```python
import torch

def _softmax(x, axis=-1):
    return torch.softmax(x, dim=axis)
def _gelu(x):
    return torch.nn.functional.gelu(x, approximate="tanh")
def _silu(x):
    return torch.nn.functional.silu(x)
def _sigmoid(x):
    return torch.sigmoid(x)
def _layernorm(x, axis=-1, eps=1e-5):
    m = x.mean(dim=axis, keepdim=True)
    v = x.var(dim=axis, keepdim=True, unbiased=False)
    return (x - m) / torch.sqrt(v + eps)
def _scatter_add(tgt, idx, src, axis=0):
    return tgt.clone().index_add_(axis, idx, src)
def _segment_sum(src, seg, n):
    out = torch.zeros((n,) + src.shape[1:], dtype=src.dtype)
    return out.index_add_(0, seg, src)
def _pad(x, pw):
    flat = tuple(v for pair in reversed(pw) for v in pair)
    return torch.nn.functional.pad(x, flat)

kernel_name = 'recurrent_scan__gqa_block_cached__moe_arch_mod__prompt'

def setup_inputs():

    _w = (lambda a: (lambda t: t.to(torch.bfloat16) if t.is_floating_point() else t)(torch.as_tensor(a)))
    def _A_setup():
        B, Sq, D = 1, 2048, 576
        Hq, Hkv, Sk, Dh = 32, 16, 2048, 128
        assert Hq % Hkv == 0, (Hq, Hkv)
        return {
            "x": _w((lambda *s: torch.randn(*s, dtype=torch.bfloat16) * 0.05)(B, Sq, D)),
            "k_cache": _w((lambda *s: torch.randn(*s, dtype=torch.bfloat16) * 0.8)(B, Hkv, Sk, Dh)),
            "v_cache": _w((lambda *s: torch.randn(*s, dtype=torch.bfloat16) * 0.2)(B, Hkv, Sk, Dh)),
            "wq": _w((lambda *s: torch.randn(*s, dtype=torch.bfloat16) * 0.8)(D, Hq * Dh) * (D ** -0.5)),
            "wo": _w((lambda *s: torch.randn(*s, dtype=torch.bfloat16) * 0.2)(Hq * Dh, D) * ((Hq * Dh) ** -0.5)),
        }
    _A_in = _A_setup()

    def _B_setup():
        B, S, D, F, C = 1, 2048, 576, 4608, 8
        return {
            "x": _w((lambda *s: torch.randn(*s, dtype=torch.bfloat16) * 0.05)(B, S, D)),
            "w_r": _w((lambda *s: torch.randn(*s, dtype=torch.bfloat16) * 0.2)(D)),
            "w_gate": _w((lambda *s: torch.randn(*s, dtype=torch.bfloat16) * 0.1)(D, F)),
            "w_up": _w((lambda *s: torch.randn(*s, dtype=torch.bfloat16) * 0.1)(D, F)),
            "w_down": _w((lambda *s: torch.randn(*s, dtype=torch.bfloat16) * 0.1)(F, D)),
        }
    _B_in = _B_setup()

    return {
        "A_x": _A_in["x"],
        "A_k_cache": _A_in["k_cache"],
        "A_v_cache": _A_in["v_cache"],
        "A_wq": _A_in["wq"],
        "A_wo": _A_in["wo"],
        "B_x": _B_in["x"],
        "B_w_r": _B_in["w_r"],
        "B_w_gate": _B_in["w_gate"],
        "B_w_up": _B_in["w_up"],
        "B_w_down": _B_in["w_down"],
    }

def reference(A_x, A_k_cache, A_v_cache, A_wq, A_wo, B_x, B_w_r, B_w_gate, B_w_up, B_w_down):
    def _A_ref(x, k_cache, v_cache, wq, wo):
        B, Sq, D = x.shape
        Hq, Dh = 32, 128
        Hkv = k_cache.shape[1]
        rep = Hq // Hkv
        q = (lambda x, *d: x.permute(*d))((x @ wq).reshape(B, Sq, Hq, Dh), 0, 2, 1, 3)
        k = (lambda x, n, axis: torch.repeat_interleave(x, n, dim=axis))(k_cache, rep, axis=1)
        v = (lambda x, n, axis: torch.repeat_interleave(x, n, dim=axis))(v_cache, rep, axis=1)
        scores = torch.einsum("bhqd,bhkd->bhqk", q, k) * (Dh ** -0.5)
        p = _softmax(scores, axis=-1)
        o = torch.einsum("bhqk,bhkd->bhqd", p, v)
        return (lambda x, *d: x.permute(*d))(o, 0, 2, 1, 3).reshape(B, Sq, Hq * Dh) @ wo

    def _B_ref(x, w_r, w_gate, w_up, w_down):
        B, S, D = x.shape
        C = 8
        r = x @ w_r
        idx = torch.argsort(-r, axis=-1)[:, :C]
        idx_e = (lambda x, n, axis: torch.repeat_interleave(x, n, dim=axis))(idx.reshape(B, C, 1), D, axis=2)
        x_sel = (lambda x, i, axis: torch.take_along_dim(x, i, dim=axis))(x, idx_e, axis=1)
        g = _silu(x_sel @ w_gate)
        u = x_sel @ w_up
        y = (g * u) @ w_down
        r_sel = _sigmoid((lambda x, i, axis: torch.take_along_dim(x, i, dim=axis))(r, idx, axis=1))
        y = y * r_sel.reshape(B, C, 1)
        b_off = (torch.arange(B) * S).reshape(B, 1)
        flat_idx = (idx + b_off).reshape(B * C)
        zero = (x * 0.0).reshape(B * S, D)
        upd = _scatter_add(zero, flat_idx, y.reshape(B * C, D), axis=0)
        return x + upd.reshape(B, S, D)

    x = A_x
    xn = _layernorm(x, axis=-1)
    s = _A_ref(xn, A_k_cache, A_v_cache, A_wq, A_wo)
    g = _silu(_B_ref(xn, B_w_r, B_w_gate, B_w_up, B_w_down))
    return x + s * g
```

```asm
; @launch grid=(256,1,1) block=(256,1,1) lds=163840
.amdgcn_target "amdgcn-amd-amdhsa--gfx950"
.text
.globl recurrent_scan__gqa_block_cached__moe_arch_mod__prompt_kernel
.p2align 8
.type recurrent_scan__gqa_block_cached__moe_arch_mod__prompt_kernel,@function
recurrent_scan__gqa_block_cached__moe_arch_mod__prompt_kernel:
s_cmp_ge_u32 s2, 256
s_cbranch_scc1 K_END
s_mov_b32 s100, 0
s_load_dwordx16 s[64:79], s[0:1], 0
s_load_dwordx8 s[80:87], s[0:1], 64
s_load_dwordx2 s[88:89], s[0:1], 96
s_lshr_b32 s35, s2, 3
s_and_b32 s36, s2, 7
s_mul_i32 s5, s36, 9
s_lshr_b32 s5, s5, 2
s_lshl_b32 s3, s36, 8
s_lshl_b32 s28, s35, 3
s_add_u32 s3, s3, s28
v_lshrrev_b32 v5, 5, v0
v_add_u32 v5, s3, v5
v_and_b32 v6, 31, v0
v_mul_u32_u24 v7, 0x480, v5
v_lshl_add_u32 v7, v6, 2, v7
v_and_b32 v1, 63, v0
v_lshrrev_b32 v2, 6, v0
v_lshlrev_b32 v8, 2, v6
v_readfirstlane_b32 s37, v2
v_and_b32 v3, 15, v1
v_lshrrev_b32 v4, 4, v1
s_waitcnt lgkmcnt(0)
s_mov_b32 s52, s64
s_and_b32 s53, s65, 0xffff
s_mov_b32 s54, 0x240000
s_mov_b32 s55, 0x00020000
buffer_load_dword v18, v7, s[52:55], 0 offen offset:0
buffer_load_dword v19, v7, s[52:55], 0 offen offset:128
buffer_load_dword v20, v7, s[52:55], 0 offen offset:256
buffer_load_dword v21, v7, s[52:55], 0 offen offset:384
buffer_load_dword v22, v7, s[52:55], 0 offen offset:512
buffer_load_dword v23, v7, s[52:55], 0 offen offset:640
buffer_load_dword v24, v7, s[52:55], 0 offen offset:768
buffer_load_dword v25, v7, s[52:55], 0 offen offset:896
buffer_load_dword v26, v7, s[52:55], 0 offen offset:1024
s_lshl_b32 s28, s36, 9
s_add_u32 s28, s28, 0x24c000
s_load_dwordx2 s[6:7], s[88:89], s28
s_mov_b32 s92, s76
s_and_b32 s93, s77, 0xffff
s_mov_b32 s94, 0x480
s_mov_b32 s95, 0x00020000
buffer_load_dword v28, v8, s[92:95], 0 offen offset:0
buffer_load_dword v29, v8, s[92:95], 0 offen offset:128
buffer_load_dword v30, v8, s[92:95], 0 offen offset:256
buffer_load_dword v31, v8, s[92:95], 0 offen offset:384
buffer_load_dword v32, v8, s[92:95], 0 offen offset:512
buffer_load_dword v33, v8, s[92:95], 0 offen offset:640
buffer_load_dword v34, v8, s[92:95], 0 offen offset:768
buffer_load_dword v35, v8, s[92:95], 0 offen offset:896
buffer_load_dword v36, v8, s[92:95], 0 offen offset:1024
s_mov_b32 s20, s88
s_and_b32 s21, s89, 0xffff
s_mov_b32 s22, 0x8000000
s_mov_b32 s23, 0x00020000
s_lshr_b32 s45, s3, 4
s_mul_i32 s45, s45, 18432
s_and_b32 s29, s3, 15
s_lshl_b32 s29, s29, 4
s_add_u32 s45, s45, s29
v_lshrrev_b32 v9, 1, v0
v_lshlrev_b32 v9, 8, v9
v_and_b32 v10, 1, v0
v_lshl_add_u32 v9, v10, 6, v9
s_add_u32 s29, s45, 0x1800000
v_add_u32 v9, s29, v9
s_add_u32 s28, s28, 0xffffdd00
v_lshlrev_b32 v10, 6, v0
v_add_u32 v10, s28, v10
v_cmp_lt_u32 vcc, 143, v0
s_lshl_b32 s29, s3, 2
s_add_u32 s29, s29, 0x1a40000
v_cndmask_b32 v9, v9, v10, vcc
v_mov_b32 v10, s29
v_cmp_lt_u32 vcc, 147, v0
s_nop 1
v_cndmask_b32 v9, v9, v10, vcc
buffer_load_dword v176, v9, s[20:23], 0 offen sc1
s_getpc_b64 s[96:97]
PC_a:
s_sub_u32 s96, s96, PC_a-recurrent_scan__gqa_block_cached__moe_arch_mod__prompt_kernel
s_subb_u32 s97, s97, 0
s_lshl_b32 s50, s35, 2
s_add_u32 s50, s50, s37
s_min_u32 s50, s50, ((K_HOT_END-recurrent_scan__gqa_block_cached__moe_arch_mod__prompt_kernel)>>10)-1
s_lshl_b32 s50, s50, 10
v_lshlrev_b32 v11, 4, v1
v_add_u32 v11, s50, v11
global_load_dwordx4 v[172:175], v11, s[96:97]
s_mov_b32 s16, s70
s_and_b32 s17, s71, 0xffff
s_mov_b32 s18, 0x480000
s_mov_b32 s19, 0x00020000
v_add_u32 v9, 0, v4
v_lshlrev_b32 v10, 1, v9
v_xor_b32 v10, v10, v3
v_lshlrev_b32 v10, 4, v10
v_lshl_add_u32 v238, v9, 13, v10
v_add_u32 v9, 4, v4
v_lshlrev_b32 v10, 1, v9
v_xor_b32 v10, v10, v3
v_lshlrev_b32 v10, 4, v10
v_lshl_add_u32 v239, v9, 13, v10
v_subrev_u32 v239, 1024, v239
s_cmp_eq_u32 s37, 0
s_cbranch_scc1 F_NOWQ
s_sub_u32 s28, s37, 1
s_lshl_b32 s49, s28, 11
s_lshl_b32 s28, s28, 16
s_lshl_b32 s34, s35, 8
s_add_u32 s34, s34, s28
s_lshl_b32 s28, s5, 18
s_add_u32 s34, s34, s28
s_add_u32 m0, s49, 65536
s_nop 0
buffer_load_dwordx4 v238, s[16:19], s34 offen offset:0 lds
buffer_load_dwordx4 v239, s[16:19], s34 offen offset:1024 lds
s_add_u32 s34, s34, 196608
s_sub_u32 s51, s34, 4718592
s_cselect_b32 s34, s34, s51
s_add_u32 m0, s49, 71680
s_nop 0
buffer_load_dwordx4 v238, s[16:19], s34 offen offset:0 lds
buffer_load_dwordx4 v239, s[16:19], s34 offen offset:1024 lds
s_add_u32 s34, s34, 196608
s_sub_u32 s51, s34, 4718592
s_cselect_b32 s34, s34, s51
s_add_u32 m0, s49, 77824
s_nop 0
buffer_load_dwordx4 v238, s[16:19], s34 offen offset:0 lds
buffer_load_dwordx4 v239, s[16:19], s34 offen offset:1024 lds
s_add_u32 s34, s34, 196608
s_sub_u32 s51, s34, 4718592
s_cselect_b32 s34, s34, s51
s_add_u32 m0, s49, 83968
s_nop 0
buffer_load_dwordx4 v238, s[16:19], s34 offen offset:0 lds
buffer_load_dwordx4 v239, s[16:19], s34 offen offset:1024 lds
s_add_u32 s34, s34, 196608
s_sub_u32 s51, s34, 4718592
s_cselect_b32 s34, s34, s51
F_NOWQ:
s_getreg_b32 s38, hwreg(HW_REG_XCC_ID, 0, 4)
s_mov_b32 s24, s86
s_and_b32 s25, s87, 0xffff
s_mov_b32 s26, 0x100
s_mov_b32 s27, 0x00020000
v_and_b32 v66, 7, v1
v_mul_u32_u24 v67, 1168, v66
v_lshrrev_b32 v68, 5, v1
v_lshl_add_u32 v67, v68, 6, v67
v_bfe_u32 v69, v1, 3, 2
v_lshl_add_u32 v67, v69, 3, v67
s_lshl_b32 s28, s37, 7
s_add_u32 s28, s28, 0x24000
v_add_u32 v168, s28, v67
v_lshlrev_b32 v70, 10, v68
v_lshl_add_u32 v71, v69, 4, v66
v_lshl_add_u32 v169, v71, 4, v70
s_mov_b32 s76, 0x3ae38e39
s_mov_b32 s77, 0x3727c5ac
s_mov_b32 s75, 0xffff0000
s_cmp_eq_u32 s37, 0
s_cbranch_scc0 F_W1
s_waitcnt vmcnt(2)
F_W1:
s_waitcnt vmcnt(10)
v_lshlrev_b32 v40, 16, v18
v_and_b32 v41, s75, v18
v_lshlrev_b32 v42, 16, v19
v_and_b32 v43, s75, v19
v_lshlrev_b32 v44, 16, v20
v_and_b32 v45, s75, v20
v_lshlrev_b32 v46, 16, v21
v_and_b32 v47, s75, v21
v_lshlrev_b32 v48, 16, v22
v_and_b32 v49, s75, v22
v_lshlrev_b32 v50, 16, v23
v_and_b32 v51, s75, v23
v_lshlrev_b32 v52, 16, v24
v_and_b32 v53, s75, v24
v_lshlrev_b32 v54, 16, v25
v_and_b32 v55, s75, v25
v_lshlrev_b32 v56, 16, v26
v_and_b32 v57, s75, v26
v_add_f32 v60, v40, v41
v_add_f32 v61, v42, v43
v_add_f32 v60, v60, v44
v_add_f32 v61, v61, v45
v_add_f32 v60, v60, v46
v_add_f32 v61, v61, v47
v_add_f32 v60, v60, v48
v_add_f32 v61, v61, v49
v_add_f32 v60, v60, v50
v_add_f32 v61, v61, v51
v_add_f32 v60, v60, v52
v_add_f32 v61, v61, v53
v_add_f32 v60, v60, v54
v_add_f32 v61, v61, v55
v_add_f32 v60, v60, v56
v_add_f32 v61, v61, v57
v_add_f32 v60, v60, v61
s_nop 1
v_add_f32_dpp v61, v60, v60 row_ror:8 row_mask:0xf bank_mask:0xf
s_nop 1
v_add_f32_dpp v60, v61, v61 row_ror:4 row_mask:0xf bank_mask:0xf
s_nop 1
v_add_f32_dpp v61, v60, v60 row_ror:2 row_mask:0xf bank_mask:0xf
s_nop 1
v_add_f32_dpp v60, v61, v61 row_ror:1 row_mask:0xf bank_mask:0xf
v_mov_b32 v61, v60
s_nop 1
v_permlane16_swap_b32 v60, v61
v_add_f32 v60, v60, v61
v_mul_f32 v60, s76, v60
v_sub_f32 v62, v40, v60
v_mul_f32 v61, v62, v62
v_sub_f32 v62, v41, v60
v_mul_f32 v63, v62, v62
v_sub_f32 v62, v42, v60
v_sub_f32 v64, v43, v60
v_fmac_f32 v61, v62, v62
v_fmac_f32 v63, v64, v64
v_sub_f32 v62, v44, v60
v_sub_f32 v64, v45, v60
v_fmac_f32 v61, v62, v62
v_fmac_f32 v63, v64, v64
v_sub_f32 v62, v46, v60
v_sub_f32 v64, v47, v60
v_fmac_f32 v61, v62, v62
v_fmac_f32 v63, v64, v64
v_sub_f32 v62, v48, v60
v_sub_f32 v64, v49, v60
v_fmac_f32 v61, v62, v62
v_fmac_f32 v63, v64, v64
v_sub_f32 v62, v50, v60
v_sub_f32 v64, v51, v60
v_fmac_f32 v61, v62, v62
v_fmac_f32 v63, v64, v64
v_sub_f32 v62, v52, v60
v_sub_f32 v64, v53, v60
v_fmac_f32 v61, v62, v62
v_fmac_f32 v63, v64, v64
v_sub_f32 v62, v54, v60
v_sub_f32 v64, v55, v60
v_fmac_f32 v61, v62, v62
v_fmac_f32 v63, v64, v64
v_sub_f32 v62, v56, v60
v_sub_f32 v64, v57, v60
v_fmac_f32 v61, v62, v62
v_fmac_f32 v63, v64, v64
v_add_f32 v61, v61, v63
s_nop 1
v_add_f32_dpp v62, v61, v61 row_ror:8 row_mask:0xf bank_mask:0xf
s_nop 1
v_add_f32_dpp v61, v62, v62 row_ror:4 row_mask:0xf bank_mask:0xf
s_nop 1
v_add_f32_dpp v62, v61, v61 row_ror:2 row_mask:0xf bank_mask:0xf
s_nop 1
v_add_f32_dpp v61, v62, v62 row_ror:1 row_mask:0xf bank_mask:0xf
v_mov_b32 v62, v61
s_nop 1
v_permlane16_swap_b32 v61, v62
v_add_f32 v61, v61, v62
v_mul_f32 v61, s76, v61
v_cvt_pk_bf16_f32 v60, v60, v60
v_lshlrev_b32 v60, 16, v60
v_cvt_pk_bf16_f32 v61, v61, v61
v_lshlrev_b32 v61, 16, v61
v_add_f32 v61, s77, v61
v_cvt_pk_bf16_f32 v61, v61, v61
v_lshlrev_b32 v61, 16, v61
v_sqrt_f32 v61, v61
s_nop 0
v_cvt_pk_bf16_f32 v61, v61, v61
v_lshlrev_b32 v61, 16, v61
v_rcp_f32 v62, v61
v_mov_b32 v63, 0
v_lshrrev_b32 v69, 5, v0
v_mul_u32_u24 v65, 1168, v69
v_lshl_add_u32 v65, v6, 2, v65
v_add_u32 v65, 0x24000, v65
v_sub_f32 v40, v40, v60
v_sub_f32 v41, v41, v60
v_cvt_pk_bf16_f32 v66, v40, v41
v_lshlrev_b32 v40, 16, v66
v_and_b32 v41, s75, v66
v_mul_f32 v67, v40, v62
v_mul_f32 v68, v41, v62
v_fma_f32 v40, -v67, v61, v40
v_fma_f32 v41, -v68, v61, v41
v_fmac_f32 v67, v40, v62
v_fmac_f32 v68, v41, v62
v_cvt_pk_bf16_f32 v18, v67, v68
v_dot2_f32_bf16 v63, v18, v28, v63
ds_write_b32 v65, v18 offset:0
v_sub_f32 v42, v42, v60
v_sub_f32 v43, v43, v60
v_cvt_pk_bf16_f32 v66, v42, v43
v_lshlrev_b32 v42, 16, v66
v_and_b32 v43, s75, v66
v_mul_f32 v67, v42, v62
v_mul_f32 v68, v43, v62
v_fma_f32 v42, -v67, v61, v42
v_fma_f32 v43, -v68, v61, v43
v_fmac_f32 v67, v42, v62
v_fmac_f32 v68, v43, v62
v_cvt_pk_bf16_f32 v19, v67, v68
v_dot2_f32_bf16 v63, v19, v29, v63
ds_write_b32 v65, v19 offset:128
v_sub_f32 v44, v44, v60
v_sub_f32 v45, v45, v60
v_cvt_pk_bf16_f32 v66, v44, v45
v_lshlrev_b32 v44, 16, v66
v_and_b32 v45, s75, v66
v_mul_f32 v67, v44, v62
v_mul_f32 v68, v45, v62
v_fma_f32 v44, -v67, v61, v44
v_fma_f32 v45, -v68, v61, v45
v_fmac_f32 v67, v44, v62
v_fmac_f32 v68, v45, v62
v_cvt_pk_bf16_f32 v20, v67, v68
v_dot2_f32_bf16 v63, v20, v30, v63
ds_write_b32 v65, v20 offset:256
v_sub_f32 v46, v46, v60
v_sub_f32 v47, v47, v60
v_cvt_pk_bf16_f32 v66, v46, v47
v_lshlrev_b32 v46, 16, v66
v_and_b32 v47, s75, v66
v_mul_f32 v67, v46, v62
v_mul_f32 v68, v47, v62
v_fma_f32 v46, -v67, v61, v46
v_fma_f32 v47, -v68, v61, v47
v_fmac_f32 v67, v46, v62
v_fmac_f32 v68, v47, v62
v_cvt_pk_bf16_f32 v21, v67, v68
v_dot2_f32_bf16 v63, v21, v31, v63
ds_write_b32 v65, v21 offset:384
v_sub_f32 v48, v48, v60
v_sub_f32 v49, v49, v60
v_cvt_pk_bf16_f32 v66, v48, v49
v_lshlrev_b32 v48, 16, v66
v_and_b32 v49, s75, v66
v_mul_f32 v67, v48, v62
v_mul_f32 v68, v49, v62
v_fma_f32 v48, -v67, v61, v48
v_fma_f32 v49, -v68, v61, v49
v_fmac_f32 v67, v48, v62
v_fmac_f32 v68, v49, v62
v_cvt_pk_bf16_f32 v22, v67, v68
v_dot2_f32_bf16 v63, v22, v32, v63
ds_write_b32 v65, v22 offset:512
v_sub_f32 v50, v50, v60
v_sub_f32 v51, v51, v60
v_cvt_pk_bf16_f32 v66, v50, v51
v_lshlrev_b32 v50, 16, v66
v_and_b32 v51, s75, v66
v_mul_f32 v67, v50, v62
v_mul_f32 v68, v51, v62
v_fma_f32 v50, -v67, v61, v50
v_fma_f32 v51, -v68, v61, v51
v_fmac_f32 v67, v50, v62
v_fmac_f32 v68, v51, v62
v_cvt_pk_bf16_f32 v23, v67, v68
v_dot2_f32_bf16 v63, v23, v33, v63
ds_write_b32 v65, v23 offset:640
v_sub_f32 v52, v52, v60
v_sub_f32 v53, v53, v60
v_cvt_pk_bf16_f32 v66, v52, v53
v_lshlrev_b32 v52, 16, v66
v_and_b32 v53, s75, v66
v_mul_f32 v67, v52, v62
v_mul_f32 v68, v53, v62
v_fma_f32 v52, -v67, v61, v52
v_fma_f32 v53, -v68, v61, v53
v_fmac_f32 v67, v52, v62
v_fmac_f32 v68, v53, v62
v_cvt_pk_bf16_f32 v24, v67, v68
v_dot2_f32_bf16 v63, v24, v34, v63
ds_write_b32 v65, v24 offset:768
v_sub_f32 v54, v54, v60
v_sub_f32 v55, v55, v60
v_cvt_pk_bf16_f32 v66, v54, v55
v_lshlrev_b32 v54, 16, v66
v_and_b32 v55, s75, v66
v_mul_f32 v67, v54, v62
v_mul_f32 v68, v55, v62
v_fma_f32 v54, -v67, v61, v54
v_fma_f32 v55, -v68, v61, v55
v_fmac_f32 v67, v54, v62
v_fmac_f32 v68, v55, v62
v_cvt_pk_bf16_f32 v25, v67, v68
v_dot2_f32_bf16 v63, v25, v35, v63
ds_write_b32 v65, v25 offset:896
v_sub_f32 v56, v56, v60
v_sub_f32 v57, v57, v60
v_cvt_pk_bf16_f32 v66, v56, v57
v_lshlrev_b32 v56, 16, v66
v_and_b32 v57, s75, v66
v_mul_f32 v67, v56, v62
v_mul_f32 v68, v57, v62
v_fma_f32 v56, -v67, v61, v56
v_fma_f32 v57, -v68, v61, v57
v_fmac_f32 v67, v56, v62
v_fmac_f32 v68, v57, v62
v_cvt_pk_bf16_f32 v26, v67, v68
v_dot2_f32_bf16 v63, v26, v36, v63
ds_write_b32 v65, v26 offset:1024
s_nop 2
s_nop 1
v_add_f32_dpp v62, v63, v63 row_ror:8 row_mask:0xf bank_mask:0xf
s_nop 1
v_add_f32_dpp v63, v62, v62 row_ror:4 row_mask:0xf bank_mask:0xf
s_nop 1
v_add_f32_dpp v62, v63, v63 row_ror:2 row_mask:0xf bank_mask:0xf
s_nop 1
v_add_f32_dpp v63, v62, v62 row_ror:1 row_mask:0xf bank_mask:0xf
v_mov_b32 v62, v63
s_nop 1
v_permlane16_swap_b32 v63, v62
v_add_f32 v63, v63, v62
v_cvt_pk_bf16_f32 v63, v63, v63
v_lshlrev_b32 v63, 16, v63
v_ashrrev_i32 v66, 31, v63
v_or_b32 v66, 0x80000000, v66
v_xor_b32 v63, v63, v66
v_and_b32 v63, s75, v63
v_sub_u32 v66, 0xffff, v5
v_or_b32 v63, v63, v66
v_lshlrev_b32 v66, 2, v69
v_add_u32 v66, 0x26480, v66
ds_write_b32 v66, v63
v_and_b32 v64, 7, v1
v_lshlrev_b32 v64, 2, v64
s_waitcnt lgkmcnt(0)
s_barrier
s_cmp_eq_u32 s37, 0
s_cbranch_scc0 F_OTHER
ds_read2_b64 v[72:75], v168 offset0:0 offset1:4
ds_read2_b64 v[76:79], v168 offset0:16 offset1:20
ds_read2_b64 v[80:83], v168 offset0:32 offset1:36
ds_read2_b64 v[84:87], v168 offset0:48 offset1:52
ds_read2_b64 v[88:91], v168 offset0:64 offset1:68
ds_read2_b64 v[92:95], v168 offset0:80 offset1:84
ds_read2_b64 v[96:99], v168 offset0:96 offset1:100
ds_read2_b64 v[100:103], v168 offset0:112 offset1:116
ds_read2_b64 v[104:107], v168 offset0:128 offset1:132
v_add_u32 v65, 0x26480, v64
ds_read_b32 v65, v65
s_add_u32 s28, s45, 0x1800000
s_waitcnt lgkmcnt(9)
buffer_store_dwordx4 v[72:75], v169, s[20:23], s28 offen offset:0
s_waitcnt lgkmcnt(8)
buffer_store_dwordx4 v[76:79], v169, s[20:23], s28 offen offset:2048
s_add_u32 s28, s28, 4096
s_waitcnt lgkmcnt(7)
buffer_store_dwordx4 v[80:83], v169, s[20:23], s28 offen offset:0
s_waitcnt lgkmcnt(6)
buffer_store_dwordx4 v[84:87], v169, s[20:23], s28 offen offset:2048
s_add_u32 s28, s28, 4096
s_waitcnt lgkmcnt(5)
buffer_store_dwordx4 v[88:91], v169, s[20:23], s28 offen offset:0
s_waitcnt lgkmcnt(4)
buffer_store_dwordx4 v[92:95], v169, s[20:23], s28 offen offset:2048
s_add_u32 s28, s28, 4096
s_waitcnt lgkmcnt(3)
buffer_store_dwordx4 v[96:99], v169, s[20:23], s28 offen offset:0
s_waitcnt lgkmcnt(2)
buffer_store_dwordx4 v[100:103], v169, s[20:23], s28 offen offset:2048
s_add_u32 s28, s28, 4096
s_waitcnt lgkmcnt(1)
buffer_store_dwordx4 v[104:107], v169, s[20:23], s28 offen offset:0
s_lshl_b32 s28, s3, 2
s_add_u32 s28, s28, 0x1a40000
s_waitcnt lgkmcnt(0)
buffer_store_dword v65, v64, s[20:23], s28 offen
s_mul_i32 s6, s6, 0x9e3779b1
s_add_u32 s6, s6, 0x7f4a7c15
s_mul_i32 s7, s7, 0x85ebca6b
s_add_u32 s7, s7, 0x165667b1
s_and_b32 s29, s6, -16
s_or_b32 s29, s29, s38
v_mov_b32 v58, s29
v_mov_b32 v59, s7
s_lshl_b32 s29, s35, 3
v_mov_b32 v61, s29
s_lshl_b32 s28, s36, 9
s_add_u32 s28, s28, 0x24c100
s_waitcnt vmcnt(0)
s_mov_b64 exec, 1
buffer_store_dwordx2 v[58:59], v61, s[20:23], s28 offen
s_mov_b64 exec, -1
F_OTHER:
s_lshl_b32 s30, s37, 12
s_lshl_b32 s31, s37, 10
v_lshlrev_b32 v244, 4, v1
v_add_u32 v9, 0, v4
v_xor_b32 v9, v9, v3
v_lshlrev_b32 v9, 4, v9
v_lshl_add_u32 v9, v3, 8, v9
v_add_u32 v216, 0x10000, v9
v_add_u32 v9, 4, v4
v_xor_b32 v9, v9, v3
v_lshlrev_b32 v9, 4, v9
v_lshl_add_u32 v9, v3, 8, v9
v_add_u32 v217, 0x10000, v9
v_add_u32 v9, 8, v4
v_xor_b32 v9, v9, v3
v_lshlrev_b32 v9, 4, v9
v_lshl_add_u32 v9, v3, 8, v9
v_add_u32 v218, 0x10000, v9
v_add_u32 v9, 12, v4
v_xor_b32 v9, v9, v3
v_lshlrev_b32 v9, 4, v9
v_lshl_add_u32 v9, v3, 8, v9
v_add_u32 v219, 0x10000, v9
v_bfe_u32 v9, v1, 2, 2
v_and_b32 v10, 3, v1
v_lshl_add_u32 v11, v4, 2, v9
v_and_b32 v12, 7, v11
v_lshlrev_b32 v13, 8, v11
v_lshl_add_u32 v13, v10, 3, v13
v_add_u32 v13, 0x18000, v13
v_xor_b32 v14, 0, v12
v_lshl_add_u32 v220, v14, 5, v13
v_xor_b32 v14, 1, v12
v_lshl_add_u32 v221, v14, 5, v13
v_xor_b32 v14, 2, v12
v_lshl_add_u32 v222, v14, 5, v13
v_xor_b32 v14, 3, v12
v_lshl_add_u32 v223, v14, 5, v13
v_xor_b32 v14, 4, v12
v_lshl_add_u32 v224, v14, 5, v13
v_xor_b32 v14, 5, v12
v_lshl_add_u32 v225, v14, 5, v13
v_xor_b32 v14, 6, v12
v_lshl_add_u32 v226, v14, 5, v13
v_xor_b32 v14, 7, v12
v_lshl_add_u32 v227, v14, 5, v13
v_add_u32 v9, 0, v4
v_xor_b32 v9, v9, v3
v_lshlrev_b32 v9, 4, v9
v_lshl_add_u32 v9, v4, 8, v9
v_add_u32 v228, s30, v9
v_add_u32 v9, 4, v4
v_xor_b32 v9, v9, v3
v_lshlrev_b32 v9, 4, v9
v_lshl_add_u32 v9, v4, 8, v9
v_add_u32 v229, s30, v9
v_add_u32 v9, 8, v4
v_xor_b32 v9, v9, v3
v_lshlrev_b32 v9, 4, v9
v_lshl_add_u32 v9, v4, 8, v9
v_add_u32 v230, s30, v9
v_add_u32 v9, 12, v4
v_xor_b32 v9, v9, v3
v_lshlrev_b32 v9, 4, v9
v_lshl_add_u32 v9, v4, 8, v9
v_add_u32 v231, s30, v9
v_add_u32 v9, 0, v4
v_lshlrev_b32 v9, 1, v9
v_xor_b32 v9, v9, v3
v_lshlrev_b32 v9, 4, v9
v_lshl_add_u32 v9, v4, 8, v9
v_add_u32 v232, s30, v9
v_add_u32 v9, 4, v4
v_lshlrev_b32 v9, 1, v9
v_xor_b32 v9, v9, v3
v_lshlrev_b32 v9, 4, v9
v_lshl_add_u32 v9, v4, 8, v9
v_add_u32 v233, s30, v9
v_bfe_u32 v9, v1, 1, 1
v_lshrrev_b32 v10, 5, v1
v_cmp_eq_u32 vcc, v9, v10
v_mov_b32 v11, 0x3f803f80
s_nop 0
v_cndmask_b32 v11, 0, v11, vcc
v_and_b32 v9, 1, v1
v_cmp_eq_u32 vcc, 1, v9
v_mov_b32 v9, 0x44444444
v_mov_b32 v10, 0xeeeeeeee
v_cndmask_b32 v245, v9, v10, vcc
v_accvgpr_write_b32 a208, v11
v_accvgpr_write_b32 a209, v11
v_accvgpr_write_b32 a210, v11
v_accvgpr_write_b32 a211, v11
v_bfe_u32 v9, v1, 2, 2
v_and_b32 v10, 3, v1
v_lshl_add_u32 v11, v4, 2, v9
v_and_b32 v12, 7, v11
v_lshrrev_b32 v14, 1, v10
v_xor_b32 v14, v14, v12
v_and_b32 v15, 1, v10
v_lshlrev_b32 v15, 4, v15
v_lshl_add_u32 v15, v11, 8, v15
v_add_u32 v15, 0x10000, v15
v_xor_b32 v16, 0, v14
v_lshl_add_u32 v234, v16, 5, v15
v_xor_b32 v16, 2, v14
v_lshl_add_u32 v235, v16, 5, v15
v_xor_b32 v16, 4, v14
v_lshl_add_u32 v236, v16, 5, v15
v_xor_b32 v16, 6, v14
v_lshl_add_u32 v237, v16, 5, v15
s_lshl_b32 s50, s36, 4
s_lshl_b32 s51, s37, 2
s_add_u32 s50, s50, s51
s_lshr_b32 s29, s35, 2
s_add_u32 s28, s29, 0
s_and_b32 s28, s28, 3
s_add_u32 s28, s28, s50
s_mul_i32 s28, s28, 18432
v_add_u32 v240, s28, v244
s_add_u32 s28, s29, 1
s_and_b32 s28, s28, 3
s_add_u32 s28, s28, s50
s_mul_i32 s28, s28, 18432
v_add_u32 v241, s28, v244
s_add_u32 s28, s29, 2
s_and_b32 s28, s28, 3
s_add_u32 s28, s28, s50
s_mul_i32 s28, s28, 18432
v_add_u32 v242, s28, v244
s_add_u32 s28, s29, 3
s_and_b32 s28, s28, 3
s_add_u32 s28, s28, s50
s_mul_i32 s28, s28, 18432
v_add_u32 v243, s28, v244
s_lshl_b32 s28, s36, 5
s_add_u32 s28, s28, s35
s_lshl2_add_u32 s28, s28, s37
s_lshl_b32 s44, s28, 14
s_add_u32 s44, s44, 0x400000
s_mov_b32 s40, 0x3e0293ee
s_mov_b32 s41, 0x3e0293ee
s_mov_b32 s42, 0x5f800000
s_mov_b32 s43, 0
s_lshr_b32 s50, s35, 1
s_lshl_b32 s50, s50, 19
s_add_u32 s66, s66, s50
s_addc_u32 s67, s67, 0
s_add_u32 s68, s68, s50
s_addc_u32 s69, s69, 0
s_mov_b32 s8, s66
s_and_b32 s9, s67, 0xffff
s_mov_b32 s10, 0x80000
s_mov_b32 s11, 0x00020000
s_mov_b32 s12, s68
s_and_b32 s13, s69, 0xffff
s_mov_b32 s14, 0x80000
s_mov_b32 s15, 0x00020000
s_mov_b32 s56, s72
s_and_b32 s57, s73, 0xffff
s_mov_b32 s58, 0x480000
s_mov_b32 s59, 0x00020000
s_mov_b32 s60, s84
s_and_b32 s61, s85, 0xffff
s_mov_b32 s62, 0x240000
s_mov_b32 s63, 0x00020000
s_cmp_lt_u32 s2, 144
s_cselect_b32 s28, 5308416, 0
s_mov_b32 s64, s78
s_and_b32 s65, s79, 0xffff
s_mov_b32 s66, s28
s_mov_b32 s67, 0x00020000
s_mov_b32 s68, s80
s_and_b32 s69, s81, 0xffff
s_mov_b32 s70, s28
s_mov_b32 s71, 0x00020000
s_mov_b32 s72, s82
s_and_b32 s73, s83, 0xffff
s_mov_b32 s74, s28
s_mov_b32 s75, 0x00020000
s_mul_i32 s28, s36, 18
s_add_u32 s28, s28, s35
s_lshl_b32 s84, s28, 6
s_mul_i32 s29, s37, 147456
s_add_u32 s84, s84, s29
s_mul_i32 s85, s28, 36864
s_add_u32 s85, s85, s31
s_cmp_lt_u32 s2, 144
s_cselect_b32 s86, s31, 0x30000
s_lshr_b32 s28, s35, 2
s_mul_i32 s89, s28, 589824
s_and_b32 s28, s35, 3
s_mul_i32 s28, s28, 288
s_add_u32 s89, s89, s28
s_lshl_b32 s28, s36, 9
s_lshr_b32 s29, s35, 2
s_and_b32 s50, s35, 3
s_lshl_b32 s51, s29, 6
s_add_u32 s51, s51, s28
s_lshl_b32 s94, s50, 2
s_add_u32 s51, s51, s94
s_add_u32 s51, s51, 0x248000
v_lshlrev_b32 v170, 4, v1
v_add_u32 v170, s51, v170
s_lshl_b32 s51, s50, 7
s_add_u32 s51, s51, s28
s_lshl_b32 s94, s29, 2
s_add_u32 s51, s51, s94
s_add_u32 s51, s51, 0x249f80
v_lshlrev_b32 v61, 5, v1
v_add_u32 v61, s51, v61
v_cmp_lt_u32 vcc, 3, v1
s_nop 1
v_cndmask_b32 v170, v170, v61, vcc
s_lshl_b32 s51, s36, 5
s_add_u32 s51, s51, 0x241fe0
s_cmp_eq_u32 s35, 0
s_cselect_b32 s51, s51, 0x7fffeff0
v_lshlrev_b32 v61, 2, v1
v_add_u32 v61, s51, v61
v_cmp_lt_u32 vcc, 7, v1
s_nop 1
v_cndmask_b32 v170, v170, v61, vcc
s_cmp_eq_u32 s2, 0
s_mov_b32 s51, 0x7fffbff0
s_cselect_b32 s51, 0x242800, s51
v_lshlrev_b32 v61, 7, v1
v_add_u32 v61, s51, v61
v_cmp_lt_u32 vcc, 15, v1
s_nop 1
v_cndmask_b32 v170, v170, v61, vcc
v_mov_b32 v61, 0x7ffffff0
v_cmp_lt_u32 vcc, 17, v0
v_mov_b32 v171, 0
s_nop 0
v_cndmask_b32 v170, v170, v61, vcc
s_cmp_eq_u32 s37, 0
s_cbranch_scc1 F_JOIN
s_add_u32 m0, s49, 90112
s_nop 0
buffer_load_dwordx4 v238, s[16:19], s34 offen offset:0 lds
buffer_load_dwordx4 v239, s[16:19], s34 offen offset:1024 lds
s_add_u32 s34, s34, 196608
s_sub_u32 s51, s34, 4718592
s_cselect_b32 s34, s34, s51
s_add_u32 m0, s49, 96256
s_nop 0
buffer_load_dwordx4 v238, s[16:19], s34 offen offset:0 lds
buffer_load_dwordx4 v239, s[16:19], s34 offen offset:1024 lds
s_add_u32 s34, s34, 196608
s_sub_u32 s51, s34, 4718592
s_cselect_b32 s34, s34, s51
s_add_u32 m0, s49, 102400
s_nop 0
buffer_load_dwordx4 v238, s[16:19], s34 offen offset:0 lds
buffer_load_dwordx4 v239, s[16:19], s34 offen offset:1024 lds
s_add_u32 s34, s34, 196608
s_sub_u32 s51, s34, 4718592
s_cselect_b32 s34, s34, s51
s_add_u32 m0, s49, 108544
s_nop 0
buffer_load_dwordx4 v238, s[16:19], s34 offen offset:0 lds
buffer_load_dwordx4 v239, s[16:19], s34 offen offset:1024 lds
s_add_u32 s34, s34, 196608
s_sub_u32 s51, s34, 4718592
s_cselect_b32 s34, s34, s51
F_JOIN:
s_lshl_b32 s49, s37, 11
s_lshl_b32 s28, s37, 16
s_lshl_b32 s34, s35, 8
s_add_u32 s34, s34, s28
s_lshl_b32 s28, s5, 18
s_add_u32 s34, s34, s28
s_add_u32 s34, s34, 1572864
s_sub_u32 s51, s34, 4718592
s_cselect_b32 s34, s34, s51
v_mov_b32 v254, 0x7ffffff0
s_lshl_b32 s28, s36, 5
s_add_u32 s29, s28, s35
s_cmp_eq_u32 s37, 0
s_cselect_b32 s29, s29, 0x7ffffff0
v_writelane_b32 v254, s29, 0
s_or_b32 s29, s38, 0x20
v_mov_b32 v255, s29
s_cmp_eq_u32 s37, 0
s_cbranch_scc1 F_W0P
s_waitcnt vmcnt(0)
s_branch F_BAR2
F_W0P:
s_lshl_b32 s28, s36, 9
s_add_u32 s28, s28, 0x24c100
v_and_b32 v61, 31, v1
v_lshlrev_b32 v61, 3, v61
s_mov_b32 s51, 0
v_mov_b32 v60, 3
F_POLL:
buffer_load_dwordx2 v[62:63], v61, s[20:23], s28 offen sc0 sc1
s_waitcnt vmcnt(0)
v_cmp_ne_u64 vcc, v[62:63], v[58:59]
s_cbranch_vccnz F_NOTYET
F_GO:
v_mov_b32 v61, 156864
ds_write_b32 v61, v60
s_cmp_eq_u32 s35, 0
s_cbranch_scc0 F_NOEP
v_mov_b32 v62, s6
v_mov_b32 v63, s7
v_mov_b32 v61, 0
s_sub_u32 s28, s28, 256
s_mov_b64 exec, 1
buffer_store_dwordx2 v[62:63], v61, s[20:23], s28 offen
s_mov_b64 exec, -1
F_NOEP:
s_waitcnt lgkmcnt(0)
F_BAR2:
s_barrier
s_lshl_b32 s7, s36, 16
v_mov_b32 v246, 156864
ds_read_b32 v246, v246
s_mov_b32 s4, 0x1800000
s_mov_b32 s51, 3
Q_START:
s_lshl_b32 s28, s5, 10
s_add_u32 s28, s28, s4
s_add_u32 s6, s4, 18432
buffer_load_dwordx4 a[0:3], v240, s[20:23], s28 offen sc0 sc1
buffer_load_dwordx4 a[4:7], v241, s[20:23], s28 offen sc0 sc1
buffer_load_dwordx4 a[8:11], v242, s[20:23], s28 offen sc0 sc1
buffer_load_dwordx4 a[12:15], v243, s[20:23], s28 offen sc0 sc1
s_waitcnt lgkmcnt(0)
v_readfirstlane_b32 s48, v246
ds_read_b64_tr_b16 a[144:145], v234 offset:0
ds_read_b64_tr_b16 a[146:147], v234 offset:4096
ds_read_b64_tr_b16 a[148:149], v234 offset:8
ds_read_b64_tr_b16 a[150:151], v234 offset:4104
ds_read_b64_tr_b16 a[152:153], v235 offset:0
ds_read_b64_tr_b16 a[154:155], v235 offset:4096
ds_read_b64_tr_b16 a[156:157], v235 offset:8
ds_read_b64_tr_b16 a[158:159], v235 offset:4104
ds_read_b64_tr_b16 a[160:161], v236 offset:0
ds_read_b64_tr_b16 a[162:163], v236 offset:4096
ds_read_b64_tr_b16 a[164:165], v236 offset:8
ds_read_b64_tr_b16 a[166:167], v236 offset:4104
ds_read_b64_tr_b16 a[168:169], v237 offset:0
ds_read_b64_tr_b16 a[170:171], v237 offset:4096
ds_read_b64_tr_b16 a[172:173], v237 offset:8
ds_read_b64_tr_b16 a[174:175], v237 offset:4104
s_cmp_lt_u32 s48, s51
s_cbranch_scc1 Q_REDO
s_add_u32 s28, s28, 1024
s_cmp_lt_u32 s28, s6
s_cselect_b32 s28, s28, s4
buffer_load_dwordx4 a[16:19], v240, s[20:23], s28 offen sc0 sc1
buffer_load_dwordx4 a[20:23], v241, s[20:23], s28 offen sc0 sc1
buffer_load_dwordx4 a[24:27], v242, s[20:23], s28 offen sc0 sc1
buffer_load_dwordx4 a[28:31], v243, s[20:23], s28 offen sc0 sc1
s_add_u32 s28, s28, 1024
s_cmp_lt_u32 s28, s6
s_cselect_b32 s28, s28, s4
buffer_load_dwordx4 a[32:35], v240, s[20:23], s28 offen sc0 sc1
buffer_load_dwordx4 a[36:39], v241, s[20:23], s28 offen sc0 sc1
buffer_load_dwordx4 a[40:43], v242, s[20:23], s28 offen sc0 sc1
buffer_load_dwordx4 a[44:47], v243, s[20:23], s28 offen sc0 sc1
s_waitcnt vmcnt(8)
s_waitcnt lgkmcnt(8)
v_mfma_f32_16x16x32_bf16 v[8:11], a[144:147], a[0:3], 0
ds_read_b64_tr_b16 a[176:177], v234 offset:8192
v_mfma_f32_16x16x32_bf16 v[12:15], a[144:147], a[4:7], 0
ds_read_b64_tr_b16 a[178:179], v234 offset:12288
v_mfma_f32_16x16x32_bf16 v[16:19], a[144:147], a[8:11], 0
s_add_u32 s28, s28, 1024
s_cmp_lt_u32 s28, s6
s_cselect_b32 s28, s28, s4
v_mfma_f32_16x16x32_bf16 v[20:23], a[144:147], a[12:15], 0
ds_read_b64_tr_b16 a[180:181], v234 offset:8200
buffer_load_dwordx4 a[48:51], v240, s[20:23], s28 offen sc0 sc1
v_mfma_f32_16x16x32_bf16 v[24:27], a[148:151], a[0:3], 0
ds_read_b64_tr_b16 a[182:183], v234 offset:12296
buffer_load_dwordx4 a[52:55], v241, s[20:23], s28 offen sc0 sc1
v_mfma_f32_16x16x32_bf16 v[28:31], a[148:151], a[4:7], 0
s_lshl_b32 s29, s36, 10
s_add_u32 s29, s29, s4
v_mfma_f32_16x16x32_bf16 v[32:35], a[148:151], a[8:11], 0
ds_read_b64_tr_b16 a[184:185], v235 offset:8192
buffer_load_dwordx4 a[56:59], v242, s[20:23], s28 offen sc0 sc1
v_mfma_f32_16x16x32_bf16 v[36:39], a[148:151], a[12:15], 0
ds_read_b64_tr_b16 a[186:187], v235 offset:12288
v_mfma_f32_16x16x32_bf16 v[40:43], a[152:155], a[0:3], 0
buffer_load_dwordx4 a[60:63], v243, s[20:23], s28 offen sc0 sc1
v_mfma_f32_16x16x32_bf16 v[44:47], a[152:155], a[4:7], 0
ds_read_b64_tr_b16 a[188:189], v235 offset:8200
v_mfma_f32_16x16x32_bf16 v[48:51], a[152:155], a[8:11], 0
ds_read_b64_tr_b16 a[190:191], v235 offset:12296
v_mfma_f32_16x16x32_bf16 v[52:55], a[152:155], a[12:15], 0
s_add_u32 s28, s28, 1024
s_cmp_lt_u32 s28, s6
s_cselect_b32 s28, s28, s4
v_mfma_f32_16x16x32_bf16 v[56:59], a[156:159], a[0:3], 0
ds_read_b64_tr_b16 a[192:193], v236 offset:8192
buffer_load_dwordx4 a[64:67], v240, s[20:23], s28 offen sc0 sc1
v_mfma_f32_16x16x32_bf16 v[60:63], a[156:159], a[4:7], 0
s_add_u32 s29, s29, 0x240000
buffer_load_dwordx4 v[136:139], v244, s[20:23], s29 offen sc0 sc1
v_mfma_f32_16x16x32_bf16 v[64:67], a[156:159], a[8:11], 0
ds_read_b64_tr_b16 a[194:195], v236 offset:12288
v_mov_b32 v142, 0
v_mfma_f32_16x16x32_bf16 v[68:71], a[156:159], a[12:15], 0
ds_read_b64_tr_b16 a[196:197], v236 offset:8200
buffer_load_dwordx4 a[68:71], v241, s[20:23], s28 offen sc0 sc1
s_waitcnt lgkmcnt(8)
v_mfma_f32_16x16x32_bf16 v[72:75], a[160:163], a[0:3], 0
s_mov_b32 s90, 0x01010101
s_mov_b32 s91, 0x01010101
v_mfma_f32_16x16x32_bf16 v[76:79], a[160:163], a[4:7], 0
ds_read_b64_tr_b16 a[198:199], v236 offset:12296
buffer_load_dwordx4 a[72:75], v242, s[20:23], s28 offen sc0 sc1
v_mfma_f32_16x16x32_bf16 v[80:83], a[160:163], a[8:11], 0
ds_read_b64_tr_b16 a[200:201], v237 offset:8192
v_mfma_f32_16x16x32_bf16 v[84:87], a[160:163], a[12:15], 0
buffer_load_dwordx4 a[76:79], v243, s[20:23], s28 offen sc0 sc1
v_mfma_f32_16x16x32_bf16 v[88:91], a[164:167], a[0:3], 0
ds_read_b64_tr_b16 a[202:203], v237 offset:12288
v_mfma_f32_16x16x32_bf16 v[92:95], a[164:167], a[4:7], 0
ds_read_b64_tr_b16 a[204:205], v237 offset:8200
s_add_u32 m0, s49, 114688
v_mfma_f32_16x16x32_bf16 v[96:99], a[164:167], a[8:11], 0
v_mfma_f32_16x16x32_bf16 v[100:103], a[164:167], a[12:15], 0
ds_read_b64_tr_b16 a[206:207], v237 offset:12296
buffer_load_dwordx4 v238, s[16:19], s34 offen offset:0 lds
v_mfma_f32_16x16x32_bf16 v[104:107], a[168:171], a[0:3], 0
v_mfma_f32_16x16x32_bf16 v[108:111], a[168:171], a[4:7], 0
buffer_load_dwordx4 v239, s[16:19], s34 offen offset:1024 lds
v_mfma_f32_16x16x32_bf16 v[112:115], a[168:171], a[8:11], 0
v_mfma_f32_16x16x32_bf16 v[116:119], a[168:171], a[12:15], 0
s_add_u32 s34, s34, 262144
s_sub_u32 s51, s34, 4718592
s_cselect_b32 s34, s34, s51
v_mfma_f32_16x16x32_bf16 v[120:123], a[172:175], a[0:3], 0
v_mfma_f32_16x16x32_bf16 v[124:127], a[172:175], a[4:7], 0
v_mfma_f32_16x16x32_bf16 v[128:131], a[172:175], a[8:11], 0
v_mfma_f32_16x16x32_bf16 v[132:135], a[172:175], a[12:15], 0
s_waitcnt vmcnt(15)
v_mfma_f32_16x16x32_bf16 v[8:11], a[176:179], a[16:19], v[8:11]
ds_read_b64_tr_b16 a[144:145], v234 offset:16384
v_mfma_f32_16x16x32_bf16 v[12:15], a[176:179], a[20:23], v[12:15]
ds_read_b64_tr_b16 a[146:147], v234 offset:20480
v_mfma_f32_16x16x32_bf16 v[16:19], a[176:179], a[24:27], v[16:19]
s_add_u32 s28, s28, 1024
s_cmp_lt_u32 s28, s6
s_cselect_b32 s28, s28, s4
v_mfma_f32_16x16x32_bf16 v[20:23], a[176:179], a[28:31], v[20:23]
ds_read_b64_tr_b16 a[148:149], v234 offset:16392
buffer_load_dwordx4 a[80:83], v240, s[20:23], s28 offen sc0 sc1
s_waitcnt lgkmcnt(8)
v_mfma_f32_16x16x32_bf16 v[24:27], a[180:183], a[16:19], v[24:27]
ds_read_b64_tr_b16 a[150:151], v234 offset:20488
v_mfma_f32_16x16x32_bf16 v[28:31], a[180:183], a[20:23], v[28:31]
v_mfma_f32_16x16x32_bf16 v[32:35], a[180:183], a[24:27], v[32:35]
ds_read_b64_tr_b16 a[152:153], v235 offset:16384
buffer_load_dwordx4 a[84:87], v241, s[20:23], s28 offen sc0 sc1
v_mfma_f32_16x16x32_bf16 v[36:39], a[180:183], a[28:31], v[36:39]
ds_read_b64_tr_b16 a[154:155], v235 offset:20480
v_mfma_f32_16x16x32_bf16 v[40:43], a[184:187], a[16:19], v[40:43]
v_mfma_f32_16x16x32_bf16 v[44:47], a[184:187], a[20:23], v[44:47]
ds_read_b64_tr_b16 a[156:157], v235 offset:16392
v_mfma_f32_16x16x32_bf16 v[48:51], a[184:187], a[24:27], v[48:51]
ds_read_b64_tr_b16 a[158:159], v235 offset:20488
buffer_load_dwordx4 a[88:91], v242, s[20:23], s28 offen sc0 sc1
v_mfma_f32_16x16x32_bf16 v[52:55], a[184:187], a[28:31], v[52:55]
v_mfma_f32_16x16x32_bf16 v[56:59], a[188:191], a[16:19], v[56:59]
ds_read_b64_tr_b16 a[160:161], v236 offset:16384
v_mfma_f32_16x16x32_bf16 v[60:63], a[188:191], a[20:23], v[60:63]
buffer_load_dwordx4 a[92:95], v243, s[20:23], s28 offen sc0 sc1
v_mfma_f32_16x16x32_bf16 v[64:67], a[188:191], a[24:27], v[64:67]
ds_read_b64_tr_b16 a[162:163], v236 offset:20480
v_mfma_f32_16x16x32_bf16 v[68:71], a[188:191], a[28:31], v[68:71]
ds_read_b64_tr_b16 a[164:165], v236 offset:16392
v_mfma_f32_16x16x32_bf16 v[72:75], a[192:195], a[16:19], v[72:75]
s_add_u32 m0, s49, 122880
v_mfma_f32_16x16x32_bf16 v[76:79], a[192:195], a[20:23], v[76:79]
ds_read_b64_tr_b16 a[166:167], v236 offset:20488
v_mfma_f32_16x16x32_bf16 v[80:83], a[192:195], a[24:27], v[80:83]
ds_read_b64_tr_b16 a[168:169], v237 offset:16384
v_mfma_f32_16x16x32_bf16 v[84:87], a[192:195], a[28:31], v[84:87]
s_waitcnt vmcnt(9)
v_max3_u32 v140, v136, v137, v138
s_waitcnt lgkmcnt(8)
v_mfma_f32_16x16x32_bf16 v[88:91], a[196:199], a[16:19], v[88:91]
ds_read_b64_tr_b16 a[170:171], v237 offset:20480
buffer_load_dwordx4 v238, s[16:19], s34 offen offset:0 lds
v_mfma_f32_16x16x32_bf16 v[92:95], a[196:199], a[20:23], v[92:95]
ds_read_b64_tr_b16 a[172:173], v237 offset:16392
v_max_u32 v140, v140, v139
v_mfma_f32_16x16x32_bf16 v[96:99], a[196:199], a[24:27], v[96:99]
v_mfma_f32_16x16x32_bf16 v[100:103], a[196:199], a[28:31], v[100:103]
ds_read_b64_tr_b16 a[174:175], v237 offset:20488
buffer_load_dwordx4 v239, s[16:19], s34 offen offset:1024 lds
v_mfma_f32_16x16x32_bf16 v[104:107], a[200:203], a[16:19], v[104:107]
v_max_u32_dpp v141, v140, v140 row_ror:8 row_mask:0xf bank_mask:0xf
v_mfma_f32_16x16x32_bf16 v[108:111], a[200:203], a[20:23], v[108:111]
v_mfma_f32_16x16x32_bf16 v[112:115], a[200:203], a[24:27], v[112:115]
s_add_u32 s34, s34, 262144
s_sub_u32 s51, s34, 4718592
s_cselect_b32 s34, s34, s51
v_mfma_f32_16x16x32_bf16 v[116:119], a[200:203], a[28:31], v[116:119]
v_max_u32_dpp v140, v141, v141 row_ror:4 row_mask:0xf bank_mask:0xf
v_mfma_f32_16x16x32_bf16 v[120:123], a[204:207], a[16:19], v[120:123]
v_mfma_f32_16x16x32_bf16 v[124:127], a[204:207], a[20:23], v[124:127]
v_max_u32_dpp v141, v140, v140 row_ror:2 row_mask:0xf bank_mask:0xf
v_mfma_f32_16x16x32_bf16 v[128:131], a[204:207], a[24:27], v[128:131]
v_mfma_f32_16x16x32_bf16 v[132:135], a[204:207], a[28:31], v[132:135]
v_max_u32_dpp v140, v141, v141 row_ror:1 row_mask:0xf bank_mask:0xf
v_mov_b32 v141, v140
s_waitcnt vmcnt(17)
v_mfma_f32_16x16x32_bf16 v[8:11], a[144:147], a[32:35], v[8:11]
ds_read_b64_tr_b16 a[176:177], v234 offset:24576
v_mfma_f32_16x16x32_bf16 v[12:15], a[144:147], a[36:39], v[12:15]
ds_read_b64_tr_b16 a[178:179], v234 offset:28672
v_permlane16_swap_b32 v140, v141
v_mfma_f32_16x16x32_bf16 v[16:19], a[144:147], a[40:43], v[16:19]
s_add_u32 s28, s28, 1024
s_cmp_lt_u32 s28, s6
s_cselect_b32 s28, s28, s4
v_mfma_f32_16x16x32_bf16 v[20:23], a[144:147], a[44:47], v[20:23]
ds_read_b64_tr_b16 a[180:181], v234 offset:24584
buffer_load_dwordx4 a[96:99], v240, s[20:23], s28 offen sc0 sc1
v_mfma_f32_16x16x32_bf16 v[24:27], a[148:151], a[32:35], v[24:27]
ds_read_b64_tr_b16 a[182:183], v234 offset:28680
v_max_u32 v140, v140, v141
v_mfma_f32_16x16x32_bf16 v[28:31], a[148:151], a[36:39], v[28:31]
v_mov_b32 v141, v140
v_mfma_f32_16x16x32_bf16 v[32:35], a[148:151], a[40:43], v[32:35]
ds_read_b64_tr_b16 a[184:185], v235 offset:24576
buffer_load_dwordx4 a[100:103], v241, s[20:23], s28 offen sc0 sc1
v_mfma_f32_16x16x32_bf16 v[36:39], a[148:151], a[44:47], v[36:39]
ds_read_b64_tr_b16 a[186:187], v235 offset:28672
v_permlane32_swap_b32 v140, v141
s_waitcnt lgkmcnt(8)
v_mfma_f32_16x16x32_bf16 v[40:43], a[152:155], a[32:35], v[40:43]
v_max_u32 v140, v140, v141
v_add_u32 v142, v142, v140
v_mfma_f32_16x16x32_bf16 v[44:47], a[152:155], a[36:39], v[44:47]
ds_read_b64_tr_b16 a[188:189], v235 offset:24584
v_sub_u32 v136, v136, v140
v_mfma_f32_16x16x32_bf16 v[48:51], a[152:155], a[40:43], v[48:51]
ds_read_b64_tr_b16 a[190:191], v235 offset:28680
buffer_load_dwordx4 a[104:107], v242, s[20:23], s28 offen sc0 sc1
v_mfma_f32_16x16x32_bf16 v[52:55], a[152:155], a[44:47], v[52:55]
v_sub_u32 v137, v137, v140
v_sub_u32 v138, v138, v140
v_mfma_f32_16x16x32_bf16 v[56:59], a[156:159], a[32:35], v[56:59]
ds_read_b64_tr_b16 a[192:193], v236 offset:24576
v_sub_u32 v139, v139, v140
v_mfma_f32_16x16x32_bf16 v[60:63], a[156:159], a[36:39], v[60:63]
buffer_load_dwordx4 a[108:111], v243, s[20:23], s28 offen sc0 sc1
v_cndmask_b32 v143, v143, v142, s[90:91]
v_mfma_f32_16x16x32_bf16 v[64:67], a[156:159], a[40:43], v[64:67]
ds_read_b64_tr_b16 a[194:195], v236 offset:28672
s_lshl_b64 s[90:91], s[90:91], 1
v_mfma_f32_16x16x32_bf16 v[68:71], a[156:159], a[44:47], v[68:71]
ds_read_b64_tr_b16 a[196:197], v236 offset:24584
v_max3_u32 v140, v136, v137, v138
v_mfma_f32_16x16x32_bf16 v[72:75], a[160:163], a[32:35], v[72:75]
s_add_u32 m0, s49, 131072
v_max_u32 v140, v140, v139
v_mfma_f32_16x16x32_bf16 v[76:79], a[160:163], a[36:39], v[76:79]
ds_read_b64_tr_b16 a[198:199], v236 offset:28680
v_mfma_f32_16x16x32_bf16 v[80:83], a[160:163], a[40:43], v[80:83]
ds_read_b64_tr_b16 a[200:201], v237 offset:24576
v_max_u32_dpp v141, v140, v140 row_ror:8 row_mask:0xf bank_mask:0xf
v_mfma_f32_16x16x32_bf16 v[84:87], a[160:163], a[44:47], v[84:87]
v_mfma_f32_16x16x32_bf16 v[88:91], a[164:167], a[32:35], v[88:91]
ds_read_b64_tr_b16 a[202:203], v237 offset:28672
buffer_load_dwordx4 v238, s[16:19], s34 offen offset:0 lds
v_mfma_f32_16x16x32_bf16 v[92:95], a[164:167], a[36:39], v[92:95]
ds_read_b64_tr_b16 a[204:205], v237 offset:24584
v_max_u32_dpp v140, v141, v141 row_ror:4 row_mask:0xf bank_mask:0xf
v_mfma_f32_16x16x32_bf16 v[96:99], a[164:167], a[40:43], v[96:99]
v_mfma_f32_16x16x32_bf16 v[100:103], a[164:167], a[44:47], v[100:103]
ds_read_b64_tr_b16 a[206:207], v237 offset:28680
buffer_load_dwordx4 v239, s[16:19], s34 offen offset:1024 lds
v_mfma_f32_16x16x32_bf16 v[104:107], a[168:171], a[32:35], v[104:107]
v_max_u32_dpp v141, v140, v140 row_ror:2 row_mask:0xf bank_mask:0xf
v_mfma_f32_16x16x32_bf16 v[108:111], a[168:171], a[36:39], v[108:111]
v_mfma_f32_16x16x32_bf16 v[112:115], a[168:171], a[40:43], v[112:115]
s_add_u32 s34, s34, 262144
s_sub_u32 s51, s34, 4718592
s_cselect_b32 s34, s34, s51
v_mfma_f32_16x16x32_bf16 v[116:119], a[168:171], a[44:47], v[116:119]
v_max_u32_dpp v140, v141, v141 row_ror:1 row_mask:0xf bank_mask:0xf
v_mov_b32 v141, v140
s_waitcnt lgkmcnt(8)
v_mfma_f32_16x16x32_bf16 v[120:123], a[172:175], a[32:35], v[120:123]
v_mfma_f32_16x16x32_bf16 v[124:127], a[172:175], a[36:39], v[124:127]
v_permlane16_swap_b32 v140, v141
v_max_u32 v140, v140, v141
v_mfma_f32_16x16x32_bf16 v[128:131], a[172:175], a[40:43], v[128:131]
v_mov_b32 v141, v140
v_mfma_f32_16x16x32_bf16 v[132:135], a[172:175], a[44:47], v[132:135]
s_waitcnt vmcnt(19)
v_mfma_f32_16x16x32_bf16 v[8:11], a[176:179], a[48:51], v[8:11]
ds_read_b64_tr_b16 a[144:145], v234 offset:32768
v_permlane32_swap_b32 v140, v141
v_mfma_f32_16x16x32_bf16 v[12:15], a[176:179], a[52:55], v[12:15]
ds_read_b64_tr_b16 a[146:147], v234 offset:36864
v_max_u32 v140, v140, v141
v_mfma_f32_16x16x32_bf16 v[16:19], a[176:179], a[56:59], v[16:19]
s_add_u32 s28, s28, 1024
s_cmp_lt_u32 s28, s6
s_cselect_b32 s28, s28, s4
v_mfma_f32_16x16x32_bf16 v[20:23], a[176:179], a[60:63], v[20:23]
ds_read_b64_tr_b16 a[148:149], v234 offset:32776
buffer_load_dwordx4 a[112:115], v240, s[20:23], s28 offen sc0 sc1
v_mfma_f32_16x16x32_bf16 v[24:27], a[180:183], a[48:51], v[24:27]
ds_read_b64_tr_b16 a[150:151], v234 offset:36872
v_add_u32 v142, v142, v140
v_mfma_f32_16x16x32_bf16 v[28:31], a[180:183], a[52:55], v[28:31]
v_sub_u32 v136, v136, v140
v_sub_u32 v137, v137, v140
v_mfma_f32_16x16x32_bf16 v[32:35], a[180:183], a[56:59], v[32:35]
ds_read_b64_tr_b16 a[152:153], v235 offset:32768
buffer_load_dwordx4 a[116:119], v241, s[20:23], s28 offen sc0 sc1
v_mfma_f32_16x16x32_bf16 v[36:39], a[180:183], a[60:63], v[36:39]
ds_read_b64_tr_b16 a[154:155], v235 offset:36864
v_sub_u32 v138, v138, v140
v_mfma_f32_16x16x32_bf16 v[40:43], a[184:187], a[48:51], v[40:43]
v_sub_u32 v139, v139, v140
v_cndmask_b32 v143, v143, v142, s[90:91]
v_mfma_f32_16x16x32_bf16 v[44:47], a[184:187], a[52:55], v[44:47]
ds_read_b64_tr_b16 a[156:157], v235 offset:32776
s_lshl_b64 s[90:91], s[90:91], 1
v_mfma_f32_16x16x32_bf16 v[48:51], a[184:187], a[56:59], v[48:51]
ds_read_b64_tr_b16 a[158:159], v235 offset:36872
buffer_load_dwordx4 a[120:123], v242, s[20:23], s28 offen sc0 sc1
v_mfma_f32_16x16x32_bf16 v[52:55], a[184:187], a[60:63], v[52:55]
v_max3_u32 v140, v136, v137, v138
v_max_u32 v140, v140, v139
v_mfma_f32_16x16x32_bf16 v[56:59], a[188:191], a[48:51], v[56:59]
ds_read_b64_tr_b16 a[160:161], v236 offset:32768
v_mfma_f32_16x16x32_bf16 v[60:63], a[188:191], a[52:55], v[60:63]
buffer_load_dwordx4 a[124:127], v243, s[20:23], s28 offen sc0 sc1
v_max_u32_dpp v141, v140, v140 row_ror:8 row_mask:0xf bank_mask:0xf
v_mfma_f32_16x16x32_bf16 v[64:67], a[188:191], a[56:59], v[64:67]
ds_read_b64_tr_b16 a[162:163], v236 offset:36864
v_mfma_f32_16x16x32_bf16 v[68:71], a[188:191], a[60:63], v[68:71]
ds_read_b64_tr_b16 a[164:165], v236 offset:32776
v_max_u32_dpp v140, v141, v141 row_ror:4 row_mask:0xf bank_mask:0xf
s_waitcnt lgkmcnt(8)
v_mfma_f32_16x16x32_bf16 v[72:75], a[192:195], a[48:51], v[72:75]
s_add_u32 m0, s49, 139264
v_mfma_f32_16x16x32_bf16 v[76:79], a[192:195], a[52:55], v[76:79]
ds_read_b64_tr_b16 a[166:167], v236 offset:36872
v_max_u32_dpp v141, v140, v140 row_ror:2 row_mask:0xf bank_mask:0xf
v_mfma_f32_16x16x32_bf16 v[80:83], a[192:195], a[56:59], v[80:83]
ds_read_b64_tr_b16 a[168:169], v237 offset:32768
v_mfma_f32_16x16x32_bf16 v[84:87], a[192:195], a[60:63], v[84:87]
v_max_u32_dpp v140, v141, v141 row_ror:1 row_mask:0xf bank_mask:0xf
v_mov_b32 v141, v140
v_mfma_f32_16x16x32_bf16 v[88:91], a[196:199], a[48:51], v[88:91]
ds_read_b64_tr_b16 a[170:171], v237 offset:36864
buffer_load_dwordx4 v238, s[16:19], s34 offen offset:0 lds
v_mfma_f32_16x16x32_bf16 v[92:95], a[196:199], a[52:55], v[92:95]
ds_read_b64_tr_b16 a[172:173], v237 offset:32776
v_permlane16_swap_b32 v140, v141
v_mfma_f32_16x16x32_bf16 v[96:99], a[196:199], a[56:59], v[96:99]
v_max_u32 v140, v140, v141
v_mov_b32 v141, v140
v_mfma_f32_16x16x32_bf16 v[100:103], a[196:199], a[60:63], v[100:103]
ds_read_b64_tr_b16 a[174:175], v237 offset:36872
buffer_load_dwordx4 v239, s[16:19], s34 offen offset:1024 lds
v_mfma_f32_16x16x32_bf16 v[104:107], a[200:203], a[48:51], v[104:107]
v_permlane32_swap_b32 v140, v141
v_max_u32 v140, v140, v141
v_mfma_f32_16x16x32_bf16 v[108:111], a[200:203], a[52:55], v[108:111]
v_add_u32 v142, v142, v140
v_sub_u32 v136, v136, v140
v_mfma_f32_16x16x32_bf16 v[112:115], a[200:203], a[56:59], v[112:115]
s_add_u32 s34, s34, 262144
s_sub_u32 s51, s34, 4718592
s_cselect_b32 s34, s34, s51
v_mfma_f32_16x16x32_bf16 v[116:119], a[200:203], a[60:63], v[116:119]
v_sub_u32 v137, v137, v140
v_sub_u32 v138, v138, v140
v_mfma_f32_16x16x32_bf16 v[120:123], a[204:207], a[48:51], v[120:123]
v_sub_u32 v139, v139, v140
v_cndmask_b32 v143, v143, v142, s[90:91]
v_mfma_f32_16x16x32_bf16 v[124:127], a[204:207], a[52:55], v[124:127]
s_lshl_b64 s[90:91], s[90:91], 1
v_mfma_f32_16x16x32_bf16 v[128:131], a[204:207], a[56:59], v[128:131]
v_max3_u32 v140, v136, v137, v138
v_max_u32 v140, v140, v139
v_mfma_f32_16x16x32_bf16 v[132:135], a[204:207], a[60:63], v[132:135]
s_waitcnt vmcnt(20)
v_mfma_f32_16x16x32_bf16 v[8:11], a[144:147], a[64:67], v[8:11]
ds_read_b64_tr_b16 a[176:177], v234 offset:40960
v_max_u32_dpp v141, v140, v140 row_ror:8 row_mask:0xf bank_mask:0xf
v_mfma_f32_16x16x32_bf16 v[12:15], a[144:147], a[68:71], v[12:15]
ds_read_b64_tr_b16 a[178:179], v234 offset:45056
v_mfma_f32_16x16x32_bf16 v[16:19], a[144:147], a[72:75], v[16:19]
s_add_u32 s28, s28, 1024
s_cmp_lt_u32 s28, s6
s_cselect_b32 s28, s28, s4
v_mfma_f32_16x16x32_bf16 v[20:23], a[144:147], a[76:79], v[20:23]
ds_read_b64_tr_b16 a[180:181], v234 offset:40968
buffer_load_dwordx4 a[0:3], v240, s[20:23], s28 offen sc0 sc1
s_waitcnt lgkmcnt(8)
v_mfma_f32_16x16x32_bf16 v[24:27], a[148:151], a[64:67], v[24:27]
ds_read_b64_tr_b16 a[182:183], v234 offset:45064
v_max_u32_dpp v140, v141, v141 row_ror:4 row_mask:0xf bank_mask:0xf
v_mfma_f32_16x16x32_bf16 v[28:31], a[148:151], a[68:71], v[28:31]
v_mfma_f32_16x16x32_bf16 v[32:35], a[148:151], a[72:75], v[32:35]
ds_read_b64_tr_b16 a[184:185], v235 offset:40960
buffer_load_dwordx4 a[4:7], v241, s[20:23], s28 offen sc0 sc1
v_mfma_f32_16x16x32_bf16 v[36:39], a[148:151], a[76:79], v[36:39]
ds_read_b64_tr_b16 a[186:187], v235 offset:45056
v_max_u32_dpp v141, v140, v140 row_ror:2 row_mask:0xf bank_mask:0xf
v_mfma_f32_16x16x32_bf16 v[40:43], a[152:155], a[64:67], v[40:43]
v_mfma_f32_16x16x32_bf16 v[44:47], a[152:155], a[68:71], v[44:47]
ds_read_b64_tr_b16 a[188:189], v235 offset:40968
v_max_u32_dpp v140, v141, v141 row_ror:1 row_mask:0xf bank_mask:0xf
v_mfma_f32_16x16x32_bf16 v[48:51], a[152:155], a[72:75], v[48:51]
ds_read_b64_tr_b16 a[190:191], v235 offset:45064
buffer_load_dwordx4 a[8:11], v242, s[20:23], s28 offen sc0 sc1
v_mfma_f32_16x16x32_bf16 v[52:55], a[152:155], a[76:79], v[52:55]
v_mov_b32 v141, v140
v_mfma_f32_16x16x32_bf16 v[56:59], a[156:159], a[64:67], v[56:59]
ds_read_b64_tr_b16 a[192:193], v236 offset:40960
v_mfma_f32_16x16x32_bf16 v[60:63], a[156:159], a[68:71], v[60:63]
buffer_load_dwordx4 a[12:15], v243, s[20:23], s28 offen sc0 sc1
v_permlane16_swap_b32 v140, v141
v_mfma_f32_16x16x32_bf16 v[64:67], a[156:159], a[72:75], v[64:67]
ds_read_b64_tr_b16 a[194:195], v236 offset:45056
v_max_u32 v140, v140, v141
v_mfma_f32_16x16x32_bf16 v[68:71], a[156:159], a[76:79], v[68:71]
ds_read_b64_tr_b16 a[196:197], v236 offset:40968
v_mov_b32 v141, v140
v_mfma_f32_16x16x32_bf16 v[72:75], a[160:163], a[64:67], v[72:75]
s_add_u32 m0, s49, 0
v_mfma_f32_16x16x32_bf16 v[76:79], a[160:163], a[68:71], v[76:79]
ds_read_b64_tr_b16 a[198:199], v236 offset:45064
v_permlane32_swap_b32 v140, v141
v_mfma_f32_16x16x32_bf16 v[80:83], a[160:163], a[72:75], v[80:83]
ds_read_b64_tr_b16 a[200:201], v237 offset:40960
v_max_u32 v140, v140, v141
v_mfma_f32_16x16x32_bf16 v[84:87], a[160:163], a[76:79], v[84:87]
v_add_u32 v142, v142, v140
v_sub_u32 v136, v136, v140
s_waitcnt lgkmcnt(8)
v_mfma_f32_16x16x32_bf16 v[88:91], a[164:167], a[64:67], v[88:91]
ds_read_b64_tr_b16 a[202:203], v237 offset:45056
buffer_load_dwordx4 v238, s[16:19], s34 offen offset:0 lds
v_mfma_f32_16x16x32_bf16 v[92:95], a[164:167], a[68:71], v[92:95]
ds_read_b64_tr_b16 a[204:205], v237 offset:40968
v_sub_u32 v137, v137, v140
v_mfma_f32_16x16x32_bf16 v[96:99], a[164:167], a[72:75], v[96:99]
v_sub_u32 v138, v138, v140
v_sub_u32 v139, v139, v140
v_mfma_f32_16x16x32_bf16 v[100:103], a[164:167], a[76:79], v[100:103]
ds_read_b64_tr_b16 a[206:207], v237 offset:45064
buffer_load_dwordx4 v239, s[16:19], s34 offen offset:1024 lds
v_mfma_f32_16x16x32_bf16 v[104:107], a[168:171], a[64:67], v[104:107]
v_cndmask_b32 v143, v143, v142, s[90:91]
v_mfma_f32_16x16x32_bf16 v[108:111], a[168:171], a[68:71], v[108:111]
s_lshl_b64 s[90:91], s[90:91], 1
v_mfma_f32_16x16x32_bf16 v[112:115], a[168:171], a[72:75], v[112:115]
s_add_u32 s34, s34, 262144
s_sub_u32 s51, s34, 4718592
s_cselect_b32 s34, s34, s51
v_mfma_f32_16x16x32_bf16 v[116:119], a[168:171], a[76:79], v[116:119]
v_max3_u32 v140, v136, v137, v138
v_max_u32 v140, v140, v139
v_mfma_f32_16x16x32_bf16 v[120:123], a[172:175], a[64:67], v[120:123]
v_mfma_f32_16x16x32_bf16 v[124:127], a[172:175], a[68:71], v[124:127]
v_max_u32_dpp v141, v140, v140 row_ror:8 row_mask:0xf bank_mask:0xf
v_mfma_f32_16x16x32_bf16 v[128:131], a[172:175], a[72:75], v[128:131]
v_mfma_f32_16x16x32_bf16 v[132:135], a[172:175], a[76:79], v[132:135]
v_max_u32_dpp v140, v141, v141 row_ror:4 row_mask:0xf bank_mask:0xf
s_waitcnt vmcnt(20)
v_mfma_f32_16x16x32_bf16 v[8:11], a[176:179], a[80:83], v[8:11]
v_mfma_f32_16x16x32_bf16 v[12:15], a[176:179], a[84:87], v[12:15]
s_waitcnt vmcnt(12) lgkmcnt(0)
s_barrier
v_mfma_f32_16x16x32_bf16 v[16:19], a[176:179], a[88:91], v[16:19]
ds_read_b64_tr_b16 a[144:145], v234 offset:49152
v_max_u32_dpp v141, v140, v140 row_ror:2 row_mask:0xf bank_mask:0xf
v_mfma_f32_16x16x32_bf16 v[20:23], a[176:179], a[92:95], v[20:23]
ds_read_b64_tr_b16 a[146:147], v234 offset:53248
v_mfma_f32_16x16x32_bf16 v[24:27], a[180:183], a[80:83], v[24:27]
ds_read_b64_tr_b16 a[148:149], v234 offset:49160
v_max_u32_dpp v140, v141, v141 row_ror:1 row_mask:0xf bank_mask:0xf
v_mfma_f32_16x16x32_bf16 v[28:31], a[180:183], a[84:87], v[28:31]
s_add_u32 s28, s28, 1024
s_cmp_lt_u32 s28, s6
s_cselect_b32 s28, s28, s4
v_mfma_f32_16x16x32_bf16 v[32:35], a[180:183], a[88:91], v[32:35]
ds_read_b64_tr_b16 a[150:151], v234 offset:53256
buffer_load_dwordx4 a[16:19], v240, s[20:23], s28 offen sc0 sc1
v_mfma_f32_16x16x32_bf16 v[36:39], a[180:183], a[92:95], v[36:39]
ds_read_b64_tr_b16 a[152:153], v235 offset:49152
v_mov_b32 v141, v140
v_mfma_f32_16x16x32_bf16 v[40:43], a[184:187], a[80:83], v[40:43]
buffer_load_dwordx4 a[20:23], v241, s[20:23], s28 offen sc0 sc1
v_mfma_f32_16x16x32_bf16 v[44:47], a[184:187], a[84:87], v[44:47]
ds_read_b64_tr_b16 a[154:155], v235 offset:53248
v_permlane16_swap_b32 v140, v141
v_mfma_f32_16x16x32_bf16 v[48:51], a[184:187], a[88:91], v[48:51]
ds_read_b64_tr_b16 a[156:157], v235 offset:49160
v_max_u32 v140, v140, v141
v_mfma_f32_16x16x32_bf16 v[52:55], a[184:187], a[92:95], v[52:55]
buffer_load_dwordx4 a[24:27], v242, s[20:23], s28 offen sc0 sc1
v_mov_b32 v141, v140
v_mfma_f32_16x16x32_bf16 v[56:59], a[188:191], a[80:83], v[56:59]
ds_read_b64_tr_b16 a[158:159], v235 offset:53256
v_mfma_f32_16x16x32_bf16 v[60:63], a[188:191], a[84:87], v[60:63]
ds_read_b64_tr_b16 a[160:161], v236 offset:49152
v_permlane32_swap_b32 v140, v141
v_mfma_f32_16x16x32_bf16 v[64:67], a[188:191], a[88:91], v[64:67]
ds_read_b64_tr_b16 a[162:163], v236 offset:53248
buffer_load_dwordx4 a[28:31], v243, s[20:23], s28 offen sc0 sc1
v_mfma_f32_16x16x32_bf16 v[68:71], a[188:191], a[92:95], v[68:71]
v_max_u32 v140, v140, v141
v_add_u32 v142, v142, v140
v_mfma_f32_16x16x32_bf16 v[72:75], a[192:195], a[80:83], v[72:75]
ds_read_b64_tr_b16 a[164:165], v236 offset:49160
v_sub_u32 v136, v136, v140
v_mfma_f32_16x16x32_bf16 v[76:79], a[192:195], a[84:87], v[76:79]
ds_read_b64_tr_b16 a[166:167], v236 offset:53256
s_add_u32 m0, s49, 8192
v_mfma_f32_16x16x32_bf16 v[80:83], a[192:195], a[88:91], v[80:83]
v_sub_u32 v137, v137, v140
v_sub_u32 v138, v138, v140
v_mfma_f32_16x16x32_bf16 v[84:87], a[192:195], a[92:95], v[84:87]
ds_read_b64_tr_b16 a[168:169], v237 offset:49152
v_sub_u32 v139, v139, v140
v_mfma_f32_16x16x32_bf16 v[88:91], a[196:199], a[80:83], v[88:91]
ds_read_b64_tr_b16 a[170:171], v237 offset:53248
buffer_load_dwordx4 v238, s[16:19], s34 offen offset:0 lds
v_mfma_f32_16x16x32_bf16 v[92:95], a[196:199], a[84:87], v[92:95]
v_cndmask_b32 v143, v143, v142, s[90:91]
v_mfma_f32_16x16x32_bf16 v[96:99], a[196:199], a[88:91], v[96:99]
ds_read_b64_tr_b16 a[172:173], v237 offset:49160
s_lshl_b64 s[90:91], s[90:91], 1
v_mfma_f32_16x16x32_bf16 v[100:103], a[196:199], a[92:95], v[100:103]
ds_read_b64_tr_b16 a[174:175], v237 offset:53256
buffer_load_dwordx4 v239, s[16:19], s34 offen offset:1024 lds
v_mfma_f32_16x16x32_bf16 v[104:107], a[200:203], a[80:83], v[104:107]
v_max3_u32 v140, v136, v137, v138
v_max_u32 v140, v140, v139
v_mfma_f32_16x16x32_bf16 v[108:111], a[200:203], a[84:87], v[108:111]
v_mfma_f32_16x16x32_bf16 v[112:115], a[200:203], a[88:91], v[112:115]
s_add_u32 s34, s34, 262144
s_sub_u32 s51, s34, 4718592
s_cselect_b32 s34, s34, s51
v_mfma_f32_16x16x32_bf16 v[116:119], a[200:203], a[92:95], v[116:119]
v_max_u32_dpp v141, v140, v140 row_ror:8 row_mask:0xf bank_mask:0xf
v_mfma_f32_16x16x32_bf16 v[120:123], a[204:207], a[80:83], v[120:123]
v_mfma_f32_16x16x32_bf16 v[124:127], a[204:207], a[84:87], v[124:127]
v_max_u32_dpp v140, v141, v141 row_ror:4 row_mask:0xf bank_mask:0xf
v_mfma_f32_16x16x32_bf16 v[128:131], a[204:207], a[88:91], v[128:131]
v_mfma_f32_16x16x32_bf16 v[132:135], a[204:207], a[92:95], v[132:135]
v_max_u32_dpp v141, v140, v140 row_ror:2 row_mask:0xf bank_mask:0xf
s_waitcnt vmcnt(20)
s_waitcnt lgkmcnt(8)
v_mfma_f32_16x16x32_bf16 v[8:11], a[144:147], a[96:99], v[8:11]
ds_read_b64_tr_b16 a[176:177], v234 offset:57344
v_mfma_f32_16x16x32_bf16 v[12:15], a[144:147], a[100:103], v[12:15]
ds_read_b64_tr_b16 a[178:179], v234 offset:61440
v_max_u32_dpp v140, v141, v141 row_ror:1 row_mask:0xf bank_mask:0xf
v_mfma_f32_16x16x32_bf16 v[16:19], a[144:147], a[104:107], v[16:19]
s_add_u32 s28, s28, 1024
s_cmp_lt_u32 s28, s6
s_cselect_b32 s28, s28, s4
v_mfma_f32_16x16x32_bf16 v[20:23], a[144:147], a[108:111], v[20:23]
ds_read_b64_tr_b16 a[180:181], v234 offset:57352
buffer_load_dwordx4 a[32:35], v240, s[20:23], s28 offen sc0 sc1
v_mfma_f32_16x16x32_bf16 v[24:27], a[148:151], a[96:99], v[24:27]
ds_read_b64_tr_b16 a[182:183], v234 offset:61448
v_mov_b32 v141, v140
v_mfma_f32_16x16x32_bf16 v[28:31], a[148:151], a[100:103], v[28:31]
v_mfma_f32_16x16x32_bf16 v[32:35], a[148:151], a[104:107], v[32:35]
ds_read_b64_tr_b16 a[184:185], v235 offset:57344
buffer_load_dwordx4 a[36:39], v241, s[20:23], s28 offen sc0 sc1
v_mfma_f32_16x16x32_bf16 v[36:39], a[148:151], a[108:111], v[36:39]
ds_read_b64_tr_b16 a[186:187], v235 offset:61440
v_permlane16_swap_b32 v140, v141
v_mfma_f32_16x16x32_bf16 v[40:43], a[152:155], a[96:99], v[40:43]
v_max_u32 v140, v140, v141
v_mov_b32 v141, v140
v_mfma_f32_16x16x32_bf16 v[44:47], a[152:155], a[100:103], v[44:47]
ds_read_b64_tr_b16 a[188:189], v235 offset:57352
v_mfma_f32_16x16x32_bf16 v[48:51], a[152:155], a[104:107], v[48:51]
ds_read_b64_tr_b16 a[190:191], v235 offset:61448
buffer_load_dwordx4 a[40:43], v242, s[20:23], s28 offen sc0 sc1
v_mfma_f32_16x16x32_bf16 v[52:55], a[152:155], a[108:111], v[52:55]
v_permlane32_swap_b32 v140, v141
v_max_u32 v140, v140, v141
v_mfma_f32_16x16x32_bf16 v[56:59], a[156:159], a[96:99], v[56:59]
ds_read_b64_tr_b16 a[192:193], v236 offset:57344
v_add_u32 v142, v142, v140
v_mfma_f32_16x16x32_bf16 v[60:63], a[156:159], a[100:103], v[60:63]
buffer_load_dwordx4 a[44:47], v243, s[20:23], s28 offen sc0 sc1
v_sub_u32 v136, v136, v140
v_mfma_f32_16x16x32_bf16 v[64:67], a[156:159], a[104:107], v[64:67]
ds_read_b64_tr_b16 a[194:195], v236 offset:61440
v_sub_u32 v137, v137, v140
v_mfma_f32_16x16x32_bf16 v[68:71], a[156:159], a[108:111], v[68:71]
ds_read_b64_tr_b16 a[196:197], v236 offset:57352
v_sub_u32 v138, v138, v140
s_waitcnt lgkmcnt(8)
v_mfma_f32_16x16x32_bf16 v[72:75], a[160:163], a[96:99], v[72:75]
s_add_u32 m0, s49, 16384
v_sub_u32 v139, v139, v140
v_mfma_f32_16x16x32_bf16 v[76:79], a[160:163], a[100:103], v[76:79]
ds_read_b64_tr_b16 a[198:199], v236 offset:61448
v_cndmask_b32 v143, v143, v142, s[90:91]
v_mfma_f32_16x16x32_bf16 v[80:83], a[160:163], a[104:107], v[80:83]
ds_read_b64_tr_b16 a[200:201], v237 offset:57344
s_lshl_b64 s[90:91], s[90:91], 1
v_mfma_f32_16x16x32_bf16 v[84:87], a[160:163], a[108:111], v[84:87]
v_max3_u32 v140, v136, v137, v138
v_max_u32 v140, v140, v139
v_mfma_f32_16x16x32_bf16 v[88:91], a[164:167], a[96:99], v[88:91]
ds_read_b64_tr_b16 a[202:203], v237 offset:61440
buffer_load_dwordx4 v238, s[16:19], s34 offen offset:0 lds
v_mfma_f32_16x16x32_bf16 v[92:95], a[164:167], a[100:103], v[92:95]
ds_read_b64_tr_b16 a[204:205], v237 offset:57352
v_max_u32_dpp v141, v140, v140 row_ror:8 row_mask:0xf bank_mask:0xf
v_mfma_f32_16x16x32_bf16 v[96:99], a[164:167], a[104:107], v[96:99]
v_mfma_f32_16x16x32_bf16 v[100:103], a[164:167], a[108:111], v[100:103]
ds_read_b64_tr_b16 a[206:207], v237 offset:61448
buffer_load_dwordx4 v239, s[16:19], s34 offen offset:1024 lds
v_mfma_f32_16x16x32_bf16 v[104:107], a[168:171], a[96:99], v[104:107]
v_max_u32_dpp v140, v141, v141 row_ror:4 row_mask:0xf bank_mask:0xf
v_mfma_f32_16x16x32_bf16 v[108:111], a[168:171], a[100:103], v[108:111]
v_mfma_f32_16x16x32_bf16 v[112:115], a[168:171], a[104:107], v[112:115]
s_add_u32 s34, s34, 262144
s_sub_u32 s51, s34, 4718592
s_cselect_b32 s34, s34, s51
v_mfma_f32_16x16x32_bf16 v[116:119], a[168:171], a[108:111], v[116:119]
v_max_u32_dpp v141, v140, v140 row_ror:2 row_mask:0xf bank_mask:0xf
v_mfma_f32_16x16x32_bf16 v[120:123], a[172:175], a[96:99], v[120:123]
v_mfma_f32_16x16x32_bf16 v[124:127], a[172:175], a[100:103], v[124:127]
v_max_u32_dpp v140, v141, v141 row_ror:1 row_mask:0xf bank_mask:0xf
v_mov_b32 v141, v140
v_mfma_f32_16x16x32_bf16 v[128:131], a[172:175], a[104:107], v[128:131]
v_mfma_f32_16x16x32_bf16 v[132:135], a[172:175], a[108:111], v[132:135]
v_permlane16_swap_b32 v140, v141
v_max_u32 v140, v140, v141
s_waitcnt vmcnt(20)
v_mfma_f32_16x16x32_bf16 v[8:11], a[176:179], a[112:115], v[8:11]
v_add_u32 v234, 0x10000, v234
v_add_u32 v235, 0x10000, v235
v_mfma_f32_16x16x32_bf16 v[12:15], a[176:179], a[116:119], v[12:15]
v_add_u32 v236, 0x10000, v236
v_add_u32 v237, 0x10000, v237
v_mfma_f32_16x16x32_bf16 v[16:19], a[176:179], a[120:123], v[16:19]
v_mov_b32 v141, v140
v_mfma_f32_16x16x32_bf16 v[20:23], a[176:179], a[124:127], v[20:23]
ds_read_b64_tr_b16 a[144:145], v234 offset:0
s_waitcnt lgkmcnt(8)
v_mfma_f32_16x16x32_bf16 v[24:27], a[180:183], a[112:115], v[24:27]
ds_read_b64_tr_b16 a[146:147], v234 offset:4096
v_permlane32_swap_b32 v140, v141
v_mfma_f32_16x16x32_bf16 v[28:31], a[180:183], a[116:119], v[28:31]
ds_read_b64_tr_b16 a[148:149], v234 offset:8
v_max_u32 v140, v140, v141
v_mfma_f32_16x16x32_bf16 v[32:35], a[180:183], a[120:123], v[32:35]
s_add_u32 s28, s28, 1024
s_cmp_lt_u32 s28, s6
s_cselect_b32 s28, s28, s4
v_mfma_f32_16x16x32_bf16 v[36:39], a[180:183], a[124:127], v[36:39]
ds_read_b64_tr_b16 a[150:151], v234 offset:4104
buffer_load_dwordx4 a[48:51], v240, s[20:23], s28 offen sc0 sc1
v_mfma_f32_16x16x32_bf16 v[40:43], a[184:187], a[112:115], v[40:43]
ds_read_b64_tr_b16 a[152:153], v235 offset:0
v_add_u32 v142, v142, v140
v_mfma_f32_16x16x32_bf16 v[44:47], a[184:187], a[116:119], v[44:47]
ds_read_b64_tr_b16 a[154:155], v235 offset:4096
buffer_load_dwordx4 a[52:55], v241, s[20:23], s28 offen sc0 sc1
v_mfma_f32_16x16x32_bf16 v[48:51], a[184:187], a[120:123], v[48:51]
v_sub_u32 v136, v136, v140
v_sub_u32 v137, v137, v140
v_mfma_f32_16x16x32_bf16 v[52:55], a[184:187], a[124:127], v[52:55]
ds_read_b64_tr_b16 a[156:157], v235 offset:8
v_sub_u32 v138, v138, v140
v_mfma_f32_16x16x32_bf16 v[56:59], a[188:191], a[112:115], v[56:59]
ds_read_b64_tr_b16 a[158:159], v235 offset:4104
buffer_load_dwordx4 a[56:59], v242, s[20:23], s28 offen sc0 sc1
v_mfma_f32_16x16x32_bf16 v[60:63], a[188:191], a[116:119], v[60:63]
v_sub_u32 v139, v139, v140
v_cndmask_b32 v143, v143, v142, s[90:91]
v_mfma_f32_16x16x32_bf16 v[64:67], a[188:191], a[120:123], v[64:67]
ds_read_b64_tr_b16 a[160:161], v236 offset:0
s_lshl_b64 s[90:91], s[90:91], 1
v_mfma_f32_16x16x32_bf16 v[68:71], a[188:191], a[124:127], v[68:71]
ds_read_b64_tr_b16 a[162:163], v236 offset:4096
buffer_load_dwordx4 a[60:63], v243, s[20:23], s28 offen sc0 sc1
s_waitcnt lgkmcnt(8)
v_mfma_f32_16x16x32_bf16 v[72:75], a[192:195], a[112:115], v[72:75]
ds_read_b64_tr_b16 a[164:165], v236 offset:8
v_max3_u32 v140, v136, v137, v138
v_mfma_f32_16x16x32_bf16 v[76:79], a[192:195], a[116:119], v[76:79]
v_max_u32 v140, v140, v139
v_mfma_f32_16x16x32_bf16 v[80:83], a[192:195], a[120:123], v[80:83]
ds_read_b64_tr_b16 a[166:167], v236 offset:4104
s_add_u32 m0, s49, 24576
v_mfma_f32_16x16x32_bf16 v[84:87], a[192:195], a[124:127], v[84:87]
ds_read_b64_tr_b16 a[168:169], v237 offset:0
v_max_u32_dpp v141, v140, v140 row_ror:8 row_mask:0xf bank_mask:0xf
v_mfma_f32_16x16x32_bf16 v[88:91], a[196:199], a[112:115], v[88:91]
ds_read_b64_tr_b16 a[170:171], v237 offset:4096
v_mfma_f32_16x16x32_bf16 v[92:95], a[196:199], a[116:119], v[92:95]
buffer_load_dwordx4 v238, s[16:19], s34 offen offset:0 lds
v_max_u32_dpp v140, v141, v141 row_ror:4 row_mask:0xf bank_mask:0xf
v_mfma_f32_16x16x32_bf16 v[96:99], a[196:199], a[120:123], v[96:99]
ds_read_b64_tr_b16 a[172:173], v237 offset:8
v_mfma_f32_16x16x32_bf16 v[100:103], a[196:199], a[124:127], v[100:103]
ds_read_b64_tr_b16 a[174:175], v237 offset:4104
v_max_u32_dpp v141, v140, v140 row_ror:2 row_mask:0xf bank_mask:0xf
v_mfma_f32_16x16x32_bf16 v[104:107], a[200:203], a[112:115], v[104:107]
buffer_load_dwordx4 v239, s[16:19], s34 offen offset:1024 lds
v_mfma_f32_16x16x32_bf16 v[108:111], a[200:203], a[116:119], v[108:111]
v_max_u32_dpp v140, v141, v141 row_ror:1 row_mask:0xf bank_mask:0xf
v_mov_b32 v141, v140
v_mfma_f32_16x16x32_bf16 v[112:115], a[200:203], a[120:123], v[112:115]
v_mfma_f32_16x16x32_bf16 v[116:119], a[200:203], a[124:127], v[116:119]
s_add_u32 s34, s34, 262144
s_sub_u32 s51, s34, 4718592
s_cselect_b32 s34, s34, s51
v_mfma_f32_16x16x32_bf16 v[120:123], a[204:207], a[112:115], v[120:123]
v_permlane16_swap_b32 v140, v141
v_max_u32 v140, v140, v141
v_mfma_f32_16x16x32_bf16 v[124:127], a[204:207], a[116:119], v[124:127]
v_mov_b32 v141, v140
v_mfma_f32_16x16x32_bf16 v[128:131], a[204:207], a[120:123], v[128:131]
v_mfma_f32_16x16x32_bf16 v[132:135], a[204:207], a[124:127], v[132:135]
v_permlane32_swap_b32 v140, v141
v_max_u32 v140, v140, v141
s_waitcnt vmcnt(20)
v_mfma_f32_16x16x32_bf16 v[8:11], a[144:147], a[0:3], v[8:11]
v_add_u32 v142, v142, v140
v_cndmask_b32 v143, v143, v142, s[90:91]
v_mfma_f32_16x16x32_bf16 v[12:15], a[144:147], a[4:7], v[12:15]
s_waitcnt vmcnt(12) lgkmcnt(0)
s_barrier
v_mfma_f32_16x16x32_bf16 v[16:19], a[144:147], a[8:11], v[16:19]
ds_read_b64_tr_b16 a[176:177], v234 offset:8192
v_mfma_f32_16x16x32_bf16 v[20:23], a[144:147], a[12:15], v[20:23]
ds_read_b64_tr_b16 a[178:179], v234 offset:12288
v_mfma_f32_16x16x32_bf16 v[24:27], a[148:151], a[0:3], v[24:27]
ds_read_b64_tr_b16 a[180:181], v234 offset:8200
v_mfma_f32_16x16x32_bf16 v[28:31], a[148:151], a[4:7], v[28:31]
s_add_u32 s28, s28, 1024
s_cmp_lt_u32 s28, s6
s_cselect_b32 s28, s28, s4
v_mfma_f32_16x16x32_bf16 v[32:35], a[148:151], a[8:11], v[32:35]
ds_read_b64_tr_b16 a[182:183], v234 offset:12296
buffer_load_dwordx4 a[64:67], v240, s[20:23], s28 offen sc0 sc1
v_mfma_f32_16x16x32_bf16 v[36:39], a[148:151], a[12:15], v[36:39]
ds_read_b64_tr_b16 a[184:185], v235 offset:8192
v_mfma_f32_16x16x32_bf16 v[40:43], a[152:155], a[0:3], v[40:43]
buffer_load_dwordx4 a[68:71], v241, s[20:23], s28 offen sc0 sc1
v_mfma_f32_16x16x32_bf16 v[44:47], a[152:155], a[4:7], v[44:47]
ds_read_b64_tr_b16 a[186:187], v235 offset:12288
v_mfma_f32_16x16x32_bf16 v[48:51], a[152:155], a[8:11], v[48:51]
ds_read_b64_tr_b16 a[188:189], v235 offset:8200
v_mfma_f32_16x16x32_bf16 v[52:55], a[152:155], a[12:15], v[52:55]
buffer_load_dwordx4 a[72:75], v242, s[20:23], s28 offen sc0 sc1
v_mfma_f32_16x16x32_bf16 v[56:59], a[156:159], a[0:3], v[56:59]
ds_read_b64_tr_b16 a[190:191], v235 offset:12296
v_mfma_f32_16x16x32_bf16 v[60:63], a[156:159], a[4:7], v[60:63]
ds_read_b64_tr_b16 a[192:193], v236 offset:8192
v_mfma_f32_16x16x32_bf16 v[64:67], a[156:159], a[8:11], v[64:67]
ds_read_b64_tr_b16 a[194:195], v236 offset:12288
buffer_load_dwordx4 a[76:79], v243, s[20:23], s28 offen sc0 sc1
v_mfma_f32_16x16x32_bf16 v[68:71], a[156:159], a[12:15], v[68:71]
v_lshlrev_b32 v136, 2, v1
v_mov_b32 v137, 0x7ffffff0
v_mfma_f32_16x16x32_bf16 v[72:75], a[160:163], a[0:3], v[72:75]
ds_read_b64_tr_b16 a[196:197], v236 offset:8200
v_cmp_lt_u32 vcc, 7, v1
v_mfma_f32_16x16x32_bf16 v[76:79], a[160:163], a[4:7], v[76:79]
ds_read_b64_tr_b16 a[198:199], v236 offset:12296
s_add_u32 m0, s49, 32768
v_mfma_f32_16x16x32_bf16 v[80:83], a[160:163], a[8:11], v[80:83]
v_cndmask_b32 v136, v136, v137, vcc
v_mfma_f32_16x16x32_bf16 v[84:87], a[160:163], a[12:15], v[84:87]
ds_read_b64_tr_b16 a[200:201], v237 offset:8192
v_mfma_f32_16x16x32_bf16 v[88:91], a[164:167], a[0:3], v[88:91]
ds_read_b64_tr_b16 a[202:203], v237 offset:12288
buffer_load_dwordx4 v238, s[16:19], s34 offen offset:0 lds
v_mfma_f32_16x16x32_bf16 v[92:95], a[164:167], a[4:7], v[92:95]
s_lshl_b32 s29, s36, 5
s_add_u32 s29, s29, 0x242000
v_mfma_f32_16x16x32_bf16 v[96:99], a[164:167], a[8:11], v[96:99]
ds_read_b64_tr_b16 a[204:205], v237 offset:8200
v_mfma_f32_16x16x32_bf16 v[100:103], a[164:167], a[12:15], v[100:103]
ds_read_b64_tr_b16 a[206:207], v237 offset:12296
buffer_load_dwordx4 v239, s[16:19], s34 offen offset:1024 lds
v_mfma_f32_16x16x32_bf16 v[104:107], a[168:171], a[0:3], v[104:107]
s_add_u32 s50, s35, s37
s_cmp_eq_u32 s50, 0
s_cselect_b32 s29, s29, 0x7ffffff0
v_mfma_f32_16x16x32_bf16 v[108:111], a[168:171], a[4:7], v[108:111]
v_mfma_f32_16x16x32_bf16 v[112:115], a[168:171], a[8:11], v[112:115]
s_add_u32 s34, s34, 262144
s_sub_u32 s51, s34, 4718592
s_cselect_b32 s34, s34, s51
v_mfma_f32_16x16x32_bf16 v[116:119], a[168:171], a[12:15], v[116:119]
v_mfma_f32_16x16x32_bf16 v[120:123], a[172:175], a[0:3], v[120:123]
v_mfma_f32_16x16x32_bf16 v[124:127], a[172:175], a[4:7], v[124:127]
v_mfma_f32_16x16x32_bf16 v[128:131], a[172:175], a[8:11], v[128:131]
v_mfma_f32_16x16x32_bf16 v[132:135], a[172:175], a[12:15], v[132:135]
s_waitcnt vmcnt(20)
s_waitcnt lgkmcnt(8)
v_mfma_f32_16x16x32_bf16 v[8:11], a[176:179], a[16:19], v[8:11]
v_add_u32 v234, 0xfffe0000, v234
v_add_u32 v235, 0xfffe0000, v235
v_mfma_f32_16x16x32_bf16 v[12:15], a[176:179], a[20:23], v[12:15]
v_add_u32 v236, 0xfffe0000, v236
v_add_u32 v237, 0xfffe0000, v237
v_mfma_f32_16x16x32_bf16 v[16:19], a[176:179], a[24:27], v[16:19]
v_mfma_f32_16x16x32_bf16 v[20:23], a[176:179], a[28:31], v[20:23]
ds_read_b64_tr_b16 a[144:145], v234 offset:0
v_mfma_f32_16x16x32_bf16 v[24:27], a[180:183], a[16:19], v[24:27]
ds_read_b64_tr_b16 a[146:147], v234 offset:4096
v_mfma_f32_16x16x32_bf16 v[28:31], a[180:183], a[20:23], v[28:31]
ds_read_b64_tr_b16 a[148:149], v234 offset:8
v_mfma_f32_16x16x32_bf16 v[32:35], a[180:183], a[24:27], v[32:35]
s_add_u32 s28, s28, 1024
s_cmp_lt_u32 s28, s6
s_cselect_b32 s28, s28, s4
v_mfma_f32_16x16x32_bf16 v[36:39], a[180:183], a[28:31], v[36:39]
ds_read_b64_tr_b16 a[150:151], v234 offset:4104
buffer_load_dwordx4 a[80:83], v240, s[20:23], s28 offen sc0 sc1
v_mfma_f32_16x16x32_bf16 v[40:43], a[184:187], a[16:19], v[40:43]
ds_read_b64_tr_b16 a[152:153], v235 offset:0
v_mfma_f32_16x16x32_bf16 v[44:47], a[184:187], a[20:23], v[44:47]
ds_read_b64_tr_b16 a[154:155], v235 offset:4096
buffer_load_dwordx4 a[84:87], v241, s[20:23], s28 offen sc0 sc1
v_mfma_f32_16x16x32_bf16 v[48:51], a[184:187], a[24:27], v[48:51]
v_mfma_f32_16x16x32_bf16 v[52:55], a[184:187], a[28:31], v[52:55]
ds_read_b64_tr_b16 a[156:157], v235 offset:8
v_mfma_f32_16x16x32_bf16 v[56:59], a[188:191], a[16:19], v[56:59]
ds_read_b64_tr_b16 a[158:159], v235 offset:4104
buffer_load_dwordx4 a[88:91], v242, s[20:23], s28 offen sc0 sc1
v_mfma_f32_16x16x32_bf16 v[60:63], a[188:191], a[20:23], v[60:63]
v_mfma_f32_16x16x32_bf16 v[64:67], a[188:191], a[24:27], v[64:67]
ds_read_b64_tr_b16 a[160:161], v236 offset:0
v_mfma_f32_16x16x32_bf16 v[68:71], a[188:191], a[28:31], v[68:71]
ds_read_b64_tr_b16 a[162:163], v236 offset:4096
buffer_load_dwordx4 a[92:95], v243, s[20:23], s28 offen sc0 sc1
s_waitcnt lgkmcnt(8)
v_mfma_f32_16x16x32_bf16 v[72:75], a[192:195], a[16:19], v[72:75]
ds_read_b64_tr_b16 a[164:165], v236 offset:8
v_mfma_f32_16x16x32_bf16 v[76:79], a[192:195], a[20:23], v[76:79]
v_mfma_f32_16x16x32_bf16 v[80:83], a[192:195], a[24:27], v[80:83]
ds_read_b64_tr_b16 a[166:167], v236 offset:4104
s_add_u32 m0, s49, 40960
v_mfma_f32_16x16x32_bf16 v[84:87], a[192:195], a[28:31], v[84:87]
ds_read_b64_tr_b16 a[168:169], v237 offset:0
v_mfma_f32_16x16x32_bf16 v[88:91], a[196:199], a[16:19], v[88:91]
ds_read_b64_tr_b16 a[170:171], v237 offset:4096
v_mfma_f32_16x16x32_bf16 v[92:95], a[196:199], a[20:23], v[92:95]
buffer_load_dwordx4 v238, s[16:19], s34 offen offset:0 lds
v_mfma_f32_16x16x32_bf16 v[96:99], a[196:199], a[24:27], v[96:99]
ds_read_b64_tr_b16 a[172:173], v237 offset:8
v_mfma_f32_16x16x32_bf16 v[100:103], a[196:199], a[28:31], v[100:103]
ds_read_b64_tr_b16 a[174:175], v237 offset:4104
v_mfma_f32_16x16x32_bf16 v[104:107], a[200:203], a[16:19], v[104:107]
buffer_load_dwordx4 v239, s[16:19], s34 offen offset:1024 lds
v_mfma_f32_16x16x32_bf16 v[108:111], a[200:203], a[20:23], v[108:111]
v_mfma_f32_16x16x32_bf16 v[112:115], a[200:203], a[24:27], v[112:115]
v_mfma_f32_16x16x32_bf16 v[116:119], a[200:203], a[28:31], v[116:119]
s_add_u32 s34, s34, 262144
s_sub_u32 s51, s34, 4718592
s_cselect_b32 s34, s34, s51
v_mfma_f32_16x16x32_bf16 v[120:123], a[204:207], a[16:19], v[120:123]
v_mfma_f32_16x16x32_bf16 v[124:127], a[204:207], a[20:23], v[124:127]
v_mfma_f32_16x16x32_bf16 v[128:131], a[204:207], a[24:27], v[128:131]
v_mfma_f32_16x16x32_bf16 v[132:135], a[204:207], a[28:31], v[132:135]
s_waitcnt vmcnt(20)
v_mfma_f32_16x16x32_bf16 v[8:11], a[144:147], a[32:35], v[8:11]
ds_read_b64_tr_b16 a[176:177], v234 offset:8192
v_mfma_f32_16x16x32_bf16 v[12:15], a[144:147], a[36:39], v[12:15]
ds_read_b64_tr_b16 a[178:179], v234 offset:12288
v_mfma_f32_16x16x32_bf16 v[16:19], a[144:147], a[40:43], v[16:19]
s_add_u32 s28, s28, 1024
s_cmp_lt_u32 s28, s6
s_cselect_b32 s28, s28, s4
v_mfma_f32_16x16x32_bf16 v[20:23], a[144:147], a[44:47], v[20:23]
ds_read_b64_tr_b16 a[180:181], v234 offset:8200
buffer_load_dwordx4 a[96:99], v240, s[20:23], s28 offen sc0 sc1
s_waitcnt lgkmcnt(8)
v_mfma_f32_16x16x32_bf16 v[24:27], a[148:151], a[32:35], v[24:27]
ds_read_b64_tr_b16 a[182:183], v234 offset:12296
v_mfma_f32_16x16x32_bf16 v[28:31], a[148:151], a[36:39], v[28:31]
v_mfma_f32_16x16x32_bf16 v[32:35], a[148:151], a[40:43], v[32:35]
ds_read_b64_tr_b16 a[184:185], v235 offset:8192
buffer_load_dwordx4 a[100:103], v241, s[20:23], s28 offen sc0 sc1
v_mfma_f32_16x16x32_bf16 v[36:39], a[148:151], a[44:47], v[36:39]
ds_read_b64_tr_b16 a[186:187], v235 offset:12288
v_mfma_f32_16x16x32_bf16 v[40:43], a[152:155], a[32:35], v[40:43]
v_mfma_f32_16x16x32_bf16 v[44:47], a[152:155], a[36:39], v[44:47]
ds_read_b64_tr_b16 a[188:189], v235 offset:8200
v_mfma_f32_16x16x32_bf16 v[48:51], a[152:155], a[40:43], v[48:51]
ds_read_b64_tr_b16 a[190:191], v235 offset:12296
buffer_load_dwordx4 a[104:107], v242, s[20:23], s28 offen sc0 sc1
v_mfma_f32_16x16x32_bf16 v[52:55], a[152:155], a[44:47], v[52:55]
v_mfma_f32_16x16x32_bf16 v[56:59], a[156:159], a[32:35], v[56:59]
ds_read_b64_tr_b16 a[192:193], v236 offset:8192
v_mfma_f32_16x16x32_bf16 v[60:63], a[156:159], a[36:39], v[60:63]
buffer_load_dwordx4 a[108:111], v243, s[20:23], s28 offen sc0 sc1
v_mfma_f32_16x16x32_bf16 v[64:67], a[156:159], a[40:43], v[64:67]
ds_read_b64_tr_b16 a[194:195], v236 offset:12288
v_mfma_f32_16x16x32_bf16 v[68:71], a[156:159], a[44:47], v[68:71]
ds_read_b64_tr_b16 a[196:197], v236 offset:8200
v_mfma_f32_16x16x32_bf16 v[72:75], a[160:163], a[32:35], v[72:75]
s_add_u32 m0, s49, 49152
v_mfma_f32_16x16x32_bf16 v[76:79], a[160:163], a[36:39], v[76:79]
ds_read_b64_tr_b16 a[198:199], v236 offset:12296
v_mfma_f32_16x16x32_bf16 v[80:83], a[160:163], a[40:43], v[80:83]
ds_read_b64_tr_b16 a[200:201], v237 offset:8192
v_mfma_f32_16x16x32_bf16 v[84:87], a[160:163], a[44:47], v[84:87]
s_waitcnt lgkmcnt(8)
v_mfma_f32_16x16x32_bf16 v[88:91], a[164:167], a[32:35], v[88:91]
ds_read_b64_tr_b16 a[202:203], v237 offset:12288
buffer_load_dwordx4 v238, s[16:19], s34 offen offset:0 lds
v_mfma_f32_16x16x32_bf16 v[92:95], a[164:167], a[36:39], v[92:95]
ds_read_b64_tr_b16 a[204:205], v237 offset:8200
v_mfma_f32_16x16x32_bf16 v[96:99], a[164:167], a[40:43], v[96:99]
v_mfma_f32_16x16x32_bf16 v[100:103], a[164:167], a[44:47], v[100:103]
ds_read_b64_tr_b16 a[206:207], v237 offset:12296
buffer_load_dwordx4 v239, s[16:19], s34 offen offset:1024 lds
v_mfma_f32_16x16x32_bf16 v[104:107], a[168:171], a[32:35], v[104:107]
v_mfma_f32_16x16x32_bf16 v[108:111], a[168:171], a[36:39], v[108:111]
v_mfma_f32_16x16x32_bf16 v[112:115], a[168:171], a[40:43], v[112:115]
s_add_u32 s34, s34, 262144
s_sub_u32 s51, s34, 4718592
s_cselect_b32 s34, s34, s51
v_mfma_f32_16x16x32_bf16 v[116:119], a[168:171], a[44:47], v[116:119]
v_mfma_f32_16x16x32_bf16 v[120:123], a[172:175], a[32:35], v[120:123]
v_mfma_f32_16x16x32_bf16 v[124:127], a[172:175], a[36:39], v[124:127]
v_mfma_f32_16x16x32_bf16 v[128:131], a[172:175], a[40:43], v[128:131]
v_mfma_f32_16x16x32_bf16 v[132:135], a[172:175], a[44:47], v[132:135]
s_waitcnt vmcnt(20)
v_mfma_f32_16x16x32_bf16 v[8:11], a[176:179], a[48:51], v[8:11]
v_mfma_f32_16x16x32_bf16 v[12:15], a[176:179], a[52:55], v[12:15]
s_waitcnt vmcnt(12) lgkmcnt(0)
s_barrier
v_mfma_f32_16x16x32_bf16 v[16:19], a[176:179], a[56:59], v[16:19]
ds_read_b64_tr_b16 a[144:145], v234 offset:16384
v_mfma_f32_16x16x32_bf16 v[20:23], a[176:179], a[60:63], v[20:23]
ds_read_b64_tr_b16 a[146:147], v234 offset:20480
v_mfma_f32_16x16x32_bf16 v[24:27], a[180:183], a[48:51], v[24:27]
ds_read_b64_tr_b16 a[148:149], v234 offset:16392
v_mfma_f32_16x16x32_bf16 v[28:31], a[180:183], a[52:55], v[28:31]
s_add_u32 s28, s28, 1024
s_cmp_lt_u32 s28, s6
s_cselect_b32 s28, s28, s4
v_mfma_f32_16x16x32_bf16 v[32:35], a[180:183], a[56:59], v[32:35]
ds_read_b64_tr_b16 a[150:151], v234 offset:20488
buffer_load_dwordx4 a[112:115], v240, s[20:23], s28 offen sc0 sc1
v_mfma_f32_16x16x32_bf16 v[36:39], a[180:183], a[60:63], v[36:39]
ds_read_b64_tr_b16 a[152:153], v235 offset:16384
v_mfma_f32_16x16x32_bf16 v[40:43], a[184:187], a[48:51], v[40:43]
buffer_load_dwordx4 a[116:119], v241, s[20:23], s28 offen sc0 sc1
v_mfma_f32_16x16x32_bf16 v[44:47], a[184:187], a[52:55], v[44:47]
ds_read_b64_tr_b16 a[154:155], v235 offset:20480
v_mfma_f32_16x16x32_bf16 v[48:51], a[184:187], a[56:59], v[48:51]
ds_read_b64_tr_b16 a[156:157], v235 offset:16392
v_mfma_f32_16x16x32_bf16 v[52:55], a[184:187], a[60:63], v[52:55]
buffer_load_dwordx4 a[120:123], v242, s[20:23], s28 offen sc0 sc1
v_mfma_f32_16x16x32_bf16 v[56:59], a[188:191], a[48:51], v[56:59]
ds_read_b64_tr_b16 a[158:159], v235 offset:20488
v_mfma_f32_16x16x32_bf16 v[60:63], a[188:191], a[52:55], v[60:63]
ds_read_b64_tr_b16 a[160:161], v236 offset:16384
v_mfma_f32_16x16x32_bf16 v[64:67], a[188:191], a[56:59], v[64:67]
ds_read_b64_tr_b16 a[162:163], v236 offset:20480
buffer_load_dwordx4 a[124:127], v243, s[20:23], s28 offen sc0 sc1
v_mfma_f32_16x16x32_bf16 v[68:71], a[188:191], a[60:63], v[68:71]
v_mfma_f32_16x16x32_bf16 v[72:75], a[192:195], a[48:51], v[72:75]
ds_read_b64_tr_b16 a[164:165], v236 offset:16392
v_mfma_f32_16x16x32_bf16 v[76:79], a[192:195], a[52:55], v[76:79]
ds_read_b64_tr_b16 a[166:167], v236 offset:20488
s_add_u32 m0, s49, 57344
v_mfma_f32_16x16x32_bf16 v[80:83], a[192:195], a[56:59], v[80:83]
v_mfma_f32_16x16x32_bf16 v[84:87], a[192:195], a[60:63], v[84:87]
ds_read_b64_tr_b16 a[168:169], v237 offset:16384
v_mfma_f32_16x16x32_bf16 v[88:91], a[196:199], a[48:51], v[88:91]
ds_read_b64_tr_b16 a[170:171], v237 offset:20480
buffer_load_dwordx4 v238, s[16:19], s34 offen offset:0 lds
v_mfma_f32_16x16x32_bf16 v[92:95], a[196:199], a[52:55], v[92:95]
v_mfma_f32_16x16x32_bf16 v[96:99], a[196:199], a[56:59], v[96:99]
ds_read_b64_tr_b16 a[172:173], v237 offset:16392
v_mfma_f32_16x16x32_bf16 v[100:103], a[196:199], a[60:63], v[100:103]
ds_read_b64_tr_b16 a[174:175], v237 offset:20488
buffer_load_dwordx4 v239, s[16:19], s34 offen offset:1024 lds
v_mfma_f32_16x16x32_bf16 v[104:107], a[200:203], a[48:51], v[104:107]
v_mfma_f32_16x16x32_bf16 v[108:111], a[200:203], a[52:55], v[108:111]
v_mfma_f32_16x16x32_bf16 v[112:115], a[200:203], a[56:59], v[112:115]
s_add_u32 s34, s34, 262144
s_sub_u32 s51, s34, 4718592
s_cselect_b32 s34, s34, s51
v_mfma_f32_16x16x32_bf16 v[116:119], a[200:203], a[60:63], v[116:119]
v_mfma_f32_16x16x32_bf16 v[120:123], a[204:207], a[48:51], v[120:123]
v_mfma_f32_16x16x32_bf16 v[124:127], a[204:207], a[52:55], v[124:127]
v_mfma_f32_16x16x32_bf16 v[128:131], a[204:207], a[56:59], v[128:131]
v_mfma_f32_16x16x32_bf16 v[132:135], a[204:207], a[60:63], v[132:135]
s_waitcnt vmcnt(20)
s_waitcnt lgkmcnt(8)
v_mfma_f32_16x16x32_bf16 v[8:11], a[144:147], a[64:67], v[8:11]
ds_read_b64_tr_b16 a[176:177], v234 offset:24576
v_mfma_f32_16x16x32_bf16 v[12:15], a[144:147], a[68:71], v[12:15]
ds_read_b64_tr_b16 a[178:179], v234 offset:28672
v_mfma_f32_16x16x32_bf16 v[16:19], a[144:147], a[72:75], v[16:19]
s_add_u32 s28, s28, 1024
s_cmp_lt_u32 s28, s6
s_cselect_b32 s28, s28, s4
v_mfma_f32_16x16x32_bf16 v[20:23], a[144:147], a[76:79], v[20:23]
ds_read_b64_tr_b16 a[180:181], v234 offset:24584
buffer_load_dwordx4 a[0:3], v240, s[20:23], s28 offen sc0 sc1
v_mfma_f32_16x16x32_bf16 v[24:27], a[148:151], a[64:67], v[24:27]
ds_read_b64_tr_b16 a[182:183], v234 offset:28680
v_mfma_f32_16x16x32_bf16 v[28:31], a[148:151], a[68:71], v[28:31]
buffer_load_dwordx4 a[4:7], v241, s[20:23], s28 offen sc0 sc1
v_mfma_f32_16x16x32_bf16 v[32:35], a[148:151], a[72:75], v[32:35]
ds_read_b64_tr_b16 a[184:185], v235 offset:24576
v_mfma_f32_16x16x32_bf16 v[36:39], a[148:151], a[76:79], v[36:39]
ds_read_b64_tr_b16 a[186:187], v235 offset:28672
v_mfma_f32_16x16x32_bf16 v[40:43], a[152:155], a[64:67], v[40:43]
buffer_load_dwordx4 a[8:11], v242, s[20:23], s28 offen sc0 sc1
v_mfma_f32_16x16x32_bf16 v[44:47], a[152:155], a[68:71], v[44:47]
ds_read_b64_tr_b16 a[188:189], v235 offset:24584
v_mfma_f32_16x16x32_bf16 v[48:51], a[152:155], a[72:75], v[48:51]
ds_read_b64_tr_b16 a[190:191], v235 offset:28680
buffer_load_dwordx4 a[12:15], v243, s[20:23], s28 offen sc0 sc1
v_mfma_f32_16x16x32_bf16 v[52:55], a[152:155], a[76:79], v[52:55]
v_mfma_f32_16x16x32_bf16 v[56:59], a[156:159], a[64:67], v[56:59]
ds_read_b64_tr_b16 a[192:193], v236 offset:24576
v_mfma_f32_16x16x32_bf16 v[60:63], a[156:159], a[68:71], v[60:63]
s_add_u32 s32, s7, 0
v_mfma_f32_16x16x32_bf16 v[64:67], a[156:159], a[72:75], v[64:67]
ds_read_b64_tr_b16 a[194:195], v236 offset:28672
v_mfma_f32_16x16x32_bf16 v[68:71], a[156:159], a[76:79], v[68:71]
ds_read_b64_tr_b16 a[196:197], v236 offset:24584
s_waitcnt lgkmcnt(8)
v_mfma_f32_16x16x32_bf16 v[72:75], a[160:163], a[64:67], v[72:75]
s_add_u32 m0, s30, 81920
v_mfma_f32_16x16x32_bf16 v[76:79], a[160:163], a[68:71], v[76:79]
ds_read_b64_tr_b16 a[198:199], v236 offset:28680
v_mfma_f32_16x16x32_bf16 v[80:83], a[160:163], a[72:75], v[80:83]
ds_read_b64_tr_b16 a[200:201], v237 offset:24576
v_mfma_f32_16x16x32_bf16 v[84:87], a[160:163], a[76:79], v[84:87]
buffer_load_dwordx4 v228, s[8:11], s32 offen offset:0 lds
v_mfma_f32_16x16x32_bf16 v[88:91], a[164:167], a[64:67], v[88:91]
ds_read_b64_tr_b16 a[202:203], v237 offset:28672
v_mfma_f32_16x16x32_bf16 v[92:95], a[164:167], a[68:71], v[92:95]
ds_read_b64_tr_b16 a[204:205], v237 offset:24584
buffer_load_dwordx4 v229, s[8:11], s32 offen offset:1024 lds
v_mfma_f32_16x16x32_bf16 v[96:99], a[164:167], a[72:75], v[96:99]
v_mfma_f32_16x16x32_bf16 v[100:103], a[164:167], a[76:79], v[100:103]
ds_read_b64_tr_b16 a[206:207], v237 offset:28680
v_mfma_f32_16x16x32_bf16 v[104:107], a[168:171], a[64:67], v[104:107]
buffer_load_dwordx4 v230, s[8:11], s32 offen offset:2048 lds
v_mfma_f32_16x16x32_bf16 v[108:111], a[168:171], a[68:71], v[108:111]
v_mfma_f32_16x16x32_bf16 v[112:115], a[168:171], a[72:75], v[112:115]
v_mfma_f32_16x16x32_bf16 v[116:119], a[168:171], a[76:79], v[116:119]
buffer_load_dwordx4 v231, s[8:11], s32 offen offset:3072 lds
v_mfma_f32_16x16x32_bf16 v[120:123], a[172:175], a[64:67], v[120:123]
v_mfma_f32_16x16x32_bf16 v[124:127], a[172:175], a[68:71], v[124:127]
v_mfma_f32_16x16x32_bf16 v[128:131], a[172:175], a[72:75], v[128:131]
v_mfma_f32_16x16x32_bf16 v[132:135], a[172:175], a[76:79], v[132:135]
s_waitcnt vmcnt(22)
v_mfma_f32_16x16x32_bf16 v[8:11], a[176:179], a[80:83], v[8:11]
ds_read_b64_tr_b16 a[144:145], v234 offset:32768
buffer_store_dword v171, v170, s[20:23], 0 offen sc0 sc1
v_mfma_f32_16x16x32_bf16 v[12:15], a[176:179], a[84:87], v[12:15]
ds_read_b64_tr_b16 a[146:147], v234 offset:36864
ds_read2_b64 v[152:155], v168 offset0:0 offset1:4
v_mfma_f32_16x16x32_bf16 v[16:19], a[176:179], a[88:91], v[16:19]
s_add_u32 s28, s28, 1024
s_cmp_lt_u32 s28, s6
s_cselect_b32 s28, s28, s4
v_mfma_f32_16x16x32_bf16 v[20:23], a[176:179], a[92:95], v[20:23]
ds_read_b64_tr_b16 a[148:149], v234 offset:32776
ds_read2_b64 v[156:159], v168 offset0:64 offset1:68
s_waitcnt lgkmcnt(8)
v_mfma_f32_16x16x32_bf16 v[24:27], a[180:183], a[80:83], v[24:27]
ds_read_b64_tr_b16 a[150:151], v234 offset:36872
ds_read2_b64 v[160:163], v168 offset0:128 offset1:132
v_mfma_f32_16x16x32_bf16 v[28:31], a[180:183], a[84:87], v[28:31]
s_lshl1_add_u32 s45, s31, s45
v_mfma_f32_16x16x32_bf16 v[32:35], a[180:183], a[88:91], v[32:35]
ds_read_b64_tr_b16 a[152:153], v235 offset:32768
buffer_load_dwordx4 a[16:19], v240, s[20:23], s28 offen sc0 sc1
v_mfma_f32_16x16x32_bf16 v[36:39], a[180:183], a[92:95], v[36:39]
ds_read_b64_tr_b16 a[154:155], v235 offset:36864
v_mfma_f32_16x16x32_bf16 v[40:43], a[184:187], a[80:83], v[40:43]
v_mfma_f32_16x16x32_bf16 v[44:47], a[184:187], a[84:87], v[44:47]
ds_read_b64_tr_b16 a[156:157], v235 offset:32776
v_mfma_f32_16x16x32_bf16 v[48:51], a[184:187], a[88:91], v[48:51]
ds_read_b64_tr_b16 a[158:159], v235 offset:36872
v_mfma_f32_16x16x32_bf16 v[52:55], a[184:187], a[92:95], v[52:55]
s_waitcnt lgkmcnt(8)
buffer_store_dwordx4 v[152:155], v169, s[20:23], s45 offen sc0 sc1
v_mfma_f32_16x16x32_bf16 v[56:59], a[188:191], a[80:83], v[56:59]
ds_read_b64_tr_b16 a[160:161], v236 offset:32768
buffer_load_dwordx4 a[20:23], v241, s[20:23], s28 offen sc0 sc1
v_mfma_f32_16x16x32_bf16 v[60:63], a[188:191], a[84:87], v[60:63]
v_mfma_f32_16x16x32_bf16 v[64:67], a[188:191], a[88:91], v[64:67]
ds_read_b64_tr_b16 a[162:163], v236 offset:36864
v_mfma_f32_16x16x32_bf16 v[68:71], a[188:191], a[92:95], v[68:71]
ds_read_b64_tr_b16 a[164:165], v236 offset:32776
v_mfma_f32_16x16x32_bf16 v[72:75], a[192:195], a[80:83], v[72:75]
v_mfma_f32_16x16x32_bf16 v[76:79], a[192:195], a[84:87], v[76:79]
ds_read_b64_tr_b16 a[166:167], v236 offset:36872
v_mfma_f32_16x16x32_bf16 v[80:83], a[192:195], a[88:91], v[80:83]
ds_read_b64_tr_b16 a[168:169], v237 offset:32768
buffer_load_dwordx4 a[24:27], v242, s[20:23], s28 offen sc0 sc1
v_mfma_f32_16x16x32_bf16 v[84:87], a[192:195], a[92:95], v[84:87]
s_waitcnt lgkmcnt(8)
s_add_u32 s45, s45, 8192
buffer_store_dwordx4 v[156:159], v169, s[20:23], s45 offen sc0 sc1
v_mfma_f32_16x16x32_bf16 v[88:91], a[196:199], a[80:83], v[88:91]
ds_read_b64_tr_b16 a[170:171], v237 offset:36864
v_mfma_f32_16x16x32_bf16 v[92:95], a[196:199], a[84:87], v[92:95]
ds_read_b64_tr_b16 a[172:173], v237 offset:32776
v_mfma_f32_16x16x32_bf16 v[96:99], a[196:199], a[88:91], v[96:99]
v_mfma_f32_16x16x32_bf16 v[100:103], a[196:199], a[92:95], v[100:103]
ds_read_b64_tr_b16 a[174:175], v237 offset:36872
v_mfma_f32_16x16x32_bf16 v[104:107], a[200:203], a[80:83], v[104:107]
buffer_load_dwordx4 a[28:31], v243, s[20:23], s28 offen sc0 sc1
v_mfma_f32_16x16x32_bf16 v[108:111], a[200:203], a[84:87], v[108:111]
s_add_u32 s45, s45, 8192
s_cmp_eq_u32 s37, 0
s_cselect_b32 s45, s45, 0x7ffffff0
buffer_store_dwordx4 v[160:163], v169, s[20:23], s45 offen sc0 sc1
v_mfma_f32_16x16x32_bf16 v[112:115], a[200:203], a[88:91], v[112:115]
v_mfma_f32_16x16x32_bf16 v[116:119], a[200:203], a[92:95], v[116:119]
v_mfma_f32_16x16x32_bf16 v[120:123], a[204:207], a[80:83], v[120:123]
v_mfma_f32_16x16x32_bf16 v[124:127], a[204:207], a[84:87], v[124:127]
v_mfma_f32_16x16x32_bf16 v[128:131], a[204:207], a[88:91], v[128:131]
v_mfma_f32_16x16x32_bf16 v[132:135], a[204:207], a[92:95], v[132:135]
s_waitcnt vmcnt(24)
v_mfma_f32_16x16x32_bf16 v[8:11], a[144:147], a[96:99], v[8:11]
v_mfma_f32_16x16x32_bf16 v[12:15], a[144:147], a[100:103], v[12:15]
s_waitcnt vmcnt(16) lgkmcnt(0)
s_barrier
v_mfma_f32_16x16x32_bf16 v[16:19], a[144:147], a[104:107], v[16:19]
ds_read_b64_tr_b16 a[176:177], v234 offset:40960
s_add_u32 s32, s7, 16384
v_mfma_f32_16x16x32_bf16 v[20:23], a[144:147], a[108:111], v[20:23]
ds_read_b64_tr_b16 a[178:179], v234 offset:45056
v_mfma_f32_16x16x32_bf16 v[24:27], a[148:151], a[96:99], v[24:27]
ds_read_b64_tr_b16 a[180:181], v234 offset:40968
v_mfma_f32_16x16x32_bf16 v[28:31], a[148:151], a[100:103], v[28:31]
v_mfma_f32_16x16x32_bf16 v[32:35], a[148:151], a[104:107], v[32:35]
ds_read_b64_tr_b16 a[182:183], v234 offset:45064
s_add_u32 m0, s30, 114688
v_mfma_f32_16x16x32_bf16 v[36:39], a[148:151], a[108:111], v[36:39]
ds_read_b64_tr_b16 a[184:185], v235 offset:40960
v_mfma_f32_16x16x32_bf16 v[40:43], a[152:155], a[96:99], v[40:43]
v_mfma_f32_16x16x32_bf16 v[44:47], a[152:155], a[100:103], v[44:47]
ds_read_b64_tr_b16 a[186:187], v235 offset:45056
v_mfma_f32_16x16x32_bf16 v[48:51], a[152:155], a[104:107], v[48:51]
ds_read_b64_tr_b16 a[188:189], v235 offset:40968
v_mfma_f32_16x16x32_bf16 v[52:55], a[152:155], a[108:111], v[52:55]
buffer_load_dwordx4 v228, s[8:11], s32 offen offset:0 lds
v_mfma_f32_16x16x32_bf16 v[56:59], a[156:159], a[96:99], v[56:59]
ds_read_b64_tr_b16 a[190:191], v235 offset:45064
v_mfma_f32_16x16x32_bf16 v[60:63], a[156:159], a[100:103], v[60:63]
ds_read_b64_tr_b16 a[192:193], v236 offset:40960
v_mfma_f32_16x16x32_bf16 v[64:67], a[156:159], a[104:107], v[64:67]
ds_read_b64_tr_b16 a[194:195], v236 offset:45056
v_mfma_f32_16x16x32_bf16 v[68:71], a[156:159], a[108:111], v[68:71]
v_mfma_f32_16x16x32_bf16 v[72:75], a[160:163], a[96:99], v[72:75]
ds_read_b64_tr_b16 a[196:197], v236 offset:40968
buffer_load_dwordx4 v229, s[8:11], s32 offen offset:1024 lds
v_mfma_f32_16x16x32_bf16 v[76:79], a[160:163], a[100:103], v[76:79]
ds_read_b64_tr_b16 a[198:199], v236 offset:45064
v_mfma_f32_16x16x32_bf16 v[80:83], a[160:163], a[104:107], v[80:83]
v_mfma_f32_16x16x32_bf16 v[84:87], a[160:163], a[108:111], v[84:87]
ds_read_b64_tr_b16 a[200:201], v237 offset:40960
v_mfma_f32_16x16x32_bf16 v[88:91], a[164:167], a[96:99], v[88:91]
ds_read_b64_tr_b16 a[202:203], v237 offset:45056
buffer_load_dwordx4 v230, s[8:11], s32 offen offset:2048 lds
v_mfma_f32_16x16x32_bf16 v[92:95], a[164:167], a[100:103], v[92:95]
v_mfma_f32_16x16x32_bf16 v[96:99], a[164:167], a[104:107], v[96:99]
ds_read_b64_tr_b16 a[204:205], v237 offset:40968
v_mfma_f32_16x16x32_bf16 v[100:103], a[164:167], a[108:111], v[100:103]
ds_read_b64_tr_b16 a[206:207], v237 offset:45064
v_mfma_f32_16x16x32_bf16 v[104:107], a[168:171], a[96:99], v[104:107]
v_mfma_f32_16x16x32_bf16 v[108:111], a[168:171], a[100:103], v[108:111]
buffer_load_dwordx4 v231, s[8:11], s32 offen offset:3072 lds
v_mfma_f32_16x16x32_bf16 v[112:115], a[168:171], a[104:107], v[112:115]
v_mfma_f32_16x16x32_bf16 v[116:119], a[168:171], a[108:111], v[116:119]
v_mfma_f32_16x16x32_bf16 v[120:123], a[172:175], a[96:99], v[120:123]
v_mfma_f32_16x16x32_bf16 v[124:127], a[172:175], a[100:103], v[124:127]
v_mfma_f32_16x16x32_bf16 v[128:131], a[172:175], a[104:107], v[128:131]
v_mfma_f32_16x16x32_bf16 v[132:135], a[172:175], a[108:111], v[132:135]
s_waitcnt vmcnt(22)
s_waitcnt lgkmcnt(8)
v_mfma_f32_16x16x32_bf16 v[8:11], a[176:179], a[112:115], v[8:11]
ds_read_b64_tr_b16 a[144:145], v234 offset:49152
v_mfma_f32_16x16x32_bf16 v[12:15], a[176:179], a[116:119], v[12:15]
ds_read_b64_tr_b16 a[146:147], v234 offset:53248
v_mfma_f32_16x16x32_bf16 v[16:19], a[176:179], a[120:123], v[16:19]
v_mfma_f32_16x16x32_bf16 v[20:23], a[176:179], a[124:127], v[20:23]
ds_read_b64_tr_b16 a[148:149], v234 offset:49160
v_mfma_f32_16x16x32_bf16 v[24:27], a[180:183], a[112:115], v[24:27]
ds_read_b64_tr_b16 a[150:151], v234 offset:53256
v_mfma_f32_16x16x32_bf16 v[28:31], a[180:183], a[116:119], v[28:31]
v_mfma_f32_16x16x32_bf16 v[32:35], a[180:183], a[120:123], v[32:35]
ds_read_b64_tr_b16 a[152:153], v235 offset:49152
v_mfma_f32_16x16x32_bf16 v[36:39], a[180:183], a[124:127], v[36:39]
ds_read_b64_tr_b16 a[154:155], v235 offset:53248
v_mfma_f32_16x16x32_bf16 v[40:43], a[184:187], a[112:115], v[40:43]
v_mfma_f32_16x16x32_bf16 v[44:47], a[184:187], a[116:119], v[44:47]
ds_read_b64_tr_b16 a[156:157], v235 offset:49160
v_mfma_f32_16x16x32_bf16 v[48:51], a[184:187], a[120:123], v[48:51]
ds_read_b64_tr_b16 a[158:159], v235 offset:53256
v_mfma_f32_16x16x32_bf16 v[52:55], a[184:187], a[124:127], v[52:55]
v_mfma_f32_16x16x32_bf16 v[56:59], a[188:191], a[112:115], v[56:59]
ds_read_b64_tr_b16 a[160:161], v236 offset:49152
v_mfma_f32_16x16x32_bf16 v[60:63], a[188:191], a[116:119], v[60:63]
v_mfma_f32_16x16x32_bf16 v[64:67], a[188:191], a[120:123], v[64:67]
ds_read_b64_tr_b16 a[162:163], v236 offset:53248
v_mfma_f32_16x16x32_bf16 v[68:71], a[188:191], a[124:127], v[68:71]
ds_read_b64_tr_b16 a[164:165], v236 offset:49160
s_waitcnt lgkmcnt(8)
v_mfma_f32_16x16x32_bf16 v[72:75], a[192:195], a[112:115], v[72:75]
v_mfma_f32_16x16x32_bf16 v[76:79], a[192:195], a[116:119], v[76:79]
ds_read_b64_tr_b16 a[166:167], v236 offset:53256
v_mfma_f32_16x16x32_bf16 v[80:83], a[192:195], a[120:123], v[80:83]
ds_read_b64_tr_b16 a[168:169], v237 offset:49152
v_mfma_f32_16x16x32_bf16 v[84:87], a[192:195], a[124:127], v[84:87]
v_mfma_f32_16x16x32_bf16 v[88:91], a[196:199], a[112:115], v[88:91]
ds_read_b64_tr_b16 a[170:171], v237 offset:53248
v_mfma_f32_16x16x32_bf16 v[92:95], a[196:199], a[116:119], v[92:95]
ds_read_b64_tr_b16 a[172:173], v237 offset:49160
v_mfma_f32_16x16x32_bf16 v[96:99], a[196:199], a[120:123], v[96:99]
v_mfma_f32_16x16x32_bf16 v[100:103], a[196:199], a[124:127], v[100:103]
ds_read_b64_tr_b16 a[174:175], v237 offset:53256
v_mfma_f32_16x16x32_bf16 v[104:107], a[200:203], a[112:115], v[104:107]
v_mfma_f32_16x16x32_bf16 v[108:111], a[200:203], a[116:119], v[108:111]
v_mfma_f32_16x16x32_bf16 v[112:115], a[200:203], a[120:123], v[112:115]
v_mfma_f32_16x16x32_bf16 v[116:119], a[200:203], a[124:127], v[116:119]
v_mfma_f32_16x16x32_bf16 v[120:123], a[204:207], a[112:115], v[120:123]
v_mfma_f32_16x16x32_bf16 v[124:127], a[204:207], a[116:119], v[124:127]
v_mfma_f32_16x16x32_bf16 v[128:131], a[204:207], a[120:123], v[128:131]
v_mfma_f32_16x16x32_bf16 v[132:135], a[204:207], a[124:127], v[132:135]
s_waitcnt vmcnt(16)
v_mfma_f32_16x16x32_bf16 v[8:11], a[144:147], a[0:3], v[8:11]
ds_read_b64_tr_b16 a[176:177], v234 offset:57344
s_add_u32 s39, s7, 0
v_mfma_f32_16x16x32_bf16 v[12:15], a[144:147], a[4:7], v[12:15]
ds_read_b64_tr_b16 a[178:179], v234 offset:61440
v_mfma_f32_16x16x32_bf16 v[16:19], a[144:147], a[8:11], v[16:19]
s_waitcnt vmcnt(11)
buffer_store_dword v143, v136, s[20:23], s29 offen sc0 sc1
v_mfma_f32_16x16x32_bf16 v[20:23], a[144:147], a[12:15], v[20:23]
ds_read_b64_tr_b16 a[180:181], v234 offset:57352
s_waitcnt lgkmcnt(8)
v_mfma_f32_16x16x32_bf16 v[24:27], a[148:151], a[0:3], v[24:27]
ds_read_b64_tr_b16 a[182:183], v234 offset:61448
v_mfma_f32_16x16x32_bf16 v[28:31], a[148:151], a[4:7], v[28:31]
s_add_u32 m0, s30, 131072
v_mfma_f32_16x16x32_bf16 v[32:35], a[148:151], a[8:11], v[32:35]
ds_read_b64_tr_b16 a[184:185], v235 offset:57344
v_mfma_f32_16x16x32_bf16 v[36:39], a[148:151], a[12:15], v[36:39]
ds_read_b64_tr_b16 a[186:187], v235 offset:61440
v_mfma_f32_16x16x32_bf16 v[40:43], a[152:155], a[0:3], v[40:43]
v_mfma_f32_16x16x32_bf16 v[44:47], a[152:155], a[4:7], v[44:47]
ds_read_b64_tr_b16 a[188:189], v235 offset:57352
v_mfma_f32_16x16x32_bf16 v[48:51], a[152:155], a[8:11], v[48:51]
ds_read_b64_tr_b16 a[190:191], v235 offset:61448
buffer_load_dwordx4 v232, s[12:15], s39 offen offset:0 lds
v_mfma_f32_16x16x32_bf16 v[52:55], a[152:155], a[12:15], v[52:55]
v_mfma_f32_16x16x32_bf16 v[56:59], a[156:159], a[0:3], v[56:59]
ds_read_b64_tr_b16 a[192:193], v236 offset:57344
v_mfma_f32_16x16x32_bf16 v[60:63], a[156:159], a[4:7], v[60:63]
v_mfma_f32_16x16x32_bf16 v[64:67], a[156:159], a[8:11], v[64:67]
ds_read_b64_tr_b16 a[194:195], v236 offset:61440
v_mfma_f32_16x16x32_bf16 v[68:71], a[156:159], a[12:15], v[68:71]
ds_read_b64_tr_b16 a[196:197], v236 offset:57352
buffer_load_dwordx4 v233, s[12:15], s39 offen offset:1024 lds
v_mfma_f32_16x16x32_bf16 v[72:75], a[160:163], a[0:3], v[72:75]
v_mfma_f32_16x16x32_bf16 v[76:79], a[160:163], a[4:7], v[76:79]
ds_read_b64_tr_b16 a[198:199], v236 offset:61448
v_mfma_f32_16x16x32_bf16 v[80:83], a[160:163], a[8:11], v[80:83]
ds_read_b64_tr_b16 a[200:201], v237 offset:57344
v_mfma_f32_16x16x32_bf16 v[84:87], a[160:163], a[12:15], v[84:87]
s_waitcnt lgkmcnt(8)
v_mfma_f32_16x16x32_bf16 v[88:91], a[164:167], a[0:3], v[88:91]
ds_read_b64_tr_b16 a[202:203], v237 offset:61440
buffer_load_dwordx4 v232, s[12:15], s39 offen offset:2048 lds
v_mfma_f32_16x16x32_bf16 v[92:95], a[164:167], a[4:7], v[92:95]
ds_read_b64_tr_b16 a[204:205], v237 offset:57352
v_mfma_f32_16x16x32_bf16 v[96:99], a[164:167], a[8:11], v[96:99]
v_mfma_f32_16x16x32_bf16 v[100:103], a[164:167], a[12:15], v[100:103]
ds_read_b64_tr_b16 a[206:207], v237 offset:61448
v_mfma_f32_16x16x32_bf16 v[104:107], a[168:171], a[0:3], v[104:107]
v_mfma_f32_16x16x32_bf16 v[108:111], a[168:171], a[4:7], v[108:111]
buffer_load_dwordx4 v233, s[12:15], s39 offen offset:3072 lds
v_mfma_f32_16x16x32_bf16 v[112:115], a[168:171], a[8:11], v[112:115]
v_mfma_f32_16x16x32_bf16 v[116:119], a[168:171], a[12:15], v[116:119]
v_mfma_f32_16x16x32_bf16 v[120:123], a[172:175], a[0:3], v[120:123]
v_mfma_f32_16x16x32_bf16 v[124:127], a[172:175], a[4:7], v[124:127]
v_mfma_f32_16x16x32_bf16 v[128:131], a[172:175], a[8:11], v[128:131]
v_mfma_f32_16x16x32_bf16 v[132:135], a[172:175], a[12:15], v[132:135]
s_waitcnt vmcnt(10)
v_mfma_f32_16x16x32_bf16 v[8:11], a[176:179], a[16:19], v[8:11]
v_mfma_f32_16x16x32_bf16 v[12:15], a[176:179], a[20:23], v[12:15]
v_mfma_f32_16x16x32_bf16 v[16:19], a[176:179], a[24:27], v[16:19]
v_mfma_f32_16x16x32_bf16 v[20:23], a[176:179], a[28:31], v[20:23]
v_mfma_f32_16x16x32_bf16 v[24:27], a[180:183], a[16:19], v[24:27]
v_mfma_f32_16x16x32_bf16 v[28:31], a[180:183], a[20:23], v[28:31]
v_mfma_f32_16x16x32_bf16 v[32:35], a[180:183], a[24:27], v[32:35]
v_mfma_f32_16x16x32_bf16 v[36:39], a[180:183], a[28:31], v[36:39]
s_waitcnt lgkmcnt(8)
v_mfma_f32_16x16x32_bf16 v[40:43], a[184:187], a[16:19], v[40:43]
v_mfma_f32_16x16x32_bf16 v[44:47], a[184:187], a[20:23], v[44:47]
v_mfma_f32_16x16x32_bf16 v[48:51], a[184:187], a[24:27], v[48:51]
v_mfma_f32_16x16x32_bf16 v[52:55], a[184:187], a[28:31], v[52:55]
v_mfma_f32_16x16x32_bf16 v[56:59], a[188:191], a[16:19], v[56:59]
v_mfma_f32_16x16x32_bf16 v[60:63], a[188:191], a[20:23], v[60:63]
v_mfma_f32_16x16x32_bf16 v[64:67], a[188:191], a[24:27], v[64:67]
v_mfma_f32_16x16x32_bf16 v[68:71], a[188:191], a[28:31], v[68:71]
s_waitcnt lgkmcnt(6)
v_mfma_f32_16x16x32_bf16 v[72:75], a[192:195], a[16:19], v[72:75]
v_mfma_f32_16x16x32_bf16 v[76:79], a[192:195], a[20:23], v[76:79]
v_mfma_f32_16x16x32_bf16 v[80:83], a[192:195], a[24:27], v[80:83]
v_mfma_f32_16x16x32_bf16 v[84:87], a[192:195], a[28:31], v[84:87]
s_waitcnt lgkmcnt(4)
v_mfma_f32_16x16x32_bf16 v[88:91], a[196:199], a[16:19], v[88:91]
v_mfma_f32_16x16x32_bf16 v[92:95], a[196:199], a[20:23], v[92:95]
v_mfma_f32_16x16x32_bf16 v[96:99], a[196:199], a[24:27], v[96:99]
v_mfma_f32_16x16x32_bf16 v[100:103], a[196:199], a[28:31], v[100:103]
s_waitcnt lgkmcnt(2)
v_mfma_f32_16x16x32_bf16 v[104:107], a[200:203], a[16:19], v[104:107]
v_mfma_f32_16x16x32_bf16 v[108:111], a[200:203], a[20:23], v[108:111]
v_mfma_f32_16x16x32_bf16 v[112:115], a[200:203], a[24:27], v[112:115]
v_mfma_f32_16x16x32_bf16 v[116:119], a[200:203], a[28:31], v[116:119]
s_waitcnt lgkmcnt(0)
v_mfma_f32_16x16x32_bf16 v[120:123], a[204:207], a[16:19], v[120:123]
v_mfma_f32_16x16x32_bf16 v[124:127], a[204:207], a[20:23], v[124:127]
v_mfma_f32_16x16x32_bf16 v[128:131], a[204:207], a[24:27], v[128:131]
v_mfma_f32_16x16x32_bf16 v[132:135], a[204:207], a[28:31], v[132:135]
s_nop 7
s_nop 3
v_pk_mul_f32 v[8:9], v[8:9], s[40:41]
v_pk_mul_f32 v[10:11], v[10:11], s[40:41]
v_pk_mul_f32 v[24:25], v[24:25], s[40:41]
v_pk_mul_f32 v[26:27], v[26:27], s[40:41]
v_cvt_pk_bf16_f32 v152, v8, v9
v_cvt_pk_bf16_f32 v153, v10, v11
v_cvt_pk_bf16_f32 v154, v24, v25
v_cvt_pk_bf16_f32 v155, v26, v27
v_pk_mul_f32 v[40:41], v[40:41], s[40:41]
v_pk_mul_f32 v[42:43], v[42:43], s[40:41]
v_pk_mul_f32 v[56:57], v[56:57], s[40:41]
v_pk_mul_f32 v[58:59], v[58:59], s[40:41]
v_cvt_pk_bf16_f32 v156, v40, v41
v_cvt_pk_bf16_f32 v157, v42, v43
v_cvt_pk_bf16_f32 v158, v56, v57
v_cvt_pk_bf16_f32 v159, v58, v59
v_pk_mul_f32 v[72:73], v[72:73], s[40:41]
v_pk_mul_f32 v[74:75], v[74:75], s[40:41]
v_pk_mul_f32 v[88:89], v[88:89], s[40:41]
v_pk_mul_f32 v[90:91], v[90:91], s[40:41]
v_cvt_pk_bf16_f32 v160, v72, v73
v_cvt_pk_bf16_f32 v161, v74, v75
v_cvt_pk_bf16_f32 v162, v88, v89
v_cvt_pk_bf16_f32 v163, v90, v91
v_pk_mul_f32 v[104:105], v[104:105], s[40:41]
v_pk_mul_f32 v[106:107], v[106:107], s[40:41]
v_pk_mul_f32 v[120:121], v[120:121], s[40:41]
v_pk_mul_f32 v[122:123], v[122:123], s[40:41]
v_cvt_pk_bf16_f32 v164, v104, v105
v_cvt_pk_bf16_f32 v165, v106, v107
v_cvt_pk_bf16_f32 v166, v120, v121
v_cvt_pk_bf16_f32 v167, v122, v123
v_pk_mul_f32 v[12:13], v[12:13], s[40:41]
v_pk_mul_f32 v[14:15], v[14:15], s[40:41]
v_pk_mul_f32 v[28:29], v[28:29], s[40:41]
v_pk_mul_f32 v[30:31], v[30:31], s[40:41]
v_cvt_pk_bf16_f32 v168, v12, v13
v_cvt_pk_bf16_f32 v169, v14, v15
v_cvt_pk_bf16_f32 v170, v28, v29
v_cvt_pk_bf16_f32 v171, v30, v31
v_pk_mul_f32 v[44:45], v[44:45], s[40:41]
v_pk_mul_f32 v[46:47], v[46:47], s[40:41]
v_pk_mul_f32 v[60:61], v[60:61], s[40:41]
v_pk_mul_f32 v[62:63], v[62:63], s[40:41]
v_cvt_pk_bf16_f32 v172, v44, v45
v_cvt_pk_bf16_f32 v173, v46, v47
v_cvt_pk_bf16_f32 v174, v60, v61
v_cvt_pk_bf16_f32 v175, v62, v63
v_pk_mul_f32 v[76:77], v[76:77], s[40:41]
v_pk_mul_f32 v[78:79], v[78:79], s[40:41]
v_pk_mul_f32 v[92:93], v[92:93], s[40:41]
v_pk_mul_f32 v[94:95], v[94:95], s[40:41]
v_cvt_pk_bf16_f32 v176, v76, v77
v_cvt_pk_bf16_f32 v177, v78, v79
v_cvt_pk_bf16_f32 v178, v92, v93
v_cvt_pk_bf16_f32 v179, v94, v95
v_pk_mul_f32 v[108:109], v[108:109], s[40:41]
v_pk_mul_f32 v[110:111], v[110:111], s[40:41]
v_pk_mul_f32 v[124:125], v[124:125], s[40:41]
v_pk_mul_f32 v[126:127], v[126:127], s[40:41]
v_cvt_pk_bf16_f32 v180, v108, v109
v_cvt_pk_bf16_f32 v181, v110, v111
v_cvt_pk_bf16_f32 v182, v124, v125
v_cvt_pk_bf16_f32 v183, v126, v127
v_pk_mul_f32 v[16:17], v[16:17], s[40:41]
v_pk_mul_f32 v[18:19], v[18:19], s[40:41]
v_pk_mul_f32 v[32:33], v[32:33], s[40:41]
v_pk_mul_f32 v[34:35], v[34:35], s[40:41]
v_cvt_pk_bf16_f32 v184, v16, v17
v_cvt_pk_bf16_f32 v185, v18, v19
v_cvt_pk_bf16_f32 v186, v32, v33
v_cvt_pk_bf16_f32 v187, v34, v35
v_pk_mul_f32 v[48:49], v[48:49], s[40:41]
v_pk_mul_f32 v[50:51], v[50:51], s[40:41]
v_pk_mul_f32 v[64:65], v[64:65], s[40:41]
v_pk_mul_f32 v[66:67], v[66:67], s[40:41]
v_cvt_pk_bf16_f32 v188, v48, v49
v_cvt_pk_bf16_f32 v189, v50, v51
v_cvt_pk_bf16_f32 v190, v64, v65
v_cvt_pk_bf16_f32 v191, v66, v67
v_pk_mul_f32 v[80:81], v[80:81], s[40:41]
v_pk_mul_f32 v[82:83], v[82:83], s[40:41]
v_pk_mul_f32 v[96:97], v[96:97], s[40:41]
v_pk_mul_f32 v[98:99], v[98:99], s[40:41]
v_cvt_pk_bf16_f32 v192, v80, v81
v_cvt_pk_bf16_f32 v193, v82, v83
v_cvt_pk_bf16_f32 v194, v96, v97
v_cvt_pk_bf16_f32 v195, v98, v99
v_pk_mul_f32 v[112:113], v[112:113], s[40:41]
v_pk_mul_f32 v[114:115], v[114:115], s[40:41]
v_pk_mul_f32 v[128:129], v[128:129], s[40:41]
v_pk_mul_f32 v[130:131], v[130:131], s[40:41]
v_cvt_pk_bf16_f32 v196, v112, v113
v_cvt_pk_bf16_f32 v197, v114, v115
v_cvt_pk_bf16_f32 v198, v128, v129
v_cvt_pk_bf16_f32 v199, v130, v131
v_pk_mul_f32 v[20:21], v[20:21], s[40:41]
v_pk_mul_f32 v[22:23], v[22:23], s[40:41]
v_pk_mul_f32 v[36:37], v[36:37], s[40:41]
v_pk_mul_f32 v[38:39], v[38:39], s[40:41]
v_cvt_pk_bf16_f32 v200, v20, v21
v_cvt_pk_bf16_f32 v201, v22, v23
v_cvt_pk_bf16_f32 v202, v36, v37
v_cvt_pk_bf16_f32 v203, v38, v39
v_pk_mul_f32 v[52:53], v[52:53], s[40:41]
v_pk_mul_f32 v[54:55], v[54:55], s[40:41]
v_pk_mul_f32 v[68:69], v[68:69], s[40:41]
v_pk_mul_f32 v[70:71], v[70:71], s[40:41]
v_cvt_pk_bf16_f32 v204, v52, v53
v_cvt_pk_bf16_f32 v205, v54, v55
v_cvt_pk_bf16_f32 v206, v68, v69
v_cvt_pk_bf16_f32 v207, v70, v71
v_pk_mul_f32 v[84:85], v[84:85], s[40:41]
v_pk_mul_f32 v[86:87], v[86:87], s[40:41]
v_pk_mul_f32 v[100:101], v[100:101], s[40:41]
v_pk_mul_f32 v[102:103], v[102:103], s[40:41]
v_cvt_pk_bf16_f32 v208, v84, v85
v_cvt_pk_bf16_f32 v209, v86, v87
v_cvt_pk_bf16_f32 v210, v100, v101
v_cvt_pk_bf16_f32 v211, v102, v103
v_pk_mul_f32 v[116:117], v[116:117], s[40:41]
v_pk_mul_f32 v[118:119], v[118:119], s[40:41]
v_pk_mul_f32 v[132:133], v[132:133], s[40:41]
v_pk_mul_f32 v[134:135], v[134:135], s[40:41]
v_cvt_pk_bf16_f32 v212, v116, v117
v_cvt_pk_bf16_f32 v213, v118, v119
v_cvt_pk_bf16_f32 v214, v132, v133
v_cvt_pk_bf16_f32 v215, v134, v135
v_lshrrev_b32 v240, 2, v1
v_mul_u32_u24 v240, 0x2400, v240
v_and_b32 v246, 3, v1
v_lshl_add_u32 v240, v246, 4, v240
v_mul_u32_u24 v243, 3641, v1
v_lshrrev_b32 v243, 16, v243
v_mul_u32_u24 v243, 864, v243
v_add_u32 v243, v243, v244
s_sub_u32 s28, s2, 144
s_cmp_lt_u32 s28, 72
s_cselect_b32 s3, 4, 2
s_cmp_lt_u32 s2, 144
s_cselect_b32 s3, 5, s3
K_PRE:
s_waitcnt vmcnt(17)
s_barrier
ds_read_b128 a[144:147], v216 offset:16384
ds_read_b128 a[148:151], v217 offset:16384
ds_read_b128 a[152:155], v218 offset:16384
ds_read_b128 a[156:159], v219 offset:16384
ds_read_b128 a[160:163], v216 offset:20480
ds_read_b128 a[164:167], v217 offset:20480
ds_read_b128 a[168:171], v218 offset:20480
ds_read_b128 a[172:175], v219 offset:20480
s_add_u32 s32, s7, 32768
s_add_u32 m0, s30, 65536
s_nop 0
buffer_load_dwordx4 v228, s[8:11], s32 offen offset:0 lds
buffer_load_dwordx4 v229, s[8:11], s32 offen offset:1024 lds
buffer_load_dwordx4 v230, s[8:11], s32 offen offset:2048 lds
buffer_load_dwordx4 v231, s[8:11], s32 offen offset:3072 lds
s_add_u32 s39, s7, 16384
s_add_u32 m0, s30, 147456
s_nop 0
buffer_load_dwordx4 v232, s[12:15], s39 offen offset:0 lds
buffer_load_dwordx4 v233, s[12:15], s39 offen offset:1024 lds
buffer_load_dwordx4 v232, s[12:15], s39 offen offset:2048 lds
buffer_load_dwordx4 v233, s[12:15], s39 offen offset:3072 lds
s_add_u32 s32, s7, 32768
s_add_u32 s39, s7, 16384
s_mul_i32 s88, s37, 864
s_mov_b32 s87, s88
v_accvgpr_write_b32 a128, 0
v_accvgpr_write_b32 a129, 0
v_accvgpr_write_b32 a130, 0
v_accvgpr_write_b32 a131, 0
v_accvgpr_write_b32 a132, 0
v_accvgpr_write_b32 a133, 0
v_accvgpr_write_b32 a134, 0
v_accvgpr_write_b32 a135, 0
s_waitcnt lgkmcnt(7)
v_mfma_f32_16x16x32_bf16 v[8:11], a[144:147], v[152:155], 0
v_mfma_f32_16x16x32_bf16 v[16:19], a[144:147], v[168:171], 0
v_mfma_f32_16x16x32_bf16 v[24:27], a[144:147], v[184:187], 0
v_mfma_f32_16x16x32_bf16 v[32:35], a[144:147], v[200:203], 0
ds_read_b128 a[144:147], v216 offset:24576
s_waitcnt lgkmcnt(7)
v_mfma_f32_16x16x32_bf16 v[8:11], a[148:151], v[156:159], v[8:11]
v_mfma_f32_16x16x32_bf16 v[16:19], a[148:151], v[172:175], v[16:19]
v_mfma_f32_16x16x32_bf16 v[24:27], a[148:151], v[188:191], v[24:27]
v_mfma_f32_16x16x32_bf16 v[32:35], a[148:151], v[204:207], v[32:35]
ds_read_b128 a[148:151], v217 offset:24576
s_waitcnt lgkmcnt(7)
v_mfma_f32_16x16x32_bf16 v[8:11], a[152:155], v[160:163], v[8:11]
v_mfma_f32_16x16x32_bf16 v[16:19], a[152:155], v[176:179], v[16:19]
v_mfma_f32_16x16x32_bf16 v[24:27], a[152:155], v[192:195], v[24:27]
v_mfma_f32_16x16x32_bf16 v[32:35], a[152:155], v[208:211], v[32:35]
ds_read_b128 a[152:155], v218 offset:24576
s_waitcnt lgkmcnt(7)
v_mfma_f32_16x16x32_bf16 v[8:11], a[156:159], v[164:167], v[8:11]
v_mfma_f32_16x16x32_bf16 v[16:19], a[156:159], v[180:183], v[16:19]
v_mfma_f32_16x16x32_bf16 v[24:27], a[156:159], v[196:199], v[24:27]
v_mfma_f32_16x16x32_bf16 v[32:35], a[156:159], v[212:215], v[32:35]
ds_read_b128 a[156:159], v219 offset:24576
s_waitcnt lgkmcnt(7)
v_mfma_f32_16x16x32_bf16 v[12:15], a[160:163], v[152:155], 0
v_mfma_f32_16x16x32_bf16 v[20:23], a[160:163], v[168:171], 0
v_mfma_f32_16x16x32_bf16 v[28:31], a[160:163], v[184:187], 0
v_mfma_f32_16x16x32_bf16 v[36:39], a[160:163], v[200:203], 0
ds_read_b128 a[160:163], v216 offset:28672
s_waitcnt lgkmcnt(7)
v_mfma_f32_16x16x32_bf16 v[12:15], a[164:167], v[156:159], v[12:15]
v_mfma_f32_16x16x32_bf16 v[20:23], a[164:167], v[172:175], v[20:23]
v_mfma_f32_16x16x32_bf16 v[28:31], a[164:167], v[188:191], v[28:31]
v_mfma_f32_16x16x32_bf16 v[36:39], a[164:167], v[204:207], v[36:39]
ds_read_b128 a[164:167], v217 offset:28672
s_waitcnt lgkmcnt(7)
v_mfma_f32_16x16x32_bf16 v[12:15], a[168:171], v[160:163], v[12:15]
v_mfma_f32_16x16x32_bf16 v[20:23], a[168:171], v[176:179], v[20:23]
v_mfma_f32_16x16x32_bf16 v[28:31], a[168:171], v[192:195], v[28:31]
v_mfma_f32_16x16x32_bf16 v[36:39], a[168:171], v[208:211], v[36:39]
ds_read_b128 a[168:171], v218 offset:28672
s_waitcnt lgkmcnt(7)
v_mfma_f32_16x16x32_bf16 v[12:15], a[172:175], v[164:167], v[12:15]
v_mfma_f32_16x16x32_bf16 v[20:23], a[172:175], v[180:183], v[20:23]
v_mfma_f32_16x16x32_bf16 v[28:31], a[172:175], v[196:199], v[28:31]
v_mfma_f32_16x16x32_bf16 v[36:39], a[172:175], v[212:215], v[36:39]
ds_read_b128 a[172:175], v219 offset:28672
s_nop 7
s_cmp_eq_u32 s43, 0
s_cbranch_scc0 K_HAVEMAX
v_max3_f32 v104, v8, v9, v10
v_max3_f32 v104, v104, v11, v12
v_max3_f32 v104, v104, v13, v14
v_max_f32 v104, v104, v15
v_max3_f32 v105, v16, v17, v18
v_max3_f32 v105, v105, v19, v20
v_max3_f32 v105, v105, v21, v22
v_max_f32 v105, v105, v23
v_max3_f32 v106, v24, v25, v26
v_max3_f32 v106, v106, v27, v28
v_max3_f32 v106, v106, v29, v30
v_max_f32 v106, v106, v31
v_max3_f32 v107, v32, v33, v34
v_max3_f32 v107, v107, v35, v36
v_max3_f32 v107, v107, v37, v38
v_max_f32 v107, v107, v39
v_mov_b32 v108, v104
v_mov_b32 v109, v105
v_mov_b32 v110, v106
v_mov_b32 v111, v107
v_permlane16_swap_b32 v104, v108
v_permlane16_swap_b32 v105, v109
v_permlane16_swap_b32 v106, v110
v_permlane16_swap_b32 v107, v111
v_max_f32 v104, v104, v108
v_max_f32 v105, v105, v109
v_max_f32 v106, v106, v110
v_max_f32 v107, v107, v111
v_mov_b32 v108, v104
v_mov_b32 v109, v105
v_mov_b32 v110, v106
v_mov_b32 v111, v107
v_permlane32_swap_b32 v104, v108
v_permlane32_swap_b32 v105, v109
v_permlane32_swap_b32 v106, v110
v_permlane32_swap_b32 v107, v111
v_max_f32 v104, v104, v108
v_max_f32 v105, v105, v109
v_max_f32 v106, v106, v110
v_max_f32 v107, v107, v111
v_sub_f32 v136, 0, v104
v_sub_f32 v137, 0, v104
v_sub_f32 v138, 0, v104
v_sub_f32 v139, 0, v104
v_sub_f32 v140, 0, v105
v_sub_f32 v141, 0, v105
v_sub_f32 v142, 0, v105
v_sub_f32 v143, 0, v105
v_sub_f32 v144, 0, v106
v_sub_f32 v145, 0, v106
v_sub_f32 v146, 0, v106
v_sub_f32 v147, 0, v106
v_sub_f32 v148, 0, v107
v_sub_f32 v149, 0, v107
v_sub_f32 v150, 0, v107
v_sub_f32 v151, 0, v107
K_HAVEMAX:
v_pk_add_f32 v[8:9], v[8:9], v[136:137]
v_pk_add_f32 v[10:11], v[10:11], v[136:137]
v_pk_add_f32 v[12:13], v[12:13], v[136:137]
v_pk_add_f32 v[14:15], v[14:15], v[136:137]
v_pk_add_f32 v[16:17], v[16:17], v[140:141]
v_pk_add_f32 v[18:19], v[18:19], v[140:141]
v_pk_add_f32 v[20:21], v[20:21], v[140:141]
v_pk_add_f32 v[22:23], v[22:23], v[140:141]
v_pk_add_f32 v[24:25], v[24:25], v[144:145]
v_pk_add_f32 v[26:27], v[26:27], v[144:145]
v_pk_add_f32 v[28:29], v[28:29], v[144:145]
v_pk_add_f32 v[30:31], v[30:31], v[144:145]
v_pk_add_f32 v[32:33], v[32:33], v[148:149]
v_pk_add_f32 v[34:35], v[34:35], v[148:149]
v_pk_add_f32 v[36:37], v[36:37], v[148:149]
v_pk_add_f32 v[38:39], v[38:39], v[148:149]
s_waitcnt lgkmcnt(0)
v_mfma_f32_16x16x32_bf16 v[40:43], a[144:147], v[152:155], v[136:139]
v_exp_f32 v8, v8
v_exp_f32 v9, v9
v_mfma_f32_16x16x32_bf16 v[40:43], a[148:151], v[156:159], v[40:43]
v_cvt_pk_bf16_f32 v72, v8, v9
v_bfe_u32 v246, v1, 2, 2
v_exp_f32 v10, v10
v_mfma_f32_16x16x32_bf16 v[40:43], a[152:155], v[160:163], v[40:43]
v_lshl_add_u32 v246, v4, 2, v246
v_and_b32 v247, 3, v1
v_exp_f32 v11, v11
v_mfma_f32_16x16x32_bf16 v[40:43], a[156:159], v[164:167], v[40:43]
v_cvt_pk_bf16_f32 v73, v10, v11
v_lshlrev_b32 v247, 3, v247
v_exp_f32 v12, v12
v_mfma_f32_16x16x32_bf16 v[48:51], a[144:147], v[168:171], v[140:143]
v_lshl_add_u32 v241, v246, 6, v247
v_exp_f32 v13, v13
v_mfma_f32_16x16x32_bf16 v[48:51], a[148:151], v[172:175], v[48:51]
v_cvt_pk_bf16_f32 v74, v12, v13
v_exp_f32 v14, v14
v_mfma_f32_16x16x32_bf16 v[48:51], a[152:155], v[176:179], v[48:51]
s_and_b32 s28, s37, 1
s_lshl_b32 s28, s28, 5
v_exp_f32 v15, v15
v_mfma_f32_16x16x32_bf16 v[48:51], a[156:159], v[180:183], v[48:51]
s_waitcnt vmcnt(8) lgkmcnt(0)
s_barrier
v_exp_f32 v16, v16
v_mfma_f32_16x16x32_bf16 v[56:59], a[144:147], v[184:187], v[144:147]
v_exp_f32 v17, v17
v_exp_f32 v18, v18
v_mfma_f32_16x16x32_bf16 v[56:59], a[148:151], v[188:191], v[56:59]
v_cvt_pk_bf16_f32 v75, v14, v15
v_cvt_pk_bf16_f32 v76, v16, v17
v_exp_f32 v19, v19
v_mfma_f32_16x16x32_bf16 v[56:59], a[152:155], v[192:195], v[56:59]
ds_read_b64_tr_b16 a[176:177], v220 offset:32768
v_cvt_pk_bf16_f32 v77, v18, v19
v_exp_f32 v20, v20
v_mfma_f32_16x16x32_bf16 v[56:59], a[156:159], v[196:199], v[56:59]
ds_read_b64_tr_b16 a[178:179], v220 offset:36864
ds_read_b64_tr_b16 a[180:181], v221 offset:32768
v_exp_f32 v21, v21
v_mfma_f32_16x16x32_bf16 v[64:67], a[144:147], v[200:203], v[148:151]
ds_read_b64_tr_b16 a[182:183], v221 offset:36864
v_cvt_pk_bf16_f32 v78, v20, v21
v_exp_f32 v22, v22
v_mfma_f32_16x16x32_bf16 v[64:67], a[148:151], v[204:207], v[64:67]
ds_read_b64_tr_b16 a[184:185], v222 offset:32768
ds_read_b64_tr_b16 a[186:187], v222 offset:36864
v_exp_f32 v23, v23
v_mfma_f32_16x16x32_bf16 v[64:67], a[152:155], v[208:211], v[64:67]
v_exp_f32 v24, v24
v_exp_f32 v25, v25
v_mfma_f32_16x16x32_bf16 v[64:67], a[156:159], v[212:215], v[64:67]
v_cvt_pk_bf16_f32 v79, v22, v23
v_cvt_pk_bf16_f32 v80, v24, v25
v_exp_f32 v26, v26
v_mfma_f32_16x16x32_bf16 v[44:47], a[160:163], v[152:155], v[136:139]
ds_read_b64_tr_b16 a[188:189], v223 offset:32768
ds_read_b64_tr_b16 a[190:191], v223 offset:36864
v_exp_f32 v27, v27
v_mfma_f32_16x16x32_bf16 v[44:47], a[164:167], v[156:159], v[44:47]
ds_read_b128 a[144:147], v216 offset:49152
v_cvt_pk_bf16_f32 v81, v26, v27
v_exp_f32 v28, v28
v_mfma_f32_16x16x32_bf16 v[44:47], a[168:171], v[160:163], v[44:47]
ds_read_b64_tr_b16 a[192:193], v224 offset:32768
ds_read_b64_tr_b16 a[194:195], v224 offset:36864
v_exp_f32 v29, v29
v_mfma_f32_16x16x32_bf16 v[44:47], a[172:175], v[164:167], v[44:47]
ds_read_b128 a[148:151], v217 offset:49152
v_cvt_pk_bf16_f32 v82, v28, v29
v_exp_f32 v30, v30
v_mfma_f32_16x16x32_bf16 v[52:55], a[160:163], v[168:171], v[140:143]
ds_read_b128 a[152:155], v218 offset:49152
ds_read_b128 a[156:159], v219 offset:49152
v_exp_f32 v31, v31
v_mfma_f32_16x16x32_bf16 v[52:55], a[164:167], v[172:175], v[52:55]
v_exp_f32 v32, v32
v_exp_f32 v33, v33
v_mfma_f32_16x16x32_bf16 v[52:55], a[168:171], v[176:179], v[52:55]
v_cvt_pk_bf16_f32 v83, v30, v31
v_cvt_pk_bf16_f32 v84, v32, v33
v_exp_f32 v34, v34
v_mfma_f32_16x16x32_bf16 v[52:55], a[172:175], v[180:183], v[52:55]
ds_read_b64_tr_b16 a[196:197], v225 offset:32768
ds_read_b64_tr_b16 a[198:199], v225 offset:36864
v_exp_f32 v35, v35
v_mfma_f32_16x16x32_bf16 v[60:63], a[160:163], v[184:187], v[144:147]
ds_read_b64_tr_b16 a[200:201], v226 offset:32768
v_cvt_pk_bf16_f32 v85, v34, v35
v_exp_f32 v36, v36
v_mfma_f32_16x16x32_bf16 v[60:63], a[164:167], v[188:191], v[60:63]
ds_read_b64_tr_b16 a[202:203], v226 offset:36864
ds_read_b64_tr_b16 a[204:205], v227 offset:32768
v_exp_f32 v37, v37
v_mfma_f32_16x16x32_bf16 v[60:63], a[168:171], v[192:195], v[60:63]
ds_read_b64_tr_b16 a[206:207], v227 offset:36864
v_cvt_pk_bf16_f32 v86, v36, v37
v_exp_f32 v38, v38
v_mfma_f32_16x16x32_bf16 v[60:63], a[172:175], v[196:199], v[60:63]
s_add_u32 s32, s32, 16384
s_bitset0_b32 s32, 19
v_exp_f32 v39, v39
v_mfma_f32_16x16x32_bf16 v[68:71], a[160:163], v[200:203], v[148:151]
ds_read_b128 a[160:163], v216 offset:53248
s_add_u32 m0, s30, 81920
s_nop 0
buffer_load_dwordx4 v228, s[8:11], s32 offen offset:0 lds
v_cvt_pk_bf16_f32 v87, v38, v39
v_mfma_f32_16x16x32_bf16 v[68:71], a[164:167], v[204:207], v[68:71]
ds_read_b128 a[164:167], v217 offset:53248
buffer_load_dwordx4 v229, s[8:11], s32 offen offset:1024 lds
buffer_load_dwordx4 v230, s[8:11], s32 offen offset:2048 lds
buffer_load_dwordx4 v231, s[8:11], s32 offen offset:3072 lds
v_mfma_f32_16x16x32_bf16 v[68:71], a[168:171], v[208:211], v[68:71]
ds_read_b128 a[168:171], v218 offset:53248
buffer_store_byte v255, v254, s[24:27], 0 offen sc0 sc1
s_lshr_b32 s29, s37, 1
s_lshl_b32 s29, s29, 15
v_mfma_f32_16x16x32_bf16 v[68:71], a[172:175], v[212:215], v[68:71]
ds_read_b128 a[172:175], v219 offset:53248
s_add_u32 m0, s86, 0
s_add_u32 s50, s84, 0
buffer_load_dwordx4 v240, s[64:67], s50 offen lds
s_add_u32 m0, s86, 4096
s_add_u32 s50, s84, 589824
buffer_load_dwordx4 v240, s[64:67], s50 offen lds
s_waitcnt lgkmcnt(8)
v_mfma_f32_16x16x32_bf16 v[8:11], a[144:147], v[152:155], v[136:139]
v_exp_f32 v40, v40
v_mfma_f32_16x16x32_bf16 v[8:11], a[148:151], v[156:159], v[8:11]
v_exp_f32 v41, v41
v_mfma_f32_16x16x32_bf16 v[8:11], a[152:155], v[160:163], v[8:11]
s_add_u32 s28, s28, s29
v_cvt_pk_bf16_f32 v88, v40, v41
v_mfma_f32_16x16x32_bf16 v[8:11], a[156:159], v[164:167], v[8:11]
v_exp_f32 v42, v42
v_mfma_f32_16x16x32_bf16 a[0:3], a[176:179], v[72:75], 0
s_add_u32 s39, s39, 16384
v_add_u32 v241, s28, v241
v_mfma_f32_16x16x32_bf16 a[4:7], a[176:179], v[76:79], 0
v_exp_f32 v43, v43
v_mfma_f32_16x16x32_bf16 a[8:11], a[176:179], v[80:83], 0
v_cvt_pk_bf16_f32 v89, v42, v43
v_mul_u32_u24 v242, 0x480, v246
v_mfma_f32_16x16x32_bf16 a[12:15], a[176:179], v[84:87], 0
v_exp_f32 v44, v44
v_mfma_f32_16x16x32_bf16 v[16:19], a[144:147], v[168:171], v[140:143]
ds_read_b64_tr_b16 a[176:177], v220 offset:40960
ds_read_b64_tr_b16 a[178:179], v220 offset:45056
v_mfma_f32_16x16x32_bf16 v[16:19], a[148:151], v[172:175], v[16:19]
v_exp_f32 v45, v45
v_mfma_f32_16x16x32_bf16 v[16:19], a[152:155], v[176:179], v[16:19]
s_bitset0_b32 s39, 19
v_cvt_pk_bf16_f32 v90, v44, v45
v_mfma_f32_16x16x32_bf16 v[16:19], a[156:159], v[180:183], v[16:19]
v_exp_f32 v46, v46
v_mfma_f32_16x16x32_bf16 a[16:19], a[180:183], v[72:75], 0
v_add_u32 v242, v242, v247
v_mfma_f32_16x16x32_bf16 a[20:23], a[180:183], v[76:79], 0
v_exp_f32 v47, v47
v_mfma_f32_16x16x32_bf16 a[24:27], a[180:183], v[80:83], 0
v_cvt_pk_bf16_f32 v91, v46, v47
v_mfma_f32_16x16x32_bf16 a[28:31], a[180:183], v[84:87], 0
v_exp_f32 v48, v48
v_mfma_f32_16x16x32_bf16 v[24:27], a[144:147], v[184:187], v[144:147]
ds_read_b64_tr_b16 a[180:181], v221 offset:40960
ds_read_b64_tr_b16 a[182:183], v221 offset:45056
v_mfma_f32_16x16x32_bf16 v[24:27], a[148:151], v[188:191], v[24:27]
v_exp_f32 v49, v49
v_mfma_f32_16x16x32_bf16 v[24:27], a[152:155], v[192:195], v[24:27]
s_add_u32 m0, s30, 98304
v_cvt_pk_bf16_f32 v92, v48, v49
v_mfma_f32_16x16x32_bf16 v[24:27], a[156:159], v[196:199], v[24:27]
v_exp_f32 v50, v50
v_mfma_f32_16x16x32_bf16 a[32:35], a[184:187], v[72:75], 0
s_mul_i32 s28, s37, 288
s_add_u32 s28, s28, 8192
v_mfma_f32_16x16x32_bf16 a[36:39], a[184:187], v[76:79], 0
v_exp_f32 v51, v51
v_mfma_f32_16x16x32_bf16 a[40:43], a[184:187], v[80:83], 0
buffer_load_dwordx4 v232, s[12:15], s39 offen offset:0 lds
v_cvt_pk_bf16_f32 v93, v50, v51
v_mfma_f32_16x16x32_bf16 a[44:47], a[184:187], v[84:87], 0
v_exp_f32 v52, v52
v_mfma_f32_16x16x32_bf16 v[32:35], a[144:147], v[200:203], v[148:151]
ds_read_b64_tr_b16 a[184:185], v222 offset:40960
ds_read_b64_tr_b16 a[186:187], v222 offset:45056
v_mfma_f32_16x16x32_bf16 v[32:35], a[148:151], v[204:207], v[32:35]
v_exp_f32 v53, v53
v_mfma_f32_16x16x32_bf16 v[32:35], a[152:155], v[208:211], v[32:35]
ds_read_b128 a[144:147], v216 offset:57344
v_cvt_pk_bf16_f32 v94, v52, v53
v_mfma_f32_16x16x32_bf16 v[32:35], a[156:159], v[212:215], v[32:35]
v_exp_f32 v54, v54
v_mfma_f32_16x16x32_bf16 a[48:51], a[188:191], v[72:75], 0
ds_read_b128 a[148:151], v217 offset:57344
ds_read_b128 a[152:155], v218 offset:57344
v_mfma_f32_16x16x32_bf16 a[52:55], a[188:191], v[76:79], 0
v_exp_f32 v55, v55
v_mfma_f32_16x16x32_bf16 a[56:59], a[188:191], v[80:83], 0
ds_read_b128 a[156:159], v219 offset:57344
v_cvt_pk_bf16_f32 v95, v54, v55
v_mfma_f32_16x16x32_bf16 a[60:63], a[188:191], v[84:87], 0
v_exp_f32 v56, v56
v_smfmac_f32_16x16x64_bf16 a[128:131], a[208:211], v[72:79], v245
v_exp_f32 v57, v57
s_waitcnt lgkmcnt(8)
v_mfma_f32_16x16x32_bf16 v[12:15], a[160:163], v[152:155], v[136:139]
ds_read_b64_tr_b16 a[188:189], v223 offset:40960
v_cvt_pk_bf16_f32 v96, v56, v57
v_mfma_f32_16x16x32_bf16 v[12:15], a[164:167], v[156:159], v[12:15]
v_exp_f32 v58, v58
v_mfma_f32_16x16x32_bf16 v[12:15], a[168:171], v[160:163], v[12:15]
ds_read_b64_tr_b16 a[190:191], v223 offset:45056
buffer_load_dwordx4 v233, s[12:15], s39 offen offset:1024 lds
v_mfma_f32_16x16x32_bf16 v[12:15], a[172:175], v[164:167], v[12:15]
v_exp_f32 v59, v59
v_mfma_f32_16x16x32_bf16 a[64:67], a[192:195], v[72:75], 0
buffer_load_dwordx4 v232, s[12:15], s39 offen offset:2048 lds
v_cvt_pk_bf16_f32 v97, v58, v59
v_mfma_f32_16x16x32_bf16 a[68:71], a[192:195], v[76:79], 0
v_exp_f32 v60, v60
v_mfma_f32_16x16x32_bf16 a[72:75], a[192:195], v[80:83], 0
v_add_u32 v242, s28, v242
v_mfma_f32_16x16x32_bf16 a[76:79], a[192:195], v[84:87], 0
v_exp_f32 v61, v61
v_mfma_f32_16x16x32_bf16 v[20:23], a[160:163], v[168:171], v[140:143]
ds_read_b64_tr_b16 a[192:193], v224 offset:40960
v_cvt_pk_bf16_f32 v98, v60, v61
v_mfma_f32_16x16x32_bf16 v[20:23], a[164:167], v[172:175], v[20:23]
v_exp_f32 v62, v62
v_mfma_f32_16x16x32_bf16 v[20:23], a[168:171], v[176:179], v[20:23]
ds_read_b64_tr_b16 a[194:195], v224 offset:45056
buffer_load_dwordx4 v233, s[12:15], s39 offen offset:3072 lds
v_mfma_f32_16x16x32_bf16 v[20:23], a[172:175], v[180:183], v[20:23]
v_exp_f32 v63, v63
v_mfma_f32_16x16x32_bf16 a[80:83], a[196:199], v[72:75], 0
v_cvt_pk_bf16_f32 v99, v62, v63
v_lshlrev_b32 v249, 2, v1
v_mfma_f32_16x16x32_bf16 a[84:87], a[196:199], v[76:79], 0
v_exp_f32 v64, v64
v_mfma_f32_16x16x32_bf16 a[88:91], a[196:199], v[80:83], 0
s_add_u32 m0, s86, 8192
s_add_u32 s50, s84, 1179648
buffer_load_dwordx4 v240, s[64:67], s50 offen lds
v_mfma_f32_16x16x32_bf16 a[92:95], a[196:199], v[84:87], 0
v_exp_f32 v65, v65
v_mfma_f32_16x16x32_bf16 v[28:31], a[160:163], v[184:187], v[144:147]
ds_read_b64_tr_b16 a[196:197], v225 offset:40960
v_cvt_pk_bf16_f32 v100, v64, v65
v_mfma_f32_16x16x32_bf16 v[28:31], a[164:167], v[188:191], v[28:31]
v_exp_f32 v66, v66
v_mfma_f32_16x16x32_bf16 v[28:31], a[168:171], v[192:195], v[28:31]
ds_read_b64_tr_b16 a[198:199], v225 offset:45056
v_mfma_f32_16x16x32_bf16 v[28:31], a[172:175], v[196:199], v[28:31]
v_exp_f32 v67, v67
v_mfma_f32_16x16x32_bf16 a[96:99], a[200:203], v[72:75], 0
v_cvt_pk_bf16_f32 v101, v66, v67
v_mfma_f32_16x16x32_bf16 a[100:103], a[200:203], v[76:79], 0
v_exp_f32 v68, v68
v_mfma_f32_16x16x32_bf16 a[104:107], a[200:203], v[80:83], 0
s_add_u32 m0, s86, 12288
s_add_u32 s50, s84, 1769472
buffer_load_dwordx4 v240, s[64:67], s50 offen lds
v_mfma_f32_16x16x32_bf16 a[108:111], a[200:203], v[84:87], 0
v_exp_f32 v69, v69
v_mfma_f32_16x16x32_bf16 v[36:39], a[160:163], v[200:203], v[148:151]
ds_read_b64_tr_b16 a[200:201], v226 offset:40960
v_cvt_pk_bf16_f32 v102, v68, v69
v_mfma_f32_16x16x32_bf16 v[36:39], a[164:167], v[204:207], v[36:39]
v_exp_f32 v70, v70
v_mfma_f32_16x16x32_bf16 v[36:39], a[168:171], v[208:211], v[36:39]
ds_read_b64_tr_b16 a[202:203], v226 offset:45056
ds_read_b128 a[160:163], v216 offset:61440
v_mfma_f32_16x16x32_bf16 v[36:39], a[172:175], v[212:215], v[36:39]
v_exp_f32 v71, v71
v_mfma_f32_16x16x32_bf16 a[112:115], a[204:207], v[72:75], 0
ds_read_b128 a[164:167], v217 offset:61440
v_cvt_pk_bf16_f32 v103, v70, v71
v_mfma_f32_16x16x32_bf16 a[116:119], a[204:207], v[76:79], 0
ds_read_b128 a[168:171], v218 offset:61440
ds_read_b128 a[172:175], v219 offset:61440
v_mfma_f32_16x16x32_bf16 a[120:123], a[204:207], v[80:83], 0
v_mfma_f32_16x16x32_bf16 a[124:127], a[204:207], v[84:87], 0
ds_read_b64_tr_b16 a[204:205], v227 offset:40960
ds_read_b64_tr_b16 a[206:207], v227 offset:45056
v_smfmac_f32_16x16x64_bf16 a[132:135], a[208:211], v[80:87], v245
s_waitcnt lgkmcnt(8)
v_mfma_f32_16x16x32_bf16 v[40:43], a[144:147], v[152:155], v[136:139]
v_exp_f32 v8, v8
v_mfma_f32_16x16x32_bf16 v[40:43], a[148:151], v[156:159], v[40:43]
v_exp_f32 v9, v9
v_mfma_f32_16x16x32_bf16 v[40:43], a[152:155], v[160:163], v[40:43]
v_cvt_pk_bf16_f32 v72, v8, v9
v_mfma_f32_16x16x32_bf16 v[40:43], a[156:159], v[164:167], v[40:43]
v_exp_f32 v10, v10
v_mfma_f32_16x16x32_bf16 a[0:3], a[176:179], v[88:91], a[0:3]
v_mfma_f32_16x16x32_bf16 a[4:7], a[176:179], v[92:95], a[4:7]
v_exp_f32 v11, v11
v_mfma_f32_16x16x32_bf16 a[8:11], a[176:179], v[96:99], a[8:11]
v_cvt_pk_bf16_f32 v73, v10, v11
v_mfma_f32_16x16x32_bf16 a[12:15], a[176:179], v[100:103], a[12:15]
s_waitcnt vmcnt(13) lgkmcnt(0)
s_barrier
v_mfma_f32_16x16x32_bf16 v[48:51], a[144:147], v[168:171], v[140:143]
v_exp_f32 v12, v12
v_mfma_f32_16x16x32_bf16 v[48:51], a[148:151], v[172:175], v[48:51]
v_exp_f32 v13, v13
v_mfma_f32_16x16x32_bf16 v[48:51], a[152:155], v[176:179], v[48:51]
ds_read_b64_tr_b16 a[176:177], v220 offset:49152
v_cvt_pk_bf16_f32 v74, v12, v13
v_mfma_f32_16x16x32_bf16 v[48:51], a[156:159], v[180:183], v[48:51]
v_exp_f32 v14, v14
v_mfma_f32_16x16x32_bf16 a[16:19], a[180:183], v[88:91], a[16:19]
ds_read_b64_tr_b16 a[178:179], v220 offset:53248
s_add_u32 s32, s32, 16384
v_mfma_f32_16x16x32_bf16 a[20:23], a[180:183], v[92:95], a[20:23]
v_exp_f32 v15, v15
v_mfma_f32_16x16x32_bf16 a[24:27], a[180:183], v[96:99], a[24:27]
v_cvt_pk_bf16_f32 v75, v14, v15
v_mfma_f32_16x16x32_bf16 a[28:31], a[180:183], v[100:103], a[28:31]
v_exp_f32 v16, v16
v_mfma_f32_16x16x32_bf16 v[56:59], a[144:147], v[184:187], v[144:147]
ds_read_b64_tr_b16 a[180:181], v221 offset:49152
ds_read_b64_tr_b16 a[182:183], v221 offset:53248
v_mfma_f32_16x16x32_bf16 v[56:59], a[148:151], v[188:191], v[56:59]
v_exp_f32 v17, v17
v_mfma_f32_16x16x32_bf16 v[56:59], a[152:155], v[192:195], v[56:59]
s_bitset0_b32 s32, 19
v_cvt_pk_bf16_f32 v76, v16, v17
v_mfma_f32_16x16x32_bf16 v[56:59], a[156:159], v[196:199], v[56:59]
v_exp_f32 v18, v18
v_mfma_f32_16x16x32_bf16 a[32:35], a[184:187], v[88:91], a[32:35]
s_add_u32 m0, s30, 114688
v_mfma_f32_16x16x32_bf16 a[36:39], a[184:187], v[92:95], a[36:39]
v_exp_f32 v19, v19
v_mfma_f32_16x16x32_bf16 a[40:43], a[184:187], v[96:99], a[40:43]
v_cvt_pk_bf16_f32 v77, v18, v19
v_mfma_f32_16x16x32_bf16 a[44:47], a[184:187], v[100:103], a[44:47]
v_exp_f32 v20, v20
v_mfma_f32_16x16x32_bf16 v[64:67], a[144:147], v[200:203], v[148:151]
ds_read_b64_tr_b16 a[184:185], v222 offset:49152
ds_read_b64_tr_b16 a[186:187], v222 offset:53248
v_mfma_f32_16x16x32_bf16 v[64:67], a[148:151], v[204:207], v[64:67]
v_exp_f32 v21, v21
v_mfma_f32_16x16x32_bf16 v[64:67], a[152:155], v[208:211], v[64:67]
ds_read_b128 a[144:147], v216 offset:0
v_cvt_pk_bf16_f32 v78, v20, v21
v_mfma_f32_16x16x32_bf16 v[64:67], a[156:159], v[212:215], v[64:67]
v_exp_f32 v22, v22
v_mfma_f32_16x16x32_bf16 a[48:51], a[188:191], v[88:91], a[48:51]
ds_read_b128 a[148:151], v217 offset:0
ds_read_b128 a[152:155], v218 offset:0
v_mfma_f32_16x16x32_bf16 a[52:55], a[188:191], v[92:95], a[52:55]
v_exp_f32 v23, v23
v_mfma_f32_16x16x32_bf16 a[56:59], a[188:191], v[96:99], a[56:59]
ds_read_b128 a[156:159], v219 offset:0
v_cvt_pk_bf16_f32 v79, v22, v23
v_mfma_f32_16x16x32_bf16 a[60:63], a[188:191], v[100:103], a[60:63]
v_exp_f32 v24, v24
v_smfmac_f32_16x16x64_bf16 a[128:131], a[208:211], v[88:95], v245
v_exp_f32 v25, v25
v_mfma_f32_16x16x32_bf16 v[44:47], a[160:163], v[152:155], v[136:139]
ds_read_b64_tr_b16 a[188:189], v223 offset:49152
v_cvt_pk_bf16_f32 v80, v24, v25
v_mfma_f32_16x16x32_bf16 v[44:47], a[164:167], v[156:159], v[44:47]
v_exp_f32 v26, v26
v_mfma_f32_16x16x32_bf16 v[44:47], a[168:171], v[160:163], v[44:47]
ds_read_b64_tr_b16 a[190:191], v223 offset:53248
buffer_load_dwordx4 v228, s[8:11], s32 offen offset:0 lds
v_mfma_f32_16x16x32_bf16 v[44:47], a[172:175], v[164:167], v[44:47]
v_exp_f32 v27, v27
v_mfma_f32_16x16x32_bf16 a[64:67], a[192:195], v[88:91], a[64:67]
buffer_load_dwordx4 v229, s[8:11], s32 offen offset:1024 lds
v_cvt_pk_bf16_f32 v81, v26, v27
v_mfma_f32_16x16x32_bf16 a[68:71], a[192:195], v[92:95], a[68:71]
v_exp_f32 v28, v28
v_mfma_f32_16x16x32_bf16 a[72:75], a[192:195], v[96:99], a[72:75]
buffer_load_dwordx4 v230, s[8:11], s32 offen offset:2048 lds
v_mfma_f32_16x16x32_bf16 a[76:79], a[192:195], v[100:103], a[76:79]
v_exp_f32 v29, v29
v_mfma_f32_16x16x32_bf16 v[52:55], a[160:163], v[168:171], v[140:143]
ds_read_b64_tr_b16 a[192:193], v224 offset:49152
v_cvt_pk_bf16_f32 v82, v28, v29
v_mfma_f32_16x16x32_bf16 v[52:55], a[164:167], v[172:175], v[52:55]
v_exp_f32 v30, v30
v_mfma_f32_16x16x32_bf16 v[52:55], a[168:171], v[176:179], v[52:55]
ds_read_b64_tr_b16 a[194:195], v224 offset:53248
buffer_load_dwordx4 v231, s[8:11], s32 offen offset:3072 lds
v_mfma_f32_16x16x32_bf16 v[52:55], a[172:175], v[180:183], v[52:55]
v_exp_f32 v31, v31
v_mfma_f32_16x16x32_bf16 a[80:83], a[196:199], v[88:91], a[80:83]
v_cvt_pk_bf16_f32 v83, v30, v31
v_mfma_f32_16x16x32_bf16 a[84:87], a[196:199], v[92:95], a[84:87]
v_exp_f32 v32, v32
v_mfma_f32_16x16x32_bf16 a[88:91], a[196:199], v[96:99], a[88:91]
v_mfma_f32_16x16x32_bf16 a[92:95], a[196:199], v[100:103], a[92:95]
v_exp_f32 v33, v33
v_mfma_f32_16x16x32_bf16 v[60:63], a[160:163], v[184:187], v[144:147]
ds_read_b64_tr_b16 a[196:197], v225 offset:49152
v_cvt_pk_bf16_f32 v84, v32, v33
v_mfma_f32_16x16x32_bf16 v[60:63], a[164:167], v[188:191], v[60:63]
v_exp_f32 v34, v34
v_mfma_f32_16x16x32_bf16 v[60:63], a[168:171], v[192:195], v[60:63]
ds_read_b64_tr_b16 a[198:199], v225 offset:53248
v_mfma_f32_16x16x32_bf16 v[60:63], a[172:175], v[196:199], v[60:63]
v_exp_f32 v35, v35
v_mfma_f32_16x16x32_bf16 a[96:99], a[200:203], v[88:91], a[96:99]
v_cvt_pk_bf16_f32 v85, v34, v35
v_mfma_f32_16x16x32_bf16 a[100:103], a[200:203], v[92:95], a[100:103]
v_exp_f32 v36, v36
v_mfma_f32_16x16x32_bf16 a[104:107], a[200:203], v[96:99], a[104:107]
s_add_u32 m0, s86, 16384
s_add_u32 s50, s84, 2359296
buffer_load_dwordx4 v240, s[64:67], s50 offen lds
v_mfma_f32_16x16x32_bf16 a[108:111], a[200:203], v[100:103], a[108:111]
v_exp_f32 v37, v37
v_mfma_f32_16x16x32_bf16 v[68:71], a[160:163], v[200:203], v[148:151]
ds_read_b64_tr_b16 a[200:201], v226 offset:49152
v_cvt_pk_bf16_f32 v86, v36, v37
v_mfma_f32_16x16x32_bf16 v[68:71], a[164:167], v[204:207], v[68:71]
v_exp_f32 v38, v38
v_mfma_f32_16x16x32_bf16 v[68:71], a[168:171], v[208:211], v[68:71]
ds_read_b64_tr_b16 a[202:203], v226 offset:53248
ds_read_b128 a[160:163], v216 offset:4096
v_mfma_f32_16x16x32_bf16 v[68:71], a[172:175], v[212:215], v[68:71]
v_exp_f32 v39, v39
v_mfma_f32_16x16x32_bf16 a[112:115], a[204:207], v[88:91], a[112:115]
ds_read_b128 a[164:167], v217 offset:4096
v_cvt_pk_bf16_f32 v87, v38, v39
v_mfma_f32_16x16x32_bf16 a[116:119], a[204:207], v[92:95], a[116:119]
ds_read_b128 a[168:171], v218 offset:4096
ds_read_b128 a[172:175], v219 offset:4096
v_mfma_f32_16x16x32_bf16 a[120:123], a[204:207], v[96:99], a[120:123]
s_add_u32 m0, s86, 20480
s_add_u32 s50, s84, 2949120
buffer_load_dwordx4 v240, s[64:67], s50 offen lds
v_mfma_f32_16x16x32_bf16 a[124:127], a[204:207], v[100:103], a[124:127]
ds_read_b64_tr_b16 a[204:205], v227 offset:49152
ds_read_b64_tr_b16 a[206:207], v227 offset:53248
v_smfmac_f32_16x16x64_bf16 a[132:135], a[208:211], v[96:103], v245
s_waitcnt lgkmcnt(8)
v_mfma_f32_16x16x32_bf16 v[8:11], a[144:147], v[152:155], v[136:139]
v_exp_f32 v40, v40
v_mfma_f32_16x16x32_bf16 v[8:11], a[148:151], v[156:159], v[8:11]
v_exp_f32 v41, v41
v_mfma_f32_16x16x32_bf16 v[8:11], a[152:155], v[160:163], v[8:11]
v_cvt_pk_bf16_f32 v88, v40, v41
v_mfma_f32_16x16x32_bf16 v[8:11], a[156:159], v[164:167], v[8:11]
v_exp_f32 v42, v42
v_mfma_f32_16x16x32_bf16 a[0:3], a[176:179], v[72:75], a[0:3]
s_add_u32 s39, s39, 16384
v_mfma_f32_16x16x32_bf16 a[4:7], a[176:179], v[76:79], a[4:7]
v_exp_f32 v43, v43
v_mfma_f32_16x16x32_bf16 a[8:11], a[176:179], v[80:83], a[8:11]
v_cvt_pk_bf16_f32 v89, v42, v43
v_mfma_f32_16x16x32_bf16 a[12:15], a[176:179], v[84:87], a[12:15]
v_exp_f32 v44, v44
v_mfma_f32_16x16x32_bf16 v[16:19], a[144:147], v[168:171], v[140:143]
ds_read_b64_tr_b16 a[176:177], v220 offset:57344
ds_read_b64_tr_b16 a[178:179], v220 offset:61440
v_mfma_f32_16x16x32_bf16 v[16:19], a[148:151], v[172:175], v[16:19]
v_exp_f32 v45, v45
v_mfma_f32_16x16x32_bf16 v[16:19], a[152:155], v[176:179], v[16:19]
s_bitset0_b32 s39, 19
v_cvt_pk_bf16_f32 v90, v44, v45
v_mfma_f32_16x16x32_bf16 v[16:19], a[156:159], v[180:183], v[16:19]
v_exp_f32 v46, v46
v_mfma_f32_16x16x32_bf16 a[16:19], a[180:183], v[72:75], a[16:19]
v_mfma_f32_16x16x32_bf16 a[20:23], a[180:183], v[76:79], a[20:23]
v_exp_f32 v47, v47
v_mfma_f32_16x16x32_bf16 a[24:27], a[180:183], v[80:83], a[24:27]
v_cvt_pk_bf16_f32 v91, v46, v47
v_mfma_f32_16x16x32_bf16 a[28:31], a[180:183], v[84:87], a[28:31]
v_exp_f32 v48, v48
v_mfma_f32_16x16x32_bf16 v[24:27], a[144:147], v[184:187], v[144:147]
ds_read_b64_tr_b16 a[180:181], v221 offset:57344
ds_read_b64_tr_b16 a[182:183], v221 offset:61440
v_mfma_f32_16x16x32_bf16 v[24:27], a[148:151], v[188:191], v[24:27]
v_exp_f32 v49, v49
v_mfma_f32_16x16x32_bf16 v[24:27], a[152:155], v[192:195], v[24:27]
s_add_u32 m0, s30, 131072
v_cvt_pk_bf16_f32 v92, v48, v49
v_mfma_f32_16x16x32_bf16 v[24:27], a[156:159], v[196:199], v[24:27]
v_exp_f32 v50, v50
v_mfma_f32_16x16x32_bf16 a[32:35], a[184:187], v[72:75], a[32:35]
v_mfma_f32_16x16x32_bf16 a[36:39], a[184:187], v[76:79], a[36:39]
v_exp_f32 v51, v51
v_mfma_f32_16x16x32_bf16 a[40:43], a[184:187], v[80:83], a[40:43]
buffer_load_dwordx4 v232, s[12:15], s39 offen offset:0 lds
v_cvt_pk_bf16_f32 v93, v50, v51
v_mfma_f32_16x16x32_bf16 a[44:47], a[184:187], v[84:87], a[44:47]
v_exp_f32 v52, v52
v_mfma_f32_16x16x32_bf16 v[32:35], a[144:147], v[200:203], v[148:151]
ds_read_b64_tr_b16 a[184:185], v222 offset:57344
ds_read_b64_tr_b16 a[186:187], v222 offset:61440
v_mfma_f32_16x16x32_bf16 v[32:35], a[148:151], v[204:207], v[32:35]
v_exp_f32 v53, v53
v_mfma_f32_16x16x32_bf16 v[32:35], a[152:155], v[208:211], v[32:35]
ds_read_b128 a[144:147], v216 offset:8192
v_cvt_pk_bf16_f32 v94, v52, v53
v_mfma_f32_16x16x32_bf16 v[32:35], a[156:159], v[212:215], v[32:35]
v_exp_f32 v54, v54
v_mfma_f32_16x16x32_bf16 a[48:51], a[188:191], v[72:75], a[48:51]
ds_read_b128 a[148:151], v217 offset:8192
ds_read_b128 a[152:155], v218 offset:8192
v_mfma_f32_16x16x32_bf16 a[52:55], a[188:191], v[76:79], a[52:55]
v_exp_f32 v55, v55
v_mfma_f32_16x16x32_bf16 a[56:59], a[188:191], v[80:83], a[56:59]
ds_read_b128 a[156:159], v219 offset:8192
v_cvt_pk_bf16_f32 v95, v54, v55
v_mfma_f32_16x16x32_bf16 a[60:63], a[188:191], v[84:87], a[60:63]
v_exp_f32 v56, v56
v_smfmac_f32_16x16x64_bf16 a[128:131], a[208:211], v[72:79], v245
v_exp_f32 v57, v57
s_waitcnt lgkmcnt(8)
v_mfma_f32_16x16x32_bf16 v[12:15], a[160:163], v[152:155], v[136:139]
ds_read_b64_tr_b16 a[188:189], v223 offset:57344
v_cvt_pk_bf16_f32 v96, v56, v57
v_mfma_f32_16x16x32_bf16 v[12:15], a[164:167], v[156:159], v[12:15]
v_exp_f32 v58, v58
v_mfma_f32_16x16x32_bf16 v[12:15], a[168:171], v[160:163], v[12:15]
ds_read_b64_tr_b16 a[190:191], v223 offset:61440
buffer_load_dwordx4 v233, s[12:15], s39 offen offset:1024 lds
v_mfma_f32_16x16x32_bf16 v[12:15], a[172:175], v[164:167], v[12:15]
v_exp_f32 v59, v59
v_mfma_f32_16x16x32_bf16 a[64:67], a[192:195], v[72:75], a[64:67]
buffer_load_dwordx4 v232, s[12:15], s39 offen offset:2048 lds
v_cvt_pk_bf16_f32 v97, v58, v59
v_mfma_f32_16x16x32_bf16 a[68:71], a[192:195], v[76:79], a[68:71]
v_exp_f32 v60, v60
v_mfma_f32_16x16x32_bf16 a[72:75], a[192:195], v[80:83], a[72:75]
v_mfma_f32_16x16x32_bf16 a[76:79], a[192:195], v[84:87], a[76:79]
v_exp_f32 v61, v61
v_mfma_f32_16x16x32_bf16 v[20:23], a[160:163], v[168:171], v[140:143]
ds_read_b64_tr_b16 a[192:193], v224 offset:57344
v_cvt_pk_bf16_f32 v98, v60, v61
v_mfma_f32_16x16x32_bf16 v[20:23], a[164:167], v[172:175], v[20:23]
v_exp_f32 v62, v62
v_mfma_f32_16x16x32_bf16 v[20:23], a[168:171], v[176:179], v[20:23]
ds_read_b64_tr_b16 a[194:195], v224 offset:61440
buffer_load_dwordx4 v233, s[12:15], s39 offen offset:3072 lds
v_mfma_f32_16x16x32_bf16 v[20:23], a[172:175], v[180:183], v[20:23]
v_exp_f32 v63, v63
v_mfma_f32_16x16x32_bf16 a[80:83], a[196:199], v[72:75], a[80:83]
v_cvt_pk_bf16_f32 v99, v62, v63
v_mfma_f32_16x16x32_bf16 a[84:87], a[196:199], v[76:79], a[84:87]
v_exp_f32 v64, v64
v_mfma_f32_16x16x32_bf16 a[88:91], a[196:199], v[80:83], a[88:91]
s_add_u32 m0, s86, 24576
s_add_u32 s50, s84, 3538944
buffer_load_dwordx4 v240, s[64:67], s50 offen lds
v_mfma_f32_16x16x32_bf16 a[92:95], a[196:199], v[84:87], a[92:95]
v_exp_f32 v65, v65
v_mfma_f32_16x16x32_bf16 v[28:31], a[160:163], v[184:187], v[144:147]
ds_read_b64_tr_b16 a[196:197], v225 offset:57344
v_cvt_pk_bf16_f32 v100, v64, v65
v_mfma_f32_16x16x32_bf16 v[28:31], a[164:167], v[188:191], v[28:31]
v_exp_f32 v66, v66
v_mfma_f32_16x16x32_bf16 v[28:31], a[168:171], v[192:195], v[28:31]
ds_read_b64_tr_b16 a[198:199], v225 offset:61440
v_mfma_f32_16x16x32_bf16 v[28:31], a[172:175], v[196:199], v[28:31]
v_exp_f32 v67, v67
v_mfma_f32_16x16x32_bf16 a[96:99], a[200:203], v[72:75], a[96:99]
v_cvt_pk_bf16_f32 v101, v66, v67
v_mfma_f32_16x16x32_bf16 a[100:103], a[200:203], v[76:79], a[100:103]
v_exp_f32 v68, v68
v_mfma_f32_16x16x32_bf16 a[104:107], a[200:203], v[80:83], a[104:107]
s_add_u32 m0, s86, 28672
s_add_u32 s50, s84, 4128768
buffer_load_dwordx4 v240, s[64:67], s50 offen lds
v_mfma_f32_16x16x32_bf16 a[108:111], a[200:203], v[84:87], a[108:111]
v_exp_f32 v69, v69
v_mfma_f32_16x16x32_bf16 v[36:39], a[160:163], v[200:203], v[148:151]
ds_read_b64_tr_b16 a[200:201], v226 offset:57344
v_cvt_pk_bf16_f32 v102, v68, v69
v_mfma_f32_16x16x32_bf16 v[36:39], a[164:167], v[204:207], v[36:39]
v_exp_f32 v70, v70
v_mfma_f32_16x16x32_bf16 v[36:39], a[168:171], v[208:211], v[36:39]
ds_read_b64_tr_b16 a[202:203], v226 offset:61440
ds_read_b128 a[160:163], v216 offset:12288
v_mfma_f32_16x16x32_bf16 v[36:39], a[172:175], v[212:215], v[36:39]
v_exp_f32 v71, v71
v_mfma_f32_16x16x32_bf16 a[112:115], a[204:207], v[72:75], a[112:115]
ds_read_b128 a[164:167], v217 offset:12288
v_cvt_pk_bf16_f32 v103, v70, v71
v_mfma_f32_16x16x32_bf16 a[116:119], a[204:207], v[76:79], a[116:119]
ds_read_b128 a[168:171], v218 offset:12288
ds_read_b128 a[172:175], v219 offset:12288
v_mfma_f32_16x16x32_bf16 a[120:123], a[204:207], v[80:83], a[120:123]
v_mfma_f32_16x16x32_bf16 a[124:127], a[204:207], v[84:87], a[124:127]
ds_read_b64_tr_b16 a[204:205], v227 offset:57344
ds_read_b64_tr_b16 a[206:207], v227 offset:61440
v_smfmac_f32_16x16x64_bf16 a[132:135], a[208:211], v[80:87], v245
s_waitcnt lgkmcnt(8)
v_mfma_f32_16x16x32_bf16 v[40:43], a[144:147], v[152:155], v[136:139]
v_exp_f32 v8, v8
v_mfma_f32_16x16x32_bf16 v[40:43], a[148:151], v[156:159], v[40:43]
v_exp_f32 v9, v9
v_mfma_f32_16x16x32_bf16 v[40:43], a[152:155], v[160:163], v[40:43]
v_cvt_pk_bf16_f32 v72, v8, v9
v_mfma_f32_16x16x32_bf16 v[40:43], a[156:159], v[164:167], v[40:43]
v_exp_f32 v10, v10
v_mfma_f32_16x16x32_bf16 a[0:3], a[176:179], v[88:91], a[0:3]
v_mfma_f32_16x16x32_bf16 a[4:7], a[176:179], v[92:95], a[4:7]
v_exp_f32 v11, v11
v_mfma_f32_16x16x32_bf16 a[8:11], a[176:179], v[96:99], a[8:11]
v_cvt_pk_bf16_f32 v73, v10, v11
v_mfma_f32_16x16x32_bf16 a[12:15], a[176:179], v[100:103], a[12:15]
s_waitcnt vmcnt(12) lgkmcnt(0)
s_barrier
v_mfma_f32_16x16x32_bf16 v[48:51], a[144:147], v[168:171], v[140:143]
v_exp_f32 v12, v12
v_mfma_f32_16x16x32_bf16 v[48:51], a[148:151], v[172:175], v[48:51]
v_exp_f32 v13, v13
v_mfma_f32_16x16x32_bf16 v[48:51], a[152:155], v[176:179], v[48:51]
ds_read_b64_tr_b16 a[176:177], v220 offset:0
v_cvt_pk_bf16_f32 v74, v12, v13
v_mfma_f32_16x16x32_bf16 v[48:51], a[156:159], v[180:183], v[48:51]
v_exp_f32 v14, v14
v_mfma_f32_16x16x32_bf16 a[16:19], a[180:183], v[88:91], a[16:19]
ds_read_b64_tr_b16 a[178:179], v220 offset:4096
s_add_u32 s32, s32, 16384
v_mfma_f32_16x16x32_bf16 a[20:23], a[180:183], v[92:95], a[20:23]
v_exp_f32 v15, v15
v_mfma_f32_16x16x32_bf16 a[24:27], a[180:183], v[96:99], a[24:27]
v_cvt_pk_bf16_f32 v75, v14, v15
v_mfma_f32_16x16x32_bf16 a[28:31], a[180:183], v[100:103], a[28:31]
v_exp_f32 v16, v16
v_mfma_f32_16x16x32_bf16 v[56:59], a[144:147], v[184:187], v[144:147]
ds_read_b64_tr_b16 a[180:181], v221 offset:0
ds_read_b64_tr_b16 a[182:183], v221 offset:4096
v_mfma_f32_16x16x32_bf16 v[56:59], a[148:151], v[188:191], v[56:59]
v_exp_f32 v17, v17
v_mfma_f32_16x16x32_bf16 v[56:59], a[152:155], v[192:195], v[56:59]
s_bitset0_b32 s32, 19
v_cvt_pk_bf16_f32 v76, v16, v17
v_mfma_f32_16x16x32_bf16 v[56:59], a[156:159], v[196:199], v[56:59]
v_exp_f32 v18, v18
v_mfma_f32_16x16x32_bf16 a[32:35], a[184:187], v[88:91], a[32:35]
s_add_u32 m0, s30, 65536
s_nop 0
buffer_load_dword v253, v249, s[24:27], 0 offen sc0 sc1
v_mfma_f32_16x16x32_bf16 a[36:39], a[184:187], v[92:95], a[36:39]
v_exp_f32 v19, v19
v_mfma_f32_16x16x32_bf16 a[40:43], a[184:187], v[96:99], a[40:43]
v_cvt_pk_bf16_f32 v77, v18, v19
v_mfma_f32_16x16x32_bf16 a[44:47], a[184:187], v[100:103], a[44:47]
v_exp_f32 v20, v20
v_mfma_f32_16x16x32_bf16 v[64:67], a[144:147], v[200:203], v[148:151]
ds_read_b64_tr_b16 a[184:185], v222 offset:0
ds_read_b64_tr_b16 a[186:187], v222 offset:4096
v_mfma_f32_16x16x32_bf16 v[64:67], a[148:151], v[204:207], v[64:67]
v_exp_f32 v21, v21
v_mfma_f32_16x16x32_bf16 v[64:67], a[152:155], v[208:211], v[64:67]
ds_read_b128 a[144:147], v216 offset:16384
v_cvt_pk_bf16_f32 v78, v20, v21
v_mfma_f32_16x16x32_bf16 v[64:67], a[156:159], v[212:215], v[64:67]
v_exp_f32 v22, v22
v_mfma_f32_16x16x32_bf16 a[48:51], a[188:191], v[88:91], a[48:51]
ds_read_b128 a[148:151], v217 offset:16384
ds_read_b128 a[152:155], v218 offset:16384
v_mfma_f32_16x16x32_bf16 a[52:55], a[188:191], v[92:95], a[52:55]
v_exp_f32 v23, v23
v_mfma_f32_16x16x32_bf16 a[56:59], a[188:191], v[96:99], a[56:59]
ds_read_b128 a[156:159], v219 offset:16384
v_cvt_pk_bf16_f32 v79, v22, v23
v_mfma_f32_16x16x32_bf16 a[60:63], a[188:191], v[100:103], a[60:63]
v_exp_f32 v24, v24
v_smfmac_f32_16x16x64_bf16 a[128:131], a[208:211], v[88:95], v245
v_exp_f32 v25, v25
v_mfma_f32_16x16x32_bf16 v[44:47], a[160:163], v[152:155], v[136:139]
ds_read_b64_tr_b16 a[188:189], v223 offset:0
v_cvt_pk_bf16_f32 v80, v24, v25
v_mfma_f32_16x16x32_bf16 v[44:47], a[164:167], v[156:159], v[44:47]
v_exp_f32 v26, v26
v_mfma_f32_16x16x32_bf16 v[44:47], a[168:171], v[160:163], v[44:47]
ds_read_b64_tr_b16 a[190:191], v223 offset:4096
buffer_load_dwordx4 v228, s[8:11], s32 offen offset:0 lds
v_mfma_f32_16x16x32_bf16 v[44:47], a[172:175], v[164:167], v[44:47]
v_exp_f32 v27, v27
v_mfma_f32_16x16x32_bf16 a[64:67], a[192:195], v[88:91], a[64:67]
buffer_load_dwordx4 v229, s[8:11], s32 offen offset:1024 lds
v_cvt_pk_bf16_f32 v81, v26, v27
v_mfma_f32_16x16x32_bf16 a[68:71], a[192:195], v[92:95], a[68:71]
v_exp_f32 v28, v28
v_mfma_f32_16x16x32_bf16 a[72:75], a[192:195], v[96:99], a[72:75]
buffer_load_dwordx4 v230, s[8:11], s32 offen offset:2048 lds
v_mfma_f32_16x16x32_bf16 a[76:79], a[192:195], v[100:103], a[76:79]
v_exp_f32 v29, v29
v_mfma_f32_16x16x32_bf16 v[52:55], a[160:163], v[168:171], v[140:143]
ds_read_b64_tr_b16 a[192:193], v224 offset:0
v_cvt_pk_bf16_f32 v82, v28, v29
v_mfma_f32_16x16x32_bf16 v[52:55], a[164:167], v[172:175], v[52:55]
v_exp_f32 v30, v30
v_mfma_f32_16x16x32_bf16 v[52:55], a[168:171], v[176:179], v[52:55]
ds_read_b64_tr_b16 a[194:195], v224 offset:4096
buffer_load_dwordx4 v231, s[8:11], s32 offen offset:3072 lds
v_mfma_f32_16x16x32_bf16 v[52:55], a[172:175], v[180:183], v[52:55]
v_exp_f32 v31, v31
v_mfma_f32_16x16x32_bf16 a[80:83], a[196:199], v[88:91], a[80:83]
v_cvt_pk_bf16_f32 v83, v30, v31
v_mfma_f32_16x16x32_bf16 a[84:87], a[196:199], v[92:95], a[84:87]
v_exp_f32 v32, v32
v_mfma_f32_16x16x32_bf16 a[88:91], a[196:199], v[96:99], a[88:91]
v_mfma_f32_16x16x32_bf16 a[92:95], a[196:199], v[100:103], a[92:95]
v_exp_f32 v33, v33
v_mfma_f32_16x16x32_bf16 v[60:63], a[160:163], v[184:187], v[144:147]
ds_read_b64_tr_b16 a[196:197], v225 offset:0
v_cvt_pk_bf16_f32 v84, v32, v33
v_mfma_f32_16x16x32_bf16 v[60:63], a[164:167], v[188:191], v[60:63]
v_exp_f32 v34, v34
v_mfma_f32_16x16x32_bf16 v[60:63], a[168:171], v[192:195], v[60:63]
ds_read_b64_tr_b16 a[198:199], v225 offset:4096
v_mfma_f32_16x16x32_bf16 v[60:63], a[172:175], v[196:199], v[60:63]
v_exp_f32 v35, v35
v_mfma_f32_16x16x32_bf16 a[96:99], a[200:203], v[88:91], a[96:99]
v_cvt_pk_bf16_f32 v85, v34, v35
v_mfma_f32_16x16x32_bf16 a[100:103], a[200:203], v[92:95], a[100:103]
v_exp_f32 v36, v36
v_mfma_f32_16x16x32_bf16 a[104:107], a[200:203], v[96:99], a[104:107]
s_add_u32 m0, s86, 32768
s_add_u32 s50, s84, 0
buffer_load_dwordx4 v240, s[68:71], s50 offen lds
v_mfma_f32_16x16x32_bf16 a[108:111], a[200:203], v[100:103], a[108:111]
v_exp_f32 v37, v37
v_mfma_f32_16x16x32_bf16 v[68:71], a[160:163], v[200:203], v[148:151]
ds_read_b64_tr_b16 a[200:201], v226 offset:0
v_cvt_pk_bf16_f32 v86, v36, v37
v_mfma_f32_16x16x32_bf16 v[68:71], a[164:167], v[204:207], v[68:71]
v_exp_f32 v38, v38
v_mfma_f32_16x16x32_bf16 v[68:71], a[168:171], v[208:211], v[68:71]
ds_read_b64_tr_b16 a[202:203], v226 offset:4096
ds_read_b128 a[160:163], v216 offset:20480
v_mfma_f32_16x16x32_bf16 v[68:71], a[172:175], v[212:215], v[68:71]
v_exp_f32 v39, v39
v_mfma_f32_16x16x32_bf16 a[112:115], a[204:207], v[88:91], a[112:115]
ds_read_b128 a[164:167], v217 offset:20480
v_cvt_pk_bf16_f32 v87, v38, v39
v_mfma_f32_16x16x32_bf16 a[116:119], a[204:207], v[92:95], a[116:119]
ds_read_b128 a[168:171], v218 offset:20480
ds_read_b128 a[172:175], v219 offset:20480
v_mfma_f32_16x16x32_bf16 a[120:123], a[204:207], v[96:99], a[120:123]
s_add_u32 m0, s86, 36864
s_add_u32 s50, s84, 589824
buffer_load_dwordx4 v240, s[68:71], s50 offen lds
v_mfma_f32_16x16x32_bf16 a[124:127], a[204:207], v[100:103], a[124:127]
ds_read_b64_tr_b16 a[204:205], v227 offset:0
ds_read_b64_tr_b16 a[206:207], v227 offset:4096
v_smfmac_f32_16x16x64_bf16 a[132:135], a[208:211], v[96:103], v245
s_waitcnt lgkmcnt(8)
v_mfma_f32_16x16x32_bf16 v[8:11], a[144:147], v[152:155], v[136:139]
v_exp_f32 v40, v40
v_mfma_f32_16x16x32_bf16 v[8:11], a[148:151], v[156:159], v[8:11]
v_exp_f32 v41, v41
v_mfma_f32_16x16x32_bf16 v[8:11], a[152:155], v[160:163], v[8:11]
v_cvt_pk_bf16_f32 v88, v40, v41
v_mfma_f32_16x16x32_bf16 v[8:11], a[156:159], v[164:167], v[8:11]
v_exp_f32 v42, v42
v_mfma_f32_16x16x32_bf16 a[0:3], a[176:179], v[72:75], a[0:3]
s_add_u32 s39, s39, 16384
v_mfma_f32_16x16x32_bf16 a[4:7], a[176:179], v[76:79], a[4:7]
v_exp_f32 v43, v43
v_mfma_f32_16x16x32_bf16 a[8:11], a[176:179], v[80:83], a[8:11]
v_cvt_pk_bf16_f32 v89, v42, v43
v_mfma_f32_16x16x32_bf16 a[12:15], a[176:179], v[84:87], a[12:15]
v_exp_f32 v44, v44
v_mfma_f32_16x16x32_bf16 v[16:19], a[144:147], v[168:171], v[140:143]
ds_read_b64_tr_b16 a[176:177], v220 offset:8192
ds_read_b64_tr_b16 a[178:179], v220 offset:12288
v_mfma_f32_16x16x32_bf16 v[16:19], a[148:151], v[172:175], v[16:19]
v_exp_f32 v45, v45
v_mfma_f32_16x16x32_bf16 v[16:19], a[152:155], v[176:179], v[16:19]
s_bitset0_b32 s39, 19
v_cvt_pk_bf16_f32 v90, v44, v45
v_mfma_f32_16x16x32_bf16 v[16:19], a[156:159], v[180:183], v[16:19]
v_exp_f32 v46, v46
v_mfma_f32_16x16x32_bf16 a[16:19], a[180:183], v[72:75], a[16:19]
v_mfma_f32_16x16x32_bf16 a[20:23], a[180:183], v[76:79], a[20:23]
v_exp_f32 v47, v47
v_mfma_f32_16x16x32_bf16 a[24:27], a[180:183], v[80:83], a[24:27]
v_cvt_pk_bf16_f32 v91, v46, v47
v_mfma_f32_16x16x32_bf16 a[28:31], a[180:183], v[84:87], a[28:31]
v_exp_f32 v48, v48
v_mfma_f32_16x16x32_bf16 v[24:27], a[144:147], v[184:187], v[144:147]
ds_read_b64_tr_b16 a[180:181], v221 offset:8192
ds_read_b64_tr_b16 a[182:183], v221 offset:12288
v_mfma_f32_16x16x32_bf16 v[24:27], a[148:151], v[188:191], v[24:27]
v_exp_f32 v49, v49
v_mfma_f32_16x16x32_bf16 v[24:27], a[152:155], v[192:195], v[24:27]
s_add_u32 m0, s30, 147456
v_cvt_pk_bf16_f32 v92, v48, v49
v_mfma_f32_16x16x32_bf16 v[24:27], a[156:159], v[196:199], v[24:27]
v_exp_f32 v50, v50
v_mfma_f32_16x16x32_bf16 a[32:35], a[184:187], v[72:75], a[32:35]
v_mfma_f32_16x16x32_bf16 a[36:39], a[184:187], v[76:79], a[36:39]
v_exp_f32 v51, v51
v_mfma_f32_16x16x32_bf16 a[40:43], a[184:187], v[80:83], a[40:43]
buffer_load_dwordx4 v232, s[12:15], s39 offen offset:0 lds
v_cvt_pk_bf16_f32 v93, v50, v51
v_mfma_f32_16x16x32_bf16 a[44:47], a[184:187], v[84:87], a[44:47]
v_exp_f32 v52, v52
v_mfma_f32_16x16x32_bf16 v[32:35], a[144:147], v[200:203], v[148:151]
ds_read_b64_tr_b16 a[184:185], v222 offset:8192
ds_read_b64_tr_b16 a[186:187], v222 offset:12288
v_mfma_f32_16x16x32_bf16 v[32:35], a[148:151], v[204:207], v[32:35]
v_exp_f32 v53, v53
v_mfma_f32_16x16x32_bf16 v[32:35], a[152:155], v[208:211], v[32:35]
ds_read_b128 a[144:147], v216 offset:24576
v_cvt_pk_bf16_f32 v94, v52, v53
v_mfma_f32_16x16x32_bf16 v[32:35], a[156:159], v[212:215], v[32:35]
v_exp_f32 v54, v54
v_mfma_f32_16x16x32_bf16 a[48:51], a[188:191], v[72:75], a[48:51]
ds_read_b128 a[148:151], v217 offset:24576
ds_read_b128 a[152:155], v218 offset:24576
v_mfma_f32_16x16x32_bf16 a[52:55], a[188:191], v[76:79], a[52:55]
v_exp_f32 v55, v55
v_mfma_f32_16x16x32_bf16 a[56:59], a[188:191], v[80:83], a[56:59]
ds_read_b128 a[156:159], v219 offset:24576
v_cvt_pk_bf16_f32 v95, v54, v55
v_mfma_f32_16x16x32_bf16 a[60:63], a[188:191], v[84:87], a[60:63]
v_exp_f32 v56, v56
v_smfmac_f32_16x16x64_bf16 a[128:131], a[208:211], v[72:79], v245
v_exp_f32 v57, v57
s_waitcnt lgkmcnt(8)
v_mfma_f32_16x16x32_bf16 v[12:15], a[160:163], v[152:155], v[136:139]
ds_read_b64_tr_b16 a[188:189], v223 offset:8192
v_cvt_pk_bf16_f32 v96, v56, v57
v_mfma_f32_16x16x32_bf16 v[12:15], a[164:167], v[156:159], v[12:15]
v_exp_f32 v58, v58
v_mfma_f32_16x16x32_bf16 v[12:15], a[168:171], v[160:163], v[12:15]
ds_read_b64_tr_b16 a[190:191], v223 offset:12288
buffer_load_dwordx4 v233, s[12:15], s39 offen offset:1024 lds
v_mfma_f32_16x16x32_bf16 v[12:15], a[172:175], v[164:167], v[12:15]
v_exp_f32 v59, v59
v_mfma_f32_16x16x32_bf16 a[64:67], a[192:195], v[72:75], a[64:67]
buffer_load_dwordx4 v232, s[12:15], s39 offen offset:2048 lds
v_cvt_pk_bf16_f32 v97, v58, v59
v_mfma_f32_16x16x32_bf16 a[68:71], a[192:195], v[76:79], a[68:71]
v_exp_f32 v60, v60
v_mfma_f32_16x16x32_bf16 a[72:75], a[192:195], v[80:83], a[72:75]
v_mfma_f32_16x16x32_bf16 a[76:79], a[192:195], v[84:87], a[76:79]
v_exp_f32 v61, v61
v_mfma_f32_16x16x32_bf16 v[20:23], a[160:163], v[168:171], v[140:143]
ds_read_b64_tr_b16 a[192:193], v224 offset:8192
v_cvt_pk_bf16_f32 v98, v60, v61
v_mfma_f32_16x16x32_bf16 v[20:23], a[164:167], v[172:175], v[20:23]
v_exp_f32 v62, v62
v_mfma_f32_16x16x32_bf16 v[20:23], a[168:171], v[176:179], v[20:23]
ds_read_b64_tr_b16 a[194:195], v224 offset:12288
buffer_load_dwordx4 v233, s[12:15], s39 offen offset:3072 lds
v_mfma_f32_16x16x32_bf16 v[20:23], a[172:175], v[180:183], v[20:23]
v_exp_f32 v63, v63
v_mfma_f32_16x16x32_bf16 a[80:83], a[196:199], v[72:75], a[80:83]
v_cvt_pk_bf16_f32 v99, v62, v63
v_mfma_f32_16x16x32_bf16 a[84:87], a[196:199], v[76:79], a[84:87]
v_exp_f32 v64, v64
v_mfma_f32_16x16x32_bf16 a[88:91], a[196:199], v[80:83], a[88:91]
s_add_u32 m0, s86, 40960
s_add_u32 s50, s84, 1179648
buffer_load_dwordx4 v240, s[68:71], s50 offen lds
v_mfma_f32_16x16x32_bf16 a[92:95], a[196:199], v[84:87], a[92:95]
v_exp_f32 v65, v65
v_mfma_f32_16x16x32_bf16 v[28:31], a[160:163], v[184:187], v[144:147]
ds_read_b64_tr_b16 a[196:197], v225 offset:8192
v_cvt_pk_bf16_f32 v100, v64, v65
v_mfma_f32_16x16x32_bf16 v[28:31], a[164:167], v[188:191], v[28:31]
v_exp_f32 v66, v66
v_mfma_f32_16x16x32_bf16 v[28:31], a[168:171], v[192:195], v[28:31]
ds_read_b64_tr_b16 a[198:199], v225 offset:12288
v_mfma_f32_16x16x32_bf16 v[28:31], a[172:175], v[196:199], v[28:31]
v_exp_f32 v67, v67
v_mfma_f32_16x16x32_bf16 a[96:99], a[200:203], v[72:75], a[96:99]
v_cvt_pk_bf16_f32 v101, v66, v67
v_mfma_f32_16x16x32_bf16 a[100:103], a[200:203], v[76:79], a[100:103]
v_exp_f32 v68, v68
v_mfma_f32_16x16x32_bf16 a[104:107], a[200:203], v[80:83], a[104:107]
s_add_u32 m0, s86, 45056
s_add_u32 s50, s84, 1769472
buffer_load_dwordx4 v240, s[68:71], s50 offen lds
v_mfma_f32_16x16x32_bf16 a[108:111], a[200:203], v[84:87], a[108:111]
v_exp_f32 v69, v69
v_mfma_f32_16x16x32_bf16 v[36:39], a[160:163], v[200:203], v[148:151]
ds_read_b64_tr_b16 a[200:201], v226 offset:8192
v_cvt_pk_bf16_f32 v102, v68, v69
v_mfma_f32_16x16x32_bf16 v[36:39], a[164:167], v[204:207], v[36:39]
v_exp_f32 v70, v70
v_mfma_f32_16x16x32_bf16 v[36:39], a[168:171], v[208:211], v[36:39]
ds_read_b64_tr_b16 a[202:203], v226 offset:12288
ds_read_b128 a[160:163], v216 offset:28672
v_mfma_f32_16x16x32_bf16 v[36:39], a[172:175], v[212:215], v[36:39]
v_exp_f32 v71, v71
v_mfma_f32_16x16x32_bf16 a[112:115], a[204:207], v[72:75], a[112:115]
ds_read_b128 a[164:167], v217 offset:28672
v_cvt_pk_bf16_f32 v103, v70, v71
v_mfma_f32_16x16x32_bf16 a[116:119], a[204:207], v[76:79], a[116:119]
ds_read_b128 a[168:171], v218 offset:28672
ds_read_b128 a[172:175], v219 offset:28672
v_mfma_f32_16x16x32_bf16 a[120:123], a[204:207], v[80:83], a[120:123]
s_waitcnt vmcnt(12)
v_and_b32 v250, 0x20202020, v253
v_mfma_f32_16x16x32_bf16 a[124:127], a[204:207], v[84:87], a[124:127]
ds_read_b64_tr_b16 a[204:205], v227 offset:8192
ds_read_b64_tr_b16 a[206:207], v227 offset:12288
v_smfmac_f32_16x16x64_bf16 a[132:135], a[208:211], v[80:87], v245
v_cmp_ne_u32 vcc, 0x20202020, v250
s_cbranch_vccnz SP_FL
SP_FL_RET:
s_waitcnt lgkmcnt(8)
v_mfma_f32_16x16x32_bf16 v[40:43], a[144:147], v[152:155], v[136:139]
v_exp_f32 v8, v8
v_mfma_f32_16x16x32_bf16 v[40:43], a[148:151], v[156:159], v[40:43]
v_exp_f32 v9, v9
v_mfma_f32_16x16x32_bf16 v[40:43], a[152:155], v[160:163], v[40:43]
v_cvt_pk_bf16_f32 v72, v8, v9
v_mfma_f32_16x16x32_bf16 v[40:43], a[156:159], v[164:167], v[40:43]
v_exp_f32 v10, v10
v_mfma_f32_16x16x32_bf16 a[0:3], a[176:179], v[88:91], a[0:3]
v_mfma_f32_16x16x32_bf16 a[4:7], a[176:179], v[92:95], a[4:7]
v_exp_f32 v11, v11
v_mfma_f32_16x16x32_bf16 a[8:11], a[176:179], v[96:99], a[8:11]
v_cvt_pk_bf16_f32 v73, v10, v11
v_mfma_f32_16x16x32_bf16 a[12:15], a[176:179], v[100:103], a[12:15]
s_waitcnt vmcnt(13) lgkmcnt(0)
s_barrier
v_mfma_f32_16x16x32_bf16 v[48:51], a[144:147], v[168:171], v[140:143]
v_exp_f32 v12, v12
v_mfma_f32_16x16x32_bf16 v[48:51], a[148:151], v[172:175], v[48:51]
v_exp_f32 v13, v13
v_mfma_f32_16x16x32_bf16 v[48:51], a[152:155], v[176:179], v[48:51]
ds_read_b64_tr_b16 a[176:177], v220 offset:32768
v_cvt_pk_bf16_f32 v74, v12, v13
v_mfma_f32_16x16x32_bf16 v[48:51], a[156:159], v[180:183], v[48:51]
v_exp_f32 v14, v14
v_mfma_f32_16x16x32_bf16 a[16:19], a[180:183], v[88:91], a[16:19]
ds_read_b64_tr_b16 a[178:179], v220 offset:36864
s_add_u32 s32, s32, 16384
v_mfma_f32_16x16x32_bf16 a[20:23], a[180:183], v[92:95], a[20:23]
v_exp_f32 v15, v15
v_mfma_f32_16x16x32_bf16 a[24:27], a[180:183], v[96:99], a[24:27]
s_mov_b32 s29, 0x242000
buffer_load_dword v248, v249, s[20:23], s29 offen sc0 sc1
v_cvt_pk_bf16_f32 v75, v14, v15
v_mfma_f32_16x16x32_bf16 a[28:31], a[180:183], v[100:103], a[28:31]
v_exp_f32 v16, v16
v_mfma_f32_16x16x32_bf16 v[56:59], a[144:147], v[184:187], v[144:147]
ds_read_b64_tr_b16 a[180:181], v221 offset:32768
ds_read_b64_tr_b16 a[182:183], v221 offset:36864
v_mfma_f32_16x16x32_bf16 v[56:59], a[148:151], v[188:191], v[56:59]
v_exp_f32 v17, v17
v_mfma_f32_16x16x32_bf16 v[56:59], a[152:155], v[192:195], v[56:59]
s_bitset0_b32 s32, 19
v_cvt_pk_bf16_f32 v76, v16, v17
v_mfma_f32_16x16x32_bf16 v[56:59], a[156:159], v[196:199], v[56:59]
v_exp_f32 v18, v18
v_mfma_f32_16x16x32_bf16 a[32:35], a[184:187], v[88:91], a[32:35]
s_add_u32 m0, s30, 81920
v_mfma_f32_16x16x32_bf16 a[36:39], a[184:187], v[92:95], a[36:39]
v_exp_f32 v19, v19
v_mfma_f32_16x16x32_bf16 a[40:43], a[184:187], v[96:99], a[40:43]
v_cvt_pk_bf16_f32 v77, v18, v19
v_mfma_f32_16x16x32_bf16 a[44:47], a[184:187], v[100:103], a[44:47]
v_exp_f32 v20, v20
v_mfma_f32_16x16x32_bf16 v[64:67], a[144:147], v[200:203], v[148:151]
ds_read_b64_tr_b16 a[184:185], v222 offset:32768
ds_read_b64_tr_b16 a[186:187], v222 offset:36864
v_mfma_f32_16x16x32_bf16 v[64:67], a[148:151], v[204:207], v[64:67]
v_exp_f32 v21, v21
v_mfma_f32_16x16x32_bf16 v[64:67], a[152:155], v[208:211], v[64:67]
ds_read_b128 a[144:147], v216 offset:49152
v_cvt_pk_bf16_f32 v78, v20, v21
v_mfma_f32_16x16x32_bf16 v[64:67], a[156:159], v[212:215], v[64:67]
v_exp_f32 v22, v22
v_mfma_f32_16x16x32_bf16 a[48:51], a[188:191], v[88:91], a[48:51]
ds_read_b128 a[148:151], v217 offset:49152
ds_read_b128 a[152:155], v218 offset:49152
v_mfma_f32_16x16x32_bf16 a[52:55], a[188:191], v[92:95], a[52:55]
v_exp_f32 v23, v23
v_mfma_f32_16x16x32_bf16 a[56:59], a[188:191], v[96:99], a[56:59]
ds_read_b128 a[156:159], v219 offset:49152
v_cvt_pk_bf16_f32 v79, v22, v23
v_mfma_f32_16x16x32_bf16 a[60:63], a[188:191], v[100:103], a[60:63]
v_exp_f32 v24, v24
v_smfmac_f32_16x16x64_bf16 a[128:131], a[208:211], v[88:95], v245
v_exp_f32 v25, v25
v_mfma_f32_16x16x32_bf16 v[44:47], a[160:163], v[152:155], v[136:139]
ds_read_b64_tr_b16 a[188:189], v223 offset:32768
v_cvt_pk_bf16_f32 v80, v24, v25
v_mfma_f32_16x16x32_bf16 v[44:47], a[164:167], v[156:159], v[44:47]
v_exp_f32 v26, v26
v_mfma_f32_16x16x32_bf16 v[44:47], a[168:171], v[160:163], v[44:47]
ds_read_b64_tr_b16 a[190:191], v223 offset:36864
buffer_load_dwordx4 v228, s[8:11], s32 offen offset:0 lds
v_mfma_f32_16x16x32_bf16 v[44:47], a[172:175], v[164:167], v[44:47]
v_exp_f32 v27, v27
v_mfma_f32_16x16x32_bf16 a[64:67], a[192:195], v[88:91], a[64:67]
buffer_load_dwordx4 v229, s[8:11], s32 offen offset:1024 lds
v_cvt_pk_bf16_f32 v81, v26, v27
v_mfma_f32_16x16x32_bf16 a[68:71], a[192:195], v[92:95], a[68:71]
v_exp_f32 v28, v28
v_mfma_f32_16x16x32_bf16 a[72:75], a[192:195], v[96:99], a[72:75]
buffer_load_dwordx4 v230, s[8:11], s32 offen offset:2048 lds
v_mfma_f32_16x16x32_bf16 a[76:79], a[192:195], v[100:103], a[76:79]
v_exp_f32 v29, v29
v_mfma_f32_16x16x32_bf16 v[52:55], a[160:163], v[168:171], v[140:143]
ds_read_b64_tr_b16 a[192:193], v224 offset:32768
v_cvt_pk_bf16_f32 v82, v28, v29
v_mfma_f32_16x16x32_bf16 v[52:55], a[164:167], v[172:175], v[52:55]
v_exp_f32 v30, v30
v_mfma_f32_16x16x32_bf16 v[52:55], a[168:171], v[176:179], v[52:55]
ds_read_b64_tr_b16 a[194:195], v224 offset:36864
buffer_load_dwordx4 v231, s[8:11], s32 offen offset:3072 lds
v_mfma_f32_16x16x32_bf16 v[52:55], a[172:175], v[180:183], v[52:55]
v_exp_f32 v31, v31
v_mfma_f32_16x16x32_bf16 a[80:83], a[196:199], v[88:91], a[80:83]
v_cvt_pk_bf16_f32 v83, v30, v31
v_mfma_f32_16x16x32_bf16 a[84:87], a[196:199], v[92:95], a[84:87]
v_exp_f32 v32, v32
v_mfma_f32_16x16x32_bf16 a[88:91], a[196:199], v[96:99], a[88:91]
v_mfma_f32_16x16x32_bf16 a[92:95], a[196:199], v[100:103], a[92:95]
v_exp_f32 v33, v33
v_mfma_f32_16x16x32_bf16 v[60:63], a[160:163], v[184:187], v[144:147]
ds_read_b64_tr_b16 a[196:197], v225 offset:32768
v_cvt_pk_bf16_f32 v84, v32, v33
v_mfma_f32_16x16x32_bf16 v[60:63], a[164:167], v[188:191], v[60:63]
v_exp_f32 v34, v34
v_mfma_f32_16x16x32_bf16 v[60:63], a[168:171], v[192:195], v[60:63]
ds_read_b64_tr_b16 a[198:199], v225 offset:36864
v_mfma_f32_16x16x32_bf16 v[60:63], a[172:175], v[196:199], v[60:63]
v_exp_f32 v35, v35
v_mfma_f32_16x16x32_bf16 a[96:99], a[200:203], v[88:91], a[96:99]
v_cvt_pk_bf16_f32 v85, v34, v35
v_mfma_f32_16x16x32_bf16 a[100:103], a[200:203], v[92:95], a[100:103]
v_exp_f32 v36, v36
v_mfma_f32_16x16x32_bf16 a[104:107], a[200:203], v[96:99], a[104:107]
s_add_u32 m0, s86, 49152
s_add_u32 s50, s84, 2359296
buffer_load_dwordx4 v240, s[68:71], s50 offen lds
v_mfma_f32_16x16x32_bf16 a[108:111], a[200:203], v[100:103], a[108:111]
v_exp_f32 v37, v37
v_mfma_f32_16x16x32_bf16 v[68:71], a[160:163], v[200:203], v[148:151]
ds_read_b64_tr_b16 a[200:201], v226 offset:32768
v_cvt_pk_bf16_f32 v86, v36, v37
v_mfma_f32_16x16x32_bf16 v[68:71], a[164:167], v[204:207], v[68:71]
v_exp_f32 v38, v38
v_mfma_f32_16x16x32_bf16 v[68:71], a[168:171], v[208:211], v[68:71]
ds_read_b64_tr_b16 a[202:203], v226 offset:36864
ds_read_b128 a[160:163], v216 offset:53248
v_mfma_f32_16x16x32_bf16 v[68:71], a[172:175], v[212:215], v[68:71]
v_exp_f32 v39, v39
v_mfma_f32_16x16x32_bf16 a[112:115], a[204:207], v[88:91], a[112:115]
ds_read_b128 a[164:167], v217 offset:53248
v_cvt_pk_bf16_f32 v87, v38, v39
v_mfma_f32_16x16x32_bf16 a[116:119], a[204:207], v[92:95], a[116:119]
ds_read_b128 a[168:171], v218 offset:53248
ds_read_b128 a[172:175], v219 offset:53248
v_mfma_f32_16x16x32_bf16 a[120:123], a[204:207], v[96:99], a[120:123]
s_add_u32 m0, s86, 53248
s_add_u32 s50, s84, 2949120
buffer_load_dwordx4 v240, s[68:71], s50 offen lds
v_mfma_f32_16x16x32_bf16 a[124:127], a[204:207], v[100:103], a[124:127]
ds_read_b64_tr_b16 a[204:205], v227 offset:32768
ds_read_b64_tr_b16 a[206:207], v227 offset:36864
v_smfmac_f32_16x16x64_bf16 a[132:135], a[208:211], v[96:103], v245
s_waitcnt lgkmcnt(8)
v_mfma_f32_16x16x32_bf16 v[8:11], a[144:147], v[152:155], v[136:139]
v_exp_f32 v40, v40
v_mfma_f32_16x16x32_bf16 v[8:11], a[148:151], v[156:159], v[8:11]
v_exp_f32 v41, v41
v_mfma_f32_16x16x32_bf16 v[8:11], a[152:155], v[160:163], v[8:11]
v_cvt_pk_bf16_f32 v88, v40, v41
v_mfma_f32_16x16x32_bf16 v[8:11], a[156:159], v[164:167], v[8:11]
v_exp_f32 v42, v42
v_mfma_f32_16x16x32_bf16 a[0:3], a[176:179], v[72:75], a[0:3]
s_add_u32 s39, s39, 16384
v_mfma_f32_16x16x32_bf16 a[4:7], a[176:179], v[76:79], a[4:7]
v_exp_f32 v43, v43
v_mfma_f32_16x16x32_bf16 a[8:11], a[176:179], v[80:83], a[8:11]
v_cvt_pk_bf16_f32 v89, v42, v43
v_mfma_f32_16x16x32_bf16 a[12:15], a[176:179], v[84:87], a[12:15]
v_exp_f32 v44, v44
v_mfma_f32_16x16x32_bf16 v[16:19], a[144:147], v[168:171], v[140:143]
ds_read_b64_tr_b16 a[176:177], v220 offset:40960
ds_read_b64_tr_b16 a[178:179], v220 offset:45056
v_mfma_f32_16x16x32_bf16 v[16:19], a[148:151], v[172:175], v[16:19]
v_exp_f32 v45, v45
v_mfma_f32_16x16x32_bf16 v[16:19], a[152:155], v[176:179], v[16:19]
s_bitset0_b32 s39, 19
v_cvt_pk_bf16_f32 v90, v44, v45
v_mfma_f32_16x16x32_bf16 v[16:19], a[156:159], v[180:183], v[16:19]
v_exp_f32 v46, v46
v_mfma_f32_16x16x32_bf16 a[16:19], a[180:183], v[72:75], a[16:19]
v_mfma_f32_16x16x32_bf16 a[20:23], a[180:183], v[76:79], a[20:23]
v_exp_f32 v47, v47
v_mfma_f32_16x16x32_bf16 a[24:27], a[180:183], v[80:83], a[24:27]
v_cvt_pk_bf16_f32 v91, v46, v47
v_mfma_f32_16x16x32_bf16 a[28:31], a[180:183], v[84:87], a[28:31]
v_exp_f32 v48, v48
v_mfma_f32_16x16x32_bf16 v[24:27], a[144:147], v[184:187], v[144:147]
ds_read_b64_tr_b16 a[180:181], v221 offset:40960
ds_read_b64_tr_b16 a[182:183], v221 offset:45056
v_mfma_f32_16x16x32_bf16 v[24:27], a[148:151], v[188:191], v[24:27]
v_exp_f32 v49, v49
v_mfma_f32_16x16x32_bf16 v[24:27], a[152:155], v[192:195], v[24:27]
s_add_u32 m0, s30, 98304
v_cvt_pk_bf16_f32 v92, v48, v49
v_mfma_f32_16x16x32_bf16 v[24:27], a[156:159], v[196:199], v[24:27]
v_exp_f32 v50, v50
v_mfma_f32_16x16x32_bf16 a[32:35], a[184:187], v[72:75], a[32:35]
v_mfma_f32_16x16x32_bf16 a[36:39], a[184:187], v[76:79], a[36:39]
v_exp_f32 v51, v51
v_mfma_f32_16x16x32_bf16 a[40:43], a[184:187], v[80:83], a[40:43]
buffer_load_dwordx4 v232, s[12:15], s39 offen offset:0 lds
v_cvt_pk_bf16_f32 v93, v50, v51
v_mfma_f32_16x16x32_bf16 a[44:47], a[184:187], v[84:87], a[44:47]
v_exp_f32 v52, v52
v_mfma_f32_16x16x32_bf16 v[32:35], a[144:147], v[200:203], v[148:151]
ds_read_b64_tr_b16 a[184:185], v222 offset:40960
ds_read_b64_tr_b16 a[186:187], v222 offset:45056
v_mfma_f32_16x16x32_bf16 v[32:35], a[148:151], v[204:207], v[32:35]
v_exp_f32 v53, v53
v_mfma_f32_16x16x32_bf16 v[32:35], a[152:155], v[208:211], v[32:35]
ds_read_b128 a[144:147], v216 offset:57344
v_cvt_pk_bf16_f32 v94, v52, v53
v_mfma_f32_16x16x32_bf16 v[32:35], a[156:159], v[212:215], v[32:35]
v_exp_f32 v54, v54
v_mfma_f32_16x16x32_bf16 a[48:51], a[188:191], v[72:75], a[48:51]
ds_read_b128 a[148:151], v217 offset:57344
ds_read_b128 a[152:155], v218 offset:57344
v_mfma_f32_16x16x32_bf16 a[52:55], a[188:191], v[76:79], a[52:55]
v_exp_f32 v55, v55
v_mfma_f32_16x16x32_bf16 a[56:59], a[188:191], v[80:83], a[56:59]
ds_read_b128 a[156:159], v219 offset:57344
v_cvt_pk_bf16_f32 v95, v54, v55
v_mfma_f32_16x16x32_bf16 a[60:63], a[188:191], v[84:87], a[60:63]
v_exp_f32 v56, v56
v_smfmac_f32_16x16x64_bf16 a[128:131], a[208:211], v[72:79], v245
v_exp_f32 v57, v57
s_waitcnt lgkmcnt(8)
v_mfma_f32_16x16x32_bf16 v[12:15], a[160:163], v[152:155], v[136:139]
ds_read_b64_tr_b16 a[188:189], v223 offset:40960
v_cvt_pk_bf16_f32 v96, v56, v57
v_mfma_f32_16x16x32_bf16 v[12:15], a[164:167], v[156:159], v[12:15]
v_exp_f32 v58, v58
v_mfma_f32_16x16x32_bf16 v[12:15], a[168:171], v[160:163], v[12:15]
ds_read_b64_tr_b16 a[190:191], v223 offset:45056
buffer_load_dwordx4 v233, s[12:15], s39 offen offset:1024 lds
v_mfma_f32_16x16x32_bf16 v[12:15], a[172:175], v[164:167], v[12:15]
v_exp_f32 v59, v59
v_mfma_f32_16x16x32_bf16 a[64:67], a[192:195], v[72:75], a[64:67]
buffer_load_dwordx4 v232, s[12:15], s39 offen offset:2048 lds
v_cvt_pk_bf16_f32 v97, v58, v59
v_mfma_f32_16x16x32_bf16 a[68:71], a[192:195], v[76:79], a[68:71]
v_exp_f32 v60, v60
v_mfma_f32_16x16x32_bf16 a[72:75], a[192:195], v[80:83], a[72:75]
s_waitcnt vmcnt(9)
v_cmp_eq_u32 vcc, 0, v248
s_cbranch_vccnz SP_CAND
SP_CAND_RET:
v_mfma_f32_16x16x32_bf16 a[76:79], a[192:195], v[84:87], a[76:79]
v_mov_b32 v251, 0
v_exp_f32 v61, v61
v_mfma_f32_16x16x32_bf16 v[20:23], a[160:163], v[168:171], v[140:143]
ds_read_b64_tr_b16 a[192:193], v224 offset:40960
v_cvt_pk_bf16_f32 v98, v60, v61
v_mfma_f32_16x16x32_bf16 v[20:23], a[164:167], v[172:175], v[20:23]
v_exp_f32 v62, v62
v_mfma_f32_16x16x32_bf16 v[20:23], a[168:171], v[176:179], v[20:23]
ds_read_b64_tr_b16 a[194:195], v224 offset:45056
buffer_load_dwordx4 v233, s[12:15], s39 offen offset:3072 lds
v_mfma_f32_16x16x32_bf16 v[20:23], a[172:175], v[180:183], v[20:23]
v_exp_f32 v63, v63
v_mfma_f32_16x16x32_bf16 a[80:83], a[196:199], v[72:75], a[80:83]
s_mov_b32 s90, 0x01010101
s_mov_b32 s91, 0x01010101
v_cvt_pk_bf16_f32 v99, v62, v63
v_mfma_f32_16x16x32_bf16 a[84:87], a[196:199], v[76:79], a[84:87]
v_exp_f32 v64, v64
v_mfma_f32_16x16x32_bf16 a[88:91], a[196:199], v[80:83], a[88:91]
s_add_u32 m0, s86, 57344
s_add_u32 s50, s84, 3538944
buffer_load_dwordx4 v240, s[68:71], s50 offen lds
v_mfma_f32_16x16x32_bf16 a[92:95], a[196:199], v[84:87], a[92:95]
v_max_u32_dpp v250, v248, v248 row_ror:8 row_mask:0xf bank_mask:0xf
v_exp_f32 v65, v65
v_mfma_f32_16x16x32_bf16 v[28:31], a[160:163], v[184:187], v[144:147]
ds_read_b64_tr_b16 a[196:197], v225 offset:40960
v_cvt_pk_bf16_f32 v100, v64, v65
v_mfma_f32_16x16x32_bf16 v[28:31], a[164:167], v[188:191], v[28:31]
v_max_u32_dpp v249, v250, v250 row_ror:4 row_mask:0xf bank_mask:0xf
v_exp_f32 v66, v66
v_mfma_f32_16x16x32_bf16 v[28:31], a[168:171], v[192:195], v[28:31]
ds_read_b64_tr_b16 a[198:199], v225 offset:45056
v_mfma_f32_16x16x32_bf16 v[28:31], a[172:175], v[196:199], v[28:31]
v_max_u32_dpp v250, v249, v249 row_ror:2 row_mask:0xf bank_mask:0xf
v_exp_f32 v67, v67
v_mfma_f32_16x16x32_bf16 a[96:99], a[200:203], v[72:75], a[96:99]
v_cvt_pk_bf16_f32 v101, v66, v67
v_mfma_f32_16x16x32_bf16 a[100:103], a[200:203], v[76:79], a[100:103]
v_max_u32_dpp v249, v250, v250 row_ror:1 row_mask:0xf bank_mask:0xf
v_exp_f32 v68, v68
v_mfma_f32_16x16x32_bf16 a[104:107], a[200:203], v[80:83], a[104:107]
s_add_u32 m0, s86, 61440
s_add_u32 s50, s84, 4128768
buffer_load_dwordx4 v240, s[68:71], s50 offen lds
v_mfma_f32_16x16x32_bf16 a[108:111], a[200:203], v[84:87], a[108:111]
v_mov_b32 v250, v249
v_exp_f32 v69, v69
v_mfma_f32_16x16x32_bf16 v[36:39], a[160:163], v[200:203], v[148:151]
ds_read_b64_tr_b16 a[200:201], v226 offset:40960
v_cvt_pk_bf16_f32 v102, v68, v69
v_mfma_f32_16x16x32_bf16 v[36:39], a[164:167], v[204:207], v[36:39]
v_permlane16_swap_b32 v249, v250
v_exp_f32 v70, v70
v_mfma_f32_16x16x32_bf16 v[36:39], a[168:171], v[208:211], v[36:39]
ds_read_b64_tr_b16 a[202:203], v226 offset:45056
ds_read_b128 a[160:163], v216 offset:61440
v_max_u32 v249, v249, v250
v_mfma_f32_16x16x32_bf16 v[36:39], a[172:175], v[212:215], v[36:39]
v_mov_b32 v250, v249
v_exp_f32 v71, v71
v_mfma_f32_16x16x32_bf16 a[112:115], a[204:207], v[72:75], a[112:115]
ds_read_b128 a[164:167], v217 offset:61440
v_cvt_pk_bf16_f32 v103, v70, v71
v_mfma_f32_16x16x32_bf16 a[116:119], a[204:207], v[76:79], a[116:119]
ds_read_b128 a[168:171], v218 offset:61440
ds_read_b128 a[172:175], v219 offset:61440
v_permlane32_swap_b32 v249, v250
v_mfma_f32_16x16x32_bf16 a[120:123], a[204:207], v[80:83], a[120:123]
v_max_u32 v249, v249, v250
v_add_u32 v251, v251, v249
v_sub_u32 v248, v248, v249
v_mfma_f32_16x16x32_bf16 a[124:127], a[204:207], v[84:87], a[124:127]
ds_read_b64_tr_b16 a[204:205], v227 offset:40960
ds_read_b64_tr_b16 a[206:207], v227 offset:45056
v_cndmask_b32 v252, v252, v251, s[90:91]
v_smfmac_f32_16x16x64_bf16 a[132:135], a[208:211], v[80:87], v245
v_readfirstlane_b32 s76, v251
s_waitcnt lgkmcnt(8)
v_mfma_f32_16x16x32_bf16 v[40:43], a[144:147], v[152:155], v[136:139]
s_lshl_b64 s[90:91], s[90:91], 1
v_exp_f32 v8, v8
v_mfma_f32_16x16x32_bf16 v[40:43], a[148:151], v[156:159], v[40:43]
v_exp_f32 v9, v9
v_mfma_f32_16x16x32_bf16 v[40:43], a[152:155], v[160:163], v[40:43]
v_cvt_pk_bf16_f32 v72, v8, v9
v_max_u32_dpp v250, v248, v248 row_ror:8 row_mask:0xf bank_mask:0xf
v_mfma_f32_16x16x32_bf16 v[40:43], a[156:159], v[164:167], v[40:43]
v_exp_f32 v10, v10
v_mfma_f32_16x16x32_bf16 a[0:3], a[176:179], v[88:91], a[0:3]
v_max_u32_dpp v249, v250, v250 row_ror:4 row_mask:0xf bank_mask:0xf
v_mfma_f32_16x16x32_bf16 a[4:7], a[176:179], v[92:95], a[4:7]
v_exp_f32 v11, v11
v_mfma_f32_16x16x32_bf16 a[8:11], a[176:179], v[96:99], a[8:11]
v_cvt_pk_bf16_f32 v73, v10, v11
v_max_u32_dpp v250, v249, v249 row_ror:2 row_mask:0xf bank_mask:0xf
v_mfma_f32_16x16x32_bf16 a[12:15], a[176:179], v[100:103], a[12:15]
s_waitcnt vmcnt(13) lgkmcnt(0)
s_barrier
v_mfma_f32_16x16x32_bf16 v[48:51], a[144:147], v[168:171], v[140:143]
v_max_u32_dpp v249, v250, v250 row_ror:1 row_mask:0xf bank_mask:0xf
v_exp_f32 v12, v12
v_mfma_f32_16x16x32_bf16 v[48:51], a[148:151], v[172:175], v[48:51]
v_mov_b32 v250, v249
v_exp_f32 v13, v13
v_mfma_f32_16x16x32_bf16 v[48:51], a[152:155], v[176:179], v[48:51]
ds_read_b64_tr_b16 a[176:177], v220 offset:49152
v_cvt_pk_bf16_f32 v74, v12, v13
v_mfma_f32_16x16x32_bf16 v[48:51], a[156:159], v[180:183], v[48:51]
v_permlane16_swap_b32 v249, v250
v_exp_f32 v14, v14
v_mfma_f32_16x16x32_bf16 a[16:19], a[180:183], v[88:91], a[16:19]
ds_read_b64_tr_b16 a[178:179], v220 offset:53248
s_add_u32 s32, s32, 16384
v_max_u32 v249, v249, v250
v_mfma_f32_16x16x32_bf16 a[20:23], a[180:183], v[92:95], a[20:23]
v_mov_b32 v250, v249
v_exp_f32 v15, v15
v_mfma_f32_16x16x32_bf16 a[24:27], a[180:183], v[96:99], a[24:27]
v_cvt_pk_bf16_f32 v75, v14, v15
v_mfma_f32_16x16x32_bf16 a[28:31], a[180:183], v[100:103], a[28:31]
v_permlane32_swap_b32 v249, v250
v_exp_f32 v16, v16
v_mfma_f32_16x16x32_bf16 v[56:59], a[144:147], v[184:187], v[144:147]
ds_read_b64_tr_b16 a[180:181], v221 offset:49152
ds_read_b64_tr_b16 a[182:183], v221 offset:53248
v_max_u32 v249, v249, v250
v_mfma_f32_16x16x32_bf16 v[56:59], a[148:151], v[188:191], v[56:59]
v_add_u32 v251, v251, v249
v_exp_f32 v17, v17
v_mfma_f32_16x16x32_bf16 v[56:59], a[152:155], v[192:195], v[56:59]
s_bitset0_b32 s32, 19
v_cvt_pk_bf16_f32 v76, v16, v17
v_sub_u32 v248, v248, v249
v_mfma_f32_16x16x32_bf16 v[56:59], a[156:159], v[196:199], v[56:59]
v_cndmask_b32 v252, v252, v251, s[90:91]
v_exp_f32 v18, v18
v_mfma_f32_16x16x32_bf16 a[32:35], a[184:187], v[88:91], a[32:35]
v_readfirstlane_b32 s77, v251
v_mfma_f32_16x16x32_bf16 a[36:39], a[184:187], v[92:95], a[36:39]
s_lshl_b64 s[90:91], s[90:91], 1
v_exp_f32 v19, v19
v_mfma_f32_16x16x32_bf16 a[40:43], a[184:187], v[96:99], a[40:43]
v_cvt_pk_bf16_f32 v77, v18, v19
v_mfma_f32_16x16x32_bf16 a[44:47], a[184:187], v[100:103], a[44:47]
v_max_u32_dpp v250, v248, v248 row_ror:8 row_mask:0xf bank_mask:0xf
v_exp_f32 v20, v20
v_mfma_f32_16x16x32_bf16 v[64:67], a[144:147], v[200:203], v[148:151]
ds_read_b64_tr_b16 a[184:185], v222 offset:49152
ds_read_b64_tr_b16 a[186:187], v222 offset:53248
v_mfma_f32_16x16x32_bf16 v[64:67], a[148:151], v[204:207], v[64:67]
v_max_u32_dpp v249, v250, v250 row_ror:4 row_mask:0xf bank_mask:0xf
v_exp_f32 v21, v21
v_mfma_f32_16x16x32_bf16 v[64:67], a[152:155], v[208:211], v[64:67]
ds_read_b128 a[144:147], v216 offset:0
v_cvt_pk_bf16_f32 v78, v20, v21
v_mfma_f32_16x16x32_bf16 v[64:67], a[156:159], v[212:215], v[64:67]
v_max_u32_dpp v250, v249, v249 row_ror:2 row_mask:0xf bank_mask:0xf
v_exp_f32 v22, v22
v_mfma_f32_16x16x32_bf16 a[48:51], a[188:191], v[88:91], a[48:51]
ds_read_b128 a[148:151], v217 offset:0
ds_read_b128 a[152:155], v218 offset:0
v_mfma_f32_16x16x32_bf16 a[52:55], a[188:191], v[92:95], a[52:55]
v_max_u32_dpp v249, v250, v250 row_ror:1 row_mask:0xf bank_mask:0xf
v_exp_f32 v23, v23
v_mfma_f32_16x16x32_bf16 a[56:59], a[188:191], v[96:99], a[56:59]
ds_read_b128 a[156:159], v219 offset:0
v_cvt_pk_bf16_f32 v79, v22, v23
v_mov_b32 v250, v249
v_mfma_f32_16x16x32_bf16 a[60:63], a[188:191], v[100:103], a[60:63]
v_exp_f32 v24, v24
v_smfmac_f32_16x16x64_bf16 a[128:131], a[208:211], v[88:95], v245
v_permlane16_swap_b32 v249, v250
v_exp_f32 v25, v25
v_mfma_f32_16x16x32_bf16 v[44:47], a[160:163], v[152:155], v[136:139]
ds_read_b64_tr_b16 a[188:189], v223 offset:49152
v_cvt_pk_bf16_f32 v80, v24, v25
v_max_u32 v249, v249, v250
v_mfma_f32_16x16x32_bf16 v[44:47], a[164:167], v[156:159], v[44:47]
v_mov_b32 v250, v249
v_exp_f32 v26, v26
v_mfma_f32_16x16x32_bf16 v[44:47], a[168:171], v[160:163], v[44:47]
ds_read_b64_tr_b16 a[190:191], v223 offset:53248
s_add_u32 m0, s30, 114688
v_mfma_f32_16x16x32_bf16 v[44:47], a[172:175], v[164:167], v[44:47]
v_permlane32_swap_b32 v249, v250
v_exp_f32 v27, v27
v_mfma_f32_16x16x32_bf16 a[64:67], a[192:195], v[88:91], a[64:67]
buffer_load_dwordx4 v228, s[8:11], s32 offen offset:0 lds
v_cvt_pk_bf16_f32 v81, v26, v27
v_max_u32 v249, v249, v250
v_mfma_f32_16x16x32_bf16 a[68:71], a[192:195], v[92:95], a[68:71]
v_add_u32 v251, v251, v249
v_exp_f32 v28, v28
v_mfma_f32_16x16x32_bf16 a[72:75], a[192:195], v[96:99], a[72:75]
buffer_load_dwordx4 v229, s[8:11], s32 offen offset:1024 lds
v_sub_u32 v248, v248, v249
v_cndmask_b32 v252, v252, v251, s[90:91]
v_mfma_f32_16x16x32_bf16 a[76:79], a[192:195], v[100:103], a[76:79]
v_readfirstlane_b32 s78, v251
v_exp_f32 v29, v29
v_mfma_f32_16x16x32_bf16 v[52:55], a[160:163], v[168:171], v[140:143]
ds_read_b64_tr_b16 a[192:193], v224 offset:49152
s_lshl_b64 s[90:91], s[90:91], 1
v_cvt_pk_bf16_f32 v82, v28, v29
v_mfma_f32_16x16x32_bf16 v[52:55], a[164:167], v[172:175], v[52:55]
v_exp_f32 v30, v30
v_mfma_f32_16x16x32_bf16 v[52:55], a[168:171], v[176:179], v[52:55]
ds_read_b64_tr_b16 a[194:195], v224 offset:53248
v_max_u32_dpp v250, v248, v248 row_ror:8 row_mask:0xf bank_mask:0xf
v_mfma_f32_16x16x32_bf16 v[52:55], a[172:175], v[180:183], v[52:55]
v_exp_f32 v31, v31
v_mfma_f32_16x16x32_bf16 a[80:83], a[196:199], v[88:91], a[80:83]
buffer_load_dwordx4 v230, s[8:11], s32 offen offset:2048 lds
v_cvt_pk_bf16_f32 v83, v30, v31
v_max_u32_dpp v249, v250, v250 row_ror:4 row_mask:0xf bank_mask:0xf
v_mfma_f32_16x16x32_bf16 a[84:87], a[196:199], v[92:95], a[84:87]
v_exp_f32 v32, v32
v_mfma_f32_16x16x32_bf16 a[88:91], a[196:199], v[96:99], a[88:91]
v_max_u32_dpp v250, v249, v249 row_ror:2 row_mask:0xf bank_mask:0xf
v_mfma_f32_16x16x32_bf16 a[92:95], a[196:199], v[100:103], a[92:95]
v_exp_f32 v33, v33
v_mfma_f32_16x16x32_bf16 v[60:63], a[160:163], v[184:187], v[144:147]
ds_read_b64_tr_b16 a[196:197], v225 offset:49152
v_cvt_pk_bf16_f32 v84, v32, v33
v_max_u32_dpp v249, v250, v250 row_ror:1 row_mask:0xf bank_mask:0xf
v_mfma_f32_16x16x32_bf16 v[60:63], a[164:167], v[188:191], v[60:63]
v_mov_b32 v250, v249
v_exp_f32 v34, v34
v_mfma_f32_16x16x32_bf16 v[60:63], a[168:171], v[192:195], v[60:63]
ds_read_b64_tr_b16 a[198:199], v225 offset:53248
v_mfma_f32_16x16x32_bf16 v[60:63], a[172:175], v[196:199], v[60:63]
v_permlane16_swap_b32 v249, v250
v_exp_f32 v35, v35
v_mfma_f32_16x16x32_bf16 a[96:99], a[200:203], v[88:91], a[96:99]
buffer_load_dwordx4 v231, s[8:11], s32 offen offset:3072 lds
v_cvt_pk_bf16_f32 v85, v34, v35
v_max_u32 v249, v249, v250
v_mfma_f32_16x16x32_bf16 a[100:103], a[200:203], v[92:95], a[100:103]
v_mov_b32 v250, v249
v_exp_f32 v36, v36
v_mfma_f32_16x16x32_bf16 a[104:107], a[200:203], v[96:99], a[104:107]
v_mfma_f32_16x16x32_bf16 a[108:111], a[200:203], v[100:103], a[108:111]
v_permlane32_swap_b32 v249, v250
v_exp_f32 v37, v37
v_mfma_f32_16x16x32_bf16 v[68:71], a[160:163], v[200:203], v[148:151]
ds_read_b64_tr_b16 a[200:201], v226 offset:49152
v_cvt_pk_bf16_f32 v86, v36, v37
v_max_u32 v249, v249, v250
v_mfma_f32_16x16x32_bf16 v[68:71], a[164:167], v[204:207], v[68:71]
v_add_u32 v251, v251, v249
v_exp_f32 v38, v38
v_mfma_f32_16x16x32_bf16 v[68:71], a[168:171], v[208:211], v[68:71]
ds_read_b64_tr_b16 a[202:203], v226 offset:53248
ds_read_b128 a[160:163], v216 offset:4096
v_sub_u32 v248, v248, v249
v_mfma_f32_16x16x32_bf16 v[68:71], a[172:175], v[212:215], v[68:71]
v_cndmask_b32 v252, v252, v251, s[90:91]
v_exp_f32 v39, v39
v_mfma_f32_16x16x32_bf16 a[112:115], a[204:207], v[88:91], a[112:115]
ds_read_b128 a[164:167], v217 offset:4096
v_cvt_pk_bf16_f32 v87, v38, v39
v_readfirstlane_b32 s79, v251
v_mfma_f32_16x16x32_bf16 a[116:119], a[204:207], v[92:95], a[116:119]
ds_read_b128 a[168:171], v218 offset:4096
ds_read_b128 a[172:175], v219 offset:4096
s_lshl_b64 s[90:91], s[90:91], 1
v_mfma_f32_16x16x32_bf16 a[120:123], a[204:207], v[96:99], a[120:123]
v_mfma_f32_16x16x32_bf16 a[124:127], a[204:207], v[100:103], a[124:127]
ds_read_b64_tr_b16 a[204:205], v227 offset:49152
ds_read_b64_tr_b16 a[206:207], v227 offset:53248
v_max_u32_dpp v250, v248, v248 row_ror:8 row_mask:0xf bank_mask:0xf
v_smfmac_f32_16x16x64_bf16 a[132:135], a[208:211], v[96:103], v245
s_waitcnt lgkmcnt(8)
v_mfma_f32_16x16x32_bf16 v[8:11], a[144:147], v[152:155], v[136:139]
v_max_u32_dpp v249, v250, v250 row_ror:4 row_mask:0xf bank_mask:0xf
v_exp_f32 v40, v40
v_mfma_f32_16x16x32_bf16 v[8:11], a[148:151], v[156:159], v[8:11]
v_exp_f32 v41, v41
v_mfma_f32_16x16x32_bf16 v[8:11], a[152:155], v[160:163], v[8:11]
v_cvt_pk_bf16_f32 v88, v40, v41
v_max_u32_dpp v250, v249, v249 row_ror:2 row_mask:0xf bank_mask:0xf
v_mfma_f32_16x16x32_bf16 v[8:11], a[156:159], v[164:167], v[8:11]
v_exp_f32 v42, v42
v_mfma_f32_16x16x32_bf16 a[0:3], a[176:179], v[72:75], a[0:3]
s_add_u32 s39, s39, 16384
v_max_u32_dpp v249, v250, v250 row_ror:1 row_mask:0xf bank_mask:0xf
v_mov_b32 v250, v249
v_mfma_f32_16x16x32_bf16 a[4:7], a[176:179], v[76:79], a[4:7]
v_exp_f32 v43, v43
v_mfma_f32_16x16x32_bf16 a[8:11], a[176:179], v[80:83], a[8:11]
v_cvt_pk_bf16_f32 v89, v42, v43
v_permlane16_swap_b32 v249, v250
v_max_u32 v249, v249, v250
v_mfma_f32_16x16x32_bf16 a[12:15], a[176:179], v[84:87], a[12:15]
v_mov_b32 v250, v249
v_exp_f32 v44, v44
v_mfma_f32_16x16x32_bf16 v[16:19], a[144:147], v[168:171], v[140:143]
ds_read_b64_tr_b16 a[176:177], v220 offset:57344
ds_read_b64_tr_b16 a[178:179], v220 offset:61440
v_mfma_f32_16x16x32_bf16 v[16:19], a[148:151], v[172:175], v[16:19]
v_permlane32_swap_b32 v249, v250
v_exp_f32 v45, v45
v_mfma_f32_16x16x32_bf16 v[16:19], a[152:155], v[176:179], v[16:19]
v_cvt_pk_bf16_f32 v90, v44, v45
v_max_u32 v249, v249, v250
v_add_u32 v251, v251, v249
v_mfma_f32_16x16x32_bf16 v[16:19], a[156:159], v[180:183], v[16:19]
v_sub_u32 v248, v248, v249
v_exp_f32 v46, v46
v_mfma_f32_16x16x32_bf16 a[16:19], a[180:183], v[72:75], a[16:19]
s_bitset0_b32 s39, 19
v_cndmask_b32 v252, v252, v251, s[90:91]
v_mfma_f32_16x16x32_bf16 a[20:23], a[180:183], v[76:79], a[20:23]
v_readfirstlane_b32 s80, v251
v_exp_f32 v47, v47
v_mfma_f32_16x16x32_bf16 a[24:27], a[180:183], v[80:83], a[24:27]
s_lshl_b64 s[90:91], s[90:91], 1
v_cvt_pk_bf16_f32 v91, v46, v47
v_mfma_f32_16x16x32_bf16 a[28:31], a[180:183], v[84:87], a[28:31]
v_exp_f32 v48, v48
v_mfma_f32_16x16x32_bf16 v[24:27], a[144:147], v[184:187], v[144:147]
ds_read_b64_tr_b16 a[180:181], v221 offset:57344
ds_read_b64_tr_b16 a[182:183], v221 offset:61440
v_max_u32_dpp v250, v248, v248 row_ror:8 row_mask:0xf bank_mask:0xf
v_mfma_f32_16x16x32_bf16 v[24:27], a[148:151], v[188:191], v[24:27]
v_exp_f32 v49, v49
v_mfma_f32_16x16x32_bf16 v[24:27], a[152:155], v[192:195], v[24:27]
v_cvt_pk_bf16_f32 v92, v48, v49
v_max_u32_dpp v249, v250, v250 row_ror:4 row_mask:0xf bank_mask:0xf
v_mfma_f32_16x16x32_bf16 v[24:27], a[156:159], v[196:199], v[24:27]
v_exp_f32 v50, v50
v_mfma_f32_16x16x32_bf16 a[32:35], a[184:187], v[72:75], a[32:35]
s_add_u32 m0, s30, 131072
v_max_u32_dpp v250, v249, v249 row_ror:2 row_mask:0xf bank_mask:0xf
v_mfma_f32_16x16x32_bf16 a[36:39], a[184:187], v[76:79], a[36:39]
v_exp_f32 v51, v51
v_mfma_f32_16x16x32_bf16 a[40:43], a[184:187], v[80:83], a[40:43]
v_cvt_pk_bf16_f32 v93, v50, v51
v_max_u32_dpp v249, v250, v250 row_ror:1 row_mask:0xf bank_mask:0xf
v_mov_b32 v250, v249
v_mfma_f32_16x16x32_bf16 a[44:47], a[184:187], v[84:87], a[44:47]
v_exp_f32 v52, v52
v_mfma_f32_16x16x32_bf16 v[32:35], a[144:147], v[200:203], v[148:151]
ds_read_b64_tr_b16 a[184:185], v222 offset:57344
ds_read_b64_tr_b16 a[186:187], v222 offset:61440
v_permlane16_swap_b32 v249, v250
v_mfma_f32_16x16x32_bf16 v[32:35], a[148:151], v[204:207], v[32:35]
v_max_u32 v249, v249, v250
v_exp_f32 v53, v53
v_mfma_f32_16x16x32_bf16 v[32:35], a[152:155], v[208:211], v[32:35]
ds_read_b128 a[144:147], v216 offset:8192
v_cvt_pk_bf16_f32 v94, v52, v53
v_mov_b32 v250, v249
v_mfma_f32_16x16x32_bf16 v[32:35], a[156:159], v[212:215], v[32:35]
v_exp_f32 v54, v54
v_mfma_f32_16x16x32_bf16 a[48:51], a[188:191], v[72:75], a[48:51]
ds_read_b128 a[148:151], v217 offset:8192
ds_read_b128 a[152:155], v218 offset:8192
v_permlane32_swap_b32 v249, v250
v_mfma_f32_16x16x32_bf16 a[52:55], a[188:191], v[76:79], a[52:55]
v_max_u32 v249, v249, v250
v_exp_f32 v55, v55
v_mfma_f32_16x16x32_bf16 a[56:59], a[188:191], v[80:83], a[56:59]
ds_read_b128 a[156:159], v219 offset:8192
v_cvt_pk_bf16_f32 v95, v54, v55
v_add_u32 v251, v251, v249
v_mfma_f32_16x16x32_bf16 a[60:63], a[188:191], v[84:87], a[60:63]
v_sub_u32 v248, v248, v249
v_exp_f32 v56, v56
v_smfmac_f32_16x16x64_bf16 a[128:131], a[208:211], v[72:79], v245
v_cndmask_b32 v252, v252, v251, s[90:91]
v_exp_f32 v57, v57
s_waitcnt lgkmcnt(8)
v_mfma_f32_16x16x32_bf16 v[12:15], a[160:163], v[152:155], v[136:139]
ds_read_b64_tr_b16 a[188:189], v223 offset:57344
v_cvt_pk_bf16_f32 v96, v56, v57
v_readfirstlane_b32 s81, v251
v_mfma_f32_16x16x32_bf16 v[12:15], a[164:167], v[156:159], v[12:15]
s_lshl_b64 s[90:91], s[90:91], 1
v_exp_f32 v58, v58
v_mfma_f32_16x16x32_bf16 v[12:15], a[168:171], v[160:163], v[12:15]
ds_read_b64_tr_b16 a[190:191], v223 offset:61440
buffer_load_dwordx4 v232, s[12:15], s39 offen offset:0 lds
v_mfma_f32_16x16x32_bf16 v[12:15], a[172:175], v[164:167], v[12:15]
v_max_u32_dpp v250, v248, v248 row_ror:8 row_mask:0xf bank_mask:0xf
v_exp_f32 v59, v59
v_mfma_f32_16x16x32_bf16 a[64:67], a[192:195], v[72:75], a[64:67]
buffer_load_dwordx4 v233, s[12:15], s39 offen offset:1024 lds
v_cvt_pk_bf16_f32 v97, v58, v59
v_mfma_f32_16x16x32_bf16 a[68:71], a[192:195], v[76:79], a[68:71]
v_max_u32_dpp v249, v250, v250 row_ror:4 row_mask:0xf bank_mask:0xf
v_exp_f32 v60, v60
v_mfma_f32_16x16x32_bf16 a[72:75], a[192:195], v[80:83], a[72:75]
v_mfma_f32_16x16x32_bf16 a[76:79], a[192:195], v[84:87], a[76:79]
v_max_u32_dpp v250, v249, v249 row_ror:2 row_mask:0xf bank_mask:0xf
v_exp_f32 v61, v61
v_mfma_f32_16x16x32_bf16 v[20:23], a[160:163], v[168:171], v[140:143]
ds_read_b64_tr_b16 a[192:193], v224 offset:57344
v_cvt_pk_bf16_f32 v98, v60, v61
v_mfma_f32_16x16x32_bf16 v[20:23], a[164:167], v[172:175], v[20:23]
v_max_u32_dpp v249, v250, v250 row_ror:1 row_mask:0xf bank_mask:0xf
v_exp_f32 v62, v62
v_mfma_f32_16x16x32_bf16 v[20:23], a[168:171], v[176:179], v[20:23]
ds_read_b64_tr_b16 a[194:195], v224 offset:61440
buffer_load_dwordx4 v232, s[12:15], s39 offen offset:2048 lds
v_mov_b32 v250, v249
v_mfma_f32_16x16x32_bf16 v[20:23], a[172:175], v[180:183], v[20:23]
v_exp_f32 v63, v63
v_mfma_f32_16x16x32_bf16 a[80:83], a[196:199], v[72:75], a[80:83]
v_cvt_pk_bf16_f32 v99, v62, v63
v_permlane16_swap_b32 v249, v250
v_max_u32 v249, v249, v250
v_mfma_f32_16x16x32_bf16 a[84:87], a[196:199], v[76:79], a[84:87]
v_mov_b32 v250, v249
v_exp_f32 v64, v64
v_mfma_f32_16x16x32_bf16 a[88:91], a[196:199], v[80:83], a[88:91]
v_mfma_f32_16x16x32_bf16 a[92:95], a[196:199], v[84:87], a[92:95]
v_permlane32_swap_b32 v249, v250
v_exp_f32 v65, v65
v_mfma_f32_16x16x32_bf16 v[28:31], a[160:163], v[184:187], v[144:147]
ds_read_b64_tr_b16 a[196:197], v225 offset:57344
v_cvt_pk_bf16_f32 v100, v64, v65
v_max_u32 v249, v249, v250
v_mfma_f32_16x16x32_bf16 v[28:31], a[164:167], v[188:191], v[28:31]
v_add_u32 v251, v251, v249
v_exp_f32 v66, v66
v_mfma_f32_16x16x32_bf16 v[28:31], a[168:171], v[192:195], v[28:31]
ds_read_b64_tr_b16 a[198:199], v225 offset:61440
buffer_load_dwordx4 v233, s[12:15], s39 offen offset:3072 lds
v_sub_u32 v248, v248, v249
v_mfma_f32_16x16x32_bf16 v[28:31], a[172:175], v[196:199], v[28:31]
v_cndmask_b32 v252, v252, v251, s[90:91]
v_exp_f32 v67, v67
v_mfma_f32_16x16x32_bf16 a[96:99], a[200:203], v[72:75], a[96:99]
v_cvt_pk_bf16_f32 v101, v66, v67
v_readfirstlane_b32 s82, v251
v_mfma_f32_16x16x32_bf16 a[100:103], a[200:203], v[76:79], a[100:103]
s_lshl_b64 s[90:91], s[90:91], 1
v_exp_f32 v68, v68
v_mfma_f32_16x16x32_bf16 a[104:107], a[200:203], v[80:83], a[104:107]
v_mfma_f32_16x16x32_bf16 a[108:111], a[200:203], v[84:87], a[108:111]
v_max_u32_dpp v250, v248, v248 row_ror:8 row_mask:0xf bank_mask:0xf
v_exp_f32 v69, v69
v_mfma_f32_16x16x32_bf16 v[36:39], a[160:163], v[200:203], v[148:151]
ds_read_b64_tr_b16 a[200:201], v226 offset:57344
v_cvt_pk_bf16_f32 v102, v68, v69
v_mfma_f32_16x16x32_bf16 v[36:39], a[164:167], v[204:207], v[36:39]
v_max_u32_dpp v249, v250, v250 row_ror:4 row_mask:0xf bank_mask:0xf
v_exp_f32 v70, v70
v_mfma_f32_16x16x32_bf16 v[36:39], a[168:171], v[208:211], v[36:39]
ds_read_b64_tr_b16 a[202:203], v226 offset:61440
ds_read_b128 a[160:163], v216 offset:12288
v_mfma_f32_16x16x32_bf16 v[36:39], a[172:175], v[212:215], v[36:39]
v_max_u32_dpp v250, v249, v249 row_ror:2 row_mask:0xf bank_mask:0xf
v_exp_f32 v71, v71
v_mfma_f32_16x16x32_bf16 a[112:115], a[204:207], v[72:75], a[112:115]
ds_read_b128 a[164:167], v217 offset:12288
v_cvt_pk_bf16_f32 v103, v70, v71
v_mfma_f32_16x16x32_bf16 a[116:119], a[204:207], v[76:79], a[116:119]
ds_read_b128 a[168:171], v218 offset:12288
ds_read_b128 a[172:175], v219 offset:12288
v_max_u32_dpp v249, v250, v250 row_ror:1 row_mask:0xf bank_mask:0xf
v_mfma_f32_16x16x32_bf16 a[120:123], a[204:207], v[80:83], a[120:123]
v_mov_b32 v250, v249
v_mfma_f32_16x16x32_bf16 a[124:127], a[204:207], v[84:87], a[124:127]
ds_read_b64_tr_b16 a[204:205], v227 offset:57344
ds_read_b64_tr_b16 a[206:207], v227 offset:61440
v_smfmac_f32_16x16x64_bf16 a[132:135], a[208:211], v[80:87], v245
v_permlane16_swap_b32 v249, v250
v_max_u32 v249, v249, v250
v_mov_b32 v250, v249
s_waitcnt lgkmcnt(8)
v_mfma_f32_16x16x32_bf16 v[40:43], a[144:147], v[152:155], v[136:139]
v_exp_f32 v8, v8
v_mfma_f32_16x16x32_bf16 v[40:43], a[148:151], v[156:159], v[40:43]
v_permlane32_swap_b32 v249, v250
v_exp_f32 v9, v9
v_mfma_f32_16x16x32_bf16 v[40:43], a[152:155], v[160:163], v[40:43]
v_cvt_pk_bf16_f32 v72, v8, v9
v_max_u32 v249, v249, v250
v_add_u32 v251, v251, v249
v_mfma_f32_16x16x32_bf16 v[40:43], a[156:159], v[164:167], v[40:43]
v_cndmask_b32 v252, v252, v251, s[90:91]
v_exp_f32 v10, v10
v_mfma_f32_16x16x32_bf16 a[0:3], a[176:179], v[88:91], a[0:3]
v_readfirstlane_b32 s83, v251
v_mfma_f32_16x16x32_bf16 a[4:7], a[176:179], v[92:95], a[4:7]
v_and_b32 v252, 0xffff, v252
v_exp_f32 v11, v11
v_mfma_f32_16x16x32_bf16 a[8:11], a[176:179], v[96:99], a[8:11]
v_cvt_pk_bf16_f32 v73, v10, v11
v_sub_u32 v252, 0xffff, v252
v_lshrrev_b32 v249, 4, v252
v_mfma_f32_16x16x32_bf16 a[12:15], a[176:179], v[100:103], a[12:15]
s_waitcnt vmcnt(8) lgkmcnt(0)
s_barrier
v_mul_u32_u24 v249, 0x4800, v249
v_mfma_f32_16x16x32_bf16 v[48:51], a[144:147], v[168:171], v[140:143]
ds_read_b64_tr_b16 a[212:213], v241 offset:0
v_exp_f32 v12, v12
v_mfma_f32_16x16x32_bf16 v[48:51], a[148:151], v[172:175], v[48:51]
ds_read_b64_tr_b16 a[214:215], v241 offset:1024
v_exp_f32 v13, v13
v_mfma_f32_16x16x32_bf16 v[48:51], a[152:155], v[176:179], v[48:51]
ds_read_b64_tr_b16 a[176:177], v220 offset:0
ds_read_b64_tr_b16 a[216:217], v241 offset:2048
v_cvt_pk_bf16_f32 v74, v12, v13
v_mfma_f32_16x16x32_bf16 v[48:51], a[156:159], v[180:183], v[48:51]
ds_read_b64_tr_b16 a[218:219], v241 offset:3072
v_exp_f32 v14, v14
v_mfma_f32_16x16x32_bf16 a[16:19], a[180:183], v[88:91], a[16:19]
ds_read_b64_tr_b16 a[178:179], v220 offset:4096
s_add_u32 s32, s32, 16384
ds_read_b64_tr_b16 a[220:221], v241 offset:4096
v_mfma_f32_16x16x32_bf16 a[20:23], a[180:183], v[92:95], a[20:23]
ds_read_b64_tr_b16 a[222:223], v241 offset:5120
v_exp_f32 v15, v15
v_mfma_f32_16x16x32_bf16 a[24:27], a[180:183], v[96:99], a[24:27]
ds_read_b64_tr_b16 a[224:225], v241 offset:6144
ds_read_b64_tr_b16 a[226:227], v241 offset:7168
v_cvt_pk_bf16_f32 v75, v14, v15
v_mfma_f32_16x16x32_bf16 a[28:31], a[180:183], v[100:103], a[28:31]
ds_read_b64_tr_b16 a[228:229], v241 offset:8192
v_exp_f32 v16, v16
v_mfma_f32_16x16x32_bf16 v[56:59], a[144:147], v[184:187], v[144:147]
ds_read_b64_tr_b16 a[180:181], v221 offset:0
ds_read_b64_tr_b16 a[182:183], v221 offset:4096
ds_read_b64_tr_b16 a[230:231], v241 offset:9216
v_mfma_f32_16x16x32_bf16 v[56:59], a[148:151], v[188:191], v[56:59]
ds_read_b64_tr_b16 a[232:233], v241 offset:10240
v_exp_f32 v17, v17
v_mfma_f32_16x16x32_bf16 v[56:59], a[152:155], v[192:195], v[56:59]
s_bitset0_b32 s32, 19
ds_read_b64_tr_b16 a[234:235], v241 offset:11264
v_cvt_pk_bf16_f32 v76, v16, v17
v_mfma_f32_16x16x32_bf16 v[56:59], a[156:159], v[196:199], v[56:59]
ds_read_b64_tr_b16 a[236:237], v241 offset:12288
v_exp_f32 v18, v18
v_mfma_f32_16x16x32_bf16 a[32:35], a[184:187], v[88:91], a[32:35]
ds_read_b64_tr_b16 a[238:239], v241 offset:13312
ds_read_b64_tr_b16 a[240:241], v241 offset:14336
ds_read_b64_tr_b16 a[242:243], v241 offset:15360
v_mfma_f32_16x16x32_bf16 a[36:39], a[184:187], v[92:95], a[36:39]
ds_read_b64_tr_b16 a[244:245], v241 offset:16384
v_exp_f32 v19, v19
v_mfma_f32_16x16x32_bf16 a[40:43], a[184:187], v[96:99], a[40:43]
ds_read_b64_tr_b16 a[246:247], v241 offset:17408
ds_read_b64_tr_b16 a[248:249], v241 offset:18432
v_cvt_pk_bf16_f32 v77, v18, v19
v_mfma_f32_16x16x32_bf16 a[44:47], a[184:187], v[100:103], a[44:47]
ds_read_b64_tr_b16 a[250:251], v241 offset:19456
v_exp_f32 v20, v20
v_mfma_f32_16x16x32_bf16 v[64:67], a[144:147], v[200:203], v[148:151]
ds_read_b64_tr_b16 a[184:185], v222 offset:0
ds_read_b64_tr_b16 a[186:187], v222 offset:4096
ds_read_b64_tr_b16 a[252:253], v241 offset:20480
v_mfma_f32_16x16x32_bf16 v[64:67], a[148:151], v[204:207], v[64:67]
ds_read_b64_tr_b16 a[254:255], v241 offset:21504
v_exp_f32 v21, v21
v_mfma_f32_16x16x32_bf16 v[64:67], a[152:155], v[208:211], v[64:67]
ds_read_b128 a[144:147], v216 offset:16384
ds_read_b64_tr_b16 a[136:137], v241 offset:22528
v_cvt_pk_bf16_f32 v78, v20, v21
v_mfma_f32_16x16x32_bf16 v[64:67], a[156:159], v[212:215], v[64:67]
ds_read_b64_tr_b16 a[138:139], v241 offset:23552
v_exp_f32 v22, v22
v_mfma_f32_16x16x32_bf16 a[48:51], a[188:191], v[88:91], a[48:51]
ds_read_b128 a[148:151], v217 offset:16384
ds_read_b128 a[152:155], v218 offset:16384
ds_read_b64_tr_b16 a[140:141], v241 offset:24576
v_mfma_f32_16x16x32_bf16 a[52:55], a[188:191], v[92:95], a[52:55]
ds_read_b64_tr_b16 a[142:143], v241 offset:25600
v_exp_f32 v23, v23
v_mfma_f32_16x16x32_bf16 a[56:59], a[188:191], v[96:99], a[56:59]
ds_read_b128 a[156:159], v219 offset:16384
ds_read_b64_tr_b16 v[104:105], v241 offset:26624
v_cvt_pk_bf16_f32 v79, v22, v23
v_mfma_f32_16x16x32_bf16 a[60:63], a[188:191], v[100:103], a[60:63]
ds_read_b64_tr_b16 v[106:107], v241 offset:27648
v_exp_f32 v24, v24
v_smfmac_f32_16x16x64_bf16 a[128:131], a[208:211], v[88:95], v245
ds_read_b64_tr_b16 v[108:109], v241 offset:28672
v_exp_f32 v25, v25
v_mfma_f32_16x16x32_bf16 v[44:47], a[160:163], v[152:155], v[136:139]
ds_read_b64_tr_b16 a[188:189], v223 offset:0
ds_read_b64_tr_b16 v[110:111], v241 offset:29696
v_cvt_pk_bf16_f32 v80, v24, v25
v_mfma_f32_16x16x32_bf16 v[44:47], a[164:167], v[156:159], v[44:47]
ds_read_b64_tr_b16 v[112:113], v241 offset:30720
v_exp_f32 v26, v26
v_mfma_f32_16x16x32_bf16 v[44:47], a[168:171], v[160:163], v[44:47]
ds_read_b64_tr_b16 a[190:191], v223 offset:4096
s_add_u32 m0, s30, 65536
ds_read_b64_tr_b16 v[114:115], v241 offset:31744
v_mfma_f32_16x16x32_bf16 v[44:47], a[172:175], v[164:167], v[44:47]
v_and_b32 v252, 15, v252
v_exp_f32 v27, v27
v_mfma_f32_16x16x32_bf16 a[64:67], a[192:195], v[88:91], a[64:67]
buffer_load_dwordx4 v228, s[8:11], s32 offen offset:0 lds
v_cvt_pk_bf16_f32 v81, v26, v27
v_lshl_add_u32 v252, v252, 4, v249
v_mfma_f32_16x16x32_bf16 a[68:71], a[192:195], v[92:95], a[68:71]
v_lshrrev_b32 v249, 3, v1
v_exp_f32 v28, v28
v_mfma_f32_16x16x32_bf16 a[72:75], a[192:195], v[96:99], a[72:75]
buffer_load_dwordx4 v229, s[8:11], s32 offen offset:1024 lds
v_lshl_add_u32 v252, v249, 8, v252
v_mfma_f32_16x16x32_bf16 a[76:79], a[192:195], v[100:103], a[76:79]
v_exp_f32 v29, v29
v_mfma_f32_16x16x32_bf16 v[52:55], a[160:163], v[168:171], v[140:143]
ds_read_b64_tr_b16 a[192:193], v224 offset:0
v_cvt_pk_bf16_f32 v82, v28, v29
v_mfma_f32_16x16x32_bf16 v[52:55], a[164:167], v[172:175], v[52:55]
v_exp_f32 v30, v30
v_mfma_f32_16x16x32_bf16 v[52:55], a[168:171], v[176:179], v[52:55]
ds_read_b64_tr_b16 a[194:195], v224 offset:4096
v_mfma_f32_16x16x32_bf16 v[52:55], a[172:175], v[180:183], v[52:55]
v_exp_f32 v31, v31
v_mfma_f32_16x16x32_bf16 a[80:83], a[196:199], v[88:91], a[80:83]
buffer_load_dwordx4 v230, s[8:11], s32 offen offset:2048 lds
v_cvt_pk_bf16_f32 v83, v30, v31
v_mfma_f32_16x16x32_bf16 a[84:87], a[196:199], v[92:95], a[84:87]
v_exp_f32 v32, v32
v_mfma_f32_16x16x32_bf16 a[88:91], a[196:199], v[96:99], a[88:91]
v_mfma_f32_16x16x32_bf16 a[92:95], a[196:199], v[100:103], a[92:95]
v_exp_f32 v33, v33
v_mfma_f32_16x16x32_bf16 v[60:63], a[160:163], v[184:187], v[144:147]
ds_read_b64_tr_b16 a[196:197], v225 offset:0
v_cvt_pk_bf16_f32 v84, v32, v33
v_mfma_f32_16x16x32_bf16 v[60:63], a[164:167], v[188:191], v[60:63]
v_exp_f32 v34, v34
v_mfma_f32_16x16x32_bf16 v[60:63], a[168:171], v[192:195], v[60:63]
ds_read_b64_tr_b16 a[198:199], v225 offset:4096
v_mfma_f32_16x16x32_bf16 v[60:63], a[172:175], v[196:199], v[60:63]
v_exp_f32 v35, v35
v_mfma_f32_16x16x32_bf16 a[96:99], a[200:203], v[88:91], a[96:99]
buffer_load_dwordx4 v231, s[8:11], s32 offen offset:3072 lds
v_cvt_pk_bf16_f32 v85, v34, v35
v_mfma_f32_16x16x32_bf16 a[100:103], a[200:203], v[92:95], a[100:103]
v_exp_f32 v36, v36
v_mfma_f32_16x16x32_bf16 a[104:107], a[200:203], v[96:99], a[104:107]
v_mfma_f32_16x16x32_bf16 a[108:111], a[200:203], v[100:103], a[108:111]
v_exp_f32 v37, v37
v_mfma_f32_16x16x32_bf16 v[68:71], a[160:163], v[200:203], v[148:151]
ds_read_b64_tr_b16 a[200:201], v226 offset:0
v_cvt_pk_bf16_f32 v86, v36, v37
v_mfma_f32_16x16x32_bf16 v[68:71], a[164:167], v[204:207], v[68:71]
v_exp_f32 v38, v38
v_mfma_f32_16x16x32_bf16 v[68:71], a[168:171], v[208:211], v[68:71]
ds_read_b64_tr_b16 a[202:203], v226 offset:4096
ds_read_b128 a[160:163], v216 offset:20480
v_mfma_f32_16x16x32_bf16 v[68:71], a[172:175], v[212:215], v[68:71]
v_exp_f32 v39, v39
v_mfma_f32_16x16x32_bf16 a[112:115], a[204:207], v[88:91], a[112:115]
ds_read_b128 a[164:167], v217 offset:20480
v_cvt_pk_bf16_f32 v87, v38, v39
v_mfma_f32_16x16x32_bf16 a[116:119], a[204:207], v[92:95], a[116:119]
ds_read_b128 a[168:171], v218 offset:20480
ds_read_b128 a[172:175], v219 offset:20480
v_mfma_f32_16x16x32_bf16 a[120:123], a[204:207], v[96:99], a[120:123]
v_mfma_f32_16x16x32_bf16 a[124:127], a[204:207], v[100:103], a[124:127]
ds_read_b64_tr_b16 a[204:205], v227 offset:0
ds_read_b64_tr_b16 a[206:207], v227 offset:4096
v_smfmac_f32_16x16x64_bf16 a[132:135], a[208:211], v[96:103], v245
s_waitcnt lgkmcnt(8)
v_mfma_f32_16x16x32_bf16 v[8:11], a[144:147], v[152:155], v[136:139]
v_exp_f32 v40, v40
v_mfma_f32_16x16x32_bf16 v[8:11], a[148:151], v[156:159], v[8:11]
v_exp_f32 v41, v41
v_mfma_f32_16x16x32_bf16 v[8:11], a[152:155], v[160:163], v[8:11]
v_cvt_pk_bf16_f32 v88, v40, v41
v_mfma_f32_16x16x32_bf16 v[8:11], a[156:159], v[164:167], v[8:11]
v_exp_f32 v42, v42
v_mfma_f32_16x16x32_bf16 a[0:3], a[176:179], v[72:75], a[0:3]
s_add_u32 s39, s39, 16384
v_mfma_f32_16x16x32_bf16 a[4:7], a[176:179], v[76:79], a[4:7]
v_exp_f32 v43, v43
v_mfma_f32_16x16x32_bf16 a[8:11], a[176:179], v[80:83], a[8:11]
v_cvt_pk_bf16_f32 v89, v42, v43
v_mfma_f32_16x16x32_bf16 a[12:15], a[176:179], v[84:87], a[12:15]
v_exp_f32 v44, v44
v_mfma_f32_16x16x32_bf16 v[16:19], a[144:147], v[168:171], v[140:143]
ds_read_b64_tr_b16 a[176:177], v220 offset:8192
ds_read_b64_tr_b16 a[178:179], v220 offset:12288
v_mfma_f32_16x16x32_bf16 v[16:19], a[148:151], v[172:175], v[16:19]
v_exp_f32 v45, v45
v_mfma_f32_16x16x32_bf16 v[16:19], a[152:155], v[176:179], v[16:19]
v_cvt_pk_bf16_f32 v90, v44, v45
v_mfma_f32_16x16x32_bf16 v[16:19], a[156:159], v[180:183], v[16:19]
v_exp_f32 v46, v46
v_mfma_f32_16x16x32_bf16 a[16:19], a[180:183], v[72:75], a[16:19]
s_bitset0_b32 s39, 19
v_mfma_f32_16x16x32_bf16 a[20:23], a[180:183], v[76:79], a[20:23]
v_exp_f32 v47, v47
v_mfma_f32_16x16x32_bf16 a[24:27], a[180:183], v[80:83], a[24:27]
v_cvt_pk_bf16_f32 v91, v46, v47
v_mfma_f32_16x16x32_bf16 a[28:31], a[180:183], v[84:87], a[28:31]
v_exp_f32 v48, v48
v_mfma_f32_16x16x32_bf16 v[24:27], a[144:147], v[184:187], v[144:147]
ds_read_b64_tr_b16 a[180:181], v221 offset:8192
ds_read_b64_tr_b16 a[182:183], v221 offset:12288
v_mfma_f32_16x16x32_bf16 v[24:27], a[148:151], v[188:191], v[24:27]
v_exp_f32 v49, v49
v_mfma_f32_16x16x32_bf16 v[24:27], a[152:155], v[192:195], v[24:27]
v_cvt_pk_bf16_f32 v92, v48, v49
v_mfma_f32_16x16x32_bf16 v[24:27], a[156:159], v[196:199], v[24:27]
v_exp_f32 v50, v50
v_mfma_f32_16x16x32_bf16 a[32:35], a[184:187], v[72:75], a[32:35]
s_add_u32 m0, s30, 147456
v_mfma_f32_16x16x32_bf16 a[36:39], a[184:187], v[76:79], a[36:39]
v_exp_f32 v51, v51
v_mfma_f32_16x16x32_bf16 a[40:43], a[184:187], v[80:83], a[40:43]
v_cvt_pk_bf16_f32 v93, v50, v51
v_mfma_f32_16x16x32_bf16 a[44:47], a[184:187], v[84:87], a[44:47]
v_exp_f32 v52, v52
v_mfma_f32_16x16x32_bf16 v[32:35], a[144:147], v[200:203], v[148:151]
ds_read_b64_tr_b16 a[184:185], v222 offset:8192
ds_read_b64_tr_b16 a[186:187], v222 offset:12288
v_mfma_f32_16x16x32_bf16 v[32:35], a[148:151], v[204:207], v[32:35]
v_exp_f32 v53, v53
v_mfma_f32_16x16x32_bf16 v[32:35], a[152:155], v[208:211], v[32:35]
ds_read_b128 a[144:147], v216 offset:24576
v_cvt_pk_bf16_f32 v94, v52, v53
v_mfma_f32_16x16x32_bf16 v[32:35], a[156:159], v[212:215], v[32:35]
v_exp_f32 v54, v54
v_mfma_f32_16x16x32_bf16 a[48:51], a[188:191], v[72:75], a[48:51]
ds_read_b128 a[148:151], v217 offset:24576
ds_read_b128 a[152:155], v218 offset:24576
v_mfma_f32_16x16x32_bf16 a[52:55], a[188:191], v[76:79], a[52:55]
v_exp_f32 v55, v55
v_mfma_f32_16x16x32_bf16 a[56:59], a[188:191], v[80:83], a[56:59]
ds_read_b128 a[156:159], v219 offset:24576
v_cvt_pk_bf16_f32 v95, v54, v55
v_mfma_f32_16x16x32_bf16 a[60:63], a[188:191], v[84:87], a[60:63]
v_exp_f32 v56, v56
v_smfmac_f32_16x16x64_bf16 a[128:131], a[208:211], v[72:79], v245
v_exp_f32 v57, v57
s_waitcnt lgkmcnt(8)
v_mfma_f32_16x16x32_bf16 v[12:15], a[160:163], v[152:155], v[136:139]
ds_read_b64_tr_b16 a[188:189], v223 offset:8192
v_cvt_pk_bf16_f32 v96, v56, v57
v_mfma_f32_16x16x32_bf16 v[12:15], a[164:167], v[156:159], v[12:15]
v_exp_f32 v58, v58
v_mfma_f32_16x16x32_bf16 v[12:15], a[168:171], v[160:163], v[12:15]
ds_read_b64_tr_b16 a[190:191], v223 offset:12288
buffer_load_dwordx4 v232, s[12:15], s39 offen offset:0 lds
v_mfma_f32_16x16x32_bf16 v[12:15], a[172:175], v[164:167], v[12:15]
v_exp_f32 v59, v59
v_mfma_f32_16x16x32_bf16 a[64:67], a[192:195], v[72:75], a[64:67]
buffer_load_dwordx4 v233, s[12:15], s39 offen offset:1024 lds
v_cvt_pk_bf16_f32 v97, v58, v59
v_mfma_f32_16x16x32_bf16 a[68:71], a[192:195], v[76:79], a[68:71]
v_exp_f32 v60, v60
v_mfma_f32_16x16x32_bf16 a[72:75], a[192:195], v[80:83], a[72:75]
v_mfma_f32_16x16x32_bf16 a[76:79], a[192:195], v[84:87], a[76:79]
v_exp_f32 v61, v61
v_mfma_f32_16x16x32_bf16 v[20:23], a[160:163], v[168:171], v[140:143]
ds_read_b64_tr_b16 a[192:193], v224 offset:8192
v_cvt_pk_bf16_f32 v98, v60, v61
v_mfma_f32_16x16x32_bf16 v[20:23], a[164:167], v[172:175], v[20:23]
v_exp_f32 v62, v62
v_mfma_f32_16x16x32_bf16 v[20:23], a[168:171], v[176:179], v[20:23]
ds_read_b64_tr_b16 a[194:195], v224 offset:12288
buffer_load_dwordx4 v232, s[12:15], s39 offen offset:2048 lds
v_mfma_f32_16x16x32_bf16 v[20:23], a[172:175], v[180:183], v[20:23]
v_exp_f32 v63, v63
v_mfma_f32_16x16x32_bf16 a[80:83], a[196:199], v[72:75], a[80:83]
v_cvt_pk_bf16_f32 v99, v62, v63
v_mfma_f32_16x16x32_bf16 a[84:87], a[196:199], v[76:79], a[84:87]
v_exp_f32 v64, v64
v_mfma_f32_16x16x32_bf16 a[88:91], a[196:199], v[80:83], a[88:91]
v_mfma_f32_16x16x32_bf16 a[92:95], a[196:199], v[84:87], a[92:95]
v_exp_f32 v65, v65
v_mfma_f32_16x16x32_bf16 v[28:31], a[160:163], v[184:187], v[144:147]
ds_read_b64_tr_b16 a[196:197], v225 offset:8192
v_cvt_pk_bf16_f32 v100, v64, v65
v_mfma_f32_16x16x32_bf16 v[28:31], a[164:167], v[188:191], v[28:31]
v_exp_f32 v66, v66
v_mfma_f32_16x16x32_bf16 v[28:31], a[168:171], v[192:195], v[28:31]
ds_read_b64_tr_b16 a[198:199], v225 offset:12288
buffer_load_dwordx4 v233, s[12:15], s39 offen offset:3072 lds
v_mfma_f32_16x16x32_bf16 v[28:31], a[172:175], v[196:199], v[28:31]
v_exp_f32 v67, v67
v_mfma_f32_16x16x32_bf16 a[96:99], a[200:203], v[72:75], a[96:99]
v_cvt_pk_bf16_f32 v101, v66, v67
v_mfma_f32_16x16x32_bf16 a[100:103], a[200:203], v[76:79], a[100:103]
v_exp_f32 v68, v68
v_mfma_f32_16x16x32_bf16 a[104:107], a[200:203], v[80:83], a[104:107]
v_mfma_f32_16x16x32_bf16 a[108:111], a[200:203], v[84:87], a[108:111]
v_exp_f32 v69, v69
v_mfma_f32_16x16x32_bf16 v[36:39], a[160:163], v[200:203], v[148:151]
ds_read_b64_tr_b16 a[200:201], v226 offset:8192
v_cvt_pk_bf16_f32 v102, v68, v69
v_mfma_f32_16x16x32_bf16 v[36:39], a[164:167], v[204:207], v[36:39]
v_exp_f32 v70, v70
v_mfma_f32_16x16x32_bf16 v[36:39], a[168:171], v[208:211], v[36:39]
ds_read_b64_tr_b16 a[202:203], v226 offset:12288
ds_read_b128 a[160:163], v216 offset:28672
v_mfma_f32_16x16x32_bf16 v[36:39], a[172:175], v[212:215], v[36:39]
v_exp_f32 v71, v71
v_mfma_f32_16x16x32_bf16 a[112:115], a[204:207], v[72:75], a[112:115]
ds_read_b128 a[164:167], v217 offset:28672
v_cvt_pk_bf16_f32 v103, v70, v71
v_mfma_f32_16x16x32_bf16 a[116:119], a[204:207], v[76:79], a[116:119]
ds_read_b128 a[168:171], v218 offset:28672
ds_read_b128 a[172:175], v219 offset:28672
v_mfma_f32_16x16x32_bf16 a[120:123], a[204:207], v[80:83], a[120:123]
v_mfma_f32_16x16x32_bf16 a[124:127], a[204:207], v[84:87], a[124:127]
ds_read_b64_tr_b16 a[204:205], v227 offset:8192
ds_read_b64_tr_b16 a[206:207], v227 offset:12288
v_smfmac_f32_16x16x64_bf16 a[132:135], a[208:211], v[80:87], v245
s_waitcnt lgkmcnt(8)
v_mfma_f32_16x16x32_bf16 v[40:43], a[144:147], v[152:155], v[136:139]
v_exp_f32 v8, v8
v_mfma_f32_16x16x32_bf16 v[40:43], a[148:151], v[156:159], v[40:43]
v_exp_f32 v9, v9
v_mfma_f32_16x16x32_bf16 v[40:43], a[152:155], v[160:163], v[40:43]
v_cvt_pk_bf16_f32 v72, v8, v9
v_mfma_f32_16x16x32_bf16 v[40:43], a[156:159], v[164:167], v[40:43]
v_exp_f32 v10, v10
v_mfma_f32_16x16x32_bf16 a[0:3], a[176:179], v[88:91], a[0:3]
v_mfma_f32_16x16x32_bf16 a[4:7], a[176:179], v[92:95], a[4:7]
v_exp_f32 v11, v11
v_mfma_f32_16x16x32_bf16 a[8:11], a[176:179], v[96:99], a[8:11]
v_cvt_pk_bf16_f32 v73, v10, v11
v_mfma_f32_16x16x32_bf16 a[12:15], a[176:179], v[100:103], a[12:15]
s_waitcnt vmcnt(8) lgkmcnt(0)
s_barrier
v_mfma_f32_16x16x32_bf16 v[48:51], a[144:147], v[168:171], v[140:143]
v_exp_f32 v12, v12
v_mfma_f32_16x16x32_bf16 v[48:51], a[148:151], v[172:175], v[48:51]
v_exp_f32 v13, v13
v_mfma_f32_16x16x32_bf16 v[48:51], a[152:155], v[176:179], v[48:51]
ds_read_b64_tr_b16 a[176:177], v220 offset:32768
v_cvt_pk_bf16_f32 v74, v12, v13
v_mfma_f32_16x16x32_bf16 v[48:51], a[156:159], v[180:183], v[48:51]
v_exp_f32 v14, v14
v_mfma_f32_16x16x32_bf16 a[16:19], a[180:183], v[88:91], a[16:19]
ds_read_b64_tr_b16 a[178:179], v220 offset:36864
s_add_u32 s32, s32, 16384
v_mfma_f32_16x16x32_bf16 a[20:23], a[180:183], v[92:95], a[20:23]
v_exp_f32 v15, v15
v_mfma_f32_16x16x32_bf16 a[24:27], a[180:183], v[96:99], a[24:27]
s_bitset0_b32 s32, 19
v_cvt_pk_bf16_f32 v75, v14, v15
v_mfma_f32_16x16x32_bf16 a[28:31], a[180:183], v[100:103], a[28:31]
v_exp_f32 v16, v16
v_mfma_f32_16x16x32_bf16 v[56:59], a[144:147], v[184:187], v[144:147]
ds_read_b64_tr_b16 a[180:181], v221 offset:32768
ds_read_b64_tr_b16 a[182:183], v221 offset:36864
v_mfma_f32_16x16x32_bf16 v[56:59], a[148:151], v[188:191], v[56:59]
v_exp_f32 v17, v17
v_mfma_f32_16x16x32_bf16 v[56:59], a[152:155], v[192:195], v[56:59]
v_cvt_pk_bf16_f32 v76, v16, v17
v_mfma_f32_16x16x32_bf16 v[56:59], a[156:159], v[196:199], v[56:59]
v_exp_f32 v18, v18
v_mfma_f32_16x16x32_bf16 a[32:35], a[184:187], v[88:91], a[32:35]
s_add_u32 m0, s30, 81920
v_mfma_f32_16x16x32_bf16 a[36:39], a[184:187], v[92:95], a[36:39]
v_exp_f32 v19, v19
v_mfma_f32_16x16x32_bf16 a[40:43], a[184:187], v[96:99], a[40:43]
v_cvt_pk_bf16_f32 v77, v18, v19
v_mfma_f32_16x16x32_bf16 a[44:47], a[184:187], v[100:103], a[44:47]
v_exp_f32 v20, v20
v_mfma_f32_16x16x32_bf16 v[64:67], a[144:147], v[200:203], v[148:151]
ds_read_b64_tr_b16 a[184:185], v222 offset:32768
ds_read_b64_tr_b16 a[186:187], v222 offset:36864
v_mfma_f32_16x16x32_bf16 v[64:67], a[148:151], v[204:207], v[64:67]
v_exp_f32 v21, v21
v_mfma_f32_16x16x32_bf16 v[64:67], a[152:155], v[208:211], v[64:67]
ds_read_b128 a[144:147], v216 offset:49152
v_cvt_pk_bf16_f32 v78, v20, v21
v_mfma_f32_16x16x32_bf16 v[64:67], a[156:159], v[212:215], v[64:67]
v_exp_f32 v22, v22
v_mfma_f32_16x16x32_bf16 a[48:51], a[188:191], v[88:91], a[48:51]
ds_read_b128 a[148:151], v217 offset:49152
ds_read_b128 a[152:155], v218 offset:49152
v_mfma_f32_16x16x32_bf16 a[52:55], a[188:191], v[92:95], a[52:55]
v_exp_f32 v23, v23
v_mfma_f32_16x16x32_bf16 a[56:59], a[188:191], v[96:99], a[56:59]
ds_read_b128 a[156:159], v219 offset:49152
v_cvt_pk_bf16_f32 v79, v22, v23
v_mfma_f32_16x16x32_bf16 a[60:63], a[188:191], v[100:103], a[60:63]
v_exp_f32 v24, v24
v_smfmac_f32_16x16x64_bf16 a[128:131], a[208:211], v[88:95], v245
v_exp_f32 v25, v25
v_mfma_f32_16x16x32_bf16 v[44:47], a[160:163], v[152:155], v[136:139]
ds_read_b64_tr_b16 a[188:189], v223 offset:32768
v_cvt_pk_bf16_f32 v80, v24, v25
v_mfma_f32_16x16x32_bf16 v[44:47], a[164:167], v[156:159], v[44:47]
v_exp_f32 v26, v26
v_mfma_f32_16x16x32_bf16 v[44:47], a[168:171], v[160:163], v[44:47]
ds_read_b64_tr_b16 a[190:191], v223 offset:36864
buffer_load_dwordx4 v228, s[8:11], s32 offen offset:0 lds
v_mfma_f32_16x16x32_bf16 v[44:47], a[172:175], v[164:167], v[44:47]
v_exp_f32 v27, v27
v_mfma_f32_16x16x32_bf16 a[64:67], a[192:195], v[88:91], a[64:67]
buffer_load_dwordx4 v229, s[8:11], s32 offen offset:1024 lds
v_cvt_pk_bf16_f32 v81, v26, v27
v_mfma_f32_16x16x32_bf16 a[68:71], a[192:195], v[92:95], a[68:71]
v_exp_f32 v28, v28
v_mfma_f32_16x16x32_bf16 a[72:75], a[192:195], v[96:99], a[72:75]
buffer_load_dwordx4 v230, s[8:11], s32 offen offset:2048 lds
buffer_load_dwordx4 v231, s[8:11], s32 offen offset:3072 lds
v_mfma_f32_16x16x32_bf16 a[76:79], a[192:195], v[100:103], a[76:79]
v_exp_f32 v29, v29
v_mfma_f32_16x16x32_bf16 v[52:55], a[160:163], v[168:171], v[140:143]
ds_read_b64_tr_b16 a[192:193], v224 offset:32768
v_cvt_pk_bf16_f32 v82, v28, v29
v_mfma_f32_16x16x32_bf16 v[52:55], a[164:167], v[172:175], v[52:55]
v_exp_f32 v30, v30
v_mfma_f32_16x16x32_bf16 v[52:55], a[168:171], v[176:179], v[52:55]
ds_read_b64_tr_b16 a[194:195], v224 offset:36864
v_mfma_f32_16x16x32_bf16 v[52:55], a[172:175], v[180:183], v[52:55]
v_exp_f32 v31, v31
v_mfma_f32_16x16x32_bf16 a[80:83], a[196:199], v[88:91], a[80:83]
v_cvt_pk_bf16_f32 v83, v30, v31
v_mfma_f32_16x16x32_bf16 a[84:87], a[196:199], v[92:95], a[84:87]
v_exp_f32 v32, v32
v_mfma_f32_16x16x32_bf16 a[88:91], a[196:199], v[96:99], a[88:91]
s_add_u32 m0, s86, 0
s_add_u32 s50, s84, 4718592
buffer_load_dwordx4 v240, s[64:67], s50 offen lds
v_mfma_f32_16x16x32_bf16 a[92:95], a[196:199], v[100:103], a[92:95]
v_exp_f32 v33, v33
v_mfma_f32_16x16x32_bf16 v[60:63], a[160:163], v[184:187], v[144:147]
ds_read_b64_tr_b16 a[196:197], v225 offset:32768
v_cvt_pk_bf16_f32 v84, v32, v33
v_mfma_f32_16x16x32_bf16 v[60:63], a[164:167], v[188:191], v[60:63]
v_exp_f32 v34, v34
v_mfma_f32_16x16x32_bf16 v[60:63], a[168:171], v[192:195], v[60:63]
ds_read_b64_tr_b16 a[198:199], v225 offset:36864
v_mfma_f32_16x16x32_bf16 v[60:63], a[172:175], v[196:199], v[60:63]
v_exp_f32 v35, v35
v_mfma_f32_16x16x32_bf16 a[96:99], a[200:203], v[88:91], a[96:99]
v_cvt_pk_bf16_f32 v85, v34, v35
v_mfma_f32_16x16x32_bf16 a[100:103], a[200:203], v[92:95], a[100:103]
v_exp_f32 v36, v36
v_mfma_f32_16x16x32_bf16 a[104:107], a[200:203], v[96:99], a[104:107]
s_add_u32 m0, s86, 4096
s_add_u32 s50, s84, 4718592
buffer_load_dwordx4 v240, s[68:71], s50 offen lds
v_mfma_f32_16x16x32_bf16 a[108:111], a[200:203], v[100:103], a[108:111]
v_exp_f32 v37, v37
v_mfma_f32_16x16x32_bf16 v[68:71], a[160:163], v[200:203], v[148:151]
ds_read_b64_tr_b16 a[200:201], v226 offset:32768
v_cvt_pk_bf16_f32 v86, v36, v37
v_mfma_f32_16x16x32_bf16 v[68:71], a[164:167], v[204:207], v[68:71]
v_exp_f32 v38, v38
v_mfma_f32_16x16x32_bf16 v[68:71], a[168:171], v[208:211], v[68:71]
ds_read_b64_tr_b16 a[202:203], v226 offset:36864
ds_read_b128 a[160:163], v216 offset:53248
v_mfma_f32_16x16x32_bf16 v[68:71], a[172:175], v[212:215], v[68:71]
v_exp_f32 v39, v39
v_mfma_f32_16x16x32_bf16 a[112:115], a[204:207], v[88:91], a[112:115]
ds_read_b128 a[164:167], v217 offset:53248
v_cvt_pk_bf16_f32 v87, v38, v39
v_mfma_f32_16x16x32_bf16 a[116:119], a[204:207], v[92:95], a[116:119]
ds_read_b128 a[168:171], v218 offset:53248
ds_read_b128 a[172:175], v219 offset:53248
v_mfma_f32_16x16x32_bf16 a[120:123], a[204:207], v[96:99], a[120:123]
s_add_u32 m0, s86, 8192
s_add_u32 s50, s85, 0
buffer_load_dwordx4 v244, s[72:75], s50 offen lds
v_mfma_f32_16x16x32_bf16 a[124:127], a[204:207], v[100:103], a[124:127]
ds_read_b64_tr_b16 a[204:205], v227 offset:32768
ds_read_b64_tr_b16 a[206:207], v227 offset:36864
v_smfmac_f32_16x16x64_bf16 a[132:135], a[208:211], v[96:103], v245
s_waitcnt lgkmcnt(8)
v_mfma_f32_16x16x32_bf16 v[8:11], a[144:147], v[152:155], v[136:139]
v_exp_f32 v40, v40
v_mfma_f32_16x16x32_bf16 v[8:11], a[148:151], v[156:159], v[8:11]
v_exp_f32 v41, v41
v_mfma_f32_16x16x32_bf16 v[8:11], a[152:155], v[160:163], v[8:11]
v_cvt_pk_bf16_f32 v88, v40, v41
v_mfma_f32_16x16x32_bf16 v[8:11], a[156:159], v[164:167], v[8:11]
v_exp_f32 v42, v42
v_mfma_f32_16x16x32_bf16 a[0:3], a[176:179], v[72:75], a[0:3]
s_add_u32 s39, s39, 16384
v_mfma_f32_16x16x32_bf16 a[4:7], a[176:179], v[76:79], a[4:7]
v_exp_f32 v43, v43
v_mfma_f32_16x16x32_bf16 a[8:11], a[176:179], v[80:83], a[8:11]
v_cvt_pk_bf16_f32 v89, v42, v43
v_mfma_f32_16x16x32_bf16 a[12:15], a[176:179], v[84:87], a[12:15]
v_exp_f32 v44, v44
v_mfma_f32_16x16x32_bf16 v[16:19], a[144:147], v[168:171], v[140:143]
ds_read_b64_tr_b16 a[176:177], v220 offset:40960
ds_read_b64_tr_b16 a[178:179], v220 offset:45056
v_mfma_f32_16x16x32_bf16 v[16:19], a[148:151], v[172:175], v[16:19]
v_exp_f32 v45, v45
v_mfma_f32_16x16x32_bf16 v[16:19], a[152:155], v[176:179], v[16:19]
s_bitset0_b32 s39, 19
v_cvt_pk_bf16_f32 v90, v44, v45
v_mfma_f32_16x16x32_bf16 v[16:19], a[156:159], v[180:183], v[16:19]
v_exp_f32 v46, v46
v_mfma_f32_16x16x32_bf16 a[16:19], a[180:183], v[72:75], a[16:19]
v_mfma_f32_16x16x32_bf16 a[20:23], a[180:183], v[76:79], a[20:23]
v_exp_f32 v47, v47
v_mfma_f32_16x16x32_bf16 a[24:27], a[180:183], v[80:83], a[24:27]
s_add_u32 m0, s30, 98304
v_cvt_pk_bf16_f32 v91, v46, v47
v_mfma_f32_16x16x32_bf16 a[28:31], a[180:183], v[84:87], a[28:31]
v_exp_f32 v48, v48
v_mfma_f32_16x16x32_bf16 v[24:27], a[144:147], v[184:187], v[144:147]
ds_read_b64_tr_b16 a[180:181], v221 offset:40960
ds_read_b64_tr_b16 a[182:183], v221 offset:45056
v_mfma_f32_16x16x32_bf16 v[24:27], a[148:151], v[188:191], v[24:27]
v_exp_f32 v49, v49
v_mfma_f32_16x16x32_bf16 v[24:27], a[152:155], v[192:195], v[24:27]
buffer_load_dwordx4 v232, s[12:15], s39 offen offset:0 lds
v_cvt_pk_bf16_f32 v92, v48, v49
v_mfma_f32_16x16x32_bf16 v[24:27], a[156:159], v[196:199], v[24:27]
v_exp_f32 v50, v50
v_mfma_f32_16x16x32_bf16 a[32:35], a[184:187], v[72:75], a[32:35]
v_mfma_f32_16x16x32_bf16 a[36:39], a[184:187], v[76:79], a[36:39]
v_exp_f32 v51, v51
v_mfma_f32_16x16x32_bf16 a[40:43], a[184:187], v[80:83], a[40:43]
v_cvt_pk_bf16_f32 v93, v50, v51
v_mfma_f32_16x16x32_bf16 a[44:47], a[184:187], v[84:87], a[44:47]
v_exp_f32 v52, v52
v_mfma_f32_16x16x32_bf16 v[32:35], a[144:147], v[200:203], v[148:151]
ds_read_b64_tr_b16 a[184:185], v222 offset:40960
ds_read_b64_tr_b16 a[186:187], v222 offset:45056
v_mfma_f32_16x16x32_bf16 v[32:35], a[148:151], v[204:207], v[32:35]
v_exp_f32 v53, v53
v_mfma_f32_16x16x32_bf16 v[32:35], a[152:155], v[208:211], v[32:35]
ds_read_b128 a[144:147], v216 offset:57344
v_cvt_pk_bf16_f32 v94, v52, v53
v_mfma_f32_16x16x32_bf16 v[32:35], a[156:159], v[212:215], v[32:35]
v_exp_f32 v54, v54
v_mfma_f32_16x16x32_bf16 a[48:51], a[188:191], v[72:75], a[48:51]
ds_read_b128 a[148:151], v217 offset:57344
ds_read_b128 a[152:155], v218 offset:57344
v_mfma_f32_16x16x32_bf16 a[52:55], a[188:191], v[76:79], a[52:55]
v_exp_f32 v55, v55
v_mfma_f32_16x16x32_bf16 a[56:59], a[188:191], v[80:83], a[56:59]
ds_read_b128 a[156:159], v219 offset:57344
v_cvt_pk_bf16_f32 v95, v54, v55
v_mfma_f32_16x16x32_bf16 a[60:63], a[188:191], v[84:87], a[60:63]
v_exp_f32 v56, v56
v_smfmac_f32_16x16x64_bf16 a[128:131], a[208:211], v[72:79], v245
v_exp_f32 v57, v57
s_waitcnt lgkmcnt(8)
v_mfma_f32_16x16x32_bf16 v[12:15], a[160:163], v[152:155], v[136:139]
ds_read_b64_tr_b16 a[188:189], v223 offset:40960
v_cvt_pk_bf16_f32 v96, v56, v57
v_mfma_f32_16x16x32_bf16 v[12:15], a[164:167], v[156:159], v[12:15]
v_exp_f32 v58, v58
v_mfma_f32_16x16x32_bf16 v[12:15], a[168:171], v[160:163], v[12:15]
ds_read_b64_tr_b16 a[190:191], v223 offset:45056
buffer_load_dwordx4 v233, s[12:15], s39 offen offset:1024 lds
v_mfma_f32_16x16x32_bf16 v[12:15], a[172:175], v[164:167], v[12:15]
v_exp_f32 v59, v59
v_mfma_f32_16x16x32_bf16 a[64:67], a[192:195], v[72:75], a[64:67]
buffer_load_dwordx4 v232, s[12:15], s39 offen offset:2048 lds
v_cvt_pk_bf16_f32 v97, v58, v59
v_mfma_f32_16x16x32_bf16 a[68:71], a[192:195], v[76:79], a[68:71]
v_exp_f32 v60, v60
v_mfma_f32_16x16x32_bf16 a[72:75], a[192:195], v[80:83], a[72:75]
buffer_load_dwordx4 v233, s[12:15], s39 offen offset:3072 lds
v_mfma_f32_16x16x32_bf16 a[76:79], a[192:195], v[84:87], a[76:79]
v_exp_f32 v61, v61
v_mfma_f32_16x16x32_bf16 v[20:23], a[160:163], v[168:171], v[140:143]
ds_read_b64_tr_b16 a[192:193], v224 offset:40960
v_cvt_pk_bf16_f32 v98, v60, v61
v_mfma_f32_16x16x32_bf16 v[20:23], a[164:167], v[172:175], v[20:23]
v_exp_f32 v62, v62
v_mfma_f32_16x16x32_bf16 v[20:23], a[168:171], v[176:179], v[20:23]
ds_read_b64_tr_b16 a[194:195], v224 offset:45056
v_mfma_f32_16x16x32_bf16 v[20:23], a[172:175], v[180:183], v[20:23]
v_exp_f32 v63, v63
v_mfma_f32_16x16x32_bf16 a[80:83], a[196:199], v[72:75], a[80:83]
v_cvt_pk_bf16_f32 v99, v62, v63
v_mfma_f32_16x16x32_bf16 a[84:87], a[196:199], v[76:79], a[84:87]
v_exp_f32 v64, v64
v_mfma_f32_16x16x32_bf16 a[88:91], a[196:199], v[80:83], a[88:91]
s_add_u32 m0, s86, 12288
s_add_u32 s50, s85, 4096
buffer_load_dwordx4 v244, s[72:75], s50 offen lds
v_mfma_f32_16x16x32_bf16 a[92:95], a[196:199], v[84:87], a[92:95]
v_exp_f32 v65, v65
v_mfma_f32_16x16x32_bf16 v[28:31], a[160:163], v[184:187], v[144:147]
ds_read_b64_tr_b16 a[196:197], v225 offset:40960
v_cvt_pk_bf16_f32 v100, v64, v65
v_mfma_f32_16x16x32_bf16 v[28:31], a[164:167], v[188:191], v[28:31]
v_exp_f32 v66, v66
v_mfma_f32_16x16x32_bf16 v[28:31], a[168:171], v[192:195], v[28:31]
ds_read_b64_tr_b16 a[198:199], v225 offset:45056
v_mfma_f32_16x16x32_bf16 v[28:31], a[172:175], v[196:199], v[28:31]
v_exp_f32 v67, v67
v_mfma_f32_16x16x32_bf16 a[96:99], a[200:203], v[72:75], a[96:99]
v_cvt_pk_bf16_f32 v101, v66, v67
v_mfma_f32_16x16x32_bf16 a[100:103], a[200:203], v[76:79], a[100:103]
v_exp_f32 v68, v68
v_mfma_f32_16x16x32_bf16 a[104:107], a[200:203], v[80:83], a[104:107]
s_add_u32 m0, s86, 16384
s_add_u32 s50, s85, 8192
buffer_load_dwordx4 v244, s[72:75], s50 offen lds
v_mfma_f32_16x16x32_bf16 a[108:111], a[200:203], v[84:87], a[108:111]
v_exp_f32 v69, v69
v_mfma_f32_16x16x32_bf16 v[36:39], a[160:163], v[200:203], v[148:151]
ds_read_b64_tr_b16 a[200:201], v226 offset:40960
v_cvt_pk_bf16_f32 v102, v68, v69
v_mfma_f32_16x16x32_bf16 v[36:39], a[164:167], v[204:207], v[36:39]
v_exp_f32 v70, v70
v_mfma_f32_16x16x32_bf16 v[36:39], a[168:171], v[208:211], v[36:39]
ds_read_b64_tr_b16 a[202:203], v226 offset:45056
ds_read_b128 a[160:163], v216 offset:61440
v_mfma_f32_16x16x32_bf16 v[36:39], a[172:175], v[212:215], v[36:39]
v_exp_f32 v71, v71
v_mfma_f32_16x16x32_bf16 a[112:115], a[204:207], v[72:75], a[112:115]
ds_read_b128 a[164:167], v217 offset:61440
v_cvt_pk_bf16_f32 v103, v70, v71
v_mfma_f32_16x16x32_bf16 a[116:119], a[204:207], v[76:79], a[116:119]
ds_read_b128 a[168:171], v218 offset:61440
ds_read_b128 a[172:175], v219 offset:61440
v_mfma_f32_16x16x32_bf16 a[120:123], a[204:207], v[80:83], a[120:123]
s_add_u32 m0, s86, 20480
s_add_u32 s50, s85, 12288
buffer_load_dwordx4 v244, s[72:75], s50 offen lds
v_mfma_f32_16x16x32_bf16 a[124:127], a[204:207], v[84:87], a[124:127]
ds_read_b64_tr_b16 a[204:205], v227 offset:40960
ds_read_b64_tr_b16 a[206:207], v227 offset:45056
v_smfmac_f32_16x16x64_bf16 a[132:135], a[208:211], v[80:87], v245
s_add_u32 m0, s86, 24576
s_add_u32 s50, s85, 16384
buffer_load_dwordx4 v244, s[72:75], s50 offen lds
s_waitcnt lgkmcnt(8)
v_mfma_f32_16x16x32_bf16 v[40:43], a[144:147], v[152:155], v[136:139]
v_exp_f32 v8, v8
v_mfma_f32_16x16x32_bf16 v[40:43], a[148:151], v[156:159], v[40:43]
v_exp_f32 v9, v9
v_mfma_f32_16x16x32_bf16 v[40:43], a[152:155], v[160:163], v[40:43]
v_cvt_pk_bf16_f32 v72, v8, v9
v_mfma_f32_16x16x32_bf16 v[40:43], a[156:159], v[164:167], v[40:43]
v_exp_f32 v10, v10
v_mfma_f32_16x16x32_bf16 a[0:3], a[176:179], v[88:91], a[0:3]
v_mfma_f32_16x16x32_bf16 a[4:7], a[176:179], v[92:95], a[4:7]
v_exp_f32 v11, v11
v_mfma_f32_16x16x32_bf16 a[8:11], a[176:179], v[96:99], a[8:11]
v_cvt_pk_bf16_f32 v73, v10, v11
v_mfma_f32_16x16x32_bf16 a[12:15], a[176:179], v[100:103], a[12:15]
s_waitcnt vmcnt(15) lgkmcnt(0)
s_barrier
v_mfma_f32_16x16x32_bf16 v[48:51], a[144:147], v[168:171], v[140:143]
v_exp_f32 v12, v12
v_mfma_f32_16x16x32_bf16 v[48:51], a[148:151], v[172:175], v[48:51]
v_exp_f32 v13, v13
v_mfma_f32_16x16x32_bf16 v[48:51], a[152:155], v[176:179], v[48:51]
ds_read_b64_tr_b16 a[176:177], v220 offset:49152
v_cvt_pk_bf16_f32 v74, v12, v13
v_mfma_f32_16x16x32_bf16 v[48:51], a[156:159], v[180:183], v[48:51]
v_exp_f32 v14, v14
v_mfma_f32_16x16x32_bf16 a[16:19], a[180:183], v[88:91], a[16:19]
ds_read_b64_tr_b16 a[178:179], v220 offset:53248
s_add_u32 s32, s32, 16384
v_mfma_f32_16x16x32_bf16 a[20:23], a[180:183], v[92:95], a[20:23]
v_exp_f32 v15, v15
v_mfma_f32_16x16x32_bf16 a[24:27], a[180:183], v[96:99], a[24:27]
s_bitset0_b32 s32, 19
v_cvt_pk_bf16_f32 v75, v14, v15
v_mfma_f32_16x16x32_bf16 a[28:31], a[180:183], v[100:103], a[28:31]
v_exp_f32 v16, v16
v_mfma_f32_16x16x32_bf16 v[56:59], a[144:147], v[184:187], v[144:147]
ds_read_b64_tr_b16 a[180:181], v221 offset:49152
ds_read_b64_tr_b16 a[182:183], v221 offset:53248
v_mfma_f32_16x16x32_bf16 v[56:59], a[148:151], v[188:191], v[56:59]
v_exp_f32 v17, v17
v_mfma_f32_16x16x32_bf16 v[56:59], a[152:155], v[192:195], v[56:59]
s_add_u32 m0, s30, 114688
v_cvt_pk_bf16_f32 v76, v16, v17
v_mfma_f32_16x16x32_bf16 v[56:59], a[156:159], v[196:199], v[56:59]
v_exp_f32 v18, v18
v_mfma_f32_16x16x32_bf16 a[32:35], a[184:187], v[88:91], a[32:35]
v_mfma_f32_16x16x32_bf16 a[36:39], a[184:187], v[92:95], a[36:39]
v_exp_f32 v19, v19
v_mfma_f32_16x16x32_bf16 a[40:43], a[184:187], v[96:99], a[40:43]
v_cvt_pk_bf16_f32 v77, v18, v19
v_mfma_f32_16x16x32_bf16 a[44:47], a[184:187], v[100:103], a[44:47]
v_exp_f32 v20, v20
v_mfma_f32_16x16x32_bf16 v[64:67], a[144:147], v[200:203], v[148:151]
ds_read_b64_tr_b16 a[184:185], v222 offset:49152
ds_read_b64_tr_b16 a[186:187], v222 offset:53248
v_mfma_f32_16x16x32_bf16 v[64:67], a[148:151], v[204:207], v[64:67]
v_exp_f32 v21, v21
v_mfma_f32_16x16x32_bf16 v[64:67], a[152:155], v[208:211], v[64:67]
ds_read_b128 a[144:147], v216 offset:0
v_cvt_pk_bf16_f32 v78, v20, v21
v_mfma_f32_16x16x32_bf16 v[64:67], a[156:159], v[212:215], v[64:67]
v_exp_f32 v22, v22
v_mfma_f32_16x16x32_bf16 a[48:51], a[188:191], v[88:91], a[48:51]
ds_read_b128 a[148:151], v217 offset:0
ds_read_b128 a[152:155], v218 offset:0
v_mfma_f32_16x16x32_bf16 a[52:55], a[188:191], v[92:95], a[52:55]
v_exp_f32 v23, v23
v_mfma_f32_16x16x32_bf16 a[56:59], a[188:191], v[96:99], a[56:59]
ds_read_b128 a[156:159], v219 offset:0
v_cvt_pk_bf16_f32 v79, v22, v23
v_mfma_f32_16x16x32_bf16 a[60:63], a[188:191], v[100:103], a[60:63]
v_exp_f32 v24, v24
v_smfmac_f32_16x16x64_bf16 a[128:131], a[208:211], v[88:95], v245
v_exp_f32 v25, v25
v_mfma_f32_16x16x32_bf16 v[44:47], a[160:163], v[152:155], v[136:139]
ds_read_b64_tr_b16 a[188:189], v223 offset:49152
v_cvt_pk_bf16_f32 v80, v24, v25
v_mfma_f32_16x16x32_bf16 v[44:47], a[164:167], v[156:159], v[44:47]
v_exp_f32 v26, v26
v_mfma_f32_16x16x32_bf16 v[44:47], a[168:171], v[160:163], v[44:47]
ds_read_b64_tr_b16 a[190:191], v223 offset:53248
buffer_load_dwordx4 v228, s[8:11], s32 offen offset:0 lds
v_mfma_f32_16x16x32_bf16 v[44:47], a[172:175], v[164:167], v[44:47]
v_exp_f32 v27, v27
v_mfma_f32_16x16x32_bf16 a[64:67], a[192:195], v[88:91], a[64:67]
buffer_load_dwordx4 v229, s[8:11], s32 offen offset:1024 lds
v_cvt_pk_bf16_f32 v81, v26, v27
v_mfma_f32_16x16x32_bf16 a[68:71], a[192:195], v[92:95], a[68:71]
v_exp_f32 v28, v28
v_mfma_f32_16x16x32_bf16 a[72:75], a[192:195], v[96:99], a[72:75]
buffer_load_dwordx4 v230, s[8:11], s32 offen offset:2048 lds
buffer_load_dwordx4 v231, s[8:11], s32 offen offset:3072 lds
v_mfma_f32_16x16x32_bf16 a[76:79], a[192:195], v[100:103], a[76:79]
v_exp_f32 v29, v29
v_mfma_f32_16x16x32_bf16 v[52:55], a[160:163], v[168:171], v[140:143]
ds_read_b64_tr_b16 a[192:193], v224 offset:49152
v_cvt_pk_bf16_f32 v82, v28, v29
v_mfma_f32_16x16x32_bf16 v[52:55], a[164:167], v[172:175], v[52:55]
v_exp_f32 v30, v30
v_mfma_f32_16x16x32_bf16 v[52:55], a[168:171], v[176:179], v[52:55]
ds_read_b64_tr_b16 a[194:195], v224 offset:53248
v_mfma_f32_16x16x32_bf16 v[52:55], a[172:175], v[180:183], v[52:55]
v_exp_f32 v31, v31
v_mfma_f32_16x16x32_bf16 a[80:83], a[196:199], v[88:91], a[80:83]
v_cvt_pk_bf16_f32 v83, v30, v31
v_mfma_f32_16x16x32_bf16 a[84:87], a[196:199], v[92:95], a[84:87]
v_exp_f32 v32, v32
v_mfma_f32_16x16x32_bf16 a[88:91], a[196:199], v[96:99], a[88:91]
s_add_u32 m0, s86, 28672
s_add_u32 s50, s85, 20480
buffer_load_dwordx4 v244, s[72:75], s50 offen lds
v_mfma_f32_16x16x32_bf16 a[92:95], a[196:199], v[100:103], a[92:95]
v_exp_f32 v33, v33
v_mfma_f32_16x16x32_bf16 v[60:63], a[160:163], v[184:187], v[144:147]
ds_read_b64_tr_b16 a[196:197], v225 offset:49152
v_cvt_pk_bf16_f32 v84, v32, v33
v_mfma_f32_16x16x32_bf16 v[60:63], a[164:167], v[188:191], v[60:63]
v_exp_f32 v34, v34
v_mfma_f32_16x16x32_bf16 v[60:63], a[168:171], v[192:195], v[60:63]
ds_read_b64_tr_b16 a[198:199], v225 offset:53248
v_mfma_f32_16x16x32_bf16 v[60:63], a[172:175], v[196:199], v[60:63]
v_exp_f32 v35, v35
v_mfma_f32_16x16x32_bf16 a[96:99], a[200:203], v[88:91], a[96:99]
v_cvt_pk_bf16_f32 v85, v34, v35
v_mfma_f32_16x16x32_bf16 a[100:103], a[200:203], v[92:95], a[100:103]
v_exp_f32 v36, v36
v_mfma_f32_16x16x32_bf16 a[104:107], a[200:203], v[96:99], a[104:107]
s_add_u32 m0, s86, 32768
s_add_u32 s50, s85, 24576
buffer_load_dwordx4 v244, s[72:75], s50 offen lds
v_mfma_f32_16x16x32_bf16 a[108:111], a[200:203], v[100:103], a[108:111]
v_exp_f32 v37, v37
v_mfma_f32_16x16x32_bf16 v[68:71], a[160:163], v[200:203], v[148:151]
ds_read_b64_tr_b16 a[200:201], v226 offset:49152
v_cvt_pk_bf16_f32 v86, v36, v37
v_mfma_f32_16x16x32_bf16 v[68:71], a[164:167], v[204:207], v[68:71]
v_exp_f32 v38, v38
v_mfma_f32_16x16x32_bf16 v[68:71], a[168:171], v[208:211], v[68:71]
ds_read_b64_tr_b16 a[202:203], v226 offset:53248
ds_read_b128 a[160:163], v216 offset:4096
v_mfma_f32_16x16x32_bf16 v[68:71], a[172:175], v[212:215], v[68:71]
v_exp_f32 v39, v39
v_mfma_f32_16x16x32_bf16 a[112:115], a[204:207], v[88:91], a[112:115]
ds_read_b128 a[164:167], v217 offset:4096
v_cvt_pk_bf16_f32 v87, v38, v39
v_mfma_f32_16x16x32_bf16 a[116:119], a[204:207], v[92:95], a[116:119]
ds_read_b128 a[168:171], v218 offset:4096
ds_read_b128 a[172:175], v219 offset:4096
v_mfma_f32_16x16x32_bf16 a[120:123], a[204:207], v[96:99], a[120:123]
s_add_u32 m0, s86, 36864
s_add_u32 s50, s85, 28672
buffer_load_dwordx4 v244, s[72:75], s50 offen lds
v_mfma_f32_16x16x32_bf16 a[124:127], a[204:207], v[100:103], a[124:127]
ds_read_b64_tr_b16 a[204:205], v227 offset:49152
ds_read_b64_tr_b16 a[206:207], v227 offset:53248
v_smfmac_f32_16x16x64_bf16 a[132:135], a[208:211], v[96:103], v245
s_add_u32 m0, s86, 40960
s_add_u32 s50, s85, 32768
buffer_load_dwordx4 v244, s[72:75], s50 offen lds
s_waitcnt lgkmcnt(8)
v_mfma_f32_16x16x32_bf16 v[8:11], a[144:147], v[152:155], v[136:139]
v_exp_f32 v40, v40
v_mfma_f32_16x16x32_bf16 v[8:11], a[148:151], v[156:159], v[8:11]
v_exp_f32 v41, v41
v_mfma_f32_16x16x32_bf16 v[8:11], a[152:155], v[160:163], v[8:11]
v_cvt_pk_bf16_f32 v88, v40, v41
v_mfma_f32_16x16x32_bf16 v[8:11], a[156:159], v[164:167], v[8:11]
v_exp_f32 v42, v42
v_mfma_f32_16x16x32_bf16 a[0:3], a[176:179], v[72:75], a[0:3]
s_add_u32 s39, s39, 16384
v_mfma_f32_16x16x32_bf16 a[4:7], a[176:179], v[76:79], a[4:7]
v_exp_f32 v43, v43
v_mfma_f32_16x16x32_bf16 a[8:11], a[176:179], v[80:83], a[8:11]
v_cvt_pk_bf16_f32 v89, v42, v43
v_mfma_f32_16x16x32_bf16 a[12:15], a[176:179], v[84:87], a[12:15]
v_exp_f32 v44, v44
v_mfma_f32_16x16x32_bf16 v[16:19], a[144:147], v[168:171], v[140:143]
ds_read_b64_tr_b16 a[176:177], v220 offset:57344
ds_read_b64_tr_b16 a[178:179], v220 offset:61440
v_mfma_f32_16x16x32_bf16 v[16:19], a[148:151], v[172:175], v[16:19]
v_exp_f32 v45, v45
v_mfma_f32_16x16x32_bf16 v[16:19], a[152:155], v[176:179], v[16:19]
s_bitset0_b32 s39, 19
v_cvt_pk_bf16_f32 v90, v44, v45
v_mfma_f32_16x16x32_bf16 v[16:19], a[156:159], v[180:183], v[16:19]
v_exp_f32 v46, v46
v_mfma_f32_16x16x32_bf16 a[16:19], a[180:183], v[72:75], a[16:19]
v_mfma_f32_16x16x32_bf16 a[20:23], a[180:183], v[76:79], a[20:23]
v_exp_f32 v47, v47
v_mfma_f32_16x16x32_bf16 a[24:27], a[180:183], v[80:83], a[24:27]
s_add_u32 m0, s30, 131072
v_cvt_pk_bf16_f32 v91, v46, v47
v_mfma_f32_16x16x32_bf16 a[28:31], a[180:183], v[84:87], a[28:31]
v_exp_f32 v48, v48
v_mfma_f32_16x16x32_bf16 v[24:27], a[144:147], v[184:187], v[144:147]
ds_read_b64_tr_b16 a[180:181], v221 offset:57344
ds_read_b64_tr_b16 a[182:183], v221 offset:61440
v_mfma_f32_16x16x32_bf16 v[24:27], a[148:151], v[188:191], v[24:27]
v_exp_f32 v49, v49
v_mfma_f32_16x16x32_bf16 v[24:27], a[152:155], v[192:195], v[24:27]
v_cvt_pk_bf16_f32 v92, v48, v49
v_mfma_f32_16x16x32_bf16 v[24:27], a[156:159], v[196:199], v[24:27]
v_exp_f32 v50, v50
v_mfma_f32_16x16x32_bf16 a[32:35], a[184:187], v[72:75], a[32:35]
buffer_load_dwordx4 v232, s[12:15], s39 offen offset:0 lds
v_mfma_f32_16x16x32_bf16 a[36:39], a[184:187], v[76:79], a[36:39]
v_exp_f32 v51, v51
v_mfma_f32_16x16x32_bf16 a[40:43], a[184:187], v[80:83], a[40:43]
v_cvt_pk_bf16_f32 v93, v50, v51
v_mfma_f32_16x16x32_bf16 a[44:47], a[184:187], v[84:87], a[44:47]
v_exp_f32 v52, v52
v_mfma_f32_16x16x32_bf16 v[32:35], a[144:147], v[200:203], v[148:151]
ds_read_b64_tr_b16 a[184:185], v222 offset:57344
ds_read_b64_tr_b16 a[186:187], v222 offset:61440
v_mfma_f32_16x16x32_bf16 v[32:35], a[148:151], v[204:207], v[32:35]
v_exp_f32 v53, v53
v_mfma_f32_16x16x32_bf16 v[32:35], a[152:155], v[208:211], v[32:35]
ds_read_b128 a[144:147], v216 offset:8192
v_cvt_pk_bf16_f32 v94, v52, v53
v_mfma_f32_16x16x32_bf16 v[32:35], a[156:159], v[212:215], v[32:35]
v_exp_f32 v54, v54
v_mfma_f32_16x16x32_bf16 a[48:51], a[188:191], v[72:75], a[48:51]
ds_read_b128 a[148:151], v217 offset:8192
ds_read_b128 a[152:155], v218 offset:8192
v_mfma_f32_16x16x32_bf16 a[52:55], a[188:191], v[76:79], a[52:55]
v_exp_f32 v55, v55
v_mfma_f32_16x16x32_bf16 a[56:59], a[188:191], v[80:83], a[56:59]
ds_read_b128 a[156:159], v219 offset:8192
v_cvt_pk_bf16_f32 v95, v54, v55
v_mfma_f32_16x16x32_bf16 a[60:63], a[188:191], v[84:87], a[60:63]
v_exp_f32 v56, v56
v_smfmac_f32_16x16x64_bf16 a[128:131], a[208:211], v[72:79], v245
v_exp_f32 v57, v57
s_waitcnt lgkmcnt(8)
v_mfma_f32_16x16x32_bf16 v[12:15], a[160:163], v[152:155], v[136:139]
ds_read_b64_tr_b16 a[188:189], v223 offset:57344
v_cvt_pk_bf16_f32 v96, v56, v57
v_mfma_f32_16x16x32_bf16 v[12:15], a[164:167], v[156:159], v[12:15]
v_exp_f32 v58, v58
v_mfma_f32_16x16x32_bf16 v[12:15], a[168:171], v[160:163], v[12:15]
ds_read_b64_tr_b16 a[190:191], v223 offset:61440
buffer_load_dwordx4 v233, s[12:15], s39 offen offset:1024 lds
v_mfma_f32_16x16x32_bf16 v[12:15], a[172:175], v[164:167], v[12:15]
v_exp_f32 v59, v59
v_mfma_f32_16x16x32_bf16 a[64:67], a[192:195], v[72:75], a[64:67]
buffer_load_dwordx4 v232, s[12:15], s39 offen offset:2048 lds
v_cvt_pk_bf16_f32 v97, v58, v59
v_mfma_f32_16x16x32_bf16 a[68:71], a[192:195], v[76:79], a[68:71]
v_exp_f32 v60, v60
v_mfma_f32_16x16x32_bf16 a[72:75], a[192:195], v[80:83], a[72:75]
buffer_load_dwordx4 v233, s[12:15], s39 offen offset:3072 lds
v_mfma_f32_16x16x32_bf16 a[76:79], a[192:195], v[84:87], a[76:79]
v_exp_f32 v61, v61
v_mfma_f32_16x16x32_bf16 v[20:23], a[160:163], v[168:171], v[140:143]
ds_read_b64_tr_b16 a[192:193], v224 offset:57344
v_cvt_pk_bf16_f32 v98, v60, v61
v_mfma_f32_16x16x32_bf16 v[20:23], a[164:167], v[172:175], v[20:23]
v_exp_f32 v62, v62
v_mfma_f32_16x16x32_bf16 v[20:23], a[168:171], v[176:179], v[20:23]
ds_read_b64_tr_b16 a[194:195], v224 offset:61440
v_mfma_f32_16x16x32_bf16 v[20:23], a[172:175], v[180:183], v[20:23]
v_exp_f32 v63, v63
v_mfma_f32_16x16x32_bf16 a[80:83], a[196:199], v[72:75], a[80:83]
v_cvt_pk_bf16_f32 v99, v62, v63
v_mfma_f32_16x16x32_bf16 a[84:87], a[196:199], v[76:79], a[84:87]
v_exp_f32 v64, v64
v_mfma_f32_16x16x32_bf16 a[88:91], a[196:199], v[80:83], a[88:91]
s_add_u32 m0, s86, 45056
s_lshl_b32 s50, s31, 1
s_add_u32 s50, s50, 0
buffer_load_dwordx4 v252, s[20:23], s50 offen sc0 sc1 lds
v_mfma_f32_16x16x32_bf16 a[92:95], a[196:199], v[84:87], a[92:95]
v_exp_f32 v65, v65
v_mfma_f32_16x16x32_bf16 v[28:31], a[160:163], v[184:187], v[144:147]
ds_read_b64_tr_b16 a[196:197], v225 offset:57344
v_cvt_pk_bf16_f32 v100, v64, v65
v_mfma_f32_16x16x32_bf16 v[28:31], a[164:167], v[188:191], v[28:31]
v_exp_f32 v66, v66
v_mfma_f32_16x16x32_bf16 v[28:31], a[168:171], v[192:195], v[28:31]
ds_read_b64_tr_b16 a[198:199], v225 offset:61440
v_mfma_f32_16x16x32_bf16 v[28:31], a[172:175], v[196:199], v[28:31]
v_exp_f32 v67, v67
v_mfma_f32_16x16x32_bf16 a[96:99], a[200:203], v[72:75], a[96:99]
v_cvt_pk_bf16_f32 v101, v66, v67
v_mfma_f32_16x16x32_bf16 a[100:103], a[200:203], v[76:79], a[100:103]
v_exp_f32 v68, v68
v_mfma_f32_16x16x32_bf16 a[104:107], a[200:203], v[80:83], a[104:107]
s_add_u32 m0, s86, 49152
s_lshl_b32 s50, s31, 1
s_add_u32 s50, s50, 8192
buffer_load_dwordx4 v252, s[20:23], s50 offen sc0 sc1 lds
v_mfma_f32_16x16x32_bf16 a[108:111], a[200:203], v[84:87], a[108:111]
v_exp_f32 v69, v69
v_mfma_f32_16x16x32_bf16 v[36:39], a[160:163], v[200:203], v[148:151]
ds_read_b64_tr_b16 a[200:201], v226 offset:57344
v_cvt_pk_bf16_f32 v102, v68, v69
v_mfma_f32_16x16x32_bf16 v[36:39], a[164:167], v[204:207], v[36:39]
v_exp_f32 v70, v70
v_mfma_f32_16x16x32_bf16 v[36:39], a[168:171], v[208:211], v[36:39]
ds_read_b64_tr_b16 a[202:203], v226 offset:61440
ds_read_b128 a[160:163], v216 offset:12288
v_mfma_f32_16x16x32_bf16 v[36:39], a[172:175], v[212:215], v[36:39]
v_exp_f32 v71, v71
v_mfma_f32_16x16x32_bf16 a[112:115], a[204:207], v[72:75], a[112:115]
ds_read_b128 a[164:167], v217 offset:12288
v_cvt_pk_bf16_f32 v103, v70, v71
v_mfma_f32_16x16x32_bf16 a[116:119], a[204:207], v[76:79], a[116:119]
ds_read_b128 a[168:171], v218 offset:12288
ds_read_b128 a[172:175], v219 offset:12288
v_mfma_f32_16x16x32_bf16 a[120:123], a[204:207], v[80:83], a[120:123]
s_add_u32 m0, s86, 53248
s_lshl_b32 s50, s31, 1
s_add_u32 s50, s50, 16384
buffer_load_dwordx4 v252, s[20:23], s50 offen sc0 sc1 lds
v_mfma_f32_16x16x32_bf16 a[124:127], a[204:207], v[84:87], a[124:127]
ds_read_b64_tr_b16 a[204:205], v227 offset:57344
ds_read_b64_tr_b16 a[206:207], v227 offset:61440
v_smfmac_f32_16x16x64_bf16 a[132:135], a[208:211], v[80:87], v245
s_mov_b32 s33, 7
s_cmp_lt_u32 s86, 0x10000
s_cbranch_scc0 K_LOOPIN
s_waitcnt lgkmcnt(8)
v_mfma_f32_16x16x32_bf16 v[40:43], a[144:147], v[152:155], v[136:139]
v_exp_f32 v8, v8
v_mfma_f32_16x16x32_bf16 v[40:43], a[148:151], v[156:159], v[40:43]
v_exp_f32 v9, v9
v_mfma_f32_16x16x32_bf16 v[40:43], a[152:155], v[160:163], v[40:43]
v_cvt_pk_bf16_f32 v72, v8, v9
v_mfma_f32_16x16x32_bf16 v[40:43], a[156:159], v[164:167], v[40:43]
v_exp_f32 v10, v10
v_mfma_f32_16x16x32_bf16 a[0:3], a[176:179], v[88:91], a[0:3]
v_mfma_f32_16x16x32_bf16 a[4:7], a[176:179], v[92:95], a[4:7]
v_exp_f32 v11, v11
v_mfma_f32_16x16x32_bf16 a[8:11], a[176:179], v[96:99], a[8:11]
v_cvt_pk_bf16_f32 v73, v10, v11
v_mfma_f32_16x16x32_bf16 a[12:15], a[176:179], v[100:103], a[12:15]
s_waitcnt vmcnt(15) lgkmcnt(0)
s_barrier
v_mfma_f32_16x16x32_bf16 v[48:51], a[144:147], v[168:171], v[140:143]
v_exp_f32 v12, v12
v_mfma_f32_16x16x32_bf16 v[48:51], a[148:151], v[172:175], v[48:51]
v_exp_f32 v13, v13
v_mfma_f32_16x16x32_bf16 v[48:51], a[152:155], v[176:179], v[48:51]
ds_read_b64_tr_b16 a[176:177], v220 offset:0
v_cvt_pk_bf16_f32 v74, v12, v13
v_mfma_f32_16x16x32_bf16 v[48:51], a[156:159], v[180:183], v[48:51]
v_exp_f32 v14, v14
v_mfma_f32_16x16x32_bf16 a[16:19], a[180:183], v[88:91], a[16:19]
ds_read_b64_tr_b16 a[178:179], v220 offset:4096
s_add_u32 s32, s32, 16384
v_mfma_f32_16x16x32_bf16 a[20:23], a[180:183], v[92:95], a[20:23]
v_exp_f32 v15, v15
v_mfma_f32_16x16x32_bf16 a[24:27], a[180:183], v[96:99], a[24:27]
v_cvt_pk_bf16_f32 v75, v14, v15
v_mfma_f32_16x16x32_bf16 a[28:31], a[180:183], v[100:103], a[28:31]
v_exp_f32 v16, v16
v_mfma_f32_16x16x32_bf16 v[56:59], a[144:147], v[184:187], v[144:147]
ds_read_b64_tr_b16 a[180:181], v221 offset:0
ds_read_b64_tr_b16 a[182:183], v221 offset:4096
v_mfma_f32_16x16x32_bf16 v[56:59], a[148:151], v[188:191], v[56:59]
v_exp_f32 v17, v17
v_mfma_f32_16x16x32_bf16 v[56:59], a[152:155], v[192:195], v[56:59]
s_bitset0_b32 s32, 19
v_cvt_pk_bf16_f32 v76, v16, v17
v_mfma_f32_16x16x32_bf16 v[56:59], a[156:159], v[196:199], v[56:59]
v_exp_f32 v18, v18
v_mfma_f32_16x16x32_bf16 a[32:35], a[184:187], v[88:91], a[32:35]
v_mfma_f32_16x16x32_bf16 a[36:39], a[184:187], v[92:95], a[36:39]
v_exp_f32 v19, v19
v_mfma_f32_16x16x32_bf16 a[40:43], a[184:187], v[96:99], a[40:43]
v_cvt_pk_bf16_f32 v77, v18, v19
v_mfma_f32_16x16x32_bf16 a[44:47], a[184:187], v[100:103], a[44:47]
v_exp_f32 v20, v20
v_mfma_f32_16x16x32_bf16 v[64:67], a[144:147], v[200:203], v[148:151]
ds_read_b64_tr_b16 a[184:185], v222 offset:0
ds_read_b64_tr_b16 a[186:187], v222 offset:4096
v_mfma_f32_16x16x32_bf16 v[64:67], a[148:151], v[204:207], v[64:67]
v_exp_f32 v21, v21
v_mfma_f32_16x16x32_bf16 v[64:67], a[152:155], v[208:211], v[64:67]
ds_read_b128 a[144:147], v216 offset:16384
v_cvt_pk_bf16_f32 v78, v20, v21
v_mfma_f32_16x16x32_bf16 v[64:67], a[156:159], v[212:215], v[64:67]
v_exp_f32 v22, v22
v_mfma_f32_16x16x32_bf16 a[48:51], a[188:191], v[88:91], a[48:51]
ds_read_b128 a[148:151], v217 offset:16384
ds_read_b128 a[152:155], v218 offset:16384
v_mfma_f32_16x16x32_bf16 a[52:55], a[188:191], v[92:95], a[52:55]
v_exp_f32 v23, v23
v_mfma_f32_16x16x32_bf16 a[56:59], a[188:191], v[96:99], a[56:59]
ds_read_b128 a[156:159], v219 offset:16384
v_cvt_pk_bf16_f32 v79, v22, v23
v_mfma_f32_16x16x32_bf16 a[60:63], a[188:191], v[100:103], a[60:63]
v_exp_f32 v24, v24
v_smfmac_f32_16x16x64_bf16 a[128:131], a[208:211], v[88:95], v245
v_exp_f32 v25, v25
v_mfma_f32_16x16x32_bf16 v[44:47], a[160:163], v[152:155], v[136:139]
ds_read_b64_tr_b16 a[188:189], v223 offset:0
v_cvt_pk_bf16_f32 v80, v24, v25
v_mfma_f32_16x16x32_bf16 v[44:47], a[164:167], v[156:159], v[44:47]
v_exp_f32 v26, v26
v_mfma_f32_16x16x32_bf16 v[44:47], a[168:171], v[160:163], v[44:47]
ds_read_b64_tr_b16 a[190:191], v223 offset:4096
s_add_u32 m0, s30, 65536
v_mfma_f32_16x16x32_bf16 v[44:47], a[172:175], v[164:167], v[44:47]
v_exp_f32 v27, v27
v_mfma_f32_16x16x32_bf16 a[64:67], a[192:195], v[88:91], a[64:67]
buffer_load_dwordx4 v228, s[8:11], s32 offen offset:0 lds
v_cvt_pk_bf16_f32 v81, v26, v27
v_mfma_f32_16x16x32_bf16 a[68:71], a[192:195], v[92:95], a[68:71]
v_exp_f32 v28, v28
v_mfma_f32_16x16x32_bf16 a[72:75], a[192:195], v[96:99], a[72:75]
buffer_load_dwordx4 v229, s[8:11], s32 offen offset:1024 lds
v_mfma_f32_16x16x32_bf16 a[76:79], a[192:195], v[100:103], a[76:79]
v_exp_f32 v29, v29
v_mfma_f32_16x16x32_bf16 v[52:55], a[160:163], v[168:171], v[140:143]
ds_read_b64_tr_b16 a[192:193], v224 offset:0
v_cvt_pk_bf16_f32 v82, v28, v29
v_mfma_f32_16x16x32_bf16 v[52:55], a[164:167], v[172:175], v[52:55]
v_exp_f32 v30, v30
v_mfma_f32_16x16x32_bf16 v[52:55], a[168:171], v[176:179], v[52:55]
ds_read_b64_tr_b16 a[194:195], v224 offset:4096
v_mfma_f32_16x16x32_bf16 v[52:55], a[172:175], v[180:183], v[52:55]
v_exp_f32 v31, v31
v_mfma_f32_16x16x32_bf16 a[80:83], a[196:199], v[88:91], a[80:83]
buffer_load_dwordx4 v230, s[8:11], s32 offen offset:2048 lds
v_cvt_pk_bf16_f32 v83, v30, v31
v_mfma_f32_16x16x32_bf16 a[84:87], a[196:199], v[92:95], a[84:87]
v_exp_f32 v32, v32
v_mfma_f32_16x16x32_bf16 a[88:91], a[196:199], v[96:99], a[88:91]
v_mfma_f32_16x16x32_bf16 a[92:95], a[196:199], v[100:103], a[92:95]
v_exp_f32 v33, v33
v_mfma_f32_16x16x32_bf16 v[60:63], a[160:163], v[184:187], v[144:147]
ds_read_b64_tr_b16 a[196:197], v225 offset:0
v_cvt_pk_bf16_f32 v84, v32, v33
v_mfma_f32_16x16x32_bf16 v[60:63], a[164:167], v[188:191], v[60:63]
v_exp_f32 v34, v34
v_mfma_f32_16x16x32_bf16 v[60:63], a[168:171], v[192:195], v[60:63]
ds_read_b64_tr_b16 a[198:199], v225 offset:4096
v_mfma_f32_16x16x32_bf16 v[60:63], a[172:175], v[196:199], v[60:63]
v_exp_f32 v35, v35
v_mfma_f32_16x16x32_bf16 a[96:99], a[200:203], v[88:91], a[96:99]
buffer_load_dwordx4 v231, s[8:11], s32 offen offset:3072 lds
v_cvt_pk_bf16_f32 v85, v34, v35
v_mfma_f32_16x16x32_bf16 a[100:103], a[200:203], v[92:95], a[100:103]
v_exp_f32 v36, v36
v_mfma_f32_16x16x32_bf16 a[104:107], a[200:203], v[96:99], a[104:107]
v_mfma_f32_16x16x32_bf16 a[108:111], a[200:203], v[100:103], a[108:111]
v_exp_f32 v37, v37
v_mfma_f32_16x16x32_bf16 v[68:71], a[160:163], v[200:203], v[148:151]
ds_read_b64_tr_b16 a[200:201], v226 offset:0
v_cvt_pk_bf16_f32 v86, v36, v37
v_mfma_f32_16x16x32_bf16 v[68:71], a[164:167], v[204:207], v[68:71]
v_exp_f32 v38, v38
v_mfma_f32_16x16x32_bf16 v[68:71], a[168:171], v[208:211], v[68:71]
ds_read_b64_tr_b16 a[202:203], v226 offset:4096
ds_read_b128 a[160:163], v216 offset:20480
v_mfma_f32_16x16x32_bf16 v[68:71], a[172:175], v[212:215], v[68:71]
v_exp_f32 v39, v39
v_mfma_f32_16x16x32_bf16 a[112:115], a[204:207], v[88:91], a[112:115]
ds_read_b128 a[164:167], v217 offset:20480
v_cvt_pk_bf16_f32 v87, v38, v39
v_mfma_f32_16x16x32_bf16 a[116:119], a[204:207], v[92:95], a[116:119]
ds_read_b128 a[168:171], v218 offset:20480
ds_read_b128 a[172:175], v219 offset:20480
v_mfma_f32_16x16x32_bf16 a[120:123], a[204:207], v[96:99], a[120:123]
v_mfma_f32_16x16x32_bf16 a[124:127], a[204:207], v[100:103], a[124:127]
ds_read_b64_tr_b16 a[204:205], v227 offset:0
ds_read_b64_tr_b16 a[206:207], v227 offset:4096
v_smfmac_f32_16x16x64_bf16 a[132:135], a[208:211], v[96:103], v245
s_waitcnt lgkmcnt(8)
v_mfma_f32_16x16x32_bf16 v[8:11], a[144:147], v[152:155], v[136:139]
v_exp_f32 v40, v40
v_mfma_f32_16x16x32_bf16 v[8:11], a[148:151], v[156:159], v[8:11]
v_exp_f32 v41, v41
v_mfma_f32_16x16x32_bf16 v[8:11], a[152:155], v[160:163], v[8:11]
v_cvt_pk_bf16_f32 v88, v40, v41
v_mfma_f32_16x16x32_bf16 v[8:11], a[156:159], v[164:167], v[8:11]
v_exp_f32 v42, v42
v_mfma_f32_16x16x32_bf16 a[0:3], a[176:179], v[72:75], a[0:3]
s_add_u32 s39, s39, 16384
v_mfma_f32_16x16x32_bf16 a[4:7], a[176:179], v[76:79], a[4:7]
v_exp_f32 v43, v43
v_mfma_f32_16x16x32_bf16 a[8:11], a[176:179], v[80:83], a[8:11]
v_cvt_pk_bf16_f32 v89, v42, v43
v_mfma_f32_16x16x32_bf16 a[12:15], a[176:179], v[84:87], a[12:15]
v_exp_f32 v44, v44
v_mfma_f32_16x16x32_bf16 v[16:19], a[144:147], v[168:171], v[140:143]
ds_read_b64_tr_b16 a[176:177], v220 offset:8192
ds_read_b64_tr_b16 a[178:179], v220 offset:12288
v_mfma_f32_16x16x32_bf16 v[16:19], a[148:151], v[172:175], v[16:19]
v_exp_f32 v45, v45
v_mfma_f32_16x16x32_bf16 v[16:19], a[152:155], v[176:179], v[16:19]
v_cvt_pk_bf16_f32 v90, v44, v45
v_mfma_f32_16x16x32_bf16 v[16:19], a[156:159], v[180:183], v[16:19]
v_exp_f32 v46, v46
v_mfma_f32_16x16x32_bf16 a[16:19], a[180:183], v[72:75], a[16:19]
s_bitset0_b32 s39, 19
v_mfma_f32_16x16x32_bf16 a[20:23], a[180:183], v[76:79], a[20:23]
v_exp_f32 v47, v47
v_mfma_f32_16x16x32_bf16 a[24:27], a[180:183], v[80:83], a[24:27]
v_cvt_pk_bf16_f32 v91, v46, v47
v_mfma_f32_16x16x32_bf16 a[28:31], a[180:183], v[84:87], a[28:31]
v_exp_f32 v48, v48
v_mfma_f32_16x16x32_bf16 v[24:27], a[144:147], v[184:187], v[144:147]
ds_read_b64_tr_b16 a[180:181], v221 offset:8192
ds_read_b64_tr_b16 a[182:183], v221 offset:12288
v_mfma_f32_16x16x32_bf16 v[24:27], a[148:151], v[188:191], v[24:27]
v_exp_f32 v49, v49
v_mfma_f32_16x16x32_bf16 v[24:27], a[152:155], v[192:195], v[24:27]
v_cvt_pk_bf16_f32 v92, v48, v49
v_mfma_f32_16x16x32_bf16 v[24:27], a[156:159], v[196:199], v[24:27]
v_exp_f32 v50, v50
v_mfma_f32_16x16x32_bf16 a[32:35], a[184:187], v[72:75], a[32:35]
s_add_u32 m0, s30, 147456
v_mfma_f32_16x16x32_bf16 a[36:39], a[184:187], v[76:79], a[36:39]
v_exp_f32 v51, v51
v_mfma_f32_16x16x32_bf16 a[40:43], a[184:187], v[80:83], a[40:43]
v_cvt_pk_bf16_f32 v93, v50, v51
v_mfma_f32_16x16x32_bf16 a[44:47], a[184:187], v[84:87], a[44:47]
v_exp_f32 v52, v52
v_mfma_f32_16x16x32_bf16 v[32:35], a[144:147], v[200:203], v[148:151]
ds_read_b64_tr_b16 a[184:185], v222 offset:8192
ds_read_b64_tr_b16 a[186:187], v222 offset:12288
v_mfma_f32_16x16x32_bf16 v[32:35], a[148:151], v[204:207], v[32:35]
v_exp_f32 v53, v53
v_mfma_f32_16x16x32_bf16 v[32:35], a[152:155], v[208:211], v[32:35]
ds_read_b128 a[144:147], v216 offset:24576
v_cvt_pk_bf16_f32 v94, v52, v53
v_mfma_f32_16x16x32_bf16 v[32:35], a[156:159], v[212:215], v[32:35]
v_exp_f32 v54, v54
v_mfma_f32_16x16x32_bf16 a[48:51], a[188:191], v[72:75], a[48:51]
ds_read_b128 a[148:151], v217 offset:24576
ds_read_b128 a[152:155], v218 offset:24576
v_mfma_f32_16x16x32_bf16 a[52:55], a[188:191], v[76:79], a[52:55]
v_exp_f32 v55, v55
v_mfma_f32_16x16x32_bf16 a[56:59], a[188:191], v[80:83], a[56:59]
ds_read_b128 a[156:159], v219 offset:24576
v_cvt_pk_bf16_f32 v95, v54, v55
v_mfma_f32_16x16x32_bf16 a[60:63], a[188:191], v[84:87], a[60:63]
v_exp_f32 v56, v56
v_smfmac_f32_16x16x64_bf16 a[128:131], a[208:211], v[72:79], v245
v_exp_f32 v57, v57
s_waitcnt lgkmcnt(8)
v_mfma_f32_16x16x32_bf16 v[12:15], a[160:163], v[152:155], v[136:139]
ds_read_b64_tr_b16 a[188:189], v223 offset:8192
v_cvt_pk_bf16_f32 v96, v56, v57
v_mfma_f32_16x16x32_bf16 v[12:15], a[164:167], v[156:159], v[12:15]
v_exp_f32 v58, v58
v_mfma_f32_16x16x32_bf16 v[12:15], a[168:171], v[160:163], v[12:15]
ds_read_b64_tr_b16 a[190:191], v223 offset:12288
buffer_load_dwordx4 v232, s[12:15], s39 offen offset:0 lds
v_mfma_f32_16x16x32_bf16 v[12:15], a[172:175], v[164:167], v[12:15]
v_exp_f32 v59, v59
v_mfma_f32_16x16x32_bf16 a[64:67], a[192:195], v[72:75], a[64:67]
buffer_load_dwordx4 v233, s[12:15], s39 offen offset:1024 lds
v_cvt_pk_bf16_f32 v97, v58, v59
v_mfma_f32_16x16x32_bf16 a[68:71], a[192:195], v[76:79], a[68:71]
v_exp_f32 v60, v60
v_mfma_f32_16x16x32_bf16 a[72:75], a[192:195], v[80:83], a[72:75]
v_mfma_f32_16x16x32_bf16 a[76:79], a[192:195], v[84:87], a[76:79]
v_exp_f32 v61, v61
v_mfma_f32_16x16x32_bf16 v[20:23], a[160:163], v[168:171], v[140:143]
ds_read_b64_tr_b16 a[192:193], v224 offset:8192
v_cvt_pk_bf16_f32 v98, v60, v61
v_mfma_f32_16x16x32_bf16 v[20:23], a[164:167], v[172:175], v[20:23]
v_exp_f32 v62, v62
v_mfma_f32_16x16x32_bf16 v[20:23], a[168:171], v[176:179], v[20:23]
ds_read_b64_tr_b16 a[194:195], v224 offset:12288
buffer_load_dwordx4 v232, s[12:15], s39 offen offset:2048 lds
v_mfma_f32_16x16x32_bf16 v[20:23], a[172:175], v[180:183], v[20:23]
v_exp_f32 v63, v63
v_mfma_f32_16x16x32_bf16 a[80:83], a[196:199], v[72:75], a[80:83]
v_cvt_pk_bf16_f32 v99, v62, v63
v_mfma_f32_16x16x32_bf16 a[84:87], a[196:199], v[76:79], a[84:87]
v_exp_f32 v64, v64
v_mfma_f32_16x16x32_bf16 a[88:91], a[196:199], v[80:83], a[88:91]
v_mfma_f32_16x16x32_bf16 a[92:95], a[196:199], v[84:87], a[92:95]
v_exp_f32 v65, v65
v_mfma_f32_16x16x32_bf16 v[28:31], a[160:163], v[184:187], v[144:147]
ds_read_b64_tr_b16 a[196:197], v225 offset:8192
v_cvt_pk_bf16_f32 v100, v64, v65
v_mfma_f32_16x16x32_bf16 v[28:31], a[164:167], v[188:191], v[28:31]
v_exp_f32 v66, v66
v_mfma_f32_16x16x32_bf16 v[28:31], a[168:171], v[192:195], v[28:31]
ds_read_b64_tr_b16 a[198:199], v225 offset:12288
buffer_load_dwordx4 v233, s[12:15], s39 offen offset:3072 lds
v_mfma_f32_16x16x32_bf16 v[28:31], a[172:175], v[196:199], v[28:31]
v_exp_f32 v67, v67
v_mfma_f32_16x16x32_bf16 a[96:99], a[200:203], v[72:75], a[96:99]
v_cvt_pk_bf16_f32 v101, v66, v67
v_mfma_f32_16x16x32_bf16 a[100:103], a[200:203], v[76:79], a[100:103]
v_exp_f32 v68, v68
v_mfma_f32_16x16x32_bf16 a[104:107], a[200:203], v[80:83], a[104:107]
v_mfma_f32_16x16x32_bf16 a[108:111], a[200:203], v[84:87], a[108:111]
v_exp_f32 v69, v69
v_mfma_f32_16x16x32_bf16 v[36:39], a[160:163], v[200:203], v[148:151]
ds_read_b64_tr_b16 a[200:201], v226 offset:8192
v_cvt_pk_bf16_f32 v102, v68, v69
v_mfma_f32_16x16x32_bf16 v[36:39], a[164:167], v[204:207], v[36:39]
v_exp_f32 v70, v70
v_mfma_f32_16x16x32_bf16 v[36:39], a[168:171], v[208:211], v[36:39]
ds_read_b64_tr_b16 a[202:203], v226 offset:12288
ds_read_b128 a[160:163], v216 offset:28672
v_mfma_f32_16x16x32_bf16 v[36:39], a[172:175], v[212:215], v[36:39]
v_exp_f32 v71, v71
v_mfma_f32_16x16x32_bf16 a[112:115], a[204:207], v[72:75], a[112:115]
ds_read_b128 a[164:167], v217 offset:28672
v_cvt_pk_bf16_f32 v103, v70, v71
v_mfma_f32_16x16x32_bf16 a[116:119], a[204:207], v[76:79], a[116:119]
ds_read_b128 a[168:171], v218 offset:28672
ds_read_b128 a[172:175], v219 offset:28672
v_mfma_f32_16x16x32_bf16 a[120:123], a[204:207], v[80:83], a[120:123]
v_mfma_f32_16x16x32_bf16 a[124:127], a[204:207], v[84:87], a[124:127]
ds_read_b64_tr_b16 a[204:205], v227 offset:8192
ds_read_b64_tr_b16 a[206:207], v227 offset:12288
v_smfmac_f32_16x16x64_bf16 a[132:135], a[208:211], v[80:87], v245
s_waitcnt lgkmcnt(8)
v_mfma_f32_16x16x32_bf16 v[40:43], a[144:147], v[152:155], v[136:139]
v_exp_f32 v8, v8
v_mfma_f32_16x16x32_bf16 v[40:43], a[148:151], v[156:159], v[40:43]
v_exp_f32 v9, v9
v_mfma_f32_16x16x32_bf16 v[40:43], a[152:155], v[160:163], v[40:43]
s_lshr_b32 s28, s37, 1
s_mul_i32 s28, s28, 28672
v_cvt_pk_bf16_f32 v72, v8, v9
v_mfma_f32_16x16x32_bf16 v[40:43], a[156:159], v[164:167], v[40:43]
v_subrev_u32 v241, s28, v241
v_exp_f32 v10, v10
v_mfma_f32_16x16x32_bf16 a[0:3], a[176:179], v[88:91], a[0:3]
v_and_b32 v239, 7, v1
v_lshl_add_u32 v239, v4, 3, v239
v_lshlrev_b32 v239, 4, v239
v_mfma_f32_16x16x32_bf16 a[4:7], a[176:179], v[92:95], a[4:7]
v_exp_f32 v11, v11
v_mfma_f32_16x16x32_bf16 a[8:11], a[176:179], v[96:99], a[8:11]
v_cvt_pk_bf16_f32 v73, v10, v11
v_mfma_f32_16x16x32_bf16 a[12:15], a[176:179], v[100:103], a[12:15]
s_waitcnt vmcnt(8) lgkmcnt(0)
s_barrier
v_mfma_f32_16x16x32_bf16 v[48:51], a[144:147], v[168:171], v[140:143]
ds_read_b128 v[124:127], v239 offset:45056
v_exp_f32 v12, v12
v_mfma_f32_16x16x32_bf16 v[48:51], a[148:151], v[172:175], v[48:51]
ds_read_b128 v[128:131], v239 offset:45568
v_exp_f32 v13, v13
v_mfma_f32_16x16x32_bf16 v[48:51], a[152:155], v[176:179], v[48:51]
ds_read_b64_tr_b16 a[176:177], v220 offset:32768
ds_read_b128 v[248:251], v239 offset:46080
v_cvt_pk_bf16_f32 v74, v12, v13
v_mfma_f32_16x16x32_bf16 v[48:51], a[156:159], v[180:183], v[48:51]
ds_read_b128 v[252:255], v239 offset:46592
v_exp_f32 v14, v14
v_mfma_f32_16x16x32_bf16 a[16:19], a[180:183], v[88:91], a[16:19]
ds_read_b64_tr_b16 a[178:179], v220 offset:36864
s_add_u32 s32, s32, 16384
ds_read_b64_tr_b16 v[116:117], v241 offset:0
v_mfma_f32_16x16x32_bf16 a[20:23], a[180:183], v[92:95], a[20:23]
ds_read_b64_tr_b16 v[118:119], v241 offset:1024
v_exp_f32 v15, v15
v_mfma_f32_16x16x32_bf16 a[24:27], a[180:183], v[96:99], a[24:27]
ds_read_b64_tr_b16 v[120:121], v241 offset:2048
ds_read_b64_tr_b16 v[122:123], v241 offset:3072
v_cvt_pk_bf16_f32 v75, v14, v15
v_mfma_f32_16x16x32_bf16 a[28:31], a[180:183], v[100:103], a[28:31]
v_exp_f32 v16, v16
v_mfma_f32_16x16x32_bf16 v[56:59], a[144:147], v[184:187], v[144:147]
ds_read_b64_tr_b16 a[180:181], v221 offset:32768
ds_read_b64_tr_b16 a[182:183], v221 offset:36864
v_mfma_f32_16x16x32_bf16 v[56:59], a[148:151], v[188:191], v[56:59]
v_exp_f32 v17, v17
v_mfma_f32_16x16x32_bf16 v[56:59], a[152:155], v[192:195], v[56:59]
s_bitset0_b32 s32, 19
v_cvt_pk_bf16_f32 v76, v16, v17
v_mfma_f32_16x16x32_bf16 v[56:59], a[156:159], v[196:199], v[56:59]
v_exp_f32 v18, v18
v_mfma_f32_16x16x32_bf16 a[32:35], a[184:187], v[88:91], a[32:35]
s_waitcnt lgkmcnt(8)
v_mfma_f32_16x16x32_bf16 v[132:135], a[212:215], v[124:127], 0
v_mfma_f32_16x16x32_bf16 a[36:39], a[184:187], v[92:95], a[36:39]
ds_read_b128 v[124:127], v239 offset:47104
v_exp_f32 v19, v19
v_mfma_f32_16x16x32_bf16 a[40:43], a[184:187], v[96:99], a[40:43]
v_cvt_pk_bf16_f32 v77, v18, v19
v_mfma_f32_16x16x32_bf16 a[44:47], a[184:187], v[100:103], a[44:47]
v_exp_f32 v20, v20
v_mfma_f32_16x16x32_bf16 v[132:135], a[216:219], v[128:131], v[132:135]
v_mfma_f32_16x16x32_bf16 v[64:67], a[144:147], v[200:203], v[148:151]
ds_read_b64_tr_b16 a[184:185], v222 offset:32768
ds_read_b64_tr_b16 a[186:187], v222 offset:36864
ds_read_b128 v[128:131], v239 offset:47616
v_mfma_f32_16x16x32_bf16 v[64:67], a[148:151], v[204:207], v[64:67]
v_exp_f32 v21, v21
v_mfma_f32_16x16x32_bf16 v[64:67], a[152:155], v[208:211], v[64:67]
ds_read_b128 a[144:147], v216 offset:49152
v_cvt_pk_bf16_f32 v78, v20, v21
v_mfma_f32_16x16x32_bf16 v[132:135], a[220:223], v[248:251], v[132:135]
v_mfma_f32_16x16x32_bf16 v[64:67], a[156:159], v[212:215], v[64:67]
ds_read_b128 v[248:251], v239 offset:48128
v_exp_f32 v22, v22
v_mfma_f32_16x16x32_bf16 a[48:51], a[188:191], v[88:91], a[48:51]
ds_read_b128 a[148:151], v217 offset:49152
ds_read_b128 a[152:155], v218 offset:49152
v_mfma_f32_16x16x32_bf16 a[52:55], a[188:191], v[92:95], a[52:55]
v_exp_f32 v23, v23
s_waitcnt lgkmcnt(8)
v_mfma_f32_16x16x32_bf16 v[132:135], a[224:227], v[252:255], v[132:135]
v_mfma_f32_16x16x32_bf16 a[56:59], a[188:191], v[96:99], a[56:59]
ds_read_b128 a[156:159], v219 offset:49152
ds_read_b128 v[252:255], v239 offset:48640
v_cvt_pk_bf16_f32 v79, v22, v23
v_mfma_f32_16x16x32_bf16 a[60:63], a[188:191], v[100:103], a[60:63]
v_exp_f32 v24, v24
v_smfmac_f32_16x16x64_bf16 a[128:131], a[208:211], v[88:95], v245
v_exp_f32 v25, v25
s_waitcnt lgkmcnt(8)
v_mfma_f32_16x16x32_bf16 v[132:135], a[228:231], v[124:127], v[132:135]
v_mfma_f32_16x16x32_bf16 v[44:47], a[160:163], v[152:155], v[136:139]
ds_read_b64_tr_b16 a[188:189], v223 offset:32768
ds_read_b128 v[124:127], v239 offset:49152
v_cvt_pk_bf16_f32 v80, v24, v25
v_mfma_f32_16x16x32_bf16 v[44:47], a[164:167], v[156:159], v[44:47]
v_exp_f32 v26, v26
v_mfma_f32_16x16x32_bf16 v[44:47], a[168:171], v[160:163], v[44:47]
ds_read_b64_tr_b16 a[190:191], v223 offset:36864
s_add_u32 m0, s30, 81920
s_waitcnt lgkmcnt(8)
v_mfma_f32_16x16x32_bf16 v[132:135], a[232:235], v[128:131], v[132:135]
v_mfma_f32_16x16x32_bf16 v[44:47], a[172:175], v[164:167], v[44:47]
ds_read_b128 v[128:131], v239 offset:49664
v_exp_f32 v27, v27
v_mfma_f32_16x16x32_bf16 a[64:67], a[192:195], v[88:91], a[64:67]
buffer_load_dwordx4 v228, s[8:11], s32 offen offset:0 lds
v_cvt_pk_bf16_f32 v81, v26, v27
v_mfma_f32_16x16x32_bf16 a[68:71], a[192:195], v[92:95], a[68:71]
v_exp_f32 v28, v28
s_waitcnt lgkmcnt(8)
v_mfma_f32_16x16x32_bf16 v[132:135], a[236:239], v[248:251], v[132:135]
v_mfma_f32_16x16x32_bf16 a[72:75], a[192:195], v[96:99], a[72:75]
buffer_load_dwordx4 v229, s[8:11], s32 offen offset:1024 lds
ds_read_b128 v[248:251], v239 offset:50176
v_mfma_f32_16x16x32_bf16 a[76:79], a[192:195], v[100:103], a[76:79]
v_exp_f32 v29, v29
v_mfma_f32_16x16x32_bf16 v[52:55], a[160:163], v[168:171], v[140:143]
ds_read_b64_tr_b16 a[192:193], v224 offset:32768
v_cvt_pk_bf16_f32 v82, v28, v29
s_waitcnt lgkmcnt(6)
v_mfma_f32_16x16x32_bf16 v[132:135], a[240:243], v[252:255], v[132:135]
v_mfma_f32_16x16x32_bf16 v[52:55], a[164:167], v[172:175], v[52:55]
ds_read_b128 v[252:255], v239 offset:50688
v_exp_f32 v30, v30
v_mfma_f32_16x16x32_bf16 v[52:55], a[168:171], v[176:179], v[52:55]
ds_read_b64_tr_b16 a[194:195], v224 offset:36864
v_mfma_f32_16x16x32_bf16 v[52:55], a[172:175], v[180:183], v[52:55]
v_exp_f32 v31, v31
s_waitcnt lgkmcnt(6)
v_mfma_f32_16x16x32_bf16 v[132:135], a[244:247], v[124:127], v[132:135]
v_mfma_f32_16x16x32_bf16 a[80:83], a[196:199], v[88:91], a[80:83]
buffer_load_dwordx4 v230, s[8:11], s32 offen offset:2048 lds
ds_read_b128 v[124:127], v239 offset:51200
v_cvt_pk_bf16_f32 v83, v30, v31
v_mfma_f32_16x16x32_bf16 a[84:87], a[196:199], v[92:95], a[84:87]
v_exp_f32 v32, v32
v_mfma_f32_16x16x32_bf16 a[88:91], a[196:199], v[96:99], a[88:91]
s_waitcnt lgkmcnt(5)
v_mfma_f32_16x16x32_bf16 v[132:135], a[248:251], v[128:131], v[132:135]
v_mfma_f32_16x16x32_bf16 a[92:95], a[196:199], v[100:103], a[92:95]
ds_read_b128 v[128:131], v239 offset:51712
v_exp_f32 v33, v33
v_mfma_f32_16x16x32_bf16 v[60:63], a[160:163], v[184:187], v[144:147]
ds_read_b64_tr_b16 a[196:197], v225 offset:32768
v_cvt_pk_bf16_f32 v84, v32, v33
v_mfma_f32_16x16x32_bf16 v[60:63], a[164:167], v[188:191], v[60:63]
v_exp_f32 v34, v34
s_waitcnt lgkmcnt(6)
v_mfma_f32_16x16x32_bf16 v[132:135], a[252:255], v[248:251], v[132:135]
v_mfma_f32_16x16x32_bf16 v[60:63], a[168:171], v[192:195], v[60:63]
ds_read_b64_tr_b16 a[198:199], v225 offset:36864
ds_read_b128 v[248:251], v239 offset:52224
v_mfma_f32_16x16x32_bf16 v[60:63], a[172:175], v[196:199], v[60:63]
v_exp_f32 v35, v35
v_mfma_f32_16x16x32_bf16 a[96:99], a[200:203], v[88:91], a[96:99]
buffer_load_dwordx4 v231, s[8:11], s32 offen offset:3072 lds
v_cvt_pk_bf16_f32 v85, v34, v35
s_waitcnt lgkmcnt(6)
v_mfma_f32_16x16x32_bf16 v[132:135], a[136:139], v[252:255], v[132:135]
v_mfma_f32_16x16x32_bf16 a[100:103], a[200:203], v[92:95], a[100:103]
ds_read_b128 v[252:255], v239 offset:52736
v_exp_f32 v36, v36
v_mfma_f32_16x16x32_bf16 a[104:107], a[200:203], v[96:99], a[104:107]
v_mfma_f32_16x16x32_bf16 a[108:111], a[200:203], v[100:103], a[108:111]
v_exp_f32 v37, v37
s_waitcnt lgkmcnt(5)
v_mfma_f32_16x16x32_bf16 v[132:135], a[140:143], v[124:127], v[132:135]
v_mfma_f32_16x16x32_bf16 v[68:71], a[160:163], v[200:203], v[148:151]
ds_read_b64_tr_b16 a[200:201], v226 offset:32768
ds_read_b128 v[124:127], v239 offset:53248
v_cvt_pk_bf16_f32 v86, v36, v37
v_mfma_f32_16x16x32_bf16 v[68:71], a[164:167], v[204:207], v[68:71]
v_exp_f32 v38, v38
v_mfma_f32_16x16x32_bf16 v[68:71], a[168:171], v[208:211], v[68:71]
ds_read_b64_tr_b16 a[202:203], v226 offset:36864
ds_read_b128 a[160:163], v216 offset:53248
s_waitcnt lgkmcnt(8)
v_mfma_f32_16x16x32_bf16 v[132:135], v[104:107], v[128:131], v[132:135]
v_mfma_f32_16x16x32_bf16 v[68:71], a[172:175], v[212:215], v[68:71]
ds_read_b128 v[128:131], v239 offset:53760
v_exp_f32 v39, v39
v_mfma_f32_16x16x32_bf16 a[112:115], a[204:207], v[88:91], a[112:115]
ds_read_b128 a[164:167], v217 offset:53248
v_cvt_pk_bf16_f32 v87, v38, v39
v_mfma_f32_16x16x32_bf16 a[116:119], a[204:207], v[92:95], a[116:119]
ds_read_b128 a[168:171], v218 offset:53248
ds_read_b128 a[172:175], v219 offset:53248
s_waitcnt lgkmcnt(8)
v_mfma_f32_16x16x32_bf16 v[132:135], v[108:111], v[248:251], v[132:135]
v_mfma_f32_16x16x32_bf16 a[120:123], a[204:207], v[96:99], a[120:123]
v_mfma_f32_16x16x32_bf16 a[124:127], a[204:207], v[100:103], a[124:127]
ds_read_b64_tr_b16 a[204:205], v227 offset:32768
ds_read_b64_tr_b16 a[206:207], v227 offset:36864
v_mfma_f32_16x16x32_bf16 v[132:135], v[112:115], v[252:255], v[132:135]
v_smfmac_f32_16x16x64_bf16 a[132:135], a[208:211], v[96:103], v245
v_mfma_f32_16x16x32_bf16 v[8:11], a[144:147], v[152:155], v[136:139]
v_exp_f32 v40, v40
s_waitcnt lgkmcnt(8)
v_mfma_f32_16x16x32_bf16 v[132:135], v[116:119], v[124:127], v[132:135]
v_mfma_f32_16x16x32_bf16 v[8:11], a[148:151], v[156:159], v[8:11]
v_exp_f32 v41, v41
v_mfma_f32_16x16x32_bf16 v[8:11], a[152:155], v[160:163], v[8:11]
v_cvt_pk_bf16_f32 v88, v40, v41
s_waitcnt lgkmcnt(5)
v_mfma_f32_16x16x32_bf16 v[132:135], v[120:123], v[128:131], v[132:135]
v_mfma_f32_16x16x32_bf16 v[8:11], a[156:159], v[164:167], v[8:11]
v_exp_f32 v42, v42
v_mfma_f32_16x16x32_bf16 a[0:3], a[176:179], v[72:75], a[0:3]
s_add_u32 s39, s39, 16384
v_mfma_f32_16x16x32_bf16 a[4:7], a[176:179], v[76:79], a[4:7]
v_exp_f32 v43, v43
v_mfma_f32_16x16x32_bf16 a[8:11], a[176:179], v[80:83], a[8:11]
v_cvt_pk_bf16_f32 v89, v42, v43
v_mfma_f32_16x16x32_bf16 a[12:15], a[176:179], v[84:87], a[12:15]
v_exp_f32 v44, v44
v_mfma_f32_16x16x32_bf16 v[16:19], a[144:147], v[168:171], v[140:143]
ds_read_b64_tr_b16 a[176:177], v220 offset:40960
ds_read_b64_tr_b16 a[178:179], v220 offset:45056
v_mfma_f32_16x16x32_bf16 v[16:19], a[148:151], v[172:175], v[16:19]
v_exp_f32 v45, v45
v_mfma_f32_16x16x32_bf16 v[16:19], a[152:155], v[176:179], v[16:19]
v_cvt_pk_bf16_f32 v90, v44, v45
v_cvt_pk_bf16_f32 v104, v132, v133
v_cvt_pk_bf16_f32 v105, v134, v135
v_mfma_f32_16x16x32_bf16 v[16:19], a[156:159], v[180:183], v[16:19]
v_lshlrev_b32 v132, 16, v104
v_exp_f32 v46, v46
v_mfma_f32_16x16x32_bf16 a[16:19], a[180:183], v[72:75], a[16:19]
s_bitset0_b32 s39, 19
v_and_b32 v133, 0xffff0000, v104
v_lshlrev_b32 v134, 16, v105
v_mfma_f32_16x16x32_bf16 a[20:23], a[180:183], v[76:79], a[20:23]
v_and_b32 v135, 0xffff0000, v105
v_exp_f32 v47, v47
v_mfma_f32_16x16x32_bf16 a[24:27], a[180:183], v[80:83], a[24:27]
v_cvt_pk_bf16_f32 v91, v46, v47
v_mul_f32 v104, 0xbfb8aa3b, v132
v_mul_f32 v105, 0xbfb8aa3b, v133
v_mfma_f32_16x16x32_bf16 a[28:31], a[180:183], v[84:87], a[28:31]
v_mul_f32 v106, 0xbfb8aa3b, v134
v_exp_f32 v48, v48
v_mfma_f32_16x16x32_bf16 v[24:27], a[144:147], v[184:187], v[144:147]
ds_read_b64_tr_b16 a[180:181], v221 offset:40960
ds_read_b64_tr_b16 a[182:183], v221 offset:45056
v_mul_f32 v107, 0xbfb8aa3b, v135
v_mfma_f32_16x16x32_bf16 v[24:27], a[148:151], v[188:191], v[24:27]
v_exp_f32 v49, v49
v_mfma_f32_16x16x32_bf16 v[24:27], a[152:155], v[192:195], v[24:27]
v_cvt_pk_bf16_f32 v92, v48, v49
v_exp_f32 v104, v104
v_mfma_f32_16x16x32_bf16 v[24:27], a[156:159], v[196:199], v[24:27]
v_exp_f32 v50, v50
v_mfma_f32_16x16x32_bf16 a[32:35], a[184:187], v[72:75], a[32:35]
s_add_u32 m0, s30, 98304
v_exp_f32 v105, v105
v_mfma_f32_16x16x32_bf16 a[36:39], a[184:187], v[76:79], a[36:39]
v_exp_f32 v51, v51
v_mfma_f32_16x16x32_bf16 a[40:43], a[184:187], v[80:83], a[40:43]
v_cvt_pk_bf16_f32 v93, v50, v51
v_exp_f32 v106, v106
v_mfma_f32_16x16x32_bf16 a[44:47], a[184:187], v[84:87], a[44:47]
v_exp_f32 v52, v52
v_mfma_f32_16x16x32_bf16 v[32:35], a[144:147], v[200:203], v[148:151]
ds_read_b64_tr_b16 a[184:185], v222 offset:40960
ds_read_b64_tr_b16 a[186:187], v222 offset:45056
v_mfma_f32_16x16x32_bf16 v[32:35], a[148:151], v[204:207], v[32:35]
v_exp_f32 v53, v53
v_mfma_f32_16x16x32_bf16 v[32:35], a[152:155], v[208:211], v[32:35]
ds_read_b128 a[144:147], v216 offset:57344
v_cvt_pk_bf16_f32 v94, v52, v53
v_mfma_f32_16x16x32_bf16 v[32:35], a[156:159], v[212:215], v[32:35]
v_exp_f32 v54, v54
v_mfma_f32_16x16x32_bf16 a[48:51], a[188:191], v[72:75], a[48:51]
ds_read_b128 a[148:151], v217 offset:57344
ds_read_b128 a[152:155], v218 offset:57344
v_mfma_f32_16x16x32_bf16 a[52:55], a[188:191], v[76:79], a[52:55]
v_exp_f32 v55, v55
v_mfma_f32_16x16x32_bf16 a[56:59], a[188:191], v[80:83], a[56:59]
ds_read_b128 a[156:159], v219 offset:57344
v_cvt_pk_bf16_f32 v95, v54, v55
v_mfma_f32_16x16x32_bf16 a[60:63], a[188:191], v[84:87], a[60:63]
v_exp_f32 v56, v56
v_smfmac_f32_16x16x64_bf16 a[128:131], a[208:211], v[72:79], v245
v_exp_f32 v57, v57
v_mfma_f32_16x16x32_bf16 v[12:15], a[160:163], v[152:155], v[136:139]
ds_read_b64_tr_b16 a[188:189], v223 offset:40960
v_cvt_pk_bf16_f32 v96, v56, v57
s_waitcnt lgkmcnt(8)
v_mfma_f32_16x16x32_bf16 v[12:15], a[164:167], v[156:159], v[12:15]
v_exp_f32 v58, v58
v_mfma_f32_16x16x32_bf16 v[12:15], a[168:171], v[160:163], v[12:15]
ds_read_b64_tr_b16 a[190:191], v223 offset:45056
buffer_load_dwordx4 v232, s[12:15], s39 offen offset:0 lds
v_mfma_f32_16x16x32_bf16 v[12:15], a[172:175], v[164:167], v[12:15]
v_exp_f32 v59, v59
v_mfma_f32_16x16x32_bf16 a[64:67], a[192:195], v[72:75], a[64:67]
buffer_load_dwordx4 v233, s[12:15], s39 offen offset:1024 lds
v_cvt_pk_bf16_f32 v97, v58, v59
v_mfma_f32_16x16x32_bf16 a[68:71], a[192:195], v[76:79], a[68:71]
v_exp_f32 v60, v60
v_mfma_f32_16x16x32_bf16 a[72:75], a[192:195], v[80:83], a[72:75]
v_exp_f32 v107, v107
v_mfma_f32_16x16x32_bf16 a[76:79], a[192:195], v[84:87], a[76:79]
v_add_f32 v104, 1.0, v104
v_exp_f32 v61, v61
v_mfma_f32_16x16x32_bf16 v[20:23], a[160:163], v[168:171], v[140:143]
ds_read_b64_tr_b16 a[192:193], v224 offset:40960
v_cvt_pk_bf16_f32 v98, v60, v61
v_add_f32 v105, 1.0, v105
v_mfma_f32_16x16x32_bf16 v[20:23], a[164:167], v[172:175], v[20:23]
v_add_f32 v106, 1.0, v106
v_exp_f32 v62, v62
v_mfma_f32_16x16x32_bf16 v[20:23], a[168:171], v[176:179], v[20:23]
ds_read_b64_tr_b16 a[194:195], v224 offset:45056
buffer_load_dwordx4 v232, s[12:15], s39 offen offset:2048 lds
v_add_f32 v107, 1.0, v107
v_mfma_f32_16x16x32_bf16 v[20:23], a[172:175], v[180:183], v[20:23]
v_exp_f32 v63, v63
v_mfma_f32_16x16x32_bf16 a[80:83], a[196:199], v[72:75], a[80:83]
v_cvt_pk_bf16_f32 v99, v62, v63
v_rcp_f32 v104, v104
v_mfma_f32_16x16x32_bf16 a[84:87], a[196:199], v[76:79], a[84:87]
v_exp_f32 v64, v64
v_mfma_f32_16x16x32_bf16 a[88:91], a[196:199], v[80:83], a[88:91]
v_rcp_f32 v105, v105
v_mfma_f32_16x16x32_bf16 a[92:95], a[196:199], v[84:87], a[92:95]
v_exp_f32 v65, v65
v_mfma_f32_16x16x32_bf16 v[28:31], a[160:163], v[184:187], v[144:147]
ds_read_b64_tr_b16 a[196:197], v225 offset:40960
v_cvt_pk_bf16_f32 v100, v64, v65
v_mfma_f32_16x16x32_bf16 v[28:31], a[164:167], v[188:191], v[28:31]
v_exp_f32 v66, v66
v_mfma_f32_16x16x32_bf16 v[28:31], a[168:171], v[192:195], v[28:31]
ds_read_b64_tr_b16 a[198:199], v225 offset:45056
buffer_load_dwordx4 v233, s[12:15], s39 offen offset:3072 lds
v_mfma_f32_16x16x32_bf16 v[28:31], a[172:175], v[196:199], v[28:31]
v_exp_f32 v67, v67
v_mfma_f32_16x16x32_bf16 a[96:99], a[200:203], v[72:75], a[96:99]
v_cvt_pk_bf16_f32 v101, v66, v67
v_rcp_f32 v106, v106
v_mfma_f32_16x16x32_bf16 a[100:103], a[200:203], v[76:79], a[100:103]
v_exp_f32 v68, v68
v_mfma_f32_16x16x32_bf16 a[104:107], a[200:203], v[80:83], a[104:107]
v_rcp_f32 v107, v107
v_mfma_f32_16x16x32_bf16 a[108:111], a[200:203], v[84:87], a[108:111]
v_mul_f32 v104, v132, v104
v_exp_f32 v69, v69
v_mfma_f32_16x16x32_bf16 v[36:39], a[160:163], v[200:203], v[148:151]
ds_read_b64_tr_b16 a[200:201], v226 offset:40960
v_cvt_pk_bf16_f32 v102, v68, v69
v_mul_f32 v105, v133, v105
v_mfma_f32_16x16x32_bf16 v[36:39], a[164:167], v[204:207], v[36:39]
v_mul_f32 v106, v134, v106
v_exp_f32 v70, v70
v_mfma_f32_16x16x32_bf16 v[36:39], a[168:171], v[208:211], v[36:39]
ds_read_b64_tr_b16 a[202:203], v226 offset:45056
ds_read_b128 a[160:163], v216 offset:61440
v_mul_f32 v107, v135, v107
v_mfma_f32_16x16x32_bf16 v[36:39], a[172:175], v[212:215], v[36:39]
v_cvt_pk_bf16_f32 v108, v104, v105
v_exp_f32 v71, v71
v_mfma_f32_16x16x32_bf16 a[112:115], a[204:207], v[72:75], a[112:115]
ds_read_b128 a[164:167], v217 offset:61440
v_cvt_pk_bf16_f32 v103, v70, v71
v_cvt_pk_bf16_f32 v109, v106, v107
v_mfma_f32_16x16x32_bf16 a[116:119], a[204:207], v[76:79], a[116:119]
ds_read_b128 a[168:171], v218 offset:61440
ds_read_b128 a[172:175], v219 offset:61440
v_lshlrev_b32 v104, 16, v108
v_mfma_f32_16x16x32_bf16 a[120:123], a[204:207], v[80:83], a[120:123]
v_and_b32 v105, 0xffff0000, v108
v_lshlrev_b32 v106, 16, v109
v_and_b32 v107, 0xffff0000, v109
v_mfma_f32_16x16x32_bf16 a[124:127], a[204:207], v[84:87], a[124:127]
ds_read_b64_tr_b16 a[204:205], v227 offset:40960
ds_read_b64_tr_b16 a[206:207], v227 offset:45056
v_smfmac_f32_16x16x64_bf16 a[132:135], a[208:211], v[80:87], v245
s_cmp_lt_u32 s37, 2
s_cselect_b64 s[90:91], -1, 0
v_cndmask_b32 v132, v132, v104, s[90:91]
v_cndmask_b32 v133, v133, v105, s[90:91]
v_cndmask_b32 v134, v134, v106, s[90:91]
v_cndmask_b32 v135, v135, v107, s[90:91]
v_add_u32 v237, s31, v244
ds_write_b128 v237, v[132:135] offset:54272
s_waitcnt lgkmcnt(8)
v_mfma_f32_16x16x32_bf16 v[40:43], a[144:147], v[152:155], v[136:139]
v_exp_f32 v8, v8
v_mfma_f32_16x16x32_bf16 v[40:43], a[148:151], v[156:159], v[40:43]
v_exp_f32 v9, v9
v_mfma_f32_16x16x32_bf16 v[40:43], a[152:155], v[160:163], v[40:43]
v_cvt_pk_bf16_f32 v72, v8, v9
v_mfma_f32_16x16x32_bf16 v[40:43], a[156:159], v[164:167], v[40:43]
v_exp_f32 v10, v10
v_mfma_f32_16x16x32_bf16 a[0:3], a[176:179], v[88:91], a[0:3]
v_mfma_f32_16x16x32_bf16 a[4:7], a[176:179], v[92:95], a[4:7]
v_exp_f32 v11, v11
v_mfma_f32_16x16x32_bf16 a[8:11], a[176:179], v[96:99], a[8:11]
v_cvt_pk_bf16_f32 v73, v10, v11
v_mfma_f32_16x16x32_bf16 a[12:15], a[176:179], v[100:103], a[12:15]
s_waitcnt vmcnt(8) lgkmcnt(0)
s_barrier
v_mfma_f32_16x16x32_bf16 v[48:51], a[144:147], v[168:171], v[140:143]
ds_read_b128 v[104:107], v244 offset:54272
v_exp_f32 v12, v12
v_mfma_f32_16x16x32_bf16 v[48:51], a[148:151], v[172:175], v[48:51]
ds_read_b128 v[108:111], v244 offset:55296
v_exp_f32 v13, v13
v_mfma_f32_16x16x32_bf16 v[48:51], a[152:155], v[176:179], v[48:51]
ds_read_b64_tr_b16 a[176:177], v220 offset:49152
ds_read_b128 v[112:115], v244 offset:56320
v_cvt_pk_bf16_f32 v74, v12, v13
v_mfma_f32_16x16x32_bf16 v[48:51], a[156:159], v[180:183], v[48:51]
ds_read_b128 v[116:119], v244 offset:57344
v_exp_f32 v14, v14
v_mfma_f32_16x16x32_bf16 a[16:19], a[180:183], v[88:91], a[16:19]
ds_read_b64_tr_b16 a[178:179], v220 offset:53248
s_add_u32 s32, s32, 16384
ds_read_b64_tr_b16 a[212:213], v242 offset:0
v_mfma_f32_16x16x32_bf16 a[20:23], a[180:183], v[92:95], a[20:23]
ds_read_b64_tr_b16 a[214:215], v242 offset:18432
v_exp_f32 v15, v15
v_mfma_f32_16x16x32_bf16 a[24:27], a[180:183], v[96:99], a[24:27]
ds_read_b64_tr_b16 a[216:217], v242 offset:32
ds_read_b64_tr_b16 a[218:219], v242 offset:18464
v_cvt_pk_bf16_f32 v75, v14, v15
v_mfma_f32_16x16x32_bf16 a[28:31], a[180:183], v[100:103], a[28:31]
ds_read_b64_tr_b16 a[220:221], v242 offset:64
v_exp_f32 v16, v16
v_mfma_f32_16x16x32_bf16 v[56:59], a[144:147], v[184:187], v[144:147]
ds_read_b64_tr_b16 a[180:181], v221 offset:49152
ds_read_b64_tr_b16 a[182:183], v221 offset:53248
ds_read_b64_tr_b16 a[222:223], v242 offset:18496
v_mfma_f32_16x16x32_bf16 v[56:59], a[148:151], v[188:191], v[56:59]
ds_read_b64_tr_b16 a[224:225], v242 offset:96
v_exp_f32 v17, v17
v_mfma_f32_16x16x32_bf16 v[56:59], a[152:155], v[192:195], v[56:59]
s_bitset0_b32 s32, 19
ds_read_b64_tr_b16 a[226:227], v242 offset:18528
v_cvt_pk_bf16_f32 v76, v16, v17
v_mfma_f32_16x16x32_bf16 v[56:59], a[156:159], v[196:199], v[56:59]
ds_read_b64_tr_b16 a[228:229], v242 offset:128
v_exp_f32 v18, v18
v_mfma_f32_16x16x32_bf16 a[32:35], a[184:187], v[88:91], a[32:35]
ds_read_b64_tr_b16 a[230:231], v242 offset:18560
ds_read_b64_tr_b16 a[232:233], v242 offset:160
ds_read_b64_tr_b16 a[234:235], v242 offset:18592
v_mfma_f32_16x16x32_bf16 a[36:39], a[184:187], v[92:95], a[36:39]
ds_read_b64_tr_b16 a[236:237], v242 offset:192
v_exp_f32 v19, v19
v_mfma_f32_16x16x32_bf16 a[40:43], a[184:187], v[96:99], a[40:43]
ds_read_b64_tr_b16 a[238:239], v242 offset:18624
ds_read_b64_tr_b16 a[240:241], v242 offset:224
v_cvt_pk_bf16_f32 v77, v18, v19
v_mfma_f32_16x16x32_bf16 a[44:47], a[184:187], v[100:103], a[44:47]
ds_read_b64_tr_b16 a[242:243], v242 offset:18656
v_exp_f32 v20, v20
v_mfma_f32_16x16x32_bf16 v[64:67], a[144:147], v[200:203], v[148:151]
ds_read_b64_tr_b16 a[184:185], v222 offset:49152
ds_read_b64_tr_b16 a[186:187], v222 offset:53248
ds_read_b64_tr_b16 a[244:245], v242 offset:256
v_mfma_f32_16x16x32_bf16 v[64:67], a[148:151], v[204:207], v[64:67]
ds_read_b64_tr_b16 a[246:247], v242 offset:18688
v_exp_f32 v21, v21
v_mfma_f32_16x16x32_bf16 v[64:67], a[152:155], v[208:211], v[64:67]
ds_read_b128 a[144:147], v216 offset:0
v_cvt_pk_bf16_f32 v78, v20, v21
v_lshl_add_u32 v238, v4, 3, v3
v_mfma_f32_16x16x32_bf16 v[64:67], a[156:159], v[212:215], v[64:67]
v_lshlrev_b32 v238, 4, v238
v_exp_f32 v22, v22
v_mfma_f32_16x16x32_bf16 a[48:51], a[188:191], v[88:91], a[48:51]
ds_read_b128 a[148:151], v217 offset:0
ds_read_b128 a[152:155], v218 offset:0
v_mov_b32 v246, 0x7ffffff0
v_mfma_f32_16x16x32_bf16 a[52:55], a[188:191], v[92:95], a[52:55]
v_cmp_lt_u32 vcc, 7, v3
v_exp_f32 v23, v23
v_mfma_f32_16x16x32_bf16 a[56:59], a[188:191], v[96:99], a[56:59]
ds_read_b128 a[156:159], v219 offset:0
v_cvt_pk_bf16_f32 v79, v22, v23
v_mfma_f32_16x16x32_bf16 a[60:63], a[188:191], v[100:103], a[60:63]
v_cndmask_b32 v238, v238, v246, vcc
v_exp_f32 v24, v24
v_smfmac_f32_16x16x64_bf16 a[128:131], a[208:211], v[88:95], v245
v_exp_f32 v25, v25
v_mfma_f32_16x16x32_bf16 v[44:47], a[160:163], v[152:155], v[136:139]
ds_read_b64_tr_b16 a[188:189], v223 offset:49152
v_cvt_pk_bf16_f32 v80, v24, v25
v_mfma_f32_16x16x32_bf16 v[44:47], a[164:167], v[156:159], v[44:47]
v_exp_f32 v26, v26
v_mfma_f32_16x16x32_bf16 v[44:47], a[168:171], v[160:163], v[44:47]
ds_read_b64_tr_b16 a[190:191], v223 offset:53248
s_add_u32 m0, s30, 114688
v_mfma_f32_16x16x32_bf16 v[44:47], a[172:175], v[164:167], v[44:47]
v_exp_f32 v27, v27
v_mfma_f32_16x16x32_bf16 a[64:67], a[192:195], v[88:91], a[64:67]
buffer_load_dwordx4 v228, s[8:11], s32 offen offset:0 lds
v_cvt_pk_bf16_f32 v81, v26, v27
v_mfma_f32_16x16x32_bf16 a[68:71], a[192:195], v[92:95], a[68:71]
v_exp_f32 v28, v28
v_mfma_f32_16x16x32_bf16 a[72:75], a[192:195], v[96:99], a[72:75]
buffer_load_dwordx4 v229, s[8:11], s32 offen offset:1024 lds
s_mul_i32 s28, s2, 18432
s_mul_i32 s29, s37, 4608
v_mfma_f32_16x16x32_bf16 a[76:79], a[192:195], v[100:103], a[76:79]
v_exp_f32 v29, v29
v_mfma_f32_16x16x32_bf16 v[52:55], a[160:163], v[168:171], v[140:143]
ds_read_b64_tr_b16 a[192:193], v224 offset:49152
v_cvt_pk_bf16_f32 v82, v28, v29
v_mfma_f32_16x16x32_bf16 v[52:55], a[164:167], v[172:175], v[52:55]
v_exp_f32 v30, v30
v_mfma_f32_16x16x32_bf16 v[52:55], a[168:171], v[176:179], v[52:55]
ds_read_b64_tr_b16 a[194:195], v224 offset:53248
s_add_u32 s28, s28, s29
s_add_u32 s28, s28, 0x2000000
v_mfma_f32_16x16x32_bf16 v[52:55], a[172:175], v[180:183], v[52:55]
s_waitcnt lgkmcnt(8)
v_mul_f32 v104, v104, v112
v_exp_f32 v31, v31
v_mfma_f32_16x16x32_bf16 a[80:83], a[196:199], v[88:91], a[80:83]
buffer_load_dwordx4 v230, s[8:11], s32 offen offset:2048 lds
v_cvt_pk_bf16_f32 v83, v30, v31
v_mul_f32 v105, v105, v113
v_mfma_f32_16x16x32_bf16 a[84:87], a[196:199], v[92:95], a[84:87]
v_mul_f32 v106, v106, v114
v_exp_f32 v32, v32
v_mfma_f32_16x16x32_bf16 a[88:91], a[196:199], v[96:99], a[88:91]
v_mul_f32 v107, v107, v115
v_mul_f32 v108, v108, v116
v_mul_f32 v109, v109, v117
v_mfma_f32_16x16x32_bf16 a[92:95], a[196:199], v[100:103], a[92:95]
v_mul_f32 v110, v110, v118
v_exp_f32 v33, v33
v_mfma_f32_16x16x32_bf16 v[60:63], a[160:163], v[184:187], v[144:147]
ds_read_b64_tr_b16 a[196:197], v225 offset:49152
v_cvt_pk_bf16_f32 v84, v32, v33
v_mul_f32 v111, v111, v119
v_mfma_f32_16x16x32_bf16 v[60:63], a[164:167], v[188:191], v[60:63]
v_cvt_pk_bf16_f32 v120, v104, v105
v_exp_f32 v34, v34
v_mfma_f32_16x16x32_bf16 v[60:63], a[168:171], v[192:195], v[60:63]
ds_read_b64_tr_b16 a[198:199], v225 offset:53248
v_cvt_pk_bf16_f32 v121, v106, v107
v_cvt_pk_bf16_f32 v122, v108, v109
v_mfma_f32_16x16x32_bf16 v[60:63], a[172:175], v[196:199], v[60:63]
v_cvt_pk_bf16_f32 v123, v110, v111
v_exp_f32 v35, v35
v_mfma_f32_16x16x32_bf16 a[96:99], a[200:203], v[88:91], a[96:99]
buffer_load_dwordx4 v231, s[8:11], s32 offen offset:3072 lds
v_cvt_pk_bf16_f32 v85, v34, v35
v_mfma_f32_16x16x32_bf16 a[100:103], a[200:203], v[92:95], a[100:103]
v_exp_f32 v36, v36
v_mfma_f32_16x16x32_bf16 a[248:251], a[212:215], v[120:123], 0
v_mfma_f32_16x16x32_bf16 a[104:107], a[200:203], v[96:99], a[104:107]
v_mfma_f32_16x16x32_bf16 a[212:215], a[216:219], v[120:123], 0
v_mfma_f32_16x16x32_bf16 a[108:111], a[200:203], v[100:103], a[108:111]
v_exp_f32 v37, v37
v_mfma_f32_16x16x32_bf16 a[216:219], a[220:223], v[120:123], 0
v_mfma_f32_16x16x32_bf16 v[68:71], a[160:163], v[200:203], v[148:151]
ds_read_b64_tr_b16 a[200:201], v226 offset:49152
v_cvt_pk_bf16_f32 v86, v36, v37
v_mfma_f32_16x16x32_bf16 a[220:223], a[224:227], v[120:123], 0
v_mfma_f32_16x16x32_bf16 v[68:71], a[164:167], v[204:207], v[68:71]
v_exp_f32 v38, v38
v_mfma_f32_16x16x32_bf16 a[224:227], a[228:231], v[120:123], 0
v_mfma_f32_16x16x32_bf16 v[68:71], a[168:171], v[208:211], v[68:71]
ds_read_b64_tr_b16 a[202:203], v226 offset:53248
ds_read_b128 a[160:163], v216 offset:4096
v_mfma_f32_16x16x32_bf16 a[228:231], a[232:235], v[120:123], 0
v_mfma_f32_16x16x32_bf16 v[68:71], a[172:175], v[212:215], v[68:71]
v_exp_f32 v39, v39
v_mfma_f32_16x16x32_bf16 a[232:235], a[236:239], v[120:123], 0
v_mfma_f32_16x16x32_bf16 a[112:115], a[204:207], v[88:91], a[112:115]
ds_read_b128 a[164:167], v217 offset:4096
v_cvt_pk_bf16_f32 v87, v38, v39
v_mfma_f32_16x16x32_bf16 a[236:239], a[240:243], v[120:123], 0
v_mfma_f32_16x16x32_bf16 a[116:119], a[204:207], v[92:95], a[116:119]
ds_read_b128 a[168:171], v218 offset:4096
ds_read_b128 a[172:175], v219 offset:4096
v_mfma_f32_16x16x32_bf16 a[240:243], a[244:247], v[120:123], 0
v_mfma_f32_16x16x32_bf16 a[120:123], a[204:207], v[96:99], a[120:123]
v_mfma_f32_16x16x32_bf16 a[124:127], a[204:207], v[100:103], a[124:127]
ds_read_b64_tr_b16 a[204:205], v227 offset:49152
ds_read_b64_tr_b16 a[206:207], v227 offset:53248
v_smfmac_f32_16x16x64_bf16 a[132:135], a[208:211], v[96:103], v245
s_waitcnt lgkmcnt(8)
v_mfma_f32_16x16x32_bf16 v[8:11], a[144:147], v[152:155], v[136:139]
v_exp_f32 v40, v40
v_mfma_f32_16x16x32_bf16 v[8:11], a[148:151], v[156:159], v[8:11]
v_exp_f32 v41, v41
v_mfma_f32_16x16x32_bf16 v[8:11], a[152:155], v[160:163], v[8:11]
v_cvt_pk_bf16_f32 v88, v40, v41
v_mfma_f32_16x16x32_bf16 v[8:11], a[156:159], v[164:167], v[8:11]
v_exp_f32 v42, v42
v_mfma_f32_16x16x32_bf16 a[0:3], a[176:179], v[72:75], a[0:3]
s_add_u32 s39, s39, 16384
buffer_store_dwordx4 a[248:251], v238, s[20:23], s28 offen offset:0 sc0 sc1
v_mfma_f32_16x16x32_bf16 a[4:7], a[176:179], v[76:79], a[4:7]
v_exp_f32 v43, v43
v_mfma_f32_16x16x32_bf16 a[8:11], a[176:179], v[80:83], a[8:11]
buffer_store_dwordx4 a[212:215], v238, s[20:23], s28 offen offset:512 sc0 sc1
v_cvt_pk_bf16_f32 v89, v42, v43
v_mfma_f32_16x16x32_bf16 a[12:15], a[176:179], v[84:87], a[12:15]
v_exp_f32 v44, v44
v_mfma_f32_16x16x32_bf16 v[16:19], a[144:147], v[168:171], v[140:143]
ds_read_b64_tr_b16 a[176:177], v220 offset:57344
ds_read_b64_tr_b16 a[178:179], v220 offset:61440
buffer_store_dwordx4 a[216:219], v238, s[20:23], s28 offen offset:1024 sc0 sc1
v_mfma_f32_16x16x32_bf16 v[16:19], a[148:151], v[172:175], v[16:19]
v_exp_f32 v45, v45
v_mfma_f32_16x16x32_bf16 v[16:19], a[152:155], v[176:179], v[16:19]
buffer_store_dwordx4 a[220:223], v238, s[20:23], s28 offen offset:1536 sc0 sc1
v_cvt_pk_bf16_f32 v90, v44, v45
v_mfma_f32_16x16x32_bf16 v[16:19], a[156:159], v[180:183], v[16:19]
v_exp_f32 v46, v46
v_mfma_f32_16x16x32_bf16 a[16:19], a[180:183], v[72:75], a[16:19]
s_bitset0_b32 s39, 19
buffer_store_dwordx4 a[224:227], v238, s[20:23], s28 offen offset:2048 sc0 sc1
v_mfma_f32_16x16x32_bf16 a[20:23], a[180:183], v[76:79], a[20:23]
v_exp_f32 v47, v47
v_mfma_f32_16x16x32_bf16 a[24:27], a[180:183], v[80:83], a[24:27]
buffer_store_dwordx4 a[228:231], v238, s[20:23], s28 offen offset:2560 sc0 sc1
v_cvt_pk_bf16_f32 v91, v46, v47
v_mfma_f32_16x16x32_bf16 a[28:31], a[180:183], v[84:87], a[28:31]
v_exp_f32 v48, v48
v_mfma_f32_16x16x32_bf16 v[24:27], a[144:147], v[184:187], v[144:147]
ds_read_b64_tr_b16 a[180:181], v221 offset:57344
ds_read_b64_tr_b16 a[182:183], v221 offset:61440
buffer_store_dwordx4 a[232:235], v238, s[20:23], s28 offen offset:3072 sc0 sc1
v_mfma_f32_16x16x32_bf16 v[24:27], a[148:151], v[188:191], v[24:27]
v_exp_f32 v49, v49
v_mfma_f32_16x16x32_bf16 v[24:27], a[152:155], v[192:195], v[24:27]
buffer_store_dwordx4 a[236:239], v238, s[20:23], s28 offen offset:3584 sc0 sc1
v_cvt_pk_bf16_f32 v92, v48, v49
v_mfma_f32_16x16x32_bf16 v[24:27], a[156:159], v[196:199], v[24:27]
v_exp_f32 v50, v50
v_mfma_f32_16x16x32_bf16 a[32:35], a[184:187], v[72:75], a[32:35]
s_add_u32 m0, s30, 131072
s_add_u32 s28, s28, 4096
buffer_store_dwordx4 a[240:243], v238, s[20:23], s28 offen offset:0 sc0 sc1
v_mfma_f32_16x16x32_bf16 a[36:39], a[184:187], v[76:79], a[36:39]
v_exp_f32 v51, v51
v_mfma_f32_16x16x32_bf16 a[40:43], a[184:187], v[80:83], a[40:43]
v_cvt_pk_bf16_f32 v93, v50, v51
v_mfma_f32_16x16x32_bf16 a[44:47], a[184:187], v[84:87], a[44:47]
v_exp_f32 v52, v52
v_mfma_f32_16x16x32_bf16 v[32:35], a[144:147], v[200:203], v[148:151]
ds_read_b64_tr_b16 a[184:185], v222 offset:57344
ds_read_b64_tr_b16 a[186:187], v222 offset:61440
v_mfma_f32_16x16x32_bf16 v[32:35], a[148:151], v[204:207], v[32:35]
v_exp_f32 v53, v53
v_mfma_f32_16x16x32_bf16 v[32:35], a[152:155], v[208:211], v[32:35]
ds_read_b128 a[144:147], v216 offset:8192
v_cvt_pk_bf16_f32 v94, v52, v53
v_mfma_f32_16x16x32_bf16 v[32:35], a[156:159], v[212:215], v[32:35]
v_exp_f32 v54, v54
v_mfma_f32_16x16x32_bf16 a[48:51], a[188:191], v[72:75], a[48:51]
ds_read_b128 a[148:151], v217 offset:8192
ds_read_b128 a[152:155], v218 offset:8192
v_mfma_f32_16x16x32_bf16 a[52:55], a[188:191], v[76:79], a[52:55]
v_exp_f32 v55, v55
v_mfma_f32_16x16x32_bf16 a[56:59], a[188:191], v[80:83], a[56:59]
ds_read_b128 a[156:159], v219 offset:8192
v_cvt_pk_bf16_f32 v95, v54, v55
v_mfma_f32_16x16x32_bf16 a[60:63], a[188:191], v[84:87], a[60:63]
v_exp_f32 v56, v56
v_smfmac_f32_16x16x64_bf16 a[128:131], a[208:211], v[72:79], v245
v_exp_f32 v57, v57
s_waitcnt lgkmcnt(8)
v_mfma_f32_16x16x32_bf16 v[12:15], a[160:163], v[152:155], v[136:139]
ds_read_b64_tr_b16 a[188:189], v223 offset:57344
v_cvt_pk_bf16_f32 v96, v56, v57
v_mfma_f32_16x16x32_bf16 v[12:15], a[164:167], v[156:159], v[12:15]
v_exp_f32 v58, v58
v_mfma_f32_16x16x32_bf16 v[12:15], a[168:171], v[160:163], v[12:15]
ds_read_b64_tr_b16 a[190:191], v223 offset:61440
buffer_load_dwordx4 v232, s[12:15], s39 offen offset:0 lds
v_mfma_f32_16x16x32_bf16 v[12:15], a[172:175], v[164:167], v[12:15]
v_exp_f32 v59, v59
v_mfma_f32_16x16x32_bf16 a[64:67], a[192:195], v[72:75], a[64:67]
buffer_load_dwordx4 v233, s[12:15], s39 offen offset:1024 lds
v_cvt_pk_bf16_f32 v97, v58, v59
v_mfma_f32_16x16x32_bf16 a[68:71], a[192:195], v[76:79], a[68:71]
v_exp_f32 v60, v60
v_mfma_f32_16x16x32_bf16 a[72:75], a[192:195], v[80:83], a[72:75]
v_mfma_f32_16x16x32_bf16 a[76:79], a[192:195], v[84:87], a[76:79]
v_exp_f32 v61, v61
v_mfma_f32_16x16x32_bf16 v[20:23], a[160:163], v[168:171], v[140:143]
ds_read_b64_tr_b16 a[192:193], v224 offset:57344
v_cvt_pk_bf16_f32 v98, v60, v61
v_mfma_f32_16x16x32_bf16 v[20:23], a[164:167], v[172:175], v[20:23]
v_exp_f32 v62, v62
v_mfma_f32_16x16x32_bf16 v[20:23], a[168:171], v[176:179], v[20:23]
ds_read_b64_tr_b16 a[194:195], v224 offset:61440
buffer_load_dwordx4 v232, s[12:15], s39 offen offset:2048 lds
v_mfma_f32_16x16x32_bf16 v[20:23], a[172:175], v[180:183], v[20:23]
v_exp_f32 v63, v63
v_mfma_f32_16x16x32_bf16 a[80:83], a[196:199], v[72:75], a[80:83]
v_cvt_pk_bf16_f32 v99, v62, v63
v_mfma_f32_16x16x32_bf16 a[84:87], a[196:199], v[76:79], a[84:87]
v_exp_f32 v64, v64
v_mfma_f32_16x16x32_bf16 a[88:91], a[196:199], v[80:83], a[88:91]
v_mfma_f32_16x16x32_bf16 a[92:95], a[196:199], v[84:87], a[92:95]
v_exp_f32 v65, v65
v_mfma_f32_16x16x32_bf16 v[28:31], a[160:163], v[184:187], v[144:147]
ds_read_b64_tr_b16 a[196:197], v225 offset:57344
v_cvt_pk_bf16_f32 v100, v64, v65
v_mfma_f32_16x16x32_bf16 v[28:31], a[164:167], v[188:191], v[28:31]
v_exp_f32 v66, v66
v_mfma_f32_16x16x32_bf16 v[28:31], a[168:171], v[192:195], v[28:31]
ds_read_b64_tr_b16 a[198:199], v225 offset:61440
buffer_load_dwordx4 v233, s[12:15], s39 offen offset:3072 lds
v_mfma_f32_16x16x32_bf16 v[28:31], a[172:175], v[196:199], v[28:31]
v_exp_f32 v67, v67
v_mfma_f32_16x16x32_bf16 a[96:99], a[200:203], v[72:75], a[96:99]
v_cvt_pk_bf16_f32 v101, v66, v67
v_mfma_f32_16x16x32_bf16 a[100:103], a[200:203], v[76:79], a[100:103]
v_exp_f32 v68, v68
v_mfma_f32_16x16x32_bf16 a[104:107], a[200:203], v[80:83], a[104:107]
v_mfma_f32_16x16x32_bf16 a[108:111], a[200:203], v[84:87], a[108:111]
v_exp_f32 v69, v69
v_mfma_f32_16x16x32_bf16 v[36:39], a[160:163], v[200:203], v[148:151]
ds_read_b64_tr_b16 a[200:201], v226 offset:57344
v_cvt_pk_bf16_f32 v102, v68, v69
v_mfma_f32_16x16x32_bf16 v[36:39], a[164:167], v[204:207], v[36:39]
v_exp_f32 v70, v70
v_mfma_f32_16x16x32_bf16 v[36:39], a[168:171], v[208:211], v[36:39]
ds_read_b64_tr_b16 a[202:203], v226 offset:61440
ds_read_b128 a[160:163], v216 offset:12288
v_mfma_f32_16x16x32_bf16 v[36:39], a[172:175], v[212:215], v[36:39]
v_exp_f32 v71, v71
v_mfma_f32_16x16x32_bf16 a[112:115], a[204:207], v[72:75], a[112:115]
ds_read_b128 a[164:167], v217 offset:12288
v_cvt_pk_bf16_f32 v103, v70, v71
v_mfma_f32_16x16x32_bf16 a[116:119], a[204:207], v[76:79], a[116:119]
ds_read_b128 a[168:171], v218 offset:12288
ds_read_b128 a[172:175], v219 offset:12288
v_mfma_f32_16x16x32_bf16 a[120:123], a[204:207], v[80:83], a[120:123]
v_mfma_f32_16x16x32_bf16 a[124:127], a[204:207], v[84:87], a[124:127]
ds_read_b64_tr_b16 a[204:205], v227 offset:57344
ds_read_b64_tr_b16 a[206:207], v227 offset:61440
v_smfmac_f32_16x16x64_bf16 a[132:135], a[208:211], v[80:87], v245
s_mov_b32 s33, 6
K_LOOPIN:
s_waitcnt lgkmcnt(0)
v_lshlrev_b32 v241, 8, v1
s_mov_b32 s46, 0x7ffefff0
.p2align 6
K_LOOP:
s_cmp_eq_u32 s33, s3
s_cbranch_scc1 K_EVT
K_EVT_RET:
s_waitcnt lgkmcnt(8)
v_mfma_f32_16x16x32_bf16 v[40:43], a[144:147], v[152:155], v[136:139]
v_exp_f32 v8, v8
v_mfma_f32_16x16x32_bf16 v[40:43], a[148:151], v[156:159], v[40:43]
v_exp_f32 v9, v9
v_mfma_f32_16x16x32_bf16 v[40:43], a[152:155], v[160:163], v[40:43]
v_cvt_pk_bf16_f32 v72, v8, v9
v_mfma_f32_16x16x32_bf16 v[40:43], a[156:159], v[164:167], v[40:43]
v_exp_f32 v10, v10
v_mfma_f32_16x16x32_bf16 a[0:3], a[176:179], v[88:91], a[0:3]
v_mfma_f32_16x16x32_bf16 a[4:7], a[176:179], v[92:95], a[4:7]
v_exp_f32 v11, v11
v_mfma_f32_16x16x32_bf16 a[8:11], a[176:179], v[96:99], a[8:11]
v_cvt_pk_bf16_f32 v73, v10, v11
v_mfma_f32_16x16x32_bf16 a[12:15], a[176:179], v[100:103], a[12:15]
s_waitcnt vmcnt(9) lgkmcnt(0)
s_barrier
v_mfma_f32_16x16x32_bf16 v[48:51], a[144:147], v[168:171], v[140:143]
v_exp_f32 v12, v12
v_mfma_f32_16x16x32_bf16 v[48:51], a[148:151], v[172:175], v[48:51]
v_exp_f32 v13, v13
v_mfma_f32_16x16x32_bf16 v[48:51], a[152:155], v[176:179], v[48:51]
ds_read_b64_tr_b16 a[176:177], v220 offset:0
v_cvt_pk_bf16_f32 v74, v12, v13
v_mfma_f32_16x16x32_bf16 v[48:51], a[156:159], v[180:183], v[48:51]
v_exp_f32 v14, v14
v_mfma_f32_16x16x32_bf16 a[16:19], a[180:183], v[88:91], a[16:19]
ds_read_b64_tr_b16 a[178:179], v220 offset:4096
s_add_u32 s32, s32, 16384
v_mfma_f32_16x16x32_bf16 a[20:23], a[180:183], v[92:95], a[20:23]
v_exp_f32 v15, v15
v_mfma_f32_16x16x32_bf16 a[24:27], a[180:183], v[96:99], a[24:27]
v_cvt_pk_bf16_f32 v75, v14, v15
v_mfma_f32_16x16x32_bf16 a[28:31], a[180:183], v[100:103], a[28:31]
v_exp_f32 v16, v16
v_mfma_f32_16x16x32_bf16 v[56:59], a[144:147], v[184:187], v[144:147]
ds_read_b64_tr_b16 a[180:181], v221 offset:0
ds_read_b64_tr_b16 a[182:183], v221 offset:4096
v_mfma_f32_16x16x32_bf16 v[56:59], a[148:151], v[188:191], v[56:59]
v_exp_f32 v17, v17
v_mfma_f32_16x16x32_bf16 v[56:59], a[152:155], v[192:195], v[56:59]
s_bitset0_b32 s32, 19
v_cvt_pk_bf16_f32 v76, v16, v17
v_mfma_f32_16x16x32_bf16 v[56:59], a[156:159], v[196:199], v[56:59]
v_exp_f32 v18, v18
v_mfma_f32_16x16x32_bf16 a[32:35], a[184:187], v[88:91], a[32:35]
s_add_u32 m0, s30, 65536
v_mfma_f32_16x16x32_bf16 a[36:39], a[184:187], v[92:95], a[36:39]
v_exp_f32 v19, v19
v_mfma_f32_16x16x32_bf16 a[40:43], a[184:187], v[96:99], a[40:43]
v_cvt_pk_bf16_f32 v77, v18, v19
v_mfma_f32_16x16x32_bf16 a[44:47], a[184:187], v[100:103], a[44:47]
v_exp_f32 v20, v20
v_mfma_f32_16x16x32_bf16 v[64:67], a[144:147], v[200:203], v[148:151]
ds_read_b64_tr_b16 a[184:185], v222 offset:0
ds_read_b64_tr_b16 a[186:187], v222 offset:4096
v_mfma_f32_16x16x32_bf16 v[64:67], a[148:151], v[204:207], v[64:67]
v_exp_f32 v21, v21
v_mfma_f32_16x16x32_bf16 v[64:67], a[152:155], v[208:211], v[64:67]
ds_read_b128 a[144:147], v216 offset:16384
v_cvt_pk_bf16_f32 v78, v20, v21
v_mfma_f32_16x16x32_bf16 v[64:67], a[156:159], v[212:215], v[64:67]
v_exp_f32 v22, v22
v_mfma_f32_16x16x32_bf16 a[48:51], a[188:191], v[88:91], a[48:51]
ds_read_b128 a[148:151], v217 offset:16384
ds_read_b128 a[152:155], v218 offset:16384
v_mfma_f32_16x16x32_bf16 a[52:55], a[188:191], v[92:95], a[52:55]
v_exp_f32 v23, v23
v_mfma_f32_16x16x32_bf16 a[56:59], a[188:191], v[96:99], a[56:59]
ds_read_b128 a[156:159], v219 offset:16384
v_cvt_pk_bf16_f32 v79, v22, v23
v_mfma_f32_16x16x32_bf16 a[60:63], a[188:191], v[100:103], a[60:63]
v_exp_f32 v24, v24
v_smfmac_f32_16x16x64_bf16 a[128:131], a[208:211], v[88:95], v245
v_exp_f32 v25, v25
v_mfma_f32_16x16x32_bf16 v[44:47], a[160:163], v[152:155], v[136:139]
ds_read_b64_tr_b16 a[188:189], v223 offset:0
v_cvt_pk_bf16_f32 v80, v24, v25
v_mfma_f32_16x16x32_bf16 v[44:47], a[164:167], v[156:159], v[44:47]
v_exp_f32 v26, v26
v_mfma_f32_16x16x32_bf16 v[44:47], a[168:171], v[160:163], v[44:47]
ds_read_b64_tr_b16 a[190:191], v223 offset:4096
buffer_load_dwordx4 v228, s[8:11], s32 offen offset:0 lds
v_mfma_f32_16x16x32_bf16 v[44:47], a[172:175], v[164:167], v[44:47]
v_exp_f32 v27, v27
v_mfma_f32_16x16x32_bf16 a[64:67], a[192:195], v[88:91], a[64:67]
buffer_load_dwordx4 v229, s[8:11], s32 offen offset:1024 lds
v_cvt_pk_bf16_f32 v81, v26, v27
v_mfma_f32_16x16x32_bf16 a[68:71], a[192:195], v[92:95], a[68:71]
v_exp_f32 v28, v28
v_mfma_f32_16x16x32_bf16 a[72:75], a[192:195], v[96:99], a[72:75]
buffer_load_dwordx4 v230, s[8:11], s32 offen offset:2048 lds
v_mfma_f32_16x16x32_bf16 a[76:79], a[192:195], v[100:103], a[76:79]
v_exp_f32 v29, v29
v_mfma_f32_16x16x32_bf16 v[52:55], a[160:163], v[168:171], v[140:143]
ds_read_b64_tr_b16 a[192:193], v224 offset:0
v_cvt_pk_bf16_f32 v82, v28, v29
v_mfma_f32_16x16x32_bf16 v[52:55], a[164:167], v[172:175], v[52:55]
v_exp_f32 v30, v30
v_mfma_f32_16x16x32_bf16 v[52:55], a[168:171], v[176:179], v[52:55]
ds_read_b64_tr_b16 a[194:195], v224 offset:4096
buffer_load_dwordx4 v231, s[8:11], s32 offen offset:3072 lds
v_mfma_f32_16x16x32_bf16 v[52:55], a[172:175], v[180:183], v[52:55]
v_exp_f32 v31, v31
v_mfma_f32_16x16x32_bf16 a[80:83], a[196:199], v[88:91], a[80:83]
v_cvt_pk_bf16_f32 v83, v30, v31
v_mfma_f32_16x16x32_bf16 a[84:87], a[196:199], v[92:95], a[84:87]
v_exp_f32 v32, v32
v_mfma_f32_16x16x32_bf16 a[88:91], a[196:199], v[96:99], a[88:91]
v_mfma_f32_16x16x32_bf16 a[92:95], a[196:199], v[100:103], a[92:95]
v_exp_f32 v33, v33
v_mfma_f32_16x16x32_bf16 v[60:63], a[160:163], v[184:187], v[144:147]
ds_read_b64_tr_b16 a[196:197], v225 offset:0
v_cvt_pk_bf16_f32 v84, v32, v33
v_mfma_f32_16x16x32_bf16 v[60:63], a[164:167], v[188:191], v[60:63]
v_exp_f32 v34, v34
v_mfma_f32_16x16x32_bf16 v[60:63], a[168:171], v[192:195], v[60:63]
ds_read_b64_tr_b16 a[198:199], v225 offset:4096
v_mfma_f32_16x16x32_bf16 v[60:63], a[172:175], v[196:199], v[60:63]
v_exp_f32 v35, v35
v_mfma_f32_16x16x32_bf16 a[96:99], a[200:203], v[88:91], a[96:99]
v_cvt_pk_bf16_f32 v85, v34, v35
v_mfma_f32_16x16x32_bf16 a[100:103], a[200:203], v[92:95], a[100:103]
v_exp_f32 v36, v36
v_mfma_f32_16x16x32_bf16 a[104:107], a[200:203], v[96:99], a[104:107]
s_mov_b32 m0, s87
s_lshl2_add_u32 s50, s87, s89
buffer_load_dwordx4 v243, s[56:59], s50 offen  lds
v_mfma_f32_16x16x32_bf16 a[108:111], a[200:203], v[100:103], a[108:111]
v_exp_f32 v37, v37
v_mfma_f32_16x16x32_bf16 v[68:71], a[160:163], v[200:203], v[148:151]
ds_read_b64_tr_b16 a[200:201], v226 offset:0
v_cvt_pk_bf16_f32 v86, v36, v37
v_mfma_f32_16x16x32_bf16 v[68:71], a[164:167], v[204:207], v[68:71]
v_exp_f32 v38, v38
v_mfma_f32_16x16x32_bf16 v[68:71], a[168:171], v[208:211], v[68:71]
ds_read_b64_tr_b16 a[202:203], v226 offset:4096
ds_read_b128 a[160:163], v216 offset:20480
v_mfma_f32_16x16x32_bf16 v[68:71], a[172:175], v[212:215], v[68:71]
v_exp_f32 v39, v39
v_mfma_f32_16x16x32_bf16 a[112:115], a[204:207], v[88:91], a[112:115]
ds_read_b128 a[164:167], v217 offset:20480
v_cvt_pk_bf16_f32 v87, v38, v39
v_mfma_f32_16x16x32_bf16 a[116:119], a[204:207], v[92:95], a[116:119]
ds_read_b128 a[168:171], v218 offset:20480
ds_read_b128 a[172:175], v219 offset:20480
v_mfma_f32_16x16x32_bf16 a[120:123], a[204:207], v[96:99], a[120:123]
s_add_u32 s87, s87, 3456
s_min_u32 s87, s87, 63936
v_mfma_f32_16x16x32_bf16 a[124:127], a[204:207], v[100:103], a[124:127]
ds_read_b64_tr_b16 a[204:205], v227 offset:0
ds_read_b64_tr_b16 a[206:207], v227 offset:4096
v_smfmac_f32_16x16x64_bf16 a[132:135], a[208:211], v[96:103], v245
s_waitcnt lgkmcnt(8)
v_mfma_f32_16x16x32_bf16 v[8:11], a[144:147], v[152:155], v[136:139]
v_exp_f32 v40, v40
v_mfma_f32_16x16x32_bf16 v[8:11], a[148:151], v[156:159], v[8:11]
v_exp_f32 v41, v41
v_mfma_f32_16x16x32_bf16 v[8:11], a[152:155], v[160:163], v[8:11]
v_cvt_pk_bf16_f32 v88, v40, v41
v_mfma_f32_16x16x32_bf16 v[8:11], a[156:159], v[164:167], v[8:11]
v_exp_f32 v42, v42
v_mfma_f32_16x16x32_bf16 a[0:3], a[176:179], v[72:75], a[0:3]
s_add_u32 s39, s39, 16384
v_mfma_f32_16x16x32_bf16 a[4:7], a[176:179], v[76:79], a[4:7]
v_exp_f32 v43, v43
v_mfma_f32_16x16x32_bf16 a[8:11], a[176:179], v[80:83], a[8:11]
v_cvt_pk_bf16_f32 v89, v42, v43
v_mfma_f32_16x16x32_bf16 a[12:15], a[176:179], v[84:87], a[12:15]
v_exp_f32 v44, v44
v_mfma_f32_16x16x32_bf16 v[16:19], a[144:147], v[168:171], v[140:143]
ds_read_b64_tr_b16 a[176:177], v220 offset:8192
ds_read_b64_tr_b16 a[178:179], v220 offset:12288
v_mfma_f32_16x16x32_bf16 v[16:19], a[148:151], v[172:175], v[16:19]
v_exp_f32 v45, v45
v_mfma_f32_16x16x32_bf16 v[16:19], a[152:155], v[176:179], v[16:19]
s_bitset0_b32 s39, 19
v_cvt_pk_bf16_f32 v90, v44, v45
v_mfma_f32_16x16x32_bf16 v[16:19], a[156:159], v[180:183], v[16:19]
v_exp_f32 v46, v46
v_mfma_f32_16x16x32_bf16 a[16:19], a[180:183], v[72:75], a[16:19]
v_mfma_f32_16x16x32_bf16 a[20:23], a[180:183], v[76:79], a[20:23]
v_exp_f32 v47, v47
v_mfma_f32_16x16x32_bf16 a[24:27], a[180:183], v[80:83], a[24:27]
v_cvt_pk_bf16_f32 v91, v46, v47
v_mfma_f32_16x16x32_bf16 a[28:31], a[180:183], v[84:87], a[28:31]
v_exp_f32 v48, v48
v_mfma_f32_16x16x32_bf16 v[24:27], a[144:147], v[184:187], v[144:147]
ds_read_b64_tr_b16 a[180:181], v221 offset:8192
ds_read_b64_tr_b16 a[182:183], v221 offset:12288
v_mfma_f32_16x16x32_bf16 v[24:27], a[148:151], v[188:191], v[24:27]
v_exp_f32 v49, v49
v_mfma_f32_16x16x32_bf16 v[24:27], a[152:155], v[192:195], v[24:27]
s_add_u32 m0, s30, 147456
v_cvt_pk_bf16_f32 v92, v48, v49
v_mfma_f32_16x16x32_bf16 v[24:27], a[156:159], v[196:199], v[24:27]
v_exp_f32 v50, v50
v_mfma_f32_16x16x32_bf16 a[32:35], a[184:187], v[72:75], a[32:35]
v_mfma_f32_16x16x32_bf16 a[36:39], a[184:187], v[76:79], a[36:39]
v_exp_f32 v51, v51
v_mfma_f32_16x16x32_bf16 a[40:43], a[184:187], v[80:83], a[40:43]
v_cvt_pk_bf16_f32 v93, v50, v51
v_mfma_f32_16x16x32_bf16 a[44:47], a[184:187], v[84:87], a[44:47]
v_exp_f32 v52, v52
v_mfma_f32_16x16x32_bf16 v[32:35], a[144:147], v[200:203], v[148:151]
ds_read_b64_tr_b16 a[184:185], v222 offset:8192
ds_read_b64_tr_b16 a[186:187], v222 offset:12288
v_mfma_f32_16x16x32_bf16 v[32:35], a[148:151], v[204:207], v[32:35]
v_exp_f32 v53, v53
v_mfma_f32_16x16x32_bf16 v[32:35], a[152:155], v[208:211], v[32:35]
ds_read_b128 a[144:147], v216 offset:24576
v_cvt_pk_bf16_f32 v94, v52, v53
v_mfma_f32_16x16x32_bf16 v[32:35], a[156:159], v[212:215], v[32:35]
v_exp_f32 v54, v54
v_mfma_f32_16x16x32_bf16 a[48:51], a[188:191], v[72:75], a[48:51]
ds_read_b128 a[148:151], v217 offset:24576
ds_read_b128 a[152:155], v218 offset:24576
v_mfma_f32_16x16x32_bf16 a[52:55], a[188:191], v[76:79], a[52:55]
v_exp_f32 v55, v55
v_mfma_f32_16x16x32_bf16 a[56:59], a[188:191], v[80:83], a[56:59]
ds_read_b128 a[156:159], v219 offset:24576
v_cvt_pk_bf16_f32 v95, v54, v55
v_mfma_f32_16x16x32_bf16 a[60:63], a[188:191], v[84:87], a[60:63]
v_exp_f32 v56, v56
v_smfmac_f32_16x16x64_bf16 a[128:131], a[208:211], v[72:79], v245
v_exp_f32 v57, v57
s_waitcnt lgkmcnt(8)
v_mfma_f32_16x16x32_bf16 v[12:15], a[160:163], v[152:155], v[136:139]
ds_read_b64_tr_b16 a[188:189], v223 offset:8192
v_cvt_pk_bf16_f32 v96, v56, v57
v_mfma_f32_16x16x32_bf16 v[12:15], a[164:167], v[156:159], v[12:15]
v_exp_f32 v58, v58
v_mfma_f32_16x16x32_bf16 v[12:15], a[168:171], v[160:163], v[12:15]
ds_read_b64_tr_b16 a[190:191], v223 offset:12288
buffer_load_dwordx4 v232, s[12:15], s39 offen offset:0 lds
v_mfma_f32_16x16x32_bf16 v[12:15], a[172:175], v[164:167], v[12:15]
v_exp_f32 v59, v59
v_mfma_f32_16x16x32_bf16 a[64:67], a[192:195], v[72:75], a[64:67]
buffer_load_dwordx4 v233, s[12:15], s39 offen offset:1024 lds
v_cvt_pk_bf16_f32 v97, v58, v59
v_mfma_f32_16x16x32_bf16 a[68:71], a[192:195], v[76:79], a[68:71]
v_exp_f32 v60, v60
v_mfma_f32_16x16x32_bf16 a[72:75], a[192:195], v[80:83], a[72:75]
buffer_load_dwordx4 v232, s[12:15], s39 offen offset:2048 lds
v_mfma_f32_16x16x32_bf16 a[76:79], a[192:195], v[84:87], a[76:79]
v_exp_f32 v61, v61
v_mfma_f32_16x16x32_bf16 v[20:23], a[160:163], v[168:171], v[140:143]
ds_read_b64_tr_b16 a[192:193], v224 offset:8192
v_cvt_pk_bf16_f32 v98, v60, v61
v_mfma_f32_16x16x32_bf16 v[20:23], a[164:167], v[172:175], v[20:23]
v_exp_f32 v62, v62
v_mfma_f32_16x16x32_bf16 v[20:23], a[168:171], v[176:179], v[20:23]
ds_read_b64_tr_b16 a[194:195], v224 offset:12288
v_mfma_f32_16x16x32_bf16 v[20:23], a[172:175], v[180:183], v[20:23]
v_exp_f32 v63, v63
v_mfma_f32_16x16x32_bf16 a[80:83], a[196:199], v[72:75], a[80:83]
buffer_load_dwordx4 v233, s[12:15], s39 offen offset:3072 lds
v_cvt_pk_bf16_f32 v99, v62, v63
v_mfma_f32_16x16x32_bf16 a[84:87], a[196:199], v[76:79], a[84:87]
v_exp_f32 v64, v64
v_mfma_f32_16x16x32_bf16 a[88:91], a[196:199], v[80:83], a[88:91]
v_mfma_f32_16x16x32_bf16 a[92:95], a[196:199], v[84:87], a[92:95]
v_exp_f32 v65, v65
v_mfma_f32_16x16x32_bf16 v[28:31], a[160:163], v[184:187], v[144:147]
ds_read_b64_tr_b16 a[196:197], v225 offset:8192
v_cvt_pk_bf16_f32 v100, v64, v65
v_mfma_f32_16x16x32_bf16 v[28:31], a[164:167], v[188:191], v[28:31]
v_exp_f32 v66, v66
v_mfma_f32_16x16x32_bf16 v[28:31], a[168:171], v[192:195], v[28:31]
ds_read_b64_tr_b16 a[198:199], v225 offset:12288
v_mfma_f32_16x16x32_bf16 v[28:31], a[172:175], v[196:199], v[28:31]
v_exp_f32 v67, v67
v_mfma_f32_16x16x32_bf16 a[96:99], a[200:203], v[72:75], a[96:99]
buffer_load_dword v242, v241, s[20:23], s46 offen offset:0 sc1
v_cvt_pk_bf16_f32 v101, v66, v67
v_mfma_f32_16x16x32_bf16 a[100:103], a[200:203], v[76:79], a[100:103]
v_exp_f32 v68, v68
v_mfma_f32_16x16x32_bf16 a[104:107], a[200:203], v[80:83], a[104:107]
v_mfma_f32_16x16x32_bf16 a[108:111], a[200:203], v[84:87], a[108:111]
v_exp_f32 v69, v69
v_mfma_f32_16x16x32_bf16 v[36:39], a[160:163], v[200:203], v[148:151]
ds_read_b64_tr_b16 a[200:201], v226 offset:8192
v_cvt_pk_bf16_f32 v102, v68, v69
v_mfma_f32_16x16x32_bf16 v[36:39], a[164:167], v[204:207], v[36:39]
v_exp_f32 v70, v70
v_mfma_f32_16x16x32_bf16 v[36:39], a[168:171], v[208:211], v[36:39]
ds_read_b64_tr_b16 a[202:203], v226 offset:12288
ds_read_b128 a[160:163], v216 offset:28672
v_mfma_f32_16x16x32_bf16 v[36:39], a[172:175], v[212:215], v[36:39]
v_exp_f32 v71, v71
v_mfma_f32_16x16x32_bf16 a[112:115], a[204:207], v[72:75], a[112:115]
ds_read_b128 a[164:167], v217 offset:28672
v_cvt_pk_bf16_f32 v103, v70, v71
v_mfma_f32_16x16x32_bf16 a[116:119], a[204:207], v[76:79], a[116:119]
ds_read_b128 a[168:171], v218 offset:28672
ds_read_b128 a[172:175], v219 offset:28672
v_mfma_f32_16x16x32_bf16 a[120:123], a[204:207], v[80:83], a[120:123]
v_mfma_f32_16x16x32_bf16 a[124:127], a[204:207], v[84:87], a[124:127]
ds_read_b64_tr_b16 a[204:205], v227 offset:8192
ds_read_b64_tr_b16 a[206:207], v227 offset:12288
v_smfmac_f32_16x16x64_bf16 a[132:135], a[208:211], v[80:87], v245
s_waitcnt lgkmcnt(8)
v_mfma_f32_16x16x32_bf16 v[40:43], a[144:147], v[152:155], v[136:139]
v_exp_f32 v8, v8
v_mfma_f32_16x16x32_bf16 v[40:43], a[148:151], v[156:159], v[40:43]
v_exp_f32 v9, v9
v_mfma_f32_16x16x32_bf16 v[40:43], a[152:155], v[160:163], v[40:43]
v_cvt_pk_bf16_f32 v72, v8, v9
v_mfma_f32_16x16x32_bf16 v[40:43], a[156:159], v[164:167], v[40:43]
v_exp_f32 v10, v10
v_mfma_f32_16x16x32_bf16 a[0:3], a[176:179], v[88:91], a[0:3]
v_mfma_f32_16x16x32_bf16 a[4:7], a[176:179], v[92:95], a[4:7]
v_exp_f32 v11, v11
v_mfma_f32_16x16x32_bf16 a[8:11], a[176:179], v[96:99], a[8:11]
v_cvt_pk_bf16_f32 v73, v10, v11
v_mfma_f32_16x16x32_bf16 a[12:15], a[176:179], v[100:103], a[12:15]
s_waitcnt vmcnt(10) lgkmcnt(0)
s_barrier
v_mfma_f32_16x16x32_bf16 v[48:51], a[144:147], v[168:171], v[140:143]
v_exp_f32 v12, v12
v_mfma_f32_16x16x32_bf16 v[48:51], a[148:151], v[172:175], v[48:51]
v_exp_f32 v13, v13
v_mfma_f32_16x16x32_bf16 v[48:51], a[152:155], v[176:179], v[48:51]
ds_read_b64_tr_b16 a[176:177], v220 offset:32768
v_cvt_pk_bf16_f32 v74, v12, v13
v_mfma_f32_16x16x32_bf16 v[48:51], a[156:159], v[180:183], v[48:51]
v_exp_f32 v14, v14
v_mfma_f32_16x16x32_bf16 a[16:19], a[180:183], v[88:91], a[16:19]
ds_read_b64_tr_b16 a[178:179], v220 offset:36864
s_add_u32 s32, s32, 16384
v_mfma_f32_16x16x32_bf16 a[20:23], a[180:183], v[92:95], a[20:23]
v_exp_f32 v15, v15
v_mfma_f32_16x16x32_bf16 a[24:27], a[180:183], v[96:99], a[24:27]
v_cvt_pk_bf16_f32 v75, v14, v15
v_mfma_f32_16x16x32_bf16 a[28:31], a[180:183], v[100:103], a[28:31]
v_exp_f32 v16, v16
v_mfma_f32_16x16x32_bf16 v[56:59], a[144:147], v[184:187], v[144:147]
ds_read_b64_tr_b16 a[180:181], v221 offset:32768
ds_read_b64_tr_b16 a[182:183], v221 offset:36864
v_mfma_f32_16x16x32_bf16 v[56:59], a[148:151], v[188:191], v[56:59]
v_exp_f32 v17, v17
v_mfma_f32_16x16x32_bf16 v[56:59], a[152:155], v[192:195], v[56:59]
s_bitset0_b32 s32, 19
v_cvt_pk_bf16_f32 v76, v16, v17
v_mfma_f32_16x16x32_bf16 v[56:59], a[156:159], v[196:199], v[56:59]
v_exp_f32 v18, v18
v_mfma_f32_16x16x32_bf16 a[32:35], a[184:187], v[88:91], a[32:35]
s_add_u32 m0, s30, 81920
v_mfma_f32_16x16x32_bf16 a[36:39], a[184:187], v[92:95], a[36:39]
v_exp_f32 v19, v19
v_mfma_f32_16x16x32_bf16 a[40:43], a[184:187], v[96:99], a[40:43]
v_cvt_pk_bf16_f32 v77, v18, v19
v_mfma_f32_16x16x32_bf16 a[44:47], a[184:187], v[100:103], a[44:47]
v_exp_f32 v20, v20
v_mfma_f32_16x16x32_bf16 v[64:67], a[144:147], v[200:203], v[148:151]
ds_read_b64_tr_b16 a[184:185], v222 offset:32768
ds_read_b64_tr_b16 a[186:187], v222 offset:36864
v_mfma_f32_16x16x32_bf16 v[64:67], a[148:151], v[204:207], v[64:67]
v_exp_f32 v21, v21
v_mfma_f32_16x16x32_bf16 v[64:67], a[152:155], v[208:211], v[64:67]
ds_read_b128 a[144:147], v216 offset:49152
v_cvt_pk_bf16_f32 v78, v20, v21
v_mfma_f32_16x16x32_bf16 v[64:67], a[156:159], v[212:215], v[64:67]
v_exp_f32 v22, v22
v_mfma_f32_16x16x32_bf16 a[48:51], a[188:191], v[88:91], a[48:51]
ds_read_b128 a[148:151], v217 offset:49152
ds_read_b128 a[152:155], v218 offset:49152
v_mfma_f32_16x16x32_bf16 a[52:55], a[188:191], v[92:95], a[52:55]
v_exp_f32 v23, v23
v_mfma_f32_16x16x32_bf16 a[56:59], a[188:191], v[96:99], a[56:59]
ds_read_b128 a[156:159], v219 offset:49152
v_cvt_pk_bf16_f32 v79, v22, v23
v_mfma_f32_16x16x32_bf16 a[60:63], a[188:191], v[100:103], a[60:63]
v_exp_f32 v24, v24
v_smfmac_f32_16x16x64_bf16 a[128:131], a[208:211], v[88:95], v245
v_exp_f32 v25, v25
v_mfma_f32_16x16x32_bf16 v[44:47], a[160:163], v[152:155], v[136:139]
ds_read_b64_tr_b16 a[188:189], v223 offset:32768
v_cvt_pk_bf16_f32 v80, v24, v25
v_mfma_f32_16x16x32_bf16 v[44:47], a[164:167], v[156:159], v[44:47]
v_exp_f32 v26, v26
v_mfma_f32_16x16x32_bf16 v[44:47], a[168:171], v[160:163], v[44:47]
ds_read_b64_tr_b16 a[190:191], v223 offset:36864
buffer_load_dwordx4 v228, s[8:11], s32 offen offset:0 lds
v_mfma_f32_16x16x32_bf16 v[44:47], a[172:175], v[164:167], v[44:47]
v_exp_f32 v27, v27
v_mfma_f32_16x16x32_bf16 a[64:67], a[192:195], v[88:91], a[64:67]
buffer_load_dwordx4 v229, s[8:11], s32 offen offset:1024 lds
v_cvt_pk_bf16_f32 v81, v26, v27
v_mfma_f32_16x16x32_bf16 a[68:71], a[192:195], v[92:95], a[68:71]
v_exp_f32 v28, v28
v_mfma_f32_16x16x32_bf16 a[72:75], a[192:195], v[96:99], a[72:75]
buffer_load_dwordx4 v230, s[8:11], s32 offen offset:2048 lds
v_mfma_f32_16x16x32_bf16 a[76:79], a[192:195], v[100:103], a[76:79]
v_exp_f32 v29, v29
v_mfma_f32_16x16x32_bf16 v[52:55], a[160:163], v[168:171], v[140:143]
ds_read_b64_tr_b16 a[192:193], v224 offset:32768
v_cvt_pk_bf16_f32 v82, v28, v29
v_mfma_f32_16x16x32_bf16 v[52:55], a[164:167], v[172:175], v[52:55]
v_exp_f32 v30, v30
v_mfma_f32_16x16x32_bf16 v[52:55], a[168:171], v[176:179], v[52:55]
ds_read_b64_tr_b16 a[194:195], v224 offset:36864
buffer_load_dwordx4 v231, s[8:11], s32 offen offset:3072 lds
v_mfma_f32_16x16x32_bf16 v[52:55], a[172:175], v[180:183], v[52:55]
v_exp_f32 v31, v31
v_mfma_f32_16x16x32_bf16 a[80:83], a[196:199], v[88:91], a[80:83]
v_cvt_pk_bf16_f32 v83, v30, v31
v_mfma_f32_16x16x32_bf16 a[84:87], a[196:199], v[92:95], a[84:87]
v_exp_f32 v32, v32
v_mfma_f32_16x16x32_bf16 a[88:91], a[196:199], v[96:99], a[88:91]
v_mfma_f32_16x16x32_bf16 a[92:95], a[196:199], v[100:103], a[92:95]
v_exp_f32 v33, v33
v_mfma_f32_16x16x32_bf16 v[60:63], a[160:163], v[184:187], v[144:147]
ds_read_b64_tr_b16 a[196:197], v225 offset:32768
v_cvt_pk_bf16_f32 v84, v32, v33
v_mfma_f32_16x16x32_bf16 v[60:63], a[164:167], v[188:191], v[60:63]
v_exp_f32 v34, v34
v_mfma_f32_16x16x32_bf16 v[60:63], a[168:171], v[192:195], v[60:63]
ds_read_b64_tr_b16 a[198:199], v225 offset:36864
v_mfma_f32_16x16x32_bf16 v[60:63], a[172:175], v[196:199], v[60:63]
v_exp_f32 v35, v35
v_mfma_f32_16x16x32_bf16 a[96:99], a[200:203], v[88:91], a[96:99]
v_cvt_pk_bf16_f32 v85, v34, v35
v_mfma_f32_16x16x32_bf16 a[100:103], a[200:203], v[92:95], a[100:103]
v_exp_f32 v36, v36
v_mfma_f32_16x16x32_bf16 a[104:107], a[200:203], v[96:99], a[104:107]
s_mov_b32 m0, s87
s_lshl2_add_u32 s50, s87, s89
buffer_load_dwordx4 v243, s[56:59], s50 offen  lds
v_mfma_f32_16x16x32_bf16 a[108:111], a[200:203], v[100:103], a[108:111]
v_exp_f32 v37, v37
v_mfma_f32_16x16x32_bf16 v[68:71], a[160:163], v[200:203], v[148:151]
ds_read_b64_tr_b16 a[200:201], v226 offset:32768
v_cvt_pk_bf16_f32 v86, v36, v37
v_mfma_f32_16x16x32_bf16 v[68:71], a[164:167], v[204:207], v[68:71]
v_exp_f32 v38, v38
v_mfma_f32_16x16x32_bf16 v[68:71], a[168:171], v[208:211], v[68:71]
ds_read_b64_tr_b16 a[202:203], v226 offset:36864
ds_read_b128 a[160:163], v216 offset:53248
v_mfma_f32_16x16x32_bf16 v[68:71], a[172:175], v[212:215], v[68:71]
v_exp_f32 v39, v39
v_mfma_f32_16x16x32_bf16 a[112:115], a[204:207], v[88:91], a[112:115]
ds_read_b128 a[164:167], v217 offset:53248
v_cvt_pk_bf16_f32 v87, v38, v39
v_mfma_f32_16x16x32_bf16 a[116:119], a[204:207], v[92:95], a[116:119]
ds_read_b128 a[168:171], v218 offset:53248
ds_read_b128 a[172:175], v219 offset:53248
v_mfma_f32_16x16x32_bf16 a[120:123], a[204:207], v[96:99], a[120:123]
s_add_u32 s87, s87, 3456
s_min_u32 s87, s87, 63936
v_mfma_f32_16x16x32_bf16 a[124:127], a[204:207], v[100:103], a[124:127]
ds_read_b64_tr_b16 a[204:205], v227 offset:32768
ds_read_b64_tr_b16 a[206:207], v227 offset:36864
v_smfmac_f32_16x16x64_bf16 a[132:135], a[208:211], v[96:103], v245
s_waitcnt lgkmcnt(8)
v_mfma_f32_16x16x32_bf16 v[8:11], a[144:147], v[152:155], v[136:139]
v_exp_f32 v40, v40
v_mfma_f32_16x16x32_bf16 v[8:11], a[148:151], v[156:159], v[8:11]
v_exp_f32 v41, v41
v_mfma_f32_16x16x32_bf16 v[8:11], a[152:155], v[160:163], v[8:11]
v_cvt_pk_bf16_f32 v88, v40, v41
v_mfma_f32_16x16x32_bf16 v[8:11], a[156:159], v[164:167], v[8:11]
v_exp_f32 v42, v42
v_mfma_f32_16x16x32_bf16 a[0:3], a[176:179], v[72:75], a[0:3]
s_add_u32 s39, s39, 16384
v_mfma_f32_16x16x32_bf16 a[4:7], a[176:179], v[76:79], a[4:7]
v_exp_f32 v43, v43
v_mfma_f32_16x16x32_bf16 a[8:11], a[176:179], v[80:83], a[8:11]
v_cvt_pk_bf16_f32 v89, v42, v43
v_mfma_f32_16x16x32_bf16 a[12:15], a[176:179], v[84:87], a[12:15]
v_exp_f32 v44, v44
v_mfma_f32_16x16x32_bf16 v[16:19], a[144:147], v[168:171], v[140:143]
ds_read_b64_tr_b16 a[176:177], v220 offset:40960
ds_read_b64_tr_b16 a[178:179], v220 offset:45056
v_mfma_f32_16x16x32_bf16 v[16:19], a[148:151], v[172:175], v[16:19]
v_exp_f32 v45, v45
v_mfma_f32_16x16x32_bf16 v[16:19], a[152:155], v[176:179], v[16:19]
s_bitset0_b32 s39, 19
v_cvt_pk_bf16_f32 v90, v44, v45
v_mfma_f32_16x16x32_bf16 v[16:19], a[156:159], v[180:183], v[16:19]
v_exp_f32 v46, v46
v_mfma_f32_16x16x32_bf16 a[16:19], a[180:183], v[72:75], a[16:19]
v_mfma_f32_16x16x32_bf16 a[20:23], a[180:183], v[76:79], a[20:23]
v_exp_f32 v47, v47
v_mfma_f32_16x16x32_bf16 a[24:27], a[180:183], v[80:83], a[24:27]
v_cvt_pk_bf16_f32 v91, v46, v47
v_mfma_f32_16x16x32_bf16 a[28:31], a[180:183], v[84:87], a[28:31]
v_exp_f32 v48, v48
v_mfma_f32_16x16x32_bf16 v[24:27], a[144:147], v[184:187], v[144:147]
ds_read_b64_tr_b16 a[180:181], v221 offset:40960
ds_read_b64_tr_b16 a[182:183], v221 offset:45056
v_mfma_f32_16x16x32_bf16 v[24:27], a[148:151], v[188:191], v[24:27]
v_exp_f32 v49, v49
v_mfma_f32_16x16x32_bf16 v[24:27], a[152:155], v[192:195], v[24:27]
s_add_u32 m0, s30, 98304
v_cvt_pk_bf16_f32 v92, v48, v49
v_mfma_f32_16x16x32_bf16 v[24:27], a[156:159], v[196:199], v[24:27]
v_exp_f32 v50, v50
v_mfma_f32_16x16x32_bf16 a[32:35], a[184:187], v[72:75], a[32:35]
v_mfma_f32_16x16x32_bf16 a[36:39], a[184:187], v[76:79], a[36:39]
v_exp_f32 v51, v51
v_mfma_f32_16x16x32_bf16 a[40:43], a[184:187], v[80:83], a[40:43]
v_cvt_pk_bf16_f32 v93, v50, v51
v_mfma_f32_16x16x32_bf16 a[44:47], a[184:187], v[84:87], a[44:47]
v_exp_f32 v52, v52
v_mfma_f32_16x16x32_bf16 v[32:35], a[144:147], v[200:203], v[148:151]
ds_read_b64_tr_b16 a[184:185], v222 offset:40960
ds_read_b64_tr_b16 a[186:187], v222 offset:45056
v_mfma_f32_16x16x32_bf16 v[32:35], a[148:151], v[204:207], v[32:35]
v_exp_f32 v53, v53
v_mfma_f32_16x16x32_bf16 v[32:35], a[152:155], v[208:211], v[32:35]
ds_read_b128 a[144:147], v216 offset:57344
v_cvt_pk_bf16_f32 v94, v52, v53
v_mfma_f32_16x16x32_bf16 v[32:35], a[156:159], v[212:215], v[32:35]
v_exp_f32 v54, v54
v_mfma_f32_16x16x32_bf16 a[48:51], a[188:191], v[72:75], a[48:51]
ds_read_b128 a[148:151], v217 offset:57344
ds_read_b128 a[152:155], v218 offset:57344
v_mfma_f32_16x16x32_bf16 a[52:55], a[188:191], v[76:79], a[52:55]
v_exp_f32 v55, v55
v_mfma_f32_16x16x32_bf16 a[56:59], a[188:191], v[80:83], a[56:59]
ds_read_b128 a[156:159], v219 offset:57344
v_cvt_pk_bf16_f32 v95, v54, v55
v_mfma_f32_16x16x32_bf16 a[60:63], a[188:191], v[84:87], a[60:63]
v_exp_f32 v56, v56
v_smfmac_f32_16x16x64_bf16 a[128:131], a[208:211], v[72:79], v245
v_exp_f32 v57, v57
s_waitcnt lgkmcnt(8)
v_mfma_f32_16x16x32_bf16 v[12:15], a[160:163], v[152:155], v[136:139]
ds_read_b64_tr_b16 a[188:189], v223 offset:40960
v_cvt_pk_bf16_f32 v96, v56, v57
v_mfma_f32_16x16x32_bf16 v[12:15], a[164:167], v[156:159], v[12:15]
v_exp_f32 v58, v58
v_mfma_f32_16x16x32_bf16 v[12:15], a[168:171], v[160:163], v[12:15]
ds_read_b64_tr_b16 a[190:191], v223 offset:45056
buffer_load_dwordx4 v232, s[12:15], s39 offen offset:0 lds
v_mfma_f32_16x16x32_bf16 v[12:15], a[172:175], v[164:167], v[12:15]
v_exp_f32 v59, v59
v_mfma_f32_16x16x32_bf16 a[64:67], a[192:195], v[72:75], a[64:67]
buffer_load_dwordx4 v233, s[12:15], s39 offen offset:1024 lds
v_cvt_pk_bf16_f32 v97, v58, v59
v_mfma_f32_16x16x32_bf16 a[68:71], a[192:195], v[76:79], a[68:71]
v_exp_f32 v60, v60
v_mfma_f32_16x16x32_bf16 a[72:75], a[192:195], v[80:83], a[72:75]
buffer_load_dwordx4 v232, s[12:15], s39 offen offset:2048 lds
v_mfma_f32_16x16x32_bf16 a[76:79], a[192:195], v[84:87], a[76:79]
v_exp_f32 v61, v61
v_mfma_f32_16x16x32_bf16 v[20:23], a[160:163], v[168:171], v[140:143]
ds_read_b64_tr_b16 a[192:193], v224 offset:40960
v_cvt_pk_bf16_f32 v98, v60, v61
v_mfma_f32_16x16x32_bf16 v[20:23], a[164:167], v[172:175], v[20:23]
v_exp_f32 v62, v62
v_mfma_f32_16x16x32_bf16 v[20:23], a[168:171], v[176:179], v[20:23]
ds_read_b64_tr_b16 a[194:195], v224 offset:45056
v_mfma_f32_16x16x32_bf16 v[20:23], a[172:175], v[180:183], v[20:23]
v_exp_f32 v63, v63
v_mfma_f32_16x16x32_bf16 a[80:83], a[196:199], v[72:75], a[80:83]
buffer_load_dwordx4 v233, s[12:15], s39 offen offset:3072 lds
v_cvt_pk_bf16_f32 v99, v62, v63
v_mfma_f32_16x16x32_bf16 a[84:87], a[196:199], v[76:79], a[84:87]
v_exp_f32 v64, v64
v_mfma_f32_16x16x32_bf16 a[88:91], a[196:199], v[80:83], a[88:91]
v_mfma_f32_16x16x32_bf16 a[92:95], a[196:199], v[84:87], a[92:95]
v_exp_f32 v65, v65
v_mfma_f32_16x16x32_bf16 v[28:31], a[160:163], v[184:187], v[144:147]
ds_read_b64_tr_b16 a[196:197], v225 offset:40960
v_cvt_pk_bf16_f32 v100, v64, v65
v_mfma_f32_16x16x32_bf16 v[28:31], a[164:167], v[188:191], v[28:31]
v_exp_f32 v66, v66
v_mfma_f32_16x16x32_bf16 v[28:31], a[168:171], v[192:195], v[28:31]
ds_read_b64_tr_b16 a[198:199], v225 offset:45056
v_mfma_f32_16x16x32_bf16 v[28:31], a[172:175], v[196:199], v[28:31]
v_exp_f32 v67, v67
v_mfma_f32_16x16x32_bf16 a[96:99], a[200:203], v[72:75], a[96:99]
buffer_load_dword v242, v241, s[20:23], s46 offen offset:128 sc1
v_cvt_pk_bf16_f32 v101, v66, v67
v_mfma_f32_16x16x32_bf16 a[100:103], a[200:203], v[76:79], a[100:103]
v_exp_f32 v68, v68
v_mfma_f32_16x16x32_bf16 a[104:107], a[200:203], v[80:83], a[104:107]
v_mfma_f32_16x16x32_bf16 a[108:111], a[200:203], v[84:87], a[108:111]
v_exp_f32 v69, v69
v_mfma_f32_16x16x32_bf16 v[36:39], a[160:163], v[200:203], v[148:151]
ds_read_b64_tr_b16 a[200:201], v226 offset:40960
v_cvt_pk_bf16_f32 v102, v68, v69
v_mfma_f32_16x16x32_bf16 v[36:39], a[164:167], v[204:207], v[36:39]
v_exp_f32 v70, v70
v_mfma_f32_16x16x32_bf16 v[36:39], a[168:171], v[208:211], v[36:39]
ds_read_b64_tr_b16 a[202:203], v226 offset:45056
ds_read_b128 a[160:163], v216 offset:61440
v_mfma_f32_16x16x32_bf16 v[36:39], a[172:175], v[212:215], v[36:39]
v_exp_f32 v71, v71
v_mfma_f32_16x16x32_bf16 a[112:115], a[204:207], v[72:75], a[112:115]
ds_read_b128 a[164:167], v217 offset:61440
v_cvt_pk_bf16_f32 v103, v70, v71
v_mfma_f32_16x16x32_bf16 a[116:119], a[204:207], v[76:79], a[116:119]
ds_read_b128 a[168:171], v218 offset:61440
ds_read_b128 a[172:175], v219 offset:61440
v_mfma_f32_16x16x32_bf16 a[120:123], a[204:207], v[80:83], a[120:123]
v_mfma_f32_16x16x32_bf16 a[124:127], a[204:207], v[84:87], a[124:127]
ds_read_b64_tr_b16 a[204:205], v227 offset:40960
ds_read_b64_tr_b16 a[206:207], v227 offset:45056
v_smfmac_f32_16x16x64_bf16 a[132:135], a[208:211], v[80:87], v245
s_waitcnt lgkmcnt(8)
v_mfma_f32_16x16x32_bf16 v[40:43], a[144:147], v[152:155], v[136:139]
v_exp_f32 v8, v8
v_mfma_f32_16x16x32_bf16 v[40:43], a[148:151], v[156:159], v[40:43]
v_exp_f32 v9, v9
v_mfma_f32_16x16x32_bf16 v[40:43], a[152:155], v[160:163], v[40:43]
v_cvt_pk_bf16_f32 v72, v8, v9
v_mfma_f32_16x16x32_bf16 v[40:43], a[156:159], v[164:167], v[40:43]
v_exp_f32 v10, v10
v_mfma_f32_16x16x32_bf16 a[0:3], a[176:179], v[88:91], a[0:3]
v_mfma_f32_16x16x32_bf16 a[4:7], a[176:179], v[92:95], a[4:7]
v_exp_f32 v11, v11
v_mfma_f32_16x16x32_bf16 a[8:11], a[176:179], v[96:99], a[8:11]
v_cvt_pk_bf16_f32 v73, v10, v11
v_mfma_f32_16x16x32_bf16 a[12:15], a[176:179], v[100:103], a[12:15]
s_waitcnt vmcnt(10) lgkmcnt(0)
s_barrier
v_mfma_f32_16x16x32_bf16 v[48:51], a[144:147], v[168:171], v[140:143]
v_exp_f32 v12, v12
v_mfma_f32_16x16x32_bf16 v[48:51], a[148:151], v[172:175], v[48:51]
v_exp_f32 v13, v13
v_mfma_f32_16x16x32_bf16 v[48:51], a[152:155], v[176:179], v[48:51]
ds_read_b64_tr_b16 a[176:177], v220 offset:49152
v_cvt_pk_bf16_f32 v74, v12, v13
v_mfma_f32_16x16x32_bf16 v[48:51], a[156:159], v[180:183], v[48:51]
v_exp_f32 v14, v14
v_mfma_f32_16x16x32_bf16 a[16:19], a[180:183], v[88:91], a[16:19]
ds_read_b64_tr_b16 a[178:179], v220 offset:53248
s_add_u32 s32, s32, 16384
v_mfma_f32_16x16x32_bf16 a[20:23], a[180:183], v[92:95], a[20:23]
v_exp_f32 v15, v15
v_mfma_f32_16x16x32_bf16 a[24:27], a[180:183], v[96:99], a[24:27]
v_cvt_pk_bf16_f32 v75, v14, v15
v_mfma_f32_16x16x32_bf16 a[28:31], a[180:183], v[100:103], a[28:31]
v_exp_f32 v16, v16
v_mfma_f32_16x16x32_bf16 v[56:59], a[144:147], v[184:187], v[144:147]
ds_read_b64_tr_b16 a[180:181], v221 offset:49152
ds_read_b64_tr_b16 a[182:183], v221 offset:53248
v_mfma_f32_16x16x32_bf16 v[56:59], a[148:151], v[188:191], v[56:59]
v_exp_f32 v17, v17
v_mfma_f32_16x16x32_bf16 v[56:59], a[152:155], v[192:195], v[56:59]
s_bitset0_b32 s32, 19
v_cvt_pk_bf16_f32 v76, v16, v17
v_mfma_f32_16x16x32_bf16 v[56:59], a[156:159], v[196:199], v[56:59]
v_exp_f32 v18, v18
v_mfma_f32_16x16x32_bf16 a[32:35], a[184:187], v[88:91], a[32:35]
s_add_u32 m0, s30, 114688
v_mfma_f32_16x16x32_bf16 a[36:39], a[184:187], v[92:95], a[36:39]
v_exp_f32 v19, v19
v_mfma_f32_16x16x32_bf16 a[40:43], a[184:187], v[96:99], a[40:43]
v_cvt_pk_bf16_f32 v77, v18, v19
v_mfma_f32_16x16x32_bf16 a[44:47], a[184:187], v[100:103], a[44:47]
v_exp_f32 v20, v20
v_mfma_f32_16x16x32_bf16 v[64:67], a[144:147], v[200:203], v[148:151]
ds_read_b64_tr_b16 a[184:185], v222 offset:49152
ds_read_b64_tr_b16 a[186:187], v222 offset:53248
v_mfma_f32_16x16x32_bf16 v[64:67], a[148:151], v[204:207], v[64:67]
v_exp_f32 v21, v21
v_mfma_f32_16x16x32_bf16 v[64:67], a[152:155], v[208:211], v[64:67]
ds_read_b128 a[144:147], v216 offset:0
v_cvt_pk_bf16_f32 v78, v20, v21
v_mfma_f32_16x16x32_bf16 v[64:67], a[156:159], v[212:215], v[64:67]
v_exp_f32 v22, v22
v_mfma_f32_16x16x32_bf16 a[48:51], a[188:191], v[88:91], a[48:51]
ds_read_b128 a[148:151], v217 offset:0
ds_read_b128 a[152:155], v218 offset:0
v_mfma_f32_16x16x32_bf16 a[52:55], a[188:191], v[92:95], a[52:55]
v_exp_f32 v23, v23
v_mfma_f32_16x16x32_bf16 a[56:59], a[188:191], v[96:99], a[56:59]
ds_read_b128 a[156:159], v219 offset:0
v_cvt_pk_bf16_f32 v79, v22, v23
v_mfma_f32_16x16x32_bf16 a[60:63], a[188:191], v[100:103], a[60:63]
v_exp_f32 v24, v24
v_smfmac_f32_16x16x64_bf16 a[128:131], a[208:211], v[88:95], v245
v_exp_f32 v25, v25
v_mfma_f32_16x16x32_bf16 v[44:47], a[160:163], v[152:155], v[136:139]
ds_read_b64_tr_b16 a[188:189], v223 offset:49152
v_cvt_pk_bf16_f32 v80, v24, v25
v_mfma_f32_16x16x32_bf16 v[44:47], a[164:167], v[156:159], v[44:47]
v_exp_f32 v26, v26
v_mfma_f32_16x16x32_bf16 v[44:47], a[168:171], v[160:163], v[44:47]
ds_read_b64_tr_b16 a[190:191], v223 offset:53248
buffer_load_dwordx4 v228, s[8:11], s32 offen offset:0 lds
v_mfma_f32_16x16x32_bf16 v[44:47], a[172:175], v[164:167], v[44:47]
v_exp_f32 v27, v27
v_mfma_f32_16x16x32_bf16 a[64:67], a[192:195], v[88:91], a[64:67]
buffer_load_dwordx4 v229, s[8:11], s32 offen offset:1024 lds
v_cvt_pk_bf16_f32 v81, v26, v27
v_mfma_f32_16x16x32_bf16 a[68:71], a[192:195], v[92:95], a[68:71]
v_exp_f32 v28, v28
v_mfma_f32_16x16x32_bf16 a[72:75], a[192:195], v[96:99], a[72:75]
buffer_load_dwordx4 v230, s[8:11], s32 offen offset:2048 lds
v_mfma_f32_16x16x32_bf16 a[76:79], a[192:195], v[100:103], a[76:79]
v_exp_f32 v29, v29
v_mfma_f32_16x16x32_bf16 v[52:55], a[160:163], v[168:171], v[140:143]
ds_read_b64_tr_b16 a[192:193], v224 offset:49152
v_cvt_pk_bf16_f32 v82, v28, v29
v_mfma_f32_16x16x32_bf16 v[52:55], a[164:167], v[172:175], v[52:55]
v_exp_f32 v30, v30
v_mfma_f32_16x16x32_bf16 v[52:55], a[168:171], v[176:179], v[52:55]
ds_read_b64_tr_b16 a[194:195], v224 offset:53248
buffer_load_dwordx4 v231, s[8:11], s32 offen offset:3072 lds
v_mfma_f32_16x16x32_bf16 v[52:55], a[172:175], v[180:183], v[52:55]
v_exp_f32 v31, v31
v_mfma_f32_16x16x32_bf16 a[80:83], a[196:199], v[88:91], a[80:83]
v_cvt_pk_bf16_f32 v83, v30, v31
v_mfma_f32_16x16x32_bf16 a[84:87], a[196:199], v[92:95], a[84:87]
v_exp_f32 v32, v32
v_mfma_f32_16x16x32_bf16 a[88:91], a[196:199], v[96:99], a[88:91]
v_mfma_f32_16x16x32_bf16 a[92:95], a[196:199], v[100:103], a[92:95]
v_exp_f32 v33, v33
v_mfma_f32_16x16x32_bf16 v[60:63], a[160:163], v[184:187], v[144:147]
ds_read_b64_tr_b16 a[196:197], v225 offset:49152
v_cvt_pk_bf16_f32 v84, v32, v33
v_mfma_f32_16x16x32_bf16 v[60:63], a[164:167], v[188:191], v[60:63]
v_exp_f32 v34, v34
v_mfma_f32_16x16x32_bf16 v[60:63], a[168:171], v[192:195], v[60:63]
ds_read_b64_tr_b16 a[198:199], v225 offset:53248
v_mfma_f32_16x16x32_bf16 v[60:63], a[172:175], v[196:199], v[60:63]
v_exp_f32 v35, v35
v_mfma_f32_16x16x32_bf16 a[96:99], a[200:203], v[88:91], a[96:99]
v_cvt_pk_bf16_f32 v85, v34, v35
v_mfma_f32_16x16x32_bf16 a[100:103], a[200:203], v[92:95], a[100:103]
v_exp_f32 v36, v36
v_mfma_f32_16x16x32_bf16 a[104:107], a[200:203], v[96:99], a[104:107]
s_mov_b32 m0, s87
s_lshl2_add_u32 s50, s87, s89
buffer_load_dwordx4 v243, s[56:59], s50 offen  lds
v_mfma_f32_16x16x32_bf16 a[108:111], a[200:203], v[100:103], a[108:111]
v_exp_f32 v37, v37
v_mfma_f32_16x16x32_bf16 v[68:71], a[160:163], v[200:203], v[148:151]
ds_read_b64_tr_b16 a[200:201], v226 offset:49152
v_cvt_pk_bf16_f32 v86, v36, v37
v_mfma_f32_16x16x32_bf16 v[68:71], a[164:167], v[204:207], v[68:71]
v_exp_f32 v38, v38
v_mfma_f32_16x16x32_bf16 v[68:71], a[168:171], v[208:211], v[68:71]
ds_read_b64_tr_b16 a[202:203], v226 offset:53248
ds_read_b128 a[160:163], v216 offset:4096
v_mfma_f32_16x16x32_bf16 v[68:71], a[172:175], v[212:215], v[68:71]
v_exp_f32 v39, v39
v_mfma_f32_16x16x32_bf16 a[112:115], a[204:207], v[88:91], a[112:115]
ds_read_b128 a[164:167], v217 offset:4096
v_cvt_pk_bf16_f32 v87, v38, v39
v_mfma_f32_16x16x32_bf16 a[116:119], a[204:207], v[92:95], a[116:119]
ds_read_b128 a[168:171], v218 offset:4096
ds_read_b128 a[172:175], v219 offset:4096
v_mfma_f32_16x16x32_bf16 a[120:123], a[204:207], v[96:99], a[120:123]
s_add_u32 s87, s87, 3456
s_min_u32 s87, s87, 63936
v_mfma_f32_16x16x32_bf16 a[124:127], a[204:207], v[100:103], a[124:127]
ds_read_b64_tr_b16 a[204:205], v227 offset:49152
ds_read_b64_tr_b16 a[206:207], v227 offset:53248
v_smfmac_f32_16x16x64_bf16 a[132:135], a[208:211], v[96:103], v245
s_waitcnt lgkmcnt(8)
v_mfma_f32_16x16x32_bf16 v[8:11], a[144:147], v[152:155], v[136:139]
v_exp_f32 v40, v40
v_mfma_f32_16x16x32_bf16 v[8:11], a[148:151], v[156:159], v[8:11]
v_exp_f32 v41, v41
v_mfma_f32_16x16x32_bf16 v[8:11], a[152:155], v[160:163], v[8:11]
v_cvt_pk_bf16_f32 v88, v40, v41
v_mfma_f32_16x16x32_bf16 v[8:11], a[156:159], v[164:167], v[8:11]
v_exp_f32 v42, v42
v_mfma_f32_16x16x32_bf16 a[0:3], a[176:179], v[72:75], a[0:3]
s_add_u32 s39, s39, 16384
v_mfma_f32_16x16x32_bf16 a[4:7], a[176:179], v[76:79], a[4:7]
v_exp_f32 v43, v43
v_mfma_f32_16x16x32_bf16 a[8:11], a[176:179], v[80:83], a[8:11]
v_cvt_pk_bf16_f32 v89, v42, v43
v_mfma_f32_16x16x32_bf16 a[12:15], a[176:179], v[84:87], a[12:15]
v_exp_f32 v44, v44
v_mfma_f32_16x16x32_bf16 v[16:19], a[144:147], v[168:171], v[140:143]
ds_read_b64_tr_b16 a[176:177], v220 offset:57344
ds_read_b64_tr_b16 a[178:179], v220 offset:61440
v_mfma_f32_16x16x32_bf16 v[16:19], a[148:151], v[172:175], v[16:19]
v_exp_f32 v45, v45
v_mfma_f32_16x16x32_bf16 v[16:19], a[152:155], v[176:179], v[16:19]
v_cvt_pk_bf16_f32 v90, v44, v45
v_mfma_f32_16x16x32_bf16 v[16:19], a[156:159], v[180:183], v[16:19]
v_exp_f32 v46, v46
v_mfma_f32_16x16x32_bf16 a[16:19], a[180:183], v[72:75], a[16:19]
s_bitset0_b32 s39, 19
v_mfma_f32_16x16x32_bf16 a[20:23], a[180:183], v[76:79], a[20:23]
v_exp_f32 v47, v47
v_mfma_f32_16x16x32_bf16 a[24:27], a[180:183], v[80:83], a[24:27]
v_cvt_pk_bf16_f32 v91, v46, v47
v_mfma_f32_16x16x32_bf16 a[28:31], a[180:183], v[84:87], a[28:31]
v_exp_f32 v48, v48
v_mfma_f32_16x16x32_bf16 v[24:27], a[144:147], v[184:187], v[144:147]
ds_read_b64_tr_b16 a[180:181], v221 offset:57344
ds_read_b64_tr_b16 a[182:183], v221 offset:61440
v_mfma_f32_16x16x32_bf16 v[24:27], a[148:151], v[188:191], v[24:27]
v_exp_f32 v49, v49
v_mfma_f32_16x16x32_bf16 v[24:27], a[152:155], v[192:195], v[24:27]
v_cvt_pk_bf16_f32 v92, v48, v49
v_mfma_f32_16x16x32_bf16 v[24:27], a[156:159], v[196:199], v[24:27]
v_exp_f32 v50, v50
v_mfma_f32_16x16x32_bf16 a[32:35], a[184:187], v[72:75], a[32:35]
s_add_u32 m0, s30, 131072
v_mfma_f32_16x16x32_bf16 a[36:39], a[184:187], v[76:79], a[36:39]
v_exp_f32 v51, v51
v_mfma_f32_16x16x32_bf16 a[40:43], a[184:187], v[80:83], a[40:43]
v_cvt_pk_bf16_f32 v93, v50, v51
v_mfma_f32_16x16x32_bf16 a[44:47], a[184:187], v[84:87], a[44:47]
v_exp_f32 v52, v52
v_mfma_f32_16x16x32_bf16 v[32:35], a[144:147], v[200:203], v[148:151]
ds_read_b64_tr_b16 a[184:185], v222 offset:57344
ds_read_b64_tr_b16 a[186:187], v222 offset:61440
v_mfma_f32_16x16x32_bf16 v[32:35], a[148:151], v[204:207], v[32:35]
v_exp_f32 v53, v53
v_mfma_f32_16x16x32_bf16 v[32:35], a[152:155], v[208:211], v[32:35]
ds_read_b128 a[144:147], v216 offset:8192
v_cvt_pk_bf16_f32 v94, v52, v53
v_mfma_f32_16x16x32_bf16 v[32:35], a[156:159], v[212:215], v[32:35]
v_exp_f32 v54, v54
v_mfma_f32_16x16x32_bf16 a[48:51], a[188:191], v[72:75], a[48:51]
ds_read_b128 a[148:151], v217 offset:8192
ds_read_b128 a[152:155], v218 offset:8192
v_mfma_f32_16x16x32_bf16 a[52:55], a[188:191], v[76:79], a[52:55]
v_exp_f32 v55, v55
v_mfma_f32_16x16x32_bf16 a[56:59], a[188:191], v[80:83], a[56:59]
ds_read_b128 a[156:159], v219 offset:8192
v_cvt_pk_bf16_f32 v95, v54, v55
v_mfma_f32_16x16x32_bf16 a[60:63], a[188:191], v[84:87], a[60:63]
v_exp_f32 v56, v56
v_smfmac_f32_16x16x64_bf16 a[128:131], a[208:211], v[72:79], v245
v_exp_f32 v57, v57
s_waitcnt lgkmcnt(8)
v_mfma_f32_16x16x32_bf16 v[12:15], a[160:163], v[152:155], v[136:139]
ds_read_b64_tr_b16 a[188:189], v223 offset:57344
v_cvt_pk_bf16_f32 v96, v56, v57
v_mfma_f32_16x16x32_bf16 v[12:15], a[164:167], v[156:159], v[12:15]
v_exp_f32 v58, v58
v_mfma_f32_16x16x32_bf16 v[12:15], a[168:171], v[160:163], v[12:15]
ds_read_b64_tr_b16 a[190:191], v223 offset:61440
buffer_load_dwordx4 v232, s[12:15], s39 offen offset:0 lds
v_mfma_f32_16x16x32_bf16 v[12:15], a[172:175], v[164:167], v[12:15]
v_exp_f32 v59, v59
v_mfma_f32_16x16x32_bf16 a[64:67], a[192:195], v[72:75], a[64:67]
buffer_load_dwordx4 v233, s[12:15], s39 offen offset:1024 lds
v_cvt_pk_bf16_f32 v97, v58, v59
v_mfma_f32_16x16x32_bf16 a[68:71], a[192:195], v[76:79], a[68:71]
v_exp_f32 v60, v60
v_mfma_f32_16x16x32_bf16 a[72:75], a[192:195], v[80:83], a[72:75]
v_mfma_f32_16x16x32_bf16 a[76:79], a[192:195], v[84:87], a[76:79]
v_exp_f32 v61, v61
v_mfma_f32_16x16x32_bf16 v[20:23], a[160:163], v[168:171], v[140:143]
ds_read_b64_tr_b16 a[192:193], v224 offset:57344
v_cvt_pk_bf16_f32 v98, v60, v61
v_mfma_f32_16x16x32_bf16 v[20:23], a[164:167], v[172:175], v[20:23]
v_exp_f32 v62, v62
v_mfma_f32_16x16x32_bf16 v[20:23], a[168:171], v[176:179], v[20:23]
ds_read_b64_tr_b16 a[194:195], v224 offset:61440
buffer_load_dwordx4 v232, s[12:15], s39 offen offset:2048 lds
v_mfma_f32_16x16x32_bf16 v[20:23], a[172:175], v[180:183], v[20:23]
v_exp_f32 v63, v63
v_mfma_f32_16x16x32_bf16 a[80:83], a[196:199], v[72:75], a[80:83]
v_cvt_pk_bf16_f32 v99, v62, v63
v_mfma_f32_16x16x32_bf16 a[84:87], a[196:199], v[76:79], a[84:87]
v_exp_f32 v64, v64
v_mfma_f32_16x16x32_bf16 a[88:91], a[196:199], v[80:83], a[88:91]
v_mfma_f32_16x16x32_bf16 a[92:95], a[196:199], v[84:87], a[92:95]
v_exp_f32 v65, v65
v_mfma_f32_16x16x32_bf16 v[28:31], a[160:163], v[184:187], v[144:147]
ds_read_b64_tr_b16 a[196:197], v225 offset:57344
v_cvt_pk_bf16_f32 v100, v64, v65
v_mfma_f32_16x16x32_bf16 v[28:31], a[164:167], v[188:191], v[28:31]
v_exp_f32 v66, v66
v_mfma_f32_16x16x32_bf16 v[28:31], a[168:171], v[192:195], v[28:31]
ds_read_b64_tr_b16 a[198:199], v225 offset:61440
buffer_load_dwordx4 v233, s[12:15], s39 offen offset:3072 lds
v_mfma_f32_16x16x32_bf16 v[28:31], a[172:175], v[196:199], v[28:31]
v_exp_f32 v67, v67
v_mfma_f32_16x16x32_bf16 a[96:99], a[200:203], v[72:75], a[96:99]
v_cvt_pk_bf16_f32 v101, v66, v67
v_mfma_f32_16x16x32_bf16 a[100:103], a[200:203], v[76:79], a[100:103]
v_exp_f32 v68, v68
v_mfma_f32_16x16x32_bf16 a[104:107], a[200:203], v[80:83], a[104:107]
v_mfma_f32_16x16x32_bf16 a[108:111], a[200:203], v[84:87], a[108:111]
v_exp_f32 v69, v69
v_mfma_f32_16x16x32_bf16 v[36:39], a[160:163], v[200:203], v[148:151]
ds_read_b64_tr_b16 a[200:201], v226 offset:57344
v_cvt_pk_bf16_f32 v102, v68, v69
v_mfma_f32_16x16x32_bf16 v[36:39], a[164:167], v[204:207], v[36:39]
v_exp_f32 v70, v70
v_mfma_f32_16x16x32_bf16 v[36:39], a[168:171], v[208:211], v[36:39]
ds_read_b64_tr_b16 a[202:203], v226 offset:61440
ds_read_b128 a[160:163], v216 offset:12288
v_mfma_f32_16x16x32_bf16 v[36:39], a[172:175], v[212:215], v[36:39]
v_exp_f32 v71, v71
v_mfma_f32_16x16x32_bf16 a[112:115], a[204:207], v[72:75], a[112:115]
ds_read_b128 a[164:167], v217 offset:12288
v_cvt_pk_bf16_f32 v103, v70, v71
v_mfma_f32_16x16x32_bf16 a[116:119], a[204:207], v[76:79], a[116:119]
ds_read_b128 a[168:171], v218 offset:12288
ds_read_b128 a[172:175], v219 offset:12288
v_mfma_f32_16x16x32_bf16 a[120:123], a[204:207], v[80:83], a[120:123]
v_mfma_f32_16x16x32_bf16 a[124:127], a[204:207], v[84:87], a[124:127]
ds_read_b64_tr_b16 a[204:205], v227 offset:57344
ds_read_b64_tr_b16 a[206:207], v227 offset:61440
v_smfmac_f32_16x16x64_bf16 a[132:135], a[208:211], v[80:87], v245
s_sub_u32 s33, s33, 1
s_cmp_lg_u32 s33, 0
s_cbranch_scc1 K_LOOP
K_LAST:
s_waitcnt lgkmcnt(8)
v_mfma_f32_16x16x32_bf16 v[40:43], a[144:147], v[152:155], v[136:139]
v_and_b32 v246, 15, v1
v_exp_f32 v8, v8
v_mfma_f32_16x16x32_bf16 v[40:43], a[148:151], v[156:159], v[40:43]
v_lshrrev_b32 v247, 3, v246
v_exp_f32 v9, v9
v_mfma_f32_16x16x32_bf16 v[40:43], a[152:155], v[160:163], v[40:43]
v_cvt_pk_bf16_f32 v72, v8, v9
v_and_b32 v246, 7, v246
v_lshlrev_b32 v246, 6, v246
v_mfma_f32_16x16x32_bf16 v[40:43], a[156:159], v[164:167], v[40:43]
v_lshl_add_u32 v246, v247, 13, v246
v_exp_f32 v10, v10
v_mfma_f32_16x16x32_bf16 a[0:3], a[176:179], v[88:91], a[0:3]
s_lshl_b32 s28, s36, 9
s_add_u32 s28, s28, 0x248000
v_mfma_f32_16x16x32_bf16 a[4:7], a[176:179], v[92:95], a[4:7]
v_exp_f32 v11, v11
v_mfma_f32_16x16x32_bf16 a[8:11], a[176:179], v[96:99], a[8:11]
v_cvt_pk_bf16_f32 v73, v10, v11
v_mfma_f32_16x16x32_bf16 a[12:15], a[176:179], v[100:103], a[12:15]
s_waitcnt vmcnt(9) lgkmcnt(0)
s_barrier
v_mfma_f32_16x16x32_bf16 v[48:51], a[144:147], v[168:171], v[140:143]
buffer_load_dword v242, v246, s[20:23], s28 offen sc1
v_exp_f32 v12, v12
v_mfma_f32_16x16x32_bf16 v[48:51], a[148:151], v[172:175], v[48:51]
v_bfe_u32 v246, v1, 2, 2
v_exp_f32 v13, v13
v_mfma_f32_16x16x32_bf16 v[48:51], a[152:155], v[176:179], v[48:51]
ds_read_b64_tr_b16 a[176:177], v220 offset:0
v_cvt_pk_bf16_f32 v74, v12, v13
v_lshl_add_u32 v246, v4, 2, v246
v_mfma_f32_16x16x32_bf16 v[48:51], a[156:159], v[180:183], v[48:51]
v_mul_u32_u24 v246, 288, v246
v_exp_f32 v14, v14
v_mfma_f32_16x16x32_bf16 a[16:19], a[180:183], v[88:91], a[16:19]
ds_read_b64_tr_b16 a[178:179], v220 offset:4096
v_and_b32 v247, 3, v1
v_lshl_add_u32 v236, v247, 3, v246
v_mfma_f32_16x16x32_bf16 a[20:23], a[180:183], v[92:95], a[20:23]
v_add_u32 v236, 256, v236
v_exp_f32 v15, v15
v_mfma_f32_16x16x32_bf16 a[24:27], a[180:183], v[96:99], a[24:27]
v_cvt_pk_bf16_f32 v75, v14, v15
v_lshl_add_u32 v246, v247, 4, v246
v_mfma_f32_16x16x32_bf16 a[28:31], a[180:183], v[100:103], a[28:31]
v_exp_f32 v16, v16
v_mfma_f32_16x16x32_bf16 v[56:59], a[144:147], v[184:187], v[144:147]
ds_read_b64_tr_b16 a[180:181], v221 offset:0
ds_read_b64_tr_b16 a[182:183], v221 offset:4096
v_mfma_f32_16x16x32_bf16 v[56:59], a[148:151], v[188:191], v[56:59]
v_exp_f32 v17, v17
v_mfma_f32_16x16x32_bf16 v[56:59], a[152:155], v[192:195], v[56:59]
s_lshr_b32 s28, s35, 4
s_lshl_b32 s28, s28, 6
v_cvt_pk_bf16_f32 v76, v16, v17
v_mfma_f32_16x16x32_bf16 v[56:59], a[156:159], v[196:199], v[56:59]
v_add_u32 v234, s28, v246
v_exp_f32 v18, v18
v_mfma_f32_16x16x32_bf16 a[32:35], a[184:187], v[88:91], a[32:35]
s_add_u32 m0, s88, 62208
s_lshl2_add_u32 s50, m0, s89
buffer_load_dwordx4 v243, s[56:59], s50 offen  lds
v_mfma_f32_16x16x32_bf16 a[36:39], a[184:187], v[92:95], a[36:39]
s_xor_b32 s28, s28, 64
v_exp_f32 v19, v19
v_mfma_f32_16x16x32_bf16 a[40:43], a[184:187], v[96:99], a[40:43]
v_cvt_pk_bf16_f32 v77, v18, v19
v_add_u32 v235, s28, v246
v_mfma_f32_16x16x32_bf16 a[44:47], a[184:187], v[100:103], a[44:47]
v_exp_f32 v20, v20
v_mfma_f32_16x16x32_bf16 v[64:67], a[144:147], v[200:203], v[148:151]
ds_read_b64_tr_b16 a[184:185], v222 offset:0
ds_read_b64_tr_b16 a[186:187], v222 offset:4096
v_mfma_f32_16x16x32_bf16 v[64:67], a[148:151], v[204:207], v[64:67]
v_exp_f32 v21, v21
v_mfma_f32_16x16x32_bf16 v[64:67], a[152:155], v[208:211], v[64:67]
ds_read_b128 a[144:147], v216 offset:16384
v_cvt_pk_bf16_f32 v78, v20, v21
v_mfma_f32_16x16x32_bf16 v[64:67], a[156:159], v[212:215], v[64:67]
v_exp_f32 v22, v22
v_mfma_f32_16x16x32_bf16 a[48:51], a[188:191], v[88:91], a[48:51]
ds_read_b128 a[148:151], v217 offset:16384
ds_read_b128 a[152:155], v218 offset:16384
v_mfma_f32_16x16x32_bf16 a[52:55], a[188:191], v[92:95], a[52:55]
v_exp_f32 v23, v23
v_mfma_f32_16x16x32_bf16 a[56:59], a[188:191], v[96:99], a[56:59]
ds_read_b128 a[156:159], v219 offset:16384
v_cvt_pk_bf16_f32 v79, v22, v23
v_mfma_f32_16x16x32_bf16 a[60:63], a[188:191], v[100:103], a[60:63]
v_exp_f32 v24, v24
v_smfmac_f32_16x16x64_bf16 a[128:131], a[208:211], v[88:95], v245
v_exp_f32 v25, v25
v_mfma_f32_16x16x32_bf16 v[44:47], a[160:163], v[152:155], v[136:139]
ds_read_b64_tr_b16 a[188:189], v223 offset:0
v_cvt_pk_bf16_f32 v80, v24, v25
v_mfma_f32_16x16x32_bf16 v[44:47], a[164:167], v[156:159], v[44:47]
v_exp_f32 v26, v26
v_mfma_f32_16x16x32_bf16 v[44:47], a[168:171], v[160:163], v[44:47]
ds_read_b64_tr_b16 a[190:191], v223 offset:4096
s_add_u32 s28, s35, 0
s_and_b32 s28, s28, 3
v_mfma_f32_16x16x32_bf16 v[44:47], a[172:175], v[164:167], v[44:47]
s_mul_i32 s28, s28, 36864
v_exp_f32 v27, v27
v_mfma_f32_16x16x32_bf16 a[64:67], a[192:195], v[88:91], a[64:67]
v_cvt_pk_bf16_f32 v81, v26, v27
v_add_u32 v237, s28, v234
v_add_u32 v238, s28, v235
v_mfma_f32_16x16x32_bf16 a[68:71], a[192:195], v[92:95], a[68:71]
v_add_u32 v239, s28, v236
v_exp_f32 v28, v28
v_mfma_f32_16x16x32_bf16 a[72:75], a[192:195], v[96:99], a[72:75]
s_add_u32 m0, s88, 65664
s_lshl2_add_u32 s50, m0, s89
buffer_load_dwordx4 v243, s[56:59], s50 offen  lds
v_mfma_f32_16x16x32_bf16 a[76:79], a[192:195], v[100:103], a[76:79]
v_mov_b32 v254, 0x7ffffff0
v_exp_f32 v29, v29
v_mfma_f32_16x16x32_bf16 v[52:55], a[160:163], v[168:171], v[140:143]
ds_read_b64_tr_b16 a[192:193], v224 offset:0
s_lshl2_add_u32 s92, s36, s37
v_cvt_pk_bf16_f32 v82, v28, v29
v_mfma_f32_16x16x32_bf16 v[52:55], a[164:167], v[172:175], v[52:55]
s_bfe_u32 s93, s35, 0x20002
v_exp_f32 v30, v30
v_mfma_f32_16x16x32_bf16 v[52:55], a[168:171], v[176:179], v[52:55]
ds_read_b64_tr_b16 a[194:195], v224 offset:4096
s_lshl2_add_u32 s92, s92, s93
s_lshl_b32 s93, s92, 4
v_mfma_f32_16x16x32_bf16 v[52:55], a[172:175], v[180:183], v[52:55]
v_add_u32 v132, s93, v3
v_exp_f32 v31, v31
v_mfma_f32_16x16x32_bf16 a[80:83], a[196:199], v[88:91], a[80:83]
v_cvt_pk_bf16_f32 v83, v30, v31
v_writelane_b32 v254, 0, 0
v_mfma_f32_16x16x32_bf16 a[84:87], a[196:199], v[92:95], a[84:87]
s_mul_i32 s92, s92, 18432
v_exp_f32 v32, v32
v_mfma_f32_16x16x32_bf16 a[88:91], a[196:199], v[96:99], a[88:91]
s_add_u32 m0, s88, 69120
s_lshl2_add_u32 s50, m0, s89
buffer_load_dwordx4 v243, s[56:59], s50 offen  lds
v_mfma_f32_16x16x32_bf16 a[92:95], a[196:199], v[100:103], a[92:95]
s_and_b32 s93, s35, 3
v_exp_f32 v33, v33
v_mfma_f32_16x16x32_bf16 v[60:63], a[160:163], v[184:187], v[144:147]
ds_read_b64_tr_b16 a[196:197], v225 offset:0
s_mul_i32 s93, s93, 144
v_cvt_pk_bf16_f32 v84, v32, v33
v_mfma_f32_16x16x32_bf16 v[60:63], a[164:167], v[188:191], v[60:63]
v_lshlrev_b32 v251, 2, v4
v_exp_f32 v34, v34
v_mfma_f32_16x16x32_bf16 v[60:63], a[168:171], v[192:195], v[60:63]
ds_read_b64_tr_b16 a[198:199], v225 offset:4096
v_add_u32 v251, s93, v251
v_add_u32 v251, 128, v251
v_mfma_f32_16x16x32_bf16 v[60:63], a[172:175], v[196:199], v[60:63]
v_lshlrev_b32 v250, 3, v4
v_exp_f32 v35, v35
v_mfma_f32_16x16x32_bf16 a[96:99], a[200:203], v[88:91], a[96:99]
s_lshr_b32 s90, s35, 4
s_lshl_b32 s90, s90, 5
v_cvt_pk_bf16_f32 v85, v34, v35
v_mfma_f32_16x16x32_bf16 a[100:103], a[200:203], v[92:95], a[100:103]
s_add_u32 s93, s93, s90
v_exp_f32 v36, v36
v_mfma_f32_16x16x32_bf16 a[104:107], a[200:203], v[96:99], a[104:107]
v_add_u32 v250, s93, v250
v_lshrrev_b32 v133, 5, v250
v_bfe_u32 v134, v250, 2, 2
v_mfma_f32_16x16x32_bf16 a[108:111], a[200:203], v[100:103], a[108:111]
v_lshl_add_u32 v134, v134, 4, v3
v_exp_f32 v37, v37
v_mfma_f32_16x16x32_bf16 v[68:71], a[160:163], v[200:203], v[148:151]
ds_read_b64_tr_b16 a[200:201], v226 offset:0
v_cvt_pk_bf16_f32 v86, v36, v37
v_lshlrev_b32 v134, 4, v134
v_mfma_f32_16x16x32_bf16 v[68:71], a[164:167], v[204:207], v[68:71]
v_lshl_add_u32 v252, v133, 10, v134
v_exp_f32 v38, v38
v_mfma_f32_16x16x32_bf16 v[68:71], a[168:171], v[208:211], v[68:71]
ds_read_b64_tr_b16 a[202:203], v226 offset:4096
ds_read_b128 a[160:163], v216 offset:20480
v_bfe_u32 v133, v250, 4, 1
v_mfma_f32_16x16x32_bf16 v[68:71], a[172:175], v[212:215], v[68:71]
v_lshl_add_u32 v252, v133, 3, v252
v_exp_f32 v39, v39
v_mfma_f32_16x16x32_bf16 a[112:115], a[204:207], v[88:91], a[112:115]
ds_read_b128 a[164:167], v217 offset:20480
v_cvt_pk_bf16_f32 v87, v38, v39
v_lshlrev_b32 v250, 1, v250
v_mfma_f32_16x16x32_bf16 a[116:119], a[204:207], v[92:95], a[116:119]
ds_read_b128 a[168:171], v218 offset:20480
ds_read_b128 a[172:175], v219 offset:20480
v_lshrrev_b32 v133, 5, v251
v_mfma_f32_16x16x32_bf16 a[120:123], a[204:207], v[96:99], a[120:123]
v_bfe_u32 v134, v251, 2, 2
v_lshl_add_u32 v134, v134, 4, v3
v_lshlrev_b32 v134, 4, v134
v_mfma_f32_16x16x32_bf16 a[124:127], a[204:207], v[100:103], a[124:127]
ds_read_b64_tr_b16 a[204:205], v227 offset:0
ds_read_b64_tr_b16 a[206:207], v227 offset:4096
v_lshl_add_u32 v253, v133, 10, v134
v_smfmac_f32_16x16x64_bf16 a[132:135], a[208:211], v[96:103], v245
v_bfe_u32 v133, v251, 4, 1
v_lshl_add_u32 v253, v133, 3, v253
v_lshlrev_b32 v251, 1, v251
s_waitcnt lgkmcnt(8)
v_mfma_f32_16x16x32_bf16 v[8:11], a[144:147], v[152:155], v[136:139]
v_mul_u32_u24 v133, 0x480, v132
v_exp_f32 v40, v40
v_mfma_f32_16x16x32_bf16 v[8:11], a[148:151], v[156:159], v[8:11]
v_add_u32 v248, v133, v250
v_exp_f32 v41, v41
v_mfma_f32_16x16x32_bf16 v[8:11], a[152:155], v[160:163], v[8:11]
v_cvt_pk_bf16_f32 v88, v40, v41
v_add_u32 v249, v133, v251
v_mov_b32 v135, 0x7fffbff0
v_mfma_f32_16x16x32_bf16 v[8:11], a[156:159], v[164:167], v[8:11]
v_exp_f32 v42, v42
v_mfma_f32_16x16x32_bf16 a[0:3], a[176:179], v[72:75], a[0:3]
s_add_u32 s39, s39, 16384
s_mov_b32 s93, 0x243080
buffer_load_dword v246, v254, s[20:23], s93 offen sc0 sc1
v_mfma_f32_16x16x32_bf16 a[4:7], a[176:179], v[76:79], a[4:7]
v_exp_f32 v43, v43
v_mfma_f32_16x16x32_bf16 a[8:11], a[176:179], v[80:83], a[8:11]
v_cvt_pk_bf16_f32 v89, v42, v43
v_mfma_f32_16x16x32_bf16 a[12:15], a[176:179], v[84:87], a[12:15]
buffer_load_dwordx2 a[222:223], v252, s[20:23], s92 offen offset:0 sc0 sc1
v_exp_f32 v44, v44
v_mfma_f32_16x16x32_bf16 v[16:19], a[144:147], v[168:171], v[140:143]
ds_read_b64_tr_b16 a[176:177], v220 offset:8192
ds_read_b64_tr_b16 a[178:179], v220 offset:12288
v_mfma_f32_16x16x32_bf16 v[16:19], a[148:151], v[172:175], v[16:19]
v_exp_f32 v45, v45
v_mfma_f32_16x16x32_bf16 v[16:19], a[152:155], v[176:179], v[16:19]
s_bitset0_b32 s39, 19
buffer_load_dwordx2 a[224:225], v252, s[20:23], s92 offen offset:256 sc0 sc1
v_cvt_pk_bf16_f32 v90, v44, v45
v_mfma_f32_16x16x32_bf16 v[16:19], a[156:159], v[180:183], v[16:19]
v_exp_f32 v46, v46
v_mfma_f32_16x16x32_bf16 a[16:19], a[180:183], v[72:75], a[16:19]
v_mfma_f32_16x16x32_bf16 a[20:23], a[180:183], v[76:79], a[20:23]
buffer_load_dwordx2 a[226:227], v252, s[20:23], s92 offen offset:2048 sc0 sc1
v_exp_f32 v47, v47
v_mfma_f32_16x16x32_bf16 a[24:27], a[180:183], v[80:83], a[24:27]
v_cvt_pk_bf16_f32 v91, v46, v47
v_mfma_f32_16x16x32_bf16 a[28:31], a[180:183], v[84:87], a[28:31]
v_exp_f32 v48, v48
v_mfma_f32_16x16x32_bf16 v[24:27], a[144:147], v[184:187], v[144:147]
ds_read_b64_tr_b16 a[180:181], v221 offset:8192
ds_read_b64_tr_b16 a[182:183], v221 offset:12288
buffer_load_dwordx2 a[228:229], v252, s[20:23], s92 offen offset:2304 sc0 sc1
v_mfma_f32_16x16x32_bf16 v[24:27], a[148:151], v[188:191], v[24:27]
v_exp_f32 v49, v49
v_mfma_f32_16x16x32_bf16 v[24:27], a[152:155], v[192:195], v[24:27]
s_add_u32 m0, s30, 147456
v_cvt_pk_bf16_f32 v92, v48, v49
v_mfma_f32_16x16x32_bf16 v[24:27], a[156:159], v[196:199], v[24:27]
buffer_load_dwordx2 a[230:231], v253, s[20:23], s92 offen sc0 sc1
v_exp_f32 v50, v50
v_mfma_f32_16x16x32_bf16 a[32:35], a[184:187], v[72:75], a[32:35]
v_mfma_f32_16x16x32_bf16 a[36:39], a[184:187], v[76:79], a[36:39]
v_exp_f32 v51, v51
v_mfma_f32_16x16x32_bf16 a[40:43], a[184:187], v[80:83], a[40:43]
buffer_load_dwordx4 v232, s[12:15], s39 offen offset:0 lds
buffer_load_dwordx4 a[212:215], v248, s[52:55], 0 offen offset:0
v_cvt_pk_bf16_f32 v93, v50, v51
v_mfma_f32_16x16x32_bf16 a[44:47], a[184:187], v[84:87], a[44:47]
v_exp_f32 v52, v52
v_mfma_f32_16x16x32_bf16 v[32:35], a[144:147], v[200:203], v[148:151]
ds_read_b64_tr_b16 a[184:185], v222 offset:8192
ds_read_b64_tr_b16 a[186:187], v222 offset:12288
v_mfma_f32_16x16x32_bf16 v[32:35], a[148:151], v[204:207], v[32:35]
buffer_load_dwordx4 a[216:219], v248, s[52:55], 0 offen offset:128
v_exp_f32 v53, v53
v_mfma_f32_16x16x32_bf16 v[32:35], a[152:155], v[208:211], v[32:35]
ds_read_b128 a[144:147], v216 offset:24576
v_cvt_pk_bf16_f32 v94, v52, v53
v_mfma_f32_16x16x32_bf16 v[32:35], a[156:159], v[212:215], v[32:35]
v_exp_f32 v54, v54
v_mfma_f32_16x16x32_bf16 a[48:51], a[188:191], v[72:75], a[48:51]
ds_read_b128 a[148:151], v217 offset:24576
ds_read_b128 a[152:155], v218 offset:24576
buffer_load_dwordx2 a[220:221], v249, s[52:55], 0 offen
v_mfma_f32_16x16x32_bf16 a[52:55], a[188:191], v[76:79], a[52:55]
v_sub_u32 v133, 0xffff, v132
v_exp_f32 v55, v55
v_mfma_f32_16x16x32_bf16 a[56:59], a[188:191], v[80:83], a[56:59]
ds_read_b128 a[156:159], v219 offset:24576
s_and_b32 s93, s76, 0xffff
v_cvt_pk_bf16_f32 v95, v54, v55
v_mfma_f32_16x16x32_bf16 a[60:63], a[188:191], v[84:87], a[60:63]
v_cmp_eq_u32 s[90:91], s93, v133
v_exp_f32 v56, v56
v_smfmac_f32_16x16x64_bf16 a[128:131], a[208:211], v[72:79], v245
v_mov_b32 v134, 0
v_exp_f32 v57, v57
s_waitcnt lgkmcnt(8)
v_mfma_f32_16x16x32_bf16 v[12:15], a[160:163], v[152:155], v[136:139]
ds_read_b64_tr_b16 a[188:189], v223 offset:8192
v_cvt_pk_bf16_f32 v96, v56, v57
v_cndmask_b32 v135, v135, v134, s[90:91]
v_mfma_f32_16x16x32_bf16 v[12:15], a[164:167], v[156:159], v[12:15]
s_and_b32 s93, s77, 0xffff
v_exp_f32 v58, v58
v_mfma_f32_16x16x32_bf16 v[12:15], a[168:171], v[160:163], v[12:15]
ds_read_b64_tr_b16 a[190:191], v223 offset:12288
buffer_load_dwordx4 v233, s[12:15], s39 offen offset:1024 lds
v_cmp_eq_u32 s[90:91], s93, v133
v_mfma_f32_16x16x32_bf16 v[12:15], a[172:175], v[164:167], v[12:15]
v_mov_b32 v134, 1152
v_exp_f32 v59, v59
v_mfma_f32_16x16x32_bf16 a[64:67], a[192:195], v[72:75], a[64:67]
buffer_load_dwordx4 v232, s[12:15], s39 offen offset:2048 lds
v_cvt_pk_bf16_f32 v97, v58, v59
v_cndmask_b32 v135, v135, v134, s[90:91]
v_mfma_f32_16x16x32_bf16 a[68:71], a[192:195], v[76:79], a[68:71]
s_and_b32 s93, s78, 0xffff
v_exp_f32 v60, v60
v_mfma_f32_16x16x32_bf16 a[72:75], a[192:195], v[80:83], a[72:75]
v_cmp_eq_u32 s[90:91], s93, v133
v_mov_b32 v134, 2304
v_mfma_f32_16x16x32_bf16 a[76:79], a[192:195], v[84:87], a[76:79]
v_cndmask_b32 v135, v135, v134, s[90:91]
v_exp_f32 v61, v61
v_mfma_f32_16x16x32_bf16 v[20:23], a[160:163], v[168:171], v[140:143]
ds_read_b64_tr_b16 a[192:193], v224 offset:8192
s_and_b32 s93, s79, 0xffff
v_cvt_pk_bf16_f32 v98, v60, v61
v_mfma_f32_16x16x32_bf16 v[20:23], a[164:167], v[172:175], v[20:23]
v_cmp_eq_u32 s[90:91], s93, v133
v_exp_f32 v62, v62
v_mfma_f32_16x16x32_bf16 v[20:23], a[168:171], v[176:179], v[20:23]
ds_read_b64_tr_b16 a[194:195], v224 offset:12288
buffer_load_dwordx4 v233, s[12:15], s39 offen offset:3072 lds
v_mov_b32 v134, 3456
v_mfma_f32_16x16x32_bf16 v[20:23], a[172:175], v[180:183], v[20:23]
v_cndmask_b32 v135, v135, v134, s[90:91]
v_exp_f32 v63, v63
v_mfma_f32_16x16x32_bf16 a[80:83], a[196:199], v[72:75], a[80:83]
s_and_b32 s93, s80, 0xffff
v_cvt_pk_bf16_f32 v99, v62, v63
v_mfma_f32_16x16x32_bf16 a[84:87], a[196:199], v[76:79], a[84:87]
v_cmp_eq_u32 s[90:91], s93, v133
v_exp_f32 v64, v64
v_mfma_f32_16x16x32_bf16 a[88:91], a[196:199], v[80:83], a[88:91]
s_add_u32 m0, s88, 72576
s_lshl2_add_u32 s50, m0, s89
buffer_load_dwordx4 v243, s[56:59], s50 offen  lds
v_mfma_f32_16x16x32_bf16 a[92:95], a[196:199], v[84:87], a[92:95]
v_mov_b32 v134, 4608
v_exp_f32 v65, v65
v_mfma_f32_16x16x32_bf16 v[28:31], a[160:163], v[184:187], v[144:147]
ds_read_b64_tr_b16 a[196:197], v225 offset:8192
v_cvt_pk_bf16_f32 v100, v64, v65
v_cndmask_b32 v135, v135, v134, s[90:91]
v_mfma_f32_16x16x32_bf16 v[28:31], a[164:167], v[188:191], v[28:31]
s_and_b32 s93, s81, 0xffff
v_exp_f32 v66, v66
v_mfma_f32_16x16x32_bf16 v[28:31], a[168:171], v[192:195], v[28:31]
ds_read_b64_tr_b16 a[198:199], v225 offset:12288
v_cmp_eq_u32 s[90:91], s93, v133
v_mov_b32 v134, 5760
v_mfma_f32_16x16x32_bf16 v[28:31], a[172:175], v[196:199], v[28:31]
v_cndmask_b32 v135, v135, v134, s[90:91]
v_exp_f32 v67, v67
v_mfma_f32_16x16x32_bf16 a[96:99], a[200:203], v[72:75], a[96:99]
s_and_b32 s93, s82, 0xffff
v_cvt_pk_bf16_f32 v101, v66, v67
v_mfma_f32_16x16x32_bf16 a[100:103], a[200:203], v[76:79], a[100:103]
v_cmp_eq_u32 s[90:91], s93, v133
v_exp_f32 v68, v68
v_mfma_f32_16x16x32_bf16 a[104:107], a[200:203], v[80:83], a[104:107]
s_add_u32 m0, s88, 76032
s_lshl2_add_u32 s50, m0, s89
buffer_load_dwordx4 v243, s[56:59], s50 offen  lds
v_mfma_f32_16x16x32_bf16 a[108:111], a[200:203], v[84:87], a[108:111]
v_mov_b32 v134, 6912
v_exp_f32 v69, v69
v_mfma_f32_16x16x32_bf16 v[36:39], a[160:163], v[200:203], v[148:151]
ds_read_b64_tr_b16 a[200:201], v226 offset:8192
v_cvt_pk_bf16_f32 v102, v68, v69
v_cndmask_b32 v135, v135, v134, s[90:91]
v_mfma_f32_16x16x32_bf16 v[36:39], a[164:167], v[204:207], v[36:39]
s_and_b32 s93, s83, 0xffff
v_exp_f32 v70, v70
v_mfma_f32_16x16x32_bf16 v[36:39], a[168:171], v[208:211], v[36:39]
ds_read_b64_tr_b16 a[202:203], v226 offset:12288
ds_read_b128 a[160:163], v216 offset:28672
v_cmp_eq_u32 s[90:91], s93, v133
v_mfma_f32_16x16x32_bf16 v[36:39], a[172:175], v[212:215], v[36:39]
v_mov_b32 v134, 8064
v_exp_f32 v71, v71
v_mfma_f32_16x16x32_bf16 a[112:115], a[204:207], v[72:75], a[112:115]
ds_read_b128 a[164:167], v217 offset:28672
v_cvt_pk_bf16_f32 v103, v70, v71
v_cndmask_b32 v135, v135, v134, s[90:91]
v_mfma_f32_16x16x32_bf16 a[116:119], a[204:207], v[76:79], a[116:119]
ds_read_b128 a[168:171], v218 offset:28672
ds_read_b128 a[172:175], v219 offset:28672
v_add_u32 v250, v250, v135
v_mfma_f32_16x16x32_bf16 a[120:123], a[204:207], v[80:83], a[120:123]
v_add_u32 v251, v251, v135
v_lshrrev_b32 v134, 14, v135
v_cmp_eq_u32 s[90:91], 0, v134
v_mfma_f32_16x16x32_bf16 a[124:127], a[204:207], v[84:87], a[124:127]
ds_read_b64_tr_b16 a[204:205], v227 offset:8192
ds_read_b64_tr_b16 a[206:207], v227 offset:12288
v_smfmac_f32_16x16x64_bf16 a[132:135], a[208:211], v[80:87], v245
s_waitcnt vmcnt(14)
v_readfirstlane_b32 s93, v246
s_waitcnt lgkmcnt(8)
v_mfma_f32_16x16x32_bf16 v[40:43], a[144:147], v[152:155], v[136:139]
v_exp_f32 v8, v8
v_mfma_f32_16x16x32_bf16 v[40:43], a[148:151], v[156:159], v[40:43]
v_exp_f32 v9, v9
v_mfma_f32_16x16x32_bf16 v[40:43], a[152:155], v[160:163], v[40:43]
s_cmp_eq_u64 s[90:91], 0
s_cselect_b32 s93, 288, s93
v_cvt_pk_bf16_f32 v72, v8, v9
v_mfma_f32_16x16x32_bf16 v[40:43], a[156:159], v[164:167], v[40:43]
v_exp_f32 v10, v10
v_mfma_f32_16x16x32_bf16 a[0:3], a[176:179], v[88:91], a[0:3]
s_cmp_lt_u32 s93, 288
s_cbranch_scc1 SP_Y
SP_Y_RET:
v_mfma_f32_16x16x32_bf16 a[4:7], a[176:179], v[92:95], a[4:7]
s_mov_b32 s93, 0x244000
v_exp_f32 v11, v11
v_mfma_f32_16x16x32_bf16 a[8:11], a[176:179], v[96:99], a[8:11]
v_cvt_pk_bf16_f32 v73, v10, v11
v_mfma_f32_16x16x32_bf16 a[12:15], a[176:179], v[100:103], a[12:15]
s_waitcnt vmcnt(19) lgkmcnt(0)
s_barrier
v_mfma_f32_16x16x32_bf16 v[48:51], a[144:147], v[168:171], v[140:143]
buffer_load_dwordx4 a[232:235], v250, s[20:23], s93 offen offset:0 sc0 sc1
v_exp_f32 v12, v12
v_mfma_f32_16x16x32_bf16 v[48:51], a[148:151], v[172:175], v[48:51]
buffer_load_dwordx4 a[236:239], v250, s[20:23], s93 offen offset:128 sc0 sc1
v_exp_f32 v13, v13
v_mfma_f32_16x16x32_bf16 v[48:51], a[152:155], v[176:179], v[48:51]
ds_read_b64_tr_b16 a[176:177], v220 offset:32768
buffer_load_dwordx2 a[240:241], v251, s[20:23], s93 offen sc0 sc1
v_cvt_pk_bf16_f32 v74, v12, v13
v_mfma_f32_16x16x32_bf16 v[48:51], a[156:159], v[180:183], v[48:51]
v_exp_f32 v14, v14
v_mfma_f32_16x16x32_bf16 a[16:19], a[180:183], v[88:91], a[16:19]
ds_read_b64_tr_b16 a[178:179], v220 offset:36864
v_mfma_f32_16x16x32_bf16 a[20:23], a[180:183], v[92:95], a[20:23]
v_exp_f32 v15, v15
v_mfma_f32_16x16x32_bf16 a[24:27], a[180:183], v[96:99], a[24:27]
v_cvt_pk_bf16_f32 v75, v14, v15
v_mfma_f32_16x16x32_bf16 a[28:31], a[180:183], v[100:103], a[28:31]
v_exp_f32 v16, v16
v_mfma_f32_16x16x32_bf16 v[56:59], a[144:147], v[184:187], v[144:147]
ds_read_b64_tr_b16 a[180:181], v221 offset:32768
ds_read_b64_tr_b16 a[182:183], v221 offset:36864
v_mfma_f32_16x16x32_bf16 v[56:59], a[148:151], v[188:191], v[56:59]
v_exp_f32 v17, v17
v_mfma_f32_16x16x32_bf16 v[56:59], a[152:155], v[192:195], v[56:59]
v_cvt_pk_bf16_f32 v76, v16, v17
v_mfma_f32_16x16x32_bf16 v[56:59], a[156:159], v[196:199], v[56:59]
v_exp_f32 v18, v18
v_mfma_f32_16x16x32_bf16 a[32:35], a[184:187], v[88:91], a[32:35]
s_add_u32 m0, s88, 79488
s_lshl2_add_u32 s50, m0, s89
buffer_load_dwordx4 v243, s[56:59], s50 offen  lds
v_mfma_f32_16x16x32_bf16 a[36:39], a[184:187], v[92:95], a[36:39]
v_exp_f32 v19, v19
v_mfma_f32_16x16x32_bf16 a[40:43], a[184:187], v[96:99], a[40:43]
v_cvt_pk_bf16_f32 v77, v18, v19
v_mfma_f32_16x16x32_bf16 a[44:47], a[184:187], v[100:103], a[44:47]
v_exp_f32 v20, v20
v_mfma_f32_16x16x32_bf16 v[64:67], a[144:147], v[200:203], v[148:151]
ds_read_b64_tr_b16 a[184:185], v222 offset:32768
ds_read_b64_tr_b16 a[186:187], v222 offset:36864
v_mfma_f32_16x16x32_bf16 v[64:67], a[148:151], v[204:207], v[64:67]
v_exp_f32 v21, v21
v_mfma_f32_16x16x32_bf16 v[64:67], a[152:155], v[208:211], v[64:67]
ds_read_b128 a[144:147], v216 offset:49152
v_cvt_pk_bf16_f32 v78, v20, v21
v_mfma_f32_16x16x32_bf16 v[64:67], a[156:159], v[212:215], v[64:67]
v_exp_f32 v22, v22
v_mfma_f32_16x16x32_bf16 a[48:51], a[188:191], v[88:91], a[48:51]
ds_read_b128 a[148:151], v217 offset:49152
ds_read_b128 a[152:155], v218 offset:49152
v_mfma_f32_16x16x32_bf16 a[52:55], a[188:191], v[92:95], a[52:55]
v_exp_f32 v23, v23
v_mfma_f32_16x16x32_bf16 a[56:59], a[188:191], v[96:99], a[56:59]
ds_read_b128 a[156:159], v219 offset:49152
v_cvt_pk_bf16_f32 v79, v22, v23
v_mfma_f32_16x16x32_bf16 a[60:63], a[188:191], v[100:103], a[60:63]
v_exp_f32 v24, v24
v_smfmac_f32_16x16x64_bf16 a[128:131], a[208:211], v[88:95], v245
v_exp_f32 v25, v25
v_mfma_f32_16x16x32_bf16 v[44:47], a[160:163], v[152:155], v[136:139]
ds_read_b64_tr_b16 a[188:189], v223 offset:32768
v_cvt_pk_bf16_f32 v80, v24, v25
v_mfma_f32_16x16x32_bf16 v[44:47], a[164:167], v[156:159], v[44:47]
v_exp_f32 v26, v26
v_mfma_f32_16x16x32_bf16 v[44:47], a[168:171], v[160:163], v[44:47]
ds_read_b64_tr_b16 a[190:191], v223 offset:36864
v_mfma_f32_16x16x32_bf16 v[44:47], a[172:175], v[164:167], v[44:47]
v_exp_f32 v27, v27
v_mfma_f32_16x16x32_bf16 a[64:67], a[192:195], v[88:91], a[64:67]
v_cvt_pk_bf16_f32 v81, v26, v27
v_mfma_f32_16x16x32_bf16 a[68:71], a[192:195], v[92:95], a[68:71]
v_exp_f32 v28, v28
v_mfma_f32_16x16x32_bf16 a[72:75], a[192:195], v[96:99], a[72:75]
s_add_u32 m0, s88, 82944
s_lshl2_add_u32 s50, m0, s89
buffer_load_dwordx4 v243, s[56:59], s50 offen  lds
v_mfma_f32_16x16x32_bf16 a[76:79], a[192:195], v[100:103], a[76:79]
v_exp_f32 v29, v29
v_mfma_f32_16x16x32_bf16 v[52:55], a[160:163], v[168:171], v[140:143]
ds_read_b64_tr_b16 a[192:193], v224 offset:32768
v_cvt_pk_bf16_f32 v82, v28, v29
v_mfma_f32_16x16x32_bf16 v[52:55], a[164:167], v[172:175], v[52:55]
v_exp_f32 v30, v30
v_mfma_f32_16x16x32_bf16 v[52:55], a[168:171], v[176:179], v[52:55]
ds_read_b64_tr_b16 a[194:195], v224 offset:36864
v_mfma_f32_16x16x32_bf16 v[52:55], a[172:175], v[180:183], v[52:55]
v_exp_f32 v31, v31
v_mfma_f32_16x16x32_bf16 a[80:83], a[196:199], v[88:91], a[80:83]
v_cvt_pk_bf16_f32 v83, v30, v31
v_mfma_f32_16x16x32_bf16 a[84:87], a[196:199], v[92:95], a[84:87]
v_exp_f32 v32, v32
v_mfma_f32_16x16x32_bf16 a[88:91], a[196:199], v[96:99], a[88:91]
s_add_u32 m0, s88, 86400
s_lshl2_add_u32 s50, m0, s89
buffer_load_dwordx4 v243, s[56:59], s50 offen  lds
v_mfma_f32_16x16x32_bf16 a[92:95], a[196:199], v[100:103], a[92:95]
v_exp_f32 v33, v33
v_mfma_f32_16x16x32_bf16 v[60:63], a[160:163], v[184:187], v[144:147]
ds_read_b64_tr_b16 a[196:197], v225 offset:32768
v_cvt_pk_bf16_f32 v84, v32, v33
v_mfma_f32_16x16x32_bf16 v[60:63], a[164:167], v[188:191], v[60:63]
v_exp_f32 v34, v34
v_mfma_f32_16x16x32_bf16 v[60:63], a[168:171], v[192:195], v[60:63]
ds_read_b64_tr_b16 a[198:199], v225 offset:36864
v_mfma_f32_16x16x32_bf16 v[60:63], a[172:175], v[196:199], v[60:63]
v_exp_f32 v35, v35
v_mfma_f32_16x16x32_bf16 a[96:99], a[200:203], v[88:91], a[96:99]
v_cvt_pk_bf16_f32 v85, v34, v35
v_mfma_f32_16x16x32_bf16 a[100:103], a[200:203], v[92:95], a[100:103]
v_exp_f32 v36, v36
v_mfma_f32_16x16x32_bf16 a[104:107], a[200:203], v[96:99], a[104:107]
s_add_u32 m0, s88, 89856
s_lshl2_add_u32 s50, m0, s89
buffer_load_dwordx4 v243, s[56:59], s50 offen  lds
v_mfma_f32_16x16x32_bf16 a[108:111], a[200:203], v[100:103], a[108:111]
v_exp_f32 v37, v37
v_mfma_f32_16x16x32_bf16 v[68:71], a[160:163], v[200:203], v[148:151]
ds_read_b64_tr_b16 a[200:201], v226 offset:32768
v_cvt_pk_bf16_f32 v86, v36, v37
v_mfma_f32_16x16x32_bf16 v[68:71], a[164:167], v[204:207], v[68:71]
v_exp_f32 v38, v38
v_mfma_f32_16x16x32_bf16 v[68:71], a[168:171], v[208:211], v[68:71]
ds_read_b64_tr_b16 a[202:203], v226 offset:36864
ds_read_b128 a[160:163], v216 offset:53248
v_mfma_f32_16x16x32_bf16 v[68:71], a[172:175], v[212:215], v[68:71]
v_exp_f32 v39, v39
v_mfma_f32_16x16x32_bf16 a[112:115], a[204:207], v[88:91], a[112:115]
ds_read_b128 a[164:167], v217 offset:53248
v_cvt_pk_bf16_f32 v87, v38, v39
v_mfma_f32_16x16x32_bf16 a[116:119], a[204:207], v[92:95], a[116:119]
ds_read_b128 a[168:171], v218 offset:53248
ds_read_b128 a[172:175], v219 offset:53248
v_mfma_f32_16x16x32_bf16 a[120:123], a[204:207], v[96:99], a[120:123]
s_add_u32 m0, s88, 93312
s_lshl2_add_u32 s50, m0, s89
buffer_load_dwordx4 v243, s[56:59], s50 offen  lds
v_mfma_f32_16x16x32_bf16 a[124:127], a[204:207], v[100:103], a[124:127]
ds_read_b64_tr_b16 a[204:205], v227 offset:32768
ds_read_b64_tr_b16 a[206:207], v227 offset:36864
v_smfmac_f32_16x16x64_bf16 a[132:135], a[208:211], v[96:103], v245
s_waitcnt lgkmcnt(8)
v_mfma_f32_16x16x32_bf16 v[8:11], a[144:147], v[152:155], v[136:139]
v_exp_f32 v40, v40
v_mfma_f32_16x16x32_bf16 v[8:11], a[148:151], v[156:159], v[8:11]
v_exp_f32 v41, v41
v_mfma_f32_16x16x32_bf16 v[8:11], a[152:155], v[160:163], v[8:11]
v_cvt_pk_bf16_f32 v88, v40, v41
v_mfma_f32_16x16x32_bf16 v[8:11], a[156:159], v[164:167], v[8:11]
v_exp_f32 v42, v42
v_mfma_f32_16x16x32_bf16 a[0:3], a[176:179], v[72:75], a[0:3]
s_add_u32 m0, s88, 96768
s_lshl2_add_u32 s50, m0, s89
buffer_load_dwordx4 v243, s[56:59], s50 offen  lds
v_mfma_f32_16x16x32_bf16 a[4:7], a[176:179], v[76:79], a[4:7]
v_exp_f32 v43, v43
v_mfma_f32_16x16x32_bf16 a[8:11], a[176:179], v[80:83], a[8:11]
v_cvt_pk_bf16_f32 v89, v42, v43
v_mfma_f32_16x16x32_bf16 a[12:15], a[176:179], v[84:87], a[12:15]
v_exp_f32 v44, v44
v_mfma_f32_16x16x32_bf16 v[16:19], a[144:147], v[168:171], v[140:143]
ds_read_b64_tr_b16 a[176:177], v220 offset:40960
ds_read_b64_tr_b16 a[178:179], v220 offset:45056
v_mfma_f32_16x16x32_bf16 v[16:19], a[148:151], v[172:175], v[16:19]
v_exp_f32 v45, v45
v_mfma_f32_16x16x32_bf16 v[16:19], a[152:155], v[176:179], v[16:19]
v_cvt_pk_bf16_f32 v90, v44, v45
v_mfma_f32_16x16x32_bf16 v[16:19], a[156:159], v[180:183], v[16:19]
v_exp_f32 v46, v46
v_mfma_f32_16x16x32_bf16 a[16:19], a[180:183], v[72:75], a[16:19]
v_mfma_f32_16x16x32_bf16 a[20:23], a[180:183], v[76:79], a[20:23]
v_exp_f32 v47, v47
v_mfma_f32_16x16x32_bf16 a[24:27], a[180:183], v[80:83], a[24:27]
v_cvt_pk_bf16_f32 v91, v46, v47
v_mfma_f32_16x16x32_bf16 a[28:31], a[180:183], v[84:87], a[28:31]
v_exp_f32 v48, v48
v_mfma_f32_16x16x32_bf16 v[24:27], a[144:147], v[184:187], v[144:147]
ds_read_b64_tr_b16 a[180:181], v221 offset:40960
ds_read_b64_tr_b16 a[182:183], v221 offset:45056
v_mfma_f32_16x16x32_bf16 v[24:27], a[148:151], v[188:191], v[24:27]
v_exp_f32 v49, v49
v_mfma_f32_16x16x32_bf16 v[24:27], a[152:155], v[192:195], v[24:27]
v_cvt_pk_bf16_f32 v92, v48, v49
v_mfma_f32_16x16x32_bf16 v[24:27], a[156:159], v[196:199], v[24:27]
v_exp_f32 v50, v50
v_mfma_f32_16x16x32_bf16 a[32:35], a[184:187], v[72:75], a[32:35]
s_add_u32 m0, s88, 100224
s_lshl2_add_u32 s50, m0, s89
buffer_load_dwordx4 v243, s[56:59], s50 offen  lds
v_mfma_f32_16x16x32_bf16 a[36:39], a[184:187], v[76:79], a[36:39]
v_exp_f32 v51, v51
v_mfma_f32_16x16x32_bf16 a[40:43], a[184:187], v[80:83], a[40:43]
v_cvt_pk_bf16_f32 v93, v50, v51
v_mfma_f32_16x16x32_bf16 a[44:47], a[184:187], v[84:87], a[44:47]
v_exp_f32 v52, v52
v_mfma_f32_16x16x32_bf16 v[32:35], a[144:147], v[200:203], v[148:151]
ds_read_b64_tr_b16 a[184:185], v222 offset:40960
ds_read_b64_tr_b16 a[186:187], v222 offset:45056
v_mfma_f32_16x16x32_bf16 v[32:35], a[148:151], v[204:207], v[32:35]
v_exp_f32 v53, v53
v_mfma_f32_16x16x32_bf16 v[32:35], a[152:155], v[208:211], v[32:35]
ds_read_b128 a[144:147], v216 offset:57344
v_cvt_pk_bf16_f32 v94, v52, v53
v_mfma_f32_16x16x32_bf16 v[32:35], a[156:159], v[212:215], v[32:35]
v_exp_f32 v54, v54
v_mfma_f32_16x16x32_bf16 a[48:51], a[188:191], v[72:75], a[48:51]
ds_read_b128 a[148:151], v217 offset:57344
ds_read_b128 a[152:155], v218 offset:57344
v_mfma_f32_16x16x32_bf16 a[52:55], a[188:191], v[76:79], a[52:55]
v_exp_f32 v55, v55
v_mfma_f32_16x16x32_bf16 a[56:59], a[188:191], v[80:83], a[56:59]
ds_read_b128 a[156:159], v219 offset:57344
v_cvt_pk_bf16_f32 v95, v54, v55
v_mfma_f32_16x16x32_bf16 a[60:63], a[188:191], v[84:87], a[60:63]
v_exp_f32 v56, v56
v_smfmac_f32_16x16x64_bf16 a[128:131], a[208:211], v[72:79], v245
v_exp_f32 v57, v57
s_waitcnt lgkmcnt(8)
v_mfma_f32_16x16x32_bf16 v[12:15], a[160:163], v[152:155], v[136:139]
ds_read_b64_tr_b16 a[188:189], v223 offset:40960
v_cvt_pk_bf16_f32 v96, v56, v57
v_mfma_f32_16x16x32_bf16 v[12:15], a[164:167], v[156:159], v[12:15]
v_exp_f32 v58, v58
v_mfma_f32_16x16x32_bf16 v[12:15], a[168:171], v[160:163], v[12:15]
ds_read_b64_tr_b16 a[190:191], v223 offset:45056
v_mfma_f32_16x16x32_bf16 v[12:15], a[172:175], v[164:167], v[12:15]
v_exp_f32 v59, v59
v_mfma_f32_16x16x32_bf16 a[64:67], a[192:195], v[72:75], a[64:67]
v_cvt_pk_bf16_f32 v97, v58, v59
v_mfma_f32_16x16x32_bf16 a[68:71], a[192:195], v[76:79], a[68:71]
v_exp_f32 v60, v60
v_mfma_f32_16x16x32_bf16 a[72:75], a[192:195], v[80:83], a[72:75]
s_add_u32 m0, s88, 103680
s_lshl2_add_u32 s50, m0, s89
buffer_load_dwordx4 v243, s[56:59], s50 offen  lds
v_mfma_f32_16x16x32_bf16 a[76:79], a[192:195], v[84:87], a[76:79]
v_exp_f32 v61, v61
v_mfma_f32_16x16x32_bf16 v[20:23], a[160:163], v[168:171], v[140:143]
ds_read_b64_tr_b16 a[192:193], v224 offset:40960
v_cvt_pk_bf16_f32 v98, v60, v61
v_mfma_f32_16x16x32_bf16 v[20:23], a[164:167], v[172:175], v[20:23]
v_exp_f32 v62, v62
v_mfma_f32_16x16x32_bf16 v[20:23], a[168:171], v[176:179], v[20:23]
ds_read_b64_tr_b16 a[194:195], v224 offset:45056
v_mfma_f32_16x16x32_bf16 v[20:23], a[172:175], v[180:183], v[20:23]
v_exp_f32 v63, v63
v_mfma_f32_16x16x32_bf16 a[80:83], a[196:199], v[72:75], a[80:83]
v_cvt_pk_bf16_f32 v99, v62, v63
v_mfma_f32_16x16x32_bf16 a[84:87], a[196:199], v[76:79], a[84:87]
v_exp_f32 v64, v64
v_mfma_f32_16x16x32_bf16 a[88:91], a[196:199], v[80:83], a[88:91]
s_add_u32 m0, s88, 107136
s_lshl2_add_u32 s50, m0, s89
buffer_load_dwordx4 v243, s[56:59], s50 offen  lds
v_mfma_f32_16x16x32_bf16 a[92:95], a[196:199], v[84:87], a[92:95]
v_exp_f32 v65, v65
v_mfma_f32_16x16x32_bf16 v[28:31], a[160:163], v[184:187], v[144:147]
ds_read_b64_tr_b16 a[196:197], v225 offset:40960
v_cvt_pk_bf16_f32 v100, v64, v65
v_mfma_f32_16x16x32_bf16 v[28:31], a[164:167], v[188:191], v[28:31]
v_exp_f32 v66, v66
v_mfma_f32_16x16x32_bf16 v[28:31], a[168:171], v[192:195], v[28:31]
ds_read_b64_tr_b16 a[198:199], v225 offset:45056
v_mfma_f32_16x16x32_bf16 v[28:31], a[172:175], v[196:199], v[28:31]
v_exp_f32 v67, v67
v_mfma_f32_16x16x32_bf16 a[96:99], a[200:203], v[72:75], a[96:99]
v_cvt_pk_bf16_f32 v101, v66, v67
v_mfma_f32_16x16x32_bf16 a[100:103], a[200:203], v[76:79], a[100:103]
v_exp_f32 v68, v68
v_mfma_f32_16x16x32_bf16 a[104:107], a[200:203], v[80:83], a[104:107]
s_add_u32 m0, s88, 110592
s_lshl2_add_u32 s50, m0, s89
buffer_load_dwordx4 v243, s[56:59], s50 offen  lds
v_mfma_f32_16x16x32_bf16 a[108:111], a[200:203], v[84:87], a[108:111]
v_exp_f32 v69, v69
v_mfma_f32_16x16x32_bf16 v[36:39], a[160:163], v[200:203], v[148:151]
ds_read_b64_tr_b16 a[200:201], v226 offset:40960
v_cvt_pk_bf16_f32 v102, v68, v69
v_mfma_f32_16x16x32_bf16 v[36:39], a[164:167], v[204:207], v[36:39]
v_exp_f32 v70, v70
v_mfma_f32_16x16x32_bf16 v[36:39], a[168:171], v[208:211], v[36:39]
ds_read_b64_tr_b16 a[202:203], v226 offset:45056
ds_read_b128 a[160:163], v216 offset:61440
v_mfma_f32_16x16x32_bf16 v[36:39], a[172:175], v[212:215], v[36:39]
v_exp_f32 v71, v71
v_mfma_f32_16x16x32_bf16 a[112:115], a[204:207], v[72:75], a[112:115]
ds_read_b128 a[164:167], v217 offset:61440
v_cvt_pk_bf16_f32 v103, v70, v71
v_mfma_f32_16x16x32_bf16 a[116:119], a[204:207], v[76:79], a[116:119]
ds_read_b128 a[168:171], v218 offset:61440
ds_read_b128 a[172:175], v219 offset:61440
v_mfma_f32_16x16x32_bf16 a[120:123], a[204:207], v[80:83], a[120:123]
v_mfma_f32_16x16x32_bf16 a[124:127], a[204:207], v[84:87], a[124:127]
ds_read_b64_tr_b16 a[204:205], v227 offset:40960
ds_read_b64_tr_b16 a[206:207], v227 offset:45056
v_smfmac_f32_16x16x64_bf16 a[132:135], a[208:211], v[80:87], v245
s_waitcnt lgkmcnt(8)
v_mfma_f32_16x16x32_bf16 v[40:43], a[144:147], v[152:155], v[136:139]
v_exp_f32 v8, v8
v_mfma_f32_16x16x32_bf16 v[40:43], a[148:151], v[156:159], v[40:43]
v_exp_f32 v9, v9
v_mfma_f32_16x16x32_bf16 v[40:43], a[152:155], v[160:163], v[40:43]
v_cvt_pk_bf16_f32 v72, v8, v9
v_mfma_f32_16x16x32_bf16 v[40:43], a[156:159], v[164:167], v[40:43]
v_exp_f32 v10, v10
v_mfma_f32_16x16x32_bf16 a[0:3], a[176:179], v[88:91], a[0:3]
v_mfma_f32_16x16x32_bf16 a[4:7], a[176:179], v[92:95], a[4:7]
v_exp_f32 v11, v11
v_mfma_f32_16x16x32_bf16 a[8:11], a[176:179], v[96:99], a[8:11]
v_cvt_pk_bf16_f32 v73, v10, v11
v_mfma_f32_16x16x32_bf16 a[12:15], a[176:179], v[100:103], a[12:15]
s_waitcnt vmcnt(13) lgkmcnt(0)
s_barrier
v_mfma_f32_16x16x32_bf16 v[48:51], a[144:147], v[168:171], v[140:143]
v_exp_f32 v12, v12
v_mfma_f32_16x16x32_bf16 v[48:51], a[148:151], v[172:175], v[48:51]
v_exp_f32 v13, v13
v_mfma_f32_16x16x32_bf16 v[48:51], a[152:155], v[176:179], v[48:51]
ds_read_b64_tr_b16 a[176:177], v220 offset:49152
v_cvt_pk_bf16_f32 v74, v12, v13
v_mfma_f32_16x16x32_bf16 v[48:51], a[156:159], v[180:183], v[48:51]
v_exp_f32 v14, v14
v_mfma_f32_16x16x32_bf16 a[16:19], a[180:183], v[88:91], a[16:19]
ds_read_b64_tr_b16 a[178:179], v220 offset:53248
v_mfma_f32_16x16x32_bf16 a[20:23], a[180:183], v[92:95], a[20:23]
v_exp_f32 v15, v15
v_mfma_f32_16x16x32_bf16 a[24:27], a[180:183], v[96:99], a[24:27]
v_cvt_pk_bf16_f32 v75, v14, v15
v_mfma_f32_16x16x32_bf16 a[28:31], a[180:183], v[100:103], a[28:31]
v_exp_f32 v16, v16
v_mfma_f32_16x16x32_bf16 v[56:59], a[144:147], v[184:187], v[144:147]
ds_read_b64_tr_b16 a[180:181], v221 offset:49152
ds_read_b64_tr_b16 a[182:183], v221 offset:53248
v_mfma_f32_16x16x32_bf16 v[56:59], a[148:151], v[188:191], v[56:59]
v_exp_f32 v17, v17
v_mfma_f32_16x16x32_bf16 v[56:59], a[152:155], v[192:195], v[56:59]
v_cvt_pk_bf16_f32 v76, v16, v17
v_mfma_f32_16x16x32_bf16 v[56:59], a[156:159], v[196:199], v[56:59]
v_exp_f32 v18, v18
v_mfma_f32_16x16x32_bf16 a[32:35], a[184:187], v[88:91], a[32:35]
s_add_u32 m0, s88, 114048
s_lshl2_add_u32 s50, m0, s89
buffer_load_dwordx4 v243, s[56:59], s50 offen  lds
v_mfma_f32_16x16x32_bf16 a[36:39], a[184:187], v[92:95], a[36:39]
v_exp_f32 v19, v19
v_mfma_f32_16x16x32_bf16 a[40:43], a[184:187], v[96:99], a[40:43]
v_cvt_pk_bf16_f32 v77, v18, v19
v_mfma_f32_16x16x32_bf16 a[44:47], a[184:187], v[100:103], a[44:47]
v_exp_f32 v20, v20
v_mfma_f32_16x16x32_bf16 v[64:67], a[144:147], v[200:203], v[148:151]
ds_read_b64_tr_b16 a[184:185], v222 offset:49152
ds_read_b64_tr_b16 a[186:187], v222 offset:53248
v_mfma_f32_16x16x32_bf16 v[64:67], a[148:151], v[204:207], v[64:67]
v_exp_f32 v21, v21
v_mfma_f32_16x16x32_bf16 v[64:67], a[152:155], v[208:211], v[64:67]
v_cvt_pk_bf16_f32 v78, v20, v21
v_mfma_f32_16x16x32_bf16 v[64:67], a[156:159], v[212:215], v[64:67]
v_exp_f32 v22, v22
v_mfma_f32_16x16x32_bf16 a[48:51], a[188:191], v[88:91], a[48:51]
s_add_u32 m0, s88, 117504
s_lshl2_add_u32 s50, m0, s89
buffer_load_dwordx4 v243, s[56:59], s50 offen  lds
v_mfma_f32_16x16x32_bf16 a[52:55], a[188:191], v[92:95], a[52:55]
v_exp_f32 v23, v23
v_mfma_f32_16x16x32_bf16 a[56:59], a[188:191], v[96:99], a[56:59]
v_cvt_pk_bf16_f32 v79, v22, v23
v_mfma_f32_16x16x32_bf16 a[60:63], a[188:191], v[100:103], a[60:63]
v_exp_f32 v24, v24
v_smfmac_f32_16x16x64_bf16 a[128:131], a[208:211], v[88:95], v245
v_exp_f32 v25, v25
v_mfma_f32_16x16x32_bf16 v[44:47], a[160:163], v[152:155], v[136:139]
ds_read_b64_tr_b16 a[188:189], v223 offset:49152
v_cvt_pk_bf16_f32 v80, v24, v25
v_mfma_f32_16x16x32_bf16 v[44:47], a[164:167], v[156:159], v[44:47]
v_exp_f32 v26, v26
v_mfma_f32_16x16x32_bf16 v[44:47], a[168:171], v[160:163], v[44:47]
ds_read_b64_tr_b16 a[190:191], v223 offset:53248
v_mfma_f32_16x16x32_bf16 v[44:47], a[172:175], v[164:167], v[44:47]
v_exp_f32 v27, v27
v_mfma_f32_16x16x32_bf16 a[64:67], a[192:195], v[88:91], a[64:67]
v_cvt_pk_bf16_f32 v81, v26, v27
v_mfma_f32_16x16x32_bf16 a[68:71], a[192:195], v[92:95], a[68:71]
v_exp_f32 v28, v28
v_mfma_f32_16x16x32_bf16 a[72:75], a[192:195], v[96:99], a[72:75]
s_add_u32 m0, s88, 120960
s_lshl2_add_u32 s50, m0, s89
buffer_load_dwordx4 v243, s[56:59], s50 offen  lds
v_mfma_f32_16x16x32_bf16 a[76:79], a[192:195], v[100:103], a[76:79]
v_exp_f32 v29, v29
v_mfma_f32_16x16x32_bf16 v[52:55], a[160:163], v[168:171], v[140:143]
ds_read_b64_tr_b16 a[192:193], v224 offset:49152
v_cvt_pk_bf16_f32 v82, v28, v29
v_mfma_f32_16x16x32_bf16 v[52:55], a[164:167], v[172:175], v[52:55]
v_exp_f32 v30, v30
v_mfma_f32_16x16x32_bf16 v[52:55], a[168:171], v[176:179], v[52:55]
ds_read_b64_tr_b16 a[194:195], v224 offset:53248
v_mfma_f32_16x16x32_bf16 v[52:55], a[172:175], v[180:183], v[52:55]
v_exp_f32 v31, v31
v_mfma_f32_16x16x32_bf16 a[80:83], a[196:199], v[88:91], a[80:83]
v_cvt_pk_bf16_f32 v83, v30, v31
v_mfma_f32_16x16x32_bf16 a[84:87], a[196:199], v[92:95], a[84:87]
v_exp_f32 v32, v32
v_mfma_f32_16x16x32_bf16 a[88:91], a[196:199], v[96:99], a[88:91]
s_add_u32 m0, s88, 124416
s_lshl2_add_u32 s50, m0, s89
buffer_load_dwordx4 v243, s[56:59], s50 offen  lds
v_mfma_f32_16x16x32_bf16 a[92:95], a[196:199], v[100:103], a[92:95]
v_exp_f32 v33, v33
v_mfma_f32_16x16x32_bf16 v[60:63], a[160:163], v[184:187], v[144:147]
ds_read_b64_tr_b16 a[196:197], v225 offset:49152
v_cvt_pk_bf16_f32 v84, v32, v33
v_mfma_f32_16x16x32_bf16 v[60:63], a[164:167], v[188:191], v[60:63]
v_exp_f32 v34, v34
v_mfma_f32_16x16x32_bf16 v[60:63], a[168:171], v[192:195], v[60:63]
ds_read_b64_tr_b16 a[198:199], v225 offset:53248
v_mfma_f32_16x16x32_bf16 v[60:63], a[172:175], v[196:199], v[60:63]
v_exp_f32 v35, v35
v_mfma_f32_16x16x32_bf16 a[96:99], a[200:203], v[88:91], a[96:99]
v_cvt_pk_bf16_f32 v85, v34, v35
v_mfma_f32_16x16x32_bf16 a[100:103], a[200:203], v[92:95], a[100:103]
v_exp_f32 v36, v36
v_mfma_f32_16x16x32_bf16 a[104:107], a[200:203], v[96:99], a[104:107]
s_add_u32 m0, s88, 127872
s_lshl2_add_u32 s50, m0, s89
buffer_load_dwordx4 v243, s[56:59], s50 offen  lds
v_mfma_f32_16x16x32_bf16 a[108:111], a[200:203], v[100:103], a[108:111]
v_exp_f32 v37, v37
v_mfma_f32_16x16x32_bf16 v[68:71], a[160:163], v[200:203], v[148:151]
ds_read_b64_tr_b16 a[200:201], v226 offset:49152
v_cvt_pk_bf16_f32 v86, v36, v37
v_mfma_f32_16x16x32_bf16 v[68:71], a[164:167], v[204:207], v[68:71]
v_exp_f32 v38, v38
v_mfma_f32_16x16x32_bf16 v[68:71], a[168:171], v[208:211], v[68:71]
ds_read_b64_tr_b16 a[202:203], v226 offset:53248
v_mfma_f32_16x16x32_bf16 v[68:71], a[172:175], v[212:215], v[68:71]
v_exp_f32 v39, v39
v_mfma_f32_16x16x32_bf16 a[112:115], a[204:207], v[88:91], a[112:115]
v_cvt_pk_bf16_f32 v87, v38, v39
v_mfma_f32_16x16x32_bf16 a[116:119], a[204:207], v[92:95], a[116:119]
s_add_u32 m0, s88, 131328
s_lshl2_add_u32 s50, m0, s89
buffer_load_dwordx4 v243, s[56:59], s50 offen  lds
v_mfma_f32_16x16x32_bf16 a[120:123], a[204:207], v[96:99], a[120:123]
s_add_u32 m0, s88, 134784
s_lshl2_add_u32 s50, m0, s89
buffer_load_dwordx4 v243, s[56:59], s50 offen  lds
v_mfma_f32_16x16x32_bf16 a[124:127], a[204:207], v[100:103], a[124:127]
ds_read_b64_tr_b16 a[204:205], v227 offset:49152
ds_read_b64_tr_b16 a[206:207], v227 offset:53248
v_smfmac_f32_16x16x64_bf16 a[132:135], a[208:211], v[96:103], v245
s_waitcnt lgkmcnt(8)
v_mfma_f32_16x16x32_bf16 a[0:3], a[176:179], v[72:75], a[0:3]
v_exp_f32 v40, v40
v_exp_f32 v41, v41
v_mfma_f32_16x16x32_bf16 a[4:7], a[176:179], v[76:79], a[4:7]
v_cvt_pk_bf16_f32 v88, v40, v41
v_exp_f32 v42, v42
v_mfma_f32_16x16x32_bf16 a[8:11], a[176:179], v[80:83], a[8:11]
v_exp_f32 v43, v43
v_mfma_f32_16x16x32_bf16 a[12:15], a[176:179], v[84:87], a[12:15]
ds_read_b64_tr_b16 a[176:177], v220 offset:57344
v_cvt_pk_bf16_f32 v89, v42, v43
v_exp_f32 v44, v44
v_mfma_f32_16x16x32_bf16 a[16:19], a[180:183], v[72:75], a[16:19]
ds_read_b64_tr_b16 a[178:179], v220 offset:61440
v_exp_f32 v45, v45
v_mfma_f32_16x16x32_bf16 a[20:23], a[180:183], v[76:79], a[20:23]
v_cvt_pk_bf16_f32 v90, v44, v45
v_exp_f32 v46, v46
v_mfma_f32_16x16x32_bf16 a[24:27], a[180:183], v[80:83], a[24:27]
v_exp_f32 v47, v47
v_mfma_f32_16x16x32_bf16 a[28:31], a[180:183], v[84:87], a[28:31]
ds_read_b64_tr_b16 a[180:181], v221 offset:57344
v_cvt_pk_bf16_f32 v91, v46, v47
v_exp_f32 v48, v48
v_mfma_f32_16x16x32_bf16 a[32:35], a[184:187], v[72:75], a[32:35]
ds_read_b64_tr_b16 a[182:183], v221 offset:61440
v_exp_f32 v49, v49
v_mfma_f32_16x16x32_bf16 a[36:39], a[184:187], v[76:79], a[36:39]
v_cvt_pk_bf16_f32 v92, v48, v49
v_exp_f32 v50, v50
v_mfma_f32_16x16x32_bf16 a[40:43], a[184:187], v[80:83], a[40:43]
v_exp_f32 v51, v51
v_mfma_f32_16x16x32_bf16 a[44:47], a[184:187], v[84:87], a[44:47]
ds_read_b64_tr_b16 a[184:185], v222 offset:57344
v_cvt_pk_bf16_f32 v93, v50, v51
v_exp_f32 v52, v52
v_mfma_f32_16x16x32_bf16 a[48:51], a[188:191], v[72:75], a[48:51]
ds_read_b64_tr_b16 a[186:187], v222 offset:61440
v_exp_f32 v53, v53
v_mfma_f32_16x16x32_bf16 a[52:55], a[188:191], v[76:79], a[52:55]
v_cvt_pk_bf16_f32 v94, v52, v53
v_exp_f32 v54, v54
v_mfma_f32_16x16x32_bf16 a[56:59], a[188:191], v[80:83], a[56:59]
v_exp_f32 v55, v55
v_mfma_f32_16x16x32_bf16 a[60:63], a[188:191], v[84:87], a[60:63]
v_exp_f32 v56, v56
v_exp_f32 v57, v57
v_smfmac_f32_16x16x64_bf16 a[128:131], a[208:211], v[72:79], v245
v_cvt_pk_bf16_f32 v95, v54, v55
v_cvt_pk_bf16_f32 v96, v56, v57
v_exp_f32 v58, v58
s_waitcnt lgkmcnt(8)
v_mfma_f32_16x16x32_bf16 a[64:67], a[192:195], v[72:75], a[64:67]
ds_read_b64_tr_b16 a[188:189], v223 offset:57344
ds_read_b64_tr_b16 a[190:191], v223 offset:61440
v_exp_f32 v59, v59
v_mfma_f32_16x16x32_bf16 a[68:71], a[192:195], v[76:79], a[68:71]
v_cvt_pk_bf16_f32 v97, v58, v59
v_exp_f32 v60, v60
v_mfma_f32_16x16x32_bf16 a[72:75], a[192:195], v[80:83], a[72:75]
v_exp_f32 v61, v61
v_mfma_f32_16x16x32_bf16 a[76:79], a[192:195], v[84:87], a[76:79]
ds_read_b64_tr_b16 a[192:193], v224 offset:57344
v_cvt_pk_bf16_f32 v98, v60, v61
v_exp_f32 v62, v62
v_mfma_f32_16x16x32_bf16 a[80:83], a[196:199], v[72:75], a[80:83]
ds_read_b64_tr_b16 a[194:195], v224 offset:61440
v_exp_f32 v63, v63
v_mfma_f32_16x16x32_bf16 a[84:87], a[196:199], v[76:79], a[84:87]
v_cvt_pk_bf16_f32 v99, v62, v63
v_exp_f32 v64, v64
v_mfma_f32_16x16x32_bf16 a[88:91], a[196:199], v[80:83], a[88:91]
v_exp_f32 v65, v65
v_mfma_f32_16x16x32_bf16 a[92:95], a[196:199], v[84:87], a[92:95]
ds_read_b64_tr_b16 a[196:197], v225 offset:57344
v_cvt_pk_bf16_f32 v100, v64, v65
v_exp_f32 v66, v66
v_mfma_f32_16x16x32_bf16 a[96:99], a[200:203], v[72:75], a[96:99]
ds_read_b64_tr_b16 a[198:199], v225 offset:61440
v_exp_f32 v67, v67
v_mfma_f32_16x16x32_bf16 a[100:103], a[200:203], v[76:79], a[100:103]
v_cvt_pk_bf16_f32 v101, v66, v67
v_exp_f32 v68, v68
v_mfma_f32_16x16x32_bf16 a[104:107], a[200:203], v[80:83], a[104:107]
v_exp_f32 v69, v69
v_mfma_f32_16x16x32_bf16 a[108:111], a[200:203], v[84:87], a[108:111]
ds_read_b64_tr_b16 a[200:201], v226 offset:57344
v_cvt_pk_bf16_f32 v102, v68, v69
v_exp_f32 v70, v70
s_waitcnt lgkmcnt(8)
v_mfma_f32_16x16x32_bf16 a[112:115], a[204:207], v[72:75], a[112:115]
ds_read_b64_tr_b16 a[202:203], v226 offset:61440
v_exp_f32 v71, v71
v_mfma_f32_16x16x32_bf16 a[116:119], a[204:207], v[76:79], a[116:119]
s_add_u32 m0, s88, 138240
s_lshl2_add_u32 s50, m0, s89
buffer_load_dwordx4 v243, s[56:59], s50 offen  lds
v_cvt_pk_bf16_f32 v103, v70, v71
v_mfma_f32_16x16x32_bf16 a[120:123], a[204:207], v[80:83], a[120:123]
s_add_u32 m0, s88, 141696
s_lshl2_add_u32 s50, m0, s89
buffer_load_dwordx4 v243, s[56:59], s50 offen  lds
v_mfma_f32_16x16x32_bf16 a[124:127], a[204:207], v[84:87], a[124:127]
ds_read_b64_tr_b16 a[204:205], v227 offset:57344
ds_read_b64_tr_b16 a[206:207], v227 offset:61440
v_smfmac_f32_16x16x64_bf16 a[132:135], a[208:211], v[80:87], v245
s_add_u32 m0, s88, 145152
s_min_u32 m0, m0, 146880
s_lshl2_add_u32 s50, m0, s89
s_cmp_ge_u32 s37, 2
s_cselect_b32 exec_hi, 15, -1
buffer_load_dwordx4 v243, s[56:59], s50 offen  lds
s_mov_b32 exec_hi, -1
s_cmp_eq_u32 s48, 0
s_cbranch_scc1 K_MIXED
s_waitcnt lgkmcnt(0)
s_barrier
v_smfmac_f32_16x16x64_bf16 a[128:131], a[208:211], v[88:95], v245
v_smfmac_f32_16x16x64_bf16 a[132:135], a[208:211], v[96:103], v245
v_mfma_f32_16x16x32_bf16 a[0:3], a[176:179], v[88:91], a[0:3]
v_mfma_f32_16x16x32_bf16 a[16:19], a[180:183], v[88:91], a[16:19]
v_mfma_f32_16x16x32_bf16 a[32:35], a[184:187], v[88:91], a[32:35]
v_mfma_f32_16x16x32_bf16 a[48:51], a[188:191], v[88:91], a[48:51]
v_mfma_f32_16x16x32_bf16 a[64:67], a[192:195], v[88:91], a[64:67]
v_mfma_f32_16x16x32_bf16 a[80:83], a[196:199], v[88:91], a[80:83]
v_mfma_f32_16x16x32_bf16 a[96:99], a[200:203], v[88:91], a[96:99]
v_mfma_f32_16x16x32_bf16 a[112:115], a[204:207], v[88:91], a[112:115]
v_mfma_f32_16x16x32_bf16 a[4:7], a[176:179], v[92:95], a[4:7]
v_mfma_f32_16x16x32_bf16 a[20:23], a[180:183], v[92:95], a[20:23]
v_mfma_f32_16x16x32_bf16 a[36:39], a[184:187], v[92:95], a[36:39]
v_mfma_f32_16x16x32_bf16 a[52:55], a[188:191], v[92:95], a[52:55]
v_mfma_f32_16x16x32_bf16 a[68:71], a[192:195], v[92:95], a[68:71]
v_mfma_f32_16x16x32_bf16 a[84:87], a[196:199], v[92:95], a[84:87]
v_mfma_f32_16x16x32_bf16 a[100:103], a[200:203], v[92:95], a[100:103]
v_mfma_f32_16x16x32_bf16 a[116:119], a[204:207], v[92:95], a[116:119]
v_accvgpr_read_b32 v120, a128
v_accvgpr_read_b32 v124, a129
v_add_f32 v120, v120, v124
v_rcp_f32 v124, v120
s_add_u32 s50, s44, 0
v_mov_b32 v125, v124
v_accvgpr_read_b32 v104, a0
v_accvgpr_read_b32 v105, a1
v_accvgpr_read_b32 v106, a2
v_accvgpr_read_b32 v107, a3
v_accvgpr_read_b32 v108, a16
v_accvgpr_read_b32 v109, a17
v_accvgpr_read_b32 v110, a18
v_accvgpr_read_b32 v111, a19
v_pk_mul_f32 v[104:105], v[104:105], v[124:125]
v_pk_mul_f32 v[106:107], v[106:107], v[124:125]
v_pk_mul_f32 v[108:109], v[108:109], v[124:125]
v_pk_mul_f32 v[110:111], v[110:111], v[124:125]
v_cvt_pk_bf16_f32 v8, v104, v105
v_cvt_pk_bf16_f32 v9, v106, v107
v_cvt_pk_bf16_f32 v10, v108, v109
v_cvt_pk_bf16_f32 v11, v110, v111
buffer_store_dwordx4 v[8:11], v244, s[20:23], s50 offen offset:0
v_accvgpr_read_b32 v112, a32
v_accvgpr_read_b32 v113, a33
v_accvgpr_read_b32 v114, a34
v_accvgpr_read_b32 v115, a35
v_accvgpr_read_b32 v116, a48
v_accvgpr_read_b32 v117, a49
v_accvgpr_read_b32 v118, a50
v_accvgpr_read_b32 v119, a51
v_pk_mul_f32 v[112:113], v[112:113], v[124:125]
v_pk_mul_f32 v[114:115], v[114:115], v[124:125]
v_pk_mul_f32 v[116:117], v[116:117], v[124:125]
v_pk_mul_f32 v[118:119], v[118:119], v[124:125]
v_cvt_pk_bf16_f32 v12, v112, v113
v_cvt_pk_bf16_f32 v13, v114, v115
v_cvt_pk_bf16_f32 v14, v116, v117
v_cvt_pk_bf16_f32 v15, v118, v119
buffer_store_dwordx4 v[12:15], v244, s[20:23], s50 offen offset:1024
v_accvgpr_read_b32 v104, a64
v_accvgpr_read_b32 v105, a65
v_accvgpr_read_b32 v106, a66
v_accvgpr_read_b32 v107, a67
v_accvgpr_read_b32 v108, a80
v_accvgpr_read_b32 v109, a81
v_accvgpr_read_b32 v110, a82
v_accvgpr_read_b32 v111, a83
v_pk_mul_f32 v[104:105], v[104:105], v[124:125]
v_pk_mul_f32 v[106:107], v[106:107], v[124:125]
v_pk_mul_f32 v[108:109], v[108:109], v[124:125]
v_pk_mul_f32 v[110:111], v[110:111], v[124:125]
v_cvt_pk_bf16_f32 v16, v104, v105
v_cvt_pk_bf16_f32 v17, v106, v107
v_cvt_pk_bf16_f32 v18, v108, v109
v_cvt_pk_bf16_f32 v19, v110, v111
buffer_store_dwordx4 v[16:19], v244, s[20:23], s50 offen offset:2048
v_accvgpr_read_b32 v112, a96
v_accvgpr_read_b32 v113, a97
v_accvgpr_read_b32 v114, a98
v_accvgpr_read_b32 v115, a99
v_accvgpr_read_b32 v116, a112
v_accvgpr_read_b32 v117, a113
v_accvgpr_read_b32 v118, a114
v_accvgpr_read_b32 v119, a115
v_pk_mul_f32 v[112:113], v[112:113], v[124:125]
v_pk_mul_f32 v[114:115], v[114:115], v[124:125]
v_pk_mul_f32 v[116:117], v[116:117], v[124:125]
v_pk_mul_f32 v[118:119], v[118:119], v[124:125]
v_cvt_pk_bf16_f32 v20, v112, v113
v_cvt_pk_bf16_f32 v21, v114, v115
v_cvt_pk_bf16_f32 v22, v116, v117
v_cvt_pk_bf16_f32 v23, v118, v119
buffer_store_dwordx4 v[20:23], v244, s[20:23], s50 offen offset:3072
v_mfma_f32_16x16x32_bf16 a[8:11], a[176:179], v[96:99], a[8:11]
v_mfma_f32_16x16x32_bf16 a[24:27], a[180:183], v[96:99], a[24:27]
v_mfma_f32_16x16x32_bf16 a[40:43], a[184:187], v[96:99], a[40:43]
v_mfma_f32_16x16x32_bf16 a[56:59], a[188:191], v[96:99], a[56:59]
v_mfma_f32_16x16x32_bf16 a[72:75], a[192:195], v[96:99], a[72:75]
v_mfma_f32_16x16x32_bf16 a[88:91], a[196:199], v[96:99], a[88:91]
v_mfma_f32_16x16x32_bf16 a[104:107], a[200:203], v[96:99], a[104:107]
v_mfma_f32_16x16x32_bf16 a[120:123], a[204:207], v[96:99], a[120:123]
v_accvgpr_read_b32 v121, a130
v_accvgpr_read_b32 v126, a131
v_add_f32 v121, v121, v126
v_rcp_f32 v126, v121
s_add_u32 s50, s44, 4096
v_mov_b32 v127, v126
v_accvgpr_read_b32 v104, a4
v_accvgpr_read_b32 v105, a5
v_accvgpr_read_b32 v106, a6
v_accvgpr_read_b32 v107, a7
v_accvgpr_read_b32 v108, a20
v_accvgpr_read_b32 v109, a21
v_accvgpr_read_b32 v110, a22
v_accvgpr_read_b32 v111, a23
v_pk_mul_f32 v[104:105], v[104:105], v[126:127]
v_pk_mul_f32 v[106:107], v[106:107], v[126:127]
v_pk_mul_f32 v[108:109], v[108:109], v[126:127]
v_pk_mul_f32 v[110:111], v[110:111], v[126:127]
v_cvt_pk_bf16_f32 v24, v104, v105
v_cvt_pk_bf16_f32 v25, v106, v107
v_cvt_pk_bf16_f32 v26, v108, v109
v_cvt_pk_bf16_f32 v27, v110, v111
buffer_store_dwordx4 v[24:27], v244, s[20:23], s50 offen offset:0
v_accvgpr_read_b32 v112, a36
v_accvgpr_read_b32 v113, a37
v_accvgpr_read_b32 v114, a38
v_accvgpr_read_b32 v115, a39
v_accvgpr_read_b32 v116, a52
v_accvgpr_read_b32 v117, a53
v_accvgpr_read_b32 v118, a54
v_accvgpr_read_b32 v119, a55
v_pk_mul_f32 v[112:113], v[112:113], v[126:127]
v_pk_mul_f32 v[114:115], v[114:115], v[126:127]
v_pk_mul_f32 v[116:117], v[116:117], v[126:127]
v_pk_mul_f32 v[118:119], v[118:119], v[126:127]
v_cvt_pk_bf16_f32 v28, v112, v113
v_cvt_pk_bf16_f32 v29, v114, v115
v_cvt_pk_bf16_f32 v30, v116, v117
v_cvt_pk_bf16_f32 v31, v118, v119
buffer_store_dwordx4 v[28:31], v244, s[20:23], s50 offen offset:1024
v_accvgpr_read_b32 v104, a68
v_accvgpr_read_b32 v105, a69
v_accvgpr_read_b32 v106, a70
v_accvgpr_read_b32 v107, a71
v_accvgpr_read_b32 v108, a84
v_accvgpr_read_b32 v109, a85
v_accvgpr_read_b32 v110, a86
v_accvgpr_read_b32 v111, a87
v_pk_mul_f32 v[104:105], v[104:105], v[126:127]
v_pk_mul_f32 v[106:107], v[106:107], v[126:127]
v_pk_mul_f32 v[108:109], v[108:109], v[126:127]
v_pk_mul_f32 v[110:111], v[110:111], v[126:127]
v_cvt_pk_bf16_f32 v32, v104, v105
v_cvt_pk_bf16_f32 v33, v106, v107
v_cvt_pk_bf16_f32 v34, v108, v109
v_cvt_pk_bf16_f32 v35, v110, v111
buffer_store_dwordx4 v[32:35], v244, s[20:23], s50 offen offset:2048
v_accvgpr_read_b32 v112, a100
v_accvgpr_read_b32 v113, a101
v_accvgpr_read_b32 v114, a102
v_accvgpr_read_b32 v115, a103
v_accvgpr_read_b32 v116, a116
v_accvgpr_read_b32 v117, a117
v_accvgpr_read_b32 v118, a118
v_accvgpr_read_b32 v119, a119
v_pk_mul_f32 v[112:113], v[112:113], v[126:127]
v_pk_mul_f32 v[114:115], v[114:115], v[126:127]
v_pk_mul_f32 v[116:117], v[116:117], v[126:127]
v_pk_mul_f32 v[118:119], v[118:119], v[126:127]
v_cvt_pk_bf16_f32 v36, v112, v113
v_cvt_pk_bf16_f32 v37, v114, v115
v_cvt_pk_bf16_f32 v38, v116, v117
v_cvt_pk_bf16_f32 v39, v118, v119
buffer_store_dwordx4 v[36:39], v244, s[20:23], s50 offen offset:3072
v_mfma_f32_16x16x32_bf16 a[12:15], a[176:179], v[100:103], a[12:15]
v_mfma_f32_16x16x32_bf16 a[28:31], a[180:183], v[100:103], a[28:31]
v_mfma_f32_16x16x32_bf16 a[44:47], a[184:187], v[100:103], a[44:47]
v_mfma_f32_16x16x32_bf16 a[60:63], a[188:191], v[100:103], a[60:63]
v_mfma_f32_16x16x32_bf16 a[76:79], a[192:195], v[100:103], a[76:79]
v_mfma_f32_16x16x32_bf16 a[92:95], a[196:199], v[100:103], a[92:95]
v_mfma_f32_16x16x32_bf16 a[108:111], a[200:203], v[100:103], a[108:111]
v_mfma_f32_16x16x32_bf16 a[124:127], a[204:207], v[100:103], a[124:127]
v_accvgpr_read_b32 v122, a132
v_accvgpr_read_b32 v128, a133
v_add_f32 v122, v122, v128
v_rcp_f32 v128, v122
s_add_u32 s50, s44, 8192
v_mov_b32 v129, v128
v_accvgpr_read_b32 v104, a8
v_accvgpr_read_b32 v105, a9
v_accvgpr_read_b32 v106, a10
v_accvgpr_read_b32 v107, a11
v_accvgpr_read_b32 v108, a24
v_accvgpr_read_b32 v109, a25
v_accvgpr_read_b32 v110, a26
v_accvgpr_read_b32 v111, a27
v_pk_mul_f32 v[104:105], v[104:105], v[128:129]
v_pk_mul_f32 v[106:107], v[106:107], v[128:129]
v_pk_mul_f32 v[108:109], v[108:109], v[128:129]
v_pk_mul_f32 v[110:111], v[110:111], v[128:129]
v_cvt_pk_bf16_f32 v40, v104, v105
v_cvt_pk_bf16_f32 v41, v106, v107
v_cvt_pk_bf16_f32 v42, v108, v109
v_cvt_pk_bf16_f32 v43, v110, v111
buffer_store_dwordx4 v[40:43], v244, s[20:23], s50 offen offset:0
v_accvgpr_read_b32 v112, a40
v_accvgpr_read_b32 v113, a41
v_accvgpr_read_b32 v114, a42
v_accvgpr_read_b32 v115, a43
v_accvgpr_read_b32 v116, a56
v_accvgpr_read_b32 v117, a57
v_accvgpr_read_b32 v118, a58
v_accvgpr_read_b32 v119, a59
v_pk_mul_f32 v[112:113], v[112:113], v[128:129]
v_pk_mul_f32 v[114:115], v[114:115], v[128:129]
v_pk_mul_f32 v[116:117], v[116:117], v[128:129]
v_pk_mul_f32 v[118:119], v[118:119], v[128:129]
v_cvt_pk_bf16_f32 v44, v112, v113
v_cvt_pk_bf16_f32 v45, v114, v115
v_cvt_pk_bf16_f32 v46, v116, v117
v_cvt_pk_bf16_f32 v47, v118, v119
buffer_store_dwordx4 v[44:47], v244, s[20:23], s50 offen offset:1024
v_accvgpr_read_b32 v104, a72
v_accvgpr_read_b32 v105, a73
v_accvgpr_read_b32 v106, a74
v_accvgpr_read_b32 v107, a75
v_accvgpr_read_b32 v108, a88
v_accvgpr_read_b32 v109, a89
v_accvgpr_read_b32 v110, a90
v_accvgpr_read_b32 v111, a91
v_pk_mul_f32 v[104:105], v[104:105], v[128:129]
v_pk_mul_f32 v[106:107], v[106:107], v[128:129]
v_pk_mul_f32 v[108:109], v[108:109], v[128:129]
v_pk_mul_f32 v[110:111], v[110:111], v[128:129]
v_cvt_pk_bf16_f32 v48, v104, v105
v_cvt_pk_bf16_f32 v49, v106, v107
v_cvt_pk_bf16_f32 v50, v108, v109
v_cvt_pk_bf16_f32 v51, v110, v111
buffer_store_dwordx4 v[48:51], v244, s[20:23], s50 offen offset:2048
v_accvgpr_read_b32 v112, a104
v_accvgpr_read_b32 v113, a105
v_accvgpr_read_b32 v114, a106
v_accvgpr_read_b32 v115, a107
v_accvgpr_read_b32 v116, a120
v_accvgpr_read_b32 v117, a121
v_accvgpr_read_b32 v118, a122
v_accvgpr_read_b32 v119, a123
v_pk_mul_f32 v[112:113], v[112:113], v[128:129]
v_pk_mul_f32 v[114:115], v[114:115], v[128:129]
v_pk_mul_f32 v[116:117], v[116:117], v[128:129]
v_pk_mul_f32 v[118:119], v[118:119], v[128:129]
v_cvt_pk_bf16_f32 v52, v112, v113
v_cvt_pk_bf16_f32 v53, v114, v115
v_cvt_pk_bf16_f32 v54, v116, v117
v_cvt_pk_bf16_f32 v55, v118, v119
buffer_store_dwordx4 v[52:55], v244, s[20:23], s50 offen offset:3072
s_nop 7
v_accvgpr_read_b32 v123, a134
v_accvgpr_read_b32 v130, a135
v_add_f32 v123, v123, v130
v_rcp_f32 v130, v123
s_add_u32 s50, s44, 12288
v_mov_b32 v131, v130
v_accvgpr_read_b32 v104, a12
v_accvgpr_read_b32 v105, a13
v_accvgpr_read_b32 v106, a14
v_accvgpr_read_b32 v107, a15
v_accvgpr_read_b32 v108, a28
v_accvgpr_read_b32 v109, a29
v_accvgpr_read_b32 v110, a30
v_accvgpr_read_b32 v111, a31
v_pk_mul_f32 v[104:105], v[104:105], v[130:131]
v_pk_mul_f32 v[106:107], v[106:107], v[130:131]
v_pk_mul_f32 v[108:109], v[108:109], v[130:131]
v_pk_mul_f32 v[110:111], v[110:111], v[130:131]
v_cvt_pk_bf16_f32 v56, v104, v105
v_cvt_pk_bf16_f32 v57, v106, v107
v_cvt_pk_bf16_f32 v58, v108, v109
v_cvt_pk_bf16_f32 v59, v110, v111
buffer_store_dwordx4 v[56:59], v244, s[20:23], s50 offen offset:0
v_accvgpr_read_b32 v112, a44
v_accvgpr_read_b32 v113, a45
v_accvgpr_read_b32 v114, a46
v_accvgpr_read_b32 v115, a47
v_accvgpr_read_b32 v116, a60
v_accvgpr_read_b32 v117, a61
v_accvgpr_read_b32 v118, a62
v_accvgpr_read_b32 v119, a63
v_pk_mul_f32 v[112:113], v[112:113], v[130:131]
v_pk_mul_f32 v[114:115], v[114:115], v[130:131]
v_pk_mul_f32 v[116:117], v[116:117], v[130:131]
v_pk_mul_f32 v[118:119], v[118:119], v[130:131]
v_cvt_pk_bf16_f32 v60, v112, v113
v_cvt_pk_bf16_f32 v61, v114, v115
v_cvt_pk_bf16_f32 v62, v116, v117
v_cvt_pk_bf16_f32 v63, v118, v119
buffer_store_dwordx4 v[60:63], v244, s[20:23], s50 offen offset:1024
v_accvgpr_read_b32 v104, a76
v_accvgpr_read_b32 v105, a77
v_accvgpr_read_b32 v106, a78
v_accvgpr_read_b32 v107, a79
v_accvgpr_read_b32 v108, a92
v_accvgpr_read_b32 v109, a93
v_accvgpr_read_b32 v110, a94
v_accvgpr_read_b32 v111, a95
v_pk_mul_f32 v[104:105], v[104:105], v[130:131]
v_pk_mul_f32 v[106:107], v[106:107], v[130:131]
v_pk_mul_f32 v[108:109], v[108:109], v[130:131]
v_pk_mul_f32 v[110:111], v[110:111], v[130:131]
v_cvt_pk_bf16_f32 v64, v104, v105
v_cvt_pk_bf16_f32 v65, v106, v107
v_cvt_pk_bf16_f32 v66, v108, v109
v_cvt_pk_bf16_f32 v67, v110, v111
buffer_store_dwordx4 v[64:67], v244, s[20:23], s50 offen offset:2048
v_accvgpr_read_b32 v112, a108
v_accvgpr_read_b32 v113, a109
v_accvgpr_read_b32 v114, a110
v_accvgpr_read_b32 v115, a111
v_accvgpr_read_b32 v116, a124
v_accvgpr_read_b32 v117, a125
v_accvgpr_read_b32 v118, a126
v_accvgpr_read_b32 v119, a127
v_pk_mul_f32 v[112:113], v[112:113], v[130:131]
v_pk_mul_f32 v[114:115], v[114:115], v[130:131]
v_pk_mul_f32 v[116:117], v[116:117], v[130:131]
v_pk_mul_f32 v[118:119], v[118:119], v[130:131]
v_cvt_pk_bf16_f32 v68, v112, v113
v_cvt_pk_bf16_f32 v69, v114, v115
v_cvt_pk_bf16_f32 v70, v116, v117
v_cvt_pk_bf16_f32 v71, v118, v119
buffer_store_dwordx4 v[68:71], v244, s[20:23], s50 offen offset:3072
v_max3_f32 v104, v120, v121, v122
v_max_f32 v104, v104, v123
v_add_f32 v105, v120, v121
v_add_f32 v105, v105, v122
v_add_f32 v105, v105, v123
v_cmp_nge_f32 vcc, s42, v104
v_cmp_u_f32 s[28:29], v105, v105
s_or_b64 vcc, vcc, s[28:29]
s_cmp_lg_u64 vcc, 0
s_cselect_b32 s28, 1, 0
v_mov_b32 v104, s28
s_lshl_b32 s29, s37, 2
s_add_u32 s29, s29, 147968
v_mov_b32 v105, s29
v_mov_b32 v106, 147968
ds_write_b32 v105, v104
s_waitcnt vmcnt(16) lgkmcnt(0)
s_barrier
ds_read_b128 v[108:111], v106
ds_read_b64_tr_b16 a[64:65], v237 offset:0
ds_read_b64_tr_b16 a[66:67], v237 offset:4608
ds_read_b64_tr_b16 a[68:69], v237 offset:8
ds_read_b64_tr_b16 a[70:71], v237 offset:4616
ds_read_b64_tr_b16 a[72:73], v238 offset:0
ds_read_b64_tr_b16 a[74:75], v238 offset:4608
ds_read_b64_tr_b16 a[76:77], v238 offset:8
ds_read_b64_tr_b16 a[78:79], v238 offset:4616
ds_read_b64_tr_b16 a[80:81], v237 offset:128
ds_read_b64_tr_b16 a[82:83], v237 offset:4736
ds_read_b64_tr_b16 a[84:85], v237 offset:136
ds_read_b64_tr_b16 a[86:87], v237 offset:4744
ds_read_b64_tr_b16 a[88:89], v238 offset:128
ds_read_b64_tr_b16 a[90:91], v238 offset:4736
s_waitcnt lgkmcnt(14)
v_or_b32 v108, v108, v109
v_or3_b32 v108, v108, v110, v111
s_nop 0
v_readfirstlane_b32 s28, v108
s_cmp_gt_u32 s28, s43
s_cbranch_scc1 K_FALLBACK
s_waitcnt lgkmcnt(8)
v_mfma_f32_16x16x32_bf16 v[72:75], a[64:67], v[8:11], 0
ds_read_b64_tr_b16 a[92:93], v238 offset:136
ds_read_b64_tr_b16 a[94:95], v238 offset:4744
v_mfma_f32_16x16x32_bf16 v[80:83], a[64:67], v[24:27], 0
s_lshr_b32 s32, s35, 2
s_and_b32 s33, s35, 3
v_mfma_f32_16x16x32_bf16 v[88:91], a[64:67], v[40:43], 0
s_lshl_b32 s94, s36, 9
s_lshl_b32 s28, s32, 6
v_mfma_f32_16x16x32_bf16 v[96:99], a[64:67], v[56:59], 0
s_lshr_b32 s34, s32, 2
v_mfma_f32_16x16x32_bf16 v[76:79], a[68:71], v[8:11], 0
ds_read_b64_tr_b16 a[64:65], v239 offset:0
ds_read_b64_tr_b16 a[66:67], v239 offset:4608
v_mfma_f32_16x16x32_bf16 v[84:87], a[68:71], v[24:27], 0
s_add_u32 s94, s94, s28
s_lshl_b32 s28, s37, 4
v_mfma_f32_16x16x32_bf16 v[92:95], a[68:71], v[40:43], 0
s_add_u32 s94, s94, s28
s_add_u32 s94, s94, 0x248000
v_mfma_f32_16x16x32_bf16 v[100:103], a[68:71], v[56:59], 0
v_mov_b32 v231, 1
v_and_b32 v229, 7, v1
v_mfma_f32_16x16x32_bf16 v[104:107], a[72:75], v[8:11], 0
ds_read_b64_tr_b16 a[68:69], v237 offset:9216
ds_read_b64_tr_b16 a[70:71], v237 offset:13824
v_mfma_f32_16x16x32_bf16 v[112:115], a[72:75], v[24:27], 0
v_lshlrev_b32 v229, 2, v229
v_lshlrev_b32 v226, 3, v1
v_mfma_f32_16x16x32_bf16 v[120:123], a[72:75], v[40:43], 0
s_lshl2_add_u32 s29, s33, s94
v_mfma_f32_16x16x32_bf16 v[128:131], a[72:75], v[56:59], 0
s_waitcnt lgkmcnt(8)
v_mfma_f32_16x16x32_bf16 v[108:111], a[76:79], v[8:11], 0
ds_read_b64_tr_b16 a[72:73], v237 offset:9224
ds_read_b64_tr_b16 a[74:75], v237 offset:13832
v_mfma_f32_16x16x32_bf16 v[116:119], a[76:79], v[24:27], 0
v_mfma_f32_16x16x32_bf16 v[124:127], a[76:79], v[40:43], 0
v_mfma_f32_16x16x32_bf16 v[132:135], a[76:79], v[56:59], 0
v_mfma_f32_16x16x32_bf16 v[136:139], a[80:83], v[8:11], 0
ds_read_b64_tr_b16 a[76:77], v238 offset:9216
ds_read_b64_tr_b16 a[78:79], v238 offset:13824
v_mfma_f32_16x16x32_bf16 v[144:147], a[80:83], v[24:27], 0
v_mfma_f32_16x16x32_bf16 v[152:155], a[80:83], v[40:43], 0
v_mfma_f32_16x16x32_bf16 v[160:163], a[80:83], v[56:59], 0
v_mfma_f32_16x16x32_bf16 v[140:143], a[84:87], v[8:11], 0
ds_read_b64_tr_b16 a[80:81], v238 offset:9224
ds_read_b64_tr_b16 a[82:83], v238 offset:13832
v_mfma_f32_16x16x32_bf16 v[148:151], a[84:87], v[24:27], 0
s_waitcnt vmcnt(0)
buffer_store_dword v231, v254, s[20:23], s29 offen
v_mfma_f32_16x16x32_bf16 v[156:159], a[84:87], v[40:43], 0
s_add_u32 s28, s35, 1
s_and_b32 s28, s28, 3
v_mfma_f32_16x16x32_bf16 v[164:167], a[84:87], v[56:59], 0
s_mul_i32 s28, s28, 36864
s_waitcnt lgkmcnt(8)
v_mfma_f32_16x16x32_bf16 v[168:171], a[88:91], v[8:11], 0
ds_read_b64_tr_b16 a[84:85], v237 offset:9344
ds_read_b64_tr_b16 a[86:87], v237 offset:13952
v_mfma_f32_16x16x32_bf16 v[176:179], a[88:91], v[24:27], 0
v_add_u32 v216, s28, v234
v_add_u32 v217, s28, v235
v_mfma_f32_16x16x32_bf16 v[184:187], a[88:91], v[40:43], 0
v_add_u32 v218, s28, v236
v_mfma_f32_16x16x32_bf16 v[192:195], a[88:91], v[56:59], 0
v_mfma_f32_16x16x32_bf16 v[172:175], a[92:95], v[8:11], 0
ds_read_b64_tr_b16 a[88:89], v237 offset:9352
ds_read_b64_tr_b16 a[90:91], v237 offset:13960
v_mfma_f32_16x16x32_bf16 v[180:183], a[92:95], v[24:27], 0
v_mfma_f32_16x16x32_bf16 v[188:191], a[92:95], v[40:43], 0
v_mfma_f32_16x16x32_bf16 v[196:199], a[92:95], v[56:59], 0
v_mfma_f32_16x16x32_bf16 v[200:203], a[64:67], v[8:11], 0
ds_read_b64_tr_b16 a[92:93], v238 offset:9344
ds_read_b64_tr_b16 a[94:95], v238 offset:13952
v_mfma_f32_16x16x32_bf16 v[204:207], a[64:67], v[24:27], 0
v_mfma_f32_16x16x32_bf16 v[208:211], a[64:67], v[40:43], 0
v_mfma_f32_16x16x32_bf16 v[212:215], a[64:67], v[56:59], 0
s_waitcnt lgkmcnt(8)
v_mfma_f32_16x16x32_bf16 v[72:75], a[68:71], v[12:15], v[72:75]
ds_read_b64_tr_b16 a[64:65], v238 offset:9352
ds_read_b64_tr_b16 a[66:67], v238 offset:13960
v_mfma_f32_16x16x32_bf16 v[80:83], a[68:71], v[28:31], v[80:83]
v_mfma_f32_16x16x32_bf16 v[88:91], a[68:71], v[44:47], v[88:91]
v_mfma_f32_16x16x32_bf16 v[96:99], a[68:71], v[60:63], v[96:99]
v_mfma_f32_16x16x32_bf16 v[76:79], a[72:75], v[12:15], v[76:79]
ds_read_b64_tr_b16 a[68:69], v239 offset:9216
ds_read_b64_tr_b16 a[70:71], v239 offset:13824
v_mfma_f32_16x16x32_bf16 v[84:87], a[72:75], v[28:31], v[84:87]
buffer_load_dword v230, v229, s[20:23], s94 offen sc0 sc1
v_mfma_f32_16x16x32_bf16 v[92:95], a[72:75], v[44:47], v[92:95]
s_add_u32 s39, s35, 1
s_and_b32 s39, s39, 3
v_mfma_f32_16x16x32_bf16 v[100:103], a[72:75], v[60:63], v[100:103]
s_add_u32 s28, s33, 1
s_and_b32 s28, s28, 3
v_mfma_f32_16x16x32_bf16 v[104:107], a[76:79], v[12:15], v[104:107]
ds_read_b64_tr_b16 a[72:73], v237 offset:18432
ds_read_b64_tr_b16 a[74:75], v237 offset:23040
v_mfma_f32_16x16x32_bf16 v[112:115], a[76:79], v[28:31], v[112:115]
s_sub_u32 s28, s28, s33
s_lshl_b32 s28, s28, 16
v_mfma_f32_16x16x32_bf16 v[120:123], a[76:79], v[44:47], v[120:123]
s_add_u32 s64, s28, s44
s_add_u32 s65, s64, 4096
v_mfma_f32_16x16x32_bf16 v[128:131], a[76:79], v[60:63], v[128:131]
s_add_u32 s66, s64, 8192
s_add_u32 s67, s64, 12288
s_waitcnt lgkmcnt(8)
v_mfma_f32_16x16x32_bf16 v[108:111], a[80:83], v[12:15], v[108:111]
ds_read_b64_tr_b16 a[76:77], v237 offset:18440
ds_read_b64_tr_b16 a[78:79], v237 offset:23048
v_mfma_f32_16x16x32_bf16 v[116:119], a[80:83], v[28:31], v[116:119]
s_add_u32 s28, s35, 2
s_and_b32 s28, s28, 3
v_mfma_f32_16x16x32_bf16 v[124:127], a[80:83], v[44:47], v[124:127]
s_mul_i32 s28, s28, 36864
v_mfma_f32_16x16x32_bf16 v[132:135], a[80:83], v[60:63], v[132:135]
v_add_u32 v219, s28, v234
v_add_u32 v220, s28, v235
v_mfma_f32_16x16x32_bf16 v[136:139], a[84:87], v[12:15], v[136:139]
ds_read_b64_tr_b16 a[80:81], v238 offset:18432
ds_read_b64_tr_b16 a[82:83], v238 offset:23040
v_mfma_f32_16x16x32_bf16 v[144:147], a[84:87], v[28:31], v[144:147]
v_add_u32 v221, s28, v236
v_mfma_f32_16x16x32_bf16 v[152:155], a[84:87], v[44:47], v[152:155]
s_add_u32 s28, s35, 3
s_and_b32 s28, s28, 3
v_mfma_f32_16x16x32_bf16 v[160:163], a[84:87], v[60:63], v[160:163]
s_mul_i32 s28, s28, 36864
v_mfma_f32_16x16x32_bf16 v[140:143], a[88:91], v[12:15], v[140:143]
ds_read_b64_tr_b16 a[84:85], v238 offset:18440
ds_read_b64_tr_b16 a[86:87], v238 offset:23048
v_mfma_f32_16x16x32_bf16 v[148:151], a[88:91], v[28:31], v[148:151]
v_add_u32 v222, s28, v234
v_add_u32 v223, s28, v235
v_mfma_f32_16x16x32_bf16 v[156:159], a[88:91], v[44:47], v[156:159]
v_add_u32 v224, s28, v236
v_mfma_f32_16x16x32_bf16 v[164:167], a[88:91], v[60:63], v[164:167]
s_waitcnt lgkmcnt(8)
v_mfma_f32_16x16x32_bf16 v[168:171], a[92:95], v[12:15], v[168:171]
ds_read_b64_tr_b16 a[88:89], v237 offset:18560
ds_read_b64_tr_b16 a[90:91], v237 offset:23168
v_mfma_f32_16x16x32_bf16 v[176:179], a[92:95], v[28:31], v[176:179]
v_mfma_f32_16x16x32_bf16 v[184:187], a[92:95], v[44:47], v[184:187]
s_waitcnt vmcnt(0)
v_cmp_gt_u32 vcc, 1, v230
v_mfma_f32_16x16x32_bf16 v[192:195], a[92:95], v[60:63], v[192:195]
v_mfma_f32_16x16x32_bf16 v[172:175], a[64:67], v[12:15], v[172:175]
ds_read_b64_tr_b16 a[92:93], v237 offset:18568
ds_read_b64_tr_b16 a[94:95], v237 offset:23176
v_mfma_f32_16x16x32_bf16 v[180:183], a[64:67], v[28:31], v[180:183]
s_bitcmp1_b32 vcc_lo, s39
s_cbranch_scc1 SP_O1A
SP_O1A_RET:
v_mfma_f32_16x16x32_bf16 v[188:191], a[64:67], v[44:47], v[188:191]
buffer_load_dwordx4 a[128:131], v244, s[20:23], s64 offen offset:0 sc0 sc1
v_mfma_f32_16x16x32_bf16 v[196:199], a[64:67], v[60:63], v[196:199]
v_mfma_f32_16x16x32_bf16 v[200:203], a[68:71], v[12:15], v[200:203]
ds_read_b64_tr_b16 a[64:65], v238 offset:18560
ds_read_b64_tr_b16 a[66:67], v238 offset:23168
v_mfma_f32_16x16x32_bf16 v[204:207], a[68:71], v[28:31], v[204:207]
v_mfma_f32_16x16x32_bf16 v[208:211], a[68:71], v[44:47], v[208:211]
buffer_load_dwordx4 a[144:147], v244, s[20:23], s65 offen offset:0 sc0 sc1
v_mfma_f32_16x16x32_bf16 v[212:215], a[68:71], v[60:63], v[212:215]
s_waitcnt lgkmcnt(8)
v_mfma_f32_16x16x32_bf16 v[72:75], a[72:75], v[16:19], v[72:75]
ds_read_b64_tr_b16 a[68:69], v238 offset:18568
ds_read_b64_tr_b16 a[70:71], v238 offset:23176
v_mfma_f32_16x16x32_bf16 v[80:83], a[72:75], v[32:35], v[80:83]
v_mfma_f32_16x16x32_bf16 v[88:91], a[72:75], v[48:51], v[88:91]
buffer_load_dwordx4 a[160:163], v244, s[20:23], s66 offen offset:0 sc0 sc1
v_mfma_f32_16x16x32_bf16 v[96:99], a[72:75], v[64:67], v[96:99]
v_mfma_f32_16x16x32_bf16 v[76:79], a[76:79], v[16:19], v[76:79]
ds_read_b64_tr_b16 a[72:73], v239 offset:18432
ds_read_b64_tr_b16 a[74:75], v239 offset:23040
v_mfma_f32_16x16x32_bf16 v[84:87], a[76:79], v[32:35], v[84:87]
v_mfma_f32_16x16x32_bf16 v[92:95], a[76:79], v[48:51], v[92:95]
buffer_load_dwordx4 a[176:179], v244, s[20:23], s67 offen offset:0 sc0 sc1
v_mfma_f32_16x16x32_bf16 v[100:103], a[76:79], v[64:67], v[100:103]
v_mfma_f32_16x16x32_bf16 v[104:107], a[80:83], v[16:19], v[104:107]
ds_read_b64_tr_b16 a[76:77], v237 offset:27648
ds_read_b64_tr_b16 a[78:79], v237 offset:32256
v_mfma_f32_16x16x32_bf16 v[112:115], a[80:83], v[32:35], v[112:115]
v_mfma_f32_16x16x32_bf16 v[120:123], a[80:83], v[48:51], v[120:123]
buffer_load_dwordx4 a[132:135], v244, s[20:23], s64 offen offset:1024 sc0 sc1
v_mfma_f32_16x16x32_bf16 v[128:131], a[80:83], v[64:67], v[128:131]
s_waitcnt lgkmcnt(8)
v_mfma_f32_16x16x32_bf16 v[108:111], a[84:87], v[16:19], v[108:111]
ds_read_b64_tr_b16 a[80:81], v237 offset:27656
ds_read_b64_tr_b16 a[82:83], v237 offset:32264
v_mfma_f32_16x16x32_bf16 v[116:119], a[84:87], v[32:35], v[116:119]
v_mfma_f32_16x16x32_bf16 v[124:127], a[84:87], v[48:51], v[124:127]
buffer_load_dwordx4 a[148:151], v244, s[20:23], s65 offen offset:1024 sc0 sc1
v_mfma_f32_16x16x32_bf16 v[132:135], a[84:87], v[64:67], v[132:135]
v_mfma_f32_16x16x32_bf16 v[136:139], a[88:91], v[16:19], v[136:139]
ds_read_b64_tr_b16 a[84:85], v238 offset:27648
ds_read_b64_tr_b16 a[86:87], v238 offset:32256
v_mfma_f32_16x16x32_bf16 v[144:147], a[88:91], v[32:35], v[144:147]
v_mfma_f32_16x16x32_bf16 v[152:155], a[88:91], v[48:51], v[152:155]
buffer_load_dwordx4 a[164:167], v244, s[20:23], s66 offen offset:1024 sc0 sc1
v_mfma_f32_16x16x32_bf16 v[160:163], a[88:91], v[64:67], v[160:163]
v_mfma_f32_16x16x32_bf16 v[140:143], a[92:95], v[16:19], v[140:143]
ds_read_b64_tr_b16 a[88:89], v238 offset:27656
ds_read_b64_tr_b16 a[90:91], v238 offset:32264
v_mfma_f32_16x16x32_bf16 v[148:151], a[92:95], v[32:35], v[148:151]
v_mfma_f32_16x16x32_bf16 v[156:159], a[92:95], v[48:51], v[156:159]
buffer_load_dwordx4 a[180:183], v244, s[20:23], s67 offen offset:1024 sc0 sc1
v_mfma_f32_16x16x32_bf16 v[164:167], a[92:95], v[64:67], v[164:167]
s_waitcnt lgkmcnt(8)
v_mfma_f32_16x16x32_bf16 v[168:171], a[64:67], v[16:19], v[168:171]
ds_read_b64_tr_b16 a[92:93], v237 offset:27776
ds_read_b64_tr_b16 a[94:95], v237 offset:32384
v_mfma_f32_16x16x32_bf16 v[176:179], a[64:67], v[32:35], v[176:179]
v_mfma_f32_16x16x32_bf16 v[184:187], a[64:67], v[48:51], v[184:187]
buffer_load_dwordx4 a[136:139], v244, s[20:23], s64 offen offset:2048 sc0 sc1
v_mfma_f32_16x16x32_bf16 v[192:195], a[64:67], v[64:67], v[192:195]
buffer_load_dword v230, v229, s[20:23], s94 offen sc0 sc1
v_mfma_f32_16x16x32_bf16 v[172:175], a[68:71], v[16:19], v[172:175]
ds_read_b64_tr_b16 a[64:65], v237 offset:27784
ds_read_b64_tr_b16 a[66:67], v237 offset:32392
v_mfma_f32_16x16x32_bf16 v[180:183], a[68:71], v[32:35], v[180:183]
v_mfma_f32_16x16x32_bf16 v[188:191], a[68:71], v[48:51], v[188:191]
v_mfma_f32_16x16x32_bf16 v[196:199], a[68:71], v[64:67], v[196:199]
buffer_load_dwordx4 a[152:155], v244, s[20:23], s65 offen offset:2048 sc0 sc1
v_mfma_f32_16x16x32_bf16 v[200:203], a[72:75], v[16:19], v[200:203]
ds_read_b64_tr_b16 a[68:69], v238 offset:27776
ds_read_b64_tr_b16 a[70:71], v238 offset:32384
v_mfma_f32_16x16x32_bf16 v[204:207], a[72:75], v[32:35], v[204:207]
v_mfma_f32_16x16x32_bf16 v[208:211], a[72:75], v[48:51], v[208:211]
v_mfma_f32_16x16x32_bf16 v[212:215], a[72:75], v[64:67], v[212:215]
buffer_load_dwordx4 a[168:171], v244, s[20:23], s66 offen offset:2048 sc0 sc1
s_waitcnt lgkmcnt(8)
v_mfma_f32_16x16x32_bf16 v[72:75], a[76:79], v[20:23], v[72:75]
ds_read_b64_tr_b16 a[72:73], v238 offset:27784
ds_read_b64_tr_b16 a[74:75], v238 offset:32392
v_mfma_f32_16x16x32_bf16 v[80:83], a[76:79], v[36:39], v[80:83]
v_mfma_f32_16x16x32_bf16 v[88:91], a[76:79], v[52:55], v[88:91]
v_mfma_f32_16x16x32_bf16 v[96:99], a[76:79], v[68:71], v[96:99]
buffer_load_dwordx4 a[184:187], v244, s[20:23], s67 offen offset:2048 sc0 sc1
v_mfma_f32_16x16x32_bf16 v[76:79], a[80:83], v[20:23], v[76:79]
ds_read_b64_tr_b16 a[76:77], v239 offset:27648
ds_read_b64_tr_b16 a[78:79], v239 offset:32256
v_mfma_f32_16x16x32_bf16 v[84:87], a[80:83], v[36:39], v[84:87]
v_mfma_f32_16x16x32_bf16 v[92:95], a[80:83], v[52:55], v[92:95]
v_mfma_f32_16x16x32_bf16 v[100:103], a[80:83], v[68:71], v[100:103]
buffer_load_dwordx4 a[140:143], v244, s[20:23], s64 offen offset:3072 sc0 sc1
v_mfma_f32_16x16x32_bf16 v[104:107], a[84:87], v[20:23], v[104:107]
ds_read_b64_tr_b16 a[80:81], v216 offset:0
ds_read_b64_tr_b16 a[82:83], v216 offset:4608
v_mfma_f32_16x16x32_bf16 v[112:115], a[84:87], v[36:39], v[112:115]
v_mfma_f32_16x16x32_bf16 v[120:123], a[84:87], v[52:55], v[120:123]
v_mfma_f32_16x16x32_bf16 v[128:131], a[84:87], v[68:71], v[128:131]
buffer_load_dwordx4 a[156:159], v244, s[20:23], s65 offen offset:3072 sc0 sc1
s_waitcnt lgkmcnt(8)
v_mfma_f32_16x16x32_bf16 v[108:111], a[88:91], v[20:23], v[108:111]
ds_read_b64_tr_b16 a[84:85], v216 offset:8
ds_read_b64_tr_b16 a[86:87], v216 offset:4616
v_mfma_f32_16x16x32_bf16 v[116:119], a[88:91], v[36:39], v[116:119]
v_mfma_f32_16x16x32_bf16 v[124:127], a[88:91], v[52:55], v[124:127]
v_mfma_f32_16x16x32_bf16 v[132:135], a[88:91], v[68:71], v[132:135]
buffer_load_dwordx4 a[172:175], v244, s[20:23], s66 offen offset:3072 sc0 sc1
v_mfma_f32_16x16x32_bf16 v[136:139], a[92:95], v[20:23], v[136:139]
ds_read_b64_tr_b16 a[88:89], v217 offset:0
ds_read_b64_tr_b16 a[90:91], v217 offset:4608
v_mfma_f32_16x16x32_bf16 v[144:147], a[92:95], v[36:39], v[144:147]
v_mfma_f32_16x16x32_bf16 v[152:155], a[92:95], v[52:55], v[152:155]
v_mfma_f32_16x16x32_bf16 v[160:163], a[92:95], v[68:71], v[160:163]
buffer_load_dwordx4 a[188:191], v244, s[20:23], s67 offen offset:3072 sc0 sc1
v_mfma_f32_16x16x32_bf16 v[140:143], a[64:67], v[20:23], v[140:143]
ds_read_b64_tr_b16 a[92:93], v217 offset:8
ds_read_b64_tr_b16 a[94:95], v217 offset:4616
v_mfma_f32_16x16x32_bf16 v[148:151], a[64:67], v[36:39], v[148:151]
s_add_u32 s28, s33, 2
s_and_b32 s28, s28, 3
v_mfma_f32_16x16x32_bf16 v[156:159], a[64:67], v[52:55], v[156:159]
s_sub_u32 s28, s28, s33
s_lshl_b32 s28, s28, 16
v_mfma_f32_16x16x32_bf16 v[164:167], a[64:67], v[68:71], v[164:167]
s_add_u32 s64, s28, s44
s_add_u32 s65, s64, 4096
s_waitcnt lgkmcnt(8)
v_mfma_f32_16x16x32_bf16 v[168:171], a[68:71], v[20:23], v[168:171]
ds_read_b64_tr_b16 a[64:65], v216 offset:128
ds_read_b64_tr_b16 a[66:67], v216 offset:4736
v_mfma_f32_16x16x32_bf16 v[176:179], a[68:71], v[36:39], v[176:179]
s_add_u32 s66, s64, 8192
s_add_u32 s67, s64, 12288
v_mfma_f32_16x16x32_bf16 v[184:187], a[68:71], v[52:55], v[184:187]
s_waitcnt vmcnt(7)
v_cmp_gt_u32 vcc, 1, v230
v_mfma_f32_16x16x32_bf16 v[192:195], a[68:71], v[68:71], v[192:195]
v_mfma_f32_16x16x32_bf16 v[172:175], a[72:75], v[20:23], v[172:175]
ds_read_b64_tr_b16 a[68:69], v216 offset:136
ds_read_b64_tr_b16 a[70:71], v216 offset:4744
v_mfma_f32_16x16x32_bf16 v[180:183], a[72:75], v[36:39], v[180:183]
s_and_b32 s29, vcc_lo, 15
s_cbranch_scc1 SP_O2A
SP_O2A_RET:
v_mfma_f32_16x16x32_bf16 v[188:191], a[72:75], v[52:55], v[188:191]
buffer_load_dwordx4 a[192:195], v244, s[20:23], s64 offen offset:0 sc0 sc1
v_mfma_f32_16x16x32_bf16 v[196:199], a[72:75], v[68:71], v[196:199]
v_mfma_f32_16x16x32_bf16 v[200:203], a[76:79], v[20:23], v[200:203]
ds_read_b64_tr_b16 a[72:73], v217 offset:128
ds_read_b64_tr_b16 a[74:75], v217 offset:4736
v_mfma_f32_16x16x32_bf16 v[204:207], a[76:79], v[36:39], v[204:207]
v_mfma_f32_16x16x32_bf16 v[208:211], a[76:79], v[52:55], v[208:211]
buffer_load_dwordx4 a[208:211], v244, s[20:23], s65 offen offset:0 sc0 sc1
v_mfma_f32_16x16x32_bf16 v[212:215], a[76:79], v[68:71], v[212:215]
s_waitcnt vmcnt(15)
s_waitcnt lgkmcnt(8)
v_mfma_f32_16x16x32_bf16 v[72:75], a[80:83], a[128:131], v[72:75]
ds_read_b64_tr_b16 a[76:77], v217 offset:136
ds_read_b64_tr_b16 a[78:79], v217 offset:4744
v_mfma_f32_16x16x32_bf16 v[80:83], a[80:83], a[144:147], v[80:83]
v_mfma_f32_16x16x32_bf16 v[88:91], a[80:83], a[160:163], v[88:91]
buffer_load_dwordx4 a[96:99], v244, s[20:23], s66 offen offset:0 sc0 sc1
v_accvgpr_read_b32 v39, a222
v_mfma_f32_16x16x32_bf16 v[96:99], a[80:83], a[176:179], v[96:99]
v_accvgpr_read_b32 v59, a232
v_lshlrev_b32 v38, 16, v39
v_mfma_f32_16x16x32_bf16 v[76:79], a[84:87], a[128:131], v[76:79]
ds_read_b64_tr_b16 a[80:81], v218 offset:0
ds_read_b64_tr_b16 a[82:83], v218 offset:4608
v_mfma_f32_16x16x32_bf16 v[84:87], a[84:87], a[144:147], v[84:87]
v_and_b32 v39, 0xffff0000, v39
v_lshlrev_b32 v58, 16, v59
v_mfma_f32_16x16x32_bf16 v[92:95], a[84:87], a[160:163], v[92:95]
buffer_load_dwordx4 a[112:115], v244, s[20:23], s67 offen offset:0 sc0 sc1
v_and_b32 v59, 0xffff0000, v59
v_mfma_f32_16x16x32_bf16 v[100:103], a[84:87], a[176:179], v[100:103]
v_add_f32 v38, v38, v58
v_add_f32 v39, v39, v59
v_mfma_f32_16x16x32_bf16 v[104:107], a[88:91], a[128:131], v[104:107]
ds_read_b64_tr_b16 a[84:85], v216 offset:9216
ds_read_b64_tr_b16 a[86:87], v216 offset:13824
v_mfma_f32_16x16x32_bf16 v[112:115], a[88:91], a[144:147], v[112:115]
v_cvt_pk_bf16_f32 v58, v38, v39
v_lshlrev_b32 v38, 16, v58
v_mfma_f32_16x16x32_bf16 v[120:123], a[88:91], a[160:163], v[120:123]
buffer_load_dwordx4 a[196:199], v244, s[20:23], s64 offen offset:1024 sc0 sc1
v_and_b32 v39, 0xffff0000, v58
v_mfma_f32_16x16x32_bf16 v[128:131], a[88:91], a[176:179], v[128:131]
v_mul_f32 v58, 0xbfb8aa3b, v38
v_mul_f32 v59, 0xbfb8aa3b, v39
s_waitcnt lgkmcnt(8)
v_mfma_f32_16x16x32_bf16 v[108:111], a[92:95], a[128:131], v[108:111]
ds_read_b64_tr_b16 a[88:89], v216 offset:9224
ds_read_b64_tr_b16 a[90:91], v216 offset:13832
v_mfma_f32_16x16x32_bf16 v[116:119], a[92:95], a[144:147], v[116:119]
v_exp_f32 v58, v58
v_mfma_f32_16x16x32_bf16 v[124:127], a[92:95], a[160:163], v[124:127]
buffer_load_dwordx4 a[244:247], v244, s[20:23], s65 offen offset:1024 sc0 sc1
v_mfma_f32_16x16x32_bf16 v[132:135], a[92:95], a[176:179], v[132:135]
v_exp_f32 v59, v59
v_mfma_f32_16x16x32_bf16 v[136:139], a[64:67], a[128:131], v[136:139]
ds_read_b64_tr_b16 a[92:93], v217 offset:9216
ds_read_b64_tr_b16 a[94:95], v217 offset:13824
v_mfma_f32_16x16x32_bf16 v[144:147], a[64:67], a[144:147], v[144:147]
v_add_f32 v58, 1.0, v58
v_add_f32 v59, 1.0, v59
v_mfma_f32_16x16x32_bf16 v[152:155], a[64:67], a[160:163], v[152:155]
buffer_load_dwordx4 a[100:103], v244, s[20:23], s66 offen offset:1024 sc0 sc1
v_mfma_f32_16x16x32_bf16 v[160:163], a[64:67], a[176:179], v[160:163]
v_rcp_f32 v58, v58
v_mfma_f32_16x16x32_bf16 v[140:143], a[68:71], a[128:131], v[140:143]
ds_read_b64_tr_b16 a[64:65], v217 offset:9224
ds_read_b64_tr_b16 a[66:67], v217 offset:13832
v_mfma_f32_16x16x32_bf16 v[148:151], a[68:71], a[144:147], v[148:151]
v_rcp_f32 v59, v59
v_mfma_f32_16x16x32_bf16 v[156:159], a[68:71], a[160:163], v[156:159]
buffer_load_dwordx4 a[116:119], v244, s[20:23], s67 offen offset:1024 sc0 sc1
v_mul_f32 v38, v38, v58
v_mfma_f32_16x16x32_bf16 v[164:167], a[68:71], a[176:179], v[164:167]
v_mul_f32 v39, v39, v59
v_cvt_pk_bf16_f32 v58, v38, v39
s_waitcnt lgkmcnt(8)
v_mfma_f32_16x16x32_bf16 v[168:171], a[72:75], a[128:131], v[168:171]
ds_read_b64_tr_b16 a[68:69], v216 offset:9344
ds_read_b64_tr_b16 a[70:71], v216 offset:13952
v_mfma_f32_16x16x32_bf16 v[176:179], a[72:75], a[144:147], v[176:179]
v_lshlrev_b32 v38, 16, v58
v_and_b32 v39, 0xffff0000, v58
v_mfma_f32_16x16x32_bf16 v[184:187], a[72:75], a[160:163], v[184:187]
buffer_load_dwordx4 a[200:203], v244, s[20:23], s64 offen offset:2048 sc0 sc1
v_accvgpr_read_b32 v41, a223
v_mfma_f32_16x16x32_bf16 v[192:195], a[72:75], a[176:179], v[192:195]
v_accvgpr_read_b32 v59, a233
v_lshlrev_b32 v40, 16, v41
v_mfma_f32_16x16x32_bf16 v[172:175], a[76:79], a[128:131], v[172:175]
ds_read_b64_tr_b16 a[72:73], v216 offset:9352
ds_read_b64_tr_b16 a[74:75], v216 offset:13960
v_mfma_f32_16x16x32_bf16 v[180:183], a[76:79], a[144:147], v[180:183]
v_and_b32 v41, 0xffff0000, v41
v_lshlrev_b32 v58, 16, v59
v_mfma_f32_16x16x32_bf16 v[188:191], a[76:79], a[160:163], v[188:191]
buffer_load_dwordx4 a[248:251], v244, s[20:23], s65 offen offset:2048 sc0 sc1
v_and_b32 v59, 0xffff0000, v59
v_mfma_f32_16x16x32_bf16 v[196:199], a[76:79], a[176:179], v[196:199]
v_add_f32 v40, v40, v58
v_add_f32 v41, v41, v59
v_mfma_f32_16x16x32_bf16 v[200:203], a[80:83], a[128:131], v[200:203]
ds_read_b64_tr_b16 a[76:77], v217 offset:9344
ds_read_b64_tr_b16 a[78:79], v217 offset:13952
v_mfma_f32_16x16x32_bf16 v[204:207], a[80:83], a[144:147], v[204:207]
v_cvt_pk_bf16_f32 v58, v40, v41
v_lshlrev_b32 v40, 16, v58
v_mfma_f32_16x16x32_bf16 v[208:211], a[80:83], a[160:163], v[208:211]
buffer_load_dwordx4 a[104:107], v244, s[20:23], s66 offen offset:2048 sc0 sc1
v_and_b32 v41, 0xffff0000, v58
v_mfma_f32_16x16x32_bf16 v[212:215], a[80:83], a[176:179], v[212:215]
v_mul_f32 v58, 0xbfb8aa3b, v40
v_mul_f32 v59, 0xbfb8aa3b, v41
s_waitcnt vmcnt(20)
s_waitcnt lgkmcnt(8)
v_mfma_f32_16x16x32_bf16 v[72:75], a[84:87], a[132:135], v[72:75]
ds_read_b64_tr_b16 a[80:81], v217 offset:9352
ds_read_b64_tr_b16 a[82:83], v217 offset:13960
v_mfma_f32_16x16x32_bf16 v[80:83], a[84:87], a[148:151], v[80:83]
v_exp_f32 v58, v58
v_mfma_f32_16x16x32_bf16 v[88:91], a[84:87], a[164:167], v[88:91]
buffer_load_dwordx4 a[120:123], v244, s[20:23], s67 offen offset:2048 sc0 sc1
v_mfma_f32_16x16x32_bf16 v[96:99], a[84:87], a[180:183], v[96:99]
v_exp_f32 v59, v59
v_mfma_f32_16x16x32_bf16 v[76:79], a[88:91], a[132:135], v[76:79]
ds_read_b64_tr_b16 a[84:85], v218 offset:9216
ds_read_b64_tr_b16 a[86:87], v218 offset:13824
v_mfma_f32_16x16x32_bf16 v[84:87], a[88:91], a[148:151], v[84:87]
v_add_f32 v58, 1.0, v58
v_add_f32 v59, 1.0, v59
v_mfma_f32_16x16x32_bf16 v[92:95], a[88:91], a[164:167], v[92:95]
buffer_load_dwordx4 a[204:207], v244, s[20:23], s64 offen offset:3072 sc0 sc1
v_mfma_f32_16x16x32_bf16 v[100:103], a[88:91], a[180:183], v[100:103]
v_rcp_f32 v58, v58
v_mfma_f32_16x16x32_bf16 v[104:107], a[92:95], a[132:135], v[104:107]
ds_read_b64_tr_b16 a[88:89], v216 offset:18432
ds_read_b64_tr_b16 a[90:91], v216 offset:23040
v_mfma_f32_16x16x32_bf16 v[112:115], a[92:95], a[148:151], v[112:115]
v_rcp_f32 v59, v59
v_mfma_f32_16x16x32_bf16 v[120:123], a[92:95], a[164:167], v[120:123]
buffer_load_dwordx4 a[252:255], v244, s[20:23], s65 offen offset:3072 sc0 sc1
v_mul_f32 v40, v40, v58
v_mfma_f32_16x16x32_bf16 v[128:131], a[92:95], a[180:183], v[128:131]
v_mul_f32 v41, v41, v59
v_cvt_pk_bf16_f32 v58, v40, v41
s_waitcnt lgkmcnt(8)
v_mfma_f32_16x16x32_bf16 v[108:111], a[64:67], a[132:135], v[108:111]
ds_read_b64_tr_b16 a[92:93], v216 offset:18440
ds_read_b64_tr_b16 a[94:95], v216 offset:23048
v_mfma_f32_16x16x32_bf16 v[116:119], a[64:67], a[148:151], v[116:119]
v_lshlrev_b32 v40, 16, v58
v_and_b32 v41, 0xffff0000, v58
v_mfma_f32_16x16x32_bf16 v[124:127], a[64:67], a[164:167], v[124:127]
buffer_load_dwordx4 a[108:111], v244, s[20:23], s66 offen offset:3072 sc0 sc1
v_accvgpr_read_b32 v43, a224
v_mfma_f32_16x16x32_bf16 v[132:135], a[64:67], a[180:183], v[132:135]
v_accvgpr_read_b32 v59, a234
v_lshlrev_b32 v42, 16, v43
v_mfma_f32_16x16x32_bf16 v[136:139], a[68:71], a[132:135], v[136:139]
ds_read_b64_tr_b16 a[64:65], v217 offset:18432
ds_read_b64_tr_b16 a[66:67], v217 offset:23040
v_mfma_f32_16x16x32_bf16 v[144:147], a[68:71], a[148:151], v[144:147]
v_and_b32 v43, 0xffff0000, v43
v_lshlrev_b32 v58, 16, v59
v_mfma_f32_16x16x32_bf16 v[152:155], a[68:71], a[164:167], v[152:155]
buffer_load_dwordx4 a[124:127], v244, s[20:23], s67 offen offset:3072 sc0 sc1
v_and_b32 v59, 0xffff0000, v59
v_mfma_f32_16x16x32_bf16 v[160:163], a[68:71], a[180:183], v[160:163]
s_add_u32 s28, s33, 3
s_and_b32 s28, s28, 3
v_mfma_f32_16x16x32_bf16 v[140:143], a[72:75], a[132:135], v[140:143]
ds_read_b64_tr_b16 a[68:69], v217 offset:18440
ds_read_b64_tr_b16 a[70:71], v217 offset:23048
v_mfma_f32_16x16x32_bf16 v[148:151], a[72:75], a[148:151], v[148:151]
s_sub_u32 s28, s28, s33
s_lshl_b32 s28, s28, 16
v_mfma_f32_16x16x32_bf16 v[156:159], a[72:75], a[164:167], v[156:159]
s_add_u32 s64, s28, s44
s_add_u32 s65, s64, 4096
v_mfma_f32_16x16x32_bf16 v[164:167], a[72:75], a[180:183], v[164:167]
s_add_u32 s66, s64, 8192
s_add_u32 s67, s64, 12288
s_waitcnt lgkmcnt(8)
v_mfma_f32_16x16x32_bf16 v[168:171], a[76:79], a[132:135], v[168:171]
ds_read_b64_tr_b16 a[72:73], v216 offset:18560
ds_read_b64_tr_b16 a[74:75], v216 offset:23168
v_mfma_f32_16x16x32_bf16 v[176:179], a[76:79], a[148:151], v[176:179]
buffer_load_dwordx4 a[0:3], v244, s[20:23], s64 offen offset:0 sc0 sc1
v_add_f32 v42, v42, v58
v_mfma_f32_16x16x32_bf16 v[184:187], a[76:79], a[164:167], v[184:187]
v_add_f32 v43, v43, v59
v_cvt_pk_bf16_f32 v58, v42, v43
v_mfma_f32_16x16x32_bf16 v[192:195], a[76:79], a[180:183], v[192:195]
v_lshlrev_b32 v42, 16, v58
v_and_b32 v43, 0xffff0000, v58
v_mfma_f32_16x16x32_bf16 v[172:175], a[80:83], a[132:135], v[172:175]
ds_read_b64_tr_b16 a[76:77], v216 offset:18568
ds_read_b64_tr_b16 a[78:79], v216 offset:23176
v_mfma_f32_16x16x32_bf16 v[180:183], a[80:83], a[148:151], v[180:183]
buffer_load_dwordx4 a[16:19], v244, s[20:23], s65 offen offset:0 sc0 sc1
v_mul_f32 v58, 0xbfb8aa3b, v42
v_mfma_f32_16x16x32_bf16 v[188:191], a[80:83], a[164:167], v[188:191]
v_mul_f32 v59, 0xbfb8aa3b, v43
v_mfma_f32_16x16x32_bf16 v[196:199], a[80:83], a[180:183], v[196:199]
v_exp_f32 v58, v58
v_mfma_f32_16x16x32_bf16 v[200:203], a[84:87], a[132:135], v[200:203]
ds_read_b64_tr_b16 a[80:81], v217 offset:18560
ds_read_b64_tr_b16 a[82:83], v217 offset:23168
v_mfma_f32_16x16x32_bf16 v[204:207], a[84:87], a[148:151], v[204:207]
buffer_load_dwordx4 a[32:35], v244, s[20:23], s66 offen offset:0 sc0 sc1
v_mfma_f32_16x16x32_bf16 v[208:211], a[84:87], a[164:167], v[208:211]
v_exp_f32 v59, v59
v_mfma_f32_16x16x32_bf16 v[212:215], a[84:87], a[180:183], v[212:215]
v_add_f32 v58, 1.0, v58
v_add_f32 v59, 1.0, v59
s_waitcnt vmcnt(23)
s_waitcnt lgkmcnt(8)
v_mfma_f32_16x16x32_bf16 v[72:75], a[88:91], a[136:139], v[72:75]
ds_read_b64_tr_b16 a[84:85], v217 offset:18568
ds_read_b64_tr_b16 a[86:87], v217 offset:23176
v_mfma_f32_16x16x32_bf16 v[80:83], a[88:91], a[152:155], v[80:83]
buffer_load_dwordx4 a[48:51], v244, s[20:23], s67 offen offset:0 sc0 sc1
v_mfma_f32_16x16x32_bf16 v[88:91], a[88:91], a[168:171], v[88:91]
v_rcp_f32 v58, v58
v_mfma_f32_16x16x32_bf16 v[96:99], a[88:91], a[184:187], v[96:99]
v_rcp_f32 v59, v59
v_mfma_f32_16x16x32_bf16 v[76:79], a[92:95], a[136:139], v[76:79]
ds_read_b64_tr_b16 a[88:89], v218 offset:18432
ds_read_b64_tr_b16 a[90:91], v218 offset:23040
v_mfma_f32_16x16x32_bf16 v[84:87], a[92:95], a[152:155], v[84:87]
buffer_load_dwordx4 a[4:7], v244, s[20:23], s64 offen offset:1024 sc0 sc1
v_mul_f32 v42, v42, v58
v_mfma_f32_16x16x32_bf16 v[92:95], a[92:95], a[168:171], v[92:95]
v_mul_f32 v43, v43, v59
v_cvt_pk_bf16_f32 v58, v42, v43
v_mfma_f32_16x16x32_bf16 v[100:103], a[92:95], a[184:187], v[100:103]
v_lshlrev_b32 v42, 16, v58
v_and_b32 v43, 0xffff0000, v58
v_mfma_f32_16x16x32_bf16 v[104:107], a[64:67], a[136:139], v[104:107]
ds_read_b64_tr_b16 a[92:93], v216 offset:27648
ds_read_b64_tr_b16 a[94:95], v216 offset:32256
v_mfma_f32_16x16x32_bf16 v[112:115], a[64:67], a[152:155], v[112:115]
buffer_load_dwordx4 a[20:23], v244, s[20:23], s65 offen offset:1024 sc0 sc1
v_accvgpr_read_b32 v45, a225
v_mfma_f32_16x16x32_bf16 v[120:123], a[64:67], a[168:171], v[120:123]
v_accvgpr_read_b32 v59, a235
v_lshlrev_b32 v44, 16, v45
v_mfma_f32_16x16x32_bf16 v[128:131], a[64:67], a[184:187], v[128:131]
v_and_b32 v45, 0xffff0000, v45
v_lshlrev_b32 v58, 16, v59
s_waitcnt lgkmcnt(8)
v_mfma_f32_16x16x32_bf16 v[108:111], a[68:71], a[136:139], v[108:111]
ds_read_b64_tr_b16 a[64:65], v216 offset:27656
ds_read_b64_tr_b16 a[66:67], v216 offset:32264
v_mfma_f32_16x16x32_bf16 v[116:119], a[68:71], a[152:155], v[116:119]
buffer_load_dwordx4 a[36:39], v244, s[20:23], s66 offen offset:1024 sc0 sc1
v_and_b32 v59, 0xffff0000, v59
v_mfma_f32_16x16x32_bf16 v[124:127], a[68:71], a[168:171], v[124:127]
v_add_f32 v44, v44, v58
v_add_f32 v45, v45, v59
v_mfma_f32_16x16x32_bf16 v[132:135], a[68:71], a[184:187], v[132:135]
v_cvt_pk_bf16_f32 v58, v44, v45
v_lshlrev_b32 v44, 16, v58
v_mfma_f32_16x16x32_bf16 v[136:139], a[72:75], a[136:139], v[136:139]
ds_read_b64_tr_b16 a[68:69], v217 offset:27648
ds_read_b64_tr_b16 a[70:71], v217 offset:32256
v_mfma_f32_16x16x32_bf16 v[144:147], a[72:75], a[152:155], v[144:147]
buffer_load_dwordx4 a[52:55], v244, s[20:23], s67 offen offset:1024 sc0 sc1
v_and_b32 v45, 0xffff0000, v58
v_mfma_f32_16x16x32_bf16 v[152:155], a[72:75], a[168:171], v[152:155]
v_mul_f32 v58, 0xbfb8aa3b, v44
v_mul_f32 v59, 0xbfb8aa3b, v45
v_mfma_f32_16x16x32_bf16 v[160:163], a[72:75], a[184:187], v[160:163]
v_exp_f32 v58, v58
v_mfma_f32_16x16x32_bf16 v[140:143], a[76:79], a[136:139], v[140:143]
ds_read_b64_tr_b16 a[72:73], v217 offset:27656
ds_read_b64_tr_b16 a[74:75], v217 offset:32264
v_mfma_f32_16x16x32_bf16 v[148:151], a[76:79], a[152:155], v[148:151]
buffer_load_dwordx4 a[8:11], v244, s[20:23], s64 offen offset:2048 sc0 sc1
v_mfma_f32_16x16x32_bf16 v[156:159], a[76:79], a[168:171], v[156:159]
v_exp_f32 v59, v59
v_mfma_f32_16x16x32_bf16 v[164:167], a[76:79], a[184:187], v[164:167]
v_add_f32 v58, 1.0, v58
v_add_f32 v59, 1.0, v59
s_waitcnt lgkmcnt(8)
v_mfma_f32_16x16x32_bf16 v[168:171], a[80:83], a[136:139], v[168:171]
ds_read_b64_tr_b16 a[76:77], v216 offset:27776
ds_read_b64_tr_b16 a[78:79], v216 offset:32384
v_mfma_f32_16x16x32_bf16 v[176:179], a[80:83], a[152:155], v[176:179]
buffer_load_dwordx4 a[24:27], v244, s[20:23], s65 offen offset:2048 sc0 sc1
v_mfma_f32_16x16x32_bf16 v[184:187], a[80:83], a[168:171], v[184:187]
v_rcp_f32 v58, v58
v_mfma_f32_16x16x32_bf16 v[192:195], a[80:83], a[184:187], v[192:195]
v_rcp_f32 v59, v59
v_mfma_f32_16x16x32_bf16 v[172:175], a[84:87], a[136:139], v[172:175]
ds_read_b64_tr_b16 a[80:81], v216 offset:27784
ds_read_b64_tr_b16 a[82:83], v216 offset:32392
v_mfma_f32_16x16x32_bf16 v[180:183], a[84:87], a[152:155], v[180:183]
buffer_load_dwordx4 a[40:43], v244, s[20:23], s66 offen offset:2048 sc0 sc1
v_mul_f32 v44, v44, v58
v_mfma_f32_16x16x32_bf16 v[188:191], a[84:87], a[168:171], v[188:191]
v_mul_f32 v45, v45, v59
v_cvt_pk_bf16_f32 v58, v44, v45
v_mfma_f32_16x16x32_bf16 v[196:199], a[84:87], a[184:187], v[196:199]
v_lshlrev_b32 v44, 16, v58
v_and_b32 v45, 0xffff0000, v58
v_mfma_f32_16x16x32_bf16 v[200:203], a[88:91], a[136:139], v[200:203]
ds_read_b64_tr_b16 a[84:85], v217 offset:27776
ds_read_b64_tr_b16 a[86:87], v217 offset:32384
v_mfma_f32_16x16x32_bf16 v[204:207], a[88:91], a[152:155], v[204:207]
buffer_load_dwordx4 a[56:59], v244, s[20:23], s67 offen offset:2048 sc0 sc1
v_accvgpr_read_b32 v47, a226
v_mfma_f32_16x16x32_bf16 v[208:211], a[88:91], a[168:171], v[208:211]
v_accvgpr_read_b32 v59, a236
v_lshlrev_b32 v46, 16, v47
v_mfma_f32_16x16x32_bf16 v[212:215], a[88:91], a[184:187], v[212:215]
v_and_b32 v47, 0xffff0000, v47
v_lshlrev_b32 v58, 16, v59
s_waitcnt vmcnt(28)
s_waitcnt lgkmcnt(8)
v_mfma_f32_16x16x32_bf16 v[72:75], a[92:95], a[140:143], v[72:75]
ds_read_b64_tr_b16 a[88:89], v217 offset:27784
ds_read_b64_tr_b16 a[90:91], v217 offset:32392
v_mfma_f32_16x16x32_bf16 v[80:83], a[92:95], a[156:159], v[80:83]
buffer_load_dwordx4 a[12:15], v244, s[20:23], s64 offen offset:3072 sc0 sc1
v_and_b32 v59, 0xffff0000, v59
v_mfma_f32_16x16x32_bf16 v[88:91], a[92:95], a[172:175], v[88:91]
v_add_f32 v46, v46, v58
v_add_f32 v47, v47, v59
v_mfma_f32_16x16x32_bf16 v[96:99], a[92:95], a[188:191], v[96:99]
v_cvt_pk_bf16_f32 v58, v46, v47
v_lshlrev_b32 v46, 16, v58
v_mfma_f32_16x16x32_bf16 v[76:79], a[64:67], a[140:143], v[76:79]
ds_read_b64_tr_b16 a[92:93], v218 offset:27648
ds_read_b64_tr_b16 a[94:95], v218 offset:32256
v_mfma_f32_16x16x32_bf16 v[84:87], a[64:67], a[156:159], v[84:87]
buffer_load_dwordx4 a[28:31], v244, s[20:23], s65 offen offset:3072 sc0 sc1
v_and_b32 v47, 0xffff0000, v58
v_mfma_f32_16x16x32_bf16 v[92:95], a[64:67], a[172:175], v[92:95]
v_mul_f32 v58, 0xbfb8aa3b, v46
v_mul_f32 v59, 0xbfb8aa3b, v47
v_mfma_f32_16x16x32_bf16 v[100:103], a[64:67], a[188:191], v[100:103]
v_exp_f32 v58, v58
v_mfma_f32_16x16x32_bf16 v[104:107], a[68:71], a[140:143], v[104:107]
ds_read_b64_tr_b16 a[64:65], v221 offset:0
ds_read_b64_tr_b16 a[66:67], v221 offset:4608
v_mfma_f32_16x16x32_bf16 v[112:115], a[68:71], a[156:159], v[112:115]
buffer_load_dwordx4 a[44:47], v244, s[20:23], s66 offen offset:3072 sc0 sc1
v_mfma_f32_16x16x32_bf16 v[120:123], a[68:71], a[172:175], v[120:123]
v_exp_f32 v59, v59
v_mfma_f32_16x16x32_bf16 v[128:131], a[68:71], a[188:191], v[128:131]
v_add_f32 v58, 1.0, v58
v_add_f32 v59, 1.0, v59
s_waitcnt lgkmcnt(8)
v_mfma_f32_16x16x32_bf16 v[108:111], a[72:75], a[140:143], v[108:111]
ds_read_b64_tr_b16 a[68:69], v221 offset:9216
ds_read_b64_tr_b16 a[70:71], v221 offset:13824
v_mfma_f32_16x16x32_bf16 v[116:119], a[72:75], a[156:159], v[116:119]
buffer_load_dwordx4 a[60:63], v244, s[20:23], s67 offen offset:3072 sc0 sc1
v_mfma_f32_16x16x32_bf16 v[124:127], a[72:75], a[172:175], v[124:127]
s_lshl2_add_u32 s28, s36, s33
s_lshl2_add_u32 s28, s28, s37
v_mfma_f32_16x16x32_bf16 v[132:135], a[72:75], a[188:191], v[132:135]
s_lshl_b32 s95, s28, 5
s_add_u32 s95, s95, 0x24a000
v_mfma_f32_16x16x32_bf16 v[136:139], a[76:79], a[140:143], v[136:139]
ds_read_b64_tr_b16 a[72:73], v221 offset:18432
ds_read_b64_tr_b16 a[74:75], v221 offset:23040
v_mfma_f32_16x16x32_bf16 v[144:147], a[76:79], a[156:159], v[144:147]
s_lshl_b32 s28, s32, 18
s_sub_u32 s49, s44, s28
v_mfma_f32_16x16x32_bf16 v[152:155], a[76:79], a[172:175], v[152:155]
v_add_u32 v243, 0x2000, v244
v_mov_b32 v246, 2
v_mfma_f32_16x16x32_bf16 v[160:163], a[76:79], a[188:191], v[160:163]
s_lshl2_add_u32 s29, s33, s94
v_mfma_f32_16x16x32_bf16 v[140:143], a[80:83], a[140:143], v[140:143]
ds_read_b64_tr_b16 a[76:77], v221 offset:27648
ds_read_b64_tr_b16 a[78:79], v221 offset:32256
v_mfma_f32_16x16x32_bf16 v[148:151], a[80:83], a[156:159], v[148:151]
v_rcp_f32 v58, v58
v_mfma_f32_16x16x32_bf16 v[156:159], a[80:83], a[172:175], v[156:159]
v_rcp_f32 v59, v59
v_mfma_f32_16x16x32_bf16 v[164:167], a[80:83], a[188:191], v[164:167]
v_mul_f32 v46, v46, v58
v_mul_f32 v47, v47, v59
s_waitcnt lgkmcnt(8)
v_mfma_f32_16x16x32_bf16 v[168:171], a[84:87], a[140:143], v[168:171]
ds_read_b64_tr_b16 a[80:81], v224 offset:0
ds_read_b64_tr_b16 a[82:83], v224 offset:4608
v_mfma_f32_16x16x32_bf16 v[176:179], a[84:87], a[156:159], v[176:179]
v_cvt_pk_bf16_f32 v58, v46, v47
v_lshlrev_b32 v46, 16, v58
v_mfma_f32_16x16x32_bf16 v[184:187], a[84:87], a[172:175], v[184:187]
v_and_b32 v47, 0xffff0000, v58
v_accvgpr_read_b32 v49, a227
v_mfma_f32_16x16x32_bf16 v[192:195], a[84:87], a[188:191], v[192:195]
v_accvgpr_read_b32 v59, a237
v_lshlrev_b32 v48, 16, v49
v_mfma_f32_16x16x32_bf16 v[172:175], a[88:91], a[140:143], v[172:175]
ds_read_b64_tr_b16 a[84:85], v224 offset:9216
ds_read_b64_tr_b16 a[86:87], v224 offset:13824
v_mfma_f32_16x16x32_bf16 v[180:183], a[88:91], a[156:159], v[180:183]
v_and_b32 v49, 0xffff0000, v49
v_lshlrev_b32 v58, 16, v59
v_mfma_f32_16x16x32_bf16 v[188:191], a[88:91], a[172:175], v[188:191]
v_and_b32 v59, 0xffff0000, v59
v_add_f32 v48, v48, v58
v_mfma_f32_16x16x32_bf16 v[196:199], a[88:91], a[188:191], v[196:199]
v_add_f32 v49, v49, v59
v_cvt_pk_bf16_f32 v58, v48, v49
v_mfma_f32_16x16x32_bf16 v[200:203], a[92:95], a[140:143], v[200:203]
ds_read_b64_tr_b16 a[88:89], v224 offset:18432
ds_read_b64_tr_b16 a[90:91], v224 offset:23040
v_mfma_f32_16x16x32_bf16 v[204:207], a[92:95], a[156:159], v[204:207]
v_lshlrev_b32 v48, 16, v58
v_and_b32 v49, 0xffff0000, v58
v_mfma_f32_16x16x32_bf16 v[208:211], a[92:95], a[172:175], v[208:211]
v_mul_f32 v58, 0xbfb8aa3b, v48
v_mul_f32 v59, 0xbfb8aa3b, v49
v_mfma_f32_16x16x32_bf16 v[212:215], a[92:95], a[188:191], v[212:215]
v_exp_f32 v58, v58
s_waitcnt vmcnt(28)
s_waitcnt lgkmcnt(8)
v_mfma_f32_16x16x32_bf16 v[200:203], a[64:67], a[192:195], v[200:203]
ds_read_b64_tr_b16 a[92:93], v224 offset:27648
ds_read_b64_tr_b16 a[94:95], v224 offset:32256
v_mfma_f32_16x16x32_bf16 v[204:207], a[64:67], a[208:211], v[204:207]
v_exp_f32 v59, v59
v_mfma_f32_16x16x32_bf16 v[208:211], a[64:67], a[96:99], v[208:211]
v_add_f32 v58, 1.0, v58
v_add_f32 v59, 1.0, v59
v_mfma_f32_16x16x32_bf16 v[212:215], a[64:67], a[112:115], v[212:215]
v_rcp_f32 v58, v58
s_waitcnt vmcnt(24)
v_mfma_f32_16x16x32_bf16 v[200:203], a[68:71], a[196:199], v[200:203]
ds_read_b64_tr_b16 a[64:65], v219 offset:0
ds_read_b64_tr_b16 a[66:67], v219 offset:4608
v_mfma_f32_16x16x32_bf16 v[204:207], a[68:71], a[244:247], v[204:207]
v_rcp_f32 v59, v59
v_mfma_f32_16x16x32_bf16 v[208:211], a[68:71], a[100:103], v[208:211]
v_mul_f32 v48, v48, v58
v_mul_f32 v49, v49, v59
v_mfma_f32_16x16x32_bf16 v[212:215], a[68:71], a[116:119], v[212:215]
s_waitcnt vmcnt(0)
buffer_store_dword v246, v254, s[20:23], s29 offen
s_waitcnt vmcnt(21)
v_mfma_f32_16x16x32_bf16 v[200:203], a[72:75], a[200:203], v[200:203]
ds_read_b64_tr_b16 a[68:69], v219 offset:9216
ds_read_b64_tr_b16 a[70:71], v219 offset:13824
v_mfma_f32_16x16x32_bf16 v[204:207], a[72:75], a[248:251], v[204:207]
s_add_u32 s28, s32, 0
s_and_b32 s28, s28, 7
v_mfma_f32_16x16x32_bf16 v[208:211], a[72:75], a[104:107], v[208:211]
s_xor_b32 s29, s28, s32
s_lshl_b32 s28, s28, 18
v_mfma_f32_16x16x32_bf16 v[212:215], a[72:75], a[120:123], v[212:215]
s_add_u32 s28, s28, s49
s_and_b32 s29, s29, 4
s_waitcnt vmcnt(17)
s_waitcnt lgkmcnt(8)
v_mfma_f32_16x16x32_bf16 v[200:203], a[76:79], a[204:207], v[200:203]
ds_read_b64_tr_b16 a[72:73], v219 offset:18432
ds_read_b64_tr_b16 a[74:75], v219 offset:23040
v_mfma_f32_16x16x32_bf16 v[204:207], a[76:79], a[252:255], v[204:207]
s_add_u32 s72, s28, 0
s_lshl_b32 s29, s29, 10
v_mfma_f32_16x16x32_bf16 v[208:211], a[76:79], a[108:111], v[208:211]
s_add_u32 s28, s32, 1
s_and_b32 s28, s28, 7
v_mfma_f32_16x16x32_bf16 v[212:215], a[76:79], a[124:127], v[212:215]
s_xor_b32 s29, s28, s32
s_lshl_b32 s28, s28, 18
s_waitcnt vmcnt(13)
v_mfma_f32_16x16x32_bf16 v[200:203], a[80:83], a[0:3], v[200:203]
ds_read_b64_tr_b16 a[76:77], v219 offset:27648
ds_read_b64_tr_b16 a[78:79], v219 offset:32256
v_mfma_f32_16x16x32_bf16 v[204:207], a[80:83], a[16:19], v[204:207]
s_add_u32 s28, s28, s49
s_and_b32 s29, s29, 4
v_mfma_f32_16x16x32_bf16 v[208:211], a[80:83], a[32:35], v[208:211]
s_add_u32 s73, s28, 8192
s_lshl_b32 s29, s29, 10
v_mfma_f32_16x16x32_bf16 v[212:215], a[80:83], a[48:51], v[212:215]
s_add_u32 s65, s28, s29
v_cvt_pk_bf16_f32 v58, v48, v49
s_waitcnt vmcnt(9)
v_mfma_f32_16x16x32_bf16 v[200:203], a[84:87], a[4:7], v[200:203]
ds_read_b64_tr_b16 a[80:81], v222 offset:0
ds_read_b64_tr_b16 a[82:83], v222 offset:4608
v_mfma_f32_16x16x32_bf16 v[204:207], a[84:87], a[20:23], v[204:207]
s_add_u32 s28, s32, 2
s_and_b32 s28, s28, 7
v_mfma_f32_16x16x32_bf16 v[208:211], a[84:87], a[36:39], v[208:211]
s_xor_b32 s29, s28, s32
s_lshl_b32 s28, s28, 18
v_mfma_f32_16x16x32_bf16 v[212:215], a[84:87], a[52:55], v[212:215]
s_add_u32 s28, s28, s49
s_and_b32 s29, s29, 4
s_waitcnt vmcnt(5)
s_waitcnt lgkmcnt(8)
v_mfma_f32_16x16x32_bf16 v[200:203], a[88:91], a[8:11], v[200:203]
ds_read_b64_tr_b16 a[84:85], v222 offset:9216
ds_read_b64_tr_b16 a[86:87], v222 offset:13824
v_mfma_f32_16x16x32_bf16 v[204:207], a[88:91], a[24:27], v[204:207]
s_add_u32 s74, s28, 8192
s_lshl_b32 s29, s29, 10
v_mfma_f32_16x16x32_bf16 v[208:211], a[88:91], a[40:43], v[208:211]
s_add_u32 s66, s28, s29
v_lshlrev_b32 v48, 16, v58
v_mfma_f32_16x16x32_bf16 v[212:215], a[88:91], a[56:59], v[212:215]
s_add_u32 s28, s32, 3
s_and_b32 s28, s28, 7
s_waitcnt vmcnt(1)
v_mfma_f32_16x16x32_bf16 v[200:203], a[92:95], a[12:15], v[200:203]
ds_read_b64_tr_b16 a[88:89], v222 offset:18432
ds_read_b64_tr_b16 a[90:91], v222 offset:23040
v_mfma_f32_16x16x32_bf16 v[204:207], a[92:95], a[28:31], v[204:207]
s_xor_b32 s29, s28, s32
s_lshl_b32 s28, s28, 18
v_mfma_f32_16x16x32_bf16 v[208:211], a[92:95], a[44:47], v[208:211]
s_add_u32 s28, s28, s49
s_and_b32 s29, s29, 4
v_mfma_f32_16x16x32_bf16 v[212:215], a[92:95], a[60:63], v[212:215]
s_add_u32 s75, s28, 0
s_lshl_b32 s29, s29, 10
v_mfma_f32_16x16x32_bf16 v[72:75], a[64:67], a[192:195], v[72:75]
ds_read_b64_tr_b16 a[92:93], v222 offset:27648
ds_read_b64_tr_b16 a[94:95], v222 offset:32256
v_mfma_f32_16x16x32_bf16 v[80:83], a[64:67], a[208:211], v[80:83]
s_add_u32 s67, s28, s29
v_and_b32 v49, 0xffff0000, v58
v_mfma_f32_16x16x32_bf16 v[88:91], a[64:67], a[96:99], v[88:91]
buffer_load_dword v230, v229, s[20:23], s94 offen sc0 sc1
v_accvgpr_read_b32 v51, a228
v_mfma_f32_16x16x32_bf16 v[96:99], a[64:67], a[112:115], v[96:99]
s_add_u32 s28, s32, 4
s_and_b32 s28, s28, 7
s_waitcnt lgkmcnt(8)
v_mfma_f32_16x16x32_bf16 v[72:75], a[68:71], a[196:199], v[72:75]
ds_read_b64_tr_b16 a[64:65], v219 offset:8
ds_read_b64_tr_b16 a[66:67], v219 offset:4616
v_mfma_f32_16x16x32_bf16 v[80:83], a[68:71], a[244:247], v[80:83]
s_xor_b32 s29, s28, s32
s_lshl_b32 s28, s28, 18
v_mfma_f32_16x16x32_bf16 v[88:91], a[68:71], a[100:103], v[88:91]
s_add_u32 s28, s28, s49
s_and_b32 s29, s29, 4
v_mfma_f32_16x16x32_bf16 v[96:99], a[68:71], a[116:119], v[96:99]
s_add_u32 s84, s28, 0
s_lshl_b32 s29, s29, 10
v_mfma_f32_16x16x32_bf16 v[72:75], a[72:75], a[200:203], v[72:75]
ds_read_b64_tr_b16 a[68:69], v219 offset:9224
ds_read_b64_tr_b16 a[70:71], v219 offset:13832
v_mfma_f32_16x16x32_bf16 v[80:83], a[72:75], a[248:251], v[80:83]
s_add_u32 s68, s28, s29
v_accvgpr_read_b32 v59, a238
v_mfma_f32_16x16x32_bf16 v[88:91], a[72:75], a[104:107], v[88:91]
s_add_u32 s28, s32, 5
s_and_b32 s28, s28, 7
v_mfma_f32_16x16x32_bf16 v[96:99], a[72:75], a[120:123], v[96:99]
s_xor_b32 s29, s28, s32
s_lshl_b32 s28, s28, 18
v_mfma_f32_16x16x32_bf16 v[72:75], a[76:79], a[204:207], v[72:75]
ds_read_b64_tr_b16 a[72:73], v219 offset:18440
ds_read_b64_tr_b16 a[74:75], v219 offset:23048
v_mfma_f32_16x16x32_bf16 v[80:83], a[76:79], a[252:255], v[80:83]
s_add_u32 s28, s28, s49
s_and_b32 s29, s29, 4
v_mfma_f32_16x16x32_bf16 v[88:91], a[76:79], a[108:111], v[88:91]
s_add_u32 s85, s28, 8192
s_lshl_b32 s29, s29, 10
v_mfma_f32_16x16x32_bf16 v[96:99], a[76:79], a[124:127], v[96:99]
s_add_u32 s69, s28, s29
v_lshlrev_b32 v50, 16, v51
s_waitcnt lgkmcnt(8)
v_mfma_f32_16x16x32_bf16 v[72:75], a[80:83], a[0:3], v[72:75]
ds_read_b64_tr_b16 a[76:77], v219 offset:27656
ds_read_b64_tr_b16 a[78:79], v219 offset:32264
v_mfma_f32_16x16x32_bf16 v[80:83], a[80:83], a[16:19], v[80:83]
s_add_u32 s28, s32, 6
s_and_b32 s28, s28, 7
v_mfma_f32_16x16x32_bf16 v[88:91], a[80:83], a[32:35], v[88:91]
s_xor_b32 s29, s28, s32
s_lshl_b32 s28, s28, 18
v_mfma_f32_16x16x32_bf16 v[96:99], a[80:83], a[48:51], v[96:99]
s_add_u32 s28, s28, s49
s_and_b32 s29, s29, 4
v_mfma_f32_16x16x32_bf16 v[72:75], a[84:87], a[4:7], v[72:75]
ds_read_b64_tr_b16 a[80:81], v222 offset:8
ds_read_b64_tr_b16 a[82:83], v222 offset:4616
v_mfma_f32_16x16x32_bf16 v[80:83], a[84:87], a[20:23], v[80:83]
s_add_u32 s86, s28, 8192
s_lshl_b32 s29, s29, 10
v_mfma_f32_16x16x32_bf16 v[88:91], a[84:87], a[36:39], v[88:91]
s_add_u32 s70, s28, s29
v_and_b32 v51, 0xffff0000, v51
v_mfma_f32_16x16x32_bf16 v[96:99], a[84:87], a[52:55], v[96:99]
s_add_u32 s28, s32, 7
s_and_b32 s28, s28, 7
v_mfma_f32_16x16x32_bf16 v[72:75], a[88:91], a[8:11], v[72:75]
ds_read_b64_tr_b16 a[84:85], v222 offset:9224
ds_read_b64_tr_b16 a[86:87], v222 offset:13832
v_mfma_f32_16x16x32_bf16 v[80:83], a[88:91], a[24:27], v[80:83]
s_xor_b32 s29, s28, s32
s_lshl_b32 s28, s28, 18
v_mfma_f32_16x16x32_bf16 v[88:91], a[88:91], a[40:43], v[88:91]
s_add_u32 s28, s28, s49
s_and_b32 s29, s29, 4
v_mfma_f32_16x16x32_bf16 v[96:99], a[88:91], a[56:59], v[96:99]
s_add_u32 s87, s28, 0
s_lshl_b32 s29, s29, 10
s_waitcnt lgkmcnt(8)
v_mfma_f32_16x16x32_bf16 v[72:75], a[92:95], a[12:15], v[72:75]
ds_read_b64_tr_b16 a[88:89], v222 offset:18440
ds_read_b64_tr_b16 a[90:91], v222 offset:23048
v_mfma_f32_16x16x32_bf16 v[80:83], a[92:95], a[28:31], v[80:83]
s_add_u32 s71, s28, s29
v_lshlrev_b32 v58, 16, v59
v_mfma_f32_16x16x32_bf16 v[88:91], a[92:95], a[44:47], v[88:91]
s_waitcnt vmcnt(0)
v_cmp_gt_u32 vcc, 2, v230
v_mfma_f32_16x16x32_bf16 v[96:99], a[92:95], a[60:63], v[96:99]
v_and_b32 v59, 0xffff0000, v59
v_add_f32 v50, v50, v58
v_mfma_f32_16x16x32_bf16 v[76:79], a[64:67], a[192:195], v[76:79]
ds_read_b64_tr_b16 a[92:93], v222 offset:27656
ds_read_b64_tr_b16 a[94:95], v222 offset:32264
v_mfma_f32_16x16x32_bf16 v[84:87], a[64:67], a[208:211], v[84:87]
s_and_b32 s29, vcc_lo, 15
s_cbranch_scc1 SP_O3A
SP_O3A_RET:
v_mfma_f32_16x16x32_bf16 v[92:95], a[64:67], a[96:99], v[92:95]
s_add_u32 s39, s44, 8192
v_add_f32 v51, v51, v59
v_mfma_f32_16x16x32_bf16 v[100:103], a[64:67], a[112:115], v[100:103]
v_cvt_pk_bf16_f32 v200, v200, v201
v_cvt_pk_bf16_f32 v201, v202, v203
v_mfma_f32_16x16x32_bf16 v[76:79], a[68:71], a[196:199], v[76:79]
ds_read_b64_tr_b16 a[64:65], v220 offset:0
ds_read_b64_tr_b16 a[66:67], v220 offset:4608
v_mfma_f32_16x16x32_bf16 v[84:87], a[68:71], a[244:247], v[84:87]
buffer_store_dwordx2 v[200:201], v226, s[20:23], s44 offen offset:0
v_cvt_pk_bf16_f32 v58, v50, v51
v_mfma_f32_16x16x32_bf16 v[92:95], a[68:71], a[100:103], v[92:95]
v_cvt_pk_bf16_f32 v204, v204, v205
v_cvt_pk_bf16_f32 v205, v206, v207
v_mfma_f32_16x16x32_bf16 v[100:103], a[68:71], a[116:119], v[100:103]
buffer_store_dwordx2 v[204:205], v226, s[20:23], s44 offen offset:512
v_lshlrev_b32 v50, 16, v58
s_waitcnt lgkmcnt(8)
v_mfma_f32_16x16x32_bf16 v[76:79], a[72:75], a[200:203], v[76:79]
ds_read_b64_tr_b16 a[68:69], v220 offset:9216
ds_read_b64_tr_b16 a[70:71], v220 offset:13824
v_mfma_f32_16x16x32_bf16 v[84:87], a[72:75], a[248:251], v[84:87]
v_cvt_pk_bf16_f32 v208, v208, v209
v_cvt_pk_bf16_f32 v209, v210, v211
v_mfma_f32_16x16x32_bf16 v[92:95], a[72:75], a[104:107], v[92:95]
buffer_store_dwordx2 v[208:209], v226, s[20:23], s39 offen offset:0
v_and_b32 v51, 0xffff0000, v58
v_mfma_f32_16x16x32_bf16 v[100:103], a[72:75], a[120:123], v[100:103]
v_cvt_pk_bf16_f32 v212, v212, v213
v_cvt_pk_bf16_f32 v213, v214, v215
v_mfma_f32_16x16x32_bf16 v[76:79], a[76:79], a[204:207], v[76:79]
ds_read_b64_tr_b16 a[72:73], v220 offset:18432
ds_read_b64_tr_b16 a[74:75], v220 offset:23040
v_mfma_f32_16x16x32_bf16 v[84:87], a[76:79], a[252:255], v[84:87]
buffer_store_dwordx2 v[212:213], v226, s[20:23], s39 offen offset:512
v_mul_f32 v58, 0xbfb8aa3b, v50
v_mfma_f32_16x16x32_bf16 v[92:95], a[76:79], a[108:111], v[92:95]
v_mul_f32 v59, 0xbfb8aa3b, v51
v_mfma_f32_16x16x32_bf16 v[100:103], a[76:79], a[124:127], v[100:103]
v_exp_f32 v58, v58
v_mfma_f32_16x16x32_bf16 v[76:79], a[80:83], a[0:3], v[76:79]
ds_read_b64_tr_b16 a[76:77], v220 offset:27648
ds_read_b64_tr_b16 a[78:79], v220 offset:32256
v_mfma_f32_16x16x32_bf16 v[84:87], a[80:83], a[16:19], v[84:87]
v_exp_f32 v59, v59
v_mfma_f32_16x16x32_bf16 v[92:95], a[80:83], a[32:35], v[92:95]
v_add_f32 v58, 1.0, v58
v_add_f32 v59, 1.0, v59
v_mfma_f32_16x16x32_bf16 v[100:103], a[80:83], a[48:51], v[100:103]
v_rcp_f32 v58, v58
s_waitcnt lgkmcnt(8)
v_mfma_f32_16x16x32_bf16 v[76:79], a[84:87], a[4:7], v[76:79]
ds_read_b64_tr_b16 a[80:81], v223 offset:0
ds_read_b64_tr_b16 a[82:83], v223 offset:4608
v_mfma_f32_16x16x32_bf16 v[84:87], a[84:87], a[20:23], v[84:87]
v_rcp_f32 v59, v59
v_mfma_f32_16x16x32_bf16 v[92:95], a[84:87], a[36:39], v[92:95]
v_mul_f32 v50, v50, v58
v_mul_f32 v51, v51, v59
v_mfma_f32_16x16x32_bf16 v[100:103], a[84:87], a[52:55], v[100:103]
v_cvt_pk_bf16_f32 v58, v50, v51
v_lshlrev_b32 v50, 16, v58
v_mfma_f32_16x16x32_bf16 v[76:79], a[88:91], a[8:11], v[76:79]
ds_read_b64_tr_b16 a[84:85], v223 offset:9216
ds_read_b64_tr_b16 a[86:87], v223 offset:13824
v_mfma_f32_16x16x32_bf16 v[84:87], a[88:91], a[24:27], v[84:87]
v_and_b32 v51, 0xffff0000, v58
v_accvgpr_read_b32 v53, a229
v_mfma_f32_16x16x32_bf16 v[92:95], a[88:91], a[40:43], v[92:95]
v_accvgpr_read_b32 v59, a239
v_lshlrev_b32 v52, 16, v53
v_mfma_f32_16x16x32_bf16 v[100:103], a[88:91], a[56:59], v[100:103]
v_and_b32 v53, 0xffff0000, v53
v_lshlrev_b32 v58, 16, v59
v_mfma_f32_16x16x32_bf16 v[76:79], a[92:95], a[12:15], v[76:79]
ds_read_b64_tr_b16 a[88:89], v223 offset:18432
ds_read_b64_tr_b16 a[90:91], v223 offset:23040
v_mfma_f32_16x16x32_bf16 v[84:87], a[92:95], a[28:31], v[84:87]
v_and_b32 v59, 0xffff0000, v59
v_add_f32 v52, v52, v58
v_mfma_f32_16x16x32_bf16 v[92:95], a[92:95], a[44:47], v[92:95]
v_add_f32 v53, v53, v59
v_cvt_pk_bf16_f32 v58, v52, v53
v_mfma_f32_16x16x32_bf16 v[100:103], a[92:95], a[60:63], v[100:103]
v_lshlrev_b32 v52, 16, v58
v_and_b32 v53, 0xffff0000, v58
s_waitcnt lgkmcnt(8)
v_mfma_f32_16x16x32_bf16 v[104:107], a[64:67], a[192:195], v[104:107]
ds_read_b64_tr_b16 a[92:93], v223 offset:27648
ds_read_b64_tr_b16 a[94:95], v223 offset:32256
v_mfma_f32_16x16x32_bf16 v[112:115], a[64:67], a[208:211], v[112:115]
v_mul_f32 v58, 0xbfb8aa3b, v52
v_mul_f32 v59, 0xbfb8aa3b, v53
v_mfma_f32_16x16x32_bf16 v[120:123], a[64:67], a[96:99], v[120:123]
v_exp_f32 v58, v58
v_mfma_f32_16x16x32_bf16 v[128:131], a[64:67], a[112:115], v[128:131]
v_exp_f32 v59, v59
v_mfma_f32_16x16x32_bf16 v[104:107], a[68:71], a[196:199], v[104:107]
ds_read_b64_tr_b16 a[64:65], v220 offset:8
ds_read_b64_tr_b16 a[66:67], v220 offset:4616
v_mfma_f32_16x16x32_bf16 v[112:115], a[68:71], a[244:247], v[112:115]
v_add_f32 v58, 1.0, v58
v_add_f32 v59, 1.0, v59
v_mfma_f32_16x16x32_bf16 v[120:123], a[68:71], a[100:103], v[120:123]
v_rcp_f32 v58, v58
v_mfma_f32_16x16x32_bf16 v[128:131], a[68:71], a[116:119], v[128:131]
v_rcp_f32 v59, v59
v_mfma_f32_16x16x32_bf16 v[104:107], a[72:75], a[200:203], v[104:107]
ds_read_b64_tr_b16 a[68:69], v220 offset:9224
ds_read_b64_tr_b16 a[70:71], v220 offset:13832
v_mfma_f32_16x16x32_bf16 v[112:115], a[72:75], a[248:251], v[112:115]
s_add_u32 s39, s44, 0
v_mul_f32 v52, v52, v58
v_mfma_f32_16x16x32_bf16 v[120:123], a[72:75], a[104:107], v[120:123]
v_cvt_pk_bf16_f32 v80, v80, v81
v_cvt_pk_bf16_f32 v81, v82, v83
v_mfma_f32_16x16x32_bf16 v[128:131], a[72:75], a[120:123], v[128:131]
v_cvt_pk_bf16_f32 v82, v84, v85
v_cvt_pk_bf16_f32 v83, v86, v87
s_waitcnt lgkmcnt(8)
v_mfma_f32_16x16x32_bf16 v[104:107], a[76:79], a[204:207], v[104:107]
ds_read_b64_tr_b16 a[72:73], v220 offset:18440
ds_read_b64_tr_b16 a[74:75], v220 offset:23048
v_mfma_f32_16x16x32_bf16 v[112:115], a[76:79], a[252:255], v[112:115]
buffer_store_dwordx4 v[80:83], v244, s[20:23], s39 offen offset:1024
v_mul_f32 v53, v53, v59
v_mfma_f32_16x16x32_bf16 v[120:123], a[76:79], a[108:111], v[120:123]
v_cvt_pk_bf16_f32 v88, v88, v89
v_cvt_pk_bf16_f32 v89, v90, v91
v_mfma_f32_16x16x32_bf16 v[128:131], a[76:79], a[124:127], v[128:131]
v_cvt_pk_bf16_f32 v90, v92, v93
v_cvt_pk_bf16_f32 v91, v94, v95
v_mfma_f32_16x16x32_bf16 v[104:107], a[80:83], a[0:3], v[104:107]
ds_read_b64_tr_b16 a[76:77], v220 offset:27656
ds_read_b64_tr_b16 a[78:79], v220 offset:32264
v_mfma_f32_16x16x32_bf16 v[112:115], a[80:83], a[16:19], v[112:115]
buffer_store_dwordx4 v[88:91], v244, s[20:23], s39 offen offset:2048
v_cvt_pk_bf16_f32 v58, v52, v53
v_mfma_f32_16x16x32_bf16 v[120:123], a[80:83], a[32:35], v[120:123]
v_cvt_pk_bf16_f32 v96, v96, v97
v_cvt_pk_bf16_f32 v97, v98, v99
v_mfma_f32_16x16x32_bf16 v[128:131], a[80:83], a[48:51], v[128:131]
v_cvt_pk_bf16_f32 v98, v100, v101
v_cvt_pk_bf16_f32 v99, v102, v103
v_mfma_f32_16x16x32_bf16 v[104:107], a[84:87], a[4:7], v[104:107]
ds_read_b64_tr_b16 a[80:81], v223 offset:8
ds_read_b64_tr_b16 a[82:83], v223 offset:4616
v_mfma_f32_16x16x32_bf16 v[112:115], a[84:87], a[20:23], v[112:115]
buffer_store_dwordx4 v[96:99], v244, s[20:23], s39 offen offset:3072
v_lshlrev_b32 v52, 16, v58
v_mfma_f32_16x16x32_bf16 v[120:123], a[84:87], a[36:39], v[120:123]
v_and_b32 v53, 0xffff0000, v58
v_accvgpr_read_b32 v55, a230
v_mfma_f32_16x16x32_bf16 v[128:131], a[84:87], a[52:55], v[128:131]
v_accvgpr_read_b32 v59, a240
v_lshlrev_b32 v54, 16, v55
s_waitcnt lgkmcnt(8)
v_mfma_f32_16x16x32_bf16 v[104:107], a[88:91], a[8:11], v[104:107]
ds_read_b64_tr_b16 a[84:85], v223 offset:9224
ds_read_b64_tr_b16 a[86:87], v223 offset:13832
v_mfma_f32_16x16x32_bf16 v[112:115], a[88:91], a[24:27], v[112:115]
v_and_b32 v55, 0xffff0000, v55
v_lshlrev_b32 v58, 16, v59
v_mfma_f32_16x16x32_bf16 v[120:123], a[88:91], a[40:43], v[120:123]
v_and_b32 v59, 0xffff0000, v59
v_add_f32 v54, v54, v58
v_mfma_f32_16x16x32_bf16 v[128:131], a[88:91], a[56:59], v[128:131]
v_add_f32 v55, v55, v59
v_cvt_pk_bf16_f32 v58, v54, v55
v_mfma_f32_16x16x32_bf16 v[104:107], a[92:95], a[12:15], v[104:107]
ds_read_b64_tr_b16 a[88:89], v223 offset:18440
ds_read_b64_tr_b16 a[90:91], v223 offset:23048
v_mfma_f32_16x16x32_bf16 v[112:115], a[92:95], a[28:31], v[112:115]
v_lshlrev_b32 v54, 16, v58
v_and_b32 v55, 0xffff0000, v58
v_mfma_f32_16x16x32_bf16 v[120:123], a[92:95], a[44:47], v[120:123]
v_mul_f32 v58, 0xbfb8aa3b, v54
v_mul_f32 v59, 0xbfb8aa3b, v55
v_mfma_f32_16x16x32_bf16 v[128:131], a[92:95], a[60:63], v[128:131]
v_exp_f32 v58, v58
v_mfma_f32_16x16x32_bf16 v[108:111], a[64:67], a[192:195], v[108:111]
ds_read_b64_tr_b16 a[92:93], v223 offset:27656
ds_read_b64_tr_b16 a[94:95], v223 offset:32264
v_mfma_f32_16x16x32_bf16 v[116:119], a[64:67], a[208:211], v[116:119]
v_exp_f32 v59, v59
v_mfma_f32_16x16x32_bf16 v[124:127], a[64:67], a[96:99], v[124:127]
v_add_f32 v58, 1.0, v58
v_add_f32 v59, 1.0, v59
v_mfma_f32_16x16x32_bf16 v[132:135], a[64:67], a[112:115], v[132:135]
v_rcp_f32 v58, v58
s_waitcnt lgkmcnt(8)
v_mfma_f32_16x16x32_bf16 v[108:111], a[68:71], a[196:199], v[108:111]
ds_read_b64_tr_b16 a[64:65], v219 offset:128
ds_read_b64_tr_b16 a[66:67], v219 offset:4736
v_mfma_f32_16x16x32_bf16 v[116:119], a[68:71], a[244:247], v[116:119]
v_rcp_f32 v59, v59
v_mfma_f32_16x16x32_bf16 v[124:127], a[68:71], a[100:103], v[124:127]
v_mul_f32 v54, v54, v58
v_mul_f32 v55, v55, v59
v_mfma_f32_16x16x32_bf16 v[132:135], a[68:71], a[116:119], v[132:135]
v_cvt_pk_bf16_f32 v58, v54, v55
v_lshlrev_b32 v54, 16, v58
v_mfma_f32_16x16x32_bf16 v[108:111], a[72:75], a[200:203], v[108:111]
ds_read_b64_tr_b16 a[68:69], v219 offset:9344
ds_read_b64_tr_b16 a[70:71], v219 offset:13952
v_mfma_f32_16x16x32_bf16 v[116:119], a[72:75], a[248:251], v[116:119]
v_and_b32 v55, 0xffff0000, v58
v_accvgpr_read_b32 v57, a231
v_mfma_f32_16x16x32_bf16 v[124:127], a[72:75], a[104:107], v[124:127]
v_accvgpr_read_b32 v59, a241
v_lshlrev_b32 v56, 16, v57
v_mfma_f32_16x16x32_bf16 v[132:135], a[72:75], a[120:123], v[132:135]
v_and_b32 v57, 0xffff0000, v57
v_lshlrev_b32 v58, 16, v59
v_mfma_f32_16x16x32_bf16 v[108:111], a[76:79], a[204:207], v[108:111]
ds_read_b64_tr_b16 a[72:73], v219 offset:18560
ds_read_b64_tr_b16 a[74:75], v219 offset:23168
v_mfma_f32_16x16x32_bf16 v[116:119], a[76:79], a[252:255], v[116:119]
v_and_b32 v59, 0xffff0000, v59
v_add_f32 v56, v56, v58
v_mfma_f32_16x16x32_bf16 v[124:127], a[76:79], a[108:111], v[124:127]
v_add_f32 v57, v57, v59
v_cvt_pk_bf16_f32 v58, v56, v57
v_mfma_f32_16x16x32_bf16 v[132:135], a[76:79], a[124:127], v[132:135]
v_lshlrev_b32 v56, 16, v58
v_and_b32 v57, 0xffff0000, v58
s_waitcnt lgkmcnt(8)
v_mfma_f32_16x16x32_bf16 v[108:111], a[80:83], a[0:3], v[108:111]
ds_read_b64_tr_b16 a[76:77], v219 offset:27776
ds_read_b64_tr_b16 a[78:79], v219 offset:32384
v_mfma_f32_16x16x32_bf16 v[116:119], a[80:83], a[16:19], v[116:119]
v_mul_f32 v58, 0xbfb8aa3b, v56
v_mul_f32 v59, 0xbfb8aa3b, v57
v_mfma_f32_16x16x32_bf16 v[124:127], a[80:83], a[32:35], v[124:127]
v_exp_f32 v58, v58
v_mfma_f32_16x16x32_bf16 v[132:135], a[80:83], a[48:51], v[132:135]
v_exp_f32 v59, v59
v_mfma_f32_16x16x32_bf16 v[108:111], a[84:87], a[4:7], v[108:111]
ds_read_b64_tr_b16 a[80:81], v222 offset:128
ds_read_b64_tr_b16 a[82:83], v222 offset:4736
v_mfma_f32_16x16x32_bf16 v[116:119], a[84:87], a[20:23], v[116:119]
v_add_f32 v58, 1.0, v58
v_add_f32 v59, 1.0, v59
v_mfma_f32_16x16x32_bf16 v[124:127], a[84:87], a[36:39], v[124:127]
v_rcp_f32 v58, v58
v_mfma_f32_16x16x32_bf16 v[132:135], a[84:87], a[52:55], v[132:135]
v_rcp_f32 v59, v59
v_mfma_f32_16x16x32_bf16 v[108:111], a[88:91], a[8:11], v[108:111]
ds_read_b64_tr_b16 a[84:85], v222 offset:9344
ds_read_b64_tr_b16 a[86:87], v222 offset:13952
v_mfma_f32_16x16x32_bf16 v[116:119], a[88:91], a[24:27], v[116:119]
v_mul_f32 v56, v56, v58
v_mul_f32 v57, v57, v59
v_mfma_f32_16x16x32_bf16 v[124:127], a[88:91], a[40:43], v[124:127]
v_cvt_pk_bf16_f32 v58, v56, v57
v_lshlrev_b32 v56, 16, v58
v_mfma_f32_16x16x32_bf16 v[132:135], a[88:91], a[56:59], v[132:135]
v_and_b32 v57, 0xffff0000, v58
v_accvgpr_read_b32 v19, a212
s_waitcnt lgkmcnt(8)
v_mfma_f32_16x16x32_bf16 v[108:111], a[92:95], a[12:15], v[108:111]
ds_read_b64_tr_b16 a[88:89], v222 offset:18560
ds_read_b64_tr_b16 a[90:91], v222 offset:23168
v_mfma_f32_16x16x32_bf16 v[116:119], a[92:95], a[28:31], v[116:119]
v_lshlrev_b32 v18, 16, v19
v_and_b32 v19, 0xffff0000, v19
v_mfma_f32_16x16x32_bf16 v[124:127], a[92:95], a[44:47], v[124:127]
v_accvgpr_read_b32 v21, a213
v_lshlrev_b32 v20, 16, v21
v_mfma_f32_16x16x32_bf16 v[132:135], a[92:95], a[60:63], v[132:135]
v_and_b32 v21, 0xffff0000, v21
v_accvgpr_read_b32 v23, a214
v_mfma_f32_16x16x32_bf16 v[136:139], a[64:67], a[192:195], v[136:139]
ds_read_b64_tr_b16 a[92:93], v222 offset:27776
ds_read_b64_tr_b16 a[94:95], v222 offset:32384
v_mfma_f32_16x16x32_bf16 v[144:147], a[64:67], a[208:211], v[144:147]
v_lshlrev_b32 v22, 16, v23
v_and_b32 v23, 0xffff0000, v23
v_mfma_f32_16x16x32_bf16 v[152:155], a[64:67], a[96:99], v[152:155]
v_accvgpr_read_b32 v25, a215
v_lshlrev_b32 v24, 16, v25
v_mfma_f32_16x16x32_bf16 v[160:163], a[64:67], a[112:115], v[160:163]
v_and_b32 v25, 0xffff0000, v25
v_accvgpr_read_b32 v27, a216
v_mfma_f32_16x16x32_bf16 v[136:139], a[68:71], a[196:199], v[136:139]
ds_read_b64_tr_b16 a[64:65], v219 offset:136
ds_read_b64_tr_b16 a[66:67], v219 offset:4744
v_mfma_f32_16x16x32_bf16 v[144:147], a[68:71], a[244:247], v[144:147]
v_lshlrev_b32 v26, 16, v27
v_and_b32 v27, 0xffff0000, v27
v_mfma_f32_16x16x32_bf16 v[152:155], a[68:71], a[100:103], v[152:155]
v_accvgpr_read_b32 v29, a217
v_lshlrev_b32 v28, 16, v29
v_mfma_f32_16x16x32_bf16 v[160:163], a[68:71], a[116:119], v[160:163]
v_and_b32 v29, 0xffff0000, v29
v_accvgpr_read_b32 v31, a218
s_waitcnt lgkmcnt(8)
v_mfma_f32_16x16x32_bf16 v[136:139], a[72:75], a[200:203], v[136:139]
ds_read_b64_tr_b16 a[68:69], v219 offset:9352
ds_read_b64_tr_b16 a[70:71], v219 offset:13960
v_mfma_f32_16x16x32_bf16 v[144:147], a[72:75], a[248:251], v[144:147]
s_add_u32 s39, s44, 4096
v_lshlrev_b32 v30, 16, v31
v_mfma_f32_16x16x32_bf16 v[152:155], a[72:75], a[104:107], v[152:155]
v_cvt_pk_bf16_f32 v104, v104, v105
v_cvt_pk_bf16_f32 v105, v106, v107
v_mfma_f32_16x16x32_bf16 v[160:163], a[72:75], a[120:123], v[160:163]
v_cvt_pk_bf16_f32 v106, v108, v109
v_cvt_pk_bf16_f32 v107, v110, v111
v_mfma_f32_16x16x32_bf16 v[136:139], a[76:79], a[204:207], v[136:139]
ds_read_b64_tr_b16 a[72:73], v219 offset:18568
ds_read_b64_tr_b16 a[74:75], v219 offset:23176
v_mfma_f32_16x16x32_bf16 v[144:147], a[76:79], a[252:255], v[144:147]
buffer_store_dwordx4 v[104:107], v244, s[20:23], s39 offen offset:0
v_and_b32 v31, 0xffff0000, v31
v_mfma_f32_16x16x32_bf16 v[152:155], a[76:79], a[108:111], v[152:155]
v_cvt_pk_bf16_f32 v112, v112, v113
v_cvt_pk_bf16_f32 v113, v114, v115
v_mfma_f32_16x16x32_bf16 v[160:163], a[76:79], a[124:127], v[160:163]
v_cvt_pk_bf16_f32 v114, v116, v117
v_cvt_pk_bf16_f32 v115, v118, v119
v_mfma_f32_16x16x32_bf16 v[136:139], a[80:83], a[0:3], v[136:139]
ds_read_b64_tr_b16 a[76:77], v219 offset:27784
ds_read_b64_tr_b16 a[78:79], v219 offset:32392
v_mfma_f32_16x16x32_bf16 v[144:147], a[80:83], a[16:19], v[144:147]
buffer_store_dwordx4 v[112:115], v244, s[20:23], s39 offen offset:1024
v_accvgpr_read_b32 v33, a219
v_mfma_f32_16x16x32_bf16 v[152:155], a[80:83], a[32:35], v[152:155]
v_cvt_pk_bf16_f32 v120, v120, v121
v_cvt_pk_bf16_f32 v121, v122, v123
v_mfma_f32_16x16x32_bf16 v[160:163], a[80:83], a[48:51], v[160:163]
v_cvt_pk_bf16_f32 v122, v124, v125
v_cvt_pk_bf16_f32 v123, v126, v127
s_waitcnt lgkmcnt(8)
v_mfma_f32_16x16x32_bf16 v[136:139], a[84:87], a[4:7], v[136:139]
ds_read_b64_tr_b16 a[80:81], v222 offset:136
ds_read_b64_tr_b16 a[82:83], v222 offset:4744
v_mfma_f32_16x16x32_bf16 v[144:147], a[84:87], a[20:23], v[144:147]
buffer_store_dwordx4 v[120:123], v244, s[20:23], s39 offen offset:2048
v_lshlrev_b32 v32, 16, v33
v_mfma_f32_16x16x32_bf16 v[152:155], a[84:87], a[36:39], v[152:155]
v_cvt_pk_bf16_f32 v128, v128, v129
v_cvt_pk_bf16_f32 v129, v130, v131
v_mfma_f32_16x16x32_bf16 v[160:163], a[84:87], a[52:55], v[160:163]
v_cvt_pk_bf16_f32 v130, v132, v133
v_cvt_pk_bf16_f32 v131, v134, v135
v_mfma_f32_16x16x32_bf16 v[136:139], a[88:91], a[8:11], v[136:139]
ds_read_b64_tr_b16 a[84:85], v222 offset:9352
ds_read_b64_tr_b16 a[86:87], v222 offset:13960
v_mfma_f32_16x16x32_bf16 v[144:147], a[88:91], a[24:27], v[144:147]
buffer_store_dwordx4 v[128:131], v244, s[20:23], s39 offen offset:3072
v_and_b32 v33, 0xffff0000, v33
v_mfma_f32_16x16x32_bf16 v[152:155], a[88:91], a[40:43], v[152:155]
s_lshl2_add_u32 s28, s32, s95
v_accvgpr_read_b32 v35, a220
v_mfma_f32_16x16x32_bf16 v[160:163], a[88:91], a[56:59], v[160:163]
v_lshlrev_b32 v34, 16, v35
v_and_b32 v35, 0xffff0000, v35
v_mfma_f32_16x16x32_bf16 v[136:139], a[92:95], a[12:15], v[136:139]
ds_read_b64_tr_b16 a[88:89], v222 offset:18568
ds_read_b64_tr_b16 a[90:91], v222 offset:23176
v_mfma_f32_16x16x32_bf16 v[144:147], a[92:95], a[28:31], v[144:147]
v_accvgpr_read_b32 v37, a221
v_lshlrev_b32 v36, 16, v37
v_mfma_f32_16x16x32_bf16 v[152:155], a[92:95], a[44:47], v[152:155]
v_and_b32 v37, 0xffff0000, v37
v_mfma_f32_16x16x32_bf16 v[160:163], a[92:95], a[60:63], v[160:163]
s_mov_b32 s90, 0x3f80
s_mov_b32 s91, 0x3f800000
s_waitcnt lgkmcnt(8)
v_mfma_f32_16x16x32_bf16 v[140:143], a[64:67], a[192:195], v[140:143]
ds_read_b64_tr_b16 a[92:93], v222 offset:27784
ds_read_b64_tr_b16 a[94:95], v222 offset:32392
v_mfma_f32_16x16x32_bf16 v[148:151], a[64:67], a[208:211], v[148:151]
v_mov_b32 v66, 0
v_mov_b32 v67, 0
v_mfma_f32_16x16x32_bf16 v[156:159], a[64:67], a[96:99], v[156:159]
v_mov_b32 v68, 0
v_mov_b32 v69, 0
v_mfma_f32_16x16x32_bf16 v[164:167], a[64:67], a[112:115], v[164:167]
v_mfma_f32_16x16x32_bf16 v[140:143], a[68:71], a[196:199], v[140:143]
ds_read_b64_tr_b16 a[64:65], v220 offset:128
ds_read_b64_tr_b16 a[66:67], v220 offset:4736
v_mfma_f32_16x16x32_bf16 v[148:151], a[68:71], a[244:247], v[148:151]
v_mfma_f32_16x16x32_bf16 v[156:159], a[68:71], a[100:103], v[156:159]
v_mfma_f32_16x16x32_bf16 v[164:167], a[68:71], a[116:119], v[164:167]
v_mfma_f32_16x16x32_bf16 v[140:143], a[72:75], a[200:203], v[140:143]
ds_read_b64_tr_b16 a[68:69], v220 offset:9344
ds_read_b64_tr_b16 a[70:71], v220 offset:13952
v_mfma_f32_16x16x32_bf16 v[148:151], a[72:75], a[248:251], v[148:151]
v_mfma_f32_16x16x32_bf16 v[156:159], a[72:75], a[104:107], v[156:159]
v_mfma_f32_16x16x32_bf16 v[164:167], a[72:75], a[120:123], v[164:167]
s_waitcnt lgkmcnt(8)
v_mfma_f32_16x16x32_bf16 v[140:143], a[76:79], a[204:207], v[140:143]
ds_read_b64_tr_b16 a[72:73], v220 offset:18560
ds_read_b64_tr_b16 a[74:75], v220 offset:23168
v_mfma_f32_16x16x32_bf16 v[148:151], a[76:79], a[252:255], v[148:151]
v_mfma_f32_16x16x32_bf16 v[156:159], a[76:79], a[108:111], v[156:159]
v_mfma_f32_16x16x32_bf16 v[164:167], a[76:79], a[124:127], v[164:167]
v_mfma_f32_16x16x32_bf16 v[140:143], a[80:83], a[0:3], v[140:143]
ds_read_b64_tr_b16 a[76:77], v220 offset:27776
ds_read_b64_tr_b16 a[78:79], v220 offset:32384
v_mfma_f32_16x16x32_bf16 v[148:151], a[80:83], a[16:19], v[148:151]
v_mfma_f32_16x16x32_bf16 v[156:159], a[80:83], a[32:35], v[156:159]
s_waitcnt vmcnt(0)
buffer_store_dword v231, v254, s[20:23], s28 offen
v_mfma_f32_16x16x32_bf16 v[164:167], a[80:83], a[48:51], v[164:167]
v_mfma_f32_16x16x32_bf16 v[140:143], a[84:87], a[4:7], v[140:143]
ds_read_b64_tr_b16 a[80:81], v223 offset:128
ds_read_b64_tr_b16 a[82:83], v223 offset:4736
v_mfma_f32_16x16x32_bf16 v[148:151], a[84:87], a[20:23], v[148:151]
v_mfma_f32_16x16x32_bf16 v[156:159], a[84:87], a[36:39], v[156:159]
v_mfma_f32_16x16x32_bf16 v[164:167], a[84:87], a[52:55], v[164:167]
s_waitcnt lgkmcnt(8)
v_mfma_f32_16x16x32_bf16 v[140:143], a[88:91], a[8:11], v[140:143]
ds_read_b64_tr_b16 a[84:85], v223 offset:9344
ds_read_b64_tr_b16 a[86:87], v223 offset:13952
v_mfma_f32_16x16x32_bf16 v[148:151], a[88:91], a[24:27], v[148:151]
v_mfma_f32_16x16x32_bf16 v[156:159], a[88:91], a[40:43], v[156:159]
v_mfma_f32_16x16x32_bf16 v[164:167], a[88:91], a[56:59], v[164:167]
v_mfma_f32_16x16x32_bf16 v[140:143], a[92:95], a[12:15], v[140:143]
ds_read_b64_tr_b16 a[88:89], v223 offset:18560
ds_read_b64_tr_b16 a[90:91], v223 offset:23168
v_mfma_f32_16x16x32_bf16 v[148:151], a[92:95], a[28:31], v[148:151]
v_mfma_f32_16x16x32_bf16 v[156:159], a[92:95], a[44:47], v[156:159]
v_mfma_f32_16x16x32_bf16 v[164:167], a[92:95], a[60:63], v[164:167]
v_mfma_f32_16x16x32_bf16 v[168:171], a[64:67], a[192:195], v[168:171]
ds_read_b64_tr_b16 a[92:93], v223 offset:27776
ds_read_b64_tr_b16 a[94:95], v223 offset:32384
v_mfma_f32_16x16x32_bf16 v[176:179], a[64:67], a[208:211], v[176:179]
v_mfma_f32_16x16x32_bf16 v[184:187], a[64:67], a[96:99], v[184:187]
v_mfma_f32_16x16x32_bf16 v[192:195], a[64:67], a[112:115], v[192:195]
s_waitcnt lgkmcnt(8)
v_mfma_f32_16x16x32_bf16 v[168:171], a[68:71], a[196:199], v[168:171]
ds_read_b64_tr_b16 a[64:65], v220 offset:136
ds_read_b64_tr_b16 a[66:67], v220 offset:4744
v_mfma_f32_16x16x32_bf16 v[176:179], a[68:71], a[244:247], v[176:179]
v_mfma_f32_16x16x32_bf16 v[184:187], a[68:71], a[100:103], v[184:187]
v_mfma_f32_16x16x32_bf16 v[192:195], a[68:71], a[116:119], v[192:195]
v_mfma_f32_16x16x32_bf16 v[168:171], a[72:75], a[200:203], v[168:171]
ds_read_b64_tr_b16 a[68:69], v220 offset:9352
ds_read_b64_tr_b16 a[70:71], v220 offset:13960
v_mfma_f32_16x16x32_bf16 v[176:179], a[72:75], a[248:251], v[176:179]
s_add_u32 s39, s44, 8192
v_mfma_f32_16x16x32_bf16 v[184:187], a[72:75], a[104:107], v[184:187]
v_cvt_pk_bf16_f32 v144, v144, v145
v_cvt_pk_bf16_f32 v145, v146, v147
v_mfma_f32_16x16x32_bf16 v[192:195], a[72:75], a[120:123], v[192:195]
v_cvt_pk_bf16_f32 v146, v148, v149
v_cvt_pk_bf16_f32 v147, v150, v151
v_mfma_f32_16x16x32_bf16 v[168:171], a[76:79], a[204:207], v[168:171]
ds_read_b64_tr_b16 a[72:73], v220 offset:18568
ds_read_b64_tr_b16 a[74:75], v220 offset:23176
v_mfma_f32_16x16x32_bf16 v[176:179], a[76:79], a[252:255], v[176:179]
buffer_store_dwordx4 v[144:147], v244, s[20:23], s39 offen offset:1024
v_mfma_f32_16x16x32_bf16 v[184:187], a[76:79], a[108:111], v[184:187]
v_cvt_pk_bf16_f32 v152, v152, v153
v_cvt_pk_bf16_f32 v153, v154, v155
v_mfma_f32_16x16x32_bf16 v[192:195], a[76:79], a[124:127], v[192:195]
v_cvt_pk_bf16_f32 v154, v156, v157
v_cvt_pk_bf16_f32 v155, v158, v159
s_waitcnt lgkmcnt(8)
v_mfma_f32_16x16x32_bf16 v[168:171], a[80:83], a[0:3], v[168:171]
ds_read_b64_tr_b16 a[76:77], v220 offset:27784
ds_read_b64_tr_b16 a[78:79], v220 offset:32392
v_mfma_f32_16x16x32_bf16 v[176:179], a[80:83], a[16:19], v[176:179]
buffer_store_dwordx4 v[152:155], v244, s[20:23], s39 offen offset:2048
v_mfma_f32_16x16x32_bf16 v[184:187], a[80:83], a[32:35], v[184:187]
v_cvt_pk_bf16_f32 v160, v160, v161
v_cvt_pk_bf16_f32 v161, v162, v163
v_mfma_f32_16x16x32_bf16 v[192:195], a[80:83], a[48:51], v[192:195]
v_cvt_pk_bf16_f32 v162, v164, v165
v_cvt_pk_bf16_f32 v163, v166, v167
v_mfma_f32_16x16x32_bf16 v[168:171], a[84:87], a[4:7], v[168:171]
ds_read_b64_tr_b16 a[80:81], v223 offset:136
ds_read_b64_tr_b16 a[82:83], v223 offset:4744
v_mfma_f32_16x16x32_bf16 v[176:179], a[84:87], a[20:23], v[176:179]
buffer_store_dwordx4 v[160:163], v244, s[20:23], s39 offen offset:3072
v_mfma_f32_16x16x32_bf16 v[184:187], a[84:87], a[36:39], v[184:187]
buffer_load_dword v230, v229, s[20:23], s95 offen sc0 sc1
v_mfma_f32_16x16x32_bf16 v[192:195], a[84:87], a[52:55], v[192:195]
v_mfma_f32_16x16x32_bf16 v[168:171], a[88:91], a[8:11], v[168:171]
ds_read_b64_tr_b16 a[84:85], v223 offset:9352
ds_read_b64_tr_b16 a[86:87], v223 offset:13960
v_mfma_f32_16x16x32_bf16 v[176:179], a[88:91], a[24:27], v[176:179]
v_mfma_f32_16x16x32_bf16 v[184:187], a[88:91], a[40:43], v[184:187]
v_mfma_f32_16x16x32_bf16 v[192:195], a[88:91], a[56:59], v[192:195]
s_waitcnt lgkmcnt(8)
v_mfma_f32_16x16x32_bf16 v[168:171], a[92:95], a[12:15], v[168:171]
ds_read_b64_tr_b16 a[88:89], v223 offset:18568
ds_read_b64_tr_b16 a[90:91], v223 offset:23176
v_mfma_f32_16x16x32_bf16 v[176:179], a[92:95], a[28:31], v[176:179]
v_mfma_f32_16x16x32_bf16 v[184:187], a[92:95], a[44:47], v[184:187]
v_mfma_f32_16x16x32_bf16 v[192:195], a[92:95], a[60:63], v[192:195]
v_mfma_f32_16x16x32_bf16 v[172:175], a[64:67], a[192:195], v[172:175]
ds_read_b64_tr_b16 a[92:93], v223 offset:27784
ds_read_b64_tr_b16 a[94:95], v223 offset:32392
v_mfma_f32_16x16x32_bf16 v[180:183], a[64:67], a[208:211], v[180:183]
v_mfma_f32_16x16x32_bf16 v[188:191], a[64:67], a[96:99], v[188:191]
v_mfma_f32_16x16x32_bf16 v[196:199], a[64:67], a[112:115], v[196:199]
v_mfma_f32_16x16x32_bf16 v[172:175], a[68:71], a[196:199], v[172:175]
v_mfma_f32_16x16x32_bf16 v[180:183], a[68:71], a[244:247], v[180:183]
v_mfma_f32_16x16x32_bf16 v[188:191], a[68:71], a[100:103], v[188:191]
v_mfma_f32_16x16x32_bf16 v[196:199], a[68:71], a[116:119], v[196:199]
s_waitcnt lgkmcnt(8)
v_mfma_f32_16x16x32_bf16 v[172:175], a[72:75], a[200:203], v[172:175]
v_mfma_f32_16x16x32_bf16 v[180:183], a[72:75], a[248:251], v[180:183]
v_mfma_f32_16x16x32_bf16 v[188:191], a[72:75], a[104:107], v[188:191]
v_mfma_f32_16x16x32_bf16 v[196:199], a[72:75], a[120:123], v[196:199]
v_mfma_f32_16x16x32_bf16 v[172:175], a[76:79], a[204:207], v[172:175]
v_mfma_f32_16x16x32_bf16 v[180:183], a[76:79], a[252:255], v[180:183]
v_mfma_f32_16x16x32_bf16 v[188:191], a[76:79], a[108:111], v[188:191]
s_waitcnt vmcnt(0)
v_cmp_gt_u32 vcc, 1, v230
v_mfma_f32_16x16x32_bf16 v[196:199], a[76:79], a[124:127], v[196:199]
s_waitcnt lgkmcnt(6)
v_mfma_f32_16x16x32_bf16 v[172:175], a[80:83], a[0:3], v[172:175]
s_and_b32 s29, vcc_lo, 0xff
s_cbranch_scc1 SP_P1A
SP_P1A_RET:
v_mfma_f32_16x16x32_bf16 v[180:183], a[80:83], a[16:19], v[180:183]
buffer_load_dwordx4 v[104:107], v244, s[20:23], s65 offen offset:3072 sc0 sc1
v_mfma_f32_16x16x32_bf16 v[188:191], a[80:83], a[32:35], v[188:191]
buffer_load_dwordx4 v[108:111], v244, s[20:23], s66 offen offset:2048 sc0 sc1
v_mfma_f32_16x16x32_bf16 v[196:199], a[80:83], a[48:51], v[196:199]
buffer_load_dwordx4 v[112:115], v244, s[20:23], s67 offen offset:1024 sc0 sc1
s_waitcnt lgkmcnt(4)
v_mfma_f32_16x16x32_bf16 v[172:175], a[84:87], a[4:7], v[172:175]
buffer_load_dwordx4 v[116:119], v244, s[20:23], s68 offen offset:0 sc0 sc1
v_mfma_f32_16x16x32_bf16 v[180:183], a[84:87], a[20:23], v[180:183]
buffer_load_dwordx4 v[120:123], v244, s[20:23], s69 offen offset:3072 sc0 sc1
v_mfma_f32_16x16x32_bf16 v[188:191], a[84:87], a[36:39], v[188:191]
buffer_load_dwordx4 v[124:127], v244, s[20:23], s70 offen offset:2048 sc0 sc1
v_mfma_f32_16x16x32_bf16 v[196:199], a[84:87], a[52:55], v[196:199]
buffer_load_dwordx4 v[128:131], v244, s[20:23], s71 offen offset:1024 sc0 sc1
s_waitcnt lgkmcnt(2)
v_mfma_f32_16x16x32_bf16 v[172:175], a[88:91], a[8:11], v[172:175]
v_mfma_f32_16x16x32_bf16 v[180:183], a[88:91], a[24:27], v[180:183]
v_mfma_f32_16x16x32_bf16 v[188:191], a[88:91], a[40:43], v[188:191]
v_mfma_f32_16x16x32_bf16 v[196:199], a[88:91], a[56:59], v[196:199]
s_waitcnt lgkmcnt(0)
v_mfma_f32_16x16x32_bf16 v[172:175], a[92:95], a[12:15], v[172:175]
v_mfma_f32_16x16x32_bf16 v[180:183], a[92:95], a[28:31], v[180:183]
v_mfma_f32_16x16x32_bf16 v[188:191], a[92:95], a[44:47], v[188:191]
v_mfma_f32_16x16x32_bf16 v[196:199], a[92:95], a[60:63], v[196:199]
s_add_u32 s39, s44, 12288
s_nop 5
v_cvt_pk_bf16_f32 v168, v168, v169
v_cvt_pk_bf16_f32 v169, v170, v171
v_cvt_pk_bf16_f32 v170, v172, v173
v_cvt_pk_bf16_f32 v171, v174, v175
buffer_store_dwordx4 v[168:171], v244, s[20:23], s39 offen offset:0
v_cvt_pk_bf16_f32 v176, v176, v177
v_cvt_pk_bf16_f32 v177, v178, v179
v_cvt_pk_bf16_f32 v178, v180, v181
v_cvt_pk_bf16_f32 v179, v182, v183
buffer_store_dwordx4 v[176:179], v244, s[20:23], s39 offen offset:1024
v_cvt_pk_bf16_f32 v184, v184, v185
v_cvt_pk_bf16_f32 v185, v186, v187
v_cvt_pk_bf16_f32 v186, v188, v189
v_cvt_pk_bf16_f32 v187, v190, v191
buffer_store_dwordx4 v[184:187], v244, s[20:23], s39 offen offset:2048
v_cvt_pk_bf16_f32 v192, v192, v193
v_cvt_pk_bf16_f32 v193, v194, v195
v_cvt_pk_bf16_f32 v194, v196, v197
v_cvt_pk_bf16_f32 v195, v198, v199
buffer_store_dwordx4 v[192:195], v244, s[20:23], s39 offen offset:3072
buffer_load_dwordx2 v[200:201], v226, s[20:23], s72 offen offset:0 sc0 sc1
buffer_load_dwordx2 v[202:203], v226, s[20:23], s73 offen offset:512 sc0 sc1
buffer_load_dwordx2 v[204:205], v226, s[20:23], s74 offen offset:0 sc0 sc1
buffer_load_dwordx2 v[206:207], v226, s[20:23], s75 offen offset:512 sc0 sc1
buffer_load_dwordx2 v[208:209], v226, s[20:23], s84 offen offset:0 sc0 sc1
buffer_load_dwordx2 v[210:211], v226, s[20:23], s85 offen offset:512 sc0 sc1
buffer_load_dwordx2 v[212:213], v226, s[20:23], s86 offen offset:0 sc0 sc1
buffer_load_dwordx2 v[214:215], v226, s[20:23], s87 offen offset:512 sc0 sc1
s_waitcnt vmcnt(8)
buffer_store_dword v246, v254, s[20:23], s28 offen
buffer_load_dword v230, v229, s[20:23], s95 offen sc0 sc1
s_waitcnt vmcnt(20)
v_dot2c_f32_bf16 v72, s90, v104
v_dot2c_f32_bf16 v73, s91, v104
v_dot2c_f32_bf16 v74, s90, v105
v_dot2c_f32_bf16 v75, s91, v105
v_dot2c_f32_bf16 v76, s90, v106
v_dot2c_f32_bf16 v77, s91, v106
v_dot2c_f32_bf16 v78, s90, v107
v_dot2c_f32_bf16 v79, s91, v107
s_waitcnt vmcnt(19)
v_dot2c_f32_bf16 v72, s90, v108
v_dot2c_f32_bf16 v73, s91, v108
v_dot2c_f32_bf16 v74, s90, v109
v_dot2c_f32_bf16 v75, s91, v109
v_dot2c_f32_bf16 v76, s90, v110
v_dot2c_f32_bf16 v77, s91, v110
v_dot2c_f32_bf16 v78, s90, v111
v_dot2c_f32_bf16 v79, s91, v111
s_waitcnt vmcnt(18)
v_dot2c_f32_bf16 v72, s90, v112
v_dot2c_f32_bf16 v73, s91, v112
v_dot2c_f32_bf16 v74, s90, v113
v_dot2c_f32_bf16 v75, s91, v113
v_dot2c_f32_bf16 v76, s90, v114
v_dot2c_f32_bf16 v77, s91, v114
v_dot2c_f32_bf16 v78, s90, v115
v_dot2c_f32_bf16 v79, s91, v115
s_waitcnt vmcnt(17)
v_dot2c_f32_bf16 v72, s90, v116
v_dot2c_f32_bf16 v73, s91, v116
v_dot2c_f32_bf16 v74, s90, v117
v_dot2c_f32_bf16 v75, s91, v117
v_dot2c_f32_bf16 v76, s90, v118
v_dot2c_f32_bf16 v77, s91, v118
v_dot2c_f32_bf16 v78, s90, v119
v_dot2c_f32_bf16 v79, s91, v119
s_waitcnt vmcnt(16)
v_dot2c_f32_bf16 v72, s90, v120
v_dot2c_f32_bf16 v73, s91, v120
v_dot2c_f32_bf16 v74, s90, v121
v_dot2c_f32_bf16 v75, s91, v121
v_dot2c_f32_bf16 v76, s90, v122
v_dot2c_f32_bf16 v77, s91, v122
v_dot2c_f32_bf16 v78, s90, v123
v_dot2c_f32_bf16 v79, s91, v123
s_waitcnt vmcnt(15)
v_dot2c_f32_bf16 v72, s90, v124
v_dot2c_f32_bf16 v73, s91, v124
v_dot2c_f32_bf16 v74, s90, v125
v_dot2c_f32_bf16 v75, s91, v125
v_dot2c_f32_bf16 v76, s90, v126
v_dot2c_f32_bf16 v77, s91, v126
v_dot2c_f32_bf16 v78, s90, v127
v_dot2c_f32_bf16 v79, s91, v127
s_waitcnt vmcnt(14)
v_dot2c_f32_bf16 v72, s90, v128
v_dot2c_f32_bf16 v73, s91, v128
v_dot2c_f32_bf16 v74, s90, v129
v_dot2c_f32_bf16 v75, s91, v129
v_dot2c_f32_bf16 v76, s90, v130
v_dot2c_f32_bf16 v77, s91, v130
v_dot2c_f32_bf16 v78, s90, v131
v_dot2c_f32_bf16 v79, s91, v131
s_nop 2
v_cvt_pk_bf16_f32 v58, v72, v73
v_cvt_pk_bf16_f32 v59, v74, v75
v_cvt_pk_bf16_f32 v60, v76, v77
v_cvt_pk_bf16_f32 v61, v78, v79
v_lshlrev_b32 v72, 16, v58
v_and_b32 v73, 0xffff0000, v58
v_lshlrev_b32 v74, 16, v59
v_and_b32 v75, 0xffff0000, v59
v_lshlrev_b32 v76, 16, v60
v_and_b32 v77, 0xffff0000, v60
v_lshlrev_b32 v78, 16, v61
v_and_b32 v79, 0xffff0000, v61
v_pk_mul_f32 v[72:73], v[72:73], v[38:39]
v_pk_mul_f32 v[74:75], v[74:75], v[40:41]
v_pk_mul_f32 v[76:77], v[76:77], v[42:43]
v_pk_mul_f32 v[78:79], v[78:79], v[44:45]
v_cvt_pk_bf16_f32 v58, v72, v73
v_cvt_pk_bf16_f32 v59, v74, v75
v_cvt_pk_bf16_f32 v60, v76, v77
v_cvt_pk_bf16_f32 v61, v78, v79
v_lshlrev_b32 v72, 16, v58
v_and_b32 v73, 0xffff0000, v58
v_lshlrev_b32 v74, 16, v59
v_and_b32 v75, 0xffff0000, v59
v_lshlrev_b32 v76, 16, v60
v_and_b32 v77, 0xffff0000, v60
v_lshlrev_b32 v78, 16, v61
v_and_b32 v79, 0xffff0000, v61
v_pk_add_f32 v[72:73], v[72:73], v[18:19]
v_pk_add_f32 v[74:75], v[74:75], v[20:21]
v_pk_add_f32 v[76:77], v[76:77], v[22:23]
v_pk_add_f32 v[78:79], v[78:79], v[24:25]
v_cvt_pk_bf16_f32 v72, v72, v73
v_cvt_pk_bf16_f32 v73, v74, v75
v_cvt_pk_bf16_f32 v74, v76, v77
v_cvt_pk_bf16_f32 v75, v78, v79
buffer_store_dwordx4 v[72:75], v248, s[60:63], 0 offen
s_waitcnt vmcnt(1)
v_cmp_gt_u32 vcc, 2, v230
s_nop 0
s_and_b32 s29, vcc_lo, 0xff
s_cbranch_scc1 SP_P2A
SP_P2A_RET:
buffer_load_dwordx4 v[80:83], v243, s[20:23], s65 offen offset:3072 sc0 sc1
buffer_load_dwordx4 v[84:87], v243, s[20:23], s66 offen offset:2048 sc0 sc1
buffer_load_dwordx4 v[88:91], v243, s[20:23], s67 offen offset:1024 sc0 sc1
buffer_load_dwordx4 v[92:95], v243, s[20:23], s68 offen offset:0 sc0 sc1
buffer_load_dwordx4 v[96:99], v243, s[20:23], s69 offen offset:3072 sc0 sc1
buffer_load_dwordx4 v[100:103], v243, s[20:23], s70 offen offset:2048 sc0 sc1
buffer_load_dwordx4 v[132:135], v243, s[20:23], s71 offen offset:1024 sc0 sc1
s_waitcnt vmcnt(17)
v_dot2c_f32_bf16 v66, s90, v200
v_dot2c_f32_bf16 v67, s91, v200
v_dot2c_f32_bf16 v68, s90, v201
v_dot2c_f32_bf16 v69, s91, v201
s_waitcnt vmcnt(16)
v_dot2c_f32_bf16 v66, s90, v202
v_dot2c_f32_bf16 v67, s91, v202
v_dot2c_f32_bf16 v68, s90, v203
v_dot2c_f32_bf16 v69, s91, v203
s_waitcnt vmcnt(15)
v_dot2c_f32_bf16 v66, s90, v204
v_dot2c_f32_bf16 v67, s91, v204
v_dot2c_f32_bf16 v68, s90, v205
v_dot2c_f32_bf16 v69, s91, v205
s_waitcnt vmcnt(14)
v_dot2c_f32_bf16 v66, s90, v206
v_dot2c_f32_bf16 v67, s91, v206
v_dot2c_f32_bf16 v68, s90, v207
v_dot2c_f32_bf16 v69, s91, v207
s_waitcnt vmcnt(13)
v_dot2c_f32_bf16 v66, s90, v208
v_dot2c_f32_bf16 v67, s91, v208
v_dot2c_f32_bf16 v68, s90, v209
v_dot2c_f32_bf16 v69, s91, v209
s_waitcnt vmcnt(12)
v_dot2c_f32_bf16 v66, s90, v210
v_dot2c_f32_bf16 v67, s91, v210
v_dot2c_f32_bf16 v68, s90, v211
v_dot2c_f32_bf16 v69, s91, v211
s_waitcnt vmcnt(11)
v_dot2c_f32_bf16 v66, s90, v212
v_dot2c_f32_bf16 v67, s91, v212
v_dot2c_f32_bf16 v68, s90, v213
v_dot2c_f32_bf16 v69, s91, v213
s_waitcnt vmcnt(10)
v_dot2c_f32_bf16 v66, s90, v214
v_dot2c_f32_bf16 v67, s91, v214
v_dot2c_f32_bf16 v68, s90, v215
v_dot2c_f32_bf16 v69, s91, v215
s_nop 2
s_cmp_eq_u32 s34, 0
s_cselect_b32 s29, 0, 0x7fbffff0
v_cvt_pk_bf16_f32 v58, v66, v67
v_cvt_pk_bf16_f32 v59, v68, v69
v_lshlrev_b32 v66, 16, v58
v_and_b32 v67, 0xffff0000, v58
v_lshlrev_b32 v68, 16, v59
v_and_b32 v69, 0xffff0000, v59
v_pk_mul_f32 v[66:67], v[66:67], v[54:55]
v_pk_mul_f32 v[68:69], v[68:69], v[56:57]
v_cvt_pk_bf16_f32 v58, v66, v67
v_cvt_pk_bf16_f32 v59, v68, v69
v_lshlrev_b32 v66, 16, v58
v_and_b32 v67, 0xffff0000, v58
v_lshlrev_b32 v68, 16, v59
v_and_b32 v69, 0xffff0000, v59
v_pk_add_f32 v[66:67], v[66:67], v[34:35]
v_pk_add_f32 v[68:69], v[68:69], v[36:37]
v_cvt_pk_bf16_f32 v66, v66, v67
v_cvt_pk_bf16_f32 v67, v68, v69
buffer_store_dwordx2 v[66:67], v249, s[60:63], s29 offen
s_waitcnt vmcnt(7)
v_dot2c_f32_bf16 v136, s90, v80
v_dot2c_f32_bf16 v137, s91, v80
v_dot2c_f32_bf16 v138, s90, v81
v_dot2c_f32_bf16 v139, s91, v81
v_dot2c_f32_bf16 v140, s90, v82
v_dot2c_f32_bf16 v141, s91, v82
v_dot2c_f32_bf16 v142, s90, v83
v_dot2c_f32_bf16 v143, s91, v83
s_waitcnt vmcnt(6)
v_dot2c_f32_bf16 v136, s90, v84
v_dot2c_f32_bf16 v137, s91, v84
v_dot2c_f32_bf16 v138, s90, v85
v_dot2c_f32_bf16 v139, s91, v85
v_dot2c_f32_bf16 v140, s90, v86
v_dot2c_f32_bf16 v141, s91, v86
v_dot2c_f32_bf16 v142, s90, v87
v_dot2c_f32_bf16 v143, s91, v87
s_waitcnt vmcnt(5)
v_dot2c_f32_bf16 v136, s90, v88
v_dot2c_f32_bf16 v137, s91, v88
v_dot2c_f32_bf16 v138, s90, v89
v_dot2c_f32_bf16 v139, s91, v89
v_dot2c_f32_bf16 v140, s90, v90
v_dot2c_f32_bf16 v141, s91, v90
v_dot2c_f32_bf16 v142, s90, v91
v_dot2c_f32_bf16 v143, s91, v91
s_waitcnt vmcnt(4)
v_dot2c_f32_bf16 v136, s90, v92
v_dot2c_f32_bf16 v137, s91, v92
v_dot2c_f32_bf16 v138, s90, v93
v_dot2c_f32_bf16 v139, s91, v93
v_dot2c_f32_bf16 v140, s90, v94
v_dot2c_f32_bf16 v141, s91, v94
v_dot2c_f32_bf16 v142, s90, v95
v_dot2c_f32_bf16 v143, s91, v95
s_waitcnt vmcnt(3)
v_dot2c_f32_bf16 v136, s90, v96
v_dot2c_f32_bf16 v137, s91, v96
v_dot2c_f32_bf16 v138, s90, v97
v_dot2c_f32_bf16 v139, s91, v97
v_dot2c_f32_bf16 v140, s90, v98
v_dot2c_f32_bf16 v141, s91, v98
v_dot2c_f32_bf16 v142, s90, v99
v_dot2c_f32_bf16 v143, s91, v99
s_waitcnt vmcnt(2)
v_dot2c_f32_bf16 v136, s90, v100
v_dot2c_f32_bf16 v137, s91, v100
v_dot2c_f32_bf16 v138, s90, v101
v_dot2c_f32_bf16 v139, s91, v101
v_dot2c_f32_bf16 v140, s90, v102
v_dot2c_f32_bf16 v141, s91, v102
v_dot2c_f32_bf16 v142, s90, v103
v_dot2c_f32_bf16 v143, s91, v103
s_waitcnt vmcnt(1)
v_dot2c_f32_bf16 v136, s90, v132
v_dot2c_f32_bf16 v137, s91, v132
v_dot2c_f32_bf16 v138, s90, v133
v_dot2c_f32_bf16 v139, s91, v133
v_dot2c_f32_bf16 v140, s90, v134
v_dot2c_f32_bf16 v141, s91, v134
v_dot2c_f32_bf16 v142, s90, v135
v_dot2c_f32_bf16 v143, s91, v135
s_nop 2
v_cvt_pk_bf16_f32 v58, v136, v137
v_cvt_pk_bf16_f32 v59, v138, v139
v_cvt_pk_bf16_f32 v60, v140, v141
v_cvt_pk_bf16_f32 v61, v142, v143
v_lshlrev_b32 v136, 16, v58
v_and_b32 v137, 0xffff0000, v58
v_lshlrev_b32 v138, 16, v59
v_and_b32 v139, 0xffff0000, v59
v_lshlrev_b32 v140, 16, v60
v_and_b32 v141, 0xffff0000, v60
v_lshlrev_b32 v142, 16, v61
v_and_b32 v143, 0xffff0000, v61
v_pk_mul_f32 v[136:137], v[136:137], v[46:47]
v_pk_mul_f32 v[138:139], v[138:139], v[48:49]
v_pk_mul_f32 v[140:141], v[140:141], v[50:51]
v_pk_mul_f32 v[142:143], v[142:143], v[52:53]
v_cvt_pk_bf16_f32 v58, v136, v137
v_cvt_pk_bf16_f32 v59, v138, v139
v_cvt_pk_bf16_f32 v60, v140, v141
v_cvt_pk_bf16_f32 v61, v142, v143
v_lshlrev_b32 v136, 16, v58
v_and_b32 v137, 0xffff0000, v58
v_lshlrev_b32 v138, 16, v59
v_and_b32 v139, 0xffff0000, v59
v_lshlrev_b32 v140, 16, v60
v_and_b32 v141, 0xffff0000, v60
v_lshlrev_b32 v142, 16, v61
v_and_b32 v143, 0xffff0000, v61
v_pk_add_f32 v[136:137], v[136:137], v[26:27]
v_pk_add_f32 v[138:139], v[138:139], v[28:29]
v_pk_add_f32 v[140:141], v[140:141], v[30:31]
v_pk_add_f32 v[142:143], v[142:143], v[32:33]
v_cvt_pk_bf16_f32 v136, v136, v137
v_cvt_pk_bf16_f32 v137, v138, v139
v_cvt_pk_bf16_f32 v138, v140, v141
v_cvt_pk_bf16_f32 v139, v142, v143
buffer_store_dwordx4 v[136:139], v248, s[60:63], 0 offen offset:128
K_END:
s_endpgm
K_EVT:
s_sub_u32 s3, s33, 1
s_cmp_eq_u32 s33, 2
s_cselect_b32 s46, s44, s46
s_cmp_eq_u32 s33, 1
s_cbranch_scc0 EV_N1
s_getpc_b64 s[96:97]
PC_b:
s_sub_u32 s96, s96, PC_b-K_LAST
s_subb_u32 s97, s97, 0
s_lshl_b32 s50, s35, 2
s_add_u32 s50, s50, s37
s_min_u32 s50, s50, ((K_HOT_END-K_LAST)>>10)-1
s_lshl_b32 s50, s50, 10
v_lshlrev_b32 v105, 4, v1
v_add_u32 v105, s50, v105
global_load_dwordx4 v[108:111], v105, s[96:97]
EV_N1:
s_cmp_eq_u32 s43, 0
s_cbranch_scc0 K_EVT_RET
s_cmp_lt_u32 s2, 144
s_cbranch_scc0 EV_Y
s_cmp_eq_u32 s33, 5
s_cbranch_scc0 K_EVT_RET
s_mov_b32 s3, 2
s_cmp_eq_u32 s37, 0
s_cbranch_scc0 K_EVT_RET
v_mov_b32 v246, 0
v_mov_b32 v247, 1
s_mov_b32 s28, 0x243000
s_mov_b64 exec, 1
buffer_atomic_add v247, v246, s[20:23], s28 offen sc1
s_mov_b64 exec, -1
s_branch K_EVT_RET
EV_Y:
s_cmp_lt_u32 s2, 216
s_cbranch_scc0 K_EVT_RET
s_cmp_eq_u32 s33, 4
s_cbranch_scc0 EV_Y4
v_mov_b32 v246, 0
s_mov_b32 s28, 0x243000
buffer_load_dword v247, v246, s[20:23], s28 offen sc0 sc1
s_branch K_EVT_RET
EV_Y4:
s_sub_u32 s29, s2, 144
s_lshl_b32 s29, s29, 2
s_add_u32 s29, s29, s37
s_cmp_eq_u32 s33, 3
s_cbranch_scc0 EV_Y3
v_readfirstlane_b32 s28, v247
s_cmp_ge_u32 s28, 144
s_cbranch_scc1 EV_Y4OK
EV_Y4SP:
s_sleep 8
s_add_u32 s100, s100, 1
s_bitcmp1_b32 s100, 19
s_cbranch_scc1 K_END
s_mov_b32 s28, 0x243000
buffer_load_dword v247, v246, s[20:23], s28 offen sc0 sc1
s_waitcnt vmcnt(0)
v_readfirstlane_b32 s28, v247
s_cmp_ge_u32 s28, 144
s_cbranch_scc0 EV_Y4SP
EV_Y4OK:
v_lshrrev_b32 v246, 2, v1
v_mul_u32_u24 v246, 18432, v246
v_and_b32 v247, 3, v1
v_lshl_add_u32 v246, v247, 4, v246
s_lshl_b32 s28, s29, 6
s_add_u32 s28, s28, 0x2000000
buffer_load_dwordx4 v[104:107], v246, s[20:23], s28 offen sc0 sc1
s_add_u32 s28, s28, 294912
buffer_load_dwordx4 v[108:111], v246, s[20:23], s28 offen sc0 sc1
s_add_u32 s28, s28, 294912
buffer_load_dwordx4 v[112:115], v246, s[20:23], s28 offen sc0 sc1
s_add_u32 s28, s28, 294912
buffer_load_dwordx4 v[116:119], v246, s[20:23], s28 offen sc0 sc1
s_add_u32 s28, s28, 294912
buffer_load_dwordx4 v[120:123], v246, s[20:23], s28 offen sc0 sc1
s_add_u32 s28, s28, 294912
buffer_load_dwordx4 v[124:127], v246, s[20:23], s28 offen sc0 sc1
s_add_u32 s28, s28, 294912
buffer_load_dwordx4 v[128:131], v246, s[20:23], s28 offen sc0 sc1
s_add_u32 s28, s28, 294912
buffer_load_dwordx4 v[132:135], v246, s[20:23], s28 offen sc0 sc1
s_add_u32 s28, s28, 294912
buffer_load_dwordx4 v[248:251], v246, s[20:23], s28 offen sc0 sc1
s_branch K_EVT_RET
EV_Y3:
s_cmp_eq_u32 s33, 2
s_cbranch_scc0 EV_Y2
v_pk_add_f32 v[104:105], v[104:105], v[108:109]
v_pk_add_f32 v[106:107], v[106:107], v[110:111]
v_pk_add_f32 v[112:113], v[112:113], v[116:117]
v_pk_add_f32 v[114:115], v[114:115], v[118:119]
v_pk_add_f32 v[120:121], v[120:121], v[124:125]
v_pk_add_f32 v[122:123], v[122:123], v[126:127]
v_pk_add_f32 v[128:129], v[128:129], v[132:133]
v_pk_add_f32 v[130:131], v[130:131], v[134:135]
v_pk_add_f32 v[104:105], v[104:105], v[112:113]
v_pk_add_f32 v[106:107], v[106:107], v[114:115]
v_pk_add_f32 v[120:121], v[120:121], v[128:129]
v_pk_add_f32 v[122:123], v[122:123], v[130:131]
v_pk_add_f32 v[104:105], v[104:105], v[248:249]
v_pk_add_f32 v[106:107], v[106:107], v[250:251]
v_pk_add_f32 v[104:105], v[104:105], v[120:121]
v_pk_add_f32 v[106:107], v[106:107], v[122:123]
s_nop 1
v_add_f32_dpp v108, v104, v104 row_ror:4 row_mask:0xf bank_mask:0xf
v_add_f32_dpp v109, v105, v105 row_ror:4 row_mask:0xf bank_mask:0xf
v_add_f32_dpp v110, v106, v106 row_ror:4 row_mask:0xf bank_mask:0xf
v_add_f32_dpp v111, v107, v107 row_ror:4 row_mask:0xf bank_mask:0xf
v_add_f32_dpp v104, v108, v108 row_ror:8 row_mask:0xf bank_mask:0xf
v_add_f32_dpp v105, v109, v109 row_ror:8 row_mask:0xf bank_mask:0xf
v_add_f32_dpp v106, v110, v110 row_ror:8 row_mask:0xf bank_mask:0xf
v_add_f32_dpp v107, v111, v111 row_ror:8 row_mask:0xf bank_mask:0xf
v_mov_b32 v108, v104
v_mov_b32 v109, v105
v_mov_b32 v110, v106
v_mov_b32 v111, v107
v_permlane16_swap_b32 v104, v108
v_permlane16_swap_b32 v105, v109
v_permlane16_swap_b32 v106, v110
v_permlane16_swap_b32 v107, v111
v_add_f32 v104, v104, v108
v_add_f32 v105, v105, v109
v_add_f32 v106, v106, v110
v_add_f32 v107, v107, v111
v_mov_b32 v108, v104
v_mov_b32 v109, v105
v_mov_b32 v110, v106
v_mov_b32 v111, v107
v_permlane32_swap_b32 v104, v108
v_permlane32_swap_b32 v105, v109
v_permlane32_swap_b32 v106, v110
v_permlane32_swap_b32 v107, v111
v_add_f32 v104, v104, v108
v_add_f32 v105, v105, v109
v_add_f32 v106, v106, v110
v_add_f32 v107, v107, v111
s_and_b32 s28, s29, 1
s_lshl_b32 s28, s28, 2
v_and_b32 v113, 3, v1
v_add_u32 v113, s28, v113
v_mov_b32 v112, s76
v_cmp_eq_u32 vcc, 1, v113
v_mov_b32 v114, s77
s_nop 0
v_cndmask_b32 v112, v112, v114, vcc
v_cmp_eq_u32 vcc, 2, v113
v_mov_b32 v114, s78
s_nop 0
v_cndmask_b32 v112, v112, v114, vcc
v_cmp_eq_u32 vcc, 3, v113
v_mov_b32 v114, s79
s_nop 0
v_cndmask_b32 v112, v112, v114, vcc
v_cmp_eq_u32 vcc, 4, v113
v_mov_b32 v114, s80
s_nop 0
v_cndmask_b32 v112, v112, v114, vcc
v_cmp_eq_u32 vcc, 5, v113
v_mov_b32 v114, s81
s_nop 0
v_cndmask_b32 v112, v112, v114, vcc
v_cmp_eq_u32 vcc, 6, v113
v_mov_b32 v114, s82
s_nop 0
v_cndmask_b32 v112, v112, v114, vcc
v_cmp_eq_u32 vcc, 7, v113
v_mov_b32 v114, s83
s_nop 0
v_cndmask_b32 v112, v112, v114, vcc
v_ashrrev_i32 v114, 31, v112
v_not_b32 v114, v114
v_or_b32 v114, 0x80000000, v114
v_xor_b32 v112, v112, v114
v_and_b32 v112, 0xffff0000, v112
v_mul_f32 v112, 0xbfb8aa3b, v112
v_exp_f32 v112, v112
s_nop 0
v_add_f32 v112, 1.0, v112
v_rcp_f32 v112, v112
s_nop 0
v_cvt_pk_bf16_f32 v112, v112, v112
v_lshlrev_b32 v112, 16, v112
v_cvt_pk_bf16_f32 v108, v104, v105
v_cvt_pk_bf16_f32 v109, v106, v107
v_lshlrev_b32 v104, 16, v108
v_and_b32 v105, 0xffff0000, v108
v_lshlrev_b32 v106, 16, v109
v_and_b32 v107, 0xffff0000, v109
v_mul_f32 v104, v104, v112
v_mul_f32 v105, v105, v112
v_mul_f32 v106, v106, v112
v_mul_f32 v107, v107, v112
v_cvt_pk_bf16_f32 v108, v104, v105
v_cvt_pk_bf16_f32 v109, v106, v107
v_mul_u32_u24 v113, 0x480, v113
s_lshr_b32 s28, s29, 1
s_lshl_b32 s28, s28, 3
s_add_u32 s28, s28, 0x244000
s_mov_b64 exec, 15
buffer_store_dwordx2 v[108:109], v113, s[20:23], s28 offen sc0 sc1
s_mov_b64 exec, -1
s_branch K_EVT_RET
EV_Y2:
v_mov_b32 v246, 0
v_mov_b32 v247, 1
s_mov_b32 s28, 0x243080
s_mov_b64 exec, 1
buffer_atomic_add v247, v246, s[20:23], s28 offen sc1
s_mov_b64 exec, -1
s_branch K_EVT_RET
F_NOTYET:
s_add_u32 s51, s51, 1
s_and_b32 s29, s51, 15
s_cbranch_scc1 F_NOB
s_bitcmp1_b32 s51, 30
s_cbranch_scc1 F_BSENT
s_bitset1_b32 s51, 30
s_mov_b32 s50, s28
s_add_u32 s28, s45, 0x0
buffer_store_dwordx4 v[72:75], v169, s[20:23], s28 offen offset:0 sc0 sc1
buffer_store_dwordx4 v[76:79], v169, s[20:23], s28 offen offset:2048 sc0 sc1
s_add_u32 s28, s28, 4096
buffer_store_dwordx4 v[80:83], v169, s[20:23], s28 offen offset:0 sc0 sc1
buffer_store_dwordx4 v[84:87], v169, s[20:23], s28 offen offset:2048 sc0 sc1
s_add_u32 s28, s28, 4096
buffer_store_dwordx4 v[88:91], v169, s[20:23], s28 offen offset:0 sc0 sc1
buffer_store_dwordx4 v[92:95], v169, s[20:23], s28 offen offset:2048 sc0 sc1
s_add_u32 s28, s28, 4096
buffer_store_dwordx4 v[96:99], v169, s[20:23], s28 offen offset:0 sc0 sc1
buffer_store_dwordx4 v[100:103], v169, s[20:23], s28 offen offset:2048 sc0 sc1
s_add_u32 s28, s28, 4096
buffer_store_dwordx4 v[104:107], v169, s[20:23], s28 offen offset:0 sc0 sc1
s_lshl_b32 s28, s3, 2
s_add_u32 s28, s28, 0x240000
buffer_store_dword v65, v64, s[20:23], s28 offen sc0 sc1
buffer_store_dword v171, v170, s[20:23], 0 offen sc0 sc1
s_mov_b32 s28, s50
v_mov_b32 v170, 0x7ffffff0
s_waitcnt vmcnt(0)
buffer_store_byte v255, v254, s[24:27], 0 offen sc0 sc1
F_BSENT:
s_lshl_b32 s29, s36, 5
buffer_load_dword v62, v64, s[24:27], s29 offen sc0 sc1
s_waitcnt vmcnt(0)
v_and_b32 v63, 0x20202020, v62
v_cmp_ne_u32 vcc, 0x20202020, v63
s_cbranch_vccnz F_NOB
s_or_b32 s29, s38, 0x20
s_mul_i32 s29, s29, 0x01010101
v_cmp_ne_u32 vcc, s29, v62
v_mov_b32 v60, 0
s_cbranch_vccnz F_GO
v_mov_b32 v60, 1
s_branch F_GO
F_NOB:
s_sleep 1
s_add_u32 s100, s100, 1
s_bitcmp1_b32 s100, 19
s_cbranch_scc1 K_END
s_branch F_POLL
Q_REDO:
s_mov_b32 s4, 0
s_mov_b32 s51, 0
s_waitcnt vmcnt(0) lgkmcnt(0)
s_branch Q_START
SP_FL:
s_sleep 2
s_add_u32 s100, s100, 1
s_bitcmp1_b32 s100, 19
s_cbranch_scc1 K_END
buffer_load_dword v253, v249, s[24:27], 0 offen sc0 sc1
s_waitcnt vmcnt(0)
v_and_b32 v250, 0x20202020, v253
v_cmp_ne_u32 vcc, 0x20202020, v250
s_cbranch_vccnz SP_FL
s_branch SP_FL_RET
SP_CAND:
s_sleep 2
s_add_u32 s100, s100, 1
s_bitcmp1_b32 s100, 19
s_cbranch_scc1 K_END
s_mov_b32 s29, 0x242000
buffer_load_dword v248, v249, s[20:23], s29 offen sc0 sc1
s_waitcnt vmcnt(0)
v_cmp_eq_u32 vcc, 0, v248
s_cbranch_vccnz SP_CAND
s_branch SP_CAND_RET
SP_Y:
s_sleep 4
s_add_u32 s100, s100, 1
s_bitcmp1_b32 s100, 19
s_cbranch_scc1 K_END
s_mov_b32 s93, 0x243080
buffer_load_dword v246, v254, s[20:23], s93 offen sc0 sc1
s_waitcnt vmcnt(0)
v_readfirstlane_b32 s93, v246
s_cmp_lt_u32 s93, 288
s_cbranch_scc1 SP_Y
s_branch SP_Y_RET
SP_O1A:
s_sleep 1
s_add_u32 s100, s100, 1
s_bitcmp1_b32 s100, 19
s_cbranch_scc1 K_END
buffer_load_dword v230, v229, s[20:23], s94 offen sc0 sc1
s_waitcnt vmcnt(0)
v_cmp_gt_u32 vcc, 1, v230
s_bitcmp1_b32 vcc_lo, s39
s_cbranch_scc1 SP_O1A
s_branch SP_O1A_RET
SP_O2A:
s_sleep 1
s_add_u32 s100, s100, 1
s_bitcmp1_b32 s100, 19
s_cbranch_scc1 K_END
buffer_load_dword v230, v229, s[20:23], s94 offen sc0 sc1
s_waitcnt vmcnt(0)
v_cmp_gt_u32 vcc, 1, v230
s_and_b32 s29, vcc_lo, 15
s_cbranch_scc1 SP_O2A
s_branch SP_O2A_RET
SP_O3A:
s_sleep 1
s_add_u32 s100, s100, 1
s_bitcmp1_b32 s100, 19
s_cbranch_scc1 K_END
buffer_load_dword v230, v229, s[20:23], s94 offen sc0 sc1
s_waitcnt vmcnt(0)
v_cmp_gt_u32 vcc, 2, v230
s_and_b32 s29, vcc_lo, 15
s_cbranch_scc1 SP_O3A
s_branch SP_O3A_RET
SP_P1A:
s_sleep 1
s_add_u32 s100, s100, 1
s_bitcmp1_b32 s100, 19
s_cbranch_scc1 K_END
buffer_load_dword v230, v229, s[20:23], s95 offen sc0 sc1
s_waitcnt vmcnt(0)
v_cmp_gt_u32 vcc, 1, v230
s_and_b32 s29, vcc_lo, 0xff
s_cbranch_scc1 SP_P1A
s_branch SP_P1A_RET
SP_P2A:
s_sleep 1
s_add_u32 s100, s100, 1
s_bitcmp1_b32 s100, 19
s_cbranch_scc1 K_END
buffer_load_dword v230, v229, s[20:23], s95 offen sc0 sc1
s_waitcnt vmcnt(0)
v_cmp_gt_u32 vcc, 2, v230
s_and_b32 s29, vcc_lo, 0xff
s_cbranch_scc1 SP_P2A
s_branch SP_P2A_RET
K_HOT_END:
K_MIXED:
s_waitcnt lgkmcnt(0)
s_barrier
v_smfmac_f32_16x16x64_bf16 a[128:131], a[208:211], v[88:95], v245
v_smfmac_f32_16x16x64_bf16 a[132:135], a[208:211], v[96:103], v245
v_mfma_f32_16x16x32_bf16 a[0:3], a[176:179], v[88:91], a[0:3]
v_mfma_f32_16x16x32_bf16 a[16:19], a[180:183], v[88:91], a[16:19]
v_mfma_f32_16x16x32_bf16 a[32:35], a[184:187], v[88:91], a[32:35]
v_mfma_f32_16x16x32_bf16 a[48:51], a[188:191], v[88:91], a[48:51]
v_mfma_f32_16x16x32_bf16 a[64:67], a[192:195], v[88:91], a[64:67]
v_mfma_f32_16x16x32_bf16 a[80:83], a[196:199], v[88:91], a[80:83]
v_mfma_f32_16x16x32_bf16 a[96:99], a[200:203], v[88:91], a[96:99]
v_mfma_f32_16x16x32_bf16 a[112:115], a[204:207], v[88:91], a[112:115]
v_mfma_f32_16x16x32_bf16 a[4:7], a[176:179], v[92:95], a[4:7]
v_mfma_f32_16x16x32_bf16 a[20:23], a[180:183], v[92:95], a[20:23]
v_mfma_f32_16x16x32_bf16 a[36:39], a[184:187], v[92:95], a[36:39]
v_mfma_f32_16x16x32_bf16 a[52:55], a[188:191], v[92:95], a[52:55]
v_mfma_f32_16x16x32_bf16 a[68:71], a[192:195], v[92:95], a[68:71]
v_mfma_f32_16x16x32_bf16 a[84:87], a[196:199], v[92:95], a[84:87]
v_mfma_f32_16x16x32_bf16 a[100:103], a[200:203], v[92:95], a[100:103]
v_mfma_f32_16x16x32_bf16 a[116:119], a[204:207], v[92:95], a[116:119]
v_accvgpr_read_b32 v120, a128
v_accvgpr_read_b32 v124, a129
v_add_f32 v120, v120, v124
v_rcp_f32 v124, v120
s_add_u32 s50, s44, 0
v_mov_b32 v125, v124
v_accvgpr_read_b32 v104, a0
v_accvgpr_read_b32 v105, a1
v_accvgpr_read_b32 v106, a2
v_accvgpr_read_b32 v107, a3
v_accvgpr_read_b32 v108, a16
v_accvgpr_read_b32 v109, a17
v_accvgpr_read_b32 v110, a18
v_accvgpr_read_b32 v111, a19
v_pk_mul_f32 v[104:105], v[104:105], v[124:125]
v_pk_mul_f32 v[106:107], v[106:107], v[124:125]
v_pk_mul_f32 v[108:109], v[108:109], v[124:125]
v_pk_mul_f32 v[110:111], v[110:111], v[124:125]
v_cvt_pk_bf16_f32 v8, v104, v105
v_cvt_pk_bf16_f32 v9, v106, v107
v_cvt_pk_bf16_f32 v10, v108, v109
v_cvt_pk_bf16_f32 v11, v110, v111
buffer_store_dwordx4 v[8:11], v244, s[20:23], s50 offen offset:0 sc0 sc1
v_accvgpr_read_b32 v112, a32
v_accvgpr_read_b32 v113, a33
v_accvgpr_read_b32 v114, a34
v_accvgpr_read_b32 v115, a35
v_accvgpr_read_b32 v116, a48
v_accvgpr_read_b32 v117, a49
v_accvgpr_read_b32 v118, a50
v_accvgpr_read_b32 v119, a51
v_pk_mul_f32 v[112:113], v[112:113], v[124:125]
v_pk_mul_f32 v[114:115], v[114:115], v[124:125]
v_pk_mul_f32 v[116:117], v[116:117], v[124:125]
v_pk_mul_f32 v[118:119], v[118:119], v[124:125]
v_cvt_pk_bf16_f32 v12, v112, v113
v_cvt_pk_bf16_f32 v13, v114, v115
v_cvt_pk_bf16_f32 v14, v116, v117
v_cvt_pk_bf16_f32 v15, v118, v119
buffer_store_dwordx4 v[12:15], v244, s[20:23], s50 offen offset:1024 sc0 sc1
v_accvgpr_read_b32 v104, a64
v_accvgpr_read_b32 v105, a65
v_accvgpr_read_b32 v106, a66
v_accvgpr_read_b32 v107, a67
v_accvgpr_read_b32 v108, a80
v_accvgpr_read_b32 v109, a81
v_accvgpr_read_b32 v110, a82
v_accvgpr_read_b32 v111, a83
v_pk_mul_f32 v[104:105], v[104:105], v[124:125]
v_pk_mul_f32 v[106:107], v[106:107], v[124:125]
v_pk_mul_f32 v[108:109], v[108:109], v[124:125]
v_pk_mul_f32 v[110:111], v[110:111], v[124:125]
v_cvt_pk_bf16_f32 v16, v104, v105
v_cvt_pk_bf16_f32 v17, v106, v107
v_cvt_pk_bf16_f32 v18, v108, v109
v_cvt_pk_bf16_f32 v19, v110, v111
buffer_store_dwordx4 v[16:19], v244, s[20:23], s50 offen offset:2048 sc0 sc1
v_accvgpr_read_b32 v112, a96
v_accvgpr_read_b32 v113, a97
v_accvgpr_read_b32 v114, a98
v_accvgpr_read_b32 v115, a99
v_accvgpr_read_b32 v116, a112
v_accvgpr_read_b32 v117, a113
v_accvgpr_read_b32 v118, a114
v_accvgpr_read_b32 v119, a115
v_pk_mul_f32 v[112:113], v[112:113], v[124:125]
v_pk_mul_f32 v[114:115], v[114:115], v[124:125]
v_pk_mul_f32 v[116:117], v[116:117], v[124:125]
v_pk_mul_f32 v[118:119], v[118:119], v[124:125]
v_cvt_pk_bf16_f32 v20, v112, v113
v_cvt_pk_bf16_f32 v21, v114, v115
v_cvt_pk_bf16_f32 v22, v116, v117
v_cvt_pk_bf16_f32 v23, v118, v119
buffer_store_dwordx4 v[20:23], v244, s[20:23], s50 offen offset:3072 sc0 sc1
v_mfma_f32_16x16x32_bf16 a[8:11], a[176:179], v[96:99], a[8:11]
v_mfma_f32_16x16x32_bf16 a[24:27], a[180:183], v[96:99], a[24:27]
v_mfma_f32_16x16x32_bf16 a[40:43], a[184:187], v[96:99], a[40:43]
v_mfma_f32_16x16x32_bf16 a[56:59], a[188:191], v[96:99], a[56:59]
v_mfma_f32_16x16x32_bf16 a[72:75], a[192:195], v[96:99], a[72:75]
v_mfma_f32_16x16x32_bf16 a[88:91], a[196:199], v[96:99], a[88:91]
v_mfma_f32_16x16x32_bf16 a[104:107], a[200:203], v[96:99], a[104:107]
v_mfma_f32_16x16x32_bf16 a[120:123], a[204:207], v[96:99], a[120:123]
v_accvgpr_read_b32 v121, a130
v_accvgpr_read_b32 v126, a131
v_add_f32 v121, v121, v126
v_rcp_f32 v126, v121
s_add_u32 s50, s44, 4096
v_mov_b32 v127, v126
v_accvgpr_read_b32 v104, a4
v_accvgpr_read_b32 v105, a5
v_accvgpr_read_b32 v106, a6
v_accvgpr_read_b32 v107, a7
v_accvgpr_read_b32 v108, a20
v_accvgpr_read_b32 v109, a21
v_accvgpr_read_b32 v110, a22
v_accvgpr_read_b32 v111, a23
v_pk_mul_f32 v[104:105], v[104:105], v[126:127]
v_pk_mul_f32 v[106:107], v[106:107], v[126:127]
v_pk_mul_f32 v[108:109], v[108:109], v[126:127]
v_pk_mul_f32 v[110:111], v[110:111], v[126:127]
v_cvt_pk_bf16_f32 v24, v104, v105
v_cvt_pk_bf16_f32 v25, v106, v107
v_cvt_pk_bf16_f32 v26, v108, v109
v_cvt_pk_bf16_f32 v27, v110, v111
buffer_store_dwordx4 v[24:27], v244, s[20:23], s50 offen offset:0 sc0 sc1
v_accvgpr_read_b32 v112, a36
v_accvgpr_read_b32 v113, a37
v_accvgpr_read_b32 v114, a38
v_accvgpr_read_b32 v115, a39
v_accvgpr_read_b32 v116, a52
v_accvgpr_read_b32 v117, a53
v_accvgpr_read_b32 v118, a54
v_accvgpr_read_b32 v119, a55
v_pk_mul_f32 v[112:113], v[112:113], v[126:127]
v_pk_mul_f32 v[114:115], v[114:115], v[126:127]
v_pk_mul_f32 v[116:117], v[116:117], v[126:127]
v_pk_mul_f32 v[118:119], v[118:119], v[126:127]
v_cvt_pk_bf16_f32 v28, v112, v113
v_cvt_pk_bf16_f32 v29, v114, v115
v_cvt_pk_bf16_f32 v30, v116, v117
v_cvt_pk_bf16_f32 v31, v118, v119
buffer_store_dwordx4 v[28:31], v244, s[20:23], s50 offen offset:1024 sc0 sc1
v_accvgpr_read_b32 v104, a68
v_accvgpr_read_b32 v105, a69
v_accvgpr_read_b32 v106, a70
v_accvgpr_read_b32 v107, a71
v_accvgpr_read_b32 v108, a84
v_accvgpr_read_b32 v109, a85
v_accvgpr_read_b32 v110, a86
v_accvgpr_read_b32 v111, a87
v_pk_mul_f32 v[104:105], v[104:105], v[126:127]
v_pk_mul_f32 v[106:107], v[106:107], v[126:127]
v_pk_mul_f32 v[108:109], v[108:109], v[126:127]
v_pk_mul_f32 v[110:111], v[110:111], v[126:127]
v_cvt_pk_bf16_f32 v32, v104, v105
v_cvt_pk_bf16_f32 v33, v106, v107
v_cvt_pk_bf16_f32 v34, v108, v109
v_cvt_pk_bf16_f32 v35, v110, v111
buffer_store_dwordx4 v[32:35], v244, s[20:23], s50 offen offset:2048 sc0 sc1
v_accvgpr_read_b32 v112, a100
v_accvgpr_read_b32 v113, a101
v_accvgpr_read_b32 v114, a102
v_accvgpr_read_b32 v115, a103
v_accvgpr_read_b32 v116, a116
v_accvgpr_read_b32 v117, a117
v_accvgpr_read_b32 v118, a118
v_accvgpr_read_b32 v119, a119
v_pk_mul_f32 v[112:113], v[112:113], v[126:127]
v_pk_mul_f32 v[114:115], v[114:115], v[126:127]
v_pk_mul_f32 v[116:117], v[116:117], v[126:127]
v_pk_mul_f32 v[118:119], v[118:119], v[126:127]
v_cvt_pk_bf16_f32 v36, v112, v113
v_cvt_pk_bf16_f32 v37, v114, v115
v_cvt_pk_bf16_f32 v38, v116, v117
v_cvt_pk_bf16_f32 v39, v118, v119
buffer_store_dwordx4 v[36:39], v244, s[20:23], s50 offen offset:3072 sc0 sc1
v_mfma_f32_16x16x32_bf16 a[12:15], a[176:179], v[100:103], a[12:15]
v_mfma_f32_16x16x32_bf16 a[28:31], a[180:183], v[100:103], a[28:31]
v_mfma_f32_16x16x32_bf16 a[44:47], a[184:187], v[100:103], a[44:47]
v_mfma_f32_16x16x32_bf16 a[60:63], a[188:191], v[100:103], a[60:63]
v_mfma_f32_16x16x32_bf16 a[76:79], a[192:195], v[100:103], a[76:79]
v_mfma_f32_16x16x32_bf16 a[92:95], a[196:199], v[100:103], a[92:95]
v_mfma_f32_16x16x32_bf16 a[108:111], a[200:203], v[100:103], a[108:111]
v_mfma_f32_16x16x32_bf16 a[124:127], a[204:207], v[100:103], a[124:127]
v_accvgpr_read_b32 v122, a132
v_accvgpr_read_b32 v128, a133
v_add_f32 v122, v122, v128
v_rcp_f32 v128, v122
s_add_u32 s50, s44, 8192
v_mov_b32 v129, v128
v_accvgpr_read_b32 v104, a8
v_accvgpr_read_b32 v105, a9
v_accvgpr_read_b32 v106, a10
v_accvgpr_read_b32 v107, a11
v_accvgpr_read_b32 v108, a24
v_accvgpr_read_b32 v109, a25
v_accvgpr_read_b32 v110, a26
v_accvgpr_read_b32 v111, a27
v_pk_mul_f32 v[104:105], v[104:105], v[128:129]
v_pk_mul_f32 v[106:107], v[106:107], v[128:129]
v_pk_mul_f32 v[108:109], v[108:109], v[128:129]
v_pk_mul_f32 v[110:111], v[110:111], v[128:129]
v_cvt_pk_bf16_f32 v40, v104, v105
v_cvt_pk_bf16_f32 v41, v106, v107
v_cvt_pk_bf16_f32 v42, v108, v109
v_cvt_pk_bf16_f32 v43, v110, v111
buffer_store_dwordx4 v[40:43], v244, s[20:23], s50 offen offset:0 sc0 sc1
v_accvgpr_read_b32 v112, a40
v_accvgpr_read_b32 v113, a41
v_accvgpr_read_b32 v114, a42
v_accvgpr_read_b32 v115, a43
v_accvgpr_read_b32 v116, a56
v_accvgpr_read_b32 v117, a57
v_accvgpr_read_b32 v118, a58
v_accvgpr_read_b32 v119, a59
v_pk_mul_f32 v[112:113], v[112:113], v[128:129]
v_pk_mul_f32 v[114:115], v[114:115], v[128:129]
v_pk_mul_f32 v[116:117], v[116:117], v[128:129]
v_pk_mul_f32 v[118:119], v[118:119], v[128:129]
v_cvt_pk_bf16_f32 v44, v112, v113
v_cvt_pk_bf16_f32 v45, v114, v115
v_cvt_pk_bf16_f32 v46, v116, v117
v_cvt_pk_bf16_f32 v47, v118, v119
buffer_store_dwordx4 v[44:47], v244, s[20:23], s50 offen offset:1024 sc0 sc1
v_accvgpr_read_b32 v104, a72
v_accvgpr_read_b32 v105, a73
v_accvgpr_read_b32 v106, a74
v_accvgpr_read_b32 v107, a75
v_accvgpr_read_b32 v108, a88
v_accvgpr_read_b32 v109, a89
v_accvgpr_read_b32 v110, a90
v_accvgpr_read_b32 v111, a91
v_pk_mul_f32 v[104:105], v[104:105], v[128:129]
v_pk_mul_f32 v[106:107], v[106:107], v[128:129]
v_pk_mul_f32 v[108:109], v[108:109], v[128:129]
v_pk_mul_f32 v[110:111], v[110:111], v[128:129]
v_cvt_pk_bf16_f32 v48, v104, v105
v_cvt_pk_bf16_f32 v49, v106, v107
v_cvt_pk_bf16_f32 v50, v108, v109
v_cvt_pk_bf16_f32 v51, v110, v111
buffer_store_dwordx4 v[48:51], v244, s[20:23], s50 offen offset:2048 sc0 sc1
v_accvgpr_read_b32 v112, a104
v_accvgpr_read_b32 v113, a105
v_accvgpr_read_b32 v114, a106
v_accvgpr_read_b32 v115, a107
v_accvgpr_read_b32 v116, a120
v_accvgpr_read_b32 v117, a121
v_accvgpr_read_b32 v118, a122
v_accvgpr_read_b32 v119, a123
v_pk_mul_f32 v[112:113], v[112:113], v[128:129]
v_pk_mul_f32 v[114:115], v[114:115], v[128:129]
v_pk_mul_f32 v[116:117], v[116:117], v[128:129]
v_pk_mul_f32 v[118:119], v[118:119], v[128:129]
v_cvt_pk_bf16_f32 v52, v112, v113
v_cvt_pk_bf16_f32 v53, v114, v115
v_cvt_pk_bf16_f32 v54, v116, v117
v_cvt_pk_bf16_f32 v55, v118, v119
buffer_store_dwordx4 v[52:55], v244, s[20:23], s50 offen offset:3072 sc0 sc1
s_nop 7
v_accvgpr_read_b32 v123, a134
v_accvgpr_read_b32 v130, a135
v_add_f32 v123, v123, v130
v_rcp_f32 v130, v123
s_add_u32 s50, s44, 12288
v_mov_b32 v131, v130
v_accvgpr_read_b32 v104, a12
v_accvgpr_read_b32 v105, a13
v_accvgpr_read_b32 v106, a14
v_accvgpr_read_b32 v107, a15
v_accvgpr_read_b32 v108, a28
v_accvgpr_read_b32 v109, a29
v_accvgpr_read_b32 v110, a30
v_accvgpr_read_b32 v111, a31
v_pk_mul_f32 v[104:105], v[104:105], v[130:131]
v_pk_mul_f32 v[106:107], v[106:107], v[130:131]
v_pk_mul_f32 v[108:109], v[108:109], v[130:131]
v_pk_mul_f32 v[110:111], v[110:111], v[130:131]
v_cvt_pk_bf16_f32 v56, v104, v105
v_cvt_pk_bf16_f32 v57, v106, v107
v_cvt_pk_bf16_f32 v58, v108, v109
v_cvt_pk_bf16_f32 v59, v110, v111
buffer_store_dwordx4 v[56:59], v244, s[20:23], s50 offen offset:0 sc0 sc1
v_accvgpr_read_b32 v112, a44
v_accvgpr_read_b32 v113, a45
v_accvgpr_read_b32 v114, a46
v_accvgpr_read_b32 v115, a47
v_accvgpr_read_b32 v116, a60
v_accvgpr_read_b32 v117, a61
v_accvgpr_read_b32 v118, a62
v_accvgpr_read_b32 v119, a63
v_pk_mul_f32 v[112:113], v[112:113], v[130:131]
v_pk_mul_f32 v[114:115], v[114:115], v[130:131]
v_pk_mul_f32 v[116:117], v[116:117], v[130:131]
v_pk_mul_f32 v[118:119], v[118:119], v[130:131]
v_cvt_pk_bf16_f32 v60, v112, v113
v_cvt_pk_bf16_f32 v61, v114, v115
v_cvt_pk_bf16_f32 v62, v116, v117
v_cvt_pk_bf16_f32 v63, v118, v119
buffer_store_dwordx4 v[60:63], v244, s[20:23], s50 offen offset:1024 sc0 sc1
v_accvgpr_read_b32 v104, a76
v_accvgpr_read_b32 v105, a77
v_accvgpr_read_b32 v106, a78
v_accvgpr_read_b32 v107, a79
v_accvgpr_read_b32 v108, a92
v_accvgpr_read_b32 v109, a93
v_accvgpr_read_b32 v110, a94
v_accvgpr_read_b32 v111, a95
v_pk_mul_f32 v[104:105], v[104:105], v[130:131]
v_pk_mul_f32 v[106:107], v[106:107], v[130:131]
v_pk_mul_f32 v[108:109], v[108:109], v[130:131]
v_pk_mul_f32 v[110:111], v[110:111], v[130:131]
v_cvt_pk_bf16_f32 v64, v104, v105
v_cvt_pk_bf16_f32 v65, v106, v107
v_cvt_pk_bf16_f32 v66, v108, v109
v_cvt_pk_bf16_f32 v67, v110, v111
buffer_store_dwordx4 v[64:67], v244, s[20:23], s50 offen offset:2048 sc0 sc1
v_accvgpr_read_b32 v112, a108
v_accvgpr_read_b32 v113, a109
v_accvgpr_read_b32 v114, a110
v_accvgpr_read_b32 v115, a111
v_accvgpr_read_b32 v116, a124
v_accvgpr_read_b32 v117, a125
v_accvgpr_read_b32 v118, a126
v_accvgpr_read_b32 v119, a127
v_pk_mul_f32 v[112:113], v[112:113], v[130:131]
v_pk_mul_f32 v[114:115], v[114:115], v[130:131]
v_pk_mul_f32 v[116:117], v[116:117], v[130:131]
v_pk_mul_f32 v[118:119], v[118:119], v[130:131]
v_cvt_pk_bf16_f32 v68, v112, v113
v_cvt_pk_bf16_f32 v69, v114, v115
v_cvt_pk_bf16_f32 v70, v116, v117
v_cvt_pk_bf16_f32 v71, v118, v119
buffer_store_dwordx4 v[68:71], v244, s[20:23], s50 offen offset:3072 sc0 sc1
v_max3_f32 v104, v120, v121, v122
v_max_f32 v104, v104, v123
v_add_f32 v105, v120, v121
v_add_f32 v105, v105, v122
v_add_f32 v105, v105, v123
v_cmp_nge_f32 vcc, s42, v104
v_cmp_u_f32 s[28:29], v105, v105
s_or_b64 vcc, vcc, s[28:29]
s_cmp_lg_u64 vcc, 0
s_cselect_b32 s28, 1, 0
v_mov_b32 v104, s28
s_lshl_b32 s29, s37, 2
s_add_u32 s29, s29, 147968
v_mov_b32 v105, s29
v_mov_b32 v106, 147968
ds_write_b32 v105, v104
s_waitcnt vmcnt(16) lgkmcnt(0)
s_barrier
ds_read_b128 v[108:111], v106
ds_read_b64_tr_b16 a[64:65], v237 offset:0
ds_read_b64_tr_b16 a[66:67], v237 offset:4608
ds_read_b64_tr_b16 a[68:69], v237 offset:8
ds_read_b64_tr_b16 a[70:71], v237 offset:4616
ds_read_b64_tr_b16 a[72:73], v238 offset:0
ds_read_b64_tr_b16 a[74:75], v238 offset:4608
ds_read_b64_tr_b16 a[76:77], v238 offset:8
ds_read_b64_tr_b16 a[78:79], v238 offset:4616
ds_read_b64_tr_b16 a[80:81], v237 offset:128
ds_read_b64_tr_b16 a[82:83], v237 offset:4736
ds_read_b64_tr_b16 a[84:85], v237 offset:136
ds_read_b64_tr_b16 a[86:87], v237 offset:4744
ds_read_b64_tr_b16 a[88:89], v238 offset:128
ds_read_b64_tr_b16 a[90:91], v238 offset:4736
s_waitcnt lgkmcnt(14)
v_or_b32 v108, v108, v109
v_or3_b32 v108, v108, v110, v111
s_nop 0
v_readfirstlane_b32 s28, v108
s_cmp_gt_u32 s28, s43
s_cbranch_scc1 K_FALLBACK
s_waitcnt lgkmcnt(8)
v_mfma_f32_16x16x32_bf16 v[72:75], a[64:67], v[8:11], 0
ds_read_b64_tr_b16 a[92:93], v238 offset:136
ds_read_b64_tr_b16 a[94:95], v238 offset:4744
v_mfma_f32_16x16x32_bf16 v[80:83], a[64:67], v[24:27], 0
s_lshr_b32 s32, s35, 2
s_and_b32 s33, s35, 3
v_mfma_f32_16x16x32_bf16 v[88:91], a[64:67], v[40:43], 0
s_lshl_b32 s94, s36, 9
s_lshl_b32 s28, s32, 6
v_mfma_f32_16x16x32_bf16 v[96:99], a[64:67], v[56:59], 0
s_lshr_b32 s34, s32, 2
v_mfma_f32_16x16x32_bf16 v[76:79], a[68:71], v[8:11], 0
ds_read_b64_tr_b16 a[64:65], v239 offset:0
ds_read_b64_tr_b16 a[66:67], v239 offset:4608
v_mfma_f32_16x16x32_bf16 v[84:87], a[68:71], v[24:27], 0
s_add_u32 s94, s94, s28
s_lshl_b32 s28, s37, 4
v_mfma_f32_16x16x32_bf16 v[92:95], a[68:71], v[40:43], 0
s_add_u32 s94, s94, s28
s_add_u32 s94, s94, 0x248000
v_mfma_f32_16x16x32_bf16 v[100:103], a[68:71], v[56:59], 0
v_mov_b32 v231, 1
v_and_b32 v229, 7, v1
v_mfma_f32_16x16x32_bf16 v[104:107], a[72:75], v[8:11], 0
ds_read_b64_tr_b16 a[68:69], v237 offset:9216
ds_read_b64_tr_b16 a[70:71], v237 offset:13824
v_mfma_f32_16x16x32_bf16 v[112:115], a[72:75], v[24:27], 0
v_lshlrev_b32 v229, 2, v229
v_lshlrev_b32 v226, 3, v1
v_mfma_f32_16x16x32_bf16 v[120:123], a[72:75], v[40:43], 0
s_lshl2_add_u32 s29, s33, s94
v_mfma_f32_16x16x32_bf16 v[128:131], a[72:75], v[56:59], 0
s_waitcnt lgkmcnt(8)
v_mfma_f32_16x16x32_bf16 v[108:111], a[76:79], v[8:11], 0
ds_read_b64_tr_b16 a[72:73], v237 offset:9224
ds_read_b64_tr_b16 a[74:75], v237 offset:13832
v_mfma_f32_16x16x32_bf16 v[116:119], a[76:79], v[24:27], 0
v_mfma_f32_16x16x32_bf16 v[124:127], a[76:79], v[40:43], 0
v_mfma_f32_16x16x32_bf16 v[132:135], a[76:79], v[56:59], 0
v_mfma_f32_16x16x32_bf16 v[136:139], a[80:83], v[8:11], 0
ds_read_b64_tr_b16 a[76:77], v238 offset:9216
ds_read_b64_tr_b16 a[78:79], v238 offset:13824
v_mfma_f32_16x16x32_bf16 v[144:147], a[80:83], v[24:27], 0
v_mfma_f32_16x16x32_bf16 v[152:155], a[80:83], v[40:43], 0
v_mfma_f32_16x16x32_bf16 v[160:163], a[80:83], v[56:59], 0
v_mfma_f32_16x16x32_bf16 v[140:143], a[84:87], v[8:11], 0
ds_read_b64_tr_b16 a[80:81], v238 offset:9224
ds_read_b64_tr_b16 a[82:83], v238 offset:13832
v_mfma_f32_16x16x32_bf16 v[148:151], a[84:87], v[24:27], 0
s_waitcnt vmcnt(0)
buffer_store_dword v231, v254, s[20:23], s29 offen sc0 sc1
v_mfma_f32_16x16x32_bf16 v[156:159], a[84:87], v[40:43], 0
s_add_u32 s28, s35, 1
s_and_b32 s28, s28, 3
v_mfma_f32_16x16x32_bf16 v[164:167], a[84:87], v[56:59], 0
s_mul_i32 s28, s28, 36864
s_waitcnt lgkmcnt(8)
v_mfma_f32_16x16x32_bf16 v[168:171], a[88:91], v[8:11], 0
ds_read_b64_tr_b16 a[84:85], v237 offset:9344
ds_read_b64_tr_b16 a[86:87], v237 offset:13952
v_mfma_f32_16x16x32_bf16 v[176:179], a[88:91], v[24:27], 0
v_add_u32 v216, s28, v234
v_add_u32 v217, s28, v235
v_mfma_f32_16x16x32_bf16 v[184:187], a[88:91], v[40:43], 0
v_add_u32 v218, s28, v236
v_mfma_f32_16x16x32_bf16 v[192:195], a[88:91], v[56:59], 0
v_mfma_f32_16x16x32_bf16 v[172:175], a[92:95], v[8:11], 0
ds_read_b64_tr_b16 a[88:89], v237 offset:9352
ds_read_b64_tr_b16 a[90:91], v237 offset:13960
v_mfma_f32_16x16x32_bf16 v[180:183], a[92:95], v[24:27], 0
v_mfma_f32_16x16x32_bf16 v[188:191], a[92:95], v[40:43], 0
v_mfma_f32_16x16x32_bf16 v[196:199], a[92:95], v[56:59], 0
v_mfma_f32_16x16x32_bf16 v[200:203], a[64:67], v[8:11], 0
ds_read_b64_tr_b16 a[92:93], v238 offset:9344
ds_read_b64_tr_b16 a[94:95], v238 offset:13952
v_mfma_f32_16x16x32_bf16 v[204:207], a[64:67], v[24:27], 0
v_mfma_f32_16x16x32_bf16 v[208:211], a[64:67], v[40:43], 0
v_mfma_f32_16x16x32_bf16 v[212:215], a[64:67], v[56:59], 0
s_waitcnt lgkmcnt(8)
v_mfma_f32_16x16x32_bf16 v[72:75], a[68:71], v[12:15], v[72:75]
ds_read_b64_tr_b16 a[64:65], v238 offset:9352
ds_read_b64_tr_b16 a[66:67], v238 offset:13960
v_mfma_f32_16x16x32_bf16 v[80:83], a[68:71], v[28:31], v[80:83]
v_mfma_f32_16x16x32_bf16 v[88:91], a[68:71], v[44:47], v[88:91]
v_mfma_f32_16x16x32_bf16 v[96:99], a[68:71], v[60:63], v[96:99]
v_mfma_f32_16x16x32_bf16 v[76:79], a[72:75], v[12:15], v[76:79]
ds_read_b64_tr_b16 a[68:69], v239 offset:9216
ds_read_b64_tr_b16 a[70:71], v239 offset:13824
v_mfma_f32_16x16x32_bf16 v[84:87], a[72:75], v[28:31], v[84:87]
buffer_load_dword v230, v229, s[20:23], s94 offen sc0 sc1
v_mfma_f32_16x16x32_bf16 v[92:95], a[72:75], v[44:47], v[92:95]
s_add_u32 s39, s35, 1
s_and_b32 s39, s39, 3
v_mfma_f32_16x16x32_bf16 v[100:103], a[72:75], v[60:63], v[100:103]
s_add_u32 s28, s33, 1
s_and_b32 s28, s28, 3
v_mfma_f32_16x16x32_bf16 v[104:107], a[76:79], v[12:15], v[104:107]
ds_read_b64_tr_b16 a[72:73], v237 offset:18432
ds_read_b64_tr_b16 a[74:75], v237 offset:23040
v_mfma_f32_16x16x32_bf16 v[112:115], a[76:79], v[28:31], v[112:115]
s_sub_u32 s28, s28, s33
s_lshl_b32 s28, s28, 16
v_mfma_f32_16x16x32_bf16 v[120:123], a[76:79], v[44:47], v[120:123]
s_add_u32 s64, s28, s44
s_add_u32 s65, s64, 4096
v_mfma_f32_16x16x32_bf16 v[128:131], a[76:79], v[60:63], v[128:131]
s_add_u32 s66, s64, 8192
s_add_u32 s67, s64, 12288
s_waitcnt lgkmcnt(8)
v_mfma_f32_16x16x32_bf16 v[108:111], a[80:83], v[12:15], v[108:111]
ds_read_b64_tr_b16 a[76:77], v237 offset:18440
ds_read_b64_tr_b16 a[78:79], v237 offset:23048
v_mfma_f32_16x16x32_bf16 v[116:119], a[80:83], v[28:31], v[116:119]
s_add_u32 s28, s35, 2
s_and_b32 s28, s28, 3
v_mfma_f32_16x16x32_bf16 v[124:127], a[80:83], v[44:47], v[124:127]
s_mul_i32 s28, s28, 36864
v_mfma_f32_16x16x32_bf16 v[132:135], a[80:83], v[60:63], v[132:135]
v_add_u32 v219, s28, v234
v_add_u32 v220, s28, v235
v_mfma_f32_16x16x32_bf16 v[136:139], a[84:87], v[12:15], v[136:139]
ds_read_b64_tr_b16 a[80:81], v238 offset:18432
ds_read_b64_tr_b16 a[82:83], v238 offset:23040
v_mfma_f32_16x16x32_bf16 v[144:147], a[84:87], v[28:31], v[144:147]
v_add_u32 v221, s28, v236
v_mfma_f32_16x16x32_bf16 v[152:155], a[84:87], v[44:47], v[152:155]
s_add_u32 s28, s35, 3
s_and_b32 s28, s28, 3
v_mfma_f32_16x16x32_bf16 v[160:163], a[84:87], v[60:63], v[160:163]
s_mul_i32 s28, s28, 36864
v_mfma_f32_16x16x32_bf16 v[140:143], a[88:91], v[12:15], v[140:143]
ds_read_b64_tr_b16 a[84:85], v238 offset:18440
ds_read_b64_tr_b16 a[86:87], v238 offset:23048
v_mfma_f32_16x16x32_bf16 v[148:151], a[88:91], v[28:31], v[148:151]
v_add_u32 v222, s28, v234
v_add_u32 v223, s28, v235
v_mfma_f32_16x16x32_bf16 v[156:159], a[88:91], v[44:47], v[156:159]
v_add_u32 v224, s28, v236
v_mfma_f32_16x16x32_bf16 v[164:167], a[88:91], v[60:63], v[164:167]
s_waitcnt lgkmcnt(8)
v_mfma_f32_16x16x32_bf16 v[168:171], a[92:95], v[12:15], v[168:171]
ds_read_b64_tr_b16 a[88:89], v237 offset:18560
ds_read_b64_tr_b16 a[90:91], v237 offset:23168
v_mfma_f32_16x16x32_bf16 v[176:179], a[92:95], v[28:31], v[176:179]
v_mfma_f32_16x16x32_bf16 v[184:187], a[92:95], v[44:47], v[184:187]
s_waitcnt vmcnt(0)
v_cmp_gt_u32 vcc, 1, v230
v_mfma_f32_16x16x32_bf16 v[192:195], a[92:95], v[60:63], v[192:195]
v_mfma_f32_16x16x32_bf16 v[172:175], a[64:67], v[12:15], v[172:175]
ds_read_b64_tr_b16 a[92:93], v237 offset:18568
ds_read_b64_tr_b16 a[94:95], v237 offset:23176
v_mfma_f32_16x16x32_bf16 v[180:183], a[64:67], v[28:31], v[180:183]
s_bitcmp1_b32 vcc_lo, s39
s_cbranch_scc1 SP_O1B
SP_O1B_RET:
v_mfma_f32_16x16x32_bf16 v[188:191], a[64:67], v[44:47], v[188:191]
buffer_load_dwordx4 a[128:131], v244, s[20:23], s64 offen offset:0 sc0 sc1
v_mfma_f32_16x16x32_bf16 v[196:199], a[64:67], v[60:63], v[196:199]
v_mfma_f32_16x16x32_bf16 v[200:203], a[68:71], v[12:15], v[200:203]
ds_read_b64_tr_b16 a[64:65], v238 offset:18560
ds_read_b64_tr_b16 a[66:67], v238 offset:23168
v_mfma_f32_16x16x32_bf16 v[204:207], a[68:71], v[28:31], v[204:207]
v_mfma_f32_16x16x32_bf16 v[208:211], a[68:71], v[44:47], v[208:211]
buffer_load_dwordx4 a[144:147], v244, s[20:23], s65 offen offset:0 sc0 sc1
v_mfma_f32_16x16x32_bf16 v[212:215], a[68:71], v[60:63], v[212:215]
s_waitcnt lgkmcnt(8)
v_mfma_f32_16x16x32_bf16 v[72:75], a[72:75], v[16:19], v[72:75]
ds_read_b64_tr_b16 a[68:69], v238 offset:18568
ds_read_b64_tr_b16 a[70:71], v238 offset:23176
v_mfma_f32_16x16x32_bf16 v[80:83], a[72:75], v[32:35], v[80:83]
v_mfma_f32_16x16x32_bf16 v[88:91], a[72:75], v[48:51], v[88:91]
buffer_load_dwordx4 a[160:163], v244, s[20:23], s66 offen offset:0 sc0 sc1
v_mfma_f32_16x16x32_bf16 v[96:99], a[72:75], v[64:67], v[96:99]
v_mfma_f32_16x16x32_bf16 v[76:79], a[76:79], v[16:19], v[76:79]
ds_read_b64_tr_b16 a[72:73], v239 offset:18432
ds_read_b64_tr_b16 a[74:75], v239 offset:23040
v_mfma_f32_16x16x32_bf16 v[84:87], a[76:79], v[32:35], v[84:87]
v_mfma_f32_16x16x32_bf16 v[92:95], a[76:79], v[48:51], v[92:95]
buffer_load_dwordx4 a[176:179], v244, s[20:23], s67 offen offset:0 sc0 sc1
v_mfma_f32_16x16x32_bf16 v[100:103], a[76:79], v[64:67], v[100:103]
v_mfma_f32_16x16x32_bf16 v[104:107], a[80:83], v[16:19], v[104:107]
ds_read_b64_tr_b16 a[76:77], v237 offset:27648
ds_read_b64_tr_b16 a[78:79], v237 offset:32256
v_mfma_f32_16x16x32_bf16 v[112:115], a[80:83], v[32:35], v[112:115]
v_mfma_f32_16x16x32_bf16 v[120:123], a[80:83], v[48:51], v[120:123]
buffer_load_dwordx4 a[132:135], v244, s[20:23], s64 offen offset:1024 sc0 sc1
v_mfma_f32_16x16x32_bf16 v[128:131], a[80:83], v[64:67], v[128:131]
s_waitcnt lgkmcnt(8)
v_mfma_f32_16x16x32_bf16 v[108:111], a[84:87], v[16:19], v[108:111]
ds_read_b64_tr_b16 a[80:81], v237 offset:27656
ds_read_b64_tr_b16 a[82:83], v237 offset:32264
v_mfma_f32_16x16x32_bf16 v[116:119], a[84:87], v[32:35], v[116:119]
v_mfma_f32_16x16x32_bf16 v[124:127], a[84:87], v[48:51], v[124:127]
buffer_load_dwordx4 a[148:151], v244, s[20:23], s65 offen offset:1024 sc0 sc1
v_mfma_f32_16x16x32_bf16 v[132:135], a[84:87], v[64:67], v[132:135]
v_mfma_f32_16x16x32_bf16 v[136:139], a[88:91], v[16:19], v[136:139]
ds_read_b64_tr_b16 a[84:85], v238 offset:27648
ds_read_b64_tr_b16 a[86:87], v238 offset:32256
v_mfma_f32_16x16x32_bf16 v[144:147], a[88:91], v[32:35], v[144:147]
v_mfma_f32_16x16x32_bf16 v[152:155], a[88:91], v[48:51], v[152:155]
buffer_load_dwordx4 a[164:167], v244, s[20:23], s66 offen offset:1024 sc0 sc1
v_mfma_f32_16x16x32_bf16 v[160:163], a[88:91], v[64:67], v[160:163]
v_mfma_f32_16x16x32_bf16 v[140:143], a[92:95], v[16:19], v[140:143]
ds_read_b64_tr_b16 a[88:89], v238 offset:27656
ds_read_b64_tr_b16 a[90:91], v238 offset:32264
v_mfma_f32_16x16x32_bf16 v[148:151], a[92:95], v[32:35], v[148:151]
v_mfma_f32_16x16x32_bf16 v[156:159], a[92:95], v[48:51], v[156:159]
buffer_load_dwordx4 a[180:183], v244, s[20:23], s67 offen offset:1024 sc0 sc1
v_mfma_f32_16x16x32_bf16 v[164:167], a[92:95], v[64:67], v[164:167]
s_waitcnt lgkmcnt(8)
v_mfma_f32_16x16x32_bf16 v[168:171], a[64:67], v[16:19], v[168:171]
ds_read_b64_tr_b16 a[92:93], v237 offset:27776
ds_read_b64_tr_b16 a[94:95], v237 offset:32384
v_mfma_f32_16x16x32_bf16 v[176:179], a[64:67], v[32:35], v[176:179]
v_mfma_f32_16x16x32_bf16 v[184:187], a[64:67], v[48:51], v[184:187]
buffer_load_dwordx4 a[136:139], v244, s[20:23], s64 offen offset:2048 sc0 sc1
v_mfma_f32_16x16x32_bf16 v[192:195], a[64:67], v[64:67], v[192:195]
buffer_load_dword v230, v229, s[20:23], s94 offen sc0 sc1
v_mfma_f32_16x16x32_bf16 v[172:175], a[68:71], v[16:19], v[172:175]
ds_read_b64_tr_b16 a[64:65], v237 offset:27784
ds_read_b64_tr_b16 a[66:67], v237 offset:32392
v_mfma_f32_16x16x32_bf16 v[180:183], a[68:71], v[32:35], v[180:183]
v_mfma_f32_16x16x32_bf16 v[188:191], a[68:71], v[48:51], v[188:191]
v_mfma_f32_16x16x32_bf16 v[196:199], a[68:71], v[64:67], v[196:199]
buffer_load_dwordx4 a[152:155], v244, s[20:23], s65 offen offset:2048 sc0 sc1
v_mfma_f32_16x16x32_bf16 v[200:203], a[72:75], v[16:19], v[200:203]
ds_read_b64_tr_b16 a[68:69], v238 offset:27776
ds_read_b64_tr_b16 a[70:71], v238 offset:32384
v_mfma_f32_16x16x32_bf16 v[204:207], a[72:75], v[32:35], v[204:207]
v_mfma_f32_16x16x32_bf16 v[208:211], a[72:75], v[48:51], v[208:211]
v_mfma_f32_16x16x32_bf16 v[212:215], a[72:75], v[64:67], v[212:215]
buffer_load_dwordx4 a[168:171], v244, s[20:23], s66 offen offset:2048 sc0 sc1
s_waitcnt lgkmcnt(8)
v_mfma_f32_16x16x32_bf16 v[72:75], a[76:79], v[20:23], v[72:75]
ds_read_b64_tr_b16 a[72:73], v238 offset:27784
ds_read_b64_tr_b16 a[74:75], v238 offset:32392
v_mfma_f32_16x16x32_bf16 v[80:83], a[76:79], v[36:39], v[80:83]
v_mfma_f32_16x16x32_bf16 v[88:91], a[76:79], v[52:55], v[88:91]
v_mfma_f32_16x16x32_bf16 v[96:99], a[76:79], v[68:71], v[96:99]
buffer_load_dwordx4 a[184:187], v244, s[20:23], s67 offen offset:2048 sc0 sc1
v_mfma_f32_16x16x32_bf16 v[76:79], a[80:83], v[20:23], v[76:79]
ds_read_b64_tr_b16 a[76:77], v239 offset:27648
ds_read_b64_tr_b16 a[78:79], v239 offset:32256
v_mfma_f32_16x16x32_bf16 v[84:87], a[80:83], v[36:39], v[84:87]
v_mfma_f32_16x16x32_bf16 v[92:95], a[80:83], v[52:55], v[92:95]
v_mfma_f32_16x16x32_bf16 v[100:103], a[80:83], v[68:71], v[100:103]
buffer_load_dwordx4 a[140:143], v244, s[20:23], s64 offen offset:3072 sc0 sc1
v_mfma_f32_16x16x32_bf16 v[104:107], a[84:87], v[20:23], v[104:107]
ds_read_b64_tr_b16 a[80:81], v216 offset:0
ds_read_b64_tr_b16 a[82:83], v216 offset:4608
v_mfma_f32_16x16x32_bf16 v[112:115], a[84:87], v[36:39], v[112:115]
v_mfma_f32_16x16x32_bf16 v[120:123], a[84:87], v[52:55], v[120:123]
v_mfma_f32_16x16x32_bf16 v[128:131], a[84:87], v[68:71], v[128:131]
buffer_load_dwordx4 a[156:159], v244, s[20:23], s65 offen offset:3072 sc0 sc1
s_waitcnt lgkmcnt(8)
v_mfma_f32_16x16x32_bf16 v[108:111], a[88:91], v[20:23], v[108:111]
ds_read_b64_tr_b16 a[84:85], v216 offset:8
ds_read_b64_tr_b16 a[86:87], v216 offset:4616
v_mfma_f32_16x16x32_bf16 v[116:119], a[88:91], v[36:39], v[116:119]
v_mfma_f32_16x16x32_bf16 v[124:127], a[88:91], v[52:55], v[124:127]
v_mfma_f32_16x16x32_bf16 v[132:135], a[88:91], v[68:71], v[132:135]
buffer_load_dwordx4 a[172:175], v244, s[20:23], s66 offen offset:3072 sc0 sc1
v_mfma_f32_16x16x32_bf16 v[136:139], a[92:95], v[20:23], v[136:139]
ds_read_b64_tr_b16 a[88:89], v217 offset:0
ds_read_b64_tr_b16 a[90:91], v217 offset:4608
v_mfma_f32_16x16x32_bf16 v[144:147], a[92:95], v[36:39], v[144:147]
v_mfma_f32_16x16x32_bf16 v[152:155], a[92:95], v[52:55], v[152:155]
v_mfma_f32_16x16x32_bf16 v[160:163], a[92:95], v[68:71], v[160:163]
buffer_load_dwordx4 a[188:191], v244, s[20:23], s67 offen offset:3072 sc0 sc1
v_mfma_f32_16x16x32_bf16 v[140:143], a[64:67], v[20:23], v[140:143]
ds_read_b64_tr_b16 a[92:93], v217 offset:8
ds_read_b64_tr_b16 a[94:95], v217 offset:4616
v_mfma_f32_16x16x32_bf16 v[148:151], a[64:67], v[36:39], v[148:151]
s_add_u32 s28, s33, 2
s_and_b32 s28, s28, 3
v_mfma_f32_16x16x32_bf16 v[156:159], a[64:67], v[52:55], v[156:159]
s_sub_u32 s28, s28, s33
s_lshl_b32 s28, s28, 16
v_mfma_f32_16x16x32_bf16 v[164:167], a[64:67], v[68:71], v[164:167]
s_add_u32 s64, s28, s44
s_add_u32 s65, s64, 4096
s_waitcnt lgkmcnt(8)
v_mfma_f32_16x16x32_bf16 v[168:171], a[68:71], v[20:23], v[168:171]
ds_read_b64_tr_b16 a[64:65], v216 offset:128
ds_read_b64_tr_b16 a[66:67], v216 offset:4736
v_mfma_f32_16x16x32_bf16 v[176:179], a[68:71], v[36:39], v[176:179]
s_add_u32 s66, s64, 8192
s_add_u32 s67, s64, 12288
v_mfma_f32_16x16x32_bf16 v[184:187], a[68:71], v[52:55], v[184:187]
s_waitcnt vmcnt(7)
v_cmp_gt_u32 vcc, 1, v230
v_mfma_f32_16x16x32_bf16 v[192:195], a[68:71], v[68:71], v[192:195]
v_mfma_f32_16x16x32_bf16 v[172:175], a[72:75], v[20:23], v[172:175]
ds_read_b64_tr_b16 a[68:69], v216 offset:136
ds_read_b64_tr_b16 a[70:71], v216 offset:4744
v_mfma_f32_16x16x32_bf16 v[180:183], a[72:75], v[36:39], v[180:183]
s_and_b32 s29, vcc_lo, 15
s_cbranch_scc1 SP_O2B
SP_O2B_RET:
v_mfma_f32_16x16x32_bf16 v[188:191], a[72:75], v[52:55], v[188:191]
buffer_load_dwordx4 a[192:195], v244, s[20:23], s64 offen offset:0 sc0 sc1
v_mfma_f32_16x16x32_bf16 v[196:199], a[72:75], v[68:71], v[196:199]
v_mfma_f32_16x16x32_bf16 v[200:203], a[76:79], v[20:23], v[200:203]
ds_read_b64_tr_b16 a[72:73], v217 offset:128
ds_read_b64_tr_b16 a[74:75], v217 offset:4736
v_mfma_f32_16x16x32_bf16 v[204:207], a[76:79], v[36:39], v[204:207]
v_mfma_f32_16x16x32_bf16 v[208:211], a[76:79], v[52:55], v[208:211]
buffer_load_dwordx4 a[208:211], v244, s[20:23], s65 offen offset:0 sc0 sc1
v_mfma_f32_16x16x32_bf16 v[212:215], a[76:79], v[68:71], v[212:215]
s_waitcnt vmcnt(15)
s_waitcnt lgkmcnt(8)
v_mfma_f32_16x16x32_bf16 v[72:75], a[80:83], a[128:131], v[72:75]
ds_read_b64_tr_b16 a[76:77], v217 offset:136
ds_read_b64_tr_b16 a[78:79], v217 offset:4744
v_mfma_f32_16x16x32_bf16 v[80:83], a[80:83], a[144:147], v[80:83]
v_mfma_f32_16x16x32_bf16 v[88:91], a[80:83], a[160:163], v[88:91]
buffer_load_dwordx4 a[96:99], v244, s[20:23], s66 offen offset:0 sc0 sc1
v_accvgpr_read_b32 v39, a222
v_mfma_f32_16x16x32_bf16 v[96:99], a[80:83], a[176:179], v[96:99]
v_accvgpr_read_b32 v59, a232
v_lshlrev_b32 v38, 16, v39
v_mfma_f32_16x16x32_bf16 v[76:79], a[84:87], a[128:131], v[76:79]
ds_read_b64_tr_b16 a[80:81], v218 offset:0
ds_read_b64_tr_b16 a[82:83], v218 offset:4608
v_mfma_f32_16x16x32_bf16 v[84:87], a[84:87], a[144:147], v[84:87]
v_and_b32 v39, 0xffff0000, v39
v_lshlrev_b32 v58, 16, v59
v_mfma_f32_16x16x32_bf16 v[92:95], a[84:87], a[160:163], v[92:95]
buffer_load_dwordx4 a[112:115], v244, s[20:23], s67 offen offset:0 sc0 sc1
v_and_b32 v59, 0xffff0000, v59
v_mfma_f32_16x16x32_bf16 v[100:103], a[84:87], a[176:179], v[100:103]
v_add_f32 v38, v38, v58
v_add_f32 v39, v39, v59
v_mfma_f32_16x16x32_bf16 v[104:107], a[88:91], a[128:131], v[104:107]
ds_read_b64_tr_b16 a[84:85], v216 offset:9216
ds_read_b64_tr_b16 a[86:87], v216 offset:13824
v_mfma_f32_16x16x32_bf16 v[112:115], a[88:91], a[144:147], v[112:115]
v_cvt_pk_bf16_f32 v58, v38, v39
v_lshlrev_b32 v38, 16, v58
v_mfma_f32_16x16x32_bf16 v[120:123], a[88:91], a[160:163], v[120:123]
buffer_load_dwordx4 a[196:199], v244, s[20:23], s64 offen offset:1024 sc0 sc1
v_and_b32 v39, 0xffff0000, v58
v_mfma_f32_16x16x32_bf16 v[128:131], a[88:91], a[176:179], v[128:131]
v_mul_f32 v58, 0xbfb8aa3b, v38
v_mul_f32 v59, 0xbfb8aa3b, v39
s_waitcnt lgkmcnt(8)
v_mfma_f32_16x16x32_bf16 v[108:111], a[92:95], a[128:131], v[108:111]
ds_read_b64_tr_b16 a[88:89], v216 offset:9224
ds_read_b64_tr_b16 a[90:91], v216 offset:13832
v_mfma_f32_16x16x32_bf16 v[116:119], a[92:95], a[144:147], v[116:119]
v_exp_f32 v58, v58
v_mfma_f32_16x16x32_bf16 v[124:127], a[92:95], a[160:163], v[124:127]
buffer_load_dwordx4 a[244:247], v244, s[20:23], s65 offen offset:1024 sc0 sc1
v_mfma_f32_16x16x32_bf16 v[132:135], a[92:95], a[176:179], v[132:135]
v_exp_f32 v59, v59
v_mfma_f32_16x16x32_bf16 v[136:139], a[64:67], a[128:131], v[136:139]
ds_read_b64_tr_b16 a[92:93], v217 offset:9216
ds_read_b64_tr_b16 a[94:95], v217 offset:13824
v_mfma_f32_16x16x32_bf16 v[144:147], a[64:67], a[144:147], v[144:147]
v_add_f32 v58, 1.0, v58
v_add_f32 v59, 1.0, v59
v_mfma_f32_16x16x32_bf16 v[152:155], a[64:67], a[160:163], v[152:155]
buffer_load_dwordx4 a[100:103], v244, s[20:23], s66 offen offset:1024 sc0 sc1
v_mfma_f32_16x16x32_bf16 v[160:163], a[64:67], a[176:179], v[160:163]
v_rcp_f32 v58, v58
v_mfma_f32_16x16x32_bf16 v[140:143], a[68:71], a[128:131], v[140:143]
ds_read_b64_tr_b16 a[64:65], v217 offset:9224
ds_read_b64_tr_b16 a[66:67], v217 offset:13832
v_mfma_f32_16x16x32_bf16 v[148:151], a[68:71], a[144:147], v[148:151]
v_rcp_f32 v59, v59
v_mfma_f32_16x16x32_bf16 v[156:159], a[68:71], a[160:163], v[156:159]
buffer_load_dwordx4 a[116:119], v244, s[20:23], s67 offen offset:1024 sc0 sc1
v_mul_f32 v38, v38, v58
v_mfma_f32_16x16x32_bf16 v[164:167], a[68:71], a[176:179], v[164:167]
v_mul_f32 v39, v39, v59
v_cvt_pk_bf16_f32 v58, v38, v39
s_waitcnt lgkmcnt(8)
v_mfma_f32_16x16x32_bf16 v[168:171], a[72:75], a[128:131], v[168:171]
ds_read_b64_tr_b16 a[68:69], v216 offset:9344
ds_read_b64_tr_b16 a[70:71], v216 offset:13952
v_mfma_f32_16x16x32_bf16 v[176:179], a[72:75], a[144:147], v[176:179]
v_lshlrev_b32 v38, 16, v58
v_and_b32 v39, 0xffff0000, v58
v_mfma_f32_16x16x32_bf16 v[184:187], a[72:75], a[160:163], v[184:187]
buffer_load_dwordx4 a[200:203], v244, s[20:23], s64 offen offset:2048 sc0 sc1
v_accvgpr_read_b32 v41, a223
v_mfma_f32_16x16x32_bf16 v[192:195], a[72:75], a[176:179], v[192:195]
v_accvgpr_read_b32 v59, a233
v_lshlrev_b32 v40, 16, v41
v_mfma_f32_16x16x32_bf16 v[172:175], a[76:79], a[128:131], v[172:175]
ds_read_b64_tr_b16 a[72:73], v216 offset:9352
ds_read_b64_tr_b16 a[74:75], v216 offset:13960
v_mfma_f32_16x16x32_bf16 v[180:183], a[76:79], a[144:147], v[180:183]
v_and_b32 v41, 0xffff0000, v41
v_lshlrev_b32 v58, 16, v59
v_mfma_f32_16x16x32_bf16 v[188:191], a[76:79], a[160:163], v[188:191]
buffer_load_dwordx4 a[248:251], v244, s[20:23], s65 offen offset:2048 sc0 sc1
v_and_b32 v59, 0xffff0000, v59
v_mfma_f32_16x16x32_bf16 v[196:199], a[76:79], a[176:179], v[196:199]
v_add_f32 v40, v40, v58
v_add_f32 v41, v41, v59
v_mfma_f32_16x16x32_bf16 v[200:203], a[80:83], a[128:131], v[200:203]
ds_read_b64_tr_b16 a[76:77], v217 offset:9344
ds_read_b64_tr_b16 a[78:79], v217 offset:13952
v_mfma_f32_16x16x32_bf16 v[204:207], a[80:83], a[144:147], v[204:207]
v_cvt_pk_bf16_f32 v58, v40, v41
v_lshlrev_b32 v40, 16, v58
v_mfma_f32_16x16x32_bf16 v[208:211], a[80:83], a[160:163], v[208:211]
buffer_load_dwordx4 a[104:107], v244, s[20:23], s66 offen offset:2048 sc0 sc1
v_and_b32 v41, 0xffff0000, v58
v_mfma_f32_16x16x32_bf16 v[212:215], a[80:83], a[176:179], v[212:215]
v_mul_f32 v58, 0xbfb8aa3b, v40
v_mul_f32 v59, 0xbfb8aa3b, v41
s_waitcnt vmcnt(20)
s_waitcnt lgkmcnt(8)
v_mfma_f32_16x16x32_bf16 v[72:75], a[84:87], a[132:135], v[72:75]
ds_read_b64_tr_b16 a[80:81], v217 offset:9352
ds_read_b64_tr_b16 a[82:83], v217 offset:13960
v_mfma_f32_16x16x32_bf16 v[80:83], a[84:87], a[148:151], v[80:83]
v_exp_f32 v58, v58
v_mfma_f32_16x16x32_bf16 v[88:91], a[84:87], a[164:167], v[88:91]
buffer_load_dwordx4 a[120:123], v244, s[20:23], s67 offen offset:2048 sc0 sc1
v_mfma_f32_16x16x32_bf16 v[96:99], a[84:87], a[180:183], v[96:99]
v_exp_f32 v59, v59
v_mfma_f32_16x16x32_bf16 v[76:79], a[88:91], a[132:135], v[76:79]
ds_read_b64_tr_b16 a[84:85], v218 offset:9216
ds_read_b64_tr_b16 a[86:87], v218 offset:13824
v_mfma_f32_16x16x32_bf16 v[84:87], a[88:91], a[148:151], v[84:87]
v_add_f32 v58, 1.0, v58
v_add_f32 v59, 1.0, v59
v_mfma_f32_16x16x32_bf16 v[92:95], a[88:91], a[164:167], v[92:95]
buffer_load_dwordx4 a[204:207], v244, s[20:23], s64 offen offset:3072 sc0 sc1
v_mfma_f32_16x16x32_bf16 v[100:103], a[88:91], a[180:183], v[100:103]
v_rcp_f32 v58, v58
v_mfma_f32_16x16x32_bf16 v[104:107], a[92:95], a[132:135], v[104:107]
ds_read_b64_tr_b16 a[88:89], v216 offset:18432
ds_read_b64_tr_b16 a[90:91], v216 offset:23040
v_mfma_f32_16x16x32_bf16 v[112:115], a[92:95], a[148:151], v[112:115]
v_rcp_f32 v59, v59
v_mfma_f32_16x16x32_bf16 v[120:123], a[92:95], a[164:167], v[120:123]
buffer_load_dwordx4 a[252:255], v244, s[20:23], s65 offen offset:3072 sc0 sc1
v_mul_f32 v40, v40, v58
v_mfma_f32_16x16x32_bf16 v[128:131], a[92:95], a[180:183], v[128:131]
v_mul_f32 v41, v41, v59
v_cvt_pk_bf16_f32 v58, v40, v41
s_waitcnt lgkmcnt(8)
v_mfma_f32_16x16x32_bf16 v[108:111], a[64:67], a[132:135], v[108:111]
ds_read_b64_tr_b16 a[92:93], v216 offset:18440
ds_read_b64_tr_b16 a[94:95], v216 offset:23048
v_mfma_f32_16x16x32_bf16 v[116:119], a[64:67], a[148:151], v[116:119]
v_lshlrev_b32 v40, 16, v58
v_and_b32 v41, 0xffff0000, v58
v_mfma_f32_16x16x32_bf16 v[124:127], a[64:67], a[164:167], v[124:127]
buffer_load_dwordx4 a[108:111], v244, s[20:23], s66 offen offset:3072 sc0 sc1
v_accvgpr_read_b32 v43, a224
v_mfma_f32_16x16x32_bf16 v[132:135], a[64:67], a[180:183], v[132:135]
v_accvgpr_read_b32 v59, a234
v_lshlrev_b32 v42, 16, v43
v_mfma_f32_16x16x32_bf16 v[136:139], a[68:71], a[132:135], v[136:139]
ds_read_b64_tr_b16 a[64:65], v217 offset:18432
ds_read_b64_tr_b16 a[66:67], v217 offset:23040
v_mfma_f32_16x16x32_bf16 v[144:147], a[68:71], a[148:151], v[144:147]
v_and_b32 v43, 0xffff0000, v43
v_lshlrev_b32 v58, 16, v59
v_mfma_f32_16x16x32_bf16 v[152:155], a[68:71], a[164:167], v[152:155]
buffer_load_dwordx4 a[124:127], v244, s[20:23], s67 offen offset:3072 sc0 sc1
v_and_b32 v59, 0xffff0000, v59
v_mfma_f32_16x16x32_bf16 v[160:163], a[68:71], a[180:183], v[160:163]
s_add_u32 s28, s33, 3
s_and_b32 s28, s28, 3
v_mfma_f32_16x16x32_bf16 v[140:143], a[72:75], a[132:135], v[140:143]
ds_read_b64_tr_b16 a[68:69], v217 offset:18440
ds_read_b64_tr_b16 a[70:71], v217 offset:23048
v_mfma_f32_16x16x32_bf16 v[148:151], a[72:75], a[148:151], v[148:151]
s_sub_u32 s28, s28, s33
s_lshl_b32 s28, s28, 16
v_mfma_f32_16x16x32_bf16 v[156:159], a[72:75], a[164:167], v[156:159]
s_add_u32 s64, s28, s44
s_add_u32 s65, s64, 4096
v_mfma_f32_16x16x32_bf16 v[164:167], a[72:75], a[180:183], v[164:167]
s_add_u32 s66, s64, 8192
s_add_u32 s67, s64, 12288
s_waitcnt lgkmcnt(8)
v_mfma_f32_16x16x32_bf16 v[168:171], a[76:79], a[132:135], v[168:171]
ds_read_b64_tr_b16 a[72:73], v216 offset:18560
ds_read_b64_tr_b16 a[74:75], v216 offset:23168
v_mfma_f32_16x16x32_bf16 v[176:179], a[76:79], a[148:151], v[176:179]
buffer_load_dwordx4 a[0:3], v244, s[20:23], s64 offen offset:0 sc0 sc1
v_add_f32 v42, v42, v58
v_mfma_f32_16x16x32_bf16 v[184:187], a[76:79], a[164:167], v[184:187]
v_add_f32 v43, v43, v59
v_cvt_pk_bf16_f32 v58, v42, v43
v_mfma_f32_16x16x32_bf16 v[192:195], a[76:79], a[180:183], v[192:195]
v_lshlrev_b32 v42, 16, v58
v_and_b32 v43, 0xffff0000, v58
v_mfma_f32_16x16x32_bf16 v[172:175], a[80:83], a[132:135], v[172:175]
ds_read_b64_tr_b16 a[76:77], v216 offset:18568
ds_read_b64_tr_b16 a[78:79], v216 offset:23176
v_mfma_f32_16x16x32_bf16 v[180:183], a[80:83], a[148:151], v[180:183]
buffer_load_dwordx4 a[16:19], v244, s[20:23], s65 offen offset:0 sc0 sc1
v_mul_f32 v58, 0xbfb8aa3b, v42
v_mfma_f32_16x16x32_bf16 v[188:191], a[80:83], a[164:167], v[188:191]
v_mul_f32 v59, 0xbfb8aa3b, v43
v_mfma_f32_16x16x32_bf16 v[196:199], a[80:83], a[180:183], v[196:199]
v_exp_f32 v58, v58
v_mfma_f32_16x16x32_bf16 v[200:203], a[84:87], a[132:135], v[200:203]
ds_read_b64_tr_b16 a[80:81], v217 offset:18560
ds_read_b64_tr_b16 a[82:83], v217 offset:23168
v_mfma_f32_16x16x32_bf16 v[204:207], a[84:87], a[148:151], v[204:207]
buffer_load_dwordx4 a[32:35], v244, s[20:23], s66 offen offset:0 sc0 sc1
v_mfma_f32_16x16x32_bf16 v[208:211], a[84:87], a[164:167], v[208:211]
v_exp_f32 v59, v59
v_mfma_f32_16x16x32_bf16 v[212:215], a[84:87], a[180:183], v[212:215]
v_add_f32 v58, 1.0, v58
v_add_f32 v59, 1.0, v59
s_waitcnt vmcnt(23)
s_waitcnt lgkmcnt(8)
v_mfma_f32_16x16x32_bf16 v[72:75], a[88:91], a[136:139], v[72:75]
ds_read_b64_tr_b16 a[84:85], v217 offset:18568
ds_read_b64_tr_b16 a[86:87], v217 offset:23176
v_mfma_f32_16x16x32_bf16 v[80:83], a[88:91], a[152:155], v[80:83]
buffer_load_dwordx4 a[48:51], v244, s[20:23], s67 offen offset:0 sc0 sc1
v_mfma_f32_16x16x32_bf16 v[88:91], a[88:91], a[168:171], v[88:91]
v_rcp_f32 v58, v58
v_mfma_f32_16x16x32_bf16 v[96:99], a[88:91], a[184:187], v[96:99]
v_rcp_f32 v59, v59
v_mfma_f32_16x16x32_bf16 v[76:79], a[92:95], a[136:139], v[76:79]
ds_read_b64_tr_b16 a[88:89], v218 offset:18432
ds_read_b64_tr_b16 a[90:91], v218 offset:23040
v_mfma_f32_16x16x32_bf16 v[84:87], a[92:95], a[152:155], v[84:87]
buffer_load_dwordx4 a[4:7], v244, s[20:23], s64 offen offset:1024 sc0 sc1
v_mul_f32 v42, v42, v58
v_mfma_f32_16x16x32_bf16 v[92:95], a[92:95], a[168:171], v[92:95]
v_mul_f32 v43, v43, v59
v_cvt_pk_bf16_f32 v58, v42, v43
v_mfma_f32_16x16x32_bf16 v[100:103], a[92:95], a[184:187], v[100:103]
v_lshlrev_b32 v42, 16, v58
v_and_b32 v43, 0xffff0000, v58
v_mfma_f32_16x16x32_bf16 v[104:107], a[64:67], a[136:139], v[104:107]
ds_read_b64_tr_b16 a[92:93], v216 offset:27648
ds_read_b64_tr_b16 a[94:95], v216 offset:32256
v_mfma_f32_16x16x32_bf16 v[112:115], a[64:67], a[152:155], v[112:115]
buffer_load_dwordx4 a[20:23], v244, s[20:23], s65 offen offset:1024 sc0 sc1
v_accvgpr_read_b32 v45, a225
v_mfma_f32_16x16x32_bf16 v[120:123], a[64:67], a[168:171], v[120:123]
v_accvgpr_read_b32 v59, a235
v_lshlrev_b32 v44, 16, v45
v_mfma_f32_16x16x32_bf16 v[128:131], a[64:67], a[184:187], v[128:131]
v_and_b32 v45, 0xffff0000, v45
v_lshlrev_b32 v58, 16, v59
s_waitcnt lgkmcnt(8)
v_mfma_f32_16x16x32_bf16 v[108:111], a[68:71], a[136:139], v[108:111]
ds_read_b64_tr_b16 a[64:65], v216 offset:27656
ds_read_b64_tr_b16 a[66:67], v216 offset:32264
v_mfma_f32_16x16x32_bf16 v[116:119], a[68:71], a[152:155], v[116:119]
buffer_load_dwordx4 a[36:39], v244, s[20:23], s66 offen offset:1024 sc0 sc1
v_and_b32 v59, 0xffff0000, v59
v_mfma_f32_16x16x32_bf16 v[124:127], a[68:71], a[168:171], v[124:127]
v_add_f32 v44, v44, v58
v_add_f32 v45, v45, v59
v_mfma_f32_16x16x32_bf16 v[132:135], a[68:71], a[184:187], v[132:135]
v_cvt_pk_bf16_f32 v58, v44, v45
v_lshlrev_b32 v44, 16, v58
v_mfma_f32_16x16x32_bf16 v[136:139], a[72:75], a[136:139], v[136:139]
ds_read_b64_tr_b16 a[68:69], v217 offset:27648
ds_read_b64_tr_b16 a[70:71], v217 offset:32256
v_mfma_f32_16x16x32_bf16 v[144:147], a[72:75], a[152:155], v[144:147]
buffer_load_dwordx4 a[52:55], v244, s[20:23], s67 offen offset:1024 sc0 sc1
v_and_b32 v45, 0xffff0000, v58
v_mfma_f32_16x16x32_bf16 v[152:155], a[72:75], a[168:171], v[152:155]
v_mul_f32 v58, 0xbfb8aa3b, v44
v_mul_f32 v59, 0xbfb8aa3b, v45
v_mfma_f32_16x16x32_bf16 v[160:163], a[72:75], a[184:187], v[160:163]
v_exp_f32 v58, v58
v_mfma_f32_16x16x32_bf16 v[140:143], a[76:79], a[136:139], v[140:143]
ds_read_b64_tr_b16 a[72:73], v217 offset:27656
ds_read_b64_tr_b16 a[74:75], v217 offset:32264
v_mfma_f32_16x16x32_bf16 v[148:151], a[76:79], a[152:155], v[148:151]
buffer_load_dwordx4 a[8:11], v244, s[20:23], s64 offen offset:2048 sc0 sc1
v_mfma_f32_16x16x32_bf16 v[156:159], a[76:79], a[168:171], v[156:159]
v_exp_f32 v59, v59
v_mfma_f32_16x16x32_bf16 v[164:167], a[76:79], a[184:187], v[164:167]
v_add_f32 v58, 1.0, v58
v_add_f32 v59, 1.0, v59
s_waitcnt lgkmcnt(8)
v_mfma_f32_16x16x32_bf16 v[168:171], a[80:83], a[136:139], v[168:171]
ds_read_b64_tr_b16 a[76:77], v216 offset:27776
ds_read_b64_tr_b16 a[78:79], v216 offset:32384
v_mfma_f32_16x16x32_bf16 v[176:179], a[80:83], a[152:155], v[176:179]
buffer_load_dwordx4 a[24:27], v244, s[20:23], s65 offen offset:2048 sc0 sc1
v_mfma_f32_16x16x32_bf16 v[184:187], a[80:83], a[168:171], v[184:187]
v_rcp_f32 v58, v58
v_mfma_f32_16x16x32_bf16 v[192:195], a[80:83], a[184:187], v[192:195]
v_rcp_f32 v59, v59
v_mfma_f32_16x16x32_bf16 v[172:175], a[84:87], a[136:139], v[172:175]
ds_read_b64_tr_b16 a[80:81], v216 offset:27784
ds_read_b64_tr_b16 a[82:83], v216 offset:32392
v_mfma_f32_16x16x32_bf16 v[180:183], a[84:87], a[152:155], v[180:183]
buffer_load_dwordx4 a[40:43], v244, s[20:23], s66 offen offset:2048 sc0 sc1
v_mul_f32 v44, v44, v58
v_mfma_f32_16x16x32_bf16 v[188:191], a[84:87], a[168:171], v[188:191]
v_mul_f32 v45, v45, v59
v_cvt_pk_bf16_f32 v58, v44, v45
v_mfma_f32_16x16x32_bf16 v[196:199], a[84:87], a[184:187], v[196:199]
v_lshlrev_b32 v44, 16, v58
v_and_b32 v45, 0xffff0000, v58
v_mfma_f32_16x16x32_bf16 v[200:203], a[88:91], a[136:139], v[200:203]
ds_read_b64_tr_b16 a[84:85], v217 offset:27776
ds_read_b64_tr_b16 a[86:87], v217 offset:32384
v_mfma_f32_16x16x32_bf16 v[204:207], a[88:91], a[152:155], v[204:207]
buffer_load_dwordx4 a[56:59], v244, s[20:23], s67 offen offset:2048 sc0 sc1
v_accvgpr_read_b32 v47, a226
v_mfma_f32_16x16x32_bf16 v[208:211], a[88:91], a[168:171], v[208:211]
v_accvgpr_read_b32 v59, a236
v_lshlrev_b32 v46, 16, v47
v_mfma_f32_16x16x32_bf16 v[212:215], a[88:91], a[184:187], v[212:215]
v_and_b32 v47, 0xffff0000, v47
v_lshlrev_b32 v58, 16, v59
s_waitcnt vmcnt(28)
s_waitcnt lgkmcnt(8)
v_mfma_f32_16x16x32_bf16 v[72:75], a[92:95], a[140:143], v[72:75]
ds_read_b64_tr_b16 a[88:89], v217 offset:27784
ds_read_b64_tr_b16 a[90:91], v217 offset:32392
v_mfma_f32_16x16x32_bf16 v[80:83], a[92:95], a[156:159], v[80:83]
buffer_load_dwordx4 a[12:15], v244, s[20:23], s64 offen offset:3072 sc0 sc1
v_and_b32 v59, 0xffff0000, v59
v_mfma_f32_16x16x32_bf16 v[88:91], a[92:95], a[172:175], v[88:91]
v_add_f32 v46, v46, v58
v_add_f32 v47, v47, v59
v_mfma_f32_16x16x32_bf16 v[96:99], a[92:95], a[188:191], v[96:99]
v_cvt_pk_bf16_f32 v58, v46, v47
v_lshlrev_b32 v46, 16, v58
v_mfma_f32_16x16x32_bf16 v[76:79], a[64:67], a[140:143], v[76:79]
ds_read_b64_tr_b16 a[92:93], v218 offset:27648
ds_read_b64_tr_b16 a[94:95], v218 offset:32256
v_mfma_f32_16x16x32_bf16 v[84:87], a[64:67], a[156:159], v[84:87]
buffer_load_dwordx4 a[28:31], v244, s[20:23], s65 offen offset:3072 sc0 sc1
v_and_b32 v47, 0xffff0000, v58
v_mfma_f32_16x16x32_bf16 v[92:95], a[64:67], a[172:175], v[92:95]
v_mul_f32 v58, 0xbfb8aa3b, v46
v_mul_f32 v59, 0xbfb8aa3b, v47
v_mfma_f32_16x16x32_bf16 v[100:103], a[64:67], a[188:191], v[100:103]
v_exp_f32 v58, v58
v_mfma_f32_16x16x32_bf16 v[104:107], a[68:71], a[140:143], v[104:107]
ds_read_b64_tr_b16 a[64:65], v221 offset:0
ds_read_b64_tr_b16 a[66:67], v221 offset:4608
v_mfma_f32_16x16x32_bf16 v[112:115], a[68:71], a[156:159], v[112:115]
buffer_load_dwordx4 a[44:47], v244, s[20:23], s66 offen offset:3072 sc0 sc1
v_mfma_f32_16x16x32_bf16 v[120:123], a[68:71], a[172:175], v[120:123]
v_exp_f32 v59, v59
v_mfma_f32_16x16x32_bf16 v[128:131], a[68:71], a[188:191], v[128:131]
v_add_f32 v58, 1.0, v58
v_add_f32 v59, 1.0, v59
s_waitcnt lgkmcnt(8)
v_mfma_f32_16x16x32_bf16 v[108:111], a[72:75], a[140:143], v[108:111]
ds_read_b64_tr_b16 a[68:69], v221 offset:9216
ds_read_b64_tr_b16 a[70:71], v221 offset:13824
v_mfma_f32_16x16x32_bf16 v[116:119], a[72:75], a[156:159], v[116:119]
buffer_load_dwordx4 a[60:63], v244, s[20:23], s67 offen offset:3072 sc0 sc1
v_mfma_f32_16x16x32_bf16 v[124:127], a[72:75], a[172:175], v[124:127]
s_lshl2_add_u32 s28, s36, s33
s_lshl2_add_u32 s28, s28, s37
v_mfma_f32_16x16x32_bf16 v[132:135], a[72:75], a[188:191], v[132:135]
s_lshl_b32 s95, s28, 5
s_add_u32 s95, s95, 0x24a000
v_mfma_f32_16x16x32_bf16 v[136:139], a[76:79], a[140:143], v[136:139]
ds_read_b64_tr_b16 a[72:73], v221 offset:18432
ds_read_b64_tr_b16 a[74:75], v221 offset:23040
v_mfma_f32_16x16x32_bf16 v[144:147], a[76:79], a[156:159], v[144:147]
s_lshl_b32 s28, s32, 18
s_sub_u32 s49, s44, s28
v_mfma_f32_16x16x32_bf16 v[152:155], a[76:79], a[172:175], v[152:155]
v_add_u32 v243, 0x2000, v244
v_mov_b32 v246, 2
v_mfma_f32_16x16x32_bf16 v[160:163], a[76:79], a[188:191], v[160:163]
s_lshl2_add_u32 s29, s33, s94
v_mfma_f32_16x16x32_bf16 v[140:143], a[80:83], a[140:143], v[140:143]
ds_read_b64_tr_b16 a[76:77], v221 offset:27648
ds_read_b64_tr_b16 a[78:79], v221 offset:32256
v_mfma_f32_16x16x32_bf16 v[148:151], a[80:83], a[156:159], v[148:151]
v_rcp_f32 v58, v58
v_mfma_f32_16x16x32_bf16 v[156:159], a[80:83], a[172:175], v[156:159]
v_rcp_f32 v59, v59
v_mfma_f32_16x16x32_bf16 v[164:167], a[80:83], a[188:191], v[164:167]
v_mul_f32 v46, v46, v58
v_mul_f32 v47, v47, v59
s_waitcnt lgkmcnt(8)
v_mfma_f32_16x16x32_bf16 v[168:171], a[84:87], a[140:143], v[168:171]
ds_read_b64_tr_b16 a[80:81], v224 offset:0
ds_read_b64_tr_b16 a[82:83], v224 offset:4608
v_mfma_f32_16x16x32_bf16 v[176:179], a[84:87], a[156:159], v[176:179]
v_cvt_pk_bf16_f32 v58, v46, v47
v_lshlrev_b32 v46, 16, v58
v_mfma_f32_16x16x32_bf16 v[184:187], a[84:87], a[172:175], v[184:187]
v_and_b32 v47, 0xffff0000, v58
v_accvgpr_read_b32 v49, a227
v_mfma_f32_16x16x32_bf16 v[192:195], a[84:87], a[188:191], v[192:195]
v_accvgpr_read_b32 v59, a237
v_lshlrev_b32 v48, 16, v49
v_mfma_f32_16x16x32_bf16 v[172:175], a[88:91], a[140:143], v[172:175]
ds_read_b64_tr_b16 a[84:85], v224 offset:9216
ds_read_b64_tr_b16 a[86:87], v224 offset:13824
v_mfma_f32_16x16x32_bf16 v[180:183], a[88:91], a[156:159], v[180:183]
v_and_b32 v49, 0xffff0000, v49
v_lshlrev_b32 v58, 16, v59
v_mfma_f32_16x16x32_bf16 v[188:191], a[88:91], a[172:175], v[188:191]
v_and_b32 v59, 0xffff0000, v59
v_add_f32 v48, v48, v58
v_mfma_f32_16x16x32_bf16 v[196:199], a[88:91], a[188:191], v[196:199]
v_add_f32 v49, v49, v59
v_cvt_pk_bf16_f32 v58, v48, v49
v_mfma_f32_16x16x32_bf16 v[200:203], a[92:95], a[140:143], v[200:203]
ds_read_b64_tr_b16 a[88:89], v224 offset:18432
ds_read_b64_tr_b16 a[90:91], v224 offset:23040
v_mfma_f32_16x16x32_bf16 v[204:207], a[92:95], a[156:159], v[204:207]
v_lshlrev_b32 v48, 16, v58
v_and_b32 v49, 0xffff0000, v58
v_mfma_f32_16x16x32_bf16 v[208:211], a[92:95], a[172:175], v[208:211]
v_mul_f32 v58, 0xbfb8aa3b, v48
v_mul_f32 v59, 0xbfb8aa3b, v49
v_mfma_f32_16x16x32_bf16 v[212:215], a[92:95], a[188:191], v[212:215]
v_exp_f32 v58, v58
s_waitcnt vmcnt(28)
s_waitcnt lgkmcnt(8)
v_mfma_f32_16x16x32_bf16 v[200:203], a[64:67], a[192:195], v[200:203]
ds_read_b64_tr_b16 a[92:93], v224 offset:27648
ds_read_b64_tr_b16 a[94:95], v224 offset:32256
v_mfma_f32_16x16x32_bf16 v[204:207], a[64:67], a[208:211], v[204:207]
v_exp_f32 v59, v59
v_mfma_f32_16x16x32_bf16 v[208:211], a[64:67], a[96:99], v[208:211]
v_add_f32 v58, 1.0, v58
v_add_f32 v59, 1.0, v59
v_mfma_f32_16x16x32_bf16 v[212:215], a[64:67], a[112:115], v[212:215]
v_rcp_f32 v58, v58
s_waitcnt vmcnt(24)
v_mfma_f32_16x16x32_bf16 v[200:203], a[68:71], a[196:199], v[200:203]
ds_read_b64_tr_b16 a[64:65], v219 offset:0
ds_read_b64_tr_b16 a[66:67], v219 offset:4608
v_mfma_f32_16x16x32_bf16 v[204:207], a[68:71], a[244:247], v[204:207]
v_rcp_f32 v59, v59
v_mfma_f32_16x16x32_bf16 v[208:211], a[68:71], a[100:103], v[208:211]
v_mul_f32 v48, v48, v58
v_mul_f32 v49, v49, v59
v_mfma_f32_16x16x32_bf16 v[212:215], a[68:71], a[116:119], v[212:215]
s_waitcnt vmcnt(0)
buffer_store_dword v246, v254, s[20:23], s29 offen sc0 sc1
s_waitcnt vmcnt(21)
v_mfma_f32_16x16x32_bf16 v[200:203], a[72:75], a[200:203], v[200:203]
ds_read_b64_tr_b16 a[68:69], v219 offset:9216
ds_read_b64_tr_b16 a[70:71], v219 offset:13824
v_mfma_f32_16x16x32_bf16 v[204:207], a[72:75], a[248:251], v[204:207]
s_add_u32 s28, s32, 0
s_and_b32 s28, s28, 7
v_mfma_f32_16x16x32_bf16 v[208:211], a[72:75], a[104:107], v[208:211]
s_xor_b32 s29, s28, s32
s_lshl_b32 s28, s28, 18
v_mfma_f32_16x16x32_bf16 v[212:215], a[72:75], a[120:123], v[212:215]
s_add_u32 s28, s28, s49
s_and_b32 s29, s29, 4
s_waitcnt vmcnt(17)
s_waitcnt lgkmcnt(8)
v_mfma_f32_16x16x32_bf16 v[200:203], a[76:79], a[204:207], v[200:203]
ds_read_b64_tr_b16 a[72:73], v219 offset:18432
ds_read_b64_tr_b16 a[74:75], v219 offset:23040
v_mfma_f32_16x16x32_bf16 v[204:207], a[76:79], a[252:255], v[204:207]
s_add_u32 s72, s28, 0
s_lshl_b32 s29, s29, 10
v_mfma_f32_16x16x32_bf16 v[208:211], a[76:79], a[108:111], v[208:211]
s_add_u32 s28, s32, 1
s_and_b32 s28, s28, 7
v_mfma_f32_16x16x32_bf16 v[212:215], a[76:79], a[124:127], v[212:215]
s_xor_b32 s29, s28, s32
s_lshl_b32 s28, s28, 18
s_waitcnt vmcnt(13)
v_mfma_f32_16x16x32_bf16 v[200:203], a[80:83], a[0:3], v[200:203]
ds_read_b64_tr_b16 a[76:77], v219 offset:27648
ds_read_b64_tr_b16 a[78:79], v219 offset:32256
v_mfma_f32_16x16x32_bf16 v[204:207], a[80:83], a[16:19], v[204:207]
s_add_u32 s28, s28, s49
s_and_b32 s29, s29, 4
v_mfma_f32_16x16x32_bf16 v[208:211], a[80:83], a[32:35], v[208:211]
s_add_u32 s73, s28, 8192
s_lshl_b32 s29, s29, 10
v_mfma_f32_16x16x32_bf16 v[212:215], a[80:83], a[48:51], v[212:215]
s_add_u32 s65, s28, s29
v_cvt_pk_bf16_f32 v58, v48, v49
s_waitcnt vmcnt(9)
v_mfma_f32_16x16x32_bf16 v[200:203], a[84:87], a[4:7], v[200:203]
ds_read_b64_tr_b16 a[80:81], v222 offset:0
ds_read_b64_tr_b16 a[82:83], v222 offset:4608
v_mfma_f32_16x16x32_bf16 v[204:207], a[84:87], a[20:23], v[204:207]
s_add_u32 s28, s32, 2
s_and_b32 s28, s28, 7
v_mfma_f32_16x16x32_bf16 v[208:211], a[84:87], a[36:39], v[208:211]
s_xor_b32 s29, s28, s32
s_lshl_b32 s28, s28, 18
v_mfma_f32_16x16x32_bf16 v[212:215], a[84:87], a[52:55], v[212:215]
s_add_u32 s28, s28, s49
s_and_b32 s29, s29, 4
s_waitcnt vmcnt(5)
s_waitcnt lgkmcnt(8)
v_mfma_f32_16x16x32_bf16 v[200:203], a[88:91], a[8:11], v[200:203]
ds_read_b64_tr_b16 a[84:85], v222 offset:9216
ds_read_b64_tr_b16 a[86:87], v222 offset:13824
v_mfma_f32_16x16x32_bf16 v[204:207], a[88:91], a[24:27], v[204:207]
s_add_u32 s74, s28, 8192
s_lshl_b32 s29, s29, 10
v_mfma_f32_16x16x32_bf16 v[208:211], a[88:91], a[40:43], v[208:211]
s_add_u32 s66, s28, s29
v_lshlrev_b32 v48, 16, v58
v_mfma_f32_16x16x32_bf16 v[212:215], a[88:91], a[56:59], v[212:215]
s_add_u32 s28, s32, 3
s_and_b32 s28, s28, 7
s_waitcnt vmcnt(1)
v_mfma_f32_16x16x32_bf16 v[200:203], a[92:95], a[12:15], v[200:203]
ds_read_b64_tr_b16 a[88:89], v222 offset:18432
ds_read_b64_tr_b16 a[90:91], v222 offset:23040
v_mfma_f32_16x16x32_bf16 v[204:207], a[92:95], a[28:31], v[204:207]
s_xor_b32 s29, s28, s32
s_lshl_b32 s28, s28, 18
v_mfma_f32_16x16x32_bf16 v[208:211], a[92:95], a[44:47], v[208:211]
s_add_u32 s28, s28, s49
s_and_b32 s29, s29, 4
v_mfma_f32_16x16x32_bf16 v[212:215], a[92:95], a[60:63], v[212:215]
s_add_u32 s75, s28, 0
s_lshl_b32 s29, s29, 10
v_mfma_f32_16x16x32_bf16 v[72:75], a[64:67], a[192:195], v[72:75]
ds_read_b64_tr_b16 a[92:93], v222 offset:27648
ds_read_b64_tr_b16 a[94:95], v222 offset:32256
v_mfma_f32_16x16x32_bf16 v[80:83], a[64:67], a[208:211], v[80:83]
s_add_u32 s67, s28, s29
v_and_b32 v49, 0xffff0000, v58
v_mfma_f32_16x16x32_bf16 v[88:91], a[64:67], a[96:99], v[88:91]
buffer_load_dword v230, v229, s[20:23], s94 offen sc0 sc1
v_accvgpr_read_b32 v51, a228
v_mfma_f32_16x16x32_bf16 v[96:99], a[64:67], a[112:115], v[96:99]
s_add_u32 s28, s32, 4
s_and_b32 s28, s28, 7
s_waitcnt lgkmcnt(8)
v_mfma_f32_16x16x32_bf16 v[72:75], a[68:71], a[196:199], v[72:75]
ds_read_b64_tr_b16 a[64:65], v219 offset:8
ds_read_b64_tr_b16 a[66:67], v219 offset:4616
v_mfma_f32_16x16x32_bf16 v[80:83], a[68:71], a[244:247], v[80:83]
s_xor_b32 s29, s28, s32
s_lshl_b32 s28, s28, 18
v_mfma_f32_16x16x32_bf16 v[88:91], a[68:71], a[100:103], v[88:91]
s_add_u32 s28, s28, s49
s_and_b32 s29, s29, 4
v_mfma_f32_16x16x32_bf16 v[96:99], a[68:71], a[116:119], v[96:99]
s_add_u32 s84, s28, 0
s_lshl_b32 s29, s29, 10
v_mfma_f32_16x16x32_bf16 v[72:75], a[72:75], a[200:203], v[72:75]
ds_read_b64_tr_b16 a[68:69], v219 offset:9224
ds_read_b64_tr_b16 a[70:71], v219 offset:13832
v_mfma_f32_16x16x32_bf16 v[80:83], a[72:75], a[248:251], v[80:83]
s_add_u32 s68, s28, s29
v_accvgpr_read_b32 v59, a238
v_mfma_f32_16x16x32_bf16 v[88:91], a[72:75], a[104:107], v[88:91]
s_add_u32 s28, s32, 5
s_and_b32 s28, s28, 7
v_mfma_f32_16x16x32_bf16 v[96:99], a[72:75], a[120:123], v[96:99]
s_xor_b32 s29, s28, s32
s_lshl_b32 s28, s28, 18
v_mfma_f32_16x16x32_bf16 v[72:75], a[76:79], a[204:207], v[72:75]
ds_read_b64_tr_b16 a[72:73], v219 offset:18440
ds_read_b64_tr_b16 a[74:75], v219 offset:23048
v_mfma_f32_16x16x32_bf16 v[80:83], a[76:79], a[252:255], v[80:83]
s_add_u32 s28, s28, s49
s_and_b32 s29, s29, 4
v_mfma_f32_16x16x32_bf16 v[88:91], a[76:79], a[108:111], v[88:91]
s_add_u32 s85, s28, 8192
s_lshl_b32 s29, s29, 10
v_mfma_f32_16x16x32_bf16 v[96:99], a[76:79], a[124:127], v[96:99]
s_add_u32 s69, s28, s29
v_lshlrev_b32 v50, 16, v51
s_waitcnt lgkmcnt(8)
v_mfma_f32_16x16x32_bf16 v[72:75], a[80:83], a[0:3], v[72:75]
ds_read_b64_tr_b16 a[76:77], v219 offset:27656
ds_read_b64_tr_b16 a[78:79], v219 offset:32264
v_mfma_f32_16x16x32_bf16 v[80:83], a[80:83], a[16:19], v[80:83]
s_add_u32 s28, s32, 6
s_and_b32 s28, s28, 7
v_mfma_f32_16x16x32_bf16 v[88:91], a[80:83], a[32:35], v[88:91]
s_xor_b32 s29, s28, s32
s_lshl_b32 s28, s28, 18
v_mfma_f32_16x16x32_bf16 v[96:99], a[80:83], a[48:51], v[96:99]
s_add_u32 s28, s28, s49
s_and_b32 s29, s29, 4
v_mfma_f32_16x16x32_bf16 v[72:75], a[84:87], a[4:7], v[72:75]
ds_read_b64_tr_b16 a[80:81], v222 offset:8
ds_read_b64_tr_b16 a[82:83], v222 offset:4616
v_mfma_f32_16x16x32_bf16 v[80:83], a[84:87], a[20:23], v[80:83]
s_add_u32 s86, s28, 8192
s_lshl_b32 s29, s29, 10
v_mfma_f32_16x16x32_bf16 v[88:91], a[84:87], a[36:39], v[88:91]
s_add_u32 s70, s28, s29
v_and_b32 v51, 0xffff0000, v51
v_mfma_f32_16x16x32_bf16 v[96:99], a[84:87], a[52:55], v[96:99]
s_add_u32 s28, s32, 7
s_and_b32 s28, s28, 7
v_mfma_f32_16x16x32_bf16 v[72:75], a[88:91], a[8:11], v[72:75]
ds_read_b64_tr_b16 a[84:85], v222 offset:9224
ds_read_b64_tr_b16 a[86:87], v222 offset:13832
v_mfma_f32_16x16x32_bf16 v[80:83], a[88:91], a[24:27], v[80:83]
s_xor_b32 s29, s28, s32
s_lshl_b32 s28, s28, 18
v_mfma_f32_16x16x32_bf16 v[88:91], a[88:91], a[40:43], v[88:91]
s_add_u32 s28, s28, s49
s_and_b32 s29, s29, 4
v_mfma_f32_16x16x32_bf16 v[96:99], a[88:91], a[56:59], v[96:99]
s_add_u32 s87, s28, 0
s_lshl_b32 s29, s29, 10
s_waitcnt lgkmcnt(8)
v_mfma_f32_16x16x32_bf16 v[72:75], a[92:95], a[12:15], v[72:75]
ds_read_b64_tr_b16 a[88:89], v222 offset:18440
ds_read_b64_tr_b16 a[90:91], v222 offset:23048
v_mfma_f32_16x16x32_bf16 v[80:83], a[92:95], a[28:31], v[80:83]
s_add_u32 s71, s28, s29
v_lshlrev_b32 v58, 16, v59
v_mfma_f32_16x16x32_bf16 v[88:91], a[92:95], a[44:47], v[88:91]
s_waitcnt vmcnt(0)
v_cmp_gt_u32 vcc, 2, v230
v_mfma_f32_16x16x32_bf16 v[96:99], a[92:95], a[60:63], v[96:99]
v_and_b32 v59, 0xffff0000, v59
v_add_f32 v50, v50, v58
v_mfma_f32_16x16x32_bf16 v[76:79], a[64:67], a[192:195], v[76:79]
ds_read_b64_tr_b16 a[92:93], v222 offset:27656
ds_read_b64_tr_b16 a[94:95], v222 offset:32264
v_mfma_f32_16x16x32_bf16 v[84:87], a[64:67], a[208:211], v[84:87]
s_and_b32 s29, vcc_lo, 15
s_cbranch_scc1 SP_O3B
SP_O3B_RET:
v_mfma_f32_16x16x32_bf16 v[92:95], a[64:67], a[96:99], v[92:95]
s_add_u32 s39, s44, 8192
v_add_f32 v51, v51, v59
v_mfma_f32_16x16x32_bf16 v[100:103], a[64:67], a[112:115], v[100:103]
v_cvt_pk_bf16_f32 v200, v200, v201
v_cvt_pk_bf16_f32 v201, v202, v203
v_mfma_f32_16x16x32_bf16 v[76:79], a[68:71], a[196:199], v[76:79]
ds_read_b64_tr_b16 a[64:65], v220 offset:0
ds_read_b64_tr_b16 a[66:67], v220 offset:4608
v_mfma_f32_16x16x32_bf16 v[84:87], a[68:71], a[244:247], v[84:87]
buffer_store_dwordx2 v[200:201], v226, s[20:23], s44 offen offset:0 sc0 sc1
v_cvt_pk_bf16_f32 v58, v50, v51
v_mfma_f32_16x16x32_bf16 v[92:95], a[68:71], a[100:103], v[92:95]
v_cvt_pk_bf16_f32 v204, v204, v205
v_cvt_pk_bf16_f32 v205, v206, v207
v_mfma_f32_16x16x32_bf16 v[100:103], a[68:71], a[116:119], v[100:103]
buffer_store_dwordx2 v[204:205], v226, s[20:23], s44 offen offset:512 sc0 sc1
v_lshlrev_b32 v50, 16, v58
s_waitcnt lgkmcnt(8)
v_mfma_f32_16x16x32_bf16 v[76:79], a[72:75], a[200:203], v[76:79]
ds_read_b64_tr_b16 a[68:69], v220 offset:9216
ds_read_b64_tr_b16 a[70:71], v220 offset:13824
v_mfma_f32_16x16x32_bf16 v[84:87], a[72:75], a[248:251], v[84:87]
v_cvt_pk_bf16_f32 v208, v208, v209
v_cvt_pk_bf16_f32 v209, v210, v211
v_mfma_f32_16x16x32_bf16 v[92:95], a[72:75], a[104:107], v[92:95]
buffer_store_dwordx2 v[208:209], v226, s[20:23], s39 offen offset:0 sc0 sc1
v_and_b32 v51, 0xffff0000, v58
v_mfma_f32_16x16x32_bf16 v[100:103], a[72:75], a[120:123], v[100:103]
v_cvt_pk_bf16_f32 v212, v212, v213
v_cvt_pk_bf16_f32 v213, v214, v215
v_mfma_f32_16x16x32_bf16 v[76:79], a[76:79], a[204:207], v[76:79]
ds_read_b64_tr_b16 a[72:73], v220 offset:18432
ds_read_b64_tr_b16 a[74:75], v220 offset:23040
v_mfma_f32_16x16x32_bf16 v[84:87], a[76:79], a[252:255], v[84:87]
buffer_store_dwordx2 v[212:213], v226, s[20:23], s39 offen offset:512 sc0 sc1
v_mul_f32 v58, 0xbfb8aa3b, v50
v_mfma_f32_16x16x32_bf16 v[92:95], a[76:79], a[108:111], v[92:95]
v_mul_f32 v59, 0xbfb8aa3b, v51
v_mfma_f32_16x16x32_bf16 v[100:103], a[76:79], a[124:127], v[100:103]
v_exp_f32 v58, v58
v_mfma_f32_16x16x32_bf16 v[76:79], a[80:83], a[0:3], v[76:79]
ds_read_b64_tr_b16 a[76:77], v220 offset:27648
ds_read_b64_tr_b16 a[78:79], v220 offset:32256
v_mfma_f32_16x16x32_bf16 v[84:87], a[80:83], a[16:19], v[84:87]
v_exp_f32 v59, v59
v_mfma_f32_16x16x32_bf16 v[92:95], a[80:83], a[32:35], v[92:95]
v_add_f32 v58, 1.0, v58
v_add_f32 v59, 1.0, v59
v_mfma_f32_16x16x32_bf16 v[100:103], a[80:83], a[48:51], v[100:103]
v_rcp_f32 v58, v58
s_waitcnt lgkmcnt(8)
v_mfma_f32_16x16x32_bf16 v[76:79], a[84:87], a[4:7], v[76:79]
ds_read_b64_tr_b16 a[80:81], v223 offset:0
ds_read_b64_tr_b16 a[82:83], v223 offset:4608
v_mfma_f32_16x16x32_bf16 v[84:87], a[84:87], a[20:23], v[84:87]
v_rcp_f32 v59, v59
v_mfma_f32_16x16x32_bf16 v[92:95], a[84:87], a[36:39], v[92:95]
v_mul_f32 v50, v50, v58
v_mul_f32 v51, v51, v59
v_mfma_f32_16x16x32_bf16 v[100:103], a[84:87], a[52:55], v[100:103]
v_cvt_pk_bf16_f32 v58, v50, v51
v_lshlrev_b32 v50, 16, v58
v_mfma_f32_16x16x32_bf16 v[76:79], a[88:91], a[8:11], v[76:79]
ds_read_b64_tr_b16 a[84:85], v223 offset:9216
ds_read_b64_tr_b16 a[86:87], v223 offset:13824
v_mfma_f32_16x16x32_bf16 v[84:87], a[88:91], a[24:27], v[84:87]
v_and_b32 v51, 0xffff0000, v58
v_accvgpr_read_b32 v53, a229
v_mfma_f32_16x16x32_bf16 v[92:95], a[88:91], a[40:43], v[92:95]
v_accvgpr_read_b32 v59, a239
v_lshlrev_b32 v52, 16, v53
v_mfma_f32_16x16x32_bf16 v[100:103], a[88:91], a[56:59], v[100:103]
v_and_b32 v53, 0xffff0000, v53
v_lshlrev_b32 v58, 16, v59
v_mfma_f32_16x16x32_bf16 v[76:79], a[92:95], a[12:15], v[76:79]
ds_read_b64_tr_b16 a[88:89], v223 offset:18432
ds_read_b64_tr_b16 a[90:91], v223 offset:23040
v_mfma_f32_16x16x32_bf16 v[84:87], a[92:95], a[28:31], v[84:87]
v_and_b32 v59, 0xffff0000, v59
v_add_f32 v52, v52, v58
v_mfma_f32_16x16x32_bf16 v[92:95], a[92:95], a[44:47], v[92:95]
v_add_f32 v53, v53, v59
v_cvt_pk_bf16_f32 v58, v52, v53
v_mfma_f32_16x16x32_bf16 v[100:103], a[92:95], a[60:63], v[100:103]
v_lshlrev_b32 v52, 16, v58
v_and_b32 v53, 0xffff0000, v58
s_waitcnt lgkmcnt(8)
v_mfma_f32_16x16x32_bf16 v[104:107], a[64:67], a[192:195], v[104:107]
ds_read_b64_tr_b16 a[92:93], v223 offset:27648
ds_read_b64_tr_b16 a[94:95], v223 offset:32256
v_mfma_f32_16x16x32_bf16 v[112:115], a[64:67], a[208:211], v[112:115]
v_mul_f32 v58, 0xbfb8aa3b, v52
v_mul_f32 v59, 0xbfb8aa3b, v53
v_mfma_f32_16x16x32_bf16 v[120:123], a[64:67], a[96:99], v[120:123]
v_exp_f32 v58, v58
v_mfma_f32_16x16x32_bf16 v[128:131], a[64:67], a[112:115], v[128:131]
v_exp_f32 v59, v59
v_mfma_f32_16x16x32_bf16 v[104:107], a[68:71], a[196:199], v[104:107]
ds_read_b64_tr_b16 a[64:65], v220 offset:8
ds_read_b64_tr_b16 a[66:67], v220 offset:4616
v_mfma_f32_16x16x32_bf16 v[112:115], a[68:71], a[244:247], v[112:115]
v_add_f32 v58, 1.0, v58
v_add_f32 v59, 1.0, v59
v_mfma_f32_16x16x32_bf16 v[120:123], a[68:71], a[100:103], v[120:123]
v_rcp_f32 v58, v58
v_mfma_f32_16x16x32_bf16 v[128:131], a[68:71], a[116:119], v[128:131]
v_rcp_f32 v59, v59
v_mfma_f32_16x16x32_bf16 v[104:107], a[72:75], a[200:203], v[104:107]
ds_read_b64_tr_b16 a[68:69], v220 offset:9224
ds_read_b64_tr_b16 a[70:71], v220 offset:13832
v_mfma_f32_16x16x32_bf16 v[112:115], a[72:75], a[248:251], v[112:115]
s_add_u32 s39, s44, 0
v_mul_f32 v52, v52, v58
v_mfma_f32_16x16x32_bf16 v[120:123], a[72:75], a[104:107], v[120:123]
v_cvt_pk_bf16_f32 v80, v80, v81
v_cvt_pk_bf16_f32 v81, v82, v83
v_mfma_f32_16x16x32_bf16 v[128:131], a[72:75], a[120:123], v[128:131]
v_cvt_pk_bf16_f32 v82, v84, v85
v_cvt_pk_bf16_f32 v83, v86, v87
s_waitcnt lgkmcnt(8)
v_mfma_f32_16x16x32_bf16 v[104:107], a[76:79], a[204:207], v[104:107]
ds_read_b64_tr_b16 a[72:73], v220 offset:18440
ds_read_b64_tr_b16 a[74:75], v220 offset:23048
v_mfma_f32_16x16x32_bf16 v[112:115], a[76:79], a[252:255], v[112:115]
buffer_store_dwordx4 v[80:83], v244, s[20:23], s39 offen offset:1024 sc0 sc1
v_mul_f32 v53, v53, v59
v_mfma_f32_16x16x32_bf16 v[120:123], a[76:79], a[108:111], v[120:123]
v_cvt_pk_bf16_f32 v88, v88, v89
v_cvt_pk_bf16_f32 v89, v90, v91
v_mfma_f32_16x16x32_bf16 v[128:131], a[76:79], a[124:127], v[128:131]
v_cvt_pk_bf16_f32 v90, v92, v93
v_cvt_pk_bf16_f32 v91, v94, v95
v_mfma_f32_16x16x32_bf16 v[104:107], a[80:83], a[0:3], v[104:107]
ds_read_b64_tr_b16 a[76:77], v220 offset:27656
ds_read_b64_tr_b16 a[78:79], v220 offset:32264
v_mfma_f32_16x16x32_bf16 v[112:115], a[80:83], a[16:19], v[112:115]
buffer_store_dwordx4 v[88:91], v244, s[20:23], s39 offen offset:2048 sc0 sc1
v_cvt_pk_bf16_f32 v58, v52, v53
v_mfma_f32_16x16x32_bf16 v[120:123], a[80:83], a[32:35], v[120:123]
v_cvt_pk_bf16_f32 v96, v96, v97
v_cvt_pk_bf16_f32 v97, v98, v99
v_mfma_f32_16x16x32_bf16 v[128:131], a[80:83], a[48:51], v[128:131]
v_cvt_pk_bf16_f32 v98, v100, v101
v_cvt_pk_bf16_f32 v99, v102, v103
v_mfma_f32_16x16x32_bf16 v[104:107], a[84:87], a[4:7], v[104:107]
ds_read_b64_tr_b16 a[80:81], v223 offset:8
ds_read_b64_tr_b16 a[82:83], v223 offset:4616
v_mfma_f32_16x16x32_bf16 v[112:115], a[84:87], a[20:23], v[112:115]
buffer_store_dwordx4 v[96:99], v244, s[20:23], s39 offen offset:3072 sc0 sc1
v_lshlrev_b32 v52, 16, v58
v_mfma_f32_16x16x32_bf16 v[120:123], a[84:87], a[36:39], v[120:123]
v_and_b32 v53, 0xffff0000, v58
v_accvgpr_read_b32 v55, a230
v_mfma_f32_16x16x32_bf16 v[128:131], a[84:87], a[52:55], v[128:131]
v_accvgpr_read_b32 v59, a240
v_lshlrev_b32 v54, 16, v55
s_waitcnt lgkmcnt(8)
v_mfma_f32_16x16x32_bf16 v[104:107], a[88:91], a[8:11], v[104:107]
ds_read_b64_tr_b16 a[84:85], v223 offset:9224
ds_read_b64_tr_b16 a[86:87], v223 offset:13832
v_mfma_f32_16x16x32_bf16 v[112:115], a[88:91], a[24:27], v[112:115]
v_and_b32 v55, 0xffff0000, v55
v_lshlrev_b32 v58, 16, v59
v_mfma_f32_16x16x32_bf16 v[120:123], a[88:91], a[40:43], v[120:123]
v_and_b32 v59, 0xffff0000, v59
v_add_f32 v54, v54, v58
v_mfma_f32_16x16x32_bf16 v[128:131], a[88:91], a[56:59], v[128:131]
v_add_f32 v55, v55, v59
v_cvt_pk_bf16_f32 v58, v54, v55
v_mfma_f32_16x16x32_bf16 v[104:107], a[92:95], a[12:15], v[104:107]
ds_read_b64_tr_b16 a[88:89], v223 offset:18440
ds_read_b64_tr_b16 a[90:91], v223 offset:23048
v_mfma_f32_16x16x32_bf16 v[112:115], a[92:95], a[28:31], v[112:115]
v_lshlrev_b32 v54, 16, v58
v_and_b32 v55, 0xffff0000, v58
v_mfma_f32_16x16x32_bf16 v[120:123], a[92:95], a[44:47], v[120:123]
v_mul_f32 v58, 0xbfb8aa3b, v54
v_mul_f32 v59, 0xbfb8aa3b, v55
v_mfma_f32_16x16x32_bf16 v[128:131], a[92:95], a[60:63], v[128:131]
v_exp_f32 v58, v58
v_mfma_f32_16x16x32_bf16 v[108:111], a[64:67], a[192:195], v[108:111]
ds_read_b64_tr_b16 a[92:93], v223 offset:27656
ds_read_b64_tr_b16 a[94:95], v223 offset:32264
v_mfma_f32_16x16x32_bf16 v[116:119], a[64:67], a[208:211], v[116:119]
v_exp_f32 v59, v59
v_mfma_f32_16x16x32_bf16 v[124:127], a[64:67], a[96:99], v[124:127]
v_add_f32 v58, 1.0, v58
v_add_f32 v59, 1.0, v59
v_mfma_f32_16x16x32_bf16 v[132:135], a[64:67], a[112:115], v[132:135]
v_rcp_f32 v58, v58
s_waitcnt lgkmcnt(8)
v_mfma_f32_16x16x32_bf16 v[108:111], a[68:71], a[196:199], v[108:111]
ds_read_b64_tr_b16 a[64:65], v219 offset:128
ds_read_b64_tr_b16 a[66:67], v219 offset:4736
v_mfma_f32_16x16x32_bf16 v[116:119], a[68:71], a[244:247], v[116:119]
v_rcp_f32 v59, v59
v_mfma_f32_16x16x32_bf16 v[124:127], a[68:71], a[100:103], v[124:127]
v_mul_f32 v54, v54, v58
v_mul_f32 v55, v55, v59
v_mfma_f32_16x16x32_bf16 v[132:135], a[68:71], a[116:119], v[132:135]
v_cvt_pk_bf16_f32 v58, v54, v55
v_lshlrev_b32 v54, 16, v58
v_mfma_f32_16x16x32_bf16 v[108:111], a[72:75], a[200:203], v[108:111]
ds_read_b64_tr_b16 a[68:69], v219 offset:9344
ds_read_b64_tr_b16 a[70:71], v219 offset:13952
v_mfma_f32_16x16x32_bf16 v[116:119], a[72:75], a[248:251], v[116:119]
v_and_b32 v55, 0xffff0000, v58
v_accvgpr_read_b32 v57, a231
v_mfma_f32_16x16x32_bf16 v[124:127], a[72:75], a[104:107], v[124:127]
v_accvgpr_read_b32 v59, a241
v_lshlrev_b32 v56, 16, v57
v_mfma_f32_16x16x32_bf16 v[132:135], a[72:75], a[120:123], v[132:135]
v_and_b32 v57, 0xffff0000, v57
v_lshlrev_b32 v58, 16, v59
v_mfma_f32_16x16x32_bf16 v[108:111], a[76:79], a[204:207], v[108:111]
ds_read_b64_tr_b16 a[72:73], v219 offset:18560
ds_read_b64_tr_b16 a[74:75], v219 offset:23168
v_mfma_f32_16x16x32_bf16 v[116:119], a[76:79], a[252:255], v[116:119]
v_and_b32 v59, 0xffff0000, v59
v_add_f32 v56, v56, v58
v_mfma_f32_16x16x32_bf16 v[124:127], a[76:79], a[108:111], v[124:127]
v_add_f32 v57, v57, v59
v_cvt_pk_bf16_f32 v58, v56, v57
v_mfma_f32_16x16x32_bf16 v[132:135], a[76:79], a[124:127], v[132:135]
v_lshlrev_b32 v56, 16, v58
v_and_b32 v57, 0xffff0000, v58
s_waitcnt lgkmcnt(8)
v_mfma_f32_16x16x32_bf16 v[108:111], a[80:83], a[0:3], v[108:111]
ds_read_b64_tr_b16 a[76:77], v219 offset:27776
ds_read_b64_tr_b16 a[78:79], v219 offset:32384
v_mfma_f32_16x16x32_bf16 v[116:119], a[80:83], a[16:19], v[116:119]
v_mul_f32 v58, 0xbfb8aa3b, v56
v_mul_f32 v59, 0xbfb8aa3b, v57
v_mfma_f32_16x16x32_bf16 v[124:127], a[80:83], a[32:35], v[124:127]
v_exp_f32 v58, v58
v_mfma_f32_16x16x32_bf16 v[132:135], a[80:83], a[48:51], v[132:135]
v_exp_f32 v59, v59
v_mfma_f32_16x16x32_bf16 v[108:111], a[84:87], a[4:7], v[108:111]
ds_read_b64_tr_b16 a[80:81], v222 offset:128
ds_read_b64_tr_b16 a[82:83], v222 offset:4736
v_mfma_f32_16x16x32_bf16 v[116:119], a[84:87], a[20:23], v[116:119]
v_add_f32 v58, 1.0, v58
v_add_f32 v59, 1.0, v59
v_mfma_f32_16x16x32_bf16 v[124:127], a[84:87], a[36:39], v[124:127]
v_rcp_f32 v58, v58
v_mfma_f32_16x16x32_bf16 v[132:135], a[84:87], a[52:55], v[132:135]
v_rcp_f32 v59, v59
v_mfma_f32_16x16x32_bf16 v[108:111], a[88:91], a[8:11], v[108:111]
ds_read_b64_tr_b16 a[84:85], v222 offset:9344
ds_read_b64_tr_b16 a[86:87], v222 offset:13952
v_mfma_f32_16x16x32_bf16 v[116:119], a[88:91], a[24:27], v[116:119]
v_mul_f32 v56, v56, v58
v_mul_f32 v57, v57, v59
v_mfma_f32_16x16x32_bf16 v[124:127], a[88:91], a[40:43], v[124:127]
v_cvt_pk_bf16_f32 v58, v56, v57
v_lshlrev_b32 v56, 16, v58
v_mfma_f32_16x16x32_bf16 v[132:135], a[88:91], a[56:59], v[132:135]
v_and_b32 v57, 0xffff0000, v58
v_accvgpr_read_b32 v19, a212
s_waitcnt lgkmcnt(8)
v_mfma_f32_16x16x32_bf16 v[108:111], a[92:95], a[12:15], v[108:111]
ds_read_b64_tr_b16 a[88:89], v222 offset:18560
ds_read_b64_tr_b16 a[90:91], v222 offset:23168
v_mfma_f32_16x16x32_bf16 v[116:119], a[92:95], a[28:31], v[116:119]
v_lshlrev_b32 v18, 16, v19
v_and_b32 v19, 0xffff0000, v19
v_mfma_f32_16x16x32_bf16 v[124:127], a[92:95], a[44:47], v[124:127]
v_accvgpr_read_b32 v21, a213
v_lshlrev_b32 v20, 16, v21
v_mfma_f32_16x16x32_bf16 v[132:135], a[92:95], a[60:63], v[132:135]
v_and_b32 v21, 0xffff0000, v21
v_accvgpr_read_b32 v23, a214
v_mfma_f32_16x16x32_bf16 v[136:139], a[64:67], a[192:195], v[136:139]
ds_read_b64_tr_b16 a[92:93], v222 offset:27776
ds_read_b64_tr_b16 a[94:95], v222 offset:32384
v_mfma_f32_16x16x32_bf16 v[144:147], a[64:67], a[208:211], v[144:147]
v_lshlrev_b32 v22, 16, v23
v_and_b32 v23, 0xffff0000, v23
v_mfma_f32_16x16x32_bf16 v[152:155], a[64:67], a[96:99], v[152:155]
v_accvgpr_read_b32 v25, a215
v_lshlrev_b32 v24, 16, v25
v_mfma_f32_16x16x32_bf16 v[160:163], a[64:67], a[112:115], v[160:163]
v_and_b32 v25, 0xffff0000, v25
v_accvgpr_read_b32 v27, a216
v_mfma_f32_16x16x32_bf16 v[136:139], a[68:71], a[196:199], v[136:139]
ds_read_b64_tr_b16 a[64:65], v219 offset:136
ds_read_b64_tr_b16 a[66:67], v219 offset:4744
v_mfma_f32_16x16x32_bf16 v[144:147], a[68:71], a[244:247], v[144:147]
v_lshlrev_b32 v26, 16, v27
v_and_b32 v27, 0xffff0000, v27
v_mfma_f32_16x16x32_bf16 v[152:155], a[68:71], a[100:103], v[152:155]
v_accvgpr_read_b32 v29, a217
v_lshlrev_b32 v28, 16, v29
v_mfma_f32_16x16x32_bf16 v[160:163], a[68:71], a[116:119], v[160:163]
v_and_b32 v29, 0xffff0000, v29
v_accvgpr_read_b32 v31, a218
s_waitcnt lgkmcnt(8)
v_mfma_f32_16x16x32_bf16 v[136:139], a[72:75], a[200:203], v[136:139]
ds_read_b64_tr_b16 a[68:69], v219 offset:9352
ds_read_b64_tr_b16 a[70:71], v219 offset:13960
v_mfma_f32_16x16x32_bf16 v[144:147], a[72:75], a[248:251], v[144:147]
s_add_u32 s39, s44, 4096
v_lshlrev_b32 v30, 16, v31
v_mfma_f32_16x16x32_bf16 v[152:155], a[72:75], a[104:107], v[152:155]
v_cvt_pk_bf16_f32 v104, v104, v105
v_cvt_pk_bf16_f32 v105, v106, v107
v_mfma_f32_16x16x32_bf16 v[160:163], a[72:75], a[120:123], v[160:163]
v_cvt_pk_bf16_f32 v106, v108, v109
v_cvt_pk_bf16_f32 v107, v110, v111
v_mfma_f32_16x16x32_bf16 v[136:139], a[76:79], a[204:207], v[136:139]
ds_read_b64_tr_b16 a[72:73], v219 offset:18568
ds_read_b64_tr_b16 a[74:75], v219 offset:23176
v_mfma_f32_16x16x32_bf16 v[144:147], a[76:79], a[252:255], v[144:147]
buffer_store_dwordx4 v[104:107], v244, s[20:23], s39 offen offset:0 sc0 sc1
v_and_b32 v31, 0xffff0000, v31
v_mfma_f32_16x16x32_bf16 v[152:155], a[76:79], a[108:111], v[152:155]
v_cvt_pk_bf16_f32 v112, v112, v113
v_cvt_pk_bf16_f32 v113, v114, v115
v_mfma_f32_16x16x32_bf16 v[160:163], a[76:79], a[124:127], v[160:163]
v_cvt_pk_bf16_f32 v114, v116, v117
v_cvt_pk_bf16_f32 v115, v118, v119
v_mfma_f32_16x16x32_bf16 v[136:139], a[80:83], a[0:3], v[136:139]
ds_read_b64_tr_b16 a[76:77], v219 offset:27784
ds_read_b64_tr_b16 a[78:79], v219 offset:32392
v_mfma_f32_16x16x32_bf16 v[144:147], a[80:83], a[16:19], v[144:147]
buffer_store_dwordx4 v[112:115], v244, s[20:23], s39 offen offset:1024 sc0 sc1
v_accvgpr_read_b32 v33, a219
v_mfma_f32_16x16x32_bf16 v[152:155], a[80:83], a[32:35], v[152:155]
v_cvt_pk_bf16_f32 v120, v120, v121
v_cvt_pk_bf16_f32 v121, v122, v123
v_mfma_f32_16x16x32_bf16 v[160:163], a[80:83], a[48:51], v[160:163]
v_cvt_pk_bf16_f32 v122, v124, v125
v_cvt_pk_bf16_f32 v123, v126, v127
s_waitcnt lgkmcnt(8)
v_mfma_f32_16x16x32_bf16 v[136:139], a[84:87], a[4:7], v[136:139]
ds_read_b64_tr_b16 a[80:81], v222 offset:136
ds_read_b64_tr_b16 a[82:83], v222 offset:4744
v_mfma_f32_16x16x32_bf16 v[144:147], a[84:87], a[20:23], v[144:147]
buffer_store_dwordx4 v[120:123], v244, s[20:23], s39 offen offset:2048 sc0 sc1
v_lshlrev_b32 v32, 16, v33
v_mfma_f32_16x16x32_bf16 v[152:155], a[84:87], a[36:39], v[152:155]
v_cvt_pk_bf16_f32 v128, v128, v129
v_cvt_pk_bf16_f32 v129, v130, v131
v_mfma_f32_16x16x32_bf16 v[160:163], a[84:87], a[52:55], v[160:163]
v_cvt_pk_bf16_f32 v130, v132, v133
v_cvt_pk_bf16_f32 v131, v134, v135
v_mfma_f32_16x16x32_bf16 v[136:139], a[88:91], a[8:11], v[136:139]
ds_read_b64_tr_b16 a[84:85], v222 offset:9352
ds_read_b64_tr_b16 a[86:87], v222 offset:13960
v_mfma_f32_16x16x32_bf16 v[144:147], a[88:91], a[24:27], v[144:147]
buffer_store_dwordx4 v[128:131], v244, s[20:23], s39 offen offset:3072 sc0 sc1
v_and_b32 v33, 0xffff0000, v33
v_mfma_f32_16x16x32_bf16 v[152:155], a[88:91], a[40:43], v[152:155]
s_lshl2_add_u32 s28, s32, s95
v_accvgpr_read_b32 v35, a220
v_mfma_f32_16x16x32_bf16 v[160:163], a[88:91], a[56:59], v[160:163]
v_lshlrev_b32 v34, 16, v35
v_and_b32 v35, 0xffff0000, v35
v_mfma_f32_16x16x32_bf16 v[136:139], a[92:95], a[12:15], v[136:139]
ds_read_b64_tr_b16 a[88:89], v222 offset:18568
ds_read_b64_tr_b16 a[90:91], v222 offset:23176
v_mfma_f32_16x16x32_bf16 v[144:147], a[92:95], a[28:31], v[144:147]
v_accvgpr_read_b32 v37, a221
v_lshlrev_b32 v36, 16, v37
v_mfma_f32_16x16x32_bf16 v[152:155], a[92:95], a[44:47], v[152:155]
v_and_b32 v37, 0xffff0000, v37
v_mfma_f32_16x16x32_bf16 v[160:163], a[92:95], a[60:63], v[160:163]
s_mov_b32 s90, 0x3f80
s_mov_b32 s91, 0x3f800000
s_waitcnt lgkmcnt(8)
v_mfma_f32_16x16x32_bf16 v[140:143], a[64:67], a[192:195], v[140:143]
ds_read_b64_tr_b16 a[92:93], v222 offset:27784
ds_read_b64_tr_b16 a[94:95], v222 offset:32392
v_mfma_f32_16x16x32_bf16 v[148:151], a[64:67], a[208:211], v[148:151]
v_mov_b32 v66, 0
v_mov_b32 v67, 0
v_mfma_f32_16x16x32_bf16 v[156:159], a[64:67], a[96:99], v[156:159]
v_mov_b32 v68, 0
v_mov_b32 v69, 0
v_mfma_f32_16x16x32_bf16 v[164:167], a[64:67], a[112:115], v[164:167]
v_mfma_f32_16x16x32_bf16 v[140:143], a[68:71], a[196:199], v[140:143]
ds_read_b64_tr_b16 a[64:65], v220 offset:128
ds_read_b64_tr_b16 a[66:67], v220 offset:4736
v_mfma_f32_16x16x32_bf16 v[148:151], a[68:71], a[244:247], v[148:151]
v_mfma_f32_16x16x32_bf16 v[156:159], a[68:71], a[100:103], v[156:159]
v_mfma_f32_16x16x32_bf16 v[164:167], a[68:71], a[116:119], v[164:167]
v_mfma_f32_16x16x32_bf16 v[140:143], a[72:75], a[200:203], v[140:143]
ds_read_b64_tr_b16 a[68:69], v220 offset:9344
ds_read_b64_tr_b16 a[70:71], v220 offset:13952
v_mfma_f32_16x16x32_bf16 v[148:151], a[72:75], a[248:251], v[148:151]
v_mfma_f32_16x16x32_bf16 v[156:159], a[72:75], a[104:107], v[156:159]
v_mfma_f32_16x16x32_bf16 v[164:167], a[72:75], a[120:123], v[164:167]
s_waitcnt lgkmcnt(8)
v_mfma_f32_16x16x32_bf16 v[140:143], a[76:79], a[204:207], v[140:143]
ds_read_b64_tr_b16 a[72:73], v220 offset:18560
ds_read_b64_tr_b16 a[74:75], v220 offset:23168
v_mfma_f32_16x16x32_bf16 v[148:151], a[76:79], a[252:255], v[148:151]
v_mfma_f32_16x16x32_bf16 v[156:159], a[76:79], a[108:111], v[156:159]
v_mfma_f32_16x16x32_bf16 v[164:167], a[76:79], a[124:127], v[164:167]
v_mfma_f32_16x16x32_bf16 v[140:143], a[80:83], a[0:3], v[140:143]
ds_read_b64_tr_b16 a[76:77], v220 offset:27776
ds_read_b64_tr_b16 a[78:79], v220 offset:32384
v_mfma_f32_16x16x32_bf16 v[148:151], a[80:83], a[16:19], v[148:151]
v_mfma_f32_16x16x32_bf16 v[156:159], a[80:83], a[32:35], v[156:159]
s_waitcnt vmcnt(0)
buffer_store_dword v231, v254, s[20:23], s28 offen sc0 sc1
v_mfma_f32_16x16x32_bf16 v[164:167], a[80:83], a[48:51], v[164:167]
v_mfma_f32_16x16x32_bf16 v[140:143], a[84:87], a[4:7], v[140:143]
ds_read_b64_tr_b16 a[80:81], v223 offset:128
ds_read_b64_tr_b16 a[82:83], v223 offset:4736
v_mfma_f32_16x16x32_bf16 v[148:151], a[84:87], a[20:23], v[148:151]
v_mfma_f32_16x16x32_bf16 v[156:159], a[84:87], a[36:39], v[156:159]
v_mfma_f32_16x16x32_bf16 v[164:167], a[84:87], a[52:55], v[164:167]
s_waitcnt lgkmcnt(8)
v_mfma_f32_16x16x32_bf16 v[140:143], a[88:91], a[8:11], v[140:143]
ds_read_b64_tr_b16 a[84:85], v223 offset:9344
ds_read_b64_tr_b16 a[86:87], v223 offset:13952
v_mfma_f32_16x16x32_bf16 v[148:151], a[88:91], a[24:27], v[148:151]
v_mfma_f32_16x16x32_bf16 v[156:159], a[88:91], a[40:43], v[156:159]
v_mfma_f32_16x16x32_bf16 v[164:167], a[88:91], a[56:59], v[164:167]
v_mfma_f32_16x16x32_bf16 v[140:143], a[92:95], a[12:15], v[140:143]
ds_read_b64_tr_b16 a[88:89], v223 offset:18560
ds_read_b64_tr_b16 a[90:91], v223 offset:23168
v_mfma_f32_16x16x32_bf16 v[148:151], a[92:95], a[28:31], v[148:151]
v_mfma_f32_16x16x32_bf16 v[156:159], a[92:95], a[44:47], v[156:159]
v_mfma_f32_16x16x32_bf16 v[164:167], a[92:95], a[60:63], v[164:167]
v_mfma_f32_16x16x32_bf16 v[168:171], a[64:67], a[192:195], v[168:171]
ds_read_b64_tr_b16 a[92:93], v223 offset:27776
ds_read_b64_tr_b16 a[94:95], v223 offset:32384
v_mfma_f32_16x16x32_bf16 v[176:179], a[64:67], a[208:211], v[176:179]
v_mfma_f32_16x16x32_bf16 v[184:187], a[64:67], a[96:99], v[184:187]
v_mfma_f32_16x16x32_bf16 v[192:195], a[64:67], a[112:115], v[192:195]
s_waitcnt lgkmcnt(8)
v_mfma_f32_16x16x32_bf16 v[168:171], a[68:71], a[196:199], v[168:171]
ds_read_b64_tr_b16 a[64:65], v220 offset:136
ds_read_b64_tr_b16 a[66:67], v220 offset:4744
v_mfma_f32_16x16x32_bf16 v[176:179], a[68:71], a[244:247], v[176:179]
v_mfma_f32_16x16x32_bf16 v[184:187], a[68:71], a[100:103], v[184:187]
v_mfma_f32_16x16x32_bf16 v[192:195], a[68:71], a[116:119], v[192:195]
v_mfma_f32_16x16x32_bf16 v[168:171], a[72:75], a[200:203], v[168:171]
ds_read_b64_tr_b16 a[68:69], v220 offset:9352
ds_read_b64_tr_b16 a[70:71], v220 offset:13960
v_mfma_f32_16x16x32_bf16 v[176:179], a[72:75], a[248:251], v[176:179]
s_add_u32 s39, s44, 8192
v_mfma_f32_16x16x32_bf16 v[184:187], a[72:75], a[104:107], v[184:187]
v_cvt_pk_bf16_f32 v144, v144, v145
v_cvt_pk_bf16_f32 v145, v146, v147
v_mfma_f32_16x16x32_bf16 v[192:195], a[72:75], a[120:123], v[192:195]
v_cvt_pk_bf16_f32 v146, v148, v149
v_cvt_pk_bf16_f32 v147, v150, v151
v_mfma_f32_16x16x32_bf16 v[168:171], a[76:79], a[204:207], v[168:171]
ds_read_b64_tr_b16 a[72:73], v220 offset:18568
ds_read_b64_tr_b16 a[74:75], v220 offset:23176
v_mfma_f32_16x16x32_bf16 v[176:179], a[76:79], a[252:255], v[176:179]
buffer_store_dwordx4 v[144:147], v244, s[20:23], s39 offen offset:1024 sc0 sc1
v_mfma_f32_16x16x32_bf16 v[184:187], a[76:79], a[108:111], v[184:187]
v_cvt_pk_bf16_f32 v152, v152, v153
v_cvt_pk_bf16_f32 v153, v154, v155
v_mfma_f32_16x16x32_bf16 v[192:195], a[76:79], a[124:127], v[192:195]
v_cvt_pk_bf16_f32 v154, v156, v157
v_cvt_pk_bf16_f32 v155, v158, v159
s_waitcnt lgkmcnt(8)
v_mfma_f32_16x16x32_bf16 v[168:171], a[80:83], a[0:3], v[168:171]
ds_read_b64_tr_b16 a[76:77], v220 offset:27784
ds_read_b64_tr_b16 a[78:79], v220 offset:32392
v_mfma_f32_16x16x32_bf16 v[176:179], a[80:83], a[16:19], v[176:179]
buffer_store_dwordx4 v[152:155], v244, s[20:23], s39 offen offset:2048 sc0 sc1
v_mfma_f32_16x16x32_bf16 v[184:187], a[80:83], a[32:35], v[184:187]
v_cvt_pk_bf16_f32 v160, v160, v161
v_cvt_pk_bf16_f32 v161, v162, v163
v_mfma_f32_16x16x32_bf16 v[192:195], a[80:83], a[48:51], v[192:195]
v_cvt_pk_bf16_f32 v162, v164, v165
v_cvt_pk_bf16_f32 v163, v166, v167
v_mfma_f32_16x16x32_bf16 v[168:171], a[84:87], a[4:7], v[168:171]
ds_read_b64_tr_b16 a[80:81], v223 offset:136
ds_read_b64_tr_b16 a[82:83], v223 offset:4744
v_mfma_f32_16x16x32_bf16 v[176:179], a[84:87], a[20:23], v[176:179]
buffer_store_dwordx4 v[160:163], v244, s[20:23], s39 offen offset:3072 sc0 sc1
v_mfma_f32_16x16x32_bf16 v[184:187], a[84:87], a[36:39], v[184:187]
buffer_load_dword v230, v229, s[20:23], s95 offen sc0 sc1
v_mfma_f32_16x16x32_bf16 v[192:195], a[84:87], a[52:55], v[192:195]
v_mfma_f32_16x16x32_bf16 v[168:171], a[88:91], a[8:11], v[168:171]
ds_read_b64_tr_b16 a[84:85], v223 offset:9352
ds_read_b64_tr_b16 a[86:87], v223 offset:13960
v_mfma_f32_16x16x32_bf16 v[176:179], a[88:91], a[24:27], v[176:179]
v_mfma_f32_16x16x32_bf16 v[184:187], a[88:91], a[40:43], v[184:187]
v_mfma_f32_16x16x32_bf16 v[192:195], a[88:91], a[56:59], v[192:195]
s_waitcnt lgkmcnt(8)
v_mfma_f32_16x16x32_bf16 v[168:171], a[92:95], a[12:15], v[168:171]
ds_read_b64_tr_b16 a[88:89], v223 offset:18568
ds_read_b64_tr_b16 a[90:91], v223 offset:23176
v_mfma_f32_16x16x32_bf16 v[176:179], a[92:95], a[28:31], v[176:179]
v_mfma_f32_16x16x32_bf16 v[184:187], a[92:95], a[44:47], v[184:187]
v_mfma_f32_16x16x32_bf16 v[192:195], a[92:95], a[60:63], v[192:195]
v_mfma_f32_16x16x32_bf16 v[172:175], a[64:67], a[192:195], v[172:175]
ds_read_b64_tr_b16 a[92:93], v223 offset:27784
ds_read_b64_tr_b16 a[94:95], v223 offset:32392
v_mfma_f32_16x16x32_bf16 v[180:183], a[64:67], a[208:211], v[180:183]
v_mfma_f32_16x16x32_bf16 v[188:191], a[64:67], a[96:99], v[188:191]
v_mfma_f32_16x16x32_bf16 v[196:199], a[64:67], a[112:115], v[196:199]
v_mfma_f32_16x16x32_bf16 v[172:175], a[68:71], a[196:199], v[172:175]
v_mfma_f32_16x16x32_bf16 v[180:183], a[68:71], a[244:247], v[180:183]
v_mfma_f32_16x16x32_bf16 v[188:191], a[68:71], a[100:103], v[188:191]
v_mfma_f32_16x16x32_bf16 v[196:199], a[68:71], a[116:119], v[196:199]
s_waitcnt lgkmcnt(8)
v_mfma_f32_16x16x32_bf16 v[172:175], a[72:75], a[200:203], v[172:175]
v_mfma_f32_16x16x32_bf16 v[180:183], a[72:75], a[248:251], v[180:183]
v_mfma_f32_16x16x32_bf16 v[188:191], a[72:75], a[104:107], v[188:191]
v_mfma_f32_16x16x32_bf16 v[196:199], a[72:75], a[120:123], v[196:199]
v_mfma_f32_16x16x32_bf16 v[172:175], a[76:79], a[204:207], v[172:175]
v_mfma_f32_16x16x32_bf16 v[180:183], a[76:79], a[252:255], v[180:183]
v_mfma_f32_16x16x32_bf16 v[188:191], a[76:79], a[108:111], v[188:191]
s_waitcnt vmcnt(0)
v_cmp_gt_u32 vcc, 1, v230
v_mfma_f32_16x16x32_bf16 v[196:199], a[76:79], a[124:127], v[196:199]
s_waitcnt lgkmcnt(6)
v_mfma_f32_16x16x32_bf16 v[172:175], a[80:83], a[0:3], v[172:175]
s_and_b32 s29, vcc_lo, 0xff
s_cbranch_scc1 SP_P1B
SP_P1B_RET:
v_mfma_f32_16x16x32_bf16 v[180:183], a[80:83], a[16:19], v[180:183]
buffer_load_dwordx4 v[104:107], v244, s[20:23], s65 offen offset:3072 sc0 sc1
v_mfma_f32_16x16x32_bf16 v[188:191], a[80:83], a[32:35], v[188:191]
buffer_load_dwordx4 v[108:111], v244, s[20:23], s66 offen offset:2048 sc0 sc1
v_mfma_f32_16x16x32_bf16 v[196:199], a[80:83], a[48:51], v[196:199]
buffer_load_dwordx4 v[112:115], v244, s[20:23], s67 offen offset:1024 sc0 sc1
s_waitcnt lgkmcnt(4)
v_mfma_f32_16x16x32_bf16 v[172:175], a[84:87], a[4:7], v[172:175]
buffer_load_dwordx4 v[116:119], v244, s[20:23], s68 offen offset:0 sc0 sc1
v_mfma_f32_16x16x32_bf16 v[180:183], a[84:87], a[20:23], v[180:183]
buffer_load_dwordx4 v[120:123], v244, s[20:23], s69 offen offset:3072 sc0 sc1
v_mfma_f32_16x16x32_bf16 v[188:191], a[84:87], a[36:39], v[188:191]
buffer_load_dwordx4 v[124:127], v244, s[20:23], s70 offen offset:2048 sc0 sc1
v_mfma_f32_16x16x32_bf16 v[196:199], a[84:87], a[52:55], v[196:199]
buffer_load_dwordx4 v[128:131], v244, s[20:23], s71 offen offset:1024 sc0 sc1
s_waitcnt lgkmcnt(2)
v_mfma_f32_16x16x32_bf16 v[172:175], a[88:91], a[8:11], v[172:175]
v_mfma_f32_16x16x32_bf16 v[180:183], a[88:91], a[24:27], v[180:183]
v_mfma_f32_16x16x32_bf16 v[188:191], a[88:91], a[40:43], v[188:191]
v_mfma_f32_16x16x32_bf16 v[196:199], a[88:91], a[56:59], v[196:199]
s_waitcnt lgkmcnt(0)
v_mfma_f32_16x16x32_bf16 v[172:175], a[92:95], a[12:15], v[172:175]
v_mfma_f32_16x16x32_bf16 v[180:183], a[92:95], a[28:31], v[180:183]
v_mfma_f32_16x16x32_bf16 v[188:191], a[92:95], a[44:47], v[188:191]
v_mfma_f32_16x16x32_bf16 v[196:199], a[92:95], a[60:63], v[196:199]
s_add_u32 s39, s44, 12288
s_nop 5
v_cvt_pk_bf16_f32 v168, v168, v169
v_cvt_pk_bf16_f32 v169, v170, v171
v_cvt_pk_bf16_f32 v170, v172, v173
v_cvt_pk_bf16_f32 v171, v174, v175
buffer_store_dwordx4 v[168:171], v244, s[20:23], s39 offen offset:0 sc0 sc1
v_cvt_pk_bf16_f32 v176, v176, v177
v_cvt_pk_bf16_f32 v177, v178, v179
v_cvt_pk_bf16_f32 v178, v180, v181
v_cvt_pk_bf16_f32 v179, v182, v183
buffer_store_dwordx4 v[176:179], v244, s[20:23], s39 offen offset:1024 sc0 sc1
v_cvt_pk_bf16_f32 v184, v184, v185
v_cvt_pk_bf16_f32 v185, v186, v187
v_cvt_pk_bf16_f32 v186, v188, v189
v_cvt_pk_bf16_f32 v187, v190, v191
buffer_store_dwordx4 v[184:187], v244, s[20:23], s39 offen offset:2048 sc0 sc1
v_cvt_pk_bf16_f32 v192, v192, v193
v_cvt_pk_bf16_f32 v193, v194, v195
v_cvt_pk_bf16_f32 v194, v196, v197
v_cvt_pk_bf16_f32 v195, v198, v199
buffer_store_dwordx4 v[192:195], v244, s[20:23], s39 offen offset:3072 sc0 sc1
buffer_load_dwordx2 v[200:201], v226, s[20:23], s72 offen offset:0 sc0 sc1
buffer_load_dwordx2 v[202:203], v226, s[20:23], s73 offen offset:512 sc0 sc1
buffer_load_dwordx2 v[204:205], v226, s[20:23], s74 offen offset:0 sc0 sc1
buffer_load_dwordx2 v[206:207], v226, s[20:23], s75 offen offset:512 sc0 sc1
buffer_load_dwordx2 v[208:209], v226, s[20:23], s84 offen offset:0 sc0 sc1
buffer_load_dwordx2 v[210:211], v226, s[20:23], s85 offen offset:512 sc0 sc1
buffer_load_dwordx2 v[212:213], v226, s[20:23], s86 offen offset:0 sc0 sc1
buffer_load_dwordx2 v[214:215], v226, s[20:23], s87 offen offset:512 sc0 sc1
s_waitcnt vmcnt(8)
buffer_store_dword v246, v254, s[20:23], s28 offen sc0 sc1
buffer_load_dword v230, v229, s[20:23], s95 offen sc0 sc1
s_waitcnt vmcnt(20)
v_dot2c_f32_bf16 v72, s90, v104
v_dot2c_f32_bf16 v73, s91, v104
v_dot2c_f32_bf16 v74, s90, v105
v_dot2c_f32_bf16 v75, s91, v105
v_dot2c_f32_bf16 v76, s90, v106
v_dot2c_f32_bf16 v77, s91, v106
v_dot2c_f32_bf16 v78, s90, v107
v_dot2c_f32_bf16 v79, s91, v107
s_waitcnt vmcnt(19)
v_dot2c_f32_bf16 v72, s90, v108
v_dot2c_f32_bf16 v73, s91, v108
v_dot2c_f32_bf16 v74, s90, v109
v_dot2c_f32_bf16 v75, s91, v109
v_dot2c_f32_bf16 v76, s90, v110
v_dot2c_f32_bf16 v77, s91, v110
v_dot2c_f32_bf16 v78, s90, v111
v_dot2c_f32_bf16 v79, s91, v111
s_waitcnt vmcnt(18)
v_dot2c_f32_bf16 v72, s90, v112
v_dot2c_f32_bf16 v73, s91, v112
v_dot2c_f32_bf16 v74, s90, v113
v_dot2c_f32_bf16 v75, s91, v113
v_dot2c_f32_bf16 v76, s90, v114
v_dot2c_f32_bf16 v77, s91, v114
v_dot2c_f32_bf16 v78, s90, v115
v_dot2c_f32_bf16 v79, s91, v115
s_waitcnt vmcnt(17)
v_dot2c_f32_bf16 v72, s90, v116
v_dot2c_f32_bf16 v73, s91, v116
v_dot2c_f32_bf16 v74, s90, v117
v_dot2c_f32_bf16 v75, s91, v117
v_dot2c_f32_bf16 v76, s90, v118
v_dot2c_f32_bf16 v77, s91, v118
v_dot2c_f32_bf16 v78, s90, v119
v_dot2c_f32_bf16 v79, s91, v119
s_waitcnt vmcnt(16)
v_dot2c_f32_bf16 v72, s90, v120
v_dot2c_f32_bf16 v73, s91, v120
v_dot2c_f32_bf16 v74, s90, v121
v_dot2c_f32_bf16 v75, s91, v121
v_dot2c_f32_bf16 v76, s90, v122
v_dot2c_f32_bf16 v77, s91, v122
v_dot2c_f32_bf16 v78, s90, v123
v_dot2c_f32_bf16 v79, s91, v123
s_waitcnt vmcnt(15)
v_dot2c_f32_bf16 v72, s90, v124
v_dot2c_f32_bf16 v73, s91, v124
v_dot2c_f32_bf16 v74, s90, v125
v_dot2c_f32_bf16 v75, s91, v125
v_dot2c_f32_bf16 v76, s90, v126
v_dot2c_f32_bf16 v77, s91, v126
v_dot2c_f32_bf16 v78, s90, v127
v_dot2c_f32_bf16 v79, s91, v127
s_waitcnt vmcnt(14)
v_dot2c_f32_bf16 v72, s90, v128
v_dot2c_f32_bf16 v73, s91, v128
v_dot2c_f32_bf16 v74, s90, v129
v_dot2c_f32_bf16 v75, s91, v129
v_dot2c_f32_bf16 v76, s90, v130
v_dot2c_f32_bf16 v77, s91, v130
v_dot2c_f32_bf16 v78, s90, v131
v_dot2c_f32_bf16 v79, s91, v131
s_nop 2
v_cvt_pk_bf16_f32 v58, v72, v73
v_cvt_pk_bf16_f32 v59, v74, v75
v_cvt_pk_bf16_f32 v60, v76, v77
v_cvt_pk_bf16_f32 v61, v78, v79
v_lshlrev_b32 v72, 16, v58
v_and_b32 v73, 0xffff0000, v58
v_lshlrev_b32 v74, 16, v59
v_and_b32 v75, 0xffff0000, v59
v_lshlrev_b32 v76, 16, v60
v_and_b32 v77, 0xffff0000, v60
v_lshlrev_b32 v78, 16, v61
v_and_b32 v79, 0xffff0000, v61
v_pk_mul_f32 v[72:73], v[72:73], v[38:39]
v_pk_mul_f32 v[74:75], v[74:75], v[40:41]
v_pk_mul_f32 v[76:77], v[76:77], v[42:43]
v_pk_mul_f32 v[78:79], v[78:79], v[44:45]
v_cvt_pk_bf16_f32 v58, v72, v73
v_cvt_pk_bf16_f32 v59, v74, v75
v_cvt_pk_bf16_f32 v60, v76, v77
v_cvt_pk_bf16_f32 v61, v78, v79
v_lshlrev_b32 v72, 16, v58
v_and_b32 v73, 0xffff0000, v58
v_lshlrev_b32 v74, 16, v59
v_and_b32 v75, 0xffff0000, v59
v_lshlrev_b32 v76, 16, v60
v_and_b32 v77, 0xffff0000, v60
v_lshlrev_b32 v78, 16, v61
v_and_b32 v79, 0xffff0000, v61
v_pk_add_f32 v[72:73], v[72:73], v[18:19]
v_pk_add_f32 v[74:75], v[74:75], v[20:21]
v_pk_add_f32 v[76:77], v[76:77], v[22:23]
v_pk_add_f32 v[78:79], v[78:79], v[24:25]
v_cvt_pk_bf16_f32 v72, v72, v73
v_cvt_pk_bf16_f32 v73, v74, v75
v_cvt_pk_bf16_f32 v74, v76, v77
v_cvt_pk_bf16_f32 v75, v78, v79
buffer_store_dwordx4 v[72:75], v248, s[60:63], 0 offen
s_waitcnt vmcnt(1)
v_cmp_gt_u32 vcc, 2, v230
s_nop 0
s_and_b32 s29, vcc_lo, 0xff
s_cbranch_scc1 SP_P2B
SP_P2B_RET:
buffer_load_dwordx4 v[80:83], v243, s[20:23], s65 offen offset:3072 sc0 sc1
buffer_load_dwordx4 v[84:87], v243, s[20:23], s66 offen offset:2048 sc0 sc1
buffer_load_dwordx4 v[88:91], v243, s[20:23], s67 offen offset:1024 sc0 sc1
buffer_load_dwordx4 v[92:95], v243, s[20:23], s68 offen offset:0 sc0 sc1
buffer_load_dwordx4 v[96:99], v243, s[20:23], s69 offen offset:3072 sc0 sc1
buffer_load_dwordx4 v[100:103], v243, s[20:23], s70 offen offset:2048 sc0 sc1
buffer_load_dwordx4 v[132:135], v243, s[20:23], s71 offen offset:1024 sc0 sc1
s_waitcnt vmcnt(17)
v_dot2c_f32_bf16 v66, s90, v200
v_dot2c_f32_bf16 v67, s91, v200
v_dot2c_f32_bf16 v68, s90, v201
v_dot2c_f32_bf16 v69, s91, v201
s_waitcnt vmcnt(16)
v_dot2c_f32_bf16 v66, s90, v202
v_dot2c_f32_bf16 v67, s91, v202
v_dot2c_f32_bf16 v68, s90, v203
v_dot2c_f32_bf16 v69, s91, v203
s_waitcnt vmcnt(15)
v_dot2c_f32_bf16 v66, s90, v204
v_dot2c_f32_bf16 v67, s91, v204
v_dot2c_f32_bf16 v68, s90, v205
v_dot2c_f32_bf16 v69, s91, v205
s_waitcnt vmcnt(14)
v_dot2c_f32_bf16 v66, s90, v206
v_dot2c_f32_bf16 v67, s91, v206
v_dot2c_f32_bf16 v68, s90, v207
v_dot2c_f32_bf16 v69, s91, v207
s_waitcnt vmcnt(13)
v_dot2c_f32_bf16 v66, s90, v208
v_dot2c_f32_bf16 v67, s91, v208
v_dot2c_f32_bf16 v68, s90, v209
v_dot2c_f32_bf16 v69, s91, v209
s_waitcnt vmcnt(12)
v_dot2c_f32_bf16 v66, s90, v210
v_dot2c_f32_bf16 v67, s91, v210
v_dot2c_f32_bf16 v68, s90, v211
v_dot2c_f32_bf16 v69, s91, v211
s_waitcnt vmcnt(11)
v_dot2c_f32_bf16 v66, s90, v212
v_dot2c_f32_bf16 v67, s91, v212
v_dot2c_f32_bf16 v68, s90, v213
v_dot2c_f32_bf16 v69, s91, v213
s_waitcnt vmcnt(10)
v_dot2c_f32_bf16 v66, s90, v214
v_dot2c_f32_bf16 v67, s91, v214
v_dot2c_f32_bf16 v68, s90, v215
v_dot2c_f32_bf16 v69, s91, v215
s_nop 2
s_cmp_eq_u32 s34, 0
s_cselect_b32 s29, 0, 0x7fbffff0
v_cvt_pk_bf16_f32 v58, v66, v67
v_cvt_pk_bf16_f32 v59, v68, v69
v_lshlrev_b32 v66, 16, v58
v_and_b32 v67, 0xffff0000, v58
v_lshlrev_b32 v68, 16, v59
v_and_b32 v69, 0xffff0000, v59
v_pk_mul_f32 v[66:67], v[66:67], v[54:55]
v_pk_mul_f32 v[68:69], v[68:69], v[56:57]
v_cvt_pk_bf16_f32 v58, v66, v67
v_cvt_pk_bf16_f32 v59, v68, v69
v_lshlrev_b32 v66, 16, v58
v_and_b32 v67, 0xffff0000, v58
v_lshlrev_b32 v68, 16, v59
v_and_b32 v69, 0xffff0000, v59
v_pk_add_f32 v[66:67], v[66:67], v[34:35]
v_pk_add_f32 v[68:69], v[68:69], v[36:37]
v_cvt_pk_bf16_f32 v66, v66, v67
v_cvt_pk_bf16_f32 v67, v68, v69
buffer_store_dwordx2 v[66:67], v249, s[60:63], s29 offen
s_waitcnt vmcnt(7)
v_dot2c_f32_bf16 v136, s90, v80
v_dot2c_f32_bf16 v137, s91, v80
v_dot2c_f32_bf16 v138, s90, v81
v_dot2c_f32_bf16 v139, s91, v81
v_dot2c_f32_bf16 v140, s90, v82
v_dot2c_f32_bf16 v141, s91, v82
v_dot2c_f32_bf16 v142, s90, v83
v_dot2c_f32_bf16 v143, s91, v83
s_waitcnt vmcnt(6)
v_dot2c_f32_bf16 v136, s90, v84
v_dot2c_f32_bf16 v137, s91, v84
v_dot2c_f32_bf16 v138, s90, v85
v_dot2c_f32_bf16 v139, s91, v85
v_dot2c_f32_bf16 v140, s90, v86
v_dot2c_f32_bf16 v141, s91, v86
v_dot2c_f32_bf16 v142, s90, v87
v_dot2c_f32_bf16 v143, s91, v87
s_waitcnt vmcnt(5)
v_dot2c_f32_bf16 v136, s90, v88
v_dot2c_f32_bf16 v137, s91, v88
v_dot2c_f32_bf16 v138, s90, v89
v_dot2c_f32_bf16 v139, s91, v89
v_dot2c_f32_bf16 v140, s90, v90
v_dot2c_f32_bf16 v141, s91, v90
v_dot2c_f32_bf16 v142, s90, v91
v_dot2c_f32_bf16 v143, s91, v91
s_waitcnt vmcnt(4)
v_dot2c_f32_bf16 v136, s90, v92
v_dot2c_f32_bf16 v137, s91, v92
v_dot2c_f32_bf16 v138, s90, v93
v_dot2c_f32_bf16 v139, s91, v93
v_dot2c_f32_bf16 v140, s90, v94
v_dot2c_f32_bf16 v141, s91, v94
v_dot2c_f32_bf16 v142, s90, v95
v_dot2c_f32_bf16 v143, s91, v95
s_waitcnt vmcnt(3)
v_dot2c_f32_bf16 v136, s90, v96
v_dot2c_f32_bf16 v137, s91, v96
v_dot2c_f32_bf16 v138, s90, v97
v_dot2c_f32_bf16 v139, s91, v97
v_dot2c_f32_bf16 v140, s90, v98
v_dot2c_f32_bf16 v141, s91, v98
v_dot2c_f32_bf16 v142, s90, v99
v_dot2c_f32_bf16 v143, s91, v99
s_waitcnt vmcnt(2)
v_dot2c_f32_bf16 v136, s90, v100
v_dot2c_f32_bf16 v137, s91, v100
v_dot2c_f32_bf16 v138, s90, v101
v_dot2c_f32_bf16 v139, s91, v101
v_dot2c_f32_bf16 v140, s90, v102
v_dot2c_f32_bf16 v141, s91, v102
v_dot2c_f32_bf16 v142, s90, v103
v_dot2c_f32_bf16 v143, s91, v103
s_waitcnt vmcnt(1)
v_dot2c_f32_bf16 v136, s90, v132
v_dot2c_f32_bf16 v137, s91, v132
v_dot2c_f32_bf16 v138, s90, v133
v_dot2c_f32_bf16 v139, s91, v133
v_dot2c_f32_bf16 v140, s90, v134
v_dot2c_f32_bf16 v141, s91, v134
v_dot2c_f32_bf16 v142, s90, v135
v_dot2c_f32_bf16 v143, s91, v135
s_nop 2
v_cvt_pk_bf16_f32 v58, v136, v137
v_cvt_pk_bf16_f32 v59, v138, v139
v_cvt_pk_bf16_f32 v60, v140, v141
v_cvt_pk_bf16_f32 v61, v142, v143
v_lshlrev_b32 v136, 16, v58
v_and_b32 v137, 0xffff0000, v58
v_lshlrev_b32 v138, 16, v59
v_and_b32 v139, 0xffff0000, v59
v_lshlrev_b32 v140, 16, v60
v_and_b32 v141, 0xffff0000, v60
v_lshlrev_b32 v142, 16, v61
v_and_b32 v143, 0xffff0000, v61
v_pk_mul_f32 v[136:137], v[136:137], v[46:47]
v_pk_mul_f32 v[138:139], v[138:139], v[48:49]
v_pk_mul_f32 v[140:141], v[140:141], v[50:51]
v_pk_mul_f32 v[142:143], v[142:143], v[52:53]
v_cvt_pk_bf16_f32 v58, v136, v137
v_cvt_pk_bf16_f32 v59, v138, v139
v_cvt_pk_bf16_f32 v60, v140, v141
v_cvt_pk_bf16_f32 v61, v142, v143
v_lshlrev_b32 v136, 16, v58
v_and_b32 v137, 0xffff0000, v58
v_lshlrev_b32 v138, 16, v59
v_and_b32 v139, 0xffff0000, v59
v_lshlrev_b32 v140, 16, v60
v_and_b32 v141, 0xffff0000, v60
v_lshlrev_b32 v142, 16, v61
v_and_b32 v143, 0xffff0000, v61
v_pk_add_f32 v[136:137], v[136:137], v[26:27]
v_pk_add_f32 v[138:139], v[138:139], v[28:29]
v_pk_add_f32 v[140:141], v[140:141], v[30:31]
v_pk_add_f32 v[142:143], v[142:143], v[32:33]
v_cvt_pk_bf16_f32 v136, v136, v137
v_cvt_pk_bf16_f32 v137, v138, v139
v_cvt_pk_bf16_f32 v138, v140, v141
v_cvt_pk_bf16_f32 v139, v142, v143
buffer_store_dwordx4 v[136:139], v248, s[60:63], 0 offen offset:128
s_endpgm
SP_O1B:
s_sleep 1
s_add_u32 s100, s100, 1
s_bitcmp1_b32 s100, 19
s_cbranch_scc1 K_END
buffer_load_dword v230, v229, s[20:23], s94 offen sc0 sc1
s_waitcnt vmcnt(0)
v_cmp_gt_u32 vcc, 1, v230
s_bitcmp1_b32 vcc_lo, s39
s_cbranch_scc1 SP_O1B
s_branch SP_O1B_RET
SP_O2B:
s_sleep 1
s_add_u32 s100, s100, 1
s_bitcmp1_b32 s100, 19
s_cbranch_scc1 K_END
buffer_load_dword v230, v229, s[20:23], s94 offen sc0 sc1
s_waitcnt vmcnt(0)
v_cmp_gt_u32 vcc, 1, v230
s_and_b32 s29, vcc_lo, 15
s_cbranch_scc1 SP_O2B
s_branch SP_O2B_RET
SP_O3B:
s_sleep 1
s_add_u32 s100, s100, 1
s_bitcmp1_b32 s100, 19
s_cbranch_scc1 K_END
buffer_load_dword v230, v229, s[20:23], s94 offen sc0 sc1
s_waitcnt vmcnt(0)
v_cmp_gt_u32 vcc, 2, v230
s_and_b32 s29, vcc_lo, 15
s_cbranch_scc1 SP_O3B
s_branch SP_O3B_RET
SP_P1B:
s_sleep 1
s_add_u32 s100, s100, 1
s_bitcmp1_b32 s100, 19
s_cbranch_scc1 K_END
buffer_load_dword v230, v229, s[20:23], s95 offen sc0 sc1
s_waitcnt vmcnt(0)
v_cmp_gt_u32 vcc, 1, v230
s_and_b32 s29, vcc_lo, 0xff
s_cbranch_scc1 SP_P1B
s_branch SP_P1B_RET
SP_P2B:
s_sleep 1
s_add_u32 s100, s100, 1
s_bitcmp1_b32 s100, 19
s_cbranch_scc1 K_END
buffer_load_dword v230, v229, s[20:23], s95 offen sc0 sc1
s_waitcnt vmcnt(0)
v_cmp_gt_u32 vcc, 2, v230
s_and_b32 s29, vcc_lo, 0xff
s_cbranch_scc1 SP_P2B
s_branch SP_P2B_RET
K_FALLBACK:
s_mov_b32 s43, 1
s_mov_b32 s3, 2
s_mov_b32 s86, 0x30000
s_mov_b32 s66, 0
s_mov_b32 s70, 0
s_mov_b32 s74, 0
s_waitcnt vmcnt(0) lgkmcnt(0)
s_barrier
v_mov_b32 v254, 0x7ffffff0
v_lshrrev_b32 v240, 2, v1
v_mul_u32_u24 v240, 0x2400, v240
v_and_b32 v246, 3, v1
v_lshl_add_u32 v240, v246, 4, v240
v_mul_u32_u24 v243, 3641, v1
v_lshrrev_b32 v243, 16, v243
v_mul_u32_u24 v243, 864, v243
v_add_u32 v243, v243, v244
v_mov_b32 v136, 0xff800000
v_mov_b32 v140, 0xff800000
v_mov_b32 v144, 0xff800000
v_mov_b32 v148, 0xff800000
s_mov_b32 s32, 0
s_mov_b32 s33, 32
K_FBLOOP:
s_add_u32 m0, s30, 81920
s_nop 0
buffer_load_dwordx4 v228, s[8:11], s32 offen offset:0 lds
buffer_load_dwordx4 v229, s[8:11], s32 offen offset:1024 lds
buffer_load_dwordx4 v230, s[8:11], s32 offen offset:2048 lds
buffer_load_dwordx4 v231, s[8:11], s32 offen offset:3072 lds
s_waitcnt vmcnt(0)
s_barrier
ds_read_b128 a[144:147], v216 offset:16384
ds_read_b128 a[148:151], v217 offset:16384
ds_read_b128 a[152:155], v218 offset:16384
ds_read_b128 a[156:159], v219 offset:16384
ds_read_b128 a[160:163], v216 offset:20480
ds_read_b128 a[164:167], v217 offset:20480
ds_read_b128 a[168:171], v218 offset:20480
ds_read_b128 a[172:175], v219 offset:20480
s_waitcnt lgkmcnt(0)
v_mfma_f32_16x16x32_bf16 v[8:11], a[144:147], v[152:155], 0
v_mfma_f32_16x16x32_bf16 v[16:19], a[144:147], v[168:171], 0
v_mfma_f32_16x16x32_bf16 v[24:27], a[144:147], v[184:187], 0
v_mfma_f32_16x16x32_bf16 v[32:35], a[144:147], v[200:203], 0
v_mfma_f32_16x16x32_bf16 v[8:11], a[148:151], v[156:159], v[8:11]
v_mfma_f32_16x16x32_bf16 v[16:19], a[148:151], v[172:175], v[16:19]
v_mfma_f32_16x16x32_bf16 v[24:27], a[148:151], v[188:191], v[24:27]
v_mfma_f32_16x16x32_bf16 v[32:35], a[148:151], v[204:207], v[32:35]
v_mfma_f32_16x16x32_bf16 v[8:11], a[152:155], v[160:163], v[8:11]
v_mfma_f32_16x16x32_bf16 v[16:19], a[152:155], v[176:179], v[16:19]
v_mfma_f32_16x16x32_bf16 v[24:27], a[152:155], v[192:195], v[24:27]
v_mfma_f32_16x16x32_bf16 v[32:35], a[152:155], v[208:211], v[32:35]
v_mfma_f32_16x16x32_bf16 v[8:11], a[156:159], v[164:167], v[8:11]
v_mfma_f32_16x16x32_bf16 v[16:19], a[156:159], v[180:183], v[16:19]
v_mfma_f32_16x16x32_bf16 v[24:27], a[156:159], v[196:199], v[24:27]
v_mfma_f32_16x16x32_bf16 v[32:35], a[156:159], v[212:215], v[32:35]
v_mfma_f32_16x16x32_bf16 v[12:15], a[160:163], v[152:155], 0
v_mfma_f32_16x16x32_bf16 v[20:23], a[160:163], v[168:171], 0
v_mfma_f32_16x16x32_bf16 v[28:31], a[160:163], v[184:187], 0
v_mfma_f32_16x16x32_bf16 v[36:39], a[160:163], v[200:203], 0
v_mfma_f32_16x16x32_bf16 v[12:15], a[164:167], v[156:159], v[12:15]
v_mfma_f32_16x16x32_bf16 v[20:23], a[164:167], v[172:175], v[20:23]
v_mfma_f32_16x16x32_bf16 v[28:31], a[164:167], v[188:191], v[28:31]
v_mfma_f32_16x16x32_bf16 v[36:39], a[164:167], v[204:207], v[36:39]
v_mfma_f32_16x16x32_bf16 v[12:15], a[168:171], v[160:163], v[12:15]
v_mfma_f32_16x16x32_bf16 v[20:23], a[168:171], v[176:179], v[20:23]
v_mfma_f32_16x16x32_bf16 v[28:31], a[168:171], v[192:195], v[28:31]
v_mfma_f32_16x16x32_bf16 v[36:39], a[168:171], v[208:211], v[36:39]
v_mfma_f32_16x16x32_bf16 v[12:15], a[172:175], v[164:167], v[12:15]
v_mfma_f32_16x16x32_bf16 v[20:23], a[172:175], v[180:183], v[20:23]
v_mfma_f32_16x16x32_bf16 v[28:31], a[172:175], v[196:199], v[28:31]
v_mfma_f32_16x16x32_bf16 v[36:39], a[172:175], v[212:215], v[36:39]
s_nop 7
s_nop 3
v_max3_f32 v136, v136, v8, v9
v_max3_f32 v136, v136, v10, v11
v_max3_f32 v136, v136, v12, v13
v_max3_f32 v136, v136, v14, v15
v_max3_f32 v140, v140, v16, v17
v_max3_f32 v140, v140, v18, v19
v_max3_f32 v140, v140, v20, v21
v_max3_f32 v140, v140, v22, v23
v_max3_f32 v144, v144, v24, v25
v_max3_f32 v144, v144, v26, v27
v_max3_f32 v144, v144, v28, v29
v_max3_f32 v144, v144, v30, v31
v_max3_f32 v148, v148, v32, v33
v_max3_f32 v148, v148, v34, v35
v_max3_f32 v148, v148, v36, v37
v_max3_f32 v148, v148, v38, v39
ds_read_b128 a[144:147], v216 offset:24576
ds_read_b128 a[148:151], v217 offset:24576
ds_read_b128 a[152:155], v218 offset:24576
ds_read_b128 a[156:159], v219 offset:24576
ds_read_b128 a[160:163], v216 offset:28672
ds_read_b128 a[164:167], v217 offset:28672
ds_read_b128 a[168:171], v218 offset:28672
ds_read_b128 a[172:175], v219 offset:28672
s_waitcnt lgkmcnt(0)
v_mfma_f32_16x16x32_bf16 v[8:11], a[144:147], v[152:155], 0
v_mfma_f32_16x16x32_bf16 v[16:19], a[144:147], v[168:171], 0
v_mfma_f32_16x16x32_bf16 v[24:27], a[144:147], v[184:187], 0
v_mfma_f32_16x16x32_bf16 v[32:35], a[144:147], v[200:203], 0
v_mfma_f32_16x16x32_bf16 v[8:11], a[148:151], v[156:159], v[8:11]
v_mfma_f32_16x16x32_bf16 v[16:19], a[148:151], v[172:175], v[16:19]
v_mfma_f32_16x16x32_bf16 v[24:27], a[148:151], v[188:191], v[24:27]
v_mfma_f32_16x16x32_bf16 v[32:35], a[148:151], v[204:207], v[32:35]
v_mfma_f32_16x16x32_bf16 v[8:11], a[152:155], v[160:163], v[8:11]
v_mfma_f32_16x16x32_bf16 v[16:19], a[152:155], v[176:179], v[16:19]
v_mfma_f32_16x16x32_bf16 v[24:27], a[152:155], v[192:195], v[24:27]
v_mfma_f32_16x16x32_bf16 v[32:35], a[152:155], v[208:211], v[32:35]
v_mfma_f32_16x16x32_bf16 v[8:11], a[156:159], v[164:167], v[8:11]
v_mfma_f32_16x16x32_bf16 v[16:19], a[156:159], v[180:183], v[16:19]
v_mfma_f32_16x16x32_bf16 v[24:27], a[156:159], v[196:199], v[24:27]
v_mfma_f32_16x16x32_bf16 v[32:35], a[156:159], v[212:215], v[32:35]
v_mfma_f32_16x16x32_bf16 v[12:15], a[160:163], v[152:155], 0
v_mfma_f32_16x16x32_bf16 v[20:23], a[160:163], v[168:171], 0
v_mfma_f32_16x16x32_bf16 v[28:31], a[160:163], v[184:187], 0
v_mfma_f32_16x16x32_bf16 v[36:39], a[160:163], v[200:203], 0
v_mfma_f32_16x16x32_bf16 v[12:15], a[164:167], v[156:159], v[12:15]
v_mfma_f32_16x16x32_bf16 v[20:23], a[164:167], v[172:175], v[20:23]
v_mfma_f32_16x16x32_bf16 v[28:31], a[164:167], v[188:191], v[28:31]
v_mfma_f32_16x16x32_bf16 v[36:39], a[164:167], v[204:207], v[36:39]
v_mfma_f32_16x16x32_bf16 v[12:15], a[168:171], v[160:163], v[12:15]
v_mfma_f32_16x16x32_bf16 v[20:23], a[168:171], v[176:179], v[20:23]
v_mfma_f32_16x16x32_bf16 v[28:31], a[168:171], v[192:195], v[28:31]
v_mfma_f32_16x16x32_bf16 v[36:39], a[168:171], v[208:211], v[36:39]
v_mfma_f32_16x16x32_bf16 v[12:15], a[172:175], v[164:167], v[12:15]
v_mfma_f32_16x16x32_bf16 v[20:23], a[172:175], v[180:183], v[20:23]
v_mfma_f32_16x16x32_bf16 v[28:31], a[172:175], v[196:199], v[28:31]
v_mfma_f32_16x16x32_bf16 v[36:39], a[172:175], v[212:215], v[36:39]
s_nop 7
s_nop 3
v_max3_f32 v136, v136, v8, v9
v_max3_f32 v136, v136, v10, v11
v_max3_f32 v136, v136, v12, v13
v_max3_f32 v136, v136, v14, v15
v_max3_f32 v140, v140, v16, v17
v_max3_f32 v140, v140, v18, v19
v_max3_f32 v140, v140, v20, v21
v_max3_f32 v140, v140, v22, v23
v_max3_f32 v144, v144, v24, v25
v_max3_f32 v144, v144, v26, v27
v_max3_f32 v144, v144, v28, v29
v_max3_f32 v144, v144, v30, v31
v_max3_f32 v148, v148, v32, v33
v_max3_f32 v148, v148, v34, v35
v_max3_f32 v148, v148, v36, v37
v_max3_f32 v148, v148, v38, v39
s_barrier
s_add_u32 s32, s32, 16384
s_sub_u32 s33, s33, 1
s_cmp_lg_u32 s33, 0
s_cbranch_scc1 K_FBLOOP
v_mov_b32 v246, v136
s_nop 1
v_permlane16_swap_b32 v136, v246
v_max_f32 v136, v136, v246
v_mov_b32 v246, v136
s_nop 1
v_permlane32_swap_b32 v136, v246
v_max_f32 v136, v136, v246
v_sub_f32 v136, 0, v136
v_mov_b32 v137, v136
v_mov_b32 v138, v136
v_mov_b32 v139, v136
v_mov_b32 v246, v140
s_nop 1
v_permlane16_swap_b32 v140, v246
v_max_f32 v140, v140, v246
v_mov_b32 v246, v140
s_nop 1
v_permlane32_swap_b32 v140, v246
v_max_f32 v140, v140, v246
v_sub_f32 v140, 0, v140
v_mov_b32 v141, v140
v_mov_b32 v142, v140
v_mov_b32 v143, v140
v_mov_b32 v246, v144
s_nop 1
v_permlane16_swap_b32 v144, v246
v_max_f32 v144, v144, v246
v_mov_b32 v246, v144
s_nop 1
v_permlane32_swap_b32 v144, v246
v_max_f32 v144, v144, v246
v_sub_f32 v144, 0, v144
v_mov_b32 v145, v144
v_mov_b32 v146, v144
v_mov_b32 v147, v144
v_mov_b32 v246, v148
s_nop 1
v_permlane16_swap_b32 v148, v246
v_max_f32 v148, v148, v246
v_mov_b32 v246, v148
s_nop 1
v_permlane32_swap_b32 v148, v246
v_max_f32 v148, v148, v246
v_sub_f32 v148, 0, v148
v_mov_b32 v149, v148
v_mov_b32 v150, v148
v_mov_b32 v151, v148
s_add_u32 s32, s7, 0
s_add_u32 m0, s30, 81920
s_nop 0
buffer_load_dwordx4 v228, s[8:11], s32 offen offset:0 lds
buffer_load_dwordx4 v229, s[8:11], s32 offen offset:1024 lds
buffer_load_dwordx4 v230, s[8:11], s32 offen offset:2048 lds
buffer_load_dwordx4 v231, s[8:11], s32 offen offset:3072 lds
s_add_u32 s32, s7, 16384
s_add_u32 m0, s30, 114688
s_nop 0
buffer_load_dwordx4 v228, s[8:11], s32 offen offset:0 lds
buffer_load_dwordx4 v229, s[8:11], s32 offen offset:1024 lds
buffer_load_dwordx4 v230, s[8:11], s32 offen offset:2048 lds
buffer_load_dwordx4 v231, s[8:11], s32 offen offset:3072 lds
s_add_u32 s39, s7, 0
s_add_u32 m0, s30, 131072
s_nop 0
buffer_load_dwordx4 v232, s[12:15], s39 offen offset:0 lds
buffer_load_dwordx4 v233, s[12:15], s39 offen offset:1024 lds
buffer_load_dwordx4 v232, s[12:15], s39 offen offset:2048 lds
buffer_load_dwordx4 v233, s[12:15], s39 offen offset:3072 lds
s_waitcnt vmcnt(0)
s_branch K_PRE
K_CODE_END:
.section .rodata,"a"
.p2align 6
.amdhsa_kernel recurrent_scan__gqa_block_cached__moe_arch_mod__prompt_kernel
  .amdhsa_next_free_vgpr 512
  .amdhsa_next_free_sgpr 102
  .amdhsa_accum_offset 256
  .amdhsa_group_segment_fixed_size 0
  .amdhsa_kernarg_size 104
  .amdhsa_user_sgpr_count 2
  .amdhsa_user_sgpr_kernarg_segment_ptr 1
  .amdhsa_system_sgpr_workgroup_id_x 1
  .amdhsa_float_denorm_mode_32 3
.end_amdhsa_kernel
```

```asm
; @launch grid=(256,1,1) block=(256,1,1) lds=163840
.amdgcn_target "amdgcn-amd-amdhsa--gfx950"
.text
.globl recurrent_scan__gqa_block_cached__moe_arch_mod__prompt_kernel
.p2align 8
.type recurrent_scan__gqa_block_cached__moe_arch_mod__prompt_kernel,@function
recurrent_scan__gqa_block_cached__moe_arch_mod__prompt_kernel:
s_cmp_ge_u32 s2, 256
s_cbranch_scc1 K_END
s_mov_b32 s100, 0
s_load_dwordx16 s[64:79], s[0:1], 0
s_load_dwordx8 s[80:87], s[0:1], 64
s_load_dwordx2 s[88:89], s[0:1], 96
s_lshr_b32 s35, s2, 3
s_and_b32 s36, s2, 7
s_mul_i32 s5, s36, 9
s_lshr_b32 s5, s5, 2
s_lshl_b32 s3, s36, 8
s_lshl_b32 s28, s35, 3
s_add_u32 s3, s3, s28
v_lshrrev_b32 v5, 5, v0
v_add_u32 v5, s3, v5
v_and_b32 v6, 31, v0
v_mul_u32_u24 v7, 0x480, v5
v_lshl_add_u32 v7, v6, 2, v7
v_and_b32 v1, 63, v0
v_lshrrev_b32 v2, 6, v0
v_lshlrev_b32 v8, 2, v6
v_readfirstlane_b32 s37, v2
v_and_b32 v3, 15, v1
v_lshrrev_b32 v4, 4, v1
s_waitcnt lgkmcnt(0)
s_mov_b32 s52, s64
s_and_b32 s53, s65, 0xffff
s_mov_b32 s54, 0x240000
s_mov_b32 s55, 0x00020000
buffer_load_dword v18, v7, s[52:55], 0 offen offset:0
buffer_load_dword v19, v7, s[52:55], 0 offen offset:128
buffer_load_dword v20, v7, s[52:55], 0 offen offset:256
buffer_load_dword v21, v7, s[52:55], 0 offen offset:384
buffer_load_dword v22, v7, s[52:55], 0 offen offset:512
buffer_load_dword v23, v7, s[52:55], 0 offen offset:640
buffer_load_dword v24, v7, s[52:55], 0 offen offset:768
buffer_load_dword v25, v7, s[52:55], 0 offen offset:896
buffer_load_dword v26, v7, s[52:55], 0 offen offset:1024
s_mov_b32 s28, 0x24c000
s_load_dwordx2 s[6:7], s[88:89], s28
s_mov_b32 s92, s76
s_and_b32 s93, s77, 0xffff
s_mov_b32 s94, 0x480
s_mov_b32 s95, 0x00020000
buffer_load_dword v28, v8, s[92:95], 0 offen offset:0
buffer_load_dword v29, v8, s[92:95], 0 offen offset:128
buffer_load_dword v30, v8, s[92:95], 0 offen offset:256
buffer_load_dword v31, v8, s[92:95], 0 offen offset:384
buffer_load_dword v32, v8, s[92:95], 0 offen offset:512
buffer_load_dword v33, v8, s[92:95], 0 offen offset:640
buffer_load_dword v34, v8, s[92:95], 0 offen offset:768
buffer_load_dword v35, v8, s[92:95], 0 offen offset:896
buffer_load_dword v36, v8, s[92:95], 0 offen offset:1024
s_mov_b32 s20, s88
s_and_b32 s21, s89, 0xffff
s_mov_b32 s22, 0x8000000
s_mov_b32 s23, 0x00020000
s_lshr_b32 s45, s3, 4
s_mul_i32 s45, s45, 18432
s_and_b32 s29, s3, 15
s_lshl_b32 s29, s29, 4
s_add_u32 s45, s45, s29
v_lshrrev_b32 v9, 1, v0
v_lshlrev_b32 v9, 8, v9
v_and_b32 v10, 1, v0
v_lshl_add_u32 v9, v10, 6, v9
s_add_u32 s29, s45, 0x1800000
v_add_u32 v9, s29, v9
s_lshl_b32 s28, s36, 8
s_add_u32 s28, s28, 0x24ac00
v_lshlrev_b32 v10, 6, v0
v_add_u32 v10, s28, v10
v_cmp_lt_u32 vcc, 143, v0
s_lshl_b32 s29, s3, 2
s_add_u32 s29, s29, 0x1a40000
v_cndmask_b32 v9, v9, v10, vcc
v_mov_b32 v10, s29
v_cmp_lt_u32 vcc, 147, v0
s_nop 1
v_cndmask_b32 v9, v9, v10, vcc
buffer_load_dword v176, v9, s[20:23], 0 offen sc1
s_getpc_b64 s[96:97]
PC_a:
s_sub_u32 s96, s96, PC_a-recurrent_scan__gqa_block_cached__moe_arch_mod__prompt_kernel
s_subb_u32 s97, s97, 0
s_lshl_b32 s50, s35, 2
s_add_u32 s50, s50, s37
s_min_u32 s50, s50, ((K_HOT_END-recurrent_scan__gqa_block_cached__moe_arch_mod__prompt_kernel)>>10)-1
s_lshl_b32 s50, s50, 10
v_lshlrev_b32 v11, 4, v1
v_add_u32 v11, s50, v11
global_load_dwordx4 v[172:175], v11, s[96:97]
s_mov_b32 s16, s70
s_and_b32 s17, s71, 0xffff
s_mov_b32 s18, 0x480000
s_mov_b32 s19, 0x00020000
v_add_u32 v9, 0, v4
v_lshlrev_b32 v10, 1, v9
v_xor_b32 v10, v10, v3
v_lshlrev_b32 v10, 4, v10
v_lshl_add_u32 v238, v9, 13, v10
v_add_u32 v9, 4, v4
v_lshlrev_b32 v10, 1, v9
v_xor_b32 v10, v10, v3
v_lshlrev_b32 v10, 4, v10
v_lshl_add_u32 v239, v9, 13, v10
v_subrev_u32 v239, 1024, v239
s_cmp_eq_u32 s37, 0
s_cbranch_scc1 F_NOWQ
s_sub_u32 s28, s37, 1
s_lshl_b32 s49, s28, 11
s_lshl_b32 s28, s28, 16
s_lshl_b32 s34, s35, 8
s_add_u32 s34, s34, s28
s_lshl_b32 s28, s5, 18
s_add_u32 s34, s34, s28
s_add_u32 m0, s49, 65536
s_nop 0
buffer_load_dwordx4 v238, s[16:19], s34 offen offset:0 lds
buffer_load_dwordx4 v239, s[16:19], s34 offen offset:1024 lds
s_add_u32 s34, s34, 196608
s_sub_u32 s51, s34, 4718592
s_cselect_b32 s34, s34, s51
s_add_u32 m0, s49, 71680
s_nop 0
buffer_load_dwordx4 v238, s[16:19], s34 offen offset:0 lds
buffer_load_dwordx4 v239, s[16:19], s34 offen offset:1024 lds
s_add_u32 s34, s34, 196608
s_sub_u32 s51, s34, 4718592
s_cselect_b32 s34, s34, s51
s_add_u32 m0, s49, 77824
s_nop 0
buffer_load_dwordx4 v238, s[16:19], s34 offen offset:0 lds
buffer_load_dwordx4 v239, s[16:19], s34 offen offset:1024 lds
s_add_u32 s34, s34, 196608
s_sub_u32 s51, s34, 4718592
s_cselect_b32 s34, s34, s51
s_add_u32 m0, s49, 83968
s_nop 0
buffer_load_dwordx4 v238, s[16:19], s34 offen offset:0 lds
buffer_load_dwordx4 v239, s[16:19], s34 offen offset:1024 lds
s_add_u32 s34, s34, 196608
s_sub_u32 s51, s34, 4718592
s_cselect_b32 s34, s34, s51
F_NOWQ:
s_getreg_b32 s38, hwreg(HW_REG_XCC_ID, 0, 4)
s_mov_b32 s24, s86
s_and_b32 s25, s87, 0xffff
s_mov_b32 s26, 0x100
s_mov_b32 s27, 0x00020000
v_and_b32 v66, 7, v1
v_mul_u32_u24 v67, 1168, v66
v_lshrrev_b32 v68, 5, v1
v_lshl_add_u32 v67, v68, 6, v67
v_bfe_u32 v69, v1, 3, 2
v_lshl_add_u32 v67, v69, 3, v67
v_add_u32 v168, 0x24000, v67
v_lshlrev_b32 v70, 10, v68
v_lshl_add_u32 v71, v69, 4, v66
v_lshl_add_u32 v169, v71, 4, v70
v_lshlrev_b32 v244, 4, v1
v_bfe_u32 v9, v1, 2, 2
v_and_b32 v10, 3, v1
v_lshl_add_u32 v11, v4, 2, v9
v_and_b32 v12, 7, v11
v_lshrrev_b32 v14, 1, v10
v_xor_b32 v14, v14, v12
v_and_b32 v15, 1, v10
v_lshlrev_b32 v15, 4, v15
v_lshl_add_u32 v15, v11, 8, v15
v_add_u32 v15, 0x10000, v15
v_xor_b32 v16, 0, v14
v_lshl_add_u32 v234, v16, 5, v15
v_xor_b32 v16, 2, v14
v_lshl_add_u32 v235, v16, 5, v15
v_xor_b32 v16, 4, v14
v_lshl_add_u32 v236, v16, 5, v15
v_xor_b32 v16, 6, v14
v_lshl_add_u32 v237, v16, 5, v15
s_lshl2_add_u32 s50, s36, s37
s_lshr_b32 s29, s35, 2
s_add_u32 s28, s29, 0
s_and_b32 s28, s28, 3
s_lshl2_add_u32 s28, s50, s28
s_mul_i32 s28, s28, 18432
v_add_u32 v240, s28, v244
s_add_u32 s28, s29, 1
s_and_b32 s28, s28, 3
s_lshl2_add_u32 s28, s50, s28
s_mul_i32 s28, s28, 18432
v_add_u32 v241, s28, v244
s_add_u32 s28, s29, 2
s_and_b32 s28, s28, 3
s_lshl2_add_u32 s28, s50, s28
s_mul_i32 s28, s28, 18432
v_add_u32 v242, s28, v244
s_add_u32 s28, s29, 3
s_and_b32 s28, s28, 3
s_lshl2_add_u32 s28, s50, s28
s_mul_i32 s28, s28, 18432
v_add_u32 v243, s28, v244
s_mov_b32 s46, 0
s_mov_b32 s76, 0x3ae38e39
s_mov_b32 s77, 0x3727c5ac
s_mov_b32 s75, 0xffff0000
s_cmp_eq_u32 s37, 0
s_cbranch_scc0 F_W1
s_waitcnt vmcnt(2)
s_branch F_W2
F_W1:
s_waitcnt vmcnt(10)
F_W2:
v_lshlrev_b32 v40, 16, v18
v_and_b32 v41, s75, v18
v_lshlrev_b32 v42, 16, v19
v_and_b32 v43, s75, v19
v_lshlrev_b32 v44, 16, v20
v_and_b32 v45, s75, v20
v_lshlrev_b32 v46, 16, v21
v_and_b32 v47, s75, v21
v_lshlrev_b32 v48, 16, v22
v_and_b32 v49, s75, v22
v_lshlrev_b32 v50, 16, v23
v_and_b32 v51, s75, v23
v_lshlrev_b32 v52, 16, v24
v_and_b32 v53, s75, v24
v_lshlrev_b32 v54, 16, v25
v_and_b32 v55, s75, v25
v_lshlrev_b32 v56, 16, v26
v_and_b32 v57, s75, v26
v_add_f32 v60, v40, v41
v_add_f32 v61, v42, v43
v_add_f32 v60, v60, v44
v_add_f32 v61, v61, v45
v_add_f32 v60, v60, v46
v_add_f32 v61, v61, v47
v_add_f32 v60, v60, v48
v_add_f32 v61, v61, v49
v_add_f32 v60, v60, v50
v_add_f32 v61, v61, v51
v_add_f32 v60, v60, v52
v_add_f32 v61, v61, v53
v_add_f32 v60, v60, v54
v_add_f32 v61, v61, v55
v_add_f32 v60, v60, v56
v_add_f32 v61, v61, v57
v_add_f32 v60, v60, v61
s_nop 1
v_add_f32_dpp v61, v60, v60 row_ror:8 row_mask:0xf bank_mask:0xf
s_nop 1
v_add_f32_dpp v60, v61, v61 row_ror:4 row_mask:0xf bank_mask:0xf
s_nop 1
v_add_f32_dpp v61, v60, v60 row_ror:2 row_mask:0xf bank_mask:0xf
s_nop 1
v_add_f32_dpp v60, v61, v61 row_ror:1 row_mask:0xf bank_mask:0xf
v_mov_b32 v61, v60
s_nop 1
v_permlane16_swap_b32 v60, v61
v_add_f32 v60, v60, v61
v_mul_f32 v60, s76, v60
v_sub_f32 v62, v40, v60
v_mul_f32 v61, v62, v62
v_sub_f32 v62, v41, v60
v_mul_f32 v63, v62, v62
v_sub_f32 v62, v42, v60
v_sub_f32 v64, v43, v60
v_fmac_f32 v61, v62, v62
v_fmac_f32 v63, v64, v64
v_sub_f32 v62, v44, v60
v_sub_f32 v64, v45, v60
v_fmac_f32 v61, v62, v62
v_fmac_f32 v63, v64, v64
v_sub_f32 v62, v46, v60
v_sub_f32 v64, v47, v60
v_fmac_f32 v61, v62, v62
v_fmac_f32 v63, v64, v64
v_sub_f32 v62, v48, v60
v_sub_f32 v64, v49, v60
v_fmac_f32 v61, v62, v62
v_fmac_f32 v63, v64, v64
v_sub_f32 v62, v50, v60
v_sub_f32 v64, v51, v60
v_fmac_f32 v61, v62, v62
v_fmac_f32 v63, v64, v64
v_sub_f32 v62, v52, v60
v_sub_f32 v64, v53, v60
v_fmac_f32 v61, v62, v62
v_fmac_f32 v63, v64, v64
v_sub_f32 v62, v54, v60
v_sub_f32 v64, v55, v60
v_fmac_f32 v61, v62, v62
v_fmac_f32 v63, v64, v64
v_sub_f32 v62, v56, v60
v_sub_f32 v64, v57, v60
v_fmac_f32 v61, v62, v62
v_fmac_f32 v63, v64, v64
v_add_f32 v61, v61, v63
s_nop 1
v_add_f32_dpp v62, v61, v61 row_ror:8 row_mask:0xf bank_mask:0xf
s_nop 1
v_add_f32_dpp v61, v62, v62 row_ror:4 row_mask:0xf bank_mask:0xf
s_nop 1
v_add_f32_dpp v62, v61, v61 row_ror:2 row_mask:0xf bank_mask:0xf
s_nop 1
v_add_f32_dpp v61, v62, v62 row_ror:1 row_mask:0xf bank_mask:0xf
v_mov_b32 v62, v61
s_nop 1
v_permlane16_swap_b32 v61, v62
v_add_f32 v61, v61, v62
v_mul_f32 v61, s76, v61
v_cvt_pk_bf16_f32 v60, v60, v60
v_lshlrev_b32 v60, 16, v60
v_cvt_pk_bf16_f32 v61, v61, v61
v_lshlrev_b32 v61, 16, v61
v_add_f32 v61, s77, v61
v_cvt_pk_bf16_f32 v61, v61, v61
v_lshlrev_b32 v61, 16, v61
v_sqrt_f32 v61, v61
s_nop 0
v_cvt_pk_bf16_f32 v61, v61, v61
v_lshlrev_b32 v61, 16, v61
v_rcp_f32 v62, v61
v_mov_b32 v63, 0
v_lshrrev_b32 v69, 5, v0
v_mul_u32_u24 v65, 1168, v69
v_lshl_add_u32 v65, v6, 2, v65
v_add_u32 v65, 0x24000, v65
v_sub_f32 v40, v40, v60
v_sub_f32 v41, v41, v60
v_cvt_pk_bf16_f32 v66, v40, v41
v_lshlrev_b32 v40, 16, v66
v_and_b32 v41, s75, v66
v_mul_f32 v67, v40, v62
v_mul_f32 v68, v41, v62
v_fma_f32 v40, -v67, v61, v40
v_fma_f32 v41, -v68, v61, v41
v_fmac_f32 v67, v40, v62
v_fmac_f32 v68, v41, v62
v_cvt_pk_bf16_f32 v18, v67, v68
v_dot2_f32_bf16 v63, v18, v28, v63
ds_write_b32 v65, v18 offset:0
v_sub_f32 v42, v42, v60
v_sub_f32 v43, v43, v60
v_cvt_pk_bf16_f32 v66, v42, v43
v_lshlrev_b32 v42, 16, v66
v_and_b32 v43, s75, v66
v_mul_f32 v67, v42, v62
v_mul_f32 v68, v43, v62
v_fma_f32 v42, -v67, v61, v42
v_fma_f32 v43, -v68, v61, v43
v_fmac_f32 v67, v42, v62
v_fmac_f32 v68, v43, v62
v_cvt_pk_bf16_f32 v19, v67, v68
v_dot2_f32_bf16 v63, v19, v29, v63
ds_write_b32 v65, v19 offset:128
v_sub_f32 v44, v44, v60
v_sub_f32 v45, v45, v60
v_cvt_pk_bf16_f32 v66, v44, v45
v_lshlrev_b32 v44, 16, v66
v_and_b32 v45, s75, v66
v_mul_f32 v67, v44, v62
v_mul_f32 v68, v45, v62
v_fma_f32 v44, -v67, v61, v44
v_fma_f32 v45, -v68, v61, v45
v_fmac_f32 v67, v44, v62
v_fmac_f32 v68, v45, v62
v_cvt_pk_bf16_f32 v20, v67, v68
v_dot2_f32_bf16 v63, v20, v30, v63
ds_write_b32 v65, v20 offset:256
v_sub_f32 v46, v46, v60
v_sub_f32 v47, v47, v60
v_cvt_pk_bf16_f32 v66, v46, v47
v_lshlrev_b32 v46, 16, v66
v_and_b32 v47, s75, v66
v_mul_f32 v67, v46, v62
v_mul_f32 v68, v47, v62
v_fma_f32 v46, -v67, v61, v46
v_fma_f32 v47, -v68, v61, v47
v_fmac_f32 v67, v46, v62
v_fmac_f32 v68, v47, v62
v_cvt_pk_bf16_f32 v21, v67, v68
v_dot2_f32_bf16 v63, v21, v31, v63
ds_write_b32 v65, v21 offset:384
v_sub_f32 v48, v48, v60
v_sub_f32 v49, v49, v60
v_cvt_pk_bf16_f32 v66, v48, v49
v_lshlrev_b32 v48, 16, v66
v_and_b32 v49, s75, v66
v_mul_f32 v67, v48, v62
v_mul_f32 v68, v49, v62
v_fma_f32 v48, -v67, v61, v48
v_fma_f32 v49, -v68, v61, v49
v_fmac_f32 v67, v48, v62
v_fmac_f32 v68, v49, v62
v_cvt_pk_bf16_f32 v22, v67, v68
v_dot2_f32_bf16 v63, v22, v32, v63
ds_write_b32 v65, v22 offset:512
v_sub_f32 v50, v50, v60
v_sub_f32 v51, v51, v60
v_cvt_pk_bf16_f32 v66, v50, v51
v_lshlrev_b32 v50, 16, v66
v_and_b32 v51, s75, v66
v_mul_f32 v67, v50, v62
v_mul_f32 v68, v51, v62
v_fma_f32 v50, -v67, v61, v50
v_fma_f32 v51, -v68, v61, v51
v_fmac_f32 v67, v50, v62
v_fmac_f32 v68, v51, v62
v_cvt_pk_bf16_f32 v23, v67, v68
v_dot2_f32_bf16 v63, v23, v33, v63
ds_write_b32 v65, v23 offset:640
v_sub_f32 v52, v52, v60
v_sub_f32 v53, v53, v60
v_cvt_pk_bf16_f32 v66, v52, v53
v_lshlrev_b32 v52, 16, v66
v_and_b32 v53, s75, v66
v_mul_f32 v67, v52, v62
v_mul_f32 v68, v53, v62
v_fma_f32 v52, -v67, v61, v52
v_fma_f32 v53, -v68, v61, v53
v_fmac_f32 v67, v52, v62
v_fmac_f32 v68, v53, v62
v_cvt_pk_bf16_f32 v24, v67, v68
v_dot2_f32_bf16 v63, v24, v34, v63
ds_write_b32 v65, v24 offset:768
v_sub_f32 v54, v54, v60
v_sub_f32 v55, v55, v60
v_cvt_pk_bf16_f32 v66, v54, v55
v_lshlrev_b32 v54, 16, v66
v_and_b32 v55, s75, v66
v_mul_f32 v67, v54, v62
v_mul_f32 v68, v55, v62
v_fma_f32 v54, -v67, v61, v54
v_fma_f32 v55, -v68, v61, v55
v_fmac_f32 v67, v54, v62
v_fmac_f32 v68, v55, v62
v_cvt_pk_bf16_f32 v25, v67, v68
v_dot2_f32_bf16 v63, v25, v35, v63
ds_write_b32 v65, v25 offset:896
v_sub_f32 v56, v56, v60
v_sub_f32 v57, v57, v60
v_cvt_pk_bf16_f32 v66, v56, v57
v_lshlrev_b32 v56, 16, v66
v_and_b32 v57, s75, v66
v_mul_f32 v67, v56, v62
v_mul_f32 v68, v57, v62
v_fma_f32 v56, -v67, v61, v56
v_fma_f32 v57, -v68, v61, v57
v_fmac_f32 v67, v56, v62
v_fmac_f32 v68, v57, v62
v_cvt_pk_bf16_f32 v26, v67, v68
v_dot2_f32_bf16 v63, v26, v36, v63
ds_write_b32 v65, v26 offset:1024
s_nop 2
s_nop 1
v_add_f32_dpp v62, v63, v63 row_ror:8 row_mask:0xf bank_mask:0xf
s_nop 1
v_add_f32_dpp v63, v62, v62 row_ror:4 row_mask:0xf bank_mask:0xf
s_nop 1
v_add_f32_dpp v62, v63, v63 row_ror:2 row_mask:0xf bank_mask:0xf
s_nop 1
v_add_f32_dpp v63, v62, v62 row_ror:1 row_mask:0xf bank_mask:0xf
v_mov_b32 v62, v63
s_nop 1
v_permlane16_swap_b32 v63, v62
v_add_f32 v63, v63, v62
v_cvt_pk_bf16_f32 v63, v63, v63
v_lshlrev_b32 v63, 16, v63
v_ashrrev_i32 v66, 31, v63
v_or_b32 v66, 0x80000000, v66
v_xor_b32 v63, v63, v66
v_and_b32 v63, s75, v63
v_sub_u32 v66, 0xffff, v5
v_or_b32 v63, v63, v66
v_lshlrev_b32 v66, 2, v69
v_add_u32 v66, 0x26480, v66
ds_write_b32 v66, v63
v_and_b32 v64, 7, v1
v_lshlrev_b32 v64, 2, v64
s_waitcnt lgkmcnt(0)
s_barrier
s_mul_i32 s101, s6, 0x9e3779b1
s_add_u32 s101, s101, 0x7f4a7c15
s_mul_i32 s47, s7, 0x85ebca6b
s_add_u32 s47, s47, 0x165667b1
s_cmp_eq_u32 s37, 0
s_cbranch_scc0 F_OTHER
ds_read2_b64 v[72:75], v168 offset0:0 offset1:4
ds_read2_b64 v[76:79], v168 offset0:16 offset1:20
ds_read2_b64 v[80:83], v168 offset0:32 offset1:36
ds_read2_b64 v[84:87], v168 offset0:48 offset1:52
ds_read2_b64 v[88:91], v168 offset0:64 offset1:68
ds_read2_b64 v[92:95], v168 offset0:80 offset1:84
ds_read2_b64 v[96:99], v168 offset0:96 offset1:100
ds_read2_b64 v[100:103], v168 offset0:112 offset1:116
ds_read2_b64 v[104:107], v168 offset0:128 offset1:132
v_add_u32 v65, 0x26480, v64
ds_read_b32 v65, v65
s_add_u32 s28, s45, 0x1800000
s_waitcnt lgkmcnt(9)
buffer_store_dwordx4 v[72:75], v169, s[20:23], s28 offen offset:0
s_waitcnt lgkmcnt(8)
buffer_store_dwordx4 v[76:79], v169, s[20:23], s28 offen offset:2048
s_add_u32 s28, s28, 4096
s_waitcnt lgkmcnt(7)
buffer_store_dwordx4 v[80:83], v169, s[20:23], s28 offen offset:0
s_waitcnt lgkmcnt(6)
buffer_store_dwordx4 v[84:87], v169, s[20:23], s28 offen offset:2048
s_add_u32 s28, s28, 4096
s_waitcnt lgkmcnt(5)
buffer_store_dwordx4 v[88:91], v169, s[20:23], s28 offen offset:0
s_waitcnt lgkmcnt(4)
buffer_store_dwordx4 v[92:95], v169, s[20:23], s28 offen offset:2048
s_add_u32 s28, s28, 4096
s_waitcnt lgkmcnt(3)
buffer_store_dwordx4 v[96:99], v169, s[20:23], s28 offen offset:0
s_waitcnt lgkmcnt(2)
buffer_store_dwordx4 v[100:103], v169, s[20:23], s28 offen offset:2048
s_add_u32 s28, s28, 4096
s_waitcnt lgkmcnt(1)
buffer_store_dwordx4 v[104:107], v169, s[20:23], s28 offen offset:0
s_lshl_b32 s28, s3, 2
s_add_u32 s28, s28, 0x1a40000
s_waitcnt lgkmcnt(0)
buffer_store_dword v65, v64, s[20:23], s28 offen
s_and_b32 s29, s101, -16
s_or_b32 s29, s29, s38
v_mov_b32 v58, s29
v_mov_b32 v59, s47
s_lshl_b32 s29, s35, 3
v_mov_b32 v61, s29
s_lshl_b32 s28, s36, 8
s_add_u32 s28, s28, 0x24d000
s_waitcnt vmcnt(0)
s_mov_b64 exec, 1
buffer_store_dwordx2 v[58:59], v61, s[20:23], s28 offen
s_mov_b64 exec, -1
s_branch F_JOIN
F_END0:
.p2align 12
K_P1:
F_OTHER:
STUB_0:
s_mov_b64 exec, 0
s_cmp_eq_u32 s37, 1
s_cbranch_scc1 STUB_A1
s_cmp_eq_u32 s37, 2
s_cbranch_scc1 STUB_A2
s_cmp_eq_u32 s37, 3
s_cbranch_scc1 STUB_A3
s_mov_b64 exec, -1
HOP_R1:
s_add_u32 m0, s49, 90112
s_nop 0
buffer_load_dwordx4 v238, s[16:19], s34 offen offset:0 lds
buffer_load_dwordx4 v239, s[16:19], s34 offen offset:1024 lds
s_add_u32 s34, s34, 196608
s_sub_u32 s51, s34, 4718592
s_cselect_b32 s34, s34, s51
s_add_u32 m0, s49, 96256
s_nop 0
buffer_load_dwordx4 v238, s[16:19], s34 offen offset:0 lds
buffer_load_dwordx4 v239, s[16:19], s34 offen offset:1024 lds
s_add_u32 s34, s34, 196608
s_sub_u32 s51, s34, 4718592
s_cselect_b32 s34, s34, s51
s_add_u32 m0, s49, 102400
s_nop 0
buffer_load_dwordx4 v238, s[16:19], s34 offen offset:0 lds
buffer_load_dwordx4 v239, s[16:19], s34 offen offset:1024 lds
s_add_u32 s34, s34, 196608
s_sub_u32 s51, s34, 4718592
s_cselect_b32 s34, s34, s51
s_add_u32 m0, s49, 108544
s_nop 0
buffer_load_dwordx4 v238, s[16:19], s34 offen offset:0 lds
buffer_load_dwordx4 v239, s[16:19], s34 offen offset:1024 lds
s_add_u32 s34, s34, 196608
s_sub_u32 s51, s34, 4718592
s_cselect_b32 s34, s34, s51
s_mov_b64 exec, 0
s_cmp_eq_u32 s37, 1
s_cbranch_scc1 STUB_B1
s_cmp_eq_u32 s37, 2
s_cbranch_scc1 STUB_B2
s_cmp_eq_u32 s37, 3
s_cbranch_scc1 STUB_B3
s_mov_b64 exec, -1
HOP_R2:
F_JOIN:
s_lshl_b32 s49, s37, 11
s_lshl_b32 s28, s37, 16
s_lshl_b32 s34, s35, 8
s_add_u32 s34, s34, s28
s_lshl_b32 s28, s5, 18
s_add_u32 s34, s34, s28
s_add_u32 s34, s34, 1572864
s_sub_u32 s51, s34, 4718592
s_cselect_b32 s34, s34, s51
s_cmp_eq_u32 s37, 0
s_cbranch_scc1 F_W0P
s_waitcnt vmcnt(0)
s_branch F_BAR2
HOP_RET1:
s_mov_b64 exec, -1
s_branch HOP_R1
HOP_RET2:
s_mov_b64 exec, -1
s_branch HOP_R2
F_W0P:
s_lshl_b32 s28, s36, 8
s_add_u32 s28, s28, 0x24d000
v_and_b32 v61, 31, v1
v_lshlrev_b32 v61, 3, v61
s_mov_b32 s51, 0
v_mov_b32 v60, 3
F_POLL:
buffer_load_dwordx2 v[62:63], v61, s[20:23], s28 offen sc0 sc1
s_waitcnt vmcnt(0)
v_cmp_ne_u64 vcc, v[62:63], v[58:59]
s_cbranch_vccz F_GO
s_add_u32 s51, s51, 1
s_and_b32 s29, s51, 31
s_cbranch_scc1 F_POLL
s_branch F_NOTYET
F_GO:
v_mov_b32 v61, 156864
ds_write_b32 v61, v60
s_waitcnt lgkmcnt(0)
F_BAR2:
s_barrier
s_lshl_b32 s7, s36, 31
s_mov_b32 s7, 0
v_mov_b32 v246, 156864
ds_read_b32 v246, v246
s_mov_b32 s4, 0x1800000
s_mov_b32 s51, 3
Q_START:
s_lshl_b32 s28, s5, 10
s_add_u32 s28, s28, s4
s_add_u32 s6, s4, 18432
buffer_load_dwordx4 a[0:3], v240, s[20:23], s28 offen sc0 sc1
buffer_load_dwordx4 a[4:7], v241, s[20:23], s28 offen sc0 sc1
buffer_load_dwordx4 a[8:11], v242, s[20:23], s28 offen sc0 sc1
buffer_load_dwordx4 a[12:15], v243, s[20:23], s28 offen sc0 sc1
s_waitcnt lgkmcnt(0)
v_readfirstlane_b32 s48, v246
ds_read_b64_tr_b16 a[144:145], v234 offset:0
ds_read_b64_tr_b16 a[146:147], v234 offset:4096
ds_read_b64_tr_b16 a[148:149], v234 offset:8
ds_read_b64_tr_b16 a[150:151], v234 offset:4104
ds_read_b64_tr_b16 a[152:153], v235 offset:0
ds_read_b64_tr_b16 a[154:155], v235 offset:4096
ds_read_b64_tr_b16 a[156:157], v235 offset:8
ds_read_b64_tr_b16 a[158:159], v235 offset:4104
ds_read_b64_tr_b16 a[160:161], v236 offset:0
ds_read_b64_tr_b16 a[162:163], v236 offset:4096
ds_read_b64_tr_b16 a[164:165], v236 offset:8
ds_read_b64_tr_b16 a[166:167], v236 offset:4104
ds_read_b64_tr_b16 a[168:169], v237 offset:0
ds_read_b64_tr_b16 a[170:171], v237 offset:4096
ds_read_b64_tr_b16 a[172:173], v237 offset:8
ds_read_b64_tr_b16 a[174:175], v237 offset:4104
s_cmp_lt_u32 s48, s51
s_cbranch_scc1 Q_REDO
s_add_u32 s28, s28, 1024
s_cmp_lt_u32 s28, s6
s_cselect_b32 s28, s28, s4
buffer_load_dwordx4 a[16:19], v240, s[20:23], s28 offen sc0 sc1
buffer_load_dwordx4 a[20:23], v241, s[20:23], s28 offen sc0 sc1
buffer_load_dwordx4 a[24:27], v242, s[20:23], s28 offen sc0 sc1
buffer_load_dwordx4 a[28:31], v243, s[20:23], s28 offen sc0 sc1
s_lshl_b32 s29, s36, 10
s_add_u32 s29, s29, s4
s_add_u32 s29, s29, 0x240000
buffer_load_dwordx4 v[136:139], v244, s[20:23], s29 offen sc0 sc1
s_add_u32 s28, s28, 1024
s_cmp_lt_u32 s28, s6
s_cselect_b32 s28, s28, s4
buffer_load_dwordx4 a[32:35], v240, s[20:23], s28 offen sc0 sc1
buffer_load_dwordx4 a[36:39], v241, s[20:23], s28 offen sc0 sc1
buffer_load_dwordx4 a[40:43], v242, s[20:23], s28 offen sc0 sc1
buffer_load_dwordx4 a[44:47], v243, s[20:23], s28 offen sc0 sc1
s_waitcnt vmcnt(9)
s_waitcnt lgkmcnt(8)
v_mfma_f32_16x16x32_bf16 v[8:11], a[144:147], a[0:3], 0
ds_read_b64_tr_b16 a[176:177], v234 offset:8192
s_lshl_b32 s30, s37, 12
v_mfma_f32_16x16x32_bf16 v[12:15], a[144:147], a[4:7], 0
ds_read_b64_tr_b16 a[178:179], v234 offset:12288
s_lshl_b32 s31, s37, 10
v_mfma_f32_16x16x32_bf16 v[16:19], a[144:147], a[8:11], 0
s_add_u32 s28, s28, 1024
s_cmp_lt_u32 s28, s6
s_cselect_b32 s28, s28, s4
v_mfma_f32_16x16x32_bf16 v[20:23], a[144:147], a[12:15], 0
ds_read_b64_tr_b16 a[180:181], v234 offset:8200
v_add_u32 v184, 0, v4
v_mfma_f32_16x16x32_bf16 v[36:39], a[148:151], a[12:15], 0
ds_read_b64_tr_b16 a[182:183], v234 offset:12296
v_xor_b32 v184, v184, v3
v_mfma_f32_16x16x32_bf16 v[32:35], a[148:151], a[8:11], 0
buffer_load_dwordx4 a[48:51], v240, s[20:23], s28 offen sc0 sc1
v_mfma_f32_16x16x32_bf16 v[28:31], a[148:151], a[4:7], 0
ds_read_b64_tr_b16 a[184:185], v235 offset:8192
v_lshlrev_b32 v184, 4, v184
v_mfma_f32_16x16x32_bf16 v[24:27], a[148:151], a[0:3], 0
ds_read_b64_tr_b16 a[186:187], v235 offset:12288
v_lshl_add_u32 v184, v3, 8, v184
v_mfma_f32_16x16x32_bf16 v[40:43], a[152:155], a[0:3], 0
buffer_load_dwordx4 a[52:55], v241, s[20:23], s28 offen sc0 sc1
v_mfma_f32_16x16x32_bf16 v[44:47], a[152:155], a[4:7], 0
ds_read_b64_tr_b16 a[188:189], v235 offset:8200
v_add_u32 v216, 0x10000, v184
v_mfma_f32_16x16x32_bf16 v[48:51], a[152:155], a[8:11], 0
ds_read_b64_tr_b16 a[190:191], v235 offset:12296
v_add_u32 v184, 4, v4
v_mfma_f32_16x16x32_bf16 v[52:55], a[152:155], a[12:15], 0
buffer_load_dwordx4 a[56:59], v242, s[20:23], s28 offen sc0 sc1
v_mfma_f32_16x16x32_bf16 v[68:71], a[156:159], a[12:15], 0
ds_read_b64_tr_b16 a[192:193], v236 offset:8192
v_xor_b32 v184, v184, v3
v_mfma_f32_16x16x32_bf16 v[64:67], a[156:159], a[8:11], 0
buffer_load_dwordx4 a[60:63], v243, s[20:23], s28 offen sc0 sc1
v_mfma_f32_16x16x32_bf16 v[60:63], a[156:159], a[4:7], 0
ds_read_b64_tr_b16 a[194:195], v236 offset:12288
v_lshlrev_b32 v184, 4, v184
v_mfma_f32_16x16x32_bf16 v[56:59], a[156:159], a[0:3], 0
ds_read_b64_tr_b16 a[196:197], v236 offset:8200
v_lshl_add_u32 v184, v3, 8, v184
s_waitcnt lgkmcnt(8)
v_mfma_f32_16x16x32_bf16 v[72:75], a[160:163], a[0:3], 0
s_add_u32 s28, s28, 1024
s_cmp_lt_u32 s28, s6
s_cselect_b32 s28, s28, s4
v_mfma_f32_16x16x32_bf16 v[76:79], a[160:163], a[4:7], 0
ds_read_b64_tr_b16 a[198:199], v236 offset:12296
v_add_u32 v217, 0x10000, v184
v_mfma_f32_16x16x32_bf16 v[80:83], a[160:163], a[8:11], 0
ds_read_b64_tr_b16 a[200:201], v237 offset:8192
v_add_u32 v184, 8, v4
v_mfma_f32_16x16x32_bf16 v[84:87], a[160:163], a[12:15], 0
buffer_load_dwordx4 a[64:67], v240, s[20:23], s28 offen sc0 sc1
v_mfma_f32_16x16x32_bf16 v[100:103], a[164:167], a[12:15], 0
ds_read_b64_tr_b16 a[202:203], v237 offset:12288
v_xor_b32 v184, v184, v3
v_mfma_f32_16x16x32_bf16 v[96:99], a[164:167], a[8:11], 0
ds_read_b64_tr_b16 a[204:205], v237 offset:8200
v_lshlrev_b32 v184, 4, v184
v_mfma_f32_16x16x32_bf16 v[92:95], a[164:167], a[4:7], 0
buffer_load_dwordx4 a[68:71], v241, s[20:23], s28 offen sc0 sc1
v_mfma_f32_16x16x32_bf16 v[88:91], a[164:167], a[0:3], 0
ds_read_b64_tr_b16 a[206:207], v237 offset:12296
v_lshl_add_u32 v184, v3, 8, v184
v_mfma_f32_16x16x32_bf16 v[104:107], a[168:171], a[0:3], 0
buffer_load_dwordx4 a[72:75], v242, s[20:23], s28 offen sc0 sc1
v_mfma_f32_16x16x32_bf16 v[108:111], a[168:171], a[4:7], 0
buffer_load_dwordx4 a[76:79], v243, s[20:23], s28 offen sc0 sc1
v_mfma_f32_16x16x32_bf16 v[112:115], a[168:171], a[8:11], 0
s_add_u32 m0, s49, 114688
v_add_u32 v218, 0x10000, v184
v_mfma_f32_16x16x32_bf16 v[116:119], a[168:171], a[12:15], 0
buffer_load_dwordx4 v238, s[16:19], s34 offen offset:0 lds
v_mfma_f32_16x16x32_bf16 v[132:135], a[172:175], a[12:15], 0
buffer_load_dwordx4 v239, s[16:19], s34 offen offset:1024 lds
v_mfma_f32_16x16x32_bf16 v[128:131], a[172:175], a[8:11], 0
s_add_u32 s34, s34, 262144
s_sub_u32 s51, s34, 4718592
s_cselect_b32 s34, s34, s51
v_mfma_f32_16x16x32_bf16 v[124:127], a[172:175], a[4:7], 0
v_add_u32 v184, 12, v4
v_xor_b32 v184, v184, v3
v_mfma_f32_16x16x32_bf16 v[120:123], a[172:175], a[0:3], 0
v_lshlrev_b32 v184, 4, v184
v_lshl_add_u32 v184, v3, 8, v184
s_waitcnt vmcnt(15)
v_mfma_f32_16x16x32_bf16 v[8:11], a[176:179], a[16:19], v[8:11]
ds_read_b64_tr_b16 a[144:145], v234 offset:16384
v_add_u32 v219, 0x10000, v184
v_mfma_f32_16x16x32_bf16 v[12:15], a[176:179], a[20:23], v[12:15]
ds_read_b64_tr_b16 a[146:147], v234 offset:20480
v_bfe_u32 v184, v1, 2, 2
v_mfma_f32_16x16x32_bf16 v[16:19], a[176:179], a[24:27], v[16:19]
s_add_u32 s28, s28, 1024
s_cmp_lt_u32 s28, s6
s_cselect_b32 s28, s28, s4
v_mfma_f32_16x16x32_bf16 v[20:23], a[176:179], a[28:31], v[20:23]
ds_read_b64_tr_b16 a[148:149], v234 offset:16392
v_and_b32 v185, 3, v1
s_waitcnt lgkmcnt(8)
v_mfma_f32_16x16x32_bf16 v[36:39], a[180:183], a[28:31], v[36:39]
ds_read_b64_tr_b16 a[150:151], v234 offset:20488
v_lshl_add_u32 v186, v4, 2, v184
v_mfma_f32_16x16x32_bf16 v[32:35], a[180:183], a[24:27], v[32:35]
buffer_load_dwordx4 a[80:83], v240, s[20:23], s28 offen sc0 sc1
v_mfma_f32_16x16x32_bf16 v[28:31], a[180:183], a[20:23], v[28:31]
ds_read_b64_tr_b16 a[152:153], v235 offset:16384
v_and_b32 v187, 7, v186
v_mfma_f32_16x16x32_bf16 v[24:27], a[180:183], a[16:19], v[24:27]
ds_read_b64_tr_b16 a[154:155], v235 offset:20480
v_lshlrev_b32 v188, 8, v186
v_mfma_f32_16x16x32_bf16 v[40:43], a[184:187], a[16:19], v[40:43]
buffer_load_dwordx4 a[84:87], v241, s[20:23], s28 offen sc0 sc1
v_mfma_f32_16x16x32_bf16 v[44:47], a[184:187], a[20:23], v[44:47]
ds_read_b64_tr_b16 a[156:157], v235 offset:16392
v_lshl_add_u32 v188, v185, 3, v188
v_mfma_f32_16x16x32_bf16 v[48:51], a[184:187], a[24:27], v[48:51]
ds_read_b64_tr_b16 a[158:159], v235 offset:20488
v_add_u32 v188, 0x18000, v188
v_mfma_f32_16x16x32_bf16 v[52:55], a[184:187], a[28:31], v[52:55]
buffer_load_dwordx4 a[88:91], v242, s[20:23], s28 offen sc0 sc1
v_mfma_f32_16x16x32_bf16 v[68:71], a[188:191], a[28:31], v[68:71]
ds_read_b64_tr_b16 a[160:161], v236 offset:16384
v_xor_b32 v189, 0, v187
v_mfma_f32_16x16x32_bf16 v[64:67], a[188:191], a[24:27], v[64:67]
buffer_load_dwordx4 a[92:95], v243, s[20:23], s28 offen sc0 sc1
v_mfma_f32_16x16x32_bf16 v[60:63], a[188:191], a[20:23], v[60:63]
ds_read_b64_tr_b16 a[162:163], v236 offset:20480
v_lshl_add_u32 v220, v189, 5, v188
v_mfma_f32_16x16x32_bf16 v[56:59], a[188:191], a[16:19], v[56:59]
ds_read_b64_tr_b16 a[164:165], v236 offset:16392
v_xor_b32 v189, 1, v187
v_mfma_f32_16x16x32_bf16 v[72:75], a[192:195], a[16:19], v[72:75]
s_add_u32 m0, s49, 122880
v_lshl_add_u32 v221, v189, 5, v188
v_mfma_f32_16x16x32_bf16 v[76:79], a[192:195], a[20:23], v[76:79]
ds_read_b64_tr_b16 a[166:167], v236 offset:20488
v_xor_b32 v189, 2, v187
v_mfma_f32_16x16x32_bf16 v[80:83], a[192:195], a[24:27], v[80:83]
ds_read_b64_tr_b16 a[168:169], v237 offset:16384
v_lshl_add_u32 v222, v189, 5, v188
v_mfma_f32_16x16x32_bf16 v[84:87], a[192:195], a[28:31], v[84:87]
v_xor_b32 v189, 3, v187
v_lshl_add_u32 v223, v189, 5, v188
s_waitcnt lgkmcnt(8)
v_mfma_f32_16x16x32_bf16 v[100:103], a[196:199], a[28:31], v[100:103]
ds_read_b64_tr_b16 a[170:171], v237 offset:20480
v_xor_b32 v189, 4, v187
v_mfma_f32_16x16x32_bf16 v[96:99], a[196:199], a[24:27], v[96:99]
ds_read_b64_tr_b16 a[172:173], v237 offset:16392
v_lshl_add_u32 v224, v189, 5, v188
v_mfma_f32_16x16x32_bf16 v[92:95], a[196:199], a[20:23], v[92:95]
buffer_load_dwordx4 v238, s[16:19], s34 offen offset:0 lds
v_mfma_f32_16x16x32_bf16 v[88:91], a[196:199], a[16:19], v[88:91]
ds_read_b64_tr_b16 a[174:175], v237 offset:20488
v_xor_b32 v189, 5, v187
v_mfma_f32_16x16x32_bf16 v[104:107], a[200:203], a[16:19], v[104:107]
buffer_load_dwordx4 v239, s[16:19], s34 offen offset:1024 lds
v_mfma_f32_16x16x32_bf16 v[108:111], a[200:203], a[20:23], v[108:111]
v_lshl_add_u32 v225, v189, 5, v188
v_xor_b32 v189, 6, v187
v_mfma_f32_16x16x32_bf16 v[112:115], a[200:203], a[24:27], v[112:115]
s_add_u32 s34, s34, 262144
s_sub_u32 s51, s34, 4718592
s_cselect_b32 s34, s34, s51
v_mfma_f32_16x16x32_bf16 v[116:119], a[200:203], a[28:31], v[116:119]
v_lshl_add_u32 v226, v189, 5, v188
v_xor_b32 v189, 7, v187
v_mfma_f32_16x16x32_bf16 v[132:135], a[204:207], a[28:31], v[132:135]
v_lshl_add_u32 v227, v189, 5, v188
v_add_u32 v184, 0, v4
v_mfma_f32_16x16x32_bf16 v[128:131], a[204:207], a[24:27], v[128:131]
v_xor_b32 v184, v184, v3
v_lshlrev_b32 v184, 4, v184
v_mfma_f32_16x16x32_bf16 v[124:127], a[204:207], a[20:23], v[124:127]
v_lshl_add_u32 v184, v4, 8, v184
v_add_u32 v228, s30, v184
v_mfma_f32_16x16x32_bf16 v[120:123], a[204:207], a[16:19], v[120:123]
v_add_u32 v184, 4, v4
v_xor_b32 v184, v184, v3
s_waitcnt vmcnt(16)
v_mfma_f32_16x16x32_bf16 v[8:11], a[144:147], a[32:35], v[8:11]
ds_read_b64_tr_b16 a[176:177], v234 offset:24576
v_lshlrev_b32 v184, 4, v184
v_mfma_f32_16x16x32_bf16 v[12:15], a[144:147], a[36:39], v[12:15]
ds_read_b64_tr_b16 a[178:179], v234 offset:28672
v_lshl_add_u32 v184, v4, 8, v184
v_mfma_f32_16x16x32_bf16 v[16:19], a[144:147], a[40:43], v[16:19]
s_add_u32 s28, s28, 1024
s_cmp_lt_u32 s28, s6
s_cselect_b32 s28, s28, s4
v_mfma_f32_16x16x32_bf16 v[20:23], a[144:147], a[44:47], v[20:23]
ds_read_b64_tr_b16 a[180:181], v234 offset:24584
v_add_u32 v229, s30, v184
v_mfma_f32_16x16x32_bf16 v[36:39], a[148:151], a[44:47], v[36:39]
ds_read_b64_tr_b16 a[182:183], v234 offset:28680
v_add_u32 v184, 8, v4
v_mfma_f32_16x16x32_bf16 v[32:35], a[148:151], a[40:43], v[32:35]
buffer_load_dwordx4 a[96:99], v240, s[20:23], s28 offen sc0 sc1
v_mfma_f32_16x16x32_bf16 v[28:31], a[148:151], a[36:39], v[28:31]
ds_read_b64_tr_b16 a[184:185], v235 offset:24576
v_xor_b32 v184, v184, v3
v_mfma_f32_16x16x32_bf16 v[24:27], a[148:151], a[32:35], v[24:27]
ds_read_b64_tr_b16 a[186:187], v235 offset:28672
v_lshlrev_b32 v184, 4, v184
s_waitcnt lgkmcnt(8)
v_mfma_f32_16x16x32_bf16 v[40:43], a[152:155], a[32:35], v[40:43]
buffer_load_dwordx4 a[100:103], v241, s[20:23], s28 offen sc0 sc1
v_mfma_f32_16x16x32_bf16 v[44:47], a[152:155], a[36:39], v[44:47]
ds_read_b64_tr_b16 a[188:189], v235 offset:24584
v_lshl_add_u32 v184, v4, 8, v184
v_mfma_f32_16x16x32_bf16 v[48:51], a[152:155], a[40:43], v[48:51]
ds_read_b64_tr_b16 a[190:191], v235 offset:28680
v_add_u32 v230, s30, v184
v_mfma_f32_16x16x32_bf16 v[52:55], a[152:155], a[44:47], v[52:55]
buffer_load_dwordx4 a[104:107], v242, s[20:23], s28 offen sc0 sc1
v_mfma_f32_16x16x32_bf16 v[68:71], a[156:159], a[44:47], v[68:71]
ds_read_b64_tr_b16 a[192:193], v236 offset:24576
v_add_u32 v184, 12, v4
v_mfma_f32_16x16x32_bf16 v[64:67], a[156:159], a[40:43], v[64:67]
buffer_load_dwordx4 a[108:111], v243, s[20:23], s28 offen sc0 sc1
v_mfma_f32_16x16x32_bf16 v[60:63], a[156:159], a[36:39], v[60:63]
ds_read_b64_tr_b16 a[194:195], v236 offset:28672
v_xor_b32 v184, v184, v3
v_mfma_f32_16x16x32_bf16 v[56:59], a[156:159], a[32:35], v[56:59]
ds_read_b64_tr_b16 a[196:197], v236 offset:24584
v_lshlrev_b32 v184, 4, v184
v_mfma_f32_16x16x32_bf16 v[72:75], a[160:163], a[32:35], v[72:75]
s_add_u32 m0, s49, 131072
v_lshl_add_u32 v184, v4, 8, v184
v_mfma_f32_16x16x32_bf16 v[76:79], a[160:163], a[36:39], v[76:79]
ds_read_b64_tr_b16 a[198:199], v236 offset:28680
v_add_u32 v231, s30, v184
v_mfma_f32_16x16x32_bf16 v[80:83], a[160:163], a[40:43], v[80:83]
ds_read_b64_tr_b16 a[200:201], v237 offset:24576
v_add_u32 v184, 0, v4
v_mfma_f32_16x16x32_bf16 v[84:87], a[160:163], a[44:47], v[84:87]
v_lshlrev_b32 v184, 1, v184
v_xor_b32 v184, v184, v3
v_mfma_f32_16x16x32_bf16 v[100:103], a[164:167], a[44:47], v[100:103]
ds_read_b64_tr_b16 a[202:203], v237 offset:28672
v_lshlrev_b32 v184, 4, v184
v_mfma_f32_16x16x32_bf16 v[96:99], a[164:167], a[40:43], v[96:99]
ds_read_b64_tr_b16 a[204:205], v237 offset:24584
v_lshl_add_u32 v184, v4, 8, v184
v_mfma_f32_16x16x32_bf16 v[92:95], a[164:167], a[36:39], v[92:95]
buffer_load_dwordx4 v238, s[16:19], s34 offen offset:0 lds
v_mfma_f32_16x16x32_bf16 v[88:91], a[164:167], a[32:35], v[88:91]
ds_read_b64_tr_b16 a[206:207], v237 offset:28680
v_add_u32 v232, s30, v184
v_mfma_f32_16x16x32_bf16 v[104:107], a[168:171], a[32:35], v[104:107]
buffer_load_dwordx4 v239, s[16:19], s34 offen offset:1024 lds
v_mfma_f32_16x16x32_bf16 v[108:111], a[168:171], a[36:39], v[108:111]
v_add_u32 v184, 4, v4
v_lshlrev_b32 v184, 1, v184
v_mfma_f32_16x16x32_bf16 v[112:115], a[168:171], a[40:43], v[112:115]
s_add_u32 s34, s34, 262144
s_sub_u32 s51, s34, 4718592
s_cselect_b32 s34, s34, s51
v_mfma_f32_16x16x32_bf16 v[116:119], a[168:171], a[44:47], v[116:119]
v_xor_b32 v184, v184, v3
v_lshlrev_b32 v184, 4, v184
s_waitcnt lgkmcnt(8)
v_mfma_f32_16x16x32_bf16 v[132:135], a[172:175], a[44:47], v[132:135]
v_lshl_add_u32 v184, v4, 8, v184
v_add_u32 v233, s30, v184
v_mfma_f32_16x16x32_bf16 v[128:131], a[172:175], a[40:43], v[128:131]
v_bfe_u32 v184, v1, 1, 1
v_lshrrev_b32 v185, 5, v1
v_mfma_f32_16x16x32_bf16 v[124:127], a[172:175], a[36:39], v[124:127]
v_cmp_eq_u32 vcc, v184, v185
v_mov_b32 v186, 0x3f803f80
v_mfma_f32_16x16x32_bf16 v[120:123], a[172:175], a[32:35], v[120:123]
s_waitcnt vmcnt(18)
v_mfma_f32_16x16x32_bf16 v[8:11], a[176:179], a[48:51], v[8:11]
ds_read_b64_tr_b16 a[144:145], v234 offset:32768
v_cndmask_b32 v186, 0, v186, vcc
v_mfma_f32_16x16x32_bf16 v[12:15], a[176:179], a[52:55], v[12:15]
ds_read_b64_tr_b16 a[146:147], v234 offset:36864
v_and_b32 v184, 1, v1
v_mfma_f32_16x16x32_bf16 v[16:19], a[176:179], a[56:59], v[16:19]
s_add_u32 s28, s28, 1024
s_cmp_lt_u32 s28, s6
s_cselect_b32 s28, s28, s4
v_mfma_f32_16x16x32_bf16 v[20:23], a[176:179], a[60:63], v[20:23]
ds_read_b64_tr_b16 a[148:149], v234 offset:32776
v_cmp_eq_u32 vcc, 1, v184
v_mfma_f32_16x16x32_bf16 v[36:39], a[180:183], a[60:63], v[36:39]
ds_read_b64_tr_b16 a[150:151], v234 offset:36872
v_mov_b32 v184, 0x44444444
v_mfma_f32_16x16x32_bf16 v[32:35], a[180:183], a[56:59], v[32:35]
buffer_load_dwordx4 a[112:115], v240, s[20:23], s28 offen sc0 sc1
v_mfma_f32_16x16x32_bf16 v[28:31], a[180:183], a[52:55], v[28:31]
ds_read_b64_tr_b16 a[152:153], v235 offset:32768
v_mov_b32 v185, 0xeeeeeeee
v_mfma_f32_16x16x32_bf16 v[24:27], a[180:183], a[48:51], v[24:27]
ds_read_b64_tr_b16 a[154:155], v235 offset:36864
v_mfma_f32_16x16x32_bf16 v[40:43], a[184:187], a[48:51], v[40:43]
buffer_load_dwordx4 a[116:119], v241, s[20:23], s28 offen sc0 sc1
v_mfma_f32_16x16x32_bf16 v[44:47], a[184:187], a[52:55], v[44:47]
ds_read_b64_tr_b16 a[156:157], v235 offset:32776
v_cndmask_b32 v245, v184, v185, vcc
v_mfma_f32_16x16x32_bf16 v[48:51], a[184:187], a[56:59], v[48:51]
ds_read_b64_tr_b16 a[158:159], v235 offset:36872
v_accvgpr_write_b32 a208, v186
v_mfma_f32_16x16x32_bf16 v[52:55], a[184:187], a[60:63], v[52:55]
buffer_load_dwordx4 a[120:123], v242, s[20:23], s28 offen sc0 sc1
v_mfma_f32_16x16x32_bf16 v[68:71], a[188:191], a[60:63], v[68:71]
ds_read_b64_tr_b16 a[160:161], v236 offset:32768
v_accvgpr_write_b32 a209, v186
v_mfma_f32_16x16x32_bf16 v[64:67], a[188:191], a[56:59], v[64:67]
buffer_load_dwordx4 a[124:127], v243, s[20:23], s28 offen sc0 sc1
v_mfma_f32_16x16x32_bf16 v[60:63], a[188:191], a[52:55], v[60:63]
ds_read_b64_tr_b16 a[162:163], v236 offset:36864
v_accvgpr_write_b32 a210, v186
v_mfma_f32_16x16x32_bf16 v[56:59], a[188:191], a[48:51], v[56:59]
ds_read_b64_tr_b16 a[164:165], v236 offset:32776
v_accvgpr_write_b32 a211, v186
s_waitcnt lgkmcnt(8)
v_mfma_f32_16x16x32_bf16 v[72:75], a[192:195], a[48:51], v[72:75]
s_add_u32 m0, s49, 139264
s_lshl_b32 s92, s36, 5
v_mfma_f32_16x16x32_bf16 v[76:79], a[192:195], a[52:55], v[76:79]
ds_read_b64_tr_b16 a[166:167], v236 offset:36872
s_add_u32 s92, s92, s35
v_mfma_f32_16x16x32_bf16 v[80:83], a[192:195], a[56:59], v[80:83]
ds_read_b64_tr_b16 a[168:169], v237 offset:32768
s_lshl2_add_u32 s92, s92, s37
v_mfma_f32_16x16x32_bf16 v[84:87], a[192:195], a[60:63], v[84:87]
s_lshl_b32 s44, s92, 14
s_add_u32 s44, s44, 0x400000
v_mfma_f32_16x16x32_bf16 v[100:103], a[196:199], a[60:63], v[100:103]
ds_read_b64_tr_b16 a[170:171], v237 offset:36864
s_mov_b32 s40, 0x3e0293ee
v_mfma_f32_16x16x32_bf16 v[96:99], a[196:199], a[56:59], v[96:99]
ds_read_b64_tr_b16 a[172:173], v237 offset:32776
s_mov_b32 s41, 0x3e0293ee
v_mfma_f32_16x16x32_bf16 v[92:95], a[196:199], a[52:55], v[92:95]
buffer_load_dwordx4 v238, s[16:19], s34 offen offset:0 lds
v_mfma_f32_16x16x32_bf16 v[88:91], a[196:199], a[48:51], v[88:91]
ds_read_b64_tr_b16 a[174:175], v237 offset:36872
s_mov_b32 s42, 0x5f800000
v_mfma_f32_16x16x32_bf16 v[104:107], a[200:203], a[48:51], v[104:107]
buffer_load_dwordx4 v239, s[16:19], s34 offen offset:1024 lds
v_mfma_f32_16x16x32_bf16 v[108:111], a[200:203], a[52:55], v[108:111]
s_mov_b32 s43, 0
s_lshr_b32 s92, s35, 1
v_mfma_f32_16x16x32_bf16 v[112:115], a[200:203], a[56:59], v[112:115]
s_add_u32 s34, s34, 262144
s_sub_u32 s51, s34, 4718592
s_cselect_b32 s34, s34, s51
v_mfma_f32_16x16x32_bf16 v[116:119], a[200:203], a[60:63], v[116:119]
s_lshl_b32 s92, s92, 19
v_mfma_f32_16x16x32_bf16 v[132:135], a[204:207], a[60:63], v[132:135]
s_add_u32 s66, s66, s92
s_addc_u32 s67, s67, 0
v_mfma_f32_16x16x32_bf16 v[128:131], a[204:207], a[56:59], v[128:131]
s_add_u32 s68, s68, s92
s_addc_u32 s69, s69, 0
v_mfma_f32_16x16x32_bf16 v[124:127], a[204:207], a[52:55], v[124:127]
s_mov_b32 s8, s66
s_and_b32 s9, s67, 0xffff
v_mfma_f32_16x16x32_bf16 v[120:123], a[204:207], a[48:51], v[120:123]
s_mov_b32 s10, 0x80000
s_mov_b32 s11, 0x00020000
s_waitcnt vmcnt(20)
v_mfma_f32_16x16x32_bf16 v[8:11], a[144:147], a[64:67], v[8:11]
ds_read_b64_tr_b16 a[176:177], v234 offset:40960
s_mov_b32 s12, s68
v_mfma_f32_16x16x32_bf16 v[12:15], a[144:147], a[68:71], v[12:15]
ds_read_b64_tr_b16 a[178:179], v234 offset:45056
s_and_b32 s13, s69, 0xffff
v_mfma_f32_16x16x32_bf16 v[16:19], a[144:147], a[72:75], v[16:19]
s_add_u32 s28, s28, 1024
s_cmp_lt_u32 s28, s6
s_cselect_b32 s28, s28, s4
v_mfma_f32_16x16x32_bf16 v[20:23], a[144:147], a[76:79], v[20:23]
ds_read_b64_tr_b16 a[180:181], v234 offset:40968
s_mov_b32 s14, 0x80000
s_waitcnt lgkmcnt(8)
v_mfma_f32_16x16x32_bf16 v[36:39], a[148:151], a[76:79], v[36:39]
ds_read_b64_tr_b16 a[182:183], v234 offset:45064
s_mov_b32 s15, 0x00020000
v_mfma_f32_16x16x32_bf16 v[32:35], a[148:151], a[72:75], v[32:35]
buffer_load_dwordx4 a[0:3], v240, s[20:23], s28 offen sc0 sc1
v_mfma_f32_16x16x32_bf16 v[28:31], a[148:151], a[68:71], v[28:31]
ds_read_b64_tr_b16 a[184:185], v235 offset:40960
s_mov_b32 s56, s72
v_mfma_f32_16x16x32_bf16 v[24:27], a[148:151], a[64:67], v[24:27]
ds_read_b64_tr_b16 a[186:187], v235 offset:45056
s_and_b32 s57, s73, 0xffff
v_mfma_f32_16x16x32_bf16 v[40:43], a[152:155], a[64:67], v[40:43]
buffer_load_dwordx4 a[4:7], v241, s[20:23], s28 offen sc0 sc1
v_mfma_f32_16x16x32_bf16 v[44:47], a[152:155], a[68:71], v[44:47]
ds_read_b64_tr_b16 a[188:189], v235 offset:40968
s_mov_b32 s58, 0x480000
v_mfma_f32_16x16x32_bf16 v[48:51], a[152:155], a[72:75], v[48:51]
ds_read_b64_tr_b16 a[190:191], v235 offset:45064
s_mov_b32 s59, 0x00020000
v_mfma_f32_16x16x32_bf16 v[52:55], a[152:155], a[76:79], v[52:55]
buffer_load_dwordx4 a[8:11], v242, s[20:23], s28 offen sc0 sc1
v_mfma_f32_16x16x32_bf16 v[68:71], a[156:159], a[76:79], v[68:71]
ds_read_b64_tr_b16 a[192:193], v236 offset:40960
s_mov_b32 s60, s84
v_mfma_f32_16x16x32_bf16 v[64:67], a[156:159], a[72:75], v[64:67]
buffer_load_dwordx4 a[12:15], v243, s[20:23], s28 offen sc0 sc1
v_mfma_f32_16x16x32_bf16 v[60:63], a[156:159], a[68:71], v[60:63]
ds_read_b64_tr_b16 a[194:195], v236 offset:45056
s_and_b32 s61, s85, 0xffff
v_mfma_f32_16x16x32_bf16 v[56:59], a[156:159], a[64:67], v[56:59]
ds_read_b64_tr_b16 a[196:197], v236 offset:40968
s_mov_b32 s62, 0x240000
v_mfma_f32_16x16x32_bf16 v[72:75], a[160:163], a[64:67], v[72:75]
s_add_u32 m0, s49, 0
s_mov_b32 s63, 0x00020000
v_mfma_f32_16x16x32_bf16 v[76:79], a[160:163], a[68:71], v[76:79]
ds_read_b64_tr_b16 a[198:199], v236 offset:45064
s_mov_b32 s64, s78
v_mfma_f32_16x16x32_bf16 v[80:83], a[160:163], a[72:75], v[80:83]
ds_read_b64_tr_b16 a[200:201], v237 offset:40960
s_and_b32 s65, s79, 0xffff
v_mfma_f32_16x16x32_bf16 v[84:87], a[160:163], a[76:79], v[84:87]
s_mov_b32 s66, 0x510000
s_mov_b32 s67, 0x00020000
s_waitcnt lgkmcnt(8)
v_mfma_f32_16x16x32_bf16 v[100:103], a[164:167], a[76:79], v[100:103]
ds_read_b64_tr_b16 a[202:203], v237 offset:45056
s_mov_b32 s68, s80
v_mfma_f32_16x16x32_bf16 v[96:99], a[164:167], a[72:75], v[96:99]
ds_read_b64_tr_b16 a[204:205], v237 offset:40968
s_and_b32 s69, s81, 0xffff
v_mfma_f32_16x16x32_bf16 v[92:95], a[164:167], a[68:71], v[92:95]
buffer_load_dwordx4 v238, s[16:19], s34 offen offset:0 lds
v_mfma_f32_16x16x32_bf16 v[88:91], a[164:167], a[64:67], v[88:91]
ds_read_b64_tr_b16 a[206:207], v237 offset:45064
s_mov_b32 s70, 0x510000
v_mfma_f32_16x16x32_bf16 v[104:107], a[168:171], a[64:67], v[104:107]
buffer_load_dwordx4 v239, s[16:19], s34 offen offset:1024 lds
v_mfma_f32_16x16x32_bf16 v[108:111], a[168:171], a[68:71], v[108:111]
s_mov_b32 s71, 0x00020000
s_mov_b32 s72, s82
v_mfma_f32_16x16x32_bf16 v[112:115], a[168:171], a[72:75], v[112:115]
s_add_u32 s34, s34, 262144
s_sub_u32 s51, s34, 4718592
s_cselect_b32 s34, s34, s51
v_mfma_f32_16x16x32_bf16 v[116:119], a[168:171], a[76:79], v[116:119]
s_and_b32 s73, s83, 0xffff
s_mov_b32 s74, 0x510000
v_mfma_f32_16x16x32_bf16 v[132:135], a[172:175], a[76:79], v[132:135]
s_mov_b32 s75, 0x00020000
s_mul_i32 s92, s36, 18
v_mfma_f32_16x16x32_bf16 v[128:131], a[172:175], a[72:75], v[128:131]
s_add_u32 s92, s92, s35
s_lshl_b32 s84, s92, 6
v_mfma_f32_16x16x32_bf16 v[124:127], a[172:175], a[68:71], v[124:127]
s_mul_i32 s93, s37, 147456
s_add_u32 s84, s84, s93
v_mfma_f32_16x16x32_bf16 v[120:123], a[172:175], a[64:67], v[120:123]
s_mul_i32 s85, s92, 36864
s_add_u32 s85, s85, s31
s_waitcnt vmcnt(20)
v_mfma_f32_16x16x32_bf16 v[8:11], a[176:179], a[80:83], v[8:11]
s_cmp_lt_u32 s2, 144
s_cselect_b32 s86, s31, 0x30000
s_cselect_b32 s84, s84, 0x40000000
s_cselect_b32 s85, s85, 0x40000000
v_mfma_f32_16x16x32_bf16 v[12:15], a[176:179], a[84:87], v[12:15]
STUB_1:
STUB_A1:
s_cbranch_execz STUB_4
s_waitcnt vmcnt(12) lgkmcnt(0)
s_barrier
v_mfma_f32_16x16x32_bf16 v[16:19], a[176:179], a[88:91], v[16:19]
ds_read_b64_tr_b16 a[144:145], v234 offset:49152
s_lshr_b32 s92, s35, 2
v_mfma_f32_16x16x32_bf16 v[20:23], a[176:179], a[92:95], v[20:23]
ds_read_b64_tr_b16 a[146:147], v234 offset:53248
s_mul_i32 s89, s92, 589824
v_mfma_f32_16x16x32_bf16 v[36:39], a[180:183], a[92:95], v[36:39]
ds_read_b64_tr_b16 a[148:149], v234 offset:49160
s_and_b32 s92, s35, 3
v_mfma_f32_16x16x32_bf16 v[32:35], a[180:183], a[88:91], v[32:35]
s_add_u32 s28, s28, 1024
s_cmp_lt_u32 s28, s6
s_cselect_b32 s28, s28, s4
v_mfma_f32_16x16x32_bf16 v[28:31], a[180:183], a[84:87], v[28:31]
ds_read_b64_tr_b16 a[150:151], v234 offset:53256
s_mul_i32 s92, s92, 288
v_mfma_f32_16x16x32_bf16 v[24:27], a[180:183], a[80:83], v[24:27]
ds_read_b64_tr_b16 a[152:153], v235 offset:49152
s_add_u32 s89, s89, s92
v_mfma_f32_16x16x32_bf16 v[40:43], a[184:187], a[80:83], v[40:43]
buffer_load_dwordx4 a[16:19], v240, s[20:23], s28 offen sc0 sc1
v_mfma_f32_16x16x32_bf16 v[44:47], a[184:187], a[84:87], v[44:47]
ds_read_b64_tr_b16 a[154:155], v235 offset:53248
s_lshl_b32 s92, s36, 9
v_mfma_f32_16x16x32_bf16 v[48:51], a[184:187], a[88:91], v[48:51]
ds_read_b64_tr_b16 a[156:157], v235 offset:49160
s_lshr_b32 s93, s35, 2
v_mfma_f32_16x16x32_bf16 v[52:55], a[184:187], a[92:95], v[52:55]
buffer_load_dwordx4 a[20:23], v241, s[20:23], s28 offen sc0 sc1
v_mfma_f32_16x16x32_bf16 v[68:71], a[188:191], a[92:95], v[68:71]
ds_read_b64_tr_b16 a[158:159], v235 offset:53256
s_and_b32 s94, s35, 3
v_mfma_f32_16x16x32_bf16 v[64:67], a[188:191], a[88:91], v[64:67]
ds_read_b64_tr_b16 a[160:161], v236 offset:49152
s_lshl_b32 s95, s93, 6
v_mfma_f32_16x16x32_bf16 v[60:63], a[188:191], a[84:87], v[60:63]
ds_read_b64_tr_b16 a[162:163], v236 offset:53248
s_add_u32 s95, s95, s92
v_mfma_f32_16x16x32_bf16 v[56:59], a[188:191], a[80:83], v[56:59]
buffer_load_dwordx4 a[24:27], v242, s[20:23], s28 offen sc0 sc1
v_mfma_f32_16x16x32_bf16 v[72:75], a[192:195], a[80:83], v[72:75]
ds_read_b64_tr_b16 a[164:165], v236 offset:49160
s_lshl2_add_u32 s95, s94, s95
v_mfma_f32_16x16x32_bf16 v[76:79], a[192:195], a[84:87], v[76:79]
ds_read_b64_tr_b16 a[166:167], v236 offset:53256
s_add_u32 s95, s95, 0x248000
v_mfma_f32_16x16x32_bf16 v[80:83], a[192:195], a[88:91], v[80:83]
buffer_load_dwordx4 a[28:31], v243, s[20:23], s28 offen sc0 sc1
v_mfma_f32_16x16x32_bf16 v[84:87], a[192:195], a[92:95], v[84:87]
ds_read_b64_tr_b16 a[168:169], v237 offset:49152
s_add_u32 m0, s49, 8192
v_mfma_f32_16x16x32_bf16 v[100:103], a[196:199], a[92:95], v[100:103]
ds_read_b64_tr_b16 a[170:171], v237 offset:53248
v_lshlrev_b32 v170, 4, v1
v_mfma_f32_16x16x32_bf16 v[96:99], a[196:199], a[88:91], v[96:99]
buffer_load_dwordx4 v238, s[16:19], s34 offen offset:0 lds
v_mfma_f32_16x16x32_bf16 v[92:95], a[196:199], a[84:87], v[92:95]
ds_read_b64_tr_b16 a[172:173], v237 offset:49160
v_add_u32 v170, s95, v170
v_mfma_f32_16x16x32_bf16 v[88:91], a[196:199], a[80:83], v[88:91]
ds_read_b64_tr_b16 a[174:175], v237 offset:53256
s_lshl_b32 s95, s94, 7
v_mfma_f32_16x16x32_bf16 v[104:107], a[200:203], a[80:83], v[104:107]
buffer_load_dwordx4 v239, s[16:19], s34 offen offset:1024 lds
v_mfma_f32_16x16x32_bf16 v[108:111], a[200:203], a[84:87], v[108:111]
s_add_u32 s95, s95, s92
s_lshl2_add_u32 s95, s93, s95
v_mfma_f32_16x16x32_bf16 v[112:115], a[200:203], a[88:91], v[112:115]
s_add_u32 s34, s34, 262144
s_sub_u32 s51, s34, 4718592
s_cselect_b32 s34, s34, s51
v_mfma_f32_16x16x32_bf16 v[116:119], a[200:203], a[92:95], v[116:119]
s_add_u32 s95, s95, 0x249f80
v_mfma_f32_16x16x32_bf16 v[132:135], a[204:207], a[92:95], v[132:135]
v_lshlrev_b32 v184, 5, v1
v_add_u32 v184, s95, v184
v_mfma_f32_16x16x32_bf16 v[128:131], a[204:207], a[88:91], v[128:131]
v_cmp_lt_u32 vcc, 3, v1
v_mfma_f32_16x16x32_bf16 v[124:127], a[204:207], a[84:87], v[124:127]
v_mfma_f32_16x16x32_bf16 v[120:123], a[204:207], a[80:83], v[120:123]
v_cndmask_b32 v170, v170, v184, vcc
s_waitcnt vmcnt(20)
s_waitcnt lgkmcnt(8)
v_mfma_f32_16x16x32_bf16 v[8:11], a[144:147], a[96:99], v[8:11]
ds_read_b64_tr_b16 a[176:177], v234 offset:57344
s_mov_b32 s95, 0x7fffbff0
v_mfma_f32_16x16x32_bf16 v[12:15], a[144:147], a[100:103], v[12:15]
ds_read_b64_tr_b16 a[178:179], v234 offset:61440
v_mfma_f32_16x16x32_bf16 v[16:19], a[144:147], a[104:107], v[16:19]
s_add_u32 s28, s28, 1024
s_cmp_lt_u32 s28, s6
s_cselect_b32 s28, s28, s4
v_mfma_f32_16x16x32_bf16 v[20:23], a[144:147], a[108:111], v[20:23]
ds_read_b64_tr_b16 a[180:181], v234 offset:57352
v_mfma_f32_16x16x32_bf16 v[36:39], a[148:151], a[108:111], v[36:39]
ds_read_b64_tr_b16 a[182:183], v234 offset:61448
v_mfma_f32_16x16x32_bf16 v[32:35], a[148:151], a[104:107], v[32:35]
buffer_load_dwordx4 a[32:35], v240, s[20:23], s28 offen sc0 sc1
v_mfma_f32_16x16x32_bf16 v[28:31], a[148:151], a[100:103], v[28:31]
ds_read_b64_tr_b16 a[184:185], v235 offset:57344
v_mfma_f32_16x16x32_bf16 v[24:27], a[148:151], a[96:99], v[24:27]
ds_read_b64_tr_b16 a[186:187], v235 offset:61440
v_mfma_f32_16x16x32_bf16 v[40:43], a[152:155], a[96:99], v[40:43]
buffer_load_dwordx4 a[36:39], v241, s[20:23], s28 offen sc0 sc1
v_mfma_f32_16x16x32_bf16 v[44:47], a[152:155], a[100:103], v[44:47]
ds_read_b64_tr_b16 a[188:189], v235 offset:57352
v_mfma_f32_16x16x32_bf16 v[48:51], a[152:155], a[104:107], v[48:51]
ds_read_b64_tr_b16 a[190:191], v235 offset:61448
v_mfma_f32_16x16x32_bf16 v[52:55], a[152:155], a[108:111], v[52:55]
buffer_load_dwordx4 a[40:43], v242, s[20:23], s28 offen sc0 sc1
v_mfma_f32_16x16x32_bf16 v[68:71], a[156:159], a[108:111], v[68:71]
ds_read_b64_tr_b16 a[192:193], v236 offset:57344
v_mfma_f32_16x16x32_bf16 v[64:67], a[156:159], a[104:107], v[64:67]
buffer_load_dwordx4 a[44:47], v243, s[20:23], s28 offen sc0 sc1
v_mfma_f32_16x16x32_bf16 v[60:63], a[156:159], a[100:103], v[60:63]
ds_read_b64_tr_b16 a[194:195], v236 offset:61440
v_mfma_f32_16x16x32_bf16 v[56:59], a[156:159], a[96:99], v[56:59]
ds_read_b64_tr_b16 a[196:197], v236 offset:57352
s_waitcnt lgkmcnt(8)
v_mfma_f32_16x16x32_bf16 v[72:75], a[160:163], a[96:99], v[72:75]
s_add_u32 m0, s49, 16384
v_mfma_f32_16x16x32_bf16 v[76:79], a[160:163], a[100:103], v[76:79]
ds_read_b64_tr_b16 a[198:199], v236 offset:61448
v_mfma_f32_16x16x32_bf16 v[80:83], a[160:163], a[104:107], v[80:83]
ds_read_b64_tr_b16 a[200:201], v237 offset:57344
v_mfma_f32_16x16x32_bf16 v[84:87], a[160:163], a[108:111], v[84:87]
s_cmp_eq_u32 s2, 0
s_cselect_b32 s95, 0x242c00, s95
v_mfma_f32_16x16x32_bf16 v[100:103], a[164:167], a[108:111], v[100:103]
ds_read_b64_tr_b16 a[202:203], v237 offset:61440
v_lshlrev_b32 v184, 7, v1
v_mfma_f32_16x16x32_bf16 v[96:99], a[164:167], a[104:107], v[96:99]
ds_read_b64_tr_b16 a[204:205], v237 offset:57352
v_add_u32 v184, s95, v184
v_mfma_f32_16x16x32_bf16 v[92:95], a[164:167], a[100:103], v[92:95]
buffer_load_dwordx4 v238, s[16:19], s34 offen offset:0 lds
v_mfma_f32_16x16x32_bf16 v[88:91], a[164:167], a[96:99], v[88:91]
ds_read_b64_tr_b16 a[206:207], v237 offset:61448
v_cmp_lt_u32 vcc, 7, v1
v_mfma_f32_16x16x32_bf16 v[104:107], a[168:171], a[96:99], v[104:107]
buffer_load_dwordx4 v239, s[16:19], s34 offen offset:1024 lds
v_mfma_f32_16x16x32_bf16 v[108:111], a[168:171], a[100:103], v[108:111]
v_cndmask_b32 v170, v170, v184, vcc
v_mov_b32 v184, 0x7ffffff0
v_mfma_f32_16x16x32_bf16 v[112:115], a[168:171], a[104:107], v[112:115]
s_add_u32 s34, s34, 262144
s_sub_u32 s51, s34, 4718592
s_cselect_b32 s34, s34, s51
v_mfma_f32_16x16x32_bf16 v[116:119], a[168:171], a[108:111], v[116:119]
v_mov_b32 v171, 0
v_cmp_lt_u32 vcc, 9, v0
v_mfma_f32_16x16x32_bf16 v[132:135], a[172:175], a[108:111], v[132:135]
v_mfma_f32_16x16x32_bf16 v[128:131], a[172:175], a[104:107], v[128:131]
v_cndmask_b32 v170, v170, v184, vcc
v_mov_b32 v254, 0x7ffffff0
v_mfma_f32_16x16x32_bf16 v[124:127], a[172:175], a[100:103], v[124:127]
s_lshl_b32 s92, s36, 5
s_add_u32 s92, s92, s35
v_mfma_f32_16x16x32_bf16 v[120:123], a[172:175], a[96:99], v[120:123]
s_cmp_eq_u32 s37, 0
s_cselect_b32 s92, s92, 0x7ffffff0
s_waitcnt vmcnt(20)
v_mfma_f32_16x16x32_bf16 v[8:11], a[176:179], a[112:115], v[8:11]
v_add_u32 v234, 0x10000, v234
v_add_u32 v235, 0x10000, v235
v_mfma_f32_16x16x32_bf16 v[12:15], a[176:179], a[116:119], v[12:15]
v_add_u32 v236, 0x10000, v236
v_add_u32 v237, 0x10000, v237
v_mfma_f32_16x16x32_bf16 v[16:19], a[176:179], a[120:123], v[16:19]
v_writelane_b32 v254, s92, 0
v_mfma_f32_16x16x32_bf16 v[20:23], a[176:179], a[124:127], v[20:23]
ds_read_b64_tr_b16 a[144:145], v234 offset:0
s_or_b32 s92, s38, 0x20
s_waitcnt lgkmcnt(8)
v_mfma_f32_16x16x32_bf16 v[36:39], a[180:183], a[124:127], v[36:39]
ds_read_b64_tr_b16 a[146:147], v234 offset:4096
v_mov_b32 v255, s92
v_mfma_f32_16x16x32_bf16 v[32:35], a[180:183], a[120:123], v[32:35]
ds_read_b64_tr_b16 a[148:149], v234 offset:8
v_add_u32 v184, 0, v0
v_mfma_f32_16x16x32_bf16 v[28:31], a[180:183], a[116:119], v[28:31]
s_add_u32 s28, s28, 1024
s_cmp_lt_u32 s28, s6
s_cselect_b32 s28, s28, s4
v_mfma_f32_16x16x32_bf16 v[24:27], a[180:183], a[112:115], v[24:27]
ds_read_b64_tr_b16 a[150:151], v234 offset:4104
v_mul_u32_u24 v185, 911, v184
v_mfma_f32_16x16x32_bf16 v[40:43], a[184:187], a[112:115], v[40:43]
ds_read_b64_tr_b16 a[152:153], v235 offset:0
v_lshrrev_b32 v185, 16, v185
v_mfma_f32_16x16x32_bf16 v[44:47], a[184:187], a[116:119], v[44:47]
ds_read_b64_tr_b16 a[154:155], v235 offset:4096
v_add_u32 v184, v184, v185
v_mfma_f32_16x16x32_bf16 v[48:51], a[184:187], a[120:123], v[48:51]
buffer_load_dwordx4 a[48:51], v240, s[20:23], s28 offen sc0 sc1
v_mfma_f32_16x16x32_bf16 v[52:55], a[184:187], a[124:127], v[52:55]
ds_read_b64_tr_b16 a[156:157], v235 offset:8
v_lshlrev_b32 v184, 4, v184
v_mfma_f32_16x16x32_bf16 v[68:71], a[188:191], a[124:127], v[68:71]
ds_read_b64_tr_b16 a[158:159], v235 offset:4104
v_add_u32 v178, 0x24000, v184
v_mfma_f32_16x16x32_bf16 v[64:67], a[188:191], a[120:123], v[64:67]
buffer_load_dwordx4 a[52:55], v241, s[20:23], s28 offen sc0 sc1
v_mfma_f32_16x16x32_bf16 v[60:63], a[188:191], a[116:119], v[60:63]
ds_read_b64_tr_b16 a[160:161], v236 offset:0
v_add_u32 v184, 256, v0
v_mfma_f32_16x16x32_bf16 v[56:59], a[188:191], a[112:115], v[56:59]
ds_read_b64_tr_b16 a[162:163], v236 offset:4096
v_mul_u32_u24 v185, 911, v184
s_waitcnt lgkmcnt(8)
v_mfma_f32_16x16x32_bf16 v[72:75], a[192:195], a[112:115], v[72:75]
ds_read_b64_tr_b16 a[164:165], v236 offset:8
v_lshrrev_b32 v185, 16, v185
v_mfma_f32_16x16x32_bf16 v[76:79], a[192:195], a[116:119], v[76:79]
buffer_load_dwordx4 a[56:59], v242, s[20:23], s28 offen sc0 sc1
v_mfma_f32_16x16x32_bf16 v[80:83], a[192:195], a[120:123], v[80:83]
ds_read_b64_tr_b16 a[166:167], v236 offset:4104
v_add_u32 v184, v184, v185
v_mfma_f32_16x16x32_bf16 v[84:87], a[192:195], a[124:127], v[84:87]
ds_read_b64_tr_b16 a[168:169], v237 offset:0
v_lshlrev_b32 v184, 4, v184
v_mfma_f32_16x16x32_bf16 v[100:103], a[196:199], a[124:127], v[100:103]
ds_read_b64_tr_b16 a[170:171], v237 offset:4096
v_add_u32 v179, 0x24000, v184
v_mfma_f32_16x16x32_bf16 v[96:99], a[196:199], a[120:123], v[96:99]
buffer_load_dwordx4 a[60:63], v243, s[20:23], s28 offen sc0 sc1
v_mfma_f32_16x16x32_bf16 v[92:95], a[196:199], a[116:119], v[92:95]
ds_read_b64_tr_b16 a[172:173], v237 offset:8
s_add_u32 m0, s49, 24576
v_mfma_f32_16x16x32_bf16 v[88:91], a[196:199], a[112:115], v[88:91]
ds_read_b64_tr_b16 a[174:175], v237 offset:4104
v_add_u32 v184, 512, v0
v_mfma_f32_16x16x32_bf16 v[104:107], a[200:203], a[112:115], v[104:107]
buffer_load_dwordx4 v238, s[16:19], s34 offen offset:0 lds
v_mfma_f32_16x16x32_bf16 v[108:111], a[200:203], a[116:119], v[108:111]
buffer_load_dwordx4 v239, s[16:19], s34 offen offset:1024 lds
v_mfma_f32_16x16x32_bf16 v[112:115], a[200:203], a[120:123], v[112:115]
v_mul_u32_u24 v185, 911, v184
v_lshrrev_b32 v185, 16, v185
v_mfma_f32_16x16x32_bf16 v[116:119], a[200:203], a[124:127], v[116:119]
s_add_u32 s34, s34, 262144
s_sub_u32 s51, s34, 4718592
s_cselect_b32 s34, s34, s51
v_mfma_f32_16x16x32_bf16 v[132:135], a[204:207], a[124:127], v[132:135]
v_add_u32 v184, v184, v185
v_lshlrev_b32 v184, 4, v184
v_mfma_f32_16x16x32_bf16 v[128:131], a[204:207], a[120:123], v[128:131]
v_add_u32 v180, 0x24000, v184
v_mfma_f32_16x16x32_bf16 v[124:127], a[204:207], a[116:119], v[124:127]
v_mov_b32 v143, 0
v_mfma_f32_16x16x32_bf16 v[120:123], a[204:207], a[112:115], v[120:123]
s_mov_b32 s90, 0x01010101
s_mov_b32 s91, 0x01010101
s_waitcnt vmcnt(20)
v_mfma_f32_16x16x32_bf16 v[8:11], a[144:147], a[0:3], v[8:11]
s_waitcnt vmcnt(56)
v_max3_u32 v140, v136, v137, v138
v_mfma_f32_16x16x32_bf16 v[12:15], a[144:147], a[4:7], v[12:15]
s_waitcnt vmcnt(12) lgkmcnt(0)
s_barrier
v_mfma_f32_16x16x32_bf16 v[16:19], a[144:147], a[8:11], v[16:19]
ds_read_b64_tr_b16 a[176:177], v234 offset:8192
v_max_u32 v140, v140, v139
v_mfma_f32_16x16x32_bf16 v[20:23], a[144:147], a[12:15], v[20:23]
ds_read_b64_tr_b16 a[178:179], v234 offset:12288
v_mfma_f32_16x16x32_bf16 v[36:39], a[148:151], a[12:15], v[36:39]
ds_read_b64_tr_b16 a[180:181], v234 offset:8200
v_max_u32_dpp v141, v140, v140 row_ror:8 row_mask:0xf bank_mask:0xf
v_mfma_f32_16x16x32_bf16 v[32:35], a[148:151], a[8:11], v[32:35]
s_add_u32 s28, s28, 1024
s_cmp_lt_u32 s28, s6
s_cselect_b32 s28, s28, s4
v_mfma_f32_16x16x32_bf16 v[28:31], a[148:151], a[4:7], v[28:31]
ds_read_b64_tr_b16 a[182:183], v234 offset:12296
v_max_u32_dpp v140, v141, v141 row_ror:4 row_mask:0xf bank_mask:0xf
v_mfma_f32_16x16x32_bf16 v[24:27], a[148:151], a[0:3], v[24:27]
ds_read_b64_tr_b16 a[184:185], v235 offset:8192
v_mfma_f32_16x16x32_bf16 v[40:43], a[152:155], a[0:3], v[40:43]
buffer_load_dwordx4 a[64:67], v240, s[20:23], s28 offen sc0 sc1
v_mfma_f32_16x16x32_bf16 v[44:47], a[152:155], a[4:7], v[44:47]
ds_read_b64_tr_b16 a[186:187], v235 offset:12288
v_max_u32_dpp v141, v140, v140 row_ror:2 row_mask:0xf bank_mask:0xf
v_mfma_f32_16x16x32_bf16 v[48:51], a[152:155], a[8:11], v[48:51]
ds_read_b64_tr_b16 a[188:189], v235 offset:8200
v_mfma_f32_16x16x32_bf16 v[52:55], a[152:155], a[12:15], v[52:55]
buffer_load_dwordx4 a[68:71], v241, s[20:23], s28 offen sc0 sc1
v_mfma_f32_16x16x32_bf16 v[68:71], a[156:159], a[12:15], v[68:71]
ds_read_b64_tr_b16 a[190:191], v235 offset:12296
v_max_u32_dpp v140, v141, v141 row_ror:1 row_mask:0xf bank_mask:0xf
v_mfma_f32_16x16x32_bf16 v[64:67], a[156:159], a[8:11], v[64:67]
ds_read_b64_tr_b16 a[192:193], v236 offset:8192
v_mov_b32 v141, v140
v_mfma_f32_16x16x32_bf16 v[60:63], a[156:159], a[4:7], v[60:63]
ds_read_b64_tr_b16 a[194:195], v236 offset:12288
v_mfma_f32_16x16x32_bf16 v[56:59], a[156:159], a[0:3], v[56:59]
buffer_load_dwordx4 a[72:75], v242, s[20:23], s28 offen sc0 sc1
v_mfma_f32_16x16x32_bf16 v[72:75], a[160:163], a[0:3], v[72:75]
ds_read_b64_tr_b16 a[196:197], v236 offset:8200
v_permlane16_swap_b32 v140, v141
v_mfma_f32_16x16x32_bf16 v[76:79], a[160:163], a[4:7], v[76:79]
ds_read_b64_tr_b16 a[198:199], v236 offset:12296
v_max_u32 v140, v140, v141
v_mfma_f32_16x16x32_bf16 v[80:83], a[160:163], a[8:11], v[80:83]
buffer_load_dwordx4 a[76:79], v243, s[20:23], s28 offen sc0 sc1
v_mfma_f32_16x16x32_bf16 v[84:87], a[160:163], a[12:15], v[84:87]
ds_read_b64_tr_b16 a[200:201], v237 offset:8192
s_add_u32 m0, s49, 32768
v_mfma_f32_16x16x32_bf16 v[100:103], a[164:167], a[12:15], v[100:103]
ds_read_b64_tr_b16 a[202:203], v237 offset:12288
v_mov_b32 v141, v140
v_mfma_f32_16x16x32_bf16 v[96:99], a[164:167], a[8:11], v[96:99]
buffer_load_dwordx4 v238, s[16:19], s34 offen offset:0 lds
v_mfma_f32_16x16x32_bf16 v[92:95], a[164:167], a[4:7], v[92:95]
ds_read_b64_tr_b16 a[204:205], v237 offset:8200
v_permlane32_swap_b32 v140, v141
v_mfma_f32_16x16x32_bf16 v[88:91], a[164:167], a[0:3], v[88:91]
ds_read_b64_tr_b16 a[206:207], v237 offset:12296
v_max_u32 v140, v140, v141
v_mfma_f32_16x16x32_bf16 v[104:107], a[168:171], a[0:3], v[104:107]
buffer_load_dwordx4 v239, s[16:19], s34 offen offset:1024 lds
v_mfma_f32_16x16x32_bf16 v[108:111], a[168:171], a[4:7], v[108:111]
v_add_u32 v143, v143, v140
v_sub_u32 v136, v136, v140
v_mfma_f32_16x16x32_bf16 v[112:115], a[168:171], a[8:11], v[112:115]
s_add_u32 s34, s34, 262144
s_sub_u32 s51, s34, 4718592
s_cselect_b32 s34, s34, s51
v_mfma_f32_16x16x32_bf16 v[116:119], a[168:171], a[12:15], v[116:119]
v_sub_u32 v137, v137, v140
v_sub_u32 v138, v138, v140
v_mfma_f32_16x16x32_bf16 v[132:135], a[172:175], a[12:15], v[132:135]
v_sub_u32 v139, v139, v140
v_cndmask_b32 v142, v142, v143, s[90:91]
v_mfma_f32_16x16x32_bf16 v[128:131], a[172:175], a[8:11], v[128:131]
s_lshl_b64 s[90:91], s[90:91], 1
v_mfma_f32_16x16x32_bf16 v[124:127], a[172:175], a[4:7], v[124:127]
v_max3_u32 v140, v136, v137, v138
v_max_u32 v140, v140, v139
v_mfma_f32_16x16x32_bf16 v[120:123], a[172:175], a[0:3], v[120:123]
s_waitcnt vmcnt(20)
s_waitcnt lgkmcnt(8)
v_mfma_f32_16x16x32_bf16 v[8:11], a[176:179], a[16:19], v[8:11]
v_add_u32 v234, 0xfffe0000, v234
v_add_u32 v235, 0xfffe0000, v235
v_mfma_f32_16x16x32_bf16 v[12:15], a[176:179], a[20:23], v[12:15]
v_add_u32 v236, 0xfffe0000, v236
v_add_u32 v237, 0xfffe0000, v237
v_mfma_f32_16x16x32_bf16 v[16:19], a[176:179], a[24:27], v[16:19]
v_max_u32_dpp v141, v140, v140 row_ror:8 row_mask:0xf bank_mask:0xf
v_mfma_f32_16x16x32_bf16 v[20:23], a[176:179], a[28:31], v[20:23]
ds_read_b64_tr_b16 a[144:145], v234 offset:0
v_mfma_f32_16x16x32_bf16 v[36:39], a[180:183], a[28:31], v[36:39]
ds_read_b64_tr_b16 a[146:147], v234 offset:4096
v_max_u32_dpp v140, v141, v141 row_ror:4 row_mask:0xf bank_mask:0xf
v_mfma_f32_16x16x32_bf16 v[32:35], a[180:183], a[24:27], v[32:35]
ds_read_b64_tr_b16 a[148:149], v234 offset:8
v_mfma_f32_16x16x32_bf16 v[28:31], a[180:183], a[20:23], v[28:31]
s_add_u32 s28, s28, 1024
s_cmp_lt_u32 s28, s6
s_cselect_b32 s28, s28, s4
v_mfma_f32_16x16x32_bf16 v[24:27], a[180:183], a[16:19], v[24:27]
ds_read_b64_tr_b16 a[150:151], v234 offset:4104
v_max_u32_dpp v141, v140, v140 row_ror:2 row_mask:0xf bank_mask:0xf
v_mfma_f32_16x16x32_bf16 v[40:43], a[184:187], a[16:19], v[40:43]
ds_read_b64_tr_b16 a[152:153], v235 offset:0
v_mfma_f32_16x16x32_bf16 v[44:47], a[184:187], a[20:23], v[44:47]
ds_read_b64_tr_b16 a[154:155], v235 offset:4096
v_max_u32_dpp v140, v141, v141 row_ror:1 row_mask:0xf bank_mask:0xf
v_mfma_f32_16x16x32_bf16 v[48:51], a[184:187], a[24:27], v[48:51]
buffer_load_dwordx4 a[80:83], v240, s[20:23], s28 offen sc0 sc1
v_mfma_f32_16x16x32_bf16 v[52:55], a[184:187], a[28:31], v[52:55]
ds_read_b64_tr_b16 a[156:157], v235 offset:8
v_mov_b32 v141, v140
v_mfma_f32_16x16x32_bf16 v[68:71], a[188:191], a[28:31], v[68:71]
ds_read_b64_tr_b16 a[158:159], v235 offset:4104
v_mfma_f32_16x16x32_bf16 v[64:67], a[188:191], a[24:27], v[64:67]
buffer_load_dwordx4 a[84:87], v241, s[20:23], s28 offen sc0 sc1
v_mfma_f32_16x16x32_bf16 v[60:63], a[188:191], a[20:23], v[60:63]
ds_read_b64_tr_b16 a[160:161], v236 offset:0
v_permlane16_swap_b32 v140, v141
v_mfma_f32_16x16x32_bf16 v[56:59], a[188:191], a[16:19], v[56:59]
ds_read_b64_tr_b16 a[162:163], v236 offset:4096
v_max_u32 v140, v140, v141
s_waitcnt lgkmcnt(8)
v_mfma_f32_16x16x32_bf16 v[72:75], a[192:195], a[16:19], v[72:75]
ds_read_b64_tr_b16 a[164:165], v236 offset:8
v_mov_b32 v141, v140
v_mfma_f32_16x16x32_bf16 v[76:79], a[192:195], a[20:23], v[76:79]
buffer_load_dwordx4 a[88:91], v242, s[20:23], s28 offen sc0 sc1
v_mfma_f32_16x16x32_bf16 v[80:83], a[192:195], a[24:27], v[80:83]
ds_read_b64_tr_b16 a[166:167], v236 offset:4104
v_permlane32_swap_b32 v140, v141
v_mfma_f32_16x16x32_bf16 v[84:87], a[192:195], a[28:31], v[84:87]
ds_read_b64_tr_b16 a[168:169], v237 offset:0
v_max_u32 v140, v140, v141
v_mfma_f32_16x16x32_bf16 v[100:103], a[196:199], a[28:31], v[100:103]
ds_read_b64_tr_b16 a[170:171], v237 offset:4096
v_add_u32 v143, v143, v140
v_mfma_f32_16x16x32_bf16 v[96:99], a[196:199], a[24:27], v[96:99]
buffer_load_dwordx4 a[92:95], v243, s[20:23], s28 offen sc0 sc1
v_mfma_f32_16x16x32_bf16 v[92:95], a[196:199], a[20:23], v[92:95]
ds_read_b64_tr_b16 a[172:173], v237 offset:8
s_add_u32 m0, s49, 40960
v_mfma_f32_16x16x32_bf16 v[88:91], a[196:199], a[16:19], v[88:91]
ds_read_b64_tr_b16 a[174:175], v237 offset:4104
v_sub_u32 v136, v136, v140
v_mfma_f32_16x16x32_bf16 v[104:107], a[200:203], a[16:19], v[104:107]
buffer_load_dwordx4 v238, s[16:19], s34 offen offset:0 lds
v_mfma_f32_16x16x32_bf16 v[108:111], a[200:203], a[20:23], v[108:111]
buffer_load_dwordx4 v239, s[16:19], s34 offen offset:1024 lds
v_mfma_f32_16x16x32_bf16 v[112:115], a[200:203], a[24:27], v[112:115]
v_sub_u32 v137, v137, v140
v_sub_u32 v138, v138, v140
v_mfma_f32_16x16x32_bf16 v[116:119], a[200:203], a[28:31], v[116:119]
s_add_u32 s34, s34, 262144
s_sub_u32 s51, s34, 4718592
s_cselect_b32 s34, s34, s51
v_mfma_f32_16x16x32_bf16 v[132:135], a[204:207], a[28:31], v[132:135]
v_sub_u32 v139, v139, v140
v_cndmask_b32 v142, v142, v143, s[90:91]
v_mfma_f32_16x16x32_bf16 v[128:131], a[204:207], a[24:27], v[128:131]
s_lshl_b64 s[90:91], s[90:91], 1
v_mfma_f32_16x16x32_bf16 v[124:127], a[204:207], a[20:23], v[124:127]
v_max3_u32 v140, v136, v137, v138
v_max_u32 v140, v140, v139
v_mfma_f32_16x16x32_bf16 v[120:123], a[204:207], a[16:19], v[120:123]
s_waitcnt vmcnt(20)
v_mfma_f32_16x16x32_bf16 v[8:11], a[144:147], a[32:35], v[8:11]
ds_read_b64_tr_b16 a[176:177], v234 offset:8192
v_max_u32_dpp v141, v140, v140 row_ror:8 row_mask:0xf bank_mask:0xf
v_mfma_f32_16x16x32_bf16 v[12:15], a[144:147], a[36:39], v[12:15]
ds_read_b64_tr_b16 a[178:179], v234 offset:12288
v_mfma_f32_16x16x32_bf16 v[16:19], a[144:147], a[40:43], v[16:19]
s_add_u32 s28, s28, 1024
s_cmp_lt_u32 s28, s6
s_cselect_b32 s28, s28, s4
v_mfma_f32_16x16x32_bf16 v[20:23], a[144:147], a[44:47], v[20:23]
ds_read_b64_tr_b16 a[180:181], v234 offset:8200
v_max_u32_dpp v140, v141, v141 row_ror:4 row_mask:0xf bank_mask:0xf
s_waitcnt lgkmcnt(8)
v_mfma_f32_16x16x32_bf16 v[36:39], a[148:151], a[44:47], v[36:39]
ds_read_b64_tr_b16 a[182:183], v234 offset:12296
v_mfma_f32_16x16x32_bf16 v[32:35], a[148:151], a[40:43], v[32:35]
buffer_load_dwordx4 a[96:99], v240, s[20:23], s28 offen sc0 sc1
v_mfma_f32_16x16x32_bf16 v[28:31], a[148:151], a[36:39], v[28:31]
ds_read_b64_tr_b16 a[184:185], v235 offset:8192
v_max_u32_dpp v141, v140, v140 row_ror:2 row_mask:0xf bank_mask:0xf
v_mfma_f32_16x16x32_bf16 v[24:27], a[148:151], a[32:35], v[24:27]
ds_read_b64_tr_b16 a[186:187], v235 offset:12288
v_mfma_f32_16x16x32_bf16 v[40:43], a[152:155], a[32:35], v[40:43]
buffer_load_dwordx4 a[100:103], v241, s[20:23], s28 offen sc0 sc1
v_mfma_f32_16x16x32_bf16 v[44:47], a[152:155], a[36:39], v[44:47]
ds_read_b64_tr_b16 a[188:189], v235 offset:8200
v_max_u32_dpp v140, v141, v141 row_ror:1 row_mask:0xf bank_mask:0xf
v_mfma_f32_16x16x32_bf16 v[48:51], a[152:155], a[40:43], v[48:51]
ds_read_b64_tr_b16 a[190:191], v235 offset:12296
v_mov_b32 v141, v140
v_mfma_f32_16x16x32_bf16 v[52:55], a[152:155], a[44:47], v[52:55]
buffer_load_dwordx4 a[104:107], v242, s[20:23], s28 offen sc0 sc1
v_mfma_f32_16x16x32_bf16 v[68:71], a[156:159], a[44:47], v[68:71]
ds_read_b64_tr_b16 a[192:193], v236 offset:8192
v_permlane16_swap_b32 v140, v141
v_mfma_f32_16x16x32_bf16 v[64:67], a[156:159], a[40:43], v[64:67]
buffer_load_dwordx4 a[108:111], v243, s[20:23], s28 offen sc0 sc1
v_mfma_f32_16x16x32_bf16 v[60:63], a[156:159], a[36:39], v[60:63]
ds_read_b64_tr_b16 a[194:195], v236 offset:12288
v_max_u32 v140, v140, v141
v_mfma_f32_16x16x32_bf16 v[56:59], a[156:159], a[32:35], v[56:59]
ds_read_b64_tr_b16 a[196:197], v236 offset:8200
v_mov_b32 v141, v140
v_mfma_f32_16x16x32_bf16 v[72:75], a[160:163], a[32:35], v[72:75]
s_add_u32 m0, s49, 49152
v_mfma_f32_16x16x32_bf16 v[76:79], a[160:163], a[36:39], v[76:79]
ds_read_b64_tr_b16 a[198:199], v236 offset:12296
v_permlane32_swap_b32 v140, v141
v_mfma_f32_16x16x32_bf16 v[80:83], a[160:163], a[40:43], v[80:83]
ds_read_b64_tr_b16 a[200:201], v237 offset:8192
v_max_u32 v140, v140, v141
v_mfma_f32_16x16x32_bf16 v[84:87], a[160:163], a[44:47], v[84:87]
v_add_u32 v143, v143, v140
v_sub_u32 v136, v136, v140
s_waitcnt lgkmcnt(8)
v_mfma_f32_16x16x32_bf16 v[100:103], a[164:167], a[44:47], v[100:103]
ds_read_b64_tr_b16 a[202:203], v237 offset:12288
v_sub_u32 v137, v137, v140
v_mfma_f32_16x16x32_bf16 v[96:99], a[164:167], a[40:43], v[96:99]
ds_read_b64_tr_b16 a[204:205], v237 offset:8200
v_sub_u32 v138, v138, v140
v_mfma_f32_16x16x32_bf16 v[92:95], a[164:167], a[36:39], v[92:95]
buffer_load_dwordx4 v238, s[16:19], s34 offen offset:0 lds
v_mfma_f32_16x16x32_bf16 v[88:91], a[164:167], a[32:35], v[88:91]
ds_read_b64_tr_b16 a[206:207], v237 offset:12296
v_sub_u32 v139, v139, v140
v_mfma_f32_16x16x32_bf16 v[104:107], a[168:171], a[32:35], v[104:107]
buffer_load_dwordx4 v239, s[16:19], s34 offen offset:1024 lds
v_mfma_f32_16x16x32_bf16 v[108:111], a[168:171], a[36:39], v[108:111]
v_cndmask_b32 v142, v142, v143, s[90:91]
v_mfma_f32_16x16x32_bf16 v[112:115], a[168:171], a[40:43], v[112:115]
s_add_u32 s34, s34, 262144
s_sub_u32 s51, s34, 4718592
s_cselect_b32 s34, s34, s51
v_mfma_f32_16x16x32_bf16 v[116:119], a[168:171], a[44:47], v[116:119]
s_lshl_b64 s[90:91], s[90:91], 1
v_mfma_f32_16x16x32_bf16 v[132:135], a[172:175], a[44:47], v[132:135]
v_max3_u32 v140, v136, v137, v138
v_max_u32 v140, v140, v139
v_mfma_f32_16x16x32_bf16 v[128:131], a[172:175], a[40:43], v[128:131]
v_mfma_f32_16x16x32_bf16 v[124:127], a[172:175], a[36:39], v[124:127]
v_max_u32_dpp v141, v140, v140 row_ror:8 row_mask:0xf bank_mask:0xf
v_mfma_f32_16x16x32_bf16 v[120:123], a[172:175], a[32:35], v[120:123]
s_waitcnt vmcnt(20)
v_mfma_f32_16x16x32_bf16 v[8:11], a[176:179], a[48:51], v[8:11]
v_max_u32_dpp v140, v141, v141 row_ror:4 row_mask:0xf bank_mask:0xf
v_mfma_f32_16x16x32_bf16 v[12:15], a[176:179], a[52:55], v[12:15]
s_waitcnt vmcnt(12) lgkmcnt(0)
s_barrier
v_mfma_f32_16x16x32_bf16 v[16:19], a[176:179], a[56:59], v[16:19]
ds_read_b64_tr_b16 a[144:145], v234 offset:16384
v_max_u32_dpp v141, v140, v140 row_ror:2 row_mask:0xf bank_mask:0xf
v_mfma_f32_16x16x32_bf16 v[20:23], a[176:179], a[60:63], v[20:23]
ds_read_b64_tr_b16 a[146:147], v234 offset:20480
v_mfma_f32_16x16x32_bf16 v[36:39], a[180:183], a[60:63], v[36:39]
ds_read_b64_tr_b16 a[148:149], v234 offset:16392
v_max_u32_dpp v140, v141, v141 row_ror:1 row_mask:0xf bank_mask:0xf
v_mfma_f32_16x16x32_bf16 v[32:35], a[180:183], a[56:59], v[32:35]
s_add_u32 s28, s28, 1024
s_cmp_lt_u32 s28, s6
s_cselect_b32 s28, s28, s4
v_mfma_f32_16x16x32_bf16 v[28:31], a[180:183], a[52:55], v[28:31]
ds_read_b64_tr_b16 a[150:151], v234 offset:20488
v_mov_b32 v141, v140
v_mfma_f32_16x16x32_bf16 v[24:27], a[180:183], a[48:51], v[24:27]
ds_read_b64_tr_b16 a[152:153], v235 offset:16384
v_mfma_f32_16x16x32_bf16 v[40:43], a[184:187], a[48:51], v[40:43]
buffer_load_dwordx4 a[112:115], v240, s[20:23], s28 offen sc0 sc1
v_mfma_f32_16x16x32_bf16 v[44:47], a[184:187], a[52:55], v[44:47]
ds_read_b64_tr_b16 a[154:155], v235 offset:20480
v_permlane16_swap_b32 v140, v141
v_mfma_f32_16x16x32_bf16 v[48:51], a[184:187], a[56:59], v[48:51]
ds_read_b64_tr_b16 a[156:157], v235 offset:16392
v_max_u32 v140, v140, v141
v_mfma_f32_16x16x32_bf16 v[52:55], a[184:187], a[60:63], v[52:55]
buffer_load_dwordx4 a[116:119], v241, s[20:23], s28 offen sc0 sc1
v_mfma_f32_16x16x32_bf16 v[68:71], a[188:191], a[60:63], v[68:71]
ds_read_b64_tr_b16 a[158:159], v235 offset:20488
v_mov_b32 v141, v140
v_mfma_f32_16x16x32_bf16 v[64:67], a[188:191], a[56:59], v[64:67]
ds_read_b64_tr_b16 a[160:161], v236 offset:16384
v_mfma_f32_16x16x32_bf16 v[60:63], a[188:191], a[52:55], v[60:63]
ds_read_b64_tr_b16 a[162:163], v236 offset:20480
v_permlane32_swap_b32 v140, v141
v_mfma_f32_16x16x32_bf16 v[56:59], a[188:191], a[48:51], v[56:59]
buffer_load_dwordx4 a[120:123], v242, s[20:23], s28 offen sc0 sc1
v_mfma_f32_16x16x32_bf16 v[72:75], a[192:195], a[48:51], v[72:75]
ds_read_b64_tr_b16 a[164:165], v236 offset:16392
v_max_u32 v140, v140, v141
v_mfma_f32_16x16x32_bf16 v[76:79], a[192:195], a[52:55], v[76:79]
ds_read_b64_tr_b16 a[166:167], v236 offset:20488
v_add_u32 v143, v143, v140
v_mfma_f32_16x16x32_bf16 v[80:83], a[192:195], a[56:59], v[80:83]
buffer_load_dwordx4 a[124:127], v243, s[20:23], s28 offen sc0 sc1
v_mfma_f32_16x16x32_bf16 v[84:87], a[192:195], a[60:63], v[84:87]
ds_read_b64_tr_b16 a[168:169], v237 offset:16384
s_add_u32 m0, s49, 57344
v_mfma_f32_16x16x32_bf16 v[100:103], a[196:199], a[60:63], v[100:103]
ds_read_b64_tr_b16 a[170:171], v237 offset:20480
v_sub_u32 v136, v136, v140
v_mfma_f32_16x16x32_bf16 v[96:99], a[196:199], a[56:59], v[96:99]
buffer_load_dwordx4 v238, s[16:19], s34 offen offset:0 lds
v_mfma_f32_16x16x32_bf16 v[92:95], a[196:199], a[52:55], v[92:95]
ds_read_b64_tr_b16 a[172:173], v237 offset:16392
v_sub_u32 v137, v137, v140
v_mfma_f32_16x16x32_bf16 v[88:91], a[196:199], a[48:51], v[88:91]
ds_read_b64_tr_b16 a[174:175], v237 offset:20488
v_sub_u32 v138, v138, v140
v_mfma_f32_16x16x32_bf16 v[104:107], a[200:203], a[48:51], v[104:107]
STUB_2:
STUB_A2:
s_cbranch_execz STUB_5
buffer_load_dwordx4 v239, s[16:19], s34 offen offset:1024 lds
v_mfma_f32_16x16x32_bf16 v[108:111], a[200:203], a[52:55], v[108:111]
v_sub_u32 v139, v139, v140
v_cndmask_b32 v142, v142, v143, s[90:91]
v_mfma_f32_16x16x32_bf16 v[112:115], a[200:203], a[56:59], v[112:115]
s_add_u32 s34, s34, 262144
s_sub_u32 s51, s34, 4718592
s_cselect_b32 s34, s34, s51
v_mfma_f32_16x16x32_bf16 v[116:119], a[200:203], a[60:63], v[116:119]
s_lshl_b64 s[90:91], s[90:91], 1
v_mfma_f32_16x16x32_bf16 v[132:135], a[204:207], a[60:63], v[132:135]
v_max3_u32 v140, v136, v137, v138
v_max_u32 v140, v140, v139
v_mfma_f32_16x16x32_bf16 v[128:131], a[204:207], a[56:59], v[128:131]
v_mfma_f32_16x16x32_bf16 v[124:127], a[204:207], a[52:55], v[124:127]
v_max_u32_dpp v141, v140, v140 row_ror:8 row_mask:0xf bank_mask:0xf
v_mfma_f32_16x16x32_bf16 v[120:123], a[204:207], a[48:51], v[120:123]
s_waitcnt vmcnt(20)
s_waitcnt lgkmcnt(8)
v_mfma_f32_16x16x32_bf16 v[8:11], a[144:147], a[64:67], v[8:11]
ds_read_b64_tr_b16 a[176:177], v234 offset:24576
v_max_u32_dpp v140, v141, v141 row_ror:4 row_mask:0xf bank_mask:0xf
v_mfma_f32_16x16x32_bf16 v[12:15], a[144:147], a[68:71], v[12:15]
ds_read_b64_tr_b16 a[178:179], v234 offset:28672
v_mfma_f32_16x16x32_bf16 v[16:19], a[144:147], a[72:75], v[16:19]
s_add_u32 s28, s28, 1024
s_cmp_lt_u32 s28, s6
s_cselect_b32 s28, s28, s4
v_mfma_f32_16x16x32_bf16 v[20:23], a[144:147], a[76:79], v[20:23]
ds_read_b64_tr_b16 a[180:181], v234 offset:24584
v_max_u32_dpp v141, v140, v140 row_ror:2 row_mask:0xf bank_mask:0xf
v_mfma_f32_16x16x32_bf16 v[36:39], a[148:151], a[76:79], v[36:39]
ds_read_b64_tr_b16 a[182:183], v234 offset:28680
v_mfma_f32_16x16x32_bf16 v[32:35], a[148:151], a[72:75], v[32:35]
buffer_load_dwordx4 a[0:3], v240, s[20:23], s28 offen sc0 sc1
v_mfma_f32_16x16x32_bf16 v[28:31], a[148:151], a[68:71], v[28:31]
ds_read_b64_tr_b16 a[184:185], v235 offset:24576
v_max_u32_dpp v140, v141, v141 row_ror:1 row_mask:0xf bank_mask:0xf
v_mfma_f32_16x16x32_bf16 v[24:27], a[148:151], a[64:67], v[24:27]
ds_read_b64_tr_b16 a[186:187], v235 offset:28672
v_mov_b32 v141, v140
v_mfma_f32_16x16x32_bf16 v[40:43], a[152:155], a[64:67], v[40:43]
buffer_load_dwordx4 a[4:7], v241, s[20:23], s28 offen sc0 sc1
v_mfma_f32_16x16x32_bf16 v[44:47], a[152:155], a[68:71], v[44:47]
ds_read_b64_tr_b16 a[188:189], v235 offset:24584
v_permlane16_swap_b32 v140, v141
v_mfma_f32_16x16x32_bf16 v[48:51], a[152:155], a[72:75], v[48:51]
ds_read_b64_tr_b16 a[190:191], v235 offset:28680
v_max_u32 v140, v140, v141
v_mfma_f32_16x16x32_bf16 v[52:55], a[152:155], a[76:79], v[52:55]
buffer_load_dwordx4 a[8:11], v242, s[20:23], s28 offen sc0 sc1
v_mfma_f32_16x16x32_bf16 v[68:71], a[156:159], a[76:79], v[68:71]
ds_read_b64_tr_b16 a[192:193], v236 offset:24576
v_mov_b32 v141, v140
v_mfma_f32_16x16x32_bf16 v[64:67], a[156:159], a[72:75], v[64:67]
buffer_load_dwordx4 a[12:15], v243, s[20:23], s28 offen sc0 sc1
v_mfma_f32_16x16x32_bf16 v[60:63], a[156:159], a[68:71], v[60:63]
ds_read_b64_tr_b16 a[194:195], v236 offset:28672
s_add_u32 s32, s7, 0
v_mfma_f32_16x16x32_bf16 v[56:59], a[156:159], a[64:67], v[56:59]
ds_read_b64_tr_b16 a[196:197], v236 offset:24584
v_permlane32_swap_b32 v140, v141
s_waitcnt lgkmcnt(8)
v_mfma_f32_16x16x32_bf16 v[72:75], a[160:163], a[64:67], v[72:75]
s_add_u32 m0, s30, 81920
v_max_u32 v140, v140, v141
v_mfma_f32_16x16x32_bf16 v[76:79], a[160:163], a[68:71], v[76:79]
ds_read_b64_tr_b16 a[198:199], v236 offset:28680
v_add_u32 v143, v143, v140
v_mfma_f32_16x16x32_bf16 v[80:83], a[160:163], a[72:75], v[80:83]
ds_read_b64_tr_b16 a[200:201], v237 offset:24576
v_sub_u32 v136, v136, v140
v_mfma_f32_16x16x32_bf16 v[84:87], a[160:163], a[76:79], v[84:87]
buffer_load_dwordx4 v228, s[8:11], s32 offen offset:0  lds
v_mfma_f32_16x16x32_bf16 v[100:103], a[164:167], a[76:79], v[100:103]
ds_read_b64_tr_b16 a[202:203], v237 offset:28672
v_sub_u32 v137, v137, v140
v_mfma_f32_16x16x32_bf16 v[96:99], a[164:167], a[72:75], v[96:99]
ds_read_b64_tr_b16 a[204:205], v237 offset:24584
v_sub_u32 v138, v138, v140
v_mfma_f32_16x16x32_bf16 v[92:95], a[164:167], a[68:71], v[92:95]
buffer_load_dwordx4 v229, s[8:11], s32 offen offset:1024  lds
v_mfma_f32_16x16x32_bf16 v[88:91], a[164:167], a[64:67], v[88:91]
ds_read_b64_tr_b16 a[206:207], v237 offset:28680
v_sub_u32 v139, v139, v140
v_mfma_f32_16x16x32_bf16 v[104:107], a[168:171], a[64:67], v[104:107]
buffer_load_dwordx4 v230, s[8:11], s32 offen offset:2048  lds
v_mfma_f32_16x16x32_bf16 v[108:111], a[168:171], a[68:71], v[108:111]
v_cndmask_b32 v142, v142, v143, s[90:91]
v_mfma_f32_16x16x32_bf16 v[112:115], a[168:171], a[72:75], v[112:115]
s_lshl_b64 s[90:91], s[90:91], 1
v_mfma_f32_16x16x32_bf16 v[116:119], a[168:171], a[76:79], v[116:119]
buffer_load_dwordx4 v231, s[8:11], s32 offen offset:3072  lds
v_mfma_f32_16x16x32_bf16 v[132:135], a[172:175], a[76:79], v[132:135]
v_max3_u32 v140, v136, v137, v138
v_max_u32 v140, v140, v139
v_mfma_f32_16x16x32_bf16 v[128:131], a[172:175], a[72:75], v[128:131]
v_mfma_f32_16x16x32_bf16 v[124:127], a[172:175], a[68:71], v[124:127]
v_max_u32_dpp v141, v140, v140 row_ror:8 row_mask:0xf bank_mask:0xf
v_mfma_f32_16x16x32_bf16 v[120:123], a[172:175], a[64:67], v[120:123]
s_waitcnt vmcnt(22)
v_mfma_f32_16x16x32_bf16 v[8:11], a[176:179], a[80:83], v[8:11]
ds_read_b64_tr_b16 a[144:145], v234 offset:32768
v_max_u32_dpp v140, v141, v141 row_ror:4 row_mask:0xf bank_mask:0xf
v_mfma_f32_16x16x32_bf16 v[12:15], a[176:179], a[84:87], v[12:15]
ds_read_b64_tr_b16 a[146:147], v234 offset:36864
v_mfma_f32_16x16x32_bf16 v[16:19], a[176:179], a[88:91], v[16:19]
s_add_u32 s28, s28, 1024
s_cmp_lt_u32 s28, s6
s_cselect_b32 s28, s28, s4
v_mfma_f32_16x16x32_bf16 v[20:23], a[176:179], a[92:95], v[20:23]
ds_read_b64_tr_b16 a[148:149], v234 offset:32776
v_max_u32_dpp v141, v140, v140 row_ror:2 row_mask:0xf bank_mask:0xf
s_waitcnt lgkmcnt(8)
v_mfma_f32_16x16x32_bf16 v[36:39], a[180:183], a[92:95], v[36:39]
ds_read_b64_tr_b16 a[150:151], v234 offset:36872
v_mfma_f32_16x16x32_bf16 v[32:35], a[180:183], a[88:91], v[32:35]
v_max_u32_dpp v140, v141, v141 row_ror:1 row_mask:0xf bank_mask:0xf
v_mov_b32 v141, v140
v_mfma_f32_16x16x32_bf16 v[28:31], a[180:183], a[84:87], v[28:31]
ds_read_b64_tr_b16 a[152:153], v235 offset:32768
v_mfma_f32_16x16x32_bf16 v[24:27], a[180:183], a[80:83], v[24:27]
ds_read_b64_tr_b16 a[154:155], v235 offset:36864
v_permlane16_swap_b32 v140, v141
v_mfma_f32_16x16x32_bf16 v[40:43], a[184:187], a[80:83], v[40:43]
buffer_load_dwordx4 a[16:19], v240, s[20:23], s28 offen sc0 sc1
v_mfma_f32_16x16x32_bf16 v[44:47], a[184:187], a[84:87], v[44:47]
ds_read_b64_tr_b16 a[156:157], v235 offset:32776
v_max_u32 v140, v140, v141
v_mfma_f32_16x16x32_bf16 v[48:51], a[184:187], a[88:91], v[48:51]
ds_read_b64_tr_b16 a[158:159], v235 offset:36872
v_mov_b32 v141, v140
v_mfma_f32_16x16x32_bf16 v[52:55], a[184:187], a[92:95], v[52:55]
v_mfma_f32_16x16x32_bf16 v[68:71], a[188:191], a[92:95], v[68:71]
ds_read_b64_tr_b16 a[160:161], v236 offset:32768
v_permlane32_swap_b32 v140, v141
v_mfma_f32_16x16x32_bf16 v[64:67], a[188:191], a[88:91], v[64:67]
buffer_load_dwordx4 a[20:23], v241, s[20:23], s28 offen sc0 sc1
v_mfma_f32_16x16x32_bf16 v[60:63], a[188:191], a[84:87], v[60:63]
ds_read_b64_tr_b16 a[162:163], v236 offset:36864
v_max_u32 v140, v140, v141
v_mfma_f32_16x16x32_bf16 v[56:59], a[188:191], a[80:83], v[56:59]
ds_read_b64_tr_b16 a[164:165], v236 offset:32776
v_add_u32 v143, v143, v140
v_mfma_f32_16x16x32_bf16 v[72:75], a[192:195], a[80:83], v[72:75]
v_sub_u32 v136, v136, v140
v_sub_u32 v137, v137, v140
v_mfma_f32_16x16x32_bf16 v[76:79], a[192:195], a[84:87], v[76:79]
ds_read_b64_tr_b16 a[166:167], v236 offset:36872
v_sub_u32 v138, v138, v140
v_mfma_f32_16x16x32_bf16 v[80:83], a[192:195], a[88:91], v[80:83]
ds_read_b64_tr_b16 a[168:169], v237 offset:32768
v_sub_u32 v139, v139, v140
v_mfma_f32_16x16x32_bf16 v[84:87], a[192:195], a[92:95], v[84:87]
buffer_load_dwordx4 a[24:27], v242, s[20:23], s28 offen sc0 sc1
s_waitcnt lgkmcnt(8)
v_mfma_f32_16x16x32_bf16 v[100:103], a[196:199], a[92:95], v[100:103]
ds_read_b64_tr_b16 a[170:171], v237 offset:36864
v_cndmask_b32 v142, v142, v143, s[90:91]
v_mfma_f32_16x16x32_bf16 v[96:99], a[196:199], a[88:91], v[96:99]
ds_read_b64_tr_b16 a[172:173], v237 offset:32776
s_lshl_b64 s[90:91], s[90:91], 1
v_mfma_f32_16x16x32_bf16 v[92:95], a[196:199], a[84:87], v[92:95]
v_max3_u32 v140, v136, v137, v138
v_max_u32 v140, v140, v139
v_mfma_f32_16x16x32_bf16 v[88:91], a[196:199], a[80:83], v[88:91]
ds_read_b64_tr_b16 a[174:175], v237 offset:36872
v_mfma_f32_16x16x32_bf16 v[104:107], a[200:203], a[80:83], v[104:107]
buffer_load_dwordx4 a[28:31], v243, s[20:23], s28 offen sc0 sc1
v_mfma_f32_16x16x32_bf16 v[108:111], a[200:203], a[84:87], v[108:111]
v_max_u32_dpp v141, v140, v140 row_ror:8 row_mask:0xf bank_mask:0xf
v_mfma_f32_16x16x32_bf16 v[112:115], a[200:203], a[88:91], v[112:115]
v_mfma_f32_16x16x32_bf16 v[116:119], a[200:203], a[92:95], v[116:119]
v_max_u32_dpp v140, v141, v141 row_ror:4 row_mask:0xf bank_mask:0xf
v_mfma_f32_16x16x32_bf16 v[132:135], a[204:207], a[92:95], v[132:135]
v_mfma_f32_16x16x32_bf16 v[128:131], a[204:207], a[88:91], v[128:131]
v_max_u32_dpp v141, v140, v140 row_ror:2 row_mask:0xf bank_mask:0xf
v_mfma_f32_16x16x32_bf16 v[124:127], a[204:207], a[84:87], v[124:127]
v_mfma_f32_16x16x32_bf16 v[120:123], a[204:207], a[80:83], v[120:123]
v_max_u32_dpp v140, v141, v141 row_ror:1 row_mask:0xf bank_mask:0xf
v_mov_b32 v141, v140
s_waitcnt vmcnt(20)
v_mfma_f32_16x16x32_bf16 v[8:11], a[144:147], a[96:99], v[8:11]
v_mfma_f32_16x16x32_bf16 v[12:15], a[144:147], a[100:103], v[12:15]
s_waitcnt vmcnt(12) lgkmcnt(0)
s_barrier
v_mfma_f32_16x16x32_bf16 v[16:19], a[144:147], a[104:107], v[16:19]
ds_read_b64_tr_b16 a[176:177], v234 offset:40960
s_add_u32 s32, s7, 16384
v_mfma_f32_16x16x32_bf16 v[20:23], a[144:147], a[108:111], v[20:23]
ds_read_b64_tr_b16 a[178:179], v234 offset:45056
v_permlane16_swap_b32 v140, v141
v_mfma_f32_16x16x32_bf16 v[36:39], a[148:151], a[108:111], v[36:39]
ds_read_b64_tr_b16 a[180:181], v234 offset:40968
v_max_u32 v140, v140, v141
v_mfma_f32_16x16x32_bf16 v[32:35], a[148:151], a[104:107], v[32:35]
buffer_store_dword v171, v170, s[20:23], s46 offen sc0 sc1
v_mfma_f32_16x16x32_bf16 v[28:31], a[148:151], a[100:103], v[28:31]
ds_read_b64_tr_b16 a[182:183], v234 offset:45064
s_add_u32 m0, s30, 114688
v_mfma_f32_16x16x32_bf16 v[24:27], a[148:151], a[96:99], v[24:27]
ds_read_b64_tr_b16 a[184:185], v235 offset:40960
ds_read_b128 v[152:155], v178
v_mfma_f32_16x16x32_bf16 v[40:43], a[152:155], a[96:99], v[40:43]
ds_read_b128 v[156:159], v179
v_mov_b32 v141, v140
v_mfma_f32_16x16x32_bf16 v[44:47], a[152:155], a[100:103], v[44:47]
ds_read_b64_tr_b16 a[186:187], v235 offset:45056
ds_read_b128 v[160:163], v180
v_mfma_f32_16x16x32_bf16 v[48:51], a[152:155], a[104:107], v[48:51]
ds_read_b64_tr_b16 a[188:189], v235 offset:40968
v_permlane32_swap_b32 v140, v141
v_mfma_f32_16x16x32_bf16 v[52:55], a[152:155], a[108:111], v[52:55]
buffer_load_dwordx4 v228, s[8:11], s32 offen offset:0  lds
v_mfma_f32_16x16x32_bf16 v[68:71], a[156:159], a[108:111], v[68:71]
ds_read_b64_tr_b16 a[190:191], v235 offset:45064
v_max_u32 v140, v140, v141
v_mfma_f32_16x16x32_bf16 v[64:67], a[156:159], a[104:107], v[64:67]
ds_read_b64_tr_b16 a[192:193], v236 offset:40960
v_add_u32 v143, v143, v140
v_mfma_f32_16x16x32_bf16 v[60:63], a[156:159], a[100:103], v[60:63]
ds_read_b64_tr_b16 a[194:195], v236 offset:45056
v_sub_u32 v136, v136, v140
v_mfma_f32_16x16x32_bf16 v[56:59], a[156:159], a[96:99], v[56:59]
s_mul_i32 s45, s3, 1152
s_add_u32 s45, s45, s31
v_mfma_f32_16x16x32_bf16 v[72:75], a[160:163], a[96:99], v[72:75]
ds_read_b64_tr_b16 a[196:197], v236 offset:40968
s_add_u32 s45, s45, 0x1c00000
v_mfma_f32_16x16x32_bf16 v[76:79], a[160:163], a[100:103], v[76:79]
ds_read_b64_tr_b16 a[198:199], v236 offset:45064
v_sub_u32 v137, v137, v140
v_mfma_f32_16x16x32_bf16 v[80:83], a[160:163], a[104:107], v[80:83]
buffer_load_dwordx4 v229, s[8:11], s32 offen offset:1024  lds
v_mfma_f32_16x16x32_bf16 v[84:87], a[160:163], a[108:111], v[84:87]
ds_read_b64_tr_b16 a[200:201], v237 offset:40960
v_sub_u32 v138, v138, v140
v_mfma_f32_16x16x32_bf16 v[100:103], a[164:167], a[108:111], v[100:103]
ds_read_b64_tr_b16 a[202:203], v237 offset:45056
v_sub_u32 v139, v139, v140
v_mfma_f32_16x16x32_bf16 v[96:99], a[164:167], a[104:107], v[96:99]
buffer_load_dwordx4 v230, s[8:11], s32 offen offset:2048  lds
v_mfma_f32_16x16x32_bf16 v[92:95], a[164:167], a[100:103], v[92:95]
ds_read_b64_tr_b16 a[204:205], v237 offset:40968
v_cndmask_b32 v142, v142, v143, s[90:91]
v_mfma_f32_16x16x32_bf16 v[88:91], a[164:167], a[96:99], v[88:91]
ds_read_b64_tr_b16 a[206:207], v237 offset:45064
s_lshl_b64 s[90:91], s[90:91], 1
v_mfma_f32_16x16x32_bf16 v[104:107], a[168:171], a[96:99], v[104:107]
s_waitcnt lgkmcnt(8)
buffer_store_dwordx4 v[152:155], v244, s[20:23], s45 offen sc0 sc1
v_mfma_f32_16x16x32_bf16 v[108:111], a[168:171], a[100:103], v[108:111]
buffer_load_dwordx4 v231, s[8:11], s32 offen offset:3072  lds
v_mfma_f32_16x16x32_bf16 v[112:115], a[168:171], a[104:107], v[112:115]
v_max3_u32 v140, v136, v137, v138
v_max_u32 v140, v140, v139
v_mfma_f32_16x16x32_bf16 v[116:119], a[168:171], a[108:111], v[116:119]
v_mfma_f32_16x16x32_bf16 v[132:135], a[172:175], a[108:111], v[132:135]
v_max_u32_dpp v141, v140, v140 row_ror:8 row_mask:0xf bank_mask:0xf
v_mfma_f32_16x16x32_bf16 v[128:131], a[172:175], a[104:107], v[128:131]
v_mfma_f32_16x16x32_bf16 v[124:127], a[172:175], a[100:103], v[124:127]
s_add_u32 s45, s45, 4096
buffer_store_dwordx4 v[156:159], v244, s[20:23], s45 offen sc0 sc1
v_mfma_f32_16x16x32_bf16 v[120:123], a[172:175], a[96:99], v[120:123]
v_max_u32_dpp v140, v141, v141 row_ror:4 row_mask:0xf bank_mask:0xf
s_waitcnt vmcnt(21)
v_mfma_f32_16x16x32_bf16 v[8:11], a[176:179], a[112:115], v[8:11]
ds_read_b64_tr_b16 a[144:145], v234 offset:49152
v_mfma_f32_16x16x32_bf16 v[12:15], a[176:179], a[116:119], v[12:15]
ds_read_b64_tr_b16 a[146:147], v234 offset:53248
v_max_u32_dpp v141, v140, v140 row_ror:2 row_mask:0xf bank_mask:0xf
v_mfma_f32_16x16x32_bf16 v[16:19], a[176:179], a[120:123], v[16:19]
v_mfma_f32_16x16x32_bf16 v[20:23], a[176:179], a[124:127], v[20:23]
ds_read_b64_tr_b16 a[148:149], v234 offset:49160
v_max_u32_dpp v140, v141, v141 row_ror:1 row_mask:0xf bank_mask:0xf
v_mfma_f32_16x16x32_bf16 v[36:39], a[180:183], a[124:127], v[36:39]
ds_read_b64_tr_b16 a[150:151], v234 offset:53256
v_mov_b32 v141, v140
v_mfma_f32_16x16x32_bf16 v[32:35], a[180:183], a[120:123], v[32:35]
s_add_u32 s45, s45, 4096
s_cmp_eq_u32 s37, 0
s_cselect_b32 s45, s45, 0x7ffffff0
buffer_store_dwordx4 v[160:163], v244, s[20:23], s45 offen sc0 sc1
v_mfma_f32_16x16x32_bf16 v[28:31], a[180:183], a[116:119], v[28:31]
ds_read_b64_tr_b16 a[152:153], v235 offset:49152
v_permlane16_swap_b32 v140, v141
v_mfma_f32_16x16x32_bf16 v[24:27], a[180:183], a[112:115], v[24:27]
ds_read_b64_tr_b16 a[154:155], v235 offset:53248
v_max_u32 v140, v140, v141
v_mfma_f32_16x16x32_bf16 v[40:43], a[184:187], a[112:115], v[40:43]
v_mov_b32 v141, v140
v_mfma_f32_16x16x32_bf16 v[44:47], a[184:187], a[116:119], v[44:47]
ds_read_b64_tr_b16 a[156:157], v235 offset:49160
v_mfma_f32_16x16x32_bf16 v[48:51], a[184:187], a[120:123], v[48:51]
ds_read_b64_tr_b16 a[158:159], v235 offset:53256
v_permlane32_swap_b32 v140, v141
v_mfma_f32_16x16x32_bf16 v[52:55], a[184:187], a[124:127], v[52:55]
v_max_u32 v140, v140, v141
v_add_u32 v143, v143, v140
v_mfma_f32_16x16x32_bf16 v[68:71], a[188:191], a[124:127], v[68:71]
ds_read_b64_tr_b16 a[160:161], v236 offset:49152
v_cndmask_b32 v142, v142, v143, s[90:91]
v_mfma_f32_16x16x32_bf16 v[64:67], a[188:191], a[120:123], v[64:67]
v_lshlrev_b32 v136, 3, v1
v_mov_b32 v137, 0x7ffffff0
v_mfma_f32_16x16x32_bf16 v[60:63], a[188:191], a[116:119], v[60:63]
ds_read_b64_tr_b16 a[162:163], v236 offset:53248
v_mfma_f32_16x16x32_bf16 v[56:59], a[188:191], a[112:115], v[56:59]
ds_read_b64_tr_b16 a[164:165], v236 offset:49160
s_waitcnt lgkmcnt(8)
v_mfma_f32_16x16x32_bf16 v[72:75], a[192:195], a[112:115], v[72:75]
v_cmp_lt_u32 vcc, 7, v1
v_mov_b32 v143, s47
v_mfma_f32_16x16x32_bf16 v[76:79], a[192:195], a[116:119], v[76:79]
ds_read_b64_tr_b16 a[166:167], v236 offset:53256
v_mfma_f32_16x16x32_bf16 v[80:83], a[192:195], a[120:123], v[80:83]
ds_read_b64_tr_b16 a[168:169], v237 offset:49152
v_cndmask_b32 v136, v136, v137, vcc
v_mfma_f32_16x16x32_bf16 v[84:87], a[192:195], a[124:127], v[84:87]
s_lshl_b32 s29, s36, 6
s_add_u32 s29, s29, 0x242000
v_mfma_f32_16x16x32_bf16 v[100:103], a[196:199], a[124:127], v[100:103]
ds_read_b64_tr_b16 a[170:171], v237 offset:53248
v_mfma_f32_16x16x32_bf16 v[96:99], a[196:199], a[120:123], v[96:99]
ds_read_b64_tr_b16 a[172:173], v237 offset:49160
v_mfma_f32_16x16x32_bf16 v[92:95], a[196:199], a[116:119], v[92:95]
s_add_u32 s50, s35, s37
s_cmp_eq_u32 s50, 0
s_cselect_b32 s29, s29, 0x7ffffff0
v_mfma_f32_16x16x32_bf16 v[88:91], a[196:199], a[112:115], v[88:91]
ds_read_b64_tr_b16 a[174:175], v237 offset:53256
v_mfma_f32_16x16x32_bf16 v[104:107], a[200:203], a[112:115], v[104:107]
buffer_store_dwordx2 v[142:143], v136, s[20:23], s29 offen sc0 sc1
v_mfma_f32_16x16x32_bf16 v[108:111], a[200:203], a[116:119], v[108:111]
v_mfma_f32_16x16x32_bf16 v[112:115], a[200:203], a[120:123], v[112:115]
v_mfma_f32_16x16x32_bf16 v[116:119], a[200:203], a[124:127], v[116:119]
v_mfma_f32_16x16x32_bf16 v[132:135], a[204:207], a[124:127], v[132:135]
v_mfma_f32_16x16x32_bf16 v[128:131], a[204:207], a[120:123], v[128:131]
v_mfma_f32_16x16x32_bf16 v[124:127], a[204:207], a[116:119], v[124:127]
v_mfma_f32_16x16x32_bf16 v[120:123], a[204:207], a[112:115], v[120:123]
s_waitcnt vmcnt(17)
v_mfma_f32_16x16x32_bf16 v[8:11], a[144:147], a[0:3], v[8:11]
ds_read_b64_tr_b16 a[176:177], v234 offset:57344
s_add_u32 s39, s7, 0
v_mfma_f32_16x16x32_bf16 v[12:15], a[144:147], a[4:7], v[12:15]
ds_read_b64_tr_b16 a[178:179], v234 offset:61440
v_mfma_f32_16x16x32_bf16 v[16:19], a[144:147], a[8:11], v[16:19]
v_mfma_f32_16x16x32_bf16 v[20:23], a[144:147], a[12:15], v[20:23]
ds_read_b64_tr_b16 a[180:181], v234 offset:57352
s_waitcnt lgkmcnt(8)
v_mfma_f32_16x16x32_bf16 v[36:39], a[148:151], a[12:15], v[36:39]
ds_read_b64_tr_b16 a[182:183], v234 offset:61448
v_mfma_f32_16x16x32_bf16 v[32:35], a[148:151], a[8:11], v[32:35]
s_add_u32 m0, s30, 131072
v_mfma_f32_16x16x32_bf16 v[28:31], a[148:151], a[4:7], v[28:31]
ds_read_b64_tr_b16 a[184:185], v235 offset:57344
v_mfma_f32_16x16x32_bf16 v[24:27], a[148:151], a[0:3], v[24:27]
ds_read_b64_tr_b16 a[186:187], v235 offset:61440
v_mfma_f32_16x16x32_bf16 v[40:43], a[152:155], a[0:3], v[40:43]
v_mfma_f32_16x16x32_bf16 v[44:47], a[152:155], a[4:7], v[44:47]
ds_read_b64_tr_b16 a[188:189], v235 offset:57352
v_mfma_f32_16x16x32_bf16 v[48:51], a[152:155], a[8:11], v[48:51]
ds_read_b64_tr_b16 a[190:191], v235 offset:61448
v_mfma_f32_16x16x32_bf16 v[52:55], a[152:155], a[12:15], v[52:55]
buffer_load_dwordx4 v232, s[12:15], s39 offen offset:0  lds
v_mfma_f32_16x16x32_bf16 v[68:71], a[156:159], a[12:15], v[68:71]
ds_read_b64_tr_b16 a[192:193], v236 offset:57344
v_mfma_f32_16x16x32_bf16 v[64:67], a[156:159], a[8:11], v[64:67]
v_mfma_f32_16x16x32_bf16 v[60:63], a[156:159], a[4:7], v[60:63]
ds_read_b64_tr_b16 a[194:195], v236 offset:61440
v_mfma_f32_16x16x32_bf16 v[56:59], a[156:159], a[0:3], v[56:59]
ds_read_b64_tr_b16 a[196:197], v236 offset:57352
v_mfma_f32_16x16x32_bf16 v[72:75], a[160:163], a[0:3], v[72:75]
buffer_load_dwordx4 v233, s[12:15], s39 offen offset:1024  lds
v_mfma_f32_16x16x32_bf16 v[76:79], a[160:163], a[4:7], v[76:79]
ds_read_b64_tr_b16 a[198:199], v236 offset:61448
v_mfma_f32_16x16x32_bf16 v[80:83], a[160:163], a[8:11], v[80:83]
ds_read_b64_tr_b16 a[200:201], v237 offset:57344
v_mfma_f32_16x16x32_bf16 v[84:87], a[160:163], a[12:15], v[84:87]
s_waitcnt lgkmcnt(8)
v_mfma_f32_16x16x32_bf16 v[100:103], a[164:167], a[12:15], v[100:103]
ds_read_b64_tr_b16 a[202:203], v237 offset:61440
v_mfma_f32_16x16x32_bf16 v[96:99], a[164:167], a[8:11], v[96:99]
ds_read_b64_tr_b16 a[204:205], v237 offset:57352
v_mfma_f32_16x16x32_bf16 v[92:95], a[164:167], a[4:7], v[92:95]
buffer_load_dwordx4 v232, s[12:15], s39 offen offset:2048  lds
v_mfma_f32_16x16x32_bf16 v[88:91], a[164:167], a[0:3], v[88:91]
ds_read_b64_tr_b16 a[206:207], v237 offset:61448
v_mfma_f32_16x16x32_bf16 v[104:107], a[168:171], a[0:3], v[104:107]
v_mfma_f32_16x16x32_bf16 v[108:111], a[168:171], a[4:7], v[108:111]
buffer_load_dwordx4 v233, s[12:15], s39 offen offset:3072  lds
v_mfma_f32_16x16x32_bf16 v[112:115], a[168:171], a[8:11], v[112:115]
v_mfma_f32_16x16x32_bf16 v[116:119], a[168:171], a[12:15], v[116:119]
v_mfma_f32_16x16x32_bf16 v[132:135], a[172:175], a[12:15], v[132:135]
v_mfma_f32_16x16x32_bf16 v[128:131], a[172:175], a[8:11], v[128:131]
v_mfma_f32_16x16x32_bf16 v[124:127], a[172:175], a[4:7], v[124:127]
v_mfma_f32_16x16x32_bf16 v[120:123], a[172:175], a[0:3], v[120:123]
s_waitcnt vmcnt(13)
v_mfma_f32_16x16x32_bf16 v[8:11], a[176:179], a[16:19], v[8:11]
v_mfma_f32_16x16x32_bf16 v[12:15], a[176:179], a[20:23], v[12:15]
v_mfma_f32_16x16x32_bf16 v[16:19], a[176:179], a[24:27], v[16:19]
v_mfma_f32_16x16x32_bf16 v[20:23], a[176:179], a[28:31], v[20:23]
v_mfma_f32_16x16x32_bf16 v[36:39], a[180:183], a[28:31], v[36:39]
v_mfma_f32_16x16x32_bf16 v[32:35], a[180:183], a[24:27], v[32:35]
v_mfma_f32_16x16x32_bf16 v[28:31], a[180:183], a[20:23], v[28:31]
v_mfma_f32_16x16x32_bf16 v[24:27], a[180:183], a[16:19], v[24:27]
s_waitcnt lgkmcnt(8)
v_mfma_f32_16x16x32_bf16 v[40:43], a[184:187], a[16:19], v[40:43]
v_mfma_f32_16x16x32_bf16 v[44:47], a[184:187], a[20:23], v[44:47]
v_mfma_f32_16x16x32_bf16 v[48:51], a[184:187], a[24:27], v[48:51]
v_mfma_f32_16x16x32_bf16 v[52:55], a[184:187], a[28:31], v[52:55]
v_mfma_f32_16x16x32_bf16 v[68:71], a[188:191], a[28:31], v[68:71]
v_mfma_f32_16x16x32_bf16 v[64:67], a[188:191], a[24:27], v[64:67]
v_mfma_f32_16x16x32_bf16 v[60:63], a[188:191], a[20:23], v[60:63]
v_mfma_f32_16x16x32_bf16 v[56:59], a[188:191], a[16:19], v[56:59]
s_waitcnt lgkmcnt(6)
v_mfma_f32_16x16x32_bf16 v[72:75], a[192:195], a[16:19], v[72:75]
v_mfma_f32_16x16x32_bf16 v[76:79], a[192:195], a[20:23], v[76:79]
v_mfma_f32_16x16x32_bf16 v[80:83], a[192:195], a[24:27], v[80:83]
v_mfma_f32_16x16x32_bf16 v[84:87], a[192:195], a[28:31], v[84:87]
s_waitcnt lgkmcnt(4)
v_mfma_f32_16x16x32_bf16 v[100:103], a[196:199], a[28:31], v[100:103]
v_mfma_f32_16x16x32_bf16 v[96:99], a[196:199], a[24:27], v[96:99]
v_mfma_f32_16x16x32_bf16 v[92:95], a[196:199], a[20:23], v[92:95]
v_mfma_f32_16x16x32_bf16 v[88:91], a[196:199], a[16:19], v[88:91]
s_waitcnt lgkmcnt(2)
v_mfma_f32_16x16x32_bf16 v[104:107], a[200:203], a[16:19], v[104:107]
v_mfma_f32_16x16x32_bf16 v[108:111], a[200:203], a[20:23], v[108:111]
v_mfma_f32_16x16x32_bf16 v[112:115], a[200:203], a[24:27], v[112:115]
v_mfma_f32_16x16x32_bf16 v[116:119], a[200:203], a[28:31], v[116:119]
s_waitcnt lgkmcnt(0)
v_mfma_f32_16x16x32_bf16 v[132:135], a[204:207], a[28:31], v[132:135]
v_mfma_f32_16x16x32_bf16 v[128:131], a[204:207], a[24:27], v[128:131]
v_mfma_f32_16x16x32_bf16 v[124:127], a[204:207], a[20:23], v[124:127]
v_mfma_f32_16x16x32_bf16 v[120:123], a[204:207], a[16:19], v[120:123]
s_nop 7
s_nop 3
v_pk_mul_f32 v[8:9], v[8:9], s[40:41]
v_pk_mul_f32 v[10:11], v[10:11], s[40:41]
v_pk_mul_f32 v[24:25], v[24:25], s[40:41]
v_pk_mul_f32 v[26:27], v[26:27], s[40:41]
v_cvt_pk_bf16_f32 v152, v8, v9
v_cvt_pk_bf16_f32 v153, v10, v11
v_cvt_pk_bf16_f32 v154, v24, v25
v_cvt_pk_bf16_f32 v155, v26, v27
v_pk_mul_f32 v[40:41], v[40:41], s[40:41]
v_pk_mul_f32 v[42:43], v[42:43], s[40:41]
v_pk_mul_f32 v[56:57], v[56:57], s[40:41]
v_pk_mul_f32 v[58:59], v[58:59], s[40:41]
v_cvt_pk_bf16_f32 v156, v40, v41
v_cvt_pk_bf16_f32 v157, v42, v43
v_cvt_pk_bf16_f32 v158, v56, v57
v_cvt_pk_bf16_f32 v159, v58, v59
v_pk_mul_f32 v[72:73], v[72:73], s[40:41]
v_pk_mul_f32 v[74:75], v[74:75], s[40:41]
v_pk_mul_f32 v[88:89], v[88:89], s[40:41]
v_pk_mul_f32 v[90:91], v[90:91], s[40:41]
v_cvt_pk_bf16_f32 v160, v72, v73
v_cvt_pk_bf16_f32 v161, v74, v75
v_cvt_pk_bf16_f32 v162, v88, v89
v_cvt_pk_bf16_f32 v163, v90, v91
v_pk_mul_f32 v[104:105], v[104:105], s[40:41]
v_pk_mul_f32 v[106:107], v[106:107], s[40:41]
v_pk_mul_f32 v[120:121], v[120:121], s[40:41]
v_pk_mul_f32 v[122:123], v[122:123], s[40:41]
v_cvt_pk_bf16_f32 v164, v104, v105
v_cvt_pk_bf16_f32 v165, v106, v107
v_cvt_pk_bf16_f32 v166, v120, v121
v_cvt_pk_bf16_f32 v167, v122, v123
v_pk_mul_f32 v[12:13], v[12:13], s[40:41]
v_pk_mul_f32 v[14:15], v[14:15], s[40:41]
v_pk_mul_f32 v[28:29], v[28:29], s[40:41]
v_pk_mul_f32 v[30:31], v[30:31], s[40:41]
v_cvt_pk_bf16_f32 v168, v12, v13
v_cvt_pk_bf16_f32 v169, v14, v15
v_cvt_pk_bf16_f32 v170, v28, v29
v_cvt_pk_bf16_f32 v171, v30, v31
v_pk_mul_f32 v[44:45], v[44:45], s[40:41]
v_pk_mul_f32 v[46:47], v[46:47], s[40:41]
v_pk_mul_f32 v[60:61], v[60:61], s[40:41]
v_pk_mul_f32 v[62:63], v[62:63], s[40:41]
v_cvt_pk_bf16_f32 v172, v44, v45
v_cvt_pk_bf16_f32 v173, v46, v47
v_cvt_pk_bf16_f32 v174, v60, v61
v_cvt_pk_bf16_f32 v175, v62, v63
v_pk_mul_f32 v[76:77], v[76:77], s[40:41]
v_pk_mul_f32 v[78:79], v[78:79], s[40:41]
v_pk_mul_f32 v[92:93], v[92:93], s[40:41]
v_pk_mul_f32 v[94:95], v[94:95], s[40:41]
v_cvt_pk_bf16_f32 v176, v76, v77
v_cvt_pk_bf16_f32 v177, v78, v79
v_cvt_pk_bf16_f32 v178, v92, v93
v_cvt_pk_bf16_f32 v179, v94, v95
v_pk_mul_f32 v[108:109], v[108:109], s[40:41]
v_pk_mul_f32 v[110:111], v[110:111], s[40:41]
v_pk_mul_f32 v[124:125], v[124:125], s[40:41]
v_pk_mul_f32 v[126:127], v[126:127], s[40:41]
v_cvt_pk_bf16_f32 v180, v108, v109
v_cvt_pk_bf16_f32 v181, v110, v111
v_cvt_pk_bf16_f32 v182, v124, v125
v_cvt_pk_bf16_f32 v183, v126, v127
v_pk_mul_f32 v[16:17], v[16:17], s[40:41]
v_pk_mul_f32 v[18:19], v[18:19], s[40:41]
v_pk_mul_f32 v[32:33], v[32:33], s[40:41]
v_pk_mul_f32 v[34:35], v[34:35], s[40:41]
v_cvt_pk_bf16_f32 v184, v16, v17
v_cvt_pk_bf16_f32 v185, v18, v19
v_cvt_pk_bf16_f32 v186, v32, v33
v_cvt_pk_bf16_f32 v187, v34, v35
v_pk_mul_f32 v[48:49], v[48:49], s[40:41]
v_pk_mul_f32 v[50:51], v[50:51], s[40:41]
v_pk_mul_f32 v[64:65], v[64:65], s[40:41]
v_pk_mul_f32 v[66:67], v[66:67], s[40:41]
v_cvt_pk_bf16_f32 v188, v48, v49
v_cvt_pk_bf16_f32 v189, v50, v51
v_cvt_pk_bf16_f32 v190, v64, v65
v_cvt_pk_bf16_f32 v191, v66, v67
v_pk_mul_f32 v[80:81], v[80:81], s[40:41]
v_pk_mul_f32 v[82:83], v[82:83], s[40:41]
v_pk_mul_f32 v[96:97], v[96:97], s[40:41]
v_pk_mul_f32 v[98:99], v[98:99], s[40:41]
v_cvt_pk_bf16_f32 v192, v80, v81
v_cvt_pk_bf16_f32 v193, v82, v83
v_cvt_pk_bf16_f32 v194, v96, v97
v_cvt_pk_bf16_f32 v195, v98, v99
v_pk_mul_f32 v[112:113], v[112:113], s[40:41]
v_pk_mul_f32 v[114:115], v[114:115], s[40:41]
v_pk_mul_f32 v[128:129], v[128:129], s[40:41]
v_pk_mul_f32 v[130:131], v[130:131], s[40:41]
v_cvt_pk_bf16_f32 v196, v112, v113
v_cvt_pk_bf16_f32 v197, v114, v115
v_cvt_pk_bf16_f32 v198, v128, v129
v_cvt_pk_bf16_f32 v199, v130, v131
v_pk_mul_f32 v[20:21], v[20:21], s[40:41]
v_pk_mul_f32 v[22:23], v[22:23], s[40:41]
v_pk_mul_f32 v[36:37], v[36:37], s[40:41]
v_pk_mul_f32 v[38:39], v[38:39], s[40:41]
v_cvt_pk_bf16_f32 v200, v20, v21
v_cvt_pk_bf16_f32 v201, v22, v23
v_cvt_pk_bf16_f32 v202, v36, v37
v_cvt_pk_bf16_f32 v203, v38, v39
v_pk_mul_f32 v[52:53], v[52:53], s[40:41]
v_pk_mul_f32 v[54:55], v[54:55], s[40:41]
v_pk_mul_f32 v[68:69], v[68:69], s[40:41]
v_pk_mul_f32 v[70:71], v[70:71], s[40:41]
v_cvt_pk_bf16_f32 v204, v52, v53
v_cvt_pk_bf16_f32 v205, v54, v55
v_cvt_pk_bf16_f32 v206, v68, v69
v_cvt_pk_bf16_f32 v207, v70, v71
v_pk_mul_f32 v[84:85], v[84:85], s[40:41]
v_pk_mul_f32 v[86:87], v[86:87], s[40:41]
v_pk_mul_f32 v[100:101], v[100:101], s[40:41]
v_pk_mul_f32 v[102:103], v[102:103], s[40:41]
v_cvt_pk_bf16_f32 v208, v84, v85
v_cvt_pk_bf16_f32 v209, v86, v87
STUB_3:
STUB_A3:
s_cbranch_execz STUB_6
v_cvt_pk_bf16_f32 v210, v100, v101
v_cvt_pk_bf16_f32 v211, v102, v103
v_pk_mul_f32 v[116:117], v[116:117], s[40:41]
v_pk_mul_f32 v[118:119], v[118:119], s[40:41]
v_pk_mul_f32 v[132:133], v[132:133], s[40:41]
v_pk_mul_f32 v[134:135], v[134:135], s[40:41]
v_cvt_pk_bf16_f32 v212, v116, v117
v_cvt_pk_bf16_f32 v213, v118, v119
v_cvt_pk_bf16_f32 v214, v132, v133
v_cvt_pk_bf16_f32 v215, v134, v135
v_lshrrev_b32 v240, 2, v1
v_mul_u32_u24 v240, 0x2400, v240
v_and_b32 v246, 3, v1
v_lshl_add_u32 v240, v246, 4, v240
v_mul_u32_u24 v243, 3641, v1
v_lshrrev_b32 v243, 16, v243
v_mul_u32_u24 v243, 864, v243
v_add_u32 v243, v243, v244
s_sub_u32 s28, s2, 144
s_cmp_lt_u32 s28, 72
s_cselect_b32 s3, 4, 0
s_cmp_lt_u32 s2, 144
s_cselect_b32 s3, 5, s3
K_PRE:
s_waitcnt vmcnt(17)
s_barrier
ds_read_b128 a[144:147], v216 offset:16384
ds_read_b128 a[148:151], v217 offset:16384
ds_read_b128 a[152:155], v218 offset:16384
ds_read_b128 a[156:159], v219 offset:16384
ds_read_b128 a[160:163], v216 offset:20480
ds_read_b128 a[164:167], v217 offset:20480
ds_read_b128 a[168:171], v218 offset:20480
ds_read_b128 a[172:175], v219 offset:20480
s_add_u32 s32, s7, 32768
s_add_u32 m0, s30, 65536
s_nop 0
buffer_load_dwordx4 v228, s[8:11], s32 offen offset:0  lds
buffer_load_dwordx4 v229, s[8:11], s32 offen offset:1024  lds
buffer_load_dwordx4 v230, s[8:11], s32 offen offset:2048  lds
buffer_load_dwordx4 v231, s[8:11], s32 offen offset:3072  lds
s_add_u32 s39, s7, 16384
s_add_u32 m0, s30, 147456
s_nop 0
buffer_load_dwordx4 v232, s[12:15], s39 offen offset:0  lds
buffer_load_dwordx4 v233, s[12:15], s39 offen offset:1024  lds
buffer_load_dwordx4 v232, s[12:15], s39 offen offset:2048  lds
buffer_load_dwordx4 v233, s[12:15], s39 offen offset:3072  lds
s_add_u32 s32, s7, 32768
s_add_u32 s39, s7, 16384
s_mul_i32 s88, s37, 864
s_mov_b32 s87, s88
v_accvgpr_write_b32 a128, 0
v_accvgpr_write_b32 a129, 0
v_accvgpr_write_b32 a130, 0
v_accvgpr_write_b32 a131, 0
v_accvgpr_write_b32 a132, 0
v_accvgpr_write_b32 a133, 0
v_accvgpr_write_b32 a134, 0
v_accvgpr_write_b32 a135, 0
s_waitcnt lgkmcnt(7)
v_mfma_f32_16x16x32_bf16 v[8:11], a[144:147], v[152:155], 0
v_mfma_f32_16x16x32_bf16 v[16:19], a[144:147], v[168:171], 0
v_mfma_f32_16x16x32_bf16 v[24:27], a[144:147], v[184:187], 0
v_mfma_f32_16x16x32_bf16 v[32:35], a[144:147], v[200:203], 0
ds_read_b128 a[144:147], v216 offset:24576
s_waitcnt lgkmcnt(7)
v_mfma_f32_16x16x32_bf16 v[8:11], a[148:151], v[156:159], v[8:11]
v_mfma_f32_16x16x32_bf16 v[16:19], a[148:151], v[172:175], v[16:19]
v_mfma_f32_16x16x32_bf16 v[24:27], a[148:151], v[188:191], v[24:27]
v_mfma_f32_16x16x32_bf16 v[32:35], a[148:151], v[204:207], v[32:35]
ds_read_b128 a[148:151], v217 offset:24576
s_waitcnt lgkmcnt(7)
v_mfma_f32_16x16x32_bf16 v[8:11], a[152:155], v[160:163], v[8:11]
v_mfma_f32_16x16x32_bf16 v[16:19], a[152:155], v[176:179], v[16:19]
v_mfma_f32_16x16x32_bf16 v[24:27], a[152:155], v[192:195], v[24:27]
v_mfma_f32_16x16x32_bf16 v[32:35], a[152:155], v[208:211], v[32:35]
ds_read_b128 a[152:155], v218 offset:24576
s_waitcnt lgkmcnt(7)
v_mfma_f32_16x16x32_bf16 v[8:11], a[156:159], v[164:167], v[8:11]
v_mfma_f32_16x16x32_bf16 v[16:19], a[156:159], v[180:183], v[16:19]
v_mfma_f32_16x16x32_bf16 v[24:27], a[156:159], v[196:199], v[24:27]
v_mfma_f32_16x16x32_bf16 v[32:35], a[156:159], v[212:215], v[32:35]
ds_read_b128 a[156:159], v219 offset:24576
s_waitcnt lgkmcnt(7)
v_mfma_f32_16x16x32_bf16 v[12:15], a[160:163], v[152:155], 0
v_mfma_f32_16x16x32_bf16 v[20:23], a[160:163], v[168:171], 0
v_mfma_f32_16x16x32_bf16 v[28:31], a[160:163], v[184:187], 0
v_mfma_f32_16x16x32_bf16 v[36:39], a[160:163], v[200:203], 0
ds_read_b128 a[160:163], v216 offset:28672
s_waitcnt lgkmcnt(7)
v_mfma_f32_16x16x32_bf16 v[12:15], a[164:167], v[156:159], v[12:15]
v_mfma_f32_16x16x32_bf16 v[20:23], a[164:167], v[172:175], v[20:23]
v_mfma_f32_16x16x32_bf16 v[28:31], a[164:167], v[188:191], v[28:31]
v_mfma_f32_16x16x32_bf16 v[36:39], a[164:167], v[204:207], v[36:39]
ds_read_b128 a[164:167], v217 offset:28672
s_waitcnt lgkmcnt(7)
v_mfma_f32_16x16x32_bf16 v[12:15], a[168:171], v[160:163], v[12:15]
v_mfma_f32_16x16x32_bf16 v[20:23], a[168:171], v[176:179], v[20:23]
v_mfma_f32_16x16x32_bf16 v[28:31], a[168:171], v[192:195], v[28:31]
v_mfma_f32_16x16x32_bf16 v[36:39], a[168:171], v[208:211], v[36:39]
ds_read_b128 a[168:171], v218 offset:28672
s_waitcnt lgkmcnt(7)
v_mfma_f32_16x16x32_bf16 v[12:15], a[172:175], v[164:167], v[12:15]
v_mfma_f32_16x16x32_bf16 v[20:23], a[172:175], v[180:183], v[20:23]
v_mfma_f32_16x16x32_bf16 v[28:31], a[172:175], v[196:199], v[28:31]
v_mfma_f32_16x16x32_bf16 v[36:39], a[172:175], v[212:215], v[36:39]
ds_read_b128 a[172:175], v219 offset:28672
s_nop 7
s_cmp_eq_u32 s43, 0
s_cbranch_scc0 K_HAVEMAX
v_max3_f32 v104, v8, v9, v10
v_max3_f32 v104, v104, v11, v12
v_max3_f32 v104, v104, v13, v14
v_max_f32 v104, v104, v15
v_max3_f32 v105, v16, v17, v18
v_max3_f32 v105, v105, v19, v20
v_max3_f32 v105, v105, v21, v22
v_max_f32 v105, v105, v23
v_max3_f32 v106, v24, v25, v26
v_max3_f32 v106, v106, v27, v28
v_max3_f32 v106, v106, v29, v30
v_max_f32 v106, v106, v31
v_max3_f32 v107, v32, v33, v34
v_max3_f32 v107, v107, v35, v36
v_max3_f32 v107, v107, v37, v38
v_max_f32 v107, v107, v39
v_mov_b32 v108, v104
v_mov_b32 v109, v105
v_mov_b32 v110, v106
v_mov_b32 v111, v107
v_permlane16_swap_b32 v104, v108
v_permlane16_swap_b32 v105, v109
v_permlane16_swap_b32 v106, v110
v_permlane16_swap_b32 v107, v111
v_max_f32 v104, v104, v108
v_max_f32 v105, v105, v109
v_max_f32 v106, v106, v110
v_max_f32 v107, v107, v111
v_mov_b32 v108, v104
v_mov_b32 v109, v105
v_mov_b32 v110, v106
v_mov_b32 v111, v107
v_permlane32_swap_b32 v104, v108
v_permlane32_swap_b32 v105, v109
v_permlane32_swap_b32 v106, v110
v_permlane32_swap_b32 v107, v111
v_max_f32 v104, v104, v108
v_max_f32 v105, v105, v109
v_max_f32 v106, v106, v110
v_max_f32 v107, v107, v111
v_sub_f32 v136, 0, v104
v_sub_f32 v137, 0, v104
v_sub_f32 v138, 0, v104
v_sub_f32 v139, 0, v104
v_sub_f32 v140, 0, v105
v_sub_f32 v141, 0, v105
v_sub_f32 v142, 0, v105
v_sub_f32 v143, 0, v105
v_sub_f32 v144, 0, v106
v_sub_f32 v145, 0, v106
v_sub_f32 v146, 0, v106
v_sub_f32 v147, 0, v106
v_sub_f32 v148, 0, v107
v_sub_f32 v149, 0, v107
v_sub_f32 v150, 0, v107
v_sub_f32 v151, 0, v107
K_HAVEMAX:
v_pk_add_f32 v[8:9], v[8:9], v[136:137]
v_pk_add_f32 v[10:11], v[10:11], v[136:137]
v_pk_add_f32 v[12:13], v[12:13], v[136:137]
v_pk_add_f32 v[14:15], v[14:15], v[136:137]
v_pk_add_f32 v[16:17], v[16:17], v[140:141]
v_pk_add_f32 v[18:19], v[18:19], v[140:141]
v_pk_add_f32 v[20:21], v[20:21], v[140:141]
v_pk_add_f32 v[22:23], v[22:23], v[140:141]
v_pk_add_f32 v[24:25], v[24:25], v[144:145]
v_pk_add_f32 v[26:27], v[26:27], v[144:145]
v_pk_add_f32 v[28:29], v[28:29], v[144:145]
v_pk_add_f32 v[30:31], v[30:31], v[144:145]
v_pk_add_f32 v[32:33], v[32:33], v[148:149]
v_pk_add_f32 v[34:35], v[34:35], v[148:149]
v_pk_add_f32 v[36:37], v[36:37], v[148:149]
v_pk_add_f32 v[38:39], v[38:39], v[148:149]
s_waitcnt lgkmcnt(0)
v_mfma_f32_16x16x32_bf16 v[40:43], a[144:147], v[152:155], v[136:139]
v_exp_f32 v8, v8
v_exp_f32 v9, v9
v_mfma_f32_16x16x32_bf16 v[40:43], a[148:151], v[156:159], v[40:43]
v_cvt_pk_bf16_f32 v72, v8, v9
v_bfe_u32 v246, v1, 2, 2
v_exp_f32 v10, v10
v_mfma_f32_16x16x32_bf16 v[40:43], a[152:155], v[160:163], v[40:43]
v_lshl_add_u32 v241, v4, 3, v246
v_lshl_add_u32 v246, v4, 2, v246
v_exp_f32 v11, v11
v_mfma_f32_16x16x32_bf16 v[40:43], a[156:159], v[164:167], v[40:43]
v_cvt_pk_bf16_f32 v73, v10, v11
v_and_b32 v247, 3, v1
v_exp_f32 v12, v12
v_mfma_f32_16x16x32_bf16 v[48:51], a[156:159], v[180:183], v[140:143]
v_lshlrev_b32 v247, 3, v247
v_lshl_add_u32 v241, v241, 6, v247
v_exp_f32 v13, v13
v_mfma_f32_16x16x32_bf16 v[48:51], a[152:155], v[176:179], v[48:51]
s_and_b32 s28, s37, 1
v_cvt_pk_bf16_f32 v74, v12, v13
v_exp_f32 v14, v14
v_mfma_f32_16x16x32_bf16 v[48:51], a[148:151], v[172:175], v[48:51]
s_lshl_b32 s28, s28, 5
s_lshr_b32 s29, s37, 1
v_exp_f32 v15, v15
v_mfma_f32_16x16x32_bf16 v[48:51], a[144:147], v[168:171], v[48:51]
v_exp_f32 v16, v16
v_exp_f32 v17, v17
v_mfma_f32_16x16x32_bf16 v[56:59], a[144:147], v[184:187], v[144:147]
v_cvt_pk_bf16_f32 v75, v14, v15
v_cvt_pk_bf16_f32 v76, v16, v17
v_exp_f32 v18, v18
v_mfma_f32_16x16x32_bf16 v[56:59], a[148:151], v[188:191], v[56:59]
s_lshl_b32 s29, s29, 15
s_add_u32 s28, s28, s29
v_exp_f32 v19, v19
v_mfma_f32_16x16x32_bf16 v[56:59], a[152:155], v[192:195], v[56:59]
v_cvt_pk_bf16_f32 v77, v18, v19
v_add_u32 v241, s28, v241
v_exp_f32 v20, v20
v_mfma_f32_16x16x32_bf16 v[56:59], a[156:159], v[196:199], v[56:59]
v_mul_u32_u24 v242, 0x480, v246
v_add_u32 v242, v242, v247
v_exp_f32 v21, v21
v_mfma_f32_16x16x32_bf16 v[64:67], a[156:159], v[212:215], v[148:151]
s_waitcnt vmcnt(8) lgkmcnt(0)
s_barrier
v_exp_f32 v22, v22
v_mfma_f32_16x16x32_bf16 v[64:67], a[152:155], v[208:211], v[64:67]
ds_read_b64_tr_b16 a[176:177], v220 offset:32768
v_cvt_pk_bf16_f32 v78, v20, v21
v_exp_f32 v23, v23
v_mfma_f32_16x16x32_bf16 v[64:67], a[148:151], v[204:207], v[64:67]
v_exp_f32 v24, v24
v_exp_f32 v25, v25
v_mfma_f32_16x16x32_bf16 v[64:67], a[144:147], v[200:203], v[64:67]
v_cvt_pk_bf16_f32 v79, v22, v23
v_cvt_pk_bf16_f32 v80, v24, v25
v_exp_f32 v26, v26
v_mfma_f32_16x16x32_bf16 v[44:47], a[160:163], v[152:155], v[136:139]
ds_read_b64_tr_b16 a[178:179], v220 offset:36864
ds_read_b64_tr_b16 a[180:181], v221 offset:32768
v_exp_f32 v27, v27
v_mfma_f32_16x16x32_bf16 v[44:47], a[164:167], v[156:159], v[44:47]
ds_read_b64_tr_b16 a[182:183], v221 offset:36864
v_cvt_pk_bf16_f32 v81, v26, v27
v_exp_f32 v28, v28
v_mfma_f32_16x16x32_bf16 v[44:47], a[168:171], v[160:163], v[44:47]
ds_read_b64_tr_b16 a[184:185], v222 offset:32768
ds_read_b64_tr_b16 a[186:187], v222 offset:36864
v_exp_f32 v29, v29
v_mfma_f32_16x16x32_bf16 v[44:47], a[172:175], v[164:167], v[44:47]
ds_read_b64_tr_b16 a[188:189], v223 offset:32768
v_cvt_pk_bf16_f32 v82, v28, v29
v_exp_f32 v30, v30
v_mfma_f32_16x16x32_bf16 v[52:55], a[172:175], v[180:183], v[140:143]
ds_read_b64_tr_b16 a[190:191], v223 offset:36864
ds_read_b128 a[156:159], v219 offset:49152
v_exp_f32 v31, v31
v_mfma_f32_16x16x32_bf16 v[52:55], a[168:171], v[176:179], v[52:55]
v_exp_f32 v32, v32
v_exp_f32 v33, v33
v_mfma_f32_16x16x32_bf16 v[52:55], a[164:167], v[172:175], v[52:55]
v_cvt_pk_bf16_f32 v83, v30, v31
v_cvt_pk_bf16_f32 v84, v32, v33
v_exp_f32 v34, v34
v_mfma_f32_16x16x32_bf16 v[52:55], a[160:163], v[168:171], v[52:55]
ds_read_b64_tr_b16 a[192:193], v224 offset:32768
ds_read_b64_tr_b16 a[194:195], v224 offset:36864
v_exp_f32 v35, v35
v_mfma_f32_16x16x32_bf16 v[60:63], a[160:163], v[184:187], v[144:147]
ds_read_b128 a[152:155], v218 offset:49152
v_cvt_pk_bf16_f32 v85, v34, v35
v_exp_f32 v36, v36
v_mfma_f32_16x16x32_bf16 v[60:63], a[164:167], v[188:191], v[60:63]
ds_read_b128 a[148:151], v217 offset:49152
ds_read_b128 a[144:147], v216 offset:49152
v_exp_f32 v37, v37
v_mfma_f32_16x16x32_bf16 v[60:63], a[168:171], v[192:195], v[60:63]
ds_read_b64_tr_b16 a[196:197], v225 offset:32768
v_cvt_pk_bf16_f32 v86, v36, v37
v_exp_f32 v38, v38
v_mfma_f32_16x16x32_bf16 v[60:63], a[172:175], v[196:199], v[60:63]
ds_read_b64_tr_b16 a[198:199], v225 offset:36864
ds_read_b64_tr_b16 a[200:201], v226 offset:32768
v_exp_f32 v39, v39
v_mfma_f32_16x16x32_bf16 v[68:71], a[172:175], v[212:215], v[148:151]
ds_read_b64_tr_b16 a[202:203], v226 offset:36864
ds_read_b64_tr_b16 a[204:205], v227 offset:32768
ds_read_b64_tr_b16 a[206:207], v227 offset:36864
v_cvt_pk_bf16_f32 v87, v38, v39
v_mfma_f32_16x16x32_bf16 v[68:71], a[168:171], v[208:211], v[68:71]
ds_read_b128 a[172:175], v219 offset:53248
ds_read_b128 a[168:171], v218 offset:53248
s_add_u32 s32, s32, 16384
s_bitset0_b32 s32, 19
v_mfma_f32_16x16x32_bf16 v[68:71], a[164:167], v[204:207], v[68:71]
ds_read_b128 a[164:167], v217 offset:53248
s_add_u32 m0, s30, 81920
s_nop 0
buffer_load_dwordx4 v228, s[8:11], s32 offen offset:0  lds
v_mfma_f32_16x16x32_bf16 v[68:71], a[160:163], v[200:203], v[68:71]
ds_read_b128 a[160:163], v216 offset:53248
buffer_load_dwordx4 v229, s[8:11], s32 offen offset:1024  lds
s_mul_i32 s28, s37, 288
buffer_load_dwordx4 v230, s[8:11], s32 offen offset:2048  lds
buffer_load_dwordx4 v231, s[8:11], s32 offen offset:3072  lds
buffer_store_byte v255, v254, s[24:27], 0 offen sc0 sc1
s_waitcnt lgkmcnt(8)
v_mfma_f32_16x16x32_bf16 v[8:11], a[144:147], v[152:155], v[136:139]
v_exp_f32 v40, v40
v_mfma_f32_16x16x32_bf16 v[8:11], a[148:151], v[156:159], v[8:11]
v_exp_f32 v41, v41
v_mfma_f32_16x16x32_bf16 v[8:11], a[152:155], v[160:163], v[8:11]
s_add_u32 s28, s28, 8192
v_cvt_pk_bf16_f32 v88, v40, v41
v_mfma_f32_16x16x32_bf16 v[8:11], a[156:159], v[164:167], v[8:11]
v_exp_f32 v42, v42
v_mfma_f32_16x16x32_bf16 v[16:19], a[156:159], v[180:183], v[140:143]
s_add_u32 s39, s39, 16384
v_add_u32 v242, s28, v242
v_mfma_f32_16x16x32_bf16 v[16:19], a[152:155], v[176:179], v[16:19]
v_exp_f32 v43, v43
v_mfma_f32_16x16x32_bf16 v[16:19], a[148:151], v[172:175], v[16:19]
v_cvt_pk_bf16_f32 v89, v42, v43
v_mfma_f32_16x16x32_bf16 v[16:19], a[144:147], v[168:171], v[16:19]
v_exp_f32 v44, v44
v_mfma_f32_16x16x32_bf16 v[24:27], a[144:147], v[184:187], v[144:147]
v_mfma_f32_16x16x32_bf16 v[24:27], a[148:151], v[188:191], v[24:27]
v_exp_f32 v45, v45
v_mfma_f32_16x16x32_bf16 v[24:27], a[152:155], v[192:195], v[24:27]
v_cvt_pk_bf16_f32 v90, v44, v45
v_mfma_f32_16x16x32_bf16 v[24:27], a[156:159], v[196:199], v[24:27]
v_exp_f32 v46, v46
v_mfma_f32_16x16x32_bf16 v[32:35], a[156:159], v[212:215], v[148:151]
ds_read_b128 a[156:159], v219 offset:57344
s_bitset0_b32 s39, 19
v_mfma_f32_16x16x32_bf16 v[32:35], a[152:155], v[208:211], v[32:35]
v_exp_f32 v47, v47
v_mfma_f32_16x16x32_bf16 v[32:35], a[148:151], v[204:207], v[32:35]
ds_read_b128 a[152:155], v218 offset:57344
v_cvt_pk_bf16_f32 v91, v46, v47
v_mfma_f32_16x16x32_bf16 v[32:35], a[144:147], v[200:203], v[32:35]
v_exp_f32 v48, v48
v_mfma_f32_16x16x32_bf16 a[0:3], a[176:179], v[72:75], 0
ds_read_b128 a[148:151], v217 offset:57344
ds_read_b128 a[144:147], v216 offset:57344
v_mfma_f32_16x16x32_bf16 a[4:7], a[176:179], v[76:79], 0
v_exp_f32 v49, v49
v_mfma_f32_16x16x32_bf16 a[8:11], a[176:179], v[80:83], 0
v_cvt_pk_bf16_f32 v92, v48, v49
v_mfma_f32_16x16x32_bf16 a[12:15], a[176:179], v[84:87], 0
v_exp_f32 v50, v50
v_mfma_f32_16x16x32_bf16 a[28:31], a[180:183], v[84:87], 0
ds_read_b64_tr_b16 a[176:177], v220 offset:40960
ds_read_b64_tr_b16 a[178:179], v220 offset:45056
v_mfma_f32_16x16x32_bf16 a[24:27], a[180:183], v[80:83], 0
v_exp_f32 v51, v51
v_mfma_f32_16x16x32_bf16 a[20:23], a[180:183], v[76:79], 0
s_add_u32 m0, s30, 98304
v_cvt_pk_bf16_f32 v93, v50, v51
v_mfma_f32_16x16x32_bf16 a[16:19], a[180:183], v[72:75], 0
v_exp_f32 v52, v52
v_mfma_f32_16x16x32_bf16 a[32:35], a[184:187], v[72:75], 0
ds_read_b64_tr_b16 a[180:181], v221 offset:40960
ds_read_b64_tr_b16 a[182:183], v221 offset:45056
v_mfma_f32_16x16x32_bf16 a[36:39], a[184:187], v[76:79], 0
v_exp_f32 v53, v53
v_mfma_f32_16x16x32_bf16 a[40:43], a[184:187], v[80:83], 0
v_cvt_pk_bf16_f32 v94, v52, v53
v_mfma_f32_16x16x32_bf16 a[44:47], a[184:187], v[84:87], 0
v_exp_f32 v54, v54
v_mfma_f32_16x16x32_bf16 a[60:63], a[188:191], v[84:87], 0
ds_read_b64_tr_b16 a[184:185], v222 offset:40960
ds_read_b64_tr_b16 a[186:187], v222 offset:45056
v_mfma_f32_16x16x32_bf16 a[56:59], a[188:191], v[80:83], 0
v_exp_f32 v55, v55
v_mfma_f32_16x16x32_bf16 a[52:55], a[188:191], v[76:79], 0
v_cvt_pk_bf16_f32 v95, v54, v55
v_mfma_f32_16x16x32_bf16 a[48:51], a[188:191], v[72:75], 0
v_exp_f32 v56, v56
v_smfmac_f32_16x16x64_bf16 a[128:131], a[208:211], v[72:79], v245
ds_read_b64_tr_b16 a[188:189], v223 offset:40960
s_waitcnt lgkmcnt(8)
v_mfma_f32_16x16x32_bf16 v[12:15], a[160:163], v[152:155], v[136:139]
v_exp_f32 v57, v57
v_mfma_f32_16x16x32_bf16 v[12:15], a[164:167], v[156:159], v[12:15]
v_exp_f32 v58, v58
v_mfma_f32_16x16x32_bf16 v[12:15], a[168:171], v[160:163], v[12:15]
ds_read_b64_tr_b16 a[190:191], v223 offset:45056
v_cvt_pk_bf16_f32 v96, v56, v57
v_mfma_f32_16x16x32_bf16 v[12:15], a[172:175], v[164:167], v[12:15]
v_exp_f32 v59, v59
v_mfma_f32_16x16x32_bf16 v[20:23], a[172:175], v[180:183], v[140:143]
v_cvt_pk_bf16_f32 v97, v58, v59
v_mfma_f32_16x16x32_bf16 v[20:23], a[168:171], v[176:179], v[20:23]
v_exp_f32 v60, v60
v_mfma_f32_16x16x32_bf16 v[20:23], a[164:167], v[172:175], v[20:23]
buffer_load_dwordx4 v232, s[12:15], s39 offen offset:0  lds
v_mfma_f32_16x16x32_bf16 v[20:23], a[160:163], v[168:171], v[20:23]
v_exp_f32 v61, v61
v_mfma_f32_16x16x32_bf16 v[28:31], a[160:163], v[184:187], v[144:147]
v_cvt_pk_bf16_f32 v98, v60, v61
v_mfma_f32_16x16x32_bf16 v[28:31], a[164:167], v[188:191], v[28:31]
v_exp_f32 v62, v62
v_mfma_f32_16x16x32_bf16 v[28:31], a[168:171], v[192:195], v[28:31]
buffer_load_dwordx4 v233, s[12:15], s39 offen offset:1024  lds
v_mfma_f32_16x16x32_bf16 v[28:31], a[172:175], v[196:199], v[28:31]
v_exp_f32 v63, v63
v_mfma_f32_16x16x32_bf16 v[36:39], a[172:175], v[212:215], v[148:151]
ds_read_b128 a[172:175], v219 offset:61440
v_cvt_pk_bf16_f32 v99, v62, v63
v_mfma_f32_16x16x32_bf16 v[36:39], a[168:171], v[208:211], v[36:39]
v_exp_f32 v64, v64
v_mfma_f32_16x16x32_bf16 v[36:39], a[164:167], v[204:207], v[36:39]
ds_read_b128 a[168:171], v218 offset:61440
ds_read_b128 a[164:167], v217 offset:61440
v_mfma_f32_16x16x32_bf16 v[36:39], a[160:163], v[200:203], v[36:39]
v_exp_f32 v65, v65
v_mfma_f32_16x16x32_bf16 a[64:67], a[192:195], v[72:75], 0
ds_read_b128 a[160:163], v216 offset:61440
v_cvt_pk_bf16_f32 v100, v64, v65
v_mfma_f32_16x16x32_bf16 a[68:71], a[192:195], v[76:79], 0
v_exp_f32 v66, v66
v_mfma_f32_16x16x32_bf16 a[72:75], a[192:195], v[80:83], 0
buffer_load_dwordx4 v232, s[12:15], s39 offen offset:2048  lds
v_mfma_f32_16x16x32_bf16 a[76:79], a[192:195], v[84:87], 0
v_exp_f32 v67, v67
v_mfma_f32_16x16x32_bf16 a[92:95], a[196:199], v[84:87], 0
ds_read_b64_tr_b16 a[192:193], v224 offset:40960
v_cvt_pk_bf16_f32 v101, v66, v67
v_mfma_f32_16x16x32_bf16 a[88:91], a[196:199], v[80:83], 0
v_exp_f32 v68, v68
v_mfma_f32_16x16x32_bf16 a[84:87], a[196:199], v[76:79], 0
ds_read_b64_tr_b16 a[194:195], v224 offset:45056
v_mfma_f32_16x16x32_bf16 a[80:83], a[196:199], v[72:75], 0
v_exp_f32 v69, v69
v_mfma_f32_16x16x32_bf16 a[96:99], a[200:203], v[72:75], 0
ds_read_b64_tr_b16 a[196:197], v225 offset:40960
v_cvt_pk_bf16_f32 v102, v68, v69
v_mfma_f32_16x16x32_bf16 a[100:103], a[200:203], v[76:79], 0
v_exp_f32 v70, v70
v_mfma_f32_16x16x32_bf16 a[104:107], a[200:203], v[80:83], 0
ds_read_b64_tr_b16 a[198:199], v225 offset:45056
v_mfma_f32_16x16x32_bf16 a[108:111], a[200:203], v[84:87], 0
v_exp_f32 v71, v71
v_mfma_f32_16x16x32_bf16 a[124:127], a[204:207], v[84:87], 0
ds_read_b64_tr_b16 a[200:201], v226 offset:40960
v_cvt_pk_bf16_f32 v103, v70, v71
v_mfma_f32_16x16x32_bf16 a[120:123], a[204:207], v[80:83], 0
ds_read_b64_tr_b16 a[202:203], v226 offset:45056
v_mfma_f32_16x16x32_bf16 a[116:119], a[204:207], v[76:79], 0
buffer_load_dwordx4 v233, s[12:15], s39 offen offset:3072  lds
v_mfma_f32_16x16x32_bf16 a[112:115], a[204:207], v[72:75], 0
ds_read_b64_tr_b16 a[204:205], v227 offset:40960
ds_read_b64_tr_b16 a[206:207], v227 offset:45056
v_smfmac_f32_16x16x64_bf16 a[132:135], a[208:211], v[80:87], v245
s_waitcnt lgkmcnt(8)
v_mfma_f32_16x16x32_bf16 v[40:43], a[144:147], v[152:155], v[136:139]
v_exp_f32 v8, v8
v_mfma_f32_16x16x32_bf16 v[40:43], a[148:151], v[156:159], v[40:43]
v_exp_f32 v9, v9
v_mfma_f32_16x16x32_bf16 v[40:43], a[152:155], v[160:163], v[40:43]
v_cvt_pk_bf16_f32 v72, v8, v9
v_lshlrev_b32 v250, 3, v1
v_mfma_f32_16x16x32_bf16 v[40:43], a[156:159], v[164:167], v[40:43]
v_exp_f32 v10, v10
v_mfma_f32_16x16x32_bf16 v[48:51], a[156:159], v[180:183], v[140:143]
v_mfma_f32_16x16x32_bf16 v[48:51], a[152:155], v[176:179], v[48:51]
v_exp_f32 v11, v11
v_mfma_f32_16x16x32_bf16 v[48:51], a[148:151], v[172:175], v[48:51]
v_cvt_pk_bf16_f32 v73, v10, v11
v_mfma_f32_16x16x32_bf16 v[48:51], a[144:147], v[168:171], v[48:51]
v_exp_f32 v12, v12
v_mfma_f32_16x16x32_bf16 v[56:59], a[144:147], v[184:187], v[144:147]
v_mfma_f32_16x16x32_bf16 v[56:59], a[148:151], v[188:191], v[56:59]
v_exp_f32 v13, v13
v_mfma_f32_16x16x32_bf16 v[56:59], a[152:155], v[192:195], v[56:59]
v_cvt_pk_bf16_f32 v74, v12, v13
v_mfma_f32_16x16x32_bf16 v[56:59], a[156:159], v[196:199], v[56:59]
v_exp_f32 v14, v14
v_mfma_f32_16x16x32_bf16 v[64:67], a[156:159], v[212:215], v[148:151]
s_waitcnt vmcnt(9) lgkmcnt(0)
s_barrier
v_mfma_f32_16x16x32_bf16 v[64:67], a[152:155], v[208:211], v[64:67]
v_exp_f32 v15, v15
v_mfma_f32_16x16x32_bf16 v[64:67], a[148:151], v[204:207], v[64:67]
ds_read_b128 a[156:159], v219 offset:0
v_cvt_pk_bf16_f32 v75, v14, v15
v_mfma_f32_16x16x32_bf16 v[64:67], a[144:147], v[200:203], v[64:67]
v_exp_f32 v16, v16
v_mfma_f32_16x16x32_bf16 a[0:3], a[176:179], v[88:91], a[0:3]
ds_read_b128 a[152:155], v218 offset:0
ds_read_b128 a[148:151], v217 offset:0
v_mfma_f32_16x16x32_bf16 a[4:7], a[176:179], v[92:95], a[4:7]
v_exp_f32 v17, v17
v_mfma_f32_16x16x32_bf16 a[8:11], a[176:179], v[96:99], a[8:11]
ds_read_b128 a[144:147], v216 offset:0
v_cvt_pk_bf16_f32 v76, v16, v17
v_mfma_f32_16x16x32_bf16 a[12:15], a[176:179], v[100:103], a[12:15]
v_exp_f32 v18, v18
v_mfma_f32_16x16x32_bf16 a[28:31], a[180:183], v[100:103], a[28:31]
ds_read_b64_tr_b16 a[176:177], v220 offset:49152
ds_read_b64_tr_b16 a[178:179], v220 offset:53248
v_mfma_f32_16x16x32_bf16 a[24:27], a[180:183], v[96:99], a[24:27]
v_exp_f32 v19, v19
v_mfma_f32_16x16x32_bf16 a[20:23], a[180:183], v[92:95], a[20:23]
s_add_u32 s32, s32, 16384
v_cvt_pk_bf16_f32 v77, v18, v19
v_mfma_f32_16x16x32_bf16 a[16:19], a[180:183], v[88:91], a[16:19]
v_exp_f32 v20, v20
v_mfma_f32_16x16x32_bf16 a[32:35], a[184:187], v[88:91], a[32:35]
ds_read_b64_tr_b16 a[180:181], v221 offset:49152
ds_read_b64_tr_b16 a[182:183], v221 offset:53248
v_mfma_f32_16x16x32_bf16 a[36:39], a[184:187], v[92:95], a[36:39]
v_exp_f32 v21, v21
v_mfma_f32_16x16x32_bf16 a[40:43], a[184:187], v[96:99], a[40:43]
s_bitset0_b32 s32, 19
v_cvt_pk_bf16_f32 v78, v20, v21
v_mfma_f32_16x16x32_bf16 a[44:47], a[184:187], v[100:103], a[44:47]
v_exp_f32 v22, v22
v_mfma_f32_16x16x32_bf16 a[60:63], a[188:191], v[100:103], a[60:63]
ds_read_b64_tr_b16 a[184:185], v222 offset:49152
ds_read_b64_tr_b16 a[186:187], v222 offset:53248
v_mfma_f32_16x16x32_bf16 a[56:59], a[188:191], v[96:99], a[56:59]
v_exp_f32 v23, v23
v_mfma_f32_16x16x32_bf16 a[52:55], a[188:191], v[92:95], a[52:55]
s_add_u32 m0, s30, 114688
v_cvt_pk_bf16_f32 v79, v22, v23
v_mfma_f32_16x16x32_bf16 a[48:51], a[188:191], v[88:91], a[48:51]
v_exp_f32 v24, v24
v_smfmac_f32_16x16x64_bf16 a[128:131], a[208:211], v[88:95], v245
ds_read_b64_tr_b16 a[188:189], v223 offset:49152
v_mfma_f32_16x16x32_bf16 v[44:47], a[160:163], v[152:155], v[136:139]
v_exp_f32 v25, v25
v_mfma_f32_16x16x32_bf16 v[44:47], a[164:167], v[156:159], v[44:47]
v_exp_f32 v26, v26
v_mfma_f32_16x16x32_bf16 v[44:47], a[168:171], v[160:163], v[44:47]
ds_read_b64_tr_b16 a[190:191], v223 offset:53248
v_cvt_pk_bf16_f32 v80, v24, v25
v_mfma_f32_16x16x32_bf16 v[44:47], a[172:175], v[164:167], v[44:47]
v_exp_f32 v27, v27
v_mfma_f32_16x16x32_bf16 v[52:55], a[172:175], v[180:183], v[140:143]
v_cvt_pk_bf16_f32 v81, v26, v27
v_mfma_f32_16x16x32_bf16 v[52:55], a[168:171], v[176:179], v[52:55]
v_exp_f32 v28, v28
v_mfma_f32_16x16x32_bf16 v[52:55], a[164:167], v[172:175], v[52:55]
buffer_load_dwordx4 v228, s[8:11], s32 offen offset:0  lds
v_mfma_f32_16x16x32_bf16 v[52:55], a[160:163], v[168:171], v[52:55]
v_exp_f32 v29, v29
v_mfma_f32_16x16x32_bf16 v[60:63], a[160:163], v[184:187], v[144:147]
v_cvt_pk_bf16_f32 v82, v28, v29
v_mfma_f32_16x16x32_bf16 v[60:63], a[164:167], v[188:191], v[60:63]
v_exp_f32 v30, v30
v_mfma_f32_16x16x32_bf16 v[60:63], a[168:171], v[192:195], v[60:63]
buffer_load_dwordx4 v229, s[8:11], s32 offen offset:1024  lds
v_mfma_f32_16x16x32_bf16 v[60:63], a[172:175], v[196:199], v[60:63]
v_exp_f32 v31, v31
v_mfma_f32_16x16x32_bf16 v[68:71], a[172:175], v[212:215], v[148:151]
ds_read_b128 a[172:175], v219 offset:4096
v_cvt_pk_bf16_f32 v83, v30, v31
v_mfma_f32_16x16x32_bf16 v[68:71], a[168:171], v[208:211], v[68:71]
v_exp_f32 v32, v32
v_mfma_f32_16x16x32_bf16 v[68:71], a[164:167], v[204:207], v[68:71]
ds_read_b128 a[168:171], v218 offset:4096
ds_read_b128 a[164:167], v217 offset:4096
v_mfma_f32_16x16x32_bf16 v[68:71], a[160:163], v[200:203], v[68:71]
v_exp_f32 v33, v33
v_mfma_f32_16x16x32_bf16 a[64:67], a[192:195], v[88:91], a[64:67]
ds_read_b128 a[160:163], v216 offset:4096
v_cvt_pk_bf16_f32 v84, v32, v33
v_mfma_f32_16x16x32_bf16 a[68:71], a[192:195], v[92:95], a[68:71]
v_exp_f32 v34, v34
v_mfma_f32_16x16x32_bf16 a[72:75], a[192:195], v[96:99], a[72:75]
buffer_load_dwordx4 v230, s[8:11], s32 offen offset:2048  lds
v_mfma_f32_16x16x32_bf16 a[76:79], a[192:195], v[100:103], a[76:79]
v_exp_f32 v35, v35
v_mfma_f32_16x16x32_bf16 a[92:95], a[196:199], v[100:103], a[92:95]
ds_read_b64_tr_b16 a[192:193], v224 offset:49152
v_cvt_pk_bf16_f32 v85, v34, v35
v_mfma_f32_16x16x32_bf16 a[88:91], a[196:199], v[96:99], a[88:91]
v_exp_f32 v36, v36
v_mfma_f32_16x16x32_bf16 a[84:87], a[196:199], v[92:95], a[84:87]
ds_read_b64_tr_b16 a[194:195], v224 offset:53248
v_mfma_f32_16x16x32_bf16 a[80:83], a[196:199], v[88:91], a[80:83]
v_exp_f32 v37, v37
v_mfma_f32_16x16x32_bf16 a[96:99], a[200:203], v[88:91], a[96:99]
ds_read_b64_tr_b16 a[196:197], v225 offset:49152
v_cvt_pk_bf16_f32 v86, v36, v37
v_mfma_f32_16x16x32_bf16 a[100:103], a[200:203], v[92:95], a[100:103]
v_exp_f32 v38, v38
v_mfma_f32_16x16x32_bf16 a[104:107], a[200:203], v[96:99], a[104:107]
ds_read_b64_tr_b16 a[198:199], v225 offset:53248
v_mfma_f32_16x16x32_bf16 a[108:111], a[200:203], v[100:103], a[108:111]
v_exp_f32 v39, v39
v_mfma_f32_16x16x32_bf16 a[124:127], a[204:207], v[100:103], a[124:127]
ds_read_b64_tr_b16 a[200:201], v226 offset:49152
v_cvt_pk_bf16_f32 v87, v38, v39
v_mfma_f32_16x16x32_bf16 a[120:123], a[204:207], v[96:99], a[120:123]
STUB_4:
s_cbranch_execz STUB_7
ds_read_b64_tr_b16 a[202:203], v226 offset:53248
v_mfma_f32_16x16x32_bf16 a[116:119], a[204:207], v[92:95], a[116:119]
buffer_load_dwordx4 v231, s[8:11], s32 offen offset:3072  lds
v_mfma_f32_16x16x32_bf16 a[112:115], a[204:207], v[88:91], a[112:115]
ds_read_b64_tr_b16 a[204:205], v227 offset:49152
ds_read_b64_tr_b16 a[206:207], v227 offset:53248
v_smfmac_f32_16x16x64_bf16 a[132:135], a[208:211], v[96:103], v245
s_add_u32 m0, s86, 0
s_add_u32 s50, s84, 0
buffer_load_dwordx4 v240, s[64:67], s50 offen lds
s_add_u32 m0, s86, 4096
s_add_u32 s50, s84, 589824
buffer_load_dwordx4 v240, s[64:67], s50 offen lds
s_waitcnt lgkmcnt(8)
v_mfma_f32_16x16x32_bf16 v[8:11], a[144:147], v[152:155], v[136:139]
v_exp_f32 v40, v40
v_mfma_f32_16x16x32_bf16 v[8:11], a[148:151], v[156:159], v[8:11]
v_exp_f32 v41, v41
v_mfma_f32_16x16x32_bf16 v[8:11], a[152:155], v[160:163], v[8:11]
v_cvt_pk_bf16_f32 v88, v40, v41
v_mfma_f32_16x16x32_bf16 v[8:11], a[156:159], v[164:167], v[8:11]
v_exp_f32 v42, v42
v_mfma_f32_16x16x32_bf16 v[16:19], a[156:159], v[180:183], v[140:143]
s_add_u32 s39, s39, 16384
v_mfma_f32_16x16x32_bf16 v[16:19], a[152:155], v[176:179], v[16:19]
v_exp_f32 v43, v43
v_mfma_f32_16x16x32_bf16 v[16:19], a[148:151], v[172:175], v[16:19]
v_cvt_pk_bf16_f32 v89, v42, v43
v_mfma_f32_16x16x32_bf16 v[16:19], a[144:147], v[168:171], v[16:19]
v_exp_f32 v44, v44
v_mfma_f32_16x16x32_bf16 v[24:27], a[144:147], v[184:187], v[144:147]
s_mov_b32 s29, 0x242000
buffer_load_dwordx2 v[248:249], v250, s[20:23], s29 offen sc0 sc1
v_mfma_f32_16x16x32_bf16 v[24:27], a[148:151], v[188:191], v[24:27]
v_exp_f32 v45, v45
v_mfma_f32_16x16x32_bf16 v[24:27], a[152:155], v[192:195], v[24:27]
s_bitset0_b32 s39, 19
v_cvt_pk_bf16_f32 v90, v44, v45
v_mfma_f32_16x16x32_bf16 v[24:27], a[156:159], v[196:199], v[24:27]
v_exp_f32 v46, v46
v_mfma_f32_16x16x32_bf16 v[32:35], a[156:159], v[212:215], v[148:151]
ds_read_b128 a[156:159], v219 offset:8192
v_mfma_f32_16x16x32_bf16 v[32:35], a[152:155], v[208:211], v[32:35]
v_exp_f32 v47, v47
v_mfma_f32_16x16x32_bf16 v[32:35], a[148:151], v[204:207], v[32:35]
ds_read_b128 a[152:155], v218 offset:8192
v_cvt_pk_bf16_f32 v91, v46, v47
v_mfma_f32_16x16x32_bf16 v[32:35], a[144:147], v[200:203], v[32:35]
v_exp_f32 v48, v48
v_mfma_f32_16x16x32_bf16 a[0:3], a[176:179], v[72:75], a[0:3]
ds_read_b128 a[148:151], v217 offset:8192
ds_read_b128 a[144:147], v216 offset:8192
v_mfma_f32_16x16x32_bf16 a[4:7], a[176:179], v[76:79], a[4:7]
v_exp_f32 v49, v49
v_mfma_f32_16x16x32_bf16 a[8:11], a[176:179], v[80:83], a[8:11]
s_add_u32 m0, s30, 131072
v_cvt_pk_bf16_f32 v92, v48, v49
v_mfma_f32_16x16x32_bf16 a[12:15], a[176:179], v[84:87], a[12:15]
v_exp_f32 v50, v50
v_mfma_f32_16x16x32_bf16 a[28:31], a[180:183], v[84:87], a[28:31]
ds_read_b64_tr_b16 a[176:177], v220 offset:57344
ds_read_b64_tr_b16 a[178:179], v220 offset:61440
v_mfma_f32_16x16x32_bf16 a[24:27], a[180:183], v[80:83], a[24:27]
v_exp_f32 v51, v51
v_mfma_f32_16x16x32_bf16 a[20:23], a[180:183], v[76:79], a[20:23]
v_cvt_pk_bf16_f32 v93, v50, v51
v_mfma_f32_16x16x32_bf16 a[16:19], a[180:183], v[72:75], a[16:19]
v_exp_f32 v52, v52
v_mfma_f32_16x16x32_bf16 a[32:35], a[184:187], v[72:75], a[32:35]
ds_read_b64_tr_b16 a[180:181], v221 offset:57344
ds_read_b64_tr_b16 a[182:183], v221 offset:61440
v_mfma_f32_16x16x32_bf16 a[36:39], a[184:187], v[76:79], a[36:39]
v_exp_f32 v53, v53
v_mfma_f32_16x16x32_bf16 a[40:43], a[184:187], v[80:83], a[40:43]
v_cvt_pk_bf16_f32 v94, v52, v53
v_mfma_f32_16x16x32_bf16 a[44:47], a[184:187], v[84:87], a[44:47]
v_exp_f32 v54, v54
v_mfma_f32_16x16x32_bf16 a[60:63], a[188:191], v[84:87], a[60:63]
ds_read_b64_tr_b16 a[184:185], v222 offset:57344
ds_read_b64_tr_b16 a[186:187], v222 offset:61440
v_mfma_f32_16x16x32_bf16 a[56:59], a[188:191], v[80:83], a[56:59]
v_exp_f32 v55, v55
v_mfma_f32_16x16x32_bf16 a[52:55], a[188:191], v[76:79], a[52:55]
v_cvt_pk_bf16_f32 v95, v54, v55
v_mfma_f32_16x16x32_bf16 a[48:51], a[188:191], v[72:75], a[48:51]
v_exp_f32 v56, v56
v_smfmac_f32_16x16x64_bf16 a[128:131], a[208:211], v[72:79], v245
ds_read_b64_tr_b16 a[188:189], v223 offset:57344
v_mfma_f32_16x16x32_bf16 v[12:15], a[160:163], v[152:155], v[136:139]
v_exp_f32 v57, v57
v_mfma_f32_16x16x32_bf16 v[12:15], a[164:167], v[156:159], v[12:15]
v_exp_f32 v58, v58
v_mfma_f32_16x16x32_bf16 v[12:15], a[168:171], v[160:163], v[12:15]
ds_read_b64_tr_b16 a[190:191], v223 offset:61440
v_cvt_pk_bf16_f32 v96, v56, v57
v_mfma_f32_16x16x32_bf16 v[12:15], a[172:175], v[164:167], v[12:15]
v_exp_f32 v59, v59
v_mfma_f32_16x16x32_bf16 v[20:23], a[172:175], v[180:183], v[140:143]
v_cvt_pk_bf16_f32 v97, v58, v59
v_mfma_f32_16x16x32_bf16 v[20:23], a[168:171], v[176:179], v[20:23]
v_exp_f32 v60, v60
v_mfma_f32_16x16x32_bf16 v[20:23], a[164:167], v[172:175], v[20:23]
buffer_load_dwordx4 v232, s[12:15], s39 offen offset:0  lds
v_mfma_f32_16x16x32_bf16 v[20:23], a[160:163], v[168:171], v[20:23]
v_exp_f32 v61, v61
v_mfma_f32_16x16x32_bf16 v[28:31], a[160:163], v[184:187], v[144:147]
v_cvt_pk_bf16_f32 v98, v60, v61
v_mfma_f32_16x16x32_bf16 v[28:31], a[164:167], v[188:191], v[28:31]
v_exp_f32 v62, v62
v_mfma_f32_16x16x32_bf16 v[28:31], a[168:171], v[192:195], v[28:31]
buffer_load_dwordx4 v233, s[12:15], s39 offen offset:1024  lds
v_mfma_f32_16x16x32_bf16 v[28:31], a[172:175], v[196:199], v[28:31]
v_exp_f32 v63, v63
v_mfma_f32_16x16x32_bf16 v[36:39], a[172:175], v[212:215], v[148:151]
ds_read_b128 a[172:175], v219 offset:12288
v_cvt_pk_bf16_f32 v99, v62, v63
v_mfma_f32_16x16x32_bf16 v[36:39], a[168:171], v[208:211], v[36:39]
v_exp_f32 v64, v64
v_mfma_f32_16x16x32_bf16 v[36:39], a[164:167], v[204:207], v[36:39]
ds_read_b128 a[168:171], v218 offset:12288
ds_read_b128 a[164:167], v217 offset:12288
v_mfma_f32_16x16x32_bf16 v[36:39], a[160:163], v[200:203], v[36:39]
v_exp_f32 v65, v65
s_waitcnt lgkmcnt(8)
v_mfma_f32_16x16x32_bf16 a[64:67], a[192:195], v[72:75], a[64:67]
ds_read_b128 a[160:163], v216 offset:12288
v_cvt_pk_bf16_f32 v100, v64, v65
v_mfma_f32_16x16x32_bf16 a[68:71], a[192:195], v[76:79], a[68:71]
v_exp_f32 v66, v66
v_mfma_f32_16x16x32_bf16 a[72:75], a[192:195], v[80:83], a[72:75]
buffer_load_dwordx4 v232, s[12:15], s39 offen offset:2048  lds
v_mfma_f32_16x16x32_bf16 a[76:79], a[192:195], v[84:87], a[76:79]
v_exp_f32 v67, v67
v_mfma_f32_16x16x32_bf16 a[92:95], a[196:199], v[84:87], a[92:95]
ds_read_b64_tr_b16 a[192:193], v224 offset:57344
v_cvt_pk_bf16_f32 v101, v66, v67
v_mfma_f32_16x16x32_bf16 a[88:91], a[196:199], v[80:83], a[88:91]
v_exp_f32 v68, v68
v_mfma_f32_16x16x32_bf16 a[84:87], a[196:199], v[76:79], a[84:87]
ds_read_b64_tr_b16 a[194:195], v224 offset:61440
v_mfma_f32_16x16x32_bf16 a[80:83], a[196:199], v[72:75], a[80:83]
v_exp_f32 v69, v69
v_mfma_f32_16x16x32_bf16 a[96:99], a[200:203], v[72:75], a[96:99]
ds_read_b64_tr_b16 a[196:197], v225 offset:57344
v_cvt_pk_bf16_f32 v102, v68, v69
v_mfma_f32_16x16x32_bf16 a[100:103], a[200:203], v[76:79], a[100:103]
v_exp_f32 v70, v70
v_mfma_f32_16x16x32_bf16 a[104:107], a[200:203], v[80:83], a[104:107]
ds_read_b64_tr_b16 a[198:199], v225 offset:61440
v_mfma_f32_16x16x32_bf16 a[108:111], a[200:203], v[84:87], a[108:111]
v_exp_f32 v71, v71
v_mfma_f32_16x16x32_bf16 a[124:127], a[204:207], v[84:87], a[124:127]
ds_read_b64_tr_b16 a[200:201], v226 offset:57344
v_cvt_pk_bf16_f32 v103, v70, v71
v_mfma_f32_16x16x32_bf16 a[120:123], a[204:207], v[80:83], a[120:123]
ds_read_b64_tr_b16 a[202:203], v226 offset:61440
v_mfma_f32_16x16x32_bf16 a[116:119], a[204:207], v[76:79], a[116:119]
buffer_load_dwordx4 v233, s[12:15], s39 offen offset:3072  lds
v_mfma_f32_16x16x32_bf16 a[112:115], a[204:207], v[72:75], a[112:115]
ds_read_b64_tr_b16 a[204:205], v227 offset:57344
ds_read_b64_tr_b16 a[206:207], v227 offset:61440
v_smfmac_f32_16x16x64_bf16 a[132:135], a[208:211], v[80:87], v245
s_add_u32 m0, s86, 8192
s_add_u32 s50, s84, 1179648
buffer_load_dwordx4 v240, s[64:67], s50 offen lds
s_add_u32 m0, s86, 12288
s_add_u32 s50, s84, 1769472
buffer_load_dwordx4 v240, s[64:67], s50 offen lds
v_mfma_f32_16x16x32_bf16 v[40:43], a[144:147], v[152:155], v[136:139]
v_exp_f32 v8, v8
v_mfma_f32_16x16x32_bf16 v[40:43], a[148:151], v[156:159], v[40:43]
v_exp_f32 v9, v9
v_mfma_f32_16x16x32_bf16 v[40:43], a[152:155], v[160:163], v[40:43]
v_cvt_pk_bf16_f32 v72, v8, v9
v_mfma_f32_16x16x32_bf16 v[40:43], a[156:159], v[164:167], v[40:43]
v_exp_f32 v10, v10
v_mfma_f32_16x16x32_bf16 v[48:51], a[156:159], v[180:183], v[140:143]
v_mfma_f32_16x16x32_bf16 v[48:51], a[152:155], v[176:179], v[48:51]
v_exp_f32 v11, v11
v_mfma_f32_16x16x32_bf16 v[48:51], a[148:151], v[172:175], v[48:51]
v_cvt_pk_bf16_f32 v73, v10, v11
v_mfma_f32_16x16x32_bf16 v[48:51], a[144:147], v[168:171], v[48:51]
v_exp_f32 v12, v12
v_mfma_f32_16x16x32_bf16 v[56:59], a[144:147], v[184:187], v[144:147]
v_mfma_f32_16x16x32_bf16 v[56:59], a[148:151], v[188:191], v[56:59]
v_exp_f32 v13, v13
v_mfma_f32_16x16x32_bf16 v[56:59], a[152:155], v[192:195], v[56:59]
v_cvt_pk_bf16_f32 v74, v12, v13
v_mfma_f32_16x16x32_bf16 v[56:59], a[156:159], v[196:199], v[56:59]
v_exp_f32 v14, v14
v_mfma_f32_16x16x32_bf16 v[64:67], a[156:159], v[212:215], v[148:151]
s_waitcnt vmcnt(13) lgkmcnt(0)
s_barrier
v_mfma_f32_16x16x32_bf16 v[64:67], a[152:155], v[208:211], v[64:67]
v_exp_f32 v15, v15
v_mfma_f32_16x16x32_bf16 v[64:67], a[148:151], v[204:207], v[64:67]
ds_read_b128 a[156:159], v219 offset:16384
v_cvt_pk_bf16_f32 v75, v14, v15
v_mfma_f32_16x16x32_bf16 v[64:67], a[144:147], v[200:203], v[64:67]
v_exp_f32 v16, v16
v_mfma_f32_16x16x32_bf16 a[0:3], a[176:179], v[88:91], a[0:3]
ds_read_b128 a[152:155], v218 offset:16384
ds_read_b128 a[148:151], v217 offset:16384
v_mfma_f32_16x16x32_bf16 a[4:7], a[176:179], v[92:95], a[4:7]
v_exp_f32 v17, v17
v_mfma_f32_16x16x32_bf16 a[8:11], a[176:179], v[96:99], a[8:11]
ds_read_b128 a[144:147], v216 offset:16384
v_cvt_pk_bf16_f32 v76, v16, v17
v_mfma_f32_16x16x32_bf16 a[12:15], a[176:179], v[100:103], a[12:15]
v_exp_f32 v18, v18
v_mfma_f32_16x16x32_bf16 a[28:31], a[180:183], v[100:103], a[28:31]
ds_read_b64_tr_b16 a[176:177], v220 offset:0
ds_read_b64_tr_b16 a[178:179], v220 offset:4096
v_mfma_f32_16x16x32_bf16 a[24:27], a[180:183], v[96:99], a[24:27]
v_exp_f32 v19, v19
v_mfma_f32_16x16x32_bf16 a[20:23], a[180:183], v[92:95], a[20:23]
s_add_u32 s32, s32, 16384
v_cvt_pk_bf16_f32 v77, v18, v19
v_mfma_f32_16x16x32_bf16 a[16:19], a[180:183], v[88:91], a[16:19]
v_exp_f32 v20, v20
v_mfma_f32_16x16x32_bf16 a[32:35], a[184:187], v[88:91], a[32:35]
ds_read_b64_tr_b16 a[180:181], v221 offset:0
ds_read_b64_tr_b16 a[182:183], v221 offset:4096
v_mfma_f32_16x16x32_bf16 a[36:39], a[184:187], v[92:95], a[36:39]
v_exp_f32 v21, v21
v_mfma_f32_16x16x32_bf16 a[40:43], a[184:187], v[96:99], a[40:43]
s_bitset0_b32 s32, 19
v_cvt_pk_bf16_f32 v78, v20, v21
v_mfma_f32_16x16x32_bf16 a[44:47], a[184:187], v[100:103], a[44:47]
v_exp_f32 v22, v22
v_mfma_f32_16x16x32_bf16 a[60:63], a[188:191], v[100:103], a[60:63]
ds_read_b64_tr_b16 a[184:185], v222 offset:0
ds_read_b64_tr_b16 a[186:187], v222 offset:4096
v_mfma_f32_16x16x32_bf16 a[56:59], a[188:191], v[96:99], a[56:59]
v_exp_f32 v23, v23
v_mfma_f32_16x16x32_bf16 a[52:55], a[188:191], v[92:95], a[52:55]
s_add_u32 m0, s30, 65536
v_cvt_pk_bf16_f32 v79, v22, v23
v_mfma_f32_16x16x32_bf16 a[48:51], a[188:191], v[88:91], a[48:51]
v_exp_f32 v24, v24
v_smfmac_f32_16x16x64_bf16 a[128:131], a[208:211], v[88:95], v245
ds_read_b64_tr_b16 a[188:189], v223 offset:0
v_mfma_f32_16x16x32_bf16 v[44:47], a[160:163], v[152:155], v[136:139]
v_exp_f32 v25, v25
v_mfma_f32_16x16x32_bf16 v[44:47], a[164:167], v[156:159], v[44:47]
v_exp_f32 v26, v26
v_mfma_f32_16x16x32_bf16 v[44:47], a[168:171], v[160:163], v[44:47]
ds_read_b64_tr_b16 a[190:191], v223 offset:4096
v_cvt_pk_bf16_f32 v80, v24, v25
v_mfma_f32_16x16x32_bf16 v[44:47], a[172:175], v[164:167], v[44:47]
v_exp_f32 v27, v27
v_mfma_f32_16x16x32_bf16 v[52:55], a[172:175], v[180:183], v[140:143]
v_cvt_pk_bf16_f32 v81, v26, v27
v_mfma_f32_16x16x32_bf16 v[52:55], a[168:171], v[176:179], v[52:55]
v_exp_f32 v28, v28
v_mfma_f32_16x16x32_bf16 v[52:55], a[164:167], v[172:175], v[52:55]
buffer_load_dwordx4 v228, s[8:11], s32 offen offset:0  lds
v_mfma_f32_16x16x32_bf16 v[52:55], a[160:163], v[168:171], v[52:55]
v_exp_f32 v29, v29
v_mfma_f32_16x16x32_bf16 v[60:63], a[160:163], v[184:187], v[144:147]
v_cvt_pk_bf16_f32 v82, v28, v29
v_mfma_f32_16x16x32_bf16 v[60:63], a[164:167], v[188:191], v[60:63]
v_exp_f32 v30, v30
v_mfma_f32_16x16x32_bf16 v[60:63], a[168:171], v[192:195], v[60:63]
buffer_load_dwordx4 v229, s[8:11], s32 offen offset:1024  lds
v_mfma_f32_16x16x32_bf16 v[60:63], a[172:175], v[196:199], v[60:63]
v_exp_f32 v31, v31
v_mfma_f32_16x16x32_bf16 v[68:71], a[172:175], v[212:215], v[148:151]
ds_read_b128 a[172:175], v219 offset:20480
v_cvt_pk_bf16_f32 v83, v30, v31
v_mfma_f32_16x16x32_bf16 v[68:71], a[168:171], v[208:211], v[68:71]
v_exp_f32 v32, v32
v_mfma_f32_16x16x32_bf16 v[68:71], a[164:167], v[204:207], v[68:71]
ds_read_b128 a[168:171], v218 offset:20480
ds_read_b128 a[164:167], v217 offset:20480
v_mfma_f32_16x16x32_bf16 v[68:71], a[160:163], v[200:203], v[68:71]
v_exp_f32 v33, v33
v_mfma_f32_16x16x32_bf16 a[64:67], a[192:195], v[88:91], a[64:67]
ds_read_b128 a[160:163], v216 offset:20480
v_cvt_pk_bf16_f32 v84, v32, v33
v_mfma_f32_16x16x32_bf16 a[68:71], a[192:195], v[92:95], a[68:71]
v_exp_f32 v34, v34
v_mfma_f32_16x16x32_bf16 a[72:75], a[192:195], v[96:99], a[72:75]
buffer_load_dwordx4 v230, s[8:11], s32 offen offset:2048  lds
v_mfma_f32_16x16x32_bf16 a[76:79], a[192:195], v[100:103], a[76:79]
v_exp_f32 v35, v35
v_mfma_f32_16x16x32_bf16 a[92:95], a[196:199], v[100:103], a[92:95]
ds_read_b64_tr_b16 a[192:193], v224 offset:0
v_cvt_pk_bf16_f32 v85, v34, v35
v_mfma_f32_16x16x32_bf16 a[88:91], a[196:199], v[96:99], a[88:91]
v_exp_f32 v36, v36
v_mfma_f32_16x16x32_bf16 a[84:87], a[196:199], v[92:95], a[84:87]
ds_read_b64_tr_b16 a[194:195], v224 offset:4096
v_mfma_f32_16x16x32_bf16 a[80:83], a[196:199], v[88:91], a[80:83]
v_exp_f32 v37, v37
v_mfma_f32_16x16x32_bf16 a[96:99], a[200:203], v[88:91], a[96:99]
ds_read_b64_tr_b16 a[196:197], v225 offset:0
v_cvt_pk_bf16_f32 v86, v36, v37
v_mfma_f32_16x16x32_bf16 a[100:103], a[200:203], v[92:95], a[100:103]
v_exp_f32 v38, v38
v_mfma_f32_16x16x32_bf16 a[104:107], a[200:203], v[96:99], a[104:107]
ds_read_b64_tr_b16 a[198:199], v225 offset:4096
v_mfma_f32_16x16x32_bf16 a[108:111], a[200:203], v[100:103], a[108:111]
v_exp_f32 v39, v39
v_mfma_f32_16x16x32_bf16 a[124:127], a[204:207], v[100:103], a[124:127]
ds_read_b64_tr_b16 a[200:201], v226 offset:0
v_cvt_pk_bf16_f32 v87, v38, v39
v_mfma_f32_16x16x32_bf16 a[120:123], a[204:207], v[96:99], a[120:123]
ds_read_b64_tr_b16 a[202:203], v226 offset:4096
v_mfma_f32_16x16x32_bf16 a[116:119], a[204:207], v[92:95], a[116:119]
buffer_load_dwordx4 v231, s[8:11], s32 offen offset:3072  lds
v_mfma_f32_16x16x32_bf16 a[112:115], a[204:207], v[88:91], a[112:115]
ds_read_b64_tr_b16 a[204:205], v227 offset:0
ds_read_b64_tr_b16 a[206:207], v227 offset:4096
v_smfmac_f32_16x16x64_bf16 a[132:135], a[208:211], v[96:103], v245
s_add_u32 m0, s86, 16384
s_add_u32 s50, s84, 2359296
buffer_load_dwordx4 v240, s[64:67], s50 offen lds
s_add_u32 m0, s86, 20480
s_add_u32 s50, s84, 2949120
buffer_load_dwordx4 v240, s[64:67], s50 offen lds
s_waitcnt lgkmcnt(8)
v_mfma_f32_16x16x32_bf16 v[8:11], a[144:147], v[152:155], v[136:139]
v_exp_f32 v40, v40
v_mfma_f32_16x16x32_bf16 v[8:11], a[148:151], v[156:159], v[8:11]
v_exp_f32 v41, v41
v_mfma_f32_16x16x32_bf16 v[8:11], a[152:155], v[160:163], v[8:11]
v_cvt_pk_bf16_f32 v88, v40, v41
v_mfma_f32_16x16x32_bf16 v[8:11], a[156:159], v[164:167], v[8:11]
v_exp_f32 v42, v42
v_mfma_f32_16x16x32_bf16 v[16:19], a[156:159], v[180:183], v[140:143]
s_add_u32 s39, s39, 16384
v_mfma_f32_16x16x32_bf16 v[16:19], a[152:155], v[176:179], v[16:19]
v_exp_f32 v43, v43
v_mfma_f32_16x16x32_bf16 v[16:19], a[148:151], v[172:175], v[16:19]
v_cvt_pk_bf16_f32 v89, v42, v43
v_mfma_f32_16x16x32_bf16 v[16:19], a[144:147], v[168:171], v[16:19]
v_exp_f32 v44, v44
v_mfma_f32_16x16x32_bf16 v[24:27], a[144:147], v[184:187], v[144:147]
v_mfma_f32_16x16x32_bf16 v[24:27], a[148:151], v[188:191], v[24:27]
v_exp_f32 v45, v45
v_mfma_f32_16x16x32_bf16 v[24:27], a[152:155], v[192:195], v[24:27]
s_bitset0_b32 s39, 19
v_cvt_pk_bf16_f32 v90, v44, v45
v_mfma_f32_16x16x32_bf16 v[24:27], a[156:159], v[196:199], v[24:27]
v_exp_f32 v46, v46
v_mfma_f32_16x16x32_bf16 v[32:35], a[156:159], v[212:215], v[148:151]
ds_read_b128 a[156:159], v219 offset:24576
v_mfma_f32_16x16x32_bf16 v[32:35], a[152:155], v[208:211], v[32:35]
v_exp_f32 v47, v47
v_mfma_f32_16x16x32_bf16 v[32:35], a[148:151], v[204:207], v[32:35]
ds_read_b128 a[152:155], v218 offset:24576
v_cvt_pk_bf16_f32 v91, v46, v47
v_mfma_f32_16x16x32_bf16 v[32:35], a[144:147], v[200:203], v[32:35]
v_exp_f32 v48, v48
v_mfma_f32_16x16x32_bf16 a[0:3], a[176:179], v[72:75], a[0:3]
ds_read_b128 a[148:151], v217 offset:24576
ds_read_b128 a[144:147], v216 offset:24576
v_mfma_f32_16x16x32_bf16 a[4:7], a[176:179], v[76:79], a[4:7]
v_exp_f32 v49, v49
v_mfma_f32_16x16x32_bf16 a[8:11], a[176:179], v[80:83], a[8:11]
s_add_u32 m0, s30, 147456
v_cvt_pk_bf16_f32 v92, v48, v49
v_mfma_f32_16x16x32_bf16 a[12:15], a[176:179], v[84:87], a[12:15]
v_exp_f32 v50, v50
v_mfma_f32_16x16x32_bf16 a[28:31], a[180:183], v[84:87], a[28:31]
ds_read_b64_tr_b16 a[176:177], v220 offset:8192
ds_read_b64_tr_b16 a[178:179], v220 offset:12288
v_mfma_f32_16x16x32_bf16 a[24:27], a[180:183], v[80:83], a[24:27]
v_exp_f32 v51, v51
v_mfma_f32_16x16x32_bf16 a[20:23], a[180:183], v[76:79], a[20:23]
v_cvt_pk_bf16_f32 v93, v50, v51
v_mfma_f32_16x16x32_bf16 a[16:19], a[180:183], v[72:75], a[16:19]
v_exp_f32 v52, v52
v_mfma_f32_16x16x32_bf16 a[32:35], a[184:187], v[72:75], a[32:35]
ds_read_b64_tr_b16 a[180:181], v221 offset:8192
ds_read_b64_tr_b16 a[182:183], v221 offset:12288
v_mfma_f32_16x16x32_bf16 a[36:39], a[184:187], v[76:79], a[36:39]
v_exp_f32 v53, v53
v_mfma_f32_16x16x32_bf16 a[40:43], a[184:187], v[80:83], a[40:43]
v_cvt_pk_bf16_f32 v94, v52, v53
v_mfma_f32_16x16x32_bf16 a[44:47], a[184:187], v[84:87], a[44:47]
v_exp_f32 v54, v54
v_mfma_f32_16x16x32_bf16 a[60:63], a[188:191], v[84:87], a[60:63]
ds_read_b64_tr_b16 a[184:185], v222 offset:8192
ds_read_b64_tr_b16 a[186:187], v222 offset:12288
v_mfma_f32_16x16x32_bf16 a[56:59], a[188:191], v[80:83], a[56:59]
v_exp_f32 v55, v55
v_mfma_f32_16x16x32_bf16 a[52:55], a[188:191], v[76:79], a[52:55]
v_cvt_pk_bf16_f32 v95, v54, v55
v_mfma_f32_16x16x32_bf16 a[48:51], a[188:191], v[72:75], a[48:51]
v_exp_f32 v56, v56
v_smfmac_f32_16x16x64_bf16 a[128:131], a[208:211], v[72:79], v245
ds_read_b64_tr_b16 a[188:189], v223 offset:8192
v_mfma_f32_16x16x32_bf16 v[12:15], a[160:163], v[152:155], v[136:139]
v_exp_f32 v57, v57
v_mfma_f32_16x16x32_bf16 v[12:15], a[164:167], v[156:159], v[12:15]
v_exp_f32 v58, v58
v_mfma_f32_16x16x32_bf16 v[12:15], a[168:171], v[160:163], v[12:15]
ds_read_b64_tr_b16 a[190:191], v223 offset:12288
v_cvt_pk_bf16_f32 v96, v56, v57
v_mfma_f32_16x16x32_bf16 v[12:15], a[172:175], v[164:167], v[12:15]
v_exp_f32 v59, v59
v_mfma_f32_16x16x32_bf16 v[20:23], a[172:175], v[180:183], v[140:143]
v_cvt_pk_bf16_f32 v97, v58, v59
v_mfma_f32_16x16x32_bf16 v[20:23], a[168:171], v[176:179], v[20:23]
v_exp_f32 v60, v60
v_mfma_f32_16x16x32_bf16 v[20:23], a[164:167], v[172:175], v[20:23]
buffer_load_dwordx4 v232, s[12:15], s39 offen offset:0  lds
v_mfma_f32_16x16x32_bf16 v[20:23], a[160:163], v[168:171], v[20:23]
v_exp_f32 v61, v61
v_mfma_f32_16x16x32_bf16 v[28:31], a[160:163], v[184:187], v[144:147]
v_cvt_pk_bf16_f32 v98, v60, v61
v_mfma_f32_16x16x32_bf16 v[28:31], a[164:167], v[188:191], v[28:31]
v_exp_f32 v62, v62
v_mfma_f32_16x16x32_bf16 v[28:31], a[168:171], v[192:195], v[28:31]
buffer_load_dwordx4 v233, s[12:15], s39 offen offset:1024  lds
v_mfma_f32_16x16x32_bf16 v[28:31], a[172:175], v[196:199], v[28:31]
v_exp_f32 v63, v63
v_mfma_f32_16x16x32_bf16 v[36:39], a[172:175], v[212:215], v[148:151]
ds_read_b128 a[172:175], v219 offset:28672
v_cvt_pk_bf16_f32 v99, v62, v63
v_mfma_f32_16x16x32_bf16 v[36:39], a[168:171], v[208:211], v[36:39]
v_exp_f32 v64, v64
v_mfma_f32_16x16x32_bf16 v[36:39], a[164:167], v[204:207], v[36:39]
ds_read_b128 a[168:171], v218 offset:28672
ds_read_b128 a[164:167], v217 offset:28672
v_mfma_f32_16x16x32_bf16 v[36:39], a[160:163], v[200:203], v[36:39]
v_exp_f32 v65, v65
s_waitcnt lgkmcnt(8)
v_mfma_f32_16x16x32_bf16 a[64:67], a[192:195], v[72:75], a[64:67]
ds_read_b128 a[160:163], v216 offset:28672
v_cvt_pk_bf16_f32 v100, v64, v65
v_mfma_f32_16x16x32_bf16 a[68:71], a[192:195], v[76:79], a[68:71]
v_exp_f32 v66, v66
v_mfma_f32_16x16x32_bf16 a[72:75], a[192:195], v[80:83], a[72:75]
buffer_load_dwordx4 v232, s[12:15], s39 offen offset:2048  lds
v_mfma_f32_16x16x32_bf16 a[76:79], a[192:195], v[84:87], a[76:79]
v_exp_f32 v67, v67
v_mfma_f32_16x16x32_bf16 a[92:95], a[196:199], v[84:87], a[92:95]
ds_read_b64_tr_b16 a[192:193], v224 offset:8192
v_cvt_pk_bf16_f32 v101, v66, v67
v_mfma_f32_16x16x32_bf16 a[88:91], a[196:199], v[80:83], a[88:91]
v_exp_f32 v68, v68
v_mfma_f32_16x16x32_bf16 a[84:87], a[196:199], v[76:79], a[84:87]
ds_read_b64_tr_b16 a[194:195], v224 offset:12288
v_mfma_f32_16x16x32_bf16 a[80:83], a[196:199], v[72:75], a[80:83]
v_exp_f32 v69, v69
v_mfma_f32_16x16x32_bf16 a[96:99], a[200:203], v[72:75], a[96:99]
ds_read_b64_tr_b16 a[196:197], v225 offset:8192
v_cvt_pk_bf16_f32 v102, v68, v69
v_mfma_f32_16x16x32_bf16 a[100:103], a[200:203], v[76:79], a[100:103]
v_exp_f32 v70, v70
v_mfma_f32_16x16x32_bf16 a[104:107], a[200:203], v[80:83], a[104:107]
ds_read_b64_tr_b16 a[198:199], v225 offset:12288
v_mfma_f32_16x16x32_bf16 a[108:111], a[200:203], v[84:87], a[108:111]
v_exp_f32 v71, v71
v_mfma_f32_16x16x32_bf16 a[124:127], a[204:207], v[84:87], a[124:127]
ds_read_b64_tr_b16 a[200:201], v226 offset:8192
v_cvt_pk_bf16_f32 v103, v70, v71
v_mfma_f32_16x16x32_bf16 a[120:123], a[204:207], v[80:83], a[120:123]
ds_read_b64_tr_b16 a[202:203], v226 offset:12288
v_mfma_f32_16x16x32_bf16 a[116:119], a[204:207], v[76:79], a[116:119]
buffer_load_dwordx4 v233, s[12:15], s39 offen offset:3072  lds
v_mfma_f32_16x16x32_bf16 a[112:115], a[204:207], v[72:75], a[112:115]
ds_read_b64_tr_b16 a[204:205], v227 offset:8192
ds_read_b64_tr_b16 a[206:207], v227 offset:12288
v_smfmac_f32_16x16x64_bf16 a[132:135], a[208:211], v[80:87], v245
s_add_u32 m0, s86, 24576
s_add_u32 s50, s84, 3538944
buffer_load_dwordx4 v240, s[64:67], s50 offen lds
s_add_u32 m0, s86, 28672
s_add_u32 s50, s84, 4128768
buffer_load_dwordx4 v240, s[64:67], s50 offen lds
v_mfma_f32_16x16x32_bf16 v[40:43], a[144:147], v[152:155], v[136:139]
v_exp_f32 v8, v8
v_mfma_f32_16x16x32_bf16 v[40:43], a[148:151], v[156:159], v[40:43]
v_exp_f32 v9, v9
v_mfma_f32_16x16x32_bf16 v[40:43], a[152:155], v[160:163], v[40:43]
v_cvt_pk_bf16_f32 v72, v8, v9
v_mfma_f32_16x16x32_bf16 v[40:43], a[156:159], v[164:167], v[40:43]
v_exp_f32 v10, v10
v_mfma_f32_16x16x32_bf16 v[48:51], a[156:159], v[180:183], v[140:143]
v_mfma_f32_16x16x32_bf16 v[48:51], a[152:155], v[176:179], v[48:51]
v_exp_f32 v11, v11
v_mfma_f32_16x16x32_bf16 v[48:51], a[148:151], v[172:175], v[48:51]
v_cvt_pk_bf16_f32 v73, v10, v11
v_mfma_f32_16x16x32_bf16 v[48:51], a[144:147], v[168:171], v[48:51]
v_exp_f32 v12, v12
v_mfma_f32_16x16x32_bf16 v[56:59], a[144:147], v[184:187], v[144:147]
v_mfma_f32_16x16x32_bf16 v[56:59], a[148:151], v[188:191], v[56:59]
v_exp_f32 v13, v13
v_mfma_f32_16x16x32_bf16 v[56:59], a[152:155], v[192:195], v[56:59]
v_cvt_pk_bf16_f32 v74, v12, v13
v_mfma_f32_16x16x32_bf16 v[56:59], a[156:159], v[196:199], v[56:59]
v_exp_f32 v14, v14
v_mfma_f32_16x16x32_bf16 v[64:67], a[156:159], v[212:215], v[148:151]
s_waitcnt vmcnt(12) lgkmcnt(0)
s_barrier
v_mfma_f32_16x16x32_bf16 v[64:67], a[152:155], v[208:211], v[64:67]
v_exp_f32 v15, v15
v_mfma_f32_16x16x32_bf16 v[64:67], a[148:151], v[204:207], v[64:67]
ds_read_b128 a[156:159], v219 offset:49152
v_cvt_pk_bf16_f32 v75, v14, v15
v_mfma_f32_16x16x32_bf16 v[64:67], a[144:147], v[200:203], v[64:67]
v_exp_f32 v16, v16
v_mfma_f32_16x16x32_bf16 a[0:3], a[176:179], v[88:91], a[0:3]
ds_read_b128 a[152:155], v218 offset:49152
ds_read_b128 a[148:151], v217 offset:49152
v_mfma_f32_16x16x32_bf16 a[4:7], a[176:179], v[92:95], a[4:7]
v_exp_f32 v17, v17
v_mfma_f32_16x16x32_bf16 a[8:11], a[176:179], v[96:99], a[8:11]
ds_read_b128 a[144:147], v216 offset:49152
v_cvt_pk_bf16_f32 v76, v16, v17
v_mfma_f32_16x16x32_bf16 a[12:15], a[176:179], v[100:103], a[12:15]
v_exp_f32 v18, v18
v_mfma_f32_16x16x32_bf16 a[28:31], a[180:183], v[100:103], a[28:31]
ds_read_b64_tr_b16 a[176:177], v220 offset:32768
ds_read_b64_tr_b16 a[178:179], v220 offset:36864
v_mfma_f32_16x16x32_bf16 a[24:27], a[180:183], v[96:99], a[24:27]
v_exp_f32 v19, v19
v_mfma_f32_16x16x32_bf16 a[20:23], a[180:183], v[92:95], a[20:23]
s_add_u32 s32, s32, 16384
v_cvt_pk_bf16_f32 v77, v18, v19
v_mfma_f32_16x16x32_bf16 a[16:19], a[180:183], v[88:91], a[16:19]
v_exp_f32 v20, v20
v_mfma_f32_16x16x32_bf16 a[32:35], a[184:187], v[88:91], a[32:35]
ds_read_b64_tr_b16 a[180:181], v221 offset:32768
ds_read_b64_tr_b16 a[182:183], v221 offset:36864
v_mfma_f32_16x16x32_bf16 a[36:39], a[184:187], v[92:95], a[36:39]
v_exp_f32 v21, v21
v_mfma_f32_16x16x32_bf16 a[40:43], a[184:187], v[96:99], a[40:43]
s_bitset0_b32 s32, 19
v_cvt_pk_bf16_f32 v78, v20, v21
v_mfma_f32_16x16x32_bf16 a[44:47], a[184:187], v[100:103], a[44:47]
v_exp_f32 v22, v22
v_mfma_f32_16x16x32_bf16 a[60:63], a[188:191], v[100:103], a[60:63]
ds_read_b64_tr_b16 a[184:185], v222 offset:32768
ds_read_b64_tr_b16 a[186:187], v222 offset:36864
v_mfma_f32_16x16x32_bf16 a[56:59], a[188:191], v[96:99], a[56:59]
v_exp_f32 v23, v23
v_mfma_f32_16x16x32_bf16 a[52:55], a[188:191], v[92:95], a[52:55]
s_add_u32 m0, s30, 81920
v_cvt_pk_bf16_f32 v79, v22, v23
v_mfma_f32_16x16x32_bf16 a[48:51], a[188:191], v[88:91], a[48:51]
v_exp_f32 v24, v24
v_smfmac_f32_16x16x64_bf16 a[128:131], a[208:211], v[88:95], v245
ds_read_b64_tr_b16 a[188:189], v223 offset:32768
v_mfma_f32_16x16x32_bf16 v[44:47], a[160:163], v[152:155], v[136:139]
v_exp_f32 v25, v25
v_mfma_f32_16x16x32_bf16 v[44:47], a[164:167], v[156:159], v[44:47]
v_exp_f32 v26, v26
v_mfma_f32_16x16x32_bf16 v[44:47], a[168:171], v[160:163], v[44:47]
ds_read_b64_tr_b16 a[190:191], v223 offset:36864
v_cvt_pk_bf16_f32 v80, v24, v25
v_mfma_f32_16x16x32_bf16 v[44:47], a[172:175], v[164:167], v[44:47]
v_exp_f32 v27, v27
v_mfma_f32_16x16x32_bf16 v[52:55], a[172:175], v[180:183], v[140:143]
v_cmp_ne_u32 vcc, s47, v249
s_cbranch_vccnz SP_CAND
SP_CAND_RET:
v_cvt_pk_bf16_f32 v81, v26, v27
v_mfma_f32_16x16x32_bf16 v[52:55], a[168:171], v[176:179], v[52:55]
v_mov_b32 v251, 0
v_exp_f32 v28, v28
v_mfma_f32_16x16x32_bf16 v[52:55], a[164:167], v[172:175], v[52:55]
buffer_load_dwordx4 v228, s[8:11], s32 offen offset:0  lds
v_mfma_f32_16x16x32_bf16 v[52:55], a[160:163], v[168:171], v[52:55]
v_exp_f32 v29, v29
v_mfma_f32_16x16x32_bf16 v[60:63], a[160:163], v[184:187], v[144:147]
s_mov_b32 s90, 0x01010101
s_mov_b32 s91, 0x01010101
v_cvt_pk_bf16_f32 v82, v28, v29
v_mfma_f32_16x16x32_bf16 v[60:63], a[164:167], v[188:191], v[60:63]
v_exp_f32 v30, v30
v_mfma_f32_16x16x32_bf16 v[60:63], a[168:171], v[192:195], v[60:63]
buffer_load_dwordx4 v229, s[8:11], s32 offen offset:1024  lds
v_max_u32_dpp v250, v248, v248 row_ror:8 row_mask:0xf bank_mask:0xf
v_mfma_f32_16x16x32_bf16 v[60:63], a[172:175], v[196:199], v[60:63]
v_exp_f32 v31, v31
v_mfma_f32_16x16x32_bf16 v[68:71], a[172:175], v[212:215], v[148:151]
STUB_5:
s_cbranch_execz STUB_8
ds_read_b128 a[172:175], v219 offset:53248
v_cvt_pk_bf16_f32 v83, v30, v31
v_max_u32_dpp v249, v250, v250 row_ror:4 row_mask:0xf bank_mask:0xf
v_mfma_f32_16x16x32_bf16 v[68:71], a[168:171], v[208:211], v[68:71]
v_exp_f32 v32, v32
v_mfma_f32_16x16x32_bf16 v[68:71], a[164:167], v[204:207], v[68:71]
ds_read_b128 a[168:171], v218 offset:53248
ds_read_b128 a[164:167], v217 offset:53248
v_max_u32_dpp v250, v249, v249 row_ror:2 row_mask:0xf bank_mask:0xf
v_mfma_f32_16x16x32_bf16 v[68:71], a[160:163], v[200:203], v[68:71]
v_exp_f32 v33, v33
v_mfma_f32_16x16x32_bf16 a[64:67], a[192:195], v[88:91], a[64:67]
ds_read_b128 a[160:163], v216 offset:53248
v_cvt_pk_bf16_f32 v84, v32, v33
v_max_u32_dpp v249, v250, v250 row_ror:1 row_mask:0xf bank_mask:0xf
v_mfma_f32_16x16x32_bf16 a[68:71], a[192:195], v[92:95], a[68:71]
v_mov_b32 v250, v249
v_exp_f32 v34, v34
v_mfma_f32_16x16x32_bf16 a[72:75], a[192:195], v[96:99], a[72:75]
buffer_load_dwordx4 v230, s[8:11], s32 offen offset:2048  lds
v_mfma_f32_16x16x32_bf16 a[76:79], a[192:195], v[100:103], a[76:79]
v_permlane16_swap_b32 v249, v250
v_exp_f32 v35, v35
v_mfma_f32_16x16x32_bf16 a[92:95], a[196:199], v[100:103], a[92:95]
ds_read_b64_tr_b16 a[192:193], v224 offset:32768
v_cvt_pk_bf16_f32 v85, v34, v35
v_max_u32 v249, v249, v250
v_mfma_f32_16x16x32_bf16 a[88:91], a[196:199], v[96:99], a[88:91]
v_exp_f32 v36, v36
v_mfma_f32_16x16x32_bf16 a[84:87], a[196:199], v[92:95], a[84:87]
ds_read_b64_tr_b16 a[194:195], v224 offset:36864
v_mov_b32 v250, v249
v_mfma_f32_16x16x32_bf16 a[80:83], a[196:199], v[88:91], a[80:83]
v_exp_f32 v37, v37
v_mfma_f32_16x16x32_bf16 a[96:99], a[200:203], v[88:91], a[96:99]
ds_read_b64_tr_b16 a[196:197], v225 offset:32768
v_cvt_pk_bf16_f32 v86, v36, v37
v_mfma_f32_16x16x32_bf16 a[100:103], a[200:203], v[92:95], a[100:103]
v_exp_f32 v38, v38
v_mfma_f32_16x16x32_bf16 a[104:107], a[200:203], v[96:99], a[104:107]
ds_read_b64_tr_b16 a[198:199], v225 offset:36864
v_permlane32_swap_b32 v249, v250
v_mfma_f32_16x16x32_bf16 a[108:111], a[200:203], v[100:103], a[108:111]
v_exp_f32 v39, v39
v_mfma_f32_16x16x32_bf16 a[124:127], a[204:207], v[100:103], a[124:127]
ds_read_b64_tr_b16 a[200:201], v226 offset:32768
v_cvt_pk_bf16_f32 v87, v38, v39
v_mfma_f32_16x16x32_bf16 a[120:123], a[204:207], v[96:99], a[120:123]
ds_read_b64_tr_b16 a[202:203], v226 offset:36864
v_max_u32 v249, v249, v250
v_mfma_f32_16x16x32_bf16 a[116:119], a[204:207], v[92:95], a[116:119]
buffer_load_dwordx4 v231, s[8:11], s32 offen offset:3072  lds
v_mfma_f32_16x16x32_bf16 a[112:115], a[204:207], v[88:91], a[112:115]
ds_read_b64_tr_b16 a[204:205], v227 offset:32768
ds_read_b64_tr_b16 a[206:207], v227 offset:36864
v_smfmac_f32_16x16x64_bf16 a[132:135], a[208:211], v[96:103], v245
s_add_u32 m0, s86, 32768
s_add_u32 s50, s84, 0
buffer_load_dwordx4 v240, s[68:71], s50 offen lds
s_add_u32 m0, s86, 36864
s_add_u32 s50, s84, 589824
buffer_load_dwordx4 v240, s[68:71], s50 offen lds
s_waitcnt lgkmcnt(8)
v_mfma_f32_16x16x32_bf16 v[8:11], a[144:147], v[152:155], v[136:139]
v_exp_f32 v40, v40
v_mfma_f32_16x16x32_bf16 v[8:11], a[148:151], v[156:159], v[8:11]
v_exp_f32 v41, v41
v_mfma_f32_16x16x32_bf16 v[8:11], a[152:155], v[160:163], v[8:11]
v_cvt_pk_bf16_f32 v88, v40, v41
v_add_u32 v251, v251, v249
v_mfma_f32_16x16x32_bf16 v[8:11], a[156:159], v[164:167], v[8:11]
v_exp_f32 v42, v42
v_mfma_f32_16x16x32_bf16 v[16:19], a[156:159], v[180:183], v[140:143]
s_add_u32 s39, s39, 16384
v_sub_u32 v248, v248, v249
v_mfma_f32_16x16x32_bf16 v[16:19], a[152:155], v[176:179], v[16:19]
v_exp_f32 v43, v43
v_mfma_f32_16x16x32_bf16 v[16:19], a[148:151], v[172:175], v[16:19]
v_cvt_pk_bf16_f32 v89, v42, v43
v_cndmask_b32 v252, v252, v251, s[90:91]
v_mfma_f32_16x16x32_bf16 v[16:19], a[144:147], v[168:171], v[16:19]
v_exp_f32 v44, v44
v_mfma_f32_16x16x32_bf16 v[24:27], a[144:147], v[184:187], v[144:147]
v_readfirstlane_b32 s76, v251
v_mfma_f32_16x16x32_bf16 v[24:27], a[148:151], v[188:191], v[24:27]
v_exp_f32 v45, v45
v_mfma_f32_16x16x32_bf16 v[24:27], a[152:155], v[192:195], v[24:27]
s_bitset0_b32 s39, 19
v_cvt_pk_bf16_f32 v90, v44, v45
v_mfma_f32_16x16x32_bf16 v[24:27], a[156:159], v[196:199], v[24:27]
v_exp_f32 v46, v46
v_mfma_f32_16x16x32_bf16 v[32:35], a[156:159], v[212:215], v[148:151]
ds_read_b128 a[156:159], v219 offset:57344
s_lshl_b64 s[90:91], s[90:91], 1
v_mfma_f32_16x16x32_bf16 v[32:35], a[152:155], v[208:211], v[32:35]
v_exp_f32 v47, v47
v_mfma_f32_16x16x32_bf16 v[32:35], a[148:151], v[204:207], v[32:35]
ds_read_b128 a[152:155], v218 offset:57344
v_cvt_pk_bf16_f32 v91, v46, v47
v_mfma_f32_16x16x32_bf16 v[32:35], a[144:147], v[200:203], v[32:35]
v_exp_f32 v48, v48
v_mfma_f32_16x16x32_bf16 a[0:3], a[176:179], v[72:75], a[0:3]
ds_read_b128 a[148:151], v217 offset:57344
ds_read_b128 a[144:147], v216 offset:57344
v_mfma_f32_16x16x32_bf16 a[4:7], a[176:179], v[76:79], a[4:7]
v_exp_f32 v49, v49
v_mfma_f32_16x16x32_bf16 a[8:11], a[176:179], v[80:83], a[8:11]
s_add_u32 m0, s30, 98304
v_cvt_pk_bf16_f32 v92, v48, v49
v_mfma_f32_16x16x32_bf16 a[12:15], a[176:179], v[84:87], a[12:15]
v_exp_f32 v50, v50
v_mfma_f32_16x16x32_bf16 a[28:31], a[180:183], v[84:87], a[28:31]
ds_read_b64_tr_b16 a[176:177], v220 offset:40960
ds_read_b64_tr_b16 a[178:179], v220 offset:45056
v_mfma_f32_16x16x32_bf16 a[24:27], a[180:183], v[80:83], a[24:27]
v_exp_f32 v51, v51
v_mfma_f32_16x16x32_bf16 a[20:23], a[180:183], v[76:79], a[20:23]
v_cvt_pk_bf16_f32 v93, v50, v51
v_max_u32_dpp v250, v248, v248 row_ror:8 row_mask:0xf bank_mask:0xf
v_mfma_f32_16x16x32_bf16 a[16:19], a[180:183], v[72:75], a[16:19]
v_exp_f32 v52, v52
v_mfma_f32_16x16x32_bf16 a[32:35], a[184:187], v[72:75], a[32:35]
ds_read_b64_tr_b16 a[180:181], v221 offset:40960
ds_read_b64_tr_b16 a[182:183], v221 offset:45056
v_mfma_f32_16x16x32_bf16 a[36:39], a[184:187], v[76:79], a[36:39]
v_exp_f32 v53, v53
v_mfma_f32_16x16x32_bf16 a[40:43], a[184:187], v[80:83], a[40:43]
v_cvt_pk_bf16_f32 v94, v52, v53
v_max_u32_dpp v249, v250, v250 row_ror:4 row_mask:0xf bank_mask:0xf
v_mfma_f32_16x16x32_bf16 a[44:47], a[184:187], v[84:87], a[44:47]
v_exp_f32 v54, v54
v_mfma_f32_16x16x32_bf16 a[60:63], a[188:191], v[84:87], a[60:63]
ds_read_b64_tr_b16 a[184:185], v222 offset:40960
ds_read_b64_tr_b16 a[186:187], v222 offset:45056
v_mfma_f32_16x16x32_bf16 a[56:59], a[188:191], v[80:83], a[56:59]
v_exp_f32 v55, v55
v_mfma_f32_16x16x32_bf16 a[52:55], a[188:191], v[76:79], a[52:55]
v_cvt_pk_bf16_f32 v95, v54, v55
v_max_u32_dpp v250, v249, v249 row_ror:2 row_mask:0xf bank_mask:0xf
v_mfma_f32_16x16x32_bf16 a[48:51], a[188:191], v[72:75], a[48:51]
v_exp_f32 v56, v56
v_smfmac_f32_16x16x64_bf16 a[128:131], a[208:211], v[72:79], v245
ds_read_b64_tr_b16 a[188:189], v223 offset:40960
v_mfma_f32_16x16x32_bf16 v[12:15], a[160:163], v[152:155], v[136:139]
v_exp_f32 v57, v57
v_mfma_f32_16x16x32_bf16 v[12:15], a[164:167], v[156:159], v[12:15]
v_exp_f32 v58, v58
v_mfma_f32_16x16x32_bf16 v[12:15], a[168:171], v[160:163], v[12:15]
ds_read_b64_tr_b16 a[190:191], v223 offset:45056
v_cvt_pk_bf16_f32 v96, v56, v57
v_mfma_f32_16x16x32_bf16 v[12:15], a[172:175], v[164:167], v[12:15]
v_exp_f32 v59, v59
v_mfma_f32_16x16x32_bf16 v[20:23], a[172:175], v[180:183], v[140:143]
v_cvt_pk_bf16_f32 v97, v58, v59
v_max_u32_dpp v249, v250, v250 row_ror:1 row_mask:0xf bank_mask:0xf
v_mfma_f32_16x16x32_bf16 v[20:23], a[168:171], v[176:179], v[20:23]
v_exp_f32 v60, v60
v_mfma_f32_16x16x32_bf16 v[20:23], a[164:167], v[172:175], v[20:23]
buffer_load_dwordx4 v232, s[12:15], s39 offen offset:0  lds
v_mfma_f32_16x16x32_bf16 v[20:23], a[160:163], v[168:171], v[20:23]
v_exp_f32 v61, v61
v_mfma_f32_16x16x32_bf16 v[28:31], a[160:163], v[184:187], v[144:147]
v_cvt_pk_bf16_f32 v98, v60, v61
v_mov_b32 v250, v249
v_mfma_f32_16x16x32_bf16 v[28:31], a[164:167], v[188:191], v[28:31]
v_exp_f32 v62, v62
v_mfma_f32_16x16x32_bf16 v[28:31], a[168:171], v[192:195], v[28:31]
buffer_load_dwordx4 v233, s[12:15], s39 offen offset:1024  lds
v_mfma_f32_16x16x32_bf16 v[28:31], a[172:175], v[196:199], v[28:31]
v_exp_f32 v63, v63
v_mfma_f32_16x16x32_bf16 v[36:39], a[172:175], v[212:215], v[148:151]
ds_read_b128 a[172:175], v219 offset:61440
v_cvt_pk_bf16_f32 v99, v62, v63
v_mfma_f32_16x16x32_bf16 v[36:39], a[168:171], v[208:211], v[36:39]
v_exp_f32 v64, v64
v_mfma_f32_16x16x32_bf16 v[36:39], a[164:167], v[204:207], v[36:39]
ds_read_b128 a[168:171], v218 offset:61440
ds_read_b128 a[164:167], v217 offset:61440
v_mfma_f32_16x16x32_bf16 v[36:39], a[160:163], v[200:203], v[36:39]
v_exp_f32 v65, v65
s_waitcnt lgkmcnt(8)
v_mfma_f32_16x16x32_bf16 a[64:67], a[192:195], v[72:75], a[64:67]
ds_read_b128 a[160:163], v216 offset:61440
v_cvt_pk_bf16_f32 v100, v64, v65
v_mfma_f32_16x16x32_bf16 a[68:71], a[192:195], v[76:79], a[68:71]
v_permlane16_swap_b32 v249, v250
v_exp_f32 v66, v66
v_mfma_f32_16x16x32_bf16 a[72:75], a[192:195], v[80:83], a[72:75]
buffer_load_dwordx4 v232, s[12:15], s39 offen offset:2048  lds
v_mfma_f32_16x16x32_bf16 a[76:79], a[192:195], v[84:87], a[76:79]
v_exp_f32 v67, v67
v_mfma_f32_16x16x32_bf16 a[92:95], a[196:199], v[84:87], a[92:95]
ds_read_b64_tr_b16 a[192:193], v224 offset:40960
v_cvt_pk_bf16_f32 v101, v66, v67
v_mfma_f32_16x16x32_bf16 a[88:91], a[196:199], v[80:83], a[88:91]
v_max_u32 v249, v249, v250
v_exp_f32 v68, v68
v_mfma_f32_16x16x32_bf16 a[84:87], a[196:199], v[76:79], a[84:87]
ds_read_b64_tr_b16 a[194:195], v224 offset:45056
v_mov_b32 v250, v249
v_mfma_f32_16x16x32_bf16 a[80:83], a[196:199], v[72:75], a[80:83]
v_exp_f32 v69, v69
v_mfma_f32_16x16x32_bf16 a[96:99], a[200:203], v[72:75], a[96:99]
ds_read_b64_tr_b16 a[196:197], v225 offset:40960
v_cvt_pk_bf16_f32 v102, v68, v69
v_mfma_f32_16x16x32_bf16 a[100:103], a[200:203], v[76:79], a[100:103]
v_exp_f32 v70, v70
v_mfma_f32_16x16x32_bf16 a[104:107], a[200:203], v[80:83], a[104:107]
ds_read_b64_tr_b16 a[198:199], v225 offset:45056
v_permlane32_swap_b32 v249, v250
v_mfma_f32_16x16x32_bf16 a[108:111], a[200:203], v[84:87], a[108:111]
v_exp_f32 v71, v71
v_mfma_f32_16x16x32_bf16 a[124:127], a[204:207], v[84:87], a[124:127]
ds_read_b64_tr_b16 a[200:201], v226 offset:40960
v_cvt_pk_bf16_f32 v103, v70, v71
v_mfma_f32_16x16x32_bf16 a[120:123], a[204:207], v[80:83], a[120:123]
ds_read_b64_tr_b16 a[202:203], v226 offset:45056
v_max_u32 v249, v249, v250
v_mfma_f32_16x16x32_bf16 a[116:119], a[204:207], v[76:79], a[116:119]
buffer_load_dwordx4 v233, s[12:15], s39 offen offset:3072  lds
v_mfma_f32_16x16x32_bf16 a[112:115], a[204:207], v[72:75], a[112:115]
ds_read_b64_tr_b16 a[204:205], v227 offset:40960
ds_read_b64_tr_b16 a[206:207], v227 offset:45056
v_smfmac_f32_16x16x64_bf16 a[132:135], a[208:211], v[80:87], v245
s_add_u32 m0, s86, 40960
s_add_u32 s50, s84, 1179648
buffer_load_dwordx4 v240, s[68:71], s50 offen lds
s_add_u32 m0, s86, 45056
s_add_u32 s50, s84, 1769472
buffer_load_dwordx4 v240, s[68:71], s50 offen lds
v_mfma_f32_16x16x32_bf16 v[40:43], a[144:147], v[152:155], v[136:139]
v_exp_f32 v8, v8
v_mfma_f32_16x16x32_bf16 v[40:43], a[148:151], v[156:159], v[40:43]
v_exp_f32 v9, v9
v_mfma_f32_16x16x32_bf16 v[40:43], a[152:155], v[160:163], v[40:43]
v_cvt_pk_bf16_f32 v72, v8, v9
v_lshlrev_b32 v246, 2, v1
v_mfma_f32_16x16x32_bf16 v[40:43], a[156:159], v[164:167], v[40:43]
v_exp_f32 v10, v10
v_mfma_f32_16x16x32_bf16 v[48:51], a[156:159], v[180:183], v[140:143]
v_add_u32 v251, v251, v249
v_sub_u32 v248, v248, v249
v_mfma_f32_16x16x32_bf16 v[48:51], a[152:155], v[176:179], v[48:51]
v_exp_f32 v11, v11
v_mfma_f32_16x16x32_bf16 v[48:51], a[148:151], v[172:175], v[48:51]
v_cvt_pk_bf16_f32 v73, v10, v11
v_cndmask_b32 v252, v252, v251, s[90:91]
v_mfma_f32_16x16x32_bf16 v[48:51], a[144:147], v[168:171], v[48:51]
v_exp_f32 v12, v12
v_mfma_f32_16x16x32_bf16 v[56:59], a[144:147], v[184:187], v[144:147]
v_readfirstlane_b32 s77, v251
v_mfma_f32_16x16x32_bf16 v[56:59], a[148:151], v[188:191], v[56:59]
v_exp_f32 v13, v13
v_mfma_f32_16x16x32_bf16 v[56:59], a[152:155], v[192:195], v[56:59]
s_lshl_b64 s[90:91], s[90:91], 1
v_cvt_pk_bf16_f32 v74, v12, v13
v_mfma_f32_16x16x32_bf16 v[56:59], a[156:159], v[196:199], v[56:59]
v_exp_f32 v14, v14
v_mfma_f32_16x16x32_bf16 v[64:67], a[156:159], v[212:215], v[148:151]
s_waitcnt vmcnt(12) lgkmcnt(0)
s_barrier
v_mfma_f32_16x16x32_bf16 v[64:67], a[152:155], v[208:211], v[64:67]
v_exp_f32 v15, v15
v_mfma_f32_16x16x32_bf16 v[64:67], a[148:151], v[204:207], v[64:67]
ds_read_b128 a[156:159], v219 offset:0
v_cvt_pk_bf16_f32 v75, v14, v15
v_mfma_f32_16x16x32_bf16 v[64:67], a[144:147], v[200:203], v[64:67]
v_exp_f32 v16, v16
v_mfma_f32_16x16x32_bf16 a[0:3], a[176:179], v[88:91], a[0:3]
ds_read_b128 a[152:155], v218 offset:0
ds_read_b128 a[148:151], v217 offset:0
v_mfma_f32_16x16x32_bf16 a[4:7], a[176:179], v[92:95], a[4:7]
v_exp_f32 v17, v17
v_mfma_f32_16x16x32_bf16 a[8:11], a[176:179], v[96:99], a[8:11]
ds_read_b128 a[144:147], v216 offset:0
v_cvt_pk_bf16_f32 v76, v16, v17
v_mfma_f32_16x16x32_bf16 a[12:15], a[176:179], v[100:103], a[12:15]
v_exp_f32 v18, v18
v_mfma_f32_16x16x32_bf16 a[28:31], a[180:183], v[100:103], a[28:31]
ds_read_b64_tr_b16 a[176:177], v220 offset:49152
ds_read_b64_tr_b16 a[178:179], v220 offset:53248
v_mfma_f32_16x16x32_bf16 a[24:27], a[180:183], v[96:99], a[24:27]
v_exp_f32 v19, v19
v_mfma_f32_16x16x32_bf16 a[20:23], a[180:183], v[92:95], a[20:23]
s_add_u32 s32, s32, 16384
v_cvt_pk_bf16_f32 v77, v18, v19
v_mfma_f32_16x16x32_bf16 a[16:19], a[180:183], v[88:91], a[16:19]
v_exp_f32 v20, v20
v_mfma_f32_16x16x32_bf16 a[32:35], a[184:187], v[88:91], a[32:35]
ds_read_b64_tr_b16 a[180:181], v221 offset:49152
ds_read_b64_tr_b16 a[182:183], v221 offset:53248
v_mfma_f32_16x16x32_bf16 a[36:39], a[184:187], v[92:95], a[36:39]
v_exp_f32 v21, v21
v_mfma_f32_16x16x32_bf16 a[40:43], a[184:187], v[96:99], a[40:43]
s_bitset0_b32 s32, 19
v_cvt_pk_bf16_f32 v78, v20, v21
v_mfma_f32_16x16x32_bf16 a[44:47], a[184:187], v[100:103], a[44:47]
v_exp_f32 v22, v22
v_mfma_f32_16x16x32_bf16 a[60:63], a[188:191], v[100:103], a[60:63]
ds_read_b64_tr_b16 a[184:185], v222 offset:49152
ds_read_b64_tr_b16 a[186:187], v222 offset:53248
v_mfma_f32_16x16x32_bf16 a[56:59], a[188:191], v[96:99], a[56:59]
v_max_u32_dpp v250, v248, v248 row_ror:8 row_mask:0xf bank_mask:0xf
v_exp_f32 v23, v23
v_mfma_f32_16x16x32_bf16 a[52:55], a[188:191], v[92:95], a[52:55]
s_add_u32 m0, s30, 114688
v_cvt_pk_bf16_f32 v79, v22, v23
v_mfma_f32_16x16x32_bf16 a[48:51], a[188:191], v[88:91], a[48:51]
v_exp_f32 v24, v24
v_smfmac_f32_16x16x64_bf16 a[128:131], a[208:211], v[88:95], v245
ds_read_b64_tr_b16 a[188:189], v223 offset:49152
v_mfma_f32_16x16x32_bf16 v[44:47], a[160:163], v[152:155], v[136:139]
v_exp_f32 v25, v25
v_mfma_f32_16x16x32_bf16 v[44:47], a[164:167], v[156:159], v[44:47]
v_max_u32_dpp v249, v250, v250 row_ror:4 row_mask:0xf bank_mask:0xf
v_exp_f32 v26, v26
v_mfma_f32_16x16x32_bf16 v[44:47], a[168:171], v[160:163], v[44:47]
ds_read_b64_tr_b16 a[190:191], v223 offset:53248
v_cvt_pk_bf16_f32 v80, v24, v25
v_mfma_f32_16x16x32_bf16 v[44:47], a[172:175], v[164:167], v[44:47]
v_exp_f32 v27, v27
v_mfma_f32_16x16x32_bf16 v[52:55], a[172:175], v[180:183], v[140:143]
v_cvt_pk_bf16_f32 v81, v26, v27
v_max_u32_dpp v250, v249, v249 row_ror:2 row_mask:0xf bank_mask:0xf
v_mfma_f32_16x16x32_bf16 v[52:55], a[168:171], v[176:179], v[52:55]
v_exp_f32 v28, v28
v_mfma_f32_16x16x32_bf16 v[52:55], a[164:167], v[172:175], v[52:55]
buffer_load_dwordx4 v228, s[8:11], s32 offen offset:0  lds
v_mfma_f32_16x16x32_bf16 v[52:55], a[160:163], v[168:171], v[52:55]
v_exp_f32 v29, v29
v_mfma_f32_16x16x32_bf16 v[60:63], a[160:163], v[184:187], v[144:147]
v_cvt_pk_bf16_f32 v82, v28, v29
v_max_u32_dpp v249, v250, v250 row_ror:1 row_mask:0xf bank_mask:0xf
v_mfma_f32_16x16x32_bf16 v[60:63], a[164:167], v[188:191], v[60:63]
v_exp_f32 v30, v30
v_mfma_f32_16x16x32_bf16 v[60:63], a[168:171], v[192:195], v[60:63]
buffer_load_dwordx4 v229, s[8:11], s32 offen offset:1024  lds
v_mfma_f32_16x16x32_bf16 v[60:63], a[172:175], v[196:199], v[60:63]
v_exp_f32 v31, v31
v_mfma_f32_16x16x32_bf16 v[68:71], a[172:175], v[212:215], v[148:151]
ds_read_b128 a[172:175], v219 offset:4096
v_cvt_pk_bf16_f32 v83, v30, v31
v_mfma_f32_16x16x32_bf16 v[68:71], a[168:171], v[208:211], v[68:71]
v_exp_f32 v32, v32
v_mfma_f32_16x16x32_bf16 v[68:71], a[164:167], v[204:207], v[68:71]
ds_read_b128 a[168:171], v218 offset:4096
ds_read_b128 a[164:167], v217 offset:4096
v_mov_b32 v250, v249
v_mfma_f32_16x16x32_bf16 v[68:71], a[160:163], v[200:203], v[68:71]
v_exp_f32 v33, v33
v_mfma_f32_16x16x32_bf16 a[64:67], a[192:195], v[88:91], a[64:67]
ds_read_b128 a[160:163], v216 offset:4096
v_cvt_pk_bf16_f32 v84, v32, v33
v_mfma_f32_16x16x32_bf16 a[68:71], a[192:195], v[92:95], a[68:71]
v_exp_f32 v34, v34
v_mfma_f32_16x16x32_bf16 a[72:75], a[192:195], v[96:99], a[72:75]
buffer_load_dwordx4 v230, s[8:11], s32 offen offset:2048  lds
v_mfma_f32_16x16x32_bf16 a[76:79], a[192:195], v[100:103], a[76:79]
v_permlane16_swap_b32 v249, v250
v_exp_f32 v35, v35
v_mfma_f32_16x16x32_bf16 a[92:95], a[196:199], v[100:103], a[92:95]
ds_read_b64_tr_b16 a[192:193], v224 offset:49152
v_cvt_pk_bf16_f32 v85, v34, v35
v_mfma_f32_16x16x32_bf16 a[88:91], a[196:199], v[96:99], a[88:91]
v_exp_f32 v36, v36
v_mfma_f32_16x16x32_bf16 a[84:87], a[196:199], v[92:95], a[84:87]
ds_read_b64_tr_b16 a[194:195], v224 offset:53248
v_max_u32 v249, v249, v250
v_mfma_f32_16x16x32_bf16 a[80:83], a[196:199], v[88:91], a[80:83]
v_exp_f32 v37, v37
v_mfma_f32_16x16x32_bf16 a[96:99], a[200:203], v[88:91], a[96:99]
ds_read_b64_tr_b16 a[196:197], v225 offset:49152
v_cvt_pk_bf16_f32 v86, v36, v37
v_mfma_f32_16x16x32_bf16 a[100:103], a[200:203], v[92:95], a[100:103]
v_exp_f32 v38, v38
v_mfma_f32_16x16x32_bf16 a[104:107], a[200:203], v[96:99], a[104:107]
ds_read_b64_tr_b16 a[198:199], v225 offset:53248
v_mov_b32 v250, v249
v_mfma_f32_16x16x32_bf16 a[108:111], a[200:203], v[100:103], a[108:111]
v_exp_f32 v39, v39
v_mfma_f32_16x16x32_bf16 a[124:127], a[204:207], v[100:103], a[124:127]
ds_read_b64_tr_b16 a[200:201], v226 offset:49152
v_cvt_pk_bf16_f32 v87, v38, v39
v_mfma_f32_16x16x32_bf16 a[120:123], a[204:207], v[96:99], a[120:123]
ds_read_b64_tr_b16 a[202:203], v226 offset:53248
v_permlane32_swap_b32 v249, v250
v_mfma_f32_16x16x32_bf16 a[116:119], a[204:207], v[92:95], a[116:119]
buffer_load_dwordx4 v231, s[8:11], s32 offen offset:3072  lds
v_mfma_f32_16x16x32_bf16 a[112:115], a[204:207], v[88:91], a[112:115]
ds_read_b64_tr_b16 a[204:205], v227 offset:49152
ds_read_b64_tr_b16 a[206:207], v227 offset:53248
v_smfmac_f32_16x16x64_bf16 a[132:135], a[208:211], v[96:103], v245
s_add_u32 m0, s86, 49152
s_add_u32 s50, s84, 2359296
buffer_load_dwordx4 v240, s[68:71], s50 offen lds
s_add_u32 m0, s86, 53248
s_add_u32 s50, s84, 2949120
buffer_load_dwordx4 v240, s[68:71], s50 offen lds
s_waitcnt lgkmcnt(8)
v_mfma_f32_16x16x32_bf16 v[8:11], a[144:147], v[152:155], v[136:139]
v_exp_f32 v40, v40
v_mfma_f32_16x16x32_bf16 v[8:11], a[148:151], v[156:159], v[8:11]
v_exp_f32 v41, v41
v_mfma_f32_16x16x32_bf16 v[8:11], a[152:155], v[160:163], v[8:11]
v_cvt_pk_bf16_f32 v88, v40, v41
v_max_u32 v249, v249, v250
v_mfma_f32_16x16x32_bf16 v[8:11], a[156:159], v[164:167], v[8:11]
v_exp_f32 v42, v42
v_mfma_f32_16x16x32_bf16 v[16:19], a[156:159], v[180:183], v[140:143]
s_add_u32 s39, s39, 16384
v_add_u32 v251, v251, v249
v_mfma_f32_16x16x32_bf16 v[16:19], a[152:155], v[176:179], v[16:19]
v_exp_f32 v43, v43
v_mfma_f32_16x16x32_bf16 v[16:19], a[148:151], v[172:175], v[16:19]
v_cvt_pk_bf16_f32 v89, v42, v43
v_sub_u32 v248, v248, v249
v_mfma_f32_16x16x32_bf16 v[16:19], a[144:147], v[168:171], v[16:19]
v_exp_f32 v44, v44
v_mfma_f32_16x16x32_bf16 v[24:27], a[144:147], v[184:187], v[144:147]
buffer_load_dword v253, v246, s[24:27], 0 offen sc0 sc1
v_mfma_f32_16x16x32_bf16 v[24:27], a[148:151], v[188:191], v[24:27]
v_exp_f32 v45, v45
v_mfma_f32_16x16x32_bf16 v[24:27], a[152:155], v[192:195], v[24:27]
s_bitset0_b32 s39, 19
v_cvt_pk_bf16_f32 v90, v44, v45
v_mfma_f32_16x16x32_bf16 v[24:27], a[156:159], v[196:199], v[24:27]
v_exp_f32 v46, v46
v_mfma_f32_16x16x32_bf16 v[32:35], a[156:159], v[212:215], v[148:151]
ds_read_b128 a[156:159], v219 offset:8192
v_cndmask_b32 v252, v252, v251, s[90:91]
v_mfma_f32_16x16x32_bf16 v[32:35], a[152:155], v[208:211], v[32:35]
v_exp_f32 v47, v47
v_mfma_f32_16x16x32_bf16 v[32:35], a[148:151], v[204:207], v[32:35]
ds_read_b128 a[152:155], v218 offset:8192
v_cvt_pk_bf16_f32 v91, v46, v47
v_mfma_f32_16x16x32_bf16 v[32:35], a[144:147], v[200:203], v[32:35]
v_exp_f32 v48, v48
v_mfma_f32_16x16x32_bf16 a[0:3], a[176:179], v[72:75], a[0:3]
ds_read_b128 a[148:151], v217 offset:8192
ds_read_b128 a[144:147], v216 offset:8192
v_mfma_f32_16x16x32_bf16 a[4:7], a[176:179], v[76:79], a[4:7]
v_exp_f32 v49, v49
v_mfma_f32_16x16x32_bf16 a[8:11], a[176:179], v[80:83], a[8:11]
s_add_u32 m0, s30, 131072
v_cvt_pk_bf16_f32 v92, v48, v49
v_mfma_f32_16x16x32_bf16 a[12:15], a[176:179], v[84:87], a[12:15]
v_exp_f32 v50, v50
v_mfma_f32_16x16x32_bf16 a[28:31], a[180:183], v[84:87], a[28:31]
ds_read_b64_tr_b16 a[176:177], v220 offset:57344
ds_read_b64_tr_b16 a[178:179], v220 offset:61440
v_mfma_f32_16x16x32_bf16 a[24:27], a[180:183], v[80:83], a[24:27]
v_exp_f32 v51, v51
v_mfma_f32_16x16x32_bf16 a[20:23], a[180:183], v[76:79], a[20:23]
v_cvt_pk_bf16_f32 v93, v50, v51
v_readfirstlane_b32 s78, v251
v_mfma_f32_16x16x32_bf16 a[16:19], a[180:183], v[72:75], a[16:19]
v_exp_f32 v52, v52
v_mfma_f32_16x16x32_bf16 a[32:35], a[184:187], v[72:75], a[32:35]
ds_read_b64_tr_b16 a[180:181], v221 offset:57344
ds_read_b64_tr_b16 a[182:183], v221 offset:61440
v_mfma_f32_16x16x32_bf16 a[36:39], a[184:187], v[76:79], a[36:39]
v_exp_f32 v53, v53
v_mfma_f32_16x16x32_bf16 a[40:43], a[184:187], v[80:83], a[40:43]
s_lshl_b64 s[90:91], s[90:91], 1
v_cvt_pk_bf16_f32 v94, v52, v53
v_mfma_f32_16x16x32_bf16 a[44:47], a[184:187], v[84:87], a[44:47]
v_exp_f32 v54, v54
v_mfma_f32_16x16x32_bf16 a[60:63], a[188:191], v[84:87], a[60:63]
ds_read_b64_tr_b16 a[184:185], v222 offset:57344
ds_read_b64_tr_b16 a[186:187], v222 offset:61440
v_mfma_f32_16x16x32_bf16 a[56:59], a[188:191], v[80:83], a[56:59]
v_exp_f32 v55, v55
v_mfma_f32_16x16x32_bf16 a[52:55], a[188:191], v[76:79], a[52:55]
v_cvt_pk_bf16_f32 v95, v54, v55
v_max_u32_dpp v250, v248, v248 row_ror:8 row_mask:0xf bank_mask:0xf
v_mfma_f32_16x16x32_bf16 a[48:51], a[188:191], v[72:75], a[48:51]
v_exp_f32 v56, v56
v_smfmac_f32_16x16x64_bf16 a[128:131], a[208:211], v[72:79], v245
ds_read_b64_tr_b16 a[188:189], v223 offset:57344
v_mfma_f32_16x16x32_bf16 v[12:15], a[160:163], v[152:155], v[136:139]
v_exp_f32 v57, v57
v_mfma_f32_16x16x32_bf16 v[12:15], a[164:167], v[156:159], v[12:15]
v_exp_f32 v58, v58
v_mfma_f32_16x16x32_bf16 v[12:15], a[168:171], v[160:163], v[12:15]
ds_read_b64_tr_b16 a[190:191], v223 offset:61440
v_cvt_pk_bf16_f32 v96, v56, v57
v_mfma_f32_16x16x32_bf16 v[12:15], a[172:175], v[164:167], v[12:15]
v_max_u32_dpp v249, v250, v250 row_ror:4 row_mask:0xf bank_mask:0xf
v_exp_f32 v59, v59
v_mfma_f32_16x16x32_bf16 v[20:23], a[172:175], v[180:183], v[140:143]
v_cvt_pk_bf16_f32 v97, v58, v59
v_mfma_f32_16x16x32_bf16 v[20:23], a[168:171], v[176:179], v[20:23]
v_exp_f32 v60, v60
v_mfma_f32_16x16x32_bf16 v[20:23], a[164:167], v[172:175], v[20:23]
buffer_load_dwordx4 v232, s[12:15], s39 offen offset:0  lds
v_mfma_f32_16x16x32_bf16 v[20:23], a[160:163], v[168:171], v[20:23]
v_exp_f32 v61, v61
v_mfma_f32_16x16x32_bf16 v[28:31], a[160:163], v[184:187], v[144:147]
v_cvt_pk_bf16_f32 v98, v60, v61
v_max_u32_dpp v250, v249, v249 row_ror:2 row_mask:0xf bank_mask:0xf
v_mfma_f32_16x16x32_bf16 v[28:31], a[164:167], v[188:191], v[28:31]
v_exp_f32 v62, v62
v_mfma_f32_16x16x32_bf16 v[28:31], a[168:171], v[192:195], v[28:31]
buffer_load_dwordx4 v233, s[12:15], s39 offen offset:1024  lds
v_mfma_f32_16x16x32_bf16 v[28:31], a[172:175], v[196:199], v[28:31]
v_exp_f32 v63, v63
v_mfma_f32_16x16x32_bf16 v[36:39], a[172:175], v[212:215], v[148:151]
ds_read_b128 a[172:175], v219 offset:12288
v_cvt_pk_bf16_f32 v99, v62, v63
v_max_u32_dpp v249, v250, v250 row_ror:1 row_mask:0xf bank_mask:0xf
v_mfma_f32_16x16x32_bf16 v[36:39], a[168:171], v[208:211], v[36:39]
v_exp_f32 v64, v64
v_mfma_f32_16x16x32_bf16 v[36:39], a[164:167], v[204:207], v[36:39]
ds_read_b128 a[168:171], v218 offset:12288
ds_read_b128 a[164:167], v217 offset:12288
v_mfma_f32_16x16x32_bf16 v[36:39], a[160:163], v[200:203], v[36:39]
v_exp_f32 v65, v65
s_waitcnt lgkmcnt(8)
v_mfma_f32_16x16x32_bf16 a[64:67], a[192:195], v[72:75], a[64:67]
ds_read_b128 a[160:163], v216 offset:12288
v_cvt_pk_bf16_f32 v100, v64, v65
v_mfma_f32_16x16x32_bf16 a[68:71], a[192:195], v[76:79], a[68:71]
v_mov_b32 v250, v249
v_exp_f32 v66, v66
v_mfma_f32_16x16x32_bf16 a[72:75], a[192:195], v[80:83], a[72:75]
buffer_load_dwordx4 v232, s[12:15], s39 offen offset:2048  lds
v_mfma_f32_16x16x32_bf16 a[76:79], a[192:195], v[84:87], a[76:79]
v_exp_f32 v67, v67
v_mfma_f32_16x16x32_bf16 a[92:95], a[196:199], v[84:87], a[92:95]
ds_read_b64_tr_b16 a[192:193], v224 offset:57344
v_cvt_pk_bf16_f32 v101, v66, v67
v_mfma_f32_16x16x32_bf16 a[88:91], a[196:199], v[80:83], a[88:91]
v_permlane16_swap_b32 v249, v250
v_exp_f32 v68, v68
v_mfma_f32_16x16x32_bf16 a[84:87], a[196:199], v[76:79], a[84:87]
ds_read_b64_tr_b16 a[194:195], v224 offset:61440
v_max_u32 v249, v249, v250
v_mfma_f32_16x16x32_bf16 a[80:83], a[196:199], v[72:75], a[80:83]
v_exp_f32 v69, v69
v_mfma_f32_16x16x32_bf16 a[96:99], a[200:203], v[72:75], a[96:99]
ds_read_b64_tr_b16 a[196:197], v225 offset:57344
v_cvt_pk_bf16_f32 v102, v68, v69
v_mfma_f32_16x16x32_bf16 a[100:103], a[200:203], v[76:79], a[100:103]
v_exp_f32 v70, v70
v_mfma_f32_16x16x32_bf16 a[104:107], a[200:203], v[80:83], a[104:107]
ds_read_b64_tr_b16 a[198:199], v225 offset:61440
v_mov_b32 v250, v249
v_mfma_f32_16x16x32_bf16 a[108:111], a[200:203], v[84:87], a[108:111]
v_exp_f32 v71, v71
v_mfma_f32_16x16x32_bf16 a[124:127], a[204:207], v[84:87], a[124:127]
ds_read_b64_tr_b16 a[200:201], v226 offset:57344
v_cvt_pk_bf16_f32 v103, v70, v71
v_mfma_f32_16x16x32_bf16 a[120:123], a[204:207], v[80:83], a[120:123]
ds_read_b64_tr_b16 a[202:203], v226 offset:61440
v_permlane32_swap_b32 v249, v250
v_mfma_f32_16x16x32_bf16 a[116:119], a[204:207], v[76:79], a[116:119]
buffer_load_dwordx4 v233, s[12:15], s39 offen offset:3072  lds
v_mfma_f32_16x16x32_bf16 a[112:115], a[204:207], v[72:75], a[112:115]
ds_read_b64_tr_b16 a[204:205], v227 offset:57344
ds_read_b64_tr_b16 a[206:207], v227 offset:61440
v_smfmac_f32_16x16x64_bf16 a[132:135], a[208:211], v[80:87], v245
s_add_u32 m0, s86, 57344
s_add_u32 s50, s84, 3538944
buffer_load_dwordx4 v240, s[68:71], s50 offen lds
s_add_u32 m0, s86, 61440
s_add_u32 s50, s84, 4128768
buffer_load_dwordx4 v240, s[68:71], s50 offen lds
v_mfma_f32_16x16x32_bf16 v[40:43], a[144:147], v[152:155], v[136:139]
v_exp_f32 v8, v8
v_mfma_f32_16x16x32_bf16 v[40:43], a[148:151], v[156:159], v[40:43]
v_exp_f32 v9, v9
v_mfma_f32_16x16x32_bf16 v[40:43], a[152:155], v[160:163], v[40:43]
v_cvt_pk_bf16_f32 v72, v8, v9
v_max_u32 v249, v249, v250
v_mfma_f32_16x16x32_bf16 v[40:43], a[156:159], v[164:167], v[40:43]
v_exp_f32 v10, v10
v_mfma_f32_16x16x32_bf16 v[48:51], a[156:159], v[180:183], v[140:143]
v_add_u32 v251, v251, v249
v_sub_u32 v248, v248, v249
v_mfma_f32_16x16x32_bf16 v[48:51], a[152:155], v[176:179], v[48:51]
v_exp_f32 v11, v11
v_mfma_f32_16x16x32_bf16 v[48:51], a[148:151], v[172:175], v[48:51]
v_cvt_pk_bf16_f32 v73, v10, v11
v_cndmask_b32 v252, v252, v251, s[90:91]
v_mfma_f32_16x16x32_bf16 v[48:51], a[144:147], v[168:171], v[48:51]
v_exp_f32 v12, v12
v_mfma_f32_16x16x32_bf16 v[56:59], a[144:147], v[184:187], v[144:147]
v_readfirstlane_b32 s79, v251
v_mfma_f32_16x16x32_bf16 v[56:59], a[148:151], v[188:191], v[56:59]
v_exp_f32 v13, v13
v_mfma_f32_16x16x32_bf16 v[56:59], a[152:155], v[192:195], v[56:59]
s_lshl_b64 s[90:91], s[90:91], 1
STUB_6:
s_cbranch_execz STUB_9
v_cvt_pk_bf16_f32 v74, v12, v13
v_mfma_f32_16x16x32_bf16 v[56:59], a[156:159], v[196:199], v[56:59]
v_exp_f32 v14, v14
v_mfma_f32_16x16x32_bf16 v[64:67], a[156:159], v[212:215], v[148:151]
s_waitcnt vmcnt(13) lgkmcnt(0)
s_barrier
v_mfma_f32_16x16x32_bf16 v[64:67], a[152:155], v[208:211], v[64:67]
v_exp_f32 v15, v15
v_mfma_f32_16x16x32_bf16 v[64:67], a[148:151], v[204:207], v[64:67]
ds_read_b128 a[156:159], v219 offset:16384
v_cvt_pk_bf16_f32 v75, v14, v15
v_mfma_f32_16x16x32_bf16 v[64:67], a[144:147], v[200:203], v[64:67]
v_exp_f32 v16, v16
v_mfma_f32_16x16x32_bf16 a[0:3], a[176:179], v[88:91], a[0:3]
ds_read_b128 a[152:155], v218 offset:16384
ds_read_b128 a[148:151], v217 offset:16384
v_mfma_f32_16x16x32_bf16 a[4:7], a[176:179], v[92:95], a[4:7]
v_exp_f32 v17, v17
v_mfma_f32_16x16x32_bf16 a[8:11], a[176:179], v[96:99], a[8:11]
ds_read_b128 a[144:147], v216 offset:16384
v_cvt_pk_bf16_f32 v76, v16, v17
v_mfma_f32_16x16x32_bf16 a[12:15], a[176:179], v[100:103], a[12:15]
v_exp_f32 v18, v18
v_mfma_f32_16x16x32_bf16 a[28:31], a[180:183], v[100:103], a[28:31]
ds_read_b64_tr_b16 a[176:177], v220 offset:0
ds_read_b64_tr_b16 a[178:179], v220 offset:4096
v_mfma_f32_16x16x32_bf16 a[24:27], a[180:183], v[96:99], a[24:27]
v_exp_f32 v19, v19
v_mfma_f32_16x16x32_bf16 a[20:23], a[180:183], v[92:95], a[20:23]
s_add_u32 s32, s32, 16384
v_cvt_pk_bf16_f32 v77, v18, v19
v_mfma_f32_16x16x32_bf16 a[16:19], a[180:183], v[88:91], a[16:19]
v_exp_f32 v20, v20
v_mfma_f32_16x16x32_bf16 a[32:35], a[184:187], v[88:91], a[32:35]
ds_read_b64_tr_b16 a[180:181], v221 offset:0
ds_read_b64_tr_b16 a[182:183], v221 offset:4096
v_mfma_f32_16x16x32_bf16 a[36:39], a[184:187], v[92:95], a[36:39]
v_exp_f32 v21, v21
v_mfma_f32_16x16x32_bf16 a[40:43], a[184:187], v[96:99], a[40:43]
s_bitset0_b32 s32, 19
v_cvt_pk_bf16_f32 v78, v20, v21
v_mfma_f32_16x16x32_bf16 a[44:47], a[184:187], v[100:103], a[44:47]
v_exp_f32 v22, v22
v_mfma_f32_16x16x32_bf16 a[60:63], a[188:191], v[100:103], a[60:63]
ds_read_b64_tr_b16 a[184:185], v222 offset:0
ds_read_b64_tr_b16 a[186:187], v222 offset:4096
v_mfma_f32_16x16x32_bf16 a[56:59], a[188:191], v[96:99], a[56:59]
v_exp_f32 v23, v23
v_mfma_f32_16x16x32_bf16 a[52:55], a[188:191], v[92:95], a[52:55]
s_add_u32 m0, s30, 65536
v_cvt_pk_bf16_f32 v79, v22, v23
v_mfma_f32_16x16x32_bf16 a[48:51], a[188:191], v[88:91], a[48:51]
v_exp_f32 v24, v24
v_smfmac_f32_16x16x64_bf16 a[128:131], a[208:211], v[88:95], v245
ds_read_b64_tr_b16 a[188:189], v223 offset:0
v_mfma_f32_16x16x32_bf16 v[44:47], a[160:163], v[152:155], v[136:139]
v_exp_f32 v25, v25
v_mfma_f32_16x16x32_bf16 v[44:47], a[164:167], v[156:159], v[44:47]
v_max_u32_dpp v250, v248, v248 row_ror:8 row_mask:0xf bank_mask:0xf
v_exp_f32 v26, v26
v_mfma_f32_16x16x32_bf16 v[44:47], a[168:171], v[160:163], v[44:47]
ds_read_b64_tr_b16 a[190:191], v223 offset:4096
v_cvt_pk_bf16_f32 v80, v24, v25
v_mfma_f32_16x16x32_bf16 v[44:47], a[172:175], v[164:167], v[44:47]
v_exp_f32 v27, v27
v_mfma_f32_16x16x32_bf16 v[52:55], a[172:175], v[180:183], v[140:143]
v_cvt_pk_bf16_f32 v81, v26, v27
v_max_u32_dpp v249, v250, v250 row_ror:4 row_mask:0xf bank_mask:0xf
v_mfma_f32_16x16x32_bf16 v[52:55], a[168:171], v[176:179], v[52:55]
v_exp_f32 v28, v28
v_mfma_f32_16x16x32_bf16 v[52:55], a[164:167], v[172:175], v[52:55]
buffer_load_dwordx4 v228, s[8:11], s32 offen offset:0  lds
v_mfma_f32_16x16x32_bf16 v[52:55], a[160:163], v[168:171], v[52:55]
v_exp_f32 v29, v29
v_mfma_f32_16x16x32_bf16 v[60:63], a[160:163], v[184:187], v[144:147]
v_cvt_pk_bf16_f32 v82, v28, v29
v_max_u32_dpp v250, v249, v249 row_ror:2 row_mask:0xf bank_mask:0xf
v_mfma_f32_16x16x32_bf16 v[60:63], a[164:167], v[188:191], v[60:63]
v_exp_f32 v30, v30
v_mfma_f32_16x16x32_bf16 v[60:63], a[168:171], v[192:195], v[60:63]
buffer_load_dwordx4 v229, s[8:11], s32 offen offset:1024  lds
v_mfma_f32_16x16x32_bf16 v[60:63], a[172:175], v[196:199], v[60:63]
v_exp_f32 v31, v31
v_mfma_f32_16x16x32_bf16 v[68:71], a[172:175], v[212:215], v[148:151]
ds_read_b128 a[172:175], v219 offset:20480
v_cvt_pk_bf16_f32 v83, v30, v31
v_mfma_f32_16x16x32_bf16 v[68:71], a[168:171], v[208:211], v[68:71]
v_exp_f32 v32, v32
v_mfma_f32_16x16x32_bf16 v[68:71], a[164:167], v[204:207], v[68:71]
ds_read_b128 a[168:171], v218 offset:20480
ds_read_b128 a[164:167], v217 offset:20480
v_max_u32_dpp v249, v250, v250 row_ror:1 row_mask:0xf bank_mask:0xf
v_mfma_f32_16x16x32_bf16 v[68:71], a[160:163], v[200:203], v[68:71]
v_exp_f32 v33, v33
v_mfma_f32_16x16x32_bf16 a[64:67], a[192:195], v[88:91], a[64:67]
ds_read_b128 a[160:163], v216 offset:20480
v_cvt_pk_bf16_f32 v84, v32, v33
v_mfma_f32_16x16x32_bf16 a[68:71], a[192:195], v[92:95], a[68:71]
v_exp_f32 v34, v34
v_mfma_f32_16x16x32_bf16 a[72:75], a[192:195], v[96:99], a[72:75]
buffer_load_dwordx4 v230, s[8:11], s32 offen offset:2048  lds
v_mfma_f32_16x16x32_bf16 a[76:79], a[192:195], v[100:103], a[76:79]
v_mov_b32 v250, v249
v_exp_f32 v35, v35
v_mfma_f32_16x16x32_bf16 a[92:95], a[196:199], v[100:103], a[92:95]
ds_read_b64_tr_b16 a[192:193], v224 offset:0
v_cvt_pk_bf16_f32 v85, v34, v35
v_mfma_f32_16x16x32_bf16 a[88:91], a[196:199], v[96:99], a[88:91]
v_exp_f32 v36, v36
v_mfma_f32_16x16x32_bf16 a[84:87], a[196:199], v[92:95], a[84:87]
ds_read_b64_tr_b16 a[194:195], v224 offset:4096
v_permlane16_swap_b32 v249, v250
v_mfma_f32_16x16x32_bf16 a[80:83], a[196:199], v[88:91], a[80:83]
v_exp_f32 v37, v37
v_mfma_f32_16x16x32_bf16 a[96:99], a[200:203], v[88:91], a[96:99]
ds_read_b64_tr_b16 a[196:197], v225 offset:0
v_cvt_pk_bf16_f32 v86, v36, v37
v_mfma_f32_16x16x32_bf16 a[100:103], a[200:203], v[92:95], a[100:103]
v_exp_f32 v38, v38
v_mfma_f32_16x16x32_bf16 a[104:107], a[200:203], v[96:99], a[104:107]
ds_read_b64_tr_b16 a[198:199], v225 offset:4096
v_max_u32 v249, v249, v250
v_mfma_f32_16x16x32_bf16 a[108:111], a[200:203], v[100:103], a[108:111]
v_exp_f32 v39, v39
v_mfma_f32_16x16x32_bf16 a[124:127], a[204:207], v[100:103], a[124:127]
ds_read_b64_tr_b16 a[200:201], v226 offset:0
v_cvt_pk_bf16_f32 v87, v38, v39
v_mfma_f32_16x16x32_bf16 a[120:123], a[204:207], v[96:99], a[120:123]
ds_read_b64_tr_b16 a[202:203], v226 offset:4096
v_mov_b32 v250, v249
v_mfma_f32_16x16x32_bf16 a[116:119], a[204:207], v[92:95], a[116:119]
buffer_load_dwordx4 v231, s[8:11], s32 offen offset:3072  lds
v_mfma_f32_16x16x32_bf16 a[112:115], a[204:207], v[88:91], a[112:115]
ds_read_b64_tr_b16 a[204:205], v227 offset:0
ds_read_b64_tr_b16 a[206:207], v227 offset:4096
v_smfmac_f32_16x16x64_bf16 a[132:135], a[208:211], v[96:103], v245
v_permlane32_swap_b32 v249, v250
s_waitcnt lgkmcnt(8)
v_mfma_f32_16x16x32_bf16 v[8:11], a[144:147], v[152:155], v[136:139]
v_exp_f32 v40, v40
v_mfma_f32_16x16x32_bf16 v[8:11], a[148:151], v[156:159], v[8:11]
v_exp_f32 v41, v41
v_mfma_f32_16x16x32_bf16 v[8:11], a[152:155], v[160:163], v[8:11]
v_cvt_pk_bf16_f32 v88, v40, v41
v_max_u32 v249, v249, v250
v_mfma_f32_16x16x32_bf16 v[8:11], a[156:159], v[164:167], v[8:11]
v_exp_f32 v42, v42
v_mfma_f32_16x16x32_bf16 v[16:19], a[156:159], v[180:183], v[140:143]
s_add_u32 s39, s39, 16384
v_add_u32 v251, v251, v249
v_mfma_f32_16x16x32_bf16 v[16:19], a[152:155], v[176:179], v[16:19]
v_exp_f32 v43, v43
v_mfma_f32_16x16x32_bf16 v[16:19], a[148:151], v[172:175], v[16:19]
v_cvt_pk_bf16_f32 v89, v42, v43
v_sub_u32 v248, v248, v249
v_mfma_f32_16x16x32_bf16 v[16:19], a[144:147], v[168:171], v[16:19]
v_exp_f32 v44, v44
v_mfma_f32_16x16x32_bf16 v[24:27], a[144:147], v[184:187], v[144:147]
v_cndmask_b32 v252, v252, v251, s[90:91]
v_mfma_f32_16x16x32_bf16 v[24:27], a[148:151], v[188:191], v[24:27]
v_exp_f32 v45, v45
v_mfma_f32_16x16x32_bf16 v[24:27], a[152:155], v[192:195], v[24:27]
v_cvt_pk_bf16_f32 v90, v44, v45
v_readfirstlane_b32 s80, v251
v_mfma_f32_16x16x32_bf16 v[24:27], a[156:159], v[196:199], v[24:27]
v_exp_f32 v46, v46
v_mfma_f32_16x16x32_bf16 v[32:35], a[156:159], v[212:215], v[148:151]
ds_read_b128 a[156:159], v219 offset:24576
s_bitset0_b32 s39, 19
v_mfma_f32_16x16x32_bf16 v[32:35], a[152:155], v[208:211], v[32:35]
v_exp_f32 v47, v47
v_mfma_f32_16x16x32_bf16 v[32:35], a[148:151], v[204:207], v[32:35]
ds_read_b128 a[152:155], v218 offset:24576
v_cvt_pk_bf16_f32 v91, v46, v47
v_mfma_f32_16x16x32_bf16 v[32:35], a[144:147], v[200:203], v[32:35]
v_exp_f32 v48, v48
v_mfma_f32_16x16x32_bf16 a[0:3], a[176:179], v[72:75], a[0:3]
ds_read_b128 a[148:151], v217 offset:24576
ds_read_b128 a[144:147], v216 offset:24576
v_mfma_f32_16x16x32_bf16 a[4:7], a[176:179], v[76:79], a[4:7]
v_exp_f32 v49, v49
v_mfma_f32_16x16x32_bf16 a[8:11], a[176:179], v[80:83], a[8:11]
s_lshl_b64 s[90:91], s[90:91], 1
v_cvt_pk_bf16_f32 v92, v48, v49
v_mfma_f32_16x16x32_bf16 a[12:15], a[176:179], v[84:87], a[12:15]
v_exp_f32 v50, v50
v_mfma_f32_16x16x32_bf16 a[28:31], a[180:183], v[84:87], a[28:31]
ds_read_b64_tr_b16 a[176:177], v220 offset:8192
ds_read_b64_tr_b16 a[178:179], v220 offset:12288
v_mfma_f32_16x16x32_bf16 a[24:27], a[180:183], v[80:83], a[24:27]
v_exp_f32 v51, v51
v_mfma_f32_16x16x32_bf16 a[20:23], a[180:183], v[76:79], a[20:23]
s_add_u32 m0, s30, 147456
v_cvt_pk_bf16_f32 v93, v50, v51
v_mfma_f32_16x16x32_bf16 a[16:19], a[180:183], v[72:75], a[16:19]
v_exp_f32 v52, v52
v_mfma_f32_16x16x32_bf16 a[32:35], a[184:187], v[72:75], a[32:35]
ds_read_b64_tr_b16 a[180:181], v221 offset:8192
ds_read_b64_tr_b16 a[182:183], v221 offset:12288
v_mfma_f32_16x16x32_bf16 a[36:39], a[184:187], v[76:79], a[36:39]
v_exp_f32 v53, v53
v_mfma_f32_16x16x32_bf16 a[40:43], a[184:187], v[80:83], a[40:43]
v_cvt_pk_bf16_f32 v94, v52, v53
v_max_u32_dpp v250, v248, v248 row_ror:8 row_mask:0xf bank_mask:0xf
v_mfma_f32_16x16x32_bf16 a[44:47], a[184:187], v[84:87], a[44:47]
v_exp_f32 v54, v54
v_mfma_f32_16x16x32_bf16 a[60:63], a[188:191], v[84:87], a[60:63]
ds_read_b64_tr_b16 a[184:185], v222 offset:8192
ds_read_b64_tr_b16 a[186:187], v222 offset:12288
v_mfma_f32_16x16x32_bf16 a[56:59], a[188:191], v[80:83], a[56:59]
v_exp_f32 v55, v55
v_mfma_f32_16x16x32_bf16 a[52:55], a[188:191], v[76:79], a[52:55]
v_cvt_pk_bf16_f32 v95, v54, v55
v_max_u32_dpp v249, v250, v250 row_ror:4 row_mask:0xf bank_mask:0xf
v_mfma_f32_16x16x32_bf16 a[48:51], a[188:191], v[72:75], a[48:51]
v_exp_f32 v56, v56
v_smfmac_f32_16x16x64_bf16 a[128:131], a[208:211], v[72:79], v245
ds_read_b64_tr_b16 a[188:189], v223 offset:8192
v_mfma_f32_16x16x32_bf16 v[12:15], a[160:163], v[152:155], v[136:139]
v_exp_f32 v57, v57
v_mfma_f32_16x16x32_bf16 v[12:15], a[164:167], v[156:159], v[12:15]
v_exp_f32 v58, v58
v_mfma_f32_16x16x32_bf16 v[12:15], a[168:171], v[160:163], v[12:15]
ds_read_b64_tr_b16 a[190:191], v223 offset:12288
v_cvt_pk_bf16_f32 v96, v56, v57
v_mfma_f32_16x16x32_bf16 v[12:15], a[172:175], v[164:167], v[12:15]
v_exp_f32 v59, v59
v_mfma_f32_16x16x32_bf16 v[20:23], a[172:175], v[180:183], v[140:143]
v_cvt_pk_bf16_f32 v97, v58, v59
v_max_u32_dpp v250, v249, v249 row_ror:2 row_mask:0xf bank_mask:0xf
v_mfma_f32_16x16x32_bf16 v[20:23], a[168:171], v[176:179], v[20:23]
v_exp_f32 v60, v60
v_mfma_f32_16x16x32_bf16 v[20:23], a[164:167], v[172:175], v[20:23]
buffer_load_dwordx4 v232, s[12:15], s39 offen offset:0  lds
v_mfma_f32_16x16x32_bf16 v[20:23], a[160:163], v[168:171], v[20:23]
v_exp_f32 v61, v61
v_mfma_f32_16x16x32_bf16 v[28:31], a[160:163], v[184:187], v[144:147]
v_cvt_pk_bf16_f32 v98, v60, v61
v_max_u32_dpp v249, v250, v250 row_ror:1 row_mask:0xf bank_mask:0xf
v_mfma_f32_16x16x32_bf16 v[28:31], a[164:167], v[188:191], v[28:31]
v_exp_f32 v62, v62
v_mfma_f32_16x16x32_bf16 v[28:31], a[168:171], v[192:195], v[28:31]
buffer_load_dwordx4 v233, s[12:15], s39 offen offset:1024  lds
v_mfma_f32_16x16x32_bf16 v[28:31], a[172:175], v[196:199], v[28:31]
v_exp_f32 v63, v63
v_mfma_f32_16x16x32_bf16 v[36:39], a[172:175], v[212:215], v[148:151]
ds_read_b128 a[172:175], v219 offset:28672
v_cvt_pk_bf16_f32 v99, v62, v63
v_mfma_f32_16x16x32_bf16 v[36:39], a[168:171], v[208:211], v[36:39]
v_exp_f32 v64, v64
v_mfma_f32_16x16x32_bf16 v[36:39], a[164:167], v[204:207], v[36:39]
ds_read_b128 a[168:171], v218 offset:28672
ds_read_b128 a[164:167], v217 offset:28672
v_mfma_f32_16x16x32_bf16 v[36:39], a[160:163], v[200:203], v[36:39]
v_exp_f32 v65, v65
s_waitcnt lgkmcnt(8)
v_mfma_f32_16x16x32_bf16 a[64:67], a[192:195], v[72:75], a[64:67]
ds_read_b128 a[160:163], v216 offset:28672
v_cvt_pk_bf16_f32 v100, v64, v65
v_mfma_f32_16x16x32_bf16 a[68:71], a[192:195], v[76:79], a[68:71]
v_exp_f32 v66, v66
v_mfma_f32_16x16x32_bf16 a[72:75], a[192:195], v[80:83], a[72:75]
buffer_load_dwordx4 v232, s[12:15], s39 offen offset:2048  lds
v_mfma_f32_16x16x32_bf16 a[76:79], a[192:195], v[84:87], a[76:79]
v_exp_f32 v67, v67
v_mfma_f32_16x16x32_bf16 a[92:95], a[196:199], v[84:87], a[92:95]
ds_read_b64_tr_b16 a[192:193], v224 offset:8192
v_cvt_pk_bf16_f32 v101, v66, v67
v_mfma_f32_16x16x32_bf16 a[88:91], a[196:199], v[80:83], a[88:91]
v_mov_b32 v250, v249
v_exp_f32 v68, v68
v_mfma_f32_16x16x32_bf16 a[84:87], a[196:199], v[76:79], a[84:87]
ds_read_b64_tr_b16 a[194:195], v224 offset:12288
v_mfma_f32_16x16x32_bf16 a[80:83], a[196:199], v[72:75], a[80:83]
v_exp_f32 v69, v69
v_mfma_f32_16x16x32_bf16 a[96:99], a[200:203], v[72:75], a[96:99]
ds_read_b64_tr_b16 a[196:197], v225 offset:8192
v_cvt_pk_bf16_f32 v102, v68, v69
v_mfma_f32_16x16x32_bf16 a[100:103], a[200:203], v[76:79], a[100:103]
v_exp_f32 v70, v70
v_mfma_f32_16x16x32_bf16 a[104:107], a[200:203], v[80:83], a[104:107]
ds_read_b64_tr_b16 a[198:199], v225 offset:12288
v_permlane16_swap_b32 v249, v250
v_mfma_f32_16x16x32_bf16 a[108:111], a[200:203], v[84:87], a[108:111]
v_exp_f32 v71, v71
v_mfma_f32_16x16x32_bf16 a[124:127], a[204:207], v[84:87], a[124:127]
ds_read_b64_tr_b16 a[200:201], v226 offset:8192
v_cvt_pk_bf16_f32 v103, v70, v71
v_mfma_f32_16x16x32_bf16 a[120:123], a[204:207], v[80:83], a[120:123]
ds_read_b64_tr_b16 a[202:203], v226 offset:12288
v_max_u32 v249, v249, v250
v_mfma_f32_16x16x32_bf16 a[116:119], a[204:207], v[76:79], a[116:119]
buffer_load_dwordx4 v233, s[12:15], s39 offen offset:3072  lds
v_mfma_f32_16x16x32_bf16 a[112:115], a[204:207], v[72:75], a[112:115]
ds_read_b64_tr_b16 a[204:205], v227 offset:8192
ds_read_b64_tr_b16 a[206:207], v227 offset:12288
v_smfmac_f32_16x16x64_bf16 a[132:135], a[208:211], v[80:87], v245
v_mov_b32 v250, v249
v_mfma_f32_16x16x32_bf16 v[40:43], a[144:147], v[152:155], v[136:139]
v_exp_f32 v8, v8
v_mfma_f32_16x16x32_bf16 v[40:43], a[148:151], v[156:159], v[40:43]
v_exp_f32 v9, v9
v_mfma_f32_16x16x32_bf16 v[40:43], a[152:155], v[160:163], v[40:43]
v_cvt_pk_bf16_f32 v72, v8, v9
v_permlane32_swap_b32 v249, v250
v_mfma_f32_16x16x32_bf16 v[40:43], a[156:159], v[164:167], v[40:43]
v_exp_f32 v10, v10
v_mfma_f32_16x16x32_bf16 v[48:51], a[156:159], v[180:183], v[140:143]
v_max_u32 v249, v249, v250
v_add_u32 v251, v251, v249
v_mfma_f32_16x16x32_bf16 v[48:51], a[152:155], v[176:179], v[48:51]
v_exp_f32 v11, v11
v_mfma_f32_16x16x32_bf16 v[48:51], a[148:151], v[172:175], v[48:51]
v_cvt_pk_bf16_f32 v73, v10, v11
v_sub_u32 v248, v248, v249
v_mfma_f32_16x16x32_bf16 v[48:51], a[144:147], v[168:171], v[48:51]
v_exp_f32 v12, v12
v_mfma_f32_16x16x32_bf16 v[56:59], a[144:147], v[184:187], v[144:147]
v_cndmask_b32 v252, v252, v251, s[90:91]
v_mfma_f32_16x16x32_bf16 v[56:59], a[148:151], v[188:191], v[56:59]
v_exp_f32 v13, v13
v_mfma_f32_16x16x32_bf16 v[56:59], a[152:155], v[192:195], v[56:59]
v_cvt_pk_bf16_f32 v74, v12, v13
v_readfirstlane_b32 s81, v251
v_mfma_f32_16x16x32_bf16 v[56:59], a[156:159], v[196:199], v[56:59]
v_exp_f32 v14, v14
v_mfma_f32_16x16x32_bf16 v[64:67], a[156:159], v[212:215], v[148:151]
s_waitcnt vmcnt(8) lgkmcnt(0)
s_barrier
v_mfma_f32_16x16x32_bf16 v[64:67], a[152:155], v[208:211], v[64:67]
ds_read_b64_tr_b16 a[212:213], v241 offset:0
v_exp_f32 v15, v15
v_mfma_f32_16x16x32_bf16 v[64:67], a[148:151], v[204:207], v[64:67]
ds_read_b128 a[156:159], v219 offset:49152
ds_read_b64_tr_b16 a[214:215], v241 offset:256
v_cvt_pk_bf16_f32 v75, v14, v15
v_mfma_f32_16x16x32_bf16 v[64:67], a[144:147], v[200:203], v[64:67]
ds_read_b64_tr_b16 a[216:217], v241 offset:2048
v_exp_f32 v16, v16
v_mfma_f32_16x16x32_bf16 a[0:3], a[176:179], v[88:91], a[0:3]
ds_read_b128 a[152:155], v218 offset:49152
ds_read_b128 a[148:151], v217 offset:49152
ds_read_b64_tr_b16 a[218:219], v241 offset:2304
v_mfma_f32_16x16x32_bf16 a[4:7], a[176:179], v[92:95], a[4:7]
ds_read_b64_tr_b16 a[220:221], v241 offset:4096
v_exp_f32 v17, v17
v_mfma_f32_16x16x32_bf16 a[8:11], a[176:179], v[96:99], a[8:11]
ds_read_b128 a[144:147], v216 offset:49152
ds_read_b64_tr_b16 a[222:223], v241 offset:4352
v_cvt_pk_bf16_f32 v76, v16, v17
v_mfma_f32_16x16x32_bf16 a[12:15], a[176:179], v[100:103], a[12:15]
ds_read_b64_tr_b16 a[224:225], v241 offset:6144
v_exp_f32 v18, v18
v_mfma_f32_16x16x32_bf16 a[28:31], a[180:183], v[100:103], a[28:31]
ds_read_b64_tr_b16 a[176:177], v220 offset:32768
ds_read_b64_tr_b16 a[178:179], v220 offset:36864
ds_read_b64_tr_b16 a[226:227], v241 offset:6400
v_mfma_f32_16x16x32_bf16 a[24:27], a[180:183], v[96:99], a[24:27]
ds_read_b64_tr_b16 a[228:229], v241 offset:8192
v_exp_f32 v19, v19
v_mfma_f32_16x16x32_bf16 a[20:23], a[180:183], v[92:95], a[20:23]
s_add_u32 s32, s32, 16384
ds_read_b64_tr_b16 a[230:231], v241 offset:8448
v_cvt_pk_bf16_f32 v77, v18, v19
v_mfma_f32_16x16x32_bf16 a[16:19], a[180:183], v[88:91], a[16:19]
ds_read_b64_tr_b16 a[232:233], v241 offset:10240
v_exp_f32 v20, v20
v_mfma_f32_16x16x32_bf16 a[32:35], a[184:187], v[88:91], a[32:35]
ds_read_b64_tr_b16 a[180:181], v221 offset:32768
ds_read_b64_tr_b16 a[182:183], v221 offset:36864
ds_read_b64_tr_b16 a[234:235], v241 offset:10496
v_mfma_f32_16x16x32_bf16 a[36:39], a[184:187], v[92:95], a[36:39]
ds_read_b64_tr_b16 a[236:237], v241 offset:12288
v_exp_f32 v21, v21
v_mfma_f32_16x16x32_bf16 a[40:43], a[184:187], v[96:99], a[40:43]
s_bitset0_b32 s32, 19
ds_read_b64_tr_b16 a[238:239], v241 offset:12544
v_cvt_pk_bf16_f32 v78, v20, v21
v_mfma_f32_16x16x32_bf16 a[44:47], a[184:187], v[100:103], a[44:47]
ds_read_b64_tr_b16 a[240:241], v241 offset:14336
v_exp_f32 v22, v22
v_mfma_f32_16x16x32_bf16 a[60:63], a[188:191], v[100:103], a[60:63]
ds_read_b64_tr_b16 a[184:185], v222 offset:32768
ds_read_b64_tr_b16 a[186:187], v222 offset:36864
ds_read_b64_tr_b16 a[242:243], v241 offset:14592
v_mfma_f32_16x16x32_bf16 a[56:59], a[188:191], v[96:99], a[56:59]
ds_read_b64_tr_b16 a[244:245], v241 offset:16384
v_exp_f32 v23, v23
v_mfma_f32_16x16x32_bf16 a[52:55], a[188:191], v[92:95], a[52:55]
s_add_u32 m0, s30, 81920
ds_read_b64_tr_b16 a[246:247], v241 offset:16640
v_cvt_pk_bf16_f32 v79, v22, v23
v_mfma_f32_16x16x32_bf16 a[48:51], a[188:191], v[88:91], a[48:51]
ds_read_b64_tr_b16 a[248:249], v241 offset:18432
v_exp_f32 v24, v24
v_smfmac_f32_16x16x64_bf16 a[128:131], a[208:211], v[88:95], v245
ds_read_b64_tr_b16 a[188:189], v223 offset:32768
ds_read_b64_tr_b16 a[250:251], v241 offset:18688
v_mfma_f32_16x16x32_bf16 v[44:47], a[160:163], v[152:155], v[136:139]
ds_read_b64_tr_b16 a[252:253], v241 offset:20480
v_exp_f32 v25, v25
v_mfma_f32_16x16x32_bf16 v[44:47], a[164:167], v[156:159], v[44:47]
ds_read_b64_tr_b16 a[254:255], v241 offset:20736
v_exp_f32 v26, v26
v_mfma_f32_16x16x32_bf16 v[44:47], a[168:171], v[160:163], v[44:47]
ds_read_b64_tr_b16 a[190:191], v223 offset:36864
ds_read_b64_tr_b16 a[136:137], v241 offset:22528
v_cvt_pk_bf16_f32 v80, v24, v25
v_mfma_f32_16x16x32_bf16 v[44:47], a[172:175], v[164:167], v[44:47]
ds_read_b64_tr_b16 a[138:139], v241 offset:22784
v_exp_f32 v27, v27
v_mfma_f32_16x16x32_bf16 v[52:55], a[172:175], v[180:183], v[140:143]
ds_read_b64_tr_b16 a[140:141], v241 offset:24576
s_lshl_b64 s[90:91], s[90:91], 1
v_cvt_pk_bf16_f32 v81, v26, v27
v_mfma_f32_16x16x32_bf16 v[52:55], a[168:171], v[176:179], v[52:55]
v_exp_f32 v28, v28
v_mfma_f32_16x16x32_bf16 v[52:55], a[164:167], v[172:175], v[52:55]
buffer_load_dwordx4 v228, s[8:11], s32 offen offset:0  lds
v_max_u32_dpp v250, v248, v248 row_ror:8 row_mask:0xf bank_mask:0xf
v_mfma_f32_16x16x32_bf16 v[52:55], a[160:163], v[168:171], v[52:55]
v_exp_f32 v29, v29
v_mfma_f32_16x16x32_bf16 v[60:63], a[160:163], v[184:187], v[144:147]
ds_read_b64_tr_b16 a[142:143], v241 offset:24832
v_cvt_pk_bf16_f32 v82, v28, v29
v_mfma_f32_16x16x32_bf16 v[60:63], a[164:167], v[188:191], v[60:63]
v_exp_f32 v30, v30
v_mfma_f32_16x16x32_bf16 v[60:63], a[168:171], v[192:195], v[60:63]
buffer_load_dwordx4 v229, s[8:11], s32 offen offset:1024  lds
v_max_u32_dpp v249, v250, v250 row_ror:4 row_mask:0xf bank_mask:0xf
v_mfma_f32_16x16x32_bf16 v[60:63], a[172:175], v[196:199], v[60:63]
v_exp_f32 v31, v31
v_mfma_f32_16x16x32_bf16 v[68:71], a[172:175], v[212:215], v[148:151]
ds_read_b128 a[172:175], v219 offset:53248
v_cvt_pk_bf16_f32 v83, v30, v31
v_mfma_f32_16x16x32_bf16 v[68:71], a[168:171], v[208:211], v[68:71]
v_exp_f32 v32, v32
v_mfma_f32_16x16x32_bf16 v[68:71], a[164:167], v[204:207], v[68:71]
ds_read_b128 a[168:171], v218 offset:53248
ds_read_b128 a[164:167], v217 offset:53248
v_max_u32_dpp v250, v249, v249 row_ror:2 row_mask:0xf bank_mask:0xf
v_mfma_f32_16x16x32_bf16 v[68:71], a[160:163], v[200:203], v[68:71]
v_exp_f32 v33, v33
v_mfma_f32_16x16x32_bf16 a[64:67], a[192:195], v[88:91], a[64:67]
ds_read_b128 a[160:163], v216 offset:53248
ds_read_b64_tr_b16 v[104:105], v241 offset:26624
v_cvt_pk_bf16_f32 v84, v32, v33
v_mfma_f32_16x16x32_bf16 a[68:71], a[192:195], v[92:95], a[68:71]
v_exp_f32 v34, v34
v_mfma_f32_16x16x32_bf16 a[72:75], a[192:195], v[96:99], a[72:75]
buffer_load_dwordx4 v230, s[8:11], s32 offen offset:2048  lds
v_mfma_f32_16x16x32_bf16 a[76:79], a[192:195], v[100:103], a[76:79]
v_max_u32_dpp v249, v250, v250 row_ror:1 row_mask:0xf bank_mask:0xf
v_exp_f32 v35, v35
v_mfma_f32_16x16x32_bf16 a[92:95], a[196:199], v[100:103], a[92:95]
ds_read_b64_tr_b16 a[192:193], v224 offset:32768
v_cvt_pk_bf16_f32 v85, v34, v35
v_mfma_f32_16x16x32_bf16 a[88:91], a[196:199], v[96:99], a[88:91]
ds_read_b64_tr_b16 v[106:107], v241 offset:26880
v_exp_f32 v36, v36
v_mfma_f32_16x16x32_bf16 a[84:87], a[196:199], v[92:95], a[84:87]
ds_read_b64_tr_b16 a[194:195], v224 offset:36864
ds_read_b64_tr_b16 v[108:109], v241 offset:28672
v_mfma_f32_16x16x32_bf16 a[80:83], a[196:199], v[88:91], a[80:83]
v_mov_b32 v250, v249
v_exp_f32 v37, v37
v_mfma_f32_16x16x32_bf16 a[96:99], a[200:203], v[88:91], a[96:99]
ds_read_b64_tr_b16 a[196:197], v225 offset:32768
v_cvt_pk_bf16_f32 v86, v36, v37
v_mfma_f32_16x16x32_bf16 a[100:103], a[200:203], v[92:95], a[100:103]
v_exp_f32 v38, v38
v_mfma_f32_16x16x32_bf16 a[104:107], a[200:203], v[96:99], a[104:107]
ds_read_b64_tr_b16 a[198:199], v225 offset:36864
ds_read_b64_tr_b16 v[110:111], v241 offset:28928
v_mfma_f32_16x16x32_bf16 a[108:111], a[200:203], v[100:103], a[108:111]
v_exp_f32 v39, v39
v_mfma_f32_16x16x32_bf16 a[124:127], a[204:207], v[100:103], a[124:127]
ds_read_b64_tr_b16 a[200:201], v226 offset:32768
v_cvt_pk_bf16_f32 v87, v38, v39
v_permlane16_swap_b32 v249, v250
v_mfma_f32_16x16x32_bf16 a[120:123], a[204:207], v[96:99], a[120:123]
ds_read_b64_tr_b16 a[202:203], v226 offset:36864
ds_read_b64_tr_b16 v[112:113], v241 offset:30720
v_mfma_f32_16x16x32_bf16 a[116:119], a[204:207], v[92:95], a[116:119]
buffer_load_dwordx4 v231, s[8:11], s32 offen offset:3072  lds
v_mfma_f32_16x16x32_bf16 a[112:115], a[204:207], v[88:91], a[112:115]
ds_read_b64_tr_b16 a[204:205], v227 offset:32768
ds_read_b64_tr_b16 a[206:207], v227 offset:36864
v_smfmac_f32_16x16x64_bf16 a[132:135], a[208:211], v[96:103], v245
ds_read_b64_tr_b16 v[114:115], v241 offset:30976
v_max_u32 v249, v249, v250
s_waitcnt lgkmcnt(8)
v_mfma_f32_16x16x32_bf16 v[8:11], a[144:147], v[152:155], v[136:139]
v_exp_f32 v40, v40
v_mfma_f32_16x16x32_bf16 v[8:11], a[148:151], v[156:159], v[8:11]
v_exp_f32 v41, v41
v_mfma_f32_16x16x32_bf16 v[8:11], a[152:155], v[160:163], v[8:11]
v_and_b32 v253, 0x20202020, v253
v_cvt_pk_bf16_f32 v88, v40, v41
v_mfma_f32_16x16x32_bf16 v[8:11], a[156:159], v[164:167], v[8:11]
v_exp_f32 v42, v42
v_mfma_f32_16x16x32_bf16 v[16:19], a[156:159], v[180:183], v[140:143]
s_add_u32 s39, s39, 16384
v_mov_b32 v250, v249
v_mfma_f32_16x16x32_bf16 v[16:19], a[152:155], v[176:179], v[16:19]
v_exp_f32 v43, v43
v_mfma_f32_16x16x32_bf16 v[16:19], a[148:151], v[172:175], v[16:19]
v_cvt_pk_bf16_f32 v89, v42, v43
v_permlane32_swap_b32 v249, v250
v_mfma_f32_16x16x32_bf16 v[16:19], a[144:147], v[168:171], v[16:19]
v_exp_f32 v44, v44
v_mfma_f32_16x16x32_bf16 v[24:27], a[144:147], v[184:187], v[144:147]
v_cmp_ne_u32 vcc, 0x20202020, v253
s_cbranch_vccnz SP_FL
SP_FL_RET:
v_mfma_f32_16x16x32_bf16 v[24:27], a[148:151], v[188:191], v[24:27]
v_exp_f32 v45, v45
v_mfma_f32_16x16x32_bf16 v[24:27], a[152:155], v[192:195], v[24:27]
v_cvt_pk_bf16_f32 v90, v44, v45
v_mov_b32 v246, s101
v_mfma_f32_16x16x32_bf16 v[24:27], a[156:159], v[196:199], v[24:27]
v_exp_f32 v46, v46
v_mfma_f32_16x16x32_bf16 v[32:35], a[156:159], v[212:215], v[148:151]
ds_read_b128 a[156:159], v219 offset:57344
s_bitset0_b32 s39, 19
v_mfma_f32_16x16x32_bf16 v[32:35], a[152:155], v[208:211], v[32:35]
v_max_u32 v249, v249, v250
v_exp_f32 v47, v47
v_mfma_f32_16x16x32_bf16 v[32:35], a[148:151], v[204:207], v[32:35]
ds_read_b128 a[152:155], v218 offset:57344
v_cvt_pk_bf16_f32 v91, v46, v47
v_mfma_f32_16x16x32_bf16 v[32:35], a[144:147], v[200:203], v[32:35]
v_exp_f32 v48, v48
v_mfma_f32_16x16x32_bf16 a[0:3], a[176:179], v[72:75], a[0:3]
ds_read_b128 a[148:151], v217 offset:57344
ds_read_b128 a[144:147], v216 offset:57344
v_mfma_f32_16x16x32_bf16 a[4:7], a[176:179], v[76:79], a[4:7]
v_add_u32 v251, v251, v249
v_exp_f32 v49, v49
v_mfma_f32_16x16x32_bf16 a[8:11], a[176:179], v[80:83], a[8:11]
v_cvt_pk_bf16_f32 v92, v48, v49
v_mov_b32 v247, s47
v_mfma_f32_16x16x32_bf16 a[12:15], a[176:179], v[84:87], a[12:15]
v_exp_f32 v50, v50
v_mfma_f32_16x16x32_bf16 a[28:31], a[180:183], v[84:87], a[28:31]
ds_read_b64_tr_b16 a[176:177], v220 offset:40960
ds_read_b64_tr_b16 a[178:179], v220 offset:45056
v_mfma_f32_16x16x32_bf16 a[24:27], a[180:183], v[80:83], a[24:27]
v_exp_f32 v51, v51
v_mfma_f32_16x16x32_bf16 a[20:23], a[180:183], v[76:79], a[20:23]
s_add_u32 m0, s30, 98304
v_cvt_pk_bf16_f32 v93, v50, v51
v_sub_u32 v248, v248, v249
v_mfma_f32_16x16x32_bf16 a[16:19], a[180:183], v[72:75], a[16:19]
v_exp_f32 v52, v52
v_mfma_f32_16x16x32_bf16 a[32:35], a[184:187], v[72:75], a[32:35]
ds_read_b64_tr_b16 a[180:181], v221 offset:40960
ds_read_b64_tr_b16 a[182:183], v221 offset:45056
v_mfma_f32_16x16x32_bf16 a[36:39], a[184:187], v[76:79], a[36:39]
v_exp_f32 v53, v53
v_mfma_f32_16x16x32_bf16 a[40:43], a[184:187], v[80:83], a[40:43]
v_cvt_pk_bf16_f32 v94, v52, v53
v_mov_b32 v253, 0
v_mfma_f32_16x16x32_bf16 a[44:47], a[184:187], v[84:87], a[44:47]
v_cndmask_b32 v252, v252, v251, s[90:91]
v_exp_f32 v54, v54
v_mfma_f32_16x16x32_bf16 a[60:63], a[188:191], v[84:87], a[60:63]
ds_read_b64_tr_b16 a[184:185], v222 offset:40960
ds_read_b64_tr_b16 a[186:187], v222 offset:45056
v_mfma_f32_16x16x32_bf16 a[56:59], a[188:191], v[80:83], a[56:59]
v_exp_f32 v55, v55
v_mfma_f32_16x16x32_bf16 a[52:55], a[188:191], v[76:79], a[52:55]
s_add_u32 s29, s2, s37
v_cvt_pk_bf16_f32 v95, v54, v55
v_mfma_f32_16x16x32_bf16 a[48:51], a[188:191], v[72:75], a[48:51]
v_readfirstlane_b32 s82, v251
v_exp_f32 v56, v56
v_smfmac_f32_16x16x64_bf16 a[128:131], a[208:211], v[72:79], v245
ds_read_b64_tr_b16 a[188:189], v223 offset:40960
v_mfma_f32_16x16x32_bf16 v[12:15], a[160:163], v[152:155], v[136:139]
v_exp_f32 v57, v57
v_mfma_f32_16x16x32_bf16 v[12:15], a[164:167], v[156:159], v[12:15]
v_exp_f32 v58, v58
v_mfma_f32_16x16x32_bf16 v[12:15], a[168:171], v[160:163], v[12:15]
ds_read_b64_tr_b16 a[190:191], v223 offset:45056
v_cvt_pk_bf16_f32 v96, v56, v57
v_mfma_f32_16x16x32_bf16 v[12:15], a[172:175], v[164:167], v[12:15]
s_lshl_b64 s[90:91], s[90:91], 1
v_exp_f32 v59, v59
v_mfma_f32_16x16x32_bf16 v[20:23], a[172:175], v[180:183], v[140:143]
v_cvt_pk_bf16_f32 v97, v58, v59
STUB_7:
s_cbranch_execz HOP_RET1
v_mfma_f32_16x16x32_bf16 v[20:23], a[168:171], v[176:179], v[20:23]
v_exp_f32 v60, v60
v_mfma_f32_16x16x32_bf16 v[20:23], a[164:167], v[172:175], v[20:23]
buffer_load_dwordx4 v232, s[12:15], s39 offen offset:0  lds
v_mfma_f32_16x16x32_bf16 v[20:23], a[160:163], v[168:171], v[20:23]
v_max_u32_dpp v250, v248, v248 row_ror:8 row_mask:0xf bank_mask:0xf
v_exp_f32 v61, v61
v_mfma_f32_16x16x32_bf16 v[28:31], a[160:163], v[184:187], v[144:147]
v_cvt_pk_bf16_f32 v98, v60, v61
v_mfma_f32_16x16x32_bf16 v[28:31], a[164:167], v[188:191], v[28:31]
v_exp_f32 v62, v62
v_mfma_f32_16x16x32_bf16 v[28:31], a[168:171], v[192:195], v[28:31]
buffer_load_dwordx4 v233, s[12:15], s39 offen offset:1024  lds
v_mfma_f32_16x16x32_bf16 v[28:31], a[172:175], v[196:199], v[28:31]
v_exp_f32 v63, v63
v_mfma_f32_16x16x32_bf16 v[36:39], a[172:175], v[212:215], v[148:151]
ds_read_b128 a[172:175], v219 offset:61440
v_cvt_pk_bf16_f32 v99, v62, v63
v_max_u32_dpp v249, v250, v250 row_ror:4 row_mask:0xf bank_mask:0xf
v_mfma_f32_16x16x32_bf16 v[36:39], a[168:171], v[208:211], v[36:39]
v_exp_f32 v64, v64
v_mfma_f32_16x16x32_bf16 v[36:39], a[164:167], v[204:207], v[36:39]
ds_read_b128 a[168:171], v218 offset:61440
ds_read_b128 a[164:167], v217 offset:61440
v_mfma_f32_16x16x32_bf16 v[36:39], a[160:163], v[200:203], v[36:39]
v_exp_f32 v65, v65
v_mfma_f32_16x16x32_bf16 a[64:67], a[192:195], v[72:75], a[64:67]
ds_read_b128 a[160:163], v216 offset:61440
v_cvt_pk_bf16_f32 v100, v64, v65
v_max_u32_dpp v250, v249, v249 row_ror:2 row_mask:0xf bank_mask:0xf
v_mfma_f32_16x16x32_bf16 a[68:71], a[192:195], v[76:79], a[68:71]
v_exp_f32 v66, v66
v_mfma_f32_16x16x32_bf16 a[72:75], a[192:195], v[80:83], a[72:75]
buffer_load_dwordx4 v232, s[12:15], s39 offen offset:2048  lds
v_mfma_f32_16x16x32_bf16 a[76:79], a[192:195], v[84:87], a[76:79]
v_exp_f32 v67, v67
s_waitcnt lgkmcnt(8)
v_mfma_f32_16x16x32_bf16 a[92:95], a[196:199], v[84:87], a[92:95]
ds_read_b64_tr_b16 a[192:193], v224 offset:40960
v_cvt_pk_bf16_f32 v101, v66, v67
v_mfma_f32_16x16x32_bf16 a[88:91], a[196:199], v[80:83], a[88:91]
v_max_u32_dpp v249, v250, v250 row_ror:1 row_mask:0xf bank_mask:0xf
v_exp_f32 v68, v68
v_mfma_f32_16x16x32_bf16 a[84:87], a[196:199], v[76:79], a[84:87]
ds_read_b64_tr_b16 a[194:195], v224 offset:45056
s_cmp_eq_u32 s29, 0
s_cselect_b32 s29, 0x24c000, -16
v_mfma_f32_16x16x32_bf16 a[80:83], a[196:199], v[72:75], a[80:83]
v_exp_f32 v69, v69
v_mfma_f32_16x16x32_bf16 a[96:99], a[200:203], v[72:75], a[96:99]
ds_read_b64_tr_b16 a[196:197], v225 offset:40960
v_cvt_pk_bf16_f32 v102, v68, v69
v_mfma_f32_16x16x32_bf16 a[100:103], a[200:203], v[76:79], a[100:103]
v_mov_b32 v250, v249
v_exp_f32 v70, v70
v_mfma_f32_16x16x32_bf16 a[104:107], a[200:203], v[80:83], a[104:107]
ds_read_b64_tr_b16 a[198:199], v225 offset:45056
buffer_store_dwordx2 v[246:247], v253, s[20:23], s29 offen
v_mfma_f32_16x16x32_bf16 a[108:111], a[200:203], v[84:87], a[108:111]
v_exp_f32 v71, v71
v_mfma_f32_16x16x32_bf16 a[124:127], a[204:207], v[84:87], a[124:127]
ds_read_b64_tr_b16 a[200:201], v226 offset:40960
v_cvt_pk_bf16_f32 v103, v70, v71
v_mfma_f32_16x16x32_bf16 a[120:123], a[204:207], v[80:83], a[120:123]
ds_read_b64_tr_b16 a[202:203], v226 offset:45056
v_permlane16_swap_b32 v249, v250
v_mfma_f32_16x16x32_bf16 a[116:119], a[204:207], v[76:79], a[116:119]
buffer_load_dwordx4 v233, s[12:15], s39 offen offset:3072  lds
v_mfma_f32_16x16x32_bf16 a[112:115], a[204:207], v[72:75], a[112:115]
ds_read_b64_tr_b16 a[204:205], v227 offset:40960
ds_read_b64_tr_b16 a[206:207], v227 offset:45056
v_smfmac_f32_16x16x64_bf16 a[132:135], a[208:211], v[80:87], v245
v_max_u32 v249, v249, v250
v_mfma_f32_16x16x32_bf16 v[40:43], a[144:147], v[152:155], v[136:139]
v_exp_f32 v8, v8
v_mfma_f32_16x16x32_bf16 v[40:43], a[148:151], v[156:159], v[40:43]
v_exp_f32 v9, v9
v_mfma_f32_16x16x32_bf16 v[40:43], a[152:155], v[160:163], v[40:43]
v_cvt_pk_bf16_f32 v72, v8, v9
v_mov_b32 v250, v249
v_mfma_f32_16x16x32_bf16 v[40:43], a[156:159], v[164:167], v[40:43]
v_exp_f32 v10, v10
v_mfma_f32_16x16x32_bf16 v[48:51], a[156:159], v[180:183], v[140:143]
v_permlane32_swap_b32 v249, v250
v_max_u32 v249, v249, v250
v_mfma_f32_16x16x32_bf16 v[48:51], a[152:155], v[176:179], v[48:51]
v_exp_f32 v11, v11
v_mfma_f32_16x16x32_bf16 v[48:51], a[148:151], v[172:175], v[48:51]
v_cvt_pk_bf16_f32 v73, v10, v11
v_add_u32 v251, v251, v249
v_mfma_f32_16x16x32_bf16 v[48:51], a[144:147], v[168:171], v[48:51]
v_exp_f32 v12, v12
v_mfma_f32_16x16x32_bf16 v[56:59], a[144:147], v[184:187], v[144:147]
v_cndmask_b32 v252, v252, v251, s[90:91]
v_mfma_f32_16x16x32_bf16 v[56:59], a[148:151], v[188:191], v[56:59]
v_exp_f32 v13, v13
v_mfma_f32_16x16x32_bf16 v[56:59], a[152:155], v[192:195], v[56:59]
v_cvt_pk_bf16_f32 v74, v12, v13
v_readfirstlane_b32 s83, v251
v_mfma_f32_16x16x32_bf16 v[56:59], a[156:159], v[196:199], v[56:59]
v_exp_f32 v14, v14
v_mfma_f32_16x16x32_bf16 v[64:67], a[156:159], v[212:215], v[148:151]
s_waitcnt vmcnt(9) lgkmcnt(0)
s_barrier
v_mfma_f32_16x16x32_bf16 v[64:67], a[152:155], v[208:211], v[64:67]
v_exp_f32 v15, v15
v_mfma_f32_16x16x32_bf16 v[64:67], a[148:151], v[204:207], v[64:67]
ds_read_b128 a[156:159], v219 offset:0
v_cvt_pk_bf16_f32 v75, v14, v15
v_mfma_f32_16x16x32_bf16 v[64:67], a[144:147], v[200:203], v[64:67]
v_exp_f32 v16, v16
v_mfma_f32_16x16x32_bf16 a[0:3], a[176:179], v[88:91], a[0:3]
ds_read_b128 a[152:155], v218 offset:0
ds_read_b128 a[148:151], v217 offset:0
v_mfma_f32_16x16x32_bf16 a[4:7], a[176:179], v[92:95], a[4:7]
v_exp_f32 v17, v17
v_mfma_f32_16x16x32_bf16 a[8:11], a[176:179], v[96:99], a[8:11]
ds_read_b128 a[144:147], v216 offset:0
v_cvt_pk_bf16_f32 v76, v16, v17
v_mfma_f32_16x16x32_bf16 a[12:15], a[176:179], v[100:103], a[12:15]
v_exp_f32 v18, v18
v_mfma_f32_16x16x32_bf16 a[28:31], a[180:183], v[100:103], a[28:31]
ds_read_b64_tr_b16 a[176:177], v220 offset:49152
ds_read_b64_tr_b16 a[178:179], v220 offset:53248
v_mfma_f32_16x16x32_bf16 a[24:27], a[180:183], v[96:99], a[24:27]
v_exp_f32 v19, v19
v_mfma_f32_16x16x32_bf16 a[20:23], a[180:183], v[92:95], a[20:23]
s_add_u32 s32, s32, 16384
v_cvt_pk_bf16_f32 v77, v18, v19
v_mfma_f32_16x16x32_bf16 a[16:19], a[180:183], v[88:91], a[16:19]
v_exp_f32 v20, v20
v_mfma_f32_16x16x32_bf16 a[32:35], a[184:187], v[88:91], a[32:35]
ds_read_b64_tr_b16 a[180:181], v221 offset:49152
ds_read_b64_tr_b16 a[182:183], v221 offset:53248
v_mfma_f32_16x16x32_bf16 a[36:39], a[184:187], v[92:95], a[36:39]
v_exp_f32 v21, v21
v_mfma_f32_16x16x32_bf16 a[40:43], a[184:187], v[96:99], a[40:43]
s_bitset0_b32 s32, 19
v_cvt_pk_bf16_f32 v78, v20, v21
v_mfma_f32_16x16x32_bf16 a[44:47], a[184:187], v[100:103], a[44:47]
v_exp_f32 v22, v22
v_mfma_f32_16x16x32_bf16 a[60:63], a[188:191], v[100:103], a[60:63]
ds_read_b64_tr_b16 a[184:185], v222 offset:49152
ds_read_b64_tr_b16 a[186:187], v222 offset:53248
v_mfma_f32_16x16x32_bf16 a[56:59], a[188:191], v[96:99], a[56:59]
v_exp_f32 v23, v23
v_mfma_f32_16x16x32_bf16 a[52:55], a[188:191], v[92:95], a[52:55]
s_add_u32 m0, s30, 114688
v_cvt_pk_bf16_f32 v79, v22, v23
v_mfma_f32_16x16x32_bf16 a[48:51], a[188:191], v[88:91], a[48:51]
v_exp_f32 v24, v24
v_smfmac_f32_16x16x64_bf16 a[128:131], a[208:211], v[88:95], v245
ds_read_b64_tr_b16 a[188:189], v223 offset:49152
v_mfma_f32_16x16x32_bf16 v[44:47], a[160:163], v[152:155], v[136:139]
v_mov_b32 v236, v252
v_exp_f32 v25, v25
v_mfma_f32_16x16x32_bf16 v[44:47], a[164:167], v[156:159], v[44:47]
v_exp_f32 v26, v26
v_mfma_f32_16x16x32_bf16 v[44:47], a[168:171], v[160:163], v[44:47]
ds_read_b64_tr_b16 a[190:191], v223 offset:53248
v_cvt_pk_bf16_f32 v80, v24, v25
v_mfma_f32_16x16x32_bf16 v[44:47], a[172:175], v[164:167], v[44:47]
v_exp_f32 v27, v27
v_mfma_f32_16x16x32_bf16 v[52:55], a[172:175], v[180:183], v[140:143]
v_cvt_pk_bf16_f32 v81, v26, v27
v_and_b32 v252, 0xffff, v252
v_mfma_f32_16x16x32_bf16 v[52:55], a[168:171], v[176:179], v[52:55]
v_exp_f32 v28, v28
v_mfma_f32_16x16x32_bf16 v[52:55], a[164:167], v[172:175], v[52:55]
buffer_load_dwordx4 v228, s[8:11], s32 offen offset:0  lds
v_mfma_f32_16x16x32_bf16 v[52:55], a[160:163], v[168:171], v[52:55]
v_exp_f32 v29, v29
v_mfma_f32_16x16x32_bf16 v[60:63], a[160:163], v[184:187], v[144:147]
v_cvt_pk_bf16_f32 v82, v28, v29
v_sub_u32 v252, 0xffff, v252
v_mfma_f32_16x16x32_bf16 v[60:63], a[164:167], v[188:191], v[60:63]
v_exp_f32 v30, v30
v_mfma_f32_16x16x32_bf16 v[60:63], a[168:171], v[192:195], v[60:63]
buffer_load_dwordx4 v229, s[8:11], s32 offen offset:1024  lds
v_mfma_f32_16x16x32_bf16 v[60:63], a[172:175], v[196:199], v[60:63]
v_exp_f32 v31, v31
v_mfma_f32_16x16x32_bf16 v[68:71], a[172:175], v[212:215], v[148:151]
ds_read_b128 a[172:175], v219 offset:4096
v_cvt_pk_bf16_f32 v83, v30, v31
v_mfma_f32_16x16x32_bf16 v[68:71], a[168:171], v[208:211], v[68:71]
v_exp_f32 v32, v32
v_mfma_f32_16x16x32_bf16 v[68:71], a[164:167], v[204:207], v[68:71]
ds_read_b128 a[168:171], v218 offset:4096
ds_read_b128 a[164:167], v217 offset:4096
v_mul_u32_u24 v252, 0x480, v252
v_mfma_f32_16x16x32_bf16 v[68:71], a[160:163], v[200:203], v[68:71]
v_exp_f32 v33, v33
v_mfma_f32_16x16x32_bf16 a[64:67], a[192:195], v[88:91], a[64:67]
ds_read_b128 a[160:163], v216 offset:4096
v_cvt_pk_bf16_f32 v84, v32, v33
v_mfma_f32_16x16x32_bf16 a[68:71], a[192:195], v[92:95], a[68:71]
v_exp_f32 v34, v34
v_mfma_f32_16x16x32_bf16 a[72:75], a[192:195], v[96:99], a[72:75]
buffer_load_dwordx4 v230, s[8:11], s32 offen offset:2048  lds
v_lshrrev_b32 v249, 3, v0
v_mfma_f32_16x16x32_bf16 a[76:79], a[192:195], v[100:103], a[76:79]
v_exp_f32 v35, v35
v_mfma_f32_16x16x32_bf16 a[92:95], a[196:199], v[100:103], a[92:95]
ds_read_b64_tr_b16 a[192:193], v224 offset:49152
v_cvt_pk_bf16_f32 v85, v34, v35
v_mfma_f32_16x16x32_bf16 a[88:91], a[196:199], v[96:99], a[88:91]
v_exp_f32 v36, v36
v_mfma_f32_16x16x32_bf16 a[84:87], a[196:199], v[92:95], a[84:87]
ds_read_b64_tr_b16 a[194:195], v224 offset:53248
v_lshl_add_u32 v252, v249, 4, v252
v_mfma_f32_16x16x32_bf16 a[80:83], a[196:199], v[88:91], a[80:83]
v_exp_f32 v37, v37
v_mfma_f32_16x16x32_bf16 a[96:99], a[200:203], v[88:91], a[96:99]
ds_read_b64_tr_b16 a[196:197], v225 offset:49152
v_cvt_pk_bf16_f32 v86, v36, v37
v_mfma_f32_16x16x32_bf16 a[100:103], a[200:203], v[92:95], a[100:103]
v_exp_f32 v38, v38
v_mfma_f32_16x16x32_bf16 a[104:107], a[200:203], v[96:99], a[104:107]
ds_read_b64_tr_b16 a[198:199], v225 offset:53248
v_mfma_f32_16x16x32_bf16 a[108:111], a[200:203], v[100:103], a[108:111]
v_exp_f32 v39, v39
v_mfma_f32_16x16x32_bf16 a[124:127], a[204:207], v[100:103], a[124:127]
ds_read_b64_tr_b16 a[200:201], v226 offset:49152
v_cvt_pk_bf16_f32 v87, v38, v39
v_mfma_f32_16x16x32_bf16 a[120:123], a[204:207], v[96:99], a[120:123]
ds_read_b64_tr_b16 a[202:203], v226 offset:53248
v_mfma_f32_16x16x32_bf16 a[116:119], a[204:207], v[92:95], a[116:119]
buffer_load_dwordx4 v231, s[8:11], s32 offen offset:3072  lds
v_mfma_f32_16x16x32_bf16 a[112:115], a[204:207], v[88:91], a[112:115]
ds_read_b64_tr_b16 a[204:205], v227 offset:49152
ds_read_b64_tr_b16 a[206:207], v227 offset:53248
v_smfmac_f32_16x16x64_bf16 a[132:135], a[208:211], v[96:103], v245
s_add_u32 m0, s86, 0
s_add_u32 s50, s84, 4718592
buffer_load_dwordx4 v240, s[64:67], s50 offen lds
s_add_u32 m0, s86, 4096
s_add_u32 s50, s84, 4718592
buffer_load_dwordx4 v240, s[68:71], s50 offen lds
s_add_u32 m0, s86, 8192
s_add_u32 s50, s85, 0
buffer_load_dwordx4 v244, s[72:75], s50 offen lds
s_add_u32 m0, s86, 12288
s_add_u32 s50, s85, 4096
buffer_load_dwordx4 v244, s[72:75], s50 offen lds
s_waitcnt lgkmcnt(8)
v_mfma_f32_16x16x32_bf16 v[8:11], a[144:147], v[152:155], v[136:139]
v_exp_f32 v40, v40
v_mfma_f32_16x16x32_bf16 v[8:11], a[148:151], v[156:159], v[8:11]
v_ashrrev_i32 v246, 31, v236
v_exp_f32 v41, v41
v_mfma_f32_16x16x32_bf16 v[8:11], a[152:155], v[160:163], v[8:11]
v_cvt_pk_bf16_f32 v88, v40, v41
v_not_b32 v246, v246
v_mfma_f32_16x16x32_bf16 v[8:11], a[156:159], v[164:167], v[8:11]
v_exp_f32 v42, v42
v_mfma_f32_16x16x32_bf16 v[16:19], a[156:159], v[180:183], v[140:143]
s_add_u32 s39, s39, 16384
v_or_b32 v246, 0x80000000, v246
v_mfma_f32_16x16x32_bf16 v[16:19], a[152:155], v[176:179], v[16:19]
v_exp_f32 v43, v43
v_mfma_f32_16x16x32_bf16 v[16:19], a[148:151], v[172:175], v[16:19]
v_cvt_pk_bf16_f32 v89, v42, v43
v_xor_b32 v236, v236, v246
v_mfma_f32_16x16x32_bf16 v[16:19], a[144:147], v[168:171], v[16:19]
v_exp_f32 v44, v44
v_mfma_f32_16x16x32_bf16 v[24:27], a[144:147], v[184:187], v[144:147]
s_bitset0_b32 s39, 19
v_and_b32 v236, 0xffff0000, v236
v_mfma_f32_16x16x32_bf16 v[24:27], a[148:151], v[188:191], v[24:27]
v_exp_f32 v45, v45
v_mfma_f32_16x16x32_bf16 v[24:27], a[152:155], v[192:195], v[24:27]
v_cvt_pk_bf16_f32 v90, v44, v45
v_mul_f32 v236, 0xbfb8aa3b, v236
v_mfma_f32_16x16x32_bf16 v[24:27], a[156:159], v[196:199], v[24:27]
v_exp_f32 v46, v46
v_mfma_f32_16x16x32_bf16 v[32:35], a[156:159], v[212:215], v[148:151]
ds_read_b128 a[156:159], v219 offset:8192
v_mfma_f32_16x16x32_bf16 v[32:35], a[152:155], v[208:211], v[32:35]
v_exp_f32 v47, v47
v_mfma_f32_16x16x32_bf16 v[32:35], a[148:151], v[204:207], v[32:35]
ds_read_b128 a[152:155], v218 offset:8192
v_cvt_pk_bf16_f32 v91, v46, v47
v_mfma_f32_16x16x32_bf16 v[32:35], a[144:147], v[200:203], v[32:35]
v_exp_f32 v48, v48
v_mfma_f32_16x16x32_bf16 a[0:3], a[176:179], v[72:75], a[0:3]
ds_read_b128 a[148:151], v217 offset:8192
ds_read_b128 a[144:147], v216 offset:8192
v_mfma_f32_16x16x32_bf16 a[4:7], a[176:179], v[76:79], a[4:7]
v_exp_f32 v49, v49
v_mfma_f32_16x16x32_bf16 a[8:11], a[176:179], v[80:83], a[8:11]
s_add_u32 m0, s30, 131072
v_cvt_pk_bf16_f32 v92, v48, v49
v_mfma_f32_16x16x32_bf16 a[12:15], a[176:179], v[84:87], a[12:15]
v_exp_f32 v50, v50
v_mfma_f32_16x16x32_bf16 a[28:31], a[180:183], v[84:87], a[28:31]
ds_read_b64_tr_b16 a[176:177], v220 offset:57344
ds_read_b64_tr_b16 a[178:179], v220 offset:61440
v_mfma_f32_16x16x32_bf16 a[24:27], a[180:183], v[80:83], a[24:27]
v_exp_f32 v51, v51
v_mfma_f32_16x16x32_bf16 a[20:23], a[180:183], v[76:79], a[20:23]
v_cvt_pk_bf16_f32 v93, v50, v51
v_mfma_f32_16x16x32_bf16 a[16:19], a[180:183], v[72:75], a[16:19]
v_exp_f32 v52, v52
v_mfma_f32_16x16x32_bf16 a[32:35], a[184:187], v[72:75], a[32:35]
ds_read_b64_tr_b16 a[180:181], v221 offset:57344
ds_read_b64_tr_b16 a[182:183], v221 offset:61440
v_mfma_f32_16x16x32_bf16 a[36:39], a[184:187], v[76:79], a[36:39]
v_exp_f32 v53, v53
v_mfma_f32_16x16x32_bf16 a[40:43], a[184:187], v[80:83], a[40:43]
v_cvt_pk_bf16_f32 v94, v52, v53
v_mfma_f32_16x16x32_bf16 a[44:47], a[184:187], v[84:87], a[44:47]
v_exp_f32 v54, v54
v_mfma_f32_16x16x32_bf16 a[60:63], a[188:191], v[84:87], a[60:63]
ds_read_b64_tr_b16 a[184:185], v222 offset:57344
ds_read_b64_tr_b16 a[186:187], v222 offset:61440
v_mfma_f32_16x16x32_bf16 a[56:59], a[188:191], v[80:83], a[56:59]
v_exp_f32 v55, v55
v_mfma_f32_16x16x32_bf16 a[52:55], a[188:191], v[76:79], a[52:55]
v_cvt_pk_bf16_f32 v95, v54, v55
v_exp_f32 v236, v236
v_mfma_f32_16x16x32_bf16 a[48:51], a[188:191], v[72:75], a[48:51]
v_exp_f32 v56, v56
v_smfmac_f32_16x16x64_bf16 a[128:131], a[208:211], v[72:79], v245
ds_read_b64_tr_b16 a[188:189], v223 offset:57344
v_mfma_f32_16x16x32_bf16 v[12:15], a[160:163], v[152:155], v[136:139]
v_exp_f32 v57, v57
v_mfma_f32_16x16x32_bf16 v[12:15], a[164:167], v[156:159], v[12:15]
v_exp_f32 v58, v58
v_mfma_f32_16x16x32_bf16 v[12:15], a[168:171], v[160:163], v[12:15]
ds_read_b64_tr_b16 a[190:191], v223 offset:61440
v_cvt_pk_bf16_f32 v96, v56, v57
v_mfma_f32_16x16x32_bf16 v[12:15], a[172:175], v[164:167], v[12:15]
v_exp_f32 v59, v59
v_mfma_f32_16x16x32_bf16 v[20:23], a[172:175], v[180:183], v[140:143]
v_cvt_pk_bf16_f32 v97, v58, v59
v_add_f32 v236, 1.0, v236
v_mfma_f32_16x16x32_bf16 v[20:23], a[168:171], v[176:179], v[20:23]
v_exp_f32 v60, v60
v_mfma_f32_16x16x32_bf16 v[20:23], a[164:167], v[172:175], v[20:23]
buffer_load_dwordx4 v232, s[12:15], s39 offen offset:0  lds
v_mfma_f32_16x16x32_bf16 v[20:23], a[160:163], v[168:171], v[20:23]
v_exp_f32 v61, v61
v_mfma_f32_16x16x32_bf16 v[28:31], a[160:163], v[184:187], v[144:147]
v_cvt_pk_bf16_f32 v98, v60, v61
v_mfma_f32_16x16x32_bf16 v[28:31], a[164:167], v[188:191], v[28:31]
v_exp_f32 v62, v62
v_mfma_f32_16x16x32_bf16 v[28:31], a[168:171], v[192:195], v[28:31]
buffer_load_dwordx4 v233, s[12:15], s39 offen offset:1024  lds
v_mfma_f32_16x16x32_bf16 v[28:31], a[172:175], v[196:199], v[28:31]
v_exp_f32 v63, v63
v_mfma_f32_16x16x32_bf16 v[36:39], a[172:175], v[212:215], v[148:151]
ds_read_b128 a[172:175], v219 offset:12288
v_cvt_pk_bf16_f32 v99, v62, v63
v_mfma_f32_16x16x32_bf16 v[36:39], a[168:171], v[208:211], v[36:39]
v_exp_f32 v64, v64
v_mfma_f32_16x16x32_bf16 v[36:39], a[164:167], v[204:207], v[36:39]
ds_read_b128 a[168:171], v218 offset:12288
ds_read_b128 a[164:167], v217 offset:12288
v_mfma_f32_16x16x32_bf16 v[36:39], a[160:163], v[200:203], v[36:39]
v_exp_f32 v65, v65
s_waitcnt lgkmcnt(8)
v_mfma_f32_16x16x32_bf16 a[64:67], a[192:195], v[72:75], a[64:67]
ds_read_b128 a[160:163], v216 offset:12288
v_cvt_pk_bf16_f32 v100, v64, v65
v_mfma_f32_16x16x32_bf16 a[68:71], a[192:195], v[76:79], a[68:71]
v_exp_f32 v66, v66
v_mfma_f32_16x16x32_bf16 a[72:75], a[192:195], v[80:83], a[72:75]
buffer_load_dwordx4 v232, s[12:15], s39 offen offset:2048  lds
v_mfma_f32_16x16x32_bf16 a[76:79], a[192:195], v[84:87], a[76:79]
v_exp_f32 v67, v67
v_mfma_f32_16x16x32_bf16 a[92:95], a[196:199], v[84:87], a[92:95]
ds_read_b64_tr_b16 a[192:193], v224 offset:57344
v_cvt_pk_bf16_f32 v101, v66, v67
v_mfma_f32_16x16x32_bf16 a[88:91], a[196:199], v[80:83], a[88:91]
v_exp_f32 v68, v68
v_mfma_f32_16x16x32_bf16 a[84:87], a[196:199], v[76:79], a[84:87]
ds_read_b64_tr_b16 a[194:195], v224 offset:61440
v_rcp_f32 v236, v236
v_mfma_f32_16x16x32_bf16 a[80:83], a[196:199], v[72:75], a[80:83]
v_cvt_pk_bf16_f32 v236, v236, v236
v_exp_f32 v69, v69
v_mfma_f32_16x16x32_bf16 a[96:99], a[200:203], v[72:75], a[96:99]
ds_read_b64_tr_b16 a[196:197], v225 offset:57344
v_cvt_pk_bf16_f32 v102, v68, v69
v_lshlrev_b32 v236, 16, v236
v_mfma_f32_16x16x32_bf16 a[100:103], a[200:203], v[76:79], a[100:103]
v_exp_f32 v70, v70
v_mfma_f32_16x16x32_bf16 a[104:107], a[200:203], v[80:83], a[104:107]
ds_read_b64_tr_b16 a[198:199], v225 offset:61440
v_mfma_f32_16x16x32_bf16 a[108:111], a[200:203], v[84:87], a[108:111]
v_exp_f32 v71, v71
v_mfma_f32_16x16x32_bf16 a[124:127], a[204:207], v[84:87], a[124:127]
ds_read_b64_tr_b16 a[200:201], v226 offset:57344
v_cvt_pk_bf16_f32 v103, v70, v71
v_mfma_f32_16x16x32_bf16 a[120:123], a[204:207], v[80:83], a[120:123]
ds_read_b64_tr_b16 a[202:203], v226 offset:61440
v_mfma_f32_16x16x32_bf16 a[116:119], a[204:207], v[76:79], a[116:119]
buffer_load_dwordx4 v233, s[12:15], s39 offen offset:3072  lds
v_mfma_f32_16x16x32_bf16 a[112:115], a[204:207], v[72:75], a[112:115]
ds_read_b64_tr_b16 a[204:205], v227 offset:57344
ds_read_b64_tr_b16 a[206:207], v227 offset:61440
v_smfmac_f32_16x16x64_bf16 a[132:135], a[208:211], v[80:87], v245
s_add_u32 m0, s86, 45056
s_mov_b32 s50, 29360128
buffer_load_dwordx4 v252, s[20:23], s50 offen sc0 sc1 lds
s_add_u32 m0, s86, 49152
s_mov_b32 s50, 29360640
buffer_load_dwordx4 v252, s[20:23], s50 offen sc0 sc1 lds
s_add_u32 m0, s86, 53248
s_mov_b32 s50, 29361152
buffer_load_dwordx4 v252, s[20:23], s50 offen sc0 sc1 lds
s_add_u32 m0, s86, 16384
s_add_u32 s50, s85, 8192
buffer_load_dwordx4 v244, s[72:75], s50 offen lds
s_mov_b32 s33, 7
s_cmp_lt_u32 s86, 0x10000
s_cbranch_scc0 K_LOOPIN
v_mfma_f32_16x16x32_bf16 v[40:43], a[144:147], v[152:155], v[136:139]
v_exp_f32 v8, v8
v_mfma_f32_16x16x32_bf16 v[40:43], a[148:151], v[156:159], v[40:43]
v_exp_f32 v9, v9
v_mfma_f32_16x16x32_bf16 v[40:43], a[152:155], v[160:163], v[40:43]
s_lshr_b32 s28, s37, 1
v_cvt_pk_bf16_f32 v72, v8, v9
v_mfma_f32_16x16x32_bf16 v[40:43], a[156:159], v[164:167], v[40:43]
v_exp_f32 v10, v10
v_mfma_f32_16x16x32_bf16 v[48:51], a[156:159], v[180:183], v[140:143]
s_mul_i32 s28, s28, 28672
v_mfma_f32_16x16x32_bf16 v[48:51], a[152:155], v[176:179], v[48:51]
v_exp_f32 v11, v11
v_mfma_f32_16x16x32_bf16 v[48:51], a[148:151], v[172:175], v[48:51]
v_cvt_pk_bf16_f32 v73, v10, v11
v_subrev_u32 v241, s28, v241
v_mfma_f32_16x16x32_bf16 v[48:51], a[144:147], v[168:171], v[48:51]
v_exp_f32 v12, v12
v_mfma_f32_16x16x32_bf16 v[56:59], a[144:147], v[184:187], v[144:147]
v_and_b32 v239, 7, v1
v_lshl_add_u32 v239, v4, 3, v239
v_mfma_f32_16x16x32_bf16 v[56:59], a[148:151], v[188:191], v[56:59]
v_exp_f32 v13, v13
v_mfma_f32_16x16x32_bf16 v[56:59], a[152:155], v[192:195], v[56:59]
v_cvt_pk_bf16_f32 v74, v12, v13
v_lshlrev_b32 v239, 4, v239
v_mfma_f32_16x16x32_bf16 v[56:59], a[156:159], v[196:199], v[56:59]
v_exp_f32 v14, v14
v_mfma_f32_16x16x32_bf16 v[64:67], a[156:159], v[212:215], v[148:151]
s_waitcnt vmcnt(16) lgkmcnt(0)
s_barrier
v_mfma_f32_16x16x32_bf16 v[64:67], a[152:155], v[208:211], v[64:67]
v_exp_f32 v15, v15
v_mfma_f32_16x16x32_bf16 v[64:67], a[148:151], v[204:207], v[64:67]
ds_read_b128 a[156:159], v219 offset:16384
v_cvt_pk_bf16_f32 v75, v14, v15
v_mfma_f32_16x16x32_bf16 v[64:67], a[144:147], v[200:203], v[64:67]
v_exp_f32 v16, v16
v_mfma_f32_16x16x32_bf16 a[0:3], a[176:179], v[88:91], a[0:3]
ds_read_b128 a[152:155], v218 offset:16384
ds_read_b128 a[148:151], v217 offset:16384
v_mfma_f32_16x16x32_bf16 a[4:7], a[176:179], v[92:95], a[4:7]
v_exp_f32 v17, v17
v_mfma_f32_16x16x32_bf16 a[8:11], a[176:179], v[96:99], a[8:11]
ds_read_b128 a[144:147], v216 offset:16384
v_cvt_pk_bf16_f32 v76, v16, v17
v_mfma_f32_16x16x32_bf16 a[12:15], a[176:179], v[100:103], a[12:15]
v_exp_f32 v18, v18
v_mfma_f32_16x16x32_bf16 a[28:31], a[180:183], v[100:103], a[28:31]
ds_read_b64_tr_b16 a[176:177], v220 offset:0
ds_read_b64_tr_b16 a[178:179], v220 offset:4096
v_mfma_f32_16x16x32_bf16 a[24:27], a[180:183], v[96:99], a[24:27]
v_exp_f32 v19, v19
v_mfma_f32_16x16x32_bf16 a[20:23], a[180:183], v[92:95], a[20:23]
s_add_u32 s32, s32, 16384
v_cvt_pk_bf16_f32 v77, v18, v19
v_mfma_f32_16x16x32_bf16 a[16:19], a[180:183], v[88:91], a[16:19]
v_exp_f32 v20, v20
v_mfma_f32_16x16x32_bf16 a[32:35], a[184:187], v[88:91], a[32:35]
ds_read_b64_tr_b16 a[180:181], v221 offset:0
ds_read_b64_tr_b16 a[182:183], v221 offset:4096
v_mfma_f32_16x16x32_bf16 a[36:39], a[184:187], v[92:95], a[36:39]
v_exp_f32 v21, v21
v_mfma_f32_16x16x32_bf16 a[40:43], a[184:187], v[96:99], a[40:43]
s_bitset0_b32 s32, 19
v_cvt_pk_bf16_f32 v78, v20, v21
v_mfma_f32_16x16x32_bf16 a[44:47], a[184:187], v[100:103], a[44:47]
v_exp_f32 v22, v22
v_mfma_f32_16x16x32_bf16 a[60:63], a[188:191], v[100:103], a[60:63]
ds_read_b64_tr_b16 a[184:185], v222 offset:0
ds_read_b64_tr_b16 a[186:187], v222 offset:4096
v_mfma_f32_16x16x32_bf16 a[56:59], a[188:191], v[96:99], a[56:59]
v_exp_f32 v23, v23
v_mfma_f32_16x16x32_bf16 a[52:55], a[188:191], v[92:95], a[52:55]
s_add_u32 m0, s30, 65536
v_cvt_pk_bf16_f32 v79, v22, v23
v_mfma_f32_16x16x32_bf16 a[48:51], a[188:191], v[88:91], a[48:51]
v_exp_f32 v24, v24
v_smfmac_f32_16x16x64_bf16 a[128:131], a[208:211], v[88:95], v245
ds_read_b64_tr_b16 a[188:189], v223 offset:0
v_mfma_f32_16x16x32_bf16 v[44:47], a[160:163], v[152:155], v[136:139]
v_exp_f32 v25, v25
v_mfma_f32_16x16x32_bf16 v[44:47], a[164:167], v[156:159], v[44:47]
v_exp_f32 v26, v26
v_mfma_f32_16x16x32_bf16 v[44:47], a[168:171], v[160:163], v[44:47]
ds_read_b64_tr_b16 a[190:191], v223 offset:4096
v_cvt_pk_bf16_f32 v80, v24, v25
v_mfma_f32_16x16x32_bf16 v[44:47], a[172:175], v[164:167], v[44:47]
v_exp_f32 v27, v27
v_mfma_f32_16x16x32_bf16 v[52:55], a[172:175], v[180:183], v[140:143]
v_cvt_pk_bf16_f32 v81, v26, v27
v_add_u32 v237, s31, v244
v_mfma_f32_16x16x32_bf16 v[52:55], a[168:171], v[176:179], v[52:55]
v_exp_f32 v28, v28
v_mfma_f32_16x16x32_bf16 v[52:55], a[164:167], v[172:175], v[52:55]
buffer_load_dwordx4 v228, s[8:11], s32 offen offset:0  lds
v_mfma_f32_16x16x32_bf16 v[52:55], a[160:163], v[168:171], v[52:55]
v_exp_f32 v29, v29
v_mfma_f32_16x16x32_bf16 v[60:63], a[160:163], v[184:187], v[144:147]
v_cvt_pk_bf16_f32 v82, v28, v29
v_lshl_add_u32 v238, v4, 3, v3
v_mfma_f32_16x16x32_bf16 v[60:63], a[164:167], v[188:191], v[60:63]
v_exp_f32 v30, v30
v_mfma_f32_16x16x32_bf16 v[60:63], a[168:171], v[192:195], v[60:63]
buffer_load_dwordx4 v229, s[8:11], s32 offen offset:1024  lds
v_mfma_f32_16x16x32_bf16 v[60:63], a[172:175], v[196:199], v[60:63]
v_exp_f32 v31, v31
v_mfma_f32_16x16x32_bf16 v[68:71], a[172:175], v[212:215], v[148:151]
ds_read_b128 a[172:175], v219 offset:20480
v_cvt_pk_bf16_f32 v83, v30, v31
v_mfma_f32_16x16x32_bf16 v[68:71], a[168:171], v[208:211], v[68:71]
v_exp_f32 v32, v32
v_mfma_f32_16x16x32_bf16 v[68:71], a[164:167], v[204:207], v[68:71]
ds_read_b128 a[168:171], v218 offset:20480
ds_read_b128 a[164:167], v217 offset:20480
v_mfma_f32_16x16x32_bf16 v[68:71], a[160:163], v[200:203], v[68:71]
v_exp_f32 v33, v33
v_mfma_f32_16x16x32_bf16 a[64:67], a[192:195], v[88:91], a[64:67]
ds_read_b128 a[160:163], v216 offset:20480
v_cvt_pk_bf16_f32 v84, v32, v33
v_mfma_f32_16x16x32_bf16 a[68:71], a[192:195], v[92:95], a[68:71]
v_exp_f32 v34, v34
v_mfma_f32_16x16x32_bf16 a[72:75], a[192:195], v[96:99], a[72:75]
buffer_load_dwordx4 v230, s[8:11], s32 offen offset:2048  lds
v_mfma_f32_16x16x32_bf16 a[76:79], a[192:195], v[100:103], a[76:79]
v_exp_f32 v35, v35
v_mfma_f32_16x16x32_bf16 a[92:95], a[196:199], v[100:103], a[92:95]
ds_read_b64_tr_b16 a[192:193], v224 offset:0
v_cvt_pk_bf16_f32 v85, v34, v35
v_mfma_f32_16x16x32_bf16 a[88:91], a[196:199], v[96:99], a[88:91]
v_exp_f32 v36, v36
v_mfma_f32_16x16x32_bf16 a[84:87], a[196:199], v[92:95], a[84:87]
ds_read_b64_tr_b16 a[194:195], v224 offset:4096
v_lshlrev_b32 v238, 4, v238
v_mfma_f32_16x16x32_bf16 a[80:83], a[196:199], v[88:91], a[80:83]
v_exp_f32 v37, v37
v_mfma_f32_16x16x32_bf16 a[96:99], a[200:203], v[88:91], a[96:99]
ds_read_b64_tr_b16 a[196:197], v225 offset:0
v_cvt_pk_bf16_f32 v86, v36, v37
v_mfma_f32_16x16x32_bf16 a[100:103], a[200:203], v[92:95], a[100:103]
v_exp_f32 v38, v38
v_mfma_f32_16x16x32_bf16 a[104:107], a[200:203], v[96:99], a[104:107]
ds_read_b64_tr_b16 a[198:199], v225 offset:4096
v_mov_b32 v246, 0x7ffffff0
v_mfma_f32_16x16x32_bf16 a[108:111], a[200:203], v[100:103], a[108:111]
v_exp_f32 v39, v39
v_mfma_f32_16x16x32_bf16 a[124:127], a[204:207], v[100:103], a[124:127]
ds_read_b64_tr_b16 a[200:201], v226 offset:0
v_cvt_pk_bf16_f32 v87, v38, v39
v_mfma_f32_16x16x32_bf16 a[120:123], a[204:207], v[96:99], a[120:123]
ds_read_b64_tr_b16 a[202:203], v226 offset:4096
v_cmp_lt_u32 vcc, 7, v3
v_mfma_f32_16x16x32_bf16 a[116:119], a[204:207], v[92:95], a[116:119]
buffer_load_dwordx4 v231, s[8:11], s32 offen offset:3072  lds
v_mfma_f32_16x16x32_bf16 a[112:115], a[204:207], v[88:91], a[112:115]
ds_read_b64_tr_b16 a[204:205], v227 offset:0
ds_read_b64_tr_b16 a[206:207], v227 offset:4096
v_smfmac_f32_16x16x64_bf16 a[132:135], a[208:211], v[96:103], v245
s_add_u32 m0, s86, 20480
s_add_u32 s50, s85, 12288
buffer_load_dwordx4 v244, s[72:75], s50 offen lds
s_add_u32 m0, s86, 24576
s_add_u32 s50, s85, 16384
buffer_load_dwordx4 v244, s[72:75], s50 offen lds
s_add_u32 m0, s86, 28672
s_add_u32 s50, s85, 20480
buffer_load_dwordx4 v244, s[72:75], s50 offen lds
s_waitcnt lgkmcnt(8)
STUB_8:
s_cbranch_execz HOP_RET1
v_mfma_f32_16x16x32_bf16 v[8:11], a[144:147], v[152:155], v[136:139]
v_exp_f32 v40, v40
v_mfma_f32_16x16x32_bf16 v[8:11], a[148:151], v[156:159], v[8:11]
v_exp_f32 v41, v41
v_mfma_f32_16x16x32_bf16 v[8:11], a[152:155], v[160:163], v[8:11]
v_cvt_pk_bf16_f32 v88, v40, v41
v_cndmask_b32 v238, v238, v246, vcc
v_mfma_f32_16x16x32_bf16 v[8:11], a[156:159], v[164:167], v[8:11]
v_exp_f32 v42, v42
v_mfma_f32_16x16x32_bf16 v[16:19], a[156:159], v[180:183], v[140:143]
s_add_u32 s39, s39, 16384
s_mul_i32 s28, s2, 18432
v_mfma_f32_16x16x32_bf16 v[16:19], a[152:155], v[176:179], v[16:19]
v_exp_f32 v43, v43
v_mfma_f32_16x16x32_bf16 v[16:19], a[148:151], v[172:175], v[16:19]
s_mul_i32 s29, s37, 4608
v_cvt_pk_bf16_f32 v89, v42, v43
v_mfma_f32_16x16x32_bf16 v[16:19], a[144:147], v[168:171], v[16:19]
v_exp_f32 v44, v44
v_mfma_f32_16x16x32_bf16 v[24:27], a[144:147], v[184:187], v[144:147]
s_bitset0_b32 s39, 19
s_add_u32 s28, s28, s29
v_mfma_f32_16x16x32_bf16 v[24:27], a[148:151], v[188:191], v[24:27]
v_exp_f32 v45, v45
v_mfma_f32_16x16x32_bf16 v[24:27], a[152:155], v[192:195], v[24:27]
s_add_u32 s28, s28, 0x2000000
v_cvt_pk_bf16_f32 v90, v44, v45
v_mfma_f32_16x16x32_bf16 v[24:27], a[156:159], v[196:199], v[24:27]
v_exp_f32 v46, v46
v_mfma_f32_16x16x32_bf16 v[32:35], a[156:159], v[212:215], v[148:151]
ds_read_b128 a[156:159], v219 offset:24576
v_mfma_f32_16x16x32_bf16 v[32:35], a[152:155], v[208:211], v[32:35]
v_exp_f32 v47, v47
v_mfma_f32_16x16x32_bf16 v[32:35], a[148:151], v[204:207], v[32:35]
ds_read_b128 a[152:155], v218 offset:24576
v_cvt_pk_bf16_f32 v91, v46, v47
v_mfma_f32_16x16x32_bf16 v[32:35], a[144:147], v[200:203], v[32:35]
v_exp_f32 v48, v48
v_mfma_f32_16x16x32_bf16 a[0:3], a[176:179], v[72:75], a[0:3]
ds_read_b128 a[148:151], v217 offset:24576
ds_read_b128 a[144:147], v216 offset:24576
v_mfma_f32_16x16x32_bf16 a[4:7], a[176:179], v[76:79], a[4:7]
v_exp_f32 v49, v49
v_mfma_f32_16x16x32_bf16 a[8:11], a[176:179], v[80:83], a[8:11]
s_add_u32 m0, s30, 147456
v_cvt_pk_bf16_f32 v92, v48, v49
v_mfma_f32_16x16x32_bf16 a[12:15], a[176:179], v[84:87], a[12:15]
v_exp_f32 v50, v50
v_mfma_f32_16x16x32_bf16 a[28:31], a[180:183], v[84:87], a[28:31]
ds_read_b64_tr_b16 a[176:177], v220 offset:8192
ds_read_b64_tr_b16 a[178:179], v220 offset:12288
v_mfma_f32_16x16x32_bf16 a[24:27], a[180:183], v[80:83], a[24:27]
v_exp_f32 v51, v51
v_mfma_f32_16x16x32_bf16 a[20:23], a[180:183], v[76:79], a[20:23]
v_cvt_pk_bf16_f32 v93, v50, v51
v_mfma_f32_16x16x32_bf16 a[16:19], a[180:183], v[72:75], a[16:19]
v_exp_f32 v52, v52
v_mfma_f32_16x16x32_bf16 a[32:35], a[184:187], v[72:75], a[32:35]
ds_read_b64_tr_b16 a[180:181], v221 offset:8192
ds_read_b64_tr_b16 a[182:183], v221 offset:12288
v_mfma_f32_16x16x32_bf16 a[36:39], a[184:187], v[76:79], a[36:39]
v_exp_f32 v53, v53
v_mfma_f32_16x16x32_bf16 a[40:43], a[184:187], v[80:83], a[40:43]
v_cvt_pk_bf16_f32 v94, v52, v53
v_mfma_f32_16x16x32_bf16 a[44:47], a[184:187], v[84:87], a[44:47]
v_exp_f32 v54, v54
v_mfma_f32_16x16x32_bf16 a[60:63], a[188:191], v[84:87], a[60:63]
ds_read_b64_tr_b16 a[184:185], v222 offset:8192
ds_read_b64_tr_b16 a[186:187], v222 offset:12288
v_mfma_f32_16x16x32_bf16 a[56:59], a[188:191], v[80:83], a[56:59]
v_exp_f32 v55, v55
v_mfma_f32_16x16x32_bf16 a[52:55], a[188:191], v[76:79], a[52:55]
v_cvt_pk_bf16_f32 v95, v54, v55
v_mfma_f32_16x16x32_bf16 a[48:51], a[188:191], v[72:75], a[48:51]
v_exp_f32 v56, v56
v_smfmac_f32_16x16x64_bf16 a[128:131], a[208:211], v[72:79], v245
ds_read_b64_tr_b16 a[188:189], v223 offset:8192
v_mfma_f32_16x16x32_bf16 v[12:15], a[160:163], v[152:155], v[136:139]
v_exp_f32 v57, v57
v_mfma_f32_16x16x32_bf16 v[12:15], a[164:167], v[156:159], v[12:15]
v_exp_f32 v58, v58
v_mfma_f32_16x16x32_bf16 v[12:15], a[168:171], v[160:163], v[12:15]
ds_read_b64_tr_b16 a[190:191], v223 offset:12288
v_cvt_pk_bf16_f32 v96, v56, v57
v_mfma_f32_16x16x32_bf16 v[12:15], a[172:175], v[164:167], v[12:15]
v_exp_f32 v59, v59
v_mfma_f32_16x16x32_bf16 v[20:23], a[172:175], v[180:183], v[140:143]
v_cvt_pk_bf16_f32 v97, v58, v59
v_mfma_f32_16x16x32_bf16 v[20:23], a[168:171], v[176:179], v[20:23]
v_exp_f32 v60, v60
v_mfma_f32_16x16x32_bf16 v[20:23], a[164:167], v[172:175], v[20:23]
buffer_load_dwordx4 v232, s[12:15], s39 offen offset:0  lds
v_mfma_f32_16x16x32_bf16 v[20:23], a[160:163], v[168:171], v[20:23]
v_exp_f32 v61, v61
v_mfma_f32_16x16x32_bf16 v[28:31], a[160:163], v[184:187], v[144:147]
v_cvt_pk_bf16_f32 v98, v60, v61
v_mfma_f32_16x16x32_bf16 v[28:31], a[164:167], v[188:191], v[28:31]
v_exp_f32 v62, v62
v_mfma_f32_16x16x32_bf16 v[28:31], a[168:171], v[192:195], v[28:31]
buffer_load_dwordx4 v233, s[12:15], s39 offen offset:1024  lds
v_mfma_f32_16x16x32_bf16 v[28:31], a[172:175], v[196:199], v[28:31]
v_exp_f32 v63, v63
v_mfma_f32_16x16x32_bf16 v[36:39], a[172:175], v[212:215], v[148:151]
ds_read_b128 a[172:175], v219 offset:28672
v_cvt_pk_bf16_f32 v99, v62, v63
v_mfma_f32_16x16x32_bf16 v[36:39], a[168:171], v[208:211], v[36:39]
v_exp_f32 v64, v64
v_mfma_f32_16x16x32_bf16 v[36:39], a[164:167], v[204:207], v[36:39]
ds_read_b128 a[168:171], v218 offset:28672
ds_read_b128 a[164:167], v217 offset:28672
v_mfma_f32_16x16x32_bf16 v[36:39], a[160:163], v[200:203], v[36:39]
v_exp_f32 v65, v65
s_waitcnt lgkmcnt(8)
v_mfma_f32_16x16x32_bf16 a[64:67], a[192:195], v[72:75], a[64:67]
ds_read_b128 a[160:163], v216 offset:28672
v_cvt_pk_bf16_f32 v100, v64, v65
v_mfma_f32_16x16x32_bf16 a[68:71], a[192:195], v[76:79], a[68:71]
v_exp_f32 v66, v66
v_mfma_f32_16x16x32_bf16 a[72:75], a[192:195], v[80:83], a[72:75]
buffer_load_dwordx4 v232, s[12:15], s39 offen offset:2048  lds
v_mfma_f32_16x16x32_bf16 a[76:79], a[192:195], v[84:87], a[76:79]
v_exp_f32 v67, v67
v_mfma_f32_16x16x32_bf16 a[92:95], a[196:199], v[84:87], a[92:95]
ds_read_b64_tr_b16 a[192:193], v224 offset:8192
v_cvt_pk_bf16_f32 v101, v66, v67
v_mfma_f32_16x16x32_bf16 a[88:91], a[196:199], v[80:83], a[88:91]
v_exp_f32 v68, v68
v_mfma_f32_16x16x32_bf16 a[84:87], a[196:199], v[76:79], a[84:87]
ds_read_b64_tr_b16 a[194:195], v224 offset:12288
s_cmp_lt_u32 s37, 2
s_cselect_b64 s[90:91], -1, 0
v_mfma_f32_16x16x32_bf16 a[80:83], a[196:199], v[72:75], a[80:83]
v_exp_f32 v69, v69
v_mfma_f32_16x16x32_bf16 a[96:99], a[200:203], v[72:75], a[96:99]
ds_read_b64_tr_b16 a[196:197], v225 offset:8192
v_cvt_pk_bf16_f32 v102, v68, v69
v_mfma_f32_16x16x32_bf16 a[100:103], a[200:203], v[76:79], a[100:103]
v_exp_f32 v70, v70
v_mfma_f32_16x16x32_bf16 a[104:107], a[200:203], v[80:83], a[104:107]
ds_read_b64_tr_b16 a[198:199], v225 offset:12288
v_mfma_f32_16x16x32_bf16 a[108:111], a[200:203], v[84:87], a[108:111]
v_exp_f32 v71, v71
v_mfma_f32_16x16x32_bf16 a[124:127], a[204:207], v[84:87], a[124:127]
ds_read_b64_tr_b16 a[200:201], v226 offset:8192
v_cvt_pk_bf16_f32 v103, v70, v71
v_mfma_f32_16x16x32_bf16 a[120:123], a[204:207], v[80:83], a[120:123]
ds_read_b64_tr_b16 a[202:203], v226 offset:12288
v_mfma_f32_16x16x32_bf16 a[116:119], a[204:207], v[76:79], a[116:119]
buffer_load_dwordx4 v233, s[12:15], s39 offen offset:3072  lds
v_mfma_f32_16x16x32_bf16 a[112:115], a[204:207], v[72:75], a[112:115]
ds_read_b64_tr_b16 a[204:205], v227 offset:8192
ds_read_b64_tr_b16 a[206:207], v227 offset:12288
v_smfmac_f32_16x16x64_bf16 a[132:135], a[208:211], v[80:87], v245
s_add_u32 m0, s86, 32768
s_add_u32 s50, s85, 24576
buffer_load_dwordx4 v244, s[72:75], s50 offen lds
s_add_u32 m0, s86, 36864
s_add_u32 s50, s85, 28672
buffer_load_dwordx4 v244, s[72:75], s50 offen lds
s_add_u32 m0, s86, 40960
s_add_u32 s50, s85, 32768
buffer_load_dwordx4 v244, s[72:75], s50 offen lds
v_mfma_f32_16x16x32_bf16 v[40:43], a[144:147], v[152:155], v[136:139]
v_exp_f32 v8, v8
v_mfma_f32_16x16x32_bf16 v[40:43], a[148:151], v[156:159], v[40:43]
v_exp_f32 v9, v9
v_mfma_f32_16x16x32_bf16 v[40:43], a[152:155], v[160:163], v[40:43]
v_cvt_pk_bf16_f32 v72, v8, v9
v_mfma_f32_16x16x32_bf16 v[40:43], a[156:159], v[164:167], v[40:43]
v_exp_f32 v10, v10
v_mfma_f32_16x16x32_bf16 v[48:51], a[156:159], v[180:183], v[140:143]
v_mfma_f32_16x16x32_bf16 v[48:51], a[152:155], v[176:179], v[48:51]
v_exp_f32 v11, v11
v_mfma_f32_16x16x32_bf16 v[48:51], a[148:151], v[172:175], v[48:51]
v_cvt_pk_bf16_f32 v73, v10, v11
v_mfma_f32_16x16x32_bf16 v[48:51], a[144:147], v[168:171], v[48:51]
v_exp_f32 v12, v12
v_mfma_f32_16x16x32_bf16 v[56:59], a[144:147], v[184:187], v[144:147]
v_mfma_f32_16x16x32_bf16 v[56:59], a[148:151], v[188:191], v[56:59]
v_exp_f32 v13, v13
v_mfma_f32_16x16x32_bf16 v[56:59], a[152:155], v[192:195], v[56:59]
v_cvt_pk_bf16_f32 v74, v12, v13
v_mfma_f32_16x16x32_bf16 v[56:59], a[156:159], v[196:199], v[56:59]
v_exp_f32 v14, v14
v_mfma_f32_16x16x32_bf16 v[64:67], a[156:159], v[212:215], v[148:151]
s_waitcnt vmcnt(14) lgkmcnt(0)
s_barrier
v_mfma_f32_16x16x32_bf16 v[64:67], a[152:155], v[208:211], v[64:67]
ds_read_b128 v[124:127], v239 offset:45056
v_exp_f32 v15, v15
v_mfma_f32_16x16x32_bf16 v[64:67], a[148:151], v[204:207], v[64:67]
ds_read_b128 a[156:159], v219 offset:49152
ds_read_b128 v[128:131], v239 offset:45568
v_cvt_pk_bf16_f32 v75, v14, v15
v_mfma_f32_16x16x32_bf16 v[64:67], a[144:147], v[200:203], v[64:67]
ds_read_b128 v[248:251], v239 offset:46080
v_exp_f32 v16, v16
v_mfma_f32_16x16x32_bf16 a[0:3], a[176:179], v[88:91], a[0:3]
ds_read_b128 a[152:155], v218 offset:49152
ds_read_b128 a[148:151], v217 offset:49152
ds_read_b128 v[252:255], v239 offset:46592
v_mfma_f32_16x16x32_bf16 a[4:7], a[176:179], v[92:95], a[4:7]
ds_read_b64_tr_b16 v[116:117], v241 offset:0
v_exp_f32 v17, v17
v_mfma_f32_16x16x32_bf16 a[8:11], a[176:179], v[96:99], a[8:11]
ds_read_b128 a[144:147], v216 offset:49152
ds_read_b64_tr_b16 v[118:119], v241 offset:256
v_cvt_pk_bf16_f32 v76, v16, v17
v_mfma_f32_16x16x32_bf16 a[12:15], a[176:179], v[100:103], a[12:15]
ds_read_b64_tr_b16 v[120:121], v241 offset:2048
v_exp_f32 v18, v18
v_mfma_f32_16x16x32_bf16 a[28:31], a[180:183], v[100:103], a[28:31]
ds_read_b64_tr_b16 a[176:177], v220 offset:32768
ds_read_b64_tr_b16 a[178:179], v220 offset:36864
ds_read_b64_tr_b16 v[122:123], v241 offset:2304
v_mfma_f32_16x16x32_bf16 a[24:27], a[180:183], v[96:99], a[24:27]
v_exp_f32 v19, v19
v_mfma_f32_16x16x32_bf16 a[20:23], a[180:183], v[92:95], a[20:23]
s_add_u32 s32, s32, 16384
v_cvt_pk_bf16_f32 v77, v18, v19
v_mfma_f32_16x16x32_bf16 a[16:19], a[180:183], v[88:91], a[16:19]
v_exp_f32 v20, v20
v_mfma_f32_16x16x32_bf16 a[32:35], a[184:187], v[88:91], a[32:35]
ds_read_b64_tr_b16 a[180:181], v221 offset:32768
ds_read_b64_tr_b16 a[182:183], v221 offset:36864
v_mfma_f32_16x16x32_bf16 a[36:39], a[184:187], v[92:95], a[36:39]
v_exp_f32 v21, v21
v_mfma_f32_16x16x32_bf16 a[40:43], a[184:187], v[96:99], a[40:43]
s_bitset0_b32 s32, 19
v_cvt_pk_bf16_f32 v78, v20, v21
s_waitcnt lgkmcnt(8)
v_mfma_f32_16x16x32_bf16 v[132:135], a[212:215], v[124:127], 0
ds_read_b128 v[124:127], v239 offset:47104
v_mfma_f32_16x16x32_bf16 a[44:47], a[184:187], v[100:103], a[44:47]
v_exp_f32 v22, v22
v_mfma_f32_16x16x32_bf16 a[60:63], a[188:191], v[100:103], a[60:63]
ds_read_b64_tr_b16 a[184:185], v222 offset:32768
ds_read_b64_tr_b16 a[186:187], v222 offset:36864
v_mfma_f32_16x16x32_bf16 v[132:135], a[216:219], v[128:131], v[132:135]
s_add_u32 m0, s30, 81920
ds_read_b128 v[128:131], v239 offset:47616
v_mfma_f32_16x16x32_bf16 a[56:59], a[188:191], v[96:99], a[56:59]
v_exp_f32 v23, v23
v_mfma_f32_16x16x32_bf16 a[52:55], a[188:191], v[92:95], a[52:55]
v_cvt_pk_bf16_f32 v79, v22, v23
v_mfma_f32_16x16x32_bf16 v[132:135], a[220:223], v[248:251], v[132:135]
ds_read_b128 v[248:251], v239 offset:48128
v_mfma_f32_16x16x32_bf16 a[48:51], a[188:191], v[88:91], a[48:51]
v_exp_f32 v24, v24
v_smfmac_f32_16x16x64_bf16 a[128:131], a[208:211], v[88:95], v245
ds_read_b64_tr_b16 a[188:189], v223 offset:32768
v_mfma_f32_16x16x32_bf16 v[132:135], a[224:227], v[252:255], v[132:135]
ds_read_b64_tr_b16 a[190:191], v223 offset:36864
ds_read_b128 v[252:255], v239 offset:48640
v_mfma_f32_16x16x32_bf16 v[44:47], a[160:163], v[152:155], v[136:139]
v_exp_f32 v25, v25
v_mfma_f32_16x16x32_bf16 v[44:47], a[164:167], v[156:159], v[44:47]
v_exp_f32 v26, v26
s_waitcnt lgkmcnt(7)
v_mfma_f32_16x16x32_bf16 v[132:135], a[228:231], v[124:127], v[132:135]
ds_read_b128 v[124:127], v239 offset:49152
v_cvt_pk_bf16_f32 v80, v24, v25
v_mfma_f32_16x16x32_bf16 v[44:47], a[168:171], v[160:163], v[44:47]
buffer_load_dwordx4 v228, s[8:11], s32 offen offset:0  lds
v_mfma_f32_16x16x32_bf16 v[44:47], a[172:175], v[164:167], v[44:47]
v_exp_f32 v27, v27
s_waitcnt lgkmcnt(5)
v_mfma_f32_16x16x32_bf16 v[132:135], a[232:235], v[128:131], v[132:135]
ds_read_b128 v[128:131], v239 offset:49664
v_mfma_f32_16x16x32_bf16 v[52:55], a[172:175], v[180:183], v[140:143]
v_cvt_pk_bf16_f32 v81, v26, v27
v_mfma_f32_16x16x32_bf16 v[52:55], a[168:171], v[176:179], v[52:55]
v_exp_f32 v28, v28
s_waitcnt lgkmcnt(5)
v_mfma_f32_16x16x32_bf16 v[132:135], a[236:239], v[248:251], v[132:135]
ds_read_b128 v[248:251], v239 offset:50176
v_mfma_f32_16x16x32_bf16 v[52:55], a[164:167], v[172:175], v[52:55]
v_mfma_f32_16x16x32_bf16 v[52:55], a[160:163], v[168:171], v[52:55]
v_exp_f32 v29, v29
s_waitcnt lgkmcnt(3)
v_mfma_f32_16x16x32_bf16 v[132:135], a[240:243], v[252:255], v[132:135]
buffer_load_dwordx4 v229, s[8:11], s32 offen offset:1024  lds
ds_read_b128 v[252:255], v239 offset:50688
v_mfma_f32_16x16x32_bf16 v[60:63], a[160:163], v[184:187], v[144:147]
v_cvt_pk_bf16_f32 v82, v28, v29
v_mfma_f32_16x16x32_bf16 v[60:63], a[164:167], v[188:191], v[60:63]
v_exp_f32 v30, v30
s_waitcnt lgkmcnt(3)
v_mfma_f32_16x16x32_bf16 v[132:135], a[244:247], v[124:127], v[132:135]
ds_read_b128 v[124:127], v239 offset:51200
v_mfma_f32_16x16x32_bf16 v[60:63], a[168:171], v[192:195], v[60:63]
v_mfma_f32_16x16x32_bf16 v[60:63], a[172:175], v[196:199], v[60:63]
v_exp_f32 v31, v31
s_waitcnt lgkmcnt(3)
v_mfma_f32_16x16x32_bf16 v[132:135], a[248:251], v[128:131], v[132:135]
ds_read_b128 v[128:131], v239 offset:51712
v_mfma_f32_16x16x32_bf16 v[68:71], a[172:175], v[212:215], v[148:151]
ds_read_b128 a[172:175], v219 offset:53248
v_cvt_pk_bf16_f32 v83, v30, v31
v_mfma_f32_16x16x32_bf16 v[68:71], a[168:171], v[208:211], v[68:71]
v_exp_f32 v32, v32
s_waitcnt lgkmcnt(4)
v_mfma_f32_16x16x32_bf16 v[132:135], a[252:255], v[248:251], v[132:135]
ds_read_b128 a[168:171], v218 offset:53248
ds_read_b128 v[248:251], v239 offset:52224
v_mfma_f32_16x16x32_bf16 v[68:71], a[164:167], v[204:207], v[68:71]
ds_read_b128 a[164:167], v217 offset:53248
v_mfma_f32_16x16x32_bf16 v[68:71], a[160:163], v[200:203], v[68:71]
v_exp_f32 v33, v33
s_waitcnt lgkmcnt(6)
v_mfma_f32_16x16x32_bf16 v[132:135], a[136:139], v[252:255], v[132:135]
ds_read_b128 a[160:163], v216 offset:53248
ds_read_b128 v[252:255], v239 offset:52736
v_mfma_f32_16x16x32_bf16 a[64:67], a[192:195], v[88:91], a[64:67]
v_cvt_pk_bf16_f32 v84, v32, v33
v_mfma_f32_16x16x32_bf16 a[68:71], a[192:195], v[92:95], a[68:71]
v_exp_f32 v34, v34
s_waitcnt lgkmcnt(7)
v_mfma_f32_16x16x32_bf16 v[132:135], a[140:143], v[124:127], v[132:135]
buffer_load_dwordx4 v230, s[8:11], s32 offen offset:2048  lds
ds_read_b128 v[124:127], v239 offset:53248
v_mfma_f32_16x16x32_bf16 a[72:75], a[192:195], v[96:99], a[72:75]
v_mfma_f32_16x16x32_bf16 a[76:79], a[192:195], v[100:103], a[76:79]
v_exp_f32 v35, v35
s_waitcnt lgkmcnt(7)
v_mfma_f32_16x16x32_bf16 v[132:135], v[104:107], v[128:131], v[132:135]
ds_read_b64_tr_b16 a[192:193], v224 offset:32768
ds_read_b64_tr_b16 a[194:195], v224 offset:36864
ds_read_b128 v[128:131], v239 offset:53760
v_mfma_f32_16x16x32_bf16 a[92:95], a[196:199], v[100:103], a[92:95]
v_cvt_pk_bf16_f32 v85, v34, v35
v_mfma_f32_16x16x32_bf16 a[88:91], a[196:199], v[96:99], a[88:91]
v_exp_f32 v36, v36
s_waitcnt lgkmcnt(7)
v_mfma_f32_16x16x32_bf16 v[132:135], v[108:111], v[248:251], v[132:135]
buffer_load_dwordx4 v231, s[8:11], s32 offen offset:3072  lds
v_mfma_f32_16x16x32_bf16 a[84:87], a[196:199], v[92:95], a[84:87]
v_mfma_f32_16x16x32_bf16 a[80:83], a[196:199], v[88:91], a[80:83]
v_exp_f32 v37, v37
s_waitcnt lgkmcnt(4)
v_mfma_f32_16x16x32_bf16 v[132:135], v[112:115], v[252:255], v[132:135]
ds_read_b64_tr_b16 a[196:197], v225 offset:32768
ds_read_b64_tr_b16 a[198:199], v225 offset:36864
v_mfma_f32_16x16x32_bf16 a[96:99], a[200:203], v[88:91], a[96:99]
v_cvt_pk_bf16_f32 v86, v36, v37
v_mfma_f32_16x16x32_bf16 a[100:103], a[200:203], v[92:95], a[100:103]
v_exp_f32 v38, v38
s_waitcnt lgkmcnt(5)
v_mfma_f32_16x16x32_bf16 v[132:135], v[116:119], v[124:127], v[132:135]
v_mfma_f32_16x16x32_bf16 a[104:107], a[200:203], v[96:99], a[104:107]
v_mfma_f32_16x16x32_bf16 a[108:111], a[200:203], v[100:103], a[108:111]
v_exp_f32 v39, v39
s_waitcnt lgkmcnt(2)
v_mfma_f32_16x16x32_bf16 v[132:135], v[120:123], v[128:131], v[132:135]
ds_read_b64_tr_b16 a[200:201], v226 offset:32768
ds_read_b64_tr_b16 a[202:203], v226 offset:36864
v_mfma_f32_16x16x32_bf16 a[124:127], a[204:207], v[100:103], a[124:127]
v_cvt_pk_bf16_f32 v87, v38, v39
v_mfma_f32_16x16x32_bf16 a[120:123], a[204:207], v[96:99], a[120:123]
v_mfma_f32_16x16x32_bf16 a[116:119], a[204:207], v[92:95], a[116:119]
v_mfma_f32_16x16x32_bf16 a[112:115], a[204:207], v[88:91], a[112:115]
ds_read_b64_tr_b16 a[204:205], v227 offset:32768
ds_read_b64_tr_b16 a[206:207], v227 offset:36864
v_smfmac_f32_16x16x64_bf16 a[132:135], a[208:211], v[96:103], v245
v_mfma_f32_16x16x32_bf16 v[8:11], a[144:147], v[152:155], v[136:139]
v_exp_f32 v40, v40
v_mfma_f32_16x16x32_bf16 v[8:11], a[148:151], v[156:159], v[8:11]
v_exp_f32 v41, v41
v_mfma_f32_16x16x32_bf16 v[8:11], a[152:155], v[160:163], v[8:11]
v_cvt_pk_bf16_f32 v88, v40, v41
v_cvt_pk_bf16_f32 v104, v132, v133
v_cvt_pk_bf16_f32 v105, v134, v135
v_mfma_f32_16x16x32_bf16 v[8:11], a[156:159], v[164:167], v[8:11]
v_lshlrev_b32 v132, 16, v104
v_exp_f32 v42, v42
v_mfma_f32_16x16x32_bf16 v[16:19], a[156:159], v[180:183], v[140:143]
s_add_u32 s39, s39, 16384
v_and_b32 v133, 0xffff0000, v104
v_lshlrev_b32 v134, 16, v105
v_mfma_f32_16x16x32_bf16 v[16:19], a[152:155], v[176:179], v[16:19]
v_and_b32 v135, 0xffff0000, v105
v_exp_f32 v43, v43
v_mfma_f32_16x16x32_bf16 v[16:19], a[148:151], v[172:175], v[16:19]
v_cvt_pk_bf16_f32 v89, v42, v43
v_mul_f32 v104, 0xbfb8aa3b, v132
v_mul_f32 v105, 0xbfb8aa3b, v133
v_mfma_f32_16x16x32_bf16 v[16:19], a[144:147], v[168:171], v[16:19]
v_mul_f32 v106, 0xbfb8aa3b, v134
v_exp_f32 v44, v44
v_mfma_f32_16x16x32_bf16 v[24:27], a[144:147], v[184:187], v[144:147]
v_mul_f32 v107, 0xbfb8aa3b, v135
v_exp_f32 v104, v104
v_mfma_f32_16x16x32_bf16 v[24:27], a[148:151], v[188:191], v[24:27]
v_exp_f32 v45, v45
v_mfma_f32_16x16x32_bf16 v[24:27], a[152:155], v[192:195], v[24:27]
v_cvt_pk_bf16_f32 v90, v44, v45
v_exp_f32 v105, v105
v_mfma_f32_16x16x32_bf16 v[24:27], a[156:159], v[196:199], v[24:27]
v_exp_f32 v46, v46
v_mfma_f32_16x16x32_bf16 v[32:35], a[156:159], v[212:215], v[148:151]
ds_read_b128 a[156:159], v219 offset:57344
s_bitset0_b32 s39, 19
v_mfma_f32_16x16x32_bf16 v[32:35], a[152:155], v[208:211], v[32:35]
v_exp_f32 v47, v47
v_mfma_f32_16x16x32_bf16 v[32:35], a[148:151], v[204:207], v[32:35]
ds_read_b128 a[152:155], v218 offset:57344
v_cvt_pk_bf16_f32 v91, v46, v47
v_mfma_f32_16x16x32_bf16 v[32:35], a[144:147], v[200:203], v[32:35]
v_exp_f32 v48, v48
v_mfma_f32_16x16x32_bf16 a[0:3], a[176:179], v[72:75], a[0:3]
ds_read_b128 a[148:151], v217 offset:57344
ds_read_b128 a[144:147], v216 offset:57344
v_mfma_f32_16x16x32_bf16 a[4:7], a[176:179], v[76:79], a[4:7]
v_exp_f32 v49, v49
v_mfma_f32_16x16x32_bf16 a[8:11], a[176:179], v[80:83], a[8:11]
v_cvt_pk_bf16_f32 v92, v48, v49
v_exp_f32 v106, v106
v_mfma_f32_16x16x32_bf16 a[12:15], a[176:179], v[84:87], a[12:15]
v_exp_f32 v50, v50
v_mfma_f32_16x16x32_bf16 a[28:31], a[180:183], v[84:87], a[28:31]
ds_read_b64_tr_b16 a[176:177], v220 offset:40960
ds_read_b64_tr_b16 a[178:179], v220 offset:45056
v_mfma_f32_16x16x32_bf16 a[24:27], a[180:183], v[80:83], a[24:27]
v_exp_f32 v51, v51
v_mfma_f32_16x16x32_bf16 a[20:23], a[180:183], v[76:79], a[20:23]
s_add_u32 m0, s30, 98304
v_cvt_pk_bf16_f32 v93, v50, v51
v_mfma_f32_16x16x32_bf16 a[16:19], a[180:183], v[72:75], a[16:19]
v_exp_f32 v52, v52
v_mfma_f32_16x16x32_bf16 a[32:35], a[184:187], v[72:75], a[32:35]
ds_read_b64_tr_b16 a[180:181], v221 offset:40960
ds_read_b64_tr_b16 a[182:183], v221 offset:45056
v_mfma_f32_16x16x32_bf16 a[36:39], a[184:187], v[76:79], a[36:39]
v_exp_f32 v53, v53
v_mfma_f32_16x16x32_bf16 a[40:43], a[184:187], v[80:83], a[40:43]
v_cvt_pk_bf16_f32 v94, v52, v53
v_exp_f32 v107, v107
v_mfma_f32_16x16x32_bf16 a[44:47], a[184:187], v[84:87], a[44:47]
v_add_f32 v104, 1.0, v104
v_exp_f32 v54, v54
v_mfma_f32_16x16x32_bf16 a[60:63], a[188:191], v[84:87], a[60:63]
ds_read_b64_tr_b16 a[184:185], v222 offset:40960
ds_read_b64_tr_b16 a[186:187], v222 offset:45056
v_add_f32 v105, 1.0, v105
v_mfma_f32_16x16x32_bf16 a[56:59], a[188:191], v[80:83], a[56:59]
v_add_f32 v106, 1.0, v106
v_exp_f32 v55, v55
v_mfma_f32_16x16x32_bf16 a[52:55], a[188:191], v[76:79], a[52:55]
v_cvt_pk_bf16_f32 v95, v54, v55
v_add_f32 v107, 1.0, v107
v_mfma_f32_16x16x32_bf16 a[48:51], a[188:191], v[72:75], a[48:51]
v_exp_f32 v56, v56
v_smfmac_f32_16x16x64_bf16 a[128:131], a[208:211], v[72:79], v245
ds_read_b64_tr_b16 a[188:189], v223 offset:40960
v_mfma_f32_16x16x32_bf16 v[12:15], a[160:163], v[152:155], v[136:139]
v_exp_f32 v57, v57
v_mfma_f32_16x16x32_bf16 v[12:15], a[164:167], v[156:159], v[12:15]
v_exp_f32 v58, v58
v_mfma_f32_16x16x32_bf16 v[12:15], a[168:171], v[160:163], v[12:15]
ds_read_b64_tr_b16 a[190:191], v223 offset:45056
v_cvt_pk_bf16_f32 v96, v56, v57
v_mfma_f32_16x16x32_bf16 v[12:15], a[172:175], v[164:167], v[12:15]
v_exp_f32 v59, v59
v_mfma_f32_16x16x32_bf16 v[20:23], a[172:175], v[180:183], v[140:143]
v_cvt_pk_bf16_f32 v97, v58, v59
v_rcp_f32 v104, v104
v_mfma_f32_16x16x32_bf16 v[20:23], a[168:171], v[176:179], v[20:23]
v_exp_f32 v60, v60
v_mfma_f32_16x16x32_bf16 v[20:23], a[164:167], v[172:175], v[20:23]
buffer_load_dwordx4 v232, s[12:15], s39 offen offset:0  lds
v_mfma_f32_16x16x32_bf16 v[20:23], a[160:163], v[168:171], v[20:23]
v_exp_f32 v61, v61
v_mfma_f32_16x16x32_bf16 v[28:31], a[160:163], v[184:187], v[144:147]
v_cvt_pk_bf16_f32 v98, v60, v61
v_rcp_f32 v105, v105
v_mfma_f32_16x16x32_bf16 v[28:31], a[164:167], v[188:191], v[28:31]
v_exp_f32 v62, v62
v_mfma_f32_16x16x32_bf16 v[28:31], a[168:171], v[192:195], v[28:31]
buffer_load_dwordx4 v233, s[12:15], s39 offen offset:1024  lds
v_mfma_f32_16x16x32_bf16 v[28:31], a[172:175], v[196:199], v[28:31]
v_exp_f32 v63, v63
v_mfma_f32_16x16x32_bf16 v[36:39], a[172:175], v[212:215], v[148:151]
ds_read_b128 a[172:175], v219 offset:61440
v_cvt_pk_bf16_f32 v99, v62, v63
v_mfma_f32_16x16x32_bf16 v[36:39], a[168:171], v[208:211], v[36:39]
v_exp_f32 v64, v64
v_mfma_f32_16x16x32_bf16 v[36:39], a[164:167], v[204:207], v[36:39]
ds_read_b128 a[168:171], v218 offset:61440
ds_read_b128 a[164:167], v217 offset:61440
v_mfma_f32_16x16x32_bf16 v[36:39], a[160:163], v[200:203], v[36:39]
v_exp_f32 v65, v65
v_mfma_f32_16x16x32_bf16 a[64:67], a[192:195], v[72:75], a[64:67]
ds_read_b128 a[160:163], v216 offset:61440
v_cvt_pk_bf16_f32 v100, v64, v65
v_mfma_f32_16x16x32_bf16 a[68:71], a[192:195], v[76:79], a[68:71]
v_exp_f32 v66, v66
v_mfma_f32_16x16x32_bf16 a[72:75], a[192:195], v[80:83], a[72:75]
buffer_load_dwordx4 v232, s[12:15], s39 offen offset:2048  lds
v_mfma_f32_16x16x32_bf16 a[76:79], a[192:195], v[84:87], a[76:79]
v_exp_f32 v67, v67
s_waitcnt lgkmcnt(8)
v_mfma_f32_16x16x32_bf16 a[92:95], a[196:199], v[84:87], a[92:95]
ds_read_b64_tr_b16 a[192:193], v224 offset:40960
v_cvt_pk_bf16_f32 v101, v66, v67
v_mfma_f32_16x16x32_bf16 a[88:91], a[196:199], v[80:83], a[88:91]
v_exp_f32 v68, v68
v_mfma_f32_16x16x32_bf16 a[84:87], a[196:199], v[76:79], a[84:87]
ds_read_b64_tr_b16 a[194:195], v224 offset:45056
v_rcp_f32 v106, v106
v_mfma_f32_16x16x32_bf16 a[80:83], a[196:199], v[72:75], a[80:83]
v_exp_f32 v69, v69
v_mfma_f32_16x16x32_bf16 a[96:99], a[200:203], v[72:75], a[96:99]
ds_read_b64_tr_b16 a[196:197], v225 offset:40960
v_cvt_pk_bf16_f32 v102, v68, v69
v_mfma_f32_16x16x32_bf16 a[100:103], a[200:203], v[76:79], a[100:103]
v_exp_f32 v70, v70
v_mfma_f32_16x16x32_bf16 a[104:107], a[200:203], v[80:83], a[104:107]
ds_read_b64_tr_b16 a[198:199], v225 offset:45056
v_rcp_f32 v107, v107
v_mfma_f32_16x16x32_bf16 a[108:111], a[200:203], v[84:87], a[108:111]
v_mul_f32 v104, v132, v104
v_exp_f32 v71, v71
v_mfma_f32_16x16x32_bf16 a[124:127], a[204:207], v[84:87], a[124:127]
ds_read_b64_tr_b16 a[200:201], v226 offset:40960
v_cvt_pk_bf16_f32 v103, v70, v71
v_mul_f32 v105, v133, v105
v_mfma_f32_16x16x32_bf16 a[120:123], a[204:207], v[80:83], a[120:123]
ds_read_b64_tr_b16 a[202:203], v226 offset:45056
v_mul_f32 v106, v134, v106
v_mul_f32 v107, v135, v107
v_mfma_f32_16x16x32_bf16 a[116:119], a[204:207], v[76:79], a[116:119]
buffer_load_dwordx4 v233, s[12:15], s39 offen offset:3072  lds
v_cvt_pk_bf16_f32 v108, v104, v105
v_mfma_f32_16x16x32_bf16 a[112:115], a[204:207], v[72:75], a[112:115]
ds_read_b64_tr_b16 a[204:205], v227 offset:40960
ds_read_b64_tr_b16 a[206:207], v227 offset:45056
v_cvt_pk_bf16_f32 v109, v106, v107
v_smfmac_f32_16x16x64_bf16 a[132:135], a[208:211], v[80:87], v245
v_lshlrev_b32 v104, 16, v108
v_and_b32 v105, 0xffff0000, v108
v_lshlrev_b32 v106, 16, v109
v_and_b32 v107, 0xffff0000, v109
v_cndmask_b32 v132, v132, v104, s[90:91]
v_cndmask_b32 v133, v133, v105, s[90:91]
v_cndmask_b32 v134, v134, v106, s[90:91]
v_cndmask_b32 v135, v135, v107, s[90:91]
ds_write_b128 v237, v[132:135] offset:54272
v_mfma_f32_16x16x32_bf16 v[40:43], a[144:147], v[152:155], v[136:139]
v_exp_f32 v8, v8
v_mfma_f32_16x16x32_bf16 v[40:43], a[148:151], v[156:159], v[40:43]
v_exp_f32 v9, v9
v_mfma_f32_16x16x32_bf16 v[40:43], a[152:155], v[160:163], v[40:43]
v_cvt_pk_bf16_f32 v72, v8, v9
v_mfma_f32_16x16x32_bf16 v[40:43], a[156:159], v[164:167], v[40:43]
v_exp_f32 v10, v10
v_mfma_f32_16x16x32_bf16 v[48:51], a[156:159], v[180:183], v[140:143]
v_mfma_f32_16x16x32_bf16 v[48:51], a[152:155], v[176:179], v[48:51]
v_exp_f32 v11, v11
v_mfma_f32_16x16x32_bf16 v[48:51], a[148:151], v[172:175], v[48:51]
v_cvt_pk_bf16_f32 v73, v10, v11
v_mfma_f32_16x16x32_bf16 v[48:51], a[144:147], v[168:171], v[48:51]
v_exp_f32 v12, v12
v_mfma_f32_16x16x32_bf16 v[56:59], a[144:147], v[184:187], v[144:147]
v_mfma_f32_16x16x32_bf16 v[56:59], a[148:151], v[188:191], v[56:59]
v_exp_f32 v13, v13
v_mfma_f32_16x16x32_bf16 v[56:59], a[152:155], v[192:195], v[56:59]
v_cvt_pk_bf16_f32 v74, v12, v13
v_mfma_f32_16x16x32_bf16 v[56:59], a[156:159], v[196:199], v[56:59]
v_exp_f32 v14, v14
v_mfma_f32_16x16x32_bf16 v[64:67], a[156:159], v[212:215], v[148:151]
s_waitcnt vmcnt(8) lgkmcnt(0)
s_barrier
v_mfma_f32_16x16x32_bf16 v[64:67], a[152:155], v[208:211], v[64:67]
ds_read_b128 v[104:107], v244 offset:54272
v_exp_f32 v15, v15
v_mfma_f32_16x16x32_bf16 v[64:67], a[148:151], v[204:207], v[64:67]
ds_read_b128 a[156:159], v219 offset:0
ds_read_b128 v[108:111], v244 offset:55296
v_cvt_pk_bf16_f32 v75, v14, v15
v_mfma_f32_16x16x32_bf16 v[64:67], a[144:147], v[200:203], v[64:67]
ds_read_b128 v[112:115], v244 offset:56320
v_exp_f32 v16, v16
v_mfma_f32_16x16x32_bf16 a[0:3], a[176:179], v[88:91], a[0:3]
ds_read_b128 a[152:155], v218 offset:0
ds_read_b128 a[148:151], v217 offset:0
ds_read_b128 v[116:119], v244 offset:57344
v_mfma_f32_16x16x32_bf16 a[4:7], a[176:179], v[92:95], a[4:7]
ds_read_b64_tr_b16 a[212:213], v242 offset:0
STUB_9:
s_cbranch_execz HOP_RET1
v_exp_f32 v17, v17
v_mfma_f32_16x16x32_bf16 a[8:11], a[176:179], v[96:99], a[8:11]
ds_read_b128 a[144:147], v216 offset:0
ds_read_b64_tr_b16 a[214:215], v242 offset:18432
v_cvt_pk_bf16_f32 v76, v16, v17
v_mfma_f32_16x16x32_bf16 a[12:15], a[176:179], v[100:103], a[12:15]
ds_read_b64_tr_b16 a[216:217], v242 offset:32
v_exp_f32 v18, v18
v_mfma_f32_16x16x32_bf16 a[28:31], a[180:183], v[100:103], a[28:31]
ds_read_b64_tr_b16 a[176:177], v220 offset:49152
ds_read_b64_tr_b16 a[178:179], v220 offset:53248
ds_read_b64_tr_b16 a[218:219], v242 offset:18464
v_mfma_f32_16x16x32_bf16 a[24:27], a[180:183], v[96:99], a[24:27]
ds_read_b64_tr_b16 a[220:221], v242 offset:64
v_exp_f32 v19, v19
v_mfma_f32_16x16x32_bf16 a[20:23], a[180:183], v[92:95], a[20:23]
s_add_u32 s32, s32, 16384
ds_read_b64_tr_b16 a[222:223], v242 offset:18496
v_cvt_pk_bf16_f32 v77, v18, v19
v_mfma_f32_16x16x32_bf16 a[16:19], a[180:183], v[88:91], a[16:19]
ds_read_b64_tr_b16 a[224:225], v242 offset:96
v_exp_f32 v20, v20
v_mfma_f32_16x16x32_bf16 a[32:35], a[184:187], v[88:91], a[32:35]
ds_read_b64_tr_b16 a[180:181], v221 offset:49152
ds_read_b64_tr_b16 a[182:183], v221 offset:53248
ds_read_b64_tr_b16 a[226:227], v242 offset:18528
v_mfma_f32_16x16x32_bf16 a[36:39], a[184:187], v[92:95], a[36:39]
ds_read_b64_tr_b16 a[228:229], v242 offset:128
v_exp_f32 v21, v21
v_mfma_f32_16x16x32_bf16 a[40:43], a[184:187], v[96:99], a[40:43]
s_bitset0_b32 s32, 19
ds_read_b64_tr_b16 a[230:231], v242 offset:18560
v_cvt_pk_bf16_f32 v78, v20, v21
v_mfma_f32_16x16x32_bf16 a[44:47], a[184:187], v[100:103], a[44:47]
ds_read_b64_tr_b16 a[232:233], v242 offset:160
v_exp_f32 v22, v22
v_mfma_f32_16x16x32_bf16 a[60:63], a[188:191], v[100:103], a[60:63]
ds_read_b64_tr_b16 a[184:185], v222 offset:49152
ds_read_b64_tr_b16 a[186:187], v222 offset:53248
ds_read_b64_tr_b16 a[234:235], v242 offset:18592
v_mfma_f32_16x16x32_bf16 a[56:59], a[188:191], v[96:99], a[56:59]
ds_read_b64_tr_b16 a[236:237], v242 offset:192
v_exp_f32 v23, v23
v_mfma_f32_16x16x32_bf16 a[52:55], a[188:191], v[92:95], a[52:55]
s_add_u32 m0, s30, 114688
ds_read_b64_tr_b16 a[238:239], v242 offset:18624
v_cvt_pk_bf16_f32 v79, v22, v23
v_mfma_f32_16x16x32_bf16 a[48:51], a[188:191], v[88:91], a[48:51]
ds_read_b64_tr_b16 a[240:241], v242 offset:224
v_exp_f32 v24, v24
v_smfmac_f32_16x16x64_bf16 a[128:131], a[208:211], v[88:95], v245
ds_read_b64_tr_b16 a[188:189], v223 offset:49152
ds_read_b64_tr_b16 a[242:243], v242 offset:18656
v_mfma_f32_16x16x32_bf16 v[44:47], a[160:163], v[152:155], v[136:139]
ds_read_b64_tr_b16 a[244:245], v242 offset:256
v_exp_f32 v25, v25
v_mfma_f32_16x16x32_bf16 v[44:47], a[164:167], v[156:159], v[44:47]
ds_read_b64_tr_b16 a[246:247], v242 offset:18688
v_exp_f32 v26, v26
v_mfma_f32_16x16x32_bf16 v[44:47], a[168:171], v[160:163], v[44:47]
ds_read_b64_tr_b16 a[190:191], v223 offset:53248
v_cvt_pk_bf16_f32 v80, v24, v25
s_waitcnt lgkmcnt(8)
v_mul_f32 v104, v104, v112
v_mfma_f32_16x16x32_bf16 v[44:47], a[172:175], v[164:167], v[44:47]
v_mul_f32 v105, v105, v113
v_exp_f32 v27, v27
v_mfma_f32_16x16x32_bf16 v[52:55], a[172:175], v[180:183], v[140:143]
v_cvt_pk_bf16_f32 v81, v26, v27
v_mul_f32 v106, v106, v114
v_mul_f32 v107, v107, v115
v_mfma_f32_16x16x32_bf16 v[52:55], a[168:171], v[176:179], v[52:55]
v_mul_f32 v108, v108, v116
v_exp_f32 v28, v28
v_mfma_f32_16x16x32_bf16 v[52:55], a[164:167], v[172:175], v[52:55]
buffer_load_dwordx4 v228, s[8:11], s32 offen offset:0  lds
v_mul_f32 v109, v109, v117
v_mfma_f32_16x16x32_bf16 v[52:55], a[160:163], v[168:171], v[52:55]
v_mul_f32 v110, v110, v118
v_exp_f32 v29, v29
v_mfma_f32_16x16x32_bf16 v[60:63], a[160:163], v[184:187], v[144:147]
v_cvt_pk_bf16_f32 v82, v28, v29
v_mul_f32 v111, v111, v119
v_cvt_pk_bf16_f32 v120, v104, v105
v_mfma_f32_16x16x32_bf16 v[60:63], a[164:167], v[188:191], v[60:63]
v_cvt_pk_bf16_f32 v121, v106, v107
v_exp_f32 v30, v30
v_mfma_f32_16x16x32_bf16 v[60:63], a[168:171], v[192:195], v[60:63]
buffer_load_dwordx4 v229, s[8:11], s32 offen offset:1024  lds
v_cvt_pk_bf16_f32 v122, v108, v109
v_mfma_f32_16x16x32_bf16 v[60:63], a[172:175], v[196:199], v[60:63]
v_cvt_pk_bf16_f32 v123, v110, v111
v_exp_f32 v31, v31
v_mfma_f32_16x16x32_bf16 v[68:71], a[172:175], v[212:215], v[148:151]
ds_read_b128 a[172:175], v219 offset:4096
v_cvt_pk_bf16_f32 v83, v30, v31
v_mfma_f32_16x16x32_bf16 v[68:71], a[168:171], v[208:211], v[68:71]
v_exp_f32 v32, v32
v_mfma_f32_16x16x32_bf16 a[248:251], a[212:215], v[120:123], 0
ds_read_b128 a[168:171], v218 offset:4096
v_mfma_f32_16x16x32_bf16 v[68:71], a[164:167], v[204:207], v[68:71]
ds_read_b128 a[164:167], v217 offset:4096
v_mfma_f32_16x16x32_bf16 a[212:215], a[216:219], v[120:123], 0
buffer_load_dwordx4 v230, s[8:11], s32 offen offset:2048  lds
v_mfma_f32_16x16x32_bf16 v[68:71], a[160:163], v[200:203], v[68:71]
v_exp_f32 v33, v33
v_mfma_f32_16x16x32_bf16 a[216:219], a[220:223], v[120:123], 0
ds_read_b128 a[160:163], v216 offset:4096
v_mfma_f32_16x16x32_bf16 a[64:67], a[192:195], v[88:91], a[64:67]
v_cvt_pk_bf16_f32 v84, v32, v33
v_mfma_f32_16x16x32_bf16 a[220:223], a[224:227], v[120:123], 0
v_mfma_f32_16x16x32_bf16 a[68:71], a[192:195], v[92:95], a[68:71]
v_exp_f32 v34, v34
v_mfma_f32_16x16x32_bf16 a[224:227], a[228:231], v[120:123], 0
v_mfma_f32_16x16x32_bf16 a[72:75], a[192:195], v[96:99], a[72:75]
v_mfma_f32_16x16x32_bf16 a[228:231], a[232:235], v[120:123], 0
v_mfma_f32_16x16x32_bf16 a[76:79], a[192:195], v[100:103], a[76:79]
v_exp_f32 v35, v35
s_waitcnt lgkmcnt(8)
v_mfma_f32_16x16x32_bf16 a[232:235], a[236:239], v[120:123], 0
ds_read_b64_tr_b16 a[192:193], v224 offset:49152
ds_read_b64_tr_b16 a[194:195], v224 offset:53248
v_mfma_f32_16x16x32_bf16 a[92:95], a[196:199], v[100:103], a[92:95]
v_cvt_pk_bf16_f32 v85, v34, v35
s_waitcnt lgkmcnt(8)
v_mfma_f32_16x16x32_bf16 a[236:239], a[240:243], v[120:123], 0
buffer_load_dwordx4 v231, s[8:11], s32 offen offset:3072  lds
v_mfma_f32_16x16x32_bf16 a[88:91], a[196:199], v[96:99], a[88:91]
v_exp_f32 v36, v36
s_waitcnt lgkmcnt(7)
v_mfma_f32_16x16x32_bf16 a[240:243], a[244:247], v[120:123], 0
v_mfma_f32_16x16x32_bf16 a[84:87], a[196:199], v[92:95], a[84:87]
v_mfma_f32_16x16x32_bf16 a[80:83], a[196:199], v[88:91], a[80:83]
v_exp_f32 v37, v37
v_mfma_f32_16x16x32_bf16 a[96:99], a[200:203], v[88:91], a[96:99]
ds_read_b64_tr_b16 a[196:197], v225 offset:49152
v_cvt_pk_bf16_f32 v86, v36, v37
v_mfma_f32_16x16x32_bf16 a[100:103], a[200:203], v[92:95], a[100:103]
v_exp_f32 v38, v38
v_mfma_f32_16x16x32_bf16 a[104:107], a[200:203], v[96:99], a[104:107]
ds_read_b64_tr_b16 a[198:199], v225 offset:53248
v_mfma_f32_16x16x32_bf16 a[108:111], a[200:203], v[100:103], a[108:111]
v_exp_f32 v39, v39
v_mfma_f32_16x16x32_bf16 a[124:127], a[204:207], v[100:103], a[124:127]
ds_read_b64_tr_b16 a[200:201], v226 offset:49152
v_cvt_pk_bf16_f32 v87, v38, v39
v_mfma_f32_16x16x32_bf16 a[120:123], a[204:207], v[96:99], a[120:123]
ds_read_b64_tr_b16 a[202:203], v226 offset:53248
buffer_store_dwordx4 a[248:251], v238, s[20:23], s28 offen offset:0 sc0 sc1
v_mfma_f32_16x16x32_bf16 a[116:119], a[204:207], v[92:95], a[116:119]
v_mfma_f32_16x16x32_bf16 a[112:115], a[204:207], v[88:91], a[112:115]
ds_read_b64_tr_b16 a[204:205], v227 offset:49152
ds_read_b64_tr_b16 a[206:207], v227 offset:53248
v_smfmac_f32_16x16x64_bf16 a[132:135], a[208:211], v[96:103], v245
buffer_store_dwordx4 a[212:215], v238, s[20:23], s28 offen offset:512 sc0 sc1
v_mfma_f32_16x16x32_bf16 v[8:11], a[144:147], v[152:155], v[136:139]
v_exp_f32 v40, v40
v_mfma_f32_16x16x32_bf16 v[8:11], a[148:151], v[156:159], v[8:11]
v_exp_f32 v41, v41
v_mfma_f32_16x16x32_bf16 v[8:11], a[152:155], v[160:163], v[8:11]
buffer_store_dwordx4 a[216:219], v238, s[20:23], s28 offen offset:1024 sc0 sc1
v_cvt_pk_bf16_f32 v88, v40, v41
v_mfma_f32_16x16x32_bf16 v[8:11], a[156:159], v[164:167], v[8:11]
v_exp_f32 v42, v42
v_mfma_f32_16x16x32_bf16 v[16:19], a[156:159], v[180:183], v[140:143]
s_add_u32 s39, s39, 16384
buffer_store_dwordx4 a[220:223], v238, s[20:23], s28 offen offset:1536 sc0 sc1
v_mfma_f32_16x16x32_bf16 v[16:19], a[152:155], v[176:179], v[16:19]
v_exp_f32 v43, v43
v_mfma_f32_16x16x32_bf16 v[16:19], a[148:151], v[172:175], v[16:19]
v_cvt_pk_bf16_f32 v89, v42, v43
v_mfma_f32_16x16x32_bf16 v[16:19], a[144:147], v[168:171], v[16:19]
v_exp_f32 v44, v44
v_mfma_f32_16x16x32_bf16 v[24:27], a[144:147], v[184:187], v[144:147]
buffer_store_dwordx4 a[224:227], v238, s[20:23], s28 offen offset:2048 sc0 sc1
v_mfma_f32_16x16x32_bf16 v[24:27], a[148:151], v[188:191], v[24:27]
v_exp_f32 v45, v45
v_mfma_f32_16x16x32_bf16 v[24:27], a[152:155], v[192:195], v[24:27]
v_cvt_pk_bf16_f32 v90, v44, v45
v_mfma_f32_16x16x32_bf16 v[24:27], a[156:159], v[196:199], v[24:27]
v_exp_f32 v46, v46
v_mfma_f32_16x16x32_bf16 v[32:35], a[156:159], v[212:215], v[148:151]
ds_read_b128 a[156:159], v219 offset:8192
s_bitset0_b32 s39, 19
v_mfma_f32_16x16x32_bf16 v[32:35], a[152:155], v[208:211], v[32:35]
v_exp_f32 v47, v47
v_mfma_f32_16x16x32_bf16 v[32:35], a[148:151], v[204:207], v[32:35]
ds_read_b128 a[152:155], v218 offset:8192
v_cvt_pk_bf16_f32 v91, v46, v47
v_mfma_f32_16x16x32_bf16 v[32:35], a[144:147], v[200:203], v[32:35]
v_exp_f32 v48, v48
v_mfma_f32_16x16x32_bf16 a[0:3], a[176:179], v[72:75], a[0:3]
ds_read_b128 a[148:151], v217 offset:8192
ds_read_b128 a[144:147], v216 offset:8192
v_mfma_f32_16x16x32_bf16 a[4:7], a[176:179], v[76:79], a[4:7]
v_exp_f32 v49, v49
v_mfma_f32_16x16x32_bf16 a[8:11], a[176:179], v[80:83], a[8:11]
v_cvt_pk_bf16_f32 v92, v48, v49
v_mfma_f32_16x16x32_bf16 a[12:15], a[176:179], v[84:87], a[12:15]
v_exp_f32 v50, v50
v_mfma_f32_16x16x32_bf16 a[28:31], a[180:183], v[84:87], a[28:31]
ds_read_b64_tr_b16 a[176:177], v220 offset:57344
ds_read_b64_tr_b16 a[178:179], v220 offset:61440
v_mfma_f32_16x16x32_bf16 a[24:27], a[180:183], v[80:83], a[24:27]
v_exp_f32 v51, v51
v_mfma_f32_16x16x32_bf16 a[20:23], a[180:183], v[76:79], a[20:23]
s_add_u32 m0, s30, 131072
v_cvt_pk_bf16_f32 v93, v50, v51
v_mfma_f32_16x16x32_bf16 a[16:19], a[180:183], v[72:75], a[16:19]
v_exp_f32 v52, v52
v_mfma_f32_16x16x32_bf16 a[32:35], a[184:187], v[72:75], a[32:35]
ds_read_b64_tr_b16 a[180:181], v221 offset:57344
ds_read_b64_tr_b16 a[182:183], v221 offset:61440
v_mfma_f32_16x16x32_bf16 a[36:39], a[184:187], v[76:79], a[36:39]
v_exp_f32 v53, v53
v_mfma_f32_16x16x32_bf16 a[40:43], a[184:187], v[80:83], a[40:43]
buffer_store_dwordx4 a[228:231], v238, s[20:23], s28 offen offset:2560 sc0 sc1
v_cvt_pk_bf16_f32 v94, v52, v53
v_mfma_f32_16x16x32_bf16 a[44:47], a[184:187], v[84:87], a[44:47]
v_exp_f32 v54, v54
s_waitcnt lgkmcnt(8)
v_mfma_f32_16x16x32_bf16 a[60:63], a[188:191], v[84:87], a[60:63]
ds_read_b64_tr_b16 a[184:185], v222 offset:57344
ds_read_b64_tr_b16 a[186:187], v222 offset:61440
v_mfma_f32_16x16x32_bf16 a[56:59], a[188:191], v[80:83], a[56:59]
v_exp_f32 v55, v55
v_mfma_f32_16x16x32_bf16 a[52:55], a[188:191], v[76:79], a[52:55]
buffer_store_dwordx4 a[232:235], v238, s[20:23], s28 offen offset:3072 sc0 sc1
v_cvt_pk_bf16_f32 v95, v54, v55
v_mfma_f32_16x16x32_bf16 a[48:51], a[188:191], v[72:75], a[48:51]
v_exp_f32 v56, v56
v_smfmac_f32_16x16x64_bf16 a[128:131], a[208:211], v[72:79], v245
ds_read_b64_tr_b16 a[188:189], v223 offset:57344
v_mfma_f32_16x16x32_bf16 v[12:15], a[160:163], v[152:155], v[136:139]
v_exp_f32 v57, v57
v_mfma_f32_16x16x32_bf16 v[12:15], a[164:167], v[156:159], v[12:15]
v_exp_f32 v58, v58
v_mfma_f32_16x16x32_bf16 v[12:15], a[168:171], v[160:163], v[12:15]
ds_read_b64_tr_b16 a[190:191], v223 offset:61440
v_cvt_pk_bf16_f32 v96, v56, v57
v_mfma_f32_16x16x32_bf16 v[12:15], a[172:175], v[164:167], v[12:15]
v_exp_f32 v59, v59
v_mfma_f32_16x16x32_bf16 v[20:23], a[172:175], v[180:183], v[140:143]
v_cvt_pk_bf16_f32 v97, v58, v59
v_mfma_f32_16x16x32_bf16 v[20:23], a[168:171], v[176:179], v[20:23]
v_exp_f32 v60, v60
v_mfma_f32_16x16x32_bf16 v[20:23], a[164:167], v[172:175], v[20:23]
buffer_load_dwordx4 v232, s[12:15], s39 offen offset:0  lds
v_mfma_f32_16x16x32_bf16 v[20:23], a[160:163], v[168:171], v[20:23]
v_exp_f32 v61, v61
v_mfma_f32_16x16x32_bf16 v[28:31], a[160:163], v[184:187], v[144:147]
buffer_store_dwordx4 a[236:239], v238, s[20:23], s28 offen offset:3584 sc0 sc1
v_cvt_pk_bf16_f32 v98, v60, v61
v_mfma_f32_16x16x32_bf16 v[28:31], a[164:167], v[188:191], v[28:31]
v_exp_f32 v62, v62
v_mfma_f32_16x16x32_bf16 v[28:31], a[168:171], v[192:195], v[28:31]
buffer_load_dwordx4 v233, s[12:15], s39 offen offset:1024  lds
v_mfma_f32_16x16x32_bf16 v[28:31], a[172:175], v[196:199], v[28:31]
v_exp_f32 v63, v63
v_mfma_f32_16x16x32_bf16 v[36:39], a[172:175], v[212:215], v[148:151]
ds_read_b128 a[172:175], v219 offset:12288
v_cvt_pk_bf16_f32 v99, v62, v63
v_mfma_f32_16x16x32_bf16 v[36:39], a[168:171], v[208:211], v[36:39]
v_exp_f32 v64, v64
v_mfma_f32_16x16x32_bf16 v[36:39], a[164:167], v[204:207], v[36:39]
ds_read_b128 a[168:171], v218 offset:12288
ds_read_b128 a[164:167], v217 offset:12288
v_mfma_f32_16x16x32_bf16 v[36:39], a[160:163], v[200:203], v[36:39]
v_exp_f32 v65, v65
v_mfma_f32_16x16x32_bf16 a[64:67], a[192:195], v[72:75], a[64:67]
ds_read_b128 a[160:163], v216 offset:12288
v_cvt_pk_bf16_f32 v100, v64, v65
v_mfma_f32_16x16x32_bf16 a[68:71], a[192:195], v[76:79], a[68:71]
v_exp_f32 v66, v66
v_mfma_f32_16x16x32_bf16 a[72:75], a[192:195], v[80:83], a[72:75]
buffer_load_dwordx4 v232, s[12:15], s39 offen offset:2048  lds
v_mfma_f32_16x16x32_bf16 a[76:79], a[192:195], v[84:87], a[76:79]
v_exp_f32 v67, v67
v_mfma_f32_16x16x32_bf16 a[92:95], a[196:199], v[84:87], a[92:95]
ds_read_b64_tr_b16 a[192:193], v224 offset:57344
v_cvt_pk_bf16_f32 v101, v66, v67
v_mfma_f32_16x16x32_bf16 a[88:91], a[196:199], v[80:83], a[88:91]
v_exp_f32 v68, v68
v_mfma_f32_16x16x32_bf16 a[84:87], a[196:199], v[76:79], a[84:87]
ds_read_b64_tr_b16 a[194:195], v224 offset:61440
v_mfma_f32_16x16x32_bf16 a[80:83], a[196:199], v[72:75], a[80:83]
v_exp_f32 v69, v69
v_mfma_f32_16x16x32_bf16 a[96:99], a[200:203], v[72:75], a[96:99]
ds_read_b64_tr_b16 a[196:197], v225 offset:57344
v_cvt_pk_bf16_f32 v102, v68, v69
v_mfma_f32_16x16x32_bf16 a[100:103], a[200:203], v[76:79], a[100:103]
v_exp_f32 v70, v70
v_mfma_f32_16x16x32_bf16 a[104:107], a[200:203], v[80:83], a[104:107]
ds_read_b64_tr_b16 a[198:199], v225 offset:61440
v_mfma_f32_16x16x32_bf16 a[108:111], a[200:203], v[84:87], a[108:111]
v_exp_f32 v71, v71
v_mfma_f32_16x16x32_bf16 a[124:127], a[204:207], v[84:87], a[124:127]
ds_read_b64_tr_b16 a[200:201], v226 offset:57344
v_cvt_pk_bf16_f32 v103, v70, v71
v_mfma_f32_16x16x32_bf16 a[120:123], a[204:207], v[80:83], a[120:123]
ds_read_b64_tr_b16 a[202:203], v226 offset:61440
v_mfma_f32_16x16x32_bf16 a[116:119], a[204:207], v[76:79], a[116:119]
buffer_load_dwordx4 v233, s[12:15], s39 offen offset:3072  lds
v_mfma_f32_16x16x32_bf16 a[112:115], a[204:207], v[72:75], a[112:115]
ds_read_b64_tr_b16 a[204:205], v227 offset:57344
ds_read_b64_tr_b16 a[206:207], v227 offset:61440
v_smfmac_f32_16x16x64_bf16 a[132:135], a[208:211], v[80:87], v245
s_add_u32 s28, s28, 4096
buffer_store_dwordx4 a[240:243], v238, s[20:23], s28 offen offset:0 sc0 sc1
s_mov_b32 s33, 6
K_LOOPIN:
s_waitcnt lgkmcnt(0)
v_lshlrev_b32 v241, 4, v1
s_mov_b32 s46, s44
.p2align 6
K_LOOP:
s_cmp_eq_u32 s33, s3
s_cbranch_scc1 K_EVT
K_EVT_RET:
v_mfma_f32_16x16x32_bf16 v[40:43], a[144:147], v[152:155], v[136:139]
v_exp_f32 v8, v8
v_mfma_f32_16x16x32_bf16 v[40:43], a[148:151], v[156:159], v[40:43]
v_exp_f32 v9, v9
v_mfma_f32_16x16x32_bf16 v[40:43], a[152:155], v[160:163], v[40:43]
v_cvt_pk_bf16_f32 v72, v8, v9
v_mfma_f32_16x16x32_bf16 v[40:43], a[156:159], v[164:167], v[40:43]
v_exp_f32 v10, v10
v_mfma_f32_16x16x32_bf16 v[48:51], a[156:159], v[180:183], v[140:143]
v_mfma_f32_16x16x32_bf16 v[48:51], a[152:155], v[176:179], v[48:51]
v_exp_f32 v11, v11
v_mfma_f32_16x16x32_bf16 v[48:51], a[148:151], v[172:175], v[48:51]
v_cvt_pk_bf16_f32 v73, v10, v11
v_mfma_f32_16x16x32_bf16 v[48:51], a[144:147], v[168:171], v[48:51]
v_exp_f32 v12, v12
v_mfma_f32_16x16x32_bf16 v[56:59], a[144:147], v[184:187], v[144:147]
v_mfma_f32_16x16x32_bf16 v[56:59], a[148:151], v[188:191], v[56:59]
v_exp_f32 v13, v13
v_mfma_f32_16x16x32_bf16 v[56:59], a[152:155], v[192:195], v[56:59]
v_cvt_pk_bf16_f32 v74, v12, v13
v_mfma_f32_16x16x32_bf16 v[56:59], a[156:159], v[196:199], v[56:59]
v_exp_f32 v14, v14
v_mfma_f32_16x16x32_bf16 v[64:67], a[156:159], v[212:215], v[148:151]
s_waitcnt vmcnt(10) lgkmcnt(0)
s_barrier
v_mfma_f32_16x16x32_bf16 v[64:67], a[152:155], v[208:211], v[64:67]
v_exp_f32 v15, v15
v_mfma_f32_16x16x32_bf16 v[64:67], a[148:151], v[204:207], v[64:67]
ds_read_b128 a[156:159], v219 offset:16384
v_cvt_pk_bf16_f32 v75, v14, v15
v_mfma_f32_16x16x32_bf16 v[64:67], a[144:147], v[200:203], v[64:67]
v_exp_f32 v16, v16
v_mfma_f32_16x16x32_bf16 a[0:3], a[176:179], v[88:91], a[0:3]
ds_read_b128 a[152:155], v218 offset:16384
ds_read_b128 a[148:151], v217 offset:16384
v_mfma_f32_16x16x32_bf16 a[4:7], a[176:179], v[92:95], a[4:7]
v_exp_f32 v17, v17
v_mfma_f32_16x16x32_bf16 a[8:11], a[176:179], v[96:99], a[8:11]
ds_read_b128 a[144:147], v216 offset:16384
v_cvt_pk_bf16_f32 v76, v16, v17
v_mfma_f32_16x16x32_bf16 a[12:15], a[176:179], v[100:103], a[12:15]
v_exp_f32 v18, v18
v_mfma_f32_16x16x32_bf16 a[28:31], a[180:183], v[100:103], a[28:31]
ds_read_b64_tr_b16 a[176:177], v220 offset:0
ds_read_b64_tr_b16 a[178:179], v220 offset:4096
v_mfma_f32_16x16x32_bf16 a[24:27], a[180:183], v[96:99], a[24:27]
v_exp_f32 v19, v19
v_mfma_f32_16x16x32_bf16 a[20:23], a[180:183], v[92:95], a[20:23]
s_add_u32 s32, s32, 16384
v_cvt_pk_bf16_f32 v77, v18, v19
v_mfma_f32_16x16x32_bf16 a[16:19], a[180:183], v[88:91], a[16:19]
v_exp_f32 v20, v20
v_mfma_f32_16x16x32_bf16 a[32:35], a[184:187], v[88:91], a[32:35]
ds_read_b64_tr_b16 a[180:181], v221 offset:0
ds_read_b64_tr_b16 a[182:183], v221 offset:4096
v_mfma_f32_16x16x32_bf16 a[36:39], a[184:187], v[92:95], a[36:39]
v_exp_f32 v21, v21
v_mfma_f32_16x16x32_bf16 a[40:43], a[184:187], v[96:99], a[40:43]
s_bitset0_b32 s32, 19
v_cvt_pk_bf16_f32 v78, v20, v21
v_mfma_f32_16x16x32_bf16 a[44:47], a[184:187], v[100:103], a[44:47]
v_exp_f32 v22, v22
v_mfma_f32_16x16x32_bf16 a[60:63], a[188:191], v[100:103], a[60:63]
ds_read_b64_tr_b16 a[184:185], v222 offset:0
ds_read_b64_tr_b16 a[186:187], v222 offset:4096
v_mfma_f32_16x16x32_bf16 a[56:59], a[188:191], v[96:99], a[56:59]
v_exp_f32 v23, v23
v_mfma_f32_16x16x32_bf16 a[52:55], a[188:191], v[92:95], a[52:55]
s_add_u32 m0, s30, 65536
v_cvt_pk_bf16_f32 v79, v22, v23
v_mfma_f32_16x16x32_bf16 a[48:51], a[188:191], v[88:91], a[48:51]
v_exp_f32 v24, v24
v_smfmac_f32_16x16x64_bf16 a[128:131], a[208:211], v[88:95], v245
ds_read_b64_tr_b16 a[188:189], v223 offset:0
v_mfma_f32_16x16x32_bf16 v[44:47], a[160:163], v[152:155], v[136:139]
v_exp_f32 v25, v25
v_mfma_f32_16x16x32_bf16 v[44:47], a[164:167], v[156:159], v[44:47]
v_exp_f32 v26, v26
v_mfma_f32_16x16x32_bf16 v[44:47], a[168:171], v[160:163], v[44:47]
ds_read_b64_tr_b16 a[190:191], v223 offset:4096
v_cvt_pk_bf16_f32 v80, v24, v25
v_mfma_f32_16x16x32_bf16 v[44:47], a[172:175], v[164:167], v[44:47]
v_exp_f32 v27, v27
v_mfma_f32_16x16x32_bf16 v[52:55], a[172:175], v[180:183], v[140:143]
v_cvt_pk_bf16_f32 v81, v26, v27
v_mfma_f32_16x16x32_bf16 v[52:55], a[168:171], v[176:179], v[52:55]
v_exp_f32 v28, v28
v_mfma_f32_16x16x32_bf16 v[52:55], a[164:167], v[172:175], v[52:55]
buffer_load_dwordx4 v228, s[8:11], s32 offen offset:0  lds
v_mfma_f32_16x16x32_bf16 v[52:55], a[160:163], v[168:171], v[52:55]
v_exp_f32 v29, v29
v_mfma_f32_16x16x32_bf16 v[60:63], a[160:163], v[184:187], v[144:147]
v_cvt_pk_bf16_f32 v82, v28, v29
v_mfma_f32_16x16x32_bf16 v[60:63], a[164:167], v[188:191], v[60:63]
v_exp_f32 v30, v30
v_mfma_f32_16x16x32_bf16 v[60:63], a[168:171], v[192:195], v[60:63]
buffer_load_dwordx4 v229, s[8:11], s32 offen offset:1024  lds
v_mfma_f32_16x16x32_bf16 v[60:63], a[172:175], v[196:199], v[60:63]
v_exp_f32 v31, v31
v_mfma_f32_16x16x32_bf16 v[68:71], a[172:175], v[212:215], v[148:151]
ds_read_b128 a[172:175], v219 offset:20480
v_cvt_pk_bf16_f32 v83, v30, v31
v_mfma_f32_16x16x32_bf16 v[68:71], a[168:171], v[208:211], v[68:71]
v_exp_f32 v32, v32
v_mfma_f32_16x16x32_bf16 v[68:71], a[164:167], v[204:207], v[68:71]
ds_read_b128 a[168:171], v218 offset:20480
ds_read_b128 a[164:167], v217 offset:20480
v_mfma_f32_16x16x32_bf16 v[68:71], a[160:163], v[200:203], v[68:71]
v_exp_f32 v33, v33
v_mfma_f32_16x16x32_bf16 a[64:67], a[192:195], v[88:91], a[64:67]
ds_read_b128 a[160:163], v216 offset:20480
v_cvt_pk_bf16_f32 v84, v32, v33
v_mfma_f32_16x16x32_bf16 a[68:71], a[192:195], v[92:95], a[68:71]
v_exp_f32 v34, v34
v_mfma_f32_16x16x32_bf16 a[72:75], a[192:195], v[96:99], a[72:75]
buffer_load_dwordx4 v230, s[8:11], s32 offen offset:2048  lds
v_mfma_f32_16x16x32_bf16 a[76:79], a[192:195], v[100:103], a[76:79]
v_exp_f32 v35, v35
v_mfma_f32_16x16x32_bf16 a[92:95], a[196:199], v[100:103], a[92:95]
ds_read_b64_tr_b16 a[192:193], v224 offset:0
v_cvt_pk_bf16_f32 v85, v34, v35
v_mfma_f32_16x16x32_bf16 a[88:91], a[196:199], v[96:99], a[88:91]
v_exp_f32 v36, v36
v_mfma_f32_16x16x32_bf16 a[84:87], a[196:199], v[92:95], a[84:87]
ds_read_b64_tr_b16 a[194:195], v224 offset:4096
v_mfma_f32_16x16x32_bf16 a[80:83], a[196:199], v[88:91], a[80:83]
v_exp_f32 v37, v37
v_mfma_f32_16x16x32_bf16 a[96:99], a[200:203], v[88:91], a[96:99]
ds_read_b64_tr_b16 a[196:197], v225 offset:0
v_cvt_pk_bf16_f32 v86, v36, v37
v_mfma_f32_16x16x32_bf16 a[100:103], a[200:203], v[92:95], a[100:103]
v_exp_f32 v38, v38
v_mfma_f32_16x16x32_bf16 a[104:107], a[200:203], v[96:99], a[104:107]
ds_read_b64_tr_b16 a[198:199], v225 offset:4096
v_mfma_f32_16x16x32_bf16 a[108:111], a[200:203], v[100:103], a[108:111]
v_exp_f32 v39, v39
v_mfma_f32_16x16x32_bf16 a[124:127], a[204:207], v[100:103], a[124:127]
ds_read_b64_tr_b16 a[200:201], v226 offset:0
v_cvt_pk_bf16_f32 v87, v38, v39
v_mfma_f32_16x16x32_bf16 a[120:123], a[204:207], v[96:99], a[120:123]
ds_read_b64_tr_b16 a[202:203], v226 offset:4096
v_mfma_f32_16x16x32_bf16 a[116:119], a[204:207], v[92:95], a[116:119]
buffer_load_dwordx4 v231, s[8:11], s32 offen offset:3072  lds
v_mfma_f32_16x16x32_bf16 a[112:115], a[204:207], v[88:91], a[112:115]
ds_read_b64_tr_b16 a[204:205], v227 offset:0
ds_read_b64_tr_b16 a[206:207], v227 offset:4096
v_smfmac_f32_16x16x64_bf16 a[132:135], a[208:211], v[96:103], v245
s_mov_b32 m0, s87
s_lshl2_add_u32 s50, s87, s89
buffer_load_dwordx4 v243, s[56:59], s50 offen  lds
s_add_u32 s87, s87, 3456
s_min_u32 s87, s87, 63936
s_waitcnt lgkmcnt(8)
v_mfma_f32_16x16x32_bf16 v[8:11], a[144:147], v[152:155], v[136:139]
v_exp_f32 v40, v40
v_mfma_f32_16x16x32_bf16 v[8:11], a[148:151], v[156:159], v[8:11]
v_exp_f32 v41, v41
v_mfma_f32_16x16x32_bf16 v[8:11], a[152:155], v[160:163], v[8:11]
v_cvt_pk_bf16_f32 v88, v40, v41
v_mfma_f32_16x16x32_bf16 v[8:11], a[156:159], v[164:167], v[8:11]
v_exp_f32 v42, v42
v_mfma_f32_16x16x32_bf16 v[16:19], a[156:159], v[180:183], v[140:143]
s_add_u32 s39, s39, 16384
v_mfma_f32_16x16x32_bf16 v[16:19], a[152:155], v[176:179], v[16:19]
v_exp_f32 v43, v43
v_mfma_f32_16x16x32_bf16 v[16:19], a[148:151], v[172:175], v[16:19]
v_cvt_pk_bf16_f32 v89, v42, v43
v_mfma_f32_16x16x32_bf16 v[16:19], a[144:147], v[168:171], v[16:19]
v_exp_f32 v44, v44
v_mfma_f32_16x16x32_bf16 v[24:27], a[144:147], v[184:187], v[144:147]
s_bitset0_b32 s39, 19
v_mfma_f32_16x16x32_bf16 v[24:27], a[148:151], v[188:191], v[24:27]
v_exp_f32 v45, v45
v_mfma_f32_16x16x32_bf16 v[24:27], a[152:155], v[192:195], v[24:27]
v_cvt_pk_bf16_f32 v90, v44, v45
v_mfma_f32_16x16x32_bf16 v[24:27], a[156:159], v[196:199], v[24:27]
v_exp_f32 v46, v46
v_mfma_f32_16x16x32_bf16 v[32:35], a[156:159], v[212:215], v[148:151]
ds_read_b128 a[156:159], v219 offset:24576
v_mfma_f32_16x16x32_bf16 v[32:35], a[152:155], v[208:211], v[32:35]
v_exp_f32 v47, v47
v_mfma_f32_16x16x32_bf16 v[32:35], a[148:151], v[204:207], v[32:35]
ds_read_b128 a[152:155], v218 offset:24576
v_cvt_pk_bf16_f32 v91, v46, v47
v_mfma_f32_16x16x32_bf16 v[32:35], a[144:147], v[200:203], v[32:35]
v_exp_f32 v48, v48
v_mfma_f32_16x16x32_bf16 a[0:3], a[176:179], v[72:75], a[0:3]
ds_read_b128 a[148:151], v217 offset:24576
ds_read_b128 a[144:147], v216 offset:24576
v_mfma_f32_16x16x32_bf16 a[4:7], a[176:179], v[76:79], a[4:7]
v_exp_f32 v49, v49
v_mfma_f32_16x16x32_bf16 a[8:11], a[176:179], v[80:83], a[8:11]
s_add_u32 m0, s30, 147456
v_cvt_pk_bf16_f32 v92, v48, v49
v_mfma_f32_16x16x32_bf16 a[12:15], a[176:179], v[84:87], a[12:15]
v_exp_f32 v50, v50
v_mfma_f32_16x16x32_bf16 a[28:31], a[180:183], v[84:87], a[28:31]
ds_read_b64_tr_b16 a[176:177], v220 offset:8192
ds_read_b64_tr_b16 a[178:179], v220 offset:12288
v_mfma_f32_16x16x32_bf16 a[24:27], a[180:183], v[80:83], a[24:27]
v_exp_f32 v51, v51
v_mfma_f32_16x16x32_bf16 a[20:23], a[180:183], v[76:79], a[20:23]
v_cvt_pk_bf16_f32 v93, v50, v51
v_mfma_f32_16x16x32_bf16 a[16:19], a[180:183], v[72:75], a[16:19]
v_exp_f32 v52, v52
v_mfma_f32_16x16x32_bf16 a[32:35], a[184:187], v[72:75], a[32:35]
ds_read_b64_tr_b16 a[180:181], v221 offset:8192
ds_read_b64_tr_b16 a[182:183], v221 offset:12288
v_mfma_f32_16x16x32_bf16 a[36:39], a[184:187], v[76:79], a[36:39]
v_exp_f32 v53, v53
v_mfma_f32_16x16x32_bf16 a[40:43], a[184:187], v[80:83], a[40:43]
v_cvt_pk_bf16_f32 v94, v52, v53
v_mfma_f32_16x16x32_bf16 a[44:47], a[184:187], v[84:87], a[44:47]
v_exp_f32 v54, v54
v_mfma_f32_16x16x32_bf16 a[60:63], a[188:191], v[84:87], a[60:63]
ds_read_b64_tr_b16 a[184:185], v222 offset:8192
ds_read_b64_tr_b16 a[186:187], v222 offset:12288
v_mfma_f32_16x16x32_bf16 a[56:59], a[188:191], v[80:83], a[56:59]
v_exp_f32 v55, v55
v_mfma_f32_16x16x32_bf16 a[52:55], a[188:191], v[76:79], a[52:55]
v_cvt_pk_bf16_f32 v95, v54, v55
v_mfma_f32_16x16x32_bf16 a[48:51], a[188:191], v[72:75], a[48:51]
v_exp_f32 v56, v56
v_smfmac_f32_16x16x64_bf16 a[128:131], a[208:211], v[72:79], v245
ds_read_b64_tr_b16 a[188:189], v223 offset:8192
v_mfma_f32_16x16x32_bf16 v[12:15], a[160:163], v[152:155], v[136:139]
v_exp_f32 v57, v57
v_mfma_f32_16x16x32_bf16 v[12:15], a[164:167], v[156:159], v[12:15]
v_exp_f32 v58, v58
v_mfma_f32_16x16x32_bf16 v[12:15], a[168:171], v[160:163], v[12:15]
ds_read_b64_tr_b16 a[190:191], v223 offset:12288
v_cvt_pk_bf16_f32 v96, v56, v57
v_mfma_f32_16x16x32_bf16 v[12:15], a[172:175], v[164:167], v[12:15]
v_exp_f32 v59, v59
v_mfma_f32_16x16x32_bf16 v[20:23], a[172:175], v[180:183], v[140:143]
v_cvt_pk_bf16_f32 v97, v58, v59
v_mfma_f32_16x16x32_bf16 v[20:23], a[168:171], v[176:179], v[20:23]
v_exp_f32 v60, v60
v_mfma_f32_16x16x32_bf16 v[20:23], a[164:167], v[172:175], v[20:23]
buffer_load_dwordx4 v232, s[12:15], s39 offen offset:0  lds
v_mfma_f32_16x16x32_bf16 v[20:23], a[160:163], v[168:171], v[20:23]
v_exp_f32 v61, v61
v_mfma_f32_16x16x32_bf16 v[28:31], a[160:163], v[184:187], v[144:147]
v_cvt_pk_bf16_f32 v98, v60, v61
v_mfma_f32_16x16x32_bf16 v[28:31], a[164:167], v[188:191], v[28:31]
v_exp_f32 v62, v62
v_mfma_f32_16x16x32_bf16 v[28:31], a[168:171], v[192:195], v[28:31]
buffer_load_dwordx4 v233, s[12:15], s39 offen offset:1024  lds
v_mfma_f32_16x16x32_bf16 v[28:31], a[172:175], v[196:199], v[28:31]
v_exp_f32 v63, v63
v_mfma_f32_16x16x32_bf16 v[36:39], a[172:175], v[212:215], v[148:151]
ds_read_b128 a[172:175], v219 offset:28672
v_cvt_pk_bf16_f32 v99, v62, v63
v_mfma_f32_16x16x32_bf16 v[36:39], a[168:171], v[208:211], v[36:39]
v_exp_f32 v64, v64
v_mfma_f32_16x16x32_bf16 v[36:39], a[164:167], v[204:207], v[36:39]
ds_read_b128 a[168:171], v218 offset:28672
ds_read_b128 a[164:167], v217 offset:28672
v_mfma_f32_16x16x32_bf16 v[36:39], a[160:163], v[200:203], v[36:39]
v_exp_f32 v65, v65
s_waitcnt lgkmcnt(8)
v_mfma_f32_16x16x32_bf16 a[64:67], a[192:195], v[72:75], a[64:67]
ds_read_b128 a[160:163], v216 offset:28672
v_cvt_pk_bf16_f32 v100, v64, v65
STUB_10:
STUB_B1:
s_cbranch_execz STUB_13
v_mfma_f32_16x16x32_bf16 a[68:71], a[192:195], v[76:79], a[68:71]
v_exp_f32 v66, v66
v_mfma_f32_16x16x32_bf16 a[72:75], a[192:195], v[80:83], a[72:75]
buffer_load_dwordx4 v232, s[12:15], s39 offen offset:2048  lds
v_mfma_f32_16x16x32_bf16 a[76:79], a[192:195], v[84:87], a[76:79]
v_exp_f32 v67, v67
v_mfma_f32_16x16x32_bf16 a[92:95], a[196:199], v[84:87], a[92:95]
ds_read_b64_tr_b16 a[192:193], v224 offset:8192
v_cvt_pk_bf16_f32 v101, v66, v67
v_mfma_f32_16x16x32_bf16 a[88:91], a[196:199], v[80:83], a[88:91]
v_exp_f32 v68, v68
v_mfma_f32_16x16x32_bf16 a[84:87], a[196:199], v[76:79], a[84:87]
ds_read_b64_tr_b16 a[194:195], v224 offset:12288
v_mfma_f32_16x16x32_bf16 a[80:83], a[196:199], v[72:75], a[80:83]
v_exp_f32 v69, v69
v_mfma_f32_16x16x32_bf16 a[96:99], a[200:203], v[72:75], a[96:99]
ds_read_b64_tr_b16 a[196:197], v225 offset:8192
v_cvt_pk_bf16_f32 v102, v68, v69
v_mfma_f32_16x16x32_bf16 a[100:103], a[200:203], v[76:79], a[100:103]
v_exp_f32 v70, v70
v_mfma_f32_16x16x32_bf16 a[104:107], a[200:203], v[80:83], a[104:107]
ds_read_b64_tr_b16 a[198:199], v225 offset:12288
v_mfma_f32_16x16x32_bf16 a[108:111], a[200:203], v[84:87], a[108:111]
v_exp_f32 v71, v71
v_mfma_f32_16x16x32_bf16 a[124:127], a[204:207], v[84:87], a[124:127]
ds_read_b64_tr_b16 a[200:201], v226 offset:8192
v_cvt_pk_bf16_f32 v103, v70, v71
v_mfma_f32_16x16x32_bf16 a[120:123], a[204:207], v[80:83], a[120:123]
ds_read_b64_tr_b16 a[202:203], v226 offset:12288
v_mfma_f32_16x16x32_bf16 a[116:119], a[204:207], v[76:79], a[116:119]
buffer_load_dwordx4 v233, s[12:15], s39 offen offset:3072  lds
v_mfma_f32_16x16x32_bf16 a[112:115], a[204:207], v[72:75], a[112:115]
ds_read_b64_tr_b16 a[204:205], v227 offset:8192
ds_read_b64_tr_b16 a[206:207], v227 offset:12288
v_smfmac_f32_16x16x64_bf16 a[132:135], a[208:211], v[80:87], v245
buffer_load_dword v242, v241, s[20:23], s46 offen sc1
v_add_u32 v241, 1024, v241
v_and_b32 v241, 0x3fff, v241
v_mfma_f32_16x16x32_bf16 v[40:43], a[144:147], v[152:155], v[136:139]
v_exp_f32 v8, v8
v_mfma_f32_16x16x32_bf16 v[40:43], a[148:151], v[156:159], v[40:43]
v_exp_f32 v9, v9
v_mfma_f32_16x16x32_bf16 v[40:43], a[152:155], v[160:163], v[40:43]
v_cvt_pk_bf16_f32 v72, v8, v9
v_mfma_f32_16x16x32_bf16 v[40:43], a[156:159], v[164:167], v[40:43]
v_exp_f32 v10, v10
v_mfma_f32_16x16x32_bf16 v[48:51], a[156:159], v[180:183], v[140:143]
v_mfma_f32_16x16x32_bf16 v[48:51], a[152:155], v[176:179], v[48:51]
v_exp_f32 v11, v11
v_mfma_f32_16x16x32_bf16 v[48:51], a[148:151], v[172:175], v[48:51]
v_cvt_pk_bf16_f32 v73, v10, v11
v_mfma_f32_16x16x32_bf16 v[48:51], a[144:147], v[168:171], v[48:51]
v_exp_f32 v12, v12
v_mfma_f32_16x16x32_bf16 v[56:59], a[144:147], v[184:187], v[144:147]
v_mfma_f32_16x16x32_bf16 v[56:59], a[148:151], v[188:191], v[56:59]
v_exp_f32 v13, v13
v_mfma_f32_16x16x32_bf16 v[56:59], a[152:155], v[192:195], v[56:59]
v_cvt_pk_bf16_f32 v74, v12, v13
v_mfma_f32_16x16x32_bf16 v[56:59], a[156:159], v[196:199], v[56:59]
v_exp_f32 v14, v14
v_mfma_f32_16x16x32_bf16 v[64:67], a[156:159], v[212:215], v[148:151]
s_waitcnt vmcnt(10) lgkmcnt(0)
s_barrier
v_mfma_f32_16x16x32_bf16 v[64:67], a[152:155], v[208:211], v[64:67]
v_exp_f32 v15, v15
v_mfma_f32_16x16x32_bf16 v[64:67], a[148:151], v[204:207], v[64:67]
ds_read_b128 a[156:159], v219 offset:49152
v_cvt_pk_bf16_f32 v75, v14, v15
v_mfma_f32_16x16x32_bf16 v[64:67], a[144:147], v[200:203], v[64:67]
v_exp_f32 v16, v16
v_mfma_f32_16x16x32_bf16 a[0:3], a[176:179], v[88:91], a[0:3]
ds_read_b128 a[152:155], v218 offset:49152
ds_read_b128 a[148:151], v217 offset:49152
v_mfma_f32_16x16x32_bf16 a[4:7], a[176:179], v[92:95], a[4:7]
v_exp_f32 v17, v17
v_mfma_f32_16x16x32_bf16 a[8:11], a[176:179], v[96:99], a[8:11]
ds_read_b128 a[144:147], v216 offset:49152
v_cvt_pk_bf16_f32 v76, v16, v17
v_mfma_f32_16x16x32_bf16 a[12:15], a[176:179], v[100:103], a[12:15]
v_exp_f32 v18, v18
v_mfma_f32_16x16x32_bf16 a[28:31], a[180:183], v[100:103], a[28:31]
ds_read_b64_tr_b16 a[176:177], v220 offset:32768
ds_read_b64_tr_b16 a[178:179], v220 offset:36864
v_mfma_f32_16x16x32_bf16 a[24:27], a[180:183], v[96:99], a[24:27]
v_exp_f32 v19, v19
v_mfma_f32_16x16x32_bf16 a[20:23], a[180:183], v[92:95], a[20:23]
s_add_u32 s32, s32, 16384
v_cvt_pk_bf16_f32 v77, v18, v19
v_mfma_f32_16x16x32_bf16 a[16:19], a[180:183], v[88:91], a[16:19]
v_exp_f32 v20, v20
v_mfma_f32_16x16x32_bf16 a[32:35], a[184:187], v[88:91], a[32:35]
ds_read_b64_tr_b16 a[180:181], v221 offset:32768
ds_read_b64_tr_b16 a[182:183], v221 offset:36864
v_mfma_f32_16x16x32_bf16 a[36:39], a[184:187], v[92:95], a[36:39]
v_exp_f32 v21, v21
v_mfma_f32_16x16x32_bf16 a[40:43], a[184:187], v[96:99], a[40:43]
s_bitset0_b32 s32, 19
v_cvt_pk_bf16_f32 v78, v20, v21
v_mfma_f32_16x16x32_bf16 a[44:47], a[184:187], v[100:103], a[44:47]
v_exp_f32 v22, v22
v_mfma_f32_16x16x32_bf16 a[60:63], a[188:191], v[100:103], a[60:63]
ds_read_b64_tr_b16 a[184:185], v222 offset:32768
ds_read_b64_tr_b16 a[186:187], v222 offset:36864
v_mfma_f32_16x16x32_bf16 a[56:59], a[188:191], v[96:99], a[56:59]
v_exp_f32 v23, v23
v_mfma_f32_16x16x32_bf16 a[52:55], a[188:191], v[92:95], a[52:55]
s_add_u32 m0, s30, 81920
v_cvt_pk_bf16_f32 v79, v22, v23
v_mfma_f32_16x16x32_bf16 a[48:51], a[188:191], v[88:91], a[48:51]
v_exp_f32 v24, v24
v_smfmac_f32_16x16x64_bf16 a[128:131], a[208:211], v[88:95], v245
ds_read_b64_tr_b16 a[188:189], v223 offset:32768
v_mfma_f32_16x16x32_bf16 v[44:47], a[160:163], v[152:155], v[136:139]
v_exp_f32 v25, v25
v_mfma_f32_16x16x32_bf16 v[44:47], a[164:167], v[156:159], v[44:47]
v_exp_f32 v26, v26
v_mfma_f32_16x16x32_bf16 v[44:47], a[168:171], v[160:163], v[44:47]
ds_read_b64_tr_b16 a[190:191], v223 offset:36864
v_cvt_pk_bf16_f32 v80, v24, v25
v_mfma_f32_16x16x32_bf16 v[44:47], a[172:175], v[164:167], v[44:47]
v_exp_f32 v27, v27
v_mfma_f32_16x16x32_bf16 v[52:55], a[172:175], v[180:183], v[140:143]
v_cvt_pk_bf16_f32 v81, v26, v27
v_mfma_f32_16x16x32_bf16 v[52:55], a[168:171], v[176:179], v[52:55]
v_exp_f32 v28, v28
v_mfma_f32_16x16x32_bf16 v[52:55], a[164:167], v[172:175], v[52:55]
buffer_load_dwordx4 v228, s[8:11], s32 offen offset:0  lds
v_mfma_f32_16x16x32_bf16 v[52:55], a[160:163], v[168:171], v[52:55]
v_exp_f32 v29, v29
v_mfma_f32_16x16x32_bf16 v[60:63], a[160:163], v[184:187], v[144:147]
v_cvt_pk_bf16_f32 v82, v28, v29
v_mfma_f32_16x16x32_bf16 v[60:63], a[164:167], v[188:191], v[60:63]
v_exp_f32 v30, v30
v_mfma_f32_16x16x32_bf16 v[60:63], a[168:171], v[192:195], v[60:63]
buffer_load_dwordx4 v229, s[8:11], s32 offen offset:1024  lds
v_mfma_f32_16x16x32_bf16 v[60:63], a[172:175], v[196:199], v[60:63]
v_exp_f32 v31, v31
v_mfma_f32_16x16x32_bf16 v[68:71], a[172:175], v[212:215], v[148:151]
ds_read_b128 a[172:175], v219 offset:53248
v_cvt_pk_bf16_f32 v83, v30, v31
v_mfma_f32_16x16x32_bf16 v[68:71], a[168:171], v[208:211], v[68:71]
v_exp_f32 v32, v32
v_mfma_f32_16x16x32_bf16 v[68:71], a[164:167], v[204:207], v[68:71]
ds_read_b128 a[168:171], v218 offset:53248
ds_read_b128 a[164:167], v217 offset:53248
v_mfma_f32_16x16x32_bf16 v[68:71], a[160:163], v[200:203], v[68:71]
v_exp_f32 v33, v33
v_mfma_f32_16x16x32_bf16 a[64:67], a[192:195], v[88:91], a[64:67]
ds_read_b128 a[160:163], v216 offset:53248
v_cvt_pk_bf16_f32 v84, v32, v33
v_mfma_f32_16x16x32_bf16 a[68:71], a[192:195], v[92:95], a[68:71]
v_exp_f32 v34, v34
v_mfma_f32_16x16x32_bf16 a[72:75], a[192:195], v[96:99], a[72:75]
buffer_load_dwordx4 v230, s[8:11], s32 offen offset:2048  lds
v_mfma_f32_16x16x32_bf16 a[76:79], a[192:195], v[100:103], a[76:79]
v_exp_f32 v35, v35
v_mfma_f32_16x16x32_bf16 a[92:95], a[196:199], v[100:103], a[92:95]
ds_read_b64_tr_b16 a[192:193], v224 offset:32768
v_cvt_pk_bf16_f32 v85, v34, v35
v_mfma_f32_16x16x32_bf16 a[88:91], a[196:199], v[96:99], a[88:91]
v_exp_f32 v36, v36
v_mfma_f32_16x16x32_bf16 a[84:87], a[196:199], v[92:95], a[84:87]
ds_read_b64_tr_b16 a[194:195], v224 offset:36864
v_mfma_f32_16x16x32_bf16 a[80:83], a[196:199], v[88:91], a[80:83]
v_exp_f32 v37, v37
v_mfma_f32_16x16x32_bf16 a[96:99], a[200:203], v[88:91], a[96:99]
ds_read_b64_tr_b16 a[196:197], v225 offset:32768
v_cvt_pk_bf16_f32 v86, v36, v37
v_mfma_f32_16x16x32_bf16 a[100:103], a[200:203], v[92:95], a[100:103]
v_exp_f32 v38, v38
v_mfma_f32_16x16x32_bf16 a[104:107], a[200:203], v[96:99], a[104:107]
ds_read_b64_tr_b16 a[198:199], v225 offset:36864
v_mfma_f32_16x16x32_bf16 a[108:111], a[200:203], v[100:103], a[108:111]
v_exp_f32 v39, v39
v_mfma_f32_16x16x32_bf16 a[124:127], a[204:207], v[100:103], a[124:127]
ds_read_b64_tr_b16 a[200:201], v226 offset:32768
v_cvt_pk_bf16_f32 v87, v38, v39
v_mfma_f32_16x16x32_bf16 a[120:123], a[204:207], v[96:99], a[120:123]
ds_read_b64_tr_b16 a[202:203], v226 offset:36864
v_mfma_f32_16x16x32_bf16 a[116:119], a[204:207], v[92:95], a[116:119]
buffer_load_dwordx4 v231, s[8:11], s32 offen offset:3072  lds
v_mfma_f32_16x16x32_bf16 a[112:115], a[204:207], v[88:91], a[112:115]
ds_read_b64_tr_b16 a[204:205], v227 offset:32768
ds_read_b64_tr_b16 a[206:207], v227 offset:36864
v_smfmac_f32_16x16x64_bf16 a[132:135], a[208:211], v[96:103], v245
s_mov_b32 m0, s87
s_lshl2_add_u32 s50, s87, s89
buffer_load_dwordx4 v243, s[56:59], s50 offen  lds
s_add_u32 s87, s87, 3456
s_min_u32 s87, s87, 63936
s_waitcnt lgkmcnt(8)
v_mfma_f32_16x16x32_bf16 v[8:11], a[144:147], v[152:155], v[136:139]
v_exp_f32 v40, v40
v_mfma_f32_16x16x32_bf16 v[8:11], a[148:151], v[156:159], v[8:11]
v_exp_f32 v41, v41
v_mfma_f32_16x16x32_bf16 v[8:11], a[152:155], v[160:163], v[8:11]
v_cvt_pk_bf16_f32 v88, v40, v41
v_mfma_f32_16x16x32_bf16 v[8:11], a[156:159], v[164:167], v[8:11]
v_exp_f32 v42, v42
v_mfma_f32_16x16x32_bf16 v[16:19], a[156:159], v[180:183], v[140:143]
s_add_u32 s39, s39, 16384
v_mfma_f32_16x16x32_bf16 v[16:19], a[152:155], v[176:179], v[16:19]
v_exp_f32 v43, v43
v_mfma_f32_16x16x32_bf16 v[16:19], a[148:151], v[172:175], v[16:19]
v_cvt_pk_bf16_f32 v89, v42, v43
v_mfma_f32_16x16x32_bf16 v[16:19], a[144:147], v[168:171], v[16:19]
v_exp_f32 v44, v44
v_mfma_f32_16x16x32_bf16 v[24:27], a[144:147], v[184:187], v[144:147]
s_bitset0_b32 s39, 19
v_mfma_f32_16x16x32_bf16 v[24:27], a[148:151], v[188:191], v[24:27]
v_exp_f32 v45, v45
v_mfma_f32_16x16x32_bf16 v[24:27], a[152:155], v[192:195], v[24:27]
v_cvt_pk_bf16_f32 v90, v44, v45
v_mfma_f32_16x16x32_bf16 v[24:27], a[156:159], v[196:199], v[24:27]
v_exp_f32 v46, v46
v_mfma_f32_16x16x32_bf16 v[32:35], a[156:159], v[212:215], v[148:151]
ds_read_b128 a[156:159], v219 offset:57344
v_mfma_f32_16x16x32_bf16 v[32:35], a[152:155], v[208:211], v[32:35]
v_exp_f32 v47, v47
v_mfma_f32_16x16x32_bf16 v[32:35], a[148:151], v[204:207], v[32:35]
ds_read_b128 a[152:155], v218 offset:57344
v_cvt_pk_bf16_f32 v91, v46, v47
v_mfma_f32_16x16x32_bf16 v[32:35], a[144:147], v[200:203], v[32:35]
v_exp_f32 v48, v48
v_mfma_f32_16x16x32_bf16 a[0:3], a[176:179], v[72:75], a[0:3]
ds_read_b128 a[148:151], v217 offset:57344
ds_read_b128 a[144:147], v216 offset:57344
v_mfma_f32_16x16x32_bf16 a[4:7], a[176:179], v[76:79], a[4:7]
v_exp_f32 v49, v49
v_mfma_f32_16x16x32_bf16 a[8:11], a[176:179], v[80:83], a[8:11]
s_add_u32 m0, s30, 98304
v_cvt_pk_bf16_f32 v92, v48, v49
v_mfma_f32_16x16x32_bf16 a[12:15], a[176:179], v[84:87], a[12:15]
v_exp_f32 v50, v50
v_mfma_f32_16x16x32_bf16 a[28:31], a[180:183], v[84:87], a[28:31]
ds_read_b64_tr_b16 a[176:177], v220 offset:40960
ds_read_b64_tr_b16 a[178:179], v220 offset:45056
v_mfma_f32_16x16x32_bf16 a[24:27], a[180:183], v[80:83], a[24:27]
v_exp_f32 v51, v51
v_mfma_f32_16x16x32_bf16 a[20:23], a[180:183], v[76:79], a[20:23]
v_cvt_pk_bf16_f32 v93, v50, v51
v_mfma_f32_16x16x32_bf16 a[16:19], a[180:183], v[72:75], a[16:19]
v_exp_f32 v52, v52
v_mfma_f32_16x16x32_bf16 a[32:35], a[184:187], v[72:75], a[32:35]
ds_read_b64_tr_b16 a[180:181], v221 offset:40960
ds_read_b64_tr_b16 a[182:183], v221 offset:45056
v_mfma_f32_16x16x32_bf16 a[36:39], a[184:187], v[76:79], a[36:39]
v_exp_f32 v53, v53
v_mfma_f32_16x16x32_bf16 a[40:43], a[184:187], v[80:83], a[40:43]
v_cvt_pk_bf16_f32 v94, v52, v53
v_mfma_f32_16x16x32_bf16 a[44:47], a[184:187], v[84:87], a[44:47]
v_exp_f32 v54, v54
v_mfma_f32_16x16x32_bf16 a[60:63], a[188:191], v[84:87], a[60:63]
ds_read_b64_tr_b16 a[184:185], v222 offset:40960
ds_read_b64_tr_b16 a[186:187], v222 offset:45056
v_mfma_f32_16x16x32_bf16 a[56:59], a[188:191], v[80:83], a[56:59]
v_exp_f32 v55, v55
v_mfma_f32_16x16x32_bf16 a[52:55], a[188:191], v[76:79], a[52:55]
v_cvt_pk_bf16_f32 v95, v54, v55
v_mfma_f32_16x16x32_bf16 a[48:51], a[188:191], v[72:75], a[48:51]
v_exp_f32 v56, v56
v_smfmac_f32_16x16x64_bf16 a[128:131], a[208:211], v[72:79], v245
ds_read_b64_tr_b16 a[188:189], v223 offset:40960
v_mfma_f32_16x16x32_bf16 v[12:15], a[160:163], v[152:155], v[136:139]
v_exp_f32 v57, v57
v_mfma_f32_16x16x32_bf16 v[12:15], a[164:167], v[156:159], v[12:15]
v_exp_f32 v58, v58
v_mfma_f32_16x16x32_bf16 v[12:15], a[168:171], v[160:163], v[12:15]
ds_read_b64_tr_b16 a[190:191], v223 offset:45056
v_cvt_pk_bf16_f32 v96, v56, v57
v_mfma_f32_16x16x32_bf16 v[12:15], a[172:175], v[164:167], v[12:15]
v_exp_f32 v59, v59
v_mfma_f32_16x16x32_bf16 v[20:23], a[172:175], v[180:183], v[140:143]
v_cvt_pk_bf16_f32 v97, v58, v59
v_mfma_f32_16x16x32_bf16 v[20:23], a[168:171], v[176:179], v[20:23]
v_exp_f32 v60, v60
v_mfma_f32_16x16x32_bf16 v[20:23], a[164:167], v[172:175], v[20:23]
buffer_load_dwordx4 v232, s[12:15], s39 offen offset:0  lds
v_mfma_f32_16x16x32_bf16 v[20:23], a[160:163], v[168:171], v[20:23]
v_exp_f32 v61, v61
v_mfma_f32_16x16x32_bf16 v[28:31], a[160:163], v[184:187], v[144:147]
v_cvt_pk_bf16_f32 v98, v60, v61
v_mfma_f32_16x16x32_bf16 v[28:31], a[164:167], v[188:191], v[28:31]
v_exp_f32 v62, v62
v_mfma_f32_16x16x32_bf16 v[28:31], a[168:171], v[192:195], v[28:31]
buffer_load_dwordx4 v233, s[12:15], s39 offen offset:1024  lds
v_mfma_f32_16x16x32_bf16 v[28:31], a[172:175], v[196:199], v[28:31]
v_exp_f32 v63, v63
v_mfma_f32_16x16x32_bf16 v[36:39], a[172:175], v[212:215], v[148:151]
ds_read_b128 a[172:175], v219 offset:61440
v_cvt_pk_bf16_f32 v99, v62, v63
v_mfma_f32_16x16x32_bf16 v[36:39], a[168:171], v[208:211], v[36:39]
v_exp_f32 v64, v64
v_mfma_f32_16x16x32_bf16 v[36:39], a[164:167], v[204:207], v[36:39]
ds_read_b128 a[168:171], v218 offset:61440
ds_read_b128 a[164:167], v217 offset:61440
v_mfma_f32_16x16x32_bf16 v[36:39], a[160:163], v[200:203], v[36:39]
v_exp_f32 v65, v65
s_waitcnt lgkmcnt(8)
v_mfma_f32_16x16x32_bf16 a[64:67], a[192:195], v[72:75], a[64:67]
ds_read_b128 a[160:163], v216 offset:61440
v_cvt_pk_bf16_f32 v100, v64, v65
v_mfma_f32_16x16x32_bf16 a[68:71], a[192:195], v[76:79], a[68:71]
v_exp_f32 v66, v66
v_mfma_f32_16x16x32_bf16 a[72:75], a[192:195], v[80:83], a[72:75]
buffer_load_dwordx4 v232, s[12:15], s39 offen offset:2048  lds
v_mfma_f32_16x16x32_bf16 a[76:79], a[192:195], v[84:87], a[76:79]
v_exp_f32 v67, v67
v_mfma_f32_16x16x32_bf16 a[92:95], a[196:199], v[84:87], a[92:95]
ds_read_b64_tr_b16 a[192:193], v224 offset:40960
v_cvt_pk_bf16_f32 v101, v66, v67
v_mfma_f32_16x16x32_bf16 a[88:91], a[196:199], v[80:83], a[88:91]
v_exp_f32 v68, v68
v_mfma_f32_16x16x32_bf16 a[84:87], a[196:199], v[76:79], a[84:87]
ds_read_b64_tr_b16 a[194:195], v224 offset:45056
v_mfma_f32_16x16x32_bf16 a[80:83], a[196:199], v[72:75], a[80:83]
v_exp_f32 v69, v69
v_mfma_f32_16x16x32_bf16 a[96:99], a[200:203], v[72:75], a[96:99]
ds_read_b64_tr_b16 a[196:197], v225 offset:40960
v_cvt_pk_bf16_f32 v102, v68, v69
v_mfma_f32_16x16x32_bf16 a[100:103], a[200:203], v[76:79], a[100:103]
v_exp_f32 v70, v70
v_mfma_f32_16x16x32_bf16 a[104:107], a[200:203], v[80:83], a[104:107]
ds_read_b64_tr_b16 a[198:199], v225 offset:45056
v_mfma_f32_16x16x32_bf16 a[108:111], a[200:203], v[84:87], a[108:111]
v_exp_f32 v71, v71
v_mfma_f32_16x16x32_bf16 a[124:127], a[204:207], v[84:87], a[124:127]
ds_read_b64_tr_b16 a[200:201], v226 offset:40960
v_cvt_pk_bf16_f32 v103, v70, v71
v_mfma_f32_16x16x32_bf16 a[120:123], a[204:207], v[80:83], a[120:123]
ds_read_b64_tr_b16 a[202:203], v226 offset:45056
v_mfma_f32_16x16x32_bf16 a[116:119], a[204:207], v[76:79], a[116:119]
buffer_load_dwordx4 v233, s[12:15], s39 offen offset:3072  lds
v_mfma_f32_16x16x32_bf16 a[112:115], a[204:207], v[72:75], a[112:115]
ds_read_b64_tr_b16 a[204:205], v227 offset:40960
ds_read_b64_tr_b16 a[206:207], v227 offset:45056
v_smfmac_f32_16x16x64_bf16 a[132:135], a[208:211], v[80:87], v245
buffer_load_dword v242, v241, s[20:23], s46 offen sc1
v_add_u32 v241, 1024, v241
v_and_b32 v241, 0x3fff, v241
v_mfma_f32_16x16x32_bf16 v[40:43], a[144:147], v[152:155], v[136:139]
v_exp_f32 v8, v8
v_mfma_f32_16x16x32_bf16 v[40:43], a[148:151], v[156:159], v[40:43]
v_exp_f32 v9, v9
v_mfma_f32_16x16x32_bf16 v[40:43], a[152:155], v[160:163], v[40:43]
v_cvt_pk_bf16_f32 v72, v8, v9
v_mfma_f32_16x16x32_bf16 v[40:43], a[156:159], v[164:167], v[40:43]
v_exp_f32 v10, v10
v_mfma_f32_16x16x32_bf16 v[48:51], a[156:159], v[180:183], v[140:143]
v_mfma_f32_16x16x32_bf16 v[48:51], a[152:155], v[176:179], v[48:51]
v_exp_f32 v11, v11
v_mfma_f32_16x16x32_bf16 v[48:51], a[148:151], v[172:175], v[48:51]
v_cvt_pk_bf16_f32 v73, v10, v11
v_mfma_f32_16x16x32_bf16 v[48:51], a[144:147], v[168:171], v[48:51]
v_exp_f32 v12, v12
v_mfma_f32_16x16x32_bf16 v[56:59], a[144:147], v[184:187], v[144:147]
v_mfma_f32_16x16x32_bf16 v[56:59], a[148:151], v[188:191], v[56:59]
v_exp_f32 v13, v13
v_mfma_f32_16x16x32_bf16 v[56:59], a[152:155], v[192:195], v[56:59]
v_cvt_pk_bf16_f32 v74, v12, v13
v_mfma_f32_16x16x32_bf16 v[56:59], a[156:159], v[196:199], v[56:59]
v_exp_f32 v14, v14
v_mfma_f32_16x16x32_bf16 v[64:67], a[156:159], v[212:215], v[148:151]
s_waitcnt vmcnt(10) lgkmcnt(0)
s_barrier
v_mfma_f32_16x16x32_bf16 v[64:67], a[152:155], v[208:211], v[64:67]
v_exp_f32 v15, v15
v_mfma_f32_16x16x32_bf16 v[64:67], a[148:151], v[204:207], v[64:67]
ds_read_b128 a[156:159], v219 offset:0
v_cvt_pk_bf16_f32 v75, v14, v15
v_mfma_f32_16x16x32_bf16 v[64:67], a[144:147], v[200:203], v[64:67]
v_exp_f32 v16, v16
v_mfma_f32_16x16x32_bf16 a[0:3], a[176:179], v[88:91], a[0:3]
ds_read_b128 a[152:155], v218 offset:0
ds_read_b128 a[148:151], v217 offset:0
v_mfma_f32_16x16x32_bf16 a[4:7], a[176:179], v[92:95], a[4:7]
v_exp_f32 v17, v17
v_mfma_f32_16x16x32_bf16 a[8:11], a[176:179], v[96:99], a[8:11]
ds_read_b128 a[144:147], v216 offset:0
v_cvt_pk_bf16_f32 v76, v16, v17
v_mfma_f32_16x16x32_bf16 a[12:15], a[176:179], v[100:103], a[12:15]
v_exp_f32 v18, v18
v_mfma_f32_16x16x32_bf16 a[28:31], a[180:183], v[100:103], a[28:31]
ds_read_b64_tr_b16 a[176:177], v220 offset:49152
ds_read_b64_tr_b16 a[178:179], v220 offset:53248
v_mfma_f32_16x16x32_bf16 a[24:27], a[180:183], v[96:99], a[24:27]
v_exp_f32 v19, v19
v_mfma_f32_16x16x32_bf16 a[20:23], a[180:183], v[92:95], a[20:23]
s_add_u32 s32, s32, 16384
v_cvt_pk_bf16_f32 v77, v18, v19
v_mfma_f32_16x16x32_bf16 a[16:19], a[180:183], v[88:91], a[16:19]
v_exp_f32 v20, v20
v_mfma_f32_16x16x32_bf16 a[32:35], a[184:187], v[88:91], a[32:35]
ds_read_b64_tr_b16 a[180:181], v221 offset:49152
ds_read_b64_tr_b16 a[182:183], v221 offset:53248
v_mfma_f32_16x16x32_bf16 a[36:39], a[184:187], v[92:95], a[36:39]
v_exp_f32 v21, v21
v_mfma_f32_16x16x32_bf16 a[40:43], a[184:187], v[96:99], a[40:43]
s_bitset0_b32 s32, 19
v_cvt_pk_bf16_f32 v78, v20, v21
v_mfma_f32_16x16x32_bf16 a[44:47], a[184:187], v[100:103], a[44:47]
v_exp_f32 v22, v22
v_mfma_f32_16x16x32_bf16 a[60:63], a[188:191], v[100:103], a[60:63]
ds_read_b64_tr_b16 a[184:185], v222 offset:49152
ds_read_b64_tr_b16 a[186:187], v222 offset:53248
v_mfma_f32_16x16x32_bf16 a[56:59], a[188:191], v[96:99], a[56:59]
v_exp_f32 v23, v23
v_mfma_f32_16x16x32_bf16 a[52:55], a[188:191], v[92:95], a[52:55]
s_add_u32 m0, s30, 114688
v_cvt_pk_bf16_f32 v79, v22, v23
v_mfma_f32_16x16x32_bf16 a[48:51], a[188:191], v[88:91], a[48:51]
v_exp_f32 v24, v24
v_smfmac_f32_16x16x64_bf16 a[128:131], a[208:211], v[88:95], v245
ds_read_b64_tr_b16 a[188:189], v223 offset:49152
v_mfma_f32_16x16x32_bf16 v[44:47], a[160:163], v[152:155], v[136:139]
v_exp_f32 v25, v25
v_mfma_f32_16x16x32_bf16 v[44:47], a[164:167], v[156:159], v[44:47]
v_exp_f32 v26, v26
v_mfma_f32_16x16x32_bf16 v[44:47], a[168:171], v[160:163], v[44:47]
ds_read_b64_tr_b16 a[190:191], v223 offset:53248
v_cvt_pk_bf16_f32 v80, v24, v25
v_mfma_f32_16x16x32_bf16 v[44:47], a[172:175], v[164:167], v[44:47]
v_exp_f32 v27, v27
v_mfma_f32_16x16x32_bf16 v[52:55], a[172:175], v[180:183], v[140:143]
v_cvt_pk_bf16_f32 v81, v26, v27
v_mfma_f32_16x16x32_bf16 v[52:55], a[168:171], v[176:179], v[52:55]
v_exp_f32 v28, v28
v_mfma_f32_16x16x32_bf16 v[52:55], a[164:167], v[172:175], v[52:55]
buffer_load_dwordx4 v228, s[8:11], s32 offen offset:0  lds
v_mfma_f32_16x16x32_bf16 v[52:55], a[160:163], v[168:171], v[52:55]
v_exp_f32 v29, v29
v_mfma_f32_16x16x32_bf16 v[60:63], a[160:163], v[184:187], v[144:147]
v_cvt_pk_bf16_f32 v82, v28, v29
v_mfma_f32_16x16x32_bf16 v[60:63], a[164:167], v[188:191], v[60:63]
v_exp_f32 v30, v30
v_mfma_f32_16x16x32_bf16 v[60:63], a[168:171], v[192:195], v[60:63]
buffer_load_dwordx4 v229, s[8:11], s32 offen offset:1024  lds
v_mfma_f32_16x16x32_bf16 v[60:63], a[172:175], v[196:199], v[60:63]
v_exp_f32 v31, v31
v_mfma_f32_16x16x32_bf16 v[68:71], a[172:175], v[212:215], v[148:151]
ds_read_b128 a[172:175], v219 offset:4096
v_cvt_pk_bf16_f32 v83, v30, v31
v_mfma_f32_16x16x32_bf16 v[68:71], a[168:171], v[208:211], v[68:71]
v_exp_f32 v32, v32
v_mfma_f32_16x16x32_bf16 v[68:71], a[164:167], v[204:207], v[68:71]
ds_read_b128 a[168:171], v218 offset:4096
ds_read_b128 a[164:167], v217 offset:4096
v_mfma_f32_16x16x32_bf16 v[68:71], a[160:163], v[200:203], v[68:71]
v_exp_f32 v33, v33
v_mfma_f32_16x16x32_bf16 a[64:67], a[192:195], v[88:91], a[64:67]
ds_read_b128 a[160:163], v216 offset:4096
v_cvt_pk_bf16_f32 v84, v32, v33
v_mfma_f32_16x16x32_bf16 a[68:71], a[192:195], v[92:95], a[68:71]
v_exp_f32 v34, v34
v_mfma_f32_16x16x32_bf16 a[72:75], a[192:195], v[96:99], a[72:75]
buffer_load_dwordx4 v230, s[8:11], s32 offen offset:2048  lds
v_mfma_f32_16x16x32_bf16 a[76:79], a[192:195], v[100:103], a[76:79]
v_exp_f32 v35, v35
v_mfma_f32_16x16x32_bf16 a[92:95], a[196:199], v[100:103], a[92:95]
ds_read_b64_tr_b16 a[192:193], v224 offset:49152
v_cvt_pk_bf16_f32 v85, v34, v35
v_mfma_f32_16x16x32_bf16 a[88:91], a[196:199], v[96:99], a[88:91]
v_exp_f32 v36, v36
v_mfma_f32_16x16x32_bf16 a[84:87], a[196:199], v[92:95], a[84:87]
ds_read_b64_tr_b16 a[194:195], v224 offset:53248
v_mfma_f32_16x16x32_bf16 a[80:83], a[196:199], v[88:91], a[80:83]
v_exp_f32 v37, v37
v_mfma_f32_16x16x32_bf16 a[96:99], a[200:203], v[88:91], a[96:99]
ds_read_b64_tr_b16 a[196:197], v225 offset:49152
v_cvt_pk_bf16_f32 v86, v36, v37
v_mfma_f32_16x16x32_bf16 a[100:103], a[200:203], v[92:95], a[100:103]
v_exp_f32 v38, v38
v_mfma_f32_16x16x32_bf16 a[104:107], a[200:203], v[96:99], a[104:107]
ds_read_b64_tr_b16 a[198:199], v225 offset:53248
v_mfma_f32_16x16x32_bf16 a[108:111], a[200:203], v[100:103], a[108:111]
v_exp_f32 v39, v39
v_mfma_f32_16x16x32_bf16 a[124:127], a[204:207], v[100:103], a[124:127]
ds_read_b64_tr_b16 a[200:201], v226 offset:49152
v_cvt_pk_bf16_f32 v87, v38, v39
v_mfma_f32_16x16x32_bf16 a[120:123], a[204:207], v[96:99], a[120:123]
ds_read_b64_tr_b16 a[202:203], v226 offset:53248
v_mfma_f32_16x16x32_bf16 a[116:119], a[204:207], v[92:95], a[116:119]
buffer_load_dwordx4 v231, s[8:11], s32 offen offset:3072  lds
v_mfma_f32_16x16x32_bf16 a[112:115], a[204:207], v[88:91], a[112:115]
ds_read_b64_tr_b16 a[204:205], v227 offset:49152
ds_read_b64_tr_b16 a[206:207], v227 offset:53248
v_smfmac_f32_16x16x64_bf16 a[132:135], a[208:211], v[96:103], v245
s_mov_b32 m0, s87
s_lshl2_add_u32 s50, s87, s89
buffer_load_dwordx4 v243, s[56:59], s50 offen  lds
s_add_u32 s87, s87, 3456
s_min_u32 s87, s87, 63936
s_waitcnt lgkmcnt(8)
v_mfma_f32_16x16x32_bf16 v[8:11], a[144:147], v[152:155], v[136:139]
v_exp_f32 v40, v40
v_mfma_f32_16x16x32_bf16 v[8:11], a[148:151], v[156:159], v[8:11]
v_exp_f32 v41, v41
v_mfma_f32_16x16x32_bf16 v[8:11], a[152:155], v[160:163], v[8:11]
v_cvt_pk_bf16_f32 v88, v40, v41
v_mfma_f32_16x16x32_bf16 v[8:11], a[156:159], v[164:167], v[8:11]
v_exp_f32 v42, v42
v_mfma_f32_16x16x32_bf16 v[16:19], a[156:159], v[180:183], v[140:143]
s_add_u32 s39, s39, 16384
v_mfma_f32_16x16x32_bf16 v[16:19], a[152:155], v[176:179], v[16:19]
v_exp_f32 v43, v43
v_mfma_f32_16x16x32_bf16 v[16:19], a[148:151], v[172:175], v[16:19]
v_cvt_pk_bf16_f32 v89, v42, v43
v_mfma_f32_16x16x32_bf16 v[16:19], a[144:147], v[168:171], v[16:19]
v_exp_f32 v44, v44
v_mfma_f32_16x16x32_bf16 v[24:27], a[144:147], v[184:187], v[144:147]
s_bitset0_b32 s39, 19
v_mfma_f32_16x16x32_bf16 v[24:27], a[148:151], v[188:191], v[24:27]
v_exp_f32 v45, v45
v_mfma_f32_16x16x32_bf16 v[24:27], a[152:155], v[192:195], v[24:27]
v_cvt_pk_bf16_f32 v90, v44, v45
v_mfma_f32_16x16x32_bf16 v[24:27], a[156:159], v[196:199], v[24:27]
v_exp_f32 v46, v46
v_mfma_f32_16x16x32_bf16 v[32:35], a[156:159], v[212:215], v[148:151]
ds_read_b128 a[156:159], v219 offset:8192
v_mfma_f32_16x16x32_bf16 v[32:35], a[152:155], v[208:211], v[32:35]
v_exp_f32 v47, v47
v_mfma_f32_16x16x32_bf16 v[32:35], a[148:151], v[204:207], v[32:35]
ds_read_b128 a[152:155], v218 offset:8192
v_cvt_pk_bf16_f32 v91, v46, v47
v_mfma_f32_16x16x32_bf16 v[32:35], a[144:147], v[200:203], v[32:35]
v_exp_f32 v48, v48
v_mfma_f32_16x16x32_bf16 a[0:3], a[176:179], v[72:75], a[0:3]
ds_read_b128 a[148:151], v217 offset:8192
ds_read_b128 a[144:147], v216 offset:8192
v_mfma_f32_16x16x32_bf16 a[4:7], a[176:179], v[76:79], a[4:7]
v_exp_f32 v49, v49
v_mfma_f32_16x16x32_bf16 a[8:11], a[176:179], v[80:83], a[8:11]
s_add_u32 m0, s30, 131072
v_cvt_pk_bf16_f32 v92, v48, v49
v_mfma_f32_16x16x32_bf16 a[12:15], a[176:179], v[84:87], a[12:15]
v_exp_f32 v50, v50
v_mfma_f32_16x16x32_bf16 a[28:31], a[180:183], v[84:87], a[28:31]
ds_read_b64_tr_b16 a[176:177], v220 offset:57344
ds_read_b64_tr_b16 a[178:179], v220 offset:61440
v_mfma_f32_16x16x32_bf16 a[24:27], a[180:183], v[80:83], a[24:27]
v_exp_f32 v51, v51
v_mfma_f32_16x16x32_bf16 a[20:23], a[180:183], v[76:79], a[20:23]
v_cvt_pk_bf16_f32 v93, v50, v51
v_mfma_f32_16x16x32_bf16 a[16:19], a[180:183], v[72:75], a[16:19]
v_exp_f32 v52, v52
v_mfma_f32_16x16x32_bf16 a[32:35], a[184:187], v[72:75], a[32:35]
ds_read_b64_tr_b16 a[180:181], v221 offset:57344
ds_read_b64_tr_b16 a[182:183], v221 offset:61440
v_mfma_f32_16x16x32_bf16 a[36:39], a[184:187], v[76:79], a[36:39]
v_exp_f32 v53, v53
v_mfma_f32_16x16x32_bf16 a[40:43], a[184:187], v[80:83], a[40:43]
v_cvt_pk_bf16_f32 v94, v52, v53
v_mfma_f32_16x16x32_bf16 a[44:47], a[184:187], v[84:87], a[44:47]
v_exp_f32 v54, v54
v_mfma_f32_16x16x32_bf16 a[60:63], a[188:191], v[84:87], a[60:63]
ds_read_b64_tr_b16 a[184:185], v222 offset:57344
ds_read_b64_tr_b16 a[186:187], v222 offset:61440
v_mfma_f32_16x16x32_bf16 a[56:59], a[188:191], v[80:83], a[56:59]
v_exp_f32 v55, v55
v_mfma_f32_16x16x32_bf16 a[52:55], a[188:191], v[76:79], a[52:55]
v_cvt_pk_bf16_f32 v95, v54, v55
v_mfma_f32_16x16x32_bf16 a[48:51], a[188:191], v[72:75], a[48:51]
v_exp_f32 v56, v56
v_smfmac_f32_16x16x64_bf16 a[128:131], a[208:211], v[72:79], v245
ds_read_b64_tr_b16 a[188:189], v223 offset:57344
v_mfma_f32_16x16x32_bf16 v[12:15], a[160:163], v[152:155], v[136:139]
v_exp_f32 v57, v57
v_mfma_f32_16x16x32_bf16 v[12:15], a[164:167], v[156:159], v[12:15]
v_exp_f32 v58, v58
v_mfma_f32_16x16x32_bf16 v[12:15], a[168:171], v[160:163], v[12:15]
ds_read_b64_tr_b16 a[190:191], v223 offset:61440
v_cvt_pk_bf16_f32 v96, v56, v57
v_mfma_f32_16x16x32_bf16 v[12:15], a[172:175], v[164:167], v[12:15]
v_exp_f32 v59, v59
v_mfma_f32_16x16x32_bf16 v[20:23], a[172:175], v[180:183], v[140:143]
v_cvt_pk_bf16_f32 v97, v58, v59
v_mfma_f32_16x16x32_bf16 v[20:23], a[168:171], v[176:179], v[20:23]
v_exp_f32 v60, v60
v_mfma_f32_16x16x32_bf16 v[20:23], a[164:167], v[172:175], v[20:23]
buffer_load_dwordx4 v232, s[12:15], s39 offen offset:0  lds
v_mfma_f32_16x16x32_bf16 v[20:23], a[160:163], v[168:171], v[20:23]
STUB_11:
STUB_B2:
s_cbranch_execz STUB_14
v_exp_f32 v61, v61
v_mfma_f32_16x16x32_bf16 v[28:31], a[160:163], v[184:187], v[144:147]
v_cvt_pk_bf16_f32 v98, v60, v61
v_mfma_f32_16x16x32_bf16 v[28:31], a[164:167], v[188:191], v[28:31]
v_exp_f32 v62, v62
v_mfma_f32_16x16x32_bf16 v[28:31], a[168:171], v[192:195], v[28:31]
buffer_load_dwordx4 v233, s[12:15], s39 offen offset:1024  lds
v_mfma_f32_16x16x32_bf16 v[28:31], a[172:175], v[196:199], v[28:31]
v_exp_f32 v63, v63
v_mfma_f32_16x16x32_bf16 v[36:39], a[172:175], v[212:215], v[148:151]
ds_read_b128 a[172:175], v219 offset:12288
v_cvt_pk_bf16_f32 v99, v62, v63
v_mfma_f32_16x16x32_bf16 v[36:39], a[168:171], v[208:211], v[36:39]
v_exp_f32 v64, v64
v_mfma_f32_16x16x32_bf16 v[36:39], a[164:167], v[204:207], v[36:39]
ds_read_b128 a[168:171], v218 offset:12288
ds_read_b128 a[164:167], v217 offset:12288
v_mfma_f32_16x16x32_bf16 v[36:39], a[160:163], v[200:203], v[36:39]
v_exp_f32 v65, v65
s_waitcnt lgkmcnt(8)
v_mfma_f32_16x16x32_bf16 a[64:67], a[192:195], v[72:75], a[64:67]
ds_read_b128 a[160:163], v216 offset:12288
v_cvt_pk_bf16_f32 v100, v64, v65
v_mfma_f32_16x16x32_bf16 a[68:71], a[192:195], v[76:79], a[68:71]
v_exp_f32 v66, v66
v_mfma_f32_16x16x32_bf16 a[72:75], a[192:195], v[80:83], a[72:75]
buffer_load_dwordx4 v232, s[12:15], s39 offen offset:2048  lds
v_mfma_f32_16x16x32_bf16 a[76:79], a[192:195], v[84:87], a[76:79]
v_exp_f32 v67, v67
v_mfma_f32_16x16x32_bf16 a[92:95], a[196:199], v[84:87], a[92:95]
ds_read_b64_tr_b16 a[192:193], v224 offset:57344
v_cvt_pk_bf16_f32 v101, v66, v67
v_mfma_f32_16x16x32_bf16 a[88:91], a[196:199], v[80:83], a[88:91]
v_exp_f32 v68, v68
v_mfma_f32_16x16x32_bf16 a[84:87], a[196:199], v[76:79], a[84:87]
ds_read_b64_tr_b16 a[194:195], v224 offset:61440
v_mfma_f32_16x16x32_bf16 a[80:83], a[196:199], v[72:75], a[80:83]
v_exp_f32 v69, v69
v_mfma_f32_16x16x32_bf16 a[96:99], a[200:203], v[72:75], a[96:99]
ds_read_b64_tr_b16 a[196:197], v225 offset:57344
v_cvt_pk_bf16_f32 v102, v68, v69
v_mfma_f32_16x16x32_bf16 a[100:103], a[200:203], v[76:79], a[100:103]
v_exp_f32 v70, v70
v_mfma_f32_16x16x32_bf16 a[104:107], a[200:203], v[80:83], a[104:107]
ds_read_b64_tr_b16 a[198:199], v225 offset:61440
v_mfma_f32_16x16x32_bf16 a[108:111], a[200:203], v[84:87], a[108:111]
v_exp_f32 v71, v71
v_mfma_f32_16x16x32_bf16 a[124:127], a[204:207], v[84:87], a[124:127]
ds_read_b64_tr_b16 a[200:201], v226 offset:57344
v_cvt_pk_bf16_f32 v103, v70, v71
v_mfma_f32_16x16x32_bf16 a[120:123], a[204:207], v[80:83], a[120:123]
ds_read_b64_tr_b16 a[202:203], v226 offset:61440
v_mfma_f32_16x16x32_bf16 a[116:119], a[204:207], v[76:79], a[116:119]
buffer_load_dwordx4 v233, s[12:15], s39 offen offset:3072  lds
v_mfma_f32_16x16x32_bf16 a[112:115], a[204:207], v[72:75], a[112:115]
ds_read_b64_tr_b16 a[204:205], v227 offset:57344
ds_read_b64_tr_b16 a[206:207], v227 offset:61440
v_smfmac_f32_16x16x64_bf16 a[132:135], a[208:211], v[80:87], v245
s_sub_u32 s33, s33, 1
buffer_load_dword v242, v241, s[20:23], s46 offen sc1
s_cmp_lg_u32 s33, 0
v_add_u32 v241, 1024, v241
v_and_b32 v241, 0x3fff, v241
s_cbranch_scc1 K_LOOP
K_LAST:
v_mfma_f32_16x16x32_bf16 v[40:43], a[144:147], v[152:155], v[136:139]
v_and_b32 v246, 15, v1
v_exp_f32 v8, v8
v_mfma_f32_16x16x32_bf16 v[40:43], a[148:151], v[156:159], v[40:43]
v_lshrrev_b32 v247, 3, v246
v_exp_f32 v9, v9
v_mfma_f32_16x16x32_bf16 v[40:43], a[152:155], v[160:163], v[40:43]
v_cvt_pk_bf16_f32 v72, v8, v9
v_and_b32 v246, 7, v246
v_lshlrev_b32 v246, 6, v246
v_mfma_f32_16x16x32_bf16 v[40:43], a[156:159], v[164:167], v[40:43]
v_lshl_add_u32 v246, v247, 13, v246
v_exp_f32 v10, v10
v_mfma_f32_16x16x32_bf16 v[48:51], a[156:159], v[180:183], v[140:143]
s_lshl_b32 s28, s36, 9
s_add_u32 s28, s28, 0x248000
v_mfma_f32_16x16x32_bf16 v[48:51], a[152:155], v[176:179], v[48:51]
v_exp_f32 v11, v11
v_mfma_f32_16x16x32_bf16 v[48:51], a[148:151], v[172:175], v[48:51]
v_cvt_pk_bf16_f32 v73, v10, v11
v_mfma_f32_16x16x32_bf16 v[48:51], a[144:147], v[168:171], v[48:51]
v_exp_f32 v12, v12
v_mfma_f32_16x16x32_bf16 v[56:59], a[144:147], v[184:187], v[144:147]
v_mfma_f32_16x16x32_bf16 v[56:59], a[148:151], v[188:191], v[56:59]
v_exp_f32 v13, v13
v_mfma_f32_16x16x32_bf16 v[56:59], a[152:155], v[192:195], v[56:59]
v_cvt_pk_bf16_f32 v74, v12, v13
v_mfma_f32_16x16x32_bf16 v[56:59], a[156:159], v[196:199], v[56:59]
v_exp_f32 v14, v14
v_mfma_f32_16x16x32_bf16 v[64:67], a[156:159], v[212:215], v[148:151]
s_waitcnt vmcnt(10) lgkmcnt(0)
s_barrier
v_mfma_f32_16x16x32_bf16 v[64:67], a[152:155], v[208:211], v[64:67]
v_exp_f32 v15, v15
v_mfma_f32_16x16x32_bf16 v[64:67], a[148:151], v[204:207], v[64:67]
ds_read_b128 a[156:159], v219 offset:16384
v_cvt_pk_bf16_f32 v75, v14, v15
v_mfma_f32_16x16x32_bf16 v[64:67], a[144:147], v[200:203], v[64:67]
v_exp_f32 v16, v16
v_mfma_f32_16x16x32_bf16 a[0:3], a[176:179], v[88:91], a[0:3]
ds_read_b128 a[152:155], v218 offset:16384
ds_read_b128 a[148:151], v217 offset:16384
v_mfma_f32_16x16x32_bf16 a[4:7], a[176:179], v[92:95], a[4:7]
v_exp_f32 v17, v17
v_mfma_f32_16x16x32_bf16 a[8:11], a[176:179], v[96:99], a[8:11]
ds_read_b128 a[144:147], v216 offset:16384
v_cvt_pk_bf16_f32 v76, v16, v17
v_mfma_f32_16x16x32_bf16 a[12:15], a[176:179], v[100:103], a[12:15]
v_exp_f32 v18, v18
v_mfma_f32_16x16x32_bf16 a[28:31], a[180:183], v[100:103], a[28:31]
ds_read_b64_tr_b16 a[176:177], v220 offset:0
ds_read_b64_tr_b16 a[178:179], v220 offset:4096
v_mfma_f32_16x16x32_bf16 a[24:27], a[180:183], v[96:99], a[24:27]
v_exp_f32 v19, v19
v_mfma_f32_16x16x32_bf16 a[20:23], a[180:183], v[92:95], a[20:23]
buffer_load_dword v242, v246, s[20:23], s28 offen sc1
v_cvt_pk_bf16_f32 v77, v18, v19
v_mfma_f32_16x16x32_bf16 a[16:19], a[180:183], v[88:91], a[16:19]
v_bfe_u32 v246, v1, 2, 2
v_exp_f32 v20, v20
v_mfma_f32_16x16x32_bf16 a[32:35], a[184:187], v[88:91], a[32:35]
ds_read_b64_tr_b16 a[180:181], v221 offset:0
ds_read_b64_tr_b16 a[182:183], v221 offset:4096
v_lshl_add_u32 v246, v4, 2, v246
v_mfma_f32_16x16x32_bf16 a[36:39], a[184:187], v[92:95], a[36:39]
v_mul_u32_u24 v246, 288, v246
v_exp_f32 v21, v21
v_mfma_f32_16x16x32_bf16 a[40:43], a[184:187], v[96:99], a[40:43]
v_cvt_pk_bf16_f32 v78, v20, v21
v_and_b32 v247, 3, v1
v_lshl_add_u32 v236, v247, 3, v246
v_mfma_f32_16x16x32_bf16 a[44:47], a[184:187], v[100:103], a[44:47]
v_add_u32 v236, 256, v236
v_exp_f32 v22, v22
v_mfma_f32_16x16x32_bf16 a[60:63], a[188:191], v[100:103], a[60:63]
ds_read_b64_tr_b16 a[184:185], v222 offset:0
ds_read_b64_tr_b16 a[186:187], v222 offset:4096
v_lshl_add_u32 v246, v247, 4, v246
v_mfma_f32_16x16x32_bf16 a[56:59], a[188:191], v[96:99], a[56:59]
v_exp_f32 v23, v23
v_mfma_f32_16x16x32_bf16 a[52:55], a[188:191], v[92:95], a[52:55]
s_lshr_b32 s28, s35, 4
s_lshl_b32 s28, s28, 6
v_cvt_pk_bf16_f32 v79, v22, v23
v_mfma_f32_16x16x32_bf16 a[48:51], a[188:191], v[88:91], a[48:51]
v_add_u32 v234, s28, v246
v_exp_f32 v24, v24
v_smfmac_f32_16x16x64_bf16 a[128:131], a[208:211], v[88:95], v245
ds_read_b64_tr_b16 a[188:189], v223 offset:0
s_xor_b32 s28, s28, 64
v_mfma_f32_16x16x32_bf16 v[44:47], a[160:163], v[152:155], v[136:139]
v_add_u32 v235, s28, v246
v_exp_f32 v25, v25
v_mfma_f32_16x16x32_bf16 v[44:47], a[164:167], v[156:159], v[44:47]
v_exp_f32 v26, v26
v_mfma_f32_16x16x32_bf16 v[44:47], a[168:171], v[160:163], v[44:47]
ds_read_b64_tr_b16 a[190:191], v223 offset:4096
v_cvt_pk_bf16_f32 v80, v24, v25
v_mfma_f32_16x16x32_bf16 v[44:47], a[172:175], v[164:167], v[44:47]
v_exp_f32 v27, v27
v_mfma_f32_16x16x32_bf16 v[52:55], a[172:175], v[180:183], v[140:143]
s_add_u32 s28, s35, 0
s_and_b32 s28, s28, 3
v_cvt_pk_bf16_f32 v81, v26, v27
v_mfma_f32_16x16x32_bf16 v[52:55], a[168:171], v[176:179], v[52:55]
s_mul_i32 s28, s28, 36864
v_exp_f32 v28, v28
v_mfma_f32_16x16x32_bf16 v[52:55], a[164:167], v[172:175], v[52:55]
s_add_u32 m0, s88, 62208
s_lshl2_add_u32 s50, m0, s89
buffer_load_dwordx4 v243, s[56:59], s50 offen  lds
v_mfma_f32_16x16x32_bf16 v[52:55], a[160:163], v[168:171], v[52:55]
v_add_u32 v237, s28, v234
v_exp_f32 v29, v29
v_mfma_f32_16x16x32_bf16 v[60:63], a[160:163], v[184:187], v[144:147]
v_cvt_pk_bf16_f32 v82, v28, v29
v_add_u32 v238, s28, v235
v_add_u32 v239, s28, v236
v_mfma_f32_16x16x32_bf16 v[60:63], a[164:167], v[188:191], v[60:63]
v_mov_b32 v254, 0x7ffffff0
v_exp_f32 v30, v30
v_mfma_f32_16x16x32_bf16 v[60:63], a[168:171], v[192:195], v[60:63]
s_add_u32 m0, s88, 65664
s_lshl2_add_u32 s50, m0, s89
buffer_load_dwordx4 v243, s[56:59], s50 offen  lds
v_mfma_f32_16x16x32_bf16 v[60:63], a[172:175], v[196:199], v[60:63]
s_lshl2_add_u32 s92, s36, s37
v_exp_f32 v31, v31
v_mfma_f32_16x16x32_bf16 v[68:71], a[172:175], v[212:215], v[148:151]
ds_read_b128 a[172:175], v219 offset:20480
s_bfe_u32 s93, s35, 0x20002
v_cvt_pk_bf16_f32 v83, v30, v31
v_mfma_f32_16x16x32_bf16 v[68:71], a[168:171], v[208:211], v[68:71]
s_lshl2_add_u32 s92, s92, s93
v_exp_f32 v32, v32
v_mfma_f32_16x16x32_bf16 v[68:71], a[164:167], v[204:207], v[68:71]
ds_read_b128 a[168:171], v218 offset:20480
ds_read_b128 a[164:167], v217 offset:20480
s_lshl_b32 s93, s92, 4
v_mfma_f32_16x16x32_bf16 v[68:71], a[160:163], v[200:203], v[68:71]
v_add_u32 v132, s93, v3
v_exp_f32 v33, v33
v_mfma_f32_16x16x32_bf16 a[64:67], a[192:195], v[88:91], a[64:67]
ds_read_b128 a[160:163], v216 offset:20480
v_cvt_pk_bf16_f32 v84, v32, v33
v_writelane_b32 v254, 0, 0
v_mfma_f32_16x16x32_bf16 a[68:71], a[192:195], v[92:95], a[68:71]
s_and_b32 s93, s35, 3
v_exp_f32 v34, v34
v_mfma_f32_16x16x32_bf16 a[72:75], a[192:195], v[96:99], a[72:75]
s_add_u32 m0, s88, 69120
s_lshl2_add_u32 s50, m0, s89
buffer_load_dwordx4 v243, s[56:59], s50 offen  lds
v_mfma_f32_16x16x32_bf16 a[76:79], a[192:195], v[100:103], a[76:79]
s_mul_i32 s93, s93, 144
v_exp_f32 v35, v35
v_mfma_f32_16x16x32_bf16 a[92:95], a[196:199], v[100:103], a[92:95]
ds_read_b64_tr_b16 a[192:193], v224 offset:0
v_cvt_pk_bf16_f32 v85, v34, v35
v_lshlrev_b32 v251, 2, v4
v_mfma_f32_16x16x32_bf16 a[88:91], a[196:199], v[96:99], a[88:91]
v_add_u32 v251, s93, v251
v_exp_f32 v36, v36
v_mfma_f32_16x16x32_bf16 a[84:87], a[196:199], v[92:95], a[84:87]
ds_read_b64_tr_b16 a[194:195], v224 offset:4096
v_add_u32 v251, 128, v251
v_lshlrev_b32 v250, 3, v4
v_mfma_f32_16x16x32_bf16 a[80:83], a[196:199], v[88:91], a[80:83]
s_lshr_b32 s90, s35, 4
v_exp_f32 v37, v37
v_mfma_f32_16x16x32_bf16 a[96:99], a[200:203], v[88:91], a[96:99]
ds_read_b64_tr_b16 a[196:197], v225 offset:0
s_lshl_b32 s90, s90, 5
v_cvt_pk_bf16_f32 v86, v36, v37
v_mfma_f32_16x16x32_bf16 a[100:103], a[200:203], v[92:95], a[100:103]
s_add_u32 s93, s93, s90
v_exp_f32 v38, v38
v_mfma_f32_16x16x32_bf16 a[104:107], a[200:203], v[96:99], a[104:107]
ds_read_b64_tr_b16 a[198:199], v225 offset:4096
v_add_u32 v250, s93, v250
v_lshlrev_b32 v250, 1, v250
v_mfma_f32_16x16x32_bf16 a[108:111], a[200:203], v[100:103], a[108:111]
v_lshlrev_b32 v251, 1, v251
v_exp_f32 v39, v39
v_mfma_f32_16x16x32_bf16 a[124:127], a[204:207], v[100:103], a[124:127]
ds_read_b64_tr_b16 a[200:201], v226 offset:0
v_cvt_pk_bf16_f32 v87, v38, v39
v_mul_u32_u24 v133, 0x480, v132
v_mfma_f32_16x16x32_bf16 a[120:123], a[204:207], v[96:99], a[120:123]
ds_read_b64_tr_b16 a[202:203], v226 offset:4096
v_add_u32 v248, v133, v250
v_add_u32 v249, v133, v251
v_mfma_f32_16x16x32_bf16 a[116:119], a[204:207], v[92:95], a[116:119]
v_mov_b32 v135, 0x7fffbff0
v_mfma_f32_16x16x32_bf16 a[112:115], a[204:207], v[88:91], a[112:115]
ds_read_b64_tr_b16 a[204:205], v227 offset:0
ds_read_b64_tr_b16 a[206:207], v227 offset:4096
v_smfmac_f32_16x16x64_bf16 a[132:135], a[208:211], v[96:103], v245
s_mov_b32 s93, 0x243080
buffer_load_dword v246, v254, s[20:23], s93 offen sc0 sc1
s_waitcnt lgkmcnt(8)
v_mfma_f32_16x16x32_bf16 v[8:11], a[144:147], v[152:155], v[136:139]
v_exp_f32 v40, v40
v_mfma_f32_16x16x32_bf16 v[8:11], a[148:151], v[156:159], v[8:11]
v_exp_f32 v41, v41
v_mfma_f32_16x16x32_bf16 v[8:11], a[152:155], v[160:163], v[8:11]
s_mov_b32 s92, 0x1c00000
v_cvt_pk_bf16_f32 v88, v40, v41
v_mfma_f32_16x16x32_bf16 v[8:11], a[156:159], v[164:167], v[8:11]
v_exp_f32 v42, v42
v_mfma_f32_16x16x32_bf16 v[16:19], a[156:159], v[180:183], v[140:143]
s_add_u32 s39, s39, 16384
v_mfma_f32_16x16x32_bf16 v[16:19], a[152:155], v[176:179], v[16:19]
v_exp_f32 v43, v43
v_mfma_f32_16x16x32_bf16 v[16:19], a[148:151], v[172:175], v[16:19]
v_cvt_pk_bf16_f32 v89, v42, v43
v_mfma_f32_16x16x32_bf16 v[16:19], a[144:147], v[168:171], v[16:19]
v_exp_f32 v44, v44
v_mfma_f32_16x16x32_bf16 v[24:27], a[144:147], v[184:187], v[144:147]
v_mfma_f32_16x16x32_bf16 v[24:27], a[148:151], v[188:191], v[24:27]
v_exp_f32 v45, v45
v_mfma_f32_16x16x32_bf16 v[24:27], a[152:155], v[192:195], v[24:27]
s_bitset0_b32 s39, 19
v_cvt_pk_bf16_f32 v90, v44, v45
v_mfma_f32_16x16x32_bf16 v[24:27], a[156:159], v[196:199], v[24:27]
v_exp_f32 v46, v46
v_mfma_f32_16x16x32_bf16 v[32:35], a[156:159], v[212:215], v[148:151]
ds_read_b128 a[156:159], v219 offset:24576
buffer_load_dwordx4 a[222:225], v248, s[20:23], s92 offen offset:0 sc0 sc1
v_mfma_f32_16x16x32_bf16 v[32:35], a[152:155], v[208:211], v[32:35]
v_exp_f32 v47, v47
v_mfma_f32_16x16x32_bf16 v[32:35], a[148:151], v[204:207], v[32:35]
ds_read_b128 a[152:155], v218 offset:24576
v_cvt_pk_bf16_f32 v91, v46, v47
v_mfma_f32_16x16x32_bf16 v[32:35], a[144:147], v[200:203], v[32:35]
v_exp_f32 v48, v48
v_mfma_f32_16x16x32_bf16 a[0:3], a[176:179], v[72:75], a[0:3]
ds_read_b128 a[148:151], v217 offset:24576
ds_read_b128 a[144:147], v216 offset:24576
v_mfma_f32_16x16x32_bf16 a[4:7], a[176:179], v[76:79], a[4:7]
v_exp_f32 v49, v49
v_mfma_f32_16x16x32_bf16 a[8:11], a[176:179], v[80:83], a[8:11]
s_add_u32 m0, s30, 147456
v_cvt_pk_bf16_f32 v92, v48, v49
v_mfma_f32_16x16x32_bf16 a[12:15], a[176:179], v[84:87], a[12:15]
v_exp_f32 v50, v50
v_mfma_f32_16x16x32_bf16 a[28:31], a[180:183], v[84:87], a[28:31]
ds_read_b64_tr_b16 a[176:177], v220 offset:8192
ds_read_b64_tr_b16 a[178:179], v220 offset:12288
v_mfma_f32_16x16x32_bf16 a[24:27], a[180:183], v[80:83], a[24:27]
v_exp_f32 v51, v51
v_mfma_f32_16x16x32_bf16 a[20:23], a[180:183], v[76:79], a[20:23]
buffer_load_dwordx4 a[226:229], v248, s[20:23], s92 offen offset:128 sc0 sc1
v_cvt_pk_bf16_f32 v93, v50, v51
v_mfma_f32_16x16x32_bf16 a[16:19], a[180:183], v[72:75], a[16:19]
v_exp_f32 v52, v52
v_mfma_f32_16x16x32_bf16 a[32:35], a[184:187], v[72:75], a[32:35]
ds_read_b64_tr_b16 a[180:181], v221 offset:8192
ds_read_b64_tr_b16 a[182:183], v221 offset:12288
v_mfma_f32_16x16x32_bf16 a[36:39], a[184:187], v[76:79], a[36:39]
v_exp_f32 v53, v53
v_mfma_f32_16x16x32_bf16 a[40:43], a[184:187], v[80:83], a[40:43]
v_cvt_pk_bf16_f32 v94, v52, v53
v_mfma_f32_16x16x32_bf16 a[44:47], a[184:187], v[84:87], a[44:47]
v_exp_f32 v54, v54
v_mfma_f32_16x16x32_bf16 a[60:63], a[188:191], v[84:87], a[60:63]
ds_read_b64_tr_b16 a[184:185], v222 offset:8192
ds_read_b64_tr_b16 a[186:187], v222 offset:12288
v_mfma_f32_16x16x32_bf16 a[56:59], a[188:191], v[80:83], a[56:59]
v_exp_f32 v55, v55
v_mfma_f32_16x16x32_bf16 a[52:55], a[188:191], v[76:79], a[52:55]
v_cvt_pk_bf16_f32 v95, v54, v55
v_mfma_f32_16x16x32_bf16 a[48:51], a[188:191], v[72:75], a[48:51]
v_exp_f32 v56, v56
v_smfmac_f32_16x16x64_bf16 a[128:131], a[208:211], v[72:79], v245
ds_read_b64_tr_b16 a[188:189], v223 offset:8192
v_mfma_f32_16x16x32_bf16 v[12:15], a[160:163], v[152:155], v[136:139]
v_exp_f32 v57, v57
v_mfma_f32_16x16x32_bf16 v[12:15], a[164:167], v[156:159], v[12:15]
v_exp_f32 v58, v58
v_mfma_f32_16x16x32_bf16 v[12:15], a[168:171], v[160:163], v[12:15]
ds_read_b64_tr_b16 a[190:191], v223 offset:12288
v_cvt_pk_bf16_f32 v96, v56, v57
v_mfma_f32_16x16x32_bf16 v[12:15], a[172:175], v[164:167], v[12:15]
v_exp_f32 v59, v59
v_mfma_f32_16x16x32_bf16 v[20:23], a[172:175], v[180:183], v[140:143]
buffer_load_dwordx2 a[230:231], v249, s[20:23], s92 offen sc0 sc1
v_cvt_pk_bf16_f32 v97, v58, v59
v_mfma_f32_16x16x32_bf16 v[20:23], a[168:171], v[176:179], v[20:23]
v_exp_f32 v60, v60
v_mfma_f32_16x16x32_bf16 v[20:23], a[164:167], v[172:175], v[20:23]
buffer_load_dwordx4 v232, s[12:15], s39 offen offset:0  lds
v_mfma_f32_16x16x32_bf16 v[20:23], a[160:163], v[168:171], v[20:23]
v_exp_f32 v61, v61
v_mfma_f32_16x16x32_bf16 v[28:31], a[160:163], v[184:187], v[144:147]
v_cvt_pk_bf16_f32 v98, v60, v61
v_mfma_f32_16x16x32_bf16 v[28:31], a[164:167], v[188:191], v[28:31]
v_exp_f32 v62, v62
v_mfma_f32_16x16x32_bf16 v[28:31], a[168:171], v[192:195], v[28:31]
buffer_load_dwordx4 v233, s[12:15], s39 offen offset:1024  lds
v_mfma_f32_16x16x32_bf16 v[28:31], a[172:175], v[196:199], v[28:31]
v_exp_f32 v63, v63
v_mfma_f32_16x16x32_bf16 v[36:39], a[172:175], v[212:215], v[148:151]
ds_read_b128 a[172:175], v219 offset:28672
v_cvt_pk_bf16_f32 v99, v62, v63
v_mfma_f32_16x16x32_bf16 v[36:39], a[168:171], v[208:211], v[36:39]
v_exp_f32 v64, v64
v_mfma_f32_16x16x32_bf16 v[36:39], a[164:167], v[204:207], v[36:39]
ds_read_b128 a[168:171], v218 offset:28672
ds_read_b128 a[164:167], v217 offset:28672
v_mfma_f32_16x16x32_bf16 v[36:39], a[160:163], v[200:203], v[36:39]
v_exp_f32 v65, v65
s_waitcnt lgkmcnt(8)
v_mfma_f32_16x16x32_bf16 a[64:67], a[192:195], v[72:75], a[64:67]
ds_read_b128 a[160:163], v216 offset:28672
v_cvt_pk_bf16_f32 v100, v64, v65
v_mfma_f32_16x16x32_bf16 a[68:71], a[192:195], v[76:79], a[68:71]
v_exp_f32 v66, v66
v_mfma_f32_16x16x32_bf16 a[72:75], a[192:195], v[80:83], a[72:75]
buffer_load_dwordx4 v232, s[12:15], s39 offen offset:2048  lds
v_mfma_f32_16x16x32_bf16 a[76:79], a[192:195], v[84:87], a[76:79]
v_exp_f32 v67, v67
v_mfma_f32_16x16x32_bf16 a[92:95], a[196:199], v[84:87], a[92:95]
ds_read_b64_tr_b16 a[192:193], v224 offset:8192
v_cvt_pk_bf16_f32 v101, v66, v67
v_mfma_f32_16x16x32_bf16 a[88:91], a[196:199], v[80:83], a[88:91]
v_exp_f32 v68, v68
v_mfma_f32_16x16x32_bf16 a[84:87], a[196:199], v[76:79], a[84:87]
ds_read_b64_tr_b16 a[194:195], v224 offset:12288
buffer_load_dwordx4 a[212:215], v248, s[52:55], 0 offen offset:0
v_mfma_f32_16x16x32_bf16 a[80:83], a[196:199], v[72:75], a[80:83]
v_exp_f32 v69, v69
v_mfma_f32_16x16x32_bf16 a[96:99], a[200:203], v[72:75], a[96:99]
ds_read_b64_tr_b16 a[196:197], v225 offset:8192
v_cvt_pk_bf16_f32 v102, v68, v69
v_mfma_f32_16x16x32_bf16 a[100:103], a[200:203], v[76:79], a[100:103]
v_exp_f32 v70, v70
v_mfma_f32_16x16x32_bf16 a[104:107], a[200:203], v[80:83], a[104:107]
ds_read_b64_tr_b16 a[198:199], v225 offset:12288
v_mfma_f32_16x16x32_bf16 a[108:111], a[200:203], v[84:87], a[108:111]
v_exp_f32 v71, v71
v_mfma_f32_16x16x32_bf16 a[124:127], a[204:207], v[84:87], a[124:127]
ds_read_b64_tr_b16 a[200:201], v226 offset:8192
v_cvt_pk_bf16_f32 v103, v70, v71
v_mfma_f32_16x16x32_bf16 a[120:123], a[204:207], v[80:83], a[120:123]
ds_read_b64_tr_b16 a[202:203], v226 offset:12288
v_mfma_f32_16x16x32_bf16 a[116:119], a[204:207], v[76:79], a[116:119]
buffer_load_dwordx4 v233, s[12:15], s39 offen offset:3072  lds
v_mfma_f32_16x16x32_bf16 a[112:115], a[204:207], v[72:75], a[112:115]
ds_read_b64_tr_b16 a[204:205], v227 offset:8192
ds_read_b64_tr_b16 a[206:207], v227 offset:12288
v_smfmac_f32_16x16x64_bf16 a[132:135], a[208:211], v[80:87], v245
s_add_u32 m0, s88, 72576
s_lshl2_add_u32 s50, m0, s89
buffer_load_dwordx4 v243, s[56:59], s50 offen  lds
s_add_u32 m0, s88, 76032
s_lshl2_add_u32 s50, m0, s89
buffer_load_dwordx4 v243, s[56:59], s50 offen  lds
v_mfma_f32_16x16x32_bf16 v[40:43], a[144:147], v[152:155], v[136:139]
v_exp_f32 v8, v8
v_mfma_f32_16x16x32_bf16 v[40:43], a[148:151], v[156:159], v[40:43]
v_exp_f32 v9, v9
v_mfma_f32_16x16x32_bf16 v[40:43], a[152:155], v[160:163], v[40:43]
v_cvt_pk_bf16_f32 v72, v8, v9
v_mfma_f32_16x16x32_bf16 v[40:43], a[156:159], v[164:167], v[40:43]
v_exp_f32 v10, v10
v_mfma_f32_16x16x32_bf16 v[48:51], a[156:159], v[180:183], v[140:143]
v_mfma_f32_16x16x32_bf16 v[48:51], a[152:155], v[176:179], v[48:51]
v_exp_f32 v11, v11
v_mfma_f32_16x16x32_bf16 v[48:51], a[148:151], v[172:175], v[48:51]
v_cvt_pk_bf16_f32 v73, v10, v11
v_mfma_f32_16x16x32_bf16 v[48:51], a[144:147], v[168:171], v[48:51]
v_exp_f32 v12, v12
v_mfma_f32_16x16x32_bf16 v[56:59], a[144:147], v[184:187], v[144:147]
v_mfma_f32_16x16x32_bf16 v[56:59], a[148:151], v[188:191], v[56:59]
v_exp_f32 v13, v13
v_mfma_f32_16x16x32_bf16 v[56:59], a[152:155], v[192:195], v[56:59]
v_cvt_pk_bf16_f32 v74, v12, v13
v_mfma_f32_16x16x32_bf16 v[56:59], a[156:159], v[196:199], v[56:59]
v_exp_f32 v14, v14
v_mfma_f32_16x16x32_bf16 v[64:67], a[156:159], v[212:215], v[148:151]
s_waitcnt vmcnt(15) lgkmcnt(0)
s_barrier
v_mfma_f32_16x16x32_bf16 v[64:67], a[152:155], v[208:211], v[64:67]
v_exp_f32 v15, v15
v_mfma_f32_16x16x32_bf16 v[64:67], a[148:151], v[204:207], v[64:67]
ds_read_b128 a[156:159], v219 offset:49152
v_cvt_pk_bf16_f32 v75, v14, v15
v_mfma_f32_16x16x32_bf16 v[64:67], a[144:147], v[200:203], v[64:67]
v_exp_f32 v16, v16
v_mfma_f32_16x16x32_bf16 a[0:3], a[176:179], v[88:91], a[0:3]
ds_read_b128 a[152:155], v218 offset:49152
ds_read_b128 a[148:151], v217 offset:49152
v_mfma_f32_16x16x32_bf16 a[4:7], a[176:179], v[92:95], a[4:7]
v_exp_f32 v17, v17
v_mfma_f32_16x16x32_bf16 a[8:11], a[176:179], v[96:99], a[8:11]
ds_read_b128 a[144:147], v216 offset:49152
v_cvt_pk_bf16_f32 v76, v16, v17
v_mfma_f32_16x16x32_bf16 a[12:15], a[176:179], v[100:103], a[12:15]
v_exp_f32 v18, v18
v_mfma_f32_16x16x32_bf16 a[28:31], a[180:183], v[100:103], a[28:31]
ds_read_b64_tr_b16 a[176:177], v220 offset:32768
ds_read_b64_tr_b16 a[178:179], v220 offset:36864
v_mfma_f32_16x16x32_bf16 a[24:27], a[180:183], v[96:99], a[24:27]
v_exp_f32 v19, v19
v_mfma_f32_16x16x32_bf16 a[20:23], a[180:183], v[92:95], a[20:23]
buffer_load_dwordx4 a[216:219], v248, s[52:55], 0 offen offset:128
v_cvt_pk_bf16_f32 v77, v18, v19
v_mfma_f32_16x16x32_bf16 a[16:19], a[180:183], v[88:91], a[16:19]
v_exp_f32 v20, v20
v_mfma_f32_16x16x32_bf16 a[32:35], a[184:187], v[88:91], a[32:35]
ds_read_b64_tr_b16 a[180:181], v221 offset:32768
ds_read_b64_tr_b16 a[182:183], v221 offset:36864
v_mfma_f32_16x16x32_bf16 a[36:39], a[184:187], v[92:95], a[36:39]
v_exp_f32 v21, v21
v_mfma_f32_16x16x32_bf16 a[40:43], a[184:187], v[96:99], a[40:43]
v_cvt_pk_bf16_f32 v78, v20, v21
v_mfma_f32_16x16x32_bf16 a[44:47], a[184:187], v[100:103], a[44:47]
v_exp_f32 v22, v22
v_mfma_f32_16x16x32_bf16 a[60:63], a[188:191], v[100:103], a[60:63]
ds_read_b64_tr_b16 a[184:185], v222 offset:32768
ds_read_b64_tr_b16 a[186:187], v222 offset:36864
v_mfma_f32_16x16x32_bf16 a[56:59], a[188:191], v[96:99], a[56:59]
v_exp_f32 v23, v23
v_mfma_f32_16x16x32_bf16 a[52:55], a[188:191], v[92:95], a[52:55]
v_cvt_pk_bf16_f32 v79, v22, v23
v_mfma_f32_16x16x32_bf16 a[48:51], a[188:191], v[88:91], a[48:51]
v_exp_f32 v24, v24
v_smfmac_f32_16x16x64_bf16 a[128:131], a[208:211], v[88:95], v245
ds_read_b64_tr_b16 a[188:189], v223 offset:32768
v_mfma_f32_16x16x32_bf16 v[44:47], a[160:163], v[152:155], v[136:139]
v_exp_f32 v25, v25
v_mfma_f32_16x16x32_bf16 v[44:47], a[164:167], v[156:159], v[44:47]
v_exp_f32 v26, v26
v_mfma_f32_16x16x32_bf16 v[44:47], a[168:171], v[160:163], v[44:47]
ds_read_b64_tr_b16 a[190:191], v223 offset:36864
v_cvt_pk_bf16_f32 v80, v24, v25
v_mfma_f32_16x16x32_bf16 v[44:47], a[172:175], v[164:167], v[44:47]
v_exp_f32 v27, v27
v_mfma_f32_16x16x32_bf16 v[52:55], a[172:175], v[180:183], v[140:143]
buffer_load_dwordx2 a[220:221], v249, s[52:55], 0 offen
v_cvt_pk_bf16_f32 v81, v26, v27
v_mfma_f32_16x16x32_bf16 v[52:55], a[168:171], v[176:179], v[52:55]
v_sub_u32 v133, 0xffff, v132
v_exp_f32 v28, v28
v_mfma_f32_16x16x32_bf16 v[52:55], a[164:167], v[172:175], v[52:55]
s_add_u32 m0, s88, 79488
s_lshl2_add_u32 s50, m0, s89
buffer_load_dwordx4 v243, s[56:59], s50 offen  lds
v_mfma_f32_16x16x32_bf16 v[52:55], a[160:163], v[168:171], v[52:55]
s_and_b32 s93, s76, 0xffff
v_exp_f32 v29, v29
v_mfma_f32_16x16x32_bf16 v[60:63], a[160:163], v[184:187], v[144:147]
v_cvt_pk_bf16_f32 v82, v28, v29
v_cmp_eq_u32 s[90:91], s93, v133
v_mov_b32 v134, 0
v_mfma_f32_16x16x32_bf16 v[60:63], a[164:167], v[188:191], v[60:63]
v_cndmask_b32 v135, v135, v134, s[90:91]
v_exp_f32 v30, v30
v_mfma_f32_16x16x32_bf16 v[60:63], a[168:171], v[192:195], v[60:63]
s_add_u32 m0, s88, 82944
s_lshl2_add_u32 s50, m0, s89
buffer_load_dwordx4 v243, s[56:59], s50 offen  lds
v_mfma_f32_16x16x32_bf16 v[60:63], a[172:175], v[196:199], v[60:63]
s_and_b32 s93, s77, 0xffff
v_exp_f32 v31, v31
v_mfma_f32_16x16x32_bf16 v[68:71], a[172:175], v[212:215], v[148:151]
ds_read_b128 a[172:175], v219 offset:53248
v_cvt_pk_bf16_f32 v83, v30, v31
v_cmp_eq_u32 s[90:91], s93, v133
v_mfma_f32_16x16x32_bf16 v[68:71], a[168:171], v[208:211], v[68:71]
v_mov_b32 v134, 1152
v_exp_f32 v32, v32
v_mfma_f32_16x16x32_bf16 v[68:71], a[164:167], v[204:207], v[68:71]
ds_read_b128 a[168:171], v218 offset:53248
ds_read_b128 a[164:167], v217 offset:53248
v_cndmask_b32 v135, v135, v134, s[90:91]
v_mfma_f32_16x16x32_bf16 v[68:71], a[160:163], v[200:203], v[68:71]
s_and_b32 s93, s78, 0xffff
v_exp_f32 v33, v33
v_mfma_f32_16x16x32_bf16 a[64:67], a[192:195], v[88:91], a[64:67]
ds_read_b128 a[160:163], v216 offset:53248
v_cvt_pk_bf16_f32 v84, v32, v33
v_cmp_eq_u32 s[90:91], s93, v133
v_mfma_f32_16x16x32_bf16 a[68:71], a[192:195], v[92:95], a[68:71]
v_mov_b32 v134, 2304
v_exp_f32 v34, v34
v_mfma_f32_16x16x32_bf16 a[72:75], a[192:195], v[96:99], a[72:75]
s_add_u32 m0, s88, 86400
s_lshl2_add_u32 s50, m0, s89
buffer_load_dwordx4 v243, s[56:59], s50 offen  lds
v_mfma_f32_16x16x32_bf16 a[76:79], a[192:195], v[100:103], a[76:79]
v_cndmask_b32 v135, v135, v134, s[90:91]
v_exp_f32 v35, v35
v_mfma_f32_16x16x32_bf16 a[92:95], a[196:199], v[100:103], a[92:95]
ds_read_b64_tr_b16 a[192:193], v224 offset:32768
v_cvt_pk_bf16_f32 v85, v34, v35
v_mfma_f32_16x16x32_bf16 a[88:91], a[196:199], v[96:99], a[88:91]
s_and_b32 s93, s79, 0xffff
v_exp_f32 v36, v36
v_mfma_f32_16x16x32_bf16 a[84:87], a[196:199], v[92:95], a[84:87]
ds_read_b64_tr_b16 a[194:195], v224 offset:36864
v_cmp_eq_u32 s[90:91], s93, v133
v_mfma_f32_16x16x32_bf16 a[80:83], a[196:199], v[88:91], a[80:83]
v_exp_f32 v37, v37
v_mfma_f32_16x16x32_bf16 a[96:99], a[200:203], v[88:91], a[96:99]
ds_read_b64_tr_b16 a[196:197], v225 offset:32768
v_cvt_pk_bf16_f32 v86, v36, v37
v_mfma_f32_16x16x32_bf16 a[100:103], a[200:203], v[92:95], a[100:103]
v_exp_f32 v38, v38
v_mfma_f32_16x16x32_bf16 a[104:107], a[200:203], v[96:99], a[104:107]
ds_read_b64_tr_b16 a[198:199], v225 offset:36864
v_mov_b32 v134, 3456
v_mfma_f32_16x16x32_bf16 a[108:111], a[200:203], v[100:103], a[108:111]
v_exp_f32 v39, v39
v_mfma_f32_16x16x32_bf16 a[124:127], a[204:207], v[100:103], a[124:127]
ds_read_b64_tr_b16 a[200:201], v226 offset:32768
v_cvt_pk_bf16_f32 v87, v38, v39
v_mfma_f32_16x16x32_bf16 a[120:123], a[204:207], v[96:99], a[120:123]
ds_read_b64_tr_b16 a[202:203], v226 offset:36864
v_cndmask_b32 v135, v135, v134, s[90:91]
v_mfma_f32_16x16x32_bf16 a[116:119], a[204:207], v[92:95], a[116:119]
s_add_u32 m0, s88, 89856
s_lshl2_add_u32 s50, m0, s89
buffer_load_dwordx4 v243, s[56:59], s50 offen  lds
v_mfma_f32_16x16x32_bf16 a[112:115], a[204:207], v[88:91], a[112:115]
ds_read_b64_tr_b16 a[204:205], v227 offset:32768
STUB_12:
STUB_B3:
s_cbranch_execz STUB_15
ds_read_b64_tr_b16 a[206:207], v227 offset:36864
v_smfmac_f32_16x16x64_bf16 a[132:135], a[208:211], v[96:103], v245
s_add_u32 m0, s88, 93312
s_lshl2_add_u32 s50, m0, s89
buffer_load_dwordx4 v243, s[56:59], s50 offen  lds
s_waitcnt lgkmcnt(8)
v_mfma_f32_16x16x32_bf16 v[8:11], a[144:147], v[152:155], v[136:139]
v_exp_f32 v40, v40
v_mfma_f32_16x16x32_bf16 v[8:11], a[148:151], v[156:159], v[8:11]
v_exp_f32 v41, v41
v_mfma_f32_16x16x32_bf16 v[8:11], a[152:155], v[160:163], v[8:11]
s_and_b32 s93, s80, 0xffff
v_cvt_pk_bf16_f32 v88, v40, v41
v_mfma_f32_16x16x32_bf16 v[8:11], a[156:159], v[164:167], v[8:11]
v_exp_f32 v42, v42
v_mfma_f32_16x16x32_bf16 v[16:19], a[156:159], v[180:183], v[140:143]
s_add_u32 m0, s88, 96768
s_lshl2_add_u32 s50, m0, s89
buffer_load_dwordx4 v243, s[56:59], s50 offen  lds
v_mfma_f32_16x16x32_bf16 v[16:19], a[152:155], v[176:179], v[16:19]
v_exp_f32 v43, v43
v_mfma_f32_16x16x32_bf16 v[16:19], a[148:151], v[172:175], v[16:19]
v_cvt_pk_bf16_f32 v89, v42, v43
v_cmp_eq_u32 s[90:91], s93, v133
v_mfma_f32_16x16x32_bf16 v[16:19], a[144:147], v[168:171], v[16:19]
v_exp_f32 v44, v44
v_mfma_f32_16x16x32_bf16 v[24:27], a[144:147], v[184:187], v[144:147]
v_mov_b32 v134, 4608
v_mfma_f32_16x16x32_bf16 v[24:27], a[148:151], v[188:191], v[24:27]
v_exp_f32 v45, v45
v_mfma_f32_16x16x32_bf16 v[24:27], a[152:155], v[192:195], v[24:27]
v_cvt_pk_bf16_f32 v90, v44, v45
v_cndmask_b32 v135, v135, v134, s[90:91]
v_mfma_f32_16x16x32_bf16 v[24:27], a[156:159], v[196:199], v[24:27]
v_exp_f32 v46, v46
v_mfma_f32_16x16x32_bf16 v[32:35], a[156:159], v[212:215], v[148:151]
ds_read_b128 a[156:159], v219 offset:57344
s_and_b32 s93, s81, 0xffff
v_mfma_f32_16x16x32_bf16 v[32:35], a[152:155], v[208:211], v[32:35]
v_exp_f32 v47, v47
v_mfma_f32_16x16x32_bf16 v[32:35], a[148:151], v[204:207], v[32:35]
ds_read_b128 a[152:155], v218 offset:57344
v_cvt_pk_bf16_f32 v91, v46, v47
v_mfma_f32_16x16x32_bf16 v[32:35], a[144:147], v[200:203], v[32:35]
v_exp_f32 v48, v48
v_mfma_f32_16x16x32_bf16 a[0:3], a[176:179], v[72:75], a[0:3]
ds_read_b128 a[148:151], v217 offset:57344
ds_read_b128 a[144:147], v216 offset:57344
v_mfma_f32_16x16x32_bf16 a[4:7], a[176:179], v[76:79], a[4:7]
v_exp_f32 v49, v49
v_mfma_f32_16x16x32_bf16 a[8:11], a[176:179], v[80:83], a[8:11]
v_cvt_pk_bf16_f32 v92, v48, v49
v_cmp_eq_u32 s[90:91], s93, v133
v_mfma_f32_16x16x32_bf16 a[12:15], a[176:179], v[84:87], a[12:15]
v_exp_f32 v50, v50
v_mfma_f32_16x16x32_bf16 a[28:31], a[180:183], v[84:87], a[28:31]
ds_read_b64_tr_b16 a[176:177], v220 offset:40960
ds_read_b64_tr_b16 a[178:179], v220 offset:45056
v_mfma_f32_16x16x32_bf16 a[24:27], a[180:183], v[80:83], a[24:27]
v_exp_f32 v51, v51
v_mfma_f32_16x16x32_bf16 a[20:23], a[180:183], v[76:79], a[20:23]
v_cvt_pk_bf16_f32 v93, v50, v51
v_mov_b32 v134, 5760
v_mfma_f32_16x16x32_bf16 a[16:19], a[180:183], v[72:75], a[16:19]
v_exp_f32 v52, v52
v_mfma_f32_16x16x32_bf16 a[32:35], a[184:187], v[72:75], a[32:35]
ds_read_b64_tr_b16 a[180:181], v221 offset:40960
ds_read_b64_tr_b16 a[182:183], v221 offset:45056
v_mfma_f32_16x16x32_bf16 a[36:39], a[184:187], v[76:79], a[36:39]
v_exp_f32 v53, v53
v_mfma_f32_16x16x32_bf16 a[40:43], a[184:187], v[80:83], a[40:43]
v_cvt_pk_bf16_f32 v94, v52, v53
v_cndmask_b32 v135, v135, v134, s[90:91]
v_mfma_f32_16x16x32_bf16 a[44:47], a[184:187], v[84:87], a[44:47]
v_exp_f32 v54, v54
v_mfma_f32_16x16x32_bf16 a[60:63], a[188:191], v[84:87], a[60:63]
ds_read_b64_tr_b16 a[184:185], v222 offset:40960
ds_read_b64_tr_b16 a[186:187], v222 offset:45056
v_mfma_f32_16x16x32_bf16 a[56:59], a[188:191], v[80:83], a[56:59]
v_exp_f32 v55, v55
v_mfma_f32_16x16x32_bf16 a[52:55], a[188:191], v[76:79], a[52:55]
s_and_b32 s93, s82, 0xffff
v_cvt_pk_bf16_f32 v95, v54, v55
v_mfma_f32_16x16x32_bf16 a[48:51], a[188:191], v[72:75], a[48:51]
v_exp_f32 v56, v56
v_smfmac_f32_16x16x64_bf16 a[128:131], a[208:211], v[72:79], v245
ds_read_b64_tr_b16 a[188:189], v223 offset:40960
v_mfma_f32_16x16x32_bf16 v[12:15], a[160:163], v[152:155], v[136:139]
v_exp_f32 v57, v57
v_mfma_f32_16x16x32_bf16 v[12:15], a[164:167], v[156:159], v[12:15]
v_exp_f32 v58, v58
v_mfma_f32_16x16x32_bf16 v[12:15], a[168:171], v[160:163], v[12:15]
ds_read_b64_tr_b16 a[190:191], v223 offset:45056
v_cvt_pk_bf16_f32 v96, v56, v57
v_mfma_f32_16x16x32_bf16 v[12:15], a[172:175], v[164:167], v[12:15]
v_exp_f32 v59, v59
v_mfma_f32_16x16x32_bf16 v[20:23], a[172:175], v[180:183], v[140:143]
v_cvt_pk_bf16_f32 v97, v58, v59
v_cmp_eq_u32 s[90:91], s93, v133
v_mfma_f32_16x16x32_bf16 v[20:23], a[168:171], v[176:179], v[20:23]
v_exp_f32 v60, v60
v_mfma_f32_16x16x32_bf16 v[20:23], a[164:167], v[172:175], v[20:23]
s_add_u32 m0, s88, 100224
s_lshl2_add_u32 s50, m0, s89
buffer_load_dwordx4 v243, s[56:59], s50 offen  lds
v_mfma_f32_16x16x32_bf16 v[20:23], a[160:163], v[168:171], v[20:23]
v_exp_f32 v61, v61
v_mfma_f32_16x16x32_bf16 v[28:31], a[160:163], v[184:187], v[144:147]
v_cvt_pk_bf16_f32 v98, v60, v61
v_mov_b32 v134, 6912
v_mfma_f32_16x16x32_bf16 v[28:31], a[164:167], v[188:191], v[28:31]
v_exp_f32 v62, v62
v_mfma_f32_16x16x32_bf16 v[28:31], a[168:171], v[192:195], v[28:31]
s_add_u32 m0, s88, 103680
s_lshl2_add_u32 s50, m0, s89
buffer_load_dwordx4 v243, s[56:59], s50 offen  lds
v_mfma_f32_16x16x32_bf16 v[28:31], a[172:175], v[196:199], v[28:31]
v_exp_f32 v63, v63
v_mfma_f32_16x16x32_bf16 v[36:39], a[172:175], v[212:215], v[148:151]
ds_read_b128 a[172:175], v219 offset:61440
v_cvt_pk_bf16_f32 v99, v62, v63
v_mfma_f32_16x16x32_bf16 v[36:39], a[168:171], v[208:211], v[36:39]
v_exp_f32 v64, v64
v_mfma_f32_16x16x32_bf16 v[36:39], a[164:167], v[204:207], v[36:39]
ds_read_b128 a[168:171], v218 offset:61440
ds_read_b128 a[164:167], v217 offset:61440
v_mfma_f32_16x16x32_bf16 v[36:39], a[160:163], v[200:203], v[36:39]
v_exp_f32 v65, v65
s_waitcnt lgkmcnt(8)
v_mfma_f32_16x16x32_bf16 a[64:67], a[192:195], v[72:75], a[64:67]
ds_read_b128 a[160:163], v216 offset:61440
v_cvt_pk_bf16_f32 v100, v64, v65
v_mfma_f32_16x16x32_bf16 a[68:71], a[192:195], v[76:79], a[68:71]
v_exp_f32 v66, v66
v_mfma_f32_16x16x32_bf16 a[72:75], a[192:195], v[80:83], a[72:75]
s_add_u32 m0, s88, 107136
s_lshl2_add_u32 s50, m0, s89
buffer_load_dwordx4 v243, s[56:59], s50 offen  lds
v_mfma_f32_16x16x32_bf16 a[76:79], a[192:195], v[84:87], a[76:79]
v_exp_f32 v67, v67
v_mfma_f32_16x16x32_bf16 a[92:95], a[196:199], v[84:87], a[92:95]
ds_read_b64_tr_b16 a[192:193], v224 offset:40960
v_cvt_pk_bf16_f32 v101, v66, v67
v_mfma_f32_16x16x32_bf16 a[88:91], a[196:199], v[80:83], a[88:91]
v_exp_f32 v68, v68
v_mfma_f32_16x16x32_bf16 a[84:87], a[196:199], v[76:79], a[84:87]
ds_read_b64_tr_b16 a[194:195], v224 offset:45056
v_cndmask_b32 v135, v135, v134, s[90:91]
v_mfma_f32_16x16x32_bf16 a[80:83], a[196:199], v[72:75], a[80:83]
v_exp_f32 v69, v69
v_mfma_f32_16x16x32_bf16 a[96:99], a[200:203], v[72:75], a[96:99]
ds_read_b64_tr_b16 a[196:197], v225 offset:40960
v_cvt_pk_bf16_f32 v102, v68, v69
v_mfma_f32_16x16x32_bf16 a[100:103], a[200:203], v[76:79], a[100:103]
v_exp_f32 v70, v70
v_mfma_f32_16x16x32_bf16 a[104:107], a[200:203], v[80:83], a[104:107]
ds_read_b64_tr_b16 a[198:199], v225 offset:45056
s_and_b32 s93, s83, 0xffff
v_mfma_f32_16x16x32_bf16 a[108:111], a[200:203], v[84:87], a[108:111]
v_exp_f32 v71, v71
v_mfma_f32_16x16x32_bf16 a[124:127], a[204:207], v[84:87], a[124:127]
ds_read_b64_tr_b16 a[200:201], v226 offset:40960
v_cvt_pk_bf16_f32 v103, v70, v71
v_mfma_f32_16x16x32_bf16 a[120:123], a[204:207], v[80:83], a[120:123]
ds_read_b64_tr_b16 a[202:203], v226 offset:45056
v_cmp_eq_u32 s[90:91], s93, v133
v_mfma_f32_16x16x32_bf16 a[116:119], a[204:207], v[76:79], a[116:119]
s_add_u32 m0, s88, 110592
s_lshl2_add_u32 s50, m0, s89
buffer_load_dwordx4 v243, s[56:59], s50 offen  lds
v_mfma_f32_16x16x32_bf16 a[112:115], a[204:207], v[72:75], a[112:115]
ds_read_b64_tr_b16 a[204:205], v227 offset:40960
ds_read_b64_tr_b16 a[206:207], v227 offset:45056
v_smfmac_f32_16x16x64_bf16 a[132:135], a[208:211], v[80:87], v245
v_mov_b32 v134, 8064
v_mfma_f32_16x16x32_bf16 v[40:43], a[144:147], v[152:155], v[136:139]
v_exp_f32 v8, v8
v_mfma_f32_16x16x32_bf16 v[40:43], a[148:151], v[156:159], v[40:43]
v_exp_f32 v9, v9
v_mfma_f32_16x16x32_bf16 v[40:43], a[152:155], v[160:163], v[40:43]
v_cvt_pk_bf16_f32 v72, v8, v9
v_cndmask_b32 v135, v135, v134, s[90:91]
v_mfma_f32_16x16x32_bf16 v[40:43], a[156:159], v[164:167], v[40:43]
v_exp_f32 v10, v10
v_mfma_f32_16x16x32_bf16 v[48:51], a[156:159], v[180:183], v[140:143]
v_add_u32 v250, v250, v135
v_add_u32 v251, v251, v135
v_mfma_f32_16x16x32_bf16 v[48:51], a[152:155], v[176:179], v[48:51]
v_exp_f32 v11, v11
v_mfma_f32_16x16x32_bf16 v[48:51], a[148:151], v[172:175], v[48:51]
v_cvt_pk_bf16_f32 v73, v10, v11
v_lshrrev_b32 v134, 14, v135
v_mfma_f32_16x16x32_bf16 v[48:51], a[144:147], v[168:171], v[48:51]
v_exp_f32 v12, v12
v_mfma_f32_16x16x32_bf16 v[56:59], a[144:147], v[184:187], v[144:147]
v_cmp_eq_u32 s[90:91], 0, v134
v_mfma_f32_16x16x32_bf16 v[56:59], a[148:151], v[188:191], v[56:59]
v_exp_f32 v13, v13
v_mfma_f32_16x16x32_bf16 v[56:59], a[152:155], v[192:195], v[56:59]
v_cvt_pk_bf16_f32 v74, v12, v13
v_mfma_f32_16x16x32_bf16 v[56:59], a[156:159], v[196:199], v[56:59]
v_exp_f32 v14, v14
v_mfma_f32_16x16x32_bf16 v[64:67], a[156:159], v[212:215], v[148:151]
s_waitcnt vmcnt(12) lgkmcnt(0)
s_barrier
v_mfma_f32_16x16x32_bf16 v[64:67], a[152:155], v[208:211], v[64:67]
v_exp_f32 v15, v15
v_mfma_f32_16x16x32_bf16 v[64:67], a[148:151], v[204:207], v[64:67]
v_cvt_pk_bf16_f32 v75, v14, v15
v_mfma_f32_16x16x32_bf16 v[64:67], a[144:147], v[200:203], v[64:67]
v_exp_f32 v16, v16
v_mfma_f32_16x16x32_bf16 a[0:3], a[176:179], v[88:91], a[0:3]
s_add_u32 m0, s88, 114048
s_lshl2_add_u32 s50, m0, s89
buffer_load_dwordx4 v243, s[56:59], s50 offen  lds
v_mfma_f32_16x16x32_bf16 a[4:7], a[176:179], v[92:95], a[4:7]
v_exp_f32 v17, v17
v_mfma_f32_16x16x32_bf16 a[8:11], a[176:179], v[96:99], a[8:11]
v_cvt_pk_bf16_f32 v76, v16, v17
v_mfma_f32_16x16x32_bf16 a[12:15], a[176:179], v[100:103], a[12:15]
v_exp_f32 v18, v18
v_mfma_f32_16x16x32_bf16 a[28:31], a[180:183], v[100:103], a[28:31]
ds_read_b64_tr_b16 a[176:177], v220 offset:49152
ds_read_b64_tr_b16 a[178:179], v220 offset:53248
v_mfma_f32_16x16x32_bf16 a[24:27], a[180:183], v[96:99], a[24:27]
v_exp_f32 v19, v19
v_mfma_f32_16x16x32_bf16 a[20:23], a[180:183], v[92:95], a[20:23]
v_cvt_pk_bf16_f32 v77, v18, v19
v_mfma_f32_16x16x32_bf16 a[16:19], a[180:183], v[88:91], a[16:19]
v_exp_f32 v20, v20
v_mfma_f32_16x16x32_bf16 a[32:35], a[184:187], v[88:91], a[32:35]
ds_read_b64_tr_b16 a[180:181], v221 offset:49152
ds_read_b64_tr_b16 a[182:183], v221 offset:53248
v_mfma_f32_16x16x32_bf16 a[36:39], a[184:187], v[92:95], a[36:39]
v_exp_f32 v21, v21
v_mfma_f32_16x16x32_bf16 a[40:43], a[184:187], v[96:99], a[40:43]
v_cvt_pk_bf16_f32 v78, v20, v21
v_mfma_f32_16x16x32_bf16 a[44:47], a[184:187], v[100:103], a[44:47]
v_exp_f32 v22, v22
v_mfma_f32_16x16x32_bf16 a[60:63], a[188:191], v[100:103], a[60:63]
ds_read_b64_tr_b16 a[184:185], v222 offset:49152
ds_read_b64_tr_b16 a[186:187], v222 offset:53248
v_mfma_f32_16x16x32_bf16 a[56:59], a[188:191], v[96:99], a[56:59]
v_exp_f32 v23, v23
v_mfma_f32_16x16x32_bf16 a[52:55], a[188:191], v[92:95], a[52:55]
v_cvt_pk_bf16_f32 v79, v22, v23
v_mfma_f32_16x16x32_bf16 a[48:51], a[188:191], v[88:91], a[48:51]
v_exp_f32 v24, v24
v_smfmac_f32_16x16x64_bf16 a[128:131], a[208:211], v[88:95], v245
ds_read_b64_tr_b16 a[188:189], v223 offset:49152
v_mfma_f32_16x16x32_bf16 v[44:47], a[160:163], v[152:155], v[136:139]
v_exp_f32 v25, v25
v_mfma_f32_16x16x32_bf16 v[44:47], a[164:167], v[156:159], v[44:47]
v_exp_f32 v26, v26
v_mfma_f32_16x16x32_bf16 v[44:47], a[168:171], v[160:163], v[44:47]
ds_read_b64_tr_b16 a[190:191], v223 offset:53248
v_cvt_pk_bf16_f32 v80, v24, v25
v_mfma_f32_16x16x32_bf16 v[44:47], a[172:175], v[164:167], v[44:47]
v_exp_f32 v27, v27
v_mfma_f32_16x16x32_bf16 v[52:55], a[172:175], v[180:183], v[140:143]
v_cvt_pk_bf16_f32 v81, v26, v27
s_waitcnt vmcnt(23)
v_readfirstlane_b32 s93, v246
v_mfma_f32_16x16x32_bf16 v[52:55], a[168:171], v[176:179], v[52:55]
v_exp_f32 v28, v28
v_mfma_f32_16x16x32_bf16 v[52:55], a[164:167], v[172:175], v[52:55]
s_add_u32 m0, s88, 117504
s_lshl2_add_u32 s50, m0, s89
buffer_load_dwordx4 v243, s[56:59], s50 offen  lds
v_mfma_f32_16x16x32_bf16 v[52:55], a[160:163], v[168:171], v[52:55]
v_exp_f32 v29, v29
v_mfma_f32_16x16x32_bf16 v[60:63], a[160:163], v[184:187], v[144:147]
s_cmp_eq_u64 s[90:91], 0
s_cselect_b32 s93, 144, s93
v_cvt_pk_bf16_f32 v82, v28, v29
v_mfma_f32_16x16x32_bf16 v[60:63], a[164:167], v[188:191], v[60:63]
v_exp_f32 v30, v30
v_mfma_f32_16x16x32_bf16 v[60:63], a[168:171], v[192:195], v[60:63]
s_add_u32 m0, s88, 120960
s_lshl2_add_u32 s50, m0, s89
buffer_load_dwordx4 v243, s[56:59], s50 offen  lds
v_mfma_f32_16x16x32_bf16 v[60:63], a[172:175], v[196:199], v[60:63]
v_exp_f32 v31, v31
v_mfma_f32_16x16x32_bf16 v[68:71], a[172:175], v[212:215], v[148:151]
v_cvt_pk_bf16_f32 v83, v30, v31
v_mfma_f32_16x16x32_bf16 v[68:71], a[168:171], v[208:211], v[68:71]
v_exp_f32 v32, v32
v_mfma_f32_16x16x32_bf16 v[68:71], a[164:167], v[204:207], v[68:71]
s_add_u32 m0, s88, 124416
s_lshl2_add_u32 s50, m0, s89
buffer_load_dwordx4 v243, s[56:59], s50 offen  lds
v_mfma_f32_16x16x32_bf16 v[68:71], a[160:163], v[200:203], v[68:71]
v_exp_f32 v33, v33
v_mfma_f32_16x16x32_bf16 a[64:67], a[192:195], v[88:91], a[64:67]
v_cvt_pk_bf16_f32 v84, v32, v33
v_mfma_f32_16x16x32_bf16 a[68:71], a[192:195], v[92:95], a[68:71]
v_exp_f32 v34, v34
v_mfma_f32_16x16x32_bf16 a[72:75], a[192:195], v[96:99], a[72:75]
s_add_u32 m0, s88, 127872
s_lshl2_add_u32 s50, m0, s89
buffer_load_dwordx4 v243, s[56:59], s50 offen  lds
v_mfma_f32_16x16x32_bf16 a[76:79], a[192:195], v[100:103], a[76:79]
v_exp_f32 v35, v35
v_mfma_f32_16x16x32_bf16 a[92:95], a[196:199], v[100:103], a[92:95]
ds_read_b64_tr_b16 a[192:193], v224 offset:49152
v_cvt_pk_bf16_f32 v85, v34, v35
v_mfma_f32_16x16x32_bf16 a[88:91], a[196:199], v[96:99], a[88:91]
v_exp_f32 v36, v36
v_mfma_f32_16x16x32_bf16 a[84:87], a[196:199], v[92:95], a[84:87]
ds_read_b64_tr_b16 a[194:195], v224 offset:53248
s_cmp_lt_u32 s93, 144
s_cbranch_scc1 SP_Y
SP_Y_RET:
v_mfma_f32_16x16x32_bf16 a[80:83], a[196:199], v[88:91], a[80:83]
v_exp_f32 v37, v37
v_mfma_f32_16x16x32_bf16 a[96:99], a[200:203], v[88:91], a[96:99]
ds_read_b64_tr_b16 a[196:197], v225 offset:49152
v_cvt_pk_bf16_f32 v86, v36, v37
v_mfma_f32_16x16x32_bf16 a[100:103], a[200:203], v[92:95], a[100:103]
v_exp_f32 v38, v38
v_mfma_f32_16x16x32_bf16 a[104:107], a[200:203], v[96:99], a[104:107]
ds_read_b64_tr_b16 a[198:199], v225 offset:53248
s_mov_b32 s93, 0x244000
v_mfma_f32_16x16x32_bf16 a[108:111], a[200:203], v[100:103], a[108:111]
v_exp_f32 v39, v39
v_mfma_f32_16x16x32_bf16 a[124:127], a[204:207], v[100:103], a[124:127]
ds_read_b64_tr_b16 a[200:201], v226 offset:49152
v_cvt_pk_bf16_f32 v87, v38, v39
v_mfma_f32_16x16x32_bf16 a[120:123], a[204:207], v[96:99], a[120:123]
ds_read_b64_tr_b16 a[202:203], v226 offset:53248
v_mfma_f32_16x16x32_bf16 a[116:119], a[204:207], v[92:95], a[116:119]
s_add_u32 m0, s88, 131328
s_lshl2_add_u32 s50, m0, s89
buffer_load_dwordx4 v243, s[56:59], s50 offen  lds
v_mfma_f32_16x16x32_bf16 a[112:115], a[204:207], v[88:91], a[112:115]
ds_read_b64_tr_b16 a[204:205], v227 offset:49152
ds_read_b64_tr_b16 a[206:207], v227 offset:53248
v_smfmac_f32_16x16x64_bf16 a[132:135], a[208:211], v[96:103], v245
s_add_u32 m0, s88, 134784
s_lshl2_add_u32 s50, m0, s89
buffer_load_dwordx4 v243, s[56:59], s50 offen  lds
s_waitcnt lgkmcnt(8)
v_mfma_f32_16x16x32_bf16 a[0:3], a[176:179], v[72:75], a[0:3]
v_exp_f32 v40, v40
v_exp_f32 v41, v41
v_mfma_f32_16x16x32_bf16 a[4:7], a[176:179], v[76:79], a[4:7]
buffer_load_dwordx4 a[232:235], v250, s[20:23], s93 offen offset:0 sc0 sc1
v_cvt_pk_bf16_f32 v88, v40, v41
v_exp_f32 v42, v42
v_mfma_f32_16x16x32_bf16 a[8:11], a[176:179], v[80:83], a[8:11]
buffer_load_dwordx4 a[236:239], v250, s[20:23], s93 offen offset:128 sc0 sc1
v_exp_f32 v43, v43
v_mfma_f32_16x16x32_bf16 a[12:15], a[176:179], v[84:87], a[12:15]
ds_read_b64_tr_b16 a[176:177], v220 offset:57344
v_cvt_pk_bf16_f32 v89, v42, v43
v_exp_f32 v44, v44
v_mfma_f32_16x16x32_bf16 a[28:31], a[180:183], v[84:87], a[28:31]
ds_read_b64_tr_b16 a[178:179], v220 offset:61440
v_exp_f32 v45, v45
v_mfma_f32_16x16x32_bf16 a[24:27], a[180:183], v[80:83], a[24:27]
v_cvt_pk_bf16_f32 v90, v44, v45
v_exp_f32 v46, v46
v_mfma_f32_16x16x32_bf16 a[20:23], a[180:183], v[76:79], a[20:23]
buffer_load_dwordx2 a[240:241], v251, s[20:23], s93 offen sc0 sc1
v_exp_f32 v47, v47
v_mfma_f32_16x16x32_bf16 a[16:19], a[180:183], v[72:75], a[16:19]
ds_read_b64_tr_b16 a[180:181], v221 offset:57344
v_cvt_pk_bf16_f32 v91, v46, v47
v_exp_f32 v48, v48
v_mfma_f32_16x16x32_bf16 a[32:35], a[184:187], v[72:75], a[32:35]
ds_read_b64_tr_b16 a[182:183], v221 offset:61440
v_exp_f32 v49, v49
v_mfma_f32_16x16x32_bf16 a[36:39], a[184:187], v[76:79], a[36:39]
v_cvt_pk_bf16_f32 v92, v48, v49
v_exp_f32 v50, v50
v_mfma_f32_16x16x32_bf16 a[40:43], a[184:187], v[80:83], a[40:43]
v_exp_f32 v51, v51
v_mfma_f32_16x16x32_bf16 a[44:47], a[184:187], v[84:87], a[44:47]
ds_read_b64_tr_b16 a[184:185], v222 offset:57344
v_cvt_pk_bf16_f32 v93, v50, v51
v_exp_f32 v52, v52
v_mfma_f32_16x16x32_bf16 a[60:63], a[188:191], v[84:87], a[60:63]
ds_read_b64_tr_b16 a[186:187], v222 offset:61440
v_exp_f32 v53, v53
v_mfma_f32_16x16x32_bf16 a[56:59], a[188:191], v[80:83], a[56:59]
v_cvt_pk_bf16_f32 v94, v52, v53
v_exp_f32 v54, v54
v_mfma_f32_16x16x32_bf16 a[52:55], a[188:191], v[76:79], a[52:55]
v_exp_f32 v55, v55
v_mfma_f32_16x16x32_bf16 a[48:51], a[188:191], v[72:75], a[48:51]
v_exp_f32 v56, v56
v_exp_f32 v57, v57
v_smfmac_f32_16x16x64_bf16 a[128:131], a[208:211], v[72:79], v245
v_cvt_pk_bf16_f32 v95, v54, v55
v_cvt_pk_bf16_f32 v96, v56, v57
v_exp_f32 v58, v58
s_waitcnt lgkmcnt(8)
v_mfma_f32_16x16x32_bf16 a[64:67], a[192:195], v[72:75], a[64:67]
ds_read_b64_tr_b16 a[188:189], v223 offset:57344
ds_read_b64_tr_b16 a[190:191], v223 offset:61440
v_exp_f32 v59, v59
v_mfma_f32_16x16x32_bf16 a[68:71], a[192:195], v[76:79], a[68:71]
v_cvt_pk_bf16_f32 v97, v58, v59
v_exp_f32 v60, v60
v_mfma_f32_16x16x32_bf16 a[72:75], a[192:195], v[80:83], a[72:75]
v_exp_f32 v61, v61
v_mfma_f32_16x16x32_bf16 a[76:79], a[192:195], v[84:87], a[76:79]
ds_read_b64_tr_b16 a[192:193], v224 offset:57344
v_cvt_pk_bf16_f32 v98, v60, v61
v_exp_f32 v62, v62
v_mfma_f32_16x16x32_bf16 a[92:95], a[196:199], v[84:87], a[92:95]
ds_read_b64_tr_b16 a[194:195], v224 offset:61440
v_exp_f32 v63, v63
v_mfma_f32_16x16x32_bf16 a[88:91], a[196:199], v[80:83], a[88:91]
v_cvt_pk_bf16_f32 v99, v62, v63
v_exp_f32 v64, v64
v_mfma_f32_16x16x32_bf16 a[84:87], a[196:199], v[76:79], a[84:87]
v_exp_f32 v65, v65
v_mfma_f32_16x16x32_bf16 a[80:83], a[196:199], v[72:75], a[80:83]
ds_read_b64_tr_b16 a[196:197], v225 offset:57344
v_cvt_pk_bf16_f32 v100, v64, v65
v_exp_f32 v66, v66
v_mfma_f32_16x16x32_bf16 a[96:99], a[200:203], v[72:75], a[96:99]
ds_read_b64_tr_b16 a[198:199], v225 offset:61440
v_exp_f32 v67, v67
v_mfma_f32_16x16x32_bf16 a[100:103], a[200:203], v[76:79], a[100:103]
v_cvt_pk_bf16_f32 v101, v66, v67
v_exp_f32 v68, v68
v_mfma_f32_16x16x32_bf16 a[104:107], a[200:203], v[80:83], a[104:107]
v_exp_f32 v69, v69
v_mfma_f32_16x16x32_bf16 a[108:111], a[200:203], v[84:87], a[108:111]
ds_read_b64_tr_b16 a[200:201], v226 offset:57344
v_cvt_pk_bf16_f32 v102, v68, v69
v_exp_f32 v70, v70
s_waitcnt lgkmcnt(8)
v_mfma_f32_16x16x32_bf16 a[124:127], a[204:207], v[84:87], a[124:127]
ds_read_b64_tr_b16 a[202:203], v226 offset:61440
v_exp_f32 v71, v71
v_mfma_f32_16x16x32_bf16 a[120:123], a[204:207], v[80:83], a[120:123]
v_cvt_pk_bf16_f32 v103, v70, v71
v_mfma_f32_16x16x32_bf16 a[116:119], a[204:207], v[76:79], a[116:119]
s_add_u32 m0, s88, 138240
s_lshl2_add_u32 s50, m0, s89
buffer_load_dwordx4 v243, s[56:59], s50 offen  lds
v_mfma_f32_16x16x32_bf16 a[112:115], a[204:207], v[72:75], a[112:115]
ds_read_b64_tr_b16 a[204:205], v227 offset:57344
ds_read_b64_tr_b16 a[206:207], v227 offset:61440
v_smfmac_f32_16x16x64_bf16 a[132:135], a[208:211], v[80:87], v245
s_add_u32 m0, s88, 141696
s_lshl2_add_u32 s50, m0, s89
buffer_load_dwordx4 v243, s[56:59], s50 offen  lds
s_add_u32 m0, s88, 145152
s_min_u32 m0, m0, 146880
s_lshl2_add_u32 s50, m0, s89
s_cmp_ge_u32 s37, 2
s_cselect_b32 exec_hi, 15, -1
buffer_load_dwordx4 v243, s[56:59], s50 offen  lds
s_mov_b32 exec_hi, -1
s_cmp_eq_u32 s48, 0
s_cbranch_scc1 K_MIXED
s_waitcnt lgkmcnt(0)
s_barrier
v_smfmac_f32_16x16x64_bf16 a[128:131], a[208:211], v[88:95], v245
v_smfmac_f32_16x16x64_bf16 a[132:135], a[208:211], v[96:103], v245
v_mfma_f32_16x16x32_bf16 a[0:3], a[176:179], v[88:91], a[0:3]
v_mfma_f32_16x16x32_bf16 a[16:19], a[180:183], v[88:91], a[16:19]
v_mfma_f32_16x16x32_bf16 a[32:35], a[184:187], v[88:91], a[32:35]
v_mfma_f32_16x16x32_bf16 a[48:51], a[188:191], v[88:91], a[48:51]
v_mfma_f32_16x16x32_bf16 a[64:67], a[192:195], v[88:91], a[64:67]
v_mfma_f32_16x16x32_bf16 a[80:83], a[196:199], v[88:91], a[80:83]
v_mfma_f32_16x16x32_bf16 a[96:99], a[200:203], v[88:91], a[96:99]
v_mfma_f32_16x16x32_bf16 a[112:115], a[204:207], v[88:91], a[112:115]
v_mfma_f32_16x16x32_bf16 a[4:7], a[176:179], v[92:95], a[4:7]
v_mfma_f32_16x16x32_bf16 a[20:23], a[180:183], v[92:95], a[20:23]
v_mfma_f32_16x16x32_bf16 a[36:39], a[184:187], v[92:95], a[36:39]
v_mfma_f32_16x16x32_bf16 a[52:55], a[188:191], v[92:95], a[52:55]
v_mfma_f32_16x16x32_bf16 a[68:71], a[192:195], v[92:95], a[68:71]
v_mfma_f32_16x16x32_bf16 a[84:87], a[196:199], v[92:95], a[84:87]
v_mfma_f32_16x16x32_bf16 a[100:103], a[200:203], v[92:95], a[100:103]
v_mfma_f32_16x16x32_bf16 a[116:119], a[204:207], v[92:95], a[116:119]
v_accvgpr_read_b32 v120, a128
v_accvgpr_read_b32 v124, a129
v_add_f32 v120, v120, v124
v_rcp_f32 v124, v120
s_add_u32 s50, s44, 0
v_mov_b32 v125, v124
v_accvgpr_read_b32 v104, a0
v_accvgpr_read_b32 v105, a1
v_accvgpr_read_b32 v106, a2
v_accvgpr_read_b32 v107, a3
v_accvgpr_read_b32 v108, a16
v_accvgpr_read_b32 v109, a17
v_accvgpr_read_b32 v110, a18
v_accvgpr_read_b32 v111, a19
v_pk_mul_f32 v[104:105], v[104:105], v[124:125]
v_pk_mul_f32 v[106:107], v[106:107], v[124:125]
v_pk_mul_f32 v[108:109], v[108:109], v[124:125]
v_pk_mul_f32 v[110:111], v[110:111], v[124:125]
v_cvt_pk_bf16_f32 v8, v104, v105
v_cvt_pk_bf16_f32 v9, v106, v107
v_cvt_pk_bf16_f32 v10, v108, v109
v_cvt_pk_bf16_f32 v11, v110, v111
buffer_store_dwordx4 v[8:11], v244, s[20:23], s50 offen offset:0
v_accvgpr_read_b32 v112, a32
v_accvgpr_read_b32 v113, a33
v_accvgpr_read_b32 v114, a34
v_accvgpr_read_b32 v115, a35
v_accvgpr_read_b32 v116, a48
v_accvgpr_read_b32 v117, a49
v_accvgpr_read_b32 v118, a50
v_accvgpr_read_b32 v119, a51
v_pk_mul_f32 v[112:113], v[112:113], v[124:125]
v_pk_mul_f32 v[114:115], v[114:115], v[124:125]
v_pk_mul_f32 v[116:117], v[116:117], v[124:125]
v_pk_mul_f32 v[118:119], v[118:119], v[124:125]
v_cvt_pk_bf16_f32 v12, v112, v113
v_cvt_pk_bf16_f32 v13, v114, v115
v_cvt_pk_bf16_f32 v14, v116, v117
v_cvt_pk_bf16_f32 v15, v118, v119
buffer_store_dwordx4 v[12:15], v244, s[20:23], s50 offen offset:1024
v_accvgpr_read_b32 v104, a64
v_accvgpr_read_b32 v105, a65
v_accvgpr_read_b32 v106, a66
v_accvgpr_read_b32 v107, a67
v_accvgpr_read_b32 v108, a80
v_accvgpr_read_b32 v109, a81
v_accvgpr_read_b32 v110, a82
v_accvgpr_read_b32 v111, a83
v_pk_mul_f32 v[104:105], v[104:105], v[124:125]
v_pk_mul_f32 v[106:107], v[106:107], v[124:125]
v_pk_mul_f32 v[108:109], v[108:109], v[124:125]
v_pk_mul_f32 v[110:111], v[110:111], v[124:125]
v_cvt_pk_bf16_f32 v16, v104, v105
v_cvt_pk_bf16_f32 v17, v106, v107
v_cvt_pk_bf16_f32 v18, v108, v109
v_cvt_pk_bf16_f32 v19, v110, v111
buffer_store_dwordx4 v[16:19], v244, s[20:23], s50 offen offset:2048
v_accvgpr_read_b32 v112, a96
v_accvgpr_read_b32 v113, a97
v_accvgpr_read_b32 v114, a98
v_accvgpr_read_b32 v115, a99
v_accvgpr_read_b32 v116, a112
v_accvgpr_read_b32 v117, a113
v_accvgpr_read_b32 v118, a114
v_accvgpr_read_b32 v119, a115
v_pk_mul_f32 v[112:113], v[112:113], v[124:125]
v_pk_mul_f32 v[114:115], v[114:115], v[124:125]
v_pk_mul_f32 v[116:117], v[116:117], v[124:125]
v_pk_mul_f32 v[118:119], v[118:119], v[124:125]
v_cvt_pk_bf16_f32 v20, v112, v113
v_cvt_pk_bf16_f32 v21, v114, v115
v_cvt_pk_bf16_f32 v22, v116, v117
v_cvt_pk_bf16_f32 v23, v118, v119
buffer_store_dwordx4 v[20:23], v244, s[20:23], s50 offen offset:3072
v_mfma_f32_16x16x32_bf16 a[8:11], a[176:179], v[96:99], a[8:11]
v_mfma_f32_16x16x32_bf16 a[24:27], a[180:183], v[96:99], a[24:27]
v_mfma_f32_16x16x32_bf16 a[40:43], a[184:187], v[96:99], a[40:43]
v_mfma_f32_16x16x32_bf16 a[56:59], a[188:191], v[96:99], a[56:59]
v_mfma_f32_16x16x32_bf16 a[72:75], a[192:195], v[96:99], a[72:75]
v_mfma_f32_16x16x32_bf16 a[88:91], a[196:199], v[96:99], a[88:91]
v_mfma_f32_16x16x32_bf16 a[104:107], a[200:203], v[96:99], a[104:107]
v_mfma_f32_16x16x32_bf16 a[120:123], a[204:207], v[96:99], a[120:123]
v_accvgpr_read_b32 v121, a130
v_accvgpr_read_b32 v126, a131
v_add_f32 v121, v121, v126
v_rcp_f32 v126, v121
s_add_u32 s50, s44, 4096
v_mov_b32 v127, v126
v_accvgpr_read_b32 v104, a4
v_accvgpr_read_b32 v105, a5
v_accvgpr_read_b32 v106, a6
v_accvgpr_read_b32 v107, a7
v_accvgpr_read_b32 v108, a20
v_accvgpr_read_b32 v109, a21
v_accvgpr_read_b32 v110, a22
v_accvgpr_read_b32 v111, a23
v_pk_mul_f32 v[104:105], v[104:105], v[126:127]
v_pk_mul_f32 v[106:107], v[106:107], v[126:127]
v_pk_mul_f32 v[108:109], v[108:109], v[126:127]
v_pk_mul_f32 v[110:111], v[110:111], v[126:127]
v_cvt_pk_bf16_f32 v24, v104, v105
v_cvt_pk_bf16_f32 v25, v106, v107
v_cvt_pk_bf16_f32 v26, v108, v109
STUB_13:
s_cbranch_execz STUB_16
v_cvt_pk_bf16_f32 v27, v110, v111
buffer_store_dwordx4 v[24:27], v244, s[20:23], s50 offen offset:0
v_accvgpr_read_b32 v112, a36
v_accvgpr_read_b32 v113, a37
v_accvgpr_read_b32 v114, a38
v_accvgpr_read_b32 v115, a39
v_accvgpr_read_b32 v116, a52
v_accvgpr_read_b32 v117, a53
v_accvgpr_read_b32 v118, a54
v_accvgpr_read_b32 v119, a55
v_pk_mul_f32 v[112:113], v[112:113], v[126:127]
v_pk_mul_f32 v[114:115], v[114:115], v[126:127]
v_pk_mul_f32 v[116:117], v[116:117], v[126:127]
v_pk_mul_f32 v[118:119], v[118:119], v[126:127]
v_cvt_pk_bf16_f32 v28, v112, v113
v_cvt_pk_bf16_f32 v29, v114, v115
v_cvt_pk_bf16_f32 v30, v116, v117
v_cvt_pk_bf16_f32 v31, v118, v119
buffer_store_dwordx4 v[28:31], v244, s[20:23], s50 offen offset:1024
v_accvgpr_read_b32 v104, a68
v_accvgpr_read_b32 v105, a69
v_accvgpr_read_b32 v106, a70
v_accvgpr_read_b32 v107, a71
v_accvgpr_read_b32 v108, a84
v_accvgpr_read_b32 v109, a85
v_accvgpr_read_b32 v110, a86
v_accvgpr_read_b32 v111, a87
v_pk_mul_f32 v[104:105], v[104:105], v[126:127]
v_pk_mul_f32 v[106:107], v[106:107], v[126:127]
v_pk_mul_f32 v[108:109], v[108:109], v[126:127]
v_pk_mul_f32 v[110:111], v[110:111], v[126:127]
v_cvt_pk_bf16_f32 v32, v104, v105
v_cvt_pk_bf16_f32 v33, v106, v107
v_cvt_pk_bf16_f32 v34, v108, v109
v_cvt_pk_bf16_f32 v35, v110, v111
buffer_store_dwordx4 v[32:35], v244, s[20:23], s50 offen offset:2048
v_accvgpr_read_b32 v112, a100
v_accvgpr_read_b32 v113, a101
v_accvgpr_read_b32 v114, a102
v_accvgpr_read_b32 v115, a103
v_accvgpr_read_b32 v116, a116
v_accvgpr_read_b32 v117, a117
v_accvgpr_read_b32 v118, a118
v_accvgpr_read_b32 v119, a119
v_pk_mul_f32 v[112:113], v[112:113], v[126:127]
v_pk_mul_f32 v[114:115], v[114:115], v[126:127]
v_pk_mul_f32 v[116:117], v[116:117], v[126:127]
v_pk_mul_f32 v[118:119], v[118:119], v[126:127]
v_cvt_pk_bf16_f32 v36, v112, v113
v_cvt_pk_bf16_f32 v37, v114, v115
v_cvt_pk_bf16_f32 v38, v116, v117
v_cvt_pk_bf16_f32 v39, v118, v119
buffer_store_dwordx4 v[36:39], v244, s[20:23], s50 offen offset:3072
v_mfma_f32_16x16x32_bf16 a[12:15], a[176:179], v[100:103], a[12:15]
v_mfma_f32_16x16x32_bf16 a[28:31], a[180:183], v[100:103], a[28:31]
v_mfma_f32_16x16x32_bf16 a[44:47], a[184:187], v[100:103], a[44:47]
v_mfma_f32_16x16x32_bf16 a[60:63], a[188:191], v[100:103], a[60:63]
v_mfma_f32_16x16x32_bf16 a[76:79], a[192:195], v[100:103], a[76:79]
v_mfma_f32_16x16x32_bf16 a[92:95], a[196:199], v[100:103], a[92:95]
v_mfma_f32_16x16x32_bf16 a[108:111], a[200:203], v[100:103], a[108:111]
v_mfma_f32_16x16x32_bf16 a[124:127], a[204:207], v[100:103], a[124:127]
v_accvgpr_read_b32 v122, a132
v_accvgpr_read_b32 v128, a133
v_add_f32 v122, v122, v128
v_rcp_f32 v128, v122
s_add_u32 s50, s44, 8192
v_mov_b32 v129, v128
v_accvgpr_read_b32 v104, a8
v_accvgpr_read_b32 v105, a9
v_accvgpr_read_b32 v106, a10
v_accvgpr_read_b32 v107, a11
v_accvgpr_read_b32 v108, a24
v_accvgpr_read_b32 v109, a25
v_accvgpr_read_b32 v110, a26
v_accvgpr_read_b32 v111, a27
v_pk_mul_f32 v[104:105], v[104:105], v[128:129]
v_pk_mul_f32 v[106:107], v[106:107], v[128:129]
v_pk_mul_f32 v[108:109], v[108:109], v[128:129]
v_pk_mul_f32 v[110:111], v[110:111], v[128:129]
v_cvt_pk_bf16_f32 v40, v104, v105
v_cvt_pk_bf16_f32 v41, v106, v107
v_cvt_pk_bf16_f32 v42, v108, v109
v_cvt_pk_bf16_f32 v43, v110, v111
buffer_store_dwordx4 v[40:43], v244, s[20:23], s50 offen offset:0
v_accvgpr_read_b32 v112, a40
v_accvgpr_read_b32 v113, a41
v_accvgpr_read_b32 v114, a42
v_accvgpr_read_b32 v115, a43
v_accvgpr_read_b32 v116, a56
v_accvgpr_read_b32 v117, a57
v_accvgpr_read_b32 v118, a58
v_accvgpr_read_b32 v119, a59
v_pk_mul_f32 v[112:113], v[112:113], v[128:129]
v_pk_mul_f32 v[114:115], v[114:115], v[128:129]
v_pk_mul_f32 v[116:117], v[116:117], v[128:129]
v_pk_mul_f32 v[118:119], v[118:119], v[128:129]
v_cvt_pk_bf16_f32 v44, v112, v113
v_cvt_pk_bf16_f32 v45, v114, v115
v_cvt_pk_bf16_f32 v46, v116, v117
v_cvt_pk_bf16_f32 v47, v118, v119
buffer_store_dwordx4 v[44:47], v244, s[20:23], s50 offen offset:1024
v_accvgpr_read_b32 v104, a72
v_accvgpr_read_b32 v105, a73
v_accvgpr_read_b32 v106, a74
v_accvgpr_read_b32 v107, a75
v_accvgpr_read_b32 v108, a88
v_accvgpr_read_b32 v109, a89
v_accvgpr_read_b32 v110, a90
v_accvgpr_read_b32 v111, a91
v_pk_mul_f32 v[104:105], v[104:105], v[128:129]
v_pk_mul_f32 v[106:107], v[106:107], v[128:129]
v_pk_mul_f32 v[108:109], v[108:109], v[128:129]
v_pk_mul_f32 v[110:111], v[110:111], v[128:129]
v_cvt_pk_bf16_f32 v48, v104, v105
v_cvt_pk_bf16_f32 v49, v106, v107
v_cvt_pk_bf16_f32 v50, v108, v109
v_cvt_pk_bf16_f32 v51, v110, v111
buffer_store_dwordx4 v[48:51], v244, s[20:23], s50 offen offset:2048
v_accvgpr_read_b32 v112, a104
v_accvgpr_read_b32 v113, a105
v_accvgpr_read_b32 v114, a106
v_accvgpr_read_b32 v115, a107
v_accvgpr_read_b32 v116, a120
v_accvgpr_read_b32 v117, a121
v_accvgpr_read_b32 v118, a122
v_accvgpr_read_b32 v119, a123
v_pk_mul_f32 v[112:113], v[112:113], v[128:129]
v_pk_mul_f32 v[114:115], v[114:115], v[128:129]
v_pk_mul_f32 v[116:117], v[116:117], v[128:129]
v_pk_mul_f32 v[118:119], v[118:119], v[128:129]
v_cvt_pk_bf16_f32 v52, v112, v113
v_cvt_pk_bf16_f32 v53, v114, v115
v_cvt_pk_bf16_f32 v54, v116, v117
v_cvt_pk_bf16_f32 v55, v118, v119
buffer_store_dwordx4 v[52:55], v244, s[20:23], s50 offen offset:3072
s_nop 7
v_accvgpr_read_b32 v123, a134
v_accvgpr_read_b32 v130, a135
v_add_f32 v123, v123, v130
v_rcp_f32 v130, v123
s_add_u32 s50, s44, 12288
v_mov_b32 v131, v130
v_accvgpr_read_b32 v104, a12
v_accvgpr_read_b32 v105, a13
v_accvgpr_read_b32 v106, a14
v_accvgpr_read_b32 v107, a15
v_accvgpr_read_b32 v108, a28
v_accvgpr_read_b32 v109, a29
v_accvgpr_read_b32 v110, a30
v_accvgpr_read_b32 v111, a31
v_pk_mul_f32 v[104:105], v[104:105], v[130:131]
v_pk_mul_f32 v[106:107], v[106:107], v[130:131]
v_pk_mul_f32 v[108:109], v[108:109], v[130:131]
v_pk_mul_f32 v[110:111], v[110:111], v[130:131]
v_cvt_pk_bf16_f32 v56, v104, v105
v_cvt_pk_bf16_f32 v57, v106, v107
v_cvt_pk_bf16_f32 v58, v108, v109
v_cvt_pk_bf16_f32 v59, v110, v111
buffer_store_dwordx4 v[56:59], v244, s[20:23], s50 offen offset:0
v_accvgpr_read_b32 v112, a44
v_accvgpr_read_b32 v113, a45
v_accvgpr_read_b32 v114, a46
v_accvgpr_read_b32 v115, a47
v_accvgpr_read_b32 v116, a60
v_accvgpr_read_b32 v117, a61
v_accvgpr_read_b32 v118, a62
v_accvgpr_read_b32 v119, a63
v_pk_mul_f32 v[112:113], v[112:113], v[130:131]
v_pk_mul_f32 v[114:115], v[114:115], v[130:131]
v_pk_mul_f32 v[116:117], v[116:117], v[130:131]
v_pk_mul_f32 v[118:119], v[118:119], v[130:131]
v_cvt_pk_bf16_f32 v60, v112, v113
v_cvt_pk_bf16_f32 v61, v114, v115
v_cvt_pk_bf16_f32 v62, v116, v117
v_cvt_pk_bf16_f32 v63, v118, v119
buffer_store_dwordx4 v[60:63], v244, s[20:23], s50 offen offset:1024
v_accvgpr_read_b32 v104, a76
v_accvgpr_read_b32 v105, a77
v_accvgpr_read_b32 v106, a78
v_accvgpr_read_b32 v107, a79
v_accvgpr_read_b32 v108, a92
v_accvgpr_read_b32 v109, a93
v_accvgpr_read_b32 v110, a94
v_accvgpr_read_b32 v111, a95
v_pk_mul_f32 v[104:105], v[104:105], v[130:131]
v_pk_mul_f32 v[106:107], v[106:107], v[130:131]
v_pk_mul_f32 v[108:109], v[108:109], v[130:131]
v_pk_mul_f32 v[110:111], v[110:111], v[130:131]
v_cvt_pk_bf16_f32 v64, v104, v105
v_cvt_pk_bf16_f32 v65, v106, v107
v_cvt_pk_bf16_f32 v66, v108, v109
v_cvt_pk_bf16_f32 v67, v110, v111
buffer_store_dwordx4 v[64:67], v244, s[20:23], s50 offen offset:2048
v_accvgpr_read_b32 v112, a108
v_accvgpr_read_b32 v113, a109
v_accvgpr_read_b32 v114, a110
v_accvgpr_read_b32 v115, a111
v_accvgpr_read_b32 v116, a124
v_accvgpr_read_b32 v117, a125
v_accvgpr_read_b32 v118, a126
v_accvgpr_read_b32 v119, a127
v_pk_mul_f32 v[112:113], v[112:113], v[130:131]
v_pk_mul_f32 v[114:115], v[114:115], v[130:131]
v_pk_mul_f32 v[116:117], v[116:117], v[130:131]
v_pk_mul_f32 v[118:119], v[118:119], v[130:131]
v_cvt_pk_bf16_f32 v68, v112, v113
v_cvt_pk_bf16_f32 v69, v114, v115
v_cvt_pk_bf16_f32 v70, v116, v117
v_cvt_pk_bf16_f32 v71, v118, v119
buffer_store_dwordx4 v[68:71], v244, s[20:23], s50 offen offset:3072
v_max3_f32 v104, v120, v121, v122
v_max_f32 v104, v104, v123
v_add_f32 v105, v120, v121
v_add_f32 v105, v105, v122
v_add_f32 v105, v105, v123
v_cmp_nge_f32 vcc, s42, v104
v_cmp_u_f32 s[28:29], v105, v105
s_or_b64 vcc, vcc, s[28:29]
s_cmp_lg_u64 vcc, 0
s_cselect_b32 s28, 1, 0
v_mov_b32 v104, s28
s_lshl_b32 s29, s37, 2
s_add_u32 s29, s29, 147968
v_mov_b32 v105, s29
v_mov_b32 v106, 147968
ds_write_b32 v105, v104
s_waitcnt vmcnt(16) lgkmcnt(0)
s_barrier
ds_read_b128 v[108:111], v106
ds_read_b64_tr_b16 a[64:65], v237 offset:0
ds_read_b64_tr_b16 a[66:67], v237 offset:4608
ds_read_b64_tr_b16 a[68:69], v237 offset:8
ds_read_b64_tr_b16 a[70:71], v237 offset:4616
ds_read_b64_tr_b16 a[72:73], v238 offset:0
ds_read_b64_tr_b16 a[74:75], v238 offset:4608
ds_read_b64_tr_b16 a[76:77], v238 offset:8
ds_read_b64_tr_b16 a[78:79], v238 offset:4616
ds_read_b64_tr_b16 a[80:81], v237 offset:128
ds_read_b64_tr_b16 a[82:83], v237 offset:4736
ds_read_b64_tr_b16 a[84:85], v237 offset:136
ds_read_b64_tr_b16 a[86:87], v237 offset:4744
ds_read_b64_tr_b16 a[88:89], v238 offset:128
ds_read_b64_tr_b16 a[90:91], v238 offset:4736
s_waitcnt lgkmcnt(14)
v_or_b32 v108, v108, v109
v_or3_b32 v108, v108, v110, v111
s_nop 0
v_readfirstlane_b32 s28, v108
s_cmp_gt_u32 s28, s43
s_cbranch_scc1 K_FALLBACK
s_waitcnt lgkmcnt(8)
v_mfma_f32_16x16x32_bf16 v[96:99], a[64:67], v[56:59], 0
ds_read_b64_tr_b16 a[92:93], v238 offset:136
ds_read_b64_tr_b16 a[94:95], v238 offset:4744
v_mfma_f32_16x16x32_bf16 v[88:91], a[64:67], v[40:43], 0
s_lshr_b32 s32, s35, 2
s_and_b32 s33, s35, 3
v_mfma_f32_16x16x32_bf16 v[80:83], a[64:67], v[24:27], 0
s_lshl_b32 s94, s36, 9
s_lshl_b32 s28, s32, 6
v_mfma_f32_16x16x32_bf16 v[72:75], a[64:67], v[8:11], 0
s_lshr_b32 s34, s32, 2
v_mfma_f32_16x16x32_bf16 v[76:79], a[68:71], v[8:11], 0
ds_read_b64_tr_b16 a[64:65], v239 offset:0
ds_read_b64_tr_b16 a[66:67], v239 offset:4608
v_mfma_f32_16x16x32_bf16 v[84:87], a[68:71], v[24:27], 0
s_add_u32 s94, s94, s28
s_lshl_b32 s28, s37, 4
v_mfma_f32_16x16x32_bf16 v[92:95], a[68:71], v[40:43], 0
s_add_u32 s94, s94, s28
s_add_u32 s94, s94, 0x248000
v_mfma_f32_16x16x32_bf16 v[100:103], a[68:71], v[56:59], 0
v_mov_b32 v231, 1
v_and_b32 v229, 7, v1
v_mfma_f32_16x16x32_bf16 v[128:131], a[72:75], v[56:59], 0
ds_read_b64_tr_b16 a[68:69], v237 offset:9216
ds_read_b64_tr_b16 a[70:71], v237 offset:13824
v_mfma_f32_16x16x32_bf16 v[120:123], a[72:75], v[40:43], 0
v_lshlrev_b32 v229, 2, v229
v_lshlrev_b32 v226, 3, v1
v_mfma_f32_16x16x32_bf16 v[112:115], a[72:75], v[24:27], 0
s_lshl2_add_u32 s29, s33, s94
v_mfma_f32_16x16x32_bf16 v[104:107], a[72:75], v[8:11], 0
s_waitcnt lgkmcnt(8)
v_mfma_f32_16x16x32_bf16 v[108:111], a[76:79], v[8:11], 0
ds_read_b64_tr_b16 a[72:73], v237 offset:9224
ds_read_b64_tr_b16 a[74:75], v237 offset:13832
v_mfma_f32_16x16x32_bf16 v[116:119], a[76:79], v[24:27], 0
v_mfma_f32_16x16x32_bf16 v[124:127], a[76:79], v[40:43], 0
v_mfma_f32_16x16x32_bf16 v[132:135], a[76:79], v[56:59], 0
v_mfma_f32_16x16x32_bf16 v[160:163], a[80:83], v[56:59], 0
ds_read_b64_tr_b16 a[76:77], v238 offset:9216
ds_read_b64_tr_b16 a[78:79], v238 offset:13824
v_mfma_f32_16x16x32_bf16 v[152:155], a[80:83], v[40:43], 0
v_mfma_f32_16x16x32_bf16 v[144:147], a[80:83], v[24:27], 0
v_mfma_f32_16x16x32_bf16 v[136:139], a[80:83], v[8:11], 0
v_mfma_f32_16x16x32_bf16 v[140:143], a[84:87], v[8:11], 0
ds_read_b64_tr_b16 a[80:81], v238 offset:9224
ds_read_b64_tr_b16 a[82:83], v238 offset:13832
v_mfma_f32_16x16x32_bf16 v[148:151], a[84:87], v[24:27], 0
s_waitcnt vmcnt(0)
buffer_store_dword v231, v254, s[20:23], s29 offen
v_mfma_f32_16x16x32_bf16 v[156:159], a[84:87], v[40:43], 0
s_add_u32 s28, s35, 1
s_and_b32 s28, s28, 3
v_mfma_f32_16x16x32_bf16 v[164:167], a[84:87], v[56:59], 0
s_mul_i32 s28, s28, 36864
s_waitcnt lgkmcnt(8)
v_mfma_f32_16x16x32_bf16 v[192:195], a[88:91], v[56:59], 0
ds_read_b64_tr_b16 a[84:85], v237 offset:9344
ds_read_b64_tr_b16 a[86:87], v237 offset:13952
v_mfma_f32_16x16x32_bf16 v[184:187], a[88:91], v[40:43], 0
v_add_u32 v216, s28, v234
v_add_u32 v217, s28, v235
v_mfma_f32_16x16x32_bf16 v[176:179], a[88:91], v[24:27], 0
v_add_u32 v218, s28, v236
v_mfma_f32_16x16x32_bf16 v[168:171], a[88:91], v[8:11], 0
v_mfma_f32_16x16x32_bf16 v[172:175], a[92:95], v[8:11], 0
ds_read_b64_tr_b16 a[88:89], v237 offset:9352
ds_read_b64_tr_b16 a[90:91], v237 offset:13960
v_mfma_f32_16x16x32_bf16 v[180:183], a[92:95], v[24:27], 0
v_mfma_f32_16x16x32_bf16 v[188:191], a[92:95], v[40:43], 0
v_mfma_f32_16x16x32_bf16 v[196:199], a[92:95], v[56:59], 0
v_mfma_f32_16x16x32_bf16 v[212:215], a[64:67], v[56:59], 0
ds_read_b64_tr_b16 a[92:93], v238 offset:9344
ds_read_b64_tr_b16 a[94:95], v238 offset:13952
v_mfma_f32_16x16x32_bf16 v[208:211], a[64:67], v[40:43], 0
v_mfma_f32_16x16x32_bf16 v[204:207], a[64:67], v[24:27], 0
v_mfma_f32_16x16x32_bf16 v[200:203], a[64:67], v[8:11], 0
s_waitcnt lgkmcnt(8)
v_mfma_f32_16x16x32_bf16 v[72:75], a[68:71], v[12:15], v[72:75]
ds_read_b64_tr_b16 a[64:65], v238 offset:9352
ds_read_b64_tr_b16 a[66:67], v238 offset:13960
v_mfma_f32_16x16x32_bf16 v[80:83], a[68:71], v[28:31], v[80:83]
v_mfma_f32_16x16x32_bf16 v[88:91], a[68:71], v[44:47], v[88:91]
v_mfma_f32_16x16x32_bf16 v[96:99], a[68:71], v[60:63], v[96:99]
v_mfma_f32_16x16x32_bf16 v[100:103], a[72:75], v[60:63], v[100:103]
ds_read_b64_tr_b16 a[68:69], v239 offset:9216
ds_read_b64_tr_b16 a[70:71], v239 offset:13824
v_mfma_f32_16x16x32_bf16 v[92:95], a[72:75], v[44:47], v[92:95]
buffer_load_dword v230, v229, s[20:23], s94 offen sc0 sc1
v_mfma_f32_16x16x32_bf16 v[84:87], a[72:75], v[28:31], v[84:87]
s_add_u32 s39, s35, 1
s_and_b32 s39, s39, 3
v_mfma_f32_16x16x32_bf16 v[76:79], a[72:75], v[12:15], v[76:79]
s_add_u32 s28, s33, 1
s_and_b32 s28, s28, 3
v_mfma_f32_16x16x32_bf16 v[104:107], a[76:79], v[12:15], v[104:107]
ds_read_b64_tr_b16 a[72:73], v237 offset:18432
ds_read_b64_tr_b16 a[74:75], v237 offset:23040
v_mfma_f32_16x16x32_bf16 v[112:115], a[76:79], v[28:31], v[112:115]
s_sub_u32 s28, s28, s33
s_lshl_b32 s28, s28, 16
v_mfma_f32_16x16x32_bf16 v[120:123], a[76:79], v[44:47], v[120:123]
s_add_u32 s64, s28, s44
s_add_u32 s65, s64, 4096
v_mfma_f32_16x16x32_bf16 v[128:131], a[76:79], v[60:63], v[128:131]
s_add_u32 s66, s64, 8192
s_add_u32 s67, s64, 12288
s_waitcnt lgkmcnt(8)
v_mfma_f32_16x16x32_bf16 v[132:135], a[80:83], v[60:63], v[132:135]
ds_read_b64_tr_b16 a[76:77], v237 offset:18440
ds_read_b64_tr_b16 a[78:79], v237 offset:23048
v_mfma_f32_16x16x32_bf16 v[124:127], a[80:83], v[44:47], v[124:127]
s_add_u32 s28, s35, 2
s_and_b32 s28, s28, 3
v_mfma_f32_16x16x32_bf16 v[116:119], a[80:83], v[28:31], v[116:119]
s_mul_i32 s28, s28, 36864
v_mfma_f32_16x16x32_bf16 v[108:111], a[80:83], v[12:15], v[108:111]
v_add_u32 v219, s28, v234
v_add_u32 v220, s28, v235
v_mfma_f32_16x16x32_bf16 v[136:139], a[84:87], v[12:15], v[136:139]
ds_read_b64_tr_b16 a[80:81], v238 offset:18432
ds_read_b64_tr_b16 a[82:83], v238 offset:23040
v_mfma_f32_16x16x32_bf16 v[144:147], a[84:87], v[28:31], v[144:147]
v_add_u32 v221, s28, v236
v_mfma_f32_16x16x32_bf16 v[152:155], a[84:87], v[44:47], v[152:155]
s_add_u32 s28, s35, 3
s_and_b32 s28, s28, 3
v_mfma_f32_16x16x32_bf16 v[160:163], a[84:87], v[60:63], v[160:163]
s_mul_i32 s28, s28, 36864
v_mfma_f32_16x16x32_bf16 v[164:167], a[88:91], v[60:63], v[164:167]
ds_read_b64_tr_b16 a[84:85], v238 offset:18440
ds_read_b64_tr_b16 a[86:87], v238 offset:23048
v_mfma_f32_16x16x32_bf16 v[156:159], a[88:91], v[44:47], v[156:159]
v_add_u32 v222, s28, v234
v_add_u32 v223, s28, v235
v_mfma_f32_16x16x32_bf16 v[148:151], a[88:91], v[28:31], v[148:151]
v_add_u32 v224, s28, v236
v_mfma_f32_16x16x32_bf16 v[140:143], a[88:91], v[12:15], v[140:143]
s_waitcnt lgkmcnt(8)
v_mfma_f32_16x16x32_bf16 v[168:171], a[92:95], v[12:15], v[168:171]
ds_read_b64_tr_b16 a[88:89], v237 offset:18560
ds_read_b64_tr_b16 a[90:91], v237 offset:23168
v_mfma_f32_16x16x32_bf16 v[176:179], a[92:95], v[28:31], v[176:179]
v_mfma_f32_16x16x32_bf16 v[184:187], a[92:95], v[44:47], v[184:187]
s_waitcnt vmcnt(0)
v_cmp_gt_u32 vcc, 1, v230
v_mfma_f32_16x16x32_bf16 v[192:195], a[92:95], v[60:63], v[192:195]
v_mfma_f32_16x16x32_bf16 v[196:199], a[64:67], v[60:63], v[196:199]
ds_read_b64_tr_b16 a[92:93], v237 offset:18568
ds_read_b64_tr_b16 a[94:95], v237 offset:23176
v_mfma_f32_16x16x32_bf16 v[188:191], a[64:67], v[44:47], v[188:191]
s_bitcmp1_b32 vcc_lo, s39
s_cbranch_scc1 SP_O1A
SP_O1A_RET:
v_mfma_f32_16x16x32_bf16 v[180:183], a[64:67], v[28:31], v[180:183]
buffer_load_dwordx4 a[128:131], v244, s[20:23], s64 offen offset:0 sc0 sc1
v_mfma_f32_16x16x32_bf16 v[172:175], a[64:67], v[12:15], v[172:175]
v_mfma_f32_16x16x32_bf16 v[200:203], a[68:71], v[12:15], v[200:203]
ds_read_b64_tr_b16 a[64:65], v238 offset:18560
ds_read_b64_tr_b16 a[66:67], v238 offset:23168
v_mfma_f32_16x16x32_bf16 v[204:207], a[68:71], v[28:31], v[204:207]
v_mfma_f32_16x16x32_bf16 v[208:211], a[68:71], v[44:47], v[208:211]
buffer_load_dwordx4 a[144:147], v244, s[20:23], s65 offen offset:0 sc0 sc1
v_mfma_f32_16x16x32_bf16 v[212:215], a[68:71], v[60:63], v[212:215]
s_waitcnt lgkmcnt(8)
v_mfma_f32_16x16x32_bf16 v[96:99], a[72:75], v[64:67], v[96:99]
ds_read_b64_tr_b16 a[68:69], v238 offset:18568
ds_read_b64_tr_b16 a[70:71], v238 offset:23176
v_mfma_f32_16x16x32_bf16 v[88:91], a[72:75], v[48:51], v[88:91]
v_mfma_f32_16x16x32_bf16 v[80:83], a[72:75], v[32:35], v[80:83]
buffer_load_dwordx4 a[160:163], v244, s[20:23], s66 offen offset:0 sc0 sc1
v_mfma_f32_16x16x32_bf16 v[72:75], a[72:75], v[16:19], v[72:75]
v_mfma_f32_16x16x32_bf16 v[76:79], a[76:79], v[16:19], v[76:79]
ds_read_b64_tr_b16 a[72:73], v239 offset:18432
ds_read_b64_tr_b16 a[74:75], v239 offset:23040
v_mfma_f32_16x16x32_bf16 v[84:87], a[76:79], v[32:35], v[84:87]
v_mfma_f32_16x16x32_bf16 v[92:95], a[76:79], v[48:51], v[92:95]
buffer_load_dwordx4 a[176:179], v244, s[20:23], s67 offen offset:0 sc0 sc1
v_mfma_f32_16x16x32_bf16 v[100:103], a[76:79], v[64:67], v[100:103]
v_mfma_f32_16x16x32_bf16 v[128:131], a[80:83], v[64:67], v[128:131]
ds_read_b64_tr_b16 a[76:77], v237 offset:27648
ds_read_b64_tr_b16 a[78:79], v237 offset:32256
v_mfma_f32_16x16x32_bf16 v[120:123], a[80:83], v[48:51], v[120:123]
v_mfma_f32_16x16x32_bf16 v[112:115], a[80:83], v[32:35], v[112:115]
buffer_load_dwordx4 a[132:135], v244, s[20:23], s64 offen offset:1024 sc0 sc1
v_mfma_f32_16x16x32_bf16 v[104:107], a[80:83], v[16:19], v[104:107]
s_waitcnt lgkmcnt(8)
v_mfma_f32_16x16x32_bf16 v[108:111], a[84:87], v[16:19], v[108:111]
ds_read_b64_tr_b16 a[80:81], v237 offset:27656
ds_read_b64_tr_b16 a[82:83], v237 offset:32264
v_mfma_f32_16x16x32_bf16 v[116:119], a[84:87], v[32:35], v[116:119]
v_mfma_f32_16x16x32_bf16 v[124:127], a[84:87], v[48:51], v[124:127]
buffer_load_dwordx4 a[148:151], v244, s[20:23], s65 offen offset:1024 sc0 sc1
v_mfma_f32_16x16x32_bf16 v[132:135], a[84:87], v[64:67], v[132:135]
v_mfma_f32_16x16x32_bf16 v[160:163], a[88:91], v[64:67], v[160:163]
ds_read_b64_tr_b16 a[84:85], v238 offset:27648
ds_read_b64_tr_b16 a[86:87], v238 offset:32256
v_mfma_f32_16x16x32_bf16 v[152:155], a[88:91], v[48:51], v[152:155]
v_mfma_f32_16x16x32_bf16 v[144:147], a[88:91], v[32:35], v[144:147]
buffer_load_dwordx4 a[164:167], v244, s[20:23], s66 offen offset:1024 sc0 sc1
v_mfma_f32_16x16x32_bf16 v[136:139], a[88:91], v[16:19], v[136:139]
v_mfma_f32_16x16x32_bf16 v[140:143], a[92:95], v[16:19], v[140:143]
ds_read_b64_tr_b16 a[88:89], v238 offset:27656
ds_read_b64_tr_b16 a[90:91], v238 offset:32264
v_mfma_f32_16x16x32_bf16 v[148:151], a[92:95], v[32:35], v[148:151]
v_mfma_f32_16x16x32_bf16 v[156:159], a[92:95], v[48:51], v[156:159]
buffer_load_dwordx4 a[180:183], v244, s[20:23], s67 offen offset:1024 sc0 sc1
v_mfma_f32_16x16x32_bf16 v[164:167], a[92:95], v[64:67], v[164:167]
s_waitcnt lgkmcnt(8)
v_mfma_f32_16x16x32_bf16 v[192:195], a[64:67], v[64:67], v[192:195]
ds_read_b64_tr_b16 a[92:93], v237 offset:27776
ds_read_b64_tr_b16 a[94:95], v237 offset:32384
v_mfma_f32_16x16x32_bf16 v[184:187], a[64:67], v[48:51], v[184:187]
v_mfma_f32_16x16x32_bf16 v[176:179], a[64:67], v[32:35], v[176:179]
buffer_load_dwordx4 a[136:139], v244, s[20:23], s64 offen offset:2048 sc0 sc1
v_mfma_f32_16x16x32_bf16 v[168:171], a[64:67], v[16:19], v[168:171]
buffer_load_dword v230, v229, s[20:23], s94 offen sc0 sc1
v_mfma_f32_16x16x32_bf16 v[172:175], a[68:71], v[16:19], v[172:175]
ds_read_b64_tr_b16 a[64:65], v237 offset:27784
ds_read_b64_tr_b16 a[66:67], v237 offset:32392
v_mfma_f32_16x16x32_bf16 v[180:183], a[68:71], v[32:35], v[180:183]
v_mfma_f32_16x16x32_bf16 v[188:191], a[68:71], v[48:51], v[188:191]
v_mfma_f32_16x16x32_bf16 v[196:199], a[68:71], v[64:67], v[196:199]
buffer_load_dwordx4 a[152:155], v244, s[20:23], s65 offen offset:2048 sc0 sc1
v_mfma_f32_16x16x32_bf16 v[212:215], a[72:75], v[64:67], v[212:215]
ds_read_b64_tr_b16 a[68:69], v238 offset:27776
ds_read_b64_tr_b16 a[70:71], v238 offset:32384
v_mfma_f32_16x16x32_bf16 v[208:211], a[72:75], v[48:51], v[208:211]
v_mfma_f32_16x16x32_bf16 v[204:207], a[72:75], v[32:35], v[204:207]
v_mfma_f32_16x16x32_bf16 v[200:203], a[72:75], v[16:19], v[200:203]
buffer_load_dwordx4 a[168:171], v244, s[20:23], s66 offen offset:2048 sc0 sc1
s_waitcnt lgkmcnt(8)
v_mfma_f32_16x16x32_bf16 v[72:75], a[76:79], v[20:23], v[72:75]
ds_read_b64_tr_b16 a[72:73], v238 offset:27784
ds_read_b64_tr_b16 a[74:75], v238 offset:32392
v_mfma_f32_16x16x32_bf16 v[80:83], a[76:79], v[36:39], v[80:83]
v_mfma_f32_16x16x32_bf16 v[88:91], a[76:79], v[52:55], v[88:91]
v_mfma_f32_16x16x32_bf16 v[96:99], a[76:79], v[68:71], v[96:99]
buffer_load_dwordx4 a[184:187], v244, s[20:23], s67 offen offset:2048 sc0 sc1
v_mfma_f32_16x16x32_bf16 v[100:103], a[80:83], v[68:71], v[100:103]
ds_read_b64_tr_b16 a[76:77], v239 offset:27648
ds_read_b64_tr_b16 a[78:79], v239 offset:32256
v_mfma_f32_16x16x32_bf16 v[92:95], a[80:83], v[52:55], v[92:95]
v_mfma_f32_16x16x32_bf16 v[84:87], a[80:83], v[36:39], v[84:87]
v_mfma_f32_16x16x32_bf16 v[76:79], a[80:83], v[20:23], v[76:79]
buffer_load_dwordx4 a[140:143], v244, s[20:23], s64 offen offset:3072 sc0 sc1
v_mfma_f32_16x16x32_bf16 v[104:107], a[84:87], v[20:23], v[104:107]
ds_read_b64_tr_b16 a[80:81], v216 offset:0
ds_read_b64_tr_b16 a[82:83], v216 offset:4608
v_mfma_f32_16x16x32_bf16 v[112:115], a[84:87], v[36:39], v[112:115]
v_mfma_f32_16x16x32_bf16 v[120:123], a[84:87], v[52:55], v[120:123]
v_mfma_f32_16x16x32_bf16 v[128:131], a[84:87], v[68:71], v[128:131]
buffer_load_dwordx4 a[156:159], v244, s[20:23], s65 offen offset:3072 sc0 sc1
s_waitcnt lgkmcnt(8)
v_mfma_f32_16x16x32_bf16 v[132:135], a[88:91], v[68:71], v[132:135]
ds_read_b64_tr_b16 a[84:85], v216 offset:8
ds_read_b64_tr_b16 a[86:87], v216 offset:4616
v_mfma_f32_16x16x32_bf16 v[124:127], a[88:91], v[52:55], v[124:127]
v_mfma_f32_16x16x32_bf16 v[116:119], a[88:91], v[36:39], v[116:119]
v_mfma_f32_16x16x32_bf16 v[108:111], a[88:91], v[20:23], v[108:111]
buffer_load_dwordx4 a[172:175], v244, s[20:23], s66 offen offset:3072 sc0 sc1
v_mfma_f32_16x16x32_bf16 v[136:139], a[92:95], v[20:23], v[136:139]
ds_read_b64_tr_b16 a[88:89], v217 offset:0
ds_read_b64_tr_b16 a[90:91], v217 offset:4608
v_mfma_f32_16x16x32_bf16 v[144:147], a[92:95], v[36:39], v[144:147]
v_mfma_f32_16x16x32_bf16 v[152:155], a[92:95], v[52:55], v[152:155]
v_mfma_f32_16x16x32_bf16 v[160:163], a[92:95], v[68:71], v[160:163]
buffer_load_dwordx4 a[188:191], v244, s[20:23], s67 offen offset:3072 sc0 sc1
v_mfma_f32_16x16x32_bf16 v[164:167], a[64:67], v[68:71], v[164:167]
ds_read_b64_tr_b16 a[92:93], v217 offset:8
ds_read_b64_tr_b16 a[94:95], v217 offset:4616
v_mfma_f32_16x16x32_bf16 v[156:159], a[64:67], v[52:55], v[156:159]
s_add_u32 s28, s33, 2
s_and_b32 s28, s28, 3
v_mfma_f32_16x16x32_bf16 v[148:151], a[64:67], v[36:39], v[148:151]
s_sub_u32 s28, s28, s33
s_lshl_b32 s28, s28, 16
v_mfma_f32_16x16x32_bf16 v[140:143], a[64:67], v[20:23], v[140:143]
s_add_u32 s64, s28, s44
s_add_u32 s65, s64, 4096
s_waitcnt lgkmcnt(8)
v_mfma_f32_16x16x32_bf16 v[168:171], a[68:71], v[20:23], v[168:171]
ds_read_b64_tr_b16 a[64:65], v216 offset:128
ds_read_b64_tr_b16 a[66:67], v216 offset:4736
v_mfma_f32_16x16x32_bf16 v[176:179], a[68:71], v[36:39], v[176:179]
s_add_u32 s66, s64, 8192
s_add_u32 s67, s64, 12288
v_mfma_f32_16x16x32_bf16 v[184:187], a[68:71], v[52:55], v[184:187]
s_waitcnt vmcnt(7)
v_cmp_gt_u32 vcc, 1, v230
v_mfma_f32_16x16x32_bf16 v[192:195], a[68:71], v[68:71], v[192:195]
v_mfma_f32_16x16x32_bf16 v[196:199], a[72:75], v[68:71], v[196:199]
ds_read_b64_tr_b16 a[68:69], v216 offset:136
ds_read_b64_tr_b16 a[70:71], v216 offset:4744
v_mfma_f32_16x16x32_bf16 v[188:191], a[72:75], v[52:55], v[188:191]
s_and_b32 s29, vcc_lo, 15
s_cbranch_scc1 SP_O2A
SP_O2A_RET:
v_mfma_f32_16x16x32_bf16 v[180:183], a[72:75], v[36:39], v[180:183]
buffer_load_dwordx4 a[192:195], v244, s[20:23], s64 offen offset:0 sc0 sc1
v_mfma_f32_16x16x32_bf16 v[172:175], a[72:75], v[20:23], v[172:175]
v_mfma_f32_16x16x32_bf16 v[200:203], a[76:79], v[20:23], v[200:203]
ds_read_b64_tr_b16 a[72:73], v217 offset:128
ds_read_b64_tr_b16 a[74:75], v217 offset:4736
v_mfma_f32_16x16x32_bf16 v[204:207], a[76:79], v[36:39], v[204:207]
STUB_14:
s_cbranch_execz STUB_17
v_mfma_f32_16x16x32_bf16 v[208:211], a[76:79], v[52:55], v[208:211]
buffer_load_dwordx4 a[208:211], v244, s[20:23], s65 offen offset:0 sc0 sc1
v_mfma_f32_16x16x32_bf16 v[212:215], a[76:79], v[68:71], v[212:215]
s_waitcnt vmcnt(15)
s_waitcnt lgkmcnt(8)
v_mfma_f32_16x16x32_bf16 v[96:99], a[80:83], a[176:179], v[96:99]
ds_read_b64_tr_b16 a[76:77], v217 offset:136
ds_read_b64_tr_b16 a[78:79], v217 offset:4744
v_mfma_f32_16x16x32_bf16 v[88:91], a[80:83], a[160:163], v[88:91]
v_mfma_f32_16x16x32_bf16 v[80:83], a[80:83], a[144:147], v[80:83]
buffer_load_dwordx4 a[96:99], v244, s[20:23], s66 offen offset:0 sc0 sc1
v_mfma_f32_16x16x32_bf16 v[72:75], a[80:83], a[128:131], v[72:75]
v_accvgpr_read_b32 v39, a222
v_accvgpr_read_b32 v59, a232
v_mfma_f32_16x16x32_bf16 v[76:79], a[84:87], a[128:131], v[76:79]
ds_read_b64_tr_b16 a[80:81], v218 offset:0
ds_read_b64_tr_b16 a[82:83], v218 offset:4608
v_mfma_f32_16x16x32_bf16 v[84:87], a[84:87], a[144:147], v[84:87]
v_lshlrev_b32 v38, 16, v39
v_and_b32 v39, 0xffff0000, v39
v_mfma_f32_16x16x32_bf16 v[92:95], a[84:87], a[160:163], v[92:95]
buffer_load_dwordx4 a[112:115], v244, s[20:23], s67 offen offset:0 sc0 sc1
v_mfma_f32_16x16x32_bf16 v[100:103], a[84:87], a[176:179], v[100:103]
v_lshlrev_b32 v58, 16, v59
v_and_b32 v59, 0xffff0000, v59
v_mfma_f32_16x16x32_bf16 v[128:131], a[88:91], a[176:179], v[128:131]
ds_read_b64_tr_b16 a[84:85], v216 offset:9216
ds_read_b64_tr_b16 a[86:87], v216 offset:13824
v_mfma_f32_16x16x32_bf16 v[120:123], a[88:91], a[160:163], v[120:123]
v_add_f32 v38, v38, v58
v_add_f32 v39, v39, v59
v_mfma_f32_16x16x32_bf16 v[112:115], a[88:91], a[144:147], v[112:115]
buffer_load_dwordx4 a[196:199], v244, s[20:23], s64 offen offset:1024 sc0 sc1
v_mfma_f32_16x16x32_bf16 v[104:107], a[88:91], a[128:131], v[104:107]
v_cvt_pk_bf16_f32 v58, v38, v39
v_lshlrev_b32 v38, 16, v58
s_waitcnt lgkmcnt(8)
v_mfma_f32_16x16x32_bf16 v[108:111], a[92:95], a[128:131], v[108:111]
ds_read_b64_tr_b16 a[88:89], v216 offset:9224
ds_read_b64_tr_b16 a[90:91], v216 offset:13832
v_mfma_f32_16x16x32_bf16 v[116:119], a[92:95], a[144:147], v[116:119]
v_and_b32 v39, 0xffff0000, v58
v_mul_f32 v58, 0xbfb8aa3b, v38
v_mfma_f32_16x16x32_bf16 v[124:127], a[92:95], a[160:163], v[124:127]
buffer_load_dwordx4 a[244:247], v244, s[20:23], s65 offen offset:1024 sc0 sc1
v_mfma_f32_16x16x32_bf16 v[132:135], a[92:95], a[176:179], v[132:135]
v_mul_f32 v59, 0xbfb8aa3b, v39
v_mfma_f32_16x16x32_bf16 v[160:163], a[64:67], a[176:179], v[160:163]
ds_read_b64_tr_b16 a[92:93], v217 offset:9216
ds_read_b64_tr_b16 a[94:95], v217 offset:13824
v_mfma_f32_16x16x32_bf16 v[152:155], a[64:67], a[160:163], v[152:155]
v_exp_f32 v58, v58
v_mfma_f32_16x16x32_bf16 v[144:147], a[64:67], a[144:147], v[144:147]
buffer_load_dwordx4 a[100:103], v244, s[20:23], s66 offen offset:1024 sc0 sc1
v_mfma_f32_16x16x32_bf16 v[136:139], a[64:67], a[128:131], v[136:139]
v_exp_f32 v59, v59
v_mfma_f32_16x16x32_bf16 v[140:143], a[68:71], a[128:131], v[140:143]
ds_read_b64_tr_b16 a[64:65], v217 offset:9224
ds_read_b64_tr_b16 a[66:67], v217 offset:13832
v_mfma_f32_16x16x32_bf16 v[148:151], a[68:71], a[144:147], v[148:151]
v_add_f32 v58, 1.0, v58
v_add_f32 v59, 1.0, v59
v_mfma_f32_16x16x32_bf16 v[156:159], a[68:71], a[160:163], v[156:159]
buffer_load_dwordx4 a[116:119], v244, s[20:23], s67 offen offset:1024 sc0 sc1
v_mfma_f32_16x16x32_bf16 v[164:167], a[68:71], a[176:179], v[164:167]
v_rcp_f32 v58, v58
s_waitcnt lgkmcnt(8)
v_mfma_f32_16x16x32_bf16 v[192:195], a[72:75], a[176:179], v[192:195]
ds_read_b64_tr_b16 a[68:69], v216 offset:9344
ds_read_b64_tr_b16 a[70:71], v216 offset:13952
v_mfma_f32_16x16x32_bf16 v[184:187], a[72:75], a[160:163], v[184:187]
v_rcp_f32 v59, v59
v_mfma_f32_16x16x32_bf16 v[176:179], a[72:75], a[144:147], v[176:179]
buffer_load_dwordx4 a[200:203], v244, s[20:23], s64 offen offset:2048 sc0 sc1
v_mfma_f32_16x16x32_bf16 v[168:171], a[72:75], a[128:131], v[168:171]
v_mul_f32 v38, v38, v58
v_mul_f32 v39, v39, v59
v_mfma_f32_16x16x32_bf16 v[172:175], a[76:79], a[128:131], v[172:175]
ds_read_b64_tr_b16 a[72:73], v216 offset:9352
ds_read_b64_tr_b16 a[74:75], v216 offset:13960
v_mfma_f32_16x16x32_bf16 v[180:183], a[76:79], a[144:147], v[180:183]
v_cvt_pk_bf16_f32 v58, v38, v39
v_lshlrev_b32 v38, 16, v58
v_mfma_f32_16x16x32_bf16 v[188:191], a[76:79], a[160:163], v[188:191]
buffer_load_dwordx4 a[248:251], v244, s[20:23], s65 offen offset:2048 sc0 sc1
v_mfma_f32_16x16x32_bf16 v[196:199], a[76:79], a[176:179], v[196:199]
v_and_b32 v39, 0xffff0000, v58
v_accvgpr_read_b32 v41, a223
v_mfma_f32_16x16x32_bf16 v[212:215], a[80:83], a[176:179], v[212:215]
ds_read_b64_tr_b16 a[76:77], v217 offset:9344
ds_read_b64_tr_b16 a[78:79], v217 offset:13952
v_mfma_f32_16x16x32_bf16 v[208:211], a[80:83], a[160:163], v[208:211]
v_accvgpr_read_b32 v59, a233
v_lshlrev_b32 v40, 16, v41
v_mfma_f32_16x16x32_bf16 v[204:207], a[80:83], a[144:147], v[204:207]
buffer_load_dwordx4 a[104:107], v244, s[20:23], s66 offen offset:2048 sc0 sc1
v_mfma_f32_16x16x32_bf16 v[200:203], a[80:83], a[128:131], v[200:203]
v_and_b32 v41, 0xffff0000, v41
v_lshlrev_b32 v58, 16, v59
s_waitcnt vmcnt(20)
s_waitcnt lgkmcnt(8)
v_mfma_f32_16x16x32_bf16 v[72:75], a[84:87], a[132:135], v[72:75]
ds_read_b64_tr_b16 a[80:81], v217 offset:9352
ds_read_b64_tr_b16 a[82:83], v217 offset:13960
v_mfma_f32_16x16x32_bf16 v[80:83], a[84:87], a[148:151], v[80:83]
v_and_b32 v59, 0xffff0000, v59
v_add_f32 v40, v40, v58
v_mfma_f32_16x16x32_bf16 v[88:91], a[84:87], a[164:167], v[88:91]
buffer_load_dwordx4 a[120:123], v244, s[20:23], s67 offen offset:2048 sc0 sc1
v_mfma_f32_16x16x32_bf16 v[96:99], a[84:87], a[180:183], v[96:99]
v_add_f32 v41, v41, v59
v_cvt_pk_bf16_f32 v58, v40, v41
v_mfma_f32_16x16x32_bf16 v[100:103], a[88:91], a[180:183], v[100:103]
ds_read_b64_tr_b16 a[84:85], v218 offset:9216
ds_read_b64_tr_b16 a[86:87], v218 offset:13824
v_mfma_f32_16x16x32_bf16 v[92:95], a[88:91], a[164:167], v[92:95]
v_lshlrev_b32 v40, 16, v58
v_and_b32 v41, 0xffff0000, v58
v_mfma_f32_16x16x32_bf16 v[84:87], a[88:91], a[148:151], v[84:87]
buffer_load_dwordx4 a[204:207], v244, s[20:23], s64 offen offset:3072 sc0 sc1
v_mfma_f32_16x16x32_bf16 v[76:79], a[88:91], a[132:135], v[76:79]
v_mul_f32 v58, 0xbfb8aa3b, v40
v_mul_f32 v59, 0xbfb8aa3b, v41
v_mfma_f32_16x16x32_bf16 v[104:107], a[92:95], a[132:135], v[104:107]
ds_read_b64_tr_b16 a[88:89], v216 offset:18432
ds_read_b64_tr_b16 a[90:91], v216 offset:23040
v_mfma_f32_16x16x32_bf16 v[112:115], a[92:95], a[148:151], v[112:115]
v_exp_f32 v58, v58
v_mfma_f32_16x16x32_bf16 v[120:123], a[92:95], a[164:167], v[120:123]
buffer_load_dwordx4 a[252:255], v244, s[20:23], s65 offen offset:3072 sc0 sc1
v_mfma_f32_16x16x32_bf16 v[128:131], a[92:95], a[180:183], v[128:131]
v_exp_f32 v59, v59
s_waitcnt lgkmcnt(8)
v_mfma_f32_16x16x32_bf16 v[132:135], a[64:67], a[180:183], v[132:135]
ds_read_b64_tr_b16 a[92:93], v216 offset:18440
ds_read_b64_tr_b16 a[94:95], v216 offset:23048
v_mfma_f32_16x16x32_bf16 v[124:127], a[64:67], a[164:167], v[124:127]
v_add_f32 v58, 1.0, v58
v_add_f32 v59, 1.0, v59
v_mfma_f32_16x16x32_bf16 v[116:119], a[64:67], a[148:151], v[116:119]
buffer_load_dwordx4 a[108:111], v244, s[20:23], s66 offen offset:3072 sc0 sc1
v_mfma_f32_16x16x32_bf16 v[108:111], a[64:67], a[132:135], v[108:111]
v_rcp_f32 v58, v58
v_mfma_f32_16x16x32_bf16 v[136:139], a[68:71], a[132:135], v[136:139]
ds_read_b64_tr_b16 a[64:65], v217 offset:18432
ds_read_b64_tr_b16 a[66:67], v217 offset:23040
v_mfma_f32_16x16x32_bf16 v[144:147], a[68:71], a[148:151], v[144:147]
v_rcp_f32 v59, v59
v_mfma_f32_16x16x32_bf16 v[152:155], a[68:71], a[164:167], v[152:155]
buffer_load_dwordx4 a[124:127], v244, s[20:23], s67 offen offset:3072 sc0 sc1
v_mfma_f32_16x16x32_bf16 v[160:163], a[68:71], a[180:183], v[160:163]
s_add_u32 s28, s33, 3
s_and_b32 s28, s28, 3
v_mfma_f32_16x16x32_bf16 v[164:167], a[72:75], a[180:183], v[164:167]
ds_read_b64_tr_b16 a[68:69], v217 offset:18440
ds_read_b64_tr_b16 a[70:71], v217 offset:23048
v_mfma_f32_16x16x32_bf16 v[156:159], a[72:75], a[164:167], v[156:159]
s_sub_u32 s28, s28, s33
s_lshl_b32 s28, s28, 16
v_mfma_f32_16x16x32_bf16 v[148:151], a[72:75], a[148:151], v[148:151]
s_add_u32 s64, s28, s44
s_add_u32 s65, s64, 4096
v_mfma_f32_16x16x32_bf16 v[140:143], a[72:75], a[132:135], v[140:143]
s_add_u32 s66, s64, 8192
s_add_u32 s67, s64, 12288
s_waitcnt lgkmcnt(8)
v_mfma_f32_16x16x32_bf16 v[168:171], a[76:79], a[132:135], v[168:171]
ds_read_b64_tr_b16 a[72:73], v216 offset:18560
ds_read_b64_tr_b16 a[74:75], v216 offset:23168
v_mfma_f32_16x16x32_bf16 v[176:179], a[76:79], a[148:151], v[176:179]
buffer_load_dwordx4 a[0:3], v244, s[20:23], s64 offen offset:0 sc0 sc1
v_mfma_f32_16x16x32_bf16 v[184:187], a[76:79], a[164:167], v[184:187]
v_mul_f32 v40, v40, v58
v_mul_f32 v41, v41, v59
v_mfma_f32_16x16x32_bf16 v[192:195], a[76:79], a[180:183], v[192:195]
v_cvt_pk_bf16_f32 v58, v40, v41
v_lshlrev_b32 v40, 16, v58
v_mfma_f32_16x16x32_bf16 v[196:199], a[80:83], a[180:183], v[196:199]
ds_read_b64_tr_b16 a[76:77], v216 offset:18568
ds_read_b64_tr_b16 a[78:79], v216 offset:23176
v_mfma_f32_16x16x32_bf16 v[188:191], a[80:83], a[164:167], v[188:191]
buffer_load_dwordx4 a[16:19], v244, s[20:23], s65 offen offset:0 sc0 sc1
v_mfma_f32_16x16x32_bf16 v[180:183], a[80:83], a[148:151], v[180:183]
v_and_b32 v41, 0xffff0000, v58
v_accvgpr_read_b32 v43, a224
v_mfma_f32_16x16x32_bf16 v[172:175], a[80:83], a[132:135], v[172:175]
v_accvgpr_read_b32 v59, a234
v_lshlrev_b32 v42, 16, v43
v_mfma_f32_16x16x32_bf16 v[200:203], a[84:87], a[132:135], v[200:203]
ds_read_b64_tr_b16 a[80:81], v217 offset:18560
ds_read_b64_tr_b16 a[82:83], v217 offset:23168
v_mfma_f32_16x16x32_bf16 v[204:207], a[84:87], a[148:151], v[204:207]
buffer_load_dwordx4 a[32:35], v244, s[20:23], s66 offen offset:0 sc0 sc1
v_mfma_f32_16x16x32_bf16 v[208:211], a[84:87], a[164:167], v[208:211]
v_and_b32 v43, 0xffff0000, v43
v_lshlrev_b32 v58, 16, v59
v_mfma_f32_16x16x32_bf16 v[212:215], a[84:87], a[180:183], v[212:215]
v_and_b32 v59, 0xffff0000, v59
v_add_f32 v42, v42, v58
s_waitcnt vmcnt(23)
s_waitcnt lgkmcnt(8)
v_mfma_f32_16x16x32_bf16 v[96:99], a[88:91], a[184:187], v[96:99]
ds_read_b64_tr_b16 a[84:85], v217 offset:18568
ds_read_b64_tr_b16 a[86:87], v217 offset:23176
v_mfma_f32_16x16x32_bf16 v[88:91], a[88:91], a[168:171], v[88:91]
buffer_load_dwordx4 a[48:51], v244, s[20:23], s67 offen offset:0 sc0 sc1
v_mfma_f32_16x16x32_bf16 v[80:83], a[88:91], a[152:155], v[80:83]
v_add_f32 v43, v43, v59
v_cvt_pk_bf16_f32 v58, v42, v43
v_mfma_f32_16x16x32_bf16 v[72:75], a[88:91], a[136:139], v[72:75]
v_lshlrev_b32 v42, 16, v58
v_and_b32 v43, 0xffff0000, v58
v_mfma_f32_16x16x32_bf16 v[76:79], a[92:95], a[136:139], v[76:79]
ds_read_b64_tr_b16 a[88:89], v218 offset:18432
ds_read_b64_tr_b16 a[90:91], v218 offset:23040
v_mfma_f32_16x16x32_bf16 v[84:87], a[92:95], a[152:155], v[84:87]
buffer_load_dwordx4 a[4:7], v244, s[20:23], s64 offen offset:1024 sc0 sc1
v_mfma_f32_16x16x32_bf16 v[92:95], a[92:95], a[168:171], v[92:95]
v_mul_f32 v58, 0xbfb8aa3b, v42
v_mul_f32 v59, 0xbfb8aa3b, v43
v_mfma_f32_16x16x32_bf16 v[100:103], a[92:95], a[184:187], v[100:103]
v_exp_f32 v58, v58
v_mfma_f32_16x16x32_bf16 v[128:131], a[64:67], a[184:187], v[128:131]
ds_read_b64_tr_b16 a[92:93], v216 offset:27648
ds_read_b64_tr_b16 a[94:95], v216 offset:32256
v_mfma_f32_16x16x32_bf16 v[120:123], a[64:67], a[168:171], v[120:123]
buffer_load_dwordx4 a[20:23], v244, s[20:23], s65 offen offset:1024 sc0 sc1
v_mfma_f32_16x16x32_bf16 v[112:115], a[64:67], a[152:155], v[112:115]
v_exp_f32 v59, v59
v_mfma_f32_16x16x32_bf16 v[104:107], a[64:67], a[136:139], v[104:107]
v_add_f32 v58, 1.0, v58
v_add_f32 v59, 1.0, v59
s_waitcnt lgkmcnt(8)
v_mfma_f32_16x16x32_bf16 v[108:111], a[68:71], a[136:139], v[108:111]
ds_read_b64_tr_b16 a[64:65], v216 offset:27656
ds_read_b64_tr_b16 a[66:67], v216 offset:32264
v_mfma_f32_16x16x32_bf16 v[116:119], a[68:71], a[152:155], v[116:119]
buffer_load_dwordx4 a[36:39], v244, s[20:23], s66 offen offset:1024 sc0 sc1
v_mfma_f32_16x16x32_bf16 v[124:127], a[68:71], a[168:171], v[124:127]
v_rcp_f32 v58, v58
v_mfma_f32_16x16x32_bf16 v[132:135], a[68:71], a[184:187], v[132:135]
v_rcp_f32 v59, v59
v_mfma_f32_16x16x32_bf16 v[160:163], a[72:75], a[184:187], v[160:163]
ds_read_b64_tr_b16 a[68:69], v217 offset:27648
ds_read_b64_tr_b16 a[70:71], v217 offset:32256
v_mfma_f32_16x16x32_bf16 v[152:155], a[72:75], a[168:171], v[152:155]
buffer_load_dwordx4 a[52:55], v244, s[20:23], s67 offen offset:1024 sc0 sc1
v_mfma_f32_16x16x32_bf16 v[144:147], a[72:75], a[152:155], v[144:147]
v_mul_f32 v42, v42, v58
v_mul_f32 v43, v43, v59
v_mfma_f32_16x16x32_bf16 v[136:139], a[72:75], a[136:139], v[136:139]
v_cvt_pk_bf16_f32 v58, v42, v43
v_lshlrev_b32 v42, 16, v58
v_mfma_f32_16x16x32_bf16 v[140:143], a[76:79], a[136:139], v[140:143]
ds_read_b64_tr_b16 a[72:73], v217 offset:27656
ds_read_b64_tr_b16 a[74:75], v217 offset:32264
v_mfma_f32_16x16x32_bf16 v[148:151], a[76:79], a[152:155], v[148:151]
buffer_load_dwordx4 a[8:11], v244, s[20:23], s64 offen offset:2048 sc0 sc1
v_mfma_f32_16x16x32_bf16 v[156:159], a[76:79], a[168:171], v[156:159]
v_and_b32 v43, 0xffff0000, v58
v_accvgpr_read_b32 v45, a225
v_mfma_f32_16x16x32_bf16 v[164:167], a[76:79], a[184:187], v[164:167]
v_accvgpr_read_b32 v59, a235
v_lshlrev_b32 v44, 16, v45
s_waitcnt lgkmcnt(8)
v_mfma_f32_16x16x32_bf16 v[192:195], a[80:83], a[184:187], v[192:195]
ds_read_b64_tr_b16 a[76:77], v216 offset:27776
ds_read_b64_tr_b16 a[78:79], v216 offset:32384
v_mfma_f32_16x16x32_bf16 v[184:187], a[80:83], a[168:171], v[184:187]
buffer_load_dwordx4 a[24:27], v244, s[20:23], s65 offen offset:2048 sc0 sc1
v_mfma_f32_16x16x32_bf16 v[176:179], a[80:83], a[152:155], v[176:179]
v_and_b32 v45, 0xffff0000, v45
v_lshlrev_b32 v58, 16, v59
v_mfma_f32_16x16x32_bf16 v[168:171], a[80:83], a[136:139], v[168:171]
v_and_b32 v59, 0xffff0000, v59
v_add_f32 v44, v44, v58
v_mfma_f32_16x16x32_bf16 v[172:175], a[84:87], a[136:139], v[172:175]
ds_read_b64_tr_b16 a[80:81], v216 offset:27784
ds_read_b64_tr_b16 a[82:83], v216 offset:32392
v_mfma_f32_16x16x32_bf16 v[180:183], a[84:87], a[152:155], v[180:183]
buffer_load_dwordx4 a[40:43], v244, s[20:23], s66 offen offset:2048 sc0 sc1
v_mfma_f32_16x16x32_bf16 v[188:191], a[84:87], a[168:171], v[188:191]
v_add_f32 v45, v45, v59
v_cvt_pk_bf16_f32 v58, v44, v45
v_mfma_f32_16x16x32_bf16 v[196:199], a[84:87], a[184:187], v[196:199]
v_lshlrev_b32 v44, 16, v58
v_and_b32 v45, 0xffff0000, v58
v_mfma_f32_16x16x32_bf16 v[212:215], a[88:91], a[184:187], v[212:215]
ds_read_b64_tr_b16 a[84:85], v217 offset:27776
ds_read_b64_tr_b16 a[86:87], v217 offset:32384
v_mfma_f32_16x16x32_bf16 v[208:211], a[88:91], a[168:171], v[208:211]
buffer_load_dwordx4 a[56:59], v244, s[20:23], s67 offen offset:2048 sc0 sc1
v_mfma_f32_16x16x32_bf16 v[204:207], a[88:91], a[152:155], v[204:207]
v_mul_f32 v58, 0xbfb8aa3b, v44
v_mul_f32 v59, 0xbfb8aa3b, v45
v_mfma_f32_16x16x32_bf16 v[200:203], a[88:91], a[136:139], v[200:203]
v_exp_f32 v58, v58
s_waitcnt vmcnt(28)
s_waitcnt lgkmcnt(8)
v_mfma_f32_16x16x32_bf16 v[72:75], a[92:95], a[140:143], v[72:75]
ds_read_b64_tr_b16 a[88:89], v217 offset:27784
ds_read_b64_tr_b16 a[90:91], v217 offset:32392
v_mfma_f32_16x16x32_bf16 v[80:83], a[92:95], a[156:159], v[80:83]
buffer_load_dwordx4 a[12:15], v244, s[20:23], s64 offen offset:3072 sc0 sc1
v_mfma_f32_16x16x32_bf16 v[88:91], a[92:95], a[172:175], v[88:91]
v_exp_f32 v59, v59
v_mfma_f32_16x16x32_bf16 v[96:99], a[92:95], a[188:191], v[96:99]
v_add_f32 v58, 1.0, v58
v_add_f32 v59, 1.0, v59
v_mfma_f32_16x16x32_bf16 v[100:103], a[64:67], a[188:191], v[100:103]
ds_read_b64_tr_b16 a[92:93], v218 offset:27648
ds_read_b64_tr_b16 a[94:95], v218 offset:32256
v_mfma_f32_16x16x32_bf16 v[92:95], a[64:67], a[172:175], v[92:95]
buffer_load_dwordx4 a[28:31], v244, s[20:23], s65 offen offset:3072 sc0 sc1
v_mfma_f32_16x16x32_bf16 v[84:87], a[64:67], a[156:159], v[84:87]
v_rcp_f32 v58, v58
v_mfma_f32_16x16x32_bf16 v[76:79], a[64:67], a[140:143], v[76:79]
v_rcp_f32 v59, v59
v_mfma_f32_16x16x32_bf16 v[104:107], a[68:71], a[140:143], v[104:107]
ds_read_b64_tr_b16 a[64:65], v221 offset:0
ds_read_b64_tr_b16 a[66:67], v221 offset:4608
v_mfma_f32_16x16x32_bf16 v[112:115], a[68:71], a[156:159], v[112:115]
buffer_load_dwordx4 a[44:47], v244, s[20:23], s66 offen offset:3072 sc0 sc1
v_mfma_f32_16x16x32_bf16 v[120:123], a[68:71], a[172:175], v[120:123]
v_mul_f32 v44, v44, v58
v_mul_f32 v45, v45, v59
v_mfma_f32_16x16x32_bf16 v[128:131], a[68:71], a[188:191], v[128:131]
v_cvt_pk_bf16_f32 v58, v44, v45
v_lshlrev_b32 v44, 16, v58
s_waitcnt lgkmcnt(8)
v_mfma_f32_16x16x32_bf16 v[132:135], a[72:75], a[188:191], v[132:135]
ds_read_b64_tr_b16 a[68:69], v221 offset:9216
ds_read_b64_tr_b16 a[70:71], v221 offset:13824
v_mfma_f32_16x16x32_bf16 v[124:127], a[72:75], a[172:175], v[124:127]
buffer_load_dwordx4 a[60:63], v244, s[20:23], s67 offen offset:3072 sc0 sc1
v_mfma_f32_16x16x32_bf16 v[116:119], a[72:75], a[156:159], v[116:119]
s_lshl2_add_u32 s28, s36, s33
s_lshl2_add_u32 s28, s28, s37
v_mfma_f32_16x16x32_bf16 v[108:111], a[72:75], a[140:143], v[108:111]
s_lshl_b32 s95, s28, 5
s_add_u32 s95, s95, 0x24a000
v_mfma_f32_16x16x32_bf16 v[136:139], a[76:79], a[140:143], v[136:139]
ds_read_b64_tr_b16 a[72:73], v221 offset:18432
ds_read_b64_tr_b16 a[74:75], v221 offset:23040
v_mfma_f32_16x16x32_bf16 v[144:147], a[76:79], a[156:159], v[144:147]
s_lshl_b32 s28, s32, 18
s_sub_u32 s49, s44, s28
v_mfma_f32_16x16x32_bf16 v[152:155], a[76:79], a[172:175], v[152:155]
v_add_u32 v243, 0x2000, v244
v_mov_b32 v246, 2
v_mfma_f32_16x16x32_bf16 v[160:163], a[76:79], a[188:191], v[160:163]
s_lshl2_add_u32 s29, s33, s94
v_and_b32 v45, 0xffff0000, v58
v_mfma_f32_16x16x32_bf16 v[164:167], a[80:83], a[188:191], v[164:167]
ds_read_b64_tr_b16 a[76:77], v221 offset:27648
ds_read_b64_tr_b16 a[78:79], v221 offset:32256
v_mfma_f32_16x16x32_bf16 v[156:159], a[80:83], a[172:175], v[156:159]
v_accvgpr_read_b32 v47, a226
v_accvgpr_read_b32 v59, a236
v_mfma_f32_16x16x32_bf16 v[148:151], a[80:83], a[156:159], v[148:151]
v_lshlrev_b32 v46, 16, v47
v_and_b32 v47, 0xffff0000, v47
v_mfma_f32_16x16x32_bf16 v[140:143], a[80:83], a[140:143], v[140:143]
v_lshlrev_b32 v58, 16, v59
v_and_b32 v59, 0xffff0000, v59
s_waitcnt lgkmcnt(8)
v_mfma_f32_16x16x32_bf16 v[168:171], a[84:87], a[140:143], v[168:171]
ds_read_b64_tr_b16 a[80:81], v224 offset:0
ds_read_b64_tr_b16 a[82:83], v224 offset:4608
v_mfma_f32_16x16x32_bf16 v[176:179], a[84:87], a[156:159], v[176:179]
v_add_f32 v46, v46, v58
v_add_f32 v47, v47, v59
v_mfma_f32_16x16x32_bf16 v[184:187], a[84:87], a[172:175], v[184:187]
v_cvt_pk_bf16_f32 v58, v46, v47
v_lshlrev_b32 v46, 16, v58
v_mfma_f32_16x16x32_bf16 v[192:195], a[84:87], a[188:191], v[192:195]
v_and_b32 v47, 0xffff0000, v58
v_mul_f32 v58, 0xbfb8aa3b, v46
v_mfma_f32_16x16x32_bf16 v[196:199], a[88:91], a[188:191], v[196:199]
ds_read_b64_tr_b16 a[84:85], v224 offset:9216
ds_read_b64_tr_b16 a[86:87], v224 offset:13824
v_mfma_f32_16x16x32_bf16 v[188:191], a[88:91], a[172:175], v[188:191]
v_mul_f32 v59, 0xbfb8aa3b, v47
v_mfma_f32_16x16x32_bf16 v[180:183], a[88:91], a[156:159], v[180:183]
v_exp_f32 v58, v58
v_mfma_f32_16x16x32_bf16 v[172:175], a[88:91], a[140:143], v[172:175]
v_exp_f32 v59, v59
v_mfma_f32_16x16x32_bf16 v[200:203], a[92:95], a[140:143], v[200:203]
ds_read_b64_tr_b16 a[88:89], v224 offset:18432
ds_read_b64_tr_b16 a[90:91], v224 offset:23040
v_mfma_f32_16x16x32_bf16 v[204:207], a[92:95], a[156:159], v[204:207]
v_add_f32 v58, 1.0, v58
v_add_f32 v59, 1.0, v59
v_mfma_f32_16x16x32_bf16 v[208:211], a[92:95], a[172:175], v[208:211]
v_rcp_f32 v58, v58
v_mfma_f32_16x16x32_bf16 v[212:215], a[92:95], a[188:191], v[212:215]
v_rcp_f32 v59, v59
s_waitcnt vmcnt(28)
s_waitcnt lgkmcnt(8)
v_mfma_f32_16x16x32_bf16 v[212:215], a[64:67], a[112:115], v[212:215]
ds_read_b64_tr_b16 a[92:93], v224 offset:27648
ds_read_b64_tr_b16 a[94:95], v224 offset:32256
v_mfma_f32_16x16x32_bf16 v[208:211], a[64:67], a[96:99], v[208:211]
v_mul_f32 v46, v46, v58
v_mul_f32 v47, v47, v59
v_mfma_f32_16x16x32_bf16 v[204:207], a[64:67], a[208:211], v[204:207]
v_cvt_pk_bf16_f32 v58, v46, v47
v_lshlrev_b32 v46, 16, v58
v_mfma_f32_16x16x32_bf16 v[200:203], a[64:67], a[192:195], v[200:203]
v_and_b32 v47, 0xffff0000, v58
v_accvgpr_read_b32 v49, a227
s_waitcnt vmcnt(24)
v_mfma_f32_16x16x32_bf16 v[200:203], a[68:71], a[196:199], v[200:203]
ds_read_b64_tr_b16 a[64:65], v219 offset:0
ds_read_b64_tr_b16 a[66:67], v219 offset:4608
v_mfma_f32_16x16x32_bf16 v[204:207], a[68:71], a[244:247], v[204:207]
v_accvgpr_read_b32 v59, a237
v_lshlrev_b32 v48, 16, v49
v_mfma_f32_16x16x32_bf16 v[208:211], a[68:71], a[100:103], v[208:211]
v_and_b32 v49, 0xffff0000, v49
v_lshlrev_b32 v58, 16, v59
v_mfma_f32_16x16x32_bf16 v[212:215], a[68:71], a[116:119], v[212:215]
s_waitcnt vmcnt(0)
buffer_store_dword v246, v254, s[20:23], s29 offen
s_waitcnt vmcnt(21)
v_mfma_f32_16x16x32_bf16 v[212:215], a[72:75], a[120:123], v[212:215]
ds_read_b64_tr_b16 a[68:69], v219 offset:9216
ds_read_b64_tr_b16 a[70:71], v219 offset:13824
v_mfma_f32_16x16x32_bf16 v[208:211], a[72:75], a[104:107], v[208:211]
s_add_u32 s28, s32, 0
s_and_b32 s28, s28, 7
v_mfma_f32_16x16x32_bf16 v[204:207], a[72:75], a[248:251], v[204:207]
s_xor_b32 s29, s28, s32
s_lshl_b32 s28, s28, 18
v_mfma_f32_16x16x32_bf16 v[200:203], a[72:75], a[200:203], v[200:203]
s_add_u32 s28, s28, s49
s_and_b32 s29, s29, 4
s_waitcnt vmcnt(17)
s_waitcnt lgkmcnt(8)
v_mfma_f32_16x16x32_bf16 v[200:203], a[76:79], a[204:207], v[200:203]
ds_read_b64_tr_b16 a[72:73], v219 offset:18432
ds_read_b64_tr_b16 a[74:75], v219 offset:23040
v_mfma_f32_16x16x32_bf16 v[204:207], a[76:79], a[252:255], v[204:207]
s_add_u32 s72, s28, 0
s_lshl_b32 s29, s29, 10
v_mfma_f32_16x16x32_bf16 v[208:211], a[76:79], a[108:111], v[208:211]
s_add_u32 s28, s32, 1
s_and_b32 s28, s28, 7
v_mfma_f32_16x16x32_bf16 v[212:215], a[76:79], a[124:127], v[212:215]
s_xor_b32 s29, s28, s32
s_lshl_b32 s28, s28, 18
s_waitcnt vmcnt(13)
v_mfma_f32_16x16x32_bf16 v[212:215], a[80:83], a[48:51], v[212:215]
ds_read_b64_tr_b16 a[76:77], v219 offset:27648
ds_read_b64_tr_b16 a[78:79], v219 offset:32256
v_mfma_f32_16x16x32_bf16 v[208:211], a[80:83], a[32:35], v[208:211]
s_add_u32 s28, s28, s49
s_and_b32 s29, s29, 4
v_mfma_f32_16x16x32_bf16 v[204:207], a[80:83], a[16:19], v[204:207]
s_add_u32 s73, s28, 8192
s_lshl_b32 s29, s29, 10
v_mfma_f32_16x16x32_bf16 v[200:203], a[80:83], a[0:3], v[200:203]
s_add_u32 s65, s28, s29
v_and_b32 v59, 0xffff0000, v59
s_waitcnt vmcnt(9)
v_mfma_f32_16x16x32_bf16 v[200:203], a[84:87], a[4:7], v[200:203]
ds_read_b64_tr_b16 a[80:81], v222 offset:0
ds_read_b64_tr_b16 a[82:83], v222 offset:4608
v_mfma_f32_16x16x32_bf16 v[204:207], a[84:87], a[20:23], v[204:207]
s_add_u32 s28, s32, 2
s_and_b32 s28, s28, 7
v_mfma_f32_16x16x32_bf16 v[208:211], a[84:87], a[36:39], v[208:211]
s_xor_b32 s29, s28, s32
s_lshl_b32 s28, s28, 18
v_mfma_f32_16x16x32_bf16 v[212:215], a[84:87], a[52:55], v[212:215]
s_add_u32 s28, s28, s49
s_and_b32 s29, s29, 4
s_waitcnt vmcnt(5)
s_waitcnt lgkmcnt(8)
v_mfma_f32_16x16x32_bf16 v[212:215], a[88:91], a[56:59], v[212:215]
ds_read_b64_tr_b16 a[84:85], v222 offset:9216
ds_read_b64_tr_b16 a[86:87], v222 offset:13824
v_mfma_f32_16x16x32_bf16 v[208:211], a[88:91], a[40:43], v[208:211]
s_add_u32 s74, s28, 8192
s_lshl_b32 s29, s29, 10
v_mfma_f32_16x16x32_bf16 v[204:207], a[88:91], a[24:27], v[204:207]
s_add_u32 s66, s28, s29
v_add_f32 v48, v48, v58
v_mfma_f32_16x16x32_bf16 v[200:203], a[88:91], a[8:11], v[200:203]
s_add_u32 s28, s32, 3
s_and_b32 s28, s28, 7
s_waitcnt vmcnt(1)
v_mfma_f32_16x16x32_bf16 v[200:203], a[92:95], a[12:15], v[200:203]
ds_read_b64_tr_b16 a[88:89], v222 offset:18432
ds_read_b64_tr_b16 a[90:91], v222 offset:23040
v_mfma_f32_16x16x32_bf16 v[204:207], a[92:95], a[28:31], v[204:207]
s_xor_b32 s29, s28, s32
s_lshl_b32 s28, s28, 18
v_mfma_f32_16x16x32_bf16 v[208:211], a[92:95], a[44:47], v[208:211]
s_add_u32 s28, s28, s49
s_and_b32 s29, s29, 4
v_mfma_f32_16x16x32_bf16 v[212:215], a[92:95], a[60:63], v[212:215]
s_add_u32 s75, s28, 0
s_lshl_b32 s29, s29, 10
v_mfma_f32_16x16x32_bf16 v[96:99], a[64:67], a[112:115], v[96:99]
ds_read_b64_tr_b16 a[92:93], v222 offset:27648
ds_read_b64_tr_b16 a[94:95], v222 offset:32256
v_mfma_f32_16x16x32_bf16 v[88:91], a[64:67], a[96:99], v[88:91]
s_add_u32 s67, s28, s29
v_add_f32 v49, v49, v59
v_mfma_f32_16x16x32_bf16 v[80:83], a[64:67], a[208:211], v[80:83]
buffer_load_dword v230, v229, s[20:23], s94 offen sc0 sc1
v_mfma_f32_16x16x32_bf16 v[72:75], a[64:67], a[192:195], v[72:75]
s_add_u32 s28, s32, 4
s_and_b32 s28, s28, 7
s_waitcnt lgkmcnt(8)
v_mfma_f32_16x16x32_bf16 v[72:75], a[68:71], a[196:199], v[72:75]
ds_read_b64_tr_b16 a[64:65], v219 offset:8
ds_read_b64_tr_b16 a[66:67], v219 offset:4616
v_mfma_f32_16x16x32_bf16 v[80:83], a[68:71], a[244:247], v[80:83]
s_xor_b32 s29, s28, s32
s_lshl_b32 s28, s28, 18
v_mfma_f32_16x16x32_bf16 v[88:91], a[68:71], a[100:103], v[88:91]
s_add_u32 s28, s28, s49
s_and_b32 s29, s29, 4
v_mfma_f32_16x16x32_bf16 v[96:99], a[68:71], a[116:119], v[96:99]
s_add_u32 s84, s28, 0
s_lshl_b32 s29, s29, 10
v_mfma_f32_16x16x32_bf16 v[96:99], a[72:75], a[120:123], v[96:99]
ds_read_b64_tr_b16 a[68:69], v219 offset:9224
ds_read_b64_tr_b16 a[70:71], v219 offset:13832
v_mfma_f32_16x16x32_bf16 v[88:91], a[72:75], a[104:107], v[88:91]
s_add_u32 s68, s28, s29
v_cvt_pk_bf16_f32 v58, v48, v49
v_mfma_f32_16x16x32_bf16 v[80:83], a[72:75], a[248:251], v[80:83]
s_add_u32 s28, s32, 5
s_and_b32 s28, s28, 7
v_mfma_f32_16x16x32_bf16 v[72:75], a[72:75], a[200:203], v[72:75]
s_xor_b32 s29, s28, s32
s_lshl_b32 s28, s28, 18
v_mfma_f32_16x16x32_bf16 v[72:75], a[76:79], a[204:207], v[72:75]
ds_read_b64_tr_b16 a[72:73], v219 offset:18440
ds_read_b64_tr_b16 a[74:75], v219 offset:23048
v_mfma_f32_16x16x32_bf16 v[80:83], a[76:79], a[252:255], v[80:83]
s_add_u32 s28, s28, s49
s_and_b32 s29, s29, 4
v_mfma_f32_16x16x32_bf16 v[88:91], a[76:79], a[108:111], v[88:91]
s_add_u32 s85, s28, 8192
s_lshl_b32 s29, s29, 10
v_mfma_f32_16x16x32_bf16 v[96:99], a[76:79], a[124:127], v[96:99]
s_add_u32 s69, s28, s29
v_lshlrev_b32 v48, 16, v58
s_waitcnt lgkmcnt(8)
v_mfma_f32_16x16x32_bf16 v[96:99], a[80:83], a[48:51], v[96:99]
ds_read_b64_tr_b16 a[76:77], v219 offset:27656
ds_read_b64_tr_b16 a[78:79], v219 offset:32264
v_mfma_f32_16x16x32_bf16 v[88:91], a[80:83], a[32:35], v[88:91]
s_add_u32 s28, s32, 6
s_and_b32 s28, s28, 7
v_mfma_f32_16x16x32_bf16 v[80:83], a[80:83], a[16:19], v[80:83]
s_xor_b32 s29, s28, s32
s_lshl_b32 s28, s28, 18
v_mfma_f32_16x16x32_bf16 v[72:75], a[80:83], a[0:3], v[72:75]
s_add_u32 s28, s28, s49
s_and_b32 s29, s29, 4
v_mfma_f32_16x16x32_bf16 v[72:75], a[84:87], a[4:7], v[72:75]
ds_read_b64_tr_b16 a[80:81], v222 offset:8
ds_read_b64_tr_b16 a[82:83], v222 offset:4616
v_mfma_f32_16x16x32_bf16 v[80:83], a[84:87], a[20:23], v[80:83]
s_add_u32 s86, s28, 8192
s_lshl_b32 s29, s29, 10
v_mfma_f32_16x16x32_bf16 v[88:91], a[84:87], a[36:39], v[88:91]
s_add_u32 s70, s28, s29
v_and_b32 v49, 0xffff0000, v58
v_mfma_f32_16x16x32_bf16 v[96:99], a[84:87], a[52:55], v[96:99]
s_add_u32 s28, s32, 7
s_and_b32 s28, s28, 7
v_mfma_f32_16x16x32_bf16 v[96:99], a[88:91], a[56:59], v[96:99]
ds_read_b64_tr_b16 a[84:85], v222 offset:9224
ds_read_b64_tr_b16 a[86:87], v222 offset:13832
v_mfma_f32_16x16x32_bf16 v[88:91], a[88:91], a[40:43], v[88:91]
s_xor_b32 s29, s28, s32
s_lshl_b32 s28, s28, 18
v_mfma_f32_16x16x32_bf16 v[80:83], a[88:91], a[24:27], v[80:83]
s_add_u32 s28, s28, s49
s_and_b32 s29, s29, 4
v_mfma_f32_16x16x32_bf16 v[72:75], a[88:91], a[8:11], v[72:75]
s_add_u32 s87, s28, 0
s_lshl_b32 s29, s29, 10
s_waitcnt lgkmcnt(8)
v_mfma_f32_16x16x32_bf16 v[72:75], a[92:95], a[12:15], v[72:75]
ds_read_b64_tr_b16 a[88:89], v222 offset:18440
ds_read_b64_tr_b16 a[90:91], v222 offset:23048
v_mfma_f32_16x16x32_bf16 v[80:83], a[92:95], a[28:31], v[80:83]
s_add_u32 s71, s28, s29
v_mul_f32 v58, 0xbfb8aa3b, v48
v_mfma_f32_16x16x32_bf16 v[88:91], a[92:95], a[44:47], v[88:91]
s_waitcnt vmcnt(0)
v_cmp_gt_u32 vcc, 2, v230
v_mfma_f32_16x16x32_bf16 v[96:99], a[92:95], a[60:63], v[96:99]
v_mul_f32 v59, 0xbfb8aa3b, v49
v_mfma_f32_16x16x32_bf16 v[100:103], a[64:67], a[112:115], v[100:103]
ds_read_b64_tr_b16 a[92:93], v222 offset:27656
ds_read_b64_tr_b16 a[94:95], v222 offset:32264
v_mfma_f32_16x16x32_bf16 v[92:95], a[64:67], a[96:99], v[92:95]
STUB_15:
s_cbranch_execz STUB_18
s_and_b32 s29, vcc_lo, 15
s_cbranch_scc1 SP_O3A
SP_O3A_RET:
v_mfma_f32_16x16x32_bf16 v[84:87], a[64:67], a[208:211], v[84:87]
s_add_u32 s39, s44, 8192
v_mfma_f32_16x16x32_bf16 v[76:79], a[64:67], a[192:195], v[76:79]
v_cvt_pk_bf16_f32 v200, v200, v201
v_cvt_pk_bf16_f32 v201, v202, v203
v_mfma_f32_16x16x32_bf16 v[76:79], a[68:71], a[196:199], v[76:79]
ds_read_b64_tr_b16 a[64:65], v220 offset:0
ds_read_b64_tr_b16 a[66:67], v220 offset:4608
v_mfma_f32_16x16x32_bf16 v[84:87], a[68:71], a[244:247], v[84:87]
buffer_store_dwordx2 v[200:201], v226, s[20:23], s44 offen offset:0
v_mfma_f32_16x16x32_bf16 v[92:95], a[68:71], a[100:103], v[92:95]
v_cvt_pk_bf16_f32 v204, v204, v205
v_cvt_pk_bf16_f32 v205, v206, v207
v_mfma_f32_16x16x32_bf16 v[100:103], a[68:71], a[116:119], v[100:103]
buffer_store_dwordx2 v[204:205], v226, s[20:23], s44 offen offset:512
s_waitcnt lgkmcnt(8)
v_mfma_f32_16x16x32_bf16 v[100:103], a[72:75], a[120:123], v[100:103]
ds_read_b64_tr_b16 a[68:69], v220 offset:9216
ds_read_b64_tr_b16 a[70:71], v220 offset:13824
v_mfma_f32_16x16x32_bf16 v[92:95], a[72:75], a[104:107], v[92:95]
v_cvt_pk_bf16_f32 v208, v208, v209
v_cvt_pk_bf16_f32 v209, v210, v211
v_mfma_f32_16x16x32_bf16 v[84:87], a[72:75], a[248:251], v[84:87]
buffer_store_dwordx2 v[208:209], v226, s[20:23], s39 offen offset:0
v_mfma_f32_16x16x32_bf16 v[76:79], a[72:75], a[200:203], v[76:79]
v_cvt_pk_bf16_f32 v212, v212, v213
v_cvt_pk_bf16_f32 v213, v214, v215
v_mfma_f32_16x16x32_bf16 v[76:79], a[76:79], a[204:207], v[76:79]
ds_read_b64_tr_b16 a[72:73], v220 offset:18432
ds_read_b64_tr_b16 a[74:75], v220 offset:23040
v_mfma_f32_16x16x32_bf16 v[84:87], a[76:79], a[252:255], v[84:87]
buffer_store_dwordx2 v[212:213], v226, s[20:23], s39 offen offset:512
v_mfma_f32_16x16x32_bf16 v[92:95], a[76:79], a[108:111], v[92:95]
v_exp_f32 v58, v58
v_mfma_f32_16x16x32_bf16 v[100:103], a[76:79], a[124:127], v[100:103]
v_exp_f32 v59, v59
v_mfma_f32_16x16x32_bf16 v[100:103], a[80:83], a[48:51], v[100:103]
ds_read_b64_tr_b16 a[76:77], v220 offset:27648
ds_read_b64_tr_b16 a[78:79], v220 offset:32256
v_mfma_f32_16x16x32_bf16 v[92:95], a[80:83], a[32:35], v[92:95]
v_add_f32 v58, 1.0, v58
v_add_f32 v59, 1.0, v59
v_mfma_f32_16x16x32_bf16 v[84:87], a[80:83], a[16:19], v[84:87]
v_rcp_f32 v58, v58
v_mfma_f32_16x16x32_bf16 v[76:79], a[80:83], a[0:3], v[76:79]
v_rcp_f32 v59, v59
s_waitcnt lgkmcnt(8)
v_mfma_f32_16x16x32_bf16 v[76:79], a[84:87], a[4:7], v[76:79]
ds_read_b64_tr_b16 a[80:81], v223 offset:0
ds_read_b64_tr_b16 a[82:83], v223 offset:4608
v_mfma_f32_16x16x32_bf16 v[84:87], a[84:87], a[20:23], v[84:87]
v_mul_f32 v48, v48, v58
v_mul_f32 v49, v49, v59
v_mfma_f32_16x16x32_bf16 v[92:95], a[84:87], a[36:39], v[92:95]
v_cvt_pk_bf16_f32 v58, v48, v49
v_lshlrev_b32 v48, 16, v58
v_mfma_f32_16x16x32_bf16 v[100:103], a[84:87], a[52:55], v[100:103]
v_and_b32 v49, 0xffff0000, v58
v_accvgpr_read_b32 v51, a228
v_mfma_f32_16x16x32_bf16 v[100:103], a[88:91], a[56:59], v[100:103]
ds_read_b64_tr_b16 a[84:85], v223 offset:9216
ds_read_b64_tr_b16 a[86:87], v223 offset:13824
v_mfma_f32_16x16x32_bf16 v[92:95], a[88:91], a[40:43], v[92:95]
v_accvgpr_read_b32 v59, a238
v_lshlrev_b32 v50, 16, v51
v_mfma_f32_16x16x32_bf16 v[84:87], a[88:91], a[24:27], v[84:87]
v_and_b32 v51, 0xffff0000, v51
v_lshlrev_b32 v58, 16, v59
v_mfma_f32_16x16x32_bf16 v[76:79], a[88:91], a[8:11], v[76:79]
v_and_b32 v59, 0xffff0000, v59
v_add_f32 v50, v50, v58
v_mfma_f32_16x16x32_bf16 v[76:79], a[92:95], a[12:15], v[76:79]
ds_read_b64_tr_b16 a[88:89], v223 offset:18432
ds_read_b64_tr_b16 a[90:91], v223 offset:23040
v_mfma_f32_16x16x32_bf16 v[84:87], a[92:95], a[28:31], v[84:87]
v_add_f32 v51, v51, v59
v_cvt_pk_bf16_f32 v58, v50, v51
v_mfma_f32_16x16x32_bf16 v[92:95], a[92:95], a[44:47], v[92:95]
v_lshlrev_b32 v50, 16, v58
v_and_b32 v51, 0xffff0000, v58
v_mfma_f32_16x16x32_bf16 v[100:103], a[92:95], a[60:63], v[100:103]
v_mul_f32 v58, 0xbfb8aa3b, v50
v_mul_f32 v59, 0xbfb8aa3b, v51
s_waitcnt lgkmcnt(8)
v_mfma_f32_16x16x32_bf16 v[128:131], a[64:67], a[112:115], v[128:131]
ds_read_b64_tr_b16 a[92:93], v223 offset:27648
ds_read_b64_tr_b16 a[94:95], v223 offset:32256
v_mfma_f32_16x16x32_bf16 v[120:123], a[64:67], a[96:99], v[120:123]
v_exp_f32 v58, v58
v_mfma_f32_16x16x32_bf16 v[112:115], a[64:67], a[208:211], v[112:115]
v_exp_f32 v59, v59
v_mfma_f32_16x16x32_bf16 v[104:107], a[64:67], a[192:195], v[104:107]
v_add_f32 v58, 1.0, v58
v_add_f32 v59, 1.0, v59
v_mfma_f32_16x16x32_bf16 v[104:107], a[68:71], a[196:199], v[104:107]
ds_read_b64_tr_b16 a[64:65], v220 offset:8
ds_read_b64_tr_b16 a[66:67], v220 offset:4616
v_mfma_f32_16x16x32_bf16 v[112:115], a[68:71], a[244:247], v[112:115]
v_rcp_f32 v58, v58
v_mfma_f32_16x16x32_bf16 v[120:123], a[68:71], a[100:103], v[120:123]
v_rcp_f32 v59, v59
v_mfma_f32_16x16x32_bf16 v[128:131], a[68:71], a[116:119], v[128:131]
v_mul_f32 v50, v50, v58
v_mul_f32 v51, v51, v59
v_mfma_f32_16x16x32_bf16 v[128:131], a[72:75], a[120:123], v[128:131]
ds_read_b64_tr_b16 a[68:69], v220 offset:9224
ds_read_b64_tr_b16 a[70:71], v220 offset:13832
v_mfma_f32_16x16x32_bf16 v[120:123], a[72:75], a[104:107], v[120:123]
s_add_u32 s39, s44, 0
v_cvt_pk_bf16_f32 v58, v50, v51
v_mfma_f32_16x16x32_bf16 v[112:115], a[72:75], a[248:251], v[112:115]
v_cvt_pk_bf16_f32 v80, v80, v81
v_cvt_pk_bf16_f32 v81, v82, v83
v_mfma_f32_16x16x32_bf16 v[104:107], a[72:75], a[200:203], v[104:107]
v_cvt_pk_bf16_f32 v82, v84, v85
v_cvt_pk_bf16_f32 v83, v86, v87
s_waitcnt lgkmcnt(8)
v_mfma_f32_16x16x32_bf16 v[104:107], a[76:79], a[204:207], v[104:107]
ds_read_b64_tr_b16 a[72:73], v220 offset:18440
ds_read_b64_tr_b16 a[74:75], v220 offset:23048
v_mfma_f32_16x16x32_bf16 v[112:115], a[76:79], a[252:255], v[112:115]
buffer_store_dwordx4 v[80:83], v244, s[20:23], s39 offen offset:1024
v_mfma_f32_16x16x32_bf16 v[120:123], a[76:79], a[108:111], v[120:123]
v_cvt_pk_bf16_f32 v88, v88, v89
v_cvt_pk_bf16_f32 v89, v90, v91
v_mfma_f32_16x16x32_bf16 v[128:131], a[76:79], a[124:127], v[128:131]
v_cvt_pk_bf16_f32 v90, v92, v93
v_cvt_pk_bf16_f32 v91, v94, v95
v_mfma_f32_16x16x32_bf16 v[128:131], a[80:83], a[48:51], v[128:131]
ds_read_b64_tr_b16 a[76:77], v220 offset:27656
ds_read_b64_tr_b16 a[78:79], v220 offset:32264
v_mfma_f32_16x16x32_bf16 v[120:123], a[80:83], a[32:35], v[120:123]
buffer_store_dwordx4 v[88:91], v244, s[20:23], s39 offen offset:2048
v_mfma_f32_16x16x32_bf16 v[112:115], a[80:83], a[16:19], v[112:115]
v_cvt_pk_bf16_f32 v96, v96, v97
v_cvt_pk_bf16_f32 v97, v98, v99
v_mfma_f32_16x16x32_bf16 v[104:107], a[80:83], a[0:3], v[104:107]
v_cvt_pk_bf16_f32 v98, v100, v101
v_cvt_pk_bf16_f32 v99, v102, v103
v_mfma_f32_16x16x32_bf16 v[104:107], a[84:87], a[4:7], v[104:107]
ds_read_b64_tr_b16 a[80:81], v223 offset:8
ds_read_b64_tr_b16 a[82:83], v223 offset:4616
v_mfma_f32_16x16x32_bf16 v[112:115], a[84:87], a[20:23], v[112:115]
buffer_store_dwordx4 v[96:99], v244, s[20:23], s39 offen offset:3072
v_mfma_f32_16x16x32_bf16 v[120:123], a[84:87], a[36:39], v[120:123]
v_lshlrev_b32 v50, 16, v58
v_and_b32 v51, 0xffff0000, v58
v_mfma_f32_16x16x32_bf16 v[128:131], a[84:87], a[52:55], v[128:131]
v_accvgpr_read_b32 v53, a229
v_accvgpr_read_b32 v59, a239
s_waitcnt lgkmcnt(8)
v_mfma_f32_16x16x32_bf16 v[128:131], a[88:91], a[56:59], v[128:131]
ds_read_b64_tr_b16 a[84:85], v223 offset:9224
ds_read_b64_tr_b16 a[86:87], v223 offset:13832
v_mfma_f32_16x16x32_bf16 v[120:123], a[88:91], a[40:43], v[120:123]
v_lshlrev_b32 v52, 16, v53
v_and_b32 v53, 0xffff0000, v53
v_mfma_f32_16x16x32_bf16 v[112:115], a[88:91], a[24:27], v[112:115]
v_lshlrev_b32 v58, 16, v59
v_and_b32 v59, 0xffff0000, v59
v_mfma_f32_16x16x32_bf16 v[104:107], a[88:91], a[8:11], v[104:107]
v_add_f32 v52, v52, v58
v_add_f32 v53, v53, v59
v_mfma_f32_16x16x32_bf16 v[104:107], a[92:95], a[12:15], v[104:107]
ds_read_b64_tr_b16 a[88:89], v223 offset:18440
ds_read_b64_tr_b16 a[90:91], v223 offset:23048
v_mfma_f32_16x16x32_bf16 v[112:115], a[92:95], a[28:31], v[112:115]
v_cvt_pk_bf16_f32 v58, v52, v53
v_lshlrev_b32 v52, 16, v58
v_mfma_f32_16x16x32_bf16 v[120:123], a[92:95], a[44:47], v[120:123]
v_and_b32 v53, 0xffff0000, v58
v_mul_f32 v58, 0xbfb8aa3b, v52
v_mfma_f32_16x16x32_bf16 v[128:131], a[92:95], a[60:63], v[128:131]
v_mul_f32 v59, 0xbfb8aa3b, v53
v_mfma_f32_16x16x32_bf16 v[132:135], a[64:67], a[112:115], v[132:135]
ds_read_b64_tr_b16 a[92:93], v223 offset:27656
ds_read_b64_tr_b16 a[94:95], v223 offset:32264
v_mfma_f32_16x16x32_bf16 v[124:127], a[64:67], a[96:99], v[124:127]
v_exp_f32 v58, v58
v_mfma_f32_16x16x32_bf16 v[116:119], a[64:67], a[208:211], v[116:119]
v_exp_f32 v59, v59
v_mfma_f32_16x16x32_bf16 v[108:111], a[64:67], a[192:195], v[108:111]
v_add_f32 v58, 1.0, v58
v_add_f32 v59, 1.0, v59
s_waitcnt lgkmcnt(8)
v_mfma_f32_16x16x32_bf16 v[108:111], a[68:71], a[196:199], v[108:111]
ds_read_b64_tr_b16 a[64:65], v219 offset:128
ds_read_b64_tr_b16 a[66:67], v219 offset:4736
v_mfma_f32_16x16x32_bf16 v[116:119], a[68:71], a[244:247], v[116:119]
v_rcp_f32 v58, v58
v_mfma_f32_16x16x32_bf16 v[124:127], a[68:71], a[100:103], v[124:127]
v_rcp_f32 v59, v59
v_mfma_f32_16x16x32_bf16 v[132:135], a[68:71], a[116:119], v[132:135]
v_mul_f32 v52, v52, v58
v_mul_f32 v53, v53, v59
v_mfma_f32_16x16x32_bf16 v[132:135], a[72:75], a[120:123], v[132:135]
ds_read_b64_tr_b16 a[68:69], v219 offset:9344
ds_read_b64_tr_b16 a[70:71], v219 offset:13952
v_mfma_f32_16x16x32_bf16 v[124:127], a[72:75], a[104:107], v[124:127]
v_cvt_pk_bf16_f32 v58, v52, v53
v_lshlrev_b32 v52, 16, v58
v_mfma_f32_16x16x32_bf16 v[116:119], a[72:75], a[248:251], v[116:119]
v_and_b32 v53, 0xffff0000, v58
v_accvgpr_read_b32 v55, a230
v_mfma_f32_16x16x32_bf16 v[108:111], a[72:75], a[200:203], v[108:111]
v_accvgpr_read_b32 v59, a240
v_lshlrev_b32 v54, 16, v55
v_mfma_f32_16x16x32_bf16 v[108:111], a[76:79], a[204:207], v[108:111]
ds_read_b64_tr_b16 a[72:73], v219 offset:18560
ds_read_b64_tr_b16 a[74:75], v219 offset:23168
v_mfma_f32_16x16x32_bf16 v[116:119], a[76:79], a[252:255], v[116:119]
v_and_b32 v55, 0xffff0000, v55
v_lshlrev_b32 v58, 16, v59
v_mfma_f32_16x16x32_bf16 v[124:127], a[76:79], a[108:111], v[124:127]
v_and_b32 v59, 0xffff0000, v59
v_add_f32 v54, v54, v58
v_mfma_f32_16x16x32_bf16 v[132:135], a[76:79], a[124:127], v[132:135]
v_add_f32 v55, v55, v59
v_cvt_pk_bf16_f32 v58, v54, v55
s_waitcnt lgkmcnt(8)
v_mfma_f32_16x16x32_bf16 v[132:135], a[80:83], a[48:51], v[132:135]
ds_read_b64_tr_b16 a[76:77], v219 offset:27776
ds_read_b64_tr_b16 a[78:79], v219 offset:32384
v_mfma_f32_16x16x32_bf16 v[124:127], a[80:83], a[32:35], v[124:127]
v_lshlrev_b32 v54, 16, v58
v_and_b32 v55, 0xffff0000, v58
v_mfma_f32_16x16x32_bf16 v[116:119], a[80:83], a[16:19], v[116:119]
v_mul_f32 v58, 0xbfb8aa3b, v54
v_mul_f32 v59, 0xbfb8aa3b, v55
v_mfma_f32_16x16x32_bf16 v[108:111], a[80:83], a[0:3], v[108:111]
v_exp_f32 v58, v58
v_mfma_f32_16x16x32_bf16 v[108:111], a[84:87], a[4:7], v[108:111]
ds_read_b64_tr_b16 a[80:81], v222 offset:128
ds_read_b64_tr_b16 a[82:83], v222 offset:4736
v_mfma_f32_16x16x32_bf16 v[116:119], a[84:87], a[20:23], v[116:119]
v_exp_f32 v59, v59
v_mfma_f32_16x16x32_bf16 v[124:127], a[84:87], a[36:39], v[124:127]
v_add_f32 v58, 1.0, v58
v_add_f32 v59, 1.0, v59
v_mfma_f32_16x16x32_bf16 v[132:135], a[84:87], a[52:55], v[132:135]
v_rcp_f32 v58, v58
v_mfma_f32_16x16x32_bf16 v[132:135], a[88:91], a[56:59], v[132:135]
ds_read_b64_tr_b16 a[84:85], v222 offset:9344
ds_read_b64_tr_b16 a[86:87], v222 offset:13952
v_mfma_f32_16x16x32_bf16 v[124:127], a[88:91], a[40:43], v[124:127]
v_rcp_f32 v59, v59
v_mfma_f32_16x16x32_bf16 v[116:119], a[88:91], a[24:27], v[116:119]
v_mul_f32 v54, v54, v58
v_mul_f32 v55, v55, v59
v_mfma_f32_16x16x32_bf16 v[108:111], a[88:91], a[8:11], v[108:111]
v_cvt_pk_bf16_f32 v58, v54, v55
v_lshlrev_b32 v54, 16, v58
s_waitcnt lgkmcnt(8)
v_mfma_f32_16x16x32_bf16 v[108:111], a[92:95], a[12:15], v[108:111]
ds_read_b64_tr_b16 a[88:89], v222 offset:18560
ds_read_b64_tr_b16 a[90:91], v222 offset:23168
v_mfma_f32_16x16x32_bf16 v[116:119], a[92:95], a[28:31], v[116:119]
v_and_b32 v55, 0xffff0000, v58
v_accvgpr_read_b32 v57, a231
v_mfma_f32_16x16x32_bf16 v[124:127], a[92:95], a[44:47], v[124:127]
v_accvgpr_read_b32 v59, a241
v_lshlrev_b32 v56, 16, v57
v_mfma_f32_16x16x32_bf16 v[132:135], a[92:95], a[60:63], v[132:135]
v_and_b32 v57, 0xffff0000, v57
v_lshlrev_b32 v58, 16, v59
v_mfma_f32_16x16x32_bf16 v[160:163], a[64:67], a[112:115], v[160:163]
ds_read_b64_tr_b16 a[92:93], v222 offset:27776
ds_read_b64_tr_b16 a[94:95], v222 offset:32384
v_mfma_f32_16x16x32_bf16 v[152:155], a[64:67], a[96:99], v[152:155]
v_and_b32 v59, 0xffff0000, v59
v_add_f32 v56, v56, v58
v_mfma_f32_16x16x32_bf16 v[144:147], a[64:67], a[208:211], v[144:147]
v_add_f32 v57, v57, v59
v_cvt_pk_bf16_f32 v58, v56, v57
v_mfma_f32_16x16x32_bf16 v[136:139], a[64:67], a[192:195], v[136:139]
v_lshlrev_b32 v56, 16, v58
v_and_b32 v57, 0xffff0000, v58
v_mfma_f32_16x16x32_bf16 v[136:139], a[68:71], a[196:199], v[136:139]
ds_read_b64_tr_b16 a[64:65], v219 offset:136
ds_read_b64_tr_b16 a[66:67], v219 offset:4744
v_mfma_f32_16x16x32_bf16 v[144:147], a[68:71], a[244:247], v[144:147]
v_mul_f32 v58, 0xbfb8aa3b, v56
v_mul_f32 v59, 0xbfb8aa3b, v57
v_mfma_f32_16x16x32_bf16 v[152:155], a[68:71], a[100:103], v[152:155]
v_exp_f32 v58, v58
v_mfma_f32_16x16x32_bf16 v[160:163], a[68:71], a[116:119], v[160:163]
v_exp_f32 v59, v59
s_waitcnt lgkmcnt(8)
v_mfma_f32_16x16x32_bf16 v[160:163], a[72:75], a[120:123], v[160:163]
ds_read_b64_tr_b16 a[68:69], v219 offset:9352
ds_read_b64_tr_b16 a[70:71], v219 offset:13960
v_mfma_f32_16x16x32_bf16 v[152:155], a[72:75], a[104:107], v[152:155]
s_add_u32 s39, s44, 4096
v_add_f32 v58, 1.0, v58
v_mfma_f32_16x16x32_bf16 v[144:147], a[72:75], a[248:251], v[144:147]
v_cvt_pk_bf16_f32 v104, v104, v105
v_cvt_pk_bf16_f32 v105, v106, v107
v_mfma_f32_16x16x32_bf16 v[136:139], a[72:75], a[200:203], v[136:139]
v_cvt_pk_bf16_f32 v106, v108, v109
v_cvt_pk_bf16_f32 v107, v110, v111
v_mfma_f32_16x16x32_bf16 v[136:139], a[76:79], a[204:207], v[136:139]
ds_read_b64_tr_b16 a[72:73], v219 offset:18568
ds_read_b64_tr_b16 a[74:75], v219 offset:23176
v_mfma_f32_16x16x32_bf16 v[144:147], a[76:79], a[252:255], v[144:147]
buffer_store_dwordx4 v[104:107], v244, s[20:23], s39 offen offset:0
v_mfma_f32_16x16x32_bf16 v[152:155], a[76:79], a[108:111], v[152:155]
v_cvt_pk_bf16_f32 v112, v112, v113
v_cvt_pk_bf16_f32 v113, v114, v115
v_mfma_f32_16x16x32_bf16 v[160:163], a[76:79], a[124:127], v[160:163]
v_cvt_pk_bf16_f32 v114, v116, v117
v_cvt_pk_bf16_f32 v115, v118, v119
v_mfma_f32_16x16x32_bf16 v[160:163], a[80:83], a[48:51], v[160:163]
ds_read_b64_tr_b16 a[76:77], v219 offset:27784
ds_read_b64_tr_b16 a[78:79], v219 offset:32392
v_mfma_f32_16x16x32_bf16 v[152:155], a[80:83], a[32:35], v[152:155]
buffer_store_dwordx4 v[112:115], v244, s[20:23], s39 offen offset:1024
v_mfma_f32_16x16x32_bf16 v[144:147], a[80:83], a[16:19], v[144:147]
v_cvt_pk_bf16_f32 v120, v120, v121
v_cvt_pk_bf16_f32 v121, v122, v123
v_mfma_f32_16x16x32_bf16 v[136:139], a[80:83], a[0:3], v[136:139]
v_cvt_pk_bf16_f32 v122, v124, v125
v_cvt_pk_bf16_f32 v123, v126, v127
s_waitcnt lgkmcnt(8)
v_mfma_f32_16x16x32_bf16 v[136:139], a[84:87], a[4:7], v[136:139]
ds_read_b64_tr_b16 a[80:81], v222 offset:136
ds_read_b64_tr_b16 a[82:83], v222 offset:4744
v_mfma_f32_16x16x32_bf16 v[144:147], a[84:87], a[20:23], v[144:147]
buffer_store_dwordx4 v[120:123], v244, s[20:23], s39 offen offset:2048
v_mfma_f32_16x16x32_bf16 v[152:155], a[84:87], a[36:39], v[152:155]
v_cvt_pk_bf16_f32 v128, v128, v129
v_cvt_pk_bf16_f32 v129, v130, v131
v_mfma_f32_16x16x32_bf16 v[160:163], a[84:87], a[52:55], v[160:163]
v_cvt_pk_bf16_f32 v130, v132, v133
v_cvt_pk_bf16_f32 v131, v134, v135
v_mfma_f32_16x16x32_bf16 v[160:163], a[88:91], a[56:59], v[160:163]
ds_read_b64_tr_b16 a[84:85], v222 offset:9352
ds_read_b64_tr_b16 a[86:87], v222 offset:13960
v_mfma_f32_16x16x32_bf16 v[152:155], a[88:91], a[40:43], v[152:155]
buffer_store_dwordx4 v[128:131], v244, s[20:23], s39 offen offset:3072
v_mfma_f32_16x16x32_bf16 v[144:147], a[88:91], a[24:27], v[144:147]
s_lshl2_add_u32 s28, s32, s95
v_add_f32 v59, 1.0, v59
v_mfma_f32_16x16x32_bf16 v[136:139], a[88:91], a[8:11], v[136:139]
v_rcp_f32 v58, v58
v_mfma_f32_16x16x32_bf16 v[136:139], a[92:95], a[12:15], v[136:139]
ds_read_b64_tr_b16 a[88:89], v222 offset:18568
ds_read_b64_tr_b16 a[90:91], v222 offset:23176
v_mfma_f32_16x16x32_bf16 v[144:147], a[92:95], a[28:31], v[144:147]
v_rcp_f32 v59, v59
v_mfma_f32_16x16x32_bf16 v[152:155], a[92:95], a[44:47], v[152:155]
v_mul_f32 v56, v56, v58
v_mul_f32 v57, v57, v59
v_mfma_f32_16x16x32_bf16 v[160:163], a[92:95], a[60:63], v[160:163]
v_cvt_pk_bf16_f32 v58, v56, v57
v_lshlrev_b32 v56, 16, v58
s_waitcnt lgkmcnt(8)
v_mfma_f32_16x16x32_bf16 v[164:167], a[64:67], a[112:115], v[164:167]
ds_read_b64_tr_b16 a[92:93], v222 offset:27784
ds_read_b64_tr_b16 a[94:95], v222 offset:32392
v_mfma_f32_16x16x32_bf16 v[156:159], a[64:67], a[96:99], v[156:159]
v_and_b32 v57, 0xffff0000, v58
v_accvgpr_read_b32 v19, a212
v_mfma_f32_16x16x32_bf16 v[148:151], a[64:67], a[208:211], v[148:151]
v_lshlrev_b32 v18, 16, v19
v_and_b32 v19, 0xffff0000, v19
v_mfma_f32_16x16x32_bf16 v[140:143], a[64:67], a[192:195], v[140:143]
v_accvgpr_read_b32 v21, a213
v_lshlrev_b32 v20, 16, v21
v_mfma_f32_16x16x32_bf16 v[140:143], a[68:71], a[196:199], v[140:143]
ds_read_b64_tr_b16 a[64:65], v220 offset:128
ds_read_b64_tr_b16 a[66:67], v220 offset:4736
v_mfma_f32_16x16x32_bf16 v[148:151], a[68:71], a[244:247], v[148:151]
v_and_b32 v21, 0xffff0000, v21
v_accvgpr_read_b32 v23, a214
v_mfma_f32_16x16x32_bf16 v[156:159], a[68:71], a[100:103], v[156:159]
v_lshlrev_b32 v22, 16, v23
v_and_b32 v23, 0xffff0000, v23
v_mfma_f32_16x16x32_bf16 v[164:167], a[68:71], a[116:119], v[164:167]
v_accvgpr_read_b32 v25, a215
v_lshlrev_b32 v24, 16, v25
v_mfma_f32_16x16x32_bf16 v[164:167], a[72:75], a[120:123], v[164:167]
ds_read_b64_tr_b16 a[68:69], v220 offset:9344
ds_read_b64_tr_b16 a[70:71], v220 offset:13952
v_mfma_f32_16x16x32_bf16 v[156:159], a[72:75], a[104:107], v[156:159]
v_and_b32 v25, 0xffff0000, v25
v_accvgpr_read_b32 v27, a216
v_mfma_f32_16x16x32_bf16 v[148:151], a[72:75], a[248:251], v[148:151]
v_lshlrev_b32 v26, 16, v27
v_and_b32 v27, 0xffff0000, v27
v_mfma_f32_16x16x32_bf16 v[140:143], a[72:75], a[200:203], v[140:143]
v_accvgpr_read_b32 v29, a217
v_lshlrev_b32 v28, 16, v29
s_waitcnt lgkmcnt(8)
v_mfma_f32_16x16x32_bf16 v[140:143], a[76:79], a[204:207], v[140:143]
ds_read_b64_tr_b16 a[72:73], v220 offset:18560
ds_read_b64_tr_b16 a[74:75], v220 offset:23168
v_mfma_f32_16x16x32_bf16 v[148:151], a[76:79], a[252:255], v[148:151]
v_and_b32 v29, 0xffff0000, v29
v_accvgpr_read_b32 v31, a218
v_mfma_f32_16x16x32_bf16 v[156:159], a[76:79], a[108:111], v[156:159]
v_lshlrev_b32 v30, 16, v31
v_and_b32 v31, 0xffff0000, v31
v_mfma_f32_16x16x32_bf16 v[164:167], a[76:79], a[124:127], v[164:167]
v_accvgpr_read_b32 v33, a219
v_lshlrev_b32 v32, 16, v33
v_mfma_f32_16x16x32_bf16 v[164:167], a[80:83], a[48:51], v[164:167]
ds_read_b64_tr_b16 a[76:77], v220 offset:27776
ds_read_b64_tr_b16 a[78:79], v220 offset:32384
v_mfma_f32_16x16x32_bf16 v[156:159], a[80:83], a[32:35], v[156:159]
v_and_b32 v33, 0xffff0000, v33
v_accvgpr_read_b32 v35, a220
v_mfma_f32_16x16x32_bf16 v[148:151], a[80:83], a[16:19], v[148:151]
s_waitcnt vmcnt(0)
buffer_store_dword v231, v254, s[20:23], s28 offen
v_mfma_f32_16x16x32_bf16 v[140:143], a[80:83], a[0:3], v[140:143]
v_lshlrev_b32 v34, 16, v35
v_and_b32 v35, 0xffff0000, v35
v_mfma_f32_16x16x32_bf16 v[140:143], a[84:87], a[4:7], v[140:143]
ds_read_b64_tr_b16 a[80:81], v223 offset:128
ds_read_b64_tr_b16 a[82:83], v223 offset:4736
v_mfma_f32_16x16x32_bf16 v[148:151], a[84:87], a[20:23], v[148:151]
v_accvgpr_read_b32 v37, a221
v_lshlrev_b32 v36, 16, v37
v_mfma_f32_16x16x32_bf16 v[156:159], a[84:87], a[36:39], v[156:159]
v_and_b32 v37, 0xffff0000, v37
v_mfma_f32_16x16x32_bf16 v[164:167], a[84:87], a[52:55], v[164:167]
s_mov_b32 s90, 0x3f80
s_mov_b32 s91, 0x3f800000
s_waitcnt lgkmcnt(8)
v_mfma_f32_16x16x32_bf16 v[164:167], a[88:91], a[56:59], v[164:167]
ds_read_b64_tr_b16 a[84:85], v223 offset:9344
ds_read_b64_tr_b16 a[86:87], v223 offset:13952
v_mfma_f32_16x16x32_bf16 v[156:159], a[88:91], a[40:43], v[156:159]
v_mov_b32 v66, 0
v_mov_b32 v67, 0
v_mfma_f32_16x16x32_bf16 v[148:151], a[88:91], a[24:27], v[148:151]
v_mov_b32 v68, 0
v_mov_b32 v69, 0
v_mfma_f32_16x16x32_bf16 v[140:143], a[88:91], a[8:11], v[140:143]
v_mfma_f32_16x16x32_bf16 v[140:143], a[92:95], a[12:15], v[140:143]
ds_read_b64_tr_b16 a[88:89], v223 offset:18560
ds_read_b64_tr_b16 a[90:91], v223 offset:23168
v_mfma_f32_16x16x32_bf16 v[148:151], a[92:95], a[28:31], v[148:151]
v_mfma_f32_16x16x32_bf16 v[156:159], a[92:95], a[44:47], v[156:159]
v_mfma_f32_16x16x32_bf16 v[164:167], a[92:95], a[60:63], v[164:167]
v_mfma_f32_16x16x32_bf16 v[192:195], a[64:67], a[112:115], v[192:195]
ds_read_b64_tr_b16 a[92:93], v223 offset:27776
ds_read_b64_tr_b16 a[94:95], v223 offset:32384
v_mfma_f32_16x16x32_bf16 v[184:187], a[64:67], a[96:99], v[184:187]
v_mfma_f32_16x16x32_bf16 v[176:179], a[64:67], a[208:211], v[176:179]
v_mfma_f32_16x16x32_bf16 v[168:171], a[64:67], a[192:195], v[168:171]
s_waitcnt lgkmcnt(8)
v_mfma_f32_16x16x32_bf16 v[168:171], a[68:71], a[196:199], v[168:171]
ds_read_b64_tr_b16 a[64:65], v220 offset:136
ds_read_b64_tr_b16 a[66:67], v220 offset:4744
v_mfma_f32_16x16x32_bf16 v[176:179], a[68:71], a[244:247], v[176:179]
v_mfma_f32_16x16x32_bf16 v[184:187], a[68:71], a[100:103], v[184:187]
v_mfma_f32_16x16x32_bf16 v[192:195], a[68:71], a[116:119], v[192:195]
v_mfma_f32_16x16x32_bf16 v[192:195], a[72:75], a[120:123], v[192:195]
ds_read_b64_tr_b16 a[68:69], v220 offset:9352
ds_read_b64_tr_b16 a[70:71], v220 offset:13960
v_mfma_f32_16x16x32_bf16 v[184:187], a[72:75], a[104:107], v[184:187]
s_add_u32 s39, s44, 8192
v_mfma_f32_16x16x32_bf16 v[176:179], a[72:75], a[248:251], v[176:179]
v_cvt_pk_bf16_f32 v144, v144, v145
v_cvt_pk_bf16_f32 v145, v146, v147
v_mfma_f32_16x16x32_bf16 v[168:171], a[72:75], a[200:203], v[168:171]
v_cvt_pk_bf16_f32 v146, v148, v149
v_cvt_pk_bf16_f32 v147, v150, v151
v_mfma_f32_16x16x32_bf16 v[168:171], a[76:79], a[204:207], v[168:171]
ds_read_b64_tr_b16 a[72:73], v220 offset:18568
ds_read_b64_tr_b16 a[74:75], v220 offset:23176
v_mfma_f32_16x16x32_bf16 v[176:179], a[76:79], a[252:255], v[176:179]
buffer_store_dwordx4 v[144:147], v244, s[20:23], s39 offen offset:1024
v_mfma_f32_16x16x32_bf16 v[184:187], a[76:79], a[108:111], v[184:187]
v_cvt_pk_bf16_f32 v152, v152, v153
v_cvt_pk_bf16_f32 v153, v154, v155
v_mfma_f32_16x16x32_bf16 v[192:195], a[76:79], a[124:127], v[192:195]
v_cvt_pk_bf16_f32 v154, v156, v157
v_cvt_pk_bf16_f32 v155, v158, v159
s_waitcnt lgkmcnt(8)
v_mfma_f32_16x16x32_bf16 v[192:195], a[80:83], a[48:51], v[192:195]
ds_read_b64_tr_b16 a[76:77], v220 offset:27784
ds_read_b64_tr_b16 a[78:79], v220 offset:32392
v_mfma_f32_16x16x32_bf16 v[184:187], a[80:83], a[32:35], v[184:187]
buffer_store_dwordx4 v[152:155], v244, s[20:23], s39 offen offset:2048
v_mfma_f32_16x16x32_bf16 v[176:179], a[80:83], a[16:19], v[176:179]
v_cvt_pk_bf16_f32 v160, v160, v161
v_cvt_pk_bf16_f32 v161, v162, v163
v_mfma_f32_16x16x32_bf16 v[168:171], a[80:83], a[0:3], v[168:171]
v_cvt_pk_bf16_f32 v162, v164, v165
v_cvt_pk_bf16_f32 v163, v166, v167
v_mfma_f32_16x16x32_bf16 v[168:171], a[84:87], a[4:7], v[168:171]
ds_read_b64_tr_b16 a[80:81], v223 offset:136
ds_read_b64_tr_b16 a[82:83], v223 offset:4744
v_mfma_f32_16x16x32_bf16 v[176:179], a[84:87], a[20:23], v[176:179]
buffer_store_dwordx4 v[160:163], v244, s[20:23], s39 offen offset:3072
v_mfma_f32_16x16x32_bf16 v[184:187], a[84:87], a[36:39], v[184:187]
buffer_load_dword v230, v229, s[20:23], s95 offen sc0 sc1
v_mfma_f32_16x16x32_bf16 v[192:195], a[84:87], a[52:55], v[192:195]
v_mfma_f32_16x16x32_bf16 v[192:195], a[88:91], a[56:59], v[192:195]
ds_read_b64_tr_b16 a[84:85], v223 offset:9352
ds_read_b64_tr_b16 a[86:87], v223 offset:13960
v_mfma_f32_16x16x32_bf16 v[184:187], a[88:91], a[40:43], v[184:187]
v_mfma_f32_16x16x32_bf16 v[176:179], a[88:91], a[24:27], v[176:179]
v_mfma_f32_16x16x32_bf16 v[168:171], a[88:91], a[8:11], v[168:171]
s_waitcnt lgkmcnt(8)
v_mfma_f32_16x16x32_bf16 v[168:171], a[92:95], a[12:15], v[168:171]
ds_read_b64_tr_b16 a[88:89], v223 offset:18568
ds_read_b64_tr_b16 a[90:91], v223 offset:23176
v_mfma_f32_16x16x32_bf16 v[176:179], a[92:95], a[28:31], v[176:179]
v_mfma_f32_16x16x32_bf16 v[184:187], a[92:95], a[44:47], v[184:187]
v_mfma_f32_16x16x32_bf16 v[192:195], a[92:95], a[60:63], v[192:195]
v_mfma_f32_16x16x32_bf16 v[196:199], a[64:67], a[112:115], v[196:199]
ds_read_b64_tr_b16 a[92:93], v223 offset:27784
ds_read_b64_tr_b16 a[94:95], v223 offset:32392
v_mfma_f32_16x16x32_bf16 v[188:191], a[64:67], a[96:99], v[188:191]
v_mfma_f32_16x16x32_bf16 v[180:183], a[64:67], a[208:211], v[180:183]
v_mfma_f32_16x16x32_bf16 v[172:175], a[64:67], a[192:195], v[172:175]
v_mfma_f32_16x16x32_bf16 v[172:175], a[68:71], a[196:199], v[172:175]
v_mfma_f32_16x16x32_bf16 v[180:183], a[68:71], a[244:247], v[180:183]
v_mfma_f32_16x16x32_bf16 v[188:191], a[68:71], a[100:103], v[188:191]
v_mfma_f32_16x16x32_bf16 v[196:199], a[68:71], a[116:119], v[196:199]
s_waitcnt lgkmcnt(8)
v_mfma_f32_16x16x32_bf16 v[196:199], a[72:75], a[120:123], v[196:199]
v_mfma_f32_16x16x32_bf16 v[188:191], a[72:75], a[104:107], v[188:191]
v_mfma_f32_16x16x32_bf16 v[180:183], a[72:75], a[248:251], v[180:183]
v_mfma_f32_16x16x32_bf16 v[172:175], a[72:75], a[200:203], v[172:175]
v_mfma_f32_16x16x32_bf16 v[172:175], a[76:79], a[204:207], v[172:175]
v_mfma_f32_16x16x32_bf16 v[180:183], a[76:79], a[252:255], v[180:183]
v_mfma_f32_16x16x32_bf16 v[188:191], a[76:79], a[108:111], v[188:191]
s_waitcnt vmcnt(0)
v_cmp_gt_u32 vcc, 1, v230
v_mfma_f32_16x16x32_bf16 v[196:199], a[76:79], a[124:127], v[196:199]
s_waitcnt lgkmcnt(6)
v_mfma_f32_16x16x32_bf16 v[196:199], a[80:83], a[48:51], v[196:199]
s_and_b32 s29, vcc_lo, 0xff
s_cbranch_scc1 SP_P1A
SP_P1A_RET:
v_mfma_f32_16x16x32_bf16 v[188:191], a[80:83], a[32:35], v[188:191]
buffer_load_dwordx4 v[104:107], v244, s[20:23], s65 offen offset:3072 sc0 sc1
v_mfma_f32_16x16x32_bf16 v[180:183], a[80:83], a[16:19], v[180:183]
buffer_load_dwordx4 v[108:111], v244, s[20:23], s66 offen offset:2048 sc0 sc1
v_mfma_f32_16x16x32_bf16 v[172:175], a[80:83], a[0:3], v[172:175]
buffer_load_dwordx4 v[112:115], v244, s[20:23], s67 offen offset:1024 sc0 sc1
s_waitcnt lgkmcnt(4)
v_mfma_f32_16x16x32_bf16 v[172:175], a[84:87], a[4:7], v[172:175]
buffer_load_dwordx4 v[116:119], v244, s[20:23], s68 offen offset:0 sc0 sc1
v_mfma_f32_16x16x32_bf16 v[180:183], a[84:87], a[20:23], v[180:183]
buffer_load_dwordx4 v[120:123], v244, s[20:23], s69 offen offset:3072 sc0 sc1
v_mfma_f32_16x16x32_bf16 v[188:191], a[84:87], a[36:39], v[188:191]
buffer_load_dwordx4 v[124:127], v244, s[20:23], s70 offen offset:2048 sc0 sc1
v_mfma_f32_16x16x32_bf16 v[196:199], a[84:87], a[52:55], v[196:199]
buffer_load_dwordx4 v[128:131], v244, s[20:23], s71 offen offset:1024 sc0 sc1
s_waitcnt lgkmcnt(2)
v_mfma_f32_16x16x32_bf16 v[196:199], a[88:91], a[56:59], v[196:199]
v_mfma_f32_16x16x32_bf16 v[188:191], a[88:91], a[40:43], v[188:191]
v_mfma_f32_16x16x32_bf16 v[180:183], a[88:91], a[24:27], v[180:183]
v_mfma_f32_16x16x32_bf16 v[172:175], a[88:91], a[8:11], v[172:175]
s_waitcnt lgkmcnt(0)
v_mfma_f32_16x16x32_bf16 v[172:175], a[92:95], a[12:15], v[172:175]
v_mfma_f32_16x16x32_bf16 v[180:183], a[92:95], a[28:31], v[180:183]
v_mfma_f32_16x16x32_bf16 v[188:191], a[92:95], a[44:47], v[188:191]
v_mfma_f32_16x16x32_bf16 v[196:199], a[92:95], a[60:63], v[196:199]
s_add_u32 s39, s44, 12288
STUB_16:
s_cbranch_execz HOP_RET2
s_nop 5
v_cvt_pk_bf16_f32 v168, v168, v169
v_cvt_pk_bf16_f32 v169, v170, v171
v_cvt_pk_bf16_f32 v170, v172, v173
v_cvt_pk_bf16_f32 v171, v174, v175
buffer_store_dwordx4 v[168:171], v244, s[20:23], s39 offen offset:0
v_cvt_pk_bf16_f32 v176, v176, v177
v_cvt_pk_bf16_f32 v177, v178, v179
v_cvt_pk_bf16_f32 v178, v180, v181
v_cvt_pk_bf16_f32 v179, v182, v183
buffer_store_dwordx4 v[176:179], v244, s[20:23], s39 offen offset:1024
v_cvt_pk_bf16_f32 v184, v184, v185
v_cvt_pk_bf16_f32 v185, v186, v187
v_cvt_pk_bf16_f32 v186, v188, v189
v_cvt_pk_bf16_f32 v187, v190, v191
buffer_store_dwordx4 v[184:187], v244, s[20:23], s39 offen offset:2048
v_cvt_pk_bf16_f32 v192, v192, v193
v_cvt_pk_bf16_f32 v193, v194, v195
v_cvt_pk_bf16_f32 v194, v196, v197
v_cvt_pk_bf16_f32 v195, v198, v199
buffer_store_dwordx4 v[192:195], v244, s[20:23], s39 offen offset:3072
buffer_load_dwordx2 v[200:201], v226, s[20:23], s72 offen offset:0 sc0 sc1
buffer_load_dwordx2 v[202:203], v226, s[20:23], s73 offen offset:512 sc0 sc1
buffer_load_dwordx2 v[204:205], v226, s[20:23], s74 offen offset:0 sc0 sc1
buffer_load_dwordx2 v[206:207], v226, s[20:23], s75 offen offset:512 sc0 sc1
buffer_load_dwordx2 v[208:209], v226, s[20:23], s84 offen offset:0 sc0 sc1
buffer_load_dwordx2 v[210:211], v226, s[20:23], s85 offen offset:512 sc0 sc1
buffer_load_dwordx2 v[212:213], v226, s[20:23], s86 offen offset:0 sc0 sc1
buffer_load_dwordx2 v[214:215], v226, s[20:23], s87 offen offset:512 sc0 sc1
s_waitcnt vmcnt(8)
buffer_store_dword v246, v254, s[20:23], s28 offen
buffer_load_dword v230, v229, s[20:23], s95 offen sc0 sc1
s_waitcnt vmcnt(20)
v_dot2c_f32_bf16 v72, s90, v104
v_dot2c_f32_bf16 v73, s91, v104
v_dot2c_f32_bf16 v74, s90, v105
v_dot2c_f32_bf16 v75, s91, v105
v_dot2c_f32_bf16 v76, s90, v106
v_dot2c_f32_bf16 v77, s91, v106
v_dot2c_f32_bf16 v78, s90, v107
v_dot2c_f32_bf16 v79, s91, v107
s_waitcnt vmcnt(19)
v_dot2c_f32_bf16 v72, s90, v108
v_dot2c_f32_bf16 v73, s91, v108
v_dot2c_f32_bf16 v74, s90, v109
v_dot2c_f32_bf16 v75, s91, v109
v_dot2c_f32_bf16 v76, s90, v110
v_dot2c_f32_bf16 v77, s91, v110
v_dot2c_f32_bf16 v78, s90, v111
v_dot2c_f32_bf16 v79, s91, v111
s_waitcnt vmcnt(18)
v_dot2c_f32_bf16 v72, s90, v112
v_dot2c_f32_bf16 v73, s91, v112
v_dot2c_f32_bf16 v74, s90, v113
v_dot2c_f32_bf16 v75, s91, v113
v_dot2c_f32_bf16 v76, s90, v114
v_dot2c_f32_bf16 v77, s91, v114
v_dot2c_f32_bf16 v78, s90, v115
v_dot2c_f32_bf16 v79, s91, v115
s_waitcnt vmcnt(17)
v_dot2c_f32_bf16 v72, s90, v116
v_dot2c_f32_bf16 v73, s91, v116
v_dot2c_f32_bf16 v74, s90, v117
v_dot2c_f32_bf16 v75, s91, v117
v_dot2c_f32_bf16 v76, s90, v118
v_dot2c_f32_bf16 v77, s91, v118
v_dot2c_f32_bf16 v78, s90, v119
v_dot2c_f32_bf16 v79, s91, v119
s_waitcnt vmcnt(16)
v_dot2c_f32_bf16 v72, s90, v120
v_dot2c_f32_bf16 v73, s91, v120
v_dot2c_f32_bf16 v74, s90, v121
v_dot2c_f32_bf16 v75, s91, v121
v_dot2c_f32_bf16 v76, s90, v122
v_dot2c_f32_bf16 v77, s91, v122
v_dot2c_f32_bf16 v78, s90, v123
v_dot2c_f32_bf16 v79, s91, v123
s_waitcnt vmcnt(15)
v_dot2c_f32_bf16 v72, s90, v124
v_dot2c_f32_bf16 v73, s91, v124
v_dot2c_f32_bf16 v74, s90, v125
v_dot2c_f32_bf16 v75, s91, v125
v_dot2c_f32_bf16 v76, s90, v126
v_dot2c_f32_bf16 v77, s91, v126
v_dot2c_f32_bf16 v78, s90, v127
v_dot2c_f32_bf16 v79, s91, v127
s_waitcnt vmcnt(14)
v_dot2c_f32_bf16 v72, s90, v128
v_dot2c_f32_bf16 v73, s91, v128
v_dot2c_f32_bf16 v74, s90, v129
v_dot2c_f32_bf16 v75, s91, v129
v_dot2c_f32_bf16 v76, s90, v130
v_dot2c_f32_bf16 v77, s91, v130
v_dot2c_f32_bf16 v78, s90, v131
v_dot2c_f32_bf16 v79, s91, v131
s_nop 2
v_cvt_pk_bf16_f32 v58, v72, v73
v_cvt_pk_bf16_f32 v59, v74, v75
v_cvt_pk_bf16_f32 v60, v76, v77
v_cvt_pk_bf16_f32 v61, v78, v79
v_lshlrev_b32 v72, 16, v58
v_and_b32 v73, 0xffff0000, v58
v_lshlrev_b32 v74, 16, v59
v_and_b32 v75, 0xffff0000, v59
v_lshlrev_b32 v76, 16, v60
v_and_b32 v77, 0xffff0000, v60
v_lshlrev_b32 v78, 16, v61
v_and_b32 v79, 0xffff0000, v61
v_pk_mul_f32 v[72:73], v[72:73], v[38:39]
v_pk_mul_f32 v[74:75], v[74:75], v[40:41]
v_pk_mul_f32 v[76:77], v[76:77], v[42:43]
v_pk_mul_f32 v[78:79], v[78:79], v[44:45]
v_cvt_pk_bf16_f32 v58, v72, v73
v_cvt_pk_bf16_f32 v59, v74, v75
v_cvt_pk_bf16_f32 v60, v76, v77
v_cvt_pk_bf16_f32 v61, v78, v79
v_lshlrev_b32 v72, 16, v58
v_and_b32 v73, 0xffff0000, v58
v_lshlrev_b32 v74, 16, v59
v_and_b32 v75, 0xffff0000, v59
v_lshlrev_b32 v76, 16, v60
v_and_b32 v77, 0xffff0000, v60
v_lshlrev_b32 v78, 16, v61
v_and_b32 v79, 0xffff0000, v61
v_pk_add_f32 v[72:73], v[72:73], v[18:19]
v_pk_add_f32 v[74:75], v[74:75], v[20:21]
v_pk_add_f32 v[76:77], v[76:77], v[22:23]
v_pk_add_f32 v[78:79], v[78:79], v[24:25]
v_cvt_pk_bf16_f32 v72, v72, v73
v_cvt_pk_bf16_f32 v73, v74, v75
v_cvt_pk_bf16_f32 v74, v76, v77
v_cvt_pk_bf16_f32 v75, v78, v79
buffer_store_dwordx4 v[72:75], v248, s[60:63], 0 offen
s_waitcnt vmcnt(1)
v_cmp_gt_u32 vcc, 2, v230
s_nop 0
s_and_b32 s29, vcc_lo, 0xff
s_cbranch_scc0 SP_P2A_RET
SP_P2A:
s_sleep 0
s_add_u32 s100, s100, 1
s_bitcmp1_b32 s100, 19
s_cbranch_scc1 K_END
buffer_load_dword v230, v229, s[20:23], s95 offen sc0 sc1
s_waitcnt vmcnt(0)
v_cmp_gt_u32 vcc, 2, v230
s_nop 0
s_and_b32 s29, vcc_lo, 0xff
s_cbranch_scc1 SP_P2A
SP_P2A_RET:
buffer_load_dwordx4 v[80:83], v243, s[20:23], s65 offen offset:3072 sc0 sc1
buffer_load_dwordx4 v[84:87], v243, s[20:23], s66 offen offset:2048 sc0 sc1
buffer_load_dwordx4 v[88:91], v243, s[20:23], s67 offen offset:1024 sc0 sc1
buffer_load_dwordx4 v[92:95], v243, s[20:23], s68 offen offset:0 sc0 sc1
buffer_load_dwordx4 v[96:99], v243, s[20:23], s69 offen offset:3072 sc0 sc1
buffer_load_dwordx4 v[100:103], v243, s[20:23], s70 offen offset:2048 sc0 sc1
buffer_load_dwordx4 v[132:135], v243, s[20:23], s71 offen offset:1024 sc0 sc1
s_waitcnt vmcnt(17)
v_dot2c_f32_bf16 v66, s90, v200
v_dot2c_f32_bf16 v67, s91, v200
v_dot2c_f32_bf16 v68, s90, v201
v_dot2c_f32_bf16 v69, s91, v201
s_waitcnt vmcnt(16)
v_dot2c_f32_bf16 v66, s90, v202
v_dot2c_f32_bf16 v67, s91, v202
v_dot2c_f32_bf16 v68, s90, v203
v_dot2c_f32_bf16 v69, s91, v203
s_waitcnt vmcnt(15)
v_dot2c_f32_bf16 v66, s90, v204
v_dot2c_f32_bf16 v67, s91, v204
v_dot2c_f32_bf16 v68, s90, v205
v_dot2c_f32_bf16 v69, s91, v205
s_waitcnt vmcnt(14)
v_dot2c_f32_bf16 v66, s90, v206
v_dot2c_f32_bf16 v67, s91, v206
v_dot2c_f32_bf16 v68, s90, v207
v_dot2c_f32_bf16 v69, s91, v207
s_waitcnt vmcnt(13)
v_dot2c_f32_bf16 v66, s90, v208
v_dot2c_f32_bf16 v67, s91, v208
v_dot2c_f32_bf16 v68, s90, v209
v_dot2c_f32_bf16 v69, s91, v209
s_waitcnt vmcnt(12)
v_dot2c_f32_bf16 v66, s90, v210
v_dot2c_f32_bf16 v67, s91, v210
v_dot2c_f32_bf16 v68, s90, v211
v_dot2c_f32_bf16 v69, s91, v211
s_waitcnt vmcnt(11)
v_dot2c_f32_bf16 v66, s90, v212
v_dot2c_f32_bf16 v67, s91, v212
v_dot2c_f32_bf16 v68, s90, v213
v_dot2c_f32_bf16 v69, s91, v213
s_waitcnt vmcnt(10)
v_dot2c_f32_bf16 v66, s90, v214
v_dot2c_f32_bf16 v67, s91, v214
v_dot2c_f32_bf16 v68, s90, v215
v_dot2c_f32_bf16 v69, s91, v215
s_nop 2
s_cmp_eq_u32 s34, 0
s_cselect_b32 s29, 0, 0x7fbffff0
v_cvt_pk_bf16_f32 v58, v66, v67
v_cvt_pk_bf16_f32 v59, v68, v69
v_lshlrev_b32 v66, 16, v58
v_and_b32 v67, 0xffff0000, v58
v_lshlrev_b32 v68, 16, v59
v_and_b32 v69, 0xffff0000, v59
v_pk_mul_f32 v[66:67], v[66:67], v[54:55]
v_pk_mul_f32 v[68:69], v[68:69], v[56:57]
v_cvt_pk_bf16_f32 v58, v66, v67
v_cvt_pk_bf16_f32 v59, v68, v69
v_lshlrev_b32 v66, 16, v58
v_and_b32 v67, 0xffff0000, v58
v_lshlrev_b32 v68, 16, v59
v_and_b32 v69, 0xffff0000, v59
v_pk_add_f32 v[66:67], v[66:67], v[34:35]
v_pk_add_f32 v[68:69], v[68:69], v[36:37]
v_cvt_pk_bf16_f32 v66, v66, v67
v_cvt_pk_bf16_f32 v67, v68, v69
buffer_store_dwordx2 v[66:67], v249, s[60:63], s29 offen
s_waitcnt vmcnt(7)
v_dot2c_f32_bf16 v136, s90, v80
v_dot2c_f32_bf16 v137, s91, v80
v_dot2c_f32_bf16 v138, s90, v81
v_dot2c_f32_bf16 v139, s91, v81
v_dot2c_f32_bf16 v140, s90, v82
v_dot2c_f32_bf16 v141, s91, v82
v_dot2c_f32_bf16 v142, s90, v83
v_dot2c_f32_bf16 v143, s91, v83
s_waitcnt vmcnt(6)
v_dot2c_f32_bf16 v136, s90, v84
v_dot2c_f32_bf16 v137, s91, v84
v_dot2c_f32_bf16 v138, s90, v85
v_dot2c_f32_bf16 v139, s91, v85
v_dot2c_f32_bf16 v140, s90, v86
v_dot2c_f32_bf16 v141, s91, v86
v_dot2c_f32_bf16 v142, s90, v87
v_dot2c_f32_bf16 v143, s91, v87
s_waitcnt vmcnt(5)
v_dot2c_f32_bf16 v136, s90, v88
v_dot2c_f32_bf16 v137, s91, v88
v_dot2c_f32_bf16 v138, s90, v89
v_dot2c_f32_bf16 v139, s91, v89
v_dot2c_f32_bf16 v140, s90, v90
v_dot2c_f32_bf16 v141, s91, v90
v_dot2c_f32_bf16 v142, s90, v91
v_dot2c_f32_bf16 v143, s91, v91
s_waitcnt vmcnt(4)
v_dot2c_f32_bf16 v136, s90, v92
v_dot2c_f32_bf16 v137, s91, v92
v_dot2c_f32_bf16 v138, s90, v93
v_dot2c_f32_bf16 v139, s91, v93
v_dot2c_f32_bf16 v140, s90, v94
v_dot2c_f32_bf16 v141, s91, v94
v_dot2c_f32_bf16 v142, s90, v95
v_dot2c_f32_bf16 v143, s91, v95
s_waitcnt vmcnt(3)
v_dot2c_f32_bf16 v136, s90, v96
v_dot2c_f32_bf16 v137, s91, v96
v_dot2c_f32_bf16 v138, s90, v97
v_dot2c_f32_bf16 v139, s91, v97
v_dot2c_f32_bf16 v140, s90, v98
v_dot2c_f32_bf16 v141, s91, v98
v_dot2c_f32_bf16 v142, s90, v99
v_dot2c_f32_bf16 v143, s91, v99
s_waitcnt vmcnt(2)
v_dot2c_f32_bf16 v136, s90, v100
v_dot2c_f32_bf16 v137, s91, v100
v_dot2c_f32_bf16 v138, s90, v101
v_dot2c_f32_bf16 v139, s91, v101
v_dot2c_f32_bf16 v140, s90, v102
v_dot2c_f32_bf16 v141, s91, v102
v_dot2c_f32_bf16 v142, s90, v103
v_dot2c_f32_bf16 v143, s91, v103
s_waitcnt vmcnt(1)
v_dot2c_f32_bf16 v136, s90, v132
v_dot2c_f32_bf16 v137, s91, v132
v_dot2c_f32_bf16 v138, s90, v133
v_dot2c_f32_bf16 v139, s91, v133
v_dot2c_f32_bf16 v140, s90, v134
v_dot2c_f32_bf16 v141, s91, v134
v_dot2c_f32_bf16 v142, s90, v135
v_dot2c_f32_bf16 v143, s91, v135
s_nop 2
v_cvt_pk_bf16_f32 v58, v136, v137
v_cvt_pk_bf16_f32 v59, v138, v139
v_cvt_pk_bf16_f32 v60, v140, v141
v_cvt_pk_bf16_f32 v61, v142, v143
v_lshlrev_b32 v136, 16, v58
v_and_b32 v137, 0xffff0000, v58
v_lshlrev_b32 v138, 16, v59
v_and_b32 v139, 0xffff0000, v59
v_lshlrev_b32 v140, 16, v60
v_and_b32 v141, 0xffff0000, v60
v_lshlrev_b32 v142, 16, v61
v_and_b32 v143, 0xffff0000, v61
v_pk_mul_f32 v[136:137], v[136:137], v[46:47]
v_pk_mul_f32 v[138:139], v[138:139], v[48:49]
v_pk_mul_f32 v[140:141], v[140:141], v[50:51]
v_pk_mul_f32 v[142:143], v[142:143], v[52:53]
v_cvt_pk_bf16_f32 v58, v136, v137
v_cvt_pk_bf16_f32 v59, v138, v139
v_cvt_pk_bf16_f32 v60, v140, v141
v_cvt_pk_bf16_f32 v61, v142, v143
v_lshlrev_b32 v136, 16, v58
v_and_b32 v137, 0xffff0000, v58
v_lshlrev_b32 v138, 16, v59
v_and_b32 v139, 0xffff0000, v59
v_lshlrev_b32 v140, 16, v60
v_and_b32 v141, 0xffff0000, v60
v_lshlrev_b32 v142, 16, v61
v_and_b32 v143, 0xffff0000, v61
v_pk_add_f32 v[136:137], v[136:137], v[26:27]
v_pk_add_f32 v[138:139], v[138:139], v[28:29]
v_pk_add_f32 v[140:141], v[140:141], v[30:31]
v_pk_add_f32 v[142:143], v[142:143], v[32:33]
v_cvt_pk_bf16_f32 v136, v136, v137
v_cvt_pk_bf16_f32 v137, v138, v139
v_cvt_pk_bf16_f32 v138, v140, v141
v_cvt_pk_bf16_f32 v139, v142, v143
buffer_store_dwordx4 v[136:139], v248, s[60:63], 0 offen offset:128
K_END:
s_endpgm
K_EVT:
STUB_17:
s_cbranch_execz HOP_RET2
s_sub_u32 s3, s33, 1
s_cmp_lt_u32 s2, 144
s_cbranch_scc0 EV_Y
s_mov_b32 s3, 0
s_cmp_eq_u32 s37, 0
s_cbranch_scc0 K_EVT_RET
s_mov_b32 s28, 0x243000
EV_INC:
v_mov_b32 v246, 0
v_mov_b32 v247, 1
s_mov_b64 exec, 1
buffer_atomic_add v247, v246, s[20:23], s28 offen sc1
s_mov_b64 exec, -1
s_branch K_EVT_RET
EV_Y:
s_cmp_eq_u32 s33, 4
s_cbranch_scc0 EV_Y4
v_mov_b32 v246, 0
s_mov_b32 s28, 0x243000
buffer_load_dword v247, v246, s[20:23], s28 offen sc0 sc1
s_branch K_EVT_RET
EV_Y4:
s_cmp_eq_u32 s33, 1
s_cbranch_scc0 EV_Y5
s_mov_b32 s28, 0x243080
s_bitcmp0_b32 s37, 0
s_cbranch_scc1 EV_INC
s_branch K_EVT_RET
EV_Y5:
s_sub_u32 s29, s2, 144
s_lshr_b32 s28, s37, 1
s_lshl1_add_u32 s29, s29, s28
s_cmp_eq_u32 s33, 3
s_cbranch_scc0 EV_Y3
v_readfirstlane_b32 s28, v247
s_cmp_ge_u32 s28, 144
s_cbranch_scc0 EV_Y4SP
EV_Y4OK:
v_lshrrev_b32 v246, 3, v1
v_mul_u32_u24 v246, 18432, v246
v_and_b32 v247, 7, v1
v_lshl_add_u32 v246, v247, 4, v246
s_lshl_b32 s28, s29, 7
s_and_b32 s29, s37, 1
s_mul_i32 s29, s29, 1327104
s_add_u32 s28, s28, s29
s_add_u32 s28, s28, 0x2000000
buffer_load_dwordx4 v[104:107], v246, s[20:23], s28 offen sc0 sc1
s_add_u32 s28, s28, 147456
buffer_load_dwordx4 v[108:111], v246, s[20:23], s28 offen sc0 sc1
s_add_u32 s28, s28, 147456
buffer_load_dwordx4 v[112:115], v246, s[20:23], s28 offen sc0 sc1
s_add_u32 s28, s28, 147456
buffer_load_dwordx4 v[116:119], v246, s[20:23], s28 offen sc0 sc1
s_add_u32 s28, s28, 147456
buffer_load_dwordx4 v[120:123], v246, s[20:23], s28 offen sc0 sc1
s_add_u32 s28, s28, 147456
buffer_load_dwordx4 v[124:127], v246, s[20:23], s28 offen sc0 sc1
s_add_u32 s28, s28, 147456
buffer_load_dwordx4 v[128:131], v246, s[20:23], s28 offen sc0 sc1
s_add_u32 s28, s28, 147456
buffer_load_dwordx4 v[132:135], v246, s[20:23], s28 offen sc0 sc1
s_add_u32 s28, s28, 147456
buffer_load_dwordx4 v[248:251], v246, s[20:23], s28 offen sc0 sc1
s_branch K_EVT_RET
EV_Y3:
STUB_18:
s_cbranch_execz HOP_RET2
v_pk_add_f32 v[104:105], v[104:105], v[108:109]
v_pk_add_f32 v[106:107], v[106:107], v[110:111]
v_pk_add_f32 v[112:113], v[112:113], v[116:117]
v_pk_add_f32 v[114:115], v[114:115], v[118:119]
v_pk_add_f32 v[120:121], v[120:121], v[124:125]
v_pk_add_f32 v[122:123], v[122:123], v[126:127]
v_pk_add_f32 v[128:129], v[128:129], v[132:133]
v_pk_add_f32 v[130:131], v[130:131], v[134:135]
v_pk_add_f32 v[104:105], v[104:105], v[112:113]
v_pk_add_f32 v[106:107], v[106:107], v[114:115]
v_pk_add_f32 v[120:121], v[120:121], v[128:129]
v_pk_add_f32 v[122:123], v[122:123], v[130:131]
v_pk_add_f32 v[104:105], v[104:105], v[248:249]
v_pk_add_f32 v[106:107], v[106:107], v[250:251]
v_pk_add_f32 v[104:105], v[104:105], v[120:121]
v_pk_add_f32 v[106:107], v[106:107], v[122:123]
v_and_b32 v246, 7, v1
s_lshr_b32 s28, s37, 1
s_lshl_b32 s28, s28, 7
v_add_f32_dpp v108, v104, v104 row_ror:8 row_mask:0xf bank_mask:0xf
v_add_f32_dpp v109, v105, v105 row_ror:8 row_mask:0xf bank_mask:0xf
v_add_f32_dpp v110, v106, v106 row_ror:8 row_mask:0xf bank_mask:0xf
v_add_f32_dpp v111, v107, v107 row_ror:8 row_mask:0xf bank_mask:0xf
v_mov_b32 v104, v108
v_mov_b32 v105, v109
v_mov_b32 v106, v110
v_mov_b32 v107, v111
v_permlane16_swap_b32 v104, v108
v_permlane16_swap_b32 v105, v109
v_permlane16_swap_b32 v106, v110
v_permlane16_swap_b32 v107, v111
v_add_f32 v108, v104, v108
v_add_f32 v109, v105, v109
v_add_f32 v110, v106, v110
v_add_f32 v111, v107, v111
v_mov_b32 v104, v108
v_mov_b32 v105, v109
v_mov_b32 v106, v110
v_mov_b32 v107, v111
v_permlane32_swap_b32 v104, v108
v_permlane32_swap_b32 v105, v109
v_permlane32_swap_b32 v106, v110
v_permlane32_swap_b32 v107, v111
v_add_f32 v108, v104, v108
v_add_f32 v109, v105, v109
v_add_f32 v110, v106, v110
v_add_f32 v111, v107, v111
v_lshlrev_b32 v247, 4, v246
v_add_u32 v247, s28, v247
s_bitcmp1_b32 s37, 0
s_cbranch_scc0 EV_YE
ds_write_b128 v247, v[108:111] offset:65024
s_waitcnt lgkmcnt(0)
s_barrier
s_branch K_EVT_RET
EV_YE:
s_barrier
ds_read_b128 v[104:107], v247 offset:65024
v_mul_u32_u24 v246, 0x480, v246
s_lshl_b32 s28, s29, 3
s_add_u32 s28, s28, 0x244000
s_waitcnt lgkmcnt(0)
v_pk_add_f32 v[104:105], v[104:105], v[108:109]
v_pk_add_f32 v[106:107], v[106:107], v[110:111]
v_cvt_pk_bf16_f32 v108, v104, v105
v_cvt_pk_bf16_f32 v109, v106, v107
v_lshlrev_b32 v104, 16, v108
v_and_b32 v105, 0xffff0000, v108
v_lshlrev_b32 v106, 16, v109
v_and_b32 v107, 0xffff0000, v109
v_mul_f32 v104, v104, v236
v_mul_f32 v105, v105, v236
v_mul_f32 v106, v106, v236
v_mul_f32 v107, v107, v236
v_cvt_pk_bf16_f32 v108, v104, v105
v_cvt_pk_bf16_f32 v109, v106, v107
s_mov_b64 exec, 0xff
buffer_store_dwordx2 v[108:109], v246, s[20:23], s28 offen sc0 sc1
s_mov_b64 exec, -1
s_branch K_EVT_RET
SP_CAND:
s_sleep 2
s_add_u32 s100, s100, 1
s_bitcmp1_b32 s100, 19
s_cbranch_scc1 K_END
s_mov_b32 s29, 0x242000
buffer_load_dwordx2 v[248:249], v250, s[20:23], s29 offen sc0 sc1
s_waitcnt vmcnt(0)
v_cmp_ne_u32 vcc, s47, v249
s_cbranch_vccnz SP_CAND
s_branch SP_CAND_RET
SP_FL:
s_sleep 2
s_add_u32 s100, s100, 1
s_bitcmp1_b32 s100, 19
s_cbranch_scc1 K_END
buffer_load_dword v253, v246, s[24:27], 0 offen sc0 sc1
s_waitcnt vmcnt(0)
v_and_b32 v253, 0x20202020, v253
v_cmp_ne_u32 vcc, 0x20202020, v253
s_cbranch_vccnz SP_FL
s_branch SP_FL_RET
SP_Y:
s_sleep 4
s_add_u32 s100, s100, 1
s_bitcmp1_b32 s100, 19
s_cbranch_scc1 K_END
s_mov_b32 s93, 0x243080
buffer_load_dword v246, v254, s[20:23], s93 offen sc0 sc1
s_waitcnt vmcnt(0)
v_readfirstlane_b32 s93, v246
s_cmp_lt_u32 s93, 144
s_cbranch_scc1 SP_Y
s_branch SP_Y_RET
SP_O1A:
s_sleep 1
s_add_u32 s100, s100, 1
s_bitcmp1_b32 s100, 19
s_cbranch_scc1 K_END
buffer_load_dword v230, v229, s[20:23], s94 offen sc0 sc1
s_waitcnt vmcnt(0)
v_cmp_gt_u32 vcc, 1, v230
s_bitcmp1_b32 vcc_lo, s39
s_cbranch_scc1 SP_O1A
s_branch SP_O1A_RET
SP_O2A:
s_sleep 1
s_add_u32 s100, s100, 1
s_bitcmp1_b32 s100, 19
s_cbranch_scc1 K_END
buffer_load_dword v230, v229, s[20:23], s94 offen sc0 sc1
s_waitcnt vmcnt(0)
v_cmp_gt_u32 vcc, 1, v230
s_and_b32 s29, vcc_lo, 15
s_cbranch_scc1 SP_O2A
s_branch SP_O2A_RET
SP_O3A:
s_sleep 1
s_add_u32 s100, s100, 1
s_bitcmp1_b32 s100, 19
s_cbranch_scc1 K_END
buffer_load_dword v230, v229, s[20:23], s94 offen sc0 sc1
s_waitcnt vmcnt(0)
v_cmp_gt_u32 vcc, 2, v230
s_and_b32 s29, vcc_lo, 15
s_cbranch_scc1 SP_O3A
s_branch SP_O3A_RET
SP_P1A:
s_sleep 1
s_add_u32 s100, s100, 1
s_bitcmp1_b32 s100, 19
s_cbranch_scc1 K_END
buffer_load_dword v230, v229, s[20:23], s95 offen sc0 sc1
s_waitcnt vmcnt(0)
v_cmp_gt_u32 vcc, 1, v230
s_and_b32 s29, vcc_lo, 0xff
s_cbranch_scc1 SP_P1A
s_branch SP_P1A_RET
EV_Y4SP:
s_sleep 8
s_add_u32 s100, s100, 1
s_bitcmp1_b32 s100, 19
s_cbranch_scc1 K_END
v_mov_b32 v246, 0
s_mov_b32 s28, 0x243000
buffer_load_dword v247, v246, s[20:23], s28 offen sc0 sc1
s_waitcnt vmcnt(0)
v_readfirstlane_b32 s28, v247
s_cmp_ge_u32 s28, 144
s_cbranch_scc0 EV_Y4SP
s_branch EV_Y4OK
K_HOT_END:
K_MIXED:
s_waitcnt lgkmcnt(0)
s_barrier
v_smfmac_f32_16x16x64_bf16 a[128:131], a[208:211], v[88:95], v245
v_smfmac_f32_16x16x64_bf16 a[132:135], a[208:211], v[96:103], v245
v_mfma_f32_16x16x32_bf16 a[0:3], a[176:179], v[88:91], a[0:3]
v_mfma_f32_16x16x32_bf16 a[16:19], a[180:183], v[88:91], a[16:19]
v_mfma_f32_16x16x32_bf16 a[32:35], a[184:187], v[88:91], a[32:35]
v_mfma_f32_16x16x32_bf16 a[48:51], a[188:191], v[88:91], a[48:51]
v_mfma_f32_16x16x32_bf16 a[64:67], a[192:195], v[88:91], a[64:67]
v_mfma_f32_16x16x32_bf16 a[80:83], a[196:199], v[88:91], a[80:83]
v_mfma_f32_16x16x32_bf16 a[96:99], a[200:203], v[88:91], a[96:99]
v_mfma_f32_16x16x32_bf16 a[112:115], a[204:207], v[88:91], a[112:115]
v_mfma_f32_16x16x32_bf16 a[4:7], a[176:179], v[92:95], a[4:7]
v_mfma_f32_16x16x32_bf16 a[20:23], a[180:183], v[92:95], a[20:23]
v_mfma_f32_16x16x32_bf16 a[36:39], a[184:187], v[92:95], a[36:39]
v_mfma_f32_16x16x32_bf16 a[52:55], a[188:191], v[92:95], a[52:55]
v_mfma_f32_16x16x32_bf16 a[68:71], a[192:195], v[92:95], a[68:71]
v_mfma_f32_16x16x32_bf16 a[84:87], a[196:199], v[92:95], a[84:87]
v_mfma_f32_16x16x32_bf16 a[100:103], a[200:203], v[92:95], a[100:103]
v_mfma_f32_16x16x32_bf16 a[116:119], a[204:207], v[92:95], a[116:119]
v_accvgpr_read_b32 v120, a128
v_accvgpr_read_b32 v124, a129
v_add_f32 v120, v120, v124
v_rcp_f32 v124, v120
s_add_u32 s50, s44, 0
v_mov_b32 v125, v124
v_accvgpr_read_b32 v104, a0
v_accvgpr_read_b32 v105, a1
v_accvgpr_read_b32 v106, a2
v_accvgpr_read_b32 v107, a3
v_accvgpr_read_b32 v108, a16
v_accvgpr_read_b32 v109, a17
v_accvgpr_read_b32 v110, a18
v_accvgpr_read_b32 v111, a19
v_pk_mul_f32 v[104:105], v[104:105], v[124:125]
v_pk_mul_f32 v[106:107], v[106:107], v[124:125]
v_pk_mul_f32 v[108:109], v[108:109], v[124:125]
v_pk_mul_f32 v[110:111], v[110:111], v[124:125]
v_cvt_pk_bf16_f32 v8, v104, v105
v_cvt_pk_bf16_f32 v9, v106, v107
v_cvt_pk_bf16_f32 v10, v108, v109
v_cvt_pk_bf16_f32 v11, v110, v111
buffer_store_dwordx4 v[8:11], v244, s[20:23], s50 offen offset:0 sc0 sc1
v_accvgpr_read_b32 v112, a32
v_accvgpr_read_b32 v113, a33
v_accvgpr_read_b32 v114, a34
v_accvgpr_read_b32 v115, a35
v_accvgpr_read_b32 v116, a48
v_accvgpr_read_b32 v117, a49
v_accvgpr_read_b32 v118, a50
v_accvgpr_read_b32 v119, a51
v_pk_mul_f32 v[112:113], v[112:113], v[124:125]
v_pk_mul_f32 v[114:115], v[114:115], v[124:125]
v_pk_mul_f32 v[116:117], v[116:117], v[124:125]
v_pk_mul_f32 v[118:119], v[118:119], v[124:125]
v_cvt_pk_bf16_f32 v12, v112, v113
v_cvt_pk_bf16_f32 v13, v114, v115
v_cvt_pk_bf16_f32 v14, v116, v117
v_cvt_pk_bf16_f32 v15, v118, v119
buffer_store_dwordx4 v[12:15], v244, s[20:23], s50 offen offset:1024 sc0 sc1
v_accvgpr_read_b32 v104, a64
v_accvgpr_read_b32 v105, a65
v_accvgpr_read_b32 v106, a66
v_accvgpr_read_b32 v107, a67
v_accvgpr_read_b32 v108, a80
v_accvgpr_read_b32 v109, a81
v_accvgpr_read_b32 v110, a82
v_accvgpr_read_b32 v111, a83
v_pk_mul_f32 v[104:105], v[104:105], v[124:125]
v_pk_mul_f32 v[106:107], v[106:107], v[124:125]
v_pk_mul_f32 v[108:109], v[108:109], v[124:125]
v_pk_mul_f32 v[110:111], v[110:111], v[124:125]
v_cvt_pk_bf16_f32 v16, v104, v105
v_cvt_pk_bf16_f32 v17, v106, v107
v_cvt_pk_bf16_f32 v18, v108, v109
v_cvt_pk_bf16_f32 v19, v110, v111
buffer_store_dwordx4 v[16:19], v244, s[20:23], s50 offen offset:2048 sc0 sc1
v_accvgpr_read_b32 v112, a96
v_accvgpr_read_b32 v113, a97
v_accvgpr_read_b32 v114, a98
v_accvgpr_read_b32 v115, a99
v_accvgpr_read_b32 v116, a112
v_accvgpr_read_b32 v117, a113
v_accvgpr_read_b32 v118, a114
v_accvgpr_read_b32 v119, a115
v_pk_mul_f32 v[112:113], v[112:113], v[124:125]
v_pk_mul_f32 v[114:115], v[114:115], v[124:125]
v_pk_mul_f32 v[116:117], v[116:117], v[124:125]
v_pk_mul_f32 v[118:119], v[118:119], v[124:125]
v_cvt_pk_bf16_f32 v20, v112, v113
v_cvt_pk_bf16_f32 v21, v114, v115
v_cvt_pk_bf16_f32 v22, v116, v117
v_cvt_pk_bf16_f32 v23, v118, v119
buffer_store_dwordx4 v[20:23], v244, s[20:23], s50 offen offset:3072 sc0 sc1
v_mfma_f32_16x16x32_bf16 a[8:11], a[176:179], v[96:99], a[8:11]
v_mfma_f32_16x16x32_bf16 a[24:27], a[180:183], v[96:99], a[24:27]
v_mfma_f32_16x16x32_bf16 a[40:43], a[184:187], v[96:99], a[40:43]
v_mfma_f32_16x16x32_bf16 a[56:59], a[188:191], v[96:99], a[56:59]
v_mfma_f32_16x16x32_bf16 a[72:75], a[192:195], v[96:99], a[72:75]
v_mfma_f32_16x16x32_bf16 a[88:91], a[196:199], v[96:99], a[88:91]
v_mfma_f32_16x16x32_bf16 a[104:107], a[200:203], v[96:99], a[104:107]
v_mfma_f32_16x16x32_bf16 a[120:123], a[204:207], v[96:99], a[120:123]
v_accvgpr_read_b32 v121, a130
v_accvgpr_read_b32 v126, a131
v_add_f32 v121, v121, v126
v_rcp_f32 v126, v121
s_add_u32 s50, s44, 4096
v_mov_b32 v127, v126
v_accvgpr_read_b32 v104, a4
v_accvgpr_read_b32 v105, a5
v_accvgpr_read_b32 v106, a6
v_accvgpr_read_b32 v107, a7
v_accvgpr_read_b32 v108, a20
v_accvgpr_read_b32 v109, a21
v_accvgpr_read_b32 v110, a22
v_accvgpr_read_b32 v111, a23
v_pk_mul_f32 v[104:105], v[104:105], v[126:127]
v_pk_mul_f32 v[106:107], v[106:107], v[126:127]
v_pk_mul_f32 v[108:109], v[108:109], v[126:127]
v_pk_mul_f32 v[110:111], v[110:111], v[126:127]
v_cvt_pk_bf16_f32 v24, v104, v105
v_cvt_pk_bf16_f32 v25, v106, v107
v_cvt_pk_bf16_f32 v26, v108, v109
v_cvt_pk_bf16_f32 v27, v110, v111
buffer_store_dwordx4 v[24:27], v244, s[20:23], s50 offen offset:0 sc0 sc1
v_accvgpr_read_b32 v112, a36
v_accvgpr_read_b32 v113, a37
v_accvgpr_read_b32 v114, a38
v_accvgpr_read_b32 v115, a39
v_accvgpr_read_b32 v116, a52
v_accvgpr_read_b32 v117, a53
v_accvgpr_read_b32 v118, a54
v_accvgpr_read_b32 v119, a55
v_pk_mul_f32 v[112:113], v[112:113], v[126:127]
v_pk_mul_f32 v[114:115], v[114:115], v[126:127]
v_pk_mul_f32 v[116:117], v[116:117], v[126:127]
v_pk_mul_f32 v[118:119], v[118:119], v[126:127]
v_cvt_pk_bf16_f32 v28, v112, v113
v_cvt_pk_bf16_f32 v29, v114, v115
v_cvt_pk_bf16_f32 v30, v116, v117
v_cvt_pk_bf16_f32 v31, v118, v119
buffer_store_dwordx4 v[28:31], v244, s[20:23], s50 offen offset:1024 sc0 sc1
v_accvgpr_read_b32 v104, a68
v_accvgpr_read_b32 v105, a69
v_accvgpr_read_b32 v106, a70
v_accvgpr_read_b32 v107, a71
v_accvgpr_read_b32 v108, a84
v_accvgpr_read_b32 v109, a85
v_accvgpr_read_b32 v110, a86
v_accvgpr_read_b32 v111, a87
v_pk_mul_f32 v[104:105], v[104:105], v[126:127]
v_pk_mul_f32 v[106:107], v[106:107], v[126:127]
v_pk_mul_f32 v[108:109], v[108:109], v[126:127]
v_pk_mul_f32 v[110:111], v[110:111], v[126:127]
v_cvt_pk_bf16_f32 v32, v104, v105
v_cvt_pk_bf16_f32 v33, v106, v107
v_cvt_pk_bf16_f32 v34, v108, v109
v_cvt_pk_bf16_f32 v35, v110, v111
buffer_store_dwordx4 v[32:35], v244, s[20:23], s50 offen offset:2048 sc0 sc1
v_accvgpr_read_b32 v112, a100
v_accvgpr_read_b32 v113, a101
v_accvgpr_read_b32 v114, a102
v_accvgpr_read_b32 v115, a103
v_accvgpr_read_b32 v116, a116
v_accvgpr_read_b32 v117, a117
v_accvgpr_read_b32 v118, a118
v_accvgpr_read_b32 v119, a119
v_pk_mul_f32 v[112:113], v[112:113], v[126:127]
v_pk_mul_f32 v[114:115], v[114:115], v[126:127]
v_pk_mul_f32 v[116:117], v[116:117], v[126:127]
v_pk_mul_f32 v[118:119], v[118:119], v[126:127]
v_cvt_pk_bf16_f32 v36, v112, v113
v_cvt_pk_bf16_f32 v37, v114, v115
v_cvt_pk_bf16_f32 v38, v116, v117
v_cvt_pk_bf16_f32 v39, v118, v119
buffer_store_dwordx4 v[36:39], v244, s[20:23], s50 offen offset:3072 sc0 sc1
v_mfma_f32_16x16x32_bf16 a[12:15], a[176:179], v[100:103], a[12:15]
v_mfma_f32_16x16x32_bf16 a[28:31], a[180:183], v[100:103], a[28:31]
v_mfma_f32_16x16x32_bf16 a[44:47], a[184:187], v[100:103], a[44:47]
v_mfma_f32_16x16x32_bf16 a[60:63], a[188:191], v[100:103], a[60:63]
v_mfma_f32_16x16x32_bf16 a[76:79], a[192:195], v[100:103], a[76:79]
v_mfma_f32_16x16x32_bf16 a[92:95], a[196:199], v[100:103], a[92:95]
v_mfma_f32_16x16x32_bf16 a[108:111], a[200:203], v[100:103], a[108:111]
v_mfma_f32_16x16x32_bf16 a[124:127], a[204:207], v[100:103], a[124:127]
v_accvgpr_read_b32 v122, a132
v_accvgpr_read_b32 v128, a133
v_add_f32 v122, v122, v128
v_rcp_f32 v128, v122
s_add_u32 s50, s44, 8192
v_mov_b32 v129, v128
v_accvgpr_read_b32 v104, a8
v_accvgpr_read_b32 v105, a9
v_accvgpr_read_b32 v106, a10
v_accvgpr_read_b32 v107, a11
v_accvgpr_read_b32 v108, a24
v_accvgpr_read_b32 v109, a25
v_accvgpr_read_b32 v110, a26
v_accvgpr_read_b32 v111, a27
v_pk_mul_f32 v[104:105], v[104:105], v[128:129]
v_pk_mul_f32 v[106:107], v[106:107], v[128:129]
v_pk_mul_f32 v[108:109], v[108:109], v[128:129]
v_pk_mul_f32 v[110:111], v[110:111], v[128:129]
v_cvt_pk_bf16_f32 v40, v104, v105
v_cvt_pk_bf16_f32 v41, v106, v107
v_cvt_pk_bf16_f32 v42, v108, v109
v_cvt_pk_bf16_f32 v43, v110, v111
buffer_store_dwordx4 v[40:43], v244, s[20:23], s50 offen offset:0 sc0 sc1
v_accvgpr_read_b32 v112, a40
v_accvgpr_read_b32 v113, a41
v_accvgpr_read_b32 v114, a42
v_accvgpr_read_b32 v115, a43
v_accvgpr_read_b32 v116, a56
v_accvgpr_read_b32 v117, a57
v_accvgpr_read_b32 v118, a58
v_accvgpr_read_b32 v119, a59
v_pk_mul_f32 v[112:113], v[112:113], v[128:129]
v_pk_mul_f32 v[114:115], v[114:115], v[128:129]
v_pk_mul_f32 v[116:117], v[116:117], v[128:129]
v_pk_mul_f32 v[118:119], v[118:119], v[128:129]
v_cvt_pk_bf16_f32 v44, v112, v113
v_cvt_pk_bf16_f32 v45, v114, v115
v_cvt_pk_bf16_f32 v46, v116, v117
v_cvt_pk_bf16_f32 v47, v118, v119
buffer_store_dwordx4 v[44:47], v244, s[20:23], s50 offen offset:1024 sc0 sc1
v_accvgpr_read_b32 v104, a72
v_accvgpr_read_b32 v105, a73
v_accvgpr_read_b32 v106, a74
v_accvgpr_read_b32 v107, a75
v_accvgpr_read_b32 v108, a88
v_accvgpr_read_b32 v109, a89
v_accvgpr_read_b32 v110, a90
v_accvgpr_read_b32 v111, a91
v_pk_mul_f32 v[104:105], v[104:105], v[128:129]
v_pk_mul_f32 v[106:107], v[106:107], v[128:129]
v_pk_mul_f32 v[108:109], v[108:109], v[128:129]
v_pk_mul_f32 v[110:111], v[110:111], v[128:129]
v_cvt_pk_bf16_f32 v48, v104, v105
v_cvt_pk_bf16_f32 v49, v106, v107
v_cvt_pk_bf16_f32 v50, v108, v109
v_cvt_pk_bf16_f32 v51, v110, v111
buffer_store_dwordx4 v[48:51], v244, s[20:23], s50 offen offset:2048 sc0 sc1
v_accvgpr_read_b32 v112, a104
v_accvgpr_read_b32 v113, a105
v_accvgpr_read_b32 v114, a106
v_accvgpr_read_b32 v115, a107
v_accvgpr_read_b32 v116, a120
v_accvgpr_read_b32 v117, a121
v_accvgpr_read_b32 v118, a122
v_accvgpr_read_b32 v119, a123
v_pk_mul_f32 v[112:113], v[112:113], v[128:129]
v_pk_mul_f32 v[114:115], v[114:115], v[128:129]
v_pk_mul_f32 v[116:117], v[116:117], v[128:129]
v_pk_mul_f32 v[118:119], v[118:119], v[128:129]
v_cvt_pk_bf16_f32 v52, v112, v113
v_cvt_pk_bf16_f32 v53, v114, v115
v_cvt_pk_bf16_f32 v54, v116, v117
v_cvt_pk_bf16_f32 v55, v118, v119
buffer_store_dwordx4 v[52:55], v244, s[20:23], s50 offen offset:3072 sc0 sc1
s_nop 7
v_accvgpr_read_b32 v123, a134
v_accvgpr_read_b32 v130, a135
v_add_f32 v123, v123, v130
v_rcp_f32 v130, v123
s_add_u32 s50, s44, 12288
v_mov_b32 v131, v130
v_accvgpr_read_b32 v104, a12
v_accvgpr_read_b32 v105, a13
v_accvgpr_read_b32 v106, a14
v_accvgpr_read_b32 v107, a15
v_accvgpr_read_b32 v108, a28
v_accvgpr_read_b32 v109, a29
v_accvgpr_read_b32 v110, a30
v_accvgpr_read_b32 v111, a31
v_pk_mul_f32 v[104:105], v[104:105], v[130:131]
v_pk_mul_f32 v[106:107], v[106:107], v[130:131]
v_pk_mul_f32 v[108:109], v[108:109], v[130:131]
v_pk_mul_f32 v[110:111], v[110:111], v[130:131]
v_cvt_pk_bf16_f32 v56, v104, v105
v_cvt_pk_bf16_f32 v57, v106, v107
v_cvt_pk_bf16_f32 v58, v108, v109
v_cvt_pk_bf16_f32 v59, v110, v111
buffer_store_dwordx4 v[56:59], v244, s[20:23], s50 offen offset:0 sc0 sc1
v_accvgpr_read_b32 v112, a44
v_accvgpr_read_b32 v113, a45
v_accvgpr_read_b32 v114, a46
v_accvgpr_read_b32 v115, a47
v_accvgpr_read_b32 v116, a60
v_accvgpr_read_b32 v117, a61
v_accvgpr_read_b32 v118, a62
v_accvgpr_read_b32 v119, a63
v_pk_mul_f32 v[112:113], v[112:113], v[130:131]
v_pk_mul_f32 v[114:115], v[114:115], v[130:131]
v_pk_mul_f32 v[116:117], v[116:117], v[130:131]
v_pk_mul_f32 v[118:119], v[118:119], v[130:131]
v_cvt_pk_bf16_f32 v60, v112, v113
v_cvt_pk_bf16_f32 v61, v114, v115
v_cvt_pk_bf16_f32 v62, v116, v117
v_cvt_pk_bf16_f32 v63, v118, v119
buffer_store_dwordx4 v[60:63], v244, s[20:23], s50 offen offset:1024 sc0 sc1
v_accvgpr_read_b32 v104, a76
v_accvgpr_read_b32 v105, a77
v_accvgpr_read_b32 v106, a78
v_accvgpr_read_b32 v107, a79
v_accvgpr_read_b32 v108, a92
v_accvgpr_read_b32 v109, a93
v_accvgpr_read_b32 v110, a94
v_accvgpr_read_b32 v111, a95
v_pk_mul_f32 v[104:105], v[104:105], v[130:131]
v_pk_mul_f32 v[106:107], v[106:107], v[130:131]
v_pk_mul_f32 v[108:109], v[108:109], v[130:131]
v_pk_mul_f32 v[110:111], v[110:111], v[130:131]
v_cvt_pk_bf16_f32 v64, v104, v105
v_cvt_pk_bf16_f32 v65, v106, v107
v_cvt_pk_bf16_f32 v66, v108, v109
v_cvt_pk_bf16_f32 v67, v110, v111
buffer_store_dwordx4 v[64:67], v244, s[20:23], s50 offen offset:2048 sc0 sc1
v_accvgpr_read_b32 v112, a108
v_accvgpr_read_b32 v113, a109
v_accvgpr_read_b32 v114, a110
v_accvgpr_read_b32 v115, a111
v_accvgpr_read_b32 v116, a124
v_accvgpr_read_b32 v117, a125
v_accvgpr_read_b32 v118, a126
v_accvgpr_read_b32 v119, a127
v_pk_mul_f32 v[112:113], v[112:113], v[130:131]
v_pk_mul_f32 v[114:115], v[114:115], v[130:131]
v_pk_mul_f32 v[116:117], v[116:117], v[130:131]
v_pk_mul_f32 v[118:119], v[118:119], v[130:131]
v_cvt_pk_bf16_f32 v68, v112, v113
v_cvt_pk_bf16_f32 v69, v114, v115
v_cvt_pk_bf16_f32 v70, v116, v117
v_cvt_pk_bf16_f32 v71, v118, v119
buffer_store_dwordx4 v[68:71], v244, s[20:23], s50 offen offset:3072 sc0 sc1
v_max3_f32 v104, v120, v121, v122
v_max_f32 v104, v104, v123
v_add_f32 v105, v120, v121
v_add_f32 v105, v105, v122
v_add_f32 v105, v105, v123
v_cmp_nge_f32 vcc, s42, v104
v_cmp_u_f32 s[28:29], v105, v105
s_or_b64 vcc, vcc, s[28:29]
s_cmp_lg_u64 vcc, 0
s_cselect_b32 s28, 1, 0
v_mov_b32 v104, s28
s_lshl_b32 s29, s37, 2
s_add_u32 s29, s29, 147968
v_mov_b32 v105, s29
v_mov_b32 v106, 147968
ds_write_b32 v105, v104
s_waitcnt vmcnt(16) lgkmcnt(0)
s_barrier
ds_read_b128 v[108:111], v106
ds_read_b64_tr_b16 a[64:65], v237 offset:0
ds_read_b64_tr_b16 a[66:67], v237 offset:4608
ds_read_b64_tr_b16 a[68:69], v237 offset:8
ds_read_b64_tr_b16 a[70:71], v237 offset:4616
ds_read_b64_tr_b16 a[72:73], v238 offset:0
ds_read_b64_tr_b16 a[74:75], v238 offset:4608
ds_read_b64_tr_b16 a[76:77], v238 offset:8
ds_read_b64_tr_b16 a[78:79], v238 offset:4616
ds_read_b64_tr_b16 a[80:81], v237 offset:128
ds_read_b64_tr_b16 a[82:83], v237 offset:4736
ds_read_b64_tr_b16 a[84:85], v237 offset:136
ds_read_b64_tr_b16 a[86:87], v237 offset:4744
ds_read_b64_tr_b16 a[88:89], v238 offset:128
ds_read_b64_tr_b16 a[90:91], v238 offset:4736
s_waitcnt lgkmcnt(14)
v_or_b32 v108, v108, v109
v_or3_b32 v108, v108, v110, v111
s_nop 0
v_readfirstlane_b32 s28, v108
s_cmp_gt_u32 s28, s43
s_cbranch_scc1 K_FALLBACK
s_waitcnt lgkmcnt(8)
v_mfma_f32_16x16x32_bf16 v[96:99], a[64:67], v[56:59], 0
ds_read_b64_tr_b16 a[92:93], v238 offset:136
ds_read_b64_tr_b16 a[94:95], v238 offset:4744
v_mfma_f32_16x16x32_bf16 v[88:91], a[64:67], v[40:43], 0
s_lshr_b32 s32, s35, 2
s_and_b32 s33, s35, 3
v_mfma_f32_16x16x32_bf16 v[80:83], a[64:67], v[24:27], 0
s_lshl_b32 s94, s36, 9
s_lshl_b32 s28, s32, 6
v_mfma_f32_16x16x32_bf16 v[72:75], a[64:67], v[8:11], 0
s_lshr_b32 s34, s32, 2
v_mfma_f32_16x16x32_bf16 v[76:79], a[68:71], v[8:11], 0
ds_read_b64_tr_b16 a[64:65], v239 offset:0
ds_read_b64_tr_b16 a[66:67], v239 offset:4608
v_mfma_f32_16x16x32_bf16 v[84:87], a[68:71], v[24:27], 0
s_add_u32 s94, s94, s28
s_lshl_b32 s28, s37, 4
v_mfma_f32_16x16x32_bf16 v[92:95], a[68:71], v[40:43], 0
s_add_u32 s94, s94, s28
s_add_u32 s94, s94, 0x248000
v_mfma_f32_16x16x32_bf16 v[100:103], a[68:71], v[56:59], 0
v_mov_b32 v231, 1
v_and_b32 v229, 7, v1
v_mfma_f32_16x16x32_bf16 v[128:131], a[72:75], v[56:59], 0
ds_read_b64_tr_b16 a[68:69], v237 offset:9216
ds_read_b64_tr_b16 a[70:71], v237 offset:13824
v_mfma_f32_16x16x32_bf16 v[120:123], a[72:75], v[40:43], 0
v_lshlrev_b32 v229, 2, v229
v_lshlrev_b32 v226, 3, v1
v_mfma_f32_16x16x32_bf16 v[112:115], a[72:75], v[24:27], 0
s_lshl2_add_u32 s29, s33, s94
v_mfma_f32_16x16x32_bf16 v[104:107], a[72:75], v[8:11], 0
s_waitcnt lgkmcnt(8)
v_mfma_f32_16x16x32_bf16 v[108:111], a[76:79], v[8:11], 0
ds_read_b64_tr_b16 a[72:73], v237 offset:9224
ds_read_b64_tr_b16 a[74:75], v237 offset:13832
v_mfma_f32_16x16x32_bf16 v[116:119], a[76:79], v[24:27], 0
v_mfma_f32_16x16x32_bf16 v[124:127], a[76:79], v[40:43], 0
v_mfma_f32_16x16x32_bf16 v[132:135], a[76:79], v[56:59], 0
v_mfma_f32_16x16x32_bf16 v[160:163], a[80:83], v[56:59], 0
ds_read_b64_tr_b16 a[76:77], v238 offset:9216
ds_read_b64_tr_b16 a[78:79], v238 offset:13824
v_mfma_f32_16x16x32_bf16 v[152:155], a[80:83], v[40:43], 0
v_mfma_f32_16x16x32_bf16 v[144:147], a[80:83], v[24:27], 0
v_mfma_f32_16x16x32_bf16 v[136:139], a[80:83], v[8:11], 0
v_mfma_f32_16x16x32_bf16 v[140:143], a[84:87], v[8:11], 0
ds_read_b64_tr_b16 a[80:81], v238 offset:9224
ds_read_b64_tr_b16 a[82:83], v238 offset:13832
v_mfma_f32_16x16x32_bf16 v[148:151], a[84:87], v[24:27], 0
s_waitcnt vmcnt(0)
buffer_store_dword v231, v254, s[20:23], s29 offen sc0 sc1
v_mfma_f32_16x16x32_bf16 v[156:159], a[84:87], v[40:43], 0
s_add_u32 s28, s35, 1
s_and_b32 s28, s28, 3
v_mfma_f32_16x16x32_bf16 v[164:167], a[84:87], v[56:59], 0
s_mul_i32 s28, s28, 36864
s_waitcnt lgkmcnt(8)
v_mfma_f32_16x16x32_bf16 v[192:195], a[88:91], v[56:59], 0
ds_read_b64_tr_b16 a[84:85], v237 offset:9344
ds_read_b64_tr_b16 a[86:87], v237 offset:13952
v_mfma_f32_16x16x32_bf16 v[184:187], a[88:91], v[40:43], 0
v_add_u32 v216, s28, v234
v_add_u32 v217, s28, v235
v_mfma_f32_16x16x32_bf16 v[176:179], a[88:91], v[24:27], 0
v_add_u32 v218, s28, v236
v_mfma_f32_16x16x32_bf16 v[168:171], a[88:91], v[8:11], 0
v_mfma_f32_16x16x32_bf16 v[172:175], a[92:95], v[8:11], 0
ds_read_b64_tr_b16 a[88:89], v237 offset:9352
ds_read_b64_tr_b16 a[90:91], v237 offset:13960
v_mfma_f32_16x16x32_bf16 v[180:183], a[92:95], v[24:27], 0
v_mfma_f32_16x16x32_bf16 v[188:191], a[92:95], v[40:43], 0
v_mfma_f32_16x16x32_bf16 v[196:199], a[92:95], v[56:59], 0
v_mfma_f32_16x16x32_bf16 v[212:215], a[64:67], v[56:59], 0
ds_read_b64_tr_b16 a[92:93], v238 offset:9344
ds_read_b64_tr_b16 a[94:95], v238 offset:13952
v_mfma_f32_16x16x32_bf16 v[208:211], a[64:67], v[40:43], 0
v_mfma_f32_16x16x32_bf16 v[204:207], a[64:67], v[24:27], 0
v_mfma_f32_16x16x32_bf16 v[200:203], a[64:67], v[8:11], 0
s_waitcnt lgkmcnt(8)
v_mfma_f32_16x16x32_bf16 v[72:75], a[68:71], v[12:15], v[72:75]
ds_read_b64_tr_b16 a[64:65], v238 offset:9352
ds_read_b64_tr_b16 a[66:67], v238 offset:13960
v_mfma_f32_16x16x32_bf16 v[80:83], a[68:71], v[28:31], v[80:83]
v_mfma_f32_16x16x32_bf16 v[88:91], a[68:71], v[44:47], v[88:91]
v_mfma_f32_16x16x32_bf16 v[96:99], a[68:71], v[60:63], v[96:99]
v_mfma_f32_16x16x32_bf16 v[100:103], a[72:75], v[60:63], v[100:103]
ds_read_b64_tr_b16 a[68:69], v239 offset:9216
ds_read_b64_tr_b16 a[70:71], v239 offset:13824
v_mfma_f32_16x16x32_bf16 v[92:95], a[72:75], v[44:47], v[92:95]
buffer_load_dword v230, v229, s[20:23], s94 offen sc0 sc1
v_mfma_f32_16x16x32_bf16 v[84:87], a[72:75], v[28:31], v[84:87]
s_add_u32 s39, s35, 1
s_and_b32 s39, s39, 3
v_mfma_f32_16x16x32_bf16 v[76:79], a[72:75], v[12:15], v[76:79]
s_add_u32 s28, s33, 1
s_and_b32 s28, s28, 3
v_mfma_f32_16x16x32_bf16 v[104:107], a[76:79], v[12:15], v[104:107]
ds_read_b64_tr_b16 a[72:73], v237 offset:18432
ds_read_b64_tr_b16 a[74:75], v237 offset:23040
v_mfma_f32_16x16x32_bf16 v[112:115], a[76:79], v[28:31], v[112:115]
s_sub_u32 s28, s28, s33
s_lshl_b32 s28, s28, 16
v_mfma_f32_16x16x32_bf16 v[120:123], a[76:79], v[44:47], v[120:123]
s_add_u32 s64, s28, s44
s_add_u32 s65, s64, 4096
v_mfma_f32_16x16x32_bf16 v[128:131], a[76:79], v[60:63], v[128:131]
s_add_u32 s66, s64, 8192
s_add_u32 s67, s64, 12288
s_waitcnt lgkmcnt(8)
v_mfma_f32_16x16x32_bf16 v[132:135], a[80:83], v[60:63], v[132:135]
ds_read_b64_tr_b16 a[76:77], v237 offset:18440
ds_read_b64_tr_b16 a[78:79], v237 offset:23048
v_mfma_f32_16x16x32_bf16 v[124:127], a[80:83], v[44:47], v[124:127]
s_add_u32 s28, s35, 2
s_and_b32 s28, s28, 3
v_mfma_f32_16x16x32_bf16 v[116:119], a[80:83], v[28:31], v[116:119]
s_mul_i32 s28, s28, 36864
v_mfma_f32_16x16x32_bf16 v[108:111], a[80:83], v[12:15], v[108:111]
v_add_u32 v219, s28, v234
v_add_u32 v220, s28, v235
v_mfma_f32_16x16x32_bf16 v[136:139], a[84:87], v[12:15], v[136:139]
ds_read_b64_tr_b16 a[80:81], v238 offset:18432
ds_read_b64_tr_b16 a[82:83], v238 offset:23040
v_mfma_f32_16x16x32_bf16 v[144:147], a[84:87], v[28:31], v[144:147]
v_add_u32 v221, s28, v236
v_mfma_f32_16x16x32_bf16 v[152:155], a[84:87], v[44:47], v[152:155]
s_add_u32 s28, s35, 3
s_and_b32 s28, s28, 3
v_mfma_f32_16x16x32_bf16 v[160:163], a[84:87], v[60:63], v[160:163]
s_mul_i32 s28, s28, 36864
v_mfma_f32_16x16x32_bf16 v[164:167], a[88:91], v[60:63], v[164:167]
ds_read_b64_tr_b16 a[84:85], v238 offset:18440
ds_read_b64_tr_b16 a[86:87], v238 offset:23048
v_mfma_f32_16x16x32_bf16 v[156:159], a[88:91], v[44:47], v[156:159]
v_add_u32 v222, s28, v234
v_add_u32 v223, s28, v235
v_mfma_f32_16x16x32_bf16 v[148:151], a[88:91], v[28:31], v[148:151]
v_add_u32 v224, s28, v236
v_mfma_f32_16x16x32_bf16 v[140:143], a[88:91], v[12:15], v[140:143]
s_waitcnt lgkmcnt(8)
v_mfma_f32_16x16x32_bf16 v[168:171], a[92:95], v[12:15], v[168:171]
ds_read_b64_tr_b16 a[88:89], v237 offset:18560
ds_read_b64_tr_b16 a[90:91], v237 offset:23168
v_mfma_f32_16x16x32_bf16 v[176:179], a[92:95], v[28:31], v[176:179]
v_mfma_f32_16x16x32_bf16 v[184:187], a[92:95], v[44:47], v[184:187]
s_waitcnt vmcnt(0)
v_cmp_gt_u32 vcc, 1, v230
v_mfma_f32_16x16x32_bf16 v[192:195], a[92:95], v[60:63], v[192:195]
v_mfma_f32_16x16x32_bf16 v[196:199], a[64:67], v[60:63], v[196:199]
ds_read_b64_tr_b16 a[92:93], v237 offset:18568
ds_read_b64_tr_b16 a[94:95], v237 offset:23176
v_mfma_f32_16x16x32_bf16 v[188:191], a[64:67], v[44:47], v[188:191]
s_bitcmp1_b32 vcc_lo, s39
s_cbranch_scc1 SP_O1B
SP_O1B_RET:
v_mfma_f32_16x16x32_bf16 v[180:183], a[64:67], v[28:31], v[180:183]
buffer_load_dwordx4 a[128:131], v244, s[20:23], s64 offen offset:0 sc0 sc1
v_mfma_f32_16x16x32_bf16 v[172:175], a[64:67], v[12:15], v[172:175]
v_mfma_f32_16x16x32_bf16 v[200:203], a[68:71], v[12:15], v[200:203]
ds_read_b64_tr_b16 a[64:65], v238 offset:18560
ds_read_b64_tr_b16 a[66:67], v238 offset:23168
v_mfma_f32_16x16x32_bf16 v[204:207], a[68:71], v[28:31], v[204:207]
v_mfma_f32_16x16x32_bf16 v[208:211], a[68:71], v[44:47], v[208:211]
buffer_load_dwordx4 a[144:147], v244, s[20:23], s65 offen offset:0 sc0 sc1
v_mfma_f32_16x16x32_bf16 v[212:215], a[68:71], v[60:63], v[212:215]
s_waitcnt lgkmcnt(8)
v_mfma_f32_16x16x32_bf16 v[96:99], a[72:75], v[64:67], v[96:99]
ds_read_b64_tr_b16 a[68:69], v238 offset:18568
ds_read_b64_tr_b16 a[70:71], v238 offset:23176
v_mfma_f32_16x16x32_bf16 v[88:91], a[72:75], v[48:51], v[88:91]
v_mfma_f32_16x16x32_bf16 v[80:83], a[72:75], v[32:35], v[80:83]
buffer_load_dwordx4 a[160:163], v244, s[20:23], s66 offen offset:0 sc0 sc1
v_mfma_f32_16x16x32_bf16 v[72:75], a[72:75], v[16:19], v[72:75]
v_mfma_f32_16x16x32_bf16 v[76:79], a[76:79], v[16:19], v[76:79]
ds_read_b64_tr_b16 a[72:73], v239 offset:18432
ds_read_b64_tr_b16 a[74:75], v239 offset:23040
v_mfma_f32_16x16x32_bf16 v[84:87], a[76:79], v[32:35], v[84:87]
v_mfma_f32_16x16x32_bf16 v[92:95], a[76:79], v[48:51], v[92:95]
buffer_load_dwordx4 a[176:179], v244, s[20:23], s67 offen offset:0 sc0 sc1
v_mfma_f32_16x16x32_bf16 v[100:103], a[76:79], v[64:67], v[100:103]
v_mfma_f32_16x16x32_bf16 v[128:131], a[80:83], v[64:67], v[128:131]
ds_read_b64_tr_b16 a[76:77], v237 offset:27648
ds_read_b64_tr_b16 a[78:79], v237 offset:32256
v_mfma_f32_16x16x32_bf16 v[120:123], a[80:83], v[48:51], v[120:123]
v_mfma_f32_16x16x32_bf16 v[112:115], a[80:83], v[32:35], v[112:115]
buffer_load_dwordx4 a[132:135], v244, s[20:23], s64 offen offset:1024 sc0 sc1
v_mfma_f32_16x16x32_bf16 v[104:107], a[80:83], v[16:19], v[104:107]
s_waitcnt lgkmcnt(8)
v_mfma_f32_16x16x32_bf16 v[108:111], a[84:87], v[16:19], v[108:111]
ds_read_b64_tr_b16 a[80:81], v237 offset:27656
ds_read_b64_tr_b16 a[82:83], v237 offset:32264
v_mfma_f32_16x16x32_bf16 v[116:119], a[84:87], v[32:35], v[116:119]
v_mfma_f32_16x16x32_bf16 v[124:127], a[84:87], v[48:51], v[124:127]
buffer_load_dwordx4 a[148:151], v244, s[20:23], s65 offen offset:1024 sc0 sc1
v_mfma_f32_16x16x32_bf16 v[132:135], a[84:87], v[64:67], v[132:135]
v_mfma_f32_16x16x32_bf16 v[160:163], a[88:91], v[64:67], v[160:163]
ds_read_b64_tr_b16 a[84:85], v238 offset:27648
ds_read_b64_tr_b16 a[86:87], v238 offset:32256
v_mfma_f32_16x16x32_bf16 v[152:155], a[88:91], v[48:51], v[152:155]
v_mfma_f32_16x16x32_bf16 v[144:147], a[88:91], v[32:35], v[144:147]
buffer_load_dwordx4 a[164:167], v244, s[20:23], s66 offen offset:1024 sc0 sc1
v_mfma_f32_16x16x32_bf16 v[136:139], a[88:91], v[16:19], v[136:139]
v_mfma_f32_16x16x32_bf16 v[140:143], a[92:95], v[16:19], v[140:143]
ds_read_b64_tr_b16 a[88:89], v238 offset:27656
ds_read_b64_tr_b16 a[90:91], v238 offset:32264
v_mfma_f32_16x16x32_bf16 v[148:151], a[92:95], v[32:35], v[148:151]
v_mfma_f32_16x16x32_bf16 v[156:159], a[92:95], v[48:51], v[156:159]
buffer_load_dwordx4 a[180:183], v244, s[20:23], s67 offen offset:1024 sc0 sc1
v_mfma_f32_16x16x32_bf16 v[164:167], a[92:95], v[64:67], v[164:167]
s_waitcnt lgkmcnt(8)
v_mfma_f32_16x16x32_bf16 v[192:195], a[64:67], v[64:67], v[192:195]
ds_read_b64_tr_b16 a[92:93], v237 offset:27776
ds_read_b64_tr_b16 a[94:95], v237 offset:32384
v_mfma_f32_16x16x32_bf16 v[184:187], a[64:67], v[48:51], v[184:187]
v_mfma_f32_16x16x32_bf16 v[176:179], a[64:67], v[32:35], v[176:179]
buffer_load_dwordx4 a[136:139], v244, s[20:23], s64 offen offset:2048 sc0 sc1
v_mfma_f32_16x16x32_bf16 v[168:171], a[64:67], v[16:19], v[168:171]
buffer_load_dword v230, v229, s[20:23], s94 offen sc0 sc1
v_mfma_f32_16x16x32_bf16 v[172:175], a[68:71], v[16:19], v[172:175]
ds_read_b64_tr_b16 a[64:65], v237 offset:27784
ds_read_b64_tr_b16 a[66:67], v237 offset:32392
v_mfma_f32_16x16x32_bf16 v[180:183], a[68:71], v[32:35], v[180:183]
v_mfma_f32_16x16x32_bf16 v[188:191], a[68:71], v[48:51], v[188:191]
v_mfma_f32_16x16x32_bf16 v[196:199], a[68:71], v[64:67], v[196:199]
buffer_load_dwordx4 a[152:155], v244, s[20:23], s65 offen offset:2048 sc0 sc1
v_mfma_f32_16x16x32_bf16 v[212:215], a[72:75], v[64:67], v[212:215]
ds_read_b64_tr_b16 a[68:69], v238 offset:27776
ds_read_b64_tr_b16 a[70:71], v238 offset:32384
v_mfma_f32_16x16x32_bf16 v[208:211], a[72:75], v[48:51], v[208:211]
v_mfma_f32_16x16x32_bf16 v[204:207], a[72:75], v[32:35], v[204:207]
v_mfma_f32_16x16x32_bf16 v[200:203], a[72:75], v[16:19], v[200:203]
buffer_load_dwordx4 a[168:171], v244, s[20:23], s66 offen offset:2048 sc0 sc1
s_waitcnt lgkmcnt(8)
v_mfma_f32_16x16x32_bf16 v[72:75], a[76:79], v[20:23], v[72:75]
ds_read_b64_tr_b16 a[72:73], v238 offset:27784
ds_read_b64_tr_b16 a[74:75], v238 offset:32392
v_mfma_f32_16x16x32_bf16 v[80:83], a[76:79], v[36:39], v[80:83]
v_mfma_f32_16x16x32_bf16 v[88:91], a[76:79], v[52:55], v[88:91]
v_mfma_f32_16x16x32_bf16 v[96:99], a[76:79], v[68:71], v[96:99]
buffer_load_dwordx4 a[184:187], v244, s[20:23], s67 offen offset:2048 sc0 sc1
v_mfma_f32_16x16x32_bf16 v[100:103], a[80:83], v[68:71], v[100:103]
ds_read_b64_tr_b16 a[76:77], v239 offset:27648
ds_read_b64_tr_b16 a[78:79], v239 offset:32256
v_mfma_f32_16x16x32_bf16 v[92:95], a[80:83], v[52:55], v[92:95]
v_mfma_f32_16x16x32_bf16 v[84:87], a[80:83], v[36:39], v[84:87]
v_mfma_f32_16x16x32_bf16 v[76:79], a[80:83], v[20:23], v[76:79]
buffer_load_dwordx4 a[140:143], v244, s[20:23], s64 offen offset:3072 sc0 sc1
v_mfma_f32_16x16x32_bf16 v[104:107], a[84:87], v[20:23], v[104:107]
ds_read_b64_tr_b16 a[80:81], v216 offset:0
ds_read_b64_tr_b16 a[82:83], v216 offset:4608
v_mfma_f32_16x16x32_bf16 v[112:115], a[84:87], v[36:39], v[112:115]
v_mfma_f32_16x16x32_bf16 v[120:123], a[84:87], v[52:55], v[120:123]
v_mfma_f32_16x16x32_bf16 v[128:131], a[84:87], v[68:71], v[128:131]
buffer_load_dwordx4 a[156:159], v244, s[20:23], s65 offen offset:3072 sc0 sc1
s_waitcnt lgkmcnt(8)
v_mfma_f32_16x16x32_bf16 v[132:135], a[88:91], v[68:71], v[132:135]
ds_read_b64_tr_b16 a[84:85], v216 offset:8
ds_read_b64_tr_b16 a[86:87], v216 offset:4616
v_mfma_f32_16x16x32_bf16 v[124:127], a[88:91], v[52:55], v[124:127]
v_mfma_f32_16x16x32_bf16 v[116:119], a[88:91], v[36:39], v[116:119]
v_mfma_f32_16x16x32_bf16 v[108:111], a[88:91], v[20:23], v[108:111]
buffer_load_dwordx4 a[172:175], v244, s[20:23], s66 offen offset:3072 sc0 sc1
v_mfma_f32_16x16x32_bf16 v[136:139], a[92:95], v[20:23], v[136:139]
ds_read_b64_tr_b16 a[88:89], v217 offset:0
ds_read_b64_tr_b16 a[90:91], v217 offset:4608
v_mfma_f32_16x16x32_bf16 v[144:147], a[92:95], v[36:39], v[144:147]
v_mfma_f32_16x16x32_bf16 v[152:155], a[92:95], v[52:55], v[152:155]
v_mfma_f32_16x16x32_bf16 v[160:163], a[92:95], v[68:71], v[160:163]
buffer_load_dwordx4 a[188:191], v244, s[20:23], s67 offen offset:3072 sc0 sc1
v_mfma_f32_16x16x32_bf16 v[164:167], a[64:67], v[68:71], v[164:167]
ds_read_b64_tr_b16 a[92:93], v217 offset:8
ds_read_b64_tr_b16 a[94:95], v217 offset:4616
v_mfma_f32_16x16x32_bf16 v[156:159], a[64:67], v[52:55], v[156:159]
s_add_u32 s28, s33, 2
s_and_b32 s28, s28, 3
v_mfma_f32_16x16x32_bf16 v[148:151], a[64:67], v[36:39], v[148:151]
s_sub_u32 s28, s28, s33
s_lshl_b32 s28, s28, 16
v_mfma_f32_16x16x32_bf16 v[140:143], a[64:67], v[20:23], v[140:143]
s_add_u32 s64, s28, s44
s_add_u32 s65, s64, 4096
s_waitcnt lgkmcnt(8)
v_mfma_f32_16x16x32_bf16 v[168:171], a[68:71], v[20:23], v[168:171]
ds_read_b64_tr_b16 a[64:65], v216 offset:128
ds_read_b64_tr_b16 a[66:67], v216 offset:4736
v_mfma_f32_16x16x32_bf16 v[176:179], a[68:71], v[36:39], v[176:179]
s_add_u32 s66, s64, 8192
s_add_u32 s67, s64, 12288
v_mfma_f32_16x16x32_bf16 v[184:187], a[68:71], v[52:55], v[184:187]
s_waitcnt vmcnt(7)
v_cmp_gt_u32 vcc, 1, v230
v_mfma_f32_16x16x32_bf16 v[192:195], a[68:71], v[68:71], v[192:195]
v_mfma_f32_16x16x32_bf16 v[196:199], a[72:75], v[68:71], v[196:199]
ds_read_b64_tr_b16 a[68:69], v216 offset:136
ds_read_b64_tr_b16 a[70:71], v216 offset:4744
v_mfma_f32_16x16x32_bf16 v[188:191], a[72:75], v[52:55], v[188:191]
s_and_b32 s29, vcc_lo, 15
s_cbranch_scc1 SP_O2B
SP_O2B_RET:
v_mfma_f32_16x16x32_bf16 v[180:183], a[72:75], v[36:39], v[180:183]
buffer_load_dwordx4 a[192:195], v244, s[20:23], s64 offen offset:0 sc0 sc1
v_mfma_f32_16x16x32_bf16 v[172:175], a[72:75], v[20:23], v[172:175]
v_mfma_f32_16x16x32_bf16 v[200:203], a[76:79], v[20:23], v[200:203]
ds_read_b64_tr_b16 a[72:73], v217 offset:128
ds_read_b64_tr_b16 a[74:75], v217 offset:4736
v_mfma_f32_16x16x32_bf16 v[204:207], a[76:79], v[36:39], v[204:207]
v_mfma_f32_16x16x32_bf16 v[208:211], a[76:79], v[52:55], v[208:211]
buffer_load_dwordx4 a[208:211], v244, s[20:23], s65 offen offset:0 sc0 sc1
v_mfma_f32_16x16x32_bf16 v[212:215], a[76:79], v[68:71], v[212:215]
s_waitcnt vmcnt(15)
s_waitcnt lgkmcnt(8)
v_mfma_f32_16x16x32_bf16 v[96:99], a[80:83], a[176:179], v[96:99]
ds_read_b64_tr_b16 a[76:77], v217 offset:136
ds_read_b64_tr_b16 a[78:79], v217 offset:4744
v_mfma_f32_16x16x32_bf16 v[88:91], a[80:83], a[160:163], v[88:91]
v_mfma_f32_16x16x32_bf16 v[80:83], a[80:83], a[144:147], v[80:83]
buffer_load_dwordx4 a[96:99], v244, s[20:23], s66 offen offset:0 sc0 sc1
v_mfma_f32_16x16x32_bf16 v[72:75], a[80:83], a[128:131], v[72:75]
v_accvgpr_read_b32 v39, a222
v_accvgpr_read_b32 v59, a232
v_mfma_f32_16x16x32_bf16 v[76:79], a[84:87], a[128:131], v[76:79]
ds_read_b64_tr_b16 a[80:81], v218 offset:0
ds_read_b64_tr_b16 a[82:83], v218 offset:4608
v_mfma_f32_16x16x32_bf16 v[84:87], a[84:87], a[144:147], v[84:87]
v_lshlrev_b32 v38, 16, v39
v_and_b32 v39, 0xffff0000, v39
v_mfma_f32_16x16x32_bf16 v[92:95], a[84:87], a[160:163], v[92:95]
buffer_load_dwordx4 a[112:115], v244, s[20:23], s67 offen offset:0 sc0 sc1
v_mfma_f32_16x16x32_bf16 v[100:103], a[84:87], a[176:179], v[100:103]
v_lshlrev_b32 v58, 16, v59
v_and_b32 v59, 0xffff0000, v59
v_mfma_f32_16x16x32_bf16 v[128:131], a[88:91], a[176:179], v[128:131]
ds_read_b64_tr_b16 a[84:85], v216 offset:9216
ds_read_b64_tr_b16 a[86:87], v216 offset:13824
v_mfma_f32_16x16x32_bf16 v[120:123], a[88:91], a[160:163], v[120:123]
v_add_f32 v38, v38, v58
v_add_f32 v39, v39, v59
v_mfma_f32_16x16x32_bf16 v[112:115], a[88:91], a[144:147], v[112:115]
buffer_load_dwordx4 a[196:199], v244, s[20:23], s64 offen offset:1024 sc0 sc1
v_mfma_f32_16x16x32_bf16 v[104:107], a[88:91], a[128:131], v[104:107]
v_cvt_pk_bf16_f32 v58, v38, v39
v_lshlrev_b32 v38, 16, v58
s_waitcnt lgkmcnt(8)
v_mfma_f32_16x16x32_bf16 v[108:111], a[92:95], a[128:131], v[108:111]
ds_read_b64_tr_b16 a[88:89], v216 offset:9224
ds_read_b64_tr_b16 a[90:91], v216 offset:13832
v_mfma_f32_16x16x32_bf16 v[116:119], a[92:95], a[144:147], v[116:119]
v_and_b32 v39, 0xffff0000, v58
v_mul_f32 v58, 0xbfb8aa3b, v38
v_mfma_f32_16x16x32_bf16 v[124:127], a[92:95], a[160:163], v[124:127]
buffer_load_dwordx4 a[244:247], v244, s[20:23], s65 offen offset:1024 sc0 sc1
v_mfma_f32_16x16x32_bf16 v[132:135], a[92:95], a[176:179], v[132:135]
v_mul_f32 v59, 0xbfb8aa3b, v39
v_mfma_f32_16x16x32_bf16 v[160:163], a[64:67], a[176:179], v[160:163]
ds_read_b64_tr_b16 a[92:93], v217 offset:9216
ds_read_b64_tr_b16 a[94:95], v217 offset:13824
v_mfma_f32_16x16x32_bf16 v[152:155], a[64:67], a[160:163], v[152:155]
v_exp_f32 v58, v58
v_mfma_f32_16x16x32_bf16 v[144:147], a[64:67], a[144:147], v[144:147]
buffer_load_dwordx4 a[100:103], v244, s[20:23], s66 offen offset:1024 sc0 sc1
v_mfma_f32_16x16x32_bf16 v[136:139], a[64:67], a[128:131], v[136:139]
v_exp_f32 v59, v59
v_mfma_f32_16x16x32_bf16 v[140:143], a[68:71], a[128:131], v[140:143]
ds_read_b64_tr_b16 a[64:65], v217 offset:9224
ds_read_b64_tr_b16 a[66:67], v217 offset:13832
v_mfma_f32_16x16x32_bf16 v[148:151], a[68:71], a[144:147], v[148:151]
v_add_f32 v58, 1.0, v58
v_add_f32 v59, 1.0, v59
v_mfma_f32_16x16x32_bf16 v[156:159], a[68:71], a[160:163], v[156:159]
buffer_load_dwordx4 a[116:119], v244, s[20:23], s67 offen offset:1024 sc0 sc1
v_mfma_f32_16x16x32_bf16 v[164:167], a[68:71], a[176:179], v[164:167]
v_rcp_f32 v58, v58
s_waitcnt lgkmcnt(8)
v_mfma_f32_16x16x32_bf16 v[192:195], a[72:75], a[176:179], v[192:195]
ds_read_b64_tr_b16 a[68:69], v216 offset:9344
ds_read_b64_tr_b16 a[70:71], v216 offset:13952
v_mfma_f32_16x16x32_bf16 v[184:187], a[72:75], a[160:163], v[184:187]
v_rcp_f32 v59, v59
v_mfma_f32_16x16x32_bf16 v[176:179], a[72:75], a[144:147], v[176:179]
buffer_load_dwordx4 a[200:203], v244, s[20:23], s64 offen offset:2048 sc0 sc1
v_mfma_f32_16x16x32_bf16 v[168:171], a[72:75], a[128:131], v[168:171]
v_mul_f32 v38, v38, v58
v_mul_f32 v39, v39, v59
v_mfma_f32_16x16x32_bf16 v[172:175], a[76:79], a[128:131], v[172:175]
ds_read_b64_tr_b16 a[72:73], v216 offset:9352
ds_read_b64_tr_b16 a[74:75], v216 offset:13960
v_mfma_f32_16x16x32_bf16 v[180:183], a[76:79], a[144:147], v[180:183]
v_cvt_pk_bf16_f32 v58, v38, v39
v_lshlrev_b32 v38, 16, v58
v_mfma_f32_16x16x32_bf16 v[188:191], a[76:79], a[160:163], v[188:191]
buffer_load_dwordx4 a[248:251], v244, s[20:23], s65 offen offset:2048 sc0 sc1
v_mfma_f32_16x16x32_bf16 v[196:199], a[76:79], a[176:179], v[196:199]
v_and_b32 v39, 0xffff0000, v58
v_accvgpr_read_b32 v41, a223
v_mfma_f32_16x16x32_bf16 v[212:215], a[80:83], a[176:179], v[212:215]
ds_read_b64_tr_b16 a[76:77], v217 offset:9344
ds_read_b64_tr_b16 a[78:79], v217 offset:13952
v_mfma_f32_16x16x32_bf16 v[208:211], a[80:83], a[160:163], v[208:211]
v_accvgpr_read_b32 v59, a233
v_lshlrev_b32 v40, 16, v41
v_mfma_f32_16x16x32_bf16 v[204:207], a[80:83], a[144:147], v[204:207]
buffer_load_dwordx4 a[104:107], v244, s[20:23], s66 offen offset:2048 sc0 sc1
v_mfma_f32_16x16x32_bf16 v[200:203], a[80:83], a[128:131], v[200:203]
v_and_b32 v41, 0xffff0000, v41
v_lshlrev_b32 v58, 16, v59
s_waitcnt vmcnt(20)
s_waitcnt lgkmcnt(8)
v_mfma_f32_16x16x32_bf16 v[72:75], a[84:87], a[132:135], v[72:75]
ds_read_b64_tr_b16 a[80:81], v217 offset:9352
ds_read_b64_tr_b16 a[82:83], v217 offset:13960
v_mfma_f32_16x16x32_bf16 v[80:83], a[84:87], a[148:151], v[80:83]
v_and_b32 v59, 0xffff0000, v59
v_add_f32 v40, v40, v58
v_mfma_f32_16x16x32_bf16 v[88:91], a[84:87], a[164:167], v[88:91]
buffer_load_dwordx4 a[120:123], v244, s[20:23], s67 offen offset:2048 sc0 sc1
v_mfma_f32_16x16x32_bf16 v[96:99], a[84:87], a[180:183], v[96:99]
v_add_f32 v41, v41, v59
v_cvt_pk_bf16_f32 v58, v40, v41
v_mfma_f32_16x16x32_bf16 v[100:103], a[88:91], a[180:183], v[100:103]
ds_read_b64_tr_b16 a[84:85], v218 offset:9216
ds_read_b64_tr_b16 a[86:87], v218 offset:13824
v_mfma_f32_16x16x32_bf16 v[92:95], a[88:91], a[164:167], v[92:95]
v_lshlrev_b32 v40, 16, v58
v_and_b32 v41, 0xffff0000, v58
v_mfma_f32_16x16x32_bf16 v[84:87], a[88:91], a[148:151], v[84:87]
buffer_load_dwordx4 a[204:207], v244, s[20:23], s64 offen offset:3072 sc0 sc1
v_mfma_f32_16x16x32_bf16 v[76:79], a[88:91], a[132:135], v[76:79]
v_mul_f32 v58, 0xbfb8aa3b, v40
v_mul_f32 v59, 0xbfb8aa3b, v41
v_mfma_f32_16x16x32_bf16 v[104:107], a[92:95], a[132:135], v[104:107]
ds_read_b64_tr_b16 a[88:89], v216 offset:18432
ds_read_b64_tr_b16 a[90:91], v216 offset:23040
v_mfma_f32_16x16x32_bf16 v[112:115], a[92:95], a[148:151], v[112:115]
v_exp_f32 v58, v58
v_mfma_f32_16x16x32_bf16 v[120:123], a[92:95], a[164:167], v[120:123]
buffer_load_dwordx4 a[252:255], v244, s[20:23], s65 offen offset:3072 sc0 sc1
v_mfma_f32_16x16x32_bf16 v[128:131], a[92:95], a[180:183], v[128:131]
v_exp_f32 v59, v59
s_waitcnt lgkmcnt(8)
v_mfma_f32_16x16x32_bf16 v[132:135], a[64:67], a[180:183], v[132:135]
ds_read_b64_tr_b16 a[92:93], v216 offset:18440
ds_read_b64_tr_b16 a[94:95], v216 offset:23048
v_mfma_f32_16x16x32_bf16 v[124:127], a[64:67], a[164:167], v[124:127]
v_add_f32 v58, 1.0, v58
v_add_f32 v59, 1.0, v59
v_mfma_f32_16x16x32_bf16 v[116:119], a[64:67], a[148:151], v[116:119]
buffer_load_dwordx4 a[108:111], v244, s[20:23], s66 offen offset:3072 sc0 sc1
v_mfma_f32_16x16x32_bf16 v[108:111], a[64:67], a[132:135], v[108:111]
v_rcp_f32 v58, v58
v_mfma_f32_16x16x32_bf16 v[136:139], a[68:71], a[132:135], v[136:139]
ds_read_b64_tr_b16 a[64:65], v217 offset:18432
ds_read_b64_tr_b16 a[66:67], v217 offset:23040
v_mfma_f32_16x16x32_bf16 v[144:147], a[68:71], a[148:151], v[144:147]
v_rcp_f32 v59, v59
v_mfma_f32_16x16x32_bf16 v[152:155], a[68:71], a[164:167], v[152:155]
buffer_load_dwordx4 a[124:127], v244, s[20:23], s67 offen offset:3072 sc0 sc1
v_mfma_f32_16x16x32_bf16 v[160:163], a[68:71], a[180:183], v[160:163]
s_add_u32 s28, s33, 3
s_and_b32 s28, s28, 3
v_mfma_f32_16x16x32_bf16 v[164:167], a[72:75], a[180:183], v[164:167]
ds_read_b64_tr_b16 a[68:69], v217 offset:18440
ds_read_b64_tr_b16 a[70:71], v217 offset:23048
v_mfma_f32_16x16x32_bf16 v[156:159], a[72:75], a[164:167], v[156:159]
s_sub_u32 s28, s28, s33
s_lshl_b32 s28, s28, 16
v_mfma_f32_16x16x32_bf16 v[148:151], a[72:75], a[148:151], v[148:151]
s_add_u32 s64, s28, s44
s_add_u32 s65, s64, 4096
v_mfma_f32_16x16x32_bf16 v[140:143], a[72:75], a[132:135], v[140:143]
s_add_u32 s66, s64, 8192
s_add_u32 s67, s64, 12288
s_waitcnt lgkmcnt(8)
v_mfma_f32_16x16x32_bf16 v[168:171], a[76:79], a[132:135], v[168:171]
ds_read_b64_tr_b16 a[72:73], v216 offset:18560
ds_read_b64_tr_b16 a[74:75], v216 offset:23168
v_mfma_f32_16x16x32_bf16 v[176:179], a[76:79], a[148:151], v[176:179]
buffer_load_dwordx4 a[0:3], v244, s[20:23], s64 offen offset:0 sc0 sc1
v_mfma_f32_16x16x32_bf16 v[184:187], a[76:79], a[164:167], v[184:187]
v_mul_f32 v40, v40, v58
v_mul_f32 v41, v41, v59
v_mfma_f32_16x16x32_bf16 v[192:195], a[76:79], a[180:183], v[192:195]
v_cvt_pk_bf16_f32 v58, v40, v41
v_lshlrev_b32 v40, 16, v58
v_mfma_f32_16x16x32_bf16 v[196:199], a[80:83], a[180:183], v[196:199]
ds_read_b64_tr_b16 a[76:77], v216 offset:18568
ds_read_b64_tr_b16 a[78:79], v216 offset:23176
v_mfma_f32_16x16x32_bf16 v[188:191], a[80:83], a[164:167], v[188:191]
buffer_load_dwordx4 a[16:19], v244, s[20:23], s65 offen offset:0 sc0 sc1
v_mfma_f32_16x16x32_bf16 v[180:183], a[80:83], a[148:151], v[180:183]
v_and_b32 v41, 0xffff0000, v58
v_accvgpr_read_b32 v43, a224
v_mfma_f32_16x16x32_bf16 v[172:175], a[80:83], a[132:135], v[172:175]
v_accvgpr_read_b32 v59, a234
v_lshlrev_b32 v42, 16, v43
v_mfma_f32_16x16x32_bf16 v[200:203], a[84:87], a[132:135], v[200:203]
ds_read_b64_tr_b16 a[80:81], v217 offset:18560
ds_read_b64_tr_b16 a[82:83], v217 offset:23168
v_mfma_f32_16x16x32_bf16 v[204:207], a[84:87], a[148:151], v[204:207]
buffer_load_dwordx4 a[32:35], v244, s[20:23], s66 offen offset:0 sc0 sc1
v_mfma_f32_16x16x32_bf16 v[208:211], a[84:87], a[164:167], v[208:211]
v_and_b32 v43, 0xffff0000, v43
v_lshlrev_b32 v58, 16, v59
v_mfma_f32_16x16x32_bf16 v[212:215], a[84:87], a[180:183], v[212:215]
v_and_b32 v59, 0xffff0000, v59
v_add_f32 v42, v42, v58
s_waitcnt vmcnt(23)
s_waitcnt lgkmcnt(8)
v_mfma_f32_16x16x32_bf16 v[96:99], a[88:91], a[184:187], v[96:99]
ds_read_b64_tr_b16 a[84:85], v217 offset:18568
ds_read_b64_tr_b16 a[86:87], v217 offset:23176
v_mfma_f32_16x16x32_bf16 v[88:91], a[88:91], a[168:171], v[88:91]
buffer_load_dwordx4 a[48:51], v244, s[20:23], s67 offen offset:0 sc0 sc1
v_mfma_f32_16x16x32_bf16 v[80:83], a[88:91], a[152:155], v[80:83]
v_add_f32 v43, v43, v59
v_cvt_pk_bf16_f32 v58, v42, v43
v_mfma_f32_16x16x32_bf16 v[72:75], a[88:91], a[136:139], v[72:75]
v_lshlrev_b32 v42, 16, v58
v_and_b32 v43, 0xffff0000, v58
v_mfma_f32_16x16x32_bf16 v[76:79], a[92:95], a[136:139], v[76:79]
ds_read_b64_tr_b16 a[88:89], v218 offset:18432
ds_read_b64_tr_b16 a[90:91], v218 offset:23040
v_mfma_f32_16x16x32_bf16 v[84:87], a[92:95], a[152:155], v[84:87]
buffer_load_dwordx4 a[4:7], v244, s[20:23], s64 offen offset:1024 sc0 sc1
v_mfma_f32_16x16x32_bf16 v[92:95], a[92:95], a[168:171], v[92:95]
v_mul_f32 v58, 0xbfb8aa3b, v42
v_mul_f32 v59, 0xbfb8aa3b, v43
v_mfma_f32_16x16x32_bf16 v[100:103], a[92:95], a[184:187], v[100:103]
v_exp_f32 v58, v58
v_mfma_f32_16x16x32_bf16 v[128:131], a[64:67], a[184:187], v[128:131]
ds_read_b64_tr_b16 a[92:93], v216 offset:27648
ds_read_b64_tr_b16 a[94:95], v216 offset:32256
v_mfma_f32_16x16x32_bf16 v[120:123], a[64:67], a[168:171], v[120:123]
buffer_load_dwordx4 a[20:23], v244, s[20:23], s65 offen offset:1024 sc0 sc1
v_mfma_f32_16x16x32_bf16 v[112:115], a[64:67], a[152:155], v[112:115]
v_exp_f32 v59, v59
v_mfma_f32_16x16x32_bf16 v[104:107], a[64:67], a[136:139], v[104:107]
v_add_f32 v58, 1.0, v58
v_add_f32 v59, 1.0, v59
s_waitcnt lgkmcnt(8)
v_mfma_f32_16x16x32_bf16 v[108:111], a[68:71], a[136:139], v[108:111]
ds_read_b64_tr_b16 a[64:65], v216 offset:27656
ds_read_b64_tr_b16 a[66:67], v216 offset:32264
v_mfma_f32_16x16x32_bf16 v[116:119], a[68:71], a[152:155], v[116:119]
buffer_load_dwordx4 a[36:39], v244, s[20:23], s66 offen offset:1024 sc0 sc1
v_mfma_f32_16x16x32_bf16 v[124:127], a[68:71], a[168:171], v[124:127]
v_rcp_f32 v58, v58
v_mfma_f32_16x16x32_bf16 v[132:135], a[68:71], a[184:187], v[132:135]
v_rcp_f32 v59, v59
v_mfma_f32_16x16x32_bf16 v[160:163], a[72:75], a[184:187], v[160:163]
ds_read_b64_tr_b16 a[68:69], v217 offset:27648
ds_read_b64_tr_b16 a[70:71], v217 offset:32256
v_mfma_f32_16x16x32_bf16 v[152:155], a[72:75], a[168:171], v[152:155]
buffer_load_dwordx4 a[52:55], v244, s[20:23], s67 offen offset:1024 sc0 sc1
v_mfma_f32_16x16x32_bf16 v[144:147], a[72:75], a[152:155], v[144:147]
v_mul_f32 v42, v42, v58
v_mul_f32 v43, v43, v59
v_mfma_f32_16x16x32_bf16 v[136:139], a[72:75], a[136:139], v[136:139]
v_cvt_pk_bf16_f32 v58, v42, v43
v_lshlrev_b32 v42, 16, v58
v_mfma_f32_16x16x32_bf16 v[140:143], a[76:79], a[136:139], v[140:143]
ds_read_b64_tr_b16 a[72:73], v217 offset:27656
ds_read_b64_tr_b16 a[74:75], v217 offset:32264
v_mfma_f32_16x16x32_bf16 v[148:151], a[76:79], a[152:155], v[148:151]
buffer_load_dwordx4 a[8:11], v244, s[20:23], s64 offen offset:2048 sc0 sc1
v_mfma_f32_16x16x32_bf16 v[156:159], a[76:79], a[168:171], v[156:159]
v_and_b32 v43, 0xffff0000, v58
v_accvgpr_read_b32 v45, a225
v_mfma_f32_16x16x32_bf16 v[164:167], a[76:79], a[184:187], v[164:167]
v_accvgpr_read_b32 v59, a235
v_lshlrev_b32 v44, 16, v45
s_waitcnt lgkmcnt(8)
v_mfma_f32_16x16x32_bf16 v[192:195], a[80:83], a[184:187], v[192:195]
ds_read_b64_tr_b16 a[76:77], v216 offset:27776
ds_read_b64_tr_b16 a[78:79], v216 offset:32384
v_mfma_f32_16x16x32_bf16 v[184:187], a[80:83], a[168:171], v[184:187]
buffer_load_dwordx4 a[24:27], v244, s[20:23], s65 offen offset:2048 sc0 sc1
v_mfma_f32_16x16x32_bf16 v[176:179], a[80:83], a[152:155], v[176:179]
v_and_b32 v45, 0xffff0000, v45
v_lshlrev_b32 v58, 16, v59
v_mfma_f32_16x16x32_bf16 v[168:171], a[80:83], a[136:139], v[168:171]
v_and_b32 v59, 0xffff0000, v59
v_add_f32 v44, v44, v58
v_mfma_f32_16x16x32_bf16 v[172:175], a[84:87], a[136:139], v[172:175]
ds_read_b64_tr_b16 a[80:81], v216 offset:27784
ds_read_b64_tr_b16 a[82:83], v216 offset:32392
v_mfma_f32_16x16x32_bf16 v[180:183], a[84:87], a[152:155], v[180:183]
buffer_load_dwordx4 a[40:43], v244, s[20:23], s66 offen offset:2048 sc0 sc1
v_mfma_f32_16x16x32_bf16 v[188:191], a[84:87], a[168:171], v[188:191]
v_add_f32 v45, v45, v59
v_cvt_pk_bf16_f32 v58, v44, v45
v_mfma_f32_16x16x32_bf16 v[196:199], a[84:87], a[184:187], v[196:199]
v_lshlrev_b32 v44, 16, v58
v_and_b32 v45, 0xffff0000, v58
v_mfma_f32_16x16x32_bf16 v[212:215], a[88:91], a[184:187], v[212:215]
ds_read_b64_tr_b16 a[84:85], v217 offset:27776
ds_read_b64_tr_b16 a[86:87], v217 offset:32384
v_mfma_f32_16x16x32_bf16 v[208:211], a[88:91], a[168:171], v[208:211]
buffer_load_dwordx4 a[56:59], v244, s[20:23], s67 offen offset:2048 sc0 sc1
v_mfma_f32_16x16x32_bf16 v[204:207], a[88:91], a[152:155], v[204:207]
v_mul_f32 v58, 0xbfb8aa3b, v44
v_mul_f32 v59, 0xbfb8aa3b, v45
v_mfma_f32_16x16x32_bf16 v[200:203], a[88:91], a[136:139], v[200:203]
v_exp_f32 v58, v58
s_waitcnt vmcnt(28)
s_waitcnt lgkmcnt(8)
v_mfma_f32_16x16x32_bf16 v[72:75], a[92:95], a[140:143], v[72:75]
ds_read_b64_tr_b16 a[88:89], v217 offset:27784
ds_read_b64_tr_b16 a[90:91], v217 offset:32392
v_mfma_f32_16x16x32_bf16 v[80:83], a[92:95], a[156:159], v[80:83]
buffer_load_dwordx4 a[12:15], v244, s[20:23], s64 offen offset:3072 sc0 sc1
v_mfma_f32_16x16x32_bf16 v[88:91], a[92:95], a[172:175], v[88:91]
v_exp_f32 v59, v59
v_mfma_f32_16x16x32_bf16 v[96:99], a[92:95], a[188:191], v[96:99]
v_add_f32 v58, 1.0, v58
v_add_f32 v59, 1.0, v59
v_mfma_f32_16x16x32_bf16 v[100:103], a[64:67], a[188:191], v[100:103]
ds_read_b64_tr_b16 a[92:93], v218 offset:27648
ds_read_b64_tr_b16 a[94:95], v218 offset:32256
v_mfma_f32_16x16x32_bf16 v[92:95], a[64:67], a[172:175], v[92:95]
buffer_load_dwordx4 a[28:31], v244, s[20:23], s65 offen offset:3072 sc0 sc1
v_mfma_f32_16x16x32_bf16 v[84:87], a[64:67], a[156:159], v[84:87]
v_rcp_f32 v58, v58
v_mfma_f32_16x16x32_bf16 v[76:79], a[64:67], a[140:143], v[76:79]
v_rcp_f32 v59, v59
v_mfma_f32_16x16x32_bf16 v[104:107], a[68:71], a[140:143], v[104:107]
ds_read_b64_tr_b16 a[64:65], v221 offset:0
ds_read_b64_tr_b16 a[66:67], v221 offset:4608
v_mfma_f32_16x16x32_bf16 v[112:115], a[68:71], a[156:159], v[112:115]
buffer_load_dwordx4 a[44:47], v244, s[20:23], s66 offen offset:3072 sc0 sc1
v_mfma_f32_16x16x32_bf16 v[120:123], a[68:71], a[172:175], v[120:123]
v_mul_f32 v44, v44, v58
v_mul_f32 v45, v45, v59
v_mfma_f32_16x16x32_bf16 v[128:131], a[68:71], a[188:191], v[128:131]
v_cvt_pk_bf16_f32 v58, v44, v45
v_lshlrev_b32 v44, 16, v58
s_waitcnt lgkmcnt(8)
v_mfma_f32_16x16x32_bf16 v[132:135], a[72:75], a[188:191], v[132:135]
ds_read_b64_tr_b16 a[68:69], v221 offset:9216
ds_read_b64_tr_b16 a[70:71], v221 offset:13824
v_mfma_f32_16x16x32_bf16 v[124:127], a[72:75], a[172:175], v[124:127]
buffer_load_dwordx4 a[60:63], v244, s[20:23], s67 offen offset:3072 sc0 sc1
v_mfma_f32_16x16x32_bf16 v[116:119], a[72:75], a[156:159], v[116:119]
s_lshl2_add_u32 s28, s36, s33
s_lshl2_add_u32 s28, s28, s37
v_mfma_f32_16x16x32_bf16 v[108:111], a[72:75], a[140:143], v[108:111]
s_lshl_b32 s95, s28, 5
s_add_u32 s95, s95, 0x24a000
v_mfma_f32_16x16x32_bf16 v[136:139], a[76:79], a[140:143], v[136:139]
ds_read_b64_tr_b16 a[72:73], v221 offset:18432
ds_read_b64_tr_b16 a[74:75], v221 offset:23040
v_mfma_f32_16x16x32_bf16 v[144:147], a[76:79], a[156:159], v[144:147]
s_lshl_b32 s28, s32, 18
s_sub_u32 s49, s44, s28
v_mfma_f32_16x16x32_bf16 v[152:155], a[76:79], a[172:175], v[152:155]
v_add_u32 v243, 0x2000, v244
v_mov_b32 v246, 2
v_mfma_f32_16x16x32_bf16 v[160:163], a[76:79], a[188:191], v[160:163]
s_lshl2_add_u32 s29, s33, s94
v_and_b32 v45, 0xffff0000, v58
v_mfma_f32_16x16x32_bf16 v[164:167], a[80:83], a[188:191], v[164:167]
ds_read_b64_tr_b16 a[76:77], v221 offset:27648
ds_read_b64_tr_b16 a[78:79], v221 offset:32256
v_mfma_f32_16x16x32_bf16 v[156:159], a[80:83], a[172:175], v[156:159]
v_accvgpr_read_b32 v47, a226
v_accvgpr_read_b32 v59, a236
v_mfma_f32_16x16x32_bf16 v[148:151], a[80:83], a[156:159], v[148:151]
v_lshlrev_b32 v46, 16, v47
v_and_b32 v47, 0xffff0000, v47
v_mfma_f32_16x16x32_bf16 v[140:143], a[80:83], a[140:143], v[140:143]
v_lshlrev_b32 v58, 16, v59
v_and_b32 v59, 0xffff0000, v59
s_waitcnt lgkmcnt(8)
v_mfma_f32_16x16x32_bf16 v[168:171], a[84:87], a[140:143], v[168:171]
ds_read_b64_tr_b16 a[80:81], v224 offset:0
ds_read_b64_tr_b16 a[82:83], v224 offset:4608
v_mfma_f32_16x16x32_bf16 v[176:179], a[84:87], a[156:159], v[176:179]
v_add_f32 v46, v46, v58
v_add_f32 v47, v47, v59
v_mfma_f32_16x16x32_bf16 v[184:187], a[84:87], a[172:175], v[184:187]
v_cvt_pk_bf16_f32 v58, v46, v47
v_lshlrev_b32 v46, 16, v58
v_mfma_f32_16x16x32_bf16 v[192:195], a[84:87], a[188:191], v[192:195]
v_and_b32 v47, 0xffff0000, v58
v_mul_f32 v58, 0xbfb8aa3b, v46
v_mfma_f32_16x16x32_bf16 v[196:199], a[88:91], a[188:191], v[196:199]
ds_read_b64_tr_b16 a[84:85], v224 offset:9216
ds_read_b64_tr_b16 a[86:87], v224 offset:13824
v_mfma_f32_16x16x32_bf16 v[188:191], a[88:91], a[172:175], v[188:191]
v_mul_f32 v59, 0xbfb8aa3b, v47
v_mfma_f32_16x16x32_bf16 v[180:183], a[88:91], a[156:159], v[180:183]
v_exp_f32 v58, v58
v_mfma_f32_16x16x32_bf16 v[172:175], a[88:91], a[140:143], v[172:175]
v_exp_f32 v59, v59
v_mfma_f32_16x16x32_bf16 v[200:203], a[92:95], a[140:143], v[200:203]
ds_read_b64_tr_b16 a[88:89], v224 offset:18432
ds_read_b64_tr_b16 a[90:91], v224 offset:23040
v_mfma_f32_16x16x32_bf16 v[204:207], a[92:95], a[156:159], v[204:207]
v_add_f32 v58, 1.0, v58
v_add_f32 v59, 1.0, v59
v_mfma_f32_16x16x32_bf16 v[208:211], a[92:95], a[172:175], v[208:211]
v_rcp_f32 v58, v58
v_mfma_f32_16x16x32_bf16 v[212:215], a[92:95], a[188:191], v[212:215]
v_rcp_f32 v59, v59
s_waitcnt vmcnt(28)
s_waitcnt lgkmcnt(8)
v_mfma_f32_16x16x32_bf16 v[212:215], a[64:67], a[112:115], v[212:215]
ds_read_b64_tr_b16 a[92:93], v224 offset:27648
ds_read_b64_tr_b16 a[94:95], v224 offset:32256
v_mfma_f32_16x16x32_bf16 v[208:211], a[64:67], a[96:99], v[208:211]
v_mul_f32 v46, v46, v58
v_mul_f32 v47, v47, v59
v_mfma_f32_16x16x32_bf16 v[204:207], a[64:67], a[208:211], v[204:207]
v_cvt_pk_bf16_f32 v58, v46, v47
v_lshlrev_b32 v46, 16, v58
v_mfma_f32_16x16x32_bf16 v[200:203], a[64:67], a[192:195], v[200:203]
v_and_b32 v47, 0xffff0000, v58
v_accvgpr_read_b32 v49, a227
s_waitcnt vmcnt(24)
v_mfma_f32_16x16x32_bf16 v[200:203], a[68:71], a[196:199], v[200:203]
ds_read_b64_tr_b16 a[64:65], v219 offset:0
ds_read_b64_tr_b16 a[66:67], v219 offset:4608
v_mfma_f32_16x16x32_bf16 v[204:207], a[68:71], a[244:247], v[204:207]
v_accvgpr_read_b32 v59, a237
v_lshlrev_b32 v48, 16, v49
v_mfma_f32_16x16x32_bf16 v[208:211], a[68:71], a[100:103], v[208:211]
v_and_b32 v49, 0xffff0000, v49
v_lshlrev_b32 v58, 16, v59
v_mfma_f32_16x16x32_bf16 v[212:215], a[68:71], a[116:119], v[212:215]
s_waitcnt vmcnt(0)
buffer_store_dword v246, v254, s[20:23], s29 offen sc0 sc1
s_waitcnt vmcnt(21)
v_mfma_f32_16x16x32_bf16 v[212:215], a[72:75], a[120:123], v[212:215]
ds_read_b64_tr_b16 a[68:69], v219 offset:9216
ds_read_b64_tr_b16 a[70:71], v219 offset:13824
v_mfma_f32_16x16x32_bf16 v[208:211], a[72:75], a[104:107], v[208:211]
s_add_u32 s28, s32, 0
s_and_b32 s28, s28, 7
v_mfma_f32_16x16x32_bf16 v[204:207], a[72:75], a[248:251], v[204:207]
s_xor_b32 s29, s28, s32
s_lshl_b32 s28, s28, 18
v_mfma_f32_16x16x32_bf16 v[200:203], a[72:75], a[200:203], v[200:203]
s_add_u32 s28, s28, s49
s_and_b32 s29, s29, 4
s_waitcnt vmcnt(17)
s_waitcnt lgkmcnt(8)
v_mfma_f32_16x16x32_bf16 v[200:203], a[76:79], a[204:207], v[200:203]
ds_read_b64_tr_b16 a[72:73], v219 offset:18432
ds_read_b64_tr_b16 a[74:75], v219 offset:23040
v_mfma_f32_16x16x32_bf16 v[204:207], a[76:79], a[252:255], v[204:207]
s_add_u32 s72, s28, 0
s_lshl_b32 s29, s29, 10
v_mfma_f32_16x16x32_bf16 v[208:211], a[76:79], a[108:111], v[208:211]
s_add_u32 s28, s32, 1
s_and_b32 s28, s28, 7
v_mfma_f32_16x16x32_bf16 v[212:215], a[76:79], a[124:127], v[212:215]
s_xor_b32 s29, s28, s32
s_lshl_b32 s28, s28, 18
s_waitcnt vmcnt(13)
v_mfma_f32_16x16x32_bf16 v[212:215], a[80:83], a[48:51], v[212:215]
ds_read_b64_tr_b16 a[76:77], v219 offset:27648
ds_read_b64_tr_b16 a[78:79], v219 offset:32256
v_mfma_f32_16x16x32_bf16 v[208:211], a[80:83], a[32:35], v[208:211]
s_add_u32 s28, s28, s49
s_and_b32 s29, s29, 4
v_mfma_f32_16x16x32_bf16 v[204:207], a[80:83], a[16:19], v[204:207]
s_add_u32 s73, s28, 8192
s_lshl_b32 s29, s29, 10
v_mfma_f32_16x16x32_bf16 v[200:203], a[80:83], a[0:3], v[200:203]
s_add_u32 s65, s28, s29
v_and_b32 v59, 0xffff0000, v59
s_waitcnt vmcnt(9)
v_mfma_f32_16x16x32_bf16 v[200:203], a[84:87], a[4:7], v[200:203]
ds_read_b64_tr_b16 a[80:81], v222 offset:0
ds_read_b64_tr_b16 a[82:83], v222 offset:4608
v_mfma_f32_16x16x32_bf16 v[204:207], a[84:87], a[20:23], v[204:207]
s_add_u32 s28, s32, 2
s_and_b32 s28, s28, 7
v_mfma_f32_16x16x32_bf16 v[208:211], a[84:87], a[36:39], v[208:211]
s_xor_b32 s29, s28, s32
s_lshl_b32 s28, s28, 18
v_mfma_f32_16x16x32_bf16 v[212:215], a[84:87], a[52:55], v[212:215]
s_add_u32 s28, s28, s49
s_and_b32 s29, s29, 4
s_waitcnt vmcnt(5)
s_waitcnt lgkmcnt(8)
v_mfma_f32_16x16x32_bf16 v[212:215], a[88:91], a[56:59], v[212:215]
ds_read_b64_tr_b16 a[84:85], v222 offset:9216
ds_read_b64_tr_b16 a[86:87], v222 offset:13824
v_mfma_f32_16x16x32_bf16 v[208:211], a[88:91], a[40:43], v[208:211]
s_add_u32 s74, s28, 8192
s_lshl_b32 s29, s29, 10
v_mfma_f32_16x16x32_bf16 v[204:207], a[88:91], a[24:27], v[204:207]
s_add_u32 s66, s28, s29
v_add_f32 v48, v48, v58
v_mfma_f32_16x16x32_bf16 v[200:203], a[88:91], a[8:11], v[200:203]
s_add_u32 s28, s32, 3
s_and_b32 s28, s28, 7
s_waitcnt vmcnt(1)
v_mfma_f32_16x16x32_bf16 v[200:203], a[92:95], a[12:15], v[200:203]
ds_read_b64_tr_b16 a[88:89], v222 offset:18432
ds_read_b64_tr_b16 a[90:91], v222 offset:23040
v_mfma_f32_16x16x32_bf16 v[204:207], a[92:95], a[28:31], v[204:207]
s_xor_b32 s29, s28, s32
s_lshl_b32 s28, s28, 18
v_mfma_f32_16x16x32_bf16 v[208:211], a[92:95], a[44:47], v[208:211]
s_add_u32 s28, s28, s49
s_and_b32 s29, s29, 4
v_mfma_f32_16x16x32_bf16 v[212:215], a[92:95], a[60:63], v[212:215]
s_add_u32 s75, s28, 0
s_lshl_b32 s29, s29, 10
v_mfma_f32_16x16x32_bf16 v[96:99], a[64:67], a[112:115], v[96:99]
ds_read_b64_tr_b16 a[92:93], v222 offset:27648
ds_read_b64_tr_b16 a[94:95], v222 offset:32256
v_mfma_f32_16x16x32_bf16 v[88:91], a[64:67], a[96:99], v[88:91]
s_add_u32 s67, s28, s29
v_add_f32 v49, v49, v59
v_mfma_f32_16x16x32_bf16 v[80:83], a[64:67], a[208:211], v[80:83]
buffer_load_dword v230, v229, s[20:23], s94 offen sc0 sc1
v_mfma_f32_16x16x32_bf16 v[72:75], a[64:67], a[192:195], v[72:75]
s_add_u32 s28, s32, 4
s_and_b32 s28, s28, 7
s_waitcnt lgkmcnt(8)
v_mfma_f32_16x16x32_bf16 v[72:75], a[68:71], a[196:199], v[72:75]
ds_read_b64_tr_b16 a[64:65], v219 offset:8
ds_read_b64_tr_b16 a[66:67], v219 offset:4616
v_mfma_f32_16x16x32_bf16 v[80:83], a[68:71], a[244:247], v[80:83]
s_xor_b32 s29, s28, s32
s_lshl_b32 s28, s28, 18
v_mfma_f32_16x16x32_bf16 v[88:91], a[68:71], a[100:103], v[88:91]
s_add_u32 s28, s28, s49
s_and_b32 s29, s29, 4
v_mfma_f32_16x16x32_bf16 v[96:99], a[68:71], a[116:119], v[96:99]
s_add_u32 s84, s28, 0
s_lshl_b32 s29, s29, 10
v_mfma_f32_16x16x32_bf16 v[96:99], a[72:75], a[120:123], v[96:99]
ds_read_b64_tr_b16 a[68:69], v219 offset:9224
ds_read_b64_tr_b16 a[70:71], v219 offset:13832
v_mfma_f32_16x16x32_bf16 v[88:91], a[72:75], a[104:107], v[88:91]
s_add_u32 s68, s28, s29
v_cvt_pk_bf16_f32 v58, v48, v49
v_mfma_f32_16x16x32_bf16 v[80:83], a[72:75], a[248:251], v[80:83]
s_add_u32 s28, s32, 5
s_and_b32 s28, s28, 7
v_mfma_f32_16x16x32_bf16 v[72:75], a[72:75], a[200:203], v[72:75]
s_xor_b32 s29, s28, s32
s_lshl_b32 s28, s28, 18
v_mfma_f32_16x16x32_bf16 v[72:75], a[76:79], a[204:207], v[72:75]
ds_read_b64_tr_b16 a[72:73], v219 offset:18440
ds_read_b64_tr_b16 a[74:75], v219 offset:23048
v_mfma_f32_16x16x32_bf16 v[80:83], a[76:79], a[252:255], v[80:83]
s_add_u32 s28, s28, s49
s_and_b32 s29, s29, 4
v_mfma_f32_16x16x32_bf16 v[88:91], a[76:79], a[108:111], v[88:91]
s_add_u32 s85, s28, 8192
s_lshl_b32 s29, s29, 10
v_mfma_f32_16x16x32_bf16 v[96:99], a[76:79], a[124:127], v[96:99]
s_add_u32 s69, s28, s29
v_lshlrev_b32 v48, 16, v58
s_waitcnt lgkmcnt(8)
v_mfma_f32_16x16x32_bf16 v[96:99], a[80:83], a[48:51], v[96:99]
ds_read_b64_tr_b16 a[76:77], v219 offset:27656
ds_read_b64_tr_b16 a[78:79], v219 offset:32264
v_mfma_f32_16x16x32_bf16 v[88:91], a[80:83], a[32:35], v[88:91]
s_add_u32 s28, s32, 6
s_and_b32 s28, s28, 7
v_mfma_f32_16x16x32_bf16 v[80:83], a[80:83], a[16:19], v[80:83]
s_xor_b32 s29, s28, s32
s_lshl_b32 s28, s28, 18
v_mfma_f32_16x16x32_bf16 v[72:75], a[80:83], a[0:3], v[72:75]
s_add_u32 s28, s28, s49
s_and_b32 s29, s29, 4
v_mfma_f32_16x16x32_bf16 v[72:75], a[84:87], a[4:7], v[72:75]
ds_read_b64_tr_b16 a[80:81], v222 offset:8
ds_read_b64_tr_b16 a[82:83], v222 offset:4616
v_mfma_f32_16x16x32_bf16 v[80:83], a[84:87], a[20:23], v[80:83]
s_add_u32 s86, s28, 8192
s_lshl_b32 s29, s29, 10
v_mfma_f32_16x16x32_bf16 v[88:91], a[84:87], a[36:39], v[88:91]
s_add_u32 s70, s28, s29
v_and_b32 v49, 0xffff0000, v58
v_mfma_f32_16x16x32_bf16 v[96:99], a[84:87], a[52:55], v[96:99]
s_add_u32 s28, s32, 7
s_and_b32 s28, s28, 7
v_mfma_f32_16x16x32_bf16 v[96:99], a[88:91], a[56:59], v[96:99]
ds_read_b64_tr_b16 a[84:85], v222 offset:9224
ds_read_b64_tr_b16 a[86:87], v222 offset:13832
v_mfma_f32_16x16x32_bf16 v[88:91], a[88:91], a[40:43], v[88:91]
s_xor_b32 s29, s28, s32
s_lshl_b32 s28, s28, 18
v_mfma_f32_16x16x32_bf16 v[80:83], a[88:91], a[24:27], v[80:83]
s_add_u32 s28, s28, s49
s_and_b32 s29, s29, 4
v_mfma_f32_16x16x32_bf16 v[72:75], a[88:91], a[8:11], v[72:75]
s_add_u32 s87, s28, 0
s_lshl_b32 s29, s29, 10
s_waitcnt lgkmcnt(8)
v_mfma_f32_16x16x32_bf16 v[72:75], a[92:95], a[12:15], v[72:75]
ds_read_b64_tr_b16 a[88:89], v222 offset:18440
ds_read_b64_tr_b16 a[90:91], v222 offset:23048
v_mfma_f32_16x16x32_bf16 v[80:83], a[92:95], a[28:31], v[80:83]
s_add_u32 s71, s28, s29
v_mul_f32 v58, 0xbfb8aa3b, v48
v_mfma_f32_16x16x32_bf16 v[88:91], a[92:95], a[44:47], v[88:91]
s_waitcnt vmcnt(0)
v_cmp_gt_u32 vcc, 2, v230
v_mfma_f32_16x16x32_bf16 v[96:99], a[92:95], a[60:63], v[96:99]
v_mul_f32 v59, 0xbfb8aa3b, v49
v_mfma_f32_16x16x32_bf16 v[100:103], a[64:67], a[112:115], v[100:103]
ds_read_b64_tr_b16 a[92:93], v222 offset:27656
ds_read_b64_tr_b16 a[94:95], v222 offset:32264
v_mfma_f32_16x16x32_bf16 v[92:95], a[64:67], a[96:99], v[92:95]
s_and_b32 s29, vcc_lo, 15
s_cbranch_scc1 SP_O3B
SP_O3B_RET:
v_mfma_f32_16x16x32_bf16 v[84:87], a[64:67], a[208:211], v[84:87]
s_add_u32 s39, s44, 8192
v_mfma_f32_16x16x32_bf16 v[76:79], a[64:67], a[192:195], v[76:79]
v_cvt_pk_bf16_f32 v200, v200, v201
v_cvt_pk_bf16_f32 v201, v202, v203
v_mfma_f32_16x16x32_bf16 v[76:79], a[68:71], a[196:199], v[76:79]
ds_read_b64_tr_b16 a[64:65], v220 offset:0
ds_read_b64_tr_b16 a[66:67], v220 offset:4608
v_mfma_f32_16x16x32_bf16 v[84:87], a[68:71], a[244:247], v[84:87]
buffer_store_dwordx2 v[200:201], v226, s[20:23], s44 offen offset:0 sc0 sc1
v_mfma_f32_16x16x32_bf16 v[92:95], a[68:71], a[100:103], v[92:95]
v_cvt_pk_bf16_f32 v204, v204, v205
v_cvt_pk_bf16_f32 v205, v206, v207
v_mfma_f32_16x16x32_bf16 v[100:103], a[68:71], a[116:119], v[100:103]
buffer_store_dwordx2 v[204:205], v226, s[20:23], s44 offen offset:512 sc0 sc1
s_waitcnt lgkmcnt(8)
v_mfma_f32_16x16x32_bf16 v[100:103], a[72:75], a[120:123], v[100:103]
ds_read_b64_tr_b16 a[68:69], v220 offset:9216
ds_read_b64_tr_b16 a[70:71], v220 offset:13824
v_mfma_f32_16x16x32_bf16 v[92:95], a[72:75], a[104:107], v[92:95]
v_cvt_pk_bf16_f32 v208, v208, v209
v_cvt_pk_bf16_f32 v209, v210, v211
v_mfma_f32_16x16x32_bf16 v[84:87], a[72:75], a[248:251], v[84:87]
buffer_store_dwordx2 v[208:209], v226, s[20:23], s39 offen offset:0 sc0 sc1
v_mfma_f32_16x16x32_bf16 v[76:79], a[72:75], a[200:203], v[76:79]
v_cvt_pk_bf16_f32 v212, v212, v213
v_cvt_pk_bf16_f32 v213, v214, v215
v_mfma_f32_16x16x32_bf16 v[76:79], a[76:79], a[204:207], v[76:79]
ds_read_b64_tr_b16 a[72:73], v220 offset:18432
ds_read_b64_tr_b16 a[74:75], v220 offset:23040
v_mfma_f32_16x16x32_bf16 v[84:87], a[76:79], a[252:255], v[84:87]
buffer_store_dwordx2 v[212:213], v226, s[20:23], s39 offen offset:512 sc0 sc1
v_mfma_f32_16x16x32_bf16 v[92:95], a[76:79], a[108:111], v[92:95]
v_exp_f32 v58, v58
v_mfma_f32_16x16x32_bf16 v[100:103], a[76:79], a[124:127], v[100:103]
v_exp_f32 v59, v59
v_mfma_f32_16x16x32_bf16 v[100:103], a[80:83], a[48:51], v[100:103]
ds_read_b64_tr_b16 a[76:77], v220 offset:27648
ds_read_b64_tr_b16 a[78:79], v220 offset:32256
v_mfma_f32_16x16x32_bf16 v[92:95], a[80:83], a[32:35], v[92:95]
v_add_f32 v58, 1.0, v58
v_add_f32 v59, 1.0, v59
v_mfma_f32_16x16x32_bf16 v[84:87], a[80:83], a[16:19], v[84:87]
v_rcp_f32 v58, v58
v_mfma_f32_16x16x32_bf16 v[76:79], a[80:83], a[0:3], v[76:79]
v_rcp_f32 v59, v59
s_waitcnt lgkmcnt(8)
v_mfma_f32_16x16x32_bf16 v[76:79], a[84:87], a[4:7], v[76:79]
ds_read_b64_tr_b16 a[80:81], v223 offset:0
ds_read_b64_tr_b16 a[82:83], v223 offset:4608
v_mfma_f32_16x16x32_bf16 v[84:87], a[84:87], a[20:23], v[84:87]
v_mul_f32 v48, v48, v58
v_mul_f32 v49, v49, v59
v_mfma_f32_16x16x32_bf16 v[92:95], a[84:87], a[36:39], v[92:95]
v_cvt_pk_bf16_f32 v58, v48, v49
v_lshlrev_b32 v48, 16, v58
v_mfma_f32_16x16x32_bf16 v[100:103], a[84:87], a[52:55], v[100:103]
v_and_b32 v49, 0xffff0000, v58
v_accvgpr_read_b32 v51, a228
v_mfma_f32_16x16x32_bf16 v[100:103], a[88:91], a[56:59], v[100:103]
ds_read_b64_tr_b16 a[84:85], v223 offset:9216
ds_read_b64_tr_b16 a[86:87], v223 offset:13824
v_mfma_f32_16x16x32_bf16 v[92:95], a[88:91], a[40:43], v[92:95]
v_accvgpr_read_b32 v59, a238
v_lshlrev_b32 v50, 16, v51
v_mfma_f32_16x16x32_bf16 v[84:87], a[88:91], a[24:27], v[84:87]
v_and_b32 v51, 0xffff0000, v51
v_lshlrev_b32 v58, 16, v59
v_mfma_f32_16x16x32_bf16 v[76:79], a[88:91], a[8:11], v[76:79]
v_and_b32 v59, 0xffff0000, v59
v_add_f32 v50, v50, v58
v_mfma_f32_16x16x32_bf16 v[76:79], a[92:95], a[12:15], v[76:79]
ds_read_b64_tr_b16 a[88:89], v223 offset:18432
ds_read_b64_tr_b16 a[90:91], v223 offset:23040
v_mfma_f32_16x16x32_bf16 v[84:87], a[92:95], a[28:31], v[84:87]
v_add_f32 v51, v51, v59
v_cvt_pk_bf16_f32 v58, v50, v51
v_mfma_f32_16x16x32_bf16 v[92:95], a[92:95], a[44:47], v[92:95]
v_lshlrev_b32 v50, 16, v58
v_and_b32 v51, 0xffff0000, v58
v_mfma_f32_16x16x32_bf16 v[100:103], a[92:95], a[60:63], v[100:103]
v_mul_f32 v58, 0xbfb8aa3b, v50
v_mul_f32 v59, 0xbfb8aa3b, v51
s_waitcnt lgkmcnt(8)
v_mfma_f32_16x16x32_bf16 v[128:131], a[64:67], a[112:115], v[128:131]
ds_read_b64_tr_b16 a[92:93], v223 offset:27648
ds_read_b64_tr_b16 a[94:95], v223 offset:32256
v_mfma_f32_16x16x32_bf16 v[120:123], a[64:67], a[96:99], v[120:123]
v_exp_f32 v58, v58
v_mfma_f32_16x16x32_bf16 v[112:115], a[64:67], a[208:211], v[112:115]
v_exp_f32 v59, v59
v_mfma_f32_16x16x32_bf16 v[104:107], a[64:67], a[192:195], v[104:107]
v_add_f32 v58, 1.0, v58
v_add_f32 v59, 1.0, v59
v_mfma_f32_16x16x32_bf16 v[104:107], a[68:71], a[196:199], v[104:107]
ds_read_b64_tr_b16 a[64:65], v220 offset:8
ds_read_b64_tr_b16 a[66:67], v220 offset:4616
v_mfma_f32_16x16x32_bf16 v[112:115], a[68:71], a[244:247], v[112:115]
v_rcp_f32 v58, v58
v_mfma_f32_16x16x32_bf16 v[120:123], a[68:71], a[100:103], v[120:123]
v_rcp_f32 v59, v59
v_mfma_f32_16x16x32_bf16 v[128:131], a[68:71], a[116:119], v[128:131]
v_mul_f32 v50, v50, v58
v_mul_f32 v51, v51, v59
v_mfma_f32_16x16x32_bf16 v[128:131], a[72:75], a[120:123], v[128:131]
ds_read_b64_tr_b16 a[68:69], v220 offset:9224
ds_read_b64_tr_b16 a[70:71], v220 offset:13832
v_mfma_f32_16x16x32_bf16 v[120:123], a[72:75], a[104:107], v[120:123]
s_add_u32 s39, s44, 0
v_cvt_pk_bf16_f32 v58, v50, v51
v_mfma_f32_16x16x32_bf16 v[112:115], a[72:75], a[248:251], v[112:115]
v_cvt_pk_bf16_f32 v80, v80, v81
v_cvt_pk_bf16_f32 v81, v82, v83
v_mfma_f32_16x16x32_bf16 v[104:107], a[72:75], a[200:203], v[104:107]
v_cvt_pk_bf16_f32 v82, v84, v85
v_cvt_pk_bf16_f32 v83, v86, v87
s_waitcnt lgkmcnt(8)
v_mfma_f32_16x16x32_bf16 v[104:107], a[76:79], a[204:207], v[104:107]
ds_read_b64_tr_b16 a[72:73], v220 offset:18440
ds_read_b64_tr_b16 a[74:75], v220 offset:23048
v_mfma_f32_16x16x32_bf16 v[112:115], a[76:79], a[252:255], v[112:115]
buffer_store_dwordx4 v[80:83], v244, s[20:23], s39 offen offset:1024 sc0 sc1
v_mfma_f32_16x16x32_bf16 v[120:123], a[76:79], a[108:111], v[120:123]
v_cvt_pk_bf16_f32 v88, v88, v89
v_cvt_pk_bf16_f32 v89, v90, v91
v_mfma_f32_16x16x32_bf16 v[128:131], a[76:79], a[124:127], v[128:131]
v_cvt_pk_bf16_f32 v90, v92, v93
v_cvt_pk_bf16_f32 v91, v94, v95
v_mfma_f32_16x16x32_bf16 v[128:131], a[80:83], a[48:51], v[128:131]
ds_read_b64_tr_b16 a[76:77], v220 offset:27656
ds_read_b64_tr_b16 a[78:79], v220 offset:32264
v_mfma_f32_16x16x32_bf16 v[120:123], a[80:83], a[32:35], v[120:123]
buffer_store_dwordx4 v[88:91], v244, s[20:23], s39 offen offset:2048 sc0 sc1
v_mfma_f32_16x16x32_bf16 v[112:115], a[80:83], a[16:19], v[112:115]
v_cvt_pk_bf16_f32 v96, v96, v97
v_cvt_pk_bf16_f32 v97, v98, v99
v_mfma_f32_16x16x32_bf16 v[104:107], a[80:83], a[0:3], v[104:107]
v_cvt_pk_bf16_f32 v98, v100, v101
v_cvt_pk_bf16_f32 v99, v102, v103
v_mfma_f32_16x16x32_bf16 v[104:107], a[84:87], a[4:7], v[104:107]
ds_read_b64_tr_b16 a[80:81], v223 offset:8
ds_read_b64_tr_b16 a[82:83], v223 offset:4616
v_mfma_f32_16x16x32_bf16 v[112:115], a[84:87], a[20:23], v[112:115]
buffer_store_dwordx4 v[96:99], v244, s[20:23], s39 offen offset:3072 sc0 sc1
v_mfma_f32_16x16x32_bf16 v[120:123], a[84:87], a[36:39], v[120:123]
v_lshlrev_b32 v50, 16, v58
v_and_b32 v51, 0xffff0000, v58
v_mfma_f32_16x16x32_bf16 v[128:131], a[84:87], a[52:55], v[128:131]
v_accvgpr_read_b32 v53, a229
v_accvgpr_read_b32 v59, a239
s_waitcnt lgkmcnt(8)
v_mfma_f32_16x16x32_bf16 v[128:131], a[88:91], a[56:59], v[128:131]
ds_read_b64_tr_b16 a[84:85], v223 offset:9224
ds_read_b64_tr_b16 a[86:87], v223 offset:13832
v_mfma_f32_16x16x32_bf16 v[120:123], a[88:91], a[40:43], v[120:123]
v_lshlrev_b32 v52, 16, v53
v_and_b32 v53, 0xffff0000, v53
v_mfma_f32_16x16x32_bf16 v[112:115], a[88:91], a[24:27], v[112:115]
v_lshlrev_b32 v58, 16, v59
v_and_b32 v59, 0xffff0000, v59
v_mfma_f32_16x16x32_bf16 v[104:107], a[88:91], a[8:11], v[104:107]
v_add_f32 v52, v52, v58
v_add_f32 v53, v53, v59
v_mfma_f32_16x16x32_bf16 v[104:107], a[92:95], a[12:15], v[104:107]
ds_read_b64_tr_b16 a[88:89], v223 offset:18440
ds_read_b64_tr_b16 a[90:91], v223 offset:23048
v_mfma_f32_16x16x32_bf16 v[112:115], a[92:95], a[28:31], v[112:115]
v_cvt_pk_bf16_f32 v58, v52, v53
v_lshlrev_b32 v52, 16, v58
v_mfma_f32_16x16x32_bf16 v[120:123], a[92:95], a[44:47], v[120:123]
v_and_b32 v53, 0xffff0000, v58
v_mul_f32 v58, 0xbfb8aa3b, v52
v_mfma_f32_16x16x32_bf16 v[128:131], a[92:95], a[60:63], v[128:131]
v_mul_f32 v59, 0xbfb8aa3b, v53
v_mfma_f32_16x16x32_bf16 v[132:135], a[64:67], a[112:115], v[132:135]
ds_read_b64_tr_b16 a[92:93], v223 offset:27656
ds_read_b64_tr_b16 a[94:95], v223 offset:32264
v_mfma_f32_16x16x32_bf16 v[124:127], a[64:67], a[96:99], v[124:127]
v_exp_f32 v58, v58
v_mfma_f32_16x16x32_bf16 v[116:119], a[64:67], a[208:211], v[116:119]
v_exp_f32 v59, v59
v_mfma_f32_16x16x32_bf16 v[108:111], a[64:67], a[192:195], v[108:111]
v_add_f32 v58, 1.0, v58
v_add_f32 v59, 1.0, v59
s_waitcnt lgkmcnt(8)
v_mfma_f32_16x16x32_bf16 v[108:111], a[68:71], a[196:199], v[108:111]
ds_read_b64_tr_b16 a[64:65], v219 offset:128
ds_read_b64_tr_b16 a[66:67], v219 offset:4736
v_mfma_f32_16x16x32_bf16 v[116:119], a[68:71], a[244:247], v[116:119]
v_rcp_f32 v58, v58
v_mfma_f32_16x16x32_bf16 v[124:127], a[68:71], a[100:103], v[124:127]
v_rcp_f32 v59, v59
v_mfma_f32_16x16x32_bf16 v[132:135], a[68:71], a[116:119], v[132:135]
v_mul_f32 v52, v52, v58
v_mul_f32 v53, v53, v59
v_mfma_f32_16x16x32_bf16 v[132:135], a[72:75], a[120:123], v[132:135]
ds_read_b64_tr_b16 a[68:69], v219 offset:9344
ds_read_b64_tr_b16 a[70:71], v219 offset:13952
v_mfma_f32_16x16x32_bf16 v[124:127], a[72:75], a[104:107], v[124:127]
v_cvt_pk_bf16_f32 v58, v52, v53
v_lshlrev_b32 v52, 16, v58
v_mfma_f32_16x16x32_bf16 v[116:119], a[72:75], a[248:251], v[116:119]
v_and_b32 v53, 0xffff0000, v58
v_accvgpr_read_b32 v55, a230
v_mfma_f32_16x16x32_bf16 v[108:111], a[72:75], a[200:203], v[108:111]
v_accvgpr_read_b32 v59, a240
v_lshlrev_b32 v54, 16, v55
v_mfma_f32_16x16x32_bf16 v[108:111], a[76:79], a[204:207], v[108:111]
ds_read_b64_tr_b16 a[72:73], v219 offset:18560
ds_read_b64_tr_b16 a[74:75], v219 offset:23168
v_mfma_f32_16x16x32_bf16 v[116:119], a[76:79], a[252:255], v[116:119]
v_and_b32 v55, 0xffff0000, v55
v_lshlrev_b32 v58, 16, v59
v_mfma_f32_16x16x32_bf16 v[124:127], a[76:79], a[108:111], v[124:127]
v_and_b32 v59, 0xffff0000, v59
v_add_f32 v54, v54, v58
v_mfma_f32_16x16x32_bf16 v[132:135], a[76:79], a[124:127], v[132:135]
v_add_f32 v55, v55, v59
v_cvt_pk_bf16_f32 v58, v54, v55
s_waitcnt lgkmcnt(8)
v_mfma_f32_16x16x32_bf16 v[132:135], a[80:83], a[48:51], v[132:135]
ds_read_b64_tr_b16 a[76:77], v219 offset:27776
ds_read_b64_tr_b16 a[78:79], v219 offset:32384
v_mfma_f32_16x16x32_bf16 v[124:127], a[80:83], a[32:35], v[124:127]
v_lshlrev_b32 v54, 16, v58
v_and_b32 v55, 0xffff0000, v58
v_mfma_f32_16x16x32_bf16 v[116:119], a[80:83], a[16:19], v[116:119]
v_mul_f32 v58, 0xbfb8aa3b, v54
v_mul_f32 v59, 0xbfb8aa3b, v55
v_mfma_f32_16x16x32_bf16 v[108:111], a[80:83], a[0:3], v[108:111]
v_exp_f32 v58, v58
v_mfma_f32_16x16x32_bf16 v[108:111], a[84:87], a[4:7], v[108:111]
ds_read_b64_tr_b16 a[80:81], v222 offset:128
ds_read_b64_tr_b16 a[82:83], v222 offset:4736
v_mfma_f32_16x16x32_bf16 v[116:119], a[84:87], a[20:23], v[116:119]
v_exp_f32 v59, v59
v_mfma_f32_16x16x32_bf16 v[124:127], a[84:87], a[36:39], v[124:127]
v_add_f32 v58, 1.0, v58
v_add_f32 v59, 1.0, v59
v_mfma_f32_16x16x32_bf16 v[132:135], a[84:87], a[52:55], v[132:135]
v_rcp_f32 v58, v58
v_mfma_f32_16x16x32_bf16 v[132:135], a[88:91], a[56:59], v[132:135]
ds_read_b64_tr_b16 a[84:85], v222 offset:9344
ds_read_b64_tr_b16 a[86:87], v222 offset:13952
v_mfma_f32_16x16x32_bf16 v[124:127], a[88:91], a[40:43], v[124:127]
v_rcp_f32 v59, v59
v_mfma_f32_16x16x32_bf16 v[116:119], a[88:91], a[24:27], v[116:119]
v_mul_f32 v54, v54, v58
v_mul_f32 v55, v55, v59
v_mfma_f32_16x16x32_bf16 v[108:111], a[88:91], a[8:11], v[108:111]
v_cvt_pk_bf16_f32 v58, v54, v55
v_lshlrev_b32 v54, 16, v58
s_waitcnt lgkmcnt(8)
v_mfma_f32_16x16x32_bf16 v[108:111], a[92:95], a[12:15], v[108:111]
ds_read_b64_tr_b16 a[88:89], v222 offset:18560
ds_read_b64_tr_b16 a[90:91], v222 offset:23168
v_mfma_f32_16x16x32_bf16 v[116:119], a[92:95], a[28:31], v[116:119]
v_and_b32 v55, 0xffff0000, v58
v_accvgpr_read_b32 v57, a231
v_mfma_f32_16x16x32_bf16 v[124:127], a[92:95], a[44:47], v[124:127]
v_accvgpr_read_b32 v59, a241
v_lshlrev_b32 v56, 16, v57
v_mfma_f32_16x16x32_bf16 v[132:135], a[92:95], a[60:63], v[132:135]
v_and_b32 v57, 0xffff0000, v57
v_lshlrev_b32 v58, 16, v59
v_mfma_f32_16x16x32_bf16 v[160:163], a[64:67], a[112:115], v[160:163]
ds_read_b64_tr_b16 a[92:93], v222 offset:27776
ds_read_b64_tr_b16 a[94:95], v222 offset:32384
v_mfma_f32_16x16x32_bf16 v[152:155], a[64:67], a[96:99], v[152:155]
v_and_b32 v59, 0xffff0000, v59
v_add_f32 v56, v56, v58
v_mfma_f32_16x16x32_bf16 v[144:147], a[64:67], a[208:211], v[144:147]
v_add_f32 v57, v57, v59
v_cvt_pk_bf16_f32 v58, v56, v57
v_mfma_f32_16x16x32_bf16 v[136:139], a[64:67], a[192:195], v[136:139]
v_lshlrev_b32 v56, 16, v58
v_and_b32 v57, 0xffff0000, v58
v_mfma_f32_16x16x32_bf16 v[136:139], a[68:71], a[196:199], v[136:139]
ds_read_b64_tr_b16 a[64:65], v219 offset:136
ds_read_b64_tr_b16 a[66:67], v219 offset:4744
v_mfma_f32_16x16x32_bf16 v[144:147], a[68:71], a[244:247], v[144:147]
v_mul_f32 v58, 0xbfb8aa3b, v56
v_mul_f32 v59, 0xbfb8aa3b, v57
v_mfma_f32_16x16x32_bf16 v[152:155], a[68:71], a[100:103], v[152:155]
v_exp_f32 v58, v58
v_mfma_f32_16x16x32_bf16 v[160:163], a[68:71], a[116:119], v[160:163]
v_exp_f32 v59, v59
s_waitcnt lgkmcnt(8)
v_mfma_f32_16x16x32_bf16 v[160:163], a[72:75], a[120:123], v[160:163]
ds_read_b64_tr_b16 a[68:69], v219 offset:9352
ds_read_b64_tr_b16 a[70:71], v219 offset:13960
v_mfma_f32_16x16x32_bf16 v[152:155], a[72:75], a[104:107], v[152:155]
s_add_u32 s39, s44, 4096
v_add_f32 v58, 1.0, v58
v_mfma_f32_16x16x32_bf16 v[144:147], a[72:75], a[248:251], v[144:147]
v_cvt_pk_bf16_f32 v104, v104, v105
v_cvt_pk_bf16_f32 v105, v106, v107
v_mfma_f32_16x16x32_bf16 v[136:139], a[72:75], a[200:203], v[136:139]
v_cvt_pk_bf16_f32 v106, v108, v109
v_cvt_pk_bf16_f32 v107, v110, v111
v_mfma_f32_16x16x32_bf16 v[136:139], a[76:79], a[204:207], v[136:139]
ds_read_b64_tr_b16 a[72:73], v219 offset:18568
ds_read_b64_tr_b16 a[74:75], v219 offset:23176
v_mfma_f32_16x16x32_bf16 v[144:147], a[76:79], a[252:255], v[144:147]
buffer_store_dwordx4 v[104:107], v244, s[20:23], s39 offen offset:0 sc0 sc1
v_mfma_f32_16x16x32_bf16 v[152:155], a[76:79], a[108:111], v[152:155]
v_cvt_pk_bf16_f32 v112, v112, v113
v_cvt_pk_bf16_f32 v113, v114, v115
v_mfma_f32_16x16x32_bf16 v[160:163], a[76:79], a[124:127], v[160:163]
v_cvt_pk_bf16_f32 v114, v116, v117
v_cvt_pk_bf16_f32 v115, v118, v119
v_mfma_f32_16x16x32_bf16 v[160:163], a[80:83], a[48:51], v[160:163]
ds_read_b64_tr_b16 a[76:77], v219 offset:27784
ds_read_b64_tr_b16 a[78:79], v219 offset:32392
v_mfma_f32_16x16x32_bf16 v[152:155], a[80:83], a[32:35], v[152:155]
buffer_store_dwordx4 v[112:115], v244, s[20:23], s39 offen offset:1024 sc0 sc1
v_mfma_f32_16x16x32_bf16 v[144:147], a[80:83], a[16:19], v[144:147]
v_cvt_pk_bf16_f32 v120, v120, v121
v_cvt_pk_bf16_f32 v121, v122, v123
v_mfma_f32_16x16x32_bf16 v[136:139], a[80:83], a[0:3], v[136:139]
v_cvt_pk_bf16_f32 v122, v124, v125
v_cvt_pk_bf16_f32 v123, v126, v127
s_waitcnt lgkmcnt(8)
v_mfma_f32_16x16x32_bf16 v[136:139], a[84:87], a[4:7], v[136:139]
ds_read_b64_tr_b16 a[80:81], v222 offset:136
ds_read_b64_tr_b16 a[82:83], v222 offset:4744
v_mfma_f32_16x16x32_bf16 v[144:147], a[84:87], a[20:23], v[144:147]
buffer_store_dwordx4 v[120:123], v244, s[20:23], s39 offen offset:2048 sc0 sc1
v_mfma_f32_16x16x32_bf16 v[152:155], a[84:87], a[36:39], v[152:155]
v_cvt_pk_bf16_f32 v128, v128, v129
v_cvt_pk_bf16_f32 v129, v130, v131
v_mfma_f32_16x16x32_bf16 v[160:163], a[84:87], a[52:55], v[160:163]
v_cvt_pk_bf16_f32 v130, v132, v133
v_cvt_pk_bf16_f32 v131, v134, v135
v_mfma_f32_16x16x32_bf16 v[160:163], a[88:91], a[56:59], v[160:163]
ds_read_b64_tr_b16 a[84:85], v222 offset:9352
ds_read_b64_tr_b16 a[86:87], v222 offset:13960
v_mfma_f32_16x16x32_bf16 v[152:155], a[88:91], a[40:43], v[152:155]
buffer_store_dwordx4 v[128:131], v244, s[20:23], s39 offen offset:3072 sc0 sc1
v_mfma_f32_16x16x32_bf16 v[144:147], a[88:91], a[24:27], v[144:147]
s_lshl2_add_u32 s28, s32, s95
v_add_f32 v59, 1.0, v59
v_mfma_f32_16x16x32_bf16 v[136:139], a[88:91], a[8:11], v[136:139]
v_rcp_f32 v58, v58
v_mfma_f32_16x16x32_bf16 v[136:139], a[92:95], a[12:15], v[136:139]
ds_read_b64_tr_b16 a[88:89], v222 offset:18568
ds_read_b64_tr_b16 a[90:91], v222 offset:23176
v_mfma_f32_16x16x32_bf16 v[144:147], a[92:95], a[28:31], v[144:147]
v_rcp_f32 v59, v59
v_mfma_f32_16x16x32_bf16 v[152:155], a[92:95], a[44:47], v[152:155]
v_mul_f32 v56, v56, v58
v_mul_f32 v57, v57, v59
v_mfma_f32_16x16x32_bf16 v[160:163], a[92:95], a[60:63], v[160:163]
v_cvt_pk_bf16_f32 v58, v56, v57
v_lshlrev_b32 v56, 16, v58
s_waitcnt lgkmcnt(8)
v_mfma_f32_16x16x32_bf16 v[164:167], a[64:67], a[112:115], v[164:167]
ds_read_b64_tr_b16 a[92:93], v222 offset:27784
ds_read_b64_tr_b16 a[94:95], v222 offset:32392
v_mfma_f32_16x16x32_bf16 v[156:159], a[64:67], a[96:99], v[156:159]
v_and_b32 v57, 0xffff0000, v58
v_accvgpr_read_b32 v19, a212
v_mfma_f32_16x16x32_bf16 v[148:151], a[64:67], a[208:211], v[148:151]
v_lshlrev_b32 v18, 16, v19
v_and_b32 v19, 0xffff0000, v19
v_mfma_f32_16x16x32_bf16 v[140:143], a[64:67], a[192:195], v[140:143]
v_accvgpr_read_b32 v21, a213
v_lshlrev_b32 v20, 16, v21
v_mfma_f32_16x16x32_bf16 v[140:143], a[68:71], a[196:199], v[140:143]
ds_read_b64_tr_b16 a[64:65], v220 offset:128
ds_read_b64_tr_b16 a[66:67], v220 offset:4736
v_mfma_f32_16x16x32_bf16 v[148:151], a[68:71], a[244:247], v[148:151]
v_and_b32 v21, 0xffff0000, v21
v_accvgpr_read_b32 v23, a214
v_mfma_f32_16x16x32_bf16 v[156:159], a[68:71], a[100:103], v[156:159]
v_lshlrev_b32 v22, 16, v23
v_and_b32 v23, 0xffff0000, v23
v_mfma_f32_16x16x32_bf16 v[164:167], a[68:71], a[116:119], v[164:167]
v_accvgpr_read_b32 v25, a215
v_lshlrev_b32 v24, 16, v25
v_mfma_f32_16x16x32_bf16 v[164:167], a[72:75], a[120:123], v[164:167]
ds_read_b64_tr_b16 a[68:69], v220 offset:9344
ds_read_b64_tr_b16 a[70:71], v220 offset:13952
v_mfma_f32_16x16x32_bf16 v[156:159], a[72:75], a[104:107], v[156:159]
v_and_b32 v25, 0xffff0000, v25
v_accvgpr_read_b32 v27, a216
v_mfma_f32_16x16x32_bf16 v[148:151], a[72:75], a[248:251], v[148:151]
v_lshlrev_b32 v26, 16, v27
v_and_b32 v27, 0xffff0000, v27
v_mfma_f32_16x16x32_bf16 v[140:143], a[72:75], a[200:203], v[140:143]
v_accvgpr_read_b32 v29, a217
v_lshlrev_b32 v28, 16, v29
s_waitcnt lgkmcnt(8)
v_mfma_f32_16x16x32_bf16 v[140:143], a[76:79], a[204:207], v[140:143]
ds_read_b64_tr_b16 a[72:73], v220 offset:18560
ds_read_b64_tr_b16 a[74:75], v220 offset:23168
v_mfma_f32_16x16x32_bf16 v[148:151], a[76:79], a[252:255], v[148:151]
v_and_b32 v29, 0xffff0000, v29
v_accvgpr_read_b32 v31, a218
v_mfma_f32_16x16x32_bf16 v[156:159], a[76:79], a[108:111], v[156:159]
v_lshlrev_b32 v30, 16, v31
v_and_b32 v31, 0xffff0000, v31
v_mfma_f32_16x16x32_bf16 v[164:167], a[76:79], a[124:127], v[164:167]
v_accvgpr_read_b32 v33, a219
v_lshlrev_b32 v32, 16, v33
v_mfma_f32_16x16x32_bf16 v[164:167], a[80:83], a[48:51], v[164:167]
ds_read_b64_tr_b16 a[76:77], v220 offset:27776
ds_read_b64_tr_b16 a[78:79], v220 offset:32384
v_mfma_f32_16x16x32_bf16 v[156:159], a[80:83], a[32:35], v[156:159]
v_and_b32 v33, 0xffff0000, v33
v_accvgpr_read_b32 v35, a220
v_mfma_f32_16x16x32_bf16 v[148:151], a[80:83], a[16:19], v[148:151]
s_waitcnt vmcnt(0)
buffer_store_dword v231, v254, s[20:23], s28 offen sc0 sc1
v_mfma_f32_16x16x32_bf16 v[140:143], a[80:83], a[0:3], v[140:143]
v_lshlrev_b32 v34, 16, v35
v_and_b32 v35, 0xffff0000, v35
v_mfma_f32_16x16x32_bf16 v[140:143], a[84:87], a[4:7], v[140:143]
ds_read_b64_tr_b16 a[80:81], v223 offset:128
ds_read_b64_tr_b16 a[82:83], v223 offset:4736
v_mfma_f32_16x16x32_bf16 v[148:151], a[84:87], a[20:23], v[148:151]
v_accvgpr_read_b32 v37, a221
v_lshlrev_b32 v36, 16, v37
v_mfma_f32_16x16x32_bf16 v[156:159], a[84:87], a[36:39], v[156:159]
v_and_b32 v37, 0xffff0000, v37
v_mfma_f32_16x16x32_bf16 v[164:167], a[84:87], a[52:55], v[164:167]
s_mov_b32 s90, 0x3f80
s_mov_b32 s91, 0x3f800000
s_waitcnt lgkmcnt(8)
v_mfma_f32_16x16x32_bf16 v[164:167], a[88:91], a[56:59], v[164:167]
ds_read_b64_tr_b16 a[84:85], v223 offset:9344
ds_read_b64_tr_b16 a[86:87], v223 offset:13952
v_mfma_f32_16x16x32_bf16 v[156:159], a[88:91], a[40:43], v[156:159]
v_mov_b32 v66, 0
v_mov_b32 v67, 0
v_mfma_f32_16x16x32_bf16 v[148:151], a[88:91], a[24:27], v[148:151]
v_mov_b32 v68, 0
v_mov_b32 v69, 0
v_mfma_f32_16x16x32_bf16 v[140:143], a[88:91], a[8:11], v[140:143]
v_mfma_f32_16x16x32_bf16 v[140:143], a[92:95], a[12:15], v[140:143]
ds_read_b64_tr_b16 a[88:89], v223 offset:18560
ds_read_b64_tr_b16 a[90:91], v223 offset:23168
v_mfma_f32_16x16x32_bf16 v[148:151], a[92:95], a[28:31], v[148:151]
v_mfma_f32_16x16x32_bf16 v[156:159], a[92:95], a[44:47], v[156:159]
v_mfma_f32_16x16x32_bf16 v[164:167], a[92:95], a[60:63], v[164:167]
v_mfma_f32_16x16x32_bf16 v[192:195], a[64:67], a[112:115], v[192:195]
ds_read_b64_tr_b16 a[92:93], v223 offset:27776
ds_read_b64_tr_b16 a[94:95], v223 offset:32384
v_mfma_f32_16x16x32_bf16 v[184:187], a[64:67], a[96:99], v[184:187]
v_mfma_f32_16x16x32_bf16 v[176:179], a[64:67], a[208:211], v[176:179]
v_mfma_f32_16x16x32_bf16 v[168:171], a[64:67], a[192:195], v[168:171]
s_waitcnt lgkmcnt(8)
v_mfma_f32_16x16x32_bf16 v[168:171], a[68:71], a[196:199], v[168:171]
ds_read_b64_tr_b16 a[64:65], v220 offset:136
ds_read_b64_tr_b16 a[66:67], v220 offset:4744
v_mfma_f32_16x16x32_bf16 v[176:179], a[68:71], a[244:247], v[176:179]
v_mfma_f32_16x16x32_bf16 v[184:187], a[68:71], a[100:103], v[184:187]
v_mfma_f32_16x16x32_bf16 v[192:195], a[68:71], a[116:119], v[192:195]
v_mfma_f32_16x16x32_bf16 v[192:195], a[72:75], a[120:123], v[192:195]
ds_read_b64_tr_b16 a[68:69], v220 offset:9352
ds_read_b64_tr_b16 a[70:71], v220 offset:13960
v_mfma_f32_16x16x32_bf16 v[184:187], a[72:75], a[104:107], v[184:187]
s_add_u32 s39, s44, 8192
v_mfma_f32_16x16x32_bf16 v[176:179], a[72:75], a[248:251], v[176:179]
v_cvt_pk_bf16_f32 v144, v144, v145
v_cvt_pk_bf16_f32 v145, v146, v147
v_mfma_f32_16x16x32_bf16 v[168:171], a[72:75], a[200:203], v[168:171]
v_cvt_pk_bf16_f32 v146, v148, v149
v_cvt_pk_bf16_f32 v147, v150, v151
v_mfma_f32_16x16x32_bf16 v[168:171], a[76:79], a[204:207], v[168:171]
ds_read_b64_tr_b16 a[72:73], v220 offset:18568
ds_read_b64_tr_b16 a[74:75], v220 offset:23176
v_mfma_f32_16x16x32_bf16 v[176:179], a[76:79], a[252:255], v[176:179]
buffer_store_dwordx4 v[144:147], v244, s[20:23], s39 offen offset:1024 sc0 sc1
v_mfma_f32_16x16x32_bf16 v[184:187], a[76:79], a[108:111], v[184:187]
v_cvt_pk_bf16_f32 v152, v152, v153
v_cvt_pk_bf16_f32 v153, v154, v155
v_mfma_f32_16x16x32_bf16 v[192:195], a[76:79], a[124:127], v[192:195]
v_cvt_pk_bf16_f32 v154, v156, v157
v_cvt_pk_bf16_f32 v155, v158, v159
s_waitcnt lgkmcnt(8)
v_mfma_f32_16x16x32_bf16 v[192:195], a[80:83], a[48:51], v[192:195]
ds_read_b64_tr_b16 a[76:77], v220 offset:27784
ds_read_b64_tr_b16 a[78:79], v220 offset:32392
v_mfma_f32_16x16x32_bf16 v[184:187], a[80:83], a[32:35], v[184:187]
buffer_store_dwordx4 v[152:155], v244, s[20:23], s39 offen offset:2048 sc0 sc1
v_mfma_f32_16x16x32_bf16 v[176:179], a[80:83], a[16:19], v[176:179]
v_cvt_pk_bf16_f32 v160, v160, v161
v_cvt_pk_bf16_f32 v161, v162, v163
v_mfma_f32_16x16x32_bf16 v[168:171], a[80:83], a[0:3], v[168:171]
v_cvt_pk_bf16_f32 v162, v164, v165
v_cvt_pk_bf16_f32 v163, v166, v167
v_mfma_f32_16x16x32_bf16 v[168:171], a[84:87], a[4:7], v[168:171]
ds_read_b64_tr_b16 a[80:81], v223 offset:136
ds_read_b64_tr_b16 a[82:83], v223 offset:4744
v_mfma_f32_16x16x32_bf16 v[176:179], a[84:87], a[20:23], v[176:179]
buffer_store_dwordx4 v[160:163], v244, s[20:23], s39 offen offset:3072 sc0 sc1
v_mfma_f32_16x16x32_bf16 v[184:187], a[84:87], a[36:39], v[184:187]
buffer_load_dword v230, v229, s[20:23], s95 offen sc0 sc1
v_mfma_f32_16x16x32_bf16 v[192:195], a[84:87], a[52:55], v[192:195]
v_mfma_f32_16x16x32_bf16 v[192:195], a[88:91], a[56:59], v[192:195]
ds_read_b64_tr_b16 a[84:85], v223 offset:9352
ds_read_b64_tr_b16 a[86:87], v223 offset:13960
v_mfma_f32_16x16x32_bf16 v[184:187], a[88:91], a[40:43], v[184:187]
v_mfma_f32_16x16x32_bf16 v[176:179], a[88:91], a[24:27], v[176:179]
v_mfma_f32_16x16x32_bf16 v[168:171], a[88:91], a[8:11], v[168:171]
s_waitcnt lgkmcnt(8)
v_mfma_f32_16x16x32_bf16 v[168:171], a[92:95], a[12:15], v[168:171]
ds_read_b64_tr_b16 a[88:89], v223 offset:18568
ds_read_b64_tr_b16 a[90:91], v223 offset:23176
v_mfma_f32_16x16x32_bf16 v[176:179], a[92:95], a[28:31], v[176:179]
v_mfma_f32_16x16x32_bf16 v[184:187], a[92:95], a[44:47], v[184:187]
v_mfma_f32_16x16x32_bf16 v[192:195], a[92:95], a[60:63], v[192:195]
v_mfma_f32_16x16x32_bf16 v[196:199], a[64:67], a[112:115], v[196:199]
ds_read_b64_tr_b16 a[92:93], v223 offset:27784
ds_read_b64_tr_b16 a[94:95], v223 offset:32392
v_mfma_f32_16x16x32_bf16 v[188:191], a[64:67], a[96:99], v[188:191]
v_mfma_f32_16x16x32_bf16 v[180:183], a[64:67], a[208:211], v[180:183]
v_mfma_f32_16x16x32_bf16 v[172:175], a[64:67], a[192:195], v[172:175]
v_mfma_f32_16x16x32_bf16 v[172:175], a[68:71], a[196:199], v[172:175]
v_mfma_f32_16x16x32_bf16 v[180:183], a[68:71], a[244:247], v[180:183]
v_mfma_f32_16x16x32_bf16 v[188:191], a[68:71], a[100:103], v[188:191]
v_mfma_f32_16x16x32_bf16 v[196:199], a[68:71], a[116:119], v[196:199]
s_waitcnt lgkmcnt(8)
v_mfma_f32_16x16x32_bf16 v[196:199], a[72:75], a[120:123], v[196:199]
v_mfma_f32_16x16x32_bf16 v[188:191], a[72:75], a[104:107], v[188:191]
v_mfma_f32_16x16x32_bf16 v[180:183], a[72:75], a[248:251], v[180:183]
v_mfma_f32_16x16x32_bf16 v[172:175], a[72:75], a[200:203], v[172:175]
v_mfma_f32_16x16x32_bf16 v[172:175], a[76:79], a[204:207], v[172:175]
v_mfma_f32_16x16x32_bf16 v[180:183], a[76:79], a[252:255], v[180:183]
v_mfma_f32_16x16x32_bf16 v[188:191], a[76:79], a[108:111], v[188:191]
s_waitcnt vmcnt(0)
v_cmp_gt_u32 vcc, 1, v230
v_mfma_f32_16x16x32_bf16 v[196:199], a[76:79], a[124:127], v[196:199]
s_waitcnt lgkmcnt(6)
v_mfma_f32_16x16x32_bf16 v[196:199], a[80:83], a[48:51], v[196:199]
s_and_b32 s29, vcc_lo, 0xff
s_cbranch_scc1 SP_P1B
SP_P1B_RET:
v_mfma_f32_16x16x32_bf16 v[188:191], a[80:83], a[32:35], v[188:191]
buffer_load_dwordx4 v[104:107], v244, s[20:23], s65 offen offset:3072 sc0 sc1
v_mfma_f32_16x16x32_bf16 v[180:183], a[80:83], a[16:19], v[180:183]
buffer_load_dwordx4 v[108:111], v244, s[20:23], s66 offen offset:2048 sc0 sc1
v_mfma_f32_16x16x32_bf16 v[172:175], a[80:83], a[0:3], v[172:175]
buffer_load_dwordx4 v[112:115], v244, s[20:23], s67 offen offset:1024 sc0 sc1
s_waitcnt lgkmcnt(4)
v_mfma_f32_16x16x32_bf16 v[172:175], a[84:87], a[4:7], v[172:175]
buffer_load_dwordx4 v[116:119], v244, s[20:23], s68 offen offset:0 sc0 sc1
v_mfma_f32_16x16x32_bf16 v[180:183], a[84:87], a[20:23], v[180:183]
buffer_load_dwordx4 v[120:123], v244, s[20:23], s69 offen offset:3072 sc0 sc1
v_mfma_f32_16x16x32_bf16 v[188:191], a[84:87], a[36:39], v[188:191]
buffer_load_dwordx4 v[124:127], v244, s[20:23], s70 offen offset:2048 sc0 sc1
v_mfma_f32_16x16x32_bf16 v[196:199], a[84:87], a[52:55], v[196:199]
buffer_load_dwordx4 v[128:131], v244, s[20:23], s71 offen offset:1024 sc0 sc1
s_waitcnt lgkmcnt(2)
v_mfma_f32_16x16x32_bf16 v[196:199], a[88:91], a[56:59], v[196:199]
v_mfma_f32_16x16x32_bf16 v[188:191], a[88:91], a[40:43], v[188:191]
v_mfma_f32_16x16x32_bf16 v[180:183], a[88:91], a[24:27], v[180:183]
v_mfma_f32_16x16x32_bf16 v[172:175], a[88:91], a[8:11], v[172:175]
s_waitcnt lgkmcnt(0)
v_mfma_f32_16x16x32_bf16 v[172:175], a[92:95], a[12:15], v[172:175]
v_mfma_f32_16x16x32_bf16 v[180:183], a[92:95], a[28:31], v[180:183]
v_mfma_f32_16x16x32_bf16 v[188:191], a[92:95], a[44:47], v[188:191]
v_mfma_f32_16x16x32_bf16 v[196:199], a[92:95], a[60:63], v[196:199]
s_add_u32 s39, s44, 12288
s_nop 5
v_cvt_pk_bf16_f32 v168, v168, v169
v_cvt_pk_bf16_f32 v169, v170, v171
v_cvt_pk_bf16_f32 v170, v172, v173
v_cvt_pk_bf16_f32 v171, v174, v175
buffer_store_dwordx4 v[168:171], v244, s[20:23], s39 offen offset:0 sc0 sc1
v_cvt_pk_bf16_f32 v176, v176, v177
v_cvt_pk_bf16_f32 v177, v178, v179
v_cvt_pk_bf16_f32 v178, v180, v181
v_cvt_pk_bf16_f32 v179, v182, v183
buffer_store_dwordx4 v[176:179], v244, s[20:23], s39 offen offset:1024 sc0 sc1
v_cvt_pk_bf16_f32 v184, v184, v185
v_cvt_pk_bf16_f32 v185, v186, v187
v_cvt_pk_bf16_f32 v186, v188, v189
v_cvt_pk_bf16_f32 v187, v190, v191
buffer_store_dwordx4 v[184:187], v244, s[20:23], s39 offen offset:2048 sc0 sc1
v_cvt_pk_bf16_f32 v192, v192, v193
v_cvt_pk_bf16_f32 v193, v194, v195
v_cvt_pk_bf16_f32 v194, v196, v197
v_cvt_pk_bf16_f32 v195, v198, v199
buffer_store_dwordx4 v[192:195], v244, s[20:23], s39 offen offset:3072 sc0 sc1
buffer_load_dwordx2 v[200:201], v226, s[20:23], s72 offen offset:0 sc0 sc1
buffer_load_dwordx2 v[202:203], v226, s[20:23], s73 offen offset:512 sc0 sc1
buffer_load_dwordx2 v[204:205], v226, s[20:23], s74 offen offset:0 sc0 sc1
buffer_load_dwordx2 v[206:207], v226, s[20:23], s75 offen offset:512 sc0 sc1
buffer_load_dwordx2 v[208:209], v226, s[20:23], s84 offen offset:0 sc0 sc1
buffer_load_dwordx2 v[210:211], v226, s[20:23], s85 offen offset:512 sc0 sc1
buffer_load_dwordx2 v[212:213], v226, s[20:23], s86 offen offset:0 sc0 sc1
buffer_load_dwordx2 v[214:215], v226, s[20:23], s87 offen offset:512 sc0 sc1
s_waitcnt vmcnt(8)
buffer_store_dword v246, v254, s[20:23], s28 offen sc0 sc1
buffer_load_dword v230, v229, s[20:23], s95 offen sc0 sc1
s_waitcnt vmcnt(20)
v_dot2c_f32_bf16 v72, s90, v104
v_dot2c_f32_bf16 v73, s91, v104
v_dot2c_f32_bf16 v74, s90, v105
v_dot2c_f32_bf16 v75, s91, v105
v_dot2c_f32_bf16 v76, s90, v106
v_dot2c_f32_bf16 v77, s91, v106
v_dot2c_f32_bf16 v78, s90, v107
v_dot2c_f32_bf16 v79, s91, v107
s_waitcnt vmcnt(19)
v_dot2c_f32_bf16 v72, s90, v108
v_dot2c_f32_bf16 v73, s91, v108
v_dot2c_f32_bf16 v74, s90, v109
v_dot2c_f32_bf16 v75, s91, v109
v_dot2c_f32_bf16 v76, s90, v110
v_dot2c_f32_bf16 v77, s91, v110
v_dot2c_f32_bf16 v78, s90, v111
v_dot2c_f32_bf16 v79, s91, v111
s_waitcnt vmcnt(18)
v_dot2c_f32_bf16 v72, s90, v112
v_dot2c_f32_bf16 v73, s91, v112
v_dot2c_f32_bf16 v74, s90, v113
v_dot2c_f32_bf16 v75, s91, v113
v_dot2c_f32_bf16 v76, s90, v114
v_dot2c_f32_bf16 v77, s91, v114
v_dot2c_f32_bf16 v78, s90, v115
v_dot2c_f32_bf16 v79, s91, v115
s_waitcnt vmcnt(17)
v_dot2c_f32_bf16 v72, s90, v116
v_dot2c_f32_bf16 v73, s91, v116
v_dot2c_f32_bf16 v74, s90, v117
v_dot2c_f32_bf16 v75, s91, v117
v_dot2c_f32_bf16 v76, s90, v118
v_dot2c_f32_bf16 v77, s91, v118
v_dot2c_f32_bf16 v78, s90, v119
v_dot2c_f32_bf16 v79, s91, v119
s_waitcnt vmcnt(16)
v_dot2c_f32_bf16 v72, s90, v120
v_dot2c_f32_bf16 v73, s91, v120
v_dot2c_f32_bf16 v74, s90, v121
v_dot2c_f32_bf16 v75, s91, v121
v_dot2c_f32_bf16 v76, s90, v122
v_dot2c_f32_bf16 v77, s91, v122
v_dot2c_f32_bf16 v78, s90, v123
v_dot2c_f32_bf16 v79, s91, v123
s_waitcnt vmcnt(15)
v_dot2c_f32_bf16 v72, s90, v124
v_dot2c_f32_bf16 v73, s91, v124
v_dot2c_f32_bf16 v74, s90, v125
v_dot2c_f32_bf16 v75, s91, v125
v_dot2c_f32_bf16 v76, s90, v126
v_dot2c_f32_bf16 v77, s91, v126
v_dot2c_f32_bf16 v78, s90, v127
v_dot2c_f32_bf16 v79, s91, v127
s_waitcnt vmcnt(14)
v_dot2c_f32_bf16 v72, s90, v128
v_dot2c_f32_bf16 v73, s91, v128
v_dot2c_f32_bf16 v74, s90, v129
v_dot2c_f32_bf16 v75, s91, v129
v_dot2c_f32_bf16 v76, s90, v130
v_dot2c_f32_bf16 v77, s91, v130
v_dot2c_f32_bf16 v78, s90, v131
v_dot2c_f32_bf16 v79, s91, v131
s_nop 2
v_cvt_pk_bf16_f32 v58, v72, v73
v_cvt_pk_bf16_f32 v59, v74, v75
v_cvt_pk_bf16_f32 v60, v76, v77
v_cvt_pk_bf16_f32 v61, v78, v79
v_lshlrev_b32 v72, 16, v58
v_and_b32 v73, 0xffff0000, v58
v_lshlrev_b32 v74, 16, v59
v_and_b32 v75, 0xffff0000, v59
v_lshlrev_b32 v76, 16, v60
v_and_b32 v77, 0xffff0000, v60
v_lshlrev_b32 v78, 16, v61
v_and_b32 v79, 0xffff0000, v61
v_pk_mul_f32 v[72:73], v[72:73], v[38:39]
v_pk_mul_f32 v[74:75], v[74:75], v[40:41]
v_pk_mul_f32 v[76:77], v[76:77], v[42:43]
v_pk_mul_f32 v[78:79], v[78:79], v[44:45]
v_cvt_pk_bf16_f32 v58, v72, v73
v_cvt_pk_bf16_f32 v59, v74, v75
v_cvt_pk_bf16_f32 v60, v76, v77
v_cvt_pk_bf16_f32 v61, v78, v79
v_lshlrev_b32 v72, 16, v58
v_and_b32 v73, 0xffff0000, v58
v_lshlrev_b32 v74, 16, v59
v_and_b32 v75, 0xffff0000, v59
v_lshlrev_b32 v76, 16, v60
v_and_b32 v77, 0xffff0000, v60
v_lshlrev_b32 v78, 16, v61
v_and_b32 v79, 0xffff0000, v61
v_pk_add_f32 v[72:73], v[72:73], v[18:19]
v_pk_add_f32 v[74:75], v[74:75], v[20:21]
v_pk_add_f32 v[76:77], v[76:77], v[22:23]
v_pk_add_f32 v[78:79], v[78:79], v[24:25]
v_cvt_pk_bf16_f32 v72, v72, v73
v_cvt_pk_bf16_f32 v73, v74, v75
v_cvt_pk_bf16_f32 v74, v76, v77
v_cvt_pk_bf16_f32 v75, v78, v79
buffer_store_dwordx4 v[72:75], v248, s[60:63], 0 offen
s_waitcnt vmcnt(1)
v_cmp_gt_u32 vcc, 2, v230
s_nop 0
s_and_b32 s29, vcc_lo, 0xff
s_cbranch_scc0 SP_P2B_RET
SP_P2B:
s_sleep 0
s_add_u32 s100, s100, 1
s_bitcmp1_b32 s100, 19
s_cbranch_scc1 K_END
buffer_load_dword v230, v229, s[20:23], s95 offen sc0 sc1
s_waitcnt vmcnt(0)
v_cmp_gt_u32 vcc, 2, v230
s_nop 0
s_and_b32 s29, vcc_lo, 0xff
s_cbranch_scc1 SP_P2B
SP_P2B_RET:
buffer_load_dwordx4 v[80:83], v243, s[20:23], s65 offen offset:3072 sc0 sc1
buffer_load_dwordx4 v[84:87], v243, s[20:23], s66 offen offset:2048 sc0 sc1
buffer_load_dwordx4 v[88:91], v243, s[20:23], s67 offen offset:1024 sc0 sc1
buffer_load_dwordx4 v[92:95], v243, s[20:23], s68 offen offset:0 sc0 sc1
buffer_load_dwordx4 v[96:99], v243, s[20:23], s69 offen offset:3072 sc0 sc1
buffer_load_dwordx4 v[100:103], v243, s[20:23], s70 offen offset:2048 sc0 sc1
buffer_load_dwordx4 v[132:135], v243, s[20:23], s71 offen offset:1024 sc0 sc1
s_waitcnt vmcnt(17)
v_dot2c_f32_bf16 v66, s90, v200
v_dot2c_f32_bf16 v67, s91, v200
v_dot2c_f32_bf16 v68, s90, v201
v_dot2c_f32_bf16 v69, s91, v201
s_waitcnt vmcnt(16)
v_dot2c_f32_bf16 v66, s90, v202
v_dot2c_f32_bf16 v67, s91, v202
v_dot2c_f32_bf16 v68, s90, v203
v_dot2c_f32_bf16 v69, s91, v203
s_waitcnt vmcnt(15)
v_dot2c_f32_bf16 v66, s90, v204
v_dot2c_f32_bf16 v67, s91, v204
v_dot2c_f32_bf16 v68, s90, v205
v_dot2c_f32_bf16 v69, s91, v205
s_waitcnt vmcnt(14)
v_dot2c_f32_bf16 v66, s90, v206
v_dot2c_f32_bf16 v67, s91, v206
v_dot2c_f32_bf16 v68, s90, v207
v_dot2c_f32_bf16 v69, s91, v207
s_waitcnt vmcnt(13)
v_dot2c_f32_bf16 v66, s90, v208
v_dot2c_f32_bf16 v67, s91, v208
v_dot2c_f32_bf16 v68, s90, v209
v_dot2c_f32_bf16 v69, s91, v209
s_waitcnt vmcnt(12)
v_dot2c_f32_bf16 v66, s90, v210
v_dot2c_f32_bf16 v67, s91, v210
v_dot2c_f32_bf16 v68, s90, v211
v_dot2c_f32_bf16 v69, s91, v211
s_waitcnt vmcnt(11)
v_dot2c_f32_bf16 v66, s90, v212
v_dot2c_f32_bf16 v67, s91, v212
v_dot2c_f32_bf16 v68, s90, v213
v_dot2c_f32_bf16 v69, s91, v213
s_waitcnt vmcnt(10)
v_dot2c_f32_bf16 v66, s90, v214
v_dot2c_f32_bf16 v67, s91, v214
v_dot2c_f32_bf16 v68, s90, v215
v_dot2c_f32_bf16 v69, s91, v215
s_nop 2
s_cmp_eq_u32 s34, 0
s_cselect_b32 s29, 0, 0x7fbffff0
v_cvt_pk_bf16_f32 v58, v66, v67
v_cvt_pk_bf16_f32 v59, v68, v69
v_lshlrev_b32 v66, 16, v58
v_and_b32 v67, 0xffff0000, v58
v_lshlrev_b32 v68, 16, v59
v_and_b32 v69, 0xffff0000, v59
v_pk_mul_f32 v[66:67], v[66:67], v[54:55]
v_pk_mul_f32 v[68:69], v[68:69], v[56:57]
v_cvt_pk_bf16_f32 v58, v66, v67
v_cvt_pk_bf16_f32 v59, v68, v69
v_lshlrev_b32 v66, 16, v58
v_and_b32 v67, 0xffff0000, v58
v_lshlrev_b32 v68, 16, v59
v_and_b32 v69, 0xffff0000, v59
v_pk_add_f32 v[66:67], v[66:67], v[34:35]
v_pk_add_f32 v[68:69], v[68:69], v[36:37]
v_cvt_pk_bf16_f32 v66, v66, v67
v_cvt_pk_bf16_f32 v67, v68, v69
buffer_store_dwordx2 v[66:67], v249, s[60:63], s29 offen
s_waitcnt vmcnt(7)
v_dot2c_f32_bf16 v136, s90, v80
v_dot2c_f32_bf16 v137, s91, v80
v_dot2c_f32_bf16 v138, s90, v81
v_dot2c_f32_bf16 v139, s91, v81
v_dot2c_f32_bf16 v140, s90, v82
v_dot2c_f32_bf16 v141, s91, v82
v_dot2c_f32_bf16 v142, s90, v83
v_dot2c_f32_bf16 v143, s91, v83
s_waitcnt vmcnt(6)
v_dot2c_f32_bf16 v136, s90, v84
v_dot2c_f32_bf16 v137, s91, v84
v_dot2c_f32_bf16 v138, s90, v85
v_dot2c_f32_bf16 v139, s91, v85
v_dot2c_f32_bf16 v140, s90, v86
v_dot2c_f32_bf16 v141, s91, v86
v_dot2c_f32_bf16 v142, s90, v87
v_dot2c_f32_bf16 v143, s91, v87
s_waitcnt vmcnt(5)
v_dot2c_f32_bf16 v136, s90, v88
v_dot2c_f32_bf16 v137, s91, v88
v_dot2c_f32_bf16 v138, s90, v89
v_dot2c_f32_bf16 v139, s91, v89
v_dot2c_f32_bf16 v140, s90, v90
v_dot2c_f32_bf16 v141, s91, v90
v_dot2c_f32_bf16 v142, s90, v91
v_dot2c_f32_bf16 v143, s91, v91
s_waitcnt vmcnt(4)
v_dot2c_f32_bf16 v136, s90, v92
v_dot2c_f32_bf16 v137, s91, v92
v_dot2c_f32_bf16 v138, s90, v93
v_dot2c_f32_bf16 v139, s91, v93
v_dot2c_f32_bf16 v140, s90, v94
v_dot2c_f32_bf16 v141, s91, v94
v_dot2c_f32_bf16 v142, s90, v95
v_dot2c_f32_bf16 v143, s91, v95
s_waitcnt vmcnt(3)
v_dot2c_f32_bf16 v136, s90, v96
v_dot2c_f32_bf16 v137, s91, v96
v_dot2c_f32_bf16 v138, s90, v97
v_dot2c_f32_bf16 v139, s91, v97
v_dot2c_f32_bf16 v140, s90, v98
v_dot2c_f32_bf16 v141, s91, v98
v_dot2c_f32_bf16 v142, s90, v99
v_dot2c_f32_bf16 v143, s91, v99
s_waitcnt vmcnt(2)
v_dot2c_f32_bf16 v136, s90, v100
v_dot2c_f32_bf16 v137, s91, v100
v_dot2c_f32_bf16 v138, s90, v101
v_dot2c_f32_bf16 v139, s91, v101
v_dot2c_f32_bf16 v140, s90, v102
v_dot2c_f32_bf16 v141, s91, v102
v_dot2c_f32_bf16 v142, s90, v103
v_dot2c_f32_bf16 v143, s91, v103
s_waitcnt vmcnt(1)
v_dot2c_f32_bf16 v136, s90, v132
v_dot2c_f32_bf16 v137, s91, v132
v_dot2c_f32_bf16 v138, s90, v133
v_dot2c_f32_bf16 v139, s91, v133
v_dot2c_f32_bf16 v140, s90, v134
v_dot2c_f32_bf16 v141, s91, v134
v_dot2c_f32_bf16 v142, s90, v135
v_dot2c_f32_bf16 v143, s91, v135
s_nop 2
v_cvt_pk_bf16_f32 v58, v136, v137
v_cvt_pk_bf16_f32 v59, v138, v139
v_cvt_pk_bf16_f32 v60, v140, v141
v_cvt_pk_bf16_f32 v61, v142, v143
v_lshlrev_b32 v136, 16, v58
v_and_b32 v137, 0xffff0000, v58
v_lshlrev_b32 v138, 16, v59
v_and_b32 v139, 0xffff0000, v59
v_lshlrev_b32 v140, 16, v60
v_and_b32 v141, 0xffff0000, v60
v_lshlrev_b32 v142, 16, v61
v_and_b32 v143, 0xffff0000, v61
v_pk_mul_f32 v[136:137], v[136:137], v[46:47]
v_pk_mul_f32 v[138:139], v[138:139], v[48:49]
v_pk_mul_f32 v[140:141], v[140:141], v[50:51]
v_pk_mul_f32 v[142:143], v[142:143], v[52:53]
v_cvt_pk_bf16_f32 v58, v136, v137
v_cvt_pk_bf16_f32 v59, v138, v139
v_cvt_pk_bf16_f32 v60, v140, v141
v_cvt_pk_bf16_f32 v61, v142, v143
v_lshlrev_b32 v136, 16, v58
v_and_b32 v137, 0xffff0000, v58
v_lshlrev_b32 v138, 16, v59
v_and_b32 v139, 0xffff0000, v59
v_lshlrev_b32 v140, 16, v60
v_and_b32 v141, 0xffff0000, v60
v_lshlrev_b32 v142, 16, v61
v_and_b32 v143, 0xffff0000, v61
v_pk_add_f32 v[136:137], v[136:137], v[26:27]
v_pk_add_f32 v[138:139], v[138:139], v[28:29]
v_pk_add_f32 v[140:141], v[140:141], v[30:31]
v_pk_add_f32 v[142:143], v[142:143], v[32:33]
v_cvt_pk_bf16_f32 v136, v136, v137
v_cvt_pk_bf16_f32 v137, v138, v139
v_cvt_pk_bf16_f32 v138, v140, v141
v_cvt_pk_bf16_f32 v139, v142, v143
buffer_store_dwordx4 v[136:139], v248, s[60:63], 0 offen offset:128
s_endpgm
SP_O1B:
s_sleep 1
s_add_u32 s100, s100, 1
s_bitcmp1_b32 s100, 19
s_cbranch_scc1 K_END
buffer_load_dword v230, v229, s[20:23], s94 offen sc0 sc1
s_waitcnt vmcnt(0)
v_cmp_gt_u32 vcc, 1, v230
s_bitcmp1_b32 vcc_lo, s39
s_cbranch_scc1 SP_O1B
s_branch SP_O1B_RET
SP_O2B:
s_sleep 1
s_add_u32 s100, s100, 1
s_bitcmp1_b32 s100, 19
s_cbranch_scc1 K_END
buffer_load_dword v230, v229, s[20:23], s94 offen sc0 sc1
s_waitcnt vmcnt(0)
v_cmp_gt_u32 vcc, 1, v230
s_and_b32 s29, vcc_lo, 15
s_cbranch_scc1 SP_O2B
s_branch SP_O2B_RET
SP_O3B:
s_sleep 1
s_add_u32 s100, s100, 1
s_bitcmp1_b32 s100, 19
s_cbranch_scc1 K_END
buffer_load_dword v230, v229, s[20:23], s94 offen sc0 sc1
s_waitcnt vmcnt(0)
v_cmp_gt_u32 vcc, 2, v230
s_and_b32 s29, vcc_lo, 15
s_cbranch_scc1 SP_O3B
s_branch SP_O3B_RET
SP_P1B:
s_sleep 1
s_add_u32 s100, s100, 1
s_bitcmp1_b32 s100, 19
s_cbranch_scc1 K_END
buffer_load_dword v230, v229, s[20:23], s95 offen sc0 sc1
s_waitcnt vmcnt(0)
v_cmp_gt_u32 vcc, 1, v230
s_and_b32 s29, vcc_lo, 0xff
s_cbranch_scc1 SP_P1B
s_branch SP_P1B_RET
F_NOTYET:
s_bitcmp1_b32 s51, 30
s_cbranch_scc1 F_BSENT
s_bitset1_b32 s51, 30
s_mov_b32 s50, s28
s_add_u32 s28, s45, 0x0
buffer_store_dwordx4 v[72:75], v169, s[20:23], s28 offen offset:0 sc0 sc1
buffer_store_dwordx4 v[76:79], v169, s[20:23], s28 offen offset:2048 sc0 sc1
s_add_u32 s28, s28, 4096
buffer_store_dwordx4 v[80:83], v169, s[20:23], s28 offen offset:0 sc0 sc1
buffer_store_dwordx4 v[84:87], v169, s[20:23], s28 offen offset:2048 sc0 sc1
s_add_u32 s28, s28, 4096
buffer_store_dwordx4 v[88:91], v169, s[20:23], s28 offen offset:0 sc0 sc1
buffer_store_dwordx4 v[92:95], v169, s[20:23], s28 offen offset:2048 sc0 sc1
s_add_u32 s28, s28, 4096
buffer_store_dwordx4 v[96:99], v169, s[20:23], s28 offen offset:0 sc0 sc1
buffer_store_dwordx4 v[100:103], v169, s[20:23], s28 offen offset:2048 sc0 sc1
s_add_u32 s28, s28, 4096
buffer_store_dwordx4 v[104:107], v169, s[20:23], s28 offen offset:0 sc0 sc1
s_lshl_b32 s28, s3, 2
s_add_u32 s28, s28, 0x240000
buffer_store_dword v65, v64, s[20:23], s28 offen sc0 sc1
s_mul_i32 s28, s3, 1152
s_add_u32 s28, s28, 0x1c00000
v_add_u32 v62, 0, v1
v_mul_u32_u24 v63, 911, v62
v_lshrrev_b32 v63, 16, v63
v_add_u32 v62, v62, v63
v_lshlrev_b32 v62, 4, v62
v_add_u32 v62, 0x24000, v62
ds_read_b128 v[112:115], v62
s_waitcnt lgkmcnt(0)
buffer_store_dwordx4 v[112:115], v244, s[20:23], s28 offen sc0 sc1
s_add_u32 s28, s28, 1024
v_add_u32 v62, 64, v1
v_mul_u32_u24 v63, 911, v62
v_lshrrev_b32 v63, 16, v63
v_add_u32 v62, v62, v63
v_lshlrev_b32 v62, 4, v62
v_add_u32 v62, 0x24000, v62
ds_read_b128 v[116:119], v62
s_waitcnt lgkmcnt(0)
buffer_store_dwordx4 v[116:119], v244, s[20:23], s28 offen sc0 sc1
s_add_u32 s28, s28, 1024
v_add_u32 v62, 128, v1
v_mul_u32_u24 v63, 911, v62
v_lshrrev_b32 v63, 16, v63
v_add_u32 v62, v62, v63
v_lshlrev_b32 v62, 4, v62
v_add_u32 v62, 0x24000, v62
ds_read_b128 v[112:115], v62
s_waitcnt lgkmcnt(0)
buffer_store_dwordx4 v[112:115], v244, s[20:23], s28 offen sc0 sc1
s_add_u32 s28, s28, 1024
v_add_u32 v62, 192, v1
v_mul_u32_u24 v63, 911, v62
v_lshrrev_b32 v63, 16, v63
v_add_u32 v62, v62, v63
v_lshlrev_b32 v62, 4, v62
v_add_u32 v62, 0x24000, v62
ds_read_b128 v[116:119], v62
s_waitcnt lgkmcnt(0)
buffer_store_dwordx4 v[116:119], v244, s[20:23], s28 offen sc0 sc1
s_add_u32 s28, s28, 1024
v_add_u32 v62, 256, v1
v_mul_u32_u24 v63, 911, v62
v_lshrrev_b32 v63, 16, v63
v_add_u32 v62, v62, v63
v_lshlrev_b32 v62, 4, v62
v_add_u32 v62, 0x24000, v62
ds_read_b128 v[112:115], v62
s_waitcnt lgkmcnt(0)
buffer_store_dwordx4 v[112:115], v244, s[20:23], s28 offen sc0 sc1
s_add_u32 s28, s28, 1024
v_add_u32 v62, 320, v1
v_mul_u32_u24 v63, 911, v62
v_lshrrev_b32 v63, 16, v63
v_add_u32 v62, v62, v63
v_lshlrev_b32 v62, 4, v62
v_add_u32 v62, 0x24000, v62
ds_read_b128 v[116:119], v62
s_waitcnt lgkmcnt(0)
buffer_store_dwordx4 v[116:119], v244, s[20:23], s28 offen sc0 sc1
s_add_u32 s28, s28, 1024
v_add_u32 v62, 384, v1
v_mul_u32_u24 v63, 911, v62
v_lshrrev_b32 v63, 16, v63
v_add_u32 v62, v62, v63
v_lshlrev_b32 v62, 4, v62
v_add_u32 v62, 0x24000, v62
ds_read_b128 v[112:115], v62
s_waitcnt lgkmcnt(0)
buffer_store_dwordx4 v[112:115], v244, s[20:23], s28 offen sc0 sc1
s_add_u32 s28, s28, 1024
v_add_u32 v62, 448, v1
v_mul_u32_u24 v63, 911, v62
v_lshrrev_b32 v63, 16, v63
v_add_u32 v62, v62, v63
v_lshlrev_b32 v62, 4, v62
v_add_u32 v62, 0x24000, v62
ds_read_b128 v[116:119], v62
s_waitcnt lgkmcnt(0)
buffer_store_dwordx4 v[116:119], v244, s[20:23], s28 offen sc0 sc1
s_add_u32 s28, s28, 1024
v_add_u32 v62, 512, v1
v_mul_u32_u24 v63, 911, v62
v_lshrrev_b32 v63, 16, v63
v_add_u32 v62, v62, v63
v_lshlrev_b32 v62, 4, v62
v_add_u32 v62, 0x24000, v62
ds_read_b128 v[112:115], v62
s_waitcnt lgkmcnt(0)
buffer_store_dwordx4 v[112:115], v244, s[20:23], s28 offen sc0 sc1
s_add_u32 s28, s28, 1024
s_lshl_b32 s92, s36, 9
s_lshr_b32 s93, s35, 2
s_and_b32 s94, s35, 3
s_lshl_b32 s95, s93, 6
s_add_u32 s95, s95, s92
s_lshl2_add_u32 s95, s94, s95
s_add_u32 s95, s95, 0x248000
v_lshlrev_b32 v170, 4, v1
v_add_u32 v170, s95, v170
s_lshl_b32 s95, s94, 7
s_add_u32 s95, s95, s92
s_lshl2_add_u32 s95, s93, s95
s_add_u32 s95, s95, 0x249f80
v_lshlrev_b32 v62, 5, v1
v_add_u32 v62, s95, v62
v_cmp_lt_u32 vcc, 3, v1
s_nop 1
v_cndmask_b32 v170, v170, v62, vcc
s_mov_b32 s95, 0x7fffbff0
s_cmp_eq_u32 s2, 0
s_cselect_b32 s95, 0x242c00, s95
v_lshlrev_b32 v62, 7, v1
v_add_u32 v62, s95, v62
v_cmp_lt_u32 vcc, 7, v1
s_nop 1
v_cndmask_b32 v170, v170, v62, vcc
v_mov_b32 v62, 0x7ffffff0
v_mov_b32 v171, 0
v_cmp_lt_u32 vcc, 9, v0
s_nop 1
v_cndmask_b32 v170, v170, v62, vcc
v_mov_b32 v254, 0x7ffffff0
s_lshl_b32 s92, s36, 5
s_add_u32 s92, s92, s35
s_cmp_eq_u32 s37, 0
s_cselect_b32 s92, s92, 0x7ffffff0
v_writelane_b32 v254, s92, 0
s_or_b32 s92, s38, 0x20
v_mov_b32 v255, s92
buffer_store_dword v171, v170, s[20:23], 0 offen sc0 sc1
s_mov_b32 s28, s50
s_mov_b32 s46, 0x7ffffff0
s_waitcnt vmcnt(0)
buffer_store_byte v255, v254, s[24:27], 0 offen sc0 sc1
F_BSENT:
s_lshl_b32 s29, s36, 5
buffer_load_dword v62, v64, s[24:27], s29 offen sc0 sc1
s_waitcnt vmcnt(0)
v_and_b32 v63, 0x20202020, v62
v_cmp_ne_u32 vcc, 0x20202020, v63
s_cbranch_vccnz F_NOB
s_or_b32 s29, s38, 0x20
s_mul_i32 s29, s29, 0x01010101
v_cmp_ne_u32 vcc, s29, v62
v_mov_b32 v60, 0
s_cbranch_vccnz F_GO
v_mov_b32 v60, 1
s_branch F_GO
F_NOB:
s_sleep 1
s_add_u32 s100, s100, 1
s_bitcmp1_b32 s100, 19
s_cbranch_scc1 K_END
s_branch F_POLL
Q_REDO:
s_mov_b32 s4, 0
s_mov_b32 s51, 0
s_waitcnt vmcnt(0) lgkmcnt(0)
s_branch Q_START
K_FALLBACK:
s_mov_b32 s43, 1
s_mov_b32 s3, 0
s_mov_b32 s86, 0x30000
s_mov_b32 s66, 0
s_mov_b32 s70, 0
s_mov_b32 s74, 0
s_waitcnt vmcnt(0) lgkmcnt(0)
s_barrier
v_mov_b32 v254, 0x7ffffff0
v_lshrrev_b32 v240, 2, v1
v_mul_u32_u24 v240, 0x2400, v240
v_and_b32 v246, 3, v1
v_lshl_add_u32 v240, v246, 4, v240
v_mul_u32_u24 v243, 3641, v1
v_lshrrev_b32 v243, 16, v243
v_mul_u32_u24 v243, 864, v243
v_add_u32 v243, v243, v244
v_mov_b32 v136, 0xff800000
v_mov_b32 v140, 0xff800000
v_mov_b32 v144, 0xff800000
v_mov_b32 v148, 0xff800000
s_mov_b32 s32, 0
s_mov_b32 s33, 32
K_FBLOOP:
s_add_u32 m0, s30, 81920
s_nop 0
buffer_load_dwordx4 v228, s[8:11], s32 offen offset:0  lds
buffer_load_dwordx4 v229, s[8:11], s32 offen offset:1024  lds
buffer_load_dwordx4 v230, s[8:11], s32 offen offset:2048  lds
buffer_load_dwordx4 v231, s[8:11], s32 offen offset:3072  lds
s_waitcnt vmcnt(0)
s_barrier
ds_read_b128 a[144:147], v216 offset:16384
ds_read_b128 a[148:151], v217 offset:16384
ds_read_b128 a[152:155], v218 offset:16384
ds_read_b128 a[156:159], v219 offset:16384
ds_read_b128 a[160:163], v216 offset:20480
ds_read_b128 a[164:167], v217 offset:20480
ds_read_b128 a[168:171], v218 offset:20480
ds_read_b128 a[172:175], v219 offset:20480
s_waitcnt lgkmcnt(0)
v_mfma_f32_16x16x32_bf16 v[8:11], a[144:147], v[152:155], 0
v_mfma_f32_16x16x32_bf16 v[16:19], a[144:147], v[168:171], 0
v_mfma_f32_16x16x32_bf16 v[24:27], a[144:147], v[184:187], 0
v_mfma_f32_16x16x32_bf16 v[32:35], a[144:147], v[200:203], 0
v_mfma_f32_16x16x32_bf16 v[8:11], a[148:151], v[156:159], v[8:11]
v_mfma_f32_16x16x32_bf16 v[16:19], a[148:151], v[172:175], v[16:19]
v_mfma_f32_16x16x32_bf16 v[24:27], a[148:151], v[188:191], v[24:27]
v_mfma_f32_16x16x32_bf16 v[32:35], a[148:151], v[204:207], v[32:35]
v_mfma_f32_16x16x32_bf16 v[8:11], a[152:155], v[160:163], v[8:11]
v_mfma_f32_16x16x32_bf16 v[16:19], a[152:155], v[176:179], v[16:19]
v_mfma_f32_16x16x32_bf16 v[24:27], a[152:155], v[192:195], v[24:27]
v_mfma_f32_16x16x32_bf16 v[32:35], a[152:155], v[208:211], v[32:35]
v_mfma_f32_16x16x32_bf16 v[8:11], a[156:159], v[164:167], v[8:11]
v_mfma_f32_16x16x32_bf16 v[16:19], a[156:159], v[180:183], v[16:19]
v_mfma_f32_16x16x32_bf16 v[24:27], a[156:159], v[196:199], v[24:27]
v_mfma_f32_16x16x32_bf16 v[32:35], a[156:159], v[212:215], v[32:35]
v_mfma_f32_16x16x32_bf16 v[12:15], a[160:163], v[152:155], 0
v_mfma_f32_16x16x32_bf16 v[20:23], a[160:163], v[168:171], 0
v_mfma_f32_16x16x32_bf16 v[28:31], a[160:163], v[184:187], 0
v_mfma_f32_16x16x32_bf16 v[36:39], a[160:163], v[200:203], 0
v_mfma_f32_16x16x32_bf16 v[12:15], a[164:167], v[156:159], v[12:15]
v_mfma_f32_16x16x32_bf16 v[20:23], a[164:167], v[172:175], v[20:23]
v_mfma_f32_16x16x32_bf16 v[28:31], a[164:167], v[188:191], v[28:31]
v_mfma_f32_16x16x32_bf16 v[36:39], a[164:167], v[204:207], v[36:39]
v_mfma_f32_16x16x32_bf16 v[12:15], a[168:171], v[160:163], v[12:15]
v_mfma_f32_16x16x32_bf16 v[20:23], a[168:171], v[176:179], v[20:23]
v_mfma_f32_16x16x32_bf16 v[28:31], a[168:171], v[192:195], v[28:31]
v_mfma_f32_16x16x32_bf16 v[36:39], a[168:171], v[208:211], v[36:39]
v_mfma_f32_16x16x32_bf16 v[12:15], a[172:175], v[164:167], v[12:15]
v_mfma_f32_16x16x32_bf16 v[20:23], a[172:175], v[180:183], v[20:23]
v_mfma_f32_16x16x32_bf16 v[28:31], a[172:175], v[196:199], v[28:31]
v_mfma_f32_16x16x32_bf16 v[36:39], a[172:175], v[212:215], v[36:39]
s_nop 7
s_nop 3
v_max3_f32 v136, v136, v8, v9
v_max3_f32 v136, v136, v10, v11
v_max3_f32 v136, v136, v12, v13
v_max3_f32 v136, v136, v14, v15
v_max3_f32 v140, v140, v16, v17
v_max3_f32 v140, v140, v18, v19
v_max3_f32 v140, v140, v20, v21
v_max3_f32 v140, v140, v22, v23
v_max3_f32 v144, v144, v24, v25
v_max3_f32 v144, v144, v26, v27
v_max3_f32 v144, v144, v28, v29
v_max3_f32 v144, v144, v30, v31
v_max3_f32 v148, v148, v32, v33
v_max3_f32 v148, v148, v34, v35
v_max3_f32 v148, v148, v36, v37
v_max3_f32 v148, v148, v38, v39
ds_read_b128 a[144:147], v216 offset:24576
ds_read_b128 a[148:151], v217 offset:24576
ds_read_b128 a[152:155], v218 offset:24576
ds_read_b128 a[156:159], v219 offset:24576
ds_read_b128 a[160:163], v216 offset:28672
ds_read_b128 a[164:167], v217 offset:28672
ds_read_b128 a[168:171], v218 offset:28672
ds_read_b128 a[172:175], v219 offset:28672
s_waitcnt lgkmcnt(0)
v_mfma_f32_16x16x32_bf16 v[8:11], a[144:147], v[152:155], 0
v_mfma_f32_16x16x32_bf16 v[16:19], a[144:147], v[168:171], 0
v_mfma_f32_16x16x32_bf16 v[24:27], a[144:147], v[184:187], 0
v_mfma_f32_16x16x32_bf16 v[32:35], a[144:147], v[200:203], 0
v_mfma_f32_16x16x32_bf16 v[8:11], a[148:151], v[156:159], v[8:11]
v_mfma_f32_16x16x32_bf16 v[16:19], a[148:151], v[172:175], v[16:19]
v_mfma_f32_16x16x32_bf16 v[24:27], a[148:151], v[188:191], v[24:27]
v_mfma_f32_16x16x32_bf16 v[32:35], a[148:151], v[204:207], v[32:35]
v_mfma_f32_16x16x32_bf16 v[8:11], a[152:155], v[160:163], v[8:11]
v_mfma_f32_16x16x32_bf16 v[16:19], a[152:155], v[176:179], v[16:19]
v_mfma_f32_16x16x32_bf16 v[24:27], a[152:155], v[192:195], v[24:27]
v_mfma_f32_16x16x32_bf16 v[32:35], a[152:155], v[208:211], v[32:35]
v_mfma_f32_16x16x32_bf16 v[8:11], a[156:159], v[164:167], v[8:11]
v_mfma_f32_16x16x32_bf16 v[16:19], a[156:159], v[180:183], v[16:19]
v_mfma_f32_16x16x32_bf16 v[24:27], a[156:159], v[196:199], v[24:27]
v_mfma_f32_16x16x32_bf16 v[32:35], a[156:159], v[212:215], v[32:35]
v_mfma_f32_16x16x32_bf16 v[12:15], a[160:163], v[152:155], 0
v_mfma_f32_16x16x32_bf16 v[20:23], a[160:163], v[168:171], 0
v_mfma_f32_16x16x32_bf16 v[28:31], a[160:163], v[184:187], 0
v_mfma_f32_16x16x32_bf16 v[36:39], a[160:163], v[200:203], 0
v_mfma_f32_16x16x32_bf16 v[12:15], a[164:167], v[156:159], v[12:15]
v_mfma_f32_16x16x32_bf16 v[20:23], a[164:167], v[172:175], v[20:23]
v_mfma_f32_16x16x32_bf16 v[28:31], a[164:167], v[188:191], v[28:31]
v_mfma_f32_16x16x32_bf16 v[36:39], a[164:167], v[204:207], v[36:39]
v_mfma_f32_16x16x32_bf16 v[12:15], a[168:171], v[160:163], v[12:15]
v_mfma_f32_16x16x32_bf16 v[20:23], a[168:171], v[176:179], v[20:23]
v_mfma_f32_16x16x32_bf16 v[28:31], a[168:171], v[192:195], v[28:31]
v_mfma_f32_16x16x32_bf16 v[36:39], a[168:171], v[208:211], v[36:39]
v_mfma_f32_16x16x32_bf16 v[12:15], a[172:175], v[164:167], v[12:15]
v_mfma_f32_16x16x32_bf16 v[20:23], a[172:175], v[180:183], v[20:23]
v_mfma_f32_16x16x32_bf16 v[28:31], a[172:175], v[196:199], v[28:31]
v_mfma_f32_16x16x32_bf16 v[36:39], a[172:175], v[212:215], v[36:39]
s_nop 7
s_nop 3
v_max3_f32 v136, v136, v8, v9
v_max3_f32 v136, v136, v10, v11
v_max3_f32 v136, v136, v12, v13
v_max3_f32 v136, v136, v14, v15
v_max3_f32 v140, v140, v16, v17
v_max3_f32 v140, v140, v18, v19
v_max3_f32 v140, v140, v20, v21
v_max3_f32 v140, v140, v22, v23
v_max3_f32 v144, v144, v24, v25
v_max3_f32 v144, v144, v26, v27
v_max3_f32 v144, v144, v28, v29
v_max3_f32 v144, v144, v30, v31
v_max3_f32 v148, v148, v32, v33
v_max3_f32 v148, v148, v34, v35
v_max3_f32 v148, v148, v36, v37
v_max3_f32 v148, v148, v38, v39
s_barrier
s_add_u32 s32, s32, 16384
s_sub_u32 s33, s33, 1
s_cmp_lg_u32 s33, 0
s_cbranch_scc1 K_FBLOOP
v_mov_b32 v246, v136
s_nop 1
v_permlane16_swap_b32 v136, v246
v_max_f32 v136, v136, v246
v_mov_b32 v246, v136
s_nop 1
v_permlane32_swap_b32 v136, v246
v_max_f32 v136, v136, v246
v_sub_f32 v136, 0, v136
v_mov_b32 v137, v136
v_mov_b32 v138, v136
v_mov_b32 v139, v136
v_mov_b32 v246, v140
s_nop 1
v_permlane16_swap_b32 v140, v246
v_max_f32 v140, v140, v246
v_mov_b32 v246, v140
s_nop 1
v_permlane32_swap_b32 v140, v246
v_max_f32 v140, v140, v246
v_sub_f32 v140, 0, v140
v_mov_b32 v141, v140
v_mov_b32 v142, v140
v_mov_b32 v143, v140
v_mov_b32 v246, v144
s_nop 1
v_permlane16_swap_b32 v144, v246
v_max_f32 v144, v144, v246
v_mov_b32 v246, v144
s_nop 1
v_permlane32_swap_b32 v144, v246
v_max_f32 v144, v144, v246
v_sub_f32 v144, 0, v144
v_mov_b32 v145, v144
v_mov_b32 v146, v144
v_mov_b32 v147, v144
v_mov_b32 v246, v148
s_nop 1
v_permlane16_swap_b32 v148, v246
v_max_f32 v148, v148, v246
v_mov_b32 v246, v148
s_nop 1
v_permlane32_swap_b32 v148, v246
v_max_f32 v148, v148, v246
v_sub_f32 v148, 0, v148
v_mov_b32 v149, v148
v_mov_b32 v150, v148
v_mov_b32 v151, v148
s_add_u32 s32, s7, 0
s_add_u32 m0, s30, 81920
s_nop 0
buffer_load_dwordx4 v228, s[8:11], s32 offen offset:0  lds
buffer_load_dwordx4 v229, s[8:11], s32 offen offset:1024  lds
buffer_load_dwordx4 v230, s[8:11], s32 offen offset:2048  lds
buffer_load_dwordx4 v231, s[8:11], s32 offen offset:3072  lds
s_add_u32 s32, s7, 16384
s_add_u32 m0, s30, 114688
s_nop 0
buffer_load_dwordx4 v228, s[8:11], s32 offen offset:0  lds
buffer_load_dwordx4 v229, s[8:11], s32 offen offset:1024  lds
buffer_load_dwordx4 v230, s[8:11], s32 offen offset:2048  lds
buffer_load_dwordx4 v231, s[8:11], s32 offen offset:3072  lds
s_add_u32 s39, s7, 0
s_add_u32 m0, s30, 131072
s_nop 0
buffer_load_dwordx4 v232, s[12:15], s39 offen offset:0  lds
buffer_load_dwordx4 v233, s[12:15], s39 offen offset:1024  lds
buffer_load_dwordx4 v232, s[12:15], s39 offen offset:2048  lds
buffer_load_dwordx4 v233, s[12:15], s39 offen offset:3072  lds
s_waitcnt vmcnt(0)
s_branch K_PRE
K_CODE_END:
.section .rodata,"a"
.p2align 6
.amdhsa_kernel recurrent_scan__gqa_block_cached__moe_arch_mod__prompt_kernel
  .amdhsa_next_free_vgpr 512
  .amdhsa_next_free_sgpr 102
  .amdhsa_accum_offset 256
  .amdhsa_group_segment_fixed_size 0
  .amdhsa_kernarg_size 104
  .amdhsa_user_sgpr_count 2
  .amdhsa_user_sgpr_kernarg_segment_ptr 1
  .amdhsa_system_sgpr_workgroup_id_x 1
  .amdhsa_float_denorm_mode_32 3
.end_amdhsa_kernel
```

```asm
; @launch grid=(256,1,1) block=(256,1,1) lds=163840
.amdgcn_target "amdgcn-amd-amdhsa--gfx950"
.text
.globl recurrent_scan__gqa_block_cached__moe_arch_mod__prompt_kernel
.p2align 8
.type recurrent_scan__gqa_block_cached__moe_arch_mod__prompt_kernel,@function
recurrent_scan__gqa_block_cached__moe_arch_mod__prompt_kernel:
s_cmp_ge_u32 s2, 256
s_cbranch_scc1 K_END
s_mov_b32 s100, 0
s_load_dwordx16 s[64:79], s[0:1], 0
s_load_dwordx8 s[80:87], s[0:1], 64
s_load_dwordx2 s[88:89], s[0:1], 96
s_lshr_b32 s35, s2, 3
s_and_b32 s36, s2, 7
s_mul_i32 s5, s36, 9
s_lshr_b32 s5, s5, 2
s_lshl_b32 s3, s36, 8
s_lshl_b32 s28, s35, 3
s_add_u32 s3, s3, s28
v_lshrrev_b32 v5, 5, v0
v_add_u32 v5, s3, v5
v_and_b32 v6, 31, v0
v_mul_u32_u24 v7, 0x480, v5
v_lshl_add_u32 v7, v6, 2, v7
v_and_b32 v1, 63, v0
v_lshrrev_b32 v2, 6, v0
v_lshlrev_b32 v8, 2, v6
v_readfirstlane_b32 s37, v2
v_and_b32 v3, 15, v1
v_lshrrev_b32 v4, 4, v1
s_getpc_b64 s[96:97]
PC_a:
s_sub_u32 s96, s96, PC_a-recurrent_scan__gqa_block_cached__moe_arch_mod__prompt_kernel
s_subb_u32 s97, s97, 0
s_lshl_b32 s50, s35, 2
s_add_u32 s50, s50, s37
s_min_u32 s50, s50, ((K_HOT_END-recurrent_scan__gqa_block_cached__moe_arch_mod__prompt_kernel)>>10)-1
s_lshl_b32 s50, s50, 10
v_lshlrev_b32 v11, 4, v1
v_add_u32 v11, s50, v11
global_load_dwordx4 v[172:175], v11, s[96:97]
s_waitcnt lgkmcnt(0)
s_mov_b32 s52, s64
s_and_b32 s53, s65, 0xffff
s_mov_b32 s54, 0x240000
s_mov_b32 s55, 0x00020000
buffer_load_dword v18, v7, s[52:55], 0 offen offset:0
buffer_load_dword v19, v7, s[52:55], 0 offen offset:128
buffer_load_dword v20, v7, s[52:55], 0 offen offset:256
buffer_load_dword v21, v7, s[52:55], 0 offen offset:384
buffer_load_dword v22, v7, s[52:55], 0 offen offset:512
buffer_load_dword v23, v7, s[52:55], 0 offen offset:640
buffer_load_dword v24, v7, s[52:55], 0 offen offset:768
buffer_load_dword v25, v7, s[52:55], 0 offen offset:896
buffer_load_dword v26, v7, s[52:55], 0 offen offset:1024
s_mov_b32 s28, 0x24c000
s_load_dwordx2 s[6:7], s[88:89], s28
s_mov_b32 s92, s76
s_and_b32 s93, s77, 0xffff
s_mov_b32 s94, 0x480
s_mov_b32 s95, 0x00020000
buffer_load_dword v28, v8, s[92:95], 0 offen offset:0
buffer_load_dword v29, v8, s[92:95], 0 offen offset:128
buffer_load_dword v30, v8, s[92:95], 0 offen offset:256
buffer_load_dword v31, v8, s[92:95], 0 offen offset:384
buffer_load_dword v32, v8, s[92:95], 0 offen offset:512
buffer_load_dword v33, v8, s[92:95], 0 offen offset:640
buffer_load_dword v34, v8, s[92:95], 0 offen offset:768
buffer_load_dword v35, v8, s[92:95], 0 offen offset:896
buffer_load_dword v36, v8, s[92:95], 0 offen offset:1024
s_mov_b32 s20, s88
s_and_b32 s21, s89, 0xffff
s_mov_b32 s22, 0x8000000
s_mov_b32 s23, 0x00020000
s_lshr_b32 s45, s3, 4
s_mul_i32 s45, s45, 18432
s_and_b32 s29, s3, 15
s_lshl_b32 s29, s29, 4
s_add_u32 s45, s45, s29
v_lshrrev_b32 v9, 1, v0
v_lshlrev_b32 v9, 8, v9
v_and_b32 v10, 1, v0
v_lshl_add_u32 v9, v10, 6, v9
s_add_u32 s29, s45, 0x1800000
v_add_u32 v9, s29, v9
s_lshl_b32 s28, s36, 8
s_add_u32 s28, s28, 0x24ac00
v_lshlrev_b32 v10, 6, v0
v_add_u32 v10, s28, v10
v_cmp_lt_u32 vcc, 143, v0
s_lshl_b32 s29, s3, 2
s_add_u32 s29, s29, 0x1a40000
v_cndmask_b32 v9, v9, v10, vcc
v_mov_b32 v10, s29
v_cmp_lt_u32 vcc, 147, v0
s_nop 1
v_cndmask_b32 v9, v9, v10, vcc
buffer_load_dword v176, v9, s[20:23], 0 offen sc1
s_mov_b32 s16, s70
s_and_b32 s17, s71, 0xffff
s_mov_b32 s18, 0x480000
s_mov_b32 s19, 0x00020000
v_add_u32 v9, 0, v4
v_lshlrev_b32 v10, 1, v9
v_xor_b32 v10, v10, v3
v_lshlrev_b32 v10, 4, v10
v_lshl_add_u32 v238, v9, 13, v10
v_add_u32 v9, 4, v4
v_lshlrev_b32 v10, 1, v9
v_xor_b32 v10, v10, v3
v_lshlrev_b32 v10, 4, v10
v_lshl_add_u32 v239, v9, 13, v10
v_subrev_u32 v239, 1024, v239
s_cmp_eq_u32 s37, 0
s_cbranch_scc1 F_NOWQ
s_sub_u32 s28, s37, 1
s_lshl_b32 s49, s28, 11
s_lshl_b32 s28, s28, 16
s_lshl_b32 s34, s35, 8
s_add_u32 s34, s34, s28
s_lshl_b32 s28, s5, 18
s_add_u32 s34, s34, s28
s_add_u32 m0, s49, 65536
s_nop 0
buffer_load_dwordx4 v238, s[16:19], s34 offen offset:0 lds
buffer_load_dwordx4 v239, s[16:19], s34 offen offset:1024 lds
s_add_u32 s34, s34, 196608
s_sub_u32 s51, s34, 4718592
s_cselect_b32 s34, s34, s51
s_add_u32 m0, s49, 71680
s_nop 0
buffer_load_dwordx4 v238, s[16:19], s34 offen offset:0 lds
buffer_load_dwordx4 v239, s[16:19], s34 offen offset:1024 lds
s_add_u32 s34, s34, 196608
s_sub_u32 s51, s34, 4718592
s_cselect_b32 s34, s34, s51
s_add_u32 m0, s49, 77824
s_nop 0
buffer_load_dwordx4 v238, s[16:19], s34 offen offset:0 lds
buffer_load_dwordx4 v239, s[16:19], s34 offen offset:1024 lds
s_add_u32 s34, s34, 196608
s_sub_u32 s51, s34, 4718592
s_cselect_b32 s34, s34, s51
s_add_u32 m0, s49, 83968
s_nop 0
buffer_load_dwordx4 v238, s[16:19], s34 offen offset:0 lds
buffer_load_dwordx4 v239, s[16:19], s34 offen offset:1024 lds
s_add_u32 s34, s34, 196608
s_sub_u32 s51, s34, 4718592
s_cselect_b32 s34, s34, s51
F_NOWQ:
s_getreg_b32 s38, hwreg(HW_REG_XCC_ID, 0, 4)
s_mov_b32 s24, s86
s_and_b32 s25, s87, 0xffff
s_mov_b32 s26, 0x100
s_mov_b32 s27, 0x00020000
v_and_b32 v66, 7, v1
v_mul_u32_u24 v67, 1168, v66
v_lshrrev_b32 v68, 5, v1
v_lshl_add_u32 v67, v68, 6, v67
v_bfe_u32 v69, v1, 3, 2
v_lshl_add_u32 v67, v69, 3, v67
v_add_u32 v168, 0x24000, v67
v_lshlrev_b32 v70, 10, v68
v_lshl_add_u32 v71, v69, 4, v66
v_lshl_add_u32 v169, v71, 4, v70
v_lshlrev_b32 v244, 4, v1
v_bfe_u32 v9, v1, 2, 2
v_and_b32 v10, 3, v1
v_lshl_add_u32 v11, v4, 2, v9
v_and_b32 v12, 7, v11
v_lshrrev_b32 v14, 1, v10
v_xor_b32 v14, v14, v12
v_and_b32 v15, 1, v10
v_lshlrev_b32 v15, 4, v15
v_lshl_add_u32 v15, v11, 8, v15
v_add_u32 v15, 0x10000, v15
v_xor_b32 v16, 0, v14
v_lshl_add_u32 v234, v16, 5, v15
v_xor_b32 v16, 2, v14
v_lshl_add_u32 v235, v16, 5, v15
v_xor_b32 v16, 4, v14
v_lshl_add_u32 v236, v16, 5, v15
v_xor_b32 v16, 6, v14
v_lshl_add_u32 v237, v16, 5, v15
s_lshl2_add_u32 s50, s36, s37
s_lshr_b32 s29, s35, 2
s_add_u32 s28, s29, 0
s_and_b32 s28, s28, 3
s_lshl2_add_u32 s28, s50, s28
s_mul_i32 s28, s28, 18432
v_add_u32 v240, s28, v244
s_add_u32 s28, s29, 1
s_and_b32 s28, s28, 3
s_lshl2_add_u32 s28, s50, s28
s_mul_i32 s28, s28, 18432
v_add_u32 v241, s28, v244
s_add_u32 s28, s29, 2
s_and_b32 s28, s28, 3
s_lshl2_add_u32 s28, s50, s28
s_mul_i32 s28, s28, 18432
v_add_u32 v242, s28, v244
s_add_u32 s28, s29, 3
s_and_b32 s28, s28, 3
s_lshl2_add_u32 s28, s50, s28
s_mul_i32 s28, s28, 18432
v_add_u32 v243, s28, v244
s_mov_b32 s40, 0x3e0293ee
s_mov_b32 s41, 0x3e0293ee
s_mov_b32 s76, 0x3ae38e39
s_mov_b32 s77, 0x3727c5ac
s_mov_b32 s75, 0xffff0000
s_cmp_eq_u32 s37, 0
s_cbranch_scc0 F_W1
s_waitcnt vmcnt(10)
s_branch F_W2
F_W1:
s_waitcnt vmcnt(18)
F_W2:
v_lshlrev_b32 v40, 16, v18
v_and_b32 v41, s75, v18
v_lshlrev_b32 v42, 16, v19
v_and_b32 v43, s75, v19
v_lshlrev_b32 v44, 16, v20
v_and_b32 v45, s75, v20
v_lshlrev_b32 v46, 16, v21
v_and_b32 v47, s75, v21
v_lshlrev_b32 v48, 16, v22
v_and_b32 v49, s75, v22
v_lshlrev_b32 v50, 16, v23
v_and_b32 v51, s75, v23
v_lshlrev_b32 v52, 16, v24
v_and_b32 v53, s75, v24
v_lshlrev_b32 v54, 16, v25
v_and_b32 v55, s75, v25
v_lshlrev_b32 v56, 16, v26
v_and_b32 v57, s75, v26
v_pk_add_f32 v[60:61], v[40:41], v[42:43]
v_pk_add_f32 v[62:63], v[44:45], v[46:47]
v_pk_add_f32 v[60:61], v[60:61], v[48:49]
v_pk_add_f32 v[62:63], v[62:63], v[50:51]
v_pk_add_f32 v[60:61], v[60:61], v[52:53]
v_pk_add_f32 v[62:63], v[62:63], v[54:55]
v_pk_add_f32 v[60:61], v[60:61], v[56:57]
v_pk_add_f32 v[60:61], v[60:61], v[62:63]
v_add_f32 v60, v60, v61
s_nop 1
v_add_f32_dpp v61, v60, v60 row_ror:8 row_mask:0xf bank_mask:0xf
s_nop 1
v_add_f32_dpp v60, v61, v61 row_ror:4 row_mask:0xf bank_mask:0xf
s_nop 1
v_add_f32_dpp v61, v60, v60 row_ror:2 row_mask:0xf bank_mask:0xf
s_nop 1
v_add_f32_dpp v60, v61, v61 row_ror:1 row_mask:0xf bank_mask:0xf
v_mov_b32 v61, v60
s_nop 1
v_permlane16_swap_b32 v60, v61
v_add_f32 v60, v60, v61
v_mul_f32 v60, s76, v60
v_mov_b32 v61, v60
v_pk_add_f32 v[66:67], v[40:41], v[60:61] neg_lo:[0,1] neg_hi:[0,1]
v_pk_mul_f32 v[62:63], v[66:67], v[66:67]
v_pk_add_f32 v[68:69], v[42:43], v[60:61] neg_lo:[0,1] neg_hi:[0,1]
v_pk_fma_f32 v[62:63], v[68:69], v[68:69], v[62:63]
v_pk_add_f32 v[66:67], v[44:45], v[60:61] neg_lo:[0,1] neg_hi:[0,1]
v_pk_fma_f32 v[62:63], v[66:67], v[66:67], v[62:63]
v_pk_add_f32 v[68:69], v[46:47], v[60:61] neg_lo:[0,1] neg_hi:[0,1]
v_pk_fma_f32 v[62:63], v[68:69], v[68:69], v[62:63]
v_pk_add_f32 v[66:67], v[48:49], v[60:61] neg_lo:[0,1] neg_hi:[0,1]
v_pk_fma_f32 v[62:63], v[66:67], v[66:67], v[62:63]
v_pk_add_f32 v[68:69], v[50:51], v[60:61] neg_lo:[0,1] neg_hi:[0,1]
v_pk_fma_f32 v[62:63], v[68:69], v[68:69], v[62:63]
v_pk_add_f32 v[66:67], v[52:53], v[60:61] neg_lo:[0,1] neg_hi:[0,1]
v_pk_fma_f32 v[62:63], v[66:67], v[66:67], v[62:63]
v_pk_add_f32 v[68:69], v[54:55], v[60:61] neg_lo:[0,1] neg_hi:[0,1]
v_pk_fma_f32 v[62:63], v[68:69], v[68:69], v[62:63]
v_pk_add_f32 v[66:67], v[56:57], v[60:61] neg_lo:[0,1] neg_hi:[0,1]
v_pk_fma_f32 v[62:63], v[66:67], v[66:67], v[62:63]
v_add_f32 v61, v62, v63
s_nop 1
v_add_f32_dpp v62, v61, v61 row_ror:8 row_mask:0xf bank_mask:0xf
s_nop 1
v_add_f32_dpp v61, v62, v62 row_ror:4 row_mask:0xf bank_mask:0xf
s_nop 1
v_add_f32_dpp v62, v61, v61 row_ror:2 row_mask:0xf bank_mask:0xf
s_nop 1
v_add_f32_dpp v61, v62, v62 row_ror:1 row_mask:0xf bank_mask:0xf
v_mov_b32 v62, v61
s_nop 1
v_permlane16_swap_b32 v61, v62
v_add_f32 v61, v61, v62
v_mul_f32 v61, s76, v61
v_cvt_pk_bf16_f32 v60, v60, v60
v_lshlrev_b32 v60, 16, v60
v_cvt_pk_bf16_f32 v61, v61, v61
v_lshlrev_b32 v61, 16, v61
v_add_f32 v61, s77, v61
v_cvt_pk_bf16_f32 v61, v61, v61
v_lshlrev_b32 v61, 16, v61
v_sqrt_f32 v61, v61
s_nop 0
v_cvt_pk_bf16_f32 v61, v61, v61
v_lshlrev_b32 v61, 16, v61
v_rcp_f32 v62, v61
v_mov_b32 v63, 0
v_lshrrev_b32 v69, 5, v0
v_mul_u32_u24 v65, 1168, v69
v_lshl_add_u32 v65, v6, 2, v65
v_add_u32 v209, 0x24000, v65
s_cmp_eq_u32 s37, 0
s_cbranch_scc0 F_W3
s_waitcnt vmcnt(1)
F_W3:
s_waitcnt vmcnt(9)
v_mov_b32 v70, v60
v_mov_b32 v71, v60
v_mov_b32 v72, v61
v_mov_b32 v73, v61
v_mov_b32 v74, v62
v_mov_b32 v75, v62
v_pk_add_f32 v[40:41], v[40:41], v[70:71] neg_lo:[0,1] neg_hi:[0,1]
v_cvt_pk_bf16_f32 v68, v40, v41
v_lshlrev_b32 v40, 16, v68
v_and_b32 v41, s75, v68
v_pk_mul_f32 v[66:67], v[40:41], v[74:75]
v_pk_fma_f32 v[40:41], v[66:67], v[72:73], v[40:41] neg_lo:[1,0,0] neg_hi:[1,0,0]
v_pk_fma_f32 v[66:67], v[40:41], v[74:75], v[66:67]
v_cvt_pk_bf16_f32 v200, v66, v67
v_pk_mul_f32 v[66:67], v[66:67], s[40:41]
v_dot2_f32_bf16 v63, v200, v28, v63
v_cvt_pk_bf16_f32 v18, v66, v67
ds_write_b32 v209, v18 offset:0
v_pk_add_f32 v[42:43], v[42:43], v[70:71] neg_lo:[0,1] neg_hi:[0,1]
v_cvt_pk_bf16_f32 v68, v42, v43
v_lshlrev_b32 v42, 16, v68
v_and_b32 v43, s75, v68
v_pk_mul_f32 v[66:67], v[42:43], v[74:75]
v_pk_fma_f32 v[42:43], v[66:67], v[72:73], v[42:43] neg_lo:[1,0,0] neg_hi:[1,0,0]
v_pk_fma_f32 v[66:67], v[42:43], v[74:75], v[66:67]
v_cvt_pk_bf16_f32 v201, v66, v67
v_pk_mul_f32 v[66:67], v[66:67], s[40:41]
v_dot2_f32_bf16 v63, v201, v29, v63
v_cvt_pk_bf16_f32 v19, v66, v67
ds_write_b32 v209, v19 offset:128
v_pk_add_f32 v[44:45], v[44:45], v[70:71] neg_lo:[0,1] neg_hi:[0,1]
v_cvt_pk_bf16_f32 v68, v44, v45
v_lshlrev_b32 v44, 16, v68
v_and_b32 v45, s75, v68
v_pk_mul_f32 v[66:67], v[44:45], v[74:75]
v_pk_fma_f32 v[44:45], v[66:67], v[72:73], v[44:45] neg_lo:[1,0,0] neg_hi:[1,0,0]
v_pk_fma_f32 v[66:67], v[44:45], v[74:75], v[66:67]
v_cvt_pk_bf16_f32 v202, v66, v67
v_pk_mul_f32 v[66:67], v[66:67], s[40:41]
v_dot2_f32_bf16 v63, v202, v30, v63
v_cvt_pk_bf16_f32 v20, v66, v67
ds_write_b32 v209, v20 offset:256
v_pk_add_f32 v[46:47], v[46:47], v[70:71] neg_lo:[0,1] neg_hi:[0,1]
v_cvt_pk_bf16_f32 v68, v46, v47
v_lshlrev_b32 v46, 16, v68
v_and_b32 v47, s75, v68
v_pk_mul_f32 v[66:67], v[46:47], v[74:75]
v_pk_fma_f32 v[46:47], v[66:67], v[72:73], v[46:47] neg_lo:[1,0,0] neg_hi:[1,0,0]
v_pk_fma_f32 v[66:67], v[46:47], v[74:75], v[66:67]
v_cvt_pk_bf16_f32 v203, v66, v67
v_pk_mul_f32 v[66:67], v[66:67], s[40:41]
v_dot2_f32_bf16 v63, v203, v31, v63
v_cvt_pk_bf16_f32 v21, v66, v67
ds_write_b32 v209, v21 offset:384
v_pk_add_f32 v[48:49], v[48:49], v[70:71] neg_lo:[0,1] neg_hi:[0,1]
v_cvt_pk_bf16_f32 v68, v48, v49
v_lshlrev_b32 v48, 16, v68
v_and_b32 v49, s75, v68
v_pk_mul_f32 v[66:67], v[48:49], v[74:75]
v_pk_fma_f32 v[48:49], v[66:67], v[72:73], v[48:49] neg_lo:[1,0,0] neg_hi:[1,0,0]
v_pk_fma_f32 v[66:67], v[48:49], v[74:75], v[66:67]
v_cvt_pk_bf16_f32 v204, v66, v67
v_pk_mul_f32 v[66:67], v[66:67], s[40:41]
v_dot2_f32_bf16 v63, v204, v32, v63
v_cvt_pk_bf16_f32 v22, v66, v67
ds_write_b32 v209, v22 offset:512
v_pk_add_f32 v[50:51], v[50:51], v[70:71] neg_lo:[0,1] neg_hi:[0,1]
v_cvt_pk_bf16_f32 v68, v50, v51
v_lshlrev_b32 v50, 16, v68
v_and_b32 v51, s75, v68
v_pk_mul_f32 v[66:67], v[50:51], v[74:75]
v_pk_fma_f32 v[50:51], v[66:67], v[72:73], v[50:51] neg_lo:[1,0,0] neg_hi:[1,0,0]
v_pk_fma_f32 v[66:67], v[50:51], v[74:75], v[66:67]
v_cvt_pk_bf16_f32 v205, v66, v67
v_pk_mul_f32 v[66:67], v[66:67], s[40:41]
v_dot2_f32_bf16 v63, v205, v33, v63
v_cvt_pk_bf16_f32 v23, v66, v67
ds_write_b32 v209, v23 offset:640
v_pk_add_f32 v[52:53], v[52:53], v[70:71] neg_lo:[0,1] neg_hi:[0,1]
v_cvt_pk_bf16_f32 v68, v52, v53
v_lshlrev_b32 v52, 16, v68
v_and_b32 v53, s75, v68
v_pk_mul_f32 v[66:67], v[52:53], v[74:75]
v_pk_fma_f32 v[52:53], v[66:67], v[72:73], v[52:53] neg_lo:[1,0,0] neg_hi:[1,0,0]
v_pk_fma_f32 v[66:67], v[52:53], v[74:75], v[66:67]
v_cvt_pk_bf16_f32 v206, v66, v67
v_pk_mul_f32 v[66:67], v[66:67], s[40:41]
v_dot2_f32_bf16 v63, v206, v34, v63
v_cvt_pk_bf16_f32 v24, v66, v67
ds_write_b32 v209, v24 offset:768
v_pk_add_f32 v[54:55], v[54:55], v[70:71] neg_lo:[0,1] neg_hi:[0,1]
v_cvt_pk_bf16_f32 v68, v54, v55
v_lshlrev_b32 v54, 16, v68
v_and_b32 v55, s75, v68
v_pk_mul_f32 v[66:67], v[54:55], v[74:75]
v_pk_fma_f32 v[54:55], v[66:67], v[72:73], v[54:55] neg_lo:[1,0,0] neg_hi:[1,0,0]
v_pk_fma_f32 v[66:67], v[54:55], v[74:75], v[66:67]
v_cvt_pk_bf16_f32 v207, v66, v67
v_pk_mul_f32 v[66:67], v[66:67], s[40:41]
v_dot2_f32_bf16 v63, v207, v35, v63
v_cvt_pk_bf16_f32 v25, v66, v67
ds_write_b32 v209, v25 offset:896
v_pk_add_f32 v[56:57], v[56:57], v[70:71] neg_lo:[0,1] neg_hi:[0,1]
v_cvt_pk_bf16_f32 v68, v56, v57
v_lshlrev_b32 v56, 16, v68
v_and_b32 v57, s75, v68
v_pk_mul_f32 v[66:67], v[56:57], v[74:75]
v_pk_fma_f32 v[56:57], v[66:67], v[72:73], v[56:57] neg_lo:[1,0,0] neg_hi:[1,0,0]
v_pk_fma_f32 v[66:67], v[56:57], v[74:75], v[66:67]
v_cvt_pk_bf16_f32 v208, v66, v67
v_pk_mul_f32 v[66:67], v[66:67], s[40:41]
v_dot2_f32_bf16 v63, v208, v36, v63
v_cvt_pk_bf16_f32 v26, v66, v67
ds_write_b32 v209, v26 offset:1024
s_nop 2
s_nop 1
v_add_f32_dpp v62, v63, v63 row_ror:8 row_mask:0xf bank_mask:0xf
s_nop 1
v_add_f32_dpp v63, v62, v62 row_ror:4 row_mask:0xf bank_mask:0xf
s_nop 1
v_add_f32_dpp v62, v63, v63 row_ror:2 row_mask:0xf bank_mask:0xf
s_nop 1
v_add_f32_dpp v63, v62, v62 row_ror:1 row_mask:0xf bank_mask:0xf
v_mov_b32 v62, v63
s_nop 1
v_permlane16_swap_b32 v63, v62
v_add_f32 v63, v63, v62
v_cvt_pk_bf16_f32 v63, v63, v63
v_lshlrev_b32 v63, 16, v63
v_ashrrev_i32 v66, 31, v63
v_or_b32 v66, 0x80000000, v66
v_xor_b32 v63, v63, v66
v_and_b32 v63, s75, v63
v_sub_u32 v66, 0xffff, v5
v_or_b32 v63, v63, v66
v_lshlrev_b32 v66, 2, v69
v_add_u32 v66, 0x26480, v66
ds_write_b32 v66, v63
v_and_b32 v64, 7, v1
v_lshlrev_b32 v64, 2, v64
s_waitcnt lgkmcnt(0)
s_barrier
s_mul_i32 s101, s6, 0x9e3779b1
s_add_u32 s101, s101, 0x7f4a7c15
s_mul_i32 s47, s7, 0x85ebca6b
s_add_u32 s47, s47, 0x165667b1
s_cmp_eq_u32 s37, 0
s_cbranch_scc0 F_OTHER
ds_read2_b64 v[72:75], v168 offset0:0 offset1:4
ds_read2_b64 v[76:79], v168 offset0:16 offset1:20
ds_read2_b64 v[80:83], v168 offset0:32 offset1:36
ds_read2_b64 v[84:87], v168 offset0:48 offset1:52
ds_read2_b64 v[88:91], v168 offset0:64 offset1:68
ds_read2_b64 v[92:95], v168 offset0:80 offset1:84
ds_read2_b64 v[96:99], v168 offset0:96 offset1:100
ds_read2_b64 v[100:103], v168 offset0:112 offset1:116
ds_read2_b64 v[104:107], v168 offset0:128 offset1:132
v_add_u32 v65, 0x26480, v64
ds_read_b32 v65, v65
s_add_u32 s28, s45, 0x1800000
s_waitcnt lgkmcnt(9)
buffer_store_dwordx4 v[72:75], v169, s[20:23], s28 offen offset:0
s_waitcnt lgkmcnt(8)
buffer_store_dwordx4 v[76:79], v169, s[20:23], s28 offen offset:2048
s_add_u32 s28, s28, 4096
s_waitcnt lgkmcnt(7)
buffer_store_dwordx4 v[80:83], v169, s[20:23], s28 offen offset:0
s_waitcnt lgkmcnt(6)
buffer_store_dwordx4 v[84:87], v169, s[20:23], s28 offen offset:2048
s_add_u32 s28, s28, 4096
s_waitcnt lgkmcnt(5)
buffer_store_dwordx4 v[88:91], v169, s[20:23], s28 offen offset:0
s_waitcnt lgkmcnt(4)
buffer_store_dwordx4 v[92:95], v169, s[20:23], s28 offen offset:2048
s_add_u32 s28, s28, 4096
s_waitcnt lgkmcnt(3)
buffer_store_dwordx4 v[96:99], v169, s[20:23], s28 offen offset:0
s_waitcnt lgkmcnt(2)
buffer_store_dwordx4 v[100:103], v169, s[20:23], s28 offen offset:2048
s_add_u32 s28, s28, 4096
s_waitcnt lgkmcnt(1)
buffer_store_dwordx4 v[104:107], v169, s[20:23], s28 offen offset:0
s_lshl_b32 s28, s3, 2
s_add_u32 s28, s28, 0x1a40000
s_waitcnt lgkmcnt(0)
buffer_store_dword v65, v64, s[20:23], s28 offen
s_and_b32 s29, s101, -16
s_or_b32 s29, s29, s38
v_mov_b32 v58, s29
v_mov_b32 v59, s47
s_lshl_b32 s29, s35, 3
v_mov_b32 v61, s29
s_lshl_b32 s28, s36, 8
s_add_u32 s28, s28, 0x24d000
s_waitcnt vmcnt(0)
s_mov_b64 exec, 1
buffer_store_dwordx2 v[58:59], v61, s[20:23], s28 offen
s_mov_b64 exec, -1
s_branch F_JOIN
F_END0:
.p2align 12
K_P1:
F_OTHER:
STUB_0:
s_mov_b64 exec, 0
s_cmp_eq_u32 s37, 1
s_cbranch_scc1 STUB_A1
s_cmp_eq_u32 s37, 2
s_cbranch_scc1 STUB_A2
s_cmp_eq_u32 s37, 3
s_cbranch_scc1 STUB_A3
s_mov_b64 exec, -1
HOP_R1:
s_add_u32 m0, s49, 90112
s_nop 0
buffer_load_dwordx4 v238, s[16:19], s34 offen offset:0 lds
buffer_load_dwordx4 v239, s[16:19], s34 offen offset:1024 lds
s_add_u32 s34, s34, 196608
s_sub_u32 s51, s34, 4718592
s_cselect_b32 s34, s34, s51
s_add_u32 m0, s49, 96256
s_nop 0
buffer_load_dwordx4 v238, s[16:19], s34 offen offset:0 lds
buffer_load_dwordx4 v239, s[16:19], s34 offen offset:1024 lds
s_add_u32 s34, s34, 196608
s_sub_u32 s51, s34, 4718592
s_cselect_b32 s34, s34, s51
s_add_u32 m0, s49, 102400
s_nop 0
buffer_load_dwordx4 v238, s[16:19], s34 offen offset:0 lds
buffer_load_dwordx4 v239, s[16:19], s34 offen offset:1024 lds
s_add_u32 s34, s34, 196608
s_sub_u32 s51, s34, 4718592
s_cselect_b32 s34, s34, s51
s_add_u32 m0, s49, 108544
s_nop 0
buffer_load_dwordx4 v238, s[16:19], s34 offen offset:0 lds
buffer_load_dwordx4 v239, s[16:19], s34 offen offset:1024 lds
s_add_u32 s34, s34, 196608
s_sub_u32 s51, s34, 4718592
s_cselect_b32 s34, s34, s51
s_mov_b64 exec, 0
s_cmp_eq_u32 s37, 1
s_cbranch_scc1 STUB_B1
s_cmp_eq_u32 s37, 2
s_cbranch_scc1 STUB_B2
s_cmp_eq_u32 s37, 3
s_cbranch_scc1 STUB_B3
s_mov_b64 exec, -1
HOP_R2:
F_JOIN:
s_lshl_b32 s49, s37, 11
s_lshl_b32 s28, s37, 16
s_lshl_b32 s34, s35, 8
s_add_u32 s34, s34, s28
s_lshl_b32 s28, s5, 18
s_add_u32 s34, s34, s28
s_add_u32 s34, s34, 1572864
s_sub_u32 s51, s34, 4718592
s_cselect_b32 s34, s34, s51
s_cmp_eq_u32 s37, 0
s_cbranch_scc1 F_W0P
s_waitcnt vmcnt(0)
s_branch F_BAR2
HOP_RET1:
s_mov_b64 exec, -1
s_branch HOP_R1
HOP_RET2:
s_mov_b64 exec, -1
s_branch HOP_R2
F_W0P:
s_mov_b32 s46, 0x20
s_lshl_b32 s28, s36, 8
s_add_u32 s28, s28, 0x24d000
v_and_b32 v61, 31, v1
v_lshlrev_b32 v61, 3, v61
s_mov_b32 s51, 0
v_mov_b32 v60, 3
F_POLL:
buffer_load_dwordx2 v[62:63], v61, s[20:23], s28 offen sc0 sc1
s_waitcnt vmcnt(0)
v_cmp_ne_u64 vcc, v[62:63], v[58:59]
s_cbranch_vccz F_GO
s_add_u32 s51, s51, 1
s_and_b32 s29, s51, 31
s_cbranch_scc1 F_POLL
s_branch F_NOTYET
F_GO:
v_mov_b32 v61, 156864
ds_write_b32 v61, v60
s_waitcnt lgkmcnt(0)
F_BAR2:
s_barrier
s_lshl_b32 s7, s36, 31
s_mov_b32 s7, 0
v_mov_b32 v246, 156864
ds_read_b32 v246, v246
s_mov_b32 s4, 0x1800000
s_mov_b32 s51, 3
Q_START:
s_lshl_b32 s28, s5, 10
s_add_u32 s28, s28, s4
s_add_u32 s6, s4, 18432
buffer_load_dwordx4 a[0:3], v240, s[20:23], s28 offen sc0 sc1
buffer_load_dwordx4 a[4:7], v241, s[20:23], s28 offen sc0 sc1
buffer_load_dwordx4 a[8:11], v242, s[20:23], s28 offen sc0 sc1
buffer_load_dwordx4 a[12:15], v243, s[20:23], s28 offen sc0 sc1
s_waitcnt lgkmcnt(0)
v_readfirstlane_b32 s48, v246
ds_read_b64_tr_b16 a[144:145], v234 offset:0
ds_read_b64_tr_b16 a[146:147], v234 offset:4096
ds_read_b64_tr_b16 a[148:149], v234 offset:8
ds_read_b64_tr_b16 a[150:151], v234 offset:4104
ds_read_b64_tr_b16 a[152:153], v235 offset:0
ds_read_b64_tr_b16 a[154:155], v235 offset:4096
ds_read_b64_tr_b16 a[156:157], v235 offset:8
ds_read_b64_tr_b16 a[158:159], v235 offset:4104
ds_read_b64_tr_b16 a[160:161], v236 offset:0
ds_read_b64_tr_b16 a[162:163], v236 offset:4096
ds_read_b64_tr_b16 a[164:165], v236 offset:8
ds_read_b64_tr_b16 a[166:167], v236 offset:4104
ds_read_b64_tr_b16 a[168:169], v237 offset:0
ds_read_b64_tr_b16 a[170:171], v237 offset:4096
ds_read_b64_tr_b16 a[172:173], v237 offset:8
ds_read_b64_tr_b16 a[174:175], v237 offset:4104
s_cmp_lt_u32 s48, s51
s_cbranch_scc1 Q_REDO
s_add_u32 s28, s28, 1024
s_cmp_lt_u32 s28, s6
s_cselect_b32 s28, s28, s4
buffer_load_dwordx4 a[16:19], v240, s[20:23], s28 offen sc0 sc1
buffer_load_dwordx4 a[20:23], v241, s[20:23], s28 offen sc0 sc1
buffer_load_dwordx4 a[24:27], v242, s[20:23], s28 offen sc0 sc1
buffer_load_dwordx4 a[28:31], v243, s[20:23], s28 offen sc0 sc1
s_lshl_b32 s29, s36, 10
s_add_u32 s29, s29, s4
s_add_u32 s29, s29, 0x240000
buffer_load_dwordx4 v[136:139], v244, s[20:23], s29 offen sc0 sc1
s_add_u32 s28, s28, 1024
s_cmp_lt_u32 s28, s6
s_cselect_b32 s28, s28, s4
buffer_load_dwordx4 a[32:35], v240, s[20:23], s28 offen sc0 sc1
buffer_load_dwordx4 a[36:39], v241, s[20:23], s28 offen sc0 sc1
buffer_load_dwordx4 a[40:43], v242, s[20:23], s28 offen sc0 sc1
buffer_load_dwordx4 a[44:47], v243, s[20:23], s28 offen sc0 sc1
s_waitcnt vmcnt(9)
s_waitcnt lgkmcnt(8)
v_mfma_f32_16x16x32_bf16 v[8:11], a[144:147], a[0:3], 0
ds_read_b64_tr_b16 a[176:177], v234 offset:8192
ds_write_b32 v209, v200 offset:0
v_mfma_f32_16x16x32_bf16 v[40:43], a[144:147], a[4:7], 0
ds_read_b64_tr_b16 a[178:179], v234 offset:12288
ds_write_b32 v209, v201 offset:128
v_mfma_f32_16x16x32_bf16 v[72:75], a[144:147], a[8:11], 0
s_add_u32 s28, s28, 1024
s_cmp_lt_u32 s28, s6
s_cselect_b32 s28, s28, s4
v_mfma_f32_16x16x32_bf16 v[104:107], a[144:147], a[12:15], 0
ds_read_b64_tr_b16 a[180:181], v234 offset:8200
ds_write_b32 v209, v202 offset:256
v_mfma_f32_16x16x32_bf16 v[108:111], a[148:151], a[12:15], 0
ds_read_b64_tr_b16 a[182:183], v234 offset:12296
ds_write_b32 v209, v203 offset:384
v_mfma_f32_16x16x32_bf16 v[76:79], a[148:151], a[8:11], 0
buffer_load_dwordx4 a[48:51], v240, s[20:23], s28 offen sc0 sc1
v_mfma_f32_16x16x32_bf16 v[44:47], a[148:151], a[4:7], 0
ds_read_b64_tr_b16 a[184:185], v235 offset:8192
ds_write_b32 v209, v204 offset:512
v_mfma_f32_16x16x32_bf16 v[12:15], a[148:151], a[0:3], 0
ds_read_b64_tr_b16 a[186:187], v235 offset:12288
ds_write_b32 v209, v205 offset:640
v_mfma_f32_16x16x32_bf16 v[16:19], a[152:155], a[0:3], 0
buffer_load_dwordx4 a[52:55], v241, s[20:23], s28 offen sc0 sc1
v_mfma_f32_16x16x32_bf16 v[48:51], a[152:155], a[4:7], 0
ds_read_b64_tr_b16 a[188:189], v235 offset:8200
ds_write_b32 v209, v206 offset:768
v_mfma_f32_16x16x32_bf16 v[80:83], a[152:155], a[8:11], 0
ds_read_b64_tr_b16 a[190:191], v235 offset:12296
ds_write_b32 v209, v207 offset:896
v_mfma_f32_16x16x32_bf16 v[112:115], a[152:155], a[12:15], 0
buffer_load_dwordx4 a[56:59], v242, s[20:23], s28 offen sc0 sc1
v_mfma_f32_16x16x32_bf16 v[116:119], a[156:159], a[12:15], 0
ds_read_b64_tr_b16 a[192:193], v236 offset:8192
ds_write_b32 v209, v208 offset:1024
v_mfma_f32_16x16x32_bf16 v[84:87], a[156:159], a[8:11], 0
buffer_load_dwordx4 a[60:63], v243, s[20:23], s28 offen sc0 sc1
v_mfma_f32_16x16x32_bf16 v[52:55], a[156:159], a[4:7], 0
ds_read_b64_tr_b16 a[194:195], v236 offset:12288
s_lshl_b32 s30, s37, 12
v_mfma_f32_16x16x32_bf16 v[20:23], a[156:159], a[0:3], 0
ds_read_b64_tr_b16 a[196:197], v236 offset:8200
s_lshl_b32 s31, s37, 10
s_waitcnt lgkmcnt(8)
v_mfma_f32_16x16x32_bf16 v[24:27], a[160:163], a[0:3], 0
s_add_u32 s28, s28, 1024
s_cmp_lt_u32 s28, s6
s_cselect_b32 s28, s28, s4
v_mfma_f32_16x16x32_bf16 v[56:59], a[160:163], a[4:7], 0
ds_read_b64_tr_b16 a[198:199], v236 offset:12296
v_add_u32 v184, 0, v4
v_mfma_f32_16x16x32_bf16 v[88:91], a[160:163], a[8:11], 0
ds_read_b64_tr_b16 a[200:201], v237 offset:8192
v_xor_b32 v184, v184, v3
v_mfma_f32_16x16x32_bf16 v[120:123], a[160:163], a[12:15], 0
buffer_load_dwordx4 a[64:67], v240, s[20:23], s28 offen sc0 sc1
v_mfma_f32_16x16x32_bf16 v[124:127], a[164:167], a[12:15], 0
ds_read_b64_tr_b16 a[202:203], v237 offset:12288
v_lshlrev_b32 v184, 4, v184
v_mfma_f32_16x16x32_bf16 v[92:95], a[164:167], a[8:11], 0
ds_read_b64_tr_b16 a[204:205], v237 offset:8200
v_lshl_add_u32 v184, v3, 8, v184
v_mfma_f32_16x16x32_bf16 v[60:63], a[164:167], a[4:7], 0
buffer_load_dwordx4 a[68:71], v241, s[20:23], s28 offen sc0 sc1
v_mfma_f32_16x16x32_bf16 v[28:31], a[164:167], a[0:3], 0
ds_read_b64_tr_b16 a[206:207], v237 offset:12296
v_add_u32 v216, 0x10000, v184
v_mfma_f32_16x16x32_bf16 v[32:35], a[168:171], a[0:3], 0
buffer_load_dwordx4 a[72:75], v242, s[20:23], s28 offen sc0 sc1
v_mfma_f32_16x16x32_bf16 v[64:67], a[168:171], a[4:7], 0
buffer_load_dwordx4 a[76:79], v243, s[20:23], s28 offen sc0 sc1
v_mfma_f32_16x16x32_bf16 v[96:99], a[168:171], a[8:11], 0
s_add_u32 m0, s49, 114688
v_add_u32 v184, 4, v4
v_mfma_f32_16x16x32_bf16 v[128:131], a[168:171], a[12:15], 0
buffer_load_dwordx4 v238, s[16:19], s34 offen offset:0 lds
v_mfma_f32_16x16x32_bf16 v[132:135], a[172:175], a[12:15], 0
buffer_load_dwordx4 v239, s[16:19], s34 offen offset:1024 lds
v_mfma_f32_16x16x32_bf16 v[100:103], a[172:175], a[8:11], 0
s_add_u32 s34, s34, 262144
s_sub_u32 s51, s34, 4718592
s_cselect_b32 s34, s34, s51
v_mfma_f32_16x16x32_bf16 v[68:71], a[172:175], a[4:7], 0
v_xor_b32 v184, v184, v3
v_lshlrev_b32 v184, 4, v184
v_mfma_f32_16x16x32_bf16 v[36:39], a[172:175], a[0:3], 0
v_lshl_add_u32 v184, v3, 8, v184
v_add_u32 v217, 0x10000, v184
s_waitcnt vmcnt(15)
v_mfma_f32_16x16x32_bf16 v[8:11], a[176:179], a[16:19], v[8:11]
ds_read_b64_tr_b16 a[144:145], v234 offset:16384
v_add_u32 v184, 8, v4
v_mfma_f32_16x16x32_bf16 v[40:43], a[176:179], a[20:23], v[40:43]
ds_read_b64_tr_b16 a[146:147], v234 offset:20480
v_xor_b32 v184, v184, v3
v_mfma_f32_16x16x32_bf16 v[72:75], a[176:179], a[24:27], v[72:75]
s_add_u32 s28, s28, 1024
s_cmp_lt_u32 s28, s6
s_cselect_b32 s28, s28, s4
v_mfma_f32_16x16x32_bf16 v[104:107], a[176:179], a[28:31], v[104:107]
ds_read_b64_tr_b16 a[148:149], v234 offset:16392
v_lshlrev_b32 v184, 4, v184
v_mfma_f32_16x16x32_bf16 v[108:111], a[180:183], a[28:31], v[108:111]
ds_read_b64_tr_b16 a[150:151], v234 offset:20488
v_lshl_add_u32 v184, v3, 8, v184
v_mfma_f32_16x16x32_bf16 v[76:79], a[180:183], a[24:27], v[76:79]
buffer_load_dwordx4 a[80:83], v240, s[20:23], s28 offen sc0 sc1
v_mfma_f32_16x16x32_bf16 v[44:47], a[180:183], a[20:23], v[44:47]
ds_read_b64_tr_b16 a[152:153], v235 offset:16384
v_add_u32 v218, 0x10000, v184
v_mfma_f32_16x16x32_bf16 v[12:15], a[180:183], a[16:19], v[12:15]
ds_read_b64_tr_b16 a[154:155], v235 offset:20480
v_add_u32 v184, 12, v4
v_mfma_f32_16x16x32_bf16 v[16:19], a[184:187], a[16:19], v[16:19]
buffer_load_dwordx4 a[84:87], v241, s[20:23], s28 offen sc0 sc1
v_mfma_f32_16x16x32_bf16 v[48:51], a[184:187], a[20:23], v[48:51]
ds_read_b64_tr_b16 a[156:157], v235 offset:16392
v_xor_b32 v184, v184, v3
v_mfma_f32_16x16x32_bf16 v[80:83], a[184:187], a[24:27], v[80:83]
ds_read_b64_tr_b16 a[158:159], v235 offset:20488
v_lshlrev_b32 v184, 4, v184
v_mfma_f32_16x16x32_bf16 v[112:115], a[184:187], a[28:31], v[112:115]
buffer_load_dwordx4 a[88:91], v242, s[20:23], s28 offen sc0 sc1
s_waitcnt lgkmcnt(8)
v_mfma_f32_16x16x32_bf16 v[116:119], a[188:191], a[28:31], v[116:119]
ds_read_b64_tr_b16 a[160:161], v236 offset:16384
v_lshl_add_u32 v184, v3, 8, v184
v_mfma_f32_16x16x32_bf16 v[84:87], a[188:191], a[24:27], v[84:87]
buffer_load_dwordx4 a[92:95], v243, s[20:23], s28 offen sc0 sc1
v_mfma_f32_16x16x32_bf16 v[52:55], a[188:191], a[20:23], v[52:55]
ds_read_b64_tr_b16 a[162:163], v236 offset:20480
v_add_u32 v219, 0x10000, v184
v_mfma_f32_16x16x32_bf16 v[20:23], a[188:191], a[16:19], v[20:23]
ds_read_b64_tr_b16 a[164:165], v236 offset:16392
v_bfe_u32 v184, v1, 2, 2
v_mfma_f32_16x16x32_bf16 v[24:27], a[192:195], a[16:19], v[24:27]
s_add_u32 m0, s49, 122880
v_and_b32 v185, 3, v1
v_mfma_f32_16x16x32_bf16 v[56:59], a[192:195], a[20:23], v[56:59]
ds_read_b64_tr_b16 a[166:167], v236 offset:20488
v_lshl_add_u32 v186, v4, 2, v184
v_mfma_f32_16x16x32_bf16 v[88:91], a[192:195], a[24:27], v[88:91]
ds_read_b64_tr_b16 a[168:169], v237 offset:16384
v_and_b32 v187, 7, v186
v_mfma_f32_16x16x32_bf16 v[120:123], a[192:195], a[28:31], v[120:123]
v_lshlrev_b32 v188, 8, v186
v_lshl_add_u32 v188, v185, 3, v188
v_mfma_f32_16x16x32_bf16 v[124:127], a[196:199], a[28:31], v[124:127]
ds_read_b64_tr_b16 a[170:171], v237 offset:20480
v_add_u32 v188, 0x18000, v188
v_mfma_f32_16x16x32_bf16 v[92:95], a[196:199], a[24:27], v[92:95]
ds_read_b64_tr_b16 a[172:173], v237 offset:16392
v_xor_b32 v189, 0, v187
v_mfma_f32_16x16x32_bf16 v[60:63], a[196:199], a[20:23], v[60:63]
buffer_load_dwordx4 v238, s[16:19], s34 offen offset:0 lds
v_mfma_f32_16x16x32_bf16 v[28:31], a[196:199], a[16:19], v[28:31]
ds_read_b64_tr_b16 a[174:175], v237 offset:20488
v_lshl_add_u32 v220, v189, 5, v188
v_mfma_f32_16x16x32_bf16 v[32:35], a[200:203], a[16:19], v[32:35]
buffer_load_dwordx4 v239, s[16:19], s34 offen offset:1024 lds
v_mfma_f32_16x16x32_bf16 v[64:67], a[200:203], a[20:23], v[64:67]
v_xor_b32 v189, 1, v187
v_lshl_add_u32 v221, v189, 5, v188
v_mfma_f32_16x16x32_bf16 v[96:99], a[200:203], a[24:27], v[96:99]
s_add_u32 s34, s34, 262144
s_sub_u32 s51, s34, 4718592
s_cselect_b32 s34, s34, s51
v_mfma_f32_16x16x32_bf16 v[128:131], a[200:203], a[28:31], v[128:131]
v_xor_b32 v189, 2, v187
v_lshl_add_u32 v222, v189, 5, v188
v_mfma_f32_16x16x32_bf16 v[132:135], a[204:207], a[28:31], v[132:135]
v_xor_b32 v189, 3, v187
v_lshl_add_u32 v223, v189, 5, v188
v_mfma_f32_16x16x32_bf16 v[100:103], a[204:207], a[24:27], v[100:103]
v_xor_b32 v189, 4, v187
v_lshl_add_u32 v224, v189, 5, v188
v_mfma_f32_16x16x32_bf16 v[68:71], a[204:207], a[20:23], v[68:71]
v_xor_b32 v189, 5, v187
v_lshl_add_u32 v225, v189, 5, v188
v_mfma_f32_16x16x32_bf16 v[36:39], a[204:207], a[16:19], v[36:39]
v_xor_b32 v189, 6, v187
v_lshl_add_u32 v226, v189, 5, v188
s_waitcnt vmcnt(16)
s_waitcnt lgkmcnt(8)
v_mfma_f32_16x16x32_bf16 v[8:11], a[144:147], a[32:35], v[8:11]
ds_read_b64_tr_b16 a[176:177], v234 offset:24576
v_xor_b32 v189, 7, v187
v_mfma_f32_16x16x32_bf16 v[40:43], a[144:147], a[36:39], v[40:43]
ds_read_b64_tr_b16 a[178:179], v234 offset:28672
v_lshl_add_u32 v227, v189, 5, v188
v_mfma_f32_16x16x32_bf16 v[72:75], a[144:147], a[40:43], v[72:75]
s_add_u32 s28, s28, 1024
s_cmp_lt_u32 s28, s6
s_cselect_b32 s28, s28, s4
v_mfma_f32_16x16x32_bf16 v[104:107], a[144:147], a[44:47], v[104:107]
ds_read_b64_tr_b16 a[180:181], v234 offset:24584
v_add_u32 v184, 0, v4
v_mfma_f32_16x16x32_bf16 v[108:111], a[148:151], a[44:47], v[108:111]
ds_read_b64_tr_b16 a[182:183], v234 offset:28680
v_xor_b32 v184, v184, v3
v_mfma_f32_16x16x32_bf16 v[76:79], a[148:151], a[40:43], v[76:79]
buffer_load_dwordx4 a[96:99], v240, s[20:23], s28 offen sc0 sc1
v_mfma_f32_16x16x32_bf16 v[44:47], a[148:151], a[36:39], v[44:47]
ds_read_b64_tr_b16 a[184:185], v235 offset:24576
v_lshlrev_b32 v184, 4, v184
v_mfma_f32_16x16x32_bf16 v[12:15], a[148:151], a[32:35], v[12:15]
ds_read_b64_tr_b16 a[186:187], v235 offset:28672
v_lshl_add_u32 v184, v4, 8, v184
v_mfma_f32_16x16x32_bf16 v[16:19], a[152:155], a[32:35], v[16:19]
buffer_load_dwordx4 a[100:103], v241, s[20:23], s28 offen sc0 sc1
v_mfma_f32_16x16x32_bf16 v[48:51], a[152:155], a[36:39], v[48:51]
ds_read_b64_tr_b16 a[188:189], v235 offset:24584
v_add_u32 v228, s30, v184
v_mfma_f32_16x16x32_bf16 v[80:83], a[152:155], a[40:43], v[80:83]
ds_read_b64_tr_b16 a[190:191], v235 offset:28680
v_add_u32 v184, 4, v4
v_mfma_f32_16x16x32_bf16 v[112:115], a[152:155], a[44:47], v[112:115]
buffer_load_dwordx4 a[104:107], v242, s[20:23], s28 offen sc0 sc1
v_mfma_f32_16x16x32_bf16 v[116:119], a[156:159], a[44:47], v[116:119]
ds_read_b64_tr_b16 a[192:193], v236 offset:24576
v_xor_b32 v184, v184, v3
v_mfma_f32_16x16x32_bf16 v[84:87], a[156:159], a[40:43], v[84:87]
buffer_load_dwordx4 a[108:111], v243, s[20:23], s28 offen sc0 sc1
v_mfma_f32_16x16x32_bf16 v[52:55], a[156:159], a[36:39], v[52:55]
ds_read_b64_tr_b16 a[194:195], v236 offset:28672
v_lshlrev_b32 v184, 4, v184
v_mfma_f32_16x16x32_bf16 v[20:23], a[156:159], a[32:35], v[20:23]
ds_read_b64_tr_b16 a[196:197], v236 offset:24584
v_lshl_add_u32 v184, v4, 8, v184
s_waitcnt lgkmcnt(8)
v_mfma_f32_16x16x32_bf16 v[24:27], a[160:163], a[32:35], v[24:27]
s_add_u32 m0, s49, 131072
v_add_u32 v229, s30, v184
v_mfma_f32_16x16x32_bf16 v[56:59], a[160:163], a[36:39], v[56:59]
ds_read_b64_tr_b16 a[198:199], v236 offset:28680
v_add_u32 v184, 8, v4
v_mfma_f32_16x16x32_bf16 v[88:91], a[160:163], a[40:43], v[88:91]
ds_read_b64_tr_b16 a[200:201], v237 offset:24576
v_xor_b32 v184, v184, v3
v_mfma_f32_16x16x32_bf16 v[120:123], a[160:163], a[44:47], v[120:123]
v_lshlrev_b32 v184, 4, v184
v_lshl_add_u32 v184, v4, 8, v184
v_mfma_f32_16x16x32_bf16 v[124:127], a[164:167], a[44:47], v[124:127]
ds_read_b64_tr_b16 a[202:203], v237 offset:28672
v_add_u32 v230, s30, v184
v_mfma_f32_16x16x32_bf16 v[92:95], a[164:167], a[40:43], v[92:95]
ds_read_b64_tr_b16 a[204:205], v237 offset:24584
v_add_u32 v184, 12, v4
v_mfma_f32_16x16x32_bf16 v[60:63], a[164:167], a[36:39], v[60:63]
buffer_load_dwordx4 v238, s[16:19], s34 offen offset:0 lds
v_mfma_f32_16x16x32_bf16 v[28:31], a[164:167], a[32:35], v[28:31]
ds_read_b64_tr_b16 a[206:207], v237 offset:28680
v_xor_b32 v184, v184, v3
v_mfma_f32_16x16x32_bf16 v[32:35], a[168:171], a[32:35], v[32:35]
buffer_load_dwordx4 v239, s[16:19], s34 offen offset:1024 lds
v_mfma_f32_16x16x32_bf16 v[64:67], a[168:171], a[36:39], v[64:67]
v_lshlrev_b32 v184, 4, v184
v_lshl_add_u32 v184, v4, 8, v184
v_mfma_f32_16x16x32_bf16 v[96:99], a[168:171], a[40:43], v[96:99]
s_add_u32 s34, s34, 262144
s_sub_u32 s51, s34, 4718592
s_cselect_b32 s34, s34, s51
v_mfma_f32_16x16x32_bf16 v[128:131], a[168:171], a[44:47], v[128:131]
v_add_u32 v231, s30, v184
v_add_u32 v184, 0, v4
v_mfma_f32_16x16x32_bf16 v[132:135], a[172:175], a[44:47], v[132:135]
v_lshlrev_b32 v184, 1, v184
v_xor_b32 v184, v184, v3
v_mfma_f32_16x16x32_bf16 v[100:103], a[172:175], a[40:43], v[100:103]
v_lshlrev_b32 v184, 4, v184
v_lshl_add_u32 v184, v4, 8, v184
v_mfma_f32_16x16x32_bf16 v[68:71], a[172:175], a[36:39], v[68:71]
v_add_u32 v232, s30, v184
v_add_u32 v184, 4, v4
v_mfma_f32_16x16x32_bf16 v[36:39], a[172:175], a[32:35], v[36:39]
v_lshlrev_b32 v184, 1, v184
v_xor_b32 v184, v184, v3
s_waitcnt vmcnt(18)
v_mfma_f32_16x16x32_bf16 v[8:11], a[176:179], a[48:51], v[8:11]
ds_read_b64_tr_b16 a[144:145], v234 offset:32768
v_lshlrev_b32 v184, 4, v184
v_mfma_f32_16x16x32_bf16 v[40:43], a[176:179], a[52:55], v[40:43]
ds_read_b64_tr_b16 a[146:147], v234 offset:36864
v_lshl_add_u32 v184, v4, 8, v184
v_mfma_f32_16x16x32_bf16 v[72:75], a[176:179], a[56:59], v[72:75]
s_add_u32 s28, s28, 1024
s_cmp_lt_u32 s28, s6
s_cselect_b32 s28, s28, s4
v_mfma_f32_16x16x32_bf16 v[104:107], a[176:179], a[60:63], v[104:107]
ds_read_b64_tr_b16 a[148:149], v234 offset:32776
v_add_u32 v233, s30, v184
s_waitcnt lgkmcnt(8)
v_mfma_f32_16x16x32_bf16 v[108:111], a[180:183], a[60:63], v[108:111]
ds_read_b64_tr_b16 a[150:151], v234 offset:36872
v_bfe_u32 v184, v1, 1, 1
v_mfma_f32_16x16x32_bf16 v[76:79], a[180:183], a[56:59], v[76:79]
buffer_load_dwordx4 a[112:115], v240, s[20:23], s28 offen sc0 sc1
v_mfma_f32_16x16x32_bf16 v[44:47], a[180:183], a[52:55], v[44:47]
ds_read_b64_tr_b16 a[152:153], v235 offset:32768
v_lshrrev_b32 v185, 5, v1
v_mfma_f32_16x16x32_bf16 v[12:15], a[180:183], a[48:51], v[12:15]
ds_read_b64_tr_b16 a[154:155], v235 offset:36864
v_cmp_eq_u32 vcc, v184, v185
v_mfma_f32_16x16x32_bf16 v[16:19], a[184:187], a[48:51], v[16:19]
buffer_load_dwordx4 a[116:119], v241, s[20:23], s28 offen sc0 sc1
v_mfma_f32_16x16x32_bf16 v[48:51], a[184:187], a[52:55], v[48:51]
ds_read_b64_tr_b16 a[156:157], v235 offset:32776
v_mov_b32 v186, 0x3f803f80
v_mfma_f32_16x16x32_bf16 v[80:83], a[184:187], a[56:59], v[80:83]
ds_read_b64_tr_b16 a[158:159], v235 offset:36872
v_mfma_f32_16x16x32_bf16 v[112:115], a[184:187], a[60:63], v[112:115]
buffer_load_dwordx4 a[120:123], v242, s[20:23], s28 offen sc0 sc1
v_mfma_f32_16x16x32_bf16 v[116:119], a[188:191], a[60:63], v[116:119]
ds_read_b64_tr_b16 a[160:161], v236 offset:32768
v_cndmask_b32 v186, 0, v186, vcc
v_mfma_f32_16x16x32_bf16 v[84:87], a[188:191], a[56:59], v[84:87]
buffer_load_dwordx4 a[124:127], v243, s[20:23], s28 offen sc0 sc1
v_mfma_f32_16x16x32_bf16 v[52:55], a[188:191], a[52:55], v[52:55]
ds_read_b64_tr_b16 a[162:163], v236 offset:36864
v_and_b32 v184, 1, v1
v_mfma_f32_16x16x32_bf16 v[20:23], a[188:191], a[48:51], v[20:23]
ds_read_b64_tr_b16 a[164:165], v236 offset:32776
v_cmp_eq_u32 vcc, 1, v184
v_mfma_f32_16x16x32_bf16 v[24:27], a[192:195], a[48:51], v[24:27]
s_add_u32 m0, s49, 139264
v_mov_b32 v184, 0x44444444
v_mfma_f32_16x16x32_bf16 v[56:59], a[192:195], a[52:55], v[56:59]
ds_read_b64_tr_b16 a[166:167], v236 offset:36872
v_mov_b32 v185, 0xeeeeeeee
v_mfma_f32_16x16x32_bf16 v[88:91], a[192:195], a[56:59], v[88:91]
ds_read_b64_tr_b16 a[168:169], v237 offset:32768
v_mfma_f32_16x16x32_bf16 v[120:123], a[192:195], a[60:63], v[120:123]
v_cndmask_b32 v245, v184, v185, vcc
v_accvgpr_write_b32 a208, v186
s_waitcnt lgkmcnt(8)
v_mfma_f32_16x16x32_bf16 v[124:127], a[196:199], a[60:63], v[124:127]
ds_read_b64_tr_b16 a[170:171], v237 offset:36864
v_accvgpr_write_b32 a209, v186
v_mfma_f32_16x16x32_bf16 v[92:95], a[196:199], a[56:59], v[92:95]
ds_read_b64_tr_b16 a[172:173], v237 offset:32776
v_accvgpr_write_b32 a210, v186
v_mfma_f32_16x16x32_bf16 v[60:63], a[196:199], a[52:55], v[60:63]
buffer_load_dwordx4 v238, s[16:19], s34 offen offset:0 lds
v_mfma_f32_16x16x32_bf16 v[28:31], a[196:199], a[48:51], v[28:31]
ds_read_b64_tr_b16 a[174:175], v237 offset:36872
v_accvgpr_write_b32 a211, v186
v_mfma_f32_16x16x32_bf16 v[32:35], a[200:203], a[48:51], v[32:35]
buffer_load_dwordx4 v239, s[16:19], s34 offen offset:1024 lds
v_mfma_f32_16x16x32_bf16 v[64:67], a[200:203], a[52:55], v[64:67]
s_lshl_b32 s92, s36, 5
s_add_u32 s92, s92, s35
v_mfma_f32_16x16x32_bf16 v[96:99], a[200:203], a[56:59], v[96:99]
s_add_u32 s34, s34, 262144
s_sub_u32 s51, s34, 4718592
s_cselect_b32 s34, s34, s51
v_mfma_f32_16x16x32_bf16 v[128:131], a[200:203], a[60:63], v[128:131]
s_lshl2_add_u32 s92, s92, s37
s_lshl_b32 s44, s92, 14
v_mfma_f32_16x16x32_bf16 v[132:135], a[204:207], a[60:63], v[132:135]
s_add_u32 s44, s44, 0x400000
s_mov_b32 s42, 0x5f800000
v_mfma_f32_16x16x32_bf16 v[100:103], a[204:207], a[56:59], v[100:103]
s_mov_b32 s43, 0
s_lshr_b32 s92, s35, 1
v_mfma_f32_16x16x32_bf16 v[68:71], a[204:207], a[52:55], v[68:71]
s_lshl_b32 s92, s92, 19
v_mfma_f32_16x16x32_bf16 v[36:39], a[204:207], a[48:51], v[36:39]
s_add_u32 s66, s66, s92
s_addc_u32 s67, s67, 0
s_waitcnt vmcnt(20)
v_mfma_f32_16x16x32_bf16 v[8:11], a[144:147], a[64:67], v[8:11]
ds_read_b64_tr_b16 a[176:177], v234 offset:40960
v_mfma_f32_16x16x32_bf16 v[40:43], a[144:147], a[68:71], v[40:43]
ds_read_b64_tr_b16 a[178:179], v234 offset:45056
v_mfma_f32_16x16x32_bf16 v[72:75], a[144:147], a[72:75], v[72:75]
s_add_u32 s28, s28, 1024
s_cmp_lt_u32 s28, s6
s_cselect_b32 s28, s28, s4
v_mfma_f32_16x16x32_bf16 v[104:107], a[144:147], a[76:79], v[104:107]
ds_read_b64_tr_b16 a[180:181], v234 offset:40968
v_mfma_f32_16x16x32_bf16 v[108:111], a[148:151], a[76:79], v[108:111]
ds_read_b64_tr_b16 a[182:183], v234 offset:45064
v_mfma_f32_16x16x32_bf16 v[76:79], a[148:151], a[72:75], v[76:79]
buffer_load_dwordx4 a[0:3], v240, s[20:23], s28 offen sc0 sc1
v_mfma_f32_16x16x32_bf16 v[44:47], a[148:151], a[68:71], v[44:47]
ds_read_b64_tr_b16 a[184:185], v235 offset:40960
v_mfma_f32_16x16x32_bf16 v[12:15], a[148:151], a[64:67], v[12:15]
ds_read_b64_tr_b16 a[186:187], v235 offset:45056
s_waitcnt lgkmcnt(8)
v_mfma_f32_16x16x32_bf16 v[16:19], a[152:155], a[64:67], v[16:19]
buffer_load_dwordx4 a[4:7], v241, s[20:23], s28 offen sc0 sc1
v_mfma_f32_16x16x32_bf16 v[48:51], a[152:155], a[68:71], v[48:51]
ds_read_b64_tr_b16 a[188:189], v235 offset:40968
v_mfma_f32_16x16x32_bf16 v[80:83], a[152:155], a[72:75], v[80:83]
ds_read_b64_tr_b16 a[190:191], v235 offset:45064
v_mfma_f32_16x16x32_bf16 v[112:115], a[152:155], a[76:79], v[112:115]
buffer_load_dwordx4 a[8:11], v242, s[20:23], s28 offen sc0 sc1
v_mfma_f32_16x16x32_bf16 v[116:119], a[156:159], a[76:79], v[116:119]
ds_read_b64_tr_b16 a[192:193], v236 offset:40960
v_mfma_f32_16x16x32_bf16 v[84:87], a[156:159], a[72:75], v[84:87]
buffer_load_dwordx4 a[12:15], v243, s[20:23], s28 offen sc0 sc1
v_mfma_f32_16x16x32_bf16 v[52:55], a[156:159], a[68:71], v[52:55]
ds_read_b64_tr_b16 a[194:195], v236 offset:45056
v_mfma_f32_16x16x32_bf16 v[20:23], a[156:159], a[64:67], v[20:23]
ds_read_b64_tr_b16 a[196:197], v236 offset:40968
v_mfma_f32_16x16x32_bf16 v[24:27], a[160:163], a[64:67], v[24:27]
s_add_u32 m0, s49, 0
v_mfma_f32_16x16x32_bf16 v[56:59], a[160:163], a[68:71], v[56:59]
ds_read_b64_tr_b16 a[198:199], v236 offset:45064
v_mfma_f32_16x16x32_bf16 v[88:91], a[160:163], a[72:75], v[88:91]
ds_read_b64_tr_b16 a[200:201], v237 offset:40960
v_mfma_f32_16x16x32_bf16 v[120:123], a[160:163], a[76:79], v[120:123]
s_add_u32 s68, s68, s92
s_addc_u32 s69, s69, 0
v_mfma_f32_16x16x32_bf16 v[124:127], a[164:167], a[76:79], v[124:127]
ds_read_b64_tr_b16 a[202:203], v237 offset:45056
s_mov_b32 s8, s66
v_mfma_f32_16x16x32_bf16 v[92:95], a[164:167], a[72:75], v[92:95]
ds_read_b64_tr_b16 a[204:205], v237 offset:40968
s_and_b32 s9, s67, 0xffff
v_mfma_f32_16x16x32_bf16 v[60:63], a[164:167], a[68:71], v[60:63]
buffer_load_dwordx4 v238, s[16:19], s34 offen offset:0 lds
v_mfma_f32_16x16x32_bf16 v[28:31], a[164:167], a[64:67], v[28:31]
ds_read_b64_tr_b16 a[206:207], v237 offset:45064
s_mov_b32 s10, 0x80000
v_mfma_f32_16x16x32_bf16 v[32:35], a[168:171], a[64:67], v[32:35]
buffer_load_dwordx4 v239, s[16:19], s34 offen offset:1024 lds
v_mfma_f32_16x16x32_bf16 v[64:67], a[168:171], a[68:71], v[64:67]
s_mov_b32 s11, 0x00020000
s_mov_b32 s12, s68
v_mfma_f32_16x16x32_bf16 v[96:99], a[168:171], a[72:75], v[96:99]
s_add_u32 s34, s34, 262144
s_sub_u32 s51, s34, 4718592
s_cselect_b32 s34, s34, s51
v_mfma_f32_16x16x32_bf16 v[128:131], a[168:171], a[76:79], v[128:131]
s_and_b32 s13, s69, 0xffff
s_mov_b32 s14, 0x80000
s_waitcnt lgkmcnt(8)
v_mfma_f32_16x16x32_bf16 v[132:135], a[172:175], a[76:79], v[132:135]
s_mov_b32 s15, 0x00020000
s_mov_b32 s56, s72
v_mfma_f32_16x16x32_bf16 v[100:103], a[172:175], a[72:75], v[100:103]
s_and_b32 s57, s73, 0xffff
s_mov_b32 s58, 0x480000
v_mfma_f32_16x16x32_bf16 v[68:71], a[172:175], a[68:71], v[68:71]
s_mov_b32 s59, 0x00020000
s_mov_b32 s60, s84
v_mfma_f32_16x16x32_bf16 v[36:39], a[172:175], a[64:67], v[36:39]
s_and_b32 s61, s85, 0xffff
s_mov_b32 s62, 0x240000
s_waitcnt vmcnt(20)
v_mfma_f32_16x16x32_bf16 v[8:11], a[176:179], a[80:83], v[8:11]
s_mov_b32 s63, 0x00020000
s_mov_b32 s64, s78
v_mfma_f32_16x16x32_bf16 v[40:43], a[176:179], a[84:87], v[40:43]
s_waitcnt vmcnt(12) lgkmcnt(0)
s_barrier
v_mfma_f32_16x16x32_bf16 v[72:75], a[176:179], a[88:91], v[72:75]
ds_read_b64_tr_b16 a[144:145], v234 offset:49152
s_and_b32 s65, s79, 0xffff
v_mfma_f32_16x16x32_bf16 v[104:107], a[176:179], a[92:95], v[104:107]
ds_read_b64_tr_b16 a[146:147], v234 offset:53248
s_mov_b32 s66, 0x510000
v_mfma_f32_16x16x32_bf16 v[108:111], a[180:183], a[92:95], v[108:111]
ds_read_b64_tr_b16 a[148:149], v234 offset:49160
s_mov_b32 s67, 0x00020000
STUB_1:
STUB_A1:
s_cbranch_execz STUB_4
v_mfma_f32_16x16x32_bf16 v[76:79], a[180:183], a[88:91], v[76:79]
s_add_u32 s28, s28, 1024
s_cmp_lt_u32 s28, s6
s_cselect_b32 s28, s28, s4
v_mfma_f32_16x16x32_bf16 v[44:47], a[180:183], a[84:87], v[44:47]
ds_read_b64_tr_b16 a[150:151], v234 offset:53256
s_mov_b32 s68, s80
v_mfma_f32_16x16x32_bf16 v[12:15], a[180:183], a[80:83], v[12:15]
ds_read_b64_tr_b16 a[152:153], v235 offset:49152
s_and_b32 s69, s81, 0xffff
v_mfma_f32_16x16x32_bf16 v[16:19], a[184:187], a[80:83], v[16:19]
buffer_load_dwordx4 a[16:19], v240, s[20:23], s28 offen sc0 sc1
v_mfma_f32_16x16x32_bf16 v[48:51], a[184:187], a[84:87], v[48:51]
ds_read_b64_tr_b16 a[154:155], v235 offset:53248
s_mov_b32 s70, 0x510000
v_mfma_f32_16x16x32_bf16 v[80:83], a[184:187], a[88:91], v[80:83]
ds_read_b64_tr_b16 a[156:157], v235 offset:49160
s_mov_b32 s71, 0x00020000
v_mfma_f32_16x16x32_bf16 v[112:115], a[184:187], a[92:95], v[112:115]
buffer_load_dwordx4 a[20:23], v241, s[20:23], s28 offen sc0 sc1
v_mfma_f32_16x16x32_bf16 v[116:119], a[188:191], a[92:95], v[116:119]
ds_read_b64_tr_b16 a[158:159], v235 offset:53256
s_mov_b32 s72, s82
v_mfma_f32_16x16x32_bf16 v[84:87], a[188:191], a[88:91], v[84:87]
ds_read_b64_tr_b16 a[160:161], v236 offset:49152
s_and_b32 s73, s83, 0xffff
v_mfma_f32_16x16x32_bf16 v[52:55], a[188:191], a[84:87], v[52:55]
ds_read_b64_tr_b16 a[162:163], v236 offset:53248
s_mov_b32 s74, 0x510000
v_mfma_f32_16x16x32_bf16 v[20:23], a[188:191], a[80:83], v[20:23]
buffer_load_dwordx4 a[24:27], v242, s[20:23], s28 offen sc0 sc1
v_mfma_f32_16x16x32_bf16 v[24:27], a[192:195], a[80:83], v[24:27]
ds_read_b64_tr_b16 a[164:165], v236 offset:49160
s_mov_b32 s75, 0x00020000
v_mfma_f32_16x16x32_bf16 v[56:59], a[192:195], a[84:87], v[56:59]
ds_read_b64_tr_b16 a[166:167], v236 offset:53256
s_mul_i32 s92, s36, 18
v_mfma_f32_16x16x32_bf16 v[88:91], a[192:195], a[88:91], v[88:91]
buffer_load_dwordx4 a[28:31], v243, s[20:23], s28 offen sc0 sc1
v_mfma_f32_16x16x32_bf16 v[120:123], a[192:195], a[92:95], v[120:123]
ds_read_b64_tr_b16 a[168:169], v237 offset:49152
s_add_u32 m0, s49, 8192
v_mfma_f32_16x16x32_bf16 v[124:127], a[196:199], a[92:95], v[124:127]
ds_read_b64_tr_b16 a[170:171], v237 offset:53248
s_add_u32 s92, s92, s35
v_mfma_f32_16x16x32_bf16 v[92:95], a[196:199], a[88:91], v[92:95]
buffer_load_dwordx4 v238, s[16:19], s34 offen offset:0 lds
v_mfma_f32_16x16x32_bf16 v[60:63], a[196:199], a[84:87], v[60:63]
ds_read_b64_tr_b16 a[172:173], v237 offset:49160
s_lshl_b32 s84, s92, 6
v_mfma_f32_16x16x32_bf16 v[28:31], a[196:199], a[80:83], v[28:31]
ds_read_b64_tr_b16 a[174:175], v237 offset:53256
s_mul_i32 s93, s37, 147456
v_mfma_f32_16x16x32_bf16 v[32:35], a[200:203], a[80:83], v[32:35]
buffer_load_dwordx4 v239, s[16:19], s34 offen offset:1024 lds
v_mfma_f32_16x16x32_bf16 v[64:67], a[200:203], a[84:87], v[64:67]
s_add_u32 s84, s84, s93
s_mul_i32 s85, s92, 36864
v_mfma_f32_16x16x32_bf16 v[96:99], a[200:203], a[88:91], v[96:99]
s_add_u32 s34, s34, 262144
s_sub_u32 s51, s34, 4718592
s_cselect_b32 s34, s34, s51
v_mfma_f32_16x16x32_bf16 v[128:131], a[200:203], a[92:95], v[128:131]
s_add_u32 s85, s85, s31
v_mfma_f32_16x16x32_bf16 v[132:135], a[204:207], a[92:95], v[132:135]
s_cmp_lt_u32 s2, 144
s_cselect_b32 s86, s31, 0x30000
s_cselect_b32 s84, s84, 0x40000000
s_cselect_b32 s85, s85, 0x40000000
v_mfma_f32_16x16x32_bf16 v[100:103], a[204:207], a[88:91], v[100:103]
s_lshr_b32 s92, s35, 2
s_mul_i32 s89, s92, 589824
v_mfma_f32_16x16x32_bf16 v[68:71], a[204:207], a[84:87], v[68:71]
s_and_b32 s92, s35, 3
s_mul_i32 s92, s92, 288
v_mfma_f32_16x16x32_bf16 v[36:39], a[204:207], a[80:83], v[36:39]
s_add_u32 s89, s89, s92
s_lshl_b32 s92, s36, 9
s_waitcnt vmcnt(20)
s_waitcnt lgkmcnt(8)
v_mfma_f32_16x16x32_bf16 v[8:11], a[144:147], a[96:99], v[8:11]
ds_read_b64_tr_b16 a[176:177], v234 offset:57344
s_lshr_b32 s93, s35, 2
v_mfma_f32_16x16x32_bf16 v[40:43], a[144:147], a[100:103], v[40:43]
ds_read_b64_tr_b16 a[178:179], v234 offset:61440
s_and_b32 s94, s35, 3
v_mfma_f32_16x16x32_bf16 v[72:75], a[144:147], a[104:107], v[72:75]
s_add_u32 s28, s28, 1024
s_cmp_lt_u32 s28, s6
s_cselect_b32 s28, s28, s4
v_mfma_f32_16x16x32_bf16 v[104:107], a[144:147], a[108:111], v[104:107]
ds_read_b64_tr_b16 a[180:181], v234 offset:57352
s_lshl_b32 s95, s93, 6
v_mfma_f32_16x16x32_bf16 v[108:111], a[148:151], a[108:111], v[108:111]
ds_read_b64_tr_b16 a[182:183], v234 offset:61448
s_add_u32 s95, s95, s92
v_mfma_f32_16x16x32_bf16 v[76:79], a[148:151], a[104:107], v[76:79]
buffer_load_dwordx4 a[32:35], v240, s[20:23], s28 offen sc0 sc1
v_mfma_f32_16x16x32_bf16 v[44:47], a[148:151], a[100:103], v[44:47]
ds_read_b64_tr_b16 a[184:185], v235 offset:57344
s_lshl2_add_u32 s95, s94, s95
v_mfma_f32_16x16x32_bf16 v[12:15], a[148:151], a[96:99], v[12:15]
ds_read_b64_tr_b16 a[186:187], v235 offset:61440
s_add_u32 s95, s95, 0x248000
v_mfma_f32_16x16x32_bf16 v[16:19], a[152:155], a[96:99], v[16:19]
buffer_load_dwordx4 a[36:39], v241, s[20:23], s28 offen sc0 sc1
v_mfma_f32_16x16x32_bf16 v[48:51], a[152:155], a[100:103], v[48:51]
ds_read_b64_tr_b16 a[188:189], v235 offset:57352
v_lshlrev_b32 v170, 4, v1
v_mfma_f32_16x16x32_bf16 v[80:83], a[152:155], a[104:107], v[80:83]
ds_read_b64_tr_b16 a[190:191], v235 offset:61448
v_add_u32 v170, s95, v170
v_mfma_f32_16x16x32_bf16 v[112:115], a[152:155], a[108:111], v[112:115]
buffer_load_dwordx4 a[40:43], v242, s[20:23], s28 offen sc0 sc1
v_mfma_f32_16x16x32_bf16 v[116:119], a[156:159], a[108:111], v[116:119]
ds_read_b64_tr_b16 a[192:193], v236 offset:57344
s_lshl_b32 s95, s94, 7
v_mfma_f32_16x16x32_bf16 v[84:87], a[156:159], a[104:107], v[84:87]
buffer_load_dwordx4 a[44:47], v243, s[20:23], s28 offen sc0 sc1
v_mfma_f32_16x16x32_bf16 v[52:55], a[156:159], a[100:103], v[52:55]
ds_read_b64_tr_b16 a[194:195], v236 offset:61440
s_add_u32 s95, s95, s92
v_mfma_f32_16x16x32_bf16 v[20:23], a[156:159], a[96:99], v[20:23]
ds_read_b64_tr_b16 a[196:197], v236 offset:57352
s_lshl2_add_u32 s95, s93, s95
s_waitcnt lgkmcnt(8)
v_mfma_f32_16x16x32_bf16 v[24:27], a[160:163], a[96:99], v[24:27]
s_add_u32 m0, s49, 16384
s_add_u32 s95, s95, 0x249f80
v_mfma_f32_16x16x32_bf16 v[56:59], a[160:163], a[100:103], v[56:59]
ds_read_b64_tr_b16 a[198:199], v236 offset:61448
v_lshlrev_b32 v184, 5, v1
v_mfma_f32_16x16x32_bf16 v[88:91], a[160:163], a[104:107], v[88:91]
ds_read_b64_tr_b16 a[200:201], v237 offset:57344
v_add_u32 v184, s95, v184
v_mfma_f32_16x16x32_bf16 v[120:123], a[160:163], a[108:111], v[120:123]
v_cmp_lt_u32 vcc, 3, v1
v_mfma_f32_16x16x32_bf16 v[124:127], a[164:167], a[108:111], v[124:127]
ds_read_b64_tr_b16 a[202:203], v237 offset:61440
v_mfma_f32_16x16x32_bf16 v[92:95], a[164:167], a[104:107], v[92:95]
ds_read_b64_tr_b16 a[204:205], v237 offset:57352
v_cndmask_b32 v170, v170, v184, vcc
v_mfma_f32_16x16x32_bf16 v[60:63], a[164:167], a[100:103], v[60:63]
buffer_load_dwordx4 v238, s[16:19], s34 offen offset:0 lds
v_mfma_f32_16x16x32_bf16 v[28:31], a[164:167], a[96:99], v[28:31]
ds_read_b64_tr_b16 a[206:207], v237 offset:61448
s_mov_b32 s95, 0x7fffbff0
v_mfma_f32_16x16x32_bf16 v[32:35], a[168:171], a[96:99], v[32:35]
buffer_load_dwordx4 v239, s[16:19], s34 offen offset:1024 lds
v_mfma_f32_16x16x32_bf16 v[64:67], a[168:171], a[100:103], v[64:67]
s_cmp_eq_u32 s2, 0
s_cselect_b32 s95, 0x242c00, s95
v_mfma_f32_16x16x32_bf16 v[96:99], a[168:171], a[104:107], v[96:99]
s_add_u32 s34, s34, 262144
s_sub_u32 s51, s34, 4718592
s_cselect_b32 s34, s34, s51
v_mfma_f32_16x16x32_bf16 v[128:131], a[168:171], a[108:111], v[128:131]
v_lshlrev_b32 v184, 7, v1
v_add_u32 v184, s95, v184
v_mfma_f32_16x16x32_bf16 v[132:135], a[172:175], a[108:111], v[132:135]
v_cmp_lt_u32 vcc, 7, v1
v_mfma_f32_16x16x32_bf16 v[100:103], a[172:175], a[104:107], v[100:103]
v_mfma_f32_16x16x32_bf16 v[68:71], a[172:175], a[100:103], v[68:71]
v_cndmask_b32 v170, v170, v184, vcc
v_mov_b32 v184, 0x7ffffff0
v_mfma_f32_16x16x32_bf16 v[36:39], a[172:175], a[96:99], v[36:39]
v_mov_b32 v171, 0
v_cmp_lt_u32 vcc, 9, v0
s_waitcnt vmcnt(20)
v_mfma_f32_16x16x32_bf16 v[8:11], a[176:179], a[112:115], v[8:11]
v_add_u32 v234, 0x10000, v234
v_add_u32 v235, 0x10000, v235
v_mfma_f32_16x16x32_bf16 v[40:43], a[176:179], a[116:119], v[40:43]
v_add_u32 v236, 0x10000, v236
v_add_u32 v237, 0x10000, v237
v_mfma_f32_16x16x32_bf16 v[72:75], a[176:179], a[120:123], v[72:75]
v_cndmask_b32 v170, v170, v184, vcc
v_mov_b32 v254, 0x7ffffff0
v_mfma_f32_16x16x32_bf16 v[104:107], a[176:179], a[124:127], v[104:107]
ds_read_b64_tr_b16 a[144:145], v234 offset:0
s_lshl_b32 s92, s36, 5
s_waitcnt lgkmcnt(8)
v_mfma_f32_16x16x32_bf16 v[108:111], a[180:183], a[124:127], v[108:111]
ds_read_b64_tr_b16 a[146:147], v234 offset:4096
s_add_u32 s92, s92, s35
v_mfma_f32_16x16x32_bf16 v[76:79], a[180:183], a[120:123], v[76:79]
ds_read_b64_tr_b16 a[148:149], v234 offset:8
v_mfma_f32_16x16x32_bf16 v[44:47], a[180:183], a[116:119], v[44:47]
s_add_u32 s28, s28, 1024
s_cmp_lt_u32 s28, s6
s_cselect_b32 s28, s28, s4
v_mfma_f32_16x16x32_bf16 v[12:15], a[180:183], a[112:115], v[12:15]
ds_read_b64_tr_b16 a[150:151], v234 offset:4104
v_mfma_f32_16x16x32_bf16 v[16:19], a[184:187], a[112:115], v[16:19]
ds_read_b64_tr_b16 a[152:153], v235 offset:0
v_mfma_f32_16x16x32_bf16 v[48:51], a[184:187], a[116:119], v[48:51]
ds_read_b64_tr_b16 a[154:155], v235 offset:4096
v_mfma_f32_16x16x32_bf16 v[80:83], a[184:187], a[120:123], v[80:83]
buffer_load_dwordx4 a[48:51], v240, s[20:23], s28 offen sc0 sc1
v_mfma_f32_16x16x32_bf16 v[112:115], a[184:187], a[124:127], v[112:115]
ds_read_b64_tr_b16 a[156:157], v235 offset:8
v_mfma_f32_16x16x32_bf16 v[116:119], a[188:191], a[124:127], v[116:119]
ds_read_b64_tr_b16 a[158:159], v235 offset:4104
v_mfma_f32_16x16x32_bf16 v[84:87], a[188:191], a[120:123], v[84:87]
buffer_load_dwordx4 a[52:55], v241, s[20:23], s28 offen sc0 sc1
v_mfma_f32_16x16x32_bf16 v[52:55], a[188:191], a[116:119], v[52:55]
ds_read_b64_tr_b16 a[160:161], v236 offset:0
v_mfma_f32_16x16x32_bf16 v[20:23], a[188:191], a[112:115], v[20:23]
ds_read_b64_tr_b16 a[162:163], v236 offset:4096
s_waitcnt lgkmcnt(8)
v_mfma_f32_16x16x32_bf16 v[24:27], a[192:195], a[112:115], v[24:27]
ds_read_b64_tr_b16 a[164:165], v236 offset:8
v_mfma_f32_16x16x32_bf16 v[56:59], a[192:195], a[116:119], v[56:59]
buffer_load_dwordx4 a[56:59], v242, s[20:23], s28 offen sc0 sc1
v_mfma_f32_16x16x32_bf16 v[88:91], a[192:195], a[120:123], v[88:91]
ds_read_b64_tr_b16 a[166:167], v236 offset:4104
v_mfma_f32_16x16x32_bf16 v[120:123], a[192:195], a[124:127], v[120:123]
ds_read_b64_tr_b16 a[168:169], v237 offset:0
v_mfma_f32_16x16x32_bf16 v[124:127], a[196:199], a[124:127], v[124:127]
ds_read_b64_tr_b16 a[170:171], v237 offset:4096
v_mfma_f32_16x16x32_bf16 v[92:95], a[196:199], a[120:123], v[92:95]
buffer_load_dwordx4 a[60:63], v243, s[20:23], s28 offen sc0 sc1
v_mfma_f32_16x16x32_bf16 v[60:63], a[196:199], a[116:119], v[60:63]
ds_read_b64_tr_b16 a[172:173], v237 offset:8
s_add_u32 m0, s49, 24576
v_mfma_f32_16x16x32_bf16 v[28:31], a[196:199], a[112:115], v[28:31]
ds_read_b64_tr_b16 a[174:175], v237 offset:4104
v_mfma_f32_16x16x32_bf16 v[32:35], a[200:203], a[112:115], v[32:35]
buffer_load_dwordx4 v238, s[16:19], s34 offen offset:0 lds
v_mfma_f32_16x16x32_bf16 v[64:67], a[200:203], a[116:119], v[64:67]
buffer_load_dwordx4 v239, s[16:19], s34 offen offset:1024 lds
v_mfma_f32_16x16x32_bf16 v[96:99], a[200:203], a[120:123], v[96:99]
s_cmp_eq_u32 s37, 0
s_cselect_b32 s92, s92, 0x7ffffff0
v_mfma_f32_16x16x32_bf16 v[128:131], a[200:203], a[124:127], v[128:131]
s_add_u32 s34, s34, 262144
s_sub_u32 s51, s34, 4718592
s_cselect_b32 s34, s34, s51
v_mfma_f32_16x16x32_bf16 v[132:135], a[204:207], a[124:127], v[132:135]
v_writelane_b32 v254, s92, 0
v_mfma_f32_16x16x32_bf16 v[100:103], a[204:207], a[120:123], v[100:103]
s_or_b32 s92, s38, s46
v_mfma_f32_16x16x32_bf16 v[68:71], a[204:207], a[116:119], v[68:71]
v_mov_b32 v255, s92
v_add_u32 v184, 0, v0
v_mfma_f32_16x16x32_bf16 v[36:39], a[204:207], a[112:115], v[36:39]
v_mul_u32_u24 v185, 911, v184
v_lshrrev_b32 v185, 16, v185
s_waitcnt vmcnt(20)
v_mfma_f32_16x16x32_bf16 v[8:11], a[144:147], a[0:3], v[8:11]
v_add_u32 v184, v184, v185
v_lshlrev_b32 v184, 4, v184
v_mfma_f32_16x16x32_bf16 v[40:43], a[144:147], a[4:7], v[40:43]
s_waitcnt vmcnt(12) lgkmcnt(0)
s_barrier
v_mfma_f32_16x16x32_bf16 v[72:75], a[144:147], a[8:11], v[72:75]
ds_read_b64_tr_b16 a[176:177], v234 offset:8192
v_add_u32 v178, 0x24000, v184
v_mfma_f32_16x16x32_bf16 v[104:107], a[144:147], a[12:15], v[104:107]
ds_read_b64_tr_b16 a[178:179], v234 offset:12288
v_add_u32 v184, 256, v0
v_mfma_f32_16x16x32_bf16 v[108:111], a[148:151], a[12:15], v[108:111]
ds_read_b64_tr_b16 a[180:181], v234 offset:8200
v_mul_u32_u24 v185, 911, v184
v_mfma_f32_16x16x32_bf16 v[76:79], a[148:151], a[8:11], v[76:79]
s_add_u32 s28, s28, 1024
s_cmp_lt_u32 s28, s6
s_cselect_b32 s28, s28, s4
v_mfma_f32_16x16x32_bf16 v[44:47], a[148:151], a[4:7], v[44:47]
ds_read_b64_tr_b16 a[182:183], v234 offset:12296
v_lshrrev_b32 v185, 16, v185
v_mfma_f32_16x16x32_bf16 v[12:15], a[148:151], a[0:3], v[12:15]
ds_read_b64_tr_b16 a[184:185], v235 offset:8192
v_add_u32 v184, v184, v185
v_mfma_f32_16x16x32_bf16 v[16:19], a[152:155], a[0:3], v[16:19]
buffer_load_dwordx4 a[64:67], v240, s[20:23], s28 offen sc0 sc1
v_mfma_f32_16x16x32_bf16 v[48:51], a[152:155], a[4:7], v[48:51]
ds_read_b64_tr_b16 a[186:187], v235 offset:12288
v_lshlrev_b32 v184, 4, v184
v_mfma_f32_16x16x32_bf16 v[80:83], a[152:155], a[8:11], v[80:83]
ds_read_b64_tr_b16 a[188:189], v235 offset:8200
v_add_u32 v179, 0x24000, v184
v_mfma_f32_16x16x32_bf16 v[112:115], a[152:155], a[12:15], v[112:115]
buffer_load_dwordx4 a[68:71], v241, s[20:23], s28 offen sc0 sc1
v_mfma_f32_16x16x32_bf16 v[116:119], a[156:159], a[12:15], v[116:119]
ds_read_b64_tr_b16 a[190:191], v235 offset:12296
v_add_u32 v184, 512, v0
v_mfma_f32_16x16x32_bf16 v[84:87], a[156:159], a[8:11], v[84:87]
ds_read_b64_tr_b16 a[192:193], v236 offset:8192
v_mul_u32_u24 v185, 911, v184
v_mfma_f32_16x16x32_bf16 v[52:55], a[156:159], a[4:7], v[52:55]
ds_read_b64_tr_b16 a[194:195], v236 offset:12288
v_lshrrev_b32 v185, 16, v185
v_mfma_f32_16x16x32_bf16 v[20:23], a[156:159], a[0:3], v[20:23]
buffer_load_dwordx4 a[72:75], v242, s[20:23], s28 offen sc0 sc1
v_mfma_f32_16x16x32_bf16 v[24:27], a[160:163], a[0:3], v[24:27]
ds_read_b64_tr_b16 a[196:197], v236 offset:8200
v_add_u32 v184, v184, v185
v_mfma_f32_16x16x32_bf16 v[56:59], a[160:163], a[4:7], v[56:59]
ds_read_b64_tr_b16 a[198:199], v236 offset:12296
v_lshlrev_b32 v184, 4, v184
v_mfma_f32_16x16x32_bf16 v[88:91], a[160:163], a[8:11], v[88:91]
buffer_load_dwordx4 a[76:79], v243, s[20:23], s28 offen sc0 sc1
v_mfma_f32_16x16x32_bf16 v[120:123], a[160:163], a[12:15], v[120:123]
ds_read_b64_tr_b16 a[200:201], v237 offset:8192
s_add_u32 m0, s49, 32768
v_mfma_f32_16x16x32_bf16 v[124:127], a[164:167], a[12:15], v[124:127]
ds_read_b64_tr_b16 a[202:203], v237 offset:12288
v_add_u32 v180, 0x24000, v184
v_mfma_f32_16x16x32_bf16 v[92:95], a[164:167], a[8:11], v[92:95]
buffer_load_dwordx4 v238, s[16:19], s34 offen offset:0 lds
v_mfma_f32_16x16x32_bf16 v[60:63], a[164:167], a[4:7], v[60:63]
ds_read_b64_tr_b16 a[204:205], v237 offset:8200
v_mov_b32 v143, 0
v_mfma_f32_16x16x32_bf16 v[28:31], a[164:167], a[0:3], v[28:31]
ds_read_b64_tr_b16 a[206:207], v237 offset:12296
v_mfma_f32_16x16x32_bf16 v[32:35], a[168:171], a[0:3], v[32:35]
buffer_load_dwordx4 v239, s[16:19], s34 offen offset:1024 lds
v_mfma_f32_16x16x32_bf16 v[64:67], a[168:171], a[4:7], v[64:67]
s_mov_b32 s90, 0x01010101
s_mov_b32 s91, 0x01010101
v_mfma_f32_16x16x32_bf16 v[96:99], a[168:171], a[8:11], v[96:99]
s_add_u32 s34, s34, 262144
s_sub_u32 s51, s34, 4718592
s_cselect_b32 s34, s34, s51
v_mfma_f32_16x16x32_bf16 v[128:131], a[168:171], a[12:15], v[128:131]
s_waitcnt vmcnt(62)
v_max3_u32 v140, v136, v137, v138
v_mfma_f32_16x16x32_bf16 v[132:135], a[172:175], a[12:15], v[132:135]
v_max_u32 v140, v140, v139
v_mfma_f32_16x16x32_bf16 v[100:103], a[172:175], a[8:11], v[100:103]
v_mfma_f32_16x16x32_bf16 v[68:71], a[172:175], a[4:7], v[68:71]
v_max_u32_dpp v141, v140, v140 row_ror:8 row_mask:0xf bank_mask:0xf
v_mfma_f32_16x16x32_bf16 v[36:39], a[172:175], a[0:3], v[36:39]
s_waitcnt vmcnt(20)
s_waitcnt lgkmcnt(8)
v_mfma_f32_16x16x32_bf16 v[8:11], a[176:179], a[16:19], v[8:11]
v_add_u32 v234, 0xfffe0000, v234
v_add_u32 v235, 0xfffe0000, v235
v_mfma_f32_16x16x32_bf16 v[40:43], a[176:179], a[20:23], v[40:43]
v_add_u32 v236, 0xfffe0000, v236
v_add_u32 v237, 0xfffe0000, v237
v_mfma_f32_16x16x32_bf16 v[72:75], a[176:179], a[24:27], v[72:75]
v_max_u32_dpp v140, v141, v141 row_ror:4 row_mask:0xf bank_mask:0xf
v_mfma_f32_16x16x32_bf16 v[104:107], a[176:179], a[28:31], v[104:107]
ds_read_b64_tr_b16 a[144:145], v234 offset:0
v_mfma_f32_16x16x32_bf16 v[108:111], a[180:183], a[28:31], v[108:111]
ds_read_b64_tr_b16 a[146:147], v234 offset:4096
v_max_u32_dpp v141, v140, v140 row_ror:2 row_mask:0xf bank_mask:0xf
v_mfma_f32_16x16x32_bf16 v[76:79], a[180:183], a[24:27], v[76:79]
ds_read_b64_tr_b16 a[148:149], v234 offset:8
v_mfma_f32_16x16x32_bf16 v[44:47], a[180:183], a[20:23], v[44:47]
s_add_u32 s28, s28, 1024
s_cmp_lt_u32 s28, s6
s_cselect_b32 s28, s28, s4
v_mfma_f32_16x16x32_bf16 v[12:15], a[180:183], a[16:19], v[12:15]
ds_read_b64_tr_b16 a[150:151], v234 offset:4104
v_max_u32_dpp v140, v141, v141 row_ror:1 row_mask:0xf bank_mask:0xf
v_mfma_f32_16x16x32_bf16 v[16:19], a[184:187], a[16:19], v[16:19]
ds_read_b64_tr_b16 a[152:153], v235 offset:0
v_mov_b32 v141, v140
v_mfma_f32_16x16x32_bf16 v[48:51], a[184:187], a[20:23], v[48:51]
ds_read_b64_tr_b16 a[154:155], v235 offset:4096
v_mfma_f32_16x16x32_bf16 v[80:83], a[184:187], a[24:27], v[80:83]
buffer_load_dwordx4 a[80:83], v240, s[20:23], s28 offen sc0 sc1
v_mfma_f32_16x16x32_bf16 v[112:115], a[184:187], a[28:31], v[112:115]
ds_read_b64_tr_b16 a[156:157], v235 offset:8
v_permlane16_swap_b32 v140, v141
v_mfma_f32_16x16x32_bf16 v[116:119], a[188:191], a[28:31], v[116:119]
ds_read_b64_tr_b16 a[158:159], v235 offset:4104
v_max_u32 v140, v140, v141
v_mfma_f32_16x16x32_bf16 v[84:87], a[188:191], a[24:27], v[84:87]
buffer_load_dwordx4 a[84:87], v241, s[20:23], s28 offen sc0 sc1
v_mfma_f32_16x16x32_bf16 v[52:55], a[188:191], a[20:23], v[52:55]
ds_read_b64_tr_b16 a[160:161], v236 offset:0
v_mov_b32 v141, v140
v_mfma_f32_16x16x32_bf16 v[20:23], a[188:191], a[16:19], v[20:23]
ds_read_b64_tr_b16 a[162:163], v236 offset:4096
s_waitcnt lgkmcnt(8)
v_mfma_f32_16x16x32_bf16 v[24:27], a[192:195], a[16:19], v[24:27]
ds_read_b64_tr_b16 a[164:165], v236 offset:8
v_permlane32_swap_b32 v140, v141
v_mfma_f32_16x16x32_bf16 v[56:59], a[192:195], a[20:23], v[56:59]
buffer_load_dwordx4 a[88:91], v242, s[20:23], s28 offen sc0 sc1
v_mfma_f32_16x16x32_bf16 v[88:91], a[192:195], a[24:27], v[88:91]
ds_read_b64_tr_b16 a[166:167], v236 offset:4104
v_max_u32 v140, v140, v141
v_mfma_f32_16x16x32_bf16 v[120:123], a[192:195], a[28:31], v[120:123]
ds_read_b64_tr_b16 a[168:169], v237 offset:0
v_add_u32 v143, v143, v140
v_mfma_f32_16x16x32_bf16 v[124:127], a[196:199], a[28:31], v[124:127]
ds_read_b64_tr_b16 a[170:171], v237 offset:4096
v_sub_u32 v136, v136, v140
v_mfma_f32_16x16x32_bf16 v[92:95], a[196:199], a[24:27], v[92:95]
buffer_load_dwordx4 a[92:95], v243, s[20:23], s28 offen sc0 sc1
v_mfma_f32_16x16x32_bf16 v[60:63], a[196:199], a[20:23], v[60:63]
ds_read_b64_tr_b16 a[172:173], v237 offset:8
s_add_u32 m0, s49, 40960
v_mfma_f32_16x16x32_bf16 v[28:31], a[196:199], a[16:19], v[28:31]
ds_read_b64_tr_b16 a[174:175], v237 offset:4104
v_sub_u32 v137, v137, v140
v_mfma_f32_16x16x32_bf16 v[32:35], a[200:203], a[16:19], v[32:35]
buffer_load_dwordx4 v238, s[16:19], s34 offen offset:0 lds
v_mfma_f32_16x16x32_bf16 v[64:67], a[200:203], a[20:23], v[64:67]
buffer_load_dwordx4 v239, s[16:19], s34 offen offset:1024 lds
v_mfma_f32_16x16x32_bf16 v[96:99], a[200:203], a[24:27], v[96:99]
v_sub_u32 v138, v138, v140
v_sub_u32 v139, v139, v140
v_mfma_f32_16x16x32_bf16 v[128:131], a[200:203], a[28:31], v[128:131]
s_add_u32 s34, s34, 262144
s_sub_u32 s51, s34, 4718592
s_cselect_b32 s34, s34, s51
v_mfma_f32_16x16x32_bf16 v[132:135], a[204:207], a[28:31], v[132:135]
v_cndmask_b32 v142, v142, v143, s[90:91]
v_mfma_f32_16x16x32_bf16 v[100:103], a[204:207], a[24:27], v[100:103]
s_lshl_b64 s[90:91], s[90:91], 1
v_mfma_f32_16x16x32_bf16 v[68:71], a[204:207], a[20:23], v[68:71]
v_max3_u32 v140, v136, v137, v138
v_max_u32 v140, v140, v139
v_mfma_f32_16x16x32_bf16 v[36:39], a[204:207], a[16:19], v[36:39]
s_waitcnt vmcnt(20)
v_mfma_f32_16x16x32_bf16 v[8:11], a[144:147], a[32:35], v[8:11]
ds_read_b64_tr_b16 a[176:177], v234 offset:8192
v_max_u32_dpp v141, v140, v140 row_ror:8 row_mask:0xf bank_mask:0xf
v_mfma_f32_16x16x32_bf16 v[40:43], a[144:147], a[36:39], v[40:43]
ds_read_b64_tr_b16 a[178:179], v234 offset:12288
v_mfma_f32_16x16x32_bf16 v[72:75], a[144:147], a[40:43], v[72:75]
s_add_u32 s28, s28, 1024
s_cmp_lt_u32 s28, s6
s_cselect_b32 s28, s28, s4
v_mfma_f32_16x16x32_bf16 v[104:107], a[144:147], a[44:47], v[104:107]
ds_read_b64_tr_b16 a[180:181], v234 offset:8200
v_max_u32_dpp v140, v141, v141 row_ror:4 row_mask:0xf bank_mask:0xf
s_waitcnt lgkmcnt(8)
v_mfma_f32_16x16x32_bf16 v[108:111], a[148:151], a[44:47], v[108:111]
ds_read_b64_tr_b16 a[182:183], v234 offset:12296
v_mfma_f32_16x16x32_bf16 v[76:79], a[148:151], a[40:43], v[76:79]
buffer_load_dwordx4 a[96:99], v240, s[20:23], s28 offen sc0 sc1
v_mfma_f32_16x16x32_bf16 v[44:47], a[148:151], a[36:39], v[44:47]
ds_read_b64_tr_b16 a[184:185], v235 offset:8192
v_max_u32_dpp v141, v140, v140 row_ror:2 row_mask:0xf bank_mask:0xf
v_mfma_f32_16x16x32_bf16 v[12:15], a[148:151], a[32:35], v[12:15]
ds_read_b64_tr_b16 a[186:187], v235 offset:12288
v_mfma_f32_16x16x32_bf16 v[16:19], a[152:155], a[32:35], v[16:19]
buffer_load_dwordx4 a[100:103], v241, s[20:23], s28 offen sc0 sc1
v_mfma_f32_16x16x32_bf16 v[48:51], a[152:155], a[36:39], v[48:51]
ds_read_b64_tr_b16 a[188:189], v235 offset:8200
v_max_u32_dpp v140, v141, v141 row_ror:1 row_mask:0xf bank_mask:0xf
v_mfma_f32_16x16x32_bf16 v[80:83], a[152:155], a[40:43], v[80:83]
ds_read_b64_tr_b16 a[190:191], v235 offset:12296
v_mov_b32 v141, v140
v_mfma_f32_16x16x32_bf16 v[112:115], a[152:155], a[44:47], v[112:115]
buffer_load_dwordx4 a[104:107], v242, s[20:23], s28 offen sc0 sc1
v_mfma_f32_16x16x32_bf16 v[116:119], a[156:159], a[44:47], v[116:119]
ds_read_b64_tr_b16 a[192:193], v236 offset:8192
v_permlane16_swap_b32 v140, v141
v_mfma_f32_16x16x32_bf16 v[84:87], a[156:159], a[40:43], v[84:87]
buffer_load_dwordx4 a[108:111], v243, s[20:23], s28 offen sc0 sc1
v_mfma_f32_16x16x32_bf16 v[52:55], a[156:159], a[36:39], v[52:55]
ds_read_b64_tr_b16 a[194:195], v236 offset:12288
v_max_u32 v140, v140, v141
v_mfma_f32_16x16x32_bf16 v[20:23], a[156:159], a[32:35], v[20:23]
ds_read_b64_tr_b16 a[196:197], v236 offset:8200
v_mov_b32 v141, v140
v_mfma_f32_16x16x32_bf16 v[24:27], a[160:163], a[32:35], v[24:27]
s_add_u32 m0, s49, 49152
v_mfma_f32_16x16x32_bf16 v[56:59], a[160:163], a[36:39], v[56:59]
ds_read_b64_tr_b16 a[198:199], v236 offset:12296
v_permlane32_swap_b32 v140, v141
v_mfma_f32_16x16x32_bf16 v[88:91], a[160:163], a[40:43], v[88:91]
ds_read_b64_tr_b16 a[200:201], v237 offset:8192
v_max_u32 v140, v140, v141
v_mfma_f32_16x16x32_bf16 v[120:123], a[160:163], a[44:47], v[120:123]
v_add_u32 v143, v143, v140
v_sub_u32 v136, v136, v140
s_waitcnt lgkmcnt(8)
v_mfma_f32_16x16x32_bf16 v[124:127], a[164:167], a[44:47], v[124:127]
ds_read_b64_tr_b16 a[202:203], v237 offset:12288
v_sub_u32 v137, v137, v140
v_mfma_f32_16x16x32_bf16 v[92:95], a[164:167], a[40:43], v[92:95]
ds_read_b64_tr_b16 a[204:205], v237 offset:8200
v_sub_u32 v138, v138, v140
v_mfma_f32_16x16x32_bf16 v[60:63], a[164:167], a[36:39], v[60:63]
buffer_load_dwordx4 v238, s[16:19], s34 offen offset:0 lds
v_mfma_f32_16x16x32_bf16 v[28:31], a[164:167], a[32:35], v[28:31]
ds_read_b64_tr_b16 a[206:207], v237 offset:12296
v_sub_u32 v139, v139, v140
v_mfma_f32_16x16x32_bf16 v[32:35], a[168:171], a[32:35], v[32:35]
buffer_load_dwordx4 v239, s[16:19], s34 offen offset:1024 lds
v_mfma_f32_16x16x32_bf16 v[64:67], a[168:171], a[36:39], v[64:67]
v_cndmask_b32 v142, v142, v143, s[90:91]
v_mfma_f32_16x16x32_bf16 v[96:99], a[168:171], a[40:43], v[96:99]
s_add_u32 s34, s34, 262144
s_sub_u32 s51, s34, 4718592
s_cselect_b32 s34, s34, s51
v_mfma_f32_16x16x32_bf16 v[128:131], a[168:171], a[44:47], v[128:131]
s_lshl_b64 s[90:91], s[90:91], 1
v_mfma_f32_16x16x32_bf16 v[132:135], a[172:175], a[44:47], v[132:135]
v_max3_u32 v140, v136, v137, v138
v_max_u32 v140, v140, v139
v_mfma_f32_16x16x32_bf16 v[100:103], a[172:175], a[40:43], v[100:103]
v_mfma_f32_16x16x32_bf16 v[68:71], a[172:175], a[36:39], v[68:71]
v_max_u32_dpp v141, v140, v140 row_ror:8 row_mask:0xf bank_mask:0xf
v_mfma_f32_16x16x32_bf16 v[36:39], a[172:175], a[32:35], v[36:39]
s_waitcnt vmcnt(20)
v_mfma_f32_16x16x32_bf16 v[8:11], a[176:179], a[48:51], v[8:11]
v_max_u32_dpp v140, v141, v141 row_ror:4 row_mask:0xf bank_mask:0xf
v_mfma_f32_16x16x32_bf16 v[40:43], a[176:179], a[52:55], v[40:43]
s_waitcnt vmcnt(12) lgkmcnt(0)
s_barrier
v_mfma_f32_16x16x32_bf16 v[72:75], a[176:179], a[56:59], v[72:75]
ds_read_b64_tr_b16 a[144:145], v234 offset:16384
v_max_u32_dpp v141, v140, v140 row_ror:2 row_mask:0xf bank_mask:0xf
v_mfma_f32_16x16x32_bf16 v[104:107], a[176:179], a[60:63], v[104:107]
ds_read_b64_tr_b16 a[146:147], v234 offset:20480
v_mfma_f32_16x16x32_bf16 v[108:111], a[180:183], a[60:63], v[108:111]
ds_read_b64_tr_b16 a[148:149], v234 offset:16392
v_max_u32_dpp v140, v141, v141 row_ror:1 row_mask:0xf bank_mask:0xf
v_mfma_f32_16x16x32_bf16 v[76:79], a[180:183], a[56:59], v[76:79]
s_add_u32 s28, s28, 1024
s_cmp_lt_u32 s28, s6
s_cselect_b32 s28, s28, s4
v_mfma_f32_16x16x32_bf16 v[44:47], a[180:183], a[52:55], v[44:47]
ds_read_b64_tr_b16 a[150:151], v234 offset:20488
v_mov_b32 v141, v140
v_mfma_f32_16x16x32_bf16 v[12:15], a[180:183], a[48:51], v[12:15]
ds_read_b64_tr_b16 a[152:153], v235 offset:16384
v_mfma_f32_16x16x32_bf16 v[16:19], a[184:187], a[48:51], v[16:19]
buffer_load_dwordx4 a[112:115], v240, s[20:23], s28 offen sc0 sc1
v_mfma_f32_16x16x32_bf16 v[48:51], a[184:187], a[52:55], v[48:51]
ds_read_b64_tr_b16 a[154:155], v235 offset:20480
v_permlane16_swap_b32 v140, v141
v_mfma_f32_16x16x32_bf16 v[80:83], a[184:187], a[56:59], v[80:83]
ds_read_b64_tr_b16 a[156:157], v235 offset:16392
v_max_u32 v140, v140, v141
v_mfma_f32_16x16x32_bf16 v[112:115], a[184:187], a[60:63], v[112:115]
buffer_load_dwordx4 a[116:119], v241, s[20:23], s28 offen sc0 sc1
v_mfma_f32_16x16x32_bf16 v[116:119], a[188:191], a[60:63], v[116:119]
ds_read_b64_tr_b16 a[158:159], v235 offset:20488
v_mov_b32 v141, v140
v_mfma_f32_16x16x32_bf16 v[84:87], a[188:191], a[56:59], v[84:87]
ds_read_b64_tr_b16 a[160:161], v236 offset:16384
v_mfma_f32_16x16x32_bf16 v[52:55], a[188:191], a[52:55], v[52:55]
ds_read_b64_tr_b16 a[162:163], v236 offset:20480
v_permlane32_swap_b32 v140, v141
v_mfma_f32_16x16x32_bf16 v[20:23], a[188:191], a[48:51], v[20:23]
buffer_load_dwordx4 a[120:123], v242, s[20:23], s28 offen sc0 sc1
v_mfma_f32_16x16x32_bf16 v[24:27], a[192:195], a[48:51], v[24:27]
ds_read_b64_tr_b16 a[164:165], v236 offset:16392
v_max_u32 v140, v140, v141
v_mfma_f32_16x16x32_bf16 v[56:59], a[192:195], a[52:55], v[56:59]
ds_read_b64_tr_b16 a[166:167], v236 offset:20488
v_add_u32 v143, v143, v140
v_mfma_f32_16x16x32_bf16 v[88:91], a[192:195], a[56:59], v[88:91]
buffer_load_dwordx4 a[124:127], v243, s[20:23], s28 offen sc0 sc1
v_mfma_f32_16x16x32_bf16 v[120:123], a[192:195], a[60:63], v[120:123]
ds_read_b64_tr_b16 a[168:169], v237 offset:16384
s_add_u32 m0, s49, 57344
v_mfma_f32_16x16x32_bf16 v[124:127], a[196:199], a[60:63], v[124:127]
ds_read_b64_tr_b16 a[170:171], v237 offset:20480
v_sub_u32 v136, v136, v140
v_mfma_f32_16x16x32_bf16 v[92:95], a[196:199], a[56:59], v[92:95]
buffer_load_dwordx4 v238, s[16:19], s34 offen offset:0 lds
v_mfma_f32_16x16x32_bf16 v[60:63], a[196:199], a[52:55], v[60:63]
ds_read_b64_tr_b16 a[172:173], v237 offset:16392
v_sub_u32 v137, v137, v140
v_mfma_f32_16x16x32_bf16 v[28:31], a[196:199], a[48:51], v[28:31]
ds_read_b64_tr_b16 a[174:175], v237 offset:20488
v_sub_u32 v138, v138, v140
v_mfma_f32_16x16x32_bf16 v[32:35], a[200:203], a[48:51], v[32:35]
buffer_load_dwordx4 v239, s[16:19], s34 offen offset:1024 lds
v_mfma_f32_16x16x32_bf16 v[64:67], a[200:203], a[52:55], v[64:67]
v_sub_u32 v139, v139, v140
v_cndmask_b32 v142, v142, v143, s[90:91]
v_mfma_f32_16x16x32_bf16 v[96:99], a[200:203], a[56:59], v[96:99]
STUB_2:
STUB_A2:
s_cbranch_execz STUB_5
s_add_u32 s34, s34, 262144
s_sub_u32 s51, s34, 4718592
s_cselect_b32 s34, s34, s51
v_mfma_f32_16x16x32_bf16 v[128:131], a[200:203], a[60:63], v[128:131]
s_lshl_b64 s[90:91], s[90:91], 1
v_mfma_f32_16x16x32_bf16 v[132:135], a[204:207], a[60:63], v[132:135]
v_max3_u32 v140, v136, v137, v138
v_max_u32 v140, v140, v139
v_mfma_f32_16x16x32_bf16 v[100:103], a[204:207], a[56:59], v[100:103]
v_mfma_f32_16x16x32_bf16 v[68:71], a[204:207], a[52:55], v[68:71]
v_max_u32_dpp v141, v140, v140 row_ror:8 row_mask:0xf bank_mask:0xf
v_mfma_f32_16x16x32_bf16 v[36:39], a[204:207], a[48:51], v[36:39]
s_waitcnt vmcnt(20)
s_waitcnt lgkmcnt(8)
v_mfma_f32_16x16x32_bf16 v[8:11], a[144:147], a[64:67], v[8:11]
ds_read_b64_tr_b16 a[176:177], v234 offset:24576
v_max_u32_dpp v140, v141, v141 row_ror:4 row_mask:0xf bank_mask:0xf
v_mfma_f32_16x16x32_bf16 v[40:43], a[144:147], a[68:71], v[40:43]
ds_read_b64_tr_b16 a[178:179], v234 offset:28672
v_mfma_f32_16x16x32_bf16 v[72:75], a[144:147], a[72:75], v[72:75]
s_add_u32 s28, s28, 1024
s_cmp_lt_u32 s28, s6
s_cselect_b32 s28, s28, s4
v_mfma_f32_16x16x32_bf16 v[104:107], a[144:147], a[76:79], v[104:107]
ds_read_b64_tr_b16 a[180:181], v234 offset:24584
v_max_u32_dpp v141, v140, v140 row_ror:2 row_mask:0xf bank_mask:0xf
v_mfma_f32_16x16x32_bf16 v[108:111], a[148:151], a[76:79], v[108:111]
ds_read_b64_tr_b16 a[182:183], v234 offset:28680
v_mfma_f32_16x16x32_bf16 v[76:79], a[148:151], a[72:75], v[76:79]
buffer_load_dwordx4 a[0:3], v240, s[20:23], s28 offen sc0 sc1
v_mfma_f32_16x16x32_bf16 v[44:47], a[148:151], a[68:71], v[44:47]
ds_read_b64_tr_b16 a[184:185], v235 offset:24576
v_max_u32_dpp v140, v141, v141 row_ror:1 row_mask:0xf bank_mask:0xf
v_mfma_f32_16x16x32_bf16 v[12:15], a[148:151], a[64:67], v[12:15]
ds_read_b64_tr_b16 a[186:187], v235 offset:28672
v_mov_b32 v141, v140
v_mfma_f32_16x16x32_bf16 v[16:19], a[152:155], a[64:67], v[16:19]
buffer_load_dwordx4 a[4:7], v241, s[20:23], s28 offen sc0 sc1
v_mfma_f32_16x16x32_bf16 v[48:51], a[152:155], a[68:71], v[48:51]
ds_read_b64_tr_b16 a[188:189], v235 offset:24584
v_permlane16_swap_b32 v140, v141
v_mfma_f32_16x16x32_bf16 v[80:83], a[152:155], a[72:75], v[80:83]
ds_read_b64_tr_b16 a[190:191], v235 offset:28680
v_max_u32 v140, v140, v141
v_mfma_f32_16x16x32_bf16 v[112:115], a[152:155], a[76:79], v[112:115]
buffer_load_dwordx4 a[8:11], v242, s[20:23], s28 offen sc0 sc1
v_mfma_f32_16x16x32_bf16 v[116:119], a[156:159], a[76:79], v[116:119]
ds_read_b64_tr_b16 a[192:193], v236 offset:24576
v_mov_b32 v141, v140
v_mfma_f32_16x16x32_bf16 v[84:87], a[156:159], a[72:75], v[84:87]
buffer_load_dwordx4 a[12:15], v243, s[20:23], s28 offen sc0 sc1
v_mfma_f32_16x16x32_bf16 v[52:55], a[156:159], a[68:71], v[52:55]
ds_read_b64_tr_b16 a[194:195], v236 offset:28672
s_add_u32 s32, s7, 0
v_mfma_f32_16x16x32_bf16 v[20:23], a[156:159], a[64:67], v[20:23]
ds_read_b64_tr_b16 a[196:197], v236 offset:24584
v_permlane32_swap_b32 v140, v141
s_waitcnt lgkmcnt(8)
v_mfma_f32_16x16x32_bf16 v[24:27], a[160:163], a[64:67], v[24:27]
s_add_u32 m0, s30, 81920
v_max_u32 v140, v140, v141
v_mfma_f32_16x16x32_bf16 v[56:59], a[160:163], a[68:71], v[56:59]
ds_read_b64_tr_b16 a[198:199], v236 offset:28680
v_add_u32 v143, v143, v140
v_mfma_f32_16x16x32_bf16 v[88:91], a[160:163], a[72:75], v[88:91]
ds_read_b64_tr_b16 a[200:201], v237 offset:24576
v_sub_u32 v136, v136, v140
v_mfma_f32_16x16x32_bf16 v[120:123], a[160:163], a[76:79], v[120:123]
buffer_load_dwordx4 v228, s[8:11], s32 offen offset:0  lds
v_mfma_f32_16x16x32_bf16 v[124:127], a[164:167], a[76:79], v[124:127]
ds_read_b64_tr_b16 a[202:203], v237 offset:28672
v_sub_u32 v137, v137, v140
v_mfma_f32_16x16x32_bf16 v[92:95], a[164:167], a[72:75], v[92:95]
ds_read_b64_tr_b16 a[204:205], v237 offset:24584
v_sub_u32 v138, v138, v140
v_mfma_f32_16x16x32_bf16 v[60:63], a[164:167], a[68:71], v[60:63]
buffer_load_dwordx4 v229, s[8:11], s32 offen offset:1024  lds
v_mfma_f32_16x16x32_bf16 v[28:31], a[164:167], a[64:67], v[28:31]
ds_read_b64_tr_b16 a[206:207], v237 offset:28680
v_sub_u32 v139, v139, v140
v_mfma_f32_16x16x32_bf16 v[32:35], a[168:171], a[64:67], v[32:35]
buffer_load_dwordx4 v230, s[8:11], s32 offen offset:2048  lds
v_mfma_f32_16x16x32_bf16 v[64:67], a[168:171], a[68:71], v[64:67]
v_cndmask_b32 v142, v142, v143, s[90:91]
v_mfma_f32_16x16x32_bf16 v[96:99], a[168:171], a[72:75], v[96:99]
s_lshl_b64 s[90:91], s[90:91], 1
v_mfma_f32_16x16x32_bf16 v[128:131], a[168:171], a[76:79], v[128:131]
buffer_load_dwordx4 v231, s[8:11], s32 offen offset:3072  lds
v_mfma_f32_16x16x32_bf16 v[132:135], a[172:175], a[76:79], v[132:135]
v_max3_u32 v140, v136, v137, v138
v_max_u32 v140, v140, v139
v_mfma_f32_16x16x32_bf16 v[100:103], a[172:175], a[72:75], v[100:103]
v_mfma_f32_16x16x32_bf16 v[68:71], a[172:175], a[68:71], v[68:71]
v_max_u32_dpp v141, v140, v140 row_ror:8 row_mask:0xf bank_mask:0xf
v_mfma_f32_16x16x32_bf16 v[36:39], a[172:175], a[64:67], v[36:39]
s_waitcnt vmcnt(22)
v_mfma_f32_16x16x32_bf16 v[8:11], a[176:179], a[80:83], v[8:11]
ds_read_b64_tr_b16 a[144:145], v234 offset:32768
v_max_u32_dpp v140, v141, v141 row_ror:4 row_mask:0xf bank_mask:0xf
v_mfma_f32_16x16x32_bf16 v[40:43], a[176:179], a[84:87], v[40:43]
ds_read_b64_tr_b16 a[146:147], v234 offset:36864
v_mfma_f32_16x16x32_bf16 v[72:75], a[176:179], a[88:91], v[72:75]
s_add_u32 s28, s28, 1024
s_cmp_lt_u32 s28, s6
s_cselect_b32 s28, s28, s4
v_mfma_f32_16x16x32_bf16 v[104:107], a[176:179], a[92:95], v[104:107]
ds_read_b64_tr_b16 a[148:149], v234 offset:32776
v_max_u32_dpp v141, v140, v140 row_ror:2 row_mask:0xf bank_mask:0xf
s_waitcnt lgkmcnt(8)
v_mfma_f32_16x16x32_bf16 v[108:111], a[180:183], a[92:95], v[108:111]
ds_read_b64_tr_b16 a[150:151], v234 offset:36872
v_mfma_f32_16x16x32_bf16 v[76:79], a[180:183], a[88:91], v[76:79]
v_max_u32_dpp v140, v141, v141 row_ror:1 row_mask:0xf bank_mask:0xf
v_mov_b32 v141, v140
v_mfma_f32_16x16x32_bf16 v[44:47], a[180:183], a[84:87], v[44:47]
ds_read_b64_tr_b16 a[152:153], v235 offset:32768
v_mfma_f32_16x16x32_bf16 v[12:15], a[180:183], a[80:83], v[12:15]
ds_read_b64_tr_b16 a[154:155], v235 offset:36864
v_permlane16_swap_b32 v140, v141
v_mfma_f32_16x16x32_bf16 v[16:19], a[184:187], a[80:83], v[16:19]
buffer_load_dwordx4 a[16:19], v240, s[20:23], s28 offen sc0 sc1
v_mfma_f32_16x16x32_bf16 v[48:51], a[184:187], a[84:87], v[48:51]
ds_read_b64_tr_b16 a[156:157], v235 offset:32776
v_max_u32 v140, v140, v141
v_mfma_f32_16x16x32_bf16 v[80:83], a[184:187], a[88:91], v[80:83]
ds_read_b64_tr_b16 a[158:159], v235 offset:36872
v_mov_b32 v141, v140
v_mfma_f32_16x16x32_bf16 v[112:115], a[184:187], a[92:95], v[112:115]
v_mfma_f32_16x16x32_bf16 v[116:119], a[188:191], a[92:95], v[116:119]
ds_read_b64_tr_b16 a[160:161], v236 offset:32768
v_permlane32_swap_b32 v140, v141
v_mfma_f32_16x16x32_bf16 v[84:87], a[188:191], a[88:91], v[84:87]
buffer_load_dwordx4 a[20:23], v241, s[20:23], s28 offen sc0 sc1
v_mfma_f32_16x16x32_bf16 v[52:55], a[188:191], a[84:87], v[52:55]
ds_read_b64_tr_b16 a[162:163], v236 offset:36864
v_max_u32 v140, v140, v141
v_mfma_f32_16x16x32_bf16 v[20:23], a[188:191], a[80:83], v[20:23]
ds_read_b64_tr_b16 a[164:165], v236 offset:32776
v_add_u32 v143, v143, v140
v_mfma_f32_16x16x32_bf16 v[24:27], a[192:195], a[80:83], v[24:27]
v_sub_u32 v136, v136, v140
v_sub_u32 v137, v137, v140
v_mfma_f32_16x16x32_bf16 v[56:59], a[192:195], a[84:87], v[56:59]
ds_read_b64_tr_b16 a[166:167], v236 offset:36872
v_sub_u32 v138, v138, v140
v_mfma_f32_16x16x32_bf16 v[88:91], a[192:195], a[88:91], v[88:91]
ds_read_b64_tr_b16 a[168:169], v237 offset:32768
v_sub_u32 v139, v139, v140
v_mfma_f32_16x16x32_bf16 v[120:123], a[192:195], a[92:95], v[120:123]
buffer_load_dwordx4 a[24:27], v242, s[20:23], s28 offen sc0 sc1
s_waitcnt lgkmcnt(8)
v_mfma_f32_16x16x32_bf16 v[124:127], a[196:199], a[92:95], v[124:127]
ds_read_b64_tr_b16 a[170:171], v237 offset:36864
v_cndmask_b32 v142, v142, v143, s[90:91]
v_mfma_f32_16x16x32_bf16 v[92:95], a[196:199], a[88:91], v[92:95]
ds_read_b64_tr_b16 a[172:173], v237 offset:32776
s_lshl_b64 s[90:91], s[90:91], 1
v_mfma_f32_16x16x32_bf16 v[60:63], a[196:199], a[84:87], v[60:63]
v_max3_u32 v140, v136, v137, v138
v_max_u32 v140, v140, v139
v_mfma_f32_16x16x32_bf16 v[28:31], a[196:199], a[80:83], v[28:31]
ds_read_b64_tr_b16 a[174:175], v237 offset:36872
v_mfma_f32_16x16x32_bf16 v[32:35], a[200:203], a[80:83], v[32:35]
buffer_load_dwordx4 a[28:31], v243, s[20:23], s28 offen sc0 sc1
v_mfma_f32_16x16x32_bf16 v[64:67], a[200:203], a[84:87], v[64:67]
v_max_u32_dpp v141, v140, v140 row_ror:8 row_mask:0xf bank_mask:0xf
v_mfma_f32_16x16x32_bf16 v[96:99], a[200:203], a[88:91], v[96:99]
v_mfma_f32_16x16x32_bf16 v[128:131], a[200:203], a[92:95], v[128:131]
v_max_u32_dpp v140, v141, v141 row_ror:4 row_mask:0xf bank_mask:0xf
v_mfma_f32_16x16x32_bf16 v[132:135], a[204:207], a[92:95], v[132:135]
v_mfma_f32_16x16x32_bf16 v[100:103], a[204:207], a[88:91], v[100:103]
v_max_u32_dpp v141, v140, v140 row_ror:2 row_mask:0xf bank_mask:0xf
v_mfma_f32_16x16x32_bf16 v[68:71], a[204:207], a[84:87], v[68:71]
v_mfma_f32_16x16x32_bf16 v[36:39], a[204:207], a[80:83], v[36:39]
v_max_u32_dpp v140, v141, v141 row_ror:1 row_mask:0xf bank_mask:0xf
v_mov_b32 v141, v140
s_waitcnt vmcnt(20)
v_mfma_f32_16x16x32_bf16 v[8:11], a[144:147], a[96:99], v[8:11]
v_mfma_f32_16x16x32_bf16 v[40:43], a[144:147], a[100:103], v[40:43]
s_waitcnt vmcnt(12) lgkmcnt(0)
s_barrier
v_mfma_f32_16x16x32_bf16 v[72:75], a[144:147], a[104:107], v[72:75]
ds_read_b64_tr_b16 a[176:177], v234 offset:40960
s_add_u32 s32, s7, 16384
v_mfma_f32_16x16x32_bf16 v[104:107], a[144:147], a[108:111], v[104:107]
ds_read_b64_tr_b16 a[178:179], v234 offset:45056
v_permlane16_swap_b32 v140, v141
v_mfma_f32_16x16x32_bf16 v[108:111], a[148:151], a[108:111], v[108:111]
ds_read_b64_tr_b16 a[180:181], v234 offset:40968
v_max_u32 v140, v140, v141
v_mfma_f32_16x16x32_bf16 v[76:79], a[148:151], a[104:107], v[76:79]
buffer_store_dword v171, v170, s[20:23], 0 offen sc0 sc1
v_mfma_f32_16x16x32_bf16 v[44:47], a[148:151], a[100:103], v[44:47]
ds_read_b64_tr_b16 a[182:183], v234 offset:45064
s_add_u32 m0, s30, 114688
v_mfma_f32_16x16x32_bf16 v[12:15], a[148:151], a[96:99], v[12:15]
ds_read_b64_tr_b16 a[184:185], v235 offset:40960
ds_read_b128 v[152:155], v178
v_mfma_f32_16x16x32_bf16 v[16:19], a[152:155], a[96:99], v[16:19]
ds_read_b128 v[156:159], v179
v_mov_b32 v141, v140
v_mfma_f32_16x16x32_bf16 v[48:51], a[152:155], a[100:103], v[48:51]
ds_read_b64_tr_b16 a[186:187], v235 offset:45056
ds_read_b128 v[160:163], v180
v_mfma_f32_16x16x32_bf16 v[80:83], a[152:155], a[104:107], v[80:83]
ds_read_b64_tr_b16 a[188:189], v235 offset:40968
v_permlane32_swap_b32 v140, v141
v_mfma_f32_16x16x32_bf16 v[112:115], a[152:155], a[108:111], v[112:115]
buffer_load_dwordx4 v228, s[8:11], s32 offen offset:0  lds
v_mfma_f32_16x16x32_bf16 v[116:119], a[156:159], a[108:111], v[116:119]
ds_read_b64_tr_b16 a[190:191], v235 offset:45064
v_max_u32 v140, v140, v141
v_mfma_f32_16x16x32_bf16 v[84:87], a[156:159], a[104:107], v[84:87]
ds_read_b64_tr_b16 a[192:193], v236 offset:40960
v_add_u32 v143, v143, v140
v_mfma_f32_16x16x32_bf16 v[52:55], a[156:159], a[100:103], v[52:55]
ds_read_b64_tr_b16 a[194:195], v236 offset:45056
v_sub_u32 v136, v136, v140
v_mfma_f32_16x16x32_bf16 v[20:23], a[156:159], a[96:99], v[20:23]
s_mul_i32 s45, s3, 1152
s_add_u32 s45, s45, s31
v_mfma_f32_16x16x32_bf16 v[24:27], a[160:163], a[96:99], v[24:27]
ds_read_b64_tr_b16 a[196:197], v236 offset:40968
s_add_u32 s45, s45, 0x1c00000
v_mfma_f32_16x16x32_bf16 v[56:59], a[160:163], a[100:103], v[56:59]
ds_read_b64_tr_b16 a[198:199], v236 offset:45064
v_sub_u32 v137, v137, v140
v_mfma_f32_16x16x32_bf16 v[88:91], a[160:163], a[104:107], v[88:91]
buffer_load_dwordx4 v229, s[8:11], s32 offen offset:1024  lds
v_mfma_f32_16x16x32_bf16 v[120:123], a[160:163], a[108:111], v[120:123]
ds_read_b64_tr_b16 a[200:201], v237 offset:40960
v_sub_u32 v138, v138, v140
v_mfma_f32_16x16x32_bf16 v[124:127], a[164:167], a[108:111], v[124:127]
ds_read_b64_tr_b16 a[202:203], v237 offset:45056
v_sub_u32 v139, v139, v140
v_mfma_f32_16x16x32_bf16 v[92:95], a[164:167], a[104:107], v[92:95]
buffer_load_dwordx4 v230, s[8:11], s32 offen offset:2048  lds
v_mfma_f32_16x16x32_bf16 v[60:63], a[164:167], a[100:103], v[60:63]
ds_read_b64_tr_b16 a[204:205], v237 offset:40968
v_cndmask_b32 v142, v142, v143, s[90:91]
v_mfma_f32_16x16x32_bf16 v[28:31], a[164:167], a[96:99], v[28:31]
ds_read_b64_tr_b16 a[206:207], v237 offset:45064
s_lshl_b64 s[90:91], s[90:91], 1
v_mfma_f32_16x16x32_bf16 v[32:35], a[168:171], a[96:99], v[32:35]
s_waitcnt lgkmcnt(8)
buffer_store_dwordx4 v[152:155], v244, s[20:23], s45 offen sc0 sc1
v_mfma_f32_16x16x32_bf16 v[64:67], a[168:171], a[100:103], v[64:67]
buffer_load_dwordx4 v231, s[8:11], s32 offen offset:3072  lds
v_mfma_f32_16x16x32_bf16 v[96:99], a[168:171], a[104:107], v[96:99]
v_max3_u32 v140, v136, v137, v138
v_max_u32 v140, v140, v139
v_mfma_f32_16x16x32_bf16 v[128:131], a[168:171], a[108:111], v[128:131]
v_mfma_f32_16x16x32_bf16 v[132:135], a[172:175], a[108:111], v[132:135]
v_max_u32_dpp v141, v140, v140 row_ror:8 row_mask:0xf bank_mask:0xf
v_mfma_f32_16x16x32_bf16 v[100:103], a[172:175], a[104:107], v[100:103]
v_mfma_f32_16x16x32_bf16 v[68:71], a[172:175], a[100:103], v[68:71]
s_add_u32 s45, s45, 4096
buffer_store_dwordx4 v[156:159], v244, s[20:23], s45 offen sc0 sc1
v_mfma_f32_16x16x32_bf16 v[36:39], a[172:175], a[96:99], v[36:39]
v_max_u32_dpp v140, v141, v141 row_ror:4 row_mask:0xf bank_mask:0xf
s_waitcnt vmcnt(21)
v_mfma_f32_16x16x32_bf16 v[8:11], a[176:179], a[112:115], v[8:11]
ds_read_b64_tr_b16 a[144:145], v234 offset:49152
v_mfma_f32_16x16x32_bf16 v[40:43], a[176:179], a[116:119], v[40:43]
ds_read_b64_tr_b16 a[146:147], v234 offset:53248
v_max_u32_dpp v141, v140, v140 row_ror:2 row_mask:0xf bank_mask:0xf
v_mfma_f32_16x16x32_bf16 v[72:75], a[176:179], a[120:123], v[72:75]
v_mfma_f32_16x16x32_bf16 v[104:107], a[176:179], a[124:127], v[104:107]
ds_read_b64_tr_b16 a[148:149], v234 offset:49160
v_max_u32_dpp v140, v141, v141 row_ror:1 row_mask:0xf bank_mask:0xf
v_mfma_f32_16x16x32_bf16 v[108:111], a[180:183], a[124:127], v[108:111]
ds_read_b64_tr_b16 a[150:151], v234 offset:53256
v_mov_b32 v141, v140
v_mfma_f32_16x16x32_bf16 v[76:79], a[180:183], a[120:123], v[76:79]
s_add_u32 s45, s45, 4096
s_cmp_eq_u32 s37, 0
s_cselect_b32 s45, s45, 0x7ffffff0
buffer_store_dwordx4 v[160:163], v244, s[20:23], s45 offen sc0 sc1
v_mfma_f32_16x16x32_bf16 v[44:47], a[180:183], a[116:119], v[44:47]
ds_read_b64_tr_b16 a[152:153], v235 offset:49152
s_mul_i32 s88, s37, 864
v_mfma_f32_16x16x32_bf16 v[12:15], a[180:183], a[112:115], v[12:15]
ds_read_b64_tr_b16 a[154:155], v235 offset:53248
s_mov_b32 s87, s88
v_mfma_f32_16x16x32_bf16 v[16:19], a[184:187], a[112:115], v[16:19]
v_accvgpr_write_b32 a128, 0
v_accvgpr_write_b32 a129, 0
v_mfma_f32_16x16x32_bf16 v[48:51], a[184:187], a[116:119], v[48:51]
ds_read_b64_tr_b16 a[156:157], v235 offset:49160
v_accvgpr_write_b32 a130, 0
v_mfma_f32_16x16x32_bf16 v[80:83], a[184:187], a[120:123], v[80:83]
ds_read_b64_tr_b16 a[158:159], v235 offset:53256
v_accvgpr_write_b32 a131, 0
v_mfma_f32_16x16x32_bf16 v[112:115], a[184:187], a[124:127], v[112:115]
v_accvgpr_write_b32 a132, 0
v_accvgpr_write_b32 a133, 0
v_mfma_f32_16x16x32_bf16 v[116:119], a[188:191], a[124:127], v[116:119]
ds_read_b64_tr_b16 a[160:161], v236 offset:49152
v_accvgpr_write_b32 a134, 0
v_mfma_f32_16x16x32_bf16 v[84:87], a[188:191], a[120:123], v[84:87]
v_accvgpr_write_b32 a135, 0
v_lshrrev_b32 v240, 2, v1
v_mfma_f32_16x16x32_bf16 v[52:55], a[188:191], a[116:119], v[52:55]
ds_read_b64_tr_b16 a[162:163], v236 offset:53248
v_mul_u32_u24 v240, 0x2400, v240
v_mfma_f32_16x16x32_bf16 v[20:23], a[188:191], a[112:115], v[20:23]
ds_read_b64_tr_b16 a[164:165], v236 offset:49160
v_and_b32 v246, 3, v1
s_waitcnt lgkmcnt(8)
v_mfma_f32_16x16x32_bf16 v[24:27], a[192:195], a[112:115], v[24:27]
v_lshl_add_u32 v240, v246, 4, v240
v_mul_u32_u24 v243, 3641, v1
v_mfma_f32_16x16x32_bf16 v[56:59], a[192:195], a[116:119], v[56:59]
ds_read_b64_tr_b16 a[166:167], v236 offset:53256
v_lshrrev_b32 v243, 16, v243
v_mfma_f32_16x16x32_bf16 v[88:91], a[192:195], a[120:123], v[88:91]
ds_read_b64_tr_b16 a[168:169], v237 offset:49152
v_mul_u32_u24 v243, 864, v243
v_mfma_f32_16x16x32_bf16 v[120:123], a[192:195], a[124:127], v[120:123]
v_add_u32 v243, v243, v244
v_permlane16_swap_b32 v140, v141
v_mfma_f32_16x16x32_bf16 v[124:127], a[196:199], a[124:127], v[124:127]
ds_read_b64_tr_b16 a[170:171], v237 offset:53248
s_sub_u32 s92, s2, 144
v_mfma_f32_16x16x32_bf16 v[92:95], a[196:199], a[120:123], v[92:95]
ds_read_b64_tr_b16 a[172:173], v237 offset:49160
v_max_u32 v140, v140, v141
v_mfma_f32_16x16x32_bf16 v[60:63], a[196:199], a[116:119], v[60:63]
s_cmp_lt_u32 s92, 72
s_cselect_b32 s3, 4, 0
v_mfma_f32_16x16x32_bf16 v[28:31], a[196:199], a[112:115], v[28:31]
ds_read_b64_tr_b16 a[174:175], v237 offset:53256
v_mov_b32 v141, v140
v_mfma_f32_16x16x32_bf16 v[32:35], a[200:203], a[112:115], v[32:35]
s_cmp_lt_u32 s2, 144
s_cselect_b32 s3, 5, s3
v_mfma_f32_16x16x32_bf16 v[64:67], a[200:203], a[116:119], v[64:67]
v_permlane32_swap_b32 v140, v141
v_max_u32 v140, v140, v141
v_mfma_f32_16x16x32_bf16 v[96:99], a[200:203], a[120:123], v[96:99]
v_add_u32 v143, v143, v140
v_sub_u32 v136, v136, v140
v_mfma_f32_16x16x32_bf16 v[128:131], a[200:203], a[124:127], v[128:131]
v_sub_u32 v137, v137, v140
v_sub_u32 v138, v138, v140
v_mfma_f32_16x16x32_bf16 v[132:135], a[204:207], a[124:127], v[132:135]
v_sub_u32 v139, v139, v140
v_cndmask_b32 v142, v142, v143, s[90:91]
v_mfma_f32_16x16x32_bf16 v[100:103], a[204:207], a[120:123], v[100:103]
s_lshl_b64 s[90:91], s[90:91], 1
v_mfma_f32_16x16x32_bf16 v[68:71], a[204:207], a[116:119], v[68:71]
v_max3_u32 v140, v136, v137, v138
v_max_u32 v140, v140, v139
v_mfma_f32_16x16x32_bf16 v[36:39], a[204:207], a[112:115], v[36:39]
s_waitcnt vmcnt(16)
v_mfma_f32_16x16x32_bf16 v[8:11], a[144:147], a[0:3], v[8:11]
ds_read_b64_tr_b16 a[176:177], v234 offset:57344
s_add_u32 s39, s7, 0
v_mfma_f32_16x16x32_bf16 v[40:43], a[144:147], a[4:7], v[40:43]
ds_read_b64_tr_b16 a[178:179], v234 offset:61440
v_max_u32_dpp v141, v140, v140 row_ror:8 row_mask:0xf bank_mask:0xf
v_mfma_f32_16x16x32_bf16 v[72:75], a[144:147], a[8:11], v[72:75]
v_mfma_f32_16x16x32_bf16 v[104:107], a[144:147], a[12:15], v[104:107]
ds_read_b64_tr_b16 a[180:181], v234 offset:57352
v_max_u32_dpp v140, v141, v141 row_ror:4 row_mask:0xf bank_mask:0xf
s_waitcnt lgkmcnt(8)
v_mfma_f32_16x16x32_bf16 v[108:111], a[148:151], a[12:15], v[108:111]
ds_read_b64_tr_b16 a[182:183], v234 offset:61448
v_mfma_f32_16x16x32_bf16 v[76:79], a[148:151], a[8:11], v[76:79]
s_add_u32 m0, s30, 131072
v_max_u32_dpp v141, v140, v140 row_ror:2 row_mask:0xf bank_mask:0xf
v_mfma_f32_16x16x32_bf16 v[44:47], a[148:151], a[4:7], v[44:47]
ds_read_b64_tr_b16 a[184:185], v235 offset:57344
v_mfma_f32_16x16x32_bf16 v[12:15], a[148:151], a[0:3], v[12:15]
ds_read_b64_tr_b16 a[186:187], v235 offset:61440
v_max_u32_dpp v140, v141, v141 row_ror:1 row_mask:0xf bank_mask:0xf
v_mfma_f32_16x16x32_bf16 v[16:19], a[152:155], a[0:3], v[16:19]
v_mov_b32 v141, v140
v_mfma_f32_16x16x32_bf16 v[48:51], a[152:155], a[4:7], v[48:51]
ds_read_b64_tr_b16 a[188:189], v235 offset:57352
v_mfma_f32_16x16x32_bf16 v[80:83], a[152:155], a[8:11], v[80:83]
ds_read_b64_tr_b16 a[190:191], v235 offset:61448
v_permlane16_swap_b32 v140, v141
v_mfma_f32_16x16x32_bf16 v[112:115], a[152:155], a[12:15], v[112:115]
buffer_load_dwordx4 v232, s[12:15], s39 offen offset:0  lds
v_mfma_f32_16x16x32_bf16 v[116:119], a[156:159], a[12:15], v[116:119]
ds_read_b64_tr_b16 a[192:193], v236 offset:57344
v_max_u32 v140, v140, v141
v_mfma_f32_16x16x32_bf16 v[84:87], a[156:159], a[8:11], v[84:87]
v_mov_b32 v141, v140
v_mfma_f32_16x16x32_bf16 v[52:55], a[156:159], a[4:7], v[52:55]
ds_read_b64_tr_b16 a[194:195], v236 offset:61440
v_mfma_f32_16x16x32_bf16 v[20:23], a[156:159], a[0:3], v[20:23]
ds_read_b64_tr_b16 a[196:197], v236 offset:57352
v_permlane32_swap_b32 v140, v141
v_mfma_f32_16x16x32_bf16 v[24:27], a[160:163], a[0:3], v[24:27]
buffer_load_dwordx4 v233, s[12:15], s39 offen offset:1024  lds
v_mfma_f32_16x16x32_bf16 v[56:59], a[160:163], a[4:7], v[56:59]
ds_read_b64_tr_b16 a[198:199], v236 offset:61448
v_max_u32 v140, v140, v141
v_mfma_f32_16x16x32_bf16 v[88:91], a[160:163], a[8:11], v[88:91]
ds_read_b64_tr_b16 a[200:201], v237 offset:57344
v_add_u32 v143, v143, v140
v_mfma_f32_16x16x32_bf16 v[120:123], a[160:163], a[12:15], v[120:123]
v_cndmask_b32 v142, v142, v143, s[90:91]
s_waitcnt lgkmcnt(8)
v_mfma_f32_16x16x32_bf16 v[124:127], a[164:167], a[12:15], v[124:127]
ds_read_b64_tr_b16 a[202:203], v237 offset:61440
v_mfma_f32_16x16x32_bf16 v[92:95], a[164:167], a[8:11], v[92:95]
ds_read_b64_tr_b16 a[204:205], v237 offset:57352
v_mfma_f32_16x16x32_bf16 v[60:63], a[164:167], a[4:7], v[60:63]
buffer_load_dwordx4 v232, s[12:15], s39 offen offset:2048  lds
v_mfma_f32_16x16x32_bf16 v[28:31], a[164:167], a[0:3], v[28:31]
ds_read_b64_tr_b16 a[206:207], v237 offset:61448
v_mfma_f32_16x16x32_bf16 v[32:35], a[168:171], a[0:3], v[32:35]
v_lshlrev_b32 v136, 3, v1
v_mov_b32 v137, 0x7ffffff0
v_mfma_f32_16x16x32_bf16 v[64:67], a[168:171], a[4:7], v[64:67]
buffer_load_dwordx4 v233, s[12:15], s39 offen offset:3072  lds
v_mfma_f32_16x16x32_bf16 v[96:99], a[168:171], a[8:11], v[96:99]
v_cmp_lt_u32 vcc, 7, v1
v_mov_b32 v143, s47
v_mfma_f32_16x16x32_bf16 v[128:131], a[168:171], a[12:15], v[128:131]
v_mfma_f32_16x16x32_bf16 v[132:135], a[172:175], a[12:15], v[132:135]
v_cndmask_b32 v136, v136, v137, vcc
v_mfma_f32_16x16x32_bf16 v[100:103], a[172:175], a[8:11], v[100:103]
s_lshl_b32 s29, s36, 6
s_add_u32 s29, s29, 0x242000
v_mfma_f32_16x16x32_bf16 v[68:71], a[172:175], a[4:7], v[68:71]
s_add_u32 s50, s35, s37
s_cmp_eq_u32 s50, 0
s_cselect_b32 s29, s29, 0x7ffffff0
v_mfma_f32_16x16x32_bf16 v[36:39], a[172:175], a[0:3], v[36:39]
buffer_store_dwordx2 v[142:143], v136, s[20:23], s29 offen sc0 sc1
s_waitcnt vmcnt(13)
v_mfma_f32_16x16x32_bf16 v[8:11], a[176:179], a[16:19], v[8:11]
v_mfma_f32_16x16x32_bf16 v[12:15], a[180:183], a[16:19], v[12:15]
s_waitcnt vmcnt(17) lgkmcnt(0)
s_barrier
v_mfma_f32_16x16x32_bf16 v[16:19], a[184:187], a[16:19], v[16:19]
ds_read_b128 a[144:147], v216 offset:16384
ds_read_b128 a[148:151], v217 offset:16384
v_mfma_f32_16x16x32_bf16 v[20:23], a[188:191], a[16:19], v[20:23]
ds_read_b128 a[152:155], v218 offset:16384
ds_read_b128 a[156:159], v219 offset:16384
v_mfma_f32_16x16x32_bf16 v[24:27], a[192:195], a[16:19], v[24:27]
ds_read_b128 a[160:163], v216 offset:20480
ds_read_b128 a[164:167], v217 offset:20480
v_mfma_f32_16x16x32_bf16 v[28:31], a[196:199], a[16:19], v[28:31]
ds_read_b128 a[168:171], v218 offset:20480
ds_read_b128 a[172:175], v219 offset:20480
v_mfma_f32_16x16x32_bf16 v[32:35], a[200:203], a[16:19], v[32:35]
s_add_u32 s32, s7, 32768
v_mfma_f32_16x16x32_bf16 v[36:39], a[204:207], a[16:19], v[36:39]
s_add_u32 m0, s30, 65536
v_mfma_f32_16x16x32_bf16 v[40:43], a[176:179], a[20:23], v[40:43]
v_cvt_pk_bf16_f32 v152, v8, v9
v_cvt_pk_bf16_f32 v153, v10, v11
v_mfma_f32_16x16x32_bf16 v[44:47], a[180:183], a[20:23], v[44:47]
v_cvt_pk_bf16_f32 v154, v12, v13
v_cvt_pk_bf16_f32 v155, v14, v15
v_mfma_f32_16x16x32_bf16 v[48:51], a[184:187], a[20:23], v[48:51]
v_cvt_pk_bf16_f32 v156, v16, v17
v_cvt_pk_bf16_f32 v157, v18, v19
v_mfma_f32_16x16x32_bf16 v[52:55], a[188:191], a[20:23], v[52:55]
v_cvt_pk_bf16_f32 v158, v20, v21
v_cvt_pk_bf16_f32 v159, v22, v23
v_mfma_f32_16x16x32_bf16 v[56:59], a[192:195], a[20:23], v[56:59]
v_cvt_pk_bf16_f32 v160, v24, v25
v_cvt_pk_bf16_f32 v161, v26, v27
v_mfma_f32_16x16x32_bf16 v[60:63], a[196:199], a[20:23], v[60:63]
v_cvt_pk_bf16_f32 v162, v28, v29
v_cvt_pk_bf16_f32 v163, v30, v31
v_mfma_f32_16x16x32_bf16 v[64:67], a[200:203], a[20:23], v[64:67]
v_cvt_pk_bf16_f32 v164, v32, v33
v_cvt_pk_bf16_f32 v165, v34, v35
v_mfma_f32_16x16x32_bf16 v[68:71], a[204:207], a[20:23], v[68:71]
v_cvt_pk_bf16_f32 v166, v36, v37
v_cvt_pk_bf16_f32 v167, v38, v39
v_mfma_f32_16x16x32_bf16 v[72:75], a[176:179], a[24:27], v[72:75]
v_cvt_pk_bf16_f32 v168, v40, v41
v_cvt_pk_bf16_f32 v169, v42, v43
v_mfma_f32_16x16x32_bf16 v[76:79], a[180:183], a[24:27], v[76:79]
v_cvt_pk_bf16_f32 v170, v44, v45
v_cvt_pk_bf16_f32 v171, v46, v47
v_mfma_f32_16x16x32_bf16 v[80:83], a[184:187], a[24:27], v[80:83]
v_cvt_pk_bf16_f32 v172, v48, v49
v_cvt_pk_bf16_f32 v173, v50, v51
v_mfma_f32_16x16x32_bf16 v[84:87], a[188:191], a[24:27], v[84:87]
v_cvt_pk_bf16_f32 v174, v52, v53
v_cvt_pk_bf16_f32 v175, v54, v55
v_mfma_f32_16x16x32_bf16 v[88:91], a[192:195], a[24:27], v[88:91]
v_cvt_pk_bf16_f32 v176, v56, v57
v_cvt_pk_bf16_f32 v177, v58, v59
v_mfma_f32_16x16x32_bf16 v[92:95], a[196:199], a[24:27], v[92:95]
v_cvt_pk_bf16_f32 v178, v60, v61
v_cvt_pk_bf16_f32 v179, v62, v63
v_mfma_f32_16x16x32_bf16 v[96:99], a[200:203], a[24:27], v[96:99]
v_cvt_pk_bf16_f32 v180, v64, v65
v_cvt_pk_bf16_f32 v181, v66, v67
v_mfma_f32_16x16x32_bf16 v[100:103], a[204:207], a[24:27], v[100:103]
v_cvt_pk_bf16_f32 v182, v68, v69
v_cvt_pk_bf16_f32 v183, v70, v71
v_mfma_f32_16x16x32_bf16 v[104:107], a[176:179], a[28:31], v[104:107]
v_cvt_pk_bf16_f32 v184, v72, v73
v_cvt_pk_bf16_f32 v185, v74, v75
v_mfma_f32_16x16x32_bf16 v[108:111], a[180:183], a[28:31], v[108:111]
v_cvt_pk_bf16_f32 v186, v76, v77
v_cvt_pk_bf16_f32 v187, v78, v79
v_mfma_f32_16x16x32_bf16 v[112:115], a[184:187], a[28:31], v[112:115]
v_cvt_pk_bf16_f32 v188, v80, v81
v_cvt_pk_bf16_f32 v189, v82, v83
v_mfma_f32_16x16x32_bf16 v[116:119], a[188:191], a[28:31], v[116:119]
v_cvt_pk_bf16_f32 v190, v84, v85
v_cvt_pk_bf16_f32 v191, v86, v87
v_mfma_f32_16x16x32_bf16 v[120:123], a[192:195], a[28:31], v[120:123]
v_cvt_pk_bf16_f32 v192, v88, v89
v_cvt_pk_bf16_f32 v193, v90, v91
v_mfma_f32_16x16x32_bf16 v[124:127], a[196:199], a[28:31], v[124:127]
v_cvt_pk_bf16_f32 v194, v92, v93
v_cvt_pk_bf16_f32 v195, v94, v95
v_mfma_f32_16x16x32_bf16 v[128:131], a[200:203], a[28:31], v[128:131]
v_cvt_pk_bf16_f32 v196, v96, v97
v_cvt_pk_bf16_f32 v197, v98, v99
v_mfma_f32_16x16x32_bf16 v[132:135], a[204:207], a[28:31], v[132:135]
v_cvt_pk_bf16_f32 v198, v100, v101
v_cvt_pk_bf16_f32 v199, v102, v103
s_waitcnt lgkmcnt(7)
v_mfma_f32_16x16x32_bf16 v[8:11], a[144:147], v[152:155], 0
v_cvt_pk_bf16_f32 v200, v104, v105
v_cvt_pk_bf16_f32 v201, v106, v107
s_waitcnt lgkmcnt(6)
v_mfma_f32_16x16x32_bf16 v[8:11], a[148:151], v[156:159], v[8:11]
v_cvt_pk_bf16_f32 v202, v108, v109
v_cvt_pk_bf16_f32 v203, v110, v111
s_waitcnt lgkmcnt(5)
v_mfma_f32_16x16x32_bf16 v[8:11], a[152:155], v[160:163], v[8:11]
v_cvt_pk_bf16_f32 v204, v112, v113
v_cvt_pk_bf16_f32 v205, v114, v115
s_waitcnt lgkmcnt(4)
v_mfma_f32_16x16x32_bf16 v[8:11], a[156:159], v[164:167], v[8:11]
v_cvt_pk_bf16_f32 v206, v116, v117
v_cvt_pk_bf16_f32 v207, v118, v119
s_waitcnt lgkmcnt(3)
v_mfma_f32_16x16x32_bf16 v[12:15], a[160:163], v[152:155], 0
v_cvt_pk_bf16_f32 v208, v120, v121
v_cvt_pk_bf16_f32 v209, v122, v123
s_waitcnt lgkmcnt(2)
v_mfma_f32_16x16x32_bf16 v[12:15], a[164:167], v[156:159], v[12:15]
v_cvt_pk_bf16_f32 v210, v124, v125
v_cvt_pk_bf16_f32 v211, v126, v127
s_waitcnt lgkmcnt(1)
v_mfma_f32_16x16x32_bf16 v[12:15], a[168:171], v[160:163], v[12:15]
v_cvt_pk_bf16_f32 v212, v128, v129
v_cvt_pk_bf16_f32 v213, v130, v131
s_waitcnt lgkmcnt(0)
v_mfma_f32_16x16x32_bf16 v[12:15], a[172:175], v[164:167], v[12:15]
v_cvt_pk_bf16_f32 v214, v132, v133
v_cvt_pk_bf16_f32 v215, v134, v135
v_mfma_f32_16x16x32_bf16 v[16:19], a[144:147], v[168:171], 0
buffer_load_dwordx4 v228, s[8:11], s32 offen offset:0  lds
v_mfma_f32_16x16x32_bf16 v[16:19], a[148:151], v[172:175], v[16:19]
buffer_load_dwordx4 v229, s[8:11], s32 offen offset:1024  lds
v_mfma_f32_16x16x32_bf16 v[16:19], a[152:155], v[176:179], v[16:19]
buffer_load_dwordx4 v230, s[8:11], s32 offen offset:2048  lds
v_mfma_f32_16x16x32_bf16 v[16:19], a[156:159], v[180:183], v[16:19]
buffer_load_dwordx4 v231, s[8:11], s32 offen offset:3072  lds
STUB_3:
STUB_A3:
s_cbranch_execz STUB_6
v_max3_f32 v248, v8, v9, v10
v_mfma_f32_16x16x32_bf16 v[20:23], a[160:163], v[168:171], 0
s_add_u32 s39, s7, 16384
s_add_u32 m0, s30, 147456
v_mfma_f32_16x16x32_bf16 v[20:23], a[164:167], v[172:175], v[20:23]
buffer_load_dwordx4 v232, s[12:15], s39 offen offset:0  lds
v_mfma_f32_16x16x32_bf16 v[20:23], a[168:171], v[176:179], v[20:23]
buffer_load_dwordx4 v233, s[12:15], s39 offen offset:1024  lds
v_mfma_f32_16x16x32_bf16 v[20:23], a[172:175], v[180:183], v[20:23]
v_max3_f32 v248, v248, v11, v12
v_max3_f32 v248, v248, v13, v14
v_mfma_f32_16x16x32_bf16 v[24:27], a[144:147], v[184:187], 0
v_max_f32 v248, v248, v15
v_mov_b32 v249, v248
v_mfma_f32_16x16x32_bf16 v[24:27], a[148:151], v[188:191], v[24:27]
s_nop 0
v_permlane16_swap_b32 v248, v249
v_mfma_f32_16x16x32_bf16 v[24:27], a[152:155], v[192:195], v[24:27]
v_max_f32 v248, v248, v249
v_mov_b32 v249, v248
v_mfma_f32_16x16x32_bf16 v[24:27], a[156:159], v[196:199], v[24:27]
s_nop 0
v_permlane32_swap_b32 v248, v249
v_mfma_f32_16x16x32_bf16 v[28:31], a[160:163], v[184:187], 0
v_max_f32 v248, v248, v249
v_sub_f32 v136, 0, v248
v_sub_f32 v137, 0, v248
v_mfma_f32_16x16x32_bf16 v[28:31], a[164:167], v[188:191], v[28:31]
v_sub_f32 v138, 0, v248
v_sub_f32 v139, 0, v248
v_sub_f32 v8, v8, v248
v_mfma_f32_16x16x32_bf16 v[28:31], a[168:171], v[192:195], v[28:31]
v_sub_f32 v9, v9, v248
v_sub_f32 v10, v10, v248
v_sub_f32 v11, v11, v248
v_mfma_f32_16x16x32_bf16 v[28:31], a[172:175], v[196:199], v[28:31]
v_sub_f32 v12, v12, v248
v_sub_f32 v13, v13, v248
v_sub_f32 v14, v14, v248
v_mfma_f32_16x16x32_bf16 v[32:35], a[144:147], v[200:203], 0
v_sub_f32 v15, v15, v248
v_max3_f32 v250, v16, v17, v18
v_max3_f32 v250, v250, v19, v20
v_mfma_f32_16x16x32_bf16 v[32:35], a[148:151], v[204:207], v[32:35]
v_max3_f32 v250, v250, v21, v22
v_max_f32 v250, v250, v23
v_mov_b32 v251, v250
v_mfma_f32_16x16x32_bf16 v[32:35], a[152:155], v[208:211], v[32:35]
s_nop 0
v_permlane16_swap_b32 v250, v251
v_max_f32 v250, v250, v251
v_mfma_f32_16x16x32_bf16 v[32:35], a[156:159], v[212:215], v[32:35]
v_mov_b32 v251, v250
s_nop 1
v_permlane32_swap_b32 v250, v251
v_mfma_f32_16x16x32_bf16 v[36:39], a[160:163], v[200:203], 0
v_max_f32 v250, v250, v251
v_sub_f32 v140, 0, v250
v_sub_f32 v141, 0, v250
v_mfma_f32_16x16x32_bf16 v[36:39], a[164:167], v[204:207], v[36:39]
v_sub_f32 v142, 0, v250
v_sub_f32 v143, 0, v250
v_sub_f32 v16, v16, v250
v_mfma_f32_16x16x32_bf16 v[36:39], a[168:171], v[208:211], v[36:39]
v_sub_f32 v17, v17, v250
v_sub_f32 v18, v18, v250
v_sub_f32 v19, v19, v250
v_mfma_f32_16x16x32_bf16 v[36:39], a[172:175], v[212:215], v[36:39]
v_sub_f32 v20, v20, v250
v_sub_f32 v21, v21, v250
v_sub_f32 v22, v22, v250
ds_read_b128 a[144:147], v216 offset:24576
ds_read_b128 a[148:151], v217 offset:24576
ds_read_b128 a[152:155], v218 offset:24576
ds_read_b128 a[156:159], v219 offset:24576
ds_read_b128 a[160:163], v216 offset:28672
ds_read_b128 a[164:167], v217 offset:28672
ds_read_b128 a[168:171], v218 offset:28672
ds_read_b128 a[172:175], v219 offset:28672
buffer_load_dwordx4 v232, s[12:15], s39 offen offset:2048  lds
buffer_load_dwordx4 v233, s[12:15], s39 offen offset:3072  lds
s_add_u32 s32, s7, 32768
s_add_u32 s39, s7, 16384
v_sub_f32 v23, v23, v250
v_max3_f32 v248, v24, v25, v26
v_max3_f32 v248, v248, v27, v28
v_max3_f32 v248, v248, v29, v30
v_max_f32 v248, v248, v31
s_nop 3
v_max3_f32 v250, v32, v33, v34
v_max3_f32 v250, v250, v35, v36
v_max3_f32 v250, v250, v37, v38
v_max_f32 v250, v250, v39
v_mov_b32 v249, v248
v_mov_b32 v251, v250
s_nop 0
v_permlane16_swap_b32 v248, v249
v_permlane16_swap_b32 v250, v251
v_max_f32 v248, v248, v249
v_max_f32 v250, v250, v251
v_mov_b32 v249, v248
v_mov_b32 v251, v250
s_nop 0
v_permlane32_swap_b32 v248, v249
v_permlane32_swap_b32 v250, v251
v_max_f32 v248, v248, v249
v_max_f32 v250, v250, v251
v_sub_f32 v144, 0, v248
v_sub_f32 v148, 0, v250
v_sub_f32 v145, 0, v248
v_sub_f32 v149, 0, v250
v_sub_f32 v146, 0, v248
v_sub_f32 v150, 0, v250
v_sub_f32 v147, 0, v248
v_sub_f32 v151, 0, v250
v_sub_f32 v24, v24, v248
v_sub_f32 v32, v32, v250
v_sub_f32 v25, v25, v248
v_sub_f32 v33, v33, v250
v_sub_f32 v26, v26, v248
v_sub_f32 v34, v34, v250
v_sub_f32 v27, v27, v248
v_sub_f32 v35, v35, v250
v_sub_f32 v28, v28, v248
v_sub_f32 v36, v36, v250
v_sub_f32 v29, v29, v248
v_sub_f32 v37, v37, v250
v_sub_f32 v30, v30, v248
v_sub_f32 v38, v38, v250
v_sub_f32 v31, v31, v248
v_sub_f32 v39, v39, v250
K_BODY0:
s_waitcnt lgkmcnt(0)
v_mfma_f32_16x16x32_bf16 v[40:43], a[144:147], v[152:155], v[136:139]
v_exp_f32 v8, v8
v_exp_f32 v9, v9
v_mfma_f32_16x16x32_bf16 v[40:43], a[148:151], v[156:159], v[40:43]
v_cvt_pk_bf16_f32 v72, v8, v9
v_bfe_u32 v246, v1, 2, 2
v_exp_f32 v10, v10
v_mfma_f32_16x16x32_bf16 v[40:43], a[152:155], v[160:163], v[40:43]
v_lshl_add_u32 v241, v4, 3, v246
v_lshl_add_u32 v246, v4, 2, v246
v_exp_f32 v11, v11
v_mfma_f32_16x16x32_bf16 v[40:43], a[156:159], v[164:167], v[40:43]
v_cvt_pk_bf16_f32 v73, v10, v11
v_and_b32 v247, 3, v1
v_exp_f32 v12, v12
v_mfma_f32_16x16x32_bf16 v[48:51], a[156:159], v[180:183], v[140:143]
v_lshlrev_b32 v247, 3, v247
v_lshl_add_u32 v241, v241, 6, v247
v_exp_f32 v13, v13
v_mfma_f32_16x16x32_bf16 v[48:51], a[152:155], v[176:179], v[48:51]
s_and_b32 s28, s37, 1
v_cvt_pk_bf16_f32 v74, v12, v13
v_exp_f32 v14, v14
v_mfma_f32_16x16x32_bf16 v[48:51], a[148:151], v[172:175], v[48:51]
s_lshl_b32 s28, s28, 5
s_lshr_b32 s29, s37, 1
v_exp_f32 v15, v15
v_mfma_f32_16x16x32_bf16 v[48:51], a[144:147], v[168:171], v[48:51]
v_exp_f32 v16, v16
v_exp_f32 v17, v17
v_mfma_f32_16x16x32_bf16 v[56:59], a[144:147], v[184:187], v[144:147]
v_cvt_pk_bf16_f32 v75, v14, v15
v_cvt_pk_bf16_f32 v76, v16, v17
v_exp_f32 v18, v18
v_mfma_f32_16x16x32_bf16 v[56:59], a[148:151], v[188:191], v[56:59]
s_lshl_b32 s29, s29, 15
s_add_u32 s28, s28, s29
v_exp_f32 v19, v19
v_mfma_f32_16x16x32_bf16 v[56:59], a[152:155], v[192:195], v[56:59]
v_cvt_pk_bf16_f32 v77, v18, v19
v_add_u32 v241, s28, v241
v_exp_f32 v20, v20
v_mfma_f32_16x16x32_bf16 v[56:59], a[156:159], v[196:199], v[56:59]
v_mul_u32_u24 v242, 0x480, v246
v_add_u32 v242, v242, v247
v_exp_f32 v21, v21
v_mfma_f32_16x16x32_bf16 v[64:67], a[156:159], v[212:215], v[148:151]
s_waitcnt vmcnt(8) lgkmcnt(0)
s_barrier
v_exp_f32 v22, v22
v_mfma_f32_16x16x32_bf16 v[64:67], a[152:155], v[208:211], v[64:67]
ds_read_b64_tr_b16 a[176:177], v220 offset:32768
v_cvt_pk_bf16_f32 v78, v20, v21
v_exp_f32 v23, v23
v_mfma_f32_16x16x32_bf16 v[64:67], a[148:151], v[204:207], v[64:67]
v_exp_f32 v24, v24
v_exp_f32 v25, v25
v_mfma_f32_16x16x32_bf16 v[64:67], a[144:147], v[200:203], v[64:67]
v_cvt_pk_bf16_f32 v79, v22, v23
v_cvt_pk_bf16_f32 v80, v24, v25
v_exp_f32 v26, v26
v_mfma_f32_16x16x32_bf16 v[44:47], a[160:163], v[152:155], v[136:139]
ds_read_b64_tr_b16 a[178:179], v220 offset:36864
ds_read_b64_tr_b16 a[180:181], v221 offset:32768
v_exp_f32 v27, v27
v_mfma_f32_16x16x32_bf16 v[44:47], a[164:167], v[156:159], v[44:47]
ds_read_b64_tr_b16 a[182:183], v221 offset:36864
v_cvt_pk_bf16_f32 v81, v26, v27
v_exp_f32 v28, v28
v_mfma_f32_16x16x32_bf16 v[44:47], a[168:171], v[160:163], v[44:47]
ds_read_b64_tr_b16 a[184:185], v222 offset:32768
ds_read_b64_tr_b16 a[186:187], v222 offset:36864
v_exp_f32 v29, v29
v_mfma_f32_16x16x32_bf16 v[44:47], a[172:175], v[164:167], v[44:47]
ds_read_b64_tr_b16 a[188:189], v223 offset:32768
v_cvt_pk_bf16_f32 v82, v28, v29
v_exp_f32 v30, v30
v_mfma_f32_16x16x32_bf16 v[52:55], a[172:175], v[180:183], v[140:143]
ds_read_b64_tr_b16 a[190:191], v223 offset:36864
ds_read_b128 a[156:159], v219 offset:49152
v_exp_f32 v31, v31
v_mfma_f32_16x16x32_bf16 v[52:55], a[168:171], v[176:179], v[52:55]
v_exp_f32 v32, v32
v_exp_f32 v33, v33
v_mfma_f32_16x16x32_bf16 v[52:55], a[164:167], v[172:175], v[52:55]
v_cvt_pk_bf16_f32 v83, v30, v31
v_cvt_pk_bf16_f32 v84, v32, v33
v_exp_f32 v34, v34
v_mfma_f32_16x16x32_bf16 v[52:55], a[160:163], v[168:171], v[52:55]
ds_read_b64_tr_b16 a[192:193], v224 offset:32768
ds_read_b64_tr_b16 a[194:195], v224 offset:36864
v_exp_f32 v35, v35
v_mfma_f32_16x16x32_bf16 v[60:63], a[160:163], v[184:187], v[144:147]
ds_read_b128 a[152:155], v218 offset:49152
v_cvt_pk_bf16_f32 v85, v34, v35
v_exp_f32 v36, v36
v_mfma_f32_16x16x32_bf16 v[60:63], a[164:167], v[188:191], v[60:63]
ds_read_b128 a[148:151], v217 offset:49152
ds_read_b128 a[144:147], v216 offset:49152
v_exp_f32 v37, v37
v_mfma_f32_16x16x32_bf16 v[60:63], a[168:171], v[192:195], v[60:63]
ds_read_b64_tr_b16 a[196:197], v225 offset:32768
v_cvt_pk_bf16_f32 v86, v36, v37
v_exp_f32 v38, v38
v_mfma_f32_16x16x32_bf16 v[60:63], a[172:175], v[196:199], v[60:63]
ds_read_b64_tr_b16 a[198:199], v225 offset:36864
ds_read_b64_tr_b16 a[200:201], v226 offset:32768
v_exp_f32 v39, v39
v_mfma_f32_16x16x32_bf16 v[68:71], a[172:175], v[212:215], v[148:151]
ds_read_b64_tr_b16 a[202:203], v226 offset:36864
ds_read_b64_tr_b16 a[204:205], v227 offset:32768
ds_read_b64_tr_b16 a[206:207], v227 offset:36864
v_cvt_pk_bf16_f32 v87, v38, v39
v_mfma_f32_16x16x32_bf16 v[68:71], a[168:171], v[208:211], v[68:71]
ds_read_b128 a[172:175], v219 offset:53248
ds_read_b128 a[168:171], v218 offset:53248
s_add_u32 s32, s32, 16384
s_bitset0_b32 s32, 19
v_mfma_f32_16x16x32_bf16 v[68:71], a[164:167], v[204:207], v[68:71]
ds_read_b128 a[164:167], v217 offset:53248
s_add_u32 m0, s30, 81920
s_nop 0
buffer_load_dwordx4 v228, s[8:11], s32 offen offset:0  lds
v_mfma_f32_16x16x32_bf16 v[68:71], a[160:163], v[200:203], v[68:71]
ds_read_b128 a[160:163], v216 offset:53248
buffer_load_dwordx4 v229, s[8:11], s32 offen offset:1024  lds
s_mul_i32 s28, s37, 288
buffer_load_dwordx4 v230, s[8:11], s32 offen offset:2048  lds
buffer_load_dwordx4 v231, s[8:11], s32 offen offset:3072  lds
buffer_store_byte v255, v254, s[24:27], 0 offen sc0 sc1
s_waitcnt lgkmcnt(8)
v_mfma_f32_16x16x32_bf16 v[8:11], a[144:147], v[152:155], v[136:139]
v_exp_f32 v40, v40
v_mfma_f32_16x16x32_bf16 v[8:11], a[148:151], v[156:159], v[8:11]
v_exp_f32 v41, v41
v_mfma_f32_16x16x32_bf16 v[8:11], a[152:155], v[160:163], v[8:11]
s_add_u32 s28, s28, 8192
v_cvt_pk_bf16_f32 v88, v40, v41
v_mfma_f32_16x16x32_bf16 v[8:11], a[156:159], v[164:167], v[8:11]
v_exp_f32 v42, v42
v_mfma_f32_16x16x32_bf16 v[16:19], a[156:159], v[180:183], v[140:143]
s_add_u32 s39, s39, 16384
v_add_u32 v242, s28, v242
v_mfma_f32_16x16x32_bf16 v[16:19], a[152:155], v[176:179], v[16:19]
v_exp_f32 v43, v43
v_mfma_f32_16x16x32_bf16 v[16:19], a[148:151], v[172:175], v[16:19]
v_cvt_pk_bf16_f32 v89, v42, v43
v_mfma_f32_16x16x32_bf16 v[16:19], a[144:147], v[168:171], v[16:19]
v_exp_f32 v44, v44
v_mfma_f32_16x16x32_bf16 v[24:27], a[144:147], v[184:187], v[144:147]
v_mfma_f32_16x16x32_bf16 v[24:27], a[148:151], v[188:191], v[24:27]
v_exp_f32 v45, v45
v_mfma_f32_16x16x32_bf16 v[24:27], a[152:155], v[192:195], v[24:27]
v_cvt_pk_bf16_f32 v90, v44, v45
v_mfma_f32_16x16x32_bf16 v[24:27], a[156:159], v[196:199], v[24:27]
v_exp_f32 v46, v46
v_mfma_f32_16x16x32_bf16 v[32:35], a[156:159], v[212:215], v[148:151]
ds_read_b128 a[156:159], v219 offset:57344
s_bitset0_b32 s39, 19
v_mfma_f32_16x16x32_bf16 v[32:35], a[152:155], v[208:211], v[32:35]
v_exp_f32 v47, v47
v_mfma_f32_16x16x32_bf16 v[32:35], a[148:151], v[204:207], v[32:35]
ds_read_b128 a[152:155], v218 offset:57344
v_cvt_pk_bf16_f32 v91, v46, v47
v_mfma_f32_16x16x32_bf16 v[32:35], a[144:147], v[200:203], v[32:35]
v_exp_f32 v48, v48
v_mfma_f32_16x16x32_bf16 a[0:3], a[176:179], v[72:75], 0
ds_read_b128 a[148:151], v217 offset:57344
ds_read_b128 a[144:147], v216 offset:57344
v_mfma_f32_16x16x32_bf16 a[4:7], a[176:179], v[76:79], 0
v_exp_f32 v49, v49
v_mfma_f32_16x16x32_bf16 a[8:11], a[176:179], v[80:83], 0
v_cvt_pk_bf16_f32 v92, v48, v49
v_mfma_f32_16x16x32_bf16 a[12:15], a[176:179], v[84:87], 0
v_exp_f32 v50, v50
v_mfma_f32_16x16x32_bf16 a[28:31], a[180:183], v[84:87], 0
ds_read_b64_tr_b16 a[176:177], v220 offset:40960
ds_read_b64_tr_b16 a[178:179], v220 offset:45056
v_mfma_f32_16x16x32_bf16 a[24:27], a[180:183], v[80:83], 0
v_exp_f32 v51, v51
v_mfma_f32_16x16x32_bf16 a[20:23], a[180:183], v[76:79], 0
s_add_u32 m0, s30, 98304
v_cvt_pk_bf16_f32 v93, v50, v51
v_mfma_f32_16x16x32_bf16 a[16:19], a[180:183], v[72:75], 0
v_exp_f32 v52, v52
v_mfma_f32_16x16x32_bf16 a[32:35], a[184:187], v[72:75], 0
ds_read_b64_tr_b16 a[180:181], v221 offset:40960
ds_read_b64_tr_b16 a[182:183], v221 offset:45056
v_mfma_f32_16x16x32_bf16 a[36:39], a[184:187], v[76:79], 0
v_exp_f32 v53, v53
v_mfma_f32_16x16x32_bf16 a[40:43], a[184:187], v[80:83], 0
v_cvt_pk_bf16_f32 v94, v52, v53
v_mfma_f32_16x16x32_bf16 a[44:47], a[184:187], v[84:87], 0
v_exp_f32 v54, v54
v_mfma_f32_16x16x32_bf16 a[60:63], a[188:191], v[84:87], 0
ds_read_b64_tr_b16 a[184:185], v222 offset:40960
ds_read_b64_tr_b16 a[186:187], v222 offset:45056
v_mfma_f32_16x16x32_bf16 a[56:59], a[188:191], v[80:83], 0
v_exp_f32 v55, v55
v_mfma_f32_16x16x32_bf16 a[52:55], a[188:191], v[76:79], 0
v_cvt_pk_bf16_f32 v95, v54, v55
v_mfma_f32_16x16x32_bf16 a[48:51], a[188:191], v[72:75], 0
v_exp_f32 v56, v56
v_smfmac_f32_16x16x64_bf16 a[128:131], a[208:211], v[72:79], v245
ds_read_b64_tr_b16 a[188:189], v223 offset:40960
s_waitcnt lgkmcnt(8)
v_mfma_f32_16x16x32_bf16 v[12:15], a[160:163], v[152:155], v[136:139]
v_exp_f32 v57, v57
v_mfma_f32_16x16x32_bf16 v[12:15], a[164:167], v[156:159], v[12:15]
v_exp_f32 v58, v58
v_mfma_f32_16x16x32_bf16 v[12:15], a[168:171], v[160:163], v[12:15]
ds_read_b64_tr_b16 a[190:191], v223 offset:45056
v_cvt_pk_bf16_f32 v96, v56, v57
v_mfma_f32_16x16x32_bf16 v[12:15], a[172:175], v[164:167], v[12:15]
v_exp_f32 v59, v59
v_mfma_f32_16x16x32_bf16 v[20:23], a[172:175], v[180:183], v[140:143]
v_cvt_pk_bf16_f32 v97, v58, v59
v_mfma_f32_16x16x32_bf16 v[20:23], a[168:171], v[176:179], v[20:23]
v_exp_f32 v60, v60
v_mfma_f32_16x16x32_bf16 v[20:23], a[164:167], v[172:175], v[20:23]
buffer_load_dwordx4 v232, s[12:15], s39 offen offset:0  lds
v_mfma_f32_16x16x32_bf16 v[20:23], a[160:163], v[168:171], v[20:23]
v_exp_f32 v61, v61
v_mfma_f32_16x16x32_bf16 v[28:31], a[160:163], v[184:187], v[144:147]
v_cvt_pk_bf16_f32 v98, v60, v61
v_mfma_f32_16x16x32_bf16 v[28:31], a[164:167], v[188:191], v[28:31]
v_exp_f32 v62, v62
v_mfma_f32_16x16x32_bf16 v[28:31], a[168:171], v[192:195], v[28:31]
buffer_load_dwordx4 v233, s[12:15], s39 offen offset:1024  lds
v_mfma_f32_16x16x32_bf16 v[28:31], a[172:175], v[196:199], v[28:31]
v_exp_f32 v63, v63
v_mfma_f32_16x16x32_bf16 v[36:39], a[172:175], v[212:215], v[148:151]
ds_read_b128 a[172:175], v219 offset:61440
v_cvt_pk_bf16_f32 v99, v62, v63
v_mfma_f32_16x16x32_bf16 v[36:39], a[168:171], v[208:211], v[36:39]
v_exp_f32 v64, v64
v_mfma_f32_16x16x32_bf16 v[36:39], a[164:167], v[204:207], v[36:39]
ds_read_b128 a[168:171], v218 offset:61440
ds_read_b128 a[164:167], v217 offset:61440
v_mfma_f32_16x16x32_bf16 v[36:39], a[160:163], v[200:203], v[36:39]
v_exp_f32 v65, v65
v_mfma_f32_16x16x32_bf16 a[64:67], a[192:195], v[72:75], 0
ds_read_b128 a[160:163], v216 offset:61440
v_cvt_pk_bf16_f32 v100, v64, v65
v_mfma_f32_16x16x32_bf16 a[68:71], a[192:195], v[76:79], 0
v_exp_f32 v66, v66
v_mfma_f32_16x16x32_bf16 a[72:75], a[192:195], v[80:83], 0
buffer_load_dwordx4 v232, s[12:15], s39 offen offset:2048  lds
v_mfma_f32_16x16x32_bf16 a[76:79], a[192:195], v[84:87], 0
v_exp_f32 v67, v67
v_mfma_f32_16x16x32_bf16 a[92:95], a[196:199], v[84:87], 0
ds_read_b64_tr_b16 a[192:193], v224 offset:40960
v_cvt_pk_bf16_f32 v101, v66, v67
v_mfma_f32_16x16x32_bf16 a[88:91], a[196:199], v[80:83], 0
v_exp_f32 v68, v68
v_mfma_f32_16x16x32_bf16 a[84:87], a[196:199], v[76:79], 0
ds_read_b64_tr_b16 a[194:195], v224 offset:45056
v_mfma_f32_16x16x32_bf16 a[80:83], a[196:199], v[72:75], 0
v_exp_f32 v69, v69
v_mfma_f32_16x16x32_bf16 a[96:99], a[200:203], v[72:75], 0
ds_read_b64_tr_b16 a[196:197], v225 offset:40960
v_cvt_pk_bf16_f32 v102, v68, v69
v_mfma_f32_16x16x32_bf16 a[100:103], a[200:203], v[76:79], 0
v_exp_f32 v70, v70
v_mfma_f32_16x16x32_bf16 a[104:107], a[200:203], v[80:83], 0
ds_read_b64_tr_b16 a[198:199], v225 offset:45056
v_mfma_f32_16x16x32_bf16 a[108:111], a[200:203], v[84:87], 0
v_exp_f32 v71, v71
v_mfma_f32_16x16x32_bf16 a[124:127], a[204:207], v[84:87], 0
ds_read_b64_tr_b16 a[200:201], v226 offset:40960
v_cvt_pk_bf16_f32 v103, v70, v71
v_mfma_f32_16x16x32_bf16 a[120:123], a[204:207], v[80:83], 0
ds_read_b64_tr_b16 a[202:203], v226 offset:45056
v_mfma_f32_16x16x32_bf16 a[116:119], a[204:207], v[76:79], 0
buffer_load_dwordx4 v233, s[12:15], s39 offen offset:3072  lds
v_mfma_f32_16x16x32_bf16 a[112:115], a[204:207], v[72:75], 0
ds_read_b64_tr_b16 a[204:205], v227 offset:40960
ds_read_b64_tr_b16 a[206:207], v227 offset:45056
v_smfmac_f32_16x16x64_bf16 a[132:135], a[208:211], v[80:87], v245
s_waitcnt lgkmcnt(8)
v_mfma_f32_16x16x32_bf16 v[40:43], a[144:147], v[152:155], v[136:139]
v_exp_f32 v8, v8
v_mfma_f32_16x16x32_bf16 v[40:43], a[148:151], v[156:159], v[40:43]
v_exp_f32 v9, v9
v_mfma_f32_16x16x32_bf16 v[40:43], a[152:155], v[160:163], v[40:43]
v_cvt_pk_bf16_f32 v72, v8, v9
v_lshlrev_b32 v250, 3, v1
v_mfma_f32_16x16x32_bf16 v[40:43], a[156:159], v[164:167], v[40:43]
v_exp_f32 v10, v10
v_mfma_f32_16x16x32_bf16 v[48:51], a[156:159], v[180:183], v[140:143]
v_mfma_f32_16x16x32_bf16 v[48:51], a[152:155], v[176:179], v[48:51]
v_exp_f32 v11, v11
v_mfma_f32_16x16x32_bf16 v[48:51], a[148:151], v[172:175], v[48:51]
v_cvt_pk_bf16_f32 v73, v10, v11
v_mfma_f32_16x16x32_bf16 v[48:51], a[144:147], v[168:171], v[48:51]
v_exp_f32 v12, v12
v_mfma_f32_16x16x32_bf16 v[56:59], a[144:147], v[184:187], v[144:147]
v_mfma_f32_16x16x32_bf16 v[56:59], a[148:151], v[188:191], v[56:59]
v_exp_f32 v13, v13
v_mfma_f32_16x16x32_bf16 v[56:59], a[152:155], v[192:195], v[56:59]
v_cvt_pk_bf16_f32 v74, v12, v13
v_mfma_f32_16x16x32_bf16 v[56:59], a[156:159], v[196:199], v[56:59]
v_exp_f32 v14, v14
v_mfma_f32_16x16x32_bf16 v[64:67], a[156:159], v[212:215], v[148:151]
s_waitcnt vmcnt(9) lgkmcnt(0)
s_barrier
v_mfma_f32_16x16x32_bf16 v[64:67], a[152:155], v[208:211], v[64:67]
v_exp_f32 v15, v15
v_mfma_f32_16x16x32_bf16 v[64:67], a[148:151], v[204:207], v[64:67]
ds_read_b128 a[156:159], v219 offset:0
v_cvt_pk_bf16_f32 v75, v14, v15
v_mfma_f32_16x16x32_bf16 v[64:67], a[144:147], v[200:203], v[64:67]
v_exp_f32 v16, v16
v_mfma_f32_16x16x32_bf16 a[0:3], a[176:179], v[88:91], a[0:3]
ds_read_b128 a[152:155], v218 offset:0
ds_read_b128 a[148:151], v217 offset:0
v_mfma_f32_16x16x32_bf16 a[4:7], a[176:179], v[92:95], a[4:7]
v_exp_f32 v17, v17
v_mfma_f32_16x16x32_bf16 a[8:11], a[176:179], v[96:99], a[8:11]
ds_read_b128 a[144:147], v216 offset:0
v_cvt_pk_bf16_f32 v76, v16, v17
v_mfma_f32_16x16x32_bf16 a[12:15], a[176:179], v[100:103], a[12:15]
v_exp_f32 v18, v18
v_mfma_f32_16x16x32_bf16 a[28:31], a[180:183], v[100:103], a[28:31]
ds_read_b64_tr_b16 a[176:177], v220 offset:49152
ds_read_b64_tr_b16 a[178:179], v220 offset:53248
v_mfma_f32_16x16x32_bf16 a[24:27], a[180:183], v[96:99], a[24:27]
v_exp_f32 v19, v19
v_mfma_f32_16x16x32_bf16 a[20:23], a[180:183], v[92:95], a[20:23]
s_add_u32 s32, s32, 16384
v_cvt_pk_bf16_f32 v77, v18, v19
v_mfma_f32_16x16x32_bf16 a[16:19], a[180:183], v[88:91], a[16:19]
v_exp_f32 v20, v20
v_mfma_f32_16x16x32_bf16 a[32:35], a[184:187], v[88:91], a[32:35]
ds_read_b64_tr_b16 a[180:181], v221 offset:49152
ds_read_b64_tr_b16 a[182:183], v221 offset:53248
v_mfma_f32_16x16x32_bf16 a[36:39], a[184:187], v[92:95], a[36:39]
v_exp_f32 v21, v21
v_mfma_f32_16x16x32_bf16 a[40:43], a[184:187], v[96:99], a[40:43]
s_bitset0_b32 s32, 19
v_cvt_pk_bf16_f32 v78, v20, v21
v_mfma_f32_16x16x32_bf16 a[44:47], a[184:187], v[100:103], a[44:47]
v_exp_f32 v22, v22
v_mfma_f32_16x16x32_bf16 a[60:63], a[188:191], v[100:103], a[60:63]
ds_read_b64_tr_b16 a[184:185], v222 offset:49152
ds_read_b64_tr_b16 a[186:187], v222 offset:53248
v_mfma_f32_16x16x32_bf16 a[56:59], a[188:191], v[96:99], a[56:59]
v_exp_f32 v23, v23
v_mfma_f32_16x16x32_bf16 a[52:55], a[188:191], v[92:95], a[52:55]
s_add_u32 m0, s30, 114688
v_cvt_pk_bf16_f32 v79, v22, v23
v_mfma_f32_16x16x32_bf16 a[48:51], a[188:191], v[88:91], a[48:51]
v_exp_f32 v24, v24
v_smfmac_f32_16x16x64_bf16 a[128:131], a[208:211], v[88:95], v245
ds_read_b64_tr_b16 a[188:189], v223 offset:49152
v_mfma_f32_16x16x32_bf16 v[44:47], a[160:163], v[152:155], v[136:139]
v_exp_f32 v25, v25
v_mfma_f32_16x16x32_bf16 v[44:47], a[164:167], v[156:159], v[44:47]
v_exp_f32 v26, v26
v_mfma_f32_16x16x32_bf16 v[44:47], a[168:171], v[160:163], v[44:47]
ds_read_b64_tr_b16 a[190:191], v223 offset:53248
v_cvt_pk_bf16_f32 v80, v24, v25
v_mfma_f32_16x16x32_bf16 v[44:47], a[172:175], v[164:167], v[44:47]
v_exp_f32 v27, v27
v_mfma_f32_16x16x32_bf16 v[52:55], a[172:175], v[180:183], v[140:143]
v_cvt_pk_bf16_f32 v81, v26, v27
v_mfma_f32_16x16x32_bf16 v[52:55], a[168:171], v[176:179], v[52:55]
v_exp_f32 v28, v28
v_mfma_f32_16x16x32_bf16 v[52:55], a[164:167], v[172:175], v[52:55]
buffer_load_dwordx4 v228, s[8:11], s32 offen offset:0  lds
v_mfma_f32_16x16x32_bf16 v[52:55], a[160:163], v[168:171], v[52:55]
v_exp_f32 v29, v29
v_mfma_f32_16x16x32_bf16 v[60:63], a[160:163], v[184:187], v[144:147]
v_cvt_pk_bf16_f32 v82, v28, v29
v_mfma_f32_16x16x32_bf16 v[60:63], a[164:167], v[188:191], v[60:63]
v_exp_f32 v30, v30
v_mfma_f32_16x16x32_bf16 v[60:63], a[168:171], v[192:195], v[60:63]
buffer_load_dwordx4 v229, s[8:11], s32 offen offset:1024  lds
v_mfma_f32_16x16x32_bf16 v[60:63], a[172:175], v[196:199], v[60:63]
v_exp_f32 v31, v31
v_mfma_f32_16x16x32_bf16 v[68:71], a[172:175], v[212:215], v[148:151]
ds_read_b128 a[172:175], v219 offset:4096
v_cvt_pk_bf16_f32 v83, v30, v31
v_mfma_f32_16x16x32_bf16 v[68:71], a[168:171], v[208:211], v[68:71]
v_exp_f32 v32, v32
v_mfma_f32_16x16x32_bf16 v[68:71], a[164:167], v[204:207], v[68:71]
ds_read_b128 a[168:171], v218 offset:4096
ds_read_b128 a[164:167], v217 offset:4096
v_mfma_f32_16x16x32_bf16 v[68:71], a[160:163], v[200:203], v[68:71]
v_exp_f32 v33, v33
v_mfma_f32_16x16x32_bf16 a[64:67], a[192:195], v[88:91], a[64:67]
ds_read_b128 a[160:163], v216 offset:4096
v_cvt_pk_bf16_f32 v84, v32, v33
v_mfma_f32_16x16x32_bf16 a[68:71], a[192:195], v[92:95], a[68:71]
v_exp_f32 v34, v34
v_mfma_f32_16x16x32_bf16 a[72:75], a[192:195], v[96:99], a[72:75]
buffer_load_dwordx4 v230, s[8:11], s32 offen offset:2048  lds
v_mfma_f32_16x16x32_bf16 a[76:79], a[192:195], v[100:103], a[76:79]
v_exp_f32 v35, v35
v_mfma_f32_16x16x32_bf16 a[92:95], a[196:199], v[100:103], a[92:95]
ds_read_b64_tr_b16 a[192:193], v224 offset:49152
v_cvt_pk_bf16_f32 v85, v34, v35
v_mfma_f32_16x16x32_bf16 a[88:91], a[196:199], v[96:99], a[88:91]
v_exp_f32 v36, v36
v_mfma_f32_16x16x32_bf16 a[84:87], a[196:199], v[92:95], a[84:87]
ds_read_b64_tr_b16 a[194:195], v224 offset:53248
v_mfma_f32_16x16x32_bf16 a[80:83], a[196:199], v[88:91], a[80:83]
v_exp_f32 v37, v37
v_mfma_f32_16x16x32_bf16 a[96:99], a[200:203], v[88:91], a[96:99]
ds_read_b64_tr_b16 a[196:197], v225 offset:49152
v_cvt_pk_bf16_f32 v86, v36, v37
v_mfma_f32_16x16x32_bf16 a[100:103], a[200:203], v[92:95], a[100:103]
v_exp_f32 v38, v38
v_mfma_f32_16x16x32_bf16 a[104:107], a[200:203], v[96:99], a[104:107]
ds_read_b64_tr_b16 a[198:199], v225 offset:53248
v_mfma_f32_16x16x32_bf16 a[108:111], a[200:203], v[100:103], a[108:111]
v_exp_f32 v39, v39
v_mfma_f32_16x16x32_bf16 a[124:127], a[204:207], v[100:103], a[124:127]
ds_read_b64_tr_b16 a[200:201], v226 offset:49152
v_cvt_pk_bf16_f32 v87, v38, v39
v_mfma_f32_16x16x32_bf16 a[120:123], a[204:207], v[96:99], a[120:123]
ds_read_b64_tr_b16 a[202:203], v226 offset:53248
v_mfma_f32_16x16x32_bf16 a[116:119], a[204:207], v[92:95], a[116:119]
buffer_load_dwordx4 v231, s[8:11], s32 offen offset:3072  lds
v_mfma_f32_16x16x32_bf16 a[112:115], a[204:207], v[88:91], a[112:115]
ds_read_b64_tr_b16 a[204:205], v227 offset:49152
ds_read_b64_tr_b16 a[206:207], v227 offset:53248
v_smfmac_f32_16x16x64_bf16 a[132:135], a[208:211], v[96:103], v245
s_add_u32 m0, s86, 0
s_add_u32 s50, s84, 0
buffer_load_dwordx4 v240, s[64:67], s50 offen lds
s_add_u32 m0, s86, 4096
s_add_u32 s50, s84, 589824
buffer_load_dwordx4 v240, s[64:67], s50 offen lds
s_waitcnt lgkmcnt(8)
v_mfma_f32_16x16x32_bf16 v[8:11], a[144:147], v[152:155], v[136:139]
v_exp_f32 v40, v40
v_mfma_f32_16x16x32_bf16 v[8:11], a[148:151], v[156:159], v[8:11]
v_exp_f32 v41, v41
v_mfma_f32_16x16x32_bf16 v[8:11], a[152:155], v[160:163], v[8:11]
v_cvt_pk_bf16_f32 v88, v40, v41
v_mfma_f32_16x16x32_bf16 v[8:11], a[156:159], v[164:167], v[8:11]
v_exp_f32 v42, v42
v_mfma_f32_16x16x32_bf16 v[16:19], a[156:159], v[180:183], v[140:143]
s_add_u32 s39, s39, 16384
v_mfma_f32_16x16x32_bf16 v[16:19], a[152:155], v[176:179], v[16:19]
v_exp_f32 v43, v43
v_mfma_f32_16x16x32_bf16 v[16:19], a[148:151], v[172:175], v[16:19]
v_cvt_pk_bf16_f32 v89, v42, v43
v_mfma_f32_16x16x32_bf16 v[16:19], a[144:147], v[168:171], v[16:19]
v_exp_f32 v44, v44
v_mfma_f32_16x16x32_bf16 v[24:27], a[144:147], v[184:187], v[144:147]
s_mov_b32 s29, 0x242000
buffer_load_dwordx2 v[248:249], v250, s[20:23], s29 offen sc0 sc1
v_mfma_f32_16x16x32_bf16 v[24:27], a[148:151], v[188:191], v[24:27]
v_exp_f32 v45, v45
v_mfma_f32_16x16x32_bf16 v[24:27], a[152:155], v[192:195], v[24:27]
s_bitset0_b32 s39, 19
v_cvt_pk_bf16_f32 v90, v44, v45
v_mfma_f32_16x16x32_bf16 v[24:27], a[156:159], v[196:199], v[24:27]
v_exp_f32 v46, v46
v_mfma_f32_16x16x32_bf16 v[32:35], a[156:159], v[212:215], v[148:151]
ds_read_b128 a[156:159], v219 offset:8192
v_mfma_f32_16x16x32_bf16 v[32:35], a[152:155], v[208:211], v[32:35]
v_exp_f32 v47, v47
v_mfma_f32_16x16x32_bf16 v[32:35], a[148:151], v[204:207], v[32:35]
ds_read_b128 a[152:155], v218 offset:8192
v_cvt_pk_bf16_f32 v91, v46, v47
v_mfma_f32_16x16x32_bf16 v[32:35], a[144:147], v[200:203], v[32:35]
v_exp_f32 v48, v48
v_mfma_f32_16x16x32_bf16 a[0:3], a[176:179], v[72:75], a[0:3]
ds_read_b128 a[148:151], v217 offset:8192
ds_read_b128 a[144:147], v216 offset:8192
v_mfma_f32_16x16x32_bf16 a[4:7], a[176:179], v[76:79], a[4:7]
v_exp_f32 v49, v49
v_mfma_f32_16x16x32_bf16 a[8:11], a[176:179], v[80:83], a[8:11]
s_add_u32 m0, s30, 131072
v_cvt_pk_bf16_f32 v92, v48, v49
v_mfma_f32_16x16x32_bf16 a[12:15], a[176:179], v[84:87], a[12:15]
v_exp_f32 v50, v50
v_mfma_f32_16x16x32_bf16 a[28:31], a[180:183], v[84:87], a[28:31]
ds_read_b64_tr_b16 a[176:177], v220 offset:57344
ds_read_b64_tr_b16 a[178:179], v220 offset:61440
v_mfma_f32_16x16x32_bf16 a[24:27], a[180:183], v[80:83], a[24:27]
v_exp_f32 v51, v51
v_mfma_f32_16x16x32_bf16 a[20:23], a[180:183], v[76:79], a[20:23]
v_cvt_pk_bf16_f32 v93, v50, v51
v_mfma_f32_16x16x32_bf16 a[16:19], a[180:183], v[72:75], a[16:19]
STUB_4:
s_cbranch_execz STUB_7
v_exp_f32 v52, v52
v_mfma_f32_16x16x32_bf16 a[32:35], a[184:187], v[72:75], a[32:35]
ds_read_b64_tr_b16 a[180:181], v221 offset:57344
ds_read_b64_tr_b16 a[182:183], v221 offset:61440
v_mfma_f32_16x16x32_bf16 a[36:39], a[184:187], v[76:79], a[36:39]
v_exp_f32 v53, v53
v_mfma_f32_16x16x32_bf16 a[40:43], a[184:187], v[80:83], a[40:43]
v_cvt_pk_bf16_f32 v94, v52, v53
v_mfma_f32_16x16x32_bf16 a[44:47], a[184:187], v[84:87], a[44:47]
v_exp_f32 v54, v54
v_mfma_f32_16x16x32_bf16 a[60:63], a[188:191], v[84:87], a[60:63]
ds_read_b64_tr_b16 a[184:185], v222 offset:57344
ds_read_b64_tr_b16 a[186:187], v222 offset:61440
v_mfma_f32_16x16x32_bf16 a[56:59], a[188:191], v[80:83], a[56:59]
v_exp_f32 v55, v55
v_mfma_f32_16x16x32_bf16 a[52:55], a[188:191], v[76:79], a[52:55]
v_cvt_pk_bf16_f32 v95, v54, v55
v_mfma_f32_16x16x32_bf16 a[48:51], a[188:191], v[72:75], a[48:51]
v_exp_f32 v56, v56
v_smfmac_f32_16x16x64_bf16 a[128:131], a[208:211], v[72:79], v245
ds_read_b64_tr_b16 a[188:189], v223 offset:57344
v_mfma_f32_16x16x32_bf16 v[12:15], a[160:163], v[152:155], v[136:139]
v_exp_f32 v57, v57
v_mfma_f32_16x16x32_bf16 v[12:15], a[164:167], v[156:159], v[12:15]
v_exp_f32 v58, v58
v_mfma_f32_16x16x32_bf16 v[12:15], a[168:171], v[160:163], v[12:15]
ds_read_b64_tr_b16 a[190:191], v223 offset:61440
v_cvt_pk_bf16_f32 v96, v56, v57
v_mfma_f32_16x16x32_bf16 v[12:15], a[172:175], v[164:167], v[12:15]
v_exp_f32 v59, v59
v_mfma_f32_16x16x32_bf16 v[20:23], a[172:175], v[180:183], v[140:143]
v_cvt_pk_bf16_f32 v97, v58, v59
v_mfma_f32_16x16x32_bf16 v[20:23], a[168:171], v[176:179], v[20:23]
v_exp_f32 v60, v60
v_mfma_f32_16x16x32_bf16 v[20:23], a[164:167], v[172:175], v[20:23]
buffer_load_dwordx4 v232, s[12:15], s39 offen offset:0  lds
v_mfma_f32_16x16x32_bf16 v[20:23], a[160:163], v[168:171], v[20:23]
v_exp_f32 v61, v61
v_mfma_f32_16x16x32_bf16 v[28:31], a[160:163], v[184:187], v[144:147]
v_cvt_pk_bf16_f32 v98, v60, v61
v_mfma_f32_16x16x32_bf16 v[28:31], a[164:167], v[188:191], v[28:31]
v_exp_f32 v62, v62
v_mfma_f32_16x16x32_bf16 v[28:31], a[168:171], v[192:195], v[28:31]
buffer_load_dwordx4 v233, s[12:15], s39 offen offset:1024  lds
v_mfma_f32_16x16x32_bf16 v[28:31], a[172:175], v[196:199], v[28:31]
v_exp_f32 v63, v63
v_mfma_f32_16x16x32_bf16 v[36:39], a[172:175], v[212:215], v[148:151]
ds_read_b128 a[172:175], v219 offset:12288
v_cvt_pk_bf16_f32 v99, v62, v63
v_mfma_f32_16x16x32_bf16 v[36:39], a[168:171], v[208:211], v[36:39]
v_exp_f32 v64, v64
v_mfma_f32_16x16x32_bf16 v[36:39], a[164:167], v[204:207], v[36:39]
ds_read_b128 a[168:171], v218 offset:12288
ds_read_b128 a[164:167], v217 offset:12288
v_mfma_f32_16x16x32_bf16 v[36:39], a[160:163], v[200:203], v[36:39]
v_exp_f32 v65, v65
s_waitcnt lgkmcnt(8)
v_mfma_f32_16x16x32_bf16 a[64:67], a[192:195], v[72:75], a[64:67]
ds_read_b128 a[160:163], v216 offset:12288
v_cvt_pk_bf16_f32 v100, v64, v65
v_mfma_f32_16x16x32_bf16 a[68:71], a[192:195], v[76:79], a[68:71]
v_exp_f32 v66, v66
v_mfma_f32_16x16x32_bf16 a[72:75], a[192:195], v[80:83], a[72:75]
buffer_load_dwordx4 v232, s[12:15], s39 offen offset:2048  lds
v_mfma_f32_16x16x32_bf16 a[76:79], a[192:195], v[84:87], a[76:79]
v_exp_f32 v67, v67
v_mfma_f32_16x16x32_bf16 a[92:95], a[196:199], v[84:87], a[92:95]
ds_read_b64_tr_b16 a[192:193], v224 offset:57344
v_cvt_pk_bf16_f32 v101, v66, v67
v_mfma_f32_16x16x32_bf16 a[88:91], a[196:199], v[80:83], a[88:91]
v_exp_f32 v68, v68
v_mfma_f32_16x16x32_bf16 a[84:87], a[196:199], v[76:79], a[84:87]
ds_read_b64_tr_b16 a[194:195], v224 offset:61440
v_mfma_f32_16x16x32_bf16 a[80:83], a[196:199], v[72:75], a[80:83]
v_exp_f32 v69, v69
v_mfma_f32_16x16x32_bf16 a[96:99], a[200:203], v[72:75], a[96:99]
ds_read_b64_tr_b16 a[196:197], v225 offset:57344
v_cvt_pk_bf16_f32 v102, v68, v69
v_mfma_f32_16x16x32_bf16 a[100:103], a[200:203], v[76:79], a[100:103]
v_exp_f32 v70, v70
v_mfma_f32_16x16x32_bf16 a[104:107], a[200:203], v[80:83], a[104:107]
ds_read_b64_tr_b16 a[198:199], v225 offset:61440
v_mfma_f32_16x16x32_bf16 a[108:111], a[200:203], v[84:87], a[108:111]
v_exp_f32 v71, v71
v_mfma_f32_16x16x32_bf16 a[124:127], a[204:207], v[84:87], a[124:127]
ds_read_b64_tr_b16 a[200:201], v226 offset:57344
v_cvt_pk_bf16_f32 v103, v70, v71
v_mfma_f32_16x16x32_bf16 a[120:123], a[204:207], v[80:83], a[120:123]
ds_read_b64_tr_b16 a[202:203], v226 offset:61440
v_mfma_f32_16x16x32_bf16 a[116:119], a[204:207], v[76:79], a[116:119]
buffer_load_dwordx4 v233, s[12:15], s39 offen offset:3072  lds
v_mfma_f32_16x16x32_bf16 a[112:115], a[204:207], v[72:75], a[112:115]
ds_read_b64_tr_b16 a[204:205], v227 offset:57344
ds_read_b64_tr_b16 a[206:207], v227 offset:61440
v_smfmac_f32_16x16x64_bf16 a[132:135], a[208:211], v[80:87], v245
s_add_u32 m0, s86, 8192
s_add_u32 s50, s84, 1179648
buffer_load_dwordx4 v240, s[64:67], s50 offen lds
s_add_u32 m0, s86, 12288
s_add_u32 s50, s84, 1769472
buffer_load_dwordx4 v240, s[64:67], s50 offen lds
v_mfma_f32_16x16x32_bf16 v[40:43], a[144:147], v[152:155], v[136:139]
v_exp_f32 v8, v8
v_mfma_f32_16x16x32_bf16 v[40:43], a[148:151], v[156:159], v[40:43]
v_exp_f32 v9, v9
v_mfma_f32_16x16x32_bf16 v[40:43], a[152:155], v[160:163], v[40:43]
v_cvt_pk_bf16_f32 v72, v8, v9
v_mfma_f32_16x16x32_bf16 v[40:43], a[156:159], v[164:167], v[40:43]
v_exp_f32 v10, v10
v_mfma_f32_16x16x32_bf16 v[48:51], a[156:159], v[180:183], v[140:143]
v_mfma_f32_16x16x32_bf16 v[48:51], a[152:155], v[176:179], v[48:51]
v_exp_f32 v11, v11
v_mfma_f32_16x16x32_bf16 v[48:51], a[148:151], v[172:175], v[48:51]
v_cvt_pk_bf16_f32 v73, v10, v11
v_mfma_f32_16x16x32_bf16 v[48:51], a[144:147], v[168:171], v[48:51]
v_exp_f32 v12, v12
v_mfma_f32_16x16x32_bf16 v[56:59], a[144:147], v[184:187], v[144:147]
v_mfma_f32_16x16x32_bf16 v[56:59], a[148:151], v[188:191], v[56:59]
v_exp_f32 v13, v13
v_mfma_f32_16x16x32_bf16 v[56:59], a[152:155], v[192:195], v[56:59]
v_cvt_pk_bf16_f32 v74, v12, v13
v_mfma_f32_16x16x32_bf16 v[56:59], a[156:159], v[196:199], v[56:59]
v_exp_f32 v14, v14
v_mfma_f32_16x16x32_bf16 v[64:67], a[156:159], v[212:215], v[148:151]
s_waitcnt vmcnt(13) lgkmcnt(0)
s_barrier
v_mfma_f32_16x16x32_bf16 v[64:67], a[152:155], v[208:211], v[64:67]
v_exp_f32 v15, v15
v_mfma_f32_16x16x32_bf16 v[64:67], a[148:151], v[204:207], v[64:67]
ds_read_b128 a[156:159], v219 offset:16384
v_cvt_pk_bf16_f32 v75, v14, v15
v_mfma_f32_16x16x32_bf16 v[64:67], a[144:147], v[200:203], v[64:67]
v_exp_f32 v16, v16
v_mfma_f32_16x16x32_bf16 a[0:3], a[176:179], v[88:91], a[0:3]
ds_read_b128 a[152:155], v218 offset:16384
ds_read_b128 a[148:151], v217 offset:16384
v_mfma_f32_16x16x32_bf16 a[4:7], a[176:179], v[92:95], a[4:7]
v_exp_f32 v17, v17
v_mfma_f32_16x16x32_bf16 a[8:11], a[176:179], v[96:99], a[8:11]
ds_read_b128 a[144:147], v216 offset:16384
v_cvt_pk_bf16_f32 v76, v16, v17
v_mfma_f32_16x16x32_bf16 a[12:15], a[176:179], v[100:103], a[12:15]
v_exp_f32 v18, v18
v_mfma_f32_16x16x32_bf16 a[28:31], a[180:183], v[100:103], a[28:31]
ds_read_b64_tr_b16 a[176:177], v220 offset:0
ds_read_b64_tr_b16 a[178:179], v220 offset:4096
v_mfma_f32_16x16x32_bf16 a[24:27], a[180:183], v[96:99], a[24:27]
v_exp_f32 v19, v19
v_mfma_f32_16x16x32_bf16 a[20:23], a[180:183], v[92:95], a[20:23]
s_add_u32 s32, s32, 16384
v_cvt_pk_bf16_f32 v77, v18, v19
v_mfma_f32_16x16x32_bf16 a[16:19], a[180:183], v[88:91], a[16:19]
v_exp_f32 v20, v20
v_mfma_f32_16x16x32_bf16 a[32:35], a[184:187], v[88:91], a[32:35]
ds_read_b64_tr_b16 a[180:181], v221 offset:0
ds_read_b64_tr_b16 a[182:183], v221 offset:4096
v_mfma_f32_16x16x32_bf16 a[36:39], a[184:187], v[92:95], a[36:39]
v_exp_f32 v21, v21
v_mfma_f32_16x16x32_bf16 a[40:43], a[184:187], v[96:99], a[40:43]
s_bitset0_b32 s32, 19
v_cvt_pk_bf16_f32 v78, v20, v21
v_mfma_f32_16x16x32_bf16 a[44:47], a[184:187], v[100:103], a[44:47]
v_exp_f32 v22, v22
v_mfma_f32_16x16x32_bf16 a[60:63], a[188:191], v[100:103], a[60:63]
ds_read_b64_tr_b16 a[184:185], v222 offset:0
ds_read_b64_tr_b16 a[186:187], v222 offset:4096
v_mfma_f32_16x16x32_bf16 a[56:59], a[188:191], v[96:99], a[56:59]
v_exp_f32 v23, v23
v_mfma_f32_16x16x32_bf16 a[52:55], a[188:191], v[92:95], a[52:55]
s_add_u32 m0, s30, 65536
v_cvt_pk_bf16_f32 v79, v22, v23
v_mfma_f32_16x16x32_bf16 a[48:51], a[188:191], v[88:91], a[48:51]
v_exp_f32 v24, v24
v_smfmac_f32_16x16x64_bf16 a[128:131], a[208:211], v[88:95], v245
ds_read_b64_tr_b16 a[188:189], v223 offset:0
v_mfma_f32_16x16x32_bf16 v[44:47], a[160:163], v[152:155], v[136:139]
v_exp_f32 v25, v25
v_mfma_f32_16x16x32_bf16 v[44:47], a[164:167], v[156:159], v[44:47]
v_exp_f32 v26, v26
v_mfma_f32_16x16x32_bf16 v[44:47], a[168:171], v[160:163], v[44:47]
ds_read_b64_tr_b16 a[190:191], v223 offset:4096
v_cvt_pk_bf16_f32 v80, v24, v25
v_mfma_f32_16x16x32_bf16 v[44:47], a[172:175], v[164:167], v[44:47]
v_exp_f32 v27, v27
v_mfma_f32_16x16x32_bf16 v[52:55], a[172:175], v[180:183], v[140:143]
v_cvt_pk_bf16_f32 v81, v26, v27
v_mfma_f32_16x16x32_bf16 v[52:55], a[168:171], v[176:179], v[52:55]
v_exp_f32 v28, v28
v_mfma_f32_16x16x32_bf16 v[52:55], a[164:167], v[172:175], v[52:55]
buffer_load_dwordx4 v228, s[8:11], s32 offen offset:0  lds
v_mfma_f32_16x16x32_bf16 v[52:55], a[160:163], v[168:171], v[52:55]
v_exp_f32 v29, v29
v_mfma_f32_16x16x32_bf16 v[60:63], a[160:163], v[184:187], v[144:147]
v_cvt_pk_bf16_f32 v82, v28, v29
v_mfma_f32_16x16x32_bf16 v[60:63], a[164:167], v[188:191], v[60:63]
v_exp_f32 v30, v30
v_mfma_f32_16x16x32_bf16 v[60:63], a[168:171], v[192:195], v[60:63]
buffer_load_dwordx4 v229, s[8:11], s32 offen offset:1024  lds
v_mfma_f32_16x16x32_bf16 v[60:63], a[172:175], v[196:199], v[60:63]
v_exp_f32 v31, v31
v_mfma_f32_16x16x32_bf16 v[68:71], a[172:175], v[212:215], v[148:151]
ds_read_b128 a[172:175], v219 offset:20480
v_cvt_pk_bf16_f32 v83, v30, v31
v_mfma_f32_16x16x32_bf16 v[68:71], a[168:171], v[208:211], v[68:71]
v_exp_f32 v32, v32
v_mfma_f32_16x16x32_bf16 v[68:71], a[164:167], v[204:207], v[68:71]
ds_read_b128 a[168:171], v218 offset:20480
ds_read_b128 a[164:167], v217 offset:20480
v_mfma_f32_16x16x32_bf16 v[68:71], a[160:163], v[200:203], v[68:71]
v_exp_f32 v33, v33
v_mfma_f32_16x16x32_bf16 a[64:67], a[192:195], v[88:91], a[64:67]
ds_read_b128 a[160:163], v216 offset:20480
v_cvt_pk_bf16_f32 v84, v32, v33
v_mfma_f32_16x16x32_bf16 a[68:71], a[192:195], v[92:95], a[68:71]
v_exp_f32 v34, v34
v_mfma_f32_16x16x32_bf16 a[72:75], a[192:195], v[96:99], a[72:75]
buffer_load_dwordx4 v230, s[8:11], s32 offen offset:2048  lds
v_mfma_f32_16x16x32_bf16 a[76:79], a[192:195], v[100:103], a[76:79]
v_exp_f32 v35, v35
v_mfma_f32_16x16x32_bf16 a[92:95], a[196:199], v[100:103], a[92:95]
ds_read_b64_tr_b16 a[192:193], v224 offset:0
v_cvt_pk_bf16_f32 v85, v34, v35
v_mfma_f32_16x16x32_bf16 a[88:91], a[196:199], v[96:99], a[88:91]
v_exp_f32 v36, v36
v_mfma_f32_16x16x32_bf16 a[84:87], a[196:199], v[92:95], a[84:87]
ds_read_b64_tr_b16 a[194:195], v224 offset:4096
v_mfma_f32_16x16x32_bf16 a[80:83], a[196:199], v[88:91], a[80:83]
v_exp_f32 v37, v37
v_mfma_f32_16x16x32_bf16 a[96:99], a[200:203], v[88:91], a[96:99]
ds_read_b64_tr_b16 a[196:197], v225 offset:0
v_cvt_pk_bf16_f32 v86, v36, v37
v_mfma_f32_16x16x32_bf16 a[100:103], a[200:203], v[92:95], a[100:103]
v_exp_f32 v38, v38
v_mfma_f32_16x16x32_bf16 a[104:107], a[200:203], v[96:99], a[104:107]
ds_read_b64_tr_b16 a[198:199], v225 offset:4096
v_mfma_f32_16x16x32_bf16 a[108:111], a[200:203], v[100:103], a[108:111]
v_exp_f32 v39, v39
v_mfma_f32_16x16x32_bf16 a[124:127], a[204:207], v[100:103], a[124:127]
ds_read_b64_tr_b16 a[200:201], v226 offset:0
v_cvt_pk_bf16_f32 v87, v38, v39
v_mfma_f32_16x16x32_bf16 a[120:123], a[204:207], v[96:99], a[120:123]
ds_read_b64_tr_b16 a[202:203], v226 offset:4096
v_mfma_f32_16x16x32_bf16 a[116:119], a[204:207], v[92:95], a[116:119]
buffer_load_dwordx4 v231, s[8:11], s32 offen offset:3072  lds
v_mfma_f32_16x16x32_bf16 a[112:115], a[204:207], v[88:91], a[112:115]
ds_read_b64_tr_b16 a[204:205], v227 offset:0
ds_read_b64_tr_b16 a[206:207], v227 offset:4096
v_smfmac_f32_16x16x64_bf16 a[132:135], a[208:211], v[96:103], v245
s_add_u32 m0, s86, 16384
s_add_u32 s50, s84, 2359296
buffer_load_dwordx4 v240, s[64:67], s50 offen lds
s_add_u32 m0, s86, 20480
s_add_u32 s50, s84, 2949120
buffer_load_dwordx4 v240, s[64:67], s50 offen lds
s_waitcnt lgkmcnt(8)
v_mfma_f32_16x16x32_bf16 v[8:11], a[144:147], v[152:155], v[136:139]
v_exp_f32 v40, v40
v_mfma_f32_16x16x32_bf16 v[8:11], a[148:151], v[156:159], v[8:11]
v_exp_f32 v41, v41
v_mfma_f32_16x16x32_bf16 v[8:11], a[152:155], v[160:163], v[8:11]
v_cvt_pk_bf16_f32 v88, v40, v41
v_mfma_f32_16x16x32_bf16 v[8:11], a[156:159], v[164:167], v[8:11]
v_exp_f32 v42, v42
v_mfma_f32_16x16x32_bf16 v[16:19], a[156:159], v[180:183], v[140:143]
s_add_u32 s39, s39, 16384
v_mfma_f32_16x16x32_bf16 v[16:19], a[152:155], v[176:179], v[16:19]
v_exp_f32 v43, v43
v_mfma_f32_16x16x32_bf16 v[16:19], a[148:151], v[172:175], v[16:19]
v_cvt_pk_bf16_f32 v89, v42, v43
v_mfma_f32_16x16x32_bf16 v[16:19], a[144:147], v[168:171], v[16:19]
v_exp_f32 v44, v44
v_mfma_f32_16x16x32_bf16 v[24:27], a[144:147], v[184:187], v[144:147]
v_mfma_f32_16x16x32_bf16 v[24:27], a[148:151], v[188:191], v[24:27]
v_exp_f32 v45, v45
v_mfma_f32_16x16x32_bf16 v[24:27], a[152:155], v[192:195], v[24:27]
s_bitset0_b32 s39, 19
v_cvt_pk_bf16_f32 v90, v44, v45
v_mfma_f32_16x16x32_bf16 v[24:27], a[156:159], v[196:199], v[24:27]
v_exp_f32 v46, v46
v_mfma_f32_16x16x32_bf16 v[32:35], a[156:159], v[212:215], v[148:151]
ds_read_b128 a[156:159], v219 offset:24576
v_mfma_f32_16x16x32_bf16 v[32:35], a[152:155], v[208:211], v[32:35]
v_exp_f32 v47, v47
v_mfma_f32_16x16x32_bf16 v[32:35], a[148:151], v[204:207], v[32:35]
ds_read_b128 a[152:155], v218 offset:24576
v_cvt_pk_bf16_f32 v91, v46, v47
v_mfma_f32_16x16x32_bf16 v[32:35], a[144:147], v[200:203], v[32:35]
v_exp_f32 v48, v48
v_mfma_f32_16x16x32_bf16 a[0:3], a[176:179], v[72:75], a[0:3]
ds_read_b128 a[148:151], v217 offset:24576
ds_read_b128 a[144:147], v216 offset:24576
v_mfma_f32_16x16x32_bf16 a[4:7], a[176:179], v[76:79], a[4:7]
v_exp_f32 v49, v49
v_mfma_f32_16x16x32_bf16 a[8:11], a[176:179], v[80:83], a[8:11]
s_add_u32 m0, s30, 147456
v_cvt_pk_bf16_f32 v92, v48, v49
v_mfma_f32_16x16x32_bf16 a[12:15], a[176:179], v[84:87], a[12:15]
v_exp_f32 v50, v50
v_mfma_f32_16x16x32_bf16 a[28:31], a[180:183], v[84:87], a[28:31]
ds_read_b64_tr_b16 a[176:177], v220 offset:8192
ds_read_b64_tr_b16 a[178:179], v220 offset:12288
v_mfma_f32_16x16x32_bf16 a[24:27], a[180:183], v[80:83], a[24:27]
v_exp_f32 v51, v51
v_mfma_f32_16x16x32_bf16 a[20:23], a[180:183], v[76:79], a[20:23]
v_cvt_pk_bf16_f32 v93, v50, v51
v_mfma_f32_16x16x32_bf16 a[16:19], a[180:183], v[72:75], a[16:19]
v_exp_f32 v52, v52
v_mfma_f32_16x16x32_bf16 a[32:35], a[184:187], v[72:75], a[32:35]
ds_read_b64_tr_b16 a[180:181], v221 offset:8192
ds_read_b64_tr_b16 a[182:183], v221 offset:12288
v_mfma_f32_16x16x32_bf16 a[36:39], a[184:187], v[76:79], a[36:39]
v_exp_f32 v53, v53
v_mfma_f32_16x16x32_bf16 a[40:43], a[184:187], v[80:83], a[40:43]
v_cvt_pk_bf16_f32 v94, v52, v53
v_mfma_f32_16x16x32_bf16 a[44:47], a[184:187], v[84:87], a[44:47]
v_exp_f32 v54, v54
v_mfma_f32_16x16x32_bf16 a[60:63], a[188:191], v[84:87], a[60:63]
ds_read_b64_tr_b16 a[184:185], v222 offset:8192
ds_read_b64_tr_b16 a[186:187], v222 offset:12288
v_mfma_f32_16x16x32_bf16 a[56:59], a[188:191], v[80:83], a[56:59]
v_exp_f32 v55, v55
v_mfma_f32_16x16x32_bf16 a[52:55], a[188:191], v[76:79], a[52:55]
v_cvt_pk_bf16_f32 v95, v54, v55
v_mfma_f32_16x16x32_bf16 a[48:51], a[188:191], v[72:75], a[48:51]
v_exp_f32 v56, v56
v_smfmac_f32_16x16x64_bf16 a[128:131], a[208:211], v[72:79], v245
ds_read_b64_tr_b16 a[188:189], v223 offset:8192
v_mfma_f32_16x16x32_bf16 v[12:15], a[160:163], v[152:155], v[136:139]
v_exp_f32 v57, v57
v_mfma_f32_16x16x32_bf16 v[12:15], a[164:167], v[156:159], v[12:15]
v_exp_f32 v58, v58
v_mfma_f32_16x16x32_bf16 v[12:15], a[168:171], v[160:163], v[12:15]
ds_read_b64_tr_b16 a[190:191], v223 offset:12288
v_cvt_pk_bf16_f32 v96, v56, v57
v_mfma_f32_16x16x32_bf16 v[12:15], a[172:175], v[164:167], v[12:15]
v_exp_f32 v59, v59
v_mfma_f32_16x16x32_bf16 v[20:23], a[172:175], v[180:183], v[140:143]
v_cvt_pk_bf16_f32 v97, v58, v59
v_mfma_f32_16x16x32_bf16 v[20:23], a[168:171], v[176:179], v[20:23]
v_exp_f32 v60, v60
v_mfma_f32_16x16x32_bf16 v[20:23], a[164:167], v[172:175], v[20:23]
buffer_load_dwordx4 v232, s[12:15], s39 offen offset:0  lds
v_mfma_f32_16x16x32_bf16 v[20:23], a[160:163], v[168:171], v[20:23]
v_exp_f32 v61, v61
v_mfma_f32_16x16x32_bf16 v[28:31], a[160:163], v[184:187], v[144:147]
v_cvt_pk_bf16_f32 v98, v60, v61
v_mfma_f32_16x16x32_bf16 v[28:31], a[164:167], v[188:191], v[28:31]
v_exp_f32 v62, v62
v_mfma_f32_16x16x32_bf16 v[28:31], a[168:171], v[192:195], v[28:31]
buffer_load_dwordx4 v233, s[12:15], s39 offen offset:1024  lds
v_mfma_f32_16x16x32_bf16 v[28:31], a[172:175], v[196:199], v[28:31]
v_exp_f32 v63, v63
v_mfma_f32_16x16x32_bf16 v[36:39], a[172:175], v[212:215], v[148:151]
ds_read_b128 a[172:175], v219 offset:28672
v_cvt_pk_bf16_f32 v99, v62, v63
v_mfma_f32_16x16x32_bf16 v[36:39], a[168:171], v[208:211], v[36:39]
v_exp_f32 v64, v64
v_mfma_f32_16x16x32_bf16 v[36:39], a[164:167], v[204:207], v[36:39]
ds_read_b128 a[168:171], v218 offset:28672
ds_read_b128 a[164:167], v217 offset:28672
v_mfma_f32_16x16x32_bf16 v[36:39], a[160:163], v[200:203], v[36:39]
v_exp_f32 v65, v65
s_waitcnt lgkmcnt(8)
v_mfma_f32_16x16x32_bf16 a[64:67], a[192:195], v[72:75], a[64:67]
ds_read_b128 a[160:163], v216 offset:28672
v_cvt_pk_bf16_f32 v100, v64, v65
v_mfma_f32_16x16x32_bf16 a[68:71], a[192:195], v[76:79], a[68:71]
v_exp_f32 v66, v66
v_mfma_f32_16x16x32_bf16 a[72:75], a[192:195], v[80:83], a[72:75]
buffer_load_dwordx4 v232, s[12:15], s39 offen offset:2048  lds
v_mfma_f32_16x16x32_bf16 a[76:79], a[192:195], v[84:87], a[76:79]
v_exp_f32 v67, v67
v_mfma_f32_16x16x32_bf16 a[92:95], a[196:199], v[84:87], a[92:95]
ds_read_b64_tr_b16 a[192:193], v224 offset:8192
v_cvt_pk_bf16_f32 v101, v66, v67
v_mfma_f32_16x16x32_bf16 a[88:91], a[196:199], v[80:83], a[88:91]
v_exp_f32 v68, v68
v_mfma_f32_16x16x32_bf16 a[84:87], a[196:199], v[76:79], a[84:87]
ds_read_b64_tr_b16 a[194:195], v224 offset:12288
v_mfma_f32_16x16x32_bf16 a[80:83], a[196:199], v[72:75], a[80:83]
v_exp_f32 v69, v69
v_mfma_f32_16x16x32_bf16 a[96:99], a[200:203], v[72:75], a[96:99]
ds_read_b64_tr_b16 a[196:197], v225 offset:8192
v_cvt_pk_bf16_f32 v102, v68, v69
v_mfma_f32_16x16x32_bf16 a[100:103], a[200:203], v[76:79], a[100:103]
v_exp_f32 v70, v70
v_mfma_f32_16x16x32_bf16 a[104:107], a[200:203], v[80:83], a[104:107]
ds_read_b64_tr_b16 a[198:199], v225 offset:12288
v_mfma_f32_16x16x32_bf16 a[108:111], a[200:203], v[84:87], a[108:111]
v_exp_f32 v71, v71
v_mfma_f32_16x16x32_bf16 a[124:127], a[204:207], v[84:87], a[124:127]
ds_read_b64_tr_b16 a[200:201], v226 offset:8192
v_cvt_pk_bf16_f32 v103, v70, v71
v_mfma_f32_16x16x32_bf16 a[120:123], a[204:207], v[80:83], a[120:123]
ds_read_b64_tr_b16 a[202:203], v226 offset:12288
v_mfma_f32_16x16x32_bf16 a[116:119], a[204:207], v[76:79], a[116:119]
buffer_load_dwordx4 v233, s[12:15], s39 offen offset:3072  lds
v_mfma_f32_16x16x32_bf16 a[112:115], a[204:207], v[72:75], a[112:115]
ds_read_b64_tr_b16 a[204:205], v227 offset:8192
ds_read_b64_tr_b16 a[206:207], v227 offset:12288
v_smfmac_f32_16x16x64_bf16 a[132:135], a[208:211], v[80:87], v245
s_add_u32 m0, s86, 24576
s_add_u32 s50, s84, 3538944
buffer_load_dwordx4 v240, s[64:67], s50 offen lds
s_add_u32 m0, s86, 28672
s_add_u32 s50, s84, 4128768
buffer_load_dwordx4 v240, s[64:67], s50 offen lds
v_mfma_f32_16x16x32_bf16 v[40:43], a[144:147], v[152:155], v[136:139]
v_exp_f32 v8, v8
v_mfma_f32_16x16x32_bf16 v[40:43], a[148:151], v[156:159], v[40:43]
v_exp_f32 v9, v9
v_mfma_f32_16x16x32_bf16 v[40:43], a[152:155], v[160:163], v[40:43]
v_cvt_pk_bf16_f32 v72, v8, v9
v_mfma_f32_16x16x32_bf16 v[40:43], a[156:159], v[164:167], v[40:43]
v_exp_f32 v10, v10
v_mfma_f32_16x16x32_bf16 v[48:51], a[156:159], v[180:183], v[140:143]
v_mfma_f32_16x16x32_bf16 v[48:51], a[152:155], v[176:179], v[48:51]
v_exp_f32 v11, v11
v_mfma_f32_16x16x32_bf16 v[48:51], a[148:151], v[172:175], v[48:51]
v_cvt_pk_bf16_f32 v73, v10, v11
v_mfma_f32_16x16x32_bf16 v[48:51], a[144:147], v[168:171], v[48:51]
v_exp_f32 v12, v12
v_mfma_f32_16x16x32_bf16 v[56:59], a[144:147], v[184:187], v[144:147]
v_mfma_f32_16x16x32_bf16 v[56:59], a[148:151], v[188:191], v[56:59]
v_exp_f32 v13, v13
v_mfma_f32_16x16x32_bf16 v[56:59], a[152:155], v[192:195], v[56:59]
v_cvt_pk_bf16_f32 v74, v12, v13
v_mfma_f32_16x16x32_bf16 v[56:59], a[156:159], v[196:199], v[56:59]
v_exp_f32 v14, v14
v_mfma_f32_16x16x32_bf16 v[64:67], a[156:159], v[212:215], v[148:151]
s_waitcnt vmcnt(12) lgkmcnt(0)
s_barrier
v_mfma_f32_16x16x32_bf16 v[64:67], a[152:155], v[208:211], v[64:67]
v_exp_f32 v15, v15
v_mfma_f32_16x16x32_bf16 v[64:67], a[148:151], v[204:207], v[64:67]
ds_read_b128 a[156:159], v219 offset:49152
v_cvt_pk_bf16_f32 v75, v14, v15
v_mfma_f32_16x16x32_bf16 v[64:67], a[144:147], v[200:203], v[64:67]
v_exp_f32 v16, v16
v_mfma_f32_16x16x32_bf16 a[0:3], a[176:179], v[88:91], a[0:3]
ds_read_b128 a[152:155], v218 offset:49152
ds_read_b128 a[148:151], v217 offset:49152
v_mfma_f32_16x16x32_bf16 a[4:7], a[176:179], v[92:95], a[4:7]
v_exp_f32 v17, v17
v_mfma_f32_16x16x32_bf16 a[8:11], a[176:179], v[96:99], a[8:11]
ds_read_b128 a[144:147], v216 offset:49152
v_cvt_pk_bf16_f32 v76, v16, v17
v_mfma_f32_16x16x32_bf16 a[12:15], a[176:179], v[100:103], a[12:15]
v_exp_f32 v18, v18
v_mfma_f32_16x16x32_bf16 a[28:31], a[180:183], v[100:103], a[28:31]
ds_read_b64_tr_b16 a[176:177], v220 offset:32768
ds_read_b64_tr_b16 a[178:179], v220 offset:36864
v_mfma_f32_16x16x32_bf16 a[24:27], a[180:183], v[96:99], a[24:27]
v_exp_f32 v19, v19
v_mfma_f32_16x16x32_bf16 a[20:23], a[180:183], v[92:95], a[20:23]
s_add_u32 s32, s32, 16384
v_cvt_pk_bf16_f32 v77, v18, v19
v_mfma_f32_16x16x32_bf16 a[16:19], a[180:183], v[88:91], a[16:19]
v_exp_f32 v20, v20
v_mfma_f32_16x16x32_bf16 a[32:35], a[184:187], v[88:91], a[32:35]
ds_read_b64_tr_b16 a[180:181], v221 offset:32768
ds_read_b64_tr_b16 a[182:183], v221 offset:36864
v_mfma_f32_16x16x32_bf16 a[36:39], a[184:187], v[92:95], a[36:39]
v_exp_f32 v21, v21
v_mfma_f32_16x16x32_bf16 a[40:43], a[184:187], v[96:99], a[40:43]
s_bitset0_b32 s32, 19
v_cvt_pk_bf16_f32 v78, v20, v21
v_mfma_f32_16x16x32_bf16 a[44:47], a[184:187], v[100:103], a[44:47]
v_exp_f32 v22, v22
v_mfma_f32_16x16x32_bf16 a[60:63], a[188:191], v[100:103], a[60:63]
ds_read_b64_tr_b16 a[184:185], v222 offset:32768
ds_read_b64_tr_b16 a[186:187], v222 offset:36864
v_mfma_f32_16x16x32_bf16 a[56:59], a[188:191], v[96:99], a[56:59]
v_exp_f32 v23, v23
v_mfma_f32_16x16x32_bf16 a[52:55], a[188:191], v[92:95], a[52:55]
s_add_u32 m0, s30, 81920
v_cvt_pk_bf16_f32 v79, v22, v23
v_mfma_f32_16x16x32_bf16 a[48:51], a[188:191], v[88:91], a[48:51]
v_exp_f32 v24, v24
v_smfmac_f32_16x16x64_bf16 a[128:131], a[208:211], v[88:95], v245
ds_read_b64_tr_b16 a[188:189], v223 offset:32768
v_mfma_f32_16x16x32_bf16 v[44:47], a[160:163], v[152:155], v[136:139]
v_exp_f32 v25, v25
v_mfma_f32_16x16x32_bf16 v[44:47], a[164:167], v[156:159], v[44:47]
v_exp_f32 v26, v26
v_mfma_f32_16x16x32_bf16 v[44:47], a[168:171], v[160:163], v[44:47]
ds_read_b64_tr_b16 a[190:191], v223 offset:36864
v_cvt_pk_bf16_f32 v80, v24, v25
v_mfma_f32_16x16x32_bf16 v[44:47], a[172:175], v[164:167], v[44:47]
v_exp_f32 v27, v27
v_mfma_f32_16x16x32_bf16 v[52:55], a[172:175], v[180:183], v[140:143]
v_cmp_ne_u32 vcc, s47, v249
s_cbranch_vccnz SP_CAND
SP_CAND_RET:
v_cvt_pk_bf16_f32 v81, v26, v27
v_mfma_f32_16x16x32_bf16 v[52:55], a[168:171], v[176:179], v[52:55]
v_mov_b32 v251, 0
v_exp_f32 v28, v28
v_mfma_f32_16x16x32_bf16 v[52:55], a[164:167], v[172:175], v[52:55]
buffer_load_dwordx4 v228, s[8:11], s32 offen offset:0  lds
v_mfma_f32_16x16x32_bf16 v[52:55], a[160:163], v[168:171], v[52:55]
v_exp_f32 v29, v29
v_mfma_f32_16x16x32_bf16 v[60:63], a[160:163], v[184:187], v[144:147]
s_mov_b32 s90, 0x01010101
s_mov_b32 s91, 0x01010101
v_cvt_pk_bf16_f32 v82, v28, v29
v_mfma_f32_16x16x32_bf16 v[60:63], a[164:167], v[188:191], v[60:63]
v_exp_f32 v30, v30
v_mfma_f32_16x16x32_bf16 v[60:63], a[168:171], v[192:195], v[60:63]
buffer_load_dwordx4 v229, s[8:11], s32 offen offset:1024  lds
v_max_u32_dpp v250, v248, v248 row_ror:8 row_mask:0xf bank_mask:0xf
v_mfma_f32_16x16x32_bf16 v[60:63], a[172:175], v[196:199], v[60:63]
v_exp_f32 v31, v31
v_mfma_f32_16x16x32_bf16 v[68:71], a[172:175], v[212:215], v[148:151]
ds_read_b128 a[172:175], v219 offset:53248
v_cvt_pk_bf16_f32 v83, v30, v31
v_max_u32_dpp v249, v250, v250 row_ror:4 row_mask:0xf bank_mask:0xf
v_mfma_f32_16x16x32_bf16 v[68:71], a[168:171], v[208:211], v[68:71]
v_exp_f32 v32, v32
v_mfma_f32_16x16x32_bf16 v[68:71], a[164:167], v[204:207], v[68:71]
ds_read_b128 a[168:171], v218 offset:53248
ds_read_b128 a[164:167], v217 offset:53248
v_max_u32_dpp v250, v249, v249 row_ror:2 row_mask:0xf bank_mask:0xf
v_mfma_f32_16x16x32_bf16 v[68:71], a[160:163], v[200:203], v[68:71]
v_exp_f32 v33, v33
v_mfma_f32_16x16x32_bf16 a[64:67], a[192:195], v[88:91], a[64:67]
ds_read_b128 a[160:163], v216 offset:53248
v_cvt_pk_bf16_f32 v84, v32, v33
v_max_u32_dpp v249, v250, v250 row_ror:1 row_mask:0xf bank_mask:0xf
v_mfma_f32_16x16x32_bf16 a[68:71], a[192:195], v[92:95], a[68:71]
v_mov_b32 v250, v249
v_exp_f32 v34, v34
v_mfma_f32_16x16x32_bf16 a[72:75], a[192:195], v[96:99], a[72:75]
buffer_load_dwordx4 v230, s[8:11], s32 offen offset:2048  lds
v_mfma_f32_16x16x32_bf16 a[76:79], a[192:195], v[100:103], a[76:79]
v_permlane16_swap_b32 v249, v250
v_exp_f32 v35, v35
v_mfma_f32_16x16x32_bf16 a[92:95], a[196:199], v[100:103], a[92:95]
ds_read_b64_tr_b16 a[192:193], v224 offset:32768
v_cvt_pk_bf16_f32 v85, v34, v35
v_max_u32 v249, v249, v250
v_mfma_f32_16x16x32_bf16 a[88:91], a[196:199], v[96:99], a[88:91]
v_exp_f32 v36, v36
v_mfma_f32_16x16x32_bf16 a[84:87], a[196:199], v[92:95], a[84:87]
ds_read_b64_tr_b16 a[194:195], v224 offset:36864
v_mov_b32 v250, v249
v_mfma_f32_16x16x32_bf16 a[80:83], a[196:199], v[88:91], a[80:83]
v_exp_f32 v37, v37
v_mfma_f32_16x16x32_bf16 a[96:99], a[200:203], v[88:91], a[96:99]
ds_read_b64_tr_b16 a[196:197], v225 offset:32768
v_cvt_pk_bf16_f32 v86, v36, v37
v_mfma_f32_16x16x32_bf16 a[100:103], a[200:203], v[92:95], a[100:103]
v_exp_f32 v38, v38
v_mfma_f32_16x16x32_bf16 a[104:107], a[200:203], v[96:99], a[104:107]
ds_read_b64_tr_b16 a[198:199], v225 offset:36864
v_permlane32_swap_b32 v249, v250
v_mfma_f32_16x16x32_bf16 a[108:111], a[200:203], v[100:103], a[108:111]
v_exp_f32 v39, v39
v_mfma_f32_16x16x32_bf16 a[124:127], a[204:207], v[100:103], a[124:127]
ds_read_b64_tr_b16 a[200:201], v226 offset:32768
v_cvt_pk_bf16_f32 v87, v38, v39
v_mfma_f32_16x16x32_bf16 a[120:123], a[204:207], v[96:99], a[120:123]
ds_read_b64_tr_b16 a[202:203], v226 offset:36864
v_max_u32 v249, v249, v250
v_mfma_f32_16x16x32_bf16 a[116:119], a[204:207], v[92:95], a[116:119]
buffer_load_dwordx4 v231, s[8:11], s32 offen offset:3072  lds
v_mfma_f32_16x16x32_bf16 a[112:115], a[204:207], v[88:91], a[112:115]
ds_read_b64_tr_b16 a[204:205], v227 offset:32768
ds_read_b64_tr_b16 a[206:207], v227 offset:36864
v_smfmac_f32_16x16x64_bf16 a[132:135], a[208:211], v[96:103], v245
s_add_u32 m0, s86, 32768
s_add_u32 s50, s84, 0
buffer_load_dwordx4 v240, s[68:71], s50 offen lds
s_add_u32 m0, s86, 36864
s_add_u32 s50, s84, 589824
buffer_load_dwordx4 v240, s[68:71], s50 offen lds
s_waitcnt lgkmcnt(8)
v_mfma_f32_16x16x32_bf16 v[8:11], a[144:147], v[152:155], v[136:139]
v_exp_f32 v40, v40
v_mfma_f32_16x16x32_bf16 v[8:11], a[148:151], v[156:159], v[8:11]
v_exp_f32 v41, v41
v_mfma_f32_16x16x32_bf16 v[8:11], a[152:155], v[160:163], v[8:11]
STUB_5:
s_cbranch_execz STUB_8
v_cvt_pk_bf16_f32 v88, v40, v41
v_add_u32 v251, v251, v249
v_mfma_f32_16x16x32_bf16 v[8:11], a[156:159], v[164:167], v[8:11]
v_exp_f32 v42, v42
v_mfma_f32_16x16x32_bf16 v[16:19], a[156:159], v[180:183], v[140:143]
s_add_u32 s39, s39, 16384
v_sub_u32 v248, v248, v249
v_mfma_f32_16x16x32_bf16 v[16:19], a[152:155], v[176:179], v[16:19]
v_exp_f32 v43, v43
v_mfma_f32_16x16x32_bf16 v[16:19], a[148:151], v[172:175], v[16:19]
v_cvt_pk_bf16_f32 v89, v42, v43
v_cndmask_b32 v252, v252, v251, s[90:91]
v_mfma_f32_16x16x32_bf16 v[16:19], a[144:147], v[168:171], v[16:19]
v_exp_f32 v44, v44
v_mfma_f32_16x16x32_bf16 v[24:27], a[144:147], v[184:187], v[144:147]
v_readfirstlane_b32 s76, v251
v_mfma_f32_16x16x32_bf16 v[24:27], a[148:151], v[188:191], v[24:27]
v_exp_f32 v45, v45
v_mfma_f32_16x16x32_bf16 v[24:27], a[152:155], v[192:195], v[24:27]
s_bitset0_b32 s39, 19
v_cvt_pk_bf16_f32 v90, v44, v45
v_mfma_f32_16x16x32_bf16 v[24:27], a[156:159], v[196:199], v[24:27]
v_exp_f32 v46, v46
v_mfma_f32_16x16x32_bf16 v[32:35], a[156:159], v[212:215], v[148:151]
ds_read_b128 a[156:159], v219 offset:57344
s_lshl_b64 s[90:91], s[90:91], 1
v_mfma_f32_16x16x32_bf16 v[32:35], a[152:155], v[208:211], v[32:35]
v_exp_f32 v47, v47
v_mfma_f32_16x16x32_bf16 v[32:35], a[148:151], v[204:207], v[32:35]
ds_read_b128 a[152:155], v218 offset:57344
v_cvt_pk_bf16_f32 v91, v46, v47
v_mfma_f32_16x16x32_bf16 v[32:35], a[144:147], v[200:203], v[32:35]
v_exp_f32 v48, v48
v_mfma_f32_16x16x32_bf16 a[0:3], a[176:179], v[72:75], a[0:3]
ds_read_b128 a[148:151], v217 offset:57344
ds_read_b128 a[144:147], v216 offset:57344
v_mfma_f32_16x16x32_bf16 a[4:7], a[176:179], v[76:79], a[4:7]
v_exp_f32 v49, v49
v_mfma_f32_16x16x32_bf16 a[8:11], a[176:179], v[80:83], a[8:11]
s_add_u32 m0, s30, 98304
v_cvt_pk_bf16_f32 v92, v48, v49
v_mfma_f32_16x16x32_bf16 a[12:15], a[176:179], v[84:87], a[12:15]
v_exp_f32 v50, v50
v_mfma_f32_16x16x32_bf16 a[28:31], a[180:183], v[84:87], a[28:31]
ds_read_b64_tr_b16 a[176:177], v220 offset:40960
ds_read_b64_tr_b16 a[178:179], v220 offset:45056
v_mfma_f32_16x16x32_bf16 a[24:27], a[180:183], v[80:83], a[24:27]
v_exp_f32 v51, v51
v_mfma_f32_16x16x32_bf16 a[20:23], a[180:183], v[76:79], a[20:23]
v_cvt_pk_bf16_f32 v93, v50, v51
v_max_u32_dpp v250, v248, v248 row_ror:8 row_mask:0xf bank_mask:0xf
v_mfma_f32_16x16x32_bf16 a[16:19], a[180:183], v[72:75], a[16:19]
v_exp_f32 v52, v52
v_mfma_f32_16x16x32_bf16 a[32:35], a[184:187], v[72:75], a[32:35]
ds_read_b64_tr_b16 a[180:181], v221 offset:40960
ds_read_b64_tr_b16 a[182:183], v221 offset:45056
v_mfma_f32_16x16x32_bf16 a[36:39], a[184:187], v[76:79], a[36:39]
v_exp_f32 v53, v53
v_mfma_f32_16x16x32_bf16 a[40:43], a[184:187], v[80:83], a[40:43]
v_cvt_pk_bf16_f32 v94, v52, v53
v_max_u32_dpp v249, v250, v250 row_ror:4 row_mask:0xf bank_mask:0xf
v_mfma_f32_16x16x32_bf16 a[44:47], a[184:187], v[84:87], a[44:47]
v_exp_f32 v54, v54
v_mfma_f32_16x16x32_bf16 a[60:63], a[188:191], v[84:87], a[60:63]
ds_read_b64_tr_b16 a[184:185], v222 offset:40960
ds_read_b64_tr_b16 a[186:187], v222 offset:45056
v_mfma_f32_16x16x32_bf16 a[56:59], a[188:191], v[80:83], a[56:59]
v_exp_f32 v55, v55
v_mfma_f32_16x16x32_bf16 a[52:55], a[188:191], v[76:79], a[52:55]
v_cvt_pk_bf16_f32 v95, v54, v55
v_max_u32_dpp v250, v249, v249 row_ror:2 row_mask:0xf bank_mask:0xf
v_mfma_f32_16x16x32_bf16 a[48:51], a[188:191], v[72:75], a[48:51]
v_exp_f32 v56, v56
v_smfmac_f32_16x16x64_bf16 a[128:131], a[208:211], v[72:79], v245
ds_read_b64_tr_b16 a[188:189], v223 offset:40960
v_mfma_f32_16x16x32_bf16 v[12:15], a[160:163], v[152:155], v[136:139]
v_exp_f32 v57, v57
v_mfma_f32_16x16x32_bf16 v[12:15], a[164:167], v[156:159], v[12:15]
v_exp_f32 v58, v58
v_mfma_f32_16x16x32_bf16 v[12:15], a[168:171], v[160:163], v[12:15]
ds_read_b64_tr_b16 a[190:191], v223 offset:45056
v_cvt_pk_bf16_f32 v96, v56, v57
v_mfma_f32_16x16x32_bf16 v[12:15], a[172:175], v[164:167], v[12:15]
v_exp_f32 v59, v59
v_mfma_f32_16x16x32_bf16 v[20:23], a[172:175], v[180:183], v[140:143]
v_cvt_pk_bf16_f32 v97, v58, v59
v_max_u32_dpp v249, v250, v250 row_ror:1 row_mask:0xf bank_mask:0xf
v_mfma_f32_16x16x32_bf16 v[20:23], a[168:171], v[176:179], v[20:23]
v_exp_f32 v60, v60
v_mfma_f32_16x16x32_bf16 v[20:23], a[164:167], v[172:175], v[20:23]
buffer_load_dwordx4 v232, s[12:15], s39 offen offset:0  lds
v_mfma_f32_16x16x32_bf16 v[20:23], a[160:163], v[168:171], v[20:23]
v_exp_f32 v61, v61
v_mfma_f32_16x16x32_bf16 v[28:31], a[160:163], v[184:187], v[144:147]
v_cvt_pk_bf16_f32 v98, v60, v61
v_mov_b32 v250, v249
v_mfma_f32_16x16x32_bf16 v[28:31], a[164:167], v[188:191], v[28:31]
v_exp_f32 v62, v62
v_mfma_f32_16x16x32_bf16 v[28:31], a[168:171], v[192:195], v[28:31]
buffer_load_dwordx4 v233, s[12:15], s39 offen offset:1024  lds
v_mfma_f32_16x16x32_bf16 v[28:31], a[172:175], v[196:199], v[28:31]
v_exp_f32 v63, v63
v_mfma_f32_16x16x32_bf16 v[36:39], a[172:175], v[212:215], v[148:151]
ds_read_b128 a[172:175], v219 offset:61440
v_cvt_pk_bf16_f32 v99, v62, v63
v_mfma_f32_16x16x32_bf16 v[36:39], a[168:171], v[208:211], v[36:39]
v_exp_f32 v64, v64
v_mfma_f32_16x16x32_bf16 v[36:39], a[164:167], v[204:207], v[36:39]
ds_read_b128 a[168:171], v218 offset:61440
ds_read_b128 a[164:167], v217 offset:61440
v_mfma_f32_16x16x32_bf16 v[36:39], a[160:163], v[200:203], v[36:39]
v_exp_f32 v65, v65
s_waitcnt lgkmcnt(8)
v_mfma_f32_16x16x32_bf16 a[64:67], a[192:195], v[72:75], a[64:67]
ds_read_b128 a[160:163], v216 offset:61440
v_cvt_pk_bf16_f32 v100, v64, v65
v_mfma_f32_16x16x32_bf16 a[68:71], a[192:195], v[76:79], a[68:71]
v_permlane16_swap_b32 v249, v250
v_exp_f32 v66, v66
v_mfma_f32_16x16x32_bf16 a[72:75], a[192:195], v[80:83], a[72:75]
buffer_load_dwordx4 v232, s[12:15], s39 offen offset:2048  lds
v_mfma_f32_16x16x32_bf16 a[76:79], a[192:195], v[84:87], a[76:79]
v_exp_f32 v67, v67
v_mfma_f32_16x16x32_bf16 a[92:95], a[196:199], v[84:87], a[92:95]
ds_read_b64_tr_b16 a[192:193], v224 offset:40960
v_cvt_pk_bf16_f32 v101, v66, v67
v_mfma_f32_16x16x32_bf16 a[88:91], a[196:199], v[80:83], a[88:91]
v_max_u32 v249, v249, v250
v_exp_f32 v68, v68
v_mfma_f32_16x16x32_bf16 a[84:87], a[196:199], v[76:79], a[84:87]
ds_read_b64_tr_b16 a[194:195], v224 offset:45056
v_mov_b32 v250, v249
v_mfma_f32_16x16x32_bf16 a[80:83], a[196:199], v[72:75], a[80:83]
v_exp_f32 v69, v69
v_mfma_f32_16x16x32_bf16 a[96:99], a[200:203], v[72:75], a[96:99]
ds_read_b64_tr_b16 a[196:197], v225 offset:40960
v_cvt_pk_bf16_f32 v102, v68, v69
v_mfma_f32_16x16x32_bf16 a[100:103], a[200:203], v[76:79], a[100:103]
v_exp_f32 v70, v70
v_mfma_f32_16x16x32_bf16 a[104:107], a[200:203], v[80:83], a[104:107]
ds_read_b64_tr_b16 a[198:199], v225 offset:45056
v_permlane32_swap_b32 v249, v250
v_mfma_f32_16x16x32_bf16 a[108:111], a[200:203], v[84:87], a[108:111]
v_exp_f32 v71, v71
v_mfma_f32_16x16x32_bf16 a[124:127], a[204:207], v[84:87], a[124:127]
ds_read_b64_tr_b16 a[200:201], v226 offset:40960
v_cvt_pk_bf16_f32 v103, v70, v71
v_mfma_f32_16x16x32_bf16 a[120:123], a[204:207], v[80:83], a[120:123]
ds_read_b64_tr_b16 a[202:203], v226 offset:45056
v_max_u32 v249, v249, v250
v_mfma_f32_16x16x32_bf16 a[116:119], a[204:207], v[76:79], a[116:119]
buffer_load_dwordx4 v233, s[12:15], s39 offen offset:3072  lds
v_mfma_f32_16x16x32_bf16 a[112:115], a[204:207], v[72:75], a[112:115]
ds_read_b64_tr_b16 a[204:205], v227 offset:40960
ds_read_b64_tr_b16 a[206:207], v227 offset:45056
v_smfmac_f32_16x16x64_bf16 a[132:135], a[208:211], v[80:87], v245
s_add_u32 m0, s86, 40960
s_add_u32 s50, s84, 1179648
buffer_load_dwordx4 v240, s[68:71], s50 offen lds
s_add_u32 m0, s86, 45056
s_add_u32 s50, s84, 1769472
buffer_load_dwordx4 v240, s[68:71], s50 offen lds
v_mfma_f32_16x16x32_bf16 v[40:43], a[144:147], v[152:155], v[136:139]
v_exp_f32 v8, v8
v_mfma_f32_16x16x32_bf16 v[40:43], a[148:151], v[156:159], v[40:43]
v_exp_f32 v9, v9
v_mfma_f32_16x16x32_bf16 v[40:43], a[152:155], v[160:163], v[40:43]
v_cvt_pk_bf16_f32 v72, v8, v9
v_lshlrev_b32 v246, 2, v1
v_mfma_f32_16x16x32_bf16 v[40:43], a[156:159], v[164:167], v[40:43]
v_exp_f32 v10, v10
v_mfma_f32_16x16x32_bf16 v[48:51], a[156:159], v[180:183], v[140:143]
v_add_u32 v251, v251, v249
v_sub_u32 v248, v248, v249
v_mfma_f32_16x16x32_bf16 v[48:51], a[152:155], v[176:179], v[48:51]
v_exp_f32 v11, v11
v_mfma_f32_16x16x32_bf16 v[48:51], a[148:151], v[172:175], v[48:51]
v_cvt_pk_bf16_f32 v73, v10, v11
v_cndmask_b32 v252, v252, v251, s[90:91]
v_mfma_f32_16x16x32_bf16 v[48:51], a[144:147], v[168:171], v[48:51]
v_exp_f32 v12, v12
v_mfma_f32_16x16x32_bf16 v[56:59], a[144:147], v[184:187], v[144:147]
v_readfirstlane_b32 s77, v251
v_mfma_f32_16x16x32_bf16 v[56:59], a[148:151], v[188:191], v[56:59]
v_exp_f32 v13, v13
v_mfma_f32_16x16x32_bf16 v[56:59], a[152:155], v[192:195], v[56:59]
s_lshl_b64 s[90:91], s[90:91], 1
v_cvt_pk_bf16_f32 v74, v12, v13
v_mfma_f32_16x16x32_bf16 v[56:59], a[156:159], v[196:199], v[56:59]
v_exp_f32 v14, v14
v_mfma_f32_16x16x32_bf16 v[64:67], a[156:159], v[212:215], v[148:151]
s_waitcnt vmcnt(12) lgkmcnt(0)
s_barrier
v_mfma_f32_16x16x32_bf16 v[64:67], a[152:155], v[208:211], v[64:67]
v_exp_f32 v15, v15
v_mfma_f32_16x16x32_bf16 v[64:67], a[148:151], v[204:207], v[64:67]
ds_read_b128 a[156:159], v219 offset:0
v_cvt_pk_bf16_f32 v75, v14, v15
v_mfma_f32_16x16x32_bf16 v[64:67], a[144:147], v[200:203], v[64:67]
v_exp_f32 v16, v16
v_mfma_f32_16x16x32_bf16 a[0:3], a[176:179], v[88:91], a[0:3]
ds_read_b128 a[152:155], v218 offset:0
ds_read_b128 a[148:151], v217 offset:0
v_mfma_f32_16x16x32_bf16 a[4:7], a[176:179], v[92:95], a[4:7]
v_exp_f32 v17, v17
v_mfma_f32_16x16x32_bf16 a[8:11], a[176:179], v[96:99], a[8:11]
ds_read_b128 a[144:147], v216 offset:0
v_cvt_pk_bf16_f32 v76, v16, v17
v_mfma_f32_16x16x32_bf16 a[12:15], a[176:179], v[100:103], a[12:15]
v_exp_f32 v18, v18
v_mfma_f32_16x16x32_bf16 a[28:31], a[180:183], v[100:103], a[28:31]
ds_read_b64_tr_b16 a[176:177], v220 offset:49152
ds_read_b64_tr_b16 a[178:179], v220 offset:53248
v_mfma_f32_16x16x32_bf16 a[24:27], a[180:183], v[96:99], a[24:27]
v_exp_f32 v19, v19
v_mfma_f32_16x16x32_bf16 a[20:23], a[180:183], v[92:95], a[20:23]
s_add_u32 s32, s32, 16384
v_cvt_pk_bf16_f32 v77, v18, v19
v_mfma_f32_16x16x32_bf16 a[16:19], a[180:183], v[88:91], a[16:19]
v_exp_f32 v20, v20
v_mfma_f32_16x16x32_bf16 a[32:35], a[184:187], v[88:91], a[32:35]
ds_read_b64_tr_b16 a[180:181], v221 offset:49152
ds_read_b64_tr_b16 a[182:183], v221 offset:53248
v_mfma_f32_16x16x32_bf16 a[36:39], a[184:187], v[92:95], a[36:39]
v_exp_f32 v21, v21
v_mfma_f32_16x16x32_bf16 a[40:43], a[184:187], v[96:99], a[40:43]
s_bitset0_b32 s32, 19
v_cvt_pk_bf16_f32 v78, v20, v21
v_mfma_f32_16x16x32_bf16 a[44:47], a[184:187], v[100:103], a[44:47]
v_exp_f32 v22, v22
v_mfma_f32_16x16x32_bf16 a[60:63], a[188:191], v[100:103], a[60:63]
ds_read_b64_tr_b16 a[184:185], v222 offset:49152
ds_read_b64_tr_b16 a[186:187], v222 offset:53248
v_mfma_f32_16x16x32_bf16 a[56:59], a[188:191], v[96:99], a[56:59]
v_max_u32_dpp v250, v248, v248 row_ror:8 row_mask:0xf bank_mask:0xf
v_exp_f32 v23, v23
v_mfma_f32_16x16x32_bf16 a[52:55], a[188:191], v[92:95], a[52:55]
s_add_u32 m0, s30, 114688
v_cvt_pk_bf16_f32 v79, v22, v23
v_mfma_f32_16x16x32_bf16 a[48:51], a[188:191], v[88:91], a[48:51]
v_exp_f32 v24, v24
v_smfmac_f32_16x16x64_bf16 a[128:131], a[208:211], v[88:95], v245
ds_read_b64_tr_b16 a[188:189], v223 offset:49152
v_mfma_f32_16x16x32_bf16 v[44:47], a[160:163], v[152:155], v[136:139]
v_exp_f32 v25, v25
v_mfma_f32_16x16x32_bf16 v[44:47], a[164:167], v[156:159], v[44:47]
v_max_u32_dpp v249, v250, v250 row_ror:4 row_mask:0xf bank_mask:0xf
v_exp_f32 v26, v26
v_mfma_f32_16x16x32_bf16 v[44:47], a[168:171], v[160:163], v[44:47]
ds_read_b64_tr_b16 a[190:191], v223 offset:53248
v_cvt_pk_bf16_f32 v80, v24, v25
v_mfma_f32_16x16x32_bf16 v[44:47], a[172:175], v[164:167], v[44:47]
v_exp_f32 v27, v27
v_mfma_f32_16x16x32_bf16 v[52:55], a[172:175], v[180:183], v[140:143]
v_cvt_pk_bf16_f32 v81, v26, v27
v_max_u32_dpp v250, v249, v249 row_ror:2 row_mask:0xf bank_mask:0xf
v_mfma_f32_16x16x32_bf16 v[52:55], a[168:171], v[176:179], v[52:55]
v_exp_f32 v28, v28
v_mfma_f32_16x16x32_bf16 v[52:55], a[164:167], v[172:175], v[52:55]
buffer_load_dwordx4 v228, s[8:11], s32 offen offset:0  lds
v_mfma_f32_16x16x32_bf16 v[52:55], a[160:163], v[168:171], v[52:55]
v_exp_f32 v29, v29
v_mfma_f32_16x16x32_bf16 v[60:63], a[160:163], v[184:187], v[144:147]
v_cvt_pk_bf16_f32 v82, v28, v29
v_max_u32_dpp v249, v250, v250 row_ror:1 row_mask:0xf bank_mask:0xf
v_mfma_f32_16x16x32_bf16 v[60:63], a[164:167], v[188:191], v[60:63]
v_exp_f32 v30, v30
v_mfma_f32_16x16x32_bf16 v[60:63], a[168:171], v[192:195], v[60:63]
buffer_load_dwordx4 v229, s[8:11], s32 offen offset:1024  lds
v_mfma_f32_16x16x32_bf16 v[60:63], a[172:175], v[196:199], v[60:63]
v_exp_f32 v31, v31
v_mfma_f32_16x16x32_bf16 v[68:71], a[172:175], v[212:215], v[148:151]
ds_read_b128 a[172:175], v219 offset:4096
v_cvt_pk_bf16_f32 v83, v30, v31
v_mfma_f32_16x16x32_bf16 v[68:71], a[168:171], v[208:211], v[68:71]
v_exp_f32 v32, v32
v_mfma_f32_16x16x32_bf16 v[68:71], a[164:167], v[204:207], v[68:71]
ds_read_b128 a[168:171], v218 offset:4096
ds_read_b128 a[164:167], v217 offset:4096
v_mov_b32 v250, v249
v_mfma_f32_16x16x32_bf16 v[68:71], a[160:163], v[200:203], v[68:71]
v_exp_f32 v33, v33
v_mfma_f32_16x16x32_bf16 a[64:67], a[192:195], v[88:91], a[64:67]
ds_read_b128 a[160:163], v216 offset:4096
v_cvt_pk_bf16_f32 v84, v32, v33
v_mfma_f32_16x16x32_bf16 a[68:71], a[192:195], v[92:95], a[68:71]
v_exp_f32 v34, v34
v_mfma_f32_16x16x32_bf16 a[72:75], a[192:195], v[96:99], a[72:75]
buffer_load_dwordx4 v230, s[8:11], s32 offen offset:2048  lds
v_mfma_f32_16x16x32_bf16 a[76:79], a[192:195], v[100:103], a[76:79]
v_permlane16_swap_b32 v249, v250
v_exp_f32 v35, v35
v_mfma_f32_16x16x32_bf16 a[92:95], a[196:199], v[100:103], a[92:95]
ds_read_b64_tr_b16 a[192:193], v224 offset:49152
v_cvt_pk_bf16_f32 v85, v34, v35
v_mfma_f32_16x16x32_bf16 a[88:91], a[196:199], v[96:99], a[88:91]
v_exp_f32 v36, v36
v_mfma_f32_16x16x32_bf16 a[84:87], a[196:199], v[92:95], a[84:87]
ds_read_b64_tr_b16 a[194:195], v224 offset:53248
v_max_u32 v249, v249, v250
v_mfma_f32_16x16x32_bf16 a[80:83], a[196:199], v[88:91], a[80:83]
v_exp_f32 v37, v37
v_mfma_f32_16x16x32_bf16 a[96:99], a[200:203], v[88:91], a[96:99]
ds_read_b64_tr_b16 a[196:197], v225 offset:49152
v_cvt_pk_bf16_f32 v86, v36, v37
v_mfma_f32_16x16x32_bf16 a[100:103], a[200:203], v[92:95], a[100:103]
v_exp_f32 v38, v38
v_mfma_f32_16x16x32_bf16 a[104:107], a[200:203], v[96:99], a[104:107]
ds_read_b64_tr_b16 a[198:199], v225 offset:53248
v_mov_b32 v250, v249
v_mfma_f32_16x16x32_bf16 a[108:111], a[200:203], v[100:103], a[108:111]
v_exp_f32 v39, v39
v_mfma_f32_16x16x32_bf16 a[124:127], a[204:207], v[100:103], a[124:127]
ds_read_b64_tr_b16 a[200:201], v226 offset:49152
v_cvt_pk_bf16_f32 v87, v38, v39
v_mfma_f32_16x16x32_bf16 a[120:123], a[204:207], v[96:99], a[120:123]
ds_read_b64_tr_b16 a[202:203], v226 offset:53248
v_permlane32_swap_b32 v249, v250
v_mfma_f32_16x16x32_bf16 a[116:119], a[204:207], v[92:95], a[116:119]
buffer_load_dwordx4 v231, s[8:11], s32 offen offset:3072  lds
v_mfma_f32_16x16x32_bf16 a[112:115], a[204:207], v[88:91], a[112:115]
ds_read_b64_tr_b16 a[204:205], v227 offset:49152
ds_read_b64_tr_b16 a[206:207], v227 offset:53248
v_smfmac_f32_16x16x64_bf16 a[132:135], a[208:211], v[96:103], v245
s_add_u32 m0, s86, 49152
s_add_u32 s50, s84, 2359296
buffer_load_dwordx4 v240, s[68:71], s50 offen lds
s_add_u32 m0, s86, 53248
s_add_u32 s50, s84, 2949120
buffer_load_dwordx4 v240, s[68:71], s50 offen lds
s_waitcnt lgkmcnt(8)
v_mfma_f32_16x16x32_bf16 v[8:11], a[144:147], v[152:155], v[136:139]
v_exp_f32 v40, v40
v_mfma_f32_16x16x32_bf16 v[8:11], a[148:151], v[156:159], v[8:11]
v_exp_f32 v41, v41
v_mfma_f32_16x16x32_bf16 v[8:11], a[152:155], v[160:163], v[8:11]
v_cvt_pk_bf16_f32 v88, v40, v41
v_max_u32 v249, v249, v250
v_mfma_f32_16x16x32_bf16 v[8:11], a[156:159], v[164:167], v[8:11]
v_exp_f32 v42, v42
v_mfma_f32_16x16x32_bf16 v[16:19], a[156:159], v[180:183], v[140:143]
s_add_u32 s39, s39, 16384
v_add_u32 v251, v251, v249
v_mfma_f32_16x16x32_bf16 v[16:19], a[152:155], v[176:179], v[16:19]
v_exp_f32 v43, v43
v_mfma_f32_16x16x32_bf16 v[16:19], a[148:151], v[172:175], v[16:19]
v_cvt_pk_bf16_f32 v89, v42, v43
v_sub_u32 v248, v248, v249
v_mfma_f32_16x16x32_bf16 v[16:19], a[144:147], v[168:171], v[16:19]
v_exp_f32 v44, v44
v_mfma_f32_16x16x32_bf16 v[24:27], a[144:147], v[184:187], v[144:147]
buffer_load_dword v253, v246, s[24:27], 0 offen sc0 sc1
v_mfma_f32_16x16x32_bf16 v[24:27], a[148:151], v[188:191], v[24:27]
v_exp_f32 v45, v45
v_mfma_f32_16x16x32_bf16 v[24:27], a[152:155], v[192:195], v[24:27]
s_bitset0_b32 s39, 19
v_cvt_pk_bf16_f32 v90, v44, v45
v_mfma_f32_16x16x32_bf16 v[24:27], a[156:159], v[196:199], v[24:27]
v_exp_f32 v46, v46
v_mfma_f32_16x16x32_bf16 v[32:35], a[156:159], v[212:215], v[148:151]
ds_read_b128 a[156:159], v219 offset:8192
v_cndmask_b32 v252, v252, v251, s[90:91]
v_mfma_f32_16x16x32_bf16 v[32:35], a[152:155], v[208:211], v[32:35]
v_exp_f32 v47, v47
v_mfma_f32_16x16x32_bf16 v[32:35], a[148:151], v[204:207], v[32:35]
ds_read_b128 a[152:155], v218 offset:8192
v_cvt_pk_bf16_f32 v91, v46, v47
v_mfma_f32_16x16x32_bf16 v[32:35], a[144:147], v[200:203], v[32:35]
v_exp_f32 v48, v48
v_mfma_f32_16x16x32_bf16 a[0:3], a[176:179], v[72:75], a[0:3]
ds_read_b128 a[148:151], v217 offset:8192
ds_read_b128 a[144:147], v216 offset:8192
v_mfma_f32_16x16x32_bf16 a[4:7], a[176:179], v[76:79], a[4:7]
v_exp_f32 v49, v49
v_mfma_f32_16x16x32_bf16 a[8:11], a[176:179], v[80:83], a[8:11]
s_add_u32 m0, s30, 131072
v_cvt_pk_bf16_f32 v92, v48, v49
v_mfma_f32_16x16x32_bf16 a[12:15], a[176:179], v[84:87], a[12:15]
v_exp_f32 v50, v50
v_mfma_f32_16x16x32_bf16 a[28:31], a[180:183], v[84:87], a[28:31]
ds_read_b64_tr_b16 a[176:177], v220 offset:57344
ds_read_b64_tr_b16 a[178:179], v220 offset:61440
v_mfma_f32_16x16x32_bf16 a[24:27], a[180:183], v[80:83], a[24:27]
v_exp_f32 v51, v51
v_mfma_f32_16x16x32_bf16 a[20:23], a[180:183], v[76:79], a[20:23]
v_cvt_pk_bf16_f32 v93, v50, v51
v_readfirstlane_b32 s78, v251
v_mfma_f32_16x16x32_bf16 a[16:19], a[180:183], v[72:75], a[16:19]
v_exp_f32 v52, v52
v_mfma_f32_16x16x32_bf16 a[32:35], a[184:187], v[72:75], a[32:35]
ds_read_b64_tr_b16 a[180:181], v221 offset:57344
ds_read_b64_tr_b16 a[182:183], v221 offset:61440
v_mfma_f32_16x16x32_bf16 a[36:39], a[184:187], v[76:79], a[36:39]
v_exp_f32 v53, v53
v_mfma_f32_16x16x32_bf16 a[40:43], a[184:187], v[80:83], a[40:43]
s_lshl_b64 s[90:91], s[90:91], 1
v_cvt_pk_bf16_f32 v94, v52, v53
v_mfma_f32_16x16x32_bf16 a[44:47], a[184:187], v[84:87], a[44:47]
v_exp_f32 v54, v54
v_mfma_f32_16x16x32_bf16 a[60:63], a[188:191], v[84:87], a[60:63]
ds_read_b64_tr_b16 a[184:185], v222 offset:57344
ds_read_b64_tr_b16 a[186:187], v222 offset:61440
v_mfma_f32_16x16x32_bf16 a[56:59], a[188:191], v[80:83], a[56:59]
v_exp_f32 v55, v55
v_mfma_f32_16x16x32_bf16 a[52:55], a[188:191], v[76:79], a[52:55]
v_cvt_pk_bf16_f32 v95, v54, v55
v_max_u32_dpp v250, v248, v248 row_ror:8 row_mask:0xf bank_mask:0xf
v_mfma_f32_16x16x32_bf16 a[48:51], a[188:191], v[72:75], a[48:51]
v_exp_f32 v56, v56
v_smfmac_f32_16x16x64_bf16 a[128:131], a[208:211], v[72:79], v245
ds_read_b64_tr_b16 a[188:189], v223 offset:57344
v_mfma_f32_16x16x32_bf16 v[12:15], a[160:163], v[152:155], v[136:139]
v_exp_f32 v57, v57
v_mfma_f32_16x16x32_bf16 v[12:15], a[164:167], v[156:159], v[12:15]
v_exp_f32 v58, v58
v_mfma_f32_16x16x32_bf16 v[12:15], a[168:171], v[160:163], v[12:15]
ds_read_b64_tr_b16 a[190:191], v223 offset:61440
v_cvt_pk_bf16_f32 v96, v56, v57
v_mfma_f32_16x16x32_bf16 v[12:15], a[172:175], v[164:167], v[12:15]
v_max_u32_dpp v249, v250, v250 row_ror:4 row_mask:0xf bank_mask:0xf
v_exp_f32 v59, v59
v_mfma_f32_16x16x32_bf16 v[20:23], a[172:175], v[180:183], v[140:143]
v_cvt_pk_bf16_f32 v97, v58, v59
v_mfma_f32_16x16x32_bf16 v[20:23], a[168:171], v[176:179], v[20:23]
v_exp_f32 v60, v60
v_mfma_f32_16x16x32_bf16 v[20:23], a[164:167], v[172:175], v[20:23]
buffer_load_dwordx4 v232, s[12:15], s39 offen offset:0  lds
v_mfma_f32_16x16x32_bf16 v[20:23], a[160:163], v[168:171], v[20:23]
v_exp_f32 v61, v61
v_mfma_f32_16x16x32_bf16 v[28:31], a[160:163], v[184:187], v[144:147]
v_cvt_pk_bf16_f32 v98, v60, v61
v_max_u32_dpp v250, v249, v249 row_ror:2 row_mask:0xf bank_mask:0xf
v_mfma_f32_16x16x32_bf16 v[28:31], a[164:167], v[188:191], v[28:31]
v_exp_f32 v62, v62
v_mfma_f32_16x16x32_bf16 v[28:31], a[168:171], v[192:195], v[28:31]
buffer_load_dwordx4 v233, s[12:15], s39 offen offset:1024  lds
v_mfma_f32_16x16x32_bf16 v[28:31], a[172:175], v[196:199], v[28:31]
v_exp_f32 v63, v63
v_mfma_f32_16x16x32_bf16 v[36:39], a[172:175], v[212:215], v[148:151]
ds_read_b128 a[172:175], v219 offset:12288
v_cvt_pk_bf16_f32 v99, v62, v63
v_max_u32_dpp v249, v250, v250 row_ror:1 row_mask:0xf bank_mask:0xf
v_mfma_f32_16x16x32_bf16 v[36:39], a[168:171], v[208:211], v[36:39]
v_exp_f32 v64, v64
v_mfma_f32_16x16x32_bf16 v[36:39], a[164:167], v[204:207], v[36:39]
ds_read_b128 a[168:171], v218 offset:12288
ds_read_b128 a[164:167], v217 offset:12288
v_mfma_f32_16x16x32_bf16 v[36:39], a[160:163], v[200:203], v[36:39]
v_exp_f32 v65, v65
s_waitcnt lgkmcnt(8)
v_mfma_f32_16x16x32_bf16 a[64:67], a[192:195], v[72:75], a[64:67]
ds_read_b128 a[160:163], v216 offset:12288
v_cvt_pk_bf16_f32 v100, v64, v65
v_mfma_f32_16x16x32_bf16 a[68:71], a[192:195], v[76:79], a[68:71]
v_mov_b32 v250, v249
v_exp_f32 v66, v66
v_mfma_f32_16x16x32_bf16 a[72:75], a[192:195], v[80:83], a[72:75]
buffer_load_dwordx4 v232, s[12:15], s39 offen offset:2048  lds
v_mfma_f32_16x16x32_bf16 a[76:79], a[192:195], v[84:87], a[76:79]
v_exp_f32 v67, v67
v_mfma_f32_16x16x32_bf16 a[92:95], a[196:199], v[84:87], a[92:95]
ds_read_b64_tr_b16 a[192:193], v224 offset:57344
v_cvt_pk_bf16_f32 v101, v66, v67
v_mfma_f32_16x16x32_bf16 a[88:91], a[196:199], v[80:83], a[88:91]
v_permlane16_swap_b32 v249, v250
v_exp_f32 v68, v68
v_mfma_f32_16x16x32_bf16 a[84:87], a[196:199], v[76:79], a[84:87]
ds_read_b64_tr_b16 a[194:195], v224 offset:61440
v_max_u32 v249, v249, v250
v_mfma_f32_16x16x32_bf16 a[80:83], a[196:199], v[72:75], a[80:83]
v_exp_f32 v69, v69
v_mfma_f32_16x16x32_bf16 a[96:99], a[200:203], v[72:75], a[96:99]
ds_read_b64_tr_b16 a[196:197], v225 offset:57344
v_cvt_pk_bf16_f32 v102, v68, v69
v_mfma_f32_16x16x32_bf16 a[100:103], a[200:203], v[76:79], a[100:103]
v_exp_f32 v70, v70
v_mfma_f32_16x16x32_bf16 a[104:107], a[200:203], v[80:83], a[104:107]
ds_read_b64_tr_b16 a[198:199], v225 offset:61440
v_mov_b32 v250, v249
v_mfma_f32_16x16x32_bf16 a[108:111], a[200:203], v[84:87], a[108:111]
v_exp_f32 v71, v71
v_mfma_f32_16x16x32_bf16 a[124:127], a[204:207], v[84:87], a[124:127]
ds_read_b64_tr_b16 a[200:201], v226 offset:57344
v_cvt_pk_bf16_f32 v103, v70, v71
v_mfma_f32_16x16x32_bf16 a[120:123], a[204:207], v[80:83], a[120:123]
ds_read_b64_tr_b16 a[202:203], v226 offset:61440
v_permlane32_swap_b32 v249, v250
v_mfma_f32_16x16x32_bf16 a[116:119], a[204:207], v[76:79], a[116:119]
buffer_load_dwordx4 v233, s[12:15], s39 offen offset:3072  lds
v_mfma_f32_16x16x32_bf16 a[112:115], a[204:207], v[72:75], a[112:115]
ds_read_b64_tr_b16 a[204:205], v227 offset:57344
ds_read_b64_tr_b16 a[206:207], v227 offset:61440
v_smfmac_f32_16x16x64_bf16 a[132:135], a[208:211], v[80:87], v245
s_add_u32 m0, s86, 57344
s_add_u32 s50, s84, 3538944
buffer_load_dwordx4 v240, s[68:71], s50 offen lds
s_add_u32 m0, s86, 61440
s_add_u32 s50, s84, 4128768
buffer_load_dwordx4 v240, s[68:71], s50 offen lds
v_mfma_f32_16x16x32_bf16 v[40:43], a[144:147], v[152:155], v[136:139]
v_exp_f32 v8, v8
v_mfma_f32_16x16x32_bf16 v[40:43], a[148:151], v[156:159], v[40:43]
v_exp_f32 v9, v9
v_mfma_f32_16x16x32_bf16 v[40:43], a[152:155], v[160:163], v[40:43]
v_cvt_pk_bf16_f32 v72, v8, v9
v_max_u32 v249, v249, v250
v_mfma_f32_16x16x32_bf16 v[40:43], a[156:159], v[164:167], v[40:43]
v_exp_f32 v10, v10
v_mfma_f32_16x16x32_bf16 v[48:51], a[156:159], v[180:183], v[140:143]
v_add_u32 v251, v251, v249
v_sub_u32 v248, v248, v249
v_mfma_f32_16x16x32_bf16 v[48:51], a[152:155], v[176:179], v[48:51]
v_exp_f32 v11, v11
v_mfma_f32_16x16x32_bf16 v[48:51], a[148:151], v[172:175], v[48:51]
v_cvt_pk_bf16_f32 v73, v10, v11
v_cndmask_b32 v252, v252, v251, s[90:91]
v_mfma_f32_16x16x32_bf16 v[48:51], a[144:147], v[168:171], v[48:51]
v_exp_f32 v12, v12
v_mfma_f32_16x16x32_bf16 v[56:59], a[144:147], v[184:187], v[144:147]
v_readfirstlane_b32 s79, v251
v_mfma_f32_16x16x32_bf16 v[56:59], a[148:151], v[188:191], v[56:59]
v_exp_f32 v13, v13
v_mfma_f32_16x16x32_bf16 v[56:59], a[152:155], v[192:195], v[56:59]
s_lshl_b64 s[90:91], s[90:91], 1
v_cvt_pk_bf16_f32 v74, v12, v13
v_mfma_f32_16x16x32_bf16 v[56:59], a[156:159], v[196:199], v[56:59]
v_exp_f32 v14, v14
v_mfma_f32_16x16x32_bf16 v[64:67], a[156:159], v[212:215], v[148:151]
s_waitcnt vmcnt(13) lgkmcnt(0)
s_barrier
v_mfma_f32_16x16x32_bf16 v[64:67], a[152:155], v[208:211], v[64:67]
v_exp_f32 v15, v15
v_mfma_f32_16x16x32_bf16 v[64:67], a[148:151], v[204:207], v[64:67]
ds_read_b128 a[156:159], v219 offset:16384
v_cvt_pk_bf16_f32 v75, v14, v15
v_mfma_f32_16x16x32_bf16 v[64:67], a[144:147], v[200:203], v[64:67]
v_exp_f32 v16, v16
v_mfma_f32_16x16x32_bf16 a[0:3], a[176:179], v[88:91], a[0:3]
ds_read_b128 a[152:155], v218 offset:16384
ds_read_b128 a[148:151], v217 offset:16384
v_mfma_f32_16x16x32_bf16 a[4:7], a[176:179], v[92:95], a[4:7]
v_exp_f32 v17, v17
v_mfma_f32_16x16x32_bf16 a[8:11], a[176:179], v[96:99], a[8:11]
ds_read_b128 a[144:147], v216 offset:16384
v_cvt_pk_bf16_f32 v76, v16, v17
v_mfma_f32_16x16x32_bf16 a[12:15], a[176:179], v[100:103], a[12:15]
v_exp_f32 v18, v18
v_mfma_f32_16x16x32_bf16 a[28:31], a[180:183], v[100:103], a[28:31]
ds_read_b64_tr_b16 a[176:177], v220 offset:0
ds_read_b64_tr_b16 a[178:179], v220 offset:4096
v_mfma_f32_16x16x32_bf16 a[24:27], a[180:183], v[96:99], a[24:27]
v_exp_f32 v19, v19
v_mfma_f32_16x16x32_bf16 a[20:23], a[180:183], v[92:95], a[20:23]
s_add_u32 s32, s32, 16384
v_cvt_pk_bf16_f32 v77, v18, v19
v_mfma_f32_16x16x32_bf16 a[16:19], a[180:183], v[88:91], a[16:19]
v_exp_f32 v20, v20
v_mfma_f32_16x16x32_bf16 a[32:35], a[184:187], v[88:91], a[32:35]
ds_read_b64_tr_b16 a[180:181], v221 offset:0
ds_read_b64_tr_b16 a[182:183], v221 offset:4096
v_mfma_f32_16x16x32_bf16 a[36:39], a[184:187], v[92:95], a[36:39]
v_exp_f32 v21, v21
v_mfma_f32_16x16x32_bf16 a[40:43], a[184:187], v[96:99], a[40:43]
s_bitset0_b32 s32, 19
v_cvt_pk_bf16_f32 v78, v20, v21
v_mfma_f32_16x16x32_bf16 a[44:47], a[184:187], v[100:103], a[44:47]
v_exp_f32 v22, v22
v_mfma_f32_16x16x32_bf16 a[60:63], a[188:191], v[100:103], a[60:63]
ds_read_b64_tr_b16 a[184:185], v222 offset:0
ds_read_b64_tr_b16 a[186:187], v222 offset:4096
v_mfma_f32_16x16x32_bf16 a[56:59], a[188:191], v[96:99], a[56:59]
v_exp_f32 v23, v23
v_mfma_f32_16x16x32_bf16 a[52:55], a[188:191], v[92:95], a[52:55]
s_add_u32 m0, s30, 65536
v_cvt_pk_bf16_f32 v79, v22, v23
v_mfma_f32_16x16x32_bf16 a[48:51], a[188:191], v[88:91], a[48:51]
v_exp_f32 v24, v24
v_smfmac_f32_16x16x64_bf16 a[128:131], a[208:211], v[88:95], v245
ds_read_b64_tr_b16 a[188:189], v223 offset:0
v_mfma_f32_16x16x32_bf16 v[44:47], a[160:163], v[152:155], v[136:139]
v_exp_f32 v25, v25
v_mfma_f32_16x16x32_bf16 v[44:47], a[164:167], v[156:159], v[44:47]
v_max_u32_dpp v250, v248, v248 row_ror:8 row_mask:0xf bank_mask:0xf
v_exp_f32 v26, v26
v_mfma_f32_16x16x32_bf16 v[44:47], a[168:171], v[160:163], v[44:47]
ds_read_b64_tr_b16 a[190:191], v223 offset:4096
v_cvt_pk_bf16_f32 v80, v24, v25
v_mfma_f32_16x16x32_bf16 v[44:47], a[172:175], v[164:167], v[44:47]
v_exp_f32 v27, v27
v_mfma_f32_16x16x32_bf16 v[52:55], a[172:175], v[180:183], v[140:143]
v_cvt_pk_bf16_f32 v81, v26, v27
v_max_u32_dpp v249, v250, v250 row_ror:4 row_mask:0xf bank_mask:0xf
STUB_6:
s_cbranch_execz STUB_9
v_mfma_f32_16x16x32_bf16 v[52:55], a[168:171], v[176:179], v[52:55]
v_exp_f32 v28, v28
v_mfma_f32_16x16x32_bf16 v[52:55], a[164:167], v[172:175], v[52:55]
buffer_load_dwordx4 v228, s[8:11], s32 offen offset:0  lds
v_mfma_f32_16x16x32_bf16 v[52:55], a[160:163], v[168:171], v[52:55]
v_exp_f32 v29, v29
v_mfma_f32_16x16x32_bf16 v[60:63], a[160:163], v[184:187], v[144:147]
v_cvt_pk_bf16_f32 v82, v28, v29
v_max_u32_dpp v250, v249, v249 row_ror:2 row_mask:0xf bank_mask:0xf
v_mfma_f32_16x16x32_bf16 v[60:63], a[164:167], v[188:191], v[60:63]
v_exp_f32 v30, v30
v_mfma_f32_16x16x32_bf16 v[60:63], a[168:171], v[192:195], v[60:63]
buffer_load_dwordx4 v229, s[8:11], s32 offen offset:1024  lds
v_mfma_f32_16x16x32_bf16 v[60:63], a[172:175], v[196:199], v[60:63]
v_exp_f32 v31, v31
v_mfma_f32_16x16x32_bf16 v[68:71], a[172:175], v[212:215], v[148:151]
ds_read_b128 a[172:175], v219 offset:20480
v_cvt_pk_bf16_f32 v83, v30, v31
v_mfma_f32_16x16x32_bf16 v[68:71], a[168:171], v[208:211], v[68:71]
v_exp_f32 v32, v32
v_mfma_f32_16x16x32_bf16 v[68:71], a[164:167], v[204:207], v[68:71]
ds_read_b128 a[168:171], v218 offset:20480
ds_read_b128 a[164:167], v217 offset:20480
v_max_u32_dpp v249, v250, v250 row_ror:1 row_mask:0xf bank_mask:0xf
v_mfma_f32_16x16x32_bf16 v[68:71], a[160:163], v[200:203], v[68:71]
v_exp_f32 v33, v33
v_mfma_f32_16x16x32_bf16 a[64:67], a[192:195], v[88:91], a[64:67]
ds_read_b128 a[160:163], v216 offset:20480
v_cvt_pk_bf16_f32 v84, v32, v33
v_mfma_f32_16x16x32_bf16 a[68:71], a[192:195], v[92:95], a[68:71]
v_exp_f32 v34, v34
v_mfma_f32_16x16x32_bf16 a[72:75], a[192:195], v[96:99], a[72:75]
buffer_load_dwordx4 v230, s[8:11], s32 offen offset:2048  lds
v_mfma_f32_16x16x32_bf16 a[76:79], a[192:195], v[100:103], a[76:79]
v_mov_b32 v250, v249
v_exp_f32 v35, v35
v_mfma_f32_16x16x32_bf16 a[92:95], a[196:199], v[100:103], a[92:95]
ds_read_b64_tr_b16 a[192:193], v224 offset:0
v_cvt_pk_bf16_f32 v85, v34, v35
v_mfma_f32_16x16x32_bf16 a[88:91], a[196:199], v[96:99], a[88:91]
v_exp_f32 v36, v36
v_mfma_f32_16x16x32_bf16 a[84:87], a[196:199], v[92:95], a[84:87]
ds_read_b64_tr_b16 a[194:195], v224 offset:4096
v_permlane16_swap_b32 v249, v250
v_mfma_f32_16x16x32_bf16 a[80:83], a[196:199], v[88:91], a[80:83]
v_exp_f32 v37, v37
v_mfma_f32_16x16x32_bf16 a[96:99], a[200:203], v[88:91], a[96:99]
ds_read_b64_tr_b16 a[196:197], v225 offset:0
v_cvt_pk_bf16_f32 v86, v36, v37
v_mfma_f32_16x16x32_bf16 a[100:103], a[200:203], v[92:95], a[100:103]
v_exp_f32 v38, v38
v_mfma_f32_16x16x32_bf16 a[104:107], a[200:203], v[96:99], a[104:107]
ds_read_b64_tr_b16 a[198:199], v225 offset:4096
v_max_u32 v249, v249, v250
v_mfma_f32_16x16x32_bf16 a[108:111], a[200:203], v[100:103], a[108:111]
v_exp_f32 v39, v39
v_mfma_f32_16x16x32_bf16 a[124:127], a[204:207], v[100:103], a[124:127]
ds_read_b64_tr_b16 a[200:201], v226 offset:0
v_cvt_pk_bf16_f32 v87, v38, v39
v_mfma_f32_16x16x32_bf16 a[120:123], a[204:207], v[96:99], a[120:123]
ds_read_b64_tr_b16 a[202:203], v226 offset:4096
v_mov_b32 v250, v249
v_mfma_f32_16x16x32_bf16 a[116:119], a[204:207], v[92:95], a[116:119]
buffer_load_dwordx4 v231, s[8:11], s32 offen offset:3072  lds
v_mfma_f32_16x16x32_bf16 a[112:115], a[204:207], v[88:91], a[112:115]
ds_read_b64_tr_b16 a[204:205], v227 offset:0
ds_read_b64_tr_b16 a[206:207], v227 offset:4096
v_smfmac_f32_16x16x64_bf16 a[132:135], a[208:211], v[96:103], v245
v_permlane32_swap_b32 v249, v250
s_waitcnt lgkmcnt(8)
v_mfma_f32_16x16x32_bf16 v[8:11], a[144:147], v[152:155], v[136:139]
v_exp_f32 v40, v40
v_mfma_f32_16x16x32_bf16 v[8:11], a[148:151], v[156:159], v[8:11]
v_exp_f32 v41, v41
v_mfma_f32_16x16x32_bf16 v[8:11], a[152:155], v[160:163], v[8:11]
v_cvt_pk_bf16_f32 v88, v40, v41
v_max_u32 v249, v249, v250
v_mfma_f32_16x16x32_bf16 v[8:11], a[156:159], v[164:167], v[8:11]
v_exp_f32 v42, v42
v_mfma_f32_16x16x32_bf16 v[16:19], a[156:159], v[180:183], v[140:143]
s_add_u32 s39, s39, 16384
v_add_u32 v251, v251, v249
v_mfma_f32_16x16x32_bf16 v[16:19], a[152:155], v[176:179], v[16:19]
v_exp_f32 v43, v43
v_mfma_f32_16x16x32_bf16 v[16:19], a[148:151], v[172:175], v[16:19]
v_cvt_pk_bf16_f32 v89, v42, v43
v_sub_u32 v248, v248, v249
v_mfma_f32_16x16x32_bf16 v[16:19], a[144:147], v[168:171], v[16:19]
v_exp_f32 v44, v44
v_mfma_f32_16x16x32_bf16 v[24:27], a[144:147], v[184:187], v[144:147]
v_cndmask_b32 v252, v252, v251, s[90:91]
v_mfma_f32_16x16x32_bf16 v[24:27], a[148:151], v[188:191], v[24:27]
v_exp_f32 v45, v45
v_mfma_f32_16x16x32_bf16 v[24:27], a[152:155], v[192:195], v[24:27]
v_cvt_pk_bf16_f32 v90, v44, v45
v_readfirstlane_b32 s80, v251
v_mfma_f32_16x16x32_bf16 v[24:27], a[156:159], v[196:199], v[24:27]
v_exp_f32 v46, v46
v_mfma_f32_16x16x32_bf16 v[32:35], a[156:159], v[212:215], v[148:151]
ds_read_b128 a[156:159], v219 offset:24576
s_bitset0_b32 s39, 19
v_mfma_f32_16x16x32_bf16 v[32:35], a[152:155], v[208:211], v[32:35]
v_exp_f32 v47, v47
v_mfma_f32_16x16x32_bf16 v[32:35], a[148:151], v[204:207], v[32:35]
ds_read_b128 a[152:155], v218 offset:24576
v_cvt_pk_bf16_f32 v91, v46, v47
v_mfma_f32_16x16x32_bf16 v[32:35], a[144:147], v[200:203], v[32:35]
v_exp_f32 v48, v48
v_mfma_f32_16x16x32_bf16 a[0:3], a[176:179], v[72:75], a[0:3]
ds_read_b128 a[148:151], v217 offset:24576
ds_read_b128 a[144:147], v216 offset:24576
v_mfma_f32_16x16x32_bf16 a[4:7], a[176:179], v[76:79], a[4:7]
v_exp_f32 v49, v49
v_mfma_f32_16x16x32_bf16 a[8:11], a[176:179], v[80:83], a[8:11]
s_lshl_b64 s[90:91], s[90:91], 1
v_cvt_pk_bf16_f32 v92, v48, v49
v_mfma_f32_16x16x32_bf16 a[12:15], a[176:179], v[84:87], a[12:15]
v_exp_f32 v50, v50
v_mfma_f32_16x16x32_bf16 a[28:31], a[180:183], v[84:87], a[28:31]
ds_read_b64_tr_b16 a[176:177], v220 offset:8192
ds_read_b64_tr_b16 a[178:179], v220 offset:12288
v_mfma_f32_16x16x32_bf16 a[24:27], a[180:183], v[80:83], a[24:27]
v_exp_f32 v51, v51
v_mfma_f32_16x16x32_bf16 a[20:23], a[180:183], v[76:79], a[20:23]
s_add_u32 m0, s30, 147456
v_cvt_pk_bf16_f32 v93, v50, v51
v_mfma_f32_16x16x32_bf16 a[16:19], a[180:183], v[72:75], a[16:19]
v_exp_f32 v52, v52
v_mfma_f32_16x16x32_bf16 a[32:35], a[184:187], v[72:75], a[32:35]
ds_read_b64_tr_b16 a[180:181], v221 offset:8192
ds_read_b64_tr_b16 a[182:183], v221 offset:12288
v_mfma_f32_16x16x32_bf16 a[36:39], a[184:187], v[76:79], a[36:39]
v_exp_f32 v53, v53
v_mfma_f32_16x16x32_bf16 a[40:43], a[184:187], v[80:83], a[40:43]
v_cvt_pk_bf16_f32 v94, v52, v53
v_max_u32_dpp v250, v248, v248 row_ror:8 row_mask:0xf bank_mask:0xf
v_mfma_f32_16x16x32_bf16 a[44:47], a[184:187], v[84:87], a[44:47]
v_exp_f32 v54, v54
v_mfma_f32_16x16x32_bf16 a[60:63], a[188:191], v[84:87], a[60:63]
ds_read_b64_tr_b16 a[184:185], v222 offset:8192
ds_read_b64_tr_b16 a[186:187], v222 offset:12288
v_mfma_f32_16x16x32_bf16 a[56:59], a[188:191], v[80:83], a[56:59]
v_exp_f32 v55, v55
v_mfma_f32_16x16x32_bf16 a[52:55], a[188:191], v[76:79], a[52:55]
v_cvt_pk_bf16_f32 v95, v54, v55
v_max_u32_dpp v249, v250, v250 row_ror:4 row_mask:0xf bank_mask:0xf
v_mfma_f32_16x16x32_bf16 a[48:51], a[188:191], v[72:75], a[48:51]
v_exp_f32 v56, v56
v_smfmac_f32_16x16x64_bf16 a[128:131], a[208:211], v[72:79], v245
ds_read_b64_tr_b16 a[188:189], v223 offset:8192
v_mfma_f32_16x16x32_bf16 v[12:15], a[160:163], v[152:155], v[136:139]
v_exp_f32 v57, v57
v_mfma_f32_16x16x32_bf16 v[12:15], a[164:167], v[156:159], v[12:15]
v_exp_f32 v58, v58
v_mfma_f32_16x16x32_bf16 v[12:15], a[168:171], v[160:163], v[12:15]
ds_read_b64_tr_b16 a[190:191], v223 offset:12288
v_cvt_pk_bf16_f32 v96, v56, v57
v_mfma_f32_16x16x32_bf16 v[12:15], a[172:175], v[164:167], v[12:15]
v_exp_f32 v59, v59
v_mfma_f32_16x16x32_bf16 v[20:23], a[172:175], v[180:183], v[140:143]
v_cvt_pk_bf16_f32 v97, v58, v59
v_max_u32_dpp v250, v249, v249 row_ror:2 row_mask:0xf bank_mask:0xf
v_mfma_f32_16x16x32_bf16 v[20:23], a[168:171], v[176:179], v[20:23]
v_exp_f32 v60, v60
v_mfma_f32_16x16x32_bf16 v[20:23], a[164:167], v[172:175], v[20:23]
buffer_load_dwordx4 v232, s[12:15], s39 offen offset:0  lds
v_mfma_f32_16x16x32_bf16 v[20:23], a[160:163], v[168:171], v[20:23]
v_exp_f32 v61, v61
v_mfma_f32_16x16x32_bf16 v[28:31], a[160:163], v[184:187], v[144:147]
v_cvt_pk_bf16_f32 v98, v60, v61
v_max_u32_dpp v249, v250, v250 row_ror:1 row_mask:0xf bank_mask:0xf
v_mfma_f32_16x16x32_bf16 v[28:31], a[164:167], v[188:191], v[28:31]
v_exp_f32 v62, v62
v_mfma_f32_16x16x32_bf16 v[28:31], a[168:171], v[192:195], v[28:31]
buffer_load_dwordx4 v233, s[12:15], s39 offen offset:1024  lds
v_mfma_f32_16x16x32_bf16 v[28:31], a[172:175], v[196:199], v[28:31]
v_exp_f32 v63, v63
v_mfma_f32_16x16x32_bf16 v[36:39], a[172:175], v[212:215], v[148:151]
ds_read_b128 a[172:175], v219 offset:28672
v_cvt_pk_bf16_f32 v99, v62, v63
v_mfma_f32_16x16x32_bf16 v[36:39], a[168:171], v[208:211], v[36:39]
v_exp_f32 v64, v64
v_mfma_f32_16x16x32_bf16 v[36:39], a[164:167], v[204:207], v[36:39]
ds_read_b128 a[168:171], v218 offset:28672
ds_read_b128 a[164:167], v217 offset:28672
v_mfma_f32_16x16x32_bf16 v[36:39], a[160:163], v[200:203], v[36:39]
v_exp_f32 v65, v65
s_waitcnt lgkmcnt(8)
v_mfma_f32_16x16x32_bf16 a[64:67], a[192:195], v[72:75], a[64:67]
ds_read_b128 a[160:163], v216 offset:28672
v_cvt_pk_bf16_f32 v100, v64, v65
v_mfma_f32_16x16x32_bf16 a[68:71], a[192:195], v[76:79], a[68:71]
v_exp_f32 v66, v66
v_mfma_f32_16x16x32_bf16 a[72:75], a[192:195], v[80:83], a[72:75]
buffer_load_dwordx4 v232, s[12:15], s39 offen offset:2048  lds
v_mfma_f32_16x16x32_bf16 a[76:79], a[192:195], v[84:87], a[76:79]
v_exp_f32 v67, v67
v_mfma_f32_16x16x32_bf16 a[92:95], a[196:199], v[84:87], a[92:95]
ds_read_b64_tr_b16 a[192:193], v224 offset:8192
v_cvt_pk_bf16_f32 v101, v66, v67
v_mfma_f32_16x16x32_bf16 a[88:91], a[196:199], v[80:83], a[88:91]
v_mov_b32 v250, v249
v_exp_f32 v68, v68
v_mfma_f32_16x16x32_bf16 a[84:87], a[196:199], v[76:79], a[84:87]
ds_read_b64_tr_b16 a[194:195], v224 offset:12288
v_mfma_f32_16x16x32_bf16 a[80:83], a[196:199], v[72:75], a[80:83]
v_exp_f32 v69, v69
v_mfma_f32_16x16x32_bf16 a[96:99], a[200:203], v[72:75], a[96:99]
ds_read_b64_tr_b16 a[196:197], v225 offset:8192
v_cvt_pk_bf16_f32 v102, v68, v69
v_mfma_f32_16x16x32_bf16 a[100:103], a[200:203], v[76:79], a[100:103]
v_exp_f32 v70, v70
v_mfma_f32_16x16x32_bf16 a[104:107], a[200:203], v[80:83], a[104:107]
ds_read_b64_tr_b16 a[198:199], v225 offset:12288
v_permlane16_swap_b32 v249, v250
v_mfma_f32_16x16x32_bf16 a[108:111], a[200:203], v[84:87], a[108:111]
v_exp_f32 v71, v71
v_mfma_f32_16x16x32_bf16 a[124:127], a[204:207], v[84:87], a[124:127]
ds_read_b64_tr_b16 a[200:201], v226 offset:8192
v_cvt_pk_bf16_f32 v103, v70, v71
v_mfma_f32_16x16x32_bf16 a[120:123], a[204:207], v[80:83], a[120:123]
ds_read_b64_tr_b16 a[202:203], v226 offset:12288
v_max_u32 v249, v249, v250
v_mfma_f32_16x16x32_bf16 a[116:119], a[204:207], v[76:79], a[116:119]
buffer_load_dwordx4 v233, s[12:15], s39 offen offset:3072  lds
v_mfma_f32_16x16x32_bf16 a[112:115], a[204:207], v[72:75], a[112:115]
ds_read_b64_tr_b16 a[204:205], v227 offset:8192
ds_read_b64_tr_b16 a[206:207], v227 offset:12288
v_smfmac_f32_16x16x64_bf16 a[132:135], a[208:211], v[80:87], v245
v_mov_b32 v250, v249
v_mfma_f32_16x16x32_bf16 v[40:43], a[144:147], v[152:155], v[136:139]
v_exp_f32 v8, v8
v_mfma_f32_16x16x32_bf16 v[40:43], a[148:151], v[156:159], v[40:43]
v_exp_f32 v9, v9
v_mfma_f32_16x16x32_bf16 v[40:43], a[152:155], v[160:163], v[40:43]
v_cvt_pk_bf16_f32 v72, v8, v9
v_permlane32_swap_b32 v249, v250
v_mfma_f32_16x16x32_bf16 v[40:43], a[156:159], v[164:167], v[40:43]
v_exp_f32 v10, v10
v_mfma_f32_16x16x32_bf16 v[48:51], a[156:159], v[180:183], v[140:143]
v_max_u32 v249, v249, v250
v_add_u32 v251, v251, v249
v_mfma_f32_16x16x32_bf16 v[48:51], a[152:155], v[176:179], v[48:51]
v_exp_f32 v11, v11
v_mfma_f32_16x16x32_bf16 v[48:51], a[148:151], v[172:175], v[48:51]
v_cvt_pk_bf16_f32 v73, v10, v11
v_sub_u32 v248, v248, v249
v_mfma_f32_16x16x32_bf16 v[48:51], a[144:147], v[168:171], v[48:51]
v_exp_f32 v12, v12
v_mfma_f32_16x16x32_bf16 v[56:59], a[144:147], v[184:187], v[144:147]
v_cndmask_b32 v252, v252, v251, s[90:91]
v_mfma_f32_16x16x32_bf16 v[56:59], a[148:151], v[188:191], v[56:59]
v_exp_f32 v13, v13
v_mfma_f32_16x16x32_bf16 v[56:59], a[152:155], v[192:195], v[56:59]
v_cvt_pk_bf16_f32 v74, v12, v13
v_readfirstlane_b32 s81, v251
v_mfma_f32_16x16x32_bf16 v[56:59], a[156:159], v[196:199], v[56:59]
v_exp_f32 v14, v14
v_mfma_f32_16x16x32_bf16 v[64:67], a[156:159], v[212:215], v[148:151]
s_waitcnt vmcnt(8) lgkmcnt(0)
s_barrier
v_mfma_f32_16x16x32_bf16 v[64:67], a[152:155], v[208:211], v[64:67]
ds_read_b64_tr_b16 a[212:213], v241 offset:0
v_exp_f32 v15, v15
v_mfma_f32_16x16x32_bf16 v[64:67], a[148:151], v[204:207], v[64:67]
ds_read_b128 a[156:159], v219 offset:49152
ds_read_b64_tr_b16 a[214:215], v241 offset:256
v_cvt_pk_bf16_f32 v75, v14, v15
v_mfma_f32_16x16x32_bf16 v[64:67], a[144:147], v[200:203], v[64:67]
ds_read_b64_tr_b16 a[216:217], v241 offset:2048
v_exp_f32 v16, v16
v_mfma_f32_16x16x32_bf16 a[0:3], a[176:179], v[88:91], a[0:3]
ds_read_b128 a[152:155], v218 offset:49152
ds_read_b128 a[148:151], v217 offset:49152
ds_read_b64_tr_b16 a[218:219], v241 offset:2304
v_mfma_f32_16x16x32_bf16 a[4:7], a[176:179], v[92:95], a[4:7]
ds_read_b64_tr_b16 a[220:221], v241 offset:4096
v_exp_f32 v17, v17
v_mfma_f32_16x16x32_bf16 a[8:11], a[176:179], v[96:99], a[8:11]
ds_read_b128 a[144:147], v216 offset:49152
ds_read_b64_tr_b16 a[222:223], v241 offset:4352
v_cvt_pk_bf16_f32 v76, v16, v17
v_mfma_f32_16x16x32_bf16 a[12:15], a[176:179], v[100:103], a[12:15]
ds_read_b64_tr_b16 a[224:225], v241 offset:6144
v_exp_f32 v18, v18
v_mfma_f32_16x16x32_bf16 a[28:31], a[180:183], v[100:103], a[28:31]
ds_read_b64_tr_b16 a[176:177], v220 offset:32768
ds_read_b64_tr_b16 a[178:179], v220 offset:36864
ds_read_b64_tr_b16 a[226:227], v241 offset:6400
v_mfma_f32_16x16x32_bf16 a[24:27], a[180:183], v[96:99], a[24:27]
ds_read_b64_tr_b16 a[228:229], v241 offset:8192
v_exp_f32 v19, v19
v_mfma_f32_16x16x32_bf16 a[20:23], a[180:183], v[92:95], a[20:23]
s_add_u32 s32, s32, 16384
ds_read_b64_tr_b16 a[230:231], v241 offset:8448
v_cvt_pk_bf16_f32 v77, v18, v19
v_mfma_f32_16x16x32_bf16 a[16:19], a[180:183], v[88:91], a[16:19]
ds_read_b64_tr_b16 a[232:233], v241 offset:10240
v_exp_f32 v20, v20
v_mfma_f32_16x16x32_bf16 a[32:35], a[184:187], v[88:91], a[32:35]
ds_read_b64_tr_b16 a[180:181], v221 offset:32768
ds_read_b64_tr_b16 a[182:183], v221 offset:36864
ds_read_b64_tr_b16 a[234:235], v241 offset:10496
v_mfma_f32_16x16x32_bf16 a[36:39], a[184:187], v[92:95], a[36:39]
ds_read_b64_tr_b16 a[236:237], v241 offset:12288
v_exp_f32 v21, v21
v_mfma_f32_16x16x32_bf16 a[40:43], a[184:187], v[96:99], a[40:43]
s_bitset0_b32 s32, 19
ds_read_b64_tr_b16 a[238:239], v241 offset:12544
v_cvt_pk_bf16_f32 v78, v20, v21
v_mfma_f32_16x16x32_bf16 a[44:47], a[184:187], v[100:103], a[44:47]
ds_read_b64_tr_b16 a[240:241], v241 offset:14336
v_exp_f32 v22, v22
v_mfma_f32_16x16x32_bf16 a[60:63], a[188:191], v[100:103], a[60:63]
ds_read_b64_tr_b16 a[184:185], v222 offset:32768
ds_read_b64_tr_b16 a[186:187], v222 offset:36864
ds_read_b64_tr_b16 a[242:243], v241 offset:14592
v_mfma_f32_16x16x32_bf16 a[56:59], a[188:191], v[96:99], a[56:59]
ds_read_b64_tr_b16 a[244:245], v241 offset:16384
v_exp_f32 v23, v23
v_mfma_f32_16x16x32_bf16 a[52:55], a[188:191], v[92:95], a[52:55]
s_add_u32 m0, s30, 81920
ds_read_b64_tr_b16 a[246:247], v241 offset:16640
v_cvt_pk_bf16_f32 v79, v22, v23
v_mfma_f32_16x16x32_bf16 a[48:51], a[188:191], v[88:91], a[48:51]
ds_read_b64_tr_b16 a[248:249], v241 offset:18432
v_exp_f32 v24, v24
v_smfmac_f32_16x16x64_bf16 a[128:131], a[208:211], v[88:95], v245
ds_read_b64_tr_b16 a[188:189], v223 offset:32768
ds_read_b64_tr_b16 a[250:251], v241 offset:18688
v_mfma_f32_16x16x32_bf16 v[44:47], a[160:163], v[152:155], v[136:139]
ds_read_b64_tr_b16 a[252:253], v241 offset:20480
v_exp_f32 v25, v25
v_mfma_f32_16x16x32_bf16 v[44:47], a[164:167], v[156:159], v[44:47]
ds_read_b64_tr_b16 a[254:255], v241 offset:20736
v_exp_f32 v26, v26
v_mfma_f32_16x16x32_bf16 v[44:47], a[168:171], v[160:163], v[44:47]
ds_read_b64_tr_b16 a[190:191], v223 offset:36864
ds_read_b64_tr_b16 a[136:137], v241 offset:22528
v_cvt_pk_bf16_f32 v80, v24, v25
v_mfma_f32_16x16x32_bf16 v[44:47], a[172:175], v[164:167], v[44:47]
ds_read_b64_tr_b16 a[138:139], v241 offset:22784
v_exp_f32 v27, v27
v_mfma_f32_16x16x32_bf16 v[52:55], a[172:175], v[180:183], v[140:143]
ds_read_b64_tr_b16 a[140:141], v241 offset:24576
s_lshl_b64 s[90:91], s[90:91], 1
v_cvt_pk_bf16_f32 v81, v26, v27
v_mfma_f32_16x16x32_bf16 v[52:55], a[168:171], v[176:179], v[52:55]
v_exp_f32 v28, v28
v_mfma_f32_16x16x32_bf16 v[52:55], a[164:167], v[172:175], v[52:55]
buffer_load_dwordx4 v228, s[8:11], s32 offen offset:0  lds
v_max_u32_dpp v250, v248, v248 row_ror:8 row_mask:0xf bank_mask:0xf
v_mfma_f32_16x16x32_bf16 v[52:55], a[160:163], v[168:171], v[52:55]
v_exp_f32 v29, v29
v_mfma_f32_16x16x32_bf16 v[60:63], a[160:163], v[184:187], v[144:147]
ds_read_b64_tr_b16 a[142:143], v241 offset:24832
v_cvt_pk_bf16_f32 v82, v28, v29
v_mfma_f32_16x16x32_bf16 v[60:63], a[164:167], v[188:191], v[60:63]
v_exp_f32 v30, v30
v_mfma_f32_16x16x32_bf16 v[60:63], a[168:171], v[192:195], v[60:63]
buffer_load_dwordx4 v229, s[8:11], s32 offen offset:1024  lds
v_max_u32_dpp v249, v250, v250 row_ror:4 row_mask:0xf bank_mask:0xf
v_mfma_f32_16x16x32_bf16 v[60:63], a[172:175], v[196:199], v[60:63]
v_exp_f32 v31, v31
v_mfma_f32_16x16x32_bf16 v[68:71], a[172:175], v[212:215], v[148:151]
ds_read_b128 a[172:175], v219 offset:53248
v_cvt_pk_bf16_f32 v83, v30, v31
v_mfma_f32_16x16x32_bf16 v[68:71], a[168:171], v[208:211], v[68:71]
v_exp_f32 v32, v32
v_mfma_f32_16x16x32_bf16 v[68:71], a[164:167], v[204:207], v[68:71]
ds_read_b128 a[168:171], v218 offset:53248
ds_read_b128 a[164:167], v217 offset:53248
v_max_u32_dpp v250, v249, v249 row_ror:2 row_mask:0xf bank_mask:0xf
v_mfma_f32_16x16x32_bf16 v[68:71], a[160:163], v[200:203], v[68:71]
v_exp_f32 v33, v33
v_mfma_f32_16x16x32_bf16 a[64:67], a[192:195], v[88:91], a[64:67]
ds_read_b128 a[160:163], v216 offset:53248
ds_read_b64_tr_b16 v[104:105], v241 offset:26624
v_cvt_pk_bf16_f32 v84, v32, v33
v_mfma_f32_16x16x32_bf16 a[68:71], a[192:195], v[92:95], a[68:71]
v_exp_f32 v34, v34
v_mfma_f32_16x16x32_bf16 a[72:75], a[192:195], v[96:99], a[72:75]
buffer_load_dwordx4 v230, s[8:11], s32 offen offset:2048  lds
v_mfma_f32_16x16x32_bf16 a[76:79], a[192:195], v[100:103], a[76:79]
v_max_u32_dpp v249, v250, v250 row_ror:1 row_mask:0xf bank_mask:0xf
v_exp_f32 v35, v35
v_mfma_f32_16x16x32_bf16 a[92:95], a[196:199], v[100:103], a[92:95]
ds_read_b64_tr_b16 a[192:193], v224 offset:32768
v_cvt_pk_bf16_f32 v85, v34, v35
v_mfma_f32_16x16x32_bf16 a[88:91], a[196:199], v[96:99], a[88:91]
ds_read_b64_tr_b16 v[106:107], v241 offset:26880
v_exp_f32 v36, v36
v_mfma_f32_16x16x32_bf16 a[84:87], a[196:199], v[92:95], a[84:87]
ds_read_b64_tr_b16 a[194:195], v224 offset:36864
ds_read_b64_tr_b16 v[108:109], v241 offset:28672
v_mfma_f32_16x16x32_bf16 a[80:83], a[196:199], v[88:91], a[80:83]
v_mov_b32 v250, v249
v_exp_f32 v37, v37
v_mfma_f32_16x16x32_bf16 a[96:99], a[200:203], v[88:91], a[96:99]
ds_read_b64_tr_b16 a[196:197], v225 offset:32768
v_cvt_pk_bf16_f32 v86, v36, v37
v_mfma_f32_16x16x32_bf16 a[100:103], a[200:203], v[92:95], a[100:103]
v_exp_f32 v38, v38
v_mfma_f32_16x16x32_bf16 a[104:107], a[200:203], v[96:99], a[104:107]
ds_read_b64_tr_b16 a[198:199], v225 offset:36864
ds_read_b64_tr_b16 v[110:111], v241 offset:28928
v_mfma_f32_16x16x32_bf16 a[108:111], a[200:203], v[100:103], a[108:111]
v_exp_f32 v39, v39
v_mfma_f32_16x16x32_bf16 a[124:127], a[204:207], v[100:103], a[124:127]
ds_read_b64_tr_b16 a[200:201], v226 offset:32768
v_cvt_pk_bf16_f32 v87, v38, v39
v_permlane16_swap_b32 v249, v250
v_mfma_f32_16x16x32_bf16 a[120:123], a[204:207], v[96:99], a[120:123]
ds_read_b64_tr_b16 a[202:203], v226 offset:36864
ds_read_b64_tr_b16 v[112:113], v241 offset:30720
v_mfma_f32_16x16x32_bf16 a[116:119], a[204:207], v[92:95], a[116:119]
buffer_load_dwordx4 v231, s[8:11], s32 offen offset:3072  lds
v_mfma_f32_16x16x32_bf16 a[112:115], a[204:207], v[88:91], a[112:115]
ds_read_b64_tr_b16 a[204:205], v227 offset:32768
ds_read_b64_tr_b16 a[206:207], v227 offset:36864
v_smfmac_f32_16x16x64_bf16 a[132:135], a[208:211], v[96:103], v245
ds_read_b64_tr_b16 v[114:115], v241 offset:30976
v_max_u32 v249, v249, v250
s_waitcnt lgkmcnt(8)
v_mfma_f32_16x16x32_bf16 v[8:11], a[144:147], v[152:155], v[136:139]
v_exp_f32 v40, v40
v_mfma_f32_16x16x32_bf16 v[8:11], a[148:151], v[156:159], v[8:11]
v_exp_f32 v41, v41
v_mfma_f32_16x16x32_bf16 v[8:11], a[152:155], v[160:163], v[8:11]
v_and_b32 v253, 0x20202020, v253
v_cvt_pk_bf16_f32 v88, v40, v41
v_mfma_f32_16x16x32_bf16 v[8:11], a[156:159], v[164:167], v[8:11]
v_exp_f32 v42, v42
v_mfma_f32_16x16x32_bf16 v[16:19], a[156:159], v[180:183], v[140:143]
s_add_u32 s39, s39, 16384
v_mov_b32 v250, v249
v_mfma_f32_16x16x32_bf16 v[16:19], a[152:155], v[176:179], v[16:19]
v_exp_f32 v43, v43
v_mfma_f32_16x16x32_bf16 v[16:19], a[148:151], v[172:175], v[16:19]
v_cvt_pk_bf16_f32 v89, v42, v43
v_permlane32_swap_b32 v249, v250
v_mfma_f32_16x16x32_bf16 v[16:19], a[144:147], v[168:171], v[16:19]
v_exp_f32 v44, v44
v_mfma_f32_16x16x32_bf16 v[24:27], a[144:147], v[184:187], v[144:147]
v_cmp_ne_u32 vcc, 0x20202020, v253
s_cbranch_vccnz SP_FL
SP_FL_RET:
v_mfma_f32_16x16x32_bf16 v[24:27], a[148:151], v[188:191], v[24:27]
v_exp_f32 v45, v45
v_mfma_f32_16x16x32_bf16 v[24:27], a[152:155], v[192:195], v[24:27]
v_cvt_pk_bf16_f32 v90, v44, v45
v_mov_b32 v246, s101
v_mfma_f32_16x16x32_bf16 v[24:27], a[156:159], v[196:199], v[24:27]
v_exp_f32 v46, v46
v_mfma_f32_16x16x32_bf16 v[32:35], a[156:159], v[212:215], v[148:151]
ds_read_b128 a[156:159], v219 offset:57344
s_bitset0_b32 s39, 19
v_mfma_f32_16x16x32_bf16 v[32:35], a[152:155], v[208:211], v[32:35]
v_max_u32 v249, v249, v250
v_exp_f32 v47, v47
v_mfma_f32_16x16x32_bf16 v[32:35], a[148:151], v[204:207], v[32:35]
ds_read_b128 a[152:155], v218 offset:57344
v_cvt_pk_bf16_f32 v91, v46, v47
v_mfma_f32_16x16x32_bf16 v[32:35], a[144:147], v[200:203], v[32:35]
v_exp_f32 v48, v48
v_mfma_f32_16x16x32_bf16 a[0:3], a[176:179], v[72:75], a[0:3]
ds_read_b128 a[148:151], v217 offset:57344
ds_read_b128 a[144:147], v216 offset:57344
v_mfma_f32_16x16x32_bf16 a[4:7], a[176:179], v[76:79], a[4:7]
v_add_u32 v251, v251, v249
v_exp_f32 v49, v49
v_mfma_f32_16x16x32_bf16 a[8:11], a[176:179], v[80:83], a[8:11]
v_cvt_pk_bf16_f32 v92, v48, v49
v_mov_b32 v247, s47
v_mfma_f32_16x16x32_bf16 a[12:15], a[176:179], v[84:87], a[12:15]
v_exp_f32 v50, v50
v_mfma_f32_16x16x32_bf16 a[28:31], a[180:183], v[84:87], a[28:31]
ds_read_b64_tr_b16 a[176:177], v220 offset:40960
ds_read_b64_tr_b16 a[178:179], v220 offset:45056
v_mfma_f32_16x16x32_bf16 a[24:27], a[180:183], v[80:83], a[24:27]
v_exp_f32 v51, v51
v_mfma_f32_16x16x32_bf16 a[20:23], a[180:183], v[76:79], a[20:23]
s_add_u32 m0, s30, 98304
v_cvt_pk_bf16_f32 v93, v50, v51
v_sub_u32 v248, v248, v249
v_mfma_f32_16x16x32_bf16 a[16:19], a[180:183], v[72:75], a[16:19]
v_exp_f32 v52, v52
v_mfma_f32_16x16x32_bf16 a[32:35], a[184:187], v[72:75], a[32:35]
ds_read_b64_tr_b16 a[180:181], v221 offset:40960
ds_read_b64_tr_b16 a[182:183], v221 offset:45056
v_mfma_f32_16x16x32_bf16 a[36:39], a[184:187], v[76:79], a[36:39]
v_exp_f32 v53, v53
v_mfma_f32_16x16x32_bf16 a[40:43], a[184:187], v[80:83], a[40:43]
v_cvt_pk_bf16_f32 v94, v52, v53
v_mov_b32 v253, 0
v_mfma_f32_16x16x32_bf16 a[44:47], a[184:187], v[84:87], a[44:47]
v_cndmask_b32 v252, v252, v251, s[90:91]
v_exp_f32 v54, v54
v_mfma_f32_16x16x32_bf16 a[60:63], a[188:191], v[84:87], a[60:63]
ds_read_b64_tr_b16 a[184:185], v222 offset:40960
ds_read_b64_tr_b16 a[186:187], v222 offset:45056
v_mfma_f32_16x16x32_bf16 a[56:59], a[188:191], v[80:83], a[56:59]
v_exp_f32 v55, v55
v_mfma_f32_16x16x32_bf16 a[52:55], a[188:191], v[76:79], a[52:55]
s_add_u32 s29, s2, s37
v_cvt_pk_bf16_f32 v95, v54, v55
v_mfma_f32_16x16x32_bf16 a[48:51], a[188:191], v[72:75], a[48:51]
v_readfirstlane_b32 s82, v251
v_exp_f32 v56, v56
v_smfmac_f32_16x16x64_bf16 a[128:131], a[208:211], v[72:79], v245
ds_read_b64_tr_b16 a[188:189], v223 offset:40960
v_mfma_f32_16x16x32_bf16 v[12:15], a[160:163], v[152:155], v[136:139]
v_exp_f32 v57, v57
v_mfma_f32_16x16x32_bf16 v[12:15], a[164:167], v[156:159], v[12:15]
v_exp_f32 v58, v58
v_mfma_f32_16x16x32_bf16 v[12:15], a[168:171], v[160:163], v[12:15]
ds_read_b64_tr_b16 a[190:191], v223 offset:45056
v_cvt_pk_bf16_f32 v96, v56, v57
v_mfma_f32_16x16x32_bf16 v[12:15], a[172:175], v[164:167], v[12:15]
s_lshl_b64 s[90:91], s[90:91], 1
v_exp_f32 v59, v59
v_mfma_f32_16x16x32_bf16 v[20:23], a[172:175], v[180:183], v[140:143]
v_cvt_pk_bf16_f32 v97, v58, v59
v_mfma_f32_16x16x32_bf16 v[20:23], a[168:171], v[176:179], v[20:23]
v_exp_f32 v60, v60
v_mfma_f32_16x16x32_bf16 v[20:23], a[164:167], v[172:175], v[20:23]
buffer_load_dwordx4 v232, s[12:15], s39 offen offset:0  lds
v_mfma_f32_16x16x32_bf16 v[20:23], a[160:163], v[168:171], v[20:23]
v_max_u32_dpp v250, v248, v248 row_ror:8 row_mask:0xf bank_mask:0xf
v_exp_f32 v61, v61
v_mfma_f32_16x16x32_bf16 v[28:31], a[160:163], v[184:187], v[144:147]
v_cvt_pk_bf16_f32 v98, v60, v61
v_mfma_f32_16x16x32_bf16 v[28:31], a[164:167], v[188:191], v[28:31]
v_exp_f32 v62, v62
v_mfma_f32_16x16x32_bf16 v[28:31], a[168:171], v[192:195], v[28:31]
buffer_load_dwordx4 v233, s[12:15], s39 offen offset:1024  lds
v_mfma_f32_16x16x32_bf16 v[28:31], a[172:175], v[196:199], v[28:31]
v_exp_f32 v63, v63
v_mfma_f32_16x16x32_bf16 v[36:39], a[172:175], v[212:215], v[148:151]
ds_read_b128 a[172:175], v219 offset:61440
v_cvt_pk_bf16_f32 v99, v62, v63
v_max_u32_dpp v249, v250, v250 row_ror:4 row_mask:0xf bank_mask:0xf
v_mfma_f32_16x16x32_bf16 v[36:39], a[168:171], v[208:211], v[36:39]
v_exp_f32 v64, v64
v_mfma_f32_16x16x32_bf16 v[36:39], a[164:167], v[204:207], v[36:39]
ds_read_b128 a[168:171], v218 offset:61440
ds_read_b128 a[164:167], v217 offset:61440
v_mfma_f32_16x16x32_bf16 v[36:39], a[160:163], v[200:203], v[36:39]
v_exp_f32 v65, v65
v_mfma_f32_16x16x32_bf16 a[64:67], a[192:195], v[72:75], a[64:67]
ds_read_b128 a[160:163], v216 offset:61440
v_cvt_pk_bf16_f32 v100, v64, v65
v_max_u32_dpp v250, v249, v249 row_ror:2 row_mask:0xf bank_mask:0xf
v_mfma_f32_16x16x32_bf16 a[68:71], a[192:195], v[76:79], a[68:71]
v_exp_f32 v66, v66
v_mfma_f32_16x16x32_bf16 a[72:75], a[192:195], v[80:83], a[72:75]
buffer_load_dwordx4 v232, s[12:15], s39 offen offset:2048  lds
v_mfma_f32_16x16x32_bf16 a[76:79], a[192:195], v[84:87], a[76:79]
v_exp_f32 v67, v67
s_waitcnt lgkmcnt(8)
v_mfma_f32_16x16x32_bf16 a[92:95], a[196:199], v[84:87], a[92:95]
ds_read_b64_tr_b16 a[192:193], v224 offset:40960
v_cvt_pk_bf16_f32 v101, v66, v67
v_mfma_f32_16x16x32_bf16 a[88:91], a[196:199], v[80:83], a[88:91]
v_max_u32_dpp v249, v250, v250 row_ror:1 row_mask:0xf bank_mask:0xf
v_exp_f32 v68, v68
v_mfma_f32_16x16x32_bf16 a[84:87], a[196:199], v[76:79], a[84:87]
ds_read_b64_tr_b16 a[194:195], v224 offset:45056
s_cmp_eq_u32 s29, 0
s_cselect_b32 s29, 0x24c000, -16
v_mfma_f32_16x16x32_bf16 a[80:83], a[196:199], v[72:75], a[80:83]
v_exp_f32 v69, v69
v_mfma_f32_16x16x32_bf16 a[96:99], a[200:203], v[72:75], a[96:99]
ds_read_b64_tr_b16 a[196:197], v225 offset:40960
v_cvt_pk_bf16_f32 v102, v68, v69
v_mfma_f32_16x16x32_bf16 a[100:103], a[200:203], v[76:79], a[100:103]
v_mov_b32 v250, v249
v_exp_f32 v70, v70
v_mfma_f32_16x16x32_bf16 a[104:107], a[200:203], v[80:83], a[104:107]
ds_read_b64_tr_b16 a[198:199], v225 offset:45056
buffer_store_dwordx2 v[246:247], v253, s[20:23], s29 offen
v_mfma_f32_16x16x32_bf16 a[108:111], a[200:203], v[84:87], a[108:111]
v_exp_f32 v71, v71
v_mfma_f32_16x16x32_bf16 a[124:127], a[204:207], v[84:87], a[124:127]
ds_read_b64_tr_b16 a[200:201], v226 offset:40960
v_cvt_pk_bf16_f32 v103, v70, v71
v_mfma_f32_16x16x32_bf16 a[120:123], a[204:207], v[80:83], a[120:123]
ds_read_b64_tr_b16 a[202:203], v226 offset:45056
v_permlane16_swap_b32 v249, v250
v_mfma_f32_16x16x32_bf16 a[116:119], a[204:207], v[76:79], a[116:119]
STUB_7:
s_cbranch_execz HOP_RET1
buffer_load_dwordx4 v233, s[12:15], s39 offen offset:3072  lds
v_mfma_f32_16x16x32_bf16 a[112:115], a[204:207], v[72:75], a[112:115]
ds_read_b64_tr_b16 a[204:205], v227 offset:40960
ds_read_b64_tr_b16 a[206:207], v227 offset:45056
v_smfmac_f32_16x16x64_bf16 a[132:135], a[208:211], v[80:87], v245
v_max_u32 v249, v249, v250
v_mfma_f32_16x16x32_bf16 v[40:43], a[144:147], v[152:155], v[136:139]
v_exp_f32 v8, v8
v_mfma_f32_16x16x32_bf16 v[40:43], a[148:151], v[156:159], v[40:43]
v_exp_f32 v9, v9
v_mfma_f32_16x16x32_bf16 v[40:43], a[152:155], v[160:163], v[40:43]
v_cvt_pk_bf16_f32 v72, v8, v9
v_mov_b32 v250, v249
v_mfma_f32_16x16x32_bf16 v[40:43], a[156:159], v[164:167], v[40:43]
v_exp_f32 v10, v10
v_mfma_f32_16x16x32_bf16 v[48:51], a[156:159], v[180:183], v[140:143]
v_permlane32_swap_b32 v249, v250
v_max_u32 v249, v249, v250
v_mfma_f32_16x16x32_bf16 v[48:51], a[152:155], v[176:179], v[48:51]
v_exp_f32 v11, v11
v_mfma_f32_16x16x32_bf16 v[48:51], a[148:151], v[172:175], v[48:51]
v_cvt_pk_bf16_f32 v73, v10, v11
v_add_u32 v251, v251, v249
v_mfma_f32_16x16x32_bf16 v[48:51], a[144:147], v[168:171], v[48:51]
v_exp_f32 v12, v12
v_mfma_f32_16x16x32_bf16 v[56:59], a[144:147], v[184:187], v[144:147]
v_cndmask_b32 v252, v252, v251, s[90:91]
v_mfma_f32_16x16x32_bf16 v[56:59], a[148:151], v[188:191], v[56:59]
v_exp_f32 v13, v13
v_mfma_f32_16x16x32_bf16 v[56:59], a[152:155], v[192:195], v[56:59]
v_cvt_pk_bf16_f32 v74, v12, v13
v_readfirstlane_b32 s83, v251
v_mfma_f32_16x16x32_bf16 v[56:59], a[156:159], v[196:199], v[56:59]
v_exp_f32 v14, v14
v_mfma_f32_16x16x32_bf16 v[64:67], a[156:159], v[212:215], v[148:151]
s_waitcnt vmcnt(9) lgkmcnt(0)
s_barrier
v_mfma_f32_16x16x32_bf16 v[64:67], a[152:155], v[208:211], v[64:67]
v_exp_f32 v15, v15
v_mfma_f32_16x16x32_bf16 v[64:67], a[148:151], v[204:207], v[64:67]
ds_read_b128 a[156:159], v219 offset:0
v_cvt_pk_bf16_f32 v75, v14, v15
v_mfma_f32_16x16x32_bf16 v[64:67], a[144:147], v[200:203], v[64:67]
v_exp_f32 v16, v16
v_mfma_f32_16x16x32_bf16 a[0:3], a[176:179], v[88:91], a[0:3]
ds_read_b128 a[152:155], v218 offset:0
ds_read_b128 a[148:151], v217 offset:0
v_mfma_f32_16x16x32_bf16 a[4:7], a[176:179], v[92:95], a[4:7]
v_exp_f32 v17, v17
v_mfma_f32_16x16x32_bf16 a[8:11], a[176:179], v[96:99], a[8:11]
ds_read_b128 a[144:147], v216 offset:0
v_cvt_pk_bf16_f32 v76, v16, v17
v_mfma_f32_16x16x32_bf16 a[12:15], a[176:179], v[100:103], a[12:15]
v_exp_f32 v18, v18
v_mfma_f32_16x16x32_bf16 a[28:31], a[180:183], v[100:103], a[28:31]
ds_read_b64_tr_b16 a[176:177], v220 offset:49152
ds_read_b64_tr_b16 a[178:179], v220 offset:53248
v_mfma_f32_16x16x32_bf16 a[24:27], a[180:183], v[96:99], a[24:27]
v_exp_f32 v19, v19
v_mfma_f32_16x16x32_bf16 a[20:23], a[180:183], v[92:95], a[20:23]
s_add_u32 s32, s32, 16384
v_cvt_pk_bf16_f32 v77, v18, v19
v_mfma_f32_16x16x32_bf16 a[16:19], a[180:183], v[88:91], a[16:19]
v_exp_f32 v20, v20
v_mfma_f32_16x16x32_bf16 a[32:35], a[184:187], v[88:91], a[32:35]
ds_read_b64_tr_b16 a[180:181], v221 offset:49152
ds_read_b64_tr_b16 a[182:183], v221 offset:53248
v_mfma_f32_16x16x32_bf16 a[36:39], a[184:187], v[92:95], a[36:39]
v_exp_f32 v21, v21
v_mfma_f32_16x16x32_bf16 a[40:43], a[184:187], v[96:99], a[40:43]
s_bitset0_b32 s32, 19
v_cvt_pk_bf16_f32 v78, v20, v21
v_mfma_f32_16x16x32_bf16 a[44:47], a[184:187], v[100:103], a[44:47]
v_exp_f32 v22, v22
v_mfma_f32_16x16x32_bf16 a[60:63], a[188:191], v[100:103], a[60:63]
ds_read_b64_tr_b16 a[184:185], v222 offset:49152
ds_read_b64_tr_b16 a[186:187], v222 offset:53248
v_mfma_f32_16x16x32_bf16 a[56:59], a[188:191], v[96:99], a[56:59]
v_exp_f32 v23, v23
v_mfma_f32_16x16x32_bf16 a[52:55], a[188:191], v[92:95], a[52:55]
s_add_u32 m0, s30, 114688
v_cvt_pk_bf16_f32 v79, v22, v23
v_mfma_f32_16x16x32_bf16 a[48:51], a[188:191], v[88:91], a[48:51]
v_exp_f32 v24, v24
v_smfmac_f32_16x16x64_bf16 a[128:131], a[208:211], v[88:95], v245
ds_read_b64_tr_b16 a[188:189], v223 offset:49152
v_mfma_f32_16x16x32_bf16 v[44:47], a[160:163], v[152:155], v[136:139]
v_mov_b32 v236, v252
v_exp_f32 v25, v25
v_mfma_f32_16x16x32_bf16 v[44:47], a[164:167], v[156:159], v[44:47]
v_exp_f32 v26, v26
v_mfma_f32_16x16x32_bf16 v[44:47], a[168:171], v[160:163], v[44:47]
ds_read_b64_tr_b16 a[190:191], v223 offset:53248
v_cvt_pk_bf16_f32 v80, v24, v25
v_mfma_f32_16x16x32_bf16 v[44:47], a[172:175], v[164:167], v[44:47]
v_exp_f32 v27, v27
v_mfma_f32_16x16x32_bf16 v[52:55], a[172:175], v[180:183], v[140:143]
v_cvt_pk_bf16_f32 v81, v26, v27
v_and_b32 v252, 0xffff, v252
v_mfma_f32_16x16x32_bf16 v[52:55], a[168:171], v[176:179], v[52:55]
v_exp_f32 v28, v28
v_mfma_f32_16x16x32_bf16 v[52:55], a[164:167], v[172:175], v[52:55]
buffer_load_dwordx4 v228, s[8:11], s32 offen offset:0  lds
v_mfma_f32_16x16x32_bf16 v[52:55], a[160:163], v[168:171], v[52:55]
v_exp_f32 v29, v29
v_mfma_f32_16x16x32_bf16 v[60:63], a[160:163], v[184:187], v[144:147]
v_cvt_pk_bf16_f32 v82, v28, v29
v_sub_u32 v252, 0xffff, v252
v_mfma_f32_16x16x32_bf16 v[60:63], a[164:167], v[188:191], v[60:63]
v_exp_f32 v30, v30
v_mfma_f32_16x16x32_bf16 v[60:63], a[168:171], v[192:195], v[60:63]
buffer_load_dwordx4 v229, s[8:11], s32 offen offset:1024  lds
v_mfma_f32_16x16x32_bf16 v[60:63], a[172:175], v[196:199], v[60:63]
v_exp_f32 v31, v31
v_mfma_f32_16x16x32_bf16 v[68:71], a[172:175], v[212:215], v[148:151]
ds_read_b128 a[172:175], v219 offset:4096
v_cvt_pk_bf16_f32 v83, v30, v31
v_mfma_f32_16x16x32_bf16 v[68:71], a[168:171], v[208:211], v[68:71]
v_exp_f32 v32, v32
v_mfma_f32_16x16x32_bf16 v[68:71], a[164:167], v[204:207], v[68:71]
ds_read_b128 a[168:171], v218 offset:4096
ds_read_b128 a[164:167], v217 offset:4096
v_mul_u32_u24 v252, 0x480, v252
v_mfma_f32_16x16x32_bf16 v[68:71], a[160:163], v[200:203], v[68:71]
v_exp_f32 v33, v33
v_mfma_f32_16x16x32_bf16 a[64:67], a[192:195], v[88:91], a[64:67]
ds_read_b128 a[160:163], v216 offset:4096
v_cvt_pk_bf16_f32 v84, v32, v33
v_mfma_f32_16x16x32_bf16 a[68:71], a[192:195], v[92:95], a[68:71]
v_exp_f32 v34, v34
v_mfma_f32_16x16x32_bf16 a[72:75], a[192:195], v[96:99], a[72:75]
buffer_load_dwordx4 v230, s[8:11], s32 offen offset:2048  lds
v_lshrrev_b32 v249, 3, v0
v_mfma_f32_16x16x32_bf16 a[76:79], a[192:195], v[100:103], a[76:79]
v_exp_f32 v35, v35
v_mfma_f32_16x16x32_bf16 a[92:95], a[196:199], v[100:103], a[92:95]
ds_read_b64_tr_b16 a[192:193], v224 offset:49152
v_cvt_pk_bf16_f32 v85, v34, v35
v_mfma_f32_16x16x32_bf16 a[88:91], a[196:199], v[96:99], a[88:91]
v_exp_f32 v36, v36
v_mfma_f32_16x16x32_bf16 a[84:87], a[196:199], v[92:95], a[84:87]
ds_read_b64_tr_b16 a[194:195], v224 offset:53248
v_lshl_add_u32 v252, v249, 4, v252
v_mfma_f32_16x16x32_bf16 a[80:83], a[196:199], v[88:91], a[80:83]
v_exp_f32 v37, v37
v_mfma_f32_16x16x32_bf16 a[96:99], a[200:203], v[88:91], a[96:99]
ds_read_b64_tr_b16 a[196:197], v225 offset:49152
v_cvt_pk_bf16_f32 v86, v36, v37
v_mfma_f32_16x16x32_bf16 a[100:103], a[200:203], v[92:95], a[100:103]
v_exp_f32 v38, v38
v_mfma_f32_16x16x32_bf16 a[104:107], a[200:203], v[96:99], a[104:107]
ds_read_b64_tr_b16 a[198:199], v225 offset:53248
v_mfma_f32_16x16x32_bf16 a[108:111], a[200:203], v[100:103], a[108:111]
v_exp_f32 v39, v39
v_mfma_f32_16x16x32_bf16 a[124:127], a[204:207], v[100:103], a[124:127]
ds_read_b64_tr_b16 a[200:201], v226 offset:49152
v_cvt_pk_bf16_f32 v87, v38, v39
v_mfma_f32_16x16x32_bf16 a[120:123], a[204:207], v[96:99], a[120:123]
ds_read_b64_tr_b16 a[202:203], v226 offset:53248
v_mfma_f32_16x16x32_bf16 a[116:119], a[204:207], v[92:95], a[116:119]
buffer_load_dwordx4 v231, s[8:11], s32 offen offset:3072  lds
v_mfma_f32_16x16x32_bf16 a[112:115], a[204:207], v[88:91], a[112:115]
ds_read_b64_tr_b16 a[204:205], v227 offset:49152
ds_read_b64_tr_b16 a[206:207], v227 offset:53248
v_smfmac_f32_16x16x64_bf16 a[132:135], a[208:211], v[96:103], v245
s_add_u32 m0, s86, 0
s_add_u32 s50, s84, 4718592
buffer_load_dwordx4 v240, s[64:67], s50 offen lds
s_add_u32 m0, s86, 4096
s_add_u32 s50, s84, 4718592
buffer_load_dwordx4 v240, s[68:71], s50 offen lds
s_add_u32 m0, s86, 8192
s_add_u32 s50, s85, 0
buffer_load_dwordx4 v244, s[72:75], s50 offen lds
s_add_u32 m0, s86, 12288
s_add_u32 s50, s85, 4096
buffer_load_dwordx4 v244, s[72:75], s50 offen lds
s_waitcnt lgkmcnt(8)
v_mfma_f32_16x16x32_bf16 v[8:11], a[144:147], v[152:155], v[136:139]
v_exp_f32 v40, v40
v_mfma_f32_16x16x32_bf16 v[8:11], a[148:151], v[156:159], v[8:11]
v_ashrrev_i32 v246, 31, v236
v_exp_f32 v41, v41
v_mfma_f32_16x16x32_bf16 v[8:11], a[152:155], v[160:163], v[8:11]
v_cvt_pk_bf16_f32 v88, v40, v41
v_not_b32 v246, v246
v_mfma_f32_16x16x32_bf16 v[8:11], a[156:159], v[164:167], v[8:11]
v_exp_f32 v42, v42
v_mfma_f32_16x16x32_bf16 v[16:19], a[156:159], v[180:183], v[140:143]
s_add_u32 s39, s39, 16384
v_or_b32 v246, 0x80000000, v246
v_mfma_f32_16x16x32_bf16 v[16:19], a[152:155], v[176:179], v[16:19]
v_exp_f32 v43, v43
v_mfma_f32_16x16x32_bf16 v[16:19], a[148:151], v[172:175], v[16:19]
v_cvt_pk_bf16_f32 v89, v42, v43
v_xor_b32 v236, v236, v246
v_mfma_f32_16x16x32_bf16 v[16:19], a[144:147], v[168:171], v[16:19]
v_exp_f32 v44, v44
v_mfma_f32_16x16x32_bf16 v[24:27], a[144:147], v[184:187], v[144:147]
s_bitset0_b32 s39, 19
v_and_b32 v236, 0xffff0000, v236
v_mfma_f32_16x16x32_bf16 v[24:27], a[148:151], v[188:191], v[24:27]
v_exp_f32 v45, v45
v_mfma_f32_16x16x32_bf16 v[24:27], a[152:155], v[192:195], v[24:27]
v_cvt_pk_bf16_f32 v90, v44, v45
v_mul_f32 v236, 0xbfb8aa3b, v236
v_mfma_f32_16x16x32_bf16 v[24:27], a[156:159], v[196:199], v[24:27]
v_exp_f32 v46, v46
v_mfma_f32_16x16x32_bf16 v[32:35], a[156:159], v[212:215], v[148:151]
ds_read_b128 a[156:159], v219 offset:8192
v_mfma_f32_16x16x32_bf16 v[32:35], a[152:155], v[208:211], v[32:35]
v_exp_f32 v47, v47
v_mfma_f32_16x16x32_bf16 v[32:35], a[148:151], v[204:207], v[32:35]
ds_read_b128 a[152:155], v218 offset:8192
v_cvt_pk_bf16_f32 v91, v46, v47
v_mfma_f32_16x16x32_bf16 v[32:35], a[144:147], v[200:203], v[32:35]
v_exp_f32 v48, v48
v_mfma_f32_16x16x32_bf16 a[0:3], a[176:179], v[72:75], a[0:3]
ds_read_b128 a[148:151], v217 offset:8192
ds_read_b128 a[144:147], v216 offset:8192
v_mfma_f32_16x16x32_bf16 a[4:7], a[176:179], v[76:79], a[4:7]
v_exp_f32 v49, v49
v_mfma_f32_16x16x32_bf16 a[8:11], a[176:179], v[80:83], a[8:11]
s_add_u32 m0, s30, 131072
v_cvt_pk_bf16_f32 v92, v48, v49
v_mfma_f32_16x16x32_bf16 a[12:15], a[176:179], v[84:87], a[12:15]
v_exp_f32 v50, v50
v_mfma_f32_16x16x32_bf16 a[28:31], a[180:183], v[84:87], a[28:31]
ds_read_b64_tr_b16 a[176:177], v220 offset:57344
ds_read_b64_tr_b16 a[178:179], v220 offset:61440
v_mfma_f32_16x16x32_bf16 a[24:27], a[180:183], v[80:83], a[24:27]
v_exp_f32 v51, v51
v_mfma_f32_16x16x32_bf16 a[20:23], a[180:183], v[76:79], a[20:23]
v_cvt_pk_bf16_f32 v93, v50, v51
v_mfma_f32_16x16x32_bf16 a[16:19], a[180:183], v[72:75], a[16:19]
v_exp_f32 v52, v52
v_mfma_f32_16x16x32_bf16 a[32:35], a[184:187], v[72:75], a[32:35]
ds_read_b64_tr_b16 a[180:181], v221 offset:57344
ds_read_b64_tr_b16 a[182:183], v221 offset:61440
v_mfma_f32_16x16x32_bf16 a[36:39], a[184:187], v[76:79], a[36:39]
v_exp_f32 v53, v53
v_mfma_f32_16x16x32_bf16 a[40:43], a[184:187], v[80:83], a[40:43]
v_cvt_pk_bf16_f32 v94, v52, v53
v_mfma_f32_16x16x32_bf16 a[44:47], a[184:187], v[84:87], a[44:47]
v_exp_f32 v54, v54
v_mfma_f32_16x16x32_bf16 a[60:63], a[188:191], v[84:87], a[60:63]
ds_read_b64_tr_b16 a[184:185], v222 offset:57344
ds_read_b64_tr_b16 a[186:187], v222 offset:61440
v_mfma_f32_16x16x32_bf16 a[56:59], a[188:191], v[80:83], a[56:59]
v_exp_f32 v55, v55
v_mfma_f32_16x16x32_bf16 a[52:55], a[188:191], v[76:79], a[52:55]
v_cvt_pk_bf16_f32 v95, v54, v55
v_exp_f32 v236, v236
v_mfma_f32_16x16x32_bf16 a[48:51], a[188:191], v[72:75], a[48:51]
v_exp_f32 v56, v56
v_smfmac_f32_16x16x64_bf16 a[128:131], a[208:211], v[72:79], v245
ds_read_b64_tr_b16 a[188:189], v223 offset:57344
v_mfma_f32_16x16x32_bf16 v[12:15], a[160:163], v[152:155], v[136:139]
v_exp_f32 v57, v57
v_mfma_f32_16x16x32_bf16 v[12:15], a[164:167], v[156:159], v[12:15]
v_exp_f32 v58, v58
v_mfma_f32_16x16x32_bf16 v[12:15], a[168:171], v[160:163], v[12:15]
ds_read_b64_tr_b16 a[190:191], v223 offset:61440
v_cvt_pk_bf16_f32 v96, v56, v57
v_mfma_f32_16x16x32_bf16 v[12:15], a[172:175], v[164:167], v[12:15]
v_exp_f32 v59, v59
v_mfma_f32_16x16x32_bf16 v[20:23], a[172:175], v[180:183], v[140:143]
v_cvt_pk_bf16_f32 v97, v58, v59
v_add_f32 v236, 1.0, v236
v_mfma_f32_16x16x32_bf16 v[20:23], a[168:171], v[176:179], v[20:23]
v_exp_f32 v60, v60
v_mfma_f32_16x16x32_bf16 v[20:23], a[164:167], v[172:175], v[20:23]
buffer_load_dwordx4 v232, s[12:15], s39 offen offset:0  lds
v_mfma_f32_16x16x32_bf16 v[20:23], a[160:163], v[168:171], v[20:23]
v_exp_f32 v61, v61
v_mfma_f32_16x16x32_bf16 v[28:31], a[160:163], v[184:187], v[144:147]
v_cvt_pk_bf16_f32 v98, v60, v61
v_mfma_f32_16x16x32_bf16 v[28:31], a[164:167], v[188:191], v[28:31]
v_exp_f32 v62, v62
v_mfma_f32_16x16x32_bf16 v[28:31], a[168:171], v[192:195], v[28:31]
buffer_load_dwordx4 v233, s[12:15], s39 offen offset:1024  lds
v_mfma_f32_16x16x32_bf16 v[28:31], a[172:175], v[196:199], v[28:31]
v_exp_f32 v63, v63
v_mfma_f32_16x16x32_bf16 v[36:39], a[172:175], v[212:215], v[148:151]
ds_read_b128 a[172:175], v219 offset:12288
v_cvt_pk_bf16_f32 v99, v62, v63
v_mfma_f32_16x16x32_bf16 v[36:39], a[168:171], v[208:211], v[36:39]
v_exp_f32 v64, v64
v_mfma_f32_16x16x32_bf16 v[36:39], a[164:167], v[204:207], v[36:39]
ds_read_b128 a[168:171], v218 offset:12288
ds_read_b128 a[164:167], v217 offset:12288
v_mfma_f32_16x16x32_bf16 v[36:39], a[160:163], v[200:203], v[36:39]
v_exp_f32 v65, v65
s_waitcnt lgkmcnt(8)
v_mfma_f32_16x16x32_bf16 a[64:67], a[192:195], v[72:75], a[64:67]
ds_read_b128 a[160:163], v216 offset:12288
v_cvt_pk_bf16_f32 v100, v64, v65
v_mfma_f32_16x16x32_bf16 a[68:71], a[192:195], v[76:79], a[68:71]
v_exp_f32 v66, v66
v_mfma_f32_16x16x32_bf16 a[72:75], a[192:195], v[80:83], a[72:75]
buffer_load_dwordx4 v232, s[12:15], s39 offen offset:2048  lds
v_mfma_f32_16x16x32_bf16 a[76:79], a[192:195], v[84:87], a[76:79]
v_exp_f32 v67, v67
v_mfma_f32_16x16x32_bf16 a[92:95], a[196:199], v[84:87], a[92:95]
ds_read_b64_tr_b16 a[192:193], v224 offset:57344
v_cvt_pk_bf16_f32 v101, v66, v67
v_mfma_f32_16x16x32_bf16 a[88:91], a[196:199], v[80:83], a[88:91]
v_exp_f32 v68, v68
v_mfma_f32_16x16x32_bf16 a[84:87], a[196:199], v[76:79], a[84:87]
ds_read_b64_tr_b16 a[194:195], v224 offset:61440
v_rcp_f32 v236, v236
v_mfma_f32_16x16x32_bf16 a[80:83], a[196:199], v[72:75], a[80:83]
v_cvt_pk_bf16_f32 v236, v236, v236
v_exp_f32 v69, v69
v_mfma_f32_16x16x32_bf16 a[96:99], a[200:203], v[72:75], a[96:99]
ds_read_b64_tr_b16 a[196:197], v225 offset:57344
v_cvt_pk_bf16_f32 v102, v68, v69
v_lshlrev_b32 v236, 16, v236
v_mfma_f32_16x16x32_bf16 a[100:103], a[200:203], v[76:79], a[100:103]
v_exp_f32 v70, v70
v_mfma_f32_16x16x32_bf16 a[104:107], a[200:203], v[80:83], a[104:107]
ds_read_b64_tr_b16 a[198:199], v225 offset:61440
v_mfma_f32_16x16x32_bf16 a[108:111], a[200:203], v[84:87], a[108:111]
v_exp_f32 v71, v71
v_mfma_f32_16x16x32_bf16 a[124:127], a[204:207], v[84:87], a[124:127]
ds_read_b64_tr_b16 a[200:201], v226 offset:57344
v_cvt_pk_bf16_f32 v103, v70, v71
v_mfma_f32_16x16x32_bf16 a[120:123], a[204:207], v[80:83], a[120:123]
ds_read_b64_tr_b16 a[202:203], v226 offset:61440
v_mfma_f32_16x16x32_bf16 a[116:119], a[204:207], v[76:79], a[116:119]
buffer_load_dwordx4 v233, s[12:15], s39 offen offset:3072  lds
v_mfma_f32_16x16x32_bf16 a[112:115], a[204:207], v[72:75], a[112:115]
ds_read_b64_tr_b16 a[204:205], v227 offset:57344
ds_read_b64_tr_b16 a[206:207], v227 offset:61440
v_smfmac_f32_16x16x64_bf16 a[132:135], a[208:211], v[80:87], v245
s_add_u32 m0, s86, 45056
s_mov_b32 s50, 29360128
buffer_load_dwordx4 v252, s[20:23], s50 offen sc0 sc1 lds
s_add_u32 m0, s86, 49152
s_mov_b32 s50, 29360640
buffer_load_dwordx4 v252, s[20:23], s50 offen sc0 sc1 lds
s_add_u32 m0, s86, 53248
s_mov_b32 s50, 29361152
buffer_load_dwordx4 v252, s[20:23], s50 offen sc0 sc1 lds
s_add_u32 m0, s86, 16384
s_add_u32 s50, s85, 8192
buffer_load_dwordx4 v244, s[72:75], s50 offen lds
s_mov_b32 s33, 7
s_cmp_lt_u32 s86, 0x10000
s_cbranch_scc0 K_LOOPIN
v_mfma_f32_16x16x32_bf16 v[40:43], a[144:147], v[152:155], v[136:139]
v_exp_f32 v8, v8
v_mfma_f32_16x16x32_bf16 v[40:43], a[148:151], v[156:159], v[40:43]
v_exp_f32 v9, v9
v_mfma_f32_16x16x32_bf16 v[40:43], a[152:155], v[160:163], v[40:43]
s_lshr_b32 s28, s37, 1
v_cvt_pk_bf16_f32 v72, v8, v9
v_mfma_f32_16x16x32_bf16 v[40:43], a[156:159], v[164:167], v[40:43]
v_exp_f32 v10, v10
v_mfma_f32_16x16x32_bf16 v[48:51], a[156:159], v[180:183], v[140:143]
s_mul_i32 s28, s28, 28672
v_mfma_f32_16x16x32_bf16 v[48:51], a[152:155], v[176:179], v[48:51]
v_exp_f32 v11, v11
v_mfma_f32_16x16x32_bf16 v[48:51], a[148:151], v[172:175], v[48:51]
v_cvt_pk_bf16_f32 v73, v10, v11
v_subrev_u32 v241, s28, v241
v_mfma_f32_16x16x32_bf16 v[48:51], a[144:147], v[168:171], v[48:51]
v_exp_f32 v12, v12
v_mfma_f32_16x16x32_bf16 v[56:59], a[144:147], v[184:187], v[144:147]
v_and_b32 v239, 7, v1
v_lshl_add_u32 v239, v4, 3, v239
v_mfma_f32_16x16x32_bf16 v[56:59], a[148:151], v[188:191], v[56:59]
v_exp_f32 v13, v13
v_mfma_f32_16x16x32_bf16 v[56:59], a[152:155], v[192:195], v[56:59]
v_cvt_pk_bf16_f32 v74, v12, v13
v_lshlrev_b32 v239, 4, v239
v_mfma_f32_16x16x32_bf16 v[56:59], a[156:159], v[196:199], v[56:59]
v_exp_f32 v14, v14
v_mfma_f32_16x16x32_bf16 v[64:67], a[156:159], v[212:215], v[148:151]
s_waitcnt vmcnt(16) lgkmcnt(0)
s_barrier
v_mfma_f32_16x16x32_bf16 v[64:67], a[152:155], v[208:211], v[64:67]
v_exp_f32 v15, v15
v_mfma_f32_16x16x32_bf16 v[64:67], a[148:151], v[204:207], v[64:67]
ds_read_b128 a[156:159], v219 offset:16384
v_cvt_pk_bf16_f32 v75, v14, v15
v_mfma_f32_16x16x32_bf16 v[64:67], a[144:147], v[200:203], v[64:67]
v_exp_f32 v16, v16
v_mfma_f32_16x16x32_bf16 a[0:3], a[176:179], v[88:91], a[0:3]
ds_read_b128 a[152:155], v218 offset:16384
ds_read_b128 a[148:151], v217 offset:16384
v_mfma_f32_16x16x32_bf16 a[4:7], a[176:179], v[92:95], a[4:7]
v_exp_f32 v17, v17
v_mfma_f32_16x16x32_bf16 a[8:11], a[176:179], v[96:99], a[8:11]
ds_read_b128 a[144:147], v216 offset:16384
v_cvt_pk_bf16_f32 v76, v16, v17
v_mfma_f32_16x16x32_bf16 a[12:15], a[176:179], v[100:103], a[12:15]
v_exp_f32 v18, v18
v_mfma_f32_16x16x32_bf16 a[28:31], a[180:183], v[100:103], a[28:31]
ds_read_b64_tr_b16 a[176:177], v220 offset:0
ds_read_b64_tr_b16 a[178:179], v220 offset:4096
v_mfma_f32_16x16x32_bf16 a[24:27], a[180:183], v[96:99], a[24:27]
v_exp_f32 v19, v19
v_mfma_f32_16x16x32_bf16 a[20:23], a[180:183], v[92:95], a[20:23]
s_add_u32 s32, s32, 16384
v_cvt_pk_bf16_f32 v77, v18, v19
v_mfma_f32_16x16x32_bf16 a[16:19], a[180:183], v[88:91], a[16:19]
v_exp_f32 v20, v20
v_mfma_f32_16x16x32_bf16 a[32:35], a[184:187], v[88:91], a[32:35]
ds_read_b64_tr_b16 a[180:181], v221 offset:0
ds_read_b64_tr_b16 a[182:183], v221 offset:4096
v_mfma_f32_16x16x32_bf16 a[36:39], a[184:187], v[92:95], a[36:39]
v_exp_f32 v21, v21
v_mfma_f32_16x16x32_bf16 a[40:43], a[184:187], v[96:99], a[40:43]
s_bitset0_b32 s32, 19
v_cvt_pk_bf16_f32 v78, v20, v21
v_mfma_f32_16x16x32_bf16 a[44:47], a[184:187], v[100:103], a[44:47]
v_exp_f32 v22, v22
v_mfma_f32_16x16x32_bf16 a[60:63], a[188:191], v[100:103], a[60:63]
ds_read_b64_tr_b16 a[184:185], v222 offset:0
ds_read_b64_tr_b16 a[186:187], v222 offset:4096
v_mfma_f32_16x16x32_bf16 a[56:59], a[188:191], v[96:99], a[56:59]
v_exp_f32 v23, v23
v_mfma_f32_16x16x32_bf16 a[52:55], a[188:191], v[92:95], a[52:55]
s_add_u32 m0, s30, 65536
v_cvt_pk_bf16_f32 v79, v22, v23
v_mfma_f32_16x16x32_bf16 a[48:51], a[188:191], v[88:91], a[48:51]
v_exp_f32 v24, v24
v_smfmac_f32_16x16x64_bf16 a[128:131], a[208:211], v[88:95], v245
ds_read_b64_tr_b16 a[188:189], v223 offset:0
v_mfma_f32_16x16x32_bf16 v[44:47], a[160:163], v[152:155], v[136:139]
v_exp_f32 v25, v25
v_mfma_f32_16x16x32_bf16 v[44:47], a[164:167], v[156:159], v[44:47]
v_exp_f32 v26, v26
v_mfma_f32_16x16x32_bf16 v[44:47], a[168:171], v[160:163], v[44:47]
ds_read_b64_tr_b16 a[190:191], v223 offset:4096
v_cvt_pk_bf16_f32 v80, v24, v25
v_mfma_f32_16x16x32_bf16 v[44:47], a[172:175], v[164:167], v[44:47]
v_exp_f32 v27, v27
v_mfma_f32_16x16x32_bf16 v[52:55], a[172:175], v[180:183], v[140:143]
v_cvt_pk_bf16_f32 v81, v26, v27
v_add_u32 v237, s31, v244
v_mfma_f32_16x16x32_bf16 v[52:55], a[168:171], v[176:179], v[52:55]
v_exp_f32 v28, v28
v_mfma_f32_16x16x32_bf16 v[52:55], a[164:167], v[172:175], v[52:55]
buffer_load_dwordx4 v228, s[8:11], s32 offen offset:0  lds
v_mfma_f32_16x16x32_bf16 v[52:55], a[160:163], v[168:171], v[52:55]
v_exp_f32 v29, v29
v_mfma_f32_16x16x32_bf16 v[60:63], a[160:163], v[184:187], v[144:147]
v_cvt_pk_bf16_f32 v82, v28, v29
v_lshl_add_u32 v238, v4, 3, v3
v_mfma_f32_16x16x32_bf16 v[60:63], a[164:167], v[188:191], v[60:63]
v_exp_f32 v30, v30
v_mfma_f32_16x16x32_bf16 v[60:63], a[168:171], v[192:195], v[60:63]
buffer_load_dwordx4 v229, s[8:11], s32 offen offset:1024  lds
v_mfma_f32_16x16x32_bf16 v[60:63], a[172:175], v[196:199], v[60:63]
v_exp_f32 v31, v31
v_mfma_f32_16x16x32_bf16 v[68:71], a[172:175], v[212:215], v[148:151]
ds_read_b128 a[172:175], v219 offset:20480
v_cvt_pk_bf16_f32 v83, v30, v31
v_mfma_f32_16x16x32_bf16 v[68:71], a[168:171], v[208:211], v[68:71]
v_exp_f32 v32, v32
v_mfma_f32_16x16x32_bf16 v[68:71], a[164:167], v[204:207], v[68:71]
ds_read_b128 a[168:171], v218 offset:20480
ds_read_b128 a[164:167], v217 offset:20480
v_mfma_f32_16x16x32_bf16 v[68:71], a[160:163], v[200:203], v[68:71]
v_exp_f32 v33, v33
v_mfma_f32_16x16x32_bf16 a[64:67], a[192:195], v[88:91], a[64:67]
ds_read_b128 a[160:163], v216 offset:20480
v_cvt_pk_bf16_f32 v84, v32, v33
v_mfma_f32_16x16x32_bf16 a[68:71], a[192:195], v[92:95], a[68:71]
v_exp_f32 v34, v34
v_mfma_f32_16x16x32_bf16 a[72:75], a[192:195], v[96:99], a[72:75]
buffer_load_dwordx4 v230, s[8:11], s32 offen offset:2048  lds
v_mfma_f32_16x16x32_bf16 a[76:79], a[192:195], v[100:103], a[76:79]
v_exp_f32 v35, v35
v_mfma_f32_16x16x32_bf16 a[92:95], a[196:199], v[100:103], a[92:95]
ds_read_b64_tr_b16 a[192:193], v224 offset:0
v_cvt_pk_bf16_f32 v85, v34, v35
v_mfma_f32_16x16x32_bf16 a[88:91], a[196:199], v[96:99], a[88:91]
v_exp_f32 v36, v36
v_mfma_f32_16x16x32_bf16 a[84:87], a[196:199], v[92:95], a[84:87]
ds_read_b64_tr_b16 a[194:195], v224 offset:4096
v_lshlrev_b32 v238, 4, v238
v_mfma_f32_16x16x32_bf16 a[80:83], a[196:199], v[88:91], a[80:83]
v_exp_f32 v37, v37
v_mfma_f32_16x16x32_bf16 a[96:99], a[200:203], v[88:91], a[96:99]
ds_read_b64_tr_b16 a[196:197], v225 offset:0
v_cvt_pk_bf16_f32 v86, v36, v37
v_mfma_f32_16x16x32_bf16 a[100:103], a[200:203], v[92:95], a[100:103]
v_exp_f32 v38, v38
v_mfma_f32_16x16x32_bf16 a[104:107], a[200:203], v[96:99], a[104:107]
ds_read_b64_tr_b16 a[198:199], v225 offset:4096
v_mov_b32 v246, 0x7ffffff0
v_mfma_f32_16x16x32_bf16 a[108:111], a[200:203], v[100:103], a[108:111]
v_exp_f32 v39, v39
v_mfma_f32_16x16x32_bf16 a[124:127], a[204:207], v[100:103], a[124:127]
ds_read_b64_tr_b16 a[200:201], v226 offset:0
v_cvt_pk_bf16_f32 v87, v38, v39
v_mfma_f32_16x16x32_bf16 a[120:123], a[204:207], v[96:99], a[120:123]
ds_read_b64_tr_b16 a[202:203], v226 offset:4096
v_cmp_lt_u32 vcc, 7, v3
v_mfma_f32_16x16x32_bf16 a[116:119], a[204:207], v[92:95], a[116:119]
buffer_load_dwordx4 v231, s[8:11], s32 offen offset:3072  lds
v_mfma_f32_16x16x32_bf16 a[112:115], a[204:207], v[88:91], a[112:115]
ds_read_b64_tr_b16 a[204:205], v227 offset:0
ds_read_b64_tr_b16 a[206:207], v227 offset:4096
v_smfmac_f32_16x16x64_bf16 a[132:135], a[208:211], v[96:103], v245
s_add_u32 m0, s86, 20480
s_add_u32 s50, s85, 12288
buffer_load_dwordx4 v244, s[72:75], s50 offen lds
s_add_u32 m0, s86, 24576
s_add_u32 s50, s85, 16384
buffer_load_dwordx4 v244, s[72:75], s50 offen lds
s_add_u32 m0, s86, 28672
s_add_u32 s50, s85, 20480
buffer_load_dwordx4 v244, s[72:75], s50 offen lds
s_waitcnt lgkmcnt(8)
v_mfma_f32_16x16x32_bf16 v[8:11], a[144:147], v[152:155], v[136:139]
v_exp_f32 v40, v40
v_mfma_f32_16x16x32_bf16 v[8:11], a[148:151], v[156:159], v[8:11]
v_exp_f32 v41, v41
v_mfma_f32_16x16x32_bf16 v[8:11], a[152:155], v[160:163], v[8:11]
v_cvt_pk_bf16_f32 v88, v40, v41
v_cndmask_b32 v238, v238, v246, vcc
v_mfma_f32_16x16x32_bf16 v[8:11], a[156:159], v[164:167], v[8:11]
v_exp_f32 v42, v42
v_mfma_f32_16x16x32_bf16 v[16:19], a[156:159], v[180:183], v[140:143]
s_add_u32 s39, s39, 16384
s_mul_i32 s28, s2, 18432
v_mfma_f32_16x16x32_bf16 v[16:19], a[152:155], v[176:179], v[16:19]
v_exp_f32 v43, v43
v_mfma_f32_16x16x32_bf16 v[16:19], a[148:151], v[172:175], v[16:19]
s_mul_i32 s29, s37, 4608
v_cvt_pk_bf16_f32 v89, v42, v43
v_mfma_f32_16x16x32_bf16 v[16:19], a[144:147], v[168:171], v[16:19]
v_exp_f32 v44, v44
v_mfma_f32_16x16x32_bf16 v[24:27], a[144:147], v[184:187], v[144:147]
s_bitset0_b32 s39, 19
s_add_u32 s28, s28, s29
v_mfma_f32_16x16x32_bf16 v[24:27], a[148:151], v[188:191], v[24:27]
v_exp_f32 v45, v45
v_mfma_f32_16x16x32_bf16 v[24:27], a[152:155], v[192:195], v[24:27]
s_add_u32 s28, s28, 0x2000000
v_cvt_pk_bf16_f32 v90, v44, v45
v_mfma_f32_16x16x32_bf16 v[24:27], a[156:159], v[196:199], v[24:27]
v_exp_f32 v46, v46
v_mfma_f32_16x16x32_bf16 v[32:35], a[156:159], v[212:215], v[148:151]
ds_read_b128 a[156:159], v219 offset:24576
v_mfma_f32_16x16x32_bf16 v[32:35], a[152:155], v[208:211], v[32:35]
v_exp_f32 v47, v47
v_mfma_f32_16x16x32_bf16 v[32:35], a[148:151], v[204:207], v[32:35]
ds_read_b128 a[152:155], v218 offset:24576
v_cvt_pk_bf16_f32 v91, v46, v47
v_mfma_f32_16x16x32_bf16 v[32:35], a[144:147], v[200:203], v[32:35]
v_exp_f32 v48, v48
v_mfma_f32_16x16x32_bf16 a[0:3], a[176:179], v[72:75], a[0:3]
ds_read_b128 a[148:151], v217 offset:24576
ds_read_b128 a[144:147], v216 offset:24576
v_mfma_f32_16x16x32_bf16 a[4:7], a[176:179], v[76:79], a[4:7]
v_exp_f32 v49, v49
v_mfma_f32_16x16x32_bf16 a[8:11], a[176:179], v[80:83], a[8:11]
s_add_u32 m0, s30, 147456
v_cvt_pk_bf16_f32 v92, v48, v49
v_mfma_f32_16x16x32_bf16 a[12:15], a[176:179], v[84:87], a[12:15]
v_exp_f32 v50, v50
v_mfma_f32_16x16x32_bf16 a[28:31], a[180:183], v[84:87], a[28:31]
ds_read_b64_tr_b16 a[176:177], v220 offset:8192
ds_read_b64_tr_b16 a[178:179], v220 offset:12288
v_mfma_f32_16x16x32_bf16 a[24:27], a[180:183], v[80:83], a[24:27]
v_exp_f32 v51, v51
v_mfma_f32_16x16x32_bf16 a[20:23], a[180:183], v[76:79], a[20:23]
v_cvt_pk_bf16_f32 v93, v50, v51
v_mfma_f32_16x16x32_bf16 a[16:19], a[180:183], v[72:75], a[16:19]
v_exp_f32 v52, v52
v_mfma_f32_16x16x32_bf16 a[32:35], a[184:187], v[72:75], a[32:35]
ds_read_b64_tr_b16 a[180:181], v221 offset:8192
ds_read_b64_tr_b16 a[182:183], v221 offset:12288
v_mfma_f32_16x16x32_bf16 a[36:39], a[184:187], v[76:79], a[36:39]
v_exp_f32 v53, v53
v_mfma_f32_16x16x32_bf16 a[40:43], a[184:187], v[80:83], a[40:43]
v_cvt_pk_bf16_f32 v94, v52, v53
v_mfma_f32_16x16x32_bf16 a[44:47], a[184:187], v[84:87], a[44:47]
v_exp_f32 v54, v54
v_mfma_f32_16x16x32_bf16 a[60:63], a[188:191], v[84:87], a[60:63]
ds_read_b64_tr_b16 a[184:185], v222 offset:8192
STUB_8:
s_cbranch_execz HOP_RET1
ds_read_b64_tr_b16 a[186:187], v222 offset:12288
v_mfma_f32_16x16x32_bf16 a[56:59], a[188:191], v[80:83], a[56:59]
v_exp_f32 v55, v55
v_mfma_f32_16x16x32_bf16 a[52:55], a[188:191], v[76:79], a[52:55]
v_cvt_pk_bf16_f32 v95, v54, v55
v_mfma_f32_16x16x32_bf16 a[48:51], a[188:191], v[72:75], a[48:51]
v_exp_f32 v56, v56
v_smfmac_f32_16x16x64_bf16 a[128:131], a[208:211], v[72:79], v245
ds_read_b64_tr_b16 a[188:189], v223 offset:8192
v_mfma_f32_16x16x32_bf16 v[12:15], a[160:163], v[152:155], v[136:139]
v_exp_f32 v57, v57
v_mfma_f32_16x16x32_bf16 v[12:15], a[164:167], v[156:159], v[12:15]
v_exp_f32 v58, v58
v_mfma_f32_16x16x32_bf16 v[12:15], a[168:171], v[160:163], v[12:15]
ds_read_b64_tr_b16 a[190:191], v223 offset:12288
v_cvt_pk_bf16_f32 v96, v56, v57
v_mfma_f32_16x16x32_bf16 v[12:15], a[172:175], v[164:167], v[12:15]
v_exp_f32 v59, v59
v_mfma_f32_16x16x32_bf16 v[20:23], a[172:175], v[180:183], v[140:143]
v_cvt_pk_bf16_f32 v97, v58, v59
v_mfma_f32_16x16x32_bf16 v[20:23], a[168:171], v[176:179], v[20:23]
v_exp_f32 v60, v60
v_mfma_f32_16x16x32_bf16 v[20:23], a[164:167], v[172:175], v[20:23]
buffer_load_dwordx4 v232, s[12:15], s39 offen offset:0  lds
v_mfma_f32_16x16x32_bf16 v[20:23], a[160:163], v[168:171], v[20:23]
v_exp_f32 v61, v61
v_mfma_f32_16x16x32_bf16 v[28:31], a[160:163], v[184:187], v[144:147]
v_cvt_pk_bf16_f32 v98, v60, v61
v_mfma_f32_16x16x32_bf16 v[28:31], a[164:167], v[188:191], v[28:31]
v_exp_f32 v62, v62
v_mfma_f32_16x16x32_bf16 v[28:31], a[168:171], v[192:195], v[28:31]
buffer_load_dwordx4 v233, s[12:15], s39 offen offset:1024  lds
v_mfma_f32_16x16x32_bf16 v[28:31], a[172:175], v[196:199], v[28:31]
v_exp_f32 v63, v63
v_mfma_f32_16x16x32_bf16 v[36:39], a[172:175], v[212:215], v[148:151]
ds_read_b128 a[172:175], v219 offset:28672
v_cvt_pk_bf16_f32 v99, v62, v63
v_mfma_f32_16x16x32_bf16 v[36:39], a[168:171], v[208:211], v[36:39]
v_exp_f32 v64, v64
v_mfma_f32_16x16x32_bf16 v[36:39], a[164:167], v[204:207], v[36:39]
ds_read_b128 a[168:171], v218 offset:28672
ds_read_b128 a[164:167], v217 offset:28672
v_mfma_f32_16x16x32_bf16 v[36:39], a[160:163], v[200:203], v[36:39]
v_exp_f32 v65, v65
s_waitcnt lgkmcnt(8)
v_mfma_f32_16x16x32_bf16 a[64:67], a[192:195], v[72:75], a[64:67]
ds_read_b128 a[160:163], v216 offset:28672
v_cvt_pk_bf16_f32 v100, v64, v65
v_mfma_f32_16x16x32_bf16 a[68:71], a[192:195], v[76:79], a[68:71]
v_exp_f32 v66, v66
v_mfma_f32_16x16x32_bf16 a[72:75], a[192:195], v[80:83], a[72:75]
buffer_load_dwordx4 v232, s[12:15], s39 offen offset:2048  lds
v_mfma_f32_16x16x32_bf16 a[76:79], a[192:195], v[84:87], a[76:79]
v_exp_f32 v67, v67
v_mfma_f32_16x16x32_bf16 a[92:95], a[196:199], v[84:87], a[92:95]
ds_read_b64_tr_b16 a[192:193], v224 offset:8192
v_cvt_pk_bf16_f32 v101, v66, v67
v_mfma_f32_16x16x32_bf16 a[88:91], a[196:199], v[80:83], a[88:91]
v_exp_f32 v68, v68
v_mfma_f32_16x16x32_bf16 a[84:87], a[196:199], v[76:79], a[84:87]
ds_read_b64_tr_b16 a[194:195], v224 offset:12288
s_cmp_lt_u32 s37, 2
s_cselect_b64 s[90:91], -1, 0
v_mfma_f32_16x16x32_bf16 a[80:83], a[196:199], v[72:75], a[80:83]
v_exp_f32 v69, v69
v_mfma_f32_16x16x32_bf16 a[96:99], a[200:203], v[72:75], a[96:99]
ds_read_b64_tr_b16 a[196:197], v225 offset:8192
v_cvt_pk_bf16_f32 v102, v68, v69
v_mfma_f32_16x16x32_bf16 a[100:103], a[200:203], v[76:79], a[100:103]
v_exp_f32 v70, v70
v_mfma_f32_16x16x32_bf16 a[104:107], a[200:203], v[80:83], a[104:107]
ds_read_b64_tr_b16 a[198:199], v225 offset:12288
v_mfma_f32_16x16x32_bf16 a[108:111], a[200:203], v[84:87], a[108:111]
v_exp_f32 v71, v71
v_mfma_f32_16x16x32_bf16 a[124:127], a[204:207], v[84:87], a[124:127]
ds_read_b64_tr_b16 a[200:201], v226 offset:8192
v_cvt_pk_bf16_f32 v103, v70, v71
v_mfma_f32_16x16x32_bf16 a[120:123], a[204:207], v[80:83], a[120:123]
ds_read_b64_tr_b16 a[202:203], v226 offset:12288
v_mfma_f32_16x16x32_bf16 a[116:119], a[204:207], v[76:79], a[116:119]
buffer_load_dwordx4 v233, s[12:15], s39 offen offset:3072  lds
v_mfma_f32_16x16x32_bf16 a[112:115], a[204:207], v[72:75], a[112:115]
ds_read_b64_tr_b16 a[204:205], v227 offset:8192
ds_read_b64_tr_b16 a[206:207], v227 offset:12288
v_smfmac_f32_16x16x64_bf16 a[132:135], a[208:211], v[80:87], v245
s_add_u32 m0, s86, 32768
s_add_u32 s50, s85, 24576
buffer_load_dwordx4 v244, s[72:75], s50 offen lds
s_add_u32 m0, s86, 36864
s_add_u32 s50, s85, 28672
buffer_load_dwordx4 v244, s[72:75], s50 offen lds
s_add_u32 m0, s86, 40960
s_add_u32 s50, s85, 32768
buffer_load_dwordx4 v244, s[72:75], s50 offen lds
v_mfma_f32_16x16x32_bf16 v[40:43], a[144:147], v[152:155], v[136:139]
v_exp_f32 v8, v8
v_mfma_f32_16x16x32_bf16 v[40:43], a[148:151], v[156:159], v[40:43]
v_exp_f32 v9, v9
v_mfma_f32_16x16x32_bf16 v[40:43], a[152:155], v[160:163], v[40:43]
v_cvt_pk_bf16_f32 v72, v8, v9
v_mfma_f32_16x16x32_bf16 v[40:43], a[156:159], v[164:167], v[40:43]
v_exp_f32 v10, v10
v_mfma_f32_16x16x32_bf16 v[48:51], a[156:159], v[180:183], v[140:143]
v_mfma_f32_16x16x32_bf16 v[48:51], a[152:155], v[176:179], v[48:51]
v_exp_f32 v11, v11
v_mfma_f32_16x16x32_bf16 v[48:51], a[148:151], v[172:175], v[48:51]
v_cvt_pk_bf16_f32 v73, v10, v11
v_mfma_f32_16x16x32_bf16 v[48:51], a[144:147], v[168:171], v[48:51]
v_exp_f32 v12, v12
v_mfma_f32_16x16x32_bf16 v[56:59], a[144:147], v[184:187], v[144:147]
v_mfma_f32_16x16x32_bf16 v[56:59], a[148:151], v[188:191], v[56:59]
v_exp_f32 v13, v13
v_mfma_f32_16x16x32_bf16 v[56:59], a[152:155], v[192:195], v[56:59]
v_cvt_pk_bf16_f32 v74, v12, v13
v_mfma_f32_16x16x32_bf16 v[56:59], a[156:159], v[196:199], v[56:59]
v_exp_f32 v14, v14
v_mfma_f32_16x16x32_bf16 v[64:67], a[156:159], v[212:215], v[148:151]
s_waitcnt vmcnt(14) lgkmcnt(0)
s_barrier
v_mfma_f32_16x16x32_bf16 v[64:67], a[152:155], v[208:211], v[64:67]
ds_read_b128 v[124:127], v239 offset:45056
v_exp_f32 v15, v15
v_mfma_f32_16x16x32_bf16 v[64:67], a[148:151], v[204:207], v[64:67]
ds_read_b128 a[156:159], v219 offset:49152
ds_read_b128 v[128:131], v239 offset:45568
v_cvt_pk_bf16_f32 v75, v14, v15
v_mfma_f32_16x16x32_bf16 v[64:67], a[144:147], v[200:203], v[64:67]
ds_read_b128 v[248:251], v239 offset:46080
v_exp_f32 v16, v16
v_mfma_f32_16x16x32_bf16 a[0:3], a[176:179], v[88:91], a[0:3]
ds_read_b128 a[152:155], v218 offset:49152
ds_read_b128 a[148:151], v217 offset:49152
ds_read_b128 v[252:255], v239 offset:46592
v_mfma_f32_16x16x32_bf16 a[4:7], a[176:179], v[92:95], a[4:7]
ds_read_b64_tr_b16 v[116:117], v241 offset:0
v_exp_f32 v17, v17
v_mfma_f32_16x16x32_bf16 a[8:11], a[176:179], v[96:99], a[8:11]
ds_read_b128 a[144:147], v216 offset:49152
ds_read_b64_tr_b16 v[118:119], v241 offset:256
v_cvt_pk_bf16_f32 v76, v16, v17
v_mfma_f32_16x16x32_bf16 a[12:15], a[176:179], v[100:103], a[12:15]
ds_read_b64_tr_b16 v[120:121], v241 offset:2048
v_exp_f32 v18, v18
v_mfma_f32_16x16x32_bf16 a[28:31], a[180:183], v[100:103], a[28:31]
ds_read_b64_tr_b16 a[176:177], v220 offset:32768
ds_read_b64_tr_b16 a[178:179], v220 offset:36864
ds_read_b64_tr_b16 v[122:123], v241 offset:2304
v_mfma_f32_16x16x32_bf16 a[24:27], a[180:183], v[96:99], a[24:27]
v_exp_f32 v19, v19
v_mfma_f32_16x16x32_bf16 a[20:23], a[180:183], v[92:95], a[20:23]
s_add_u32 s32, s32, 16384
v_cvt_pk_bf16_f32 v77, v18, v19
v_mfma_f32_16x16x32_bf16 a[16:19], a[180:183], v[88:91], a[16:19]
v_exp_f32 v20, v20
v_mfma_f32_16x16x32_bf16 a[32:35], a[184:187], v[88:91], a[32:35]
ds_read_b64_tr_b16 a[180:181], v221 offset:32768
ds_read_b64_tr_b16 a[182:183], v221 offset:36864
v_mfma_f32_16x16x32_bf16 a[36:39], a[184:187], v[92:95], a[36:39]
v_exp_f32 v21, v21
v_mfma_f32_16x16x32_bf16 a[40:43], a[184:187], v[96:99], a[40:43]
s_bitset0_b32 s32, 19
v_cvt_pk_bf16_f32 v78, v20, v21
s_waitcnt lgkmcnt(8)
v_mfma_f32_16x16x32_bf16 v[132:135], a[212:215], v[124:127], 0
ds_read_b128 v[124:127], v239 offset:47104
v_mfma_f32_16x16x32_bf16 a[44:47], a[184:187], v[100:103], a[44:47]
v_exp_f32 v22, v22
v_mfma_f32_16x16x32_bf16 a[60:63], a[188:191], v[100:103], a[60:63]
ds_read_b64_tr_b16 a[184:185], v222 offset:32768
ds_read_b64_tr_b16 a[186:187], v222 offset:36864
v_mfma_f32_16x16x32_bf16 v[132:135], a[216:219], v[128:131], v[132:135]
s_add_u32 m0, s30, 81920
ds_read_b128 v[128:131], v239 offset:47616
v_mfma_f32_16x16x32_bf16 a[56:59], a[188:191], v[96:99], a[56:59]
v_exp_f32 v23, v23
v_mfma_f32_16x16x32_bf16 a[52:55], a[188:191], v[92:95], a[52:55]
v_cvt_pk_bf16_f32 v79, v22, v23
v_mfma_f32_16x16x32_bf16 v[132:135], a[220:223], v[248:251], v[132:135]
ds_read_b128 v[248:251], v239 offset:48128
v_mfma_f32_16x16x32_bf16 a[48:51], a[188:191], v[88:91], a[48:51]
v_exp_f32 v24, v24
v_smfmac_f32_16x16x64_bf16 a[128:131], a[208:211], v[88:95], v245
ds_read_b64_tr_b16 a[188:189], v223 offset:32768
v_mfma_f32_16x16x32_bf16 v[132:135], a[224:227], v[252:255], v[132:135]
ds_read_b64_tr_b16 a[190:191], v223 offset:36864
ds_read_b128 v[252:255], v239 offset:48640
v_mfma_f32_16x16x32_bf16 v[44:47], a[160:163], v[152:155], v[136:139]
v_exp_f32 v25, v25
v_mfma_f32_16x16x32_bf16 v[44:47], a[164:167], v[156:159], v[44:47]
v_exp_f32 v26, v26
s_waitcnt lgkmcnt(7)
v_mfma_f32_16x16x32_bf16 v[132:135], a[228:231], v[124:127], v[132:135]
ds_read_b128 v[124:127], v239 offset:49152
v_cvt_pk_bf16_f32 v80, v24, v25
v_mfma_f32_16x16x32_bf16 v[44:47], a[168:171], v[160:163], v[44:47]
buffer_load_dwordx4 v228, s[8:11], s32 offen offset:0  lds
v_mfma_f32_16x16x32_bf16 v[44:47], a[172:175], v[164:167], v[44:47]
v_exp_f32 v27, v27
s_waitcnt lgkmcnt(5)
v_mfma_f32_16x16x32_bf16 v[132:135], a[232:235], v[128:131], v[132:135]
ds_read_b128 v[128:131], v239 offset:49664
v_mfma_f32_16x16x32_bf16 v[52:55], a[172:175], v[180:183], v[140:143]
v_cvt_pk_bf16_f32 v81, v26, v27
v_mfma_f32_16x16x32_bf16 v[52:55], a[168:171], v[176:179], v[52:55]
v_exp_f32 v28, v28
s_waitcnt lgkmcnt(5)
v_mfma_f32_16x16x32_bf16 v[132:135], a[236:239], v[248:251], v[132:135]
ds_read_b128 v[248:251], v239 offset:50176
v_mfma_f32_16x16x32_bf16 v[52:55], a[164:167], v[172:175], v[52:55]
v_mfma_f32_16x16x32_bf16 v[52:55], a[160:163], v[168:171], v[52:55]
v_exp_f32 v29, v29
s_waitcnt lgkmcnt(3)
v_mfma_f32_16x16x32_bf16 v[132:135], a[240:243], v[252:255], v[132:135]
buffer_load_dwordx4 v229, s[8:11], s32 offen offset:1024  lds
ds_read_b128 v[252:255], v239 offset:50688
v_mfma_f32_16x16x32_bf16 v[60:63], a[160:163], v[184:187], v[144:147]
v_cvt_pk_bf16_f32 v82, v28, v29
v_mfma_f32_16x16x32_bf16 v[60:63], a[164:167], v[188:191], v[60:63]
v_exp_f32 v30, v30
s_waitcnt lgkmcnt(3)
v_mfma_f32_16x16x32_bf16 v[132:135], a[244:247], v[124:127], v[132:135]
ds_read_b128 v[124:127], v239 offset:51200
v_mfma_f32_16x16x32_bf16 v[60:63], a[168:171], v[192:195], v[60:63]
v_mfma_f32_16x16x32_bf16 v[60:63], a[172:175], v[196:199], v[60:63]
v_exp_f32 v31, v31
s_waitcnt lgkmcnt(3)
v_mfma_f32_16x16x32_bf16 v[132:135], a[248:251], v[128:131], v[132:135]
ds_read_b128 v[128:131], v239 offset:51712
v_mfma_f32_16x16x32_bf16 v[68:71], a[172:175], v[212:215], v[148:151]
ds_read_b128 a[172:175], v219 offset:53248
v_cvt_pk_bf16_f32 v83, v30, v31
v_mfma_f32_16x16x32_bf16 v[68:71], a[168:171], v[208:211], v[68:71]
v_exp_f32 v32, v32
s_waitcnt lgkmcnt(4)
v_mfma_f32_16x16x32_bf16 v[132:135], a[252:255], v[248:251], v[132:135]
ds_read_b128 a[168:171], v218 offset:53248
ds_read_b128 v[248:251], v239 offset:52224
v_mfma_f32_16x16x32_bf16 v[68:71], a[164:167], v[204:207], v[68:71]
ds_read_b128 a[164:167], v217 offset:53248
v_mfma_f32_16x16x32_bf16 v[68:71], a[160:163], v[200:203], v[68:71]
v_exp_f32 v33, v33
s_waitcnt lgkmcnt(6)
v_mfma_f32_16x16x32_bf16 v[132:135], a[136:139], v[252:255], v[132:135]
ds_read_b128 a[160:163], v216 offset:53248
ds_read_b128 v[252:255], v239 offset:52736
v_mfma_f32_16x16x32_bf16 a[64:67], a[192:195], v[88:91], a[64:67]
v_cvt_pk_bf16_f32 v84, v32, v33
v_mfma_f32_16x16x32_bf16 a[68:71], a[192:195], v[92:95], a[68:71]
v_exp_f32 v34, v34
s_waitcnt lgkmcnt(7)
v_mfma_f32_16x16x32_bf16 v[132:135], a[140:143], v[124:127], v[132:135]
buffer_load_dwordx4 v230, s[8:11], s32 offen offset:2048  lds
ds_read_b128 v[124:127], v239 offset:53248
v_mfma_f32_16x16x32_bf16 a[72:75], a[192:195], v[96:99], a[72:75]
v_mfma_f32_16x16x32_bf16 a[76:79], a[192:195], v[100:103], a[76:79]
v_exp_f32 v35, v35
s_waitcnt lgkmcnt(7)
v_mfma_f32_16x16x32_bf16 v[132:135], v[104:107], v[128:131], v[132:135]
ds_read_b64_tr_b16 a[192:193], v224 offset:32768
ds_read_b64_tr_b16 a[194:195], v224 offset:36864
ds_read_b128 v[128:131], v239 offset:53760
v_mfma_f32_16x16x32_bf16 a[92:95], a[196:199], v[100:103], a[92:95]
v_cvt_pk_bf16_f32 v85, v34, v35
v_mfma_f32_16x16x32_bf16 a[88:91], a[196:199], v[96:99], a[88:91]
v_exp_f32 v36, v36
s_waitcnt lgkmcnt(7)
v_mfma_f32_16x16x32_bf16 v[132:135], v[108:111], v[248:251], v[132:135]
buffer_load_dwordx4 v231, s[8:11], s32 offen offset:3072  lds
v_mfma_f32_16x16x32_bf16 a[84:87], a[196:199], v[92:95], a[84:87]
v_mfma_f32_16x16x32_bf16 a[80:83], a[196:199], v[88:91], a[80:83]
v_exp_f32 v37, v37
s_waitcnt lgkmcnt(4)
v_mfma_f32_16x16x32_bf16 v[132:135], v[112:115], v[252:255], v[132:135]
ds_read_b64_tr_b16 a[196:197], v225 offset:32768
ds_read_b64_tr_b16 a[198:199], v225 offset:36864
v_mfma_f32_16x16x32_bf16 a[96:99], a[200:203], v[88:91], a[96:99]
v_cvt_pk_bf16_f32 v86, v36, v37
v_mfma_f32_16x16x32_bf16 a[100:103], a[200:203], v[92:95], a[100:103]
v_exp_f32 v38, v38
s_waitcnt lgkmcnt(5)
v_mfma_f32_16x16x32_bf16 v[132:135], v[116:119], v[124:127], v[132:135]
v_mfma_f32_16x16x32_bf16 a[104:107], a[200:203], v[96:99], a[104:107]
v_mfma_f32_16x16x32_bf16 a[108:111], a[200:203], v[100:103], a[108:111]
v_exp_f32 v39, v39
s_waitcnt lgkmcnt(2)
v_mfma_f32_16x16x32_bf16 v[132:135], v[120:123], v[128:131], v[132:135]
ds_read_b64_tr_b16 a[200:201], v226 offset:32768
ds_read_b64_tr_b16 a[202:203], v226 offset:36864
v_mfma_f32_16x16x32_bf16 a[124:127], a[204:207], v[100:103], a[124:127]
v_cvt_pk_bf16_f32 v87, v38, v39
v_mfma_f32_16x16x32_bf16 a[120:123], a[204:207], v[96:99], a[120:123]
v_mfma_f32_16x16x32_bf16 a[116:119], a[204:207], v[92:95], a[116:119]
v_mfma_f32_16x16x32_bf16 a[112:115], a[204:207], v[88:91], a[112:115]
ds_read_b64_tr_b16 a[204:205], v227 offset:32768
ds_read_b64_tr_b16 a[206:207], v227 offset:36864
v_smfmac_f32_16x16x64_bf16 a[132:135], a[208:211], v[96:103], v245
v_mfma_f32_16x16x32_bf16 v[8:11], a[144:147], v[152:155], v[136:139]
v_exp_f32 v40, v40
v_mfma_f32_16x16x32_bf16 v[8:11], a[148:151], v[156:159], v[8:11]
v_exp_f32 v41, v41
v_mfma_f32_16x16x32_bf16 v[8:11], a[152:155], v[160:163], v[8:11]
v_cvt_pk_bf16_f32 v88, v40, v41
v_cvt_pk_bf16_f32 v104, v132, v133
v_cvt_pk_bf16_f32 v105, v134, v135
v_mfma_f32_16x16x32_bf16 v[8:11], a[156:159], v[164:167], v[8:11]
v_lshlrev_b32 v132, 16, v104
v_exp_f32 v42, v42
v_mfma_f32_16x16x32_bf16 v[16:19], a[156:159], v[180:183], v[140:143]
s_add_u32 s39, s39, 16384
v_and_b32 v133, 0xffff0000, v104
v_lshlrev_b32 v134, 16, v105
v_mfma_f32_16x16x32_bf16 v[16:19], a[152:155], v[176:179], v[16:19]
v_and_b32 v135, 0xffff0000, v105
v_exp_f32 v43, v43
v_mfma_f32_16x16x32_bf16 v[16:19], a[148:151], v[172:175], v[16:19]
v_cvt_pk_bf16_f32 v89, v42, v43
v_mul_f32 v104, 0xbfb8aa3b, v132
v_mul_f32 v105, 0xbfb8aa3b, v133
v_mfma_f32_16x16x32_bf16 v[16:19], a[144:147], v[168:171], v[16:19]
v_mul_f32 v106, 0xbfb8aa3b, v134
v_exp_f32 v44, v44
v_mfma_f32_16x16x32_bf16 v[24:27], a[144:147], v[184:187], v[144:147]
v_mul_f32 v107, 0xbfb8aa3b, v135
v_exp_f32 v104, v104
v_mfma_f32_16x16x32_bf16 v[24:27], a[148:151], v[188:191], v[24:27]
v_exp_f32 v45, v45
v_mfma_f32_16x16x32_bf16 v[24:27], a[152:155], v[192:195], v[24:27]
v_cvt_pk_bf16_f32 v90, v44, v45
v_exp_f32 v105, v105
v_mfma_f32_16x16x32_bf16 v[24:27], a[156:159], v[196:199], v[24:27]
v_exp_f32 v46, v46
v_mfma_f32_16x16x32_bf16 v[32:35], a[156:159], v[212:215], v[148:151]
ds_read_b128 a[156:159], v219 offset:57344
s_bitset0_b32 s39, 19
v_mfma_f32_16x16x32_bf16 v[32:35], a[152:155], v[208:211], v[32:35]
v_exp_f32 v47, v47
v_mfma_f32_16x16x32_bf16 v[32:35], a[148:151], v[204:207], v[32:35]
ds_read_b128 a[152:155], v218 offset:57344
v_cvt_pk_bf16_f32 v91, v46, v47
v_mfma_f32_16x16x32_bf16 v[32:35], a[144:147], v[200:203], v[32:35]
v_exp_f32 v48, v48
v_mfma_f32_16x16x32_bf16 a[0:3], a[176:179], v[72:75], a[0:3]
ds_read_b128 a[148:151], v217 offset:57344
ds_read_b128 a[144:147], v216 offset:57344
v_mfma_f32_16x16x32_bf16 a[4:7], a[176:179], v[76:79], a[4:7]
v_exp_f32 v49, v49
v_mfma_f32_16x16x32_bf16 a[8:11], a[176:179], v[80:83], a[8:11]
v_cvt_pk_bf16_f32 v92, v48, v49
v_exp_f32 v106, v106
v_mfma_f32_16x16x32_bf16 a[12:15], a[176:179], v[84:87], a[12:15]
v_exp_f32 v50, v50
v_mfma_f32_16x16x32_bf16 a[28:31], a[180:183], v[84:87], a[28:31]
ds_read_b64_tr_b16 a[176:177], v220 offset:40960
ds_read_b64_tr_b16 a[178:179], v220 offset:45056
v_mfma_f32_16x16x32_bf16 a[24:27], a[180:183], v[80:83], a[24:27]
v_exp_f32 v51, v51
v_mfma_f32_16x16x32_bf16 a[20:23], a[180:183], v[76:79], a[20:23]
s_add_u32 m0, s30, 98304
v_cvt_pk_bf16_f32 v93, v50, v51
v_mfma_f32_16x16x32_bf16 a[16:19], a[180:183], v[72:75], a[16:19]
v_exp_f32 v52, v52
v_mfma_f32_16x16x32_bf16 a[32:35], a[184:187], v[72:75], a[32:35]
ds_read_b64_tr_b16 a[180:181], v221 offset:40960
ds_read_b64_tr_b16 a[182:183], v221 offset:45056
v_mfma_f32_16x16x32_bf16 a[36:39], a[184:187], v[76:79], a[36:39]
v_exp_f32 v53, v53
v_mfma_f32_16x16x32_bf16 a[40:43], a[184:187], v[80:83], a[40:43]
v_cvt_pk_bf16_f32 v94, v52, v53
v_exp_f32 v107, v107
v_mfma_f32_16x16x32_bf16 a[44:47], a[184:187], v[84:87], a[44:47]
v_add_f32 v104, 1.0, v104
v_exp_f32 v54, v54
v_mfma_f32_16x16x32_bf16 a[60:63], a[188:191], v[84:87], a[60:63]
ds_read_b64_tr_b16 a[184:185], v222 offset:40960
ds_read_b64_tr_b16 a[186:187], v222 offset:45056
v_add_f32 v105, 1.0, v105
v_mfma_f32_16x16x32_bf16 a[56:59], a[188:191], v[80:83], a[56:59]
v_add_f32 v106, 1.0, v106
v_exp_f32 v55, v55
v_mfma_f32_16x16x32_bf16 a[52:55], a[188:191], v[76:79], a[52:55]
v_cvt_pk_bf16_f32 v95, v54, v55
v_add_f32 v107, 1.0, v107
v_mfma_f32_16x16x32_bf16 a[48:51], a[188:191], v[72:75], a[48:51]
v_exp_f32 v56, v56
v_smfmac_f32_16x16x64_bf16 a[128:131], a[208:211], v[72:79], v245
ds_read_b64_tr_b16 a[188:189], v223 offset:40960
v_mfma_f32_16x16x32_bf16 v[12:15], a[160:163], v[152:155], v[136:139]
v_exp_f32 v57, v57
v_mfma_f32_16x16x32_bf16 v[12:15], a[164:167], v[156:159], v[12:15]
v_exp_f32 v58, v58
v_mfma_f32_16x16x32_bf16 v[12:15], a[168:171], v[160:163], v[12:15]
ds_read_b64_tr_b16 a[190:191], v223 offset:45056
v_cvt_pk_bf16_f32 v96, v56, v57
v_mfma_f32_16x16x32_bf16 v[12:15], a[172:175], v[164:167], v[12:15]
v_exp_f32 v59, v59
v_mfma_f32_16x16x32_bf16 v[20:23], a[172:175], v[180:183], v[140:143]
v_cvt_pk_bf16_f32 v97, v58, v59
v_rcp_f32 v104, v104
v_mfma_f32_16x16x32_bf16 v[20:23], a[168:171], v[176:179], v[20:23]
v_exp_f32 v60, v60
v_mfma_f32_16x16x32_bf16 v[20:23], a[164:167], v[172:175], v[20:23]
buffer_load_dwordx4 v232, s[12:15], s39 offen offset:0  lds
v_mfma_f32_16x16x32_bf16 v[20:23], a[160:163], v[168:171], v[20:23]
v_exp_f32 v61, v61
v_mfma_f32_16x16x32_bf16 v[28:31], a[160:163], v[184:187], v[144:147]
v_cvt_pk_bf16_f32 v98, v60, v61
v_rcp_f32 v105, v105
v_mfma_f32_16x16x32_bf16 v[28:31], a[164:167], v[188:191], v[28:31]
v_exp_f32 v62, v62
v_mfma_f32_16x16x32_bf16 v[28:31], a[168:171], v[192:195], v[28:31]
buffer_load_dwordx4 v233, s[12:15], s39 offen offset:1024  lds
v_mfma_f32_16x16x32_bf16 v[28:31], a[172:175], v[196:199], v[28:31]
v_exp_f32 v63, v63
v_mfma_f32_16x16x32_bf16 v[36:39], a[172:175], v[212:215], v[148:151]
ds_read_b128 a[172:175], v219 offset:61440
v_cvt_pk_bf16_f32 v99, v62, v63
v_mfma_f32_16x16x32_bf16 v[36:39], a[168:171], v[208:211], v[36:39]
v_exp_f32 v64, v64
v_mfma_f32_16x16x32_bf16 v[36:39], a[164:167], v[204:207], v[36:39]
ds_read_b128 a[168:171], v218 offset:61440
ds_read_b128 a[164:167], v217 offset:61440
v_mfma_f32_16x16x32_bf16 v[36:39], a[160:163], v[200:203], v[36:39]
v_exp_f32 v65, v65
v_mfma_f32_16x16x32_bf16 a[64:67], a[192:195], v[72:75], a[64:67]
ds_read_b128 a[160:163], v216 offset:61440
v_cvt_pk_bf16_f32 v100, v64, v65
v_mfma_f32_16x16x32_bf16 a[68:71], a[192:195], v[76:79], a[68:71]
v_exp_f32 v66, v66
v_mfma_f32_16x16x32_bf16 a[72:75], a[192:195], v[80:83], a[72:75]
buffer_load_dwordx4 v232, s[12:15], s39 offen offset:2048  lds
v_mfma_f32_16x16x32_bf16 a[76:79], a[192:195], v[84:87], a[76:79]
v_exp_f32 v67, v67
s_waitcnt lgkmcnt(8)
v_mfma_f32_16x16x32_bf16 a[92:95], a[196:199], v[84:87], a[92:95]
ds_read_b64_tr_b16 a[192:193], v224 offset:40960
v_cvt_pk_bf16_f32 v101, v66, v67
v_mfma_f32_16x16x32_bf16 a[88:91], a[196:199], v[80:83], a[88:91]
v_exp_f32 v68, v68
v_mfma_f32_16x16x32_bf16 a[84:87], a[196:199], v[76:79], a[84:87]
ds_read_b64_tr_b16 a[194:195], v224 offset:45056
v_rcp_f32 v106, v106
v_mfma_f32_16x16x32_bf16 a[80:83], a[196:199], v[72:75], a[80:83]
v_exp_f32 v69, v69
v_mfma_f32_16x16x32_bf16 a[96:99], a[200:203], v[72:75], a[96:99]
ds_read_b64_tr_b16 a[196:197], v225 offset:40960
v_cvt_pk_bf16_f32 v102, v68, v69
v_mfma_f32_16x16x32_bf16 a[100:103], a[200:203], v[76:79], a[100:103]
v_exp_f32 v70, v70
v_mfma_f32_16x16x32_bf16 a[104:107], a[200:203], v[80:83], a[104:107]
ds_read_b64_tr_b16 a[198:199], v225 offset:45056
v_rcp_f32 v107, v107
v_mfma_f32_16x16x32_bf16 a[108:111], a[200:203], v[84:87], a[108:111]
v_mul_f32 v104, v132, v104
v_exp_f32 v71, v71
v_mfma_f32_16x16x32_bf16 a[124:127], a[204:207], v[84:87], a[124:127]
ds_read_b64_tr_b16 a[200:201], v226 offset:40960
v_cvt_pk_bf16_f32 v103, v70, v71
v_mul_f32 v105, v133, v105
v_mfma_f32_16x16x32_bf16 a[120:123], a[204:207], v[80:83], a[120:123]
ds_read_b64_tr_b16 a[202:203], v226 offset:45056
v_mul_f32 v106, v134, v106
v_mul_f32 v107, v135, v107
v_mfma_f32_16x16x32_bf16 a[116:119], a[204:207], v[76:79], a[116:119]
buffer_load_dwordx4 v233, s[12:15], s39 offen offset:3072  lds
v_cvt_pk_bf16_f32 v108, v104, v105
v_mfma_f32_16x16x32_bf16 a[112:115], a[204:207], v[72:75], a[112:115]
ds_read_b64_tr_b16 a[204:205], v227 offset:40960
ds_read_b64_tr_b16 a[206:207], v227 offset:45056
v_cvt_pk_bf16_f32 v109, v106, v107
v_smfmac_f32_16x16x64_bf16 a[132:135], a[208:211], v[80:87], v245
v_lshlrev_b32 v104, 16, v108
v_and_b32 v105, 0xffff0000, v108
v_lshlrev_b32 v106, 16, v109
v_and_b32 v107, 0xffff0000, v109
v_cndmask_b32 v132, v132, v104, s[90:91]
v_cndmask_b32 v133, v133, v105, s[90:91]
v_cndmask_b32 v134, v134, v106, s[90:91]
v_cndmask_b32 v135, v135, v107, s[90:91]
ds_write_b128 v237, v[132:135] offset:54272
v_mfma_f32_16x16x32_bf16 v[40:43], a[144:147], v[152:155], v[136:139]
v_exp_f32 v8, v8
v_mfma_f32_16x16x32_bf16 v[40:43], a[148:151], v[156:159], v[40:43]
v_exp_f32 v9, v9
v_mfma_f32_16x16x32_bf16 v[40:43], a[152:155], v[160:163], v[40:43]
v_cvt_pk_bf16_f32 v72, v8, v9
v_mfma_f32_16x16x32_bf16 v[40:43], a[156:159], v[164:167], v[40:43]
v_exp_f32 v10, v10
v_mfma_f32_16x16x32_bf16 v[48:51], a[156:159], v[180:183], v[140:143]
v_mfma_f32_16x16x32_bf16 v[48:51], a[152:155], v[176:179], v[48:51]
v_exp_f32 v11, v11
v_mfma_f32_16x16x32_bf16 v[48:51], a[148:151], v[172:175], v[48:51]
v_cvt_pk_bf16_f32 v73, v10, v11
v_mfma_f32_16x16x32_bf16 v[48:51], a[144:147], v[168:171], v[48:51]
v_exp_f32 v12, v12
v_mfma_f32_16x16x32_bf16 v[56:59], a[144:147], v[184:187], v[144:147]
v_mfma_f32_16x16x32_bf16 v[56:59], a[148:151], v[188:191], v[56:59]
v_exp_f32 v13, v13
v_mfma_f32_16x16x32_bf16 v[56:59], a[152:155], v[192:195], v[56:59]
v_cvt_pk_bf16_f32 v74, v12, v13
v_mfma_f32_16x16x32_bf16 v[56:59], a[156:159], v[196:199], v[56:59]
v_exp_f32 v14, v14
v_mfma_f32_16x16x32_bf16 v[64:67], a[156:159], v[212:215], v[148:151]
s_waitcnt vmcnt(8) lgkmcnt(0)
s_barrier
v_mfma_f32_16x16x32_bf16 v[64:67], a[152:155], v[208:211], v[64:67]
ds_read_b128 v[104:107], v244 offset:54272
v_exp_f32 v15, v15
v_mfma_f32_16x16x32_bf16 v[64:67], a[148:151], v[204:207], v[64:67]
ds_read_b128 a[156:159], v219 offset:0
ds_read_b128 v[108:111], v244 offset:55296
v_cvt_pk_bf16_f32 v75, v14, v15
v_mfma_f32_16x16x32_bf16 v[64:67], a[144:147], v[200:203], v[64:67]
ds_read_b128 v[112:115], v244 offset:56320
v_exp_f32 v16, v16
v_mfma_f32_16x16x32_bf16 a[0:3], a[176:179], v[88:91], a[0:3]
ds_read_b128 a[152:155], v218 offset:0
ds_read_b128 a[148:151], v217 offset:0
ds_read_b128 v[116:119], v244 offset:57344
v_mfma_f32_16x16x32_bf16 a[4:7], a[176:179], v[92:95], a[4:7]
ds_read_b64_tr_b16 a[212:213], v242 offset:0
v_exp_f32 v17, v17
v_mfma_f32_16x16x32_bf16 a[8:11], a[176:179], v[96:99], a[8:11]
ds_read_b128 a[144:147], v216 offset:0
ds_read_b64_tr_b16 a[214:215], v242 offset:18432
v_cvt_pk_bf16_f32 v76, v16, v17
v_mfma_f32_16x16x32_bf16 a[12:15], a[176:179], v[100:103], a[12:15]
ds_read_b64_tr_b16 a[216:217], v242 offset:32
v_exp_f32 v18, v18
v_mfma_f32_16x16x32_bf16 a[28:31], a[180:183], v[100:103], a[28:31]
ds_read_b64_tr_b16 a[176:177], v220 offset:49152
ds_read_b64_tr_b16 a[178:179], v220 offset:53248
ds_read_b64_tr_b16 a[218:219], v242 offset:18464
v_mfma_f32_16x16x32_bf16 a[24:27], a[180:183], v[96:99], a[24:27]
ds_read_b64_tr_b16 a[220:221], v242 offset:64
v_exp_f32 v19, v19
v_mfma_f32_16x16x32_bf16 a[20:23], a[180:183], v[92:95], a[20:23]
s_add_u32 s32, s32, 16384
ds_read_b64_tr_b16 a[222:223], v242 offset:18496
v_cvt_pk_bf16_f32 v77, v18, v19
v_mfma_f32_16x16x32_bf16 a[16:19], a[180:183], v[88:91], a[16:19]
ds_read_b64_tr_b16 a[224:225], v242 offset:96
v_exp_f32 v20, v20
v_mfma_f32_16x16x32_bf16 a[32:35], a[184:187], v[88:91], a[32:35]
ds_read_b64_tr_b16 a[180:181], v221 offset:49152
ds_read_b64_tr_b16 a[182:183], v221 offset:53248
ds_read_b64_tr_b16 a[226:227], v242 offset:18528
v_mfma_f32_16x16x32_bf16 a[36:39], a[184:187], v[92:95], a[36:39]
ds_read_b64_tr_b16 a[228:229], v242 offset:128
v_exp_f32 v21, v21
v_mfma_f32_16x16x32_bf16 a[40:43], a[184:187], v[96:99], a[40:43]
s_bitset0_b32 s32, 19
ds_read_b64_tr_b16 a[230:231], v242 offset:18560
v_cvt_pk_bf16_f32 v78, v20, v21
v_mfma_f32_16x16x32_bf16 a[44:47], a[184:187], v[100:103], a[44:47]
ds_read_b64_tr_b16 a[232:233], v242 offset:160
v_exp_f32 v22, v22
v_mfma_f32_16x16x32_bf16 a[60:63], a[188:191], v[100:103], a[60:63]
ds_read_b64_tr_b16 a[184:185], v222 offset:49152
ds_read_b64_tr_b16 a[186:187], v222 offset:53248
ds_read_b64_tr_b16 a[234:235], v242 offset:18592
v_mfma_f32_16x16x32_bf16 a[56:59], a[188:191], v[96:99], a[56:59]
ds_read_b64_tr_b16 a[236:237], v242 offset:192
v_exp_f32 v23, v23
v_mfma_f32_16x16x32_bf16 a[52:55], a[188:191], v[92:95], a[52:55]
s_add_u32 m0, s30, 114688
ds_read_b64_tr_b16 a[238:239], v242 offset:18624
v_cvt_pk_bf16_f32 v79, v22, v23
v_mfma_f32_16x16x32_bf16 a[48:51], a[188:191], v[88:91], a[48:51]
ds_read_b64_tr_b16 a[240:241], v242 offset:224
v_exp_f32 v24, v24
v_smfmac_f32_16x16x64_bf16 a[128:131], a[208:211], v[88:95], v245
ds_read_b64_tr_b16 a[188:189], v223 offset:49152
ds_read_b64_tr_b16 a[242:243], v242 offset:18656
v_mfma_f32_16x16x32_bf16 v[44:47], a[160:163], v[152:155], v[136:139]
ds_read_b64_tr_b16 a[244:245], v242 offset:256
v_exp_f32 v25, v25
v_mfma_f32_16x16x32_bf16 v[44:47], a[164:167], v[156:159], v[44:47]
ds_read_b64_tr_b16 a[246:247], v242 offset:18688
v_exp_f32 v26, v26
v_mfma_f32_16x16x32_bf16 v[44:47], a[168:171], v[160:163], v[44:47]
ds_read_b64_tr_b16 a[190:191], v223 offset:53248
v_cvt_pk_bf16_f32 v80, v24, v25
s_waitcnt lgkmcnt(8)
v_mul_f32 v104, v104, v112
v_mfma_f32_16x16x32_bf16 v[44:47], a[172:175], v[164:167], v[44:47]
v_mul_f32 v105, v105, v113
STUB_9:
s_cbranch_execz HOP_RET1
v_exp_f32 v27, v27
v_mfma_f32_16x16x32_bf16 v[52:55], a[172:175], v[180:183], v[140:143]
v_cvt_pk_bf16_f32 v81, v26, v27
v_mul_f32 v106, v106, v114
v_mul_f32 v107, v107, v115
v_mfma_f32_16x16x32_bf16 v[52:55], a[168:171], v[176:179], v[52:55]
v_mul_f32 v108, v108, v116
v_exp_f32 v28, v28
v_mfma_f32_16x16x32_bf16 v[52:55], a[164:167], v[172:175], v[52:55]
buffer_load_dwordx4 v228, s[8:11], s32 offen offset:0  lds
v_mul_f32 v109, v109, v117
v_mfma_f32_16x16x32_bf16 v[52:55], a[160:163], v[168:171], v[52:55]
v_mul_f32 v110, v110, v118
v_exp_f32 v29, v29
v_mfma_f32_16x16x32_bf16 v[60:63], a[160:163], v[184:187], v[144:147]
v_cvt_pk_bf16_f32 v82, v28, v29
v_mul_f32 v111, v111, v119
v_cvt_pk_bf16_f32 v120, v104, v105
v_mfma_f32_16x16x32_bf16 v[60:63], a[164:167], v[188:191], v[60:63]
v_cvt_pk_bf16_f32 v121, v106, v107
v_exp_f32 v30, v30
v_mfma_f32_16x16x32_bf16 v[60:63], a[168:171], v[192:195], v[60:63]
buffer_load_dwordx4 v229, s[8:11], s32 offen offset:1024  lds
v_cvt_pk_bf16_f32 v122, v108, v109
v_mfma_f32_16x16x32_bf16 v[60:63], a[172:175], v[196:199], v[60:63]
v_cvt_pk_bf16_f32 v123, v110, v111
v_exp_f32 v31, v31
v_mfma_f32_16x16x32_bf16 v[68:71], a[172:175], v[212:215], v[148:151]
ds_read_b128 a[172:175], v219 offset:4096
v_cvt_pk_bf16_f32 v83, v30, v31
v_mfma_f32_16x16x32_bf16 v[68:71], a[168:171], v[208:211], v[68:71]
v_exp_f32 v32, v32
v_mfma_f32_16x16x32_bf16 a[248:251], a[212:215], v[120:123], 0
ds_read_b128 a[168:171], v218 offset:4096
v_mfma_f32_16x16x32_bf16 v[68:71], a[164:167], v[204:207], v[68:71]
ds_read_b128 a[164:167], v217 offset:4096
v_mfma_f32_16x16x32_bf16 a[212:215], a[216:219], v[120:123], 0
buffer_load_dwordx4 v230, s[8:11], s32 offen offset:2048  lds
v_mfma_f32_16x16x32_bf16 v[68:71], a[160:163], v[200:203], v[68:71]
v_exp_f32 v33, v33
v_mfma_f32_16x16x32_bf16 a[216:219], a[220:223], v[120:123], 0
ds_read_b128 a[160:163], v216 offset:4096
v_mfma_f32_16x16x32_bf16 a[64:67], a[192:195], v[88:91], a[64:67]
v_cvt_pk_bf16_f32 v84, v32, v33
v_mfma_f32_16x16x32_bf16 a[220:223], a[224:227], v[120:123], 0
v_mfma_f32_16x16x32_bf16 a[68:71], a[192:195], v[92:95], a[68:71]
v_exp_f32 v34, v34
v_mfma_f32_16x16x32_bf16 a[224:227], a[228:231], v[120:123], 0
v_mfma_f32_16x16x32_bf16 a[72:75], a[192:195], v[96:99], a[72:75]
v_mfma_f32_16x16x32_bf16 a[228:231], a[232:235], v[120:123], 0
v_mfma_f32_16x16x32_bf16 a[76:79], a[192:195], v[100:103], a[76:79]
v_exp_f32 v35, v35
s_waitcnt lgkmcnt(8)
v_mfma_f32_16x16x32_bf16 a[232:235], a[236:239], v[120:123], 0
ds_read_b64_tr_b16 a[192:193], v224 offset:49152
ds_read_b64_tr_b16 a[194:195], v224 offset:53248
v_mfma_f32_16x16x32_bf16 a[92:95], a[196:199], v[100:103], a[92:95]
v_cvt_pk_bf16_f32 v85, v34, v35
s_waitcnt lgkmcnt(8)
v_mfma_f32_16x16x32_bf16 a[236:239], a[240:243], v[120:123], 0
buffer_load_dwordx4 v231, s[8:11], s32 offen offset:3072  lds
v_mfma_f32_16x16x32_bf16 a[88:91], a[196:199], v[96:99], a[88:91]
v_exp_f32 v36, v36
s_waitcnt lgkmcnt(7)
v_mfma_f32_16x16x32_bf16 a[240:243], a[244:247], v[120:123], 0
v_mfma_f32_16x16x32_bf16 a[84:87], a[196:199], v[92:95], a[84:87]
v_mfma_f32_16x16x32_bf16 a[80:83], a[196:199], v[88:91], a[80:83]
v_exp_f32 v37, v37
v_mfma_f32_16x16x32_bf16 a[96:99], a[200:203], v[88:91], a[96:99]
ds_read_b64_tr_b16 a[196:197], v225 offset:49152
v_cvt_pk_bf16_f32 v86, v36, v37
v_mfma_f32_16x16x32_bf16 a[100:103], a[200:203], v[92:95], a[100:103]
v_exp_f32 v38, v38
v_mfma_f32_16x16x32_bf16 a[104:107], a[200:203], v[96:99], a[104:107]
ds_read_b64_tr_b16 a[198:199], v225 offset:53248
v_mfma_f32_16x16x32_bf16 a[108:111], a[200:203], v[100:103], a[108:111]
v_exp_f32 v39, v39
v_mfma_f32_16x16x32_bf16 a[124:127], a[204:207], v[100:103], a[124:127]
ds_read_b64_tr_b16 a[200:201], v226 offset:49152
v_cvt_pk_bf16_f32 v87, v38, v39
v_mfma_f32_16x16x32_bf16 a[120:123], a[204:207], v[96:99], a[120:123]
ds_read_b64_tr_b16 a[202:203], v226 offset:53248
buffer_store_dwordx4 a[248:251], v238, s[20:23], s28 offen offset:0 sc0 sc1
v_mfma_f32_16x16x32_bf16 a[116:119], a[204:207], v[92:95], a[116:119]
v_mfma_f32_16x16x32_bf16 a[112:115], a[204:207], v[88:91], a[112:115]
ds_read_b64_tr_b16 a[204:205], v227 offset:49152
ds_read_b64_tr_b16 a[206:207], v227 offset:53248
v_smfmac_f32_16x16x64_bf16 a[132:135], a[208:211], v[96:103], v245
buffer_store_dwordx4 a[212:215], v238, s[20:23], s28 offen offset:512 sc0 sc1
v_mfma_f32_16x16x32_bf16 v[8:11], a[144:147], v[152:155], v[136:139]
v_exp_f32 v40, v40
v_mfma_f32_16x16x32_bf16 v[8:11], a[148:151], v[156:159], v[8:11]
v_exp_f32 v41, v41
v_mfma_f32_16x16x32_bf16 v[8:11], a[152:155], v[160:163], v[8:11]
buffer_store_dwordx4 a[216:219], v238, s[20:23], s28 offen offset:1024 sc0 sc1
v_cvt_pk_bf16_f32 v88, v40, v41
v_mfma_f32_16x16x32_bf16 v[8:11], a[156:159], v[164:167], v[8:11]
v_exp_f32 v42, v42
v_mfma_f32_16x16x32_bf16 v[16:19], a[156:159], v[180:183], v[140:143]
s_add_u32 s39, s39, 16384
buffer_store_dwordx4 a[220:223], v238, s[20:23], s28 offen offset:1536 sc0 sc1
v_mfma_f32_16x16x32_bf16 v[16:19], a[152:155], v[176:179], v[16:19]
v_exp_f32 v43, v43
v_mfma_f32_16x16x32_bf16 v[16:19], a[148:151], v[172:175], v[16:19]
v_cvt_pk_bf16_f32 v89, v42, v43
v_mfma_f32_16x16x32_bf16 v[16:19], a[144:147], v[168:171], v[16:19]
v_exp_f32 v44, v44
v_mfma_f32_16x16x32_bf16 v[24:27], a[144:147], v[184:187], v[144:147]
buffer_store_dwordx4 a[224:227], v238, s[20:23], s28 offen offset:2048 sc0 sc1
v_mfma_f32_16x16x32_bf16 v[24:27], a[148:151], v[188:191], v[24:27]
v_exp_f32 v45, v45
v_mfma_f32_16x16x32_bf16 v[24:27], a[152:155], v[192:195], v[24:27]
v_cvt_pk_bf16_f32 v90, v44, v45
v_mfma_f32_16x16x32_bf16 v[24:27], a[156:159], v[196:199], v[24:27]
v_exp_f32 v46, v46
v_mfma_f32_16x16x32_bf16 v[32:35], a[156:159], v[212:215], v[148:151]
ds_read_b128 a[156:159], v219 offset:8192
s_bitset0_b32 s39, 19
v_mfma_f32_16x16x32_bf16 v[32:35], a[152:155], v[208:211], v[32:35]
v_exp_f32 v47, v47
v_mfma_f32_16x16x32_bf16 v[32:35], a[148:151], v[204:207], v[32:35]
ds_read_b128 a[152:155], v218 offset:8192
v_cvt_pk_bf16_f32 v91, v46, v47
v_mfma_f32_16x16x32_bf16 v[32:35], a[144:147], v[200:203], v[32:35]
v_exp_f32 v48, v48
v_mfma_f32_16x16x32_bf16 a[0:3], a[176:179], v[72:75], a[0:3]
ds_read_b128 a[148:151], v217 offset:8192
ds_read_b128 a[144:147], v216 offset:8192
v_mfma_f32_16x16x32_bf16 a[4:7], a[176:179], v[76:79], a[4:7]
v_exp_f32 v49, v49
v_mfma_f32_16x16x32_bf16 a[8:11], a[176:179], v[80:83], a[8:11]
v_cvt_pk_bf16_f32 v92, v48, v49
v_mfma_f32_16x16x32_bf16 a[12:15], a[176:179], v[84:87], a[12:15]
v_exp_f32 v50, v50
v_mfma_f32_16x16x32_bf16 a[28:31], a[180:183], v[84:87], a[28:31]
ds_read_b64_tr_b16 a[176:177], v220 offset:57344
ds_read_b64_tr_b16 a[178:179], v220 offset:61440
v_mfma_f32_16x16x32_bf16 a[24:27], a[180:183], v[80:83], a[24:27]
v_exp_f32 v51, v51
v_mfma_f32_16x16x32_bf16 a[20:23], a[180:183], v[76:79], a[20:23]
s_add_u32 m0, s30, 131072
v_cvt_pk_bf16_f32 v93, v50, v51
v_mfma_f32_16x16x32_bf16 a[16:19], a[180:183], v[72:75], a[16:19]
v_exp_f32 v52, v52
v_mfma_f32_16x16x32_bf16 a[32:35], a[184:187], v[72:75], a[32:35]
ds_read_b64_tr_b16 a[180:181], v221 offset:57344
ds_read_b64_tr_b16 a[182:183], v221 offset:61440
v_mfma_f32_16x16x32_bf16 a[36:39], a[184:187], v[76:79], a[36:39]
v_exp_f32 v53, v53
v_mfma_f32_16x16x32_bf16 a[40:43], a[184:187], v[80:83], a[40:43]
buffer_store_dwordx4 a[228:231], v238, s[20:23], s28 offen offset:2560 sc0 sc1
v_cvt_pk_bf16_f32 v94, v52, v53
v_mfma_f32_16x16x32_bf16 a[44:47], a[184:187], v[84:87], a[44:47]
v_exp_f32 v54, v54
s_waitcnt lgkmcnt(8)
v_mfma_f32_16x16x32_bf16 a[60:63], a[188:191], v[84:87], a[60:63]
ds_read_b64_tr_b16 a[184:185], v222 offset:57344
ds_read_b64_tr_b16 a[186:187], v222 offset:61440
v_mfma_f32_16x16x32_bf16 a[56:59], a[188:191], v[80:83], a[56:59]
v_exp_f32 v55, v55
v_mfma_f32_16x16x32_bf16 a[52:55], a[188:191], v[76:79], a[52:55]
buffer_store_dwordx4 a[232:235], v238, s[20:23], s28 offen offset:3072 sc0 sc1
v_cvt_pk_bf16_f32 v95, v54, v55
v_mfma_f32_16x16x32_bf16 a[48:51], a[188:191], v[72:75], a[48:51]
v_exp_f32 v56, v56
v_smfmac_f32_16x16x64_bf16 a[128:131], a[208:211], v[72:79], v245
ds_read_b64_tr_b16 a[188:189], v223 offset:57344
v_mfma_f32_16x16x32_bf16 v[12:15], a[160:163], v[152:155], v[136:139]
v_exp_f32 v57, v57
v_mfma_f32_16x16x32_bf16 v[12:15], a[164:167], v[156:159], v[12:15]
v_exp_f32 v58, v58
v_mfma_f32_16x16x32_bf16 v[12:15], a[168:171], v[160:163], v[12:15]
ds_read_b64_tr_b16 a[190:191], v223 offset:61440
v_cvt_pk_bf16_f32 v96, v56, v57
v_mfma_f32_16x16x32_bf16 v[12:15], a[172:175], v[164:167], v[12:15]
v_exp_f32 v59, v59
v_mfma_f32_16x16x32_bf16 v[20:23], a[172:175], v[180:183], v[140:143]
v_cvt_pk_bf16_f32 v97, v58, v59
v_mfma_f32_16x16x32_bf16 v[20:23], a[168:171], v[176:179], v[20:23]
v_exp_f32 v60, v60
v_mfma_f32_16x16x32_bf16 v[20:23], a[164:167], v[172:175], v[20:23]
buffer_load_dwordx4 v232, s[12:15], s39 offen offset:0  lds
v_mfma_f32_16x16x32_bf16 v[20:23], a[160:163], v[168:171], v[20:23]
v_exp_f32 v61, v61
v_mfma_f32_16x16x32_bf16 v[28:31], a[160:163], v[184:187], v[144:147]
buffer_store_dwordx4 a[236:239], v238, s[20:23], s28 offen offset:3584 sc0 sc1
v_cvt_pk_bf16_f32 v98, v60, v61
v_mfma_f32_16x16x32_bf16 v[28:31], a[164:167], v[188:191], v[28:31]
v_exp_f32 v62, v62
v_mfma_f32_16x16x32_bf16 v[28:31], a[168:171], v[192:195], v[28:31]
buffer_load_dwordx4 v233, s[12:15], s39 offen offset:1024  lds
v_mfma_f32_16x16x32_bf16 v[28:31], a[172:175], v[196:199], v[28:31]
v_exp_f32 v63, v63
v_mfma_f32_16x16x32_bf16 v[36:39], a[172:175], v[212:215], v[148:151]
ds_read_b128 a[172:175], v219 offset:12288
v_cvt_pk_bf16_f32 v99, v62, v63
v_mfma_f32_16x16x32_bf16 v[36:39], a[168:171], v[208:211], v[36:39]
v_exp_f32 v64, v64
v_mfma_f32_16x16x32_bf16 v[36:39], a[164:167], v[204:207], v[36:39]
ds_read_b128 a[168:171], v218 offset:12288
ds_read_b128 a[164:167], v217 offset:12288
v_mfma_f32_16x16x32_bf16 v[36:39], a[160:163], v[200:203], v[36:39]
v_exp_f32 v65, v65
v_mfma_f32_16x16x32_bf16 a[64:67], a[192:195], v[72:75], a[64:67]
ds_read_b128 a[160:163], v216 offset:12288
v_cvt_pk_bf16_f32 v100, v64, v65
v_mfma_f32_16x16x32_bf16 a[68:71], a[192:195], v[76:79], a[68:71]
v_exp_f32 v66, v66
v_mfma_f32_16x16x32_bf16 a[72:75], a[192:195], v[80:83], a[72:75]
buffer_load_dwordx4 v232, s[12:15], s39 offen offset:2048  lds
v_mfma_f32_16x16x32_bf16 a[76:79], a[192:195], v[84:87], a[76:79]
v_exp_f32 v67, v67
v_mfma_f32_16x16x32_bf16 a[92:95], a[196:199], v[84:87], a[92:95]
ds_read_b64_tr_b16 a[192:193], v224 offset:57344
v_cvt_pk_bf16_f32 v101, v66, v67
v_mfma_f32_16x16x32_bf16 a[88:91], a[196:199], v[80:83], a[88:91]
v_exp_f32 v68, v68
v_mfma_f32_16x16x32_bf16 a[84:87], a[196:199], v[76:79], a[84:87]
ds_read_b64_tr_b16 a[194:195], v224 offset:61440
v_mfma_f32_16x16x32_bf16 a[80:83], a[196:199], v[72:75], a[80:83]
v_exp_f32 v69, v69
v_mfma_f32_16x16x32_bf16 a[96:99], a[200:203], v[72:75], a[96:99]
ds_read_b64_tr_b16 a[196:197], v225 offset:57344
v_cvt_pk_bf16_f32 v102, v68, v69
v_mfma_f32_16x16x32_bf16 a[100:103], a[200:203], v[76:79], a[100:103]
v_exp_f32 v70, v70
v_mfma_f32_16x16x32_bf16 a[104:107], a[200:203], v[80:83], a[104:107]
ds_read_b64_tr_b16 a[198:199], v225 offset:61440
v_mfma_f32_16x16x32_bf16 a[108:111], a[200:203], v[84:87], a[108:111]
v_exp_f32 v71, v71
v_mfma_f32_16x16x32_bf16 a[124:127], a[204:207], v[84:87], a[124:127]
ds_read_b64_tr_b16 a[200:201], v226 offset:57344
v_cvt_pk_bf16_f32 v103, v70, v71
v_mfma_f32_16x16x32_bf16 a[120:123], a[204:207], v[80:83], a[120:123]
ds_read_b64_tr_b16 a[202:203], v226 offset:61440
v_mfma_f32_16x16x32_bf16 a[116:119], a[204:207], v[76:79], a[116:119]
buffer_load_dwordx4 v233, s[12:15], s39 offen offset:3072  lds
v_mfma_f32_16x16x32_bf16 a[112:115], a[204:207], v[72:75], a[112:115]
ds_read_b64_tr_b16 a[204:205], v227 offset:57344
ds_read_b64_tr_b16 a[206:207], v227 offset:61440
v_smfmac_f32_16x16x64_bf16 a[132:135], a[208:211], v[80:87], v245
s_add_u32 s28, s28, 4096
buffer_store_dwordx4 a[240:243], v238, s[20:23], s28 offen offset:0 sc0 sc1
s_mov_b32 s33, 6
K_LOOPIN:
s_waitcnt lgkmcnt(0)
v_lshlrev_b32 v241, 4, v1
s_mov_b32 s46, s44
.p2align 6
K_LOOP:
s_cmp_eq_u32 s33, s3
s_cbranch_scc1 K_EVT
K_EVT_RET:
v_mfma_f32_16x16x32_bf16 v[40:43], a[144:147], v[152:155], v[136:139]
v_exp_f32 v8, v8
v_mfma_f32_16x16x32_bf16 v[40:43], a[148:151], v[156:159], v[40:43]
v_exp_f32 v9, v9
v_mfma_f32_16x16x32_bf16 v[40:43], a[152:155], v[160:163], v[40:43]
v_cvt_pk_bf16_f32 v72, v8, v9
v_mfma_f32_16x16x32_bf16 v[40:43], a[156:159], v[164:167], v[40:43]
v_exp_f32 v10, v10
v_mfma_f32_16x16x32_bf16 v[48:51], a[156:159], v[180:183], v[140:143]
v_mfma_f32_16x16x32_bf16 v[48:51], a[152:155], v[176:179], v[48:51]
v_exp_f32 v11, v11
v_mfma_f32_16x16x32_bf16 v[48:51], a[148:151], v[172:175], v[48:51]
v_cvt_pk_bf16_f32 v73, v10, v11
v_mfma_f32_16x16x32_bf16 v[48:51], a[144:147], v[168:171], v[48:51]
v_exp_f32 v12, v12
v_mfma_f32_16x16x32_bf16 v[56:59], a[144:147], v[184:187], v[144:147]
v_mfma_f32_16x16x32_bf16 v[56:59], a[148:151], v[188:191], v[56:59]
v_exp_f32 v13, v13
v_mfma_f32_16x16x32_bf16 v[56:59], a[152:155], v[192:195], v[56:59]
v_cvt_pk_bf16_f32 v74, v12, v13
v_mfma_f32_16x16x32_bf16 v[56:59], a[156:159], v[196:199], v[56:59]
v_exp_f32 v14, v14
v_mfma_f32_16x16x32_bf16 v[64:67], a[156:159], v[212:215], v[148:151]
s_waitcnt vmcnt(10) lgkmcnt(0)
s_barrier
v_mfma_f32_16x16x32_bf16 v[64:67], a[152:155], v[208:211], v[64:67]
v_exp_f32 v15, v15
v_mfma_f32_16x16x32_bf16 v[64:67], a[148:151], v[204:207], v[64:67]
ds_read_b128 a[156:159], v219 offset:16384
v_cvt_pk_bf16_f32 v75, v14, v15
v_mfma_f32_16x16x32_bf16 v[64:67], a[144:147], v[200:203], v[64:67]
v_exp_f32 v16, v16
v_mfma_f32_16x16x32_bf16 a[0:3], a[176:179], v[88:91], a[0:3]
ds_read_b128 a[152:155], v218 offset:16384
ds_read_b128 a[148:151], v217 offset:16384
v_mfma_f32_16x16x32_bf16 a[4:7], a[176:179], v[92:95], a[4:7]
v_exp_f32 v17, v17
v_mfma_f32_16x16x32_bf16 a[8:11], a[176:179], v[96:99], a[8:11]
ds_read_b128 a[144:147], v216 offset:16384
v_cvt_pk_bf16_f32 v76, v16, v17
v_mfma_f32_16x16x32_bf16 a[12:15], a[176:179], v[100:103], a[12:15]
v_exp_f32 v18, v18
v_mfma_f32_16x16x32_bf16 a[28:31], a[180:183], v[100:103], a[28:31]
ds_read_b64_tr_b16 a[176:177], v220 offset:0
ds_read_b64_tr_b16 a[178:179], v220 offset:4096
v_mfma_f32_16x16x32_bf16 a[24:27], a[180:183], v[96:99], a[24:27]
v_exp_f32 v19, v19
v_mfma_f32_16x16x32_bf16 a[20:23], a[180:183], v[92:95], a[20:23]
s_add_u32 s32, s32, 16384
v_cvt_pk_bf16_f32 v77, v18, v19
v_mfma_f32_16x16x32_bf16 a[16:19], a[180:183], v[88:91], a[16:19]
v_exp_f32 v20, v20
v_mfma_f32_16x16x32_bf16 a[32:35], a[184:187], v[88:91], a[32:35]
ds_read_b64_tr_b16 a[180:181], v221 offset:0
ds_read_b64_tr_b16 a[182:183], v221 offset:4096
v_mfma_f32_16x16x32_bf16 a[36:39], a[184:187], v[92:95], a[36:39]
v_exp_f32 v21, v21
v_mfma_f32_16x16x32_bf16 a[40:43], a[184:187], v[96:99], a[40:43]
s_bitset0_b32 s32, 19
v_cvt_pk_bf16_f32 v78, v20, v21
v_mfma_f32_16x16x32_bf16 a[44:47], a[184:187], v[100:103], a[44:47]
v_exp_f32 v22, v22
v_mfma_f32_16x16x32_bf16 a[60:63], a[188:191], v[100:103], a[60:63]
ds_read_b64_tr_b16 a[184:185], v222 offset:0
ds_read_b64_tr_b16 a[186:187], v222 offset:4096
v_mfma_f32_16x16x32_bf16 a[56:59], a[188:191], v[96:99], a[56:59]
v_exp_f32 v23, v23
v_mfma_f32_16x16x32_bf16 a[52:55], a[188:191], v[92:95], a[52:55]
s_add_u32 m0, s30, 65536
v_cvt_pk_bf16_f32 v79, v22, v23
v_mfma_f32_16x16x32_bf16 a[48:51], a[188:191], v[88:91], a[48:51]
v_exp_f32 v24, v24
v_smfmac_f32_16x16x64_bf16 a[128:131], a[208:211], v[88:95], v245
ds_read_b64_tr_b16 a[188:189], v223 offset:0
v_mfma_f32_16x16x32_bf16 v[44:47], a[160:163], v[152:155], v[136:139]
v_exp_f32 v25, v25
v_mfma_f32_16x16x32_bf16 v[44:47], a[164:167], v[156:159], v[44:47]
v_exp_f32 v26, v26
v_mfma_f32_16x16x32_bf16 v[44:47], a[168:171], v[160:163], v[44:47]
ds_read_b64_tr_b16 a[190:191], v223 offset:4096
v_cvt_pk_bf16_f32 v80, v24, v25
v_mfma_f32_16x16x32_bf16 v[44:47], a[172:175], v[164:167], v[44:47]
v_exp_f32 v27, v27
v_mfma_f32_16x16x32_bf16 v[52:55], a[172:175], v[180:183], v[140:143]
v_cvt_pk_bf16_f32 v81, v26, v27
v_mfma_f32_16x16x32_bf16 v[52:55], a[168:171], v[176:179], v[52:55]
v_exp_f32 v28, v28
v_mfma_f32_16x16x32_bf16 v[52:55], a[164:167], v[172:175], v[52:55]
buffer_load_dwordx4 v228, s[8:11], s32 offen offset:0  lds
v_mfma_f32_16x16x32_bf16 v[52:55], a[160:163], v[168:171], v[52:55]
v_exp_f32 v29, v29
v_mfma_f32_16x16x32_bf16 v[60:63], a[160:163], v[184:187], v[144:147]
v_cvt_pk_bf16_f32 v82, v28, v29
v_mfma_f32_16x16x32_bf16 v[60:63], a[164:167], v[188:191], v[60:63]
v_exp_f32 v30, v30
v_mfma_f32_16x16x32_bf16 v[60:63], a[168:171], v[192:195], v[60:63]
buffer_load_dwordx4 v229, s[8:11], s32 offen offset:1024  lds
v_mfma_f32_16x16x32_bf16 v[60:63], a[172:175], v[196:199], v[60:63]
v_exp_f32 v31, v31
v_mfma_f32_16x16x32_bf16 v[68:71], a[172:175], v[212:215], v[148:151]
ds_read_b128 a[172:175], v219 offset:20480
v_cvt_pk_bf16_f32 v83, v30, v31
v_mfma_f32_16x16x32_bf16 v[68:71], a[168:171], v[208:211], v[68:71]
v_exp_f32 v32, v32
v_mfma_f32_16x16x32_bf16 v[68:71], a[164:167], v[204:207], v[68:71]
ds_read_b128 a[168:171], v218 offset:20480
ds_read_b128 a[164:167], v217 offset:20480
v_mfma_f32_16x16x32_bf16 v[68:71], a[160:163], v[200:203], v[68:71]
v_exp_f32 v33, v33
v_mfma_f32_16x16x32_bf16 a[64:67], a[192:195], v[88:91], a[64:67]
ds_read_b128 a[160:163], v216 offset:20480
v_cvt_pk_bf16_f32 v84, v32, v33
v_mfma_f32_16x16x32_bf16 a[68:71], a[192:195], v[92:95], a[68:71]
v_exp_f32 v34, v34
v_mfma_f32_16x16x32_bf16 a[72:75], a[192:195], v[96:99], a[72:75]
buffer_load_dwordx4 v230, s[8:11], s32 offen offset:2048  lds
v_mfma_f32_16x16x32_bf16 a[76:79], a[192:195], v[100:103], a[76:79]
v_exp_f32 v35, v35
v_mfma_f32_16x16x32_bf16 a[92:95], a[196:199], v[100:103], a[92:95]
ds_read_b64_tr_b16 a[192:193], v224 offset:0
v_cvt_pk_bf16_f32 v85, v34, v35
v_mfma_f32_16x16x32_bf16 a[88:91], a[196:199], v[96:99], a[88:91]
v_exp_f32 v36, v36
v_mfma_f32_16x16x32_bf16 a[84:87], a[196:199], v[92:95], a[84:87]
ds_read_b64_tr_b16 a[194:195], v224 offset:4096
v_mfma_f32_16x16x32_bf16 a[80:83], a[196:199], v[88:91], a[80:83]
v_exp_f32 v37, v37
v_mfma_f32_16x16x32_bf16 a[96:99], a[200:203], v[88:91], a[96:99]
ds_read_b64_tr_b16 a[196:197], v225 offset:0
v_cvt_pk_bf16_f32 v86, v36, v37
v_mfma_f32_16x16x32_bf16 a[100:103], a[200:203], v[92:95], a[100:103]
v_exp_f32 v38, v38
v_mfma_f32_16x16x32_bf16 a[104:107], a[200:203], v[96:99], a[104:107]
ds_read_b64_tr_b16 a[198:199], v225 offset:4096
v_mfma_f32_16x16x32_bf16 a[108:111], a[200:203], v[100:103], a[108:111]
v_exp_f32 v39, v39
v_mfma_f32_16x16x32_bf16 a[124:127], a[204:207], v[100:103], a[124:127]
ds_read_b64_tr_b16 a[200:201], v226 offset:0
v_cvt_pk_bf16_f32 v87, v38, v39
v_mfma_f32_16x16x32_bf16 a[120:123], a[204:207], v[96:99], a[120:123]
ds_read_b64_tr_b16 a[202:203], v226 offset:4096
v_mfma_f32_16x16x32_bf16 a[116:119], a[204:207], v[92:95], a[116:119]
buffer_load_dwordx4 v231, s[8:11], s32 offen offset:3072  lds
v_mfma_f32_16x16x32_bf16 a[112:115], a[204:207], v[88:91], a[112:115]
ds_read_b64_tr_b16 a[204:205], v227 offset:0
ds_read_b64_tr_b16 a[206:207], v227 offset:4096
v_smfmac_f32_16x16x64_bf16 a[132:135], a[208:211], v[96:103], v245
s_mov_b32 m0, s87
s_lshl2_add_u32 s50, s87, s89
buffer_load_dwordx4 v243, s[56:59], s50 offen  lds
s_add_u32 s87, s87, 3456
s_min_u32 s87, s87, 63936
s_waitcnt lgkmcnt(8)
v_mfma_f32_16x16x32_bf16 v[8:11], a[144:147], v[152:155], v[136:139]
v_exp_f32 v40, v40
v_mfma_f32_16x16x32_bf16 v[8:11], a[148:151], v[156:159], v[8:11]
v_exp_f32 v41, v41
v_mfma_f32_16x16x32_bf16 v[8:11], a[152:155], v[160:163], v[8:11]
v_cvt_pk_bf16_f32 v88, v40, v41
v_mfma_f32_16x16x32_bf16 v[8:11], a[156:159], v[164:167], v[8:11]
v_exp_f32 v42, v42
v_mfma_f32_16x16x32_bf16 v[16:19], a[156:159], v[180:183], v[140:143]
s_add_u32 s39, s39, 16384
v_mfma_f32_16x16x32_bf16 v[16:19], a[152:155], v[176:179], v[16:19]
v_exp_f32 v43, v43
v_mfma_f32_16x16x32_bf16 v[16:19], a[148:151], v[172:175], v[16:19]
v_cvt_pk_bf16_f32 v89, v42, v43
v_mfma_f32_16x16x32_bf16 v[16:19], a[144:147], v[168:171], v[16:19]
v_exp_f32 v44, v44
v_mfma_f32_16x16x32_bf16 v[24:27], a[144:147], v[184:187], v[144:147]
s_bitset0_b32 s39, 19
v_mfma_f32_16x16x32_bf16 v[24:27], a[148:151], v[188:191], v[24:27]
v_exp_f32 v45, v45
v_mfma_f32_16x16x32_bf16 v[24:27], a[152:155], v[192:195], v[24:27]
v_cvt_pk_bf16_f32 v90, v44, v45
v_mfma_f32_16x16x32_bf16 v[24:27], a[156:159], v[196:199], v[24:27]
v_exp_f32 v46, v46
v_mfma_f32_16x16x32_bf16 v[32:35], a[156:159], v[212:215], v[148:151]
ds_read_b128 a[156:159], v219 offset:24576
v_mfma_f32_16x16x32_bf16 v[32:35], a[152:155], v[208:211], v[32:35]
v_exp_f32 v47, v47
v_mfma_f32_16x16x32_bf16 v[32:35], a[148:151], v[204:207], v[32:35]
ds_read_b128 a[152:155], v218 offset:24576
v_cvt_pk_bf16_f32 v91, v46, v47
v_mfma_f32_16x16x32_bf16 v[32:35], a[144:147], v[200:203], v[32:35]
v_exp_f32 v48, v48
v_mfma_f32_16x16x32_bf16 a[0:3], a[176:179], v[72:75], a[0:3]
ds_read_b128 a[148:151], v217 offset:24576
ds_read_b128 a[144:147], v216 offset:24576
v_mfma_f32_16x16x32_bf16 a[4:7], a[176:179], v[76:79], a[4:7]
v_exp_f32 v49, v49
v_mfma_f32_16x16x32_bf16 a[8:11], a[176:179], v[80:83], a[8:11]
s_add_u32 m0, s30, 147456
v_cvt_pk_bf16_f32 v92, v48, v49
v_mfma_f32_16x16x32_bf16 a[12:15], a[176:179], v[84:87], a[12:15]
v_exp_f32 v50, v50
v_mfma_f32_16x16x32_bf16 a[28:31], a[180:183], v[84:87], a[28:31]
ds_read_b64_tr_b16 a[176:177], v220 offset:8192
ds_read_b64_tr_b16 a[178:179], v220 offset:12288
v_mfma_f32_16x16x32_bf16 a[24:27], a[180:183], v[80:83], a[24:27]
v_exp_f32 v51, v51
v_mfma_f32_16x16x32_bf16 a[20:23], a[180:183], v[76:79], a[20:23]
v_cvt_pk_bf16_f32 v93, v50, v51
v_mfma_f32_16x16x32_bf16 a[16:19], a[180:183], v[72:75], a[16:19]
v_exp_f32 v52, v52
v_mfma_f32_16x16x32_bf16 a[32:35], a[184:187], v[72:75], a[32:35]
ds_read_b64_tr_b16 a[180:181], v221 offset:8192
ds_read_b64_tr_b16 a[182:183], v221 offset:12288
v_mfma_f32_16x16x32_bf16 a[36:39], a[184:187], v[76:79], a[36:39]
v_exp_f32 v53, v53
v_mfma_f32_16x16x32_bf16 a[40:43], a[184:187], v[80:83], a[40:43]
v_cvt_pk_bf16_f32 v94, v52, v53
v_mfma_f32_16x16x32_bf16 a[44:47], a[184:187], v[84:87], a[44:47]
v_exp_f32 v54, v54
v_mfma_f32_16x16x32_bf16 a[60:63], a[188:191], v[84:87], a[60:63]
ds_read_b64_tr_b16 a[184:185], v222 offset:8192
ds_read_b64_tr_b16 a[186:187], v222 offset:12288
v_mfma_f32_16x16x32_bf16 a[56:59], a[188:191], v[80:83], a[56:59]
v_exp_f32 v55, v55
v_mfma_f32_16x16x32_bf16 a[52:55], a[188:191], v[76:79], a[52:55]
v_cvt_pk_bf16_f32 v95, v54, v55
v_mfma_f32_16x16x32_bf16 a[48:51], a[188:191], v[72:75], a[48:51]
v_exp_f32 v56, v56
v_smfmac_f32_16x16x64_bf16 a[128:131], a[208:211], v[72:79], v245
ds_read_b64_tr_b16 a[188:189], v223 offset:8192
v_mfma_f32_16x16x32_bf16 v[12:15], a[160:163], v[152:155], v[136:139]
v_exp_f32 v57, v57
v_mfma_f32_16x16x32_bf16 v[12:15], a[164:167], v[156:159], v[12:15]
v_exp_f32 v58, v58
v_mfma_f32_16x16x32_bf16 v[12:15], a[168:171], v[160:163], v[12:15]
ds_read_b64_tr_b16 a[190:191], v223 offset:12288
v_cvt_pk_bf16_f32 v96, v56, v57
v_mfma_f32_16x16x32_bf16 v[12:15], a[172:175], v[164:167], v[12:15]
v_exp_f32 v59, v59
v_mfma_f32_16x16x32_bf16 v[20:23], a[172:175], v[180:183], v[140:143]
v_cvt_pk_bf16_f32 v97, v58, v59
v_mfma_f32_16x16x32_bf16 v[20:23], a[168:171], v[176:179], v[20:23]
v_exp_f32 v60, v60
v_mfma_f32_16x16x32_bf16 v[20:23], a[164:167], v[172:175], v[20:23]
buffer_load_dwordx4 v232, s[12:15], s39 offen offset:0  lds
v_mfma_f32_16x16x32_bf16 v[20:23], a[160:163], v[168:171], v[20:23]
v_exp_f32 v61, v61
v_mfma_f32_16x16x32_bf16 v[28:31], a[160:163], v[184:187], v[144:147]
v_cvt_pk_bf16_f32 v98, v60, v61
v_mfma_f32_16x16x32_bf16 v[28:31], a[164:167], v[188:191], v[28:31]
v_exp_f32 v62, v62
v_mfma_f32_16x16x32_bf16 v[28:31], a[168:171], v[192:195], v[28:31]
buffer_load_dwordx4 v233, s[12:15], s39 offen offset:1024  lds
v_mfma_f32_16x16x32_bf16 v[28:31], a[172:175], v[196:199], v[28:31]
v_exp_f32 v63, v63
v_mfma_f32_16x16x32_bf16 v[36:39], a[172:175], v[212:215], v[148:151]
ds_read_b128 a[172:175], v219 offset:28672
v_cvt_pk_bf16_f32 v99, v62, v63
v_mfma_f32_16x16x32_bf16 v[36:39], a[168:171], v[208:211], v[36:39]
v_exp_f32 v64, v64
v_mfma_f32_16x16x32_bf16 v[36:39], a[164:167], v[204:207], v[36:39]
ds_read_b128 a[168:171], v218 offset:28672
ds_read_b128 a[164:167], v217 offset:28672
v_mfma_f32_16x16x32_bf16 v[36:39], a[160:163], v[200:203], v[36:39]
v_exp_f32 v65, v65
s_waitcnt lgkmcnt(8)
v_mfma_f32_16x16x32_bf16 a[64:67], a[192:195], v[72:75], a[64:67]
ds_read_b128 a[160:163], v216 offset:28672
v_cvt_pk_bf16_f32 v100, v64, v65
v_mfma_f32_16x16x32_bf16 a[68:71], a[192:195], v[76:79], a[68:71]
v_exp_f32 v66, v66
v_mfma_f32_16x16x32_bf16 a[72:75], a[192:195], v[80:83], a[72:75]
buffer_load_dwordx4 v232, s[12:15], s39 offen offset:2048  lds
v_mfma_f32_16x16x32_bf16 a[76:79], a[192:195], v[84:87], a[76:79]
v_exp_f32 v67, v67
v_mfma_f32_16x16x32_bf16 a[92:95], a[196:199], v[84:87], a[92:95]
ds_read_b64_tr_b16 a[192:193], v224 offset:8192
v_cvt_pk_bf16_f32 v101, v66, v67
v_mfma_f32_16x16x32_bf16 a[88:91], a[196:199], v[80:83], a[88:91]
v_exp_f32 v68, v68
v_mfma_f32_16x16x32_bf16 a[84:87], a[196:199], v[76:79], a[84:87]
ds_read_b64_tr_b16 a[194:195], v224 offset:12288
v_mfma_f32_16x16x32_bf16 a[80:83], a[196:199], v[72:75], a[80:83]
v_exp_f32 v69, v69
v_mfma_f32_16x16x32_bf16 a[96:99], a[200:203], v[72:75], a[96:99]
ds_read_b64_tr_b16 a[196:197], v225 offset:8192
v_cvt_pk_bf16_f32 v102, v68, v69
v_mfma_f32_16x16x32_bf16 a[100:103], a[200:203], v[76:79], a[100:103]
v_exp_f32 v70, v70
v_mfma_f32_16x16x32_bf16 a[104:107], a[200:203], v[80:83], a[104:107]
ds_read_b64_tr_b16 a[198:199], v225 offset:12288
v_mfma_f32_16x16x32_bf16 a[108:111], a[200:203], v[84:87], a[108:111]
v_exp_f32 v71, v71
v_mfma_f32_16x16x32_bf16 a[124:127], a[204:207], v[84:87], a[124:127]
ds_read_b64_tr_b16 a[200:201], v226 offset:8192
v_cvt_pk_bf16_f32 v103, v70, v71
v_mfma_f32_16x16x32_bf16 a[120:123], a[204:207], v[80:83], a[120:123]
ds_read_b64_tr_b16 a[202:203], v226 offset:12288
v_mfma_f32_16x16x32_bf16 a[116:119], a[204:207], v[76:79], a[116:119]
buffer_load_dwordx4 v233, s[12:15], s39 offen offset:3072  lds
v_mfma_f32_16x16x32_bf16 a[112:115], a[204:207], v[72:75], a[112:115]
ds_read_b64_tr_b16 a[204:205], v227 offset:8192
ds_read_b64_tr_b16 a[206:207], v227 offset:12288
v_smfmac_f32_16x16x64_bf16 a[132:135], a[208:211], v[80:87], v245
buffer_load_dword v242, v241, s[20:23], s46 offen sc1
v_add_u32 v241, 1024, v241
v_and_b32 v241, 0x3fff, v241
v_mfma_f32_16x16x32_bf16 v[40:43], a[144:147], v[152:155], v[136:139]
v_exp_f32 v8, v8
v_mfma_f32_16x16x32_bf16 v[40:43], a[148:151], v[156:159], v[40:43]
v_exp_f32 v9, v9
v_mfma_f32_16x16x32_bf16 v[40:43], a[152:155], v[160:163], v[40:43]
v_cvt_pk_bf16_f32 v72, v8, v9
v_mfma_f32_16x16x32_bf16 v[40:43], a[156:159], v[164:167], v[40:43]
v_exp_f32 v10, v10
v_mfma_f32_16x16x32_bf16 v[48:51], a[156:159], v[180:183], v[140:143]
v_mfma_f32_16x16x32_bf16 v[48:51], a[152:155], v[176:179], v[48:51]
v_exp_f32 v11, v11
v_mfma_f32_16x16x32_bf16 v[48:51], a[148:151], v[172:175], v[48:51]
v_cvt_pk_bf16_f32 v73, v10, v11
v_mfma_f32_16x16x32_bf16 v[48:51], a[144:147], v[168:171], v[48:51]
v_exp_f32 v12, v12
v_mfma_f32_16x16x32_bf16 v[56:59], a[144:147], v[184:187], v[144:147]
v_mfma_f32_16x16x32_bf16 v[56:59], a[148:151], v[188:191], v[56:59]
v_exp_f32 v13, v13
v_mfma_f32_16x16x32_bf16 v[56:59], a[152:155], v[192:195], v[56:59]
v_cvt_pk_bf16_f32 v74, v12, v13
v_mfma_f32_16x16x32_bf16 v[56:59], a[156:159], v[196:199], v[56:59]
v_exp_f32 v14, v14
v_mfma_f32_16x16x32_bf16 v[64:67], a[156:159], v[212:215], v[148:151]
s_waitcnt vmcnt(10) lgkmcnt(0)
s_barrier
v_mfma_f32_16x16x32_bf16 v[64:67], a[152:155], v[208:211], v[64:67]
STUB_10:
STUB_B1:
s_cbranch_execz STUB_13
v_exp_f32 v15, v15
v_mfma_f32_16x16x32_bf16 v[64:67], a[148:151], v[204:207], v[64:67]
ds_read_b128 a[156:159], v219 offset:49152
v_cvt_pk_bf16_f32 v75, v14, v15
v_mfma_f32_16x16x32_bf16 v[64:67], a[144:147], v[200:203], v[64:67]
v_exp_f32 v16, v16
v_mfma_f32_16x16x32_bf16 a[0:3], a[176:179], v[88:91], a[0:3]
ds_read_b128 a[152:155], v218 offset:49152
ds_read_b128 a[148:151], v217 offset:49152
v_mfma_f32_16x16x32_bf16 a[4:7], a[176:179], v[92:95], a[4:7]
v_exp_f32 v17, v17
v_mfma_f32_16x16x32_bf16 a[8:11], a[176:179], v[96:99], a[8:11]
ds_read_b128 a[144:147], v216 offset:49152
v_cvt_pk_bf16_f32 v76, v16, v17
v_mfma_f32_16x16x32_bf16 a[12:15], a[176:179], v[100:103], a[12:15]
v_exp_f32 v18, v18
v_mfma_f32_16x16x32_bf16 a[28:31], a[180:183], v[100:103], a[28:31]
ds_read_b64_tr_b16 a[176:177], v220 offset:32768
ds_read_b64_tr_b16 a[178:179], v220 offset:36864
v_mfma_f32_16x16x32_bf16 a[24:27], a[180:183], v[96:99], a[24:27]
v_exp_f32 v19, v19
v_mfma_f32_16x16x32_bf16 a[20:23], a[180:183], v[92:95], a[20:23]
s_add_u32 s32, s32, 16384
v_cvt_pk_bf16_f32 v77, v18, v19
v_mfma_f32_16x16x32_bf16 a[16:19], a[180:183], v[88:91], a[16:19]
v_exp_f32 v20, v20
v_mfma_f32_16x16x32_bf16 a[32:35], a[184:187], v[88:91], a[32:35]
ds_read_b64_tr_b16 a[180:181], v221 offset:32768
ds_read_b64_tr_b16 a[182:183], v221 offset:36864
v_mfma_f32_16x16x32_bf16 a[36:39], a[184:187], v[92:95], a[36:39]
v_exp_f32 v21, v21
v_mfma_f32_16x16x32_bf16 a[40:43], a[184:187], v[96:99], a[40:43]
s_bitset0_b32 s32, 19
v_cvt_pk_bf16_f32 v78, v20, v21
v_mfma_f32_16x16x32_bf16 a[44:47], a[184:187], v[100:103], a[44:47]
v_exp_f32 v22, v22
v_mfma_f32_16x16x32_bf16 a[60:63], a[188:191], v[100:103], a[60:63]
ds_read_b64_tr_b16 a[184:185], v222 offset:32768
ds_read_b64_tr_b16 a[186:187], v222 offset:36864
v_mfma_f32_16x16x32_bf16 a[56:59], a[188:191], v[96:99], a[56:59]
v_exp_f32 v23, v23
v_mfma_f32_16x16x32_bf16 a[52:55], a[188:191], v[92:95], a[52:55]
s_add_u32 m0, s30, 81920
v_cvt_pk_bf16_f32 v79, v22, v23
v_mfma_f32_16x16x32_bf16 a[48:51], a[188:191], v[88:91], a[48:51]
v_exp_f32 v24, v24
v_smfmac_f32_16x16x64_bf16 a[128:131], a[208:211], v[88:95], v245
ds_read_b64_tr_b16 a[188:189], v223 offset:32768
v_mfma_f32_16x16x32_bf16 v[44:47], a[160:163], v[152:155], v[136:139]
v_exp_f32 v25, v25
v_mfma_f32_16x16x32_bf16 v[44:47], a[164:167], v[156:159], v[44:47]
v_exp_f32 v26, v26
v_mfma_f32_16x16x32_bf16 v[44:47], a[168:171], v[160:163], v[44:47]
ds_read_b64_tr_b16 a[190:191], v223 offset:36864
v_cvt_pk_bf16_f32 v80, v24, v25
v_mfma_f32_16x16x32_bf16 v[44:47], a[172:175], v[164:167], v[44:47]
v_exp_f32 v27, v27
v_mfma_f32_16x16x32_bf16 v[52:55], a[172:175], v[180:183], v[140:143]
v_cvt_pk_bf16_f32 v81, v26, v27
v_mfma_f32_16x16x32_bf16 v[52:55], a[168:171], v[176:179], v[52:55]
v_exp_f32 v28, v28
v_mfma_f32_16x16x32_bf16 v[52:55], a[164:167], v[172:175], v[52:55]
buffer_load_dwordx4 v228, s[8:11], s32 offen offset:0  lds
v_mfma_f32_16x16x32_bf16 v[52:55], a[160:163], v[168:171], v[52:55]
v_exp_f32 v29, v29
v_mfma_f32_16x16x32_bf16 v[60:63], a[160:163], v[184:187], v[144:147]
v_cvt_pk_bf16_f32 v82, v28, v29
v_mfma_f32_16x16x32_bf16 v[60:63], a[164:167], v[188:191], v[60:63]
v_exp_f32 v30, v30
v_mfma_f32_16x16x32_bf16 v[60:63], a[168:171], v[192:195], v[60:63]
buffer_load_dwordx4 v229, s[8:11], s32 offen offset:1024  lds
v_mfma_f32_16x16x32_bf16 v[60:63], a[172:175], v[196:199], v[60:63]
v_exp_f32 v31, v31
v_mfma_f32_16x16x32_bf16 v[68:71], a[172:175], v[212:215], v[148:151]
ds_read_b128 a[172:175], v219 offset:53248
v_cvt_pk_bf16_f32 v83, v30, v31
v_mfma_f32_16x16x32_bf16 v[68:71], a[168:171], v[208:211], v[68:71]
v_exp_f32 v32, v32
v_mfma_f32_16x16x32_bf16 v[68:71], a[164:167], v[204:207], v[68:71]
ds_read_b128 a[168:171], v218 offset:53248
ds_read_b128 a[164:167], v217 offset:53248
v_mfma_f32_16x16x32_bf16 v[68:71], a[160:163], v[200:203], v[68:71]
v_exp_f32 v33, v33
v_mfma_f32_16x16x32_bf16 a[64:67], a[192:195], v[88:91], a[64:67]
ds_read_b128 a[160:163], v216 offset:53248
v_cvt_pk_bf16_f32 v84, v32, v33
v_mfma_f32_16x16x32_bf16 a[68:71], a[192:195], v[92:95], a[68:71]
v_exp_f32 v34, v34
v_mfma_f32_16x16x32_bf16 a[72:75], a[192:195], v[96:99], a[72:75]
buffer_load_dwordx4 v230, s[8:11], s32 offen offset:2048  lds
v_mfma_f32_16x16x32_bf16 a[76:79], a[192:195], v[100:103], a[76:79]
v_exp_f32 v35, v35
v_mfma_f32_16x16x32_bf16 a[92:95], a[196:199], v[100:103], a[92:95]
ds_read_b64_tr_b16 a[192:193], v224 offset:32768
v_cvt_pk_bf16_f32 v85, v34, v35
v_mfma_f32_16x16x32_bf16 a[88:91], a[196:199], v[96:99], a[88:91]
v_exp_f32 v36, v36
v_mfma_f32_16x16x32_bf16 a[84:87], a[196:199], v[92:95], a[84:87]
ds_read_b64_tr_b16 a[194:195], v224 offset:36864
v_mfma_f32_16x16x32_bf16 a[80:83], a[196:199], v[88:91], a[80:83]
v_exp_f32 v37, v37
v_mfma_f32_16x16x32_bf16 a[96:99], a[200:203], v[88:91], a[96:99]
ds_read_b64_tr_b16 a[196:197], v225 offset:32768
v_cvt_pk_bf16_f32 v86, v36, v37
v_mfma_f32_16x16x32_bf16 a[100:103], a[200:203], v[92:95], a[100:103]
v_exp_f32 v38, v38
v_mfma_f32_16x16x32_bf16 a[104:107], a[200:203], v[96:99], a[104:107]
ds_read_b64_tr_b16 a[198:199], v225 offset:36864
v_mfma_f32_16x16x32_bf16 a[108:111], a[200:203], v[100:103], a[108:111]
v_exp_f32 v39, v39
v_mfma_f32_16x16x32_bf16 a[124:127], a[204:207], v[100:103], a[124:127]
ds_read_b64_tr_b16 a[200:201], v226 offset:32768
v_cvt_pk_bf16_f32 v87, v38, v39
v_mfma_f32_16x16x32_bf16 a[120:123], a[204:207], v[96:99], a[120:123]
ds_read_b64_tr_b16 a[202:203], v226 offset:36864
v_mfma_f32_16x16x32_bf16 a[116:119], a[204:207], v[92:95], a[116:119]
buffer_load_dwordx4 v231, s[8:11], s32 offen offset:3072  lds
v_mfma_f32_16x16x32_bf16 a[112:115], a[204:207], v[88:91], a[112:115]
ds_read_b64_tr_b16 a[204:205], v227 offset:32768
ds_read_b64_tr_b16 a[206:207], v227 offset:36864
v_smfmac_f32_16x16x64_bf16 a[132:135], a[208:211], v[96:103], v245
s_mov_b32 m0, s87
s_lshl2_add_u32 s50, s87, s89
buffer_load_dwordx4 v243, s[56:59], s50 offen  lds
s_add_u32 s87, s87, 3456
s_min_u32 s87, s87, 63936
s_waitcnt lgkmcnt(8)
v_mfma_f32_16x16x32_bf16 v[8:11], a[144:147], v[152:155], v[136:139]
v_exp_f32 v40, v40
v_mfma_f32_16x16x32_bf16 v[8:11], a[148:151], v[156:159], v[8:11]
v_exp_f32 v41, v41
v_mfma_f32_16x16x32_bf16 v[8:11], a[152:155], v[160:163], v[8:11]
v_cvt_pk_bf16_f32 v88, v40, v41
v_mfma_f32_16x16x32_bf16 v[8:11], a[156:159], v[164:167], v[8:11]
v_exp_f32 v42, v42
v_mfma_f32_16x16x32_bf16 v[16:19], a[156:159], v[180:183], v[140:143]
s_add_u32 s39, s39, 16384
v_mfma_f32_16x16x32_bf16 v[16:19], a[152:155], v[176:179], v[16:19]
v_exp_f32 v43, v43
v_mfma_f32_16x16x32_bf16 v[16:19], a[148:151], v[172:175], v[16:19]
v_cvt_pk_bf16_f32 v89, v42, v43
v_mfma_f32_16x16x32_bf16 v[16:19], a[144:147], v[168:171], v[16:19]
v_exp_f32 v44, v44
v_mfma_f32_16x16x32_bf16 v[24:27], a[144:147], v[184:187], v[144:147]
s_bitset0_b32 s39, 19
v_mfma_f32_16x16x32_bf16 v[24:27], a[148:151], v[188:191], v[24:27]
v_exp_f32 v45, v45
v_mfma_f32_16x16x32_bf16 v[24:27], a[152:155], v[192:195], v[24:27]
v_cvt_pk_bf16_f32 v90, v44, v45
v_mfma_f32_16x16x32_bf16 v[24:27], a[156:159], v[196:199], v[24:27]
v_exp_f32 v46, v46
v_mfma_f32_16x16x32_bf16 v[32:35], a[156:159], v[212:215], v[148:151]
ds_read_b128 a[156:159], v219 offset:57344
v_mfma_f32_16x16x32_bf16 v[32:35], a[152:155], v[208:211], v[32:35]
v_exp_f32 v47, v47
v_mfma_f32_16x16x32_bf16 v[32:35], a[148:151], v[204:207], v[32:35]
ds_read_b128 a[152:155], v218 offset:57344
v_cvt_pk_bf16_f32 v91, v46, v47
v_mfma_f32_16x16x32_bf16 v[32:35], a[144:147], v[200:203], v[32:35]
v_exp_f32 v48, v48
v_mfma_f32_16x16x32_bf16 a[0:3], a[176:179], v[72:75], a[0:3]
ds_read_b128 a[148:151], v217 offset:57344
ds_read_b128 a[144:147], v216 offset:57344
v_mfma_f32_16x16x32_bf16 a[4:7], a[176:179], v[76:79], a[4:7]
v_exp_f32 v49, v49
v_mfma_f32_16x16x32_bf16 a[8:11], a[176:179], v[80:83], a[8:11]
s_add_u32 m0, s30, 98304
v_cvt_pk_bf16_f32 v92, v48, v49
v_mfma_f32_16x16x32_bf16 a[12:15], a[176:179], v[84:87], a[12:15]
v_exp_f32 v50, v50
v_mfma_f32_16x16x32_bf16 a[28:31], a[180:183], v[84:87], a[28:31]
ds_read_b64_tr_b16 a[176:177], v220 offset:40960
ds_read_b64_tr_b16 a[178:179], v220 offset:45056
v_mfma_f32_16x16x32_bf16 a[24:27], a[180:183], v[80:83], a[24:27]
v_exp_f32 v51, v51
v_mfma_f32_16x16x32_bf16 a[20:23], a[180:183], v[76:79], a[20:23]
v_cvt_pk_bf16_f32 v93, v50, v51
v_mfma_f32_16x16x32_bf16 a[16:19], a[180:183], v[72:75], a[16:19]
v_exp_f32 v52, v52
v_mfma_f32_16x16x32_bf16 a[32:35], a[184:187], v[72:75], a[32:35]
ds_read_b64_tr_b16 a[180:181], v221 offset:40960
ds_read_b64_tr_b16 a[182:183], v221 offset:45056
v_mfma_f32_16x16x32_bf16 a[36:39], a[184:187], v[76:79], a[36:39]
v_exp_f32 v53, v53
v_mfma_f32_16x16x32_bf16 a[40:43], a[184:187], v[80:83], a[40:43]
v_cvt_pk_bf16_f32 v94, v52, v53
v_mfma_f32_16x16x32_bf16 a[44:47], a[184:187], v[84:87], a[44:47]
v_exp_f32 v54, v54
v_mfma_f32_16x16x32_bf16 a[60:63], a[188:191], v[84:87], a[60:63]
ds_read_b64_tr_b16 a[184:185], v222 offset:40960
ds_read_b64_tr_b16 a[186:187], v222 offset:45056
v_mfma_f32_16x16x32_bf16 a[56:59], a[188:191], v[80:83], a[56:59]
v_exp_f32 v55, v55
v_mfma_f32_16x16x32_bf16 a[52:55], a[188:191], v[76:79], a[52:55]
v_cvt_pk_bf16_f32 v95, v54, v55
v_mfma_f32_16x16x32_bf16 a[48:51], a[188:191], v[72:75], a[48:51]
v_exp_f32 v56, v56
v_smfmac_f32_16x16x64_bf16 a[128:131], a[208:211], v[72:79], v245
ds_read_b64_tr_b16 a[188:189], v223 offset:40960
v_mfma_f32_16x16x32_bf16 v[12:15], a[160:163], v[152:155], v[136:139]
v_exp_f32 v57, v57
v_mfma_f32_16x16x32_bf16 v[12:15], a[164:167], v[156:159], v[12:15]
v_exp_f32 v58, v58
v_mfma_f32_16x16x32_bf16 v[12:15], a[168:171], v[160:163], v[12:15]
ds_read_b64_tr_b16 a[190:191], v223 offset:45056
v_cvt_pk_bf16_f32 v96, v56, v57
v_mfma_f32_16x16x32_bf16 v[12:15], a[172:175], v[164:167], v[12:15]
v_exp_f32 v59, v59
v_mfma_f32_16x16x32_bf16 v[20:23], a[172:175], v[180:183], v[140:143]
v_cvt_pk_bf16_f32 v97, v58, v59
v_mfma_f32_16x16x32_bf16 v[20:23], a[168:171], v[176:179], v[20:23]
v_exp_f32 v60, v60
v_mfma_f32_16x16x32_bf16 v[20:23], a[164:167], v[172:175], v[20:23]
buffer_load_dwordx4 v232, s[12:15], s39 offen offset:0  lds
v_mfma_f32_16x16x32_bf16 v[20:23], a[160:163], v[168:171], v[20:23]
v_exp_f32 v61, v61
v_mfma_f32_16x16x32_bf16 v[28:31], a[160:163], v[184:187], v[144:147]
v_cvt_pk_bf16_f32 v98, v60, v61
v_mfma_f32_16x16x32_bf16 v[28:31], a[164:167], v[188:191], v[28:31]
v_exp_f32 v62, v62
v_mfma_f32_16x16x32_bf16 v[28:31], a[168:171], v[192:195], v[28:31]
buffer_load_dwordx4 v233, s[12:15], s39 offen offset:1024  lds
v_mfma_f32_16x16x32_bf16 v[28:31], a[172:175], v[196:199], v[28:31]
v_exp_f32 v63, v63
v_mfma_f32_16x16x32_bf16 v[36:39], a[172:175], v[212:215], v[148:151]
ds_read_b128 a[172:175], v219 offset:61440
v_cvt_pk_bf16_f32 v99, v62, v63
v_mfma_f32_16x16x32_bf16 v[36:39], a[168:171], v[208:211], v[36:39]
v_exp_f32 v64, v64
v_mfma_f32_16x16x32_bf16 v[36:39], a[164:167], v[204:207], v[36:39]
ds_read_b128 a[168:171], v218 offset:61440
ds_read_b128 a[164:167], v217 offset:61440
v_mfma_f32_16x16x32_bf16 v[36:39], a[160:163], v[200:203], v[36:39]
v_exp_f32 v65, v65
s_waitcnt lgkmcnt(8)
v_mfma_f32_16x16x32_bf16 a[64:67], a[192:195], v[72:75], a[64:67]
ds_read_b128 a[160:163], v216 offset:61440
v_cvt_pk_bf16_f32 v100, v64, v65
v_mfma_f32_16x16x32_bf16 a[68:71], a[192:195], v[76:79], a[68:71]
v_exp_f32 v66, v66
v_mfma_f32_16x16x32_bf16 a[72:75], a[192:195], v[80:83], a[72:75]
buffer_load_dwordx4 v232, s[12:15], s39 offen offset:2048  lds
v_mfma_f32_16x16x32_bf16 a[76:79], a[192:195], v[84:87], a[76:79]
v_exp_f32 v67, v67
v_mfma_f32_16x16x32_bf16 a[92:95], a[196:199], v[84:87], a[92:95]
ds_read_b64_tr_b16 a[192:193], v224 offset:40960
v_cvt_pk_bf16_f32 v101, v66, v67
v_mfma_f32_16x16x32_bf16 a[88:91], a[196:199], v[80:83], a[88:91]
v_exp_f32 v68, v68
v_mfma_f32_16x16x32_bf16 a[84:87], a[196:199], v[76:79], a[84:87]
ds_read_b64_tr_b16 a[194:195], v224 offset:45056
v_mfma_f32_16x16x32_bf16 a[80:83], a[196:199], v[72:75], a[80:83]
v_exp_f32 v69, v69
v_mfma_f32_16x16x32_bf16 a[96:99], a[200:203], v[72:75], a[96:99]
ds_read_b64_tr_b16 a[196:197], v225 offset:40960
v_cvt_pk_bf16_f32 v102, v68, v69
v_mfma_f32_16x16x32_bf16 a[100:103], a[200:203], v[76:79], a[100:103]
v_exp_f32 v70, v70
v_mfma_f32_16x16x32_bf16 a[104:107], a[200:203], v[80:83], a[104:107]
ds_read_b64_tr_b16 a[198:199], v225 offset:45056
v_mfma_f32_16x16x32_bf16 a[108:111], a[200:203], v[84:87], a[108:111]
v_exp_f32 v71, v71
v_mfma_f32_16x16x32_bf16 a[124:127], a[204:207], v[84:87], a[124:127]
ds_read_b64_tr_b16 a[200:201], v226 offset:40960
v_cvt_pk_bf16_f32 v103, v70, v71
v_mfma_f32_16x16x32_bf16 a[120:123], a[204:207], v[80:83], a[120:123]
ds_read_b64_tr_b16 a[202:203], v226 offset:45056
v_mfma_f32_16x16x32_bf16 a[116:119], a[204:207], v[76:79], a[116:119]
buffer_load_dwordx4 v233, s[12:15], s39 offen offset:3072  lds
v_mfma_f32_16x16x32_bf16 a[112:115], a[204:207], v[72:75], a[112:115]
ds_read_b64_tr_b16 a[204:205], v227 offset:40960
ds_read_b64_tr_b16 a[206:207], v227 offset:45056
v_smfmac_f32_16x16x64_bf16 a[132:135], a[208:211], v[80:87], v245
buffer_load_dword v242, v241, s[20:23], s46 offen sc1
v_add_u32 v241, 1024, v241
v_and_b32 v241, 0x3fff, v241
v_mfma_f32_16x16x32_bf16 v[40:43], a[144:147], v[152:155], v[136:139]
v_exp_f32 v8, v8
v_mfma_f32_16x16x32_bf16 v[40:43], a[148:151], v[156:159], v[40:43]
v_exp_f32 v9, v9
v_mfma_f32_16x16x32_bf16 v[40:43], a[152:155], v[160:163], v[40:43]
v_cvt_pk_bf16_f32 v72, v8, v9
v_mfma_f32_16x16x32_bf16 v[40:43], a[156:159], v[164:167], v[40:43]
v_exp_f32 v10, v10
v_mfma_f32_16x16x32_bf16 v[48:51], a[156:159], v[180:183], v[140:143]
v_mfma_f32_16x16x32_bf16 v[48:51], a[152:155], v[176:179], v[48:51]
v_exp_f32 v11, v11
v_mfma_f32_16x16x32_bf16 v[48:51], a[148:151], v[172:175], v[48:51]
v_cvt_pk_bf16_f32 v73, v10, v11
v_mfma_f32_16x16x32_bf16 v[48:51], a[144:147], v[168:171], v[48:51]
v_exp_f32 v12, v12
v_mfma_f32_16x16x32_bf16 v[56:59], a[144:147], v[184:187], v[144:147]
v_mfma_f32_16x16x32_bf16 v[56:59], a[148:151], v[188:191], v[56:59]
v_exp_f32 v13, v13
v_mfma_f32_16x16x32_bf16 v[56:59], a[152:155], v[192:195], v[56:59]
v_cvt_pk_bf16_f32 v74, v12, v13
v_mfma_f32_16x16x32_bf16 v[56:59], a[156:159], v[196:199], v[56:59]
v_exp_f32 v14, v14
v_mfma_f32_16x16x32_bf16 v[64:67], a[156:159], v[212:215], v[148:151]
s_waitcnt vmcnt(10) lgkmcnt(0)
s_barrier
v_mfma_f32_16x16x32_bf16 v[64:67], a[152:155], v[208:211], v[64:67]
v_exp_f32 v15, v15
v_mfma_f32_16x16x32_bf16 v[64:67], a[148:151], v[204:207], v[64:67]
ds_read_b128 a[156:159], v219 offset:0
v_cvt_pk_bf16_f32 v75, v14, v15
v_mfma_f32_16x16x32_bf16 v[64:67], a[144:147], v[200:203], v[64:67]
v_exp_f32 v16, v16
v_mfma_f32_16x16x32_bf16 a[0:3], a[176:179], v[88:91], a[0:3]
ds_read_b128 a[152:155], v218 offset:0
ds_read_b128 a[148:151], v217 offset:0
v_mfma_f32_16x16x32_bf16 a[4:7], a[176:179], v[92:95], a[4:7]
v_exp_f32 v17, v17
v_mfma_f32_16x16x32_bf16 a[8:11], a[176:179], v[96:99], a[8:11]
ds_read_b128 a[144:147], v216 offset:0
v_cvt_pk_bf16_f32 v76, v16, v17
v_mfma_f32_16x16x32_bf16 a[12:15], a[176:179], v[100:103], a[12:15]
v_exp_f32 v18, v18
v_mfma_f32_16x16x32_bf16 a[28:31], a[180:183], v[100:103], a[28:31]
ds_read_b64_tr_b16 a[176:177], v220 offset:49152
ds_read_b64_tr_b16 a[178:179], v220 offset:53248
v_mfma_f32_16x16x32_bf16 a[24:27], a[180:183], v[96:99], a[24:27]
v_exp_f32 v19, v19
v_mfma_f32_16x16x32_bf16 a[20:23], a[180:183], v[92:95], a[20:23]
s_add_u32 s32, s32, 16384
v_cvt_pk_bf16_f32 v77, v18, v19
v_mfma_f32_16x16x32_bf16 a[16:19], a[180:183], v[88:91], a[16:19]
v_exp_f32 v20, v20
v_mfma_f32_16x16x32_bf16 a[32:35], a[184:187], v[88:91], a[32:35]
ds_read_b64_tr_b16 a[180:181], v221 offset:49152
ds_read_b64_tr_b16 a[182:183], v221 offset:53248
v_mfma_f32_16x16x32_bf16 a[36:39], a[184:187], v[92:95], a[36:39]
v_exp_f32 v21, v21
v_mfma_f32_16x16x32_bf16 a[40:43], a[184:187], v[96:99], a[40:43]
s_bitset0_b32 s32, 19
v_cvt_pk_bf16_f32 v78, v20, v21
v_mfma_f32_16x16x32_bf16 a[44:47], a[184:187], v[100:103], a[44:47]
v_exp_f32 v22, v22
v_mfma_f32_16x16x32_bf16 a[60:63], a[188:191], v[100:103], a[60:63]
ds_read_b64_tr_b16 a[184:185], v222 offset:49152
ds_read_b64_tr_b16 a[186:187], v222 offset:53248
v_mfma_f32_16x16x32_bf16 a[56:59], a[188:191], v[96:99], a[56:59]
v_exp_f32 v23, v23
v_mfma_f32_16x16x32_bf16 a[52:55], a[188:191], v[92:95], a[52:55]
s_add_u32 m0, s30, 114688
v_cvt_pk_bf16_f32 v79, v22, v23
v_mfma_f32_16x16x32_bf16 a[48:51], a[188:191], v[88:91], a[48:51]
v_exp_f32 v24, v24
v_smfmac_f32_16x16x64_bf16 a[128:131], a[208:211], v[88:95], v245
ds_read_b64_tr_b16 a[188:189], v223 offset:49152
v_mfma_f32_16x16x32_bf16 v[44:47], a[160:163], v[152:155], v[136:139]
v_exp_f32 v25, v25
v_mfma_f32_16x16x32_bf16 v[44:47], a[164:167], v[156:159], v[44:47]
v_exp_f32 v26, v26
v_mfma_f32_16x16x32_bf16 v[44:47], a[168:171], v[160:163], v[44:47]
ds_read_b64_tr_b16 a[190:191], v223 offset:53248
v_cvt_pk_bf16_f32 v80, v24, v25
v_mfma_f32_16x16x32_bf16 v[44:47], a[172:175], v[164:167], v[44:47]
v_exp_f32 v27, v27
v_mfma_f32_16x16x32_bf16 v[52:55], a[172:175], v[180:183], v[140:143]
v_cvt_pk_bf16_f32 v81, v26, v27
v_mfma_f32_16x16x32_bf16 v[52:55], a[168:171], v[176:179], v[52:55]
v_exp_f32 v28, v28
v_mfma_f32_16x16x32_bf16 v[52:55], a[164:167], v[172:175], v[52:55]
buffer_load_dwordx4 v228, s[8:11], s32 offen offset:0  lds
v_mfma_f32_16x16x32_bf16 v[52:55], a[160:163], v[168:171], v[52:55]
v_exp_f32 v29, v29
v_mfma_f32_16x16x32_bf16 v[60:63], a[160:163], v[184:187], v[144:147]
v_cvt_pk_bf16_f32 v82, v28, v29
v_mfma_f32_16x16x32_bf16 v[60:63], a[164:167], v[188:191], v[60:63]
v_exp_f32 v30, v30
v_mfma_f32_16x16x32_bf16 v[60:63], a[168:171], v[192:195], v[60:63]
buffer_load_dwordx4 v229, s[8:11], s32 offen offset:1024  lds
v_mfma_f32_16x16x32_bf16 v[60:63], a[172:175], v[196:199], v[60:63]
v_exp_f32 v31, v31
v_mfma_f32_16x16x32_bf16 v[68:71], a[172:175], v[212:215], v[148:151]
ds_read_b128 a[172:175], v219 offset:4096
v_cvt_pk_bf16_f32 v83, v30, v31
v_mfma_f32_16x16x32_bf16 v[68:71], a[168:171], v[208:211], v[68:71]
v_exp_f32 v32, v32
v_mfma_f32_16x16x32_bf16 v[68:71], a[164:167], v[204:207], v[68:71]
ds_read_b128 a[168:171], v218 offset:4096
ds_read_b128 a[164:167], v217 offset:4096
v_mfma_f32_16x16x32_bf16 v[68:71], a[160:163], v[200:203], v[68:71]
v_exp_f32 v33, v33
v_mfma_f32_16x16x32_bf16 a[64:67], a[192:195], v[88:91], a[64:67]
ds_read_b128 a[160:163], v216 offset:4096
v_cvt_pk_bf16_f32 v84, v32, v33
v_mfma_f32_16x16x32_bf16 a[68:71], a[192:195], v[92:95], a[68:71]
v_exp_f32 v34, v34
v_mfma_f32_16x16x32_bf16 a[72:75], a[192:195], v[96:99], a[72:75]
buffer_load_dwordx4 v230, s[8:11], s32 offen offset:2048  lds
v_mfma_f32_16x16x32_bf16 a[76:79], a[192:195], v[100:103], a[76:79]
v_exp_f32 v35, v35
v_mfma_f32_16x16x32_bf16 a[92:95], a[196:199], v[100:103], a[92:95]
ds_read_b64_tr_b16 a[192:193], v224 offset:49152
v_cvt_pk_bf16_f32 v85, v34, v35
v_mfma_f32_16x16x32_bf16 a[88:91], a[196:199], v[96:99], a[88:91]
v_exp_f32 v36, v36
v_mfma_f32_16x16x32_bf16 a[84:87], a[196:199], v[92:95], a[84:87]
ds_read_b64_tr_b16 a[194:195], v224 offset:53248
v_mfma_f32_16x16x32_bf16 a[80:83], a[196:199], v[88:91], a[80:83]
v_exp_f32 v37, v37
v_mfma_f32_16x16x32_bf16 a[96:99], a[200:203], v[88:91], a[96:99]
ds_read_b64_tr_b16 a[196:197], v225 offset:49152
v_cvt_pk_bf16_f32 v86, v36, v37
v_mfma_f32_16x16x32_bf16 a[100:103], a[200:203], v[92:95], a[100:103]
v_exp_f32 v38, v38
v_mfma_f32_16x16x32_bf16 a[104:107], a[200:203], v[96:99], a[104:107]
ds_read_b64_tr_b16 a[198:199], v225 offset:53248
v_mfma_f32_16x16x32_bf16 a[108:111], a[200:203], v[100:103], a[108:111]
v_exp_f32 v39, v39
v_mfma_f32_16x16x32_bf16 a[124:127], a[204:207], v[100:103], a[124:127]
ds_read_b64_tr_b16 a[200:201], v226 offset:49152
v_cvt_pk_bf16_f32 v87, v38, v39
v_mfma_f32_16x16x32_bf16 a[120:123], a[204:207], v[96:99], a[120:123]
ds_read_b64_tr_b16 a[202:203], v226 offset:53248
v_mfma_f32_16x16x32_bf16 a[116:119], a[204:207], v[92:95], a[116:119]
buffer_load_dwordx4 v231, s[8:11], s32 offen offset:3072  lds
v_mfma_f32_16x16x32_bf16 a[112:115], a[204:207], v[88:91], a[112:115]
ds_read_b64_tr_b16 a[204:205], v227 offset:49152
ds_read_b64_tr_b16 a[206:207], v227 offset:53248
v_smfmac_f32_16x16x64_bf16 a[132:135], a[208:211], v[96:103], v245
s_mov_b32 m0, s87
s_lshl2_add_u32 s50, s87, s89
buffer_load_dwordx4 v243, s[56:59], s50 offen  lds
s_add_u32 s87, s87, 3456
s_min_u32 s87, s87, 63936
s_waitcnt lgkmcnt(8)
v_mfma_f32_16x16x32_bf16 v[8:11], a[144:147], v[152:155], v[136:139]
v_exp_f32 v40, v40
v_mfma_f32_16x16x32_bf16 v[8:11], a[148:151], v[156:159], v[8:11]
v_exp_f32 v41, v41
v_mfma_f32_16x16x32_bf16 v[8:11], a[152:155], v[160:163], v[8:11]
v_cvt_pk_bf16_f32 v88, v40, v41
v_mfma_f32_16x16x32_bf16 v[8:11], a[156:159], v[164:167], v[8:11]
v_exp_f32 v42, v42
v_mfma_f32_16x16x32_bf16 v[16:19], a[156:159], v[180:183], v[140:143]
s_add_u32 s39, s39, 16384
v_mfma_f32_16x16x32_bf16 v[16:19], a[152:155], v[176:179], v[16:19]
v_exp_f32 v43, v43
v_mfma_f32_16x16x32_bf16 v[16:19], a[148:151], v[172:175], v[16:19]
v_cvt_pk_bf16_f32 v89, v42, v43
v_mfma_f32_16x16x32_bf16 v[16:19], a[144:147], v[168:171], v[16:19]
v_exp_f32 v44, v44
v_mfma_f32_16x16x32_bf16 v[24:27], a[144:147], v[184:187], v[144:147]
s_bitset0_b32 s39, 19
v_mfma_f32_16x16x32_bf16 v[24:27], a[148:151], v[188:191], v[24:27]
v_exp_f32 v45, v45
v_mfma_f32_16x16x32_bf16 v[24:27], a[152:155], v[192:195], v[24:27]
v_cvt_pk_bf16_f32 v90, v44, v45
v_mfma_f32_16x16x32_bf16 v[24:27], a[156:159], v[196:199], v[24:27]
v_exp_f32 v46, v46
v_mfma_f32_16x16x32_bf16 v[32:35], a[156:159], v[212:215], v[148:151]
ds_read_b128 a[156:159], v219 offset:8192
v_mfma_f32_16x16x32_bf16 v[32:35], a[152:155], v[208:211], v[32:35]
v_exp_f32 v47, v47
v_mfma_f32_16x16x32_bf16 v[32:35], a[148:151], v[204:207], v[32:35]
ds_read_b128 a[152:155], v218 offset:8192
v_cvt_pk_bf16_f32 v91, v46, v47
v_mfma_f32_16x16x32_bf16 v[32:35], a[144:147], v[200:203], v[32:35]
v_exp_f32 v48, v48
v_mfma_f32_16x16x32_bf16 a[0:3], a[176:179], v[72:75], a[0:3]
ds_read_b128 a[148:151], v217 offset:8192
ds_read_b128 a[144:147], v216 offset:8192
v_mfma_f32_16x16x32_bf16 a[4:7], a[176:179], v[76:79], a[4:7]
v_exp_f32 v49, v49
v_mfma_f32_16x16x32_bf16 a[8:11], a[176:179], v[80:83], a[8:11]
s_add_u32 m0, s30, 131072
v_cvt_pk_bf16_f32 v92, v48, v49
v_mfma_f32_16x16x32_bf16 a[12:15], a[176:179], v[84:87], a[12:15]
v_exp_f32 v50, v50
v_mfma_f32_16x16x32_bf16 a[28:31], a[180:183], v[84:87], a[28:31]
ds_read_b64_tr_b16 a[176:177], v220 offset:57344
ds_read_b64_tr_b16 a[178:179], v220 offset:61440
v_mfma_f32_16x16x32_bf16 a[24:27], a[180:183], v[80:83], a[24:27]
v_exp_f32 v51, v51
v_mfma_f32_16x16x32_bf16 a[20:23], a[180:183], v[76:79], a[20:23]
v_cvt_pk_bf16_f32 v93, v50, v51
v_mfma_f32_16x16x32_bf16 a[16:19], a[180:183], v[72:75], a[16:19]
v_exp_f32 v52, v52
v_mfma_f32_16x16x32_bf16 a[32:35], a[184:187], v[72:75], a[32:35]
ds_read_b64_tr_b16 a[180:181], v221 offset:57344
ds_read_b64_tr_b16 a[182:183], v221 offset:61440
v_mfma_f32_16x16x32_bf16 a[36:39], a[184:187], v[76:79], a[36:39]
v_exp_f32 v53, v53
v_mfma_f32_16x16x32_bf16 a[40:43], a[184:187], v[80:83], a[40:43]
v_cvt_pk_bf16_f32 v94, v52, v53
v_mfma_f32_16x16x32_bf16 a[44:47], a[184:187], v[84:87], a[44:47]
v_exp_f32 v54, v54
v_mfma_f32_16x16x32_bf16 a[60:63], a[188:191], v[84:87], a[60:63]
ds_read_b64_tr_b16 a[184:185], v222 offset:57344
ds_read_b64_tr_b16 a[186:187], v222 offset:61440
v_mfma_f32_16x16x32_bf16 a[56:59], a[188:191], v[80:83], a[56:59]
v_exp_f32 v55, v55
v_mfma_f32_16x16x32_bf16 a[52:55], a[188:191], v[76:79], a[52:55]
v_cvt_pk_bf16_f32 v95, v54, v55
v_mfma_f32_16x16x32_bf16 a[48:51], a[188:191], v[72:75], a[48:51]
v_exp_f32 v56, v56
v_smfmac_f32_16x16x64_bf16 a[128:131], a[208:211], v[72:79], v245
ds_read_b64_tr_b16 a[188:189], v223 offset:57344
v_mfma_f32_16x16x32_bf16 v[12:15], a[160:163], v[152:155], v[136:139]
v_exp_f32 v57, v57
v_mfma_f32_16x16x32_bf16 v[12:15], a[164:167], v[156:159], v[12:15]
v_exp_f32 v58, v58
v_mfma_f32_16x16x32_bf16 v[12:15], a[168:171], v[160:163], v[12:15]
ds_read_b64_tr_b16 a[190:191], v223 offset:61440
v_cvt_pk_bf16_f32 v96, v56, v57
v_mfma_f32_16x16x32_bf16 v[12:15], a[172:175], v[164:167], v[12:15]
v_exp_f32 v59, v59
v_mfma_f32_16x16x32_bf16 v[20:23], a[172:175], v[180:183], v[140:143]
v_cvt_pk_bf16_f32 v97, v58, v59
v_mfma_f32_16x16x32_bf16 v[20:23], a[168:171], v[176:179], v[20:23]
v_exp_f32 v60, v60
v_mfma_f32_16x16x32_bf16 v[20:23], a[164:167], v[172:175], v[20:23]
buffer_load_dwordx4 v232, s[12:15], s39 offen offset:0  lds
v_mfma_f32_16x16x32_bf16 v[20:23], a[160:163], v[168:171], v[20:23]
v_exp_f32 v61, v61
v_mfma_f32_16x16x32_bf16 v[28:31], a[160:163], v[184:187], v[144:147]
v_cvt_pk_bf16_f32 v98, v60, v61
v_mfma_f32_16x16x32_bf16 v[28:31], a[164:167], v[188:191], v[28:31]
v_exp_f32 v62, v62
v_mfma_f32_16x16x32_bf16 v[28:31], a[168:171], v[192:195], v[28:31]
buffer_load_dwordx4 v233, s[12:15], s39 offen offset:1024  lds
v_mfma_f32_16x16x32_bf16 v[28:31], a[172:175], v[196:199], v[28:31]
v_exp_f32 v63, v63
v_mfma_f32_16x16x32_bf16 v[36:39], a[172:175], v[212:215], v[148:151]
ds_read_b128 a[172:175], v219 offset:12288
v_cvt_pk_bf16_f32 v99, v62, v63
v_mfma_f32_16x16x32_bf16 v[36:39], a[168:171], v[208:211], v[36:39]
v_exp_f32 v64, v64
v_mfma_f32_16x16x32_bf16 v[36:39], a[164:167], v[204:207], v[36:39]
ds_read_b128 a[168:171], v218 offset:12288
ds_read_b128 a[164:167], v217 offset:12288
v_mfma_f32_16x16x32_bf16 v[36:39], a[160:163], v[200:203], v[36:39]
v_exp_f32 v65, v65
s_waitcnt lgkmcnt(8)
v_mfma_f32_16x16x32_bf16 a[64:67], a[192:195], v[72:75], a[64:67]
ds_read_b128 a[160:163], v216 offset:12288
v_cvt_pk_bf16_f32 v100, v64, v65
v_mfma_f32_16x16x32_bf16 a[68:71], a[192:195], v[76:79], a[68:71]
v_exp_f32 v66, v66
v_mfma_f32_16x16x32_bf16 a[72:75], a[192:195], v[80:83], a[72:75]
buffer_load_dwordx4 v232, s[12:15], s39 offen offset:2048  lds
v_mfma_f32_16x16x32_bf16 a[76:79], a[192:195], v[84:87], a[76:79]
v_exp_f32 v67, v67
v_mfma_f32_16x16x32_bf16 a[92:95], a[196:199], v[84:87], a[92:95]
ds_read_b64_tr_b16 a[192:193], v224 offset:57344
v_cvt_pk_bf16_f32 v101, v66, v67
v_mfma_f32_16x16x32_bf16 a[88:91], a[196:199], v[80:83], a[88:91]
v_exp_f32 v68, v68
v_mfma_f32_16x16x32_bf16 a[84:87], a[196:199], v[76:79], a[84:87]
ds_read_b64_tr_b16 a[194:195], v224 offset:61440
v_mfma_f32_16x16x32_bf16 a[80:83], a[196:199], v[72:75], a[80:83]
v_exp_f32 v69, v69
v_mfma_f32_16x16x32_bf16 a[96:99], a[200:203], v[72:75], a[96:99]
ds_read_b64_tr_b16 a[196:197], v225 offset:57344
v_cvt_pk_bf16_f32 v102, v68, v69
v_mfma_f32_16x16x32_bf16 a[100:103], a[200:203], v[76:79], a[100:103]
v_exp_f32 v70, v70
v_mfma_f32_16x16x32_bf16 a[104:107], a[200:203], v[80:83], a[104:107]
ds_read_b64_tr_b16 a[198:199], v225 offset:61440
v_mfma_f32_16x16x32_bf16 a[108:111], a[200:203], v[84:87], a[108:111]
v_exp_f32 v71, v71
v_mfma_f32_16x16x32_bf16 a[124:127], a[204:207], v[84:87], a[124:127]
ds_read_b64_tr_b16 a[200:201], v226 offset:57344
v_cvt_pk_bf16_f32 v103, v70, v71
v_mfma_f32_16x16x32_bf16 a[120:123], a[204:207], v[80:83], a[120:123]
ds_read_b64_tr_b16 a[202:203], v226 offset:61440
v_mfma_f32_16x16x32_bf16 a[116:119], a[204:207], v[76:79], a[116:119]
buffer_load_dwordx4 v233, s[12:15], s39 offen offset:3072  lds
v_mfma_f32_16x16x32_bf16 a[112:115], a[204:207], v[72:75], a[112:115]
ds_read_b64_tr_b16 a[204:205], v227 offset:57344
ds_read_b64_tr_b16 a[206:207], v227 offset:61440
v_smfmac_f32_16x16x64_bf16 a[132:135], a[208:211], v[80:87], v245
s_sub_u32 s33, s33, 1
buffer_load_dword v242, v241, s[20:23], s46 offen sc1
s_cmp_lg_u32 s33, 0
v_add_u32 v241, 1024, v241
v_and_b32 v241, 0x3fff, v241
s_cbranch_scc1 K_LOOP
K_LAST:
STUB_11:
STUB_B2:
s_cbranch_execz STUB_14
v_mfma_f32_16x16x32_bf16 v[40:43], a[144:147], v[152:155], v[136:139]
v_and_b32 v246, 15, v1
v_exp_f32 v8, v8
v_mfma_f32_16x16x32_bf16 v[40:43], a[148:151], v[156:159], v[40:43]
v_lshrrev_b32 v247, 3, v246
v_exp_f32 v9, v9
v_mfma_f32_16x16x32_bf16 v[40:43], a[152:155], v[160:163], v[40:43]
v_cvt_pk_bf16_f32 v72, v8, v9
v_and_b32 v246, 7, v246
v_lshlrev_b32 v246, 6, v246
v_mfma_f32_16x16x32_bf16 v[40:43], a[156:159], v[164:167], v[40:43]
v_lshl_add_u32 v246, v247, 13, v246
v_exp_f32 v10, v10
v_mfma_f32_16x16x32_bf16 v[48:51], a[156:159], v[180:183], v[140:143]
s_lshl_b32 s28, s36, 9
s_add_u32 s28, s28, 0x248000
v_mfma_f32_16x16x32_bf16 v[48:51], a[152:155], v[176:179], v[48:51]
v_exp_f32 v11, v11
v_mfma_f32_16x16x32_bf16 v[48:51], a[148:151], v[172:175], v[48:51]
v_cvt_pk_bf16_f32 v73, v10, v11
v_mfma_f32_16x16x32_bf16 v[48:51], a[144:147], v[168:171], v[48:51]
v_exp_f32 v12, v12
v_mfma_f32_16x16x32_bf16 v[56:59], a[144:147], v[184:187], v[144:147]
v_mfma_f32_16x16x32_bf16 v[56:59], a[148:151], v[188:191], v[56:59]
v_exp_f32 v13, v13
v_mfma_f32_16x16x32_bf16 v[56:59], a[152:155], v[192:195], v[56:59]
v_cvt_pk_bf16_f32 v74, v12, v13
v_mfma_f32_16x16x32_bf16 v[56:59], a[156:159], v[196:199], v[56:59]
v_exp_f32 v14, v14
v_mfma_f32_16x16x32_bf16 v[64:67], a[156:159], v[212:215], v[148:151]
s_waitcnt vmcnt(10) lgkmcnt(0)
s_barrier
v_mfma_f32_16x16x32_bf16 v[64:67], a[152:155], v[208:211], v[64:67]
v_exp_f32 v15, v15
v_mfma_f32_16x16x32_bf16 v[64:67], a[148:151], v[204:207], v[64:67]
ds_read_b128 a[156:159], v219 offset:16384
v_cvt_pk_bf16_f32 v75, v14, v15
v_mfma_f32_16x16x32_bf16 v[64:67], a[144:147], v[200:203], v[64:67]
v_exp_f32 v16, v16
v_mfma_f32_16x16x32_bf16 a[0:3], a[176:179], v[88:91], a[0:3]
ds_read_b128 a[152:155], v218 offset:16384
ds_read_b128 a[148:151], v217 offset:16384
v_mfma_f32_16x16x32_bf16 a[4:7], a[176:179], v[92:95], a[4:7]
v_exp_f32 v17, v17
v_mfma_f32_16x16x32_bf16 a[8:11], a[176:179], v[96:99], a[8:11]
ds_read_b128 a[144:147], v216 offset:16384
v_cvt_pk_bf16_f32 v76, v16, v17
v_mfma_f32_16x16x32_bf16 a[12:15], a[176:179], v[100:103], a[12:15]
v_exp_f32 v18, v18
v_mfma_f32_16x16x32_bf16 a[28:31], a[180:183], v[100:103], a[28:31]
ds_read_b64_tr_b16 a[176:177], v220 offset:0
ds_read_b64_tr_b16 a[178:179], v220 offset:4096
v_mfma_f32_16x16x32_bf16 a[24:27], a[180:183], v[96:99], a[24:27]
v_exp_f32 v19, v19
v_mfma_f32_16x16x32_bf16 a[20:23], a[180:183], v[92:95], a[20:23]
buffer_load_dword v242, v246, s[20:23], s28 offen sc1
v_cvt_pk_bf16_f32 v77, v18, v19
v_mfma_f32_16x16x32_bf16 a[16:19], a[180:183], v[88:91], a[16:19]
v_bfe_u32 v246, v1, 2, 2
v_exp_f32 v20, v20
v_mfma_f32_16x16x32_bf16 a[32:35], a[184:187], v[88:91], a[32:35]
ds_read_b64_tr_b16 a[180:181], v221 offset:0
ds_read_b64_tr_b16 a[182:183], v221 offset:4096
v_lshl_add_u32 v246, v4, 2, v246
v_mfma_f32_16x16x32_bf16 a[36:39], a[184:187], v[92:95], a[36:39]
v_mul_u32_u24 v246, 288, v246
v_exp_f32 v21, v21
v_mfma_f32_16x16x32_bf16 a[40:43], a[184:187], v[96:99], a[40:43]
v_cvt_pk_bf16_f32 v78, v20, v21
v_and_b32 v247, 3, v1
v_lshl_add_u32 v236, v247, 3, v246
v_mfma_f32_16x16x32_bf16 a[44:47], a[184:187], v[100:103], a[44:47]
v_add_u32 v236, 256, v236
v_exp_f32 v22, v22
v_mfma_f32_16x16x32_bf16 a[60:63], a[188:191], v[100:103], a[60:63]
ds_read_b64_tr_b16 a[184:185], v222 offset:0
ds_read_b64_tr_b16 a[186:187], v222 offset:4096
v_lshl_add_u32 v246, v247, 4, v246
v_mfma_f32_16x16x32_bf16 a[56:59], a[188:191], v[96:99], a[56:59]
v_exp_f32 v23, v23
v_mfma_f32_16x16x32_bf16 a[52:55], a[188:191], v[92:95], a[52:55]
s_lshr_b32 s28, s35, 4
s_lshl_b32 s28, s28, 6
v_cvt_pk_bf16_f32 v79, v22, v23
v_mfma_f32_16x16x32_bf16 a[48:51], a[188:191], v[88:91], a[48:51]
v_add_u32 v234, s28, v246
v_exp_f32 v24, v24
v_smfmac_f32_16x16x64_bf16 a[128:131], a[208:211], v[88:95], v245
ds_read_b64_tr_b16 a[188:189], v223 offset:0
s_xor_b32 s28, s28, 64
v_mfma_f32_16x16x32_bf16 v[44:47], a[160:163], v[152:155], v[136:139]
v_add_u32 v235, s28, v246
v_exp_f32 v25, v25
v_mfma_f32_16x16x32_bf16 v[44:47], a[164:167], v[156:159], v[44:47]
v_exp_f32 v26, v26
v_mfma_f32_16x16x32_bf16 v[44:47], a[168:171], v[160:163], v[44:47]
ds_read_b64_tr_b16 a[190:191], v223 offset:4096
v_cvt_pk_bf16_f32 v80, v24, v25
v_mfma_f32_16x16x32_bf16 v[44:47], a[172:175], v[164:167], v[44:47]
v_exp_f32 v27, v27
v_mfma_f32_16x16x32_bf16 v[52:55], a[172:175], v[180:183], v[140:143]
s_add_u32 s28, s35, 0
s_and_b32 s28, s28, 3
v_cvt_pk_bf16_f32 v81, v26, v27
v_mfma_f32_16x16x32_bf16 v[52:55], a[168:171], v[176:179], v[52:55]
s_mul_i32 s28, s28, 36864
v_exp_f32 v28, v28
v_mfma_f32_16x16x32_bf16 v[52:55], a[164:167], v[172:175], v[52:55]
s_add_u32 m0, s88, 62208
s_lshl2_add_u32 s50, m0, s89
buffer_load_dwordx4 v243, s[56:59], s50 offen  lds
v_mfma_f32_16x16x32_bf16 v[52:55], a[160:163], v[168:171], v[52:55]
v_add_u32 v237, s28, v234
v_exp_f32 v29, v29
v_mfma_f32_16x16x32_bf16 v[60:63], a[160:163], v[184:187], v[144:147]
v_cvt_pk_bf16_f32 v82, v28, v29
v_add_u32 v238, s28, v235
v_add_u32 v239, s28, v236
v_mfma_f32_16x16x32_bf16 v[60:63], a[164:167], v[188:191], v[60:63]
v_mov_b32 v254, 0x7ffffff0
v_exp_f32 v30, v30
v_mfma_f32_16x16x32_bf16 v[60:63], a[168:171], v[192:195], v[60:63]
s_add_u32 m0, s88, 65664
s_lshl2_add_u32 s50, m0, s89
buffer_load_dwordx4 v243, s[56:59], s50 offen  lds
v_mfma_f32_16x16x32_bf16 v[60:63], a[172:175], v[196:199], v[60:63]
s_lshl2_add_u32 s92, s36, s37
v_exp_f32 v31, v31
v_mfma_f32_16x16x32_bf16 v[68:71], a[172:175], v[212:215], v[148:151]
ds_read_b128 a[172:175], v219 offset:20480
s_bfe_u32 s93, s35, 0x20002
v_cvt_pk_bf16_f32 v83, v30, v31
v_mfma_f32_16x16x32_bf16 v[68:71], a[168:171], v[208:211], v[68:71]
s_lshl2_add_u32 s92, s92, s93
v_exp_f32 v32, v32
v_mfma_f32_16x16x32_bf16 v[68:71], a[164:167], v[204:207], v[68:71]
ds_read_b128 a[168:171], v218 offset:20480
ds_read_b128 a[164:167], v217 offset:20480
s_lshl_b32 s93, s92, 4
v_mfma_f32_16x16x32_bf16 v[68:71], a[160:163], v[200:203], v[68:71]
v_add_u32 v132, s93, v3
v_exp_f32 v33, v33
v_mfma_f32_16x16x32_bf16 a[64:67], a[192:195], v[88:91], a[64:67]
ds_read_b128 a[160:163], v216 offset:20480
v_cvt_pk_bf16_f32 v84, v32, v33
v_writelane_b32 v254, 0, 0
v_mfma_f32_16x16x32_bf16 a[68:71], a[192:195], v[92:95], a[68:71]
s_and_b32 s93, s35, 3
v_exp_f32 v34, v34
v_mfma_f32_16x16x32_bf16 a[72:75], a[192:195], v[96:99], a[72:75]
s_add_u32 m0, s88, 69120
s_lshl2_add_u32 s50, m0, s89
buffer_load_dwordx4 v243, s[56:59], s50 offen  lds
v_mfma_f32_16x16x32_bf16 a[76:79], a[192:195], v[100:103], a[76:79]
s_mul_i32 s93, s93, 144
v_exp_f32 v35, v35
v_mfma_f32_16x16x32_bf16 a[92:95], a[196:199], v[100:103], a[92:95]
ds_read_b64_tr_b16 a[192:193], v224 offset:0
v_cvt_pk_bf16_f32 v85, v34, v35
v_lshlrev_b32 v251, 2, v4
v_mfma_f32_16x16x32_bf16 a[88:91], a[196:199], v[96:99], a[88:91]
v_add_u32 v251, s93, v251
v_exp_f32 v36, v36
v_mfma_f32_16x16x32_bf16 a[84:87], a[196:199], v[92:95], a[84:87]
ds_read_b64_tr_b16 a[194:195], v224 offset:4096
v_add_u32 v251, 128, v251
v_lshlrev_b32 v250, 3, v4
v_mfma_f32_16x16x32_bf16 a[80:83], a[196:199], v[88:91], a[80:83]
s_lshr_b32 s90, s35, 4
v_exp_f32 v37, v37
v_mfma_f32_16x16x32_bf16 a[96:99], a[200:203], v[88:91], a[96:99]
ds_read_b64_tr_b16 a[196:197], v225 offset:0
s_lshl_b32 s90, s90, 5
v_cvt_pk_bf16_f32 v86, v36, v37
v_mfma_f32_16x16x32_bf16 a[100:103], a[200:203], v[92:95], a[100:103]
s_add_u32 s93, s93, s90
v_exp_f32 v38, v38
v_mfma_f32_16x16x32_bf16 a[104:107], a[200:203], v[96:99], a[104:107]
ds_read_b64_tr_b16 a[198:199], v225 offset:4096
v_add_u32 v250, s93, v250
v_lshlrev_b32 v250, 1, v250
v_mfma_f32_16x16x32_bf16 a[108:111], a[200:203], v[100:103], a[108:111]
v_lshlrev_b32 v251, 1, v251
v_exp_f32 v39, v39
v_mfma_f32_16x16x32_bf16 a[124:127], a[204:207], v[100:103], a[124:127]
ds_read_b64_tr_b16 a[200:201], v226 offset:0
v_cvt_pk_bf16_f32 v87, v38, v39
v_mul_u32_u24 v133, 0x480, v132
v_mfma_f32_16x16x32_bf16 a[120:123], a[204:207], v[96:99], a[120:123]
ds_read_b64_tr_b16 a[202:203], v226 offset:4096
v_add_u32 v248, v133, v250
v_add_u32 v249, v133, v251
v_mfma_f32_16x16x32_bf16 a[116:119], a[204:207], v[92:95], a[116:119]
v_mov_b32 v135, 0x7fffbff0
v_mfma_f32_16x16x32_bf16 a[112:115], a[204:207], v[88:91], a[112:115]
ds_read_b64_tr_b16 a[204:205], v227 offset:0
ds_read_b64_tr_b16 a[206:207], v227 offset:4096
v_smfmac_f32_16x16x64_bf16 a[132:135], a[208:211], v[96:103], v245
s_mov_b32 s93, 0x243080
buffer_load_dword v246, v254, s[20:23], s93 offen sc0 sc1
s_waitcnt lgkmcnt(8)
v_mfma_f32_16x16x32_bf16 v[8:11], a[144:147], v[152:155], v[136:139]
v_exp_f32 v40, v40
v_mfma_f32_16x16x32_bf16 v[8:11], a[148:151], v[156:159], v[8:11]
v_exp_f32 v41, v41
v_mfma_f32_16x16x32_bf16 v[8:11], a[152:155], v[160:163], v[8:11]
s_mov_b32 s92, 0x1c00000
v_cvt_pk_bf16_f32 v88, v40, v41
v_mfma_f32_16x16x32_bf16 v[8:11], a[156:159], v[164:167], v[8:11]
v_exp_f32 v42, v42
v_mfma_f32_16x16x32_bf16 v[16:19], a[156:159], v[180:183], v[140:143]
s_add_u32 s39, s39, 16384
v_mfma_f32_16x16x32_bf16 v[16:19], a[152:155], v[176:179], v[16:19]
v_exp_f32 v43, v43
v_mfma_f32_16x16x32_bf16 v[16:19], a[148:151], v[172:175], v[16:19]
v_cvt_pk_bf16_f32 v89, v42, v43
v_mfma_f32_16x16x32_bf16 v[16:19], a[144:147], v[168:171], v[16:19]
v_exp_f32 v44, v44
v_mfma_f32_16x16x32_bf16 v[24:27], a[144:147], v[184:187], v[144:147]
v_mfma_f32_16x16x32_bf16 v[24:27], a[148:151], v[188:191], v[24:27]
v_exp_f32 v45, v45
v_mfma_f32_16x16x32_bf16 v[24:27], a[152:155], v[192:195], v[24:27]
s_bitset0_b32 s39, 19
v_cvt_pk_bf16_f32 v90, v44, v45
v_mfma_f32_16x16x32_bf16 v[24:27], a[156:159], v[196:199], v[24:27]
v_exp_f32 v46, v46
v_mfma_f32_16x16x32_bf16 v[32:35], a[156:159], v[212:215], v[148:151]
ds_read_b128 a[156:159], v219 offset:24576
buffer_load_dwordx4 a[222:225], v248, s[20:23], s92 offen offset:0 sc0 sc1
v_mfma_f32_16x16x32_bf16 v[32:35], a[152:155], v[208:211], v[32:35]
v_exp_f32 v47, v47
v_mfma_f32_16x16x32_bf16 v[32:35], a[148:151], v[204:207], v[32:35]
ds_read_b128 a[152:155], v218 offset:24576
v_cvt_pk_bf16_f32 v91, v46, v47
v_mfma_f32_16x16x32_bf16 v[32:35], a[144:147], v[200:203], v[32:35]
v_exp_f32 v48, v48
v_mfma_f32_16x16x32_bf16 a[0:3], a[176:179], v[72:75], a[0:3]
ds_read_b128 a[148:151], v217 offset:24576
ds_read_b128 a[144:147], v216 offset:24576
v_mfma_f32_16x16x32_bf16 a[4:7], a[176:179], v[76:79], a[4:7]
v_exp_f32 v49, v49
v_mfma_f32_16x16x32_bf16 a[8:11], a[176:179], v[80:83], a[8:11]
s_add_u32 m0, s30, 147456
v_cvt_pk_bf16_f32 v92, v48, v49
v_mfma_f32_16x16x32_bf16 a[12:15], a[176:179], v[84:87], a[12:15]
v_exp_f32 v50, v50
v_mfma_f32_16x16x32_bf16 a[28:31], a[180:183], v[84:87], a[28:31]
ds_read_b64_tr_b16 a[176:177], v220 offset:8192
ds_read_b64_tr_b16 a[178:179], v220 offset:12288
v_mfma_f32_16x16x32_bf16 a[24:27], a[180:183], v[80:83], a[24:27]
v_exp_f32 v51, v51
v_mfma_f32_16x16x32_bf16 a[20:23], a[180:183], v[76:79], a[20:23]
buffer_load_dwordx4 a[226:229], v248, s[20:23], s92 offen offset:128 sc0 sc1
v_cvt_pk_bf16_f32 v93, v50, v51
v_mfma_f32_16x16x32_bf16 a[16:19], a[180:183], v[72:75], a[16:19]
v_exp_f32 v52, v52
v_mfma_f32_16x16x32_bf16 a[32:35], a[184:187], v[72:75], a[32:35]
ds_read_b64_tr_b16 a[180:181], v221 offset:8192
ds_read_b64_tr_b16 a[182:183], v221 offset:12288
v_mfma_f32_16x16x32_bf16 a[36:39], a[184:187], v[76:79], a[36:39]
v_exp_f32 v53, v53
v_mfma_f32_16x16x32_bf16 a[40:43], a[184:187], v[80:83], a[40:43]
v_cvt_pk_bf16_f32 v94, v52, v53
v_mfma_f32_16x16x32_bf16 a[44:47], a[184:187], v[84:87], a[44:47]
v_exp_f32 v54, v54
v_mfma_f32_16x16x32_bf16 a[60:63], a[188:191], v[84:87], a[60:63]
ds_read_b64_tr_b16 a[184:185], v222 offset:8192
ds_read_b64_tr_b16 a[186:187], v222 offset:12288
v_mfma_f32_16x16x32_bf16 a[56:59], a[188:191], v[80:83], a[56:59]
v_exp_f32 v55, v55
v_mfma_f32_16x16x32_bf16 a[52:55], a[188:191], v[76:79], a[52:55]
v_cvt_pk_bf16_f32 v95, v54, v55
v_mfma_f32_16x16x32_bf16 a[48:51], a[188:191], v[72:75], a[48:51]
v_exp_f32 v56, v56
v_smfmac_f32_16x16x64_bf16 a[128:131], a[208:211], v[72:79], v245
ds_read_b64_tr_b16 a[188:189], v223 offset:8192
v_mfma_f32_16x16x32_bf16 v[12:15], a[160:163], v[152:155], v[136:139]
v_exp_f32 v57, v57
v_mfma_f32_16x16x32_bf16 v[12:15], a[164:167], v[156:159], v[12:15]
v_exp_f32 v58, v58
v_mfma_f32_16x16x32_bf16 v[12:15], a[168:171], v[160:163], v[12:15]
ds_read_b64_tr_b16 a[190:191], v223 offset:12288
v_cvt_pk_bf16_f32 v96, v56, v57
v_mfma_f32_16x16x32_bf16 v[12:15], a[172:175], v[164:167], v[12:15]
v_exp_f32 v59, v59
v_mfma_f32_16x16x32_bf16 v[20:23], a[172:175], v[180:183], v[140:143]
buffer_load_dwordx2 a[230:231], v249, s[20:23], s92 offen sc0 sc1
v_cvt_pk_bf16_f32 v97, v58, v59
v_mfma_f32_16x16x32_bf16 v[20:23], a[168:171], v[176:179], v[20:23]
v_exp_f32 v60, v60
v_mfma_f32_16x16x32_bf16 v[20:23], a[164:167], v[172:175], v[20:23]
buffer_load_dwordx4 v232, s[12:15], s39 offen offset:0  lds
v_mfma_f32_16x16x32_bf16 v[20:23], a[160:163], v[168:171], v[20:23]
v_exp_f32 v61, v61
v_mfma_f32_16x16x32_bf16 v[28:31], a[160:163], v[184:187], v[144:147]
v_cvt_pk_bf16_f32 v98, v60, v61
v_mfma_f32_16x16x32_bf16 v[28:31], a[164:167], v[188:191], v[28:31]
v_exp_f32 v62, v62
v_mfma_f32_16x16x32_bf16 v[28:31], a[168:171], v[192:195], v[28:31]
buffer_load_dwordx4 v233, s[12:15], s39 offen offset:1024  lds
v_mfma_f32_16x16x32_bf16 v[28:31], a[172:175], v[196:199], v[28:31]
v_exp_f32 v63, v63
v_mfma_f32_16x16x32_bf16 v[36:39], a[172:175], v[212:215], v[148:151]
ds_read_b128 a[172:175], v219 offset:28672
v_cvt_pk_bf16_f32 v99, v62, v63
v_mfma_f32_16x16x32_bf16 v[36:39], a[168:171], v[208:211], v[36:39]
v_exp_f32 v64, v64
v_mfma_f32_16x16x32_bf16 v[36:39], a[164:167], v[204:207], v[36:39]
ds_read_b128 a[168:171], v218 offset:28672
ds_read_b128 a[164:167], v217 offset:28672
v_mfma_f32_16x16x32_bf16 v[36:39], a[160:163], v[200:203], v[36:39]
v_exp_f32 v65, v65
s_waitcnt lgkmcnt(8)
v_mfma_f32_16x16x32_bf16 a[64:67], a[192:195], v[72:75], a[64:67]
ds_read_b128 a[160:163], v216 offset:28672
v_cvt_pk_bf16_f32 v100, v64, v65
v_mfma_f32_16x16x32_bf16 a[68:71], a[192:195], v[76:79], a[68:71]
v_exp_f32 v66, v66
v_mfma_f32_16x16x32_bf16 a[72:75], a[192:195], v[80:83], a[72:75]
buffer_load_dwordx4 v232, s[12:15], s39 offen offset:2048  lds
v_mfma_f32_16x16x32_bf16 a[76:79], a[192:195], v[84:87], a[76:79]
v_exp_f32 v67, v67
v_mfma_f32_16x16x32_bf16 a[92:95], a[196:199], v[84:87], a[92:95]
ds_read_b64_tr_b16 a[192:193], v224 offset:8192
v_cvt_pk_bf16_f32 v101, v66, v67
v_mfma_f32_16x16x32_bf16 a[88:91], a[196:199], v[80:83], a[88:91]
v_exp_f32 v68, v68
v_mfma_f32_16x16x32_bf16 a[84:87], a[196:199], v[76:79], a[84:87]
ds_read_b64_tr_b16 a[194:195], v224 offset:12288
buffer_load_dwordx4 a[212:215], v248, s[52:55], 0 offen offset:0
v_mfma_f32_16x16x32_bf16 a[80:83], a[196:199], v[72:75], a[80:83]
v_exp_f32 v69, v69
v_mfma_f32_16x16x32_bf16 a[96:99], a[200:203], v[72:75], a[96:99]
ds_read_b64_tr_b16 a[196:197], v225 offset:8192
v_cvt_pk_bf16_f32 v102, v68, v69
v_mfma_f32_16x16x32_bf16 a[100:103], a[200:203], v[76:79], a[100:103]
v_exp_f32 v70, v70
v_mfma_f32_16x16x32_bf16 a[104:107], a[200:203], v[80:83], a[104:107]
ds_read_b64_tr_b16 a[198:199], v225 offset:12288
v_mfma_f32_16x16x32_bf16 a[108:111], a[200:203], v[84:87], a[108:111]
v_exp_f32 v71, v71
v_mfma_f32_16x16x32_bf16 a[124:127], a[204:207], v[84:87], a[124:127]
ds_read_b64_tr_b16 a[200:201], v226 offset:8192
v_cvt_pk_bf16_f32 v103, v70, v71
v_mfma_f32_16x16x32_bf16 a[120:123], a[204:207], v[80:83], a[120:123]
ds_read_b64_tr_b16 a[202:203], v226 offset:12288
v_mfma_f32_16x16x32_bf16 a[116:119], a[204:207], v[76:79], a[116:119]
buffer_load_dwordx4 v233, s[12:15], s39 offen offset:3072  lds
v_mfma_f32_16x16x32_bf16 a[112:115], a[204:207], v[72:75], a[112:115]
ds_read_b64_tr_b16 a[204:205], v227 offset:8192
ds_read_b64_tr_b16 a[206:207], v227 offset:12288
v_smfmac_f32_16x16x64_bf16 a[132:135], a[208:211], v[80:87], v245
s_add_u32 m0, s88, 72576
s_lshl2_add_u32 s50, m0, s89
buffer_load_dwordx4 v243, s[56:59], s50 offen  lds
s_add_u32 m0, s88, 76032
s_lshl2_add_u32 s50, m0, s89
buffer_load_dwordx4 v243, s[56:59], s50 offen  lds
v_mfma_f32_16x16x32_bf16 v[40:43], a[144:147], v[152:155], v[136:139]
v_exp_f32 v8, v8
v_mfma_f32_16x16x32_bf16 v[40:43], a[148:151], v[156:159], v[40:43]
v_exp_f32 v9, v9
v_mfma_f32_16x16x32_bf16 v[40:43], a[152:155], v[160:163], v[40:43]
v_cvt_pk_bf16_f32 v72, v8, v9
v_mfma_f32_16x16x32_bf16 v[40:43], a[156:159], v[164:167], v[40:43]
v_exp_f32 v10, v10
v_mfma_f32_16x16x32_bf16 v[48:51], a[156:159], v[180:183], v[140:143]
v_mfma_f32_16x16x32_bf16 v[48:51], a[152:155], v[176:179], v[48:51]
v_exp_f32 v11, v11
v_mfma_f32_16x16x32_bf16 v[48:51], a[148:151], v[172:175], v[48:51]
v_cvt_pk_bf16_f32 v73, v10, v11
v_mfma_f32_16x16x32_bf16 v[48:51], a[144:147], v[168:171], v[48:51]
v_exp_f32 v12, v12
v_mfma_f32_16x16x32_bf16 v[56:59], a[144:147], v[184:187], v[144:147]
v_mfma_f32_16x16x32_bf16 v[56:59], a[148:151], v[188:191], v[56:59]
v_exp_f32 v13, v13
v_mfma_f32_16x16x32_bf16 v[56:59], a[152:155], v[192:195], v[56:59]
v_cvt_pk_bf16_f32 v74, v12, v13
v_mfma_f32_16x16x32_bf16 v[56:59], a[156:159], v[196:199], v[56:59]
v_exp_f32 v14, v14
v_mfma_f32_16x16x32_bf16 v[64:67], a[156:159], v[212:215], v[148:151]
s_waitcnt vmcnt(15) lgkmcnt(0)
s_barrier
v_mfma_f32_16x16x32_bf16 v[64:67], a[152:155], v[208:211], v[64:67]
v_exp_f32 v15, v15
v_mfma_f32_16x16x32_bf16 v[64:67], a[148:151], v[204:207], v[64:67]
ds_read_b128 a[156:159], v219 offset:49152
v_cvt_pk_bf16_f32 v75, v14, v15
v_mfma_f32_16x16x32_bf16 v[64:67], a[144:147], v[200:203], v[64:67]
v_exp_f32 v16, v16
v_mfma_f32_16x16x32_bf16 a[0:3], a[176:179], v[88:91], a[0:3]
ds_read_b128 a[152:155], v218 offset:49152
ds_read_b128 a[148:151], v217 offset:49152
v_mfma_f32_16x16x32_bf16 a[4:7], a[176:179], v[92:95], a[4:7]
v_exp_f32 v17, v17
v_mfma_f32_16x16x32_bf16 a[8:11], a[176:179], v[96:99], a[8:11]
ds_read_b128 a[144:147], v216 offset:49152
v_cvt_pk_bf16_f32 v76, v16, v17
v_mfma_f32_16x16x32_bf16 a[12:15], a[176:179], v[100:103], a[12:15]
v_exp_f32 v18, v18
v_mfma_f32_16x16x32_bf16 a[28:31], a[180:183], v[100:103], a[28:31]
ds_read_b64_tr_b16 a[176:177], v220 offset:32768
ds_read_b64_tr_b16 a[178:179], v220 offset:36864
v_mfma_f32_16x16x32_bf16 a[24:27], a[180:183], v[96:99], a[24:27]
v_exp_f32 v19, v19
v_mfma_f32_16x16x32_bf16 a[20:23], a[180:183], v[92:95], a[20:23]
buffer_load_dwordx4 a[216:219], v248, s[52:55], 0 offen offset:128
v_cvt_pk_bf16_f32 v77, v18, v19
v_mfma_f32_16x16x32_bf16 a[16:19], a[180:183], v[88:91], a[16:19]
v_exp_f32 v20, v20
v_mfma_f32_16x16x32_bf16 a[32:35], a[184:187], v[88:91], a[32:35]
ds_read_b64_tr_b16 a[180:181], v221 offset:32768
ds_read_b64_tr_b16 a[182:183], v221 offset:36864
v_mfma_f32_16x16x32_bf16 a[36:39], a[184:187], v[92:95], a[36:39]
v_exp_f32 v21, v21
v_mfma_f32_16x16x32_bf16 a[40:43], a[184:187], v[96:99], a[40:43]
v_cvt_pk_bf16_f32 v78, v20, v21
v_mfma_f32_16x16x32_bf16 a[44:47], a[184:187], v[100:103], a[44:47]
v_exp_f32 v22, v22
v_mfma_f32_16x16x32_bf16 a[60:63], a[188:191], v[100:103], a[60:63]
ds_read_b64_tr_b16 a[184:185], v222 offset:32768
ds_read_b64_tr_b16 a[186:187], v222 offset:36864
v_mfma_f32_16x16x32_bf16 a[56:59], a[188:191], v[96:99], a[56:59]
v_exp_f32 v23, v23
v_mfma_f32_16x16x32_bf16 a[52:55], a[188:191], v[92:95], a[52:55]
v_cvt_pk_bf16_f32 v79, v22, v23
v_mfma_f32_16x16x32_bf16 a[48:51], a[188:191], v[88:91], a[48:51]
v_exp_f32 v24, v24
v_smfmac_f32_16x16x64_bf16 a[128:131], a[208:211], v[88:95], v245
ds_read_b64_tr_b16 a[188:189], v223 offset:32768
v_mfma_f32_16x16x32_bf16 v[44:47], a[160:163], v[152:155], v[136:139]
v_exp_f32 v25, v25
v_mfma_f32_16x16x32_bf16 v[44:47], a[164:167], v[156:159], v[44:47]
v_exp_f32 v26, v26
v_mfma_f32_16x16x32_bf16 v[44:47], a[168:171], v[160:163], v[44:47]
ds_read_b64_tr_b16 a[190:191], v223 offset:36864
v_cvt_pk_bf16_f32 v80, v24, v25
v_mfma_f32_16x16x32_bf16 v[44:47], a[172:175], v[164:167], v[44:47]
v_exp_f32 v27, v27
v_mfma_f32_16x16x32_bf16 v[52:55], a[172:175], v[180:183], v[140:143]
buffer_load_dwordx2 a[220:221], v249, s[52:55], 0 offen
v_cvt_pk_bf16_f32 v81, v26, v27
v_mfma_f32_16x16x32_bf16 v[52:55], a[168:171], v[176:179], v[52:55]
v_sub_u32 v133, 0xffff, v132
v_exp_f32 v28, v28
v_mfma_f32_16x16x32_bf16 v[52:55], a[164:167], v[172:175], v[52:55]
s_add_u32 m0, s88, 79488
s_lshl2_add_u32 s50, m0, s89
buffer_load_dwordx4 v243, s[56:59], s50 offen  lds
v_mfma_f32_16x16x32_bf16 v[52:55], a[160:163], v[168:171], v[52:55]
s_and_b32 s93, s76, 0xffff
v_exp_f32 v29, v29
v_mfma_f32_16x16x32_bf16 v[60:63], a[160:163], v[184:187], v[144:147]
v_cvt_pk_bf16_f32 v82, v28, v29
v_cmp_eq_u32 s[90:91], s93, v133
v_mov_b32 v134, 0
v_mfma_f32_16x16x32_bf16 v[60:63], a[164:167], v[188:191], v[60:63]
v_cndmask_b32 v135, v135, v134, s[90:91]
v_exp_f32 v30, v30
v_mfma_f32_16x16x32_bf16 v[60:63], a[168:171], v[192:195], v[60:63]
s_add_u32 m0, s88, 82944
s_lshl2_add_u32 s50, m0, s89
buffer_load_dwordx4 v243, s[56:59], s50 offen  lds
v_mfma_f32_16x16x32_bf16 v[60:63], a[172:175], v[196:199], v[60:63]
s_and_b32 s93, s77, 0xffff
v_exp_f32 v31, v31
v_mfma_f32_16x16x32_bf16 v[68:71], a[172:175], v[212:215], v[148:151]
ds_read_b128 a[172:175], v219 offset:53248
v_cvt_pk_bf16_f32 v83, v30, v31
v_cmp_eq_u32 s[90:91], s93, v133
v_mfma_f32_16x16x32_bf16 v[68:71], a[168:171], v[208:211], v[68:71]
v_mov_b32 v134, 1152
v_exp_f32 v32, v32
v_mfma_f32_16x16x32_bf16 v[68:71], a[164:167], v[204:207], v[68:71]
ds_read_b128 a[168:171], v218 offset:53248
ds_read_b128 a[164:167], v217 offset:53248
v_cndmask_b32 v135, v135, v134, s[90:91]
v_mfma_f32_16x16x32_bf16 v[68:71], a[160:163], v[200:203], v[68:71]
s_and_b32 s93, s78, 0xffff
v_exp_f32 v33, v33
v_mfma_f32_16x16x32_bf16 a[64:67], a[192:195], v[88:91], a[64:67]
ds_read_b128 a[160:163], v216 offset:53248
v_cvt_pk_bf16_f32 v84, v32, v33
v_cmp_eq_u32 s[90:91], s93, v133
v_mfma_f32_16x16x32_bf16 a[68:71], a[192:195], v[92:95], a[68:71]
v_mov_b32 v134, 2304
v_exp_f32 v34, v34
v_mfma_f32_16x16x32_bf16 a[72:75], a[192:195], v[96:99], a[72:75]
s_add_u32 m0, s88, 86400
s_lshl2_add_u32 s50, m0, s89
buffer_load_dwordx4 v243, s[56:59], s50 offen  lds
v_mfma_f32_16x16x32_bf16 a[76:79], a[192:195], v[100:103], a[76:79]
v_cndmask_b32 v135, v135, v134, s[90:91]
v_exp_f32 v35, v35
v_mfma_f32_16x16x32_bf16 a[92:95], a[196:199], v[100:103], a[92:95]
ds_read_b64_tr_b16 a[192:193], v224 offset:32768
v_cvt_pk_bf16_f32 v85, v34, v35
v_mfma_f32_16x16x32_bf16 a[88:91], a[196:199], v[96:99], a[88:91]
s_and_b32 s93, s79, 0xffff
v_exp_f32 v36, v36
v_mfma_f32_16x16x32_bf16 a[84:87], a[196:199], v[92:95], a[84:87]
ds_read_b64_tr_b16 a[194:195], v224 offset:36864
v_cmp_eq_u32 s[90:91], s93, v133
v_mfma_f32_16x16x32_bf16 a[80:83], a[196:199], v[88:91], a[80:83]
v_exp_f32 v37, v37
v_mfma_f32_16x16x32_bf16 a[96:99], a[200:203], v[88:91], a[96:99]
ds_read_b64_tr_b16 a[196:197], v225 offset:32768
v_cvt_pk_bf16_f32 v86, v36, v37
v_mfma_f32_16x16x32_bf16 a[100:103], a[200:203], v[92:95], a[100:103]
v_exp_f32 v38, v38
v_mfma_f32_16x16x32_bf16 a[104:107], a[200:203], v[96:99], a[104:107]
ds_read_b64_tr_b16 a[198:199], v225 offset:36864
v_mov_b32 v134, 3456
v_mfma_f32_16x16x32_bf16 a[108:111], a[200:203], v[100:103], a[108:111]
v_exp_f32 v39, v39
v_mfma_f32_16x16x32_bf16 a[124:127], a[204:207], v[100:103], a[124:127]
ds_read_b64_tr_b16 a[200:201], v226 offset:32768
v_cvt_pk_bf16_f32 v87, v38, v39
v_mfma_f32_16x16x32_bf16 a[120:123], a[204:207], v[96:99], a[120:123]
ds_read_b64_tr_b16 a[202:203], v226 offset:36864
v_cndmask_b32 v135, v135, v134, s[90:91]
v_mfma_f32_16x16x32_bf16 a[116:119], a[204:207], v[92:95], a[116:119]
s_add_u32 m0, s88, 89856
s_lshl2_add_u32 s50, m0, s89
buffer_load_dwordx4 v243, s[56:59], s50 offen  lds
v_mfma_f32_16x16x32_bf16 a[112:115], a[204:207], v[88:91], a[112:115]
ds_read_b64_tr_b16 a[204:205], v227 offset:32768
ds_read_b64_tr_b16 a[206:207], v227 offset:36864
v_smfmac_f32_16x16x64_bf16 a[132:135], a[208:211], v[96:103], v245
s_add_u32 m0, s88, 93312
s_lshl2_add_u32 s50, m0, s89
buffer_load_dwordx4 v243, s[56:59], s50 offen  lds
s_waitcnt lgkmcnt(8)
v_mfma_f32_16x16x32_bf16 v[8:11], a[144:147], v[152:155], v[136:139]
v_exp_f32 v40, v40
v_mfma_f32_16x16x32_bf16 v[8:11], a[148:151], v[156:159], v[8:11]
v_exp_f32 v41, v41
v_mfma_f32_16x16x32_bf16 v[8:11], a[152:155], v[160:163], v[8:11]
s_and_b32 s93, s80, 0xffff
v_cvt_pk_bf16_f32 v88, v40, v41
v_mfma_f32_16x16x32_bf16 v[8:11], a[156:159], v[164:167], v[8:11]
v_exp_f32 v42, v42
v_mfma_f32_16x16x32_bf16 v[16:19], a[156:159], v[180:183], v[140:143]
s_add_u32 m0, s88, 96768
s_lshl2_add_u32 s50, m0, s89
buffer_load_dwordx4 v243, s[56:59], s50 offen  lds
v_mfma_f32_16x16x32_bf16 v[16:19], a[152:155], v[176:179], v[16:19]
v_exp_f32 v43, v43
v_mfma_f32_16x16x32_bf16 v[16:19], a[148:151], v[172:175], v[16:19]
v_cvt_pk_bf16_f32 v89, v42, v43
v_cmp_eq_u32 s[90:91], s93, v133
v_mfma_f32_16x16x32_bf16 v[16:19], a[144:147], v[168:171], v[16:19]
v_exp_f32 v44, v44
v_mfma_f32_16x16x32_bf16 v[24:27], a[144:147], v[184:187], v[144:147]
v_mov_b32 v134, 4608
v_mfma_f32_16x16x32_bf16 v[24:27], a[148:151], v[188:191], v[24:27]
v_exp_f32 v45, v45
v_mfma_f32_16x16x32_bf16 v[24:27], a[152:155], v[192:195], v[24:27]
v_cvt_pk_bf16_f32 v90, v44, v45
v_cndmask_b32 v135, v135, v134, s[90:91]
v_mfma_f32_16x16x32_bf16 v[24:27], a[156:159], v[196:199], v[24:27]
v_exp_f32 v46, v46
v_mfma_f32_16x16x32_bf16 v[32:35], a[156:159], v[212:215], v[148:151]
ds_read_b128 a[156:159], v219 offset:57344
s_and_b32 s93, s81, 0xffff
v_mfma_f32_16x16x32_bf16 v[32:35], a[152:155], v[208:211], v[32:35]
v_exp_f32 v47, v47
v_mfma_f32_16x16x32_bf16 v[32:35], a[148:151], v[204:207], v[32:35]
ds_read_b128 a[152:155], v218 offset:57344
v_cvt_pk_bf16_f32 v91, v46, v47
v_mfma_f32_16x16x32_bf16 v[32:35], a[144:147], v[200:203], v[32:35]
v_exp_f32 v48, v48
v_mfma_f32_16x16x32_bf16 a[0:3], a[176:179], v[72:75], a[0:3]
ds_read_b128 a[148:151], v217 offset:57344
ds_read_b128 a[144:147], v216 offset:57344
v_mfma_f32_16x16x32_bf16 a[4:7], a[176:179], v[76:79], a[4:7]
v_exp_f32 v49, v49
v_mfma_f32_16x16x32_bf16 a[8:11], a[176:179], v[80:83], a[8:11]
v_cvt_pk_bf16_f32 v92, v48, v49
v_cmp_eq_u32 s[90:91], s93, v133
v_mfma_f32_16x16x32_bf16 a[12:15], a[176:179], v[84:87], a[12:15]
v_exp_f32 v50, v50
v_mfma_f32_16x16x32_bf16 a[28:31], a[180:183], v[84:87], a[28:31]
ds_read_b64_tr_b16 a[176:177], v220 offset:40960
ds_read_b64_tr_b16 a[178:179], v220 offset:45056
v_mfma_f32_16x16x32_bf16 a[24:27], a[180:183], v[80:83], a[24:27]
v_exp_f32 v51, v51
v_mfma_f32_16x16x32_bf16 a[20:23], a[180:183], v[76:79], a[20:23]
v_cvt_pk_bf16_f32 v93, v50, v51
v_mov_b32 v134, 5760
v_mfma_f32_16x16x32_bf16 a[16:19], a[180:183], v[72:75], a[16:19]
STUB_12:
STUB_B3:
s_cbranch_execz STUB_15
v_exp_f32 v52, v52
v_mfma_f32_16x16x32_bf16 a[32:35], a[184:187], v[72:75], a[32:35]
ds_read_b64_tr_b16 a[180:181], v221 offset:40960
ds_read_b64_tr_b16 a[182:183], v221 offset:45056
v_mfma_f32_16x16x32_bf16 a[36:39], a[184:187], v[76:79], a[36:39]
v_exp_f32 v53, v53
v_mfma_f32_16x16x32_bf16 a[40:43], a[184:187], v[80:83], a[40:43]
v_cvt_pk_bf16_f32 v94, v52, v53
v_cndmask_b32 v135, v135, v134, s[90:91]
v_mfma_f32_16x16x32_bf16 a[44:47], a[184:187], v[84:87], a[44:47]
v_exp_f32 v54, v54
v_mfma_f32_16x16x32_bf16 a[60:63], a[188:191], v[84:87], a[60:63]
ds_read_b64_tr_b16 a[184:185], v222 offset:40960
ds_read_b64_tr_b16 a[186:187], v222 offset:45056
v_mfma_f32_16x16x32_bf16 a[56:59], a[188:191], v[80:83], a[56:59]
v_exp_f32 v55, v55
v_mfma_f32_16x16x32_bf16 a[52:55], a[188:191], v[76:79], a[52:55]
s_and_b32 s93, s82, 0xffff
v_cvt_pk_bf16_f32 v95, v54, v55
v_mfma_f32_16x16x32_bf16 a[48:51], a[188:191], v[72:75], a[48:51]
v_exp_f32 v56, v56
v_smfmac_f32_16x16x64_bf16 a[128:131], a[208:211], v[72:79], v245
ds_read_b64_tr_b16 a[188:189], v223 offset:40960
v_mfma_f32_16x16x32_bf16 v[12:15], a[160:163], v[152:155], v[136:139]
v_exp_f32 v57, v57
v_mfma_f32_16x16x32_bf16 v[12:15], a[164:167], v[156:159], v[12:15]
v_exp_f32 v58, v58
v_mfma_f32_16x16x32_bf16 v[12:15], a[168:171], v[160:163], v[12:15]
ds_read_b64_tr_b16 a[190:191], v223 offset:45056
v_cvt_pk_bf16_f32 v96, v56, v57
v_mfma_f32_16x16x32_bf16 v[12:15], a[172:175], v[164:167], v[12:15]
v_exp_f32 v59, v59
v_mfma_f32_16x16x32_bf16 v[20:23], a[172:175], v[180:183], v[140:143]
v_cvt_pk_bf16_f32 v97, v58, v59
v_cmp_eq_u32 s[90:91], s93, v133
v_mfma_f32_16x16x32_bf16 v[20:23], a[168:171], v[176:179], v[20:23]
v_exp_f32 v60, v60
v_mfma_f32_16x16x32_bf16 v[20:23], a[164:167], v[172:175], v[20:23]
s_add_u32 m0, s88, 100224
s_lshl2_add_u32 s50, m0, s89
buffer_load_dwordx4 v243, s[56:59], s50 offen  lds
v_mfma_f32_16x16x32_bf16 v[20:23], a[160:163], v[168:171], v[20:23]
v_exp_f32 v61, v61
v_mfma_f32_16x16x32_bf16 v[28:31], a[160:163], v[184:187], v[144:147]
v_cvt_pk_bf16_f32 v98, v60, v61
v_mov_b32 v134, 6912
v_mfma_f32_16x16x32_bf16 v[28:31], a[164:167], v[188:191], v[28:31]
v_exp_f32 v62, v62
v_mfma_f32_16x16x32_bf16 v[28:31], a[168:171], v[192:195], v[28:31]
s_add_u32 m0, s88, 103680
s_lshl2_add_u32 s50, m0, s89
buffer_load_dwordx4 v243, s[56:59], s50 offen  lds
v_mfma_f32_16x16x32_bf16 v[28:31], a[172:175], v[196:199], v[28:31]
v_exp_f32 v63, v63
v_mfma_f32_16x16x32_bf16 v[36:39], a[172:175], v[212:215], v[148:151]
ds_read_b128 a[172:175], v219 offset:61440
v_cvt_pk_bf16_f32 v99, v62, v63
v_mfma_f32_16x16x32_bf16 v[36:39], a[168:171], v[208:211], v[36:39]
v_exp_f32 v64, v64
v_mfma_f32_16x16x32_bf16 v[36:39], a[164:167], v[204:207], v[36:39]
ds_read_b128 a[168:171], v218 offset:61440
ds_read_b128 a[164:167], v217 offset:61440
v_mfma_f32_16x16x32_bf16 v[36:39], a[160:163], v[200:203], v[36:39]
v_exp_f32 v65, v65
s_waitcnt lgkmcnt(8)
v_mfma_f32_16x16x32_bf16 a[64:67], a[192:195], v[72:75], a[64:67]
ds_read_b128 a[160:163], v216 offset:61440
v_cvt_pk_bf16_f32 v100, v64, v65
v_mfma_f32_16x16x32_bf16 a[68:71], a[192:195], v[76:79], a[68:71]
v_exp_f32 v66, v66
v_mfma_f32_16x16x32_bf16 a[72:75], a[192:195], v[80:83], a[72:75]
s_add_u32 m0, s88, 107136
s_lshl2_add_u32 s50, m0, s89
buffer_load_dwordx4 v243, s[56:59], s50 offen  lds
v_mfma_f32_16x16x32_bf16 a[76:79], a[192:195], v[84:87], a[76:79]
v_exp_f32 v67, v67
v_mfma_f32_16x16x32_bf16 a[92:95], a[196:199], v[84:87], a[92:95]
ds_read_b64_tr_b16 a[192:193], v224 offset:40960
v_cvt_pk_bf16_f32 v101, v66, v67
v_mfma_f32_16x16x32_bf16 a[88:91], a[196:199], v[80:83], a[88:91]
v_exp_f32 v68, v68
v_mfma_f32_16x16x32_bf16 a[84:87], a[196:199], v[76:79], a[84:87]
ds_read_b64_tr_b16 a[194:195], v224 offset:45056
v_cndmask_b32 v135, v135, v134, s[90:91]
v_mfma_f32_16x16x32_bf16 a[80:83], a[196:199], v[72:75], a[80:83]
v_exp_f32 v69, v69
v_mfma_f32_16x16x32_bf16 a[96:99], a[200:203], v[72:75], a[96:99]
ds_read_b64_tr_b16 a[196:197], v225 offset:40960
v_cvt_pk_bf16_f32 v102, v68, v69
v_mfma_f32_16x16x32_bf16 a[100:103], a[200:203], v[76:79], a[100:103]
v_exp_f32 v70, v70
v_mfma_f32_16x16x32_bf16 a[104:107], a[200:203], v[80:83], a[104:107]
ds_read_b64_tr_b16 a[198:199], v225 offset:45056
s_and_b32 s93, s83, 0xffff
v_mfma_f32_16x16x32_bf16 a[108:111], a[200:203], v[84:87], a[108:111]
v_exp_f32 v71, v71
v_mfma_f32_16x16x32_bf16 a[124:127], a[204:207], v[84:87], a[124:127]
ds_read_b64_tr_b16 a[200:201], v226 offset:40960
v_cvt_pk_bf16_f32 v103, v70, v71
v_mfma_f32_16x16x32_bf16 a[120:123], a[204:207], v[80:83], a[120:123]
ds_read_b64_tr_b16 a[202:203], v226 offset:45056
v_cmp_eq_u32 s[90:91], s93, v133
v_mfma_f32_16x16x32_bf16 a[116:119], a[204:207], v[76:79], a[116:119]
s_add_u32 m0, s88, 110592
s_lshl2_add_u32 s50, m0, s89
buffer_load_dwordx4 v243, s[56:59], s50 offen  lds
v_mfma_f32_16x16x32_bf16 a[112:115], a[204:207], v[72:75], a[112:115]
ds_read_b64_tr_b16 a[204:205], v227 offset:40960
ds_read_b64_tr_b16 a[206:207], v227 offset:45056
v_smfmac_f32_16x16x64_bf16 a[132:135], a[208:211], v[80:87], v245
v_mov_b32 v134, 8064
v_mfma_f32_16x16x32_bf16 v[40:43], a[144:147], v[152:155], v[136:139]
v_exp_f32 v8, v8
v_mfma_f32_16x16x32_bf16 v[40:43], a[148:151], v[156:159], v[40:43]
v_exp_f32 v9, v9
v_mfma_f32_16x16x32_bf16 v[40:43], a[152:155], v[160:163], v[40:43]
v_cvt_pk_bf16_f32 v72, v8, v9
v_cndmask_b32 v135, v135, v134, s[90:91]
v_mfma_f32_16x16x32_bf16 v[40:43], a[156:159], v[164:167], v[40:43]
v_exp_f32 v10, v10
v_mfma_f32_16x16x32_bf16 v[48:51], a[156:159], v[180:183], v[140:143]
v_add_u32 v250, v250, v135
v_add_u32 v251, v251, v135
v_mfma_f32_16x16x32_bf16 v[48:51], a[152:155], v[176:179], v[48:51]
v_exp_f32 v11, v11
v_mfma_f32_16x16x32_bf16 v[48:51], a[148:151], v[172:175], v[48:51]
v_cvt_pk_bf16_f32 v73, v10, v11
v_lshrrev_b32 v134, 14, v135
v_mfma_f32_16x16x32_bf16 v[48:51], a[144:147], v[168:171], v[48:51]
v_exp_f32 v12, v12
v_mfma_f32_16x16x32_bf16 v[56:59], a[144:147], v[184:187], v[144:147]
v_cmp_eq_u32 s[90:91], 0, v134
v_mfma_f32_16x16x32_bf16 v[56:59], a[148:151], v[188:191], v[56:59]
v_exp_f32 v13, v13
v_mfma_f32_16x16x32_bf16 v[56:59], a[152:155], v[192:195], v[56:59]
v_cvt_pk_bf16_f32 v74, v12, v13
v_mfma_f32_16x16x32_bf16 v[56:59], a[156:159], v[196:199], v[56:59]
v_exp_f32 v14, v14
v_mfma_f32_16x16x32_bf16 v[64:67], a[156:159], v[212:215], v[148:151]
s_waitcnt vmcnt(12) lgkmcnt(0)
s_barrier
v_mfma_f32_16x16x32_bf16 v[64:67], a[152:155], v[208:211], v[64:67]
v_exp_f32 v15, v15
v_mfma_f32_16x16x32_bf16 v[64:67], a[148:151], v[204:207], v[64:67]
v_cvt_pk_bf16_f32 v75, v14, v15
v_mfma_f32_16x16x32_bf16 v[64:67], a[144:147], v[200:203], v[64:67]
v_exp_f32 v16, v16
v_mfma_f32_16x16x32_bf16 a[0:3], a[176:179], v[88:91], a[0:3]
s_add_u32 m0, s88, 114048
s_lshl2_add_u32 s50, m0, s89
buffer_load_dwordx4 v243, s[56:59], s50 offen  lds
v_mfma_f32_16x16x32_bf16 a[4:7], a[176:179], v[92:95], a[4:7]
v_exp_f32 v17, v17
v_mfma_f32_16x16x32_bf16 a[8:11], a[176:179], v[96:99], a[8:11]
v_cvt_pk_bf16_f32 v76, v16, v17
v_mfma_f32_16x16x32_bf16 a[12:15], a[176:179], v[100:103], a[12:15]
v_exp_f32 v18, v18
v_mfma_f32_16x16x32_bf16 a[28:31], a[180:183], v[100:103], a[28:31]
ds_read_b64_tr_b16 a[176:177], v220 offset:49152
ds_read_b64_tr_b16 a[178:179], v220 offset:53248
v_mfma_f32_16x16x32_bf16 a[24:27], a[180:183], v[96:99], a[24:27]
v_exp_f32 v19, v19
v_mfma_f32_16x16x32_bf16 a[20:23], a[180:183], v[92:95], a[20:23]
v_cvt_pk_bf16_f32 v77, v18, v19
v_mfma_f32_16x16x32_bf16 a[16:19], a[180:183], v[88:91], a[16:19]
v_exp_f32 v20, v20
v_mfma_f32_16x16x32_bf16 a[32:35], a[184:187], v[88:91], a[32:35]
ds_read_b64_tr_b16 a[180:181], v221 offset:49152
ds_read_b64_tr_b16 a[182:183], v221 offset:53248
v_mfma_f32_16x16x32_bf16 a[36:39], a[184:187], v[92:95], a[36:39]
v_exp_f32 v21, v21
v_mfma_f32_16x16x32_bf16 a[40:43], a[184:187], v[96:99], a[40:43]
v_cvt_pk_bf16_f32 v78, v20, v21
v_mfma_f32_16x16x32_bf16 a[44:47], a[184:187], v[100:103], a[44:47]
v_exp_f32 v22, v22
v_mfma_f32_16x16x32_bf16 a[60:63], a[188:191], v[100:103], a[60:63]
ds_read_b64_tr_b16 a[184:185], v222 offset:49152
ds_read_b64_tr_b16 a[186:187], v222 offset:53248
v_mfma_f32_16x16x32_bf16 a[56:59], a[188:191], v[96:99], a[56:59]
v_exp_f32 v23, v23
v_mfma_f32_16x16x32_bf16 a[52:55], a[188:191], v[92:95], a[52:55]
v_cvt_pk_bf16_f32 v79, v22, v23
v_mfma_f32_16x16x32_bf16 a[48:51], a[188:191], v[88:91], a[48:51]
v_exp_f32 v24, v24
v_smfmac_f32_16x16x64_bf16 a[128:131], a[208:211], v[88:95], v245
ds_read_b64_tr_b16 a[188:189], v223 offset:49152
v_mfma_f32_16x16x32_bf16 v[44:47], a[160:163], v[152:155], v[136:139]
v_exp_f32 v25, v25
v_mfma_f32_16x16x32_bf16 v[44:47], a[164:167], v[156:159], v[44:47]
v_exp_f32 v26, v26
v_mfma_f32_16x16x32_bf16 v[44:47], a[168:171], v[160:163], v[44:47]
ds_read_b64_tr_b16 a[190:191], v223 offset:53248
v_cvt_pk_bf16_f32 v80, v24, v25
v_mfma_f32_16x16x32_bf16 v[44:47], a[172:175], v[164:167], v[44:47]
v_exp_f32 v27, v27
v_mfma_f32_16x16x32_bf16 v[52:55], a[172:175], v[180:183], v[140:143]
v_cvt_pk_bf16_f32 v81, v26, v27
s_waitcnt vmcnt(23)
v_readfirstlane_b32 s93, v246
v_mfma_f32_16x16x32_bf16 v[52:55], a[168:171], v[176:179], v[52:55]
v_exp_f32 v28, v28
v_mfma_f32_16x16x32_bf16 v[52:55], a[164:167], v[172:175], v[52:55]
s_add_u32 m0, s88, 117504
s_lshl2_add_u32 s50, m0, s89
buffer_load_dwordx4 v243, s[56:59], s50 offen  lds
v_mfma_f32_16x16x32_bf16 v[52:55], a[160:163], v[168:171], v[52:55]
v_exp_f32 v29, v29
v_mfma_f32_16x16x32_bf16 v[60:63], a[160:163], v[184:187], v[144:147]
s_cmp_eq_u64 s[90:91], 0
s_cselect_b32 s93, 144, s93
v_cvt_pk_bf16_f32 v82, v28, v29
v_mfma_f32_16x16x32_bf16 v[60:63], a[164:167], v[188:191], v[60:63]
v_exp_f32 v30, v30
v_mfma_f32_16x16x32_bf16 v[60:63], a[168:171], v[192:195], v[60:63]
s_add_u32 m0, s88, 120960
s_lshl2_add_u32 s50, m0, s89
buffer_load_dwordx4 v243, s[56:59], s50 offen  lds
v_mfma_f32_16x16x32_bf16 v[60:63], a[172:175], v[196:199], v[60:63]
v_exp_f32 v31, v31
v_mfma_f32_16x16x32_bf16 v[68:71], a[172:175], v[212:215], v[148:151]
v_cvt_pk_bf16_f32 v83, v30, v31
v_mfma_f32_16x16x32_bf16 v[68:71], a[168:171], v[208:211], v[68:71]
v_exp_f32 v32, v32
v_mfma_f32_16x16x32_bf16 v[68:71], a[164:167], v[204:207], v[68:71]
s_add_u32 m0, s88, 124416
s_lshl2_add_u32 s50, m0, s89
buffer_load_dwordx4 v243, s[56:59], s50 offen  lds
v_mfma_f32_16x16x32_bf16 v[68:71], a[160:163], v[200:203], v[68:71]
v_exp_f32 v33, v33
v_mfma_f32_16x16x32_bf16 a[64:67], a[192:195], v[88:91], a[64:67]
v_cvt_pk_bf16_f32 v84, v32, v33
v_mfma_f32_16x16x32_bf16 a[68:71], a[192:195], v[92:95], a[68:71]
v_exp_f32 v34, v34
v_mfma_f32_16x16x32_bf16 a[72:75], a[192:195], v[96:99], a[72:75]
s_add_u32 m0, s88, 127872
s_lshl2_add_u32 s50, m0, s89
buffer_load_dwordx4 v243, s[56:59], s50 offen  lds
v_mfma_f32_16x16x32_bf16 a[76:79], a[192:195], v[100:103], a[76:79]
v_exp_f32 v35, v35
v_mfma_f32_16x16x32_bf16 a[92:95], a[196:199], v[100:103], a[92:95]
ds_read_b64_tr_b16 a[192:193], v224 offset:49152
v_cvt_pk_bf16_f32 v85, v34, v35
v_mfma_f32_16x16x32_bf16 a[88:91], a[196:199], v[96:99], a[88:91]
v_exp_f32 v36, v36
v_mfma_f32_16x16x32_bf16 a[84:87], a[196:199], v[92:95], a[84:87]
ds_read_b64_tr_b16 a[194:195], v224 offset:53248
s_cmp_lt_u32 s93, 144
s_cbranch_scc1 SP_Y
SP_Y_RET:
v_mfma_f32_16x16x32_bf16 a[80:83], a[196:199], v[88:91], a[80:83]
v_exp_f32 v37, v37
v_mfma_f32_16x16x32_bf16 a[96:99], a[200:203], v[88:91], a[96:99]
ds_read_b64_tr_b16 a[196:197], v225 offset:49152
v_cvt_pk_bf16_f32 v86, v36, v37
v_mfma_f32_16x16x32_bf16 a[100:103], a[200:203], v[92:95], a[100:103]
v_exp_f32 v38, v38
v_mfma_f32_16x16x32_bf16 a[104:107], a[200:203], v[96:99], a[104:107]
ds_read_b64_tr_b16 a[198:199], v225 offset:53248
s_mov_b32 s93, 0x244000
v_mfma_f32_16x16x32_bf16 a[108:111], a[200:203], v[100:103], a[108:111]
v_exp_f32 v39, v39
v_mfma_f32_16x16x32_bf16 a[124:127], a[204:207], v[100:103], a[124:127]
ds_read_b64_tr_b16 a[200:201], v226 offset:49152
v_cvt_pk_bf16_f32 v87, v38, v39
v_mfma_f32_16x16x32_bf16 a[120:123], a[204:207], v[96:99], a[120:123]
ds_read_b64_tr_b16 a[202:203], v226 offset:53248
v_mfma_f32_16x16x32_bf16 a[116:119], a[204:207], v[92:95], a[116:119]
s_add_u32 m0, s88, 131328
s_lshl2_add_u32 s50, m0, s89
buffer_load_dwordx4 v243, s[56:59], s50 offen  lds
v_mfma_f32_16x16x32_bf16 a[112:115], a[204:207], v[88:91], a[112:115]
ds_read_b64_tr_b16 a[204:205], v227 offset:49152
ds_read_b64_tr_b16 a[206:207], v227 offset:53248
v_smfmac_f32_16x16x64_bf16 a[132:135], a[208:211], v[96:103], v245
s_add_u32 m0, s88, 134784
s_lshl2_add_u32 s50, m0, s89
buffer_load_dwordx4 v243, s[56:59], s50 offen  lds
s_waitcnt lgkmcnt(8)
v_mfma_f32_16x16x32_bf16 a[0:3], a[176:179], v[72:75], a[0:3]
v_exp_f32 v40, v40
v_exp_f32 v41, v41
v_mfma_f32_16x16x32_bf16 a[4:7], a[176:179], v[76:79], a[4:7]
buffer_load_dwordx4 a[232:235], v250, s[20:23], s93 offen offset:0 sc0 sc1
v_cvt_pk_bf16_f32 v88, v40, v41
v_exp_f32 v42, v42
v_mfma_f32_16x16x32_bf16 a[8:11], a[176:179], v[80:83], a[8:11]
buffer_load_dwordx4 a[236:239], v250, s[20:23], s93 offen offset:128 sc0 sc1
v_exp_f32 v43, v43
v_mfma_f32_16x16x32_bf16 a[12:15], a[176:179], v[84:87], a[12:15]
ds_read_b64_tr_b16 a[176:177], v220 offset:57344
v_cvt_pk_bf16_f32 v89, v42, v43
v_exp_f32 v44, v44
v_mfma_f32_16x16x32_bf16 a[28:31], a[180:183], v[84:87], a[28:31]
ds_read_b64_tr_b16 a[178:179], v220 offset:61440
v_exp_f32 v45, v45
v_mfma_f32_16x16x32_bf16 a[24:27], a[180:183], v[80:83], a[24:27]
v_cvt_pk_bf16_f32 v90, v44, v45
v_exp_f32 v46, v46
v_mfma_f32_16x16x32_bf16 a[20:23], a[180:183], v[76:79], a[20:23]
buffer_load_dwordx2 a[240:241], v251, s[20:23], s93 offen sc0 sc1
v_exp_f32 v47, v47
v_mfma_f32_16x16x32_bf16 a[16:19], a[180:183], v[72:75], a[16:19]
ds_read_b64_tr_b16 a[180:181], v221 offset:57344
v_cvt_pk_bf16_f32 v91, v46, v47
v_exp_f32 v48, v48
v_mfma_f32_16x16x32_bf16 a[32:35], a[184:187], v[72:75], a[32:35]
ds_read_b64_tr_b16 a[182:183], v221 offset:61440
v_exp_f32 v49, v49
v_mfma_f32_16x16x32_bf16 a[36:39], a[184:187], v[76:79], a[36:39]
v_cvt_pk_bf16_f32 v92, v48, v49
v_exp_f32 v50, v50
v_mfma_f32_16x16x32_bf16 a[40:43], a[184:187], v[80:83], a[40:43]
v_exp_f32 v51, v51
v_mfma_f32_16x16x32_bf16 a[44:47], a[184:187], v[84:87], a[44:47]
ds_read_b64_tr_b16 a[184:185], v222 offset:57344
v_cvt_pk_bf16_f32 v93, v50, v51
v_exp_f32 v52, v52
v_mfma_f32_16x16x32_bf16 a[60:63], a[188:191], v[84:87], a[60:63]
ds_read_b64_tr_b16 a[186:187], v222 offset:61440
v_exp_f32 v53, v53
v_mfma_f32_16x16x32_bf16 a[56:59], a[188:191], v[80:83], a[56:59]
v_cvt_pk_bf16_f32 v94, v52, v53
v_exp_f32 v54, v54
v_mfma_f32_16x16x32_bf16 a[52:55], a[188:191], v[76:79], a[52:55]
v_exp_f32 v55, v55
v_mfma_f32_16x16x32_bf16 a[48:51], a[188:191], v[72:75], a[48:51]
v_exp_f32 v56, v56
v_exp_f32 v57, v57
v_smfmac_f32_16x16x64_bf16 a[128:131], a[208:211], v[72:79], v245
v_cvt_pk_bf16_f32 v95, v54, v55
v_cvt_pk_bf16_f32 v96, v56, v57
v_exp_f32 v58, v58
s_waitcnt lgkmcnt(8)
v_mfma_f32_16x16x32_bf16 a[64:67], a[192:195], v[72:75], a[64:67]
ds_read_b64_tr_b16 a[188:189], v223 offset:57344
ds_read_b64_tr_b16 a[190:191], v223 offset:61440
v_exp_f32 v59, v59
v_mfma_f32_16x16x32_bf16 a[68:71], a[192:195], v[76:79], a[68:71]
v_cvt_pk_bf16_f32 v97, v58, v59
v_exp_f32 v60, v60
v_mfma_f32_16x16x32_bf16 a[72:75], a[192:195], v[80:83], a[72:75]
v_exp_f32 v61, v61
v_mfma_f32_16x16x32_bf16 a[76:79], a[192:195], v[84:87], a[76:79]
ds_read_b64_tr_b16 a[192:193], v224 offset:57344
v_cvt_pk_bf16_f32 v98, v60, v61
v_exp_f32 v62, v62
v_mfma_f32_16x16x32_bf16 a[92:95], a[196:199], v[84:87], a[92:95]
ds_read_b64_tr_b16 a[194:195], v224 offset:61440
v_exp_f32 v63, v63
v_mfma_f32_16x16x32_bf16 a[88:91], a[196:199], v[80:83], a[88:91]
v_cvt_pk_bf16_f32 v99, v62, v63
v_exp_f32 v64, v64
v_mfma_f32_16x16x32_bf16 a[84:87], a[196:199], v[76:79], a[84:87]
v_exp_f32 v65, v65
v_mfma_f32_16x16x32_bf16 a[80:83], a[196:199], v[72:75], a[80:83]
ds_read_b64_tr_b16 a[196:197], v225 offset:57344
v_cvt_pk_bf16_f32 v100, v64, v65
v_exp_f32 v66, v66
v_mfma_f32_16x16x32_bf16 a[96:99], a[200:203], v[72:75], a[96:99]
ds_read_b64_tr_b16 a[198:199], v225 offset:61440
v_exp_f32 v67, v67
v_mfma_f32_16x16x32_bf16 a[100:103], a[200:203], v[76:79], a[100:103]
v_cvt_pk_bf16_f32 v101, v66, v67
v_exp_f32 v68, v68
v_mfma_f32_16x16x32_bf16 a[104:107], a[200:203], v[80:83], a[104:107]
v_exp_f32 v69, v69
v_mfma_f32_16x16x32_bf16 a[108:111], a[200:203], v[84:87], a[108:111]
ds_read_b64_tr_b16 a[200:201], v226 offset:57344
v_cvt_pk_bf16_f32 v102, v68, v69
v_exp_f32 v70, v70
s_waitcnt lgkmcnt(8)
v_mfma_f32_16x16x32_bf16 a[124:127], a[204:207], v[84:87], a[124:127]
ds_read_b64_tr_b16 a[202:203], v226 offset:61440
v_exp_f32 v71, v71
v_mfma_f32_16x16x32_bf16 a[120:123], a[204:207], v[80:83], a[120:123]
v_cvt_pk_bf16_f32 v103, v70, v71
v_mfma_f32_16x16x32_bf16 a[116:119], a[204:207], v[76:79], a[116:119]
s_add_u32 m0, s88, 138240
s_lshl2_add_u32 s50, m0, s89
buffer_load_dwordx4 v243, s[56:59], s50 offen  lds
v_mfma_f32_16x16x32_bf16 a[112:115], a[204:207], v[72:75], a[112:115]
ds_read_b64_tr_b16 a[204:205], v227 offset:57344
ds_read_b64_tr_b16 a[206:207], v227 offset:61440
v_smfmac_f32_16x16x64_bf16 a[132:135], a[208:211], v[80:87], v245
s_add_u32 m0, s88, 141696
s_lshl2_add_u32 s50, m0, s89
buffer_load_dwordx4 v243, s[56:59], s50 offen  lds
s_add_u32 m0, s88, 145152
s_min_u32 m0, m0, 146880
s_lshl2_add_u32 s50, m0, s89
s_cmp_ge_u32 s37, 2
s_cselect_b32 exec_hi, 15, -1
buffer_load_dwordx4 v243, s[56:59], s50 offen  lds
s_mov_b32 exec_hi, -1
s_cmp_eq_u32 s48, 0
s_cbranch_scc1 K_MIXED
s_waitcnt lgkmcnt(0)
s_barrier
v_smfmac_f32_16x16x64_bf16 a[128:131], a[208:211], v[88:95], v245
v_smfmac_f32_16x16x64_bf16 a[132:135], a[208:211], v[96:103], v245
v_mfma_f32_16x16x32_bf16 a[0:3], a[176:179], v[88:91], a[0:3]
v_mfma_f32_16x16x32_bf16 a[16:19], a[180:183], v[88:91], a[16:19]
v_mfma_f32_16x16x32_bf16 a[32:35], a[184:187], v[88:91], a[32:35]
v_mfma_f32_16x16x32_bf16 a[48:51], a[188:191], v[88:91], a[48:51]
v_mfma_f32_16x16x32_bf16 a[64:67], a[192:195], v[88:91], a[64:67]
v_mfma_f32_16x16x32_bf16 a[80:83], a[196:199], v[88:91], a[80:83]
v_mfma_f32_16x16x32_bf16 a[96:99], a[200:203], v[88:91], a[96:99]
v_mfma_f32_16x16x32_bf16 a[112:115], a[204:207], v[88:91], a[112:115]
v_mfma_f32_16x16x32_bf16 a[4:7], a[176:179], v[92:95], a[4:7]
v_mfma_f32_16x16x32_bf16 a[20:23], a[180:183], v[92:95], a[20:23]
v_mfma_f32_16x16x32_bf16 a[36:39], a[184:187], v[92:95], a[36:39]
v_mfma_f32_16x16x32_bf16 a[52:55], a[188:191], v[92:95], a[52:55]
v_mfma_f32_16x16x32_bf16 a[68:71], a[192:195], v[92:95], a[68:71]
v_mfma_f32_16x16x32_bf16 a[84:87], a[196:199], v[92:95], a[84:87]
v_mfma_f32_16x16x32_bf16 a[100:103], a[200:203], v[92:95], a[100:103]
v_mfma_f32_16x16x32_bf16 a[116:119], a[204:207], v[92:95], a[116:119]
v_accvgpr_read_b32 v120, a128
v_accvgpr_read_b32 v124, a129
v_add_f32 v120, v120, v124
v_rcp_f32 v124, v120
s_add_u32 s50, s44, 0
v_mov_b32 v125, v124
v_accvgpr_read_b32 v104, a0
v_accvgpr_read_b32 v105, a1
v_accvgpr_read_b32 v106, a2
v_accvgpr_read_b32 v107, a3
v_accvgpr_read_b32 v108, a16
v_accvgpr_read_b32 v109, a17
v_accvgpr_read_b32 v110, a18
v_accvgpr_read_b32 v111, a19
v_pk_mul_f32 v[104:105], v[104:105], v[124:125]
v_pk_mul_f32 v[106:107], v[106:107], v[124:125]
v_pk_mul_f32 v[108:109], v[108:109], v[124:125]
v_pk_mul_f32 v[110:111], v[110:111], v[124:125]
v_cvt_pk_bf16_f32 v8, v104, v105
v_cvt_pk_bf16_f32 v9, v106, v107
v_cvt_pk_bf16_f32 v10, v108, v109
v_cvt_pk_bf16_f32 v11, v110, v111
buffer_store_dwordx4 v[8:11], v244, s[20:23], s50 offen offset:0
v_accvgpr_read_b32 v112, a32
v_accvgpr_read_b32 v113, a33
v_accvgpr_read_b32 v114, a34
v_accvgpr_read_b32 v115, a35
v_accvgpr_read_b32 v116, a48
v_accvgpr_read_b32 v117, a49
v_accvgpr_read_b32 v118, a50
v_accvgpr_read_b32 v119, a51
v_pk_mul_f32 v[112:113], v[112:113], v[124:125]
v_pk_mul_f32 v[114:115], v[114:115], v[124:125]
v_pk_mul_f32 v[116:117], v[116:117], v[124:125]
v_pk_mul_f32 v[118:119], v[118:119], v[124:125]
v_cvt_pk_bf16_f32 v12, v112, v113
v_cvt_pk_bf16_f32 v13, v114, v115
v_cvt_pk_bf16_f32 v14, v116, v117
v_cvt_pk_bf16_f32 v15, v118, v119
buffer_store_dwordx4 v[12:15], v244, s[20:23], s50 offen offset:1024
v_accvgpr_read_b32 v104, a64
v_accvgpr_read_b32 v105, a65
v_accvgpr_read_b32 v106, a66
v_accvgpr_read_b32 v107, a67
v_accvgpr_read_b32 v108, a80
v_accvgpr_read_b32 v109, a81
v_accvgpr_read_b32 v110, a82
v_accvgpr_read_b32 v111, a83
v_pk_mul_f32 v[104:105], v[104:105], v[124:125]
v_pk_mul_f32 v[106:107], v[106:107], v[124:125]
v_pk_mul_f32 v[108:109], v[108:109], v[124:125]
v_pk_mul_f32 v[110:111], v[110:111], v[124:125]
v_cvt_pk_bf16_f32 v16, v104, v105
v_cvt_pk_bf16_f32 v17, v106, v107
v_cvt_pk_bf16_f32 v18, v108, v109
v_cvt_pk_bf16_f32 v19, v110, v111
buffer_store_dwordx4 v[16:19], v244, s[20:23], s50 offen offset:2048
v_accvgpr_read_b32 v112, a96
v_accvgpr_read_b32 v113, a97
v_accvgpr_read_b32 v114, a98
v_accvgpr_read_b32 v115, a99
v_accvgpr_read_b32 v116, a112
v_accvgpr_read_b32 v117, a113
v_accvgpr_read_b32 v118, a114
v_accvgpr_read_b32 v119, a115
v_pk_mul_f32 v[112:113], v[112:113], v[124:125]
v_pk_mul_f32 v[114:115], v[114:115], v[124:125]
v_pk_mul_f32 v[116:117], v[116:117], v[124:125]
v_pk_mul_f32 v[118:119], v[118:119], v[124:125]
v_cvt_pk_bf16_f32 v20, v112, v113
v_cvt_pk_bf16_f32 v21, v114, v115
v_cvt_pk_bf16_f32 v22, v116, v117
v_cvt_pk_bf16_f32 v23, v118, v119
buffer_store_dwordx4 v[20:23], v244, s[20:23], s50 offen offset:3072
v_mfma_f32_16x16x32_bf16 a[8:11], a[176:179], v[96:99], a[8:11]
v_mfma_f32_16x16x32_bf16 a[24:27], a[180:183], v[96:99], a[24:27]
v_mfma_f32_16x16x32_bf16 a[40:43], a[184:187], v[96:99], a[40:43]
v_mfma_f32_16x16x32_bf16 a[56:59], a[188:191], v[96:99], a[56:59]
v_mfma_f32_16x16x32_bf16 a[72:75], a[192:195], v[96:99], a[72:75]
v_mfma_f32_16x16x32_bf16 a[88:91], a[196:199], v[96:99], a[88:91]
v_mfma_f32_16x16x32_bf16 a[104:107], a[200:203], v[96:99], a[104:107]
v_mfma_f32_16x16x32_bf16 a[120:123], a[204:207], v[96:99], a[120:123]
v_accvgpr_read_b32 v121, a130
v_accvgpr_read_b32 v126, a131
v_add_f32 v121, v121, v126
v_rcp_f32 v126, v121
s_add_u32 s50, s44, 4096
v_mov_b32 v127, v126
v_accvgpr_read_b32 v104, a4
v_accvgpr_read_b32 v105, a5
v_accvgpr_read_b32 v106, a6
v_accvgpr_read_b32 v107, a7
v_accvgpr_read_b32 v108, a20
v_accvgpr_read_b32 v109, a21
v_accvgpr_read_b32 v110, a22
v_accvgpr_read_b32 v111, a23
v_pk_mul_f32 v[104:105], v[104:105], v[126:127]
v_pk_mul_f32 v[106:107], v[106:107], v[126:127]
v_pk_mul_f32 v[108:109], v[108:109], v[126:127]
v_pk_mul_f32 v[110:111], v[110:111], v[126:127]
v_cvt_pk_bf16_f32 v24, v104, v105
v_cvt_pk_bf16_f32 v25, v106, v107
v_cvt_pk_bf16_f32 v26, v108, v109
v_cvt_pk_bf16_f32 v27, v110, v111
buffer_store_dwordx4 v[24:27], v244, s[20:23], s50 offen offset:0
v_accvgpr_read_b32 v112, a36
v_accvgpr_read_b32 v113, a37
v_accvgpr_read_b32 v114, a38
v_accvgpr_read_b32 v115, a39
v_accvgpr_read_b32 v116, a52
v_accvgpr_read_b32 v117, a53
v_accvgpr_read_b32 v118, a54
v_accvgpr_read_b32 v119, a55
v_pk_mul_f32 v[112:113], v[112:113], v[126:127]
v_pk_mul_f32 v[114:115], v[114:115], v[126:127]
v_pk_mul_f32 v[116:117], v[116:117], v[126:127]
v_pk_mul_f32 v[118:119], v[118:119], v[126:127]
v_cvt_pk_bf16_f32 v28, v112, v113
v_cvt_pk_bf16_f32 v29, v114, v115
v_cvt_pk_bf16_f32 v30, v116, v117
v_cvt_pk_bf16_f32 v31, v118, v119
buffer_store_dwordx4 v[28:31], v244, s[20:23], s50 offen offset:1024
v_accvgpr_read_b32 v104, a68
v_accvgpr_read_b32 v105, a69
v_accvgpr_read_b32 v106, a70
v_accvgpr_read_b32 v107, a71
v_accvgpr_read_b32 v108, a84
v_accvgpr_read_b32 v109, a85
v_accvgpr_read_b32 v110, a86
v_accvgpr_read_b32 v111, a87
v_pk_mul_f32 v[104:105], v[104:105], v[126:127]
v_pk_mul_f32 v[106:107], v[106:107], v[126:127]
v_pk_mul_f32 v[108:109], v[108:109], v[126:127]
v_pk_mul_f32 v[110:111], v[110:111], v[126:127]
v_cvt_pk_bf16_f32 v32, v104, v105
v_cvt_pk_bf16_f32 v33, v106, v107
v_cvt_pk_bf16_f32 v34, v108, v109
v_cvt_pk_bf16_f32 v35, v110, v111
buffer_store_dwordx4 v[32:35], v244, s[20:23], s50 offen offset:2048
v_accvgpr_read_b32 v112, a100
v_accvgpr_read_b32 v113, a101
v_accvgpr_read_b32 v114, a102
v_accvgpr_read_b32 v115, a103
v_accvgpr_read_b32 v116, a116
v_accvgpr_read_b32 v117, a117
v_accvgpr_read_b32 v118, a118
v_accvgpr_read_b32 v119, a119
v_pk_mul_f32 v[112:113], v[112:113], v[126:127]
v_pk_mul_f32 v[114:115], v[114:115], v[126:127]
v_pk_mul_f32 v[116:117], v[116:117], v[126:127]
v_pk_mul_f32 v[118:119], v[118:119], v[126:127]
v_cvt_pk_bf16_f32 v36, v112, v113
v_cvt_pk_bf16_f32 v37, v114, v115
v_cvt_pk_bf16_f32 v38, v116, v117
v_cvt_pk_bf16_f32 v39, v118, v119
buffer_store_dwordx4 v[36:39], v244, s[20:23], s50 offen offset:3072
v_mfma_f32_16x16x32_bf16 a[12:15], a[176:179], v[100:103], a[12:15]
v_mfma_f32_16x16x32_bf16 a[28:31], a[180:183], v[100:103], a[28:31]
v_mfma_f32_16x16x32_bf16 a[44:47], a[184:187], v[100:103], a[44:47]
STUB_13:
s_cbranch_execz STUB_16
v_mfma_f32_16x16x32_bf16 a[60:63], a[188:191], v[100:103], a[60:63]
v_mfma_f32_16x16x32_bf16 a[76:79], a[192:195], v[100:103], a[76:79]
v_mfma_f32_16x16x32_bf16 a[92:95], a[196:199], v[100:103], a[92:95]
v_mfma_f32_16x16x32_bf16 a[108:111], a[200:203], v[100:103], a[108:111]
v_mfma_f32_16x16x32_bf16 a[124:127], a[204:207], v[100:103], a[124:127]
v_accvgpr_read_b32 v122, a132
v_accvgpr_read_b32 v128, a133
v_add_f32 v122, v122, v128
v_rcp_f32 v128, v122
s_add_u32 s50, s44, 8192
v_mov_b32 v129, v128
v_accvgpr_read_b32 v104, a8
v_accvgpr_read_b32 v105, a9
v_accvgpr_read_b32 v106, a10
v_accvgpr_read_b32 v107, a11
v_accvgpr_read_b32 v108, a24
v_accvgpr_read_b32 v109, a25
v_accvgpr_read_b32 v110, a26
v_accvgpr_read_b32 v111, a27
v_pk_mul_f32 v[104:105], v[104:105], v[128:129]
v_pk_mul_f32 v[106:107], v[106:107], v[128:129]
v_pk_mul_f32 v[108:109], v[108:109], v[128:129]
v_pk_mul_f32 v[110:111], v[110:111], v[128:129]
v_cvt_pk_bf16_f32 v40, v104, v105
v_cvt_pk_bf16_f32 v41, v106, v107
v_cvt_pk_bf16_f32 v42, v108, v109
v_cvt_pk_bf16_f32 v43, v110, v111
buffer_store_dwordx4 v[40:43], v244, s[20:23], s50 offen offset:0
v_accvgpr_read_b32 v112, a40
v_accvgpr_read_b32 v113, a41
v_accvgpr_read_b32 v114, a42
v_accvgpr_read_b32 v115, a43
v_accvgpr_read_b32 v116, a56
v_accvgpr_read_b32 v117, a57
v_accvgpr_read_b32 v118, a58
v_accvgpr_read_b32 v119, a59
v_pk_mul_f32 v[112:113], v[112:113], v[128:129]
v_pk_mul_f32 v[114:115], v[114:115], v[128:129]
v_pk_mul_f32 v[116:117], v[116:117], v[128:129]
v_pk_mul_f32 v[118:119], v[118:119], v[128:129]
v_cvt_pk_bf16_f32 v44, v112, v113
v_cvt_pk_bf16_f32 v45, v114, v115
v_cvt_pk_bf16_f32 v46, v116, v117
v_cvt_pk_bf16_f32 v47, v118, v119
buffer_store_dwordx4 v[44:47], v244, s[20:23], s50 offen offset:1024
v_accvgpr_read_b32 v104, a72
v_accvgpr_read_b32 v105, a73
v_accvgpr_read_b32 v106, a74
v_accvgpr_read_b32 v107, a75
v_accvgpr_read_b32 v108, a88
v_accvgpr_read_b32 v109, a89
v_accvgpr_read_b32 v110, a90
v_accvgpr_read_b32 v111, a91
v_pk_mul_f32 v[104:105], v[104:105], v[128:129]
v_pk_mul_f32 v[106:107], v[106:107], v[128:129]
v_pk_mul_f32 v[108:109], v[108:109], v[128:129]
v_pk_mul_f32 v[110:111], v[110:111], v[128:129]
v_cvt_pk_bf16_f32 v48, v104, v105
v_cvt_pk_bf16_f32 v49, v106, v107
v_cvt_pk_bf16_f32 v50, v108, v109
v_cvt_pk_bf16_f32 v51, v110, v111
buffer_store_dwordx4 v[48:51], v244, s[20:23], s50 offen offset:2048
v_accvgpr_read_b32 v112, a104
v_accvgpr_read_b32 v113, a105
v_accvgpr_read_b32 v114, a106
v_accvgpr_read_b32 v115, a107
v_accvgpr_read_b32 v116, a120
v_accvgpr_read_b32 v117, a121
v_accvgpr_read_b32 v118, a122
v_accvgpr_read_b32 v119, a123
v_pk_mul_f32 v[112:113], v[112:113], v[128:129]
v_pk_mul_f32 v[114:115], v[114:115], v[128:129]
v_pk_mul_f32 v[116:117], v[116:117], v[128:129]
v_pk_mul_f32 v[118:119], v[118:119], v[128:129]
v_cvt_pk_bf16_f32 v52, v112, v113
v_cvt_pk_bf16_f32 v53, v114, v115
v_cvt_pk_bf16_f32 v54, v116, v117
v_cvt_pk_bf16_f32 v55, v118, v119
buffer_store_dwordx4 v[52:55], v244, s[20:23], s50 offen offset:3072
s_nop 7
v_accvgpr_read_b32 v123, a134
v_accvgpr_read_b32 v130, a135
v_add_f32 v123, v123, v130
v_rcp_f32 v130, v123
s_add_u32 s50, s44, 12288
v_mov_b32 v131, v130
v_accvgpr_read_b32 v104, a12
v_accvgpr_read_b32 v105, a13
v_accvgpr_read_b32 v106, a14
v_accvgpr_read_b32 v107, a15
v_accvgpr_read_b32 v108, a28
v_accvgpr_read_b32 v109, a29
v_accvgpr_read_b32 v110, a30
v_accvgpr_read_b32 v111, a31
v_pk_mul_f32 v[104:105], v[104:105], v[130:131]
v_pk_mul_f32 v[106:107], v[106:107], v[130:131]
v_pk_mul_f32 v[108:109], v[108:109], v[130:131]
v_pk_mul_f32 v[110:111], v[110:111], v[130:131]
v_cvt_pk_bf16_f32 v56, v104, v105
v_cvt_pk_bf16_f32 v57, v106, v107
v_cvt_pk_bf16_f32 v58, v108, v109
v_cvt_pk_bf16_f32 v59, v110, v111
buffer_store_dwordx4 v[56:59], v244, s[20:23], s50 offen offset:0
v_accvgpr_read_b32 v112, a44
v_accvgpr_read_b32 v113, a45
v_accvgpr_read_b32 v114, a46
v_accvgpr_read_b32 v115, a47
v_accvgpr_read_b32 v116, a60
v_accvgpr_read_b32 v117, a61
v_accvgpr_read_b32 v118, a62
v_accvgpr_read_b32 v119, a63
v_pk_mul_f32 v[112:113], v[112:113], v[130:131]
v_pk_mul_f32 v[114:115], v[114:115], v[130:131]
v_pk_mul_f32 v[116:117], v[116:117], v[130:131]
v_pk_mul_f32 v[118:119], v[118:119], v[130:131]
v_cvt_pk_bf16_f32 v60, v112, v113
v_cvt_pk_bf16_f32 v61, v114, v115
v_cvt_pk_bf16_f32 v62, v116, v117
v_cvt_pk_bf16_f32 v63, v118, v119
buffer_store_dwordx4 v[60:63], v244, s[20:23], s50 offen offset:1024
v_accvgpr_read_b32 v104, a76
v_accvgpr_read_b32 v105, a77
v_accvgpr_read_b32 v106, a78
v_accvgpr_read_b32 v107, a79
v_accvgpr_read_b32 v108, a92
v_accvgpr_read_b32 v109, a93
v_accvgpr_read_b32 v110, a94
v_accvgpr_read_b32 v111, a95
v_pk_mul_f32 v[104:105], v[104:105], v[130:131]
v_pk_mul_f32 v[106:107], v[106:107], v[130:131]
v_pk_mul_f32 v[108:109], v[108:109], v[130:131]
v_pk_mul_f32 v[110:111], v[110:111], v[130:131]
v_cvt_pk_bf16_f32 v64, v104, v105
v_cvt_pk_bf16_f32 v65, v106, v107
v_cvt_pk_bf16_f32 v66, v108, v109
v_cvt_pk_bf16_f32 v67, v110, v111
buffer_store_dwordx4 v[64:67], v244, s[20:23], s50 offen offset:2048
v_accvgpr_read_b32 v112, a108
v_accvgpr_read_b32 v113, a109
v_accvgpr_read_b32 v114, a110
v_accvgpr_read_b32 v115, a111
v_accvgpr_read_b32 v116, a124
v_accvgpr_read_b32 v117, a125
v_accvgpr_read_b32 v118, a126
v_accvgpr_read_b32 v119, a127
v_pk_mul_f32 v[112:113], v[112:113], v[130:131]
v_pk_mul_f32 v[114:115], v[114:115], v[130:131]
v_pk_mul_f32 v[116:117], v[116:117], v[130:131]
v_pk_mul_f32 v[118:119], v[118:119], v[130:131]
v_cvt_pk_bf16_f32 v68, v112, v113
v_cvt_pk_bf16_f32 v69, v114, v115
v_cvt_pk_bf16_f32 v70, v116, v117
v_cvt_pk_bf16_f32 v71, v118, v119
buffer_store_dwordx4 v[68:71], v244, s[20:23], s50 offen offset:3072
v_max3_f32 v104, v120, v121, v122
v_max_f32 v104, v104, v123
v_add_f32 v105, v120, v121
v_add_f32 v105, v105, v122
v_add_f32 v105, v105, v123
v_cmp_nge_f32 vcc, s42, v104
v_cmp_u_f32 s[28:29], v105, v105
s_or_b64 vcc, vcc, s[28:29]
s_cmp_lg_u64 vcc, 0
s_cselect_b32 s28, 1, 0
v_mov_b32 v104, s28
s_lshl_b32 s29, s37, 2
s_add_u32 s29, s29, 147968
v_mov_b32 v105, s29
v_mov_b32 v106, 147968
ds_write_b32 v105, v104
s_waitcnt vmcnt(16) lgkmcnt(0)
s_barrier
ds_read_b128 v[108:111], v106
ds_read_b64_tr_b16 a[64:65], v237 offset:0
ds_read_b64_tr_b16 a[66:67], v237 offset:4608
ds_read_b64_tr_b16 a[68:69], v237 offset:8
ds_read_b64_tr_b16 a[70:71], v237 offset:4616
ds_read_b64_tr_b16 a[72:73], v238 offset:0
ds_read_b64_tr_b16 a[74:75], v238 offset:4608
ds_read_b64_tr_b16 a[76:77], v238 offset:8
ds_read_b64_tr_b16 a[78:79], v238 offset:4616
ds_read_b64_tr_b16 a[80:81], v237 offset:128
ds_read_b64_tr_b16 a[82:83], v237 offset:4736
ds_read_b64_tr_b16 a[84:85], v237 offset:136
ds_read_b64_tr_b16 a[86:87], v237 offset:4744
ds_read_b64_tr_b16 a[88:89], v238 offset:128
ds_read_b64_tr_b16 a[90:91], v238 offset:4736
s_waitcnt lgkmcnt(14)
v_or_b32 v108, v108, v109
v_or3_b32 v108, v108, v110, v111
s_nop 0
v_readfirstlane_b32 s28, v108
s_cmp_gt_u32 s28, s43
s_cbranch_scc1 K_FALLBACK
s_waitcnt lgkmcnt(8)
v_mfma_f32_16x16x32_bf16 v[96:99], a[64:67], v[56:59], 0
ds_read_b64_tr_b16 a[92:93], v238 offset:136
ds_read_b64_tr_b16 a[94:95], v238 offset:4744
v_mfma_f32_16x16x32_bf16 v[88:91], a[64:67], v[40:43], 0
s_lshr_b32 s32, s35, 2
s_and_b32 s33, s35, 3
v_mfma_f32_16x16x32_bf16 v[80:83], a[64:67], v[24:27], 0
s_lshl_b32 s94, s36, 9
s_lshl_b32 s28, s32, 6
v_mfma_f32_16x16x32_bf16 v[72:75], a[64:67], v[8:11], 0
s_lshr_b32 s34, s32, 2
v_mfma_f32_16x16x32_bf16 v[76:79], a[68:71], v[8:11], 0
ds_read_b64_tr_b16 a[64:65], v239 offset:0
ds_read_b64_tr_b16 a[66:67], v239 offset:4608
v_mfma_f32_16x16x32_bf16 v[84:87], a[68:71], v[24:27], 0
s_add_u32 s94, s94, s28
s_lshl_b32 s28, s37, 4
v_mfma_f32_16x16x32_bf16 v[92:95], a[68:71], v[40:43], 0
s_add_u32 s94, s94, s28
s_add_u32 s94, s94, 0x248000
v_mfma_f32_16x16x32_bf16 v[100:103], a[68:71], v[56:59], 0
v_mov_b32 v231, 1
v_and_b32 v229, 7, v1
v_mfma_f32_16x16x32_bf16 v[128:131], a[72:75], v[56:59], 0
ds_read_b64_tr_b16 a[68:69], v237 offset:9216
ds_read_b64_tr_b16 a[70:71], v237 offset:13824
v_mfma_f32_16x16x32_bf16 v[120:123], a[72:75], v[40:43], 0
v_lshlrev_b32 v229, 2, v229
v_lshlrev_b32 v226, 3, v1
v_mfma_f32_16x16x32_bf16 v[112:115], a[72:75], v[24:27], 0
s_lshl2_add_u32 s29, s33, s94
v_mfma_f32_16x16x32_bf16 v[104:107], a[72:75], v[8:11], 0
s_waitcnt lgkmcnt(8)
v_mfma_f32_16x16x32_bf16 v[108:111], a[76:79], v[8:11], 0
ds_read_b64_tr_b16 a[72:73], v237 offset:9224
ds_read_b64_tr_b16 a[74:75], v237 offset:13832
v_mfma_f32_16x16x32_bf16 v[116:119], a[76:79], v[24:27], 0
v_mfma_f32_16x16x32_bf16 v[124:127], a[76:79], v[40:43], 0
v_mfma_f32_16x16x32_bf16 v[132:135], a[76:79], v[56:59], 0
v_mfma_f32_16x16x32_bf16 v[160:163], a[80:83], v[56:59], 0
ds_read_b64_tr_b16 a[76:77], v238 offset:9216
ds_read_b64_tr_b16 a[78:79], v238 offset:13824
v_mfma_f32_16x16x32_bf16 v[152:155], a[80:83], v[40:43], 0
v_mfma_f32_16x16x32_bf16 v[144:147], a[80:83], v[24:27], 0
v_mfma_f32_16x16x32_bf16 v[136:139], a[80:83], v[8:11], 0
v_mfma_f32_16x16x32_bf16 v[140:143], a[84:87], v[8:11], 0
ds_read_b64_tr_b16 a[80:81], v238 offset:9224
ds_read_b64_tr_b16 a[82:83], v238 offset:13832
v_mfma_f32_16x16x32_bf16 v[148:151], a[84:87], v[24:27], 0
s_waitcnt vmcnt(0)
buffer_store_dword v231, v254, s[20:23], s29 offen
v_mfma_f32_16x16x32_bf16 v[156:159], a[84:87], v[40:43], 0
s_add_u32 s28, s35, 1
s_and_b32 s28, s28, 3
v_mfma_f32_16x16x32_bf16 v[164:167], a[84:87], v[56:59], 0
s_mul_i32 s28, s28, 36864
s_waitcnt lgkmcnt(8)
v_mfma_f32_16x16x32_bf16 v[192:195], a[88:91], v[56:59], 0
ds_read_b64_tr_b16 a[84:85], v237 offset:9344
ds_read_b64_tr_b16 a[86:87], v237 offset:13952
v_mfma_f32_16x16x32_bf16 v[184:187], a[88:91], v[40:43], 0
v_add_u32 v216, s28, v234
v_add_u32 v217, s28, v235
v_mfma_f32_16x16x32_bf16 v[176:179], a[88:91], v[24:27], 0
v_add_u32 v218, s28, v236
v_mfma_f32_16x16x32_bf16 v[168:171], a[88:91], v[8:11], 0
v_mfma_f32_16x16x32_bf16 v[172:175], a[92:95], v[8:11], 0
ds_read_b64_tr_b16 a[88:89], v237 offset:9352
ds_read_b64_tr_b16 a[90:91], v237 offset:13960
v_mfma_f32_16x16x32_bf16 v[180:183], a[92:95], v[24:27], 0
v_mfma_f32_16x16x32_bf16 v[188:191], a[92:95], v[40:43], 0
v_mfma_f32_16x16x32_bf16 v[196:199], a[92:95], v[56:59], 0
v_mfma_f32_16x16x32_bf16 v[212:215], a[64:67], v[56:59], 0
ds_read_b64_tr_b16 a[92:93], v238 offset:9344
ds_read_b64_tr_b16 a[94:95], v238 offset:13952
v_mfma_f32_16x16x32_bf16 v[208:211], a[64:67], v[40:43], 0
v_mfma_f32_16x16x32_bf16 v[204:207], a[64:67], v[24:27], 0
v_mfma_f32_16x16x32_bf16 v[200:203], a[64:67], v[8:11], 0
s_waitcnt lgkmcnt(8)
v_mfma_f32_16x16x32_bf16 v[72:75], a[68:71], v[12:15], v[72:75]
ds_read_b64_tr_b16 a[64:65], v238 offset:9352
ds_read_b64_tr_b16 a[66:67], v238 offset:13960
v_mfma_f32_16x16x32_bf16 v[80:83], a[68:71], v[28:31], v[80:83]
v_mfma_f32_16x16x32_bf16 v[88:91], a[68:71], v[44:47], v[88:91]
v_mfma_f32_16x16x32_bf16 v[96:99], a[68:71], v[60:63], v[96:99]
v_mfma_f32_16x16x32_bf16 v[100:103], a[72:75], v[60:63], v[100:103]
ds_read_b64_tr_b16 a[68:69], v239 offset:9216
ds_read_b64_tr_b16 a[70:71], v239 offset:13824
v_mfma_f32_16x16x32_bf16 v[92:95], a[72:75], v[44:47], v[92:95]
buffer_load_dword v230, v229, s[20:23], s94 offen sc0 sc1
v_mfma_f32_16x16x32_bf16 v[84:87], a[72:75], v[28:31], v[84:87]
s_add_u32 s39, s35, 1
s_and_b32 s39, s39, 3
v_mfma_f32_16x16x32_bf16 v[76:79], a[72:75], v[12:15], v[76:79]
s_add_u32 s28, s33, 1
s_and_b32 s28, s28, 3
v_mfma_f32_16x16x32_bf16 v[104:107], a[76:79], v[12:15], v[104:107]
ds_read_b64_tr_b16 a[72:73], v237 offset:18432
ds_read_b64_tr_b16 a[74:75], v237 offset:23040
v_mfma_f32_16x16x32_bf16 v[112:115], a[76:79], v[28:31], v[112:115]
s_sub_u32 s28, s28, s33
s_lshl_b32 s28, s28, 16
v_mfma_f32_16x16x32_bf16 v[120:123], a[76:79], v[44:47], v[120:123]
s_add_u32 s64, s28, s44
s_add_u32 s65, s64, 4096
v_mfma_f32_16x16x32_bf16 v[128:131], a[76:79], v[60:63], v[128:131]
s_add_u32 s66, s64, 8192
s_add_u32 s67, s64, 12288
s_waitcnt lgkmcnt(8)
v_mfma_f32_16x16x32_bf16 v[132:135], a[80:83], v[60:63], v[132:135]
ds_read_b64_tr_b16 a[76:77], v237 offset:18440
ds_read_b64_tr_b16 a[78:79], v237 offset:23048
v_mfma_f32_16x16x32_bf16 v[124:127], a[80:83], v[44:47], v[124:127]
s_add_u32 s28, s35, 2
s_and_b32 s28, s28, 3
v_mfma_f32_16x16x32_bf16 v[116:119], a[80:83], v[28:31], v[116:119]
s_mul_i32 s28, s28, 36864
v_mfma_f32_16x16x32_bf16 v[108:111], a[80:83], v[12:15], v[108:111]
v_add_u32 v219, s28, v234
v_add_u32 v220, s28, v235
v_mfma_f32_16x16x32_bf16 v[136:139], a[84:87], v[12:15], v[136:139]
ds_read_b64_tr_b16 a[80:81], v238 offset:18432
ds_read_b64_tr_b16 a[82:83], v238 offset:23040
v_mfma_f32_16x16x32_bf16 v[144:147], a[84:87], v[28:31], v[144:147]
v_add_u32 v221, s28, v236
v_mfma_f32_16x16x32_bf16 v[152:155], a[84:87], v[44:47], v[152:155]
s_add_u32 s28, s35, 3
s_and_b32 s28, s28, 3
v_mfma_f32_16x16x32_bf16 v[160:163], a[84:87], v[60:63], v[160:163]
s_mul_i32 s28, s28, 36864
v_mfma_f32_16x16x32_bf16 v[164:167], a[88:91], v[60:63], v[164:167]
ds_read_b64_tr_b16 a[84:85], v238 offset:18440
ds_read_b64_tr_b16 a[86:87], v238 offset:23048
v_mfma_f32_16x16x32_bf16 v[156:159], a[88:91], v[44:47], v[156:159]
v_add_u32 v222, s28, v234
v_add_u32 v223, s28, v235
v_mfma_f32_16x16x32_bf16 v[148:151], a[88:91], v[28:31], v[148:151]
v_add_u32 v224, s28, v236
v_mfma_f32_16x16x32_bf16 v[140:143], a[88:91], v[12:15], v[140:143]
s_waitcnt lgkmcnt(8)
v_mfma_f32_16x16x32_bf16 v[168:171], a[92:95], v[12:15], v[168:171]
ds_read_b64_tr_b16 a[88:89], v237 offset:18560
ds_read_b64_tr_b16 a[90:91], v237 offset:23168
v_mfma_f32_16x16x32_bf16 v[176:179], a[92:95], v[28:31], v[176:179]
v_mfma_f32_16x16x32_bf16 v[184:187], a[92:95], v[44:47], v[184:187]
s_waitcnt vmcnt(0)
v_cmp_gt_u32 vcc, 1, v230
v_mfma_f32_16x16x32_bf16 v[192:195], a[92:95], v[60:63], v[192:195]
v_mfma_f32_16x16x32_bf16 v[196:199], a[64:67], v[60:63], v[196:199]
ds_read_b64_tr_b16 a[92:93], v237 offset:18568
ds_read_b64_tr_b16 a[94:95], v237 offset:23176
v_mfma_f32_16x16x32_bf16 v[188:191], a[64:67], v[44:47], v[188:191]
s_bitcmp1_b32 vcc_lo, s39
s_cbranch_scc1 SP_O1A
SP_O1A_RET:
v_mfma_f32_16x16x32_bf16 v[180:183], a[64:67], v[28:31], v[180:183]
buffer_load_dwordx4 a[128:131], v244, s[20:23], s64 offen offset:0 sc0 sc1
v_mfma_f32_16x16x32_bf16 v[172:175], a[64:67], v[12:15], v[172:175]
v_mfma_f32_16x16x32_bf16 v[200:203], a[68:71], v[12:15], v[200:203]
ds_read_b64_tr_b16 a[64:65], v238 offset:18560
ds_read_b64_tr_b16 a[66:67], v238 offset:23168
v_mfma_f32_16x16x32_bf16 v[204:207], a[68:71], v[28:31], v[204:207]
v_mfma_f32_16x16x32_bf16 v[208:211], a[68:71], v[44:47], v[208:211]
buffer_load_dwordx4 a[144:147], v244, s[20:23], s65 offen offset:0 sc0 sc1
v_mfma_f32_16x16x32_bf16 v[212:215], a[68:71], v[60:63], v[212:215]
s_waitcnt lgkmcnt(8)
v_mfma_f32_16x16x32_bf16 v[96:99], a[72:75], v[64:67], v[96:99]
ds_read_b64_tr_b16 a[68:69], v238 offset:18568
ds_read_b64_tr_b16 a[70:71], v238 offset:23176
v_mfma_f32_16x16x32_bf16 v[88:91], a[72:75], v[48:51], v[88:91]
v_mfma_f32_16x16x32_bf16 v[80:83], a[72:75], v[32:35], v[80:83]
buffer_load_dwordx4 a[160:163], v244, s[20:23], s66 offen offset:0 sc0 sc1
v_mfma_f32_16x16x32_bf16 v[72:75], a[72:75], v[16:19], v[72:75]
v_mfma_f32_16x16x32_bf16 v[76:79], a[76:79], v[16:19], v[76:79]
ds_read_b64_tr_b16 a[72:73], v239 offset:18432
ds_read_b64_tr_b16 a[74:75], v239 offset:23040
v_mfma_f32_16x16x32_bf16 v[84:87], a[76:79], v[32:35], v[84:87]
v_mfma_f32_16x16x32_bf16 v[92:95], a[76:79], v[48:51], v[92:95]
buffer_load_dwordx4 a[176:179], v244, s[20:23], s67 offen offset:0 sc0 sc1
v_mfma_f32_16x16x32_bf16 v[100:103], a[76:79], v[64:67], v[100:103]
v_mfma_f32_16x16x32_bf16 v[128:131], a[80:83], v[64:67], v[128:131]
ds_read_b64_tr_b16 a[76:77], v237 offset:27648
ds_read_b64_tr_b16 a[78:79], v237 offset:32256
v_mfma_f32_16x16x32_bf16 v[120:123], a[80:83], v[48:51], v[120:123]
v_mfma_f32_16x16x32_bf16 v[112:115], a[80:83], v[32:35], v[112:115]
buffer_load_dwordx4 a[132:135], v244, s[20:23], s64 offen offset:1024 sc0 sc1
v_mfma_f32_16x16x32_bf16 v[104:107], a[80:83], v[16:19], v[104:107]
s_waitcnt lgkmcnt(8)
v_mfma_f32_16x16x32_bf16 v[108:111], a[84:87], v[16:19], v[108:111]
ds_read_b64_tr_b16 a[80:81], v237 offset:27656
ds_read_b64_tr_b16 a[82:83], v237 offset:32264
v_mfma_f32_16x16x32_bf16 v[116:119], a[84:87], v[32:35], v[116:119]
v_mfma_f32_16x16x32_bf16 v[124:127], a[84:87], v[48:51], v[124:127]
buffer_load_dwordx4 a[148:151], v244, s[20:23], s65 offen offset:1024 sc0 sc1
v_mfma_f32_16x16x32_bf16 v[132:135], a[84:87], v[64:67], v[132:135]
v_mfma_f32_16x16x32_bf16 v[160:163], a[88:91], v[64:67], v[160:163]
ds_read_b64_tr_b16 a[84:85], v238 offset:27648
ds_read_b64_tr_b16 a[86:87], v238 offset:32256
v_mfma_f32_16x16x32_bf16 v[152:155], a[88:91], v[48:51], v[152:155]
v_mfma_f32_16x16x32_bf16 v[144:147], a[88:91], v[32:35], v[144:147]
buffer_load_dwordx4 a[164:167], v244, s[20:23], s66 offen offset:1024 sc0 sc1
v_mfma_f32_16x16x32_bf16 v[136:139], a[88:91], v[16:19], v[136:139]
v_mfma_f32_16x16x32_bf16 v[140:143], a[92:95], v[16:19], v[140:143]
ds_read_b64_tr_b16 a[88:89], v238 offset:27656
ds_read_b64_tr_b16 a[90:91], v238 offset:32264
v_mfma_f32_16x16x32_bf16 v[148:151], a[92:95], v[32:35], v[148:151]
v_mfma_f32_16x16x32_bf16 v[156:159], a[92:95], v[48:51], v[156:159]
buffer_load_dwordx4 a[180:183], v244, s[20:23], s67 offen offset:1024 sc0 sc1
v_mfma_f32_16x16x32_bf16 v[164:167], a[92:95], v[64:67], v[164:167]
s_waitcnt lgkmcnt(8)
v_mfma_f32_16x16x32_bf16 v[192:195], a[64:67], v[64:67], v[192:195]
ds_read_b64_tr_b16 a[92:93], v237 offset:27776
ds_read_b64_tr_b16 a[94:95], v237 offset:32384
v_mfma_f32_16x16x32_bf16 v[184:187], a[64:67], v[48:51], v[184:187]
v_mfma_f32_16x16x32_bf16 v[176:179], a[64:67], v[32:35], v[176:179]
buffer_load_dwordx4 a[136:139], v244, s[20:23], s64 offen offset:2048 sc0 sc1
v_mfma_f32_16x16x32_bf16 v[168:171], a[64:67], v[16:19], v[168:171]
buffer_load_dword v230, v229, s[20:23], s94 offen sc0 sc1
v_mfma_f32_16x16x32_bf16 v[172:175], a[68:71], v[16:19], v[172:175]
ds_read_b64_tr_b16 a[64:65], v237 offset:27784
ds_read_b64_tr_b16 a[66:67], v237 offset:32392
v_mfma_f32_16x16x32_bf16 v[180:183], a[68:71], v[32:35], v[180:183]
v_mfma_f32_16x16x32_bf16 v[188:191], a[68:71], v[48:51], v[188:191]
v_mfma_f32_16x16x32_bf16 v[196:199], a[68:71], v[64:67], v[196:199]
buffer_load_dwordx4 a[152:155], v244, s[20:23], s65 offen offset:2048 sc0 sc1
v_mfma_f32_16x16x32_bf16 v[212:215], a[72:75], v[64:67], v[212:215]
ds_read_b64_tr_b16 a[68:69], v238 offset:27776
ds_read_b64_tr_b16 a[70:71], v238 offset:32384
v_mfma_f32_16x16x32_bf16 v[208:211], a[72:75], v[48:51], v[208:211]
v_mfma_f32_16x16x32_bf16 v[204:207], a[72:75], v[32:35], v[204:207]
v_mfma_f32_16x16x32_bf16 v[200:203], a[72:75], v[16:19], v[200:203]
buffer_load_dwordx4 a[168:171], v244, s[20:23], s66 offen offset:2048 sc0 sc1
s_waitcnt lgkmcnt(8)
v_mfma_f32_16x16x32_bf16 v[72:75], a[76:79], v[20:23], v[72:75]
ds_read_b64_tr_b16 a[72:73], v238 offset:27784
ds_read_b64_tr_b16 a[74:75], v238 offset:32392
v_mfma_f32_16x16x32_bf16 v[80:83], a[76:79], v[36:39], v[80:83]
v_mfma_f32_16x16x32_bf16 v[88:91], a[76:79], v[52:55], v[88:91]
v_mfma_f32_16x16x32_bf16 v[96:99], a[76:79], v[68:71], v[96:99]
buffer_load_dwordx4 a[184:187], v244, s[20:23], s67 offen offset:2048 sc0 sc1
v_mfma_f32_16x16x32_bf16 v[100:103], a[80:83], v[68:71], v[100:103]
ds_read_b64_tr_b16 a[76:77], v239 offset:27648
ds_read_b64_tr_b16 a[78:79], v239 offset:32256
v_mfma_f32_16x16x32_bf16 v[92:95], a[80:83], v[52:55], v[92:95]
v_mfma_f32_16x16x32_bf16 v[84:87], a[80:83], v[36:39], v[84:87]
v_mfma_f32_16x16x32_bf16 v[76:79], a[80:83], v[20:23], v[76:79]
buffer_load_dwordx4 a[140:143], v244, s[20:23], s64 offen offset:3072 sc0 sc1
v_mfma_f32_16x16x32_bf16 v[104:107], a[84:87], v[20:23], v[104:107]
ds_read_b64_tr_b16 a[80:81], v216 offset:0
ds_read_b64_tr_b16 a[82:83], v216 offset:4608
v_mfma_f32_16x16x32_bf16 v[112:115], a[84:87], v[36:39], v[112:115]
v_mfma_f32_16x16x32_bf16 v[120:123], a[84:87], v[52:55], v[120:123]
v_mfma_f32_16x16x32_bf16 v[128:131], a[84:87], v[68:71], v[128:131]
buffer_load_dwordx4 a[156:159], v244, s[20:23], s65 offen offset:3072 sc0 sc1
s_waitcnt lgkmcnt(8)
v_mfma_f32_16x16x32_bf16 v[132:135], a[88:91], v[68:71], v[132:135]
ds_read_b64_tr_b16 a[84:85], v216 offset:8
ds_read_b64_tr_b16 a[86:87], v216 offset:4616
v_mfma_f32_16x16x32_bf16 v[124:127], a[88:91], v[52:55], v[124:127]
v_mfma_f32_16x16x32_bf16 v[116:119], a[88:91], v[36:39], v[116:119]
v_mfma_f32_16x16x32_bf16 v[108:111], a[88:91], v[20:23], v[108:111]
buffer_load_dwordx4 a[172:175], v244, s[20:23], s66 offen offset:3072 sc0 sc1
v_mfma_f32_16x16x32_bf16 v[136:139], a[92:95], v[20:23], v[136:139]
ds_read_b64_tr_b16 a[88:89], v217 offset:0
ds_read_b64_tr_b16 a[90:91], v217 offset:4608
v_mfma_f32_16x16x32_bf16 v[144:147], a[92:95], v[36:39], v[144:147]
v_mfma_f32_16x16x32_bf16 v[152:155], a[92:95], v[52:55], v[152:155]
v_mfma_f32_16x16x32_bf16 v[160:163], a[92:95], v[68:71], v[160:163]
buffer_load_dwordx4 a[188:191], v244, s[20:23], s67 offen offset:3072 sc0 sc1
v_mfma_f32_16x16x32_bf16 v[164:167], a[64:67], v[68:71], v[164:167]
ds_read_b64_tr_b16 a[92:93], v217 offset:8
ds_read_b64_tr_b16 a[94:95], v217 offset:4616
v_mfma_f32_16x16x32_bf16 v[156:159], a[64:67], v[52:55], v[156:159]
s_add_u32 s28, s33, 2
s_and_b32 s28, s28, 3
v_mfma_f32_16x16x32_bf16 v[148:151], a[64:67], v[36:39], v[148:151]
s_sub_u32 s28, s28, s33
s_lshl_b32 s28, s28, 16
v_mfma_f32_16x16x32_bf16 v[140:143], a[64:67], v[20:23], v[140:143]
s_add_u32 s64, s28, s44
s_add_u32 s65, s64, 4096
s_waitcnt lgkmcnt(8)
v_mfma_f32_16x16x32_bf16 v[168:171], a[68:71], v[20:23], v[168:171]
ds_read_b64_tr_b16 a[64:65], v216 offset:128
ds_read_b64_tr_b16 a[66:67], v216 offset:4736
v_mfma_f32_16x16x32_bf16 v[176:179], a[68:71], v[36:39], v[176:179]
s_add_u32 s66, s64, 8192
s_add_u32 s67, s64, 12288
v_mfma_f32_16x16x32_bf16 v[184:187], a[68:71], v[52:55], v[184:187]
s_waitcnt vmcnt(7)
v_cmp_gt_u32 vcc, 1, v230
v_mfma_f32_16x16x32_bf16 v[192:195], a[68:71], v[68:71], v[192:195]
v_mfma_f32_16x16x32_bf16 v[196:199], a[72:75], v[68:71], v[196:199]
ds_read_b64_tr_b16 a[68:69], v216 offset:136
ds_read_b64_tr_b16 a[70:71], v216 offset:4744
v_mfma_f32_16x16x32_bf16 v[188:191], a[72:75], v[52:55], v[188:191]
s_and_b32 s29, vcc_lo, 15
s_cbranch_scc1 SP_O2A
SP_O2A_RET:
v_mfma_f32_16x16x32_bf16 v[180:183], a[72:75], v[36:39], v[180:183]
buffer_load_dwordx4 a[192:195], v244, s[20:23], s64 offen offset:0 sc0 sc1
v_mfma_f32_16x16x32_bf16 v[172:175], a[72:75], v[20:23], v[172:175]
v_mfma_f32_16x16x32_bf16 v[200:203], a[76:79], v[20:23], v[200:203]
ds_read_b64_tr_b16 a[72:73], v217 offset:128
ds_read_b64_tr_b16 a[74:75], v217 offset:4736
v_mfma_f32_16x16x32_bf16 v[204:207], a[76:79], v[36:39], v[204:207]
v_mfma_f32_16x16x32_bf16 v[208:211], a[76:79], v[52:55], v[208:211]
buffer_load_dwordx4 a[208:211], v244, s[20:23], s65 offen offset:0 sc0 sc1
v_mfma_f32_16x16x32_bf16 v[212:215], a[76:79], v[68:71], v[212:215]
s_waitcnt vmcnt(15)
s_waitcnt lgkmcnt(8)
v_mfma_f32_16x16x32_bf16 v[96:99], a[80:83], a[176:179], v[96:99]
ds_read_b64_tr_b16 a[76:77], v217 offset:136
ds_read_b64_tr_b16 a[78:79], v217 offset:4744
v_mfma_f32_16x16x32_bf16 v[88:91], a[80:83], a[160:163], v[88:91]
v_mfma_f32_16x16x32_bf16 v[80:83], a[80:83], a[144:147], v[80:83]
buffer_load_dwordx4 a[96:99], v244, s[20:23], s66 offen offset:0 sc0 sc1
v_mfma_f32_16x16x32_bf16 v[72:75], a[80:83], a[128:131], v[72:75]
v_accvgpr_read_b32 v39, a222
v_accvgpr_read_b32 v59, a232
v_mfma_f32_16x16x32_bf16 v[76:79], a[84:87], a[128:131], v[76:79]
ds_read_b64_tr_b16 a[80:81], v218 offset:0
ds_read_b64_tr_b16 a[82:83], v218 offset:4608
v_mfma_f32_16x16x32_bf16 v[84:87], a[84:87], a[144:147], v[84:87]
v_lshlrev_b32 v38, 16, v39
v_and_b32 v39, 0xffff0000, v39
v_mfma_f32_16x16x32_bf16 v[92:95], a[84:87], a[160:163], v[92:95]
buffer_load_dwordx4 a[112:115], v244, s[20:23], s67 offen offset:0 sc0 sc1
v_mfma_f32_16x16x32_bf16 v[100:103], a[84:87], a[176:179], v[100:103]
v_lshlrev_b32 v58, 16, v59
v_and_b32 v59, 0xffff0000, v59
v_mfma_f32_16x16x32_bf16 v[128:131], a[88:91], a[176:179], v[128:131]
ds_read_b64_tr_b16 a[84:85], v216 offset:9216
ds_read_b64_tr_b16 a[86:87], v216 offset:13824
v_mfma_f32_16x16x32_bf16 v[120:123], a[88:91], a[160:163], v[120:123]
v_add_f32 v38, v38, v58
v_add_f32 v39, v39, v59
v_mfma_f32_16x16x32_bf16 v[112:115], a[88:91], a[144:147], v[112:115]
buffer_load_dwordx4 a[196:199], v244, s[20:23], s64 offen offset:1024 sc0 sc1
v_mfma_f32_16x16x32_bf16 v[104:107], a[88:91], a[128:131], v[104:107]
v_cvt_pk_bf16_f32 v58, v38, v39
v_lshlrev_b32 v38, 16, v58
s_waitcnt lgkmcnt(8)
v_mfma_f32_16x16x32_bf16 v[108:111], a[92:95], a[128:131], v[108:111]
ds_read_b64_tr_b16 a[88:89], v216 offset:9224
ds_read_b64_tr_b16 a[90:91], v216 offset:13832
v_mfma_f32_16x16x32_bf16 v[116:119], a[92:95], a[144:147], v[116:119]
v_and_b32 v39, 0xffff0000, v58
v_mul_f32 v58, 0xbfb8aa3b, v38
v_mfma_f32_16x16x32_bf16 v[124:127], a[92:95], a[160:163], v[124:127]
buffer_load_dwordx4 a[244:247], v244, s[20:23], s65 offen offset:1024 sc0 sc1
v_mfma_f32_16x16x32_bf16 v[132:135], a[92:95], a[176:179], v[132:135]
v_mul_f32 v59, 0xbfb8aa3b, v39
v_mfma_f32_16x16x32_bf16 v[160:163], a[64:67], a[176:179], v[160:163]
ds_read_b64_tr_b16 a[92:93], v217 offset:9216
ds_read_b64_tr_b16 a[94:95], v217 offset:13824
v_mfma_f32_16x16x32_bf16 v[152:155], a[64:67], a[160:163], v[152:155]
v_exp_f32 v58, v58
v_mfma_f32_16x16x32_bf16 v[144:147], a[64:67], a[144:147], v[144:147]
buffer_load_dwordx4 a[100:103], v244, s[20:23], s66 offen offset:1024 sc0 sc1
v_mfma_f32_16x16x32_bf16 v[136:139], a[64:67], a[128:131], v[136:139]
v_exp_f32 v59, v59
v_mfma_f32_16x16x32_bf16 v[140:143], a[68:71], a[128:131], v[140:143]
ds_read_b64_tr_b16 a[64:65], v217 offset:9224
ds_read_b64_tr_b16 a[66:67], v217 offset:13832
v_mfma_f32_16x16x32_bf16 v[148:151], a[68:71], a[144:147], v[148:151]
v_add_f32 v58, 1.0, v58
STUB_14:
s_cbranch_execz STUB_17
v_add_f32 v59, 1.0, v59
v_mfma_f32_16x16x32_bf16 v[156:159], a[68:71], a[160:163], v[156:159]
buffer_load_dwordx4 a[116:119], v244, s[20:23], s67 offen offset:1024 sc0 sc1
v_mfma_f32_16x16x32_bf16 v[164:167], a[68:71], a[176:179], v[164:167]
v_rcp_f32 v58, v58
s_waitcnt lgkmcnt(8)
v_mfma_f32_16x16x32_bf16 v[192:195], a[72:75], a[176:179], v[192:195]
ds_read_b64_tr_b16 a[68:69], v216 offset:9344
ds_read_b64_tr_b16 a[70:71], v216 offset:13952
v_mfma_f32_16x16x32_bf16 v[184:187], a[72:75], a[160:163], v[184:187]
v_rcp_f32 v59, v59
v_mfma_f32_16x16x32_bf16 v[176:179], a[72:75], a[144:147], v[176:179]
buffer_load_dwordx4 a[200:203], v244, s[20:23], s64 offen offset:2048 sc0 sc1
v_mfma_f32_16x16x32_bf16 v[168:171], a[72:75], a[128:131], v[168:171]
v_mul_f32 v38, v38, v58
v_mul_f32 v39, v39, v59
v_mfma_f32_16x16x32_bf16 v[172:175], a[76:79], a[128:131], v[172:175]
ds_read_b64_tr_b16 a[72:73], v216 offset:9352
ds_read_b64_tr_b16 a[74:75], v216 offset:13960
v_mfma_f32_16x16x32_bf16 v[180:183], a[76:79], a[144:147], v[180:183]
v_cvt_pk_bf16_f32 v58, v38, v39
v_lshlrev_b32 v38, 16, v58
v_mfma_f32_16x16x32_bf16 v[188:191], a[76:79], a[160:163], v[188:191]
buffer_load_dwordx4 a[248:251], v244, s[20:23], s65 offen offset:2048 sc0 sc1
v_mfma_f32_16x16x32_bf16 v[196:199], a[76:79], a[176:179], v[196:199]
v_and_b32 v39, 0xffff0000, v58
v_accvgpr_read_b32 v41, a223
v_mfma_f32_16x16x32_bf16 v[212:215], a[80:83], a[176:179], v[212:215]
ds_read_b64_tr_b16 a[76:77], v217 offset:9344
ds_read_b64_tr_b16 a[78:79], v217 offset:13952
v_mfma_f32_16x16x32_bf16 v[208:211], a[80:83], a[160:163], v[208:211]
v_accvgpr_read_b32 v59, a233
v_lshlrev_b32 v40, 16, v41
v_mfma_f32_16x16x32_bf16 v[204:207], a[80:83], a[144:147], v[204:207]
buffer_load_dwordx4 a[104:107], v244, s[20:23], s66 offen offset:2048 sc0 sc1
v_mfma_f32_16x16x32_bf16 v[200:203], a[80:83], a[128:131], v[200:203]
v_and_b32 v41, 0xffff0000, v41
v_lshlrev_b32 v58, 16, v59
s_waitcnt vmcnt(20)
s_waitcnt lgkmcnt(8)
v_mfma_f32_16x16x32_bf16 v[72:75], a[84:87], a[132:135], v[72:75]
ds_read_b64_tr_b16 a[80:81], v217 offset:9352
ds_read_b64_tr_b16 a[82:83], v217 offset:13960
v_mfma_f32_16x16x32_bf16 v[80:83], a[84:87], a[148:151], v[80:83]
v_and_b32 v59, 0xffff0000, v59
v_add_f32 v40, v40, v58
v_mfma_f32_16x16x32_bf16 v[88:91], a[84:87], a[164:167], v[88:91]
buffer_load_dwordx4 a[120:123], v244, s[20:23], s67 offen offset:2048 sc0 sc1
v_mfma_f32_16x16x32_bf16 v[96:99], a[84:87], a[180:183], v[96:99]
v_add_f32 v41, v41, v59
v_cvt_pk_bf16_f32 v58, v40, v41
v_mfma_f32_16x16x32_bf16 v[100:103], a[88:91], a[180:183], v[100:103]
ds_read_b64_tr_b16 a[84:85], v218 offset:9216
ds_read_b64_tr_b16 a[86:87], v218 offset:13824
v_mfma_f32_16x16x32_bf16 v[92:95], a[88:91], a[164:167], v[92:95]
v_lshlrev_b32 v40, 16, v58
v_and_b32 v41, 0xffff0000, v58
v_mfma_f32_16x16x32_bf16 v[84:87], a[88:91], a[148:151], v[84:87]
buffer_load_dwordx4 a[204:207], v244, s[20:23], s64 offen offset:3072 sc0 sc1
v_mfma_f32_16x16x32_bf16 v[76:79], a[88:91], a[132:135], v[76:79]
v_mul_f32 v58, 0xbfb8aa3b, v40
v_mul_f32 v59, 0xbfb8aa3b, v41
v_mfma_f32_16x16x32_bf16 v[104:107], a[92:95], a[132:135], v[104:107]
ds_read_b64_tr_b16 a[88:89], v216 offset:18432
ds_read_b64_tr_b16 a[90:91], v216 offset:23040
v_mfma_f32_16x16x32_bf16 v[112:115], a[92:95], a[148:151], v[112:115]
v_exp_f32 v58, v58
v_mfma_f32_16x16x32_bf16 v[120:123], a[92:95], a[164:167], v[120:123]
buffer_load_dwordx4 a[252:255], v244, s[20:23], s65 offen offset:3072 sc0 sc1
v_mfma_f32_16x16x32_bf16 v[128:131], a[92:95], a[180:183], v[128:131]
v_exp_f32 v59, v59
s_waitcnt lgkmcnt(8)
v_mfma_f32_16x16x32_bf16 v[132:135], a[64:67], a[180:183], v[132:135]
ds_read_b64_tr_b16 a[92:93], v216 offset:18440
ds_read_b64_tr_b16 a[94:95], v216 offset:23048
v_mfma_f32_16x16x32_bf16 v[124:127], a[64:67], a[164:167], v[124:127]
v_add_f32 v58, 1.0, v58
v_add_f32 v59, 1.0, v59
v_mfma_f32_16x16x32_bf16 v[116:119], a[64:67], a[148:151], v[116:119]
buffer_load_dwordx4 a[108:111], v244, s[20:23], s66 offen offset:3072 sc0 sc1
v_mfma_f32_16x16x32_bf16 v[108:111], a[64:67], a[132:135], v[108:111]
v_rcp_f32 v58, v58
v_mfma_f32_16x16x32_bf16 v[136:139], a[68:71], a[132:135], v[136:139]
ds_read_b64_tr_b16 a[64:65], v217 offset:18432
ds_read_b64_tr_b16 a[66:67], v217 offset:23040
v_mfma_f32_16x16x32_bf16 v[144:147], a[68:71], a[148:151], v[144:147]
v_rcp_f32 v59, v59
v_mfma_f32_16x16x32_bf16 v[152:155], a[68:71], a[164:167], v[152:155]
buffer_load_dwordx4 a[124:127], v244, s[20:23], s67 offen offset:3072 sc0 sc1
v_mfma_f32_16x16x32_bf16 v[160:163], a[68:71], a[180:183], v[160:163]
s_add_u32 s28, s33, 3
s_and_b32 s28, s28, 3
v_mfma_f32_16x16x32_bf16 v[164:167], a[72:75], a[180:183], v[164:167]
ds_read_b64_tr_b16 a[68:69], v217 offset:18440
ds_read_b64_tr_b16 a[70:71], v217 offset:23048
v_mfma_f32_16x16x32_bf16 v[156:159], a[72:75], a[164:167], v[156:159]
s_sub_u32 s28, s28, s33
s_lshl_b32 s28, s28, 16
v_mfma_f32_16x16x32_bf16 v[148:151], a[72:75], a[148:151], v[148:151]
s_add_u32 s64, s28, s44
s_add_u32 s65, s64, 4096
v_mfma_f32_16x16x32_bf16 v[140:143], a[72:75], a[132:135], v[140:143]
s_add_u32 s66, s64, 8192
s_add_u32 s67, s64, 12288
s_waitcnt lgkmcnt(8)
v_mfma_f32_16x16x32_bf16 v[168:171], a[76:79], a[132:135], v[168:171]
ds_read_b64_tr_b16 a[72:73], v216 offset:18560
ds_read_b64_tr_b16 a[74:75], v216 offset:23168
v_mfma_f32_16x16x32_bf16 v[176:179], a[76:79], a[148:151], v[176:179]
buffer_load_dwordx4 a[0:3], v244, s[20:23], s64 offen offset:0 sc0 sc1
v_mfma_f32_16x16x32_bf16 v[184:187], a[76:79], a[164:167], v[184:187]
v_mul_f32 v40, v40, v58
v_mul_f32 v41, v41, v59
v_mfma_f32_16x16x32_bf16 v[192:195], a[76:79], a[180:183], v[192:195]
v_cvt_pk_bf16_f32 v58, v40, v41
v_lshlrev_b32 v40, 16, v58
v_mfma_f32_16x16x32_bf16 v[196:199], a[80:83], a[180:183], v[196:199]
ds_read_b64_tr_b16 a[76:77], v216 offset:18568
ds_read_b64_tr_b16 a[78:79], v216 offset:23176
v_mfma_f32_16x16x32_bf16 v[188:191], a[80:83], a[164:167], v[188:191]
buffer_load_dwordx4 a[16:19], v244, s[20:23], s65 offen offset:0 sc0 sc1
v_mfma_f32_16x16x32_bf16 v[180:183], a[80:83], a[148:151], v[180:183]
v_and_b32 v41, 0xffff0000, v58
v_accvgpr_read_b32 v43, a224
v_mfma_f32_16x16x32_bf16 v[172:175], a[80:83], a[132:135], v[172:175]
v_accvgpr_read_b32 v59, a234
v_lshlrev_b32 v42, 16, v43
v_mfma_f32_16x16x32_bf16 v[200:203], a[84:87], a[132:135], v[200:203]
ds_read_b64_tr_b16 a[80:81], v217 offset:18560
ds_read_b64_tr_b16 a[82:83], v217 offset:23168
v_mfma_f32_16x16x32_bf16 v[204:207], a[84:87], a[148:151], v[204:207]
buffer_load_dwordx4 a[32:35], v244, s[20:23], s66 offen offset:0 sc0 sc1
v_mfma_f32_16x16x32_bf16 v[208:211], a[84:87], a[164:167], v[208:211]
v_and_b32 v43, 0xffff0000, v43
v_lshlrev_b32 v58, 16, v59
v_mfma_f32_16x16x32_bf16 v[212:215], a[84:87], a[180:183], v[212:215]
v_and_b32 v59, 0xffff0000, v59
v_add_f32 v42, v42, v58
s_waitcnt vmcnt(23)
s_waitcnt lgkmcnt(8)
v_mfma_f32_16x16x32_bf16 v[96:99], a[88:91], a[184:187], v[96:99]
ds_read_b64_tr_b16 a[84:85], v217 offset:18568
ds_read_b64_tr_b16 a[86:87], v217 offset:23176
v_mfma_f32_16x16x32_bf16 v[88:91], a[88:91], a[168:171], v[88:91]
buffer_load_dwordx4 a[48:51], v244, s[20:23], s67 offen offset:0 sc0 sc1
v_mfma_f32_16x16x32_bf16 v[80:83], a[88:91], a[152:155], v[80:83]
v_add_f32 v43, v43, v59
v_cvt_pk_bf16_f32 v58, v42, v43
v_mfma_f32_16x16x32_bf16 v[72:75], a[88:91], a[136:139], v[72:75]
v_lshlrev_b32 v42, 16, v58
v_and_b32 v43, 0xffff0000, v58
v_mfma_f32_16x16x32_bf16 v[76:79], a[92:95], a[136:139], v[76:79]
ds_read_b64_tr_b16 a[88:89], v218 offset:18432
ds_read_b64_tr_b16 a[90:91], v218 offset:23040
v_mfma_f32_16x16x32_bf16 v[84:87], a[92:95], a[152:155], v[84:87]
buffer_load_dwordx4 a[4:7], v244, s[20:23], s64 offen offset:1024 sc0 sc1
v_mfma_f32_16x16x32_bf16 v[92:95], a[92:95], a[168:171], v[92:95]
v_mul_f32 v58, 0xbfb8aa3b, v42
v_mul_f32 v59, 0xbfb8aa3b, v43
v_mfma_f32_16x16x32_bf16 v[100:103], a[92:95], a[184:187], v[100:103]
v_exp_f32 v58, v58
v_mfma_f32_16x16x32_bf16 v[128:131], a[64:67], a[184:187], v[128:131]
ds_read_b64_tr_b16 a[92:93], v216 offset:27648
ds_read_b64_tr_b16 a[94:95], v216 offset:32256
v_mfma_f32_16x16x32_bf16 v[120:123], a[64:67], a[168:171], v[120:123]
buffer_load_dwordx4 a[20:23], v244, s[20:23], s65 offen offset:1024 sc0 sc1
v_mfma_f32_16x16x32_bf16 v[112:115], a[64:67], a[152:155], v[112:115]
v_exp_f32 v59, v59
v_mfma_f32_16x16x32_bf16 v[104:107], a[64:67], a[136:139], v[104:107]
v_add_f32 v58, 1.0, v58
v_add_f32 v59, 1.0, v59
s_waitcnt lgkmcnt(8)
v_mfma_f32_16x16x32_bf16 v[108:111], a[68:71], a[136:139], v[108:111]
ds_read_b64_tr_b16 a[64:65], v216 offset:27656
ds_read_b64_tr_b16 a[66:67], v216 offset:32264
v_mfma_f32_16x16x32_bf16 v[116:119], a[68:71], a[152:155], v[116:119]
buffer_load_dwordx4 a[36:39], v244, s[20:23], s66 offen offset:1024 sc0 sc1
v_mfma_f32_16x16x32_bf16 v[124:127], a[68:71], a[168:171], v[124:127]
v_rcp_f32 v58, v58
v_mfma_f32_16x16x32_bf16 v[132:135], a[68:71], a[184:187], v[132:135]
v_rcp_f32 v59, v59
v_mfma_f32_16x16x32_bf16 v[160:163], a[72:75], a[184:187], v[160:163]
ds_read_b64_tr_b16 a[68:69], v217 offset:27648
ds_read_b64_tr_b16 a[70:71], v217 offset:32256
v_mfma_f32_16x16x32_bf16 v[152:155], a[72:75], a[168:171], v[152:155]
buffer_load_dwordx4 a[52:55], v244, s[20:23], s67 offen offset:1024 sc0 sc1
v_mfma_f32_16x16x32_bf16 v[144:147], a[72:75], a[152:155], v[144:147]
v_mul_f32 v42, v42, v58
v_mul_f32 v43, v43, v59
v_mfma_f32_16x16x32_bf16 v[136:139], a[72:75], a[136:139], v[136:139]
v_cvt_pk_bf16_f32 v58, v42, v43
v_lshlrev_b32 v42, 16, v58
v_mfma_f32_16x16x32_bf16 v[140:143], a[76:79], a[136:139], v[140:143]
ds_read_b64_tr_b16 a[72:73], v217 offset:27656
ds_read_b64_tr_b16 a[74:75], v217 offset:32264
v_mfma_f32_16x16x32_bf16 v[148:151], a[76:79], a[152:155], v[148:151]
buffer_load_dwordx4 a[8:11], v244, s[20:23], s64 offen offset:2048 sc0 sc1
v_mfma_f32_16x16x32_bf16 v[156:159], a[76:79], a[168:171], v[156:159]
v_and_b32 v43, 0xffff0000, v58
v_accvgpr_read_b32 v45, a225
v_mfma_f32_16x16x32_bf16 v[164:167], a[76:79], a[184:187], v[164:167]
v_accvgpr_read_b32 v59, a235
v_lshlrev_b32 v44, 16, v45
s_waitcnt lgkmcnt(8)
v_mfma_f32_16x16x32_bf16 v[192:195], a[80:83], a[184:187], v[192:195]
ds_read_b64_tr_b16 a[76:77], v216 offset:27776
ds_read_b64_tr_b16 a[78:79], v216 offset:32384
v_mfma_f32_16x16x32_bf16 v[184:187], a[80:83], a[168:171], v[184:187]
buffer_load_dwordx4 a[24:27], v244, s[20:23], s65 offen offset:2048 sc0 sc1
v_mfma_f32_16x16x32_bf16 v[176:179], a[80:83], a[152:155], v[176:179]
v_and_b32 v45, 0xffff0000, v45
v_lshlrev_b32 v58, 16, v59
v_mfma_f32_16x16x32_bf16 v[168:171], a[80:83], a[136:139], v[168:171]
v_and_b32 v59, 0xffff0000, v59
v_add_f32 v44, v44, v58
v_mfma_f32_16x16x32_bf16 v[172:175], a[84:87], a[136:139], v[172:175]
ds_read_b64_tr_b16 a[80:81], v216 offset:27784
ds_read_b64_tr_b16 a[82:83], v216 offset:32392
v_mfma_f32_16x16x32_bf16 v[180:183], a[84:87], a[152:155], v[180:183]
buffer_load_dwordx4 a[40:43], v244, s[20:23], s66 offen offset:2048 sc0 sc1
v_mfma_f32_16x16x32_bf16 v[188:191], a[84:87], a[168:171], v[188:191]
v_add_f32 v45, v45, v59
v_cvt_pk_bf16_f32 v58, v44, v45
v_mfma_f32_16x16x32_bf16 v[196:199], a[84:87], a[184:187], v[196:199]
v_lshlrev_b32 v44, 16, v58
v_and_b32 v45, 0xffff0000, v58
v_mfma_f32_16x16x32_bf16 v[212:215], a[88:91], a[184:187], v[212:215]
ds_read_b64_tr_b16 a[84:85], v217 offset:27776
ds_read_b64_tr_b16 a[86:87], v217 offset:32384
v_mfma_f32_16x16x32_bf16 v[208:211], a[88:91], a[168:171], v[208:211]
buffer_load_dwordx4 a[56:59], v244, s[20:23], s67 offen offset:2048 sc0 sc1
v_mfma_f32_16x16x32_bf16 v[204:207], a[88:91], a[152:155], v[204:207]
v_mul_f32 v58, 0xbfb8aa3b, v44
v_mul_f32 v59, 0xbfb8aa3b, v45
v_mfma_f32_16x16x32_bf16 v[200:203], a[88:91], a[136:139], v[200:203]
v_exp_f32 v58, v58
s_waitcnt vmcnt(28)
s_waitcnt lgkmcnt(8)
v_mfma_f32_16x16x32_bf16 v[72:75], a[92:95], a[140:143], v[72:75]
ds_read_b64_tr_b16 a[88:89], v217 offset:27784
ds_read_b64_tr_b16 a[90:91], v217 offset:32392
v_mfma_f32_16x16x32_bf16 v[80:83], a[92:95], a[156:159], v[80:83]
buffer_load_dwordx4 a[12:15], v244, s[20:23], s64 offen offset:3072 sc0 sc1
v_mfma_f32_16x16x32_bf16 v[88:91], a[92:95], a[172:175], v[88:91]
v_exp_f32 v59, v59
v_mfma_f32_16x16x32_bf16 v[96:99], a[92:95], a[188:191], v[96:99]
v_add_f32 v58, 1.0, v58
v_add_f32 v59, 1.0, v59
v_mfma_f32_16x16x32_bf16 v[100:103], a[64:67], a[188:191], v[100:103]
ds_read_b64_tr_b16 a[92:93], v218 offset:27648
ds_read_b64_tr_b16 a[94:95], v218 offset:32256
v_mfma_f32_16x16x32_bf16 v[92:95], a[64:67], a[172:175], v[92:95]
buffer_load_dwordx4 a[28:31], v244, s[20:23], s65 offen offset:3072 sc0 sc1
v_mfma_f32_16x16x32_bf16 v[84:87], a[64:67], a[156:159], v[84:87]
v_rcp_f32 v58, v58
v_mfma_f32_16x16x32_bf16 v[76:79], a[64:67], a[140:143], v[76:79]
v_rcp_f32 v59, v59
v_mfma_f32_16x16x32_bf16 v[104:107], a[68:71], a[140:143], v[104:107]
ds_read_b64_tr_b16 a[64:65], v221 offset:0
ds_read_b64_tr_b16 a[66:67], v221 offset:4608
v_mfma_f32_16x16x32_bf16 v[112:115], a[68:71], a[156:159], v[112:115]
buffer_load_dwordx4 a[44:47], v244, s[20:23], s66 offen offset:3072 sc0 sc1
v_mfma_f32_16x16x32_bf16 v[120:123], a[68:71], a[172:175], v[120:123]
v_mul_f32 v44, v44, v58
v_mul_f32 v45, v45, v59
v_mfma_f32_16x16x32_bf16 v[128:131], a[68:71], a[188:191], v[128:131]
v_cvt_pk_bf16_f32 v58, v44, v45
v_lshlrev_b32 v44, 16, v58
s_waitcnt lgkmcnt(8)
v_mfma_f32_16x16x32_bf16 v[132:135], a[72:75], a[188:191], v[132:135]
ds_read_b64_tr_b16 a[68:69], v221 offset:9216
ds_read_b64_tr_b16 a[70:71], v221 offset:13824
v_mfma_f32_16x16x32_bf16 v[124:127], a[72:75], a[172:175], v[124:127]
buffer_load_dwordx4 a[60:63], v244, s[20:23], s67 offen offset:3072 sc0 sc1
v_mfma_f32_16x16x32_bf16 v[116:119], a[72:75], a[156:159], v[116:119]
s_lshl2_add_u32 s28, s36, s33
s_lshl2_add_u32 s28, s28, s37
v_mfma_f32_16x16x32_bf16 v[108:111], a[72:75], a[140:143], v[108:111]
s_lshl_b32 s95, s28, 5
s_add_u32 s95, s95, 0x24a000
v_mfma_f32_16x16x32_bf16 v[136:139], a[76:79], a[140:143], v[136:139]
ds_read_b64_tr_b16 a[72:73], v221 offset:18432
ds_read_b64_tr_b16 a[74:75], v221 offset:23040
v_mfma_f32_16x16x32_bf16 v[144:147], a[76:79], a[156:159], v[144:147]
s_lshl_b32 s28, s32, 18
s_sub_u32 s49, s44, s28
v_mfma_f32_16x16x32_bf16 v[152:155], a[76:79], a[172:175], v[152:155]
v_add_u32 v243, 0x2000, v244
v_mov_b32 v246, 2
v_mfma_f32_16x16x32_bf16 v[160:163], a[76:79], a[188:191], v[160:163]
s_lshl2_add_u32 s29, s33, s94
v_and_b32 v45, 0xffff0000, v58
v_mfma_f32_16x16x32_bf16 v[164:167], a[80:83], a[188:191], v[164:167]
ds_read_b64_tr_b16 a[76:77], v221 offset:27648
ds_read_b64_tr_b16 a[78:79], v221 offset:32256
v_mfma_f32_16x16x32_bf16 v[156:159], a[80:83], a[172:175], v[156:159]
v_accvgpr_read_b32 v47, a226
v_accvgpr_read_b32 v59, a236
v_mfma_f32_16x16x32_bf16 v[148:151], a[80:83], a[156:159], v[148:151]
v_lshlrev_b32 v46, 16, v47
v_and_b32 v47, 0xffff0000, v47
v_mfma_f32_16x16x32_bf16 v[140:143], a[80:83], a[140:143], v[140:143]
v_lshlrev_b32 v58, 16, v59
v_and_b32 v59, 0xffff0000, v59
s_waitcnt lgkmcnt(8)
v_mfma_f32_16x16x32_bf16 v[168:171], a[84:87], a[140:143], v[168:171]
ds_read_b64_tr_b16 a[80:81], v224 offset:0
ds_read_b64_tr_b16 a[82:83], v224 offset:4608
v_mfma_f32_16x16x32_bf16 v[176:179], a[84:87], a[156:159], v[176:179]
v_add_f32 v46, v46, v58
v_add_f32 v47, v47, v59
v_mfma_f32_16x16x32_bf16 v[184:187], a[84:87], a[172:175], v[184:187]
v_cvt_pk_bf16_f32 v58, v46, v47
v_lshlrev_b32 v46, 16, v58
v_mfma_f32_16x16x32_bf16 v[192:195], a[84:87], a[188:191], v[192:195]
v_and_b32 v47, 0xffff0000, v58
v_mul_f32 v58, 0xbfb8aa3b, v46
v_mfma_f32_16x16x32_bf16 v[196:199], a[88:91], a[188:191], v[196:199]
ds_read_b64_tr_b16 a[84:85], v224 offset:9216
ds_read_b64_tr_b16 a[86:87], v224 offset:13824
v_mfma_f32_16x16x32_bf16 v[188:191], a[88:91], a[172:175], v[188:191]
v_mul_f32 v59, 0xbfb8aa3b, v47
v_mfma_f32_16x16x32_bf16 v[180:183], a[88:91], a[156:159], v[180:183]
v_exp_f32 v58, v58
v_mfma_f32_16x16x32_bf16 v[172:175], a[88:91], a[140:143], v[172:175]
v_exp_f32 v59, v59
v_mfma_f32_16x16x32_bf16 v[200:203], a[92:95], a[140:143], v[200:203]
ds_read_b64_tr_b16 a[88:89], v224 offset:18432
ds_read_b64_tr_b16 a[90:91], v224 offset:23040
v_mfma_f32_16x16x32_bf16 v[204:207], a[92:95], a[156:159], v[204:207]
v_add_f32 v58, 1.0, v58
v_add_f32 v59, 1.0, v59
v_mfma_f32_16x16x32_bf16 v[208:211], a[92:95], a[172:175], v[208:211]
v_rcp_f32 v58, v58
v_mfma_f32_16x16x32_bf16 v[212:215], a[92:95], a[188:191], v[212:215]
v_rcp_f32 v59, v59
s_waitcnt vmcnt(28)
s_waitcnt lgkmcnt(8)
v_mfma_f32_16x16x32_bf16 v[212:215], a[64:67], a[112:115], v[212:215]
ds_read_b64_tr_b16 a[92:93], v224 offset:27648
ds_read_b64_tr_b16 a[94:95], v224 offset:32256
v_mfma_f32_16x16x32_bf16 v[208:211], a[64:67], a[96:99], v[208:211]
v_mul_f32 v46, v46, v58
v_mul_f32 v47, v47, v59
v_mfma_f32_16x16x32_bf16 v[204:207], a[64:67], a[208:211], v[204:207]
v_cvt_pk_bf16_f32 v58, v46, v47
v_lshlrev_b32 v46, 16, v58
v_mfma_f32_16x16x32_bf16 v[200:203], a[64:67], a[192:195], v[200:203]
v_and_b32 v47, 0xffff0000, v58
v_accvgpr_read_b32 v49, a227
s_waitcnt vmcnt(24)
v_mfma_f32_16x16x32_bf16 v[200:203], a[68:71], a[196:199], v[200:203]
ds_read_b64_tr_b16 a[64:65], v219 offset:0
ds_read_b64_tr_b16 a[66:67], v219 offset:4608
v_mfma_f32_16x16x32_bf16 v[204:207], a[68:71], a[244:247], v[204:207]
v_accvgpr_read_b32 v59, a237
v_lshlrev_b32 v48, 16, v49
v_mfma_f32_16x16x32_bf16 v[208:211], a[68:71], a[100:103], v[208:211]
v_and_b32 v49, 0xffff0000, v49
v_lshlrev_b32 v58, 16, v59
v_mfma_f32_16x16x32_bf16 v[212:215], a[68:71], a[116:119], v[212:215]
s_waitcnt vmcnt(0)
buffer_store_dword v246, v254, s[20:23], s29 offen
s_waitcnt vmcnt(21)
v_mfma_f32_16x16x32_bf16 v[212:215], a[72:75], a[120:123], v[212:215]
ds_read_b64_tr_b16 a[68:69], v219 offset:9216
ds_read_b64_tr_b16 a[70:71], v219 offset:13824
v_mfma_f32_16x16x32_bf16 v[208:211], a[72:75], a[104:107], v[208:211]
s_add_u32 s28, s32, 0
s_and_b32 s28, s28, 7
v_mfma_f32_16x16x32_bf16 v[204:207], a[72:75], a[248:251], v[204:207]
s_xor_b32 s29, s28, s32
s_lshl_b32 s28, s28, 18
v_mfma_f32_16x16x32_bf16 v[200:203], a[72:75], a[200:203], v[200:203]
s_add_u32 s28, s28, s49
s_and_b32 s29, s29, 4
s_waitcnt vmcnt(17)
s_waitcnt lgkmcnt(8)
v_mfma_f32_16x16x32_bf16 v[200:203], a[76:79], a[204:207], v[200:203]
ds_read_b64_tr_b16 a[72:73], v219 offset:18432
ds_read_b64_tr_b16 a[74:75], v219 offset:23040
v_mfma_f32_16x16x32_bf16 v[204:207], a[76:79], a[252:255], v[204:207]
s_add_u32 s72, s28, 0
s_lshl_b32 s29, s29, 10
v_mfma_f32_16x16x32_bf16 v[208:211], a[76:79], a[108:111], v[208:211]
s_add_u32 s28, s32, 1
s_and_b32 s28, s28, 7
v_mfma_f32_16x16x32_bf16 v[212:215], a[76:79], a[124:127], v[212:215]
s_xor_b32 s29, s28, s32
s_lshl_b32 s28, s28, 18
s_waitcnt vmcnt(13)
v_mfma_f32_16x16x32_bf16 v[212:215], a[80:83], a[48:51], v[212:215]
ds_read_b64_tr_b16 a[76:77], v219 offset:27648
ds_read_b64_tr_b16 a[78:79], v219 offset:32256
v_mfma_f32_16x16x32_bf16 v[208:211], a[80:83], a[32:35], v[208:211]
s_add_u32 s28, s28, s49
s_and_b32 s29, s29, 4
v_mfma_f32_16x16x32_bf16 v[204:207], a[80:83], a[16:19], v[204:207]
s_add_u32 s73, s28, 8192
s_lshl_b32 s29, s29, 10
v_mfma_f32_16x16x32_bf16 v[200:203], a[80:83], a[0:3], v[200:203]
s_add_u32 s65, s28, s29
v_and_b32 v59, 0xffff0000, v59
s_waitcnt vmcnt(9)
v_mfma_f32_16x16x32_bf16 v[200:203], a[84:87], a[4:7], v[200:203]
ds_read_b64_tr_b16 a[80:81], v222 offset:0
ds_read_b64_tr_b16 a[82:83], v222 offset:4608
v_mfma_f32_16x16x32_bf16 v[204:207], a[84:87], a[20:23], v[204:207]
s_add_u32 s28, s32, 2
s_and_b32 s28, s28, 7
v_mfma_f32_16x16x32_bf16 v[208:211], a[84:87], a[36:39], v[208:211]
s_xor_b32 s29, s28, s32
s_lshl_b32 s28, s28, 18
v_mfma_f32_16x16x32_bf16 v[212:215], a[84:87], a[52:55], v[212:215]
s_add_u32 s28, s28, s49
s_and_b32 s29, s29, 4
s_waitcnt vmcnt(5)
s_waitcnt lgkmcnt(8)
v_mfma_f32_16x16x32_bf16 v[212:215], a[88:91], a[56:59], v[212:215]
ds_read_b64_tr_b16 a[84:85], v222 offset:9216
ds_read_b64_tr_b16 a[86:87], v222 offset:13824
v_mfma_f32_16x16x32_bf16 v[208:211], a[88:91], a[40:43], v[208:211]
s_add_u32 s74, s28, 8192
s_lshl_b32 s29, s29, 10
v_mfma_f32_16x16x32_bf16 v[204:207], a[88:91], a[24:27], v[204:207]
s_add_u32 s66, s28, s29
v_add_f32 v48, v48, v58
v_mfma_f32_16x16x32_bf16 v[200:203], a[88:91], a[8:11], v[200:203]
s_add_u32 s28, s32, 3
s_and_b32 s28, s28, 7
s_waitcnt vmcnt(1)
v_mfma_f32_16x16x32_bf16 v[200:203], a[92:95], a[12:15], v[200:203]
ds_read_b64_tr_b16 a[88:89], v222 offset:18432
ds_read_b64_tr_b16 a[90:91], v222 offset:23040
v_mfma_f32_16x16x32_bf16 v[204:207], a[92:95], a[28:31], v[204:207]
s_xor_b32 s29, s28, s32
s_lshl_b32 s28, s28, 18
v_mfma_f32_16x16x32_bf16 v[208:211], a[92:95], a[44:47], v[208:211]
s_add_u32 s28, s28, s49
s_and_b32 s29, s29, 4
v_mfma_f32_16x16x32_bf16 v[212:215], a[92:95], a[60:63], v[212:215]
s_add_u32 s75, s28, 0
s_lshl_b32 s29, s29, 10
v_mfma_f32_16x16x32_bf16 v[96:99], a[64:67], a[112:115], v[96:99]
ds_read_b64_tr_b16 a[92:93], v222 offset:27648
ds_read_b64_tr_b16 a[94:95], v222 offset:32256
v_mfma_f32_16x16x32_bf16 v[88:91], a[64:67], a[96:99], v[88:91]
s_add_u32 s67, s28, s29
v_add_f32 v49, v49, v59
v_mfma_f32_16x16x32_bf16 v[80:83], a[64:67], a[208:211], v[80:83]
buffer_load_dword v230, v229, s[20:23], s94 offen sc0 sc1
v_mfma_f32_16x16x32_bf16 v[72:75], a[64:67], a[192:195], v[72:75]
s_add_u32 s28, s32, 4
s_and_b32 s28, s28, 7
s_waitcnt lgkmcnt(8)
v_mfma_f32_16x16x32_bf16 v[72:75], a[68:71], a[196:199], v[72:75]
ds_read_b64_tr_b16 a[64:65], v219 offset:8
ds_read_b64_tr_b16 a[66:67], v219 offset:4616
v_mfma_f32_16x16x32_bf16 v[80:83], a[68:71], a[244:247], v[80:83]
s_xor_b32 s29, s28, s32
s_lshl_b32 s28, s28, 18
v_mfma_f32_16x16x32_bf16 v[88:91], a[68:71], a[100:103], v[88:91]
s_add_u32 s28, s28, s49
s_and_b32 s29, s29, 4
v_mfma_f32_16x16x32_bf16 v[96:99], a[68:71], a[116:119], v[96:99]
s_add_u32 s84, s28, 0
s_lshl_b32 s29, s29, 10
v_mfma_f32_16x16x32_bf16 v[96:99], a[72:75], a[120:123], v[96:99]
ds_read_b64_tr_b16 a[68:69], v219 offset:9224
ds_read_b64_tr_b16 a[70:71], v219 offset:13832
v_mfma_f32_16x16x32_bf16 v[88:91], a[72:75], a[104:107], v[88:91]
s_add_u32 s68, s28, s29
v_cvt_pk_bf16_f32 v58, v48, v49
v_mfma_f32_16x16x32_bf16 v[80:83], a[72:75], a[248:251], v[80:83]
s_add_u32 s28, s32, 5
s_and_b32 s28, s28, 7
v_mfma_f32_16x16x32_bf16 v[72:75], a[72:75], a[200:203], v[72:75]
s_xor_b32 s29, s28, s32
s_lshl_b32 s28, s28, 18
v_mfma_f32_16x16x32_bf16 v[72:75], a[76:79], a[204:207], v[72:75]
ds_read_b64_tr_b16 a[72:73], v219 offset:18440
ds_read_b64_tr_b16 a[74:75], v219 offset:23048
v_mfma_f32_16x16x32_bf16 v[80:83], a[76:79], a[252:255], v[80:83]
s_add_u32 s28, s28, s49
s_and_b32 s29, s29, 4
v_mfma_f32_16x16x32_bf16 v[88:91], a[76:79], a[108:111], v[88:91]
s_add_u32 s85, s28, 8192
s_lshl_b32 s29, s29, 10
v_mfma_f32_16x16x32_bf16 v[96:99], a[76:79], a[124:127], v[96:99]
s_add_u32 s69, s28, s29
v_lshlrev_b32 v48, 16, v58
s_waitcnt lgkmcnt(8)
v_mfma_f32_16x16x32_bf16 v[96:99], a[80:83], a[48:51], v[96:99]
ds_read_b64_tr_b16 a[76:77], v219 offset:27656
ds_read_b64_tr_b16 a[78:79], v219 offset:32264
v_mfma_f32_16x16x32_bf16 v[88:91], a[80:83], a[32:35], v[88:91]
s_add_u32 s28, s32, 6
s_and_b32 s28, s28, 7
v_mfma_f32_16x16x32_bf16 v[80:83], a[80:83], a[16:19], v[80:83]
s_xor_b32 s29, s28, s32
s_lshl_b32 s28, s28, 18
v_mfma_f32_16x16x32_bf16 v[72:75], a[80:83], a[0:3], v[72:75]
s_add_u32 s28, s28, s49
s_and_b32 s29, s29, 4
v_mfma_f32_16x16x32_bf16 v[72:75], a[84:87], a[4:7], v[72:75]
ds_read_b64_tr_b16 a[80:81], v222 offset:8
ds_read_b64_tr_b16 a[82:83], v222 offset:4616
v_mfma_f32_16x16x32_bf16 v[80:83], a[84:87], a[20:23], v[80:83]
s_add_u32 s86, s28, 8192
s_lshl_b32 s29, s29, 10
v_mfma_f32_16x16x32_bf16 v[88:91], a[84:87], a[36:39], v[88:91]
s_add_u32 s70, s28, s29
v_and_b32 v49, 0xffff0000, v58
v_mfma_f32_16x16x32_bf16 v[96:99], a[84:87], a[52:55], v[96:99]
s_add_u32 s28, s32, 7
s_and_b32 s28, s28, 7
v_mfma_f32_16x16x32_bf16 v[96:99], a[88:91], a[56:59], v[96:99]
ds_read_b64_tr_b16 a[84:85], v222 offset:9224
ds_read_b64_tr_b16 a[86:87], v222 offset:13832
v_mfma_f32_16x16x32_bf16 v[88:91], a[88:91], a[40:43], v[88:91]
s_xor_b32 s29, s28, s32
s_lshl_b32 s28, s28, 18
v_mfma_f32_16x16x32_bf16 v[80:83], a[88:91], a[24:27], v[80:83]
s_add_u32 s28, s28, s49
s_and_b32 s29, s29, 4
v_mfma_f32_16x16x32_bf16 v[72:75], a[88:91], a[8:11], v[72:75]
s_add_u32 s87, s28, 0
s_lshl_b32 s29, s29, 10
s_waitcnt lgkmcnt(8)
v_mfma_f32_16x16x32_bf16 v[72:75], a[92:95], a[12:15], v[72:75]
ds_read_b64_tr_b16 a[88:89], v222 offset:18440
ds_read_b64_tr_b16 a[90:91], v222 offset:23048
v_mfma_f32_16x16x32_bf16 v[80:83], a[92:95], a[28:31], v[80:83]
s_add_u32 s71, s28, s29
v_mul_f32 v58, 0xbfb8aa3b, v48
v_mfma_f32_16x16x32_bf16 v[88:91], a[92:95], a[44:47], v[88:91]
s_waitcnt vmcnt(0)
v_cmp_gt_u32 vcc, 2, v230
v_mfma_f32_16x16x32_bf16 v[96:99], a[92:95], a[60:63], v[96:99]
v_mul_f32 v59, 0xbfb8aa3b, v49
v_mfma_f32_16x16x32_bf16 v[100:103], a[64:67], a[112:115], v[100:103]
ds_read_b64_tr_b16 a[92:93], v222 offset:27656
ds_read_b64_tr_b16 a[94:95], v222 offset:32264
v_mfma_f32_16x16x32_bf16 v[92:95], a[64:67], a[96:99], v[92:95]
s_and_b32 s29, vcc_lo, 15
s_cbranch_scc1 SP_O3A
SP_O3A_RET:
v_mfma_f32_16x16x32_bf16 v[84:87], a[64:67], a[208:211], v[84:87]
s_add_u32 s39, s44, 8192
v_mfma_f32_16x16x32_bf16 v[76:79], a[64:67], a[192:195], v[76:79]
v_cvt_pk_bf16_f32 v200, v200, v201
v_cvt_pk_bf16_f32 v201, v202, v203
v_mfma_f32_16x16x32_bf16 v[76:79], a[68:71], a[196:199], v[76:79]
ds_read_b64_tr_b16 a[64:65], v220 offset:0
ds_read_b64_tr_b16 a[66:67], v220 offset:4608
v_mfma_f32_16x16x32_bf16 v[84:87], a[68:71], a[244:247], v[84:87]
buffer_store_dwordx2 v[200:201], v226, s[20:23], s44 offen offset:0
v_mfma_f32_16x16x32_bf16 v[92:95], a[68:71], a[100:103], v[92:95]
v_cvt_pk_bf16_f32 v204, v204, v205
v_cvt_pk_bf16_f32 v205, v206, v207
v_mfma_f32_16x16x32_bf16 v[100:103], a[68:71], a[116:119], v[100:103]
buffer_store_dwordx2 v[204:205], v226, s[20:23], s44 offen offset:512
s_waitcnt lgkmcnt(8)
v_mfma_f32_16x16x32_bf16 v[100:103], a[72:75], a[120:123], v[100:103]
ds_read_b64_tr_b16 a[68:69], v220 offset:9216
ds_read_b64_tr_b16 a[70:71], v220 offset:13824
v_mfma_f32_16x16x32_bf16 v[92:95], a[72:75], a[104:107], v[92:95]
v_cvt_pk_bf16_f32 v208, v208, v209
v_cvt_pk_bf16_f32 v209, v210, v211
v_mfma_f32_16x16x32_bf16 v[84:87], a[72:75], a[248:251], v[84:87]
buffer_store_dwordx2 v[208:209], v226, s[20:23], s39 offen offset:0
v_mfma_f32_16x16x32_bf16 v[76:79], a[72:75], a[200:203], v[76:79]
v_cvt_pk_bf16_f32 v212, v212, v213
v_cvt_pk_bf16_f32 v213, v214, v215
v_mfma_f32_16x16x32_bf16 v[76:79], a[76:79], a[204:207], v[76:79]
ds_read_b64_tr_b16 a[72:73], v220 offset:18432
ds_read_b64_tr_b16 a[74:75], v220 offset:23040
v_mfma_f32_16x16x32_bf16 v[84:87], a[76:79], a[252:255], v[84:87]
buffer_store_dwordx2 v[212:213], v226, s[20:23], s39 offen offset:512
v_mfma_f32_16x16x32_bf16 v[92:95], a[76:79], a[108:111], v[92:95]
v_exp_f32 v58, v58
v_mfma_f32_16x16x32_bf16 v[100:103], a[76:79], a[124:127], v[100:103]
v_exp_f32 v59, v59
v_mfma_f32_16x16x32_bf16 v[100:103], a[80:83], a[48:51], v[100:103]
ds_read_b64_tr_b16 a[76:77], v220 offset:27648
ds_read_b64_tr_b16 a[78:79], v220 offset:32256
v_mfma_f32_16x16x32_bf16 v[92:95], a[80:83], a[32:35], v[92:95]
v_add_f32 v58, 1.0, v58
v_add_f32 v59, 1.0, v59
v_mfma_f32_16x16x32_bf16 v[84:87], a[80:83], a[16:19], v[84:87]
v_rcp_f32 v58, v58
v_mfma_f32_16x16x32_bf16 v[76:79], a[80:83], a[0:3], v[76:79]
v_rcp_f32 v59, v59
s_waitcnt lgkmcnt(8)
v_mfma_f32_16x16x32_bf16 v[76:79], a[84:87], a[4:7], v[76:79]
ds_read_b64_tr_b16 a[80:81], v223 offset:0
ds_read_b64_tr_b16 a[82:83], v223 offset:4608
v_mfma_f32_16x16x32_bf16 v[84:87], a[84:87], a[20:23], v[84:87]
v_mul_f32 v48, v48, v58
v_mul_f32 v49, v49, v59
v_mfma_f32_16x16x32_bf16 v[92:95], a[84:87], a[36:39], v[92:95]
v_cvt_pk_bf16_f32 v58, v48, v49
v_lshlrev_b32 v48, 16, v58
v_mfma_f32_16x16x32_bf16 v[100:103], a[84:87], a[52:55], v[100:103]
v_and_b32 v49, 0xffff0000, v58
v_accvgpr_read_b32 v51, a228
v_mfma_f32_16x16x32_bf16 v[100:103], a[88:91], a[56:59], v[100:103]
STUB_15:
s_cbranch_execz STUB_18
ds_read_b64_tr_b16 a[84:85], v223 offset:9216
ds_read_b64_tr_b16 a[86:87], v223 offset:13824
v_mfma_f32_16x16x32_bf16 v[92:95], a[88:91], a[40:43], v[92:95]
v_accvgpr_read_b32 v59, a238
v_lshlrev_b32 v50, 16, v51
v_mfma_f32_16x16x32_bf16 v[84:87], a[88:91], a[24:27], v[84:87]
v_and_b32 v51, 0xffff0000, v51
v_lshlrev_b32 v58, 16, v59
v_mfma_f32_16x16x32_bf16 v[76:79], a[88:91], a[8:11], v[76:79]
v_and_b32 v59, 0xffff0000, v59
v_add_f32 v50, v50, v58
v_mfma_f32_16x16x32_bf16 v[76:79], a[92:95], a[12:15], v[76:79]
ds_read_b64_tr_b16 a[88:89], v223 offset:18432
ds_read_b64_tr_b16 a[90:91], v223 offset:23040
v_mfma_f32_16x16x32_bf16 v[84:87], a[92:95], a[28:31], v[84:87]
v_add_f32 v51, v51, v59
v_cvt_pk_bf16_f32 v58, v50, v51
v_mfma_f32_16x16x32_bf16 v[92:95], a[92:95], a[44:47], v[92:95]
v_lshlrev_b32 v50, 16, v58
v_and_b32 v51, 0xffff0000, v58
v_mfma_f32_16x16x32_bf16 v[100:103], a[92:95], a[60:63], v[100:103]
v_mul_f32 v58, 0xbfb8aa3b, v50
v_mul_f32 v59, 0xbfb8aa3b, v51
s_waitcnt lgkmcnt(8)
v_mfma_f32_16x16x32_bf16 v[128:131], a[64:67], a[112:115], v[128:131]
ds_read_b64_tr_b16 a[92:93], v223 offset:27648
ds_read_b64_tr_b16 a[94:95], v223 offset:32256
v_mfma_f32_16x16x32_bf16 v[120:123], a[64:67], a[96:99], v[120:123]
v_exp_f32 v58, v58
v_mfma_f32_16x16x32_bf16 v[112:115], a[64:67], a[208:211], v[112:115]
v_exp_f32 v59, v59
v_mfma_f32_16x16x32_bf16 v[104:107], a[64:67], a[192:195], v[104:107]
v_add_f32 v58, 1.0, v58
v_add_f32 v59, 1.0, v59
v_mfma_f32_16x16x32_bf16 v[104:107], a[68:71], a[196:199], v[104:107]
ds_read_b64_tr_b16 a[64:65], v220 offset:8
ds_read_b64_tr_b16 a[66:67], v220 offset:4616
v_mfma_f32_16x16x32_bf16 v[112:115], a[68:71], a[244:247], v[112:115]
v_rcp_f32 v58, v58
v_mfma_f32_16x16x32_bf16 v[120:123], a[68:71], a[100:103], v[120:123]
v_rcp_f32 v59, v59
v_mfma_f32_16x16x32_bf16 v[128:131], a[68:71], a[116:119], v[128:131]
v_mul_f32 v50, v50, v58
v_mul_f32 v51, v51, v59
v_mfma_f32_16x16x32_bf16 v[128:131], a[72:75], a[120:123], v[128:131]
ds_read_b64_tr_b16 a[68:69], v220 offset:9224
ds_read_b64_tr_b16 a[70:71], v220 offset:13832
v_mfma_f32_16x16x32_bf16 v[120:123], a[72:75], a[104:107], v[120:123]
s_add_u32 s39, s44, 0
v_cvt_pk_bf16_f32 v58, v50, v51
v_mfma_f32_16x16x32_bf16 v[112:115], a[72:75], a[248:251], v[112:115]
v_cvt_pk_bf16_f32 v80, v80, v81
v_cvt_pk_bf16_f32 v81, v82, v83
v_mfma_f32_16x16x32_bf16 v[104:107], a[72:75], a[200:203], v[104:107]
v_cvt_pk_bf16_f32 v82, v84, v85
v_cvt_pk_bf16_f32 v83, v86, v87
s_waitcnt lgkmcnt(8)
v_mfma_f32_16x16x32_bf16 v[104:107], a[76:79], a[204:207], v[104:107]
ds_read_b64_tr_b16 a[72:73], v220 offset:18440
ds_read_b64_tr_b16 a[74:75], v220 offset:23048
v_mfma_f32_16x16x32_bf16 v[112:115], a[76:79], a[252:255], v[112:115]
buffer_store_dwordx4 v[80:83], v244, s[20:23], s39 offen offset:1024
v_mfma_f32_16x16x32_bf16 v[120:123], a[76:79], a[108:111], v[120:123]
v_cvt_pk_bf16_f32 v88, v88, v89
v_cvt_pk_bf16_f32 v89, v90, v91
v_mfma_f32_16x16x32_bf16 v[128:131], a[76:79], a[124:127], v[128:131]
v_cvt_pk_bf16_f32 v90, v92, v93
v_cvt_pk_bf16_f32 v91, v94, v95
v_mfma_f32_16x16x32_bf16 v[128:131], a[80:83], a[48:51], v[128:131]
ds_read_b64_tr_b16 a[76:77], v220 offset:27656
ds_read_b64_tr_b16 a[78:79], v220 offset:32264
v_mfma_f32_16x16x32_bf16 v[120:123], a[80:83], a[32:35], v[120:123]
buffer_store_dwordx4 v[88:91], v244, s[20:23], s39 offen offset:2048
v_mfma_f32_16x16x32_bf16 v[112:115], a[80:83], a[16:19], v[112:115]
v_cvt_pk_bf16_f32 v96, v96, v97
v_cvt_pk_bf16_f32 v97, v98, v99
v_mfma_f32_16x16x32_bf16 v[104:107], a[80:83], a[0:3], v[104:107]
v_cvt_pk_bf16_f32 v98, v100, v101
v_cvt_pk_bf16_f32 v99, v102, v103
v_mfma_f32_16x16x32_bf16 v[104:107], a[84:87], a[4:7], v[104:107]
ds_read_b64_tr_b16 a[80:81], v223 offset:8
ds_read_b64_tr_b16 a[82:83], v223 offset:4616
v_mfma_f32_16x16x32_bf16 v[112:115], a[84:87], a[20:23], v[112:115]
buffer_store_dwordx4 v[96:99], v244, s[20:23], s39 offen offset:3072
v_mfma_f32_16x16x32_bf16 v[120:123], a[84:87], a[36:39], v[120:123]
v_lshlrev_b32 v50, 16, v58
v_and_b32 v51, 0xffff0000, v58
v_mfma_f32_16x16x32_bf16 v[128:131], a[84:87], a[52:55], v[128:131]
v_accvgpr_read_b32 v53, a229
v_accvgpr_read_b32 v59, a239
s_waitcnt lgkmcnt(8)
v_mfma_f32_16x16x32_bf16 v[128:131], a[88:91], a[56:59], v[128:131]
ds_read_b64_tr_b16 a[84:85], v223 offset:9224
ds_read_b64_tr_b16 a[86:87], v223 offset:13832
v_mfma_f32_16x16x32_bf16 v[120:123], a[88:91], a[40:43], v[120:123]
v_lshlrev_b32 v52, 16, v53
v_and_b32 v53, 0xffff0000, v53
v_mfma_f32_16x16x32_bf16 v[112:115], a[88:91], a[24:27], v[112:115]
v_lshlrev_b32 v58, 16, v59
v_and_b32 v59, 0xffff0000, v59
v_mfma_f32_16x16x32_bf16 v[104:107], a[88:91], a[8:11], v[104:107]
v_add_f32 v52, v52, v58
v_add_f32 v53, v53, v59
v_mfma_f32_16x16x32_bf16 v[104:107], a[92:95], a[12:15], v[104:107]
ds_read_b64_tr_b16 a[88:89], v223 offset:18440
ds_read_b64_tr_b16 a[90:91], v223 offset:23048
v_mfma_f32_16x16x32_bf16 v[112:115], a[92:95], a[28:31], v[112:115]
v_cvt_pk_bf16_f32 v58, v52, v53
v_lshlrev_b32 v52, 16, v58
v_mfma_f32_16x16x32_bf16 v[120:123], a[92:95], a[44:47], v[120:123]
v_and_b32 v53, 0xffff0000, v58
v_mul_f32 v58, 0xbfb8aa3b, v52
v_mfma_f32_16x16x32_bf16 v[128:131], a[92:95], a[60:63], v[128:131]
v_mul_f32 v59, 0xbfb8aa3b, v53
v_mfma_f32_16x16x32_bf16 v[132:135], a[64:67], a[112:115], v[132:135]
ds_read_b64_tr_b16 a[92:93], v223 offset:27656
ds_read_b64_tr_b16 a[94:95], v223 offset:32264
v_mfma_f32_16x16x32_bf16 v[124:127], a[64:67], a[96:99], v[124:127]
v_exp_f32 v58, v58
v_mfma_f32_16x16x32_bf16 v[116:119], a[64:67], a[208:211], v[116:119]
v_exp_f32 v59, v59
v_mfma_f32_16x16x32_bf16 v[108:111], a[64:67], a[192:195], v[108:111]
v_add_f32 v58, 1.0, v58
v_add_f32 v59, 1.0, v59
s_waitcnt lgkmcnt(8)
v_mfma_f32_16x16x32_bf16 v[108:111], a[68:71], a[196:199], v[108:111]
ds_read_b64_tr_b16 a[64:65], v219 offset:128
ds_read_b64_tr_b16 a[66:67], v219 offset:4736
v_mfma_f32_16x16x32_bf16 v[116:119], a[68:71], a[244:247], v[116:119]
v_rcp_f32 v58, v58
v_mfma_f32_16x16x32_bf16 v[124:127], a[68:71], a[100:103], v[124:127]
v_rcp_f32 v59, v59
v_mfma_f32_16x16x32_bf16 v[132:135], a[68:71], a[116:119], v[132:135]
v_mul_f32 v52, v52, v58
v_mul_f32 v53, v53, v59
v_mfma_f32_16x16x32_bf16 v[132:135], a[72:75], a[120:123], v[132:135]
ds_read_b64_tr_b16 a[68:69], v219 offset:9344
ds_read_b64_tr_b16 a[70:71], v219 offset:13952
v_mfma_f32_16x16x32_bf16 v[124:127], a[72:75], a[104:107], v[124:127]
v_cvt_pk_bf16_f32 v58, v52, v53
v_lshlrev_b32 v52, 16, v58
v_mfma_f32_16x16x32_bf16 v[116:119], a[72:75], a[248:251], v[116:119]
v_and_b32 v53, 0xffff0000, v58
v_accvgpr_read_b32 v55, a230
v_mfma_f32_16x16x32_bf16 v[108:111], a[72:75], a[200:203], v[108:111]
v_accvgpr_read_b32 v59, a240
v_lshlrev_b32 v54, 16, v55
v_mfma_f32_16x16x32_bf16 v[108:111], a[76:79], a[204:207], v[108:111]
ds_read_b64_tr_b16 a[72:73], v219 offset:18560
ds_read_b64_tr_b16 a[74:75], v219 offset:23168
v_mfma_f32_16x16x32_bf16 v[116:119], a[76:79], a[252:255], v[116:119]
v_and_b32 v55, 0xffff0000, v55
v_lshlrev_b32 v58, 16, v59
v_mfma_f32_16x16x32_bf16 v[124:127], a[76:79], a[108:111], v[124:127]
v_and_b32 v59, 0xffff0000, v59
v_add_f32 v54, v54, v58
v_mfma_f32_16x16x32_bf16 v[132:135], a[76:79], a[124:127], v[132:135]
v_add_f32 v55, v55, v59
v_cvt_pk_bf16_f32 v58, v54, v55
s_waitcnt lgkmcnt(8)
v_mfma_f32_16x16x32_bf16 v[132:135], a[80:83], a[48:51], v[132:135]
ds_read_b64_tr_b16 a[76:77], v219 offset:27776
ds_read_b64_tr_b16 a[78:79], v219 offset:32384
v_mfma_f32_16x16x32_bf16 v[124:127], a[80:83], a[32:35], v[124:127]
v_lshlrev_b32 v54, 16, v58
v_and_b32 v55, 0xffff0000, v58
v_mfma_f32_16x16x32_bf16 v[116:119], a[80:83], a[16:19], v[116:119]
v_mul_f32 v58, 0xbfb8aa3b, v54
v_mul_f32 v59, 0xbfb8aa3b, v55
v_mfma_f32_16x16x32_bf16 v[108:111], a[80:83], a[0:3], v[108:111]
v_exp_f32 v58, v58
v_mfma_f32_16x16x32_bf16 v[108:111], a[84:87], a[4:7], v[108:111]
ds_read_b64_tr_b16 a[80:81], v222 offset:128
ds_read_b64_tr_b16 a[82:83], v222 offset:4736
v_mfma_f32_16x16x32_bf16 v[116:119], a[84:87], a[20:23], v[116:119]
v_exp_f32 v59, v59
v_mfma_f32_16x16x32_bf16 v[124:127], a[84:87], a[36:39], v[124:127]
v_add_f32 v58, 1.0, v58
v_add_f32 v59, 1.0, v59
v_mfma_f32_16x16x32_bf16 v[132:135], a[84:87], a[52:55], v[132:135]
v_rcp_f32 v58, v58
v_mfma_f32_16x16x32_bf16 v[132:135], a[88:91], a[56:59], v[132:135]
ds_read_b64_tr_b16 a[84:85], v222 offset:9344
ds_read_b64_tr_b16 a[86:87], v222 offset:13952
v_mfma_f32_16x16x32_bf16 v[124:127], a[88:91], a[40:43], v[124:127]
v_rcp_f32 v59, v59
v_mfma_f32_16x16x32_bf16 v[116:119], a[88:91], a[24:27], v[116:119]
v_mul_f32 v54, v54, v58
v_mul_f32 v55, v55, v59
v_mfma_f32_16x16x32_bf16 v[108:111], a[88:91], a[8:11], v[108:111]
v_cvt_pk_bf16_f32 v58, v54, v55
v_lshlrev_b32 v54, 16, v58
s_waitcnt lgkmcnt(8)
v_mfma_f32_16x16x32_bf16 v[108:111], a[92:95], a[12:15], v[108:111]
ds_read_b64_tr_b16 a[88:89], v222 offset:18560
ds_read_b64_tr_b16 a[90:91], v222 offset:23168
v_mfma_f32_16x16x32_bf16 v[116:119], a[92:95], a[28:31], v[116:119]
v_and_b32 v55, 0xffff0000, v58
v_accvgpr_read_b32 v57, a231
v_mfma_f32_16x16x32_bf16 v[124:127], a[92:95], a[44:47], v[124:127]
v_accvgpr_read_b32 v59, a241
v_lshlrev_b32 v56, 16, v57
v_mfma_f32_16x16x32_bf16 v[132:135], a[92:95], a[60:63], v[132:135]
v_and_b32 v57, 0xffff0000, v57
v_lshlrev_b32 v58, 16, v59
v_mfma_f32_16x16x32_bf16 v[160:163], a[64:67], a[112:115], v[160:163]
ds_read_b64_tr_b16 a[92:93], v222 offset:27776
ds_read_b64_tr_b16 a[94:95], v222 offset:32384
v_mfma_f32_16x16x32_bf16 v[152:155], a[64:67], a[96:99], v[152:155]
v_and_b32 v59, 0xffff0000, v59
v_add_f32 v56, v56, v58
v_mfma_f32_16x16x32_bf16 v[144:147], a[64:67], a[208:211], v[144:147]
v_add_f32 v57, v57, v59
v_cvt_pk_bf16_f32 v58, v56, v57
v_mfma_f32_16x16x32_bf16 v[136:139], a[64:67], a[192:195], v[136:139]
v_lshlrev_b32 v56, 16, v58
v_and_b32 v57, 0xffff0000, v58
v_mfma_f32_16x16x32_bf16 v[136:139], a[68:71], a[196:199], v[136:139]
ds_read_b64_tr_b16 a[64:65], v219 offset:136
ds_read_b64_tr_b16 a[66:67], v219 offset:4744
v_mfma_f32_16x16x32_bf16 v[144:147], a[68:71], a[244:247], v[144:147]
v_mul_f32 v58, 0xbfb8aa3b, v56
v_mul_f32 v59, 0xbfb8aa3b, v57
v_mfma_f32_16x16x32_bf16 v[152:155], a[68:71], a[100:103], v[152:155]
v_exp_f32 v58, v58
v_mfma_f32_16x16x32_bf16 v[160:163], a[68:71], a[116:119], v[160:163]
v_exp_f32 v59, v59
s_waitcnt lgkmcnt(8)
v_mfma_f32_16x16x32_bf16 v[160:163], a[72:75], a[120:123], v[160:163]
ds_read_b64_tr_b16 a[68:69], v219 offset:9352
ds_read_b64_tr_b16 a[70:71], v219 offset:13960
v_mfma_f32_16x16x32_bf16 v[152:155], a[72:75], a[104:107], v[152:155]
s_add_u32 s39, s44, 4096
v_add_f32 v58, 1.0, v58
v_mfma_f32_16x16x32_bf16 v[144:147], a[72:75], a[248:251], v[144:147]
v_cvt_pk_bf16_f32 v104, v104, v105
v_cvt_pk_bf16_f32 v105, v106, v107
v_mfma_f32_16x16x32_bf16 v[136:139], a[72:75], a[200:203], v[136:139]
v_cvt_pk_bf16_f32 v106, v108, v109
v_cvt_pk_bf16_f32 v107, v110, v111
v_mfma_f32_16x16x32_bf16 v[136:139], a[76:79], a[204:207], v[136:139]
ds_read_b64_tr_b16 a[72:73], v219 offset:18568
ds_read_b64_tr_b16 a[74:75], v219 offset:23176
v_mfma_f32_16x16x32_bf16 v[144:147], a[76:79], a[252:255], v[144:147]
buffer_store_dwordx4 v[104:107], v244, s[20:23], s39 offen offset:0
v_mfma_f32_16x16x32_bf16 v[152:155], a[76:79], a[108:111], v[152:155]
v_cvt_pk_bf16_f32 v112, v112, v113
v_cvt_pk_bf16_f32 v113, v114, v115
v_mfma_f32_16x16x32_bf16 v[160:163], a[76:79], a[124:127], v[160:163]
v_cvt_pk_bf16_f32 v114, v116, v117
v_cvt_pk_bf16_f32 v115, v118, v119
v_mfma_f32_16x16x32_bf16 v[160:163], a[80:83], a[48:51], v[160:163]
ds_read_b64_tr_b16 a[76:77], v219 offset:27784
ds_read_b64_tr_b16 a[78:79], v219 offset:32392
v_mfma_f32_16x16x32_bf16 v[152:155], a[80:83], a[32:35], v[152:155]
buffer_store_dwordx4 v[112:115], v244, s[20:23], s39 offen offset:1024
v_mfma_f32_16x16x32_bf16 v[144:147], a[80:83], a[16:19], v[144:147]
v_cvt_pk_bf16_f32 v120, v120, v121
v_cvt_pk_bf16_f32 v121, v122, v123
v_mfma_f32_16x16x32_bf16 v[136:139], a[80:83], a[0:3], v[136:139]
v_cvt_pk_bf16_f32 v122, v124, v125
v_cvt_pk_bf16_f32 v123, v126, v127
s_waitcnt lgkmcnt(8)
v_mfma_f32_16x16x32_bf16 v[136:139], a[84:87], a[4:7], v[136:139]
ds_read_b64_tr_b16 a[80:81], v222 offset:136
ds_read_b64_tr_b16 a[82:83], v222 offset:4744
v_mfma_f32_16x16x32_bf16 v[144:147], a[84:87], a[20:23], v[144:147]
buffer_store_dwordx4 v[120:123], v244, s[20:23], s39 offen offset:2048
v_mfma_f32_16x16x32_bf16 v[152:155], a[84:87], a[36:39], v[152:155]
v_cvt_pk_bf16_f32 v128, v128, v129
v_cvt_pk_bf16_f32 v129, v130, v131
v_mfma_f32_16x16x32_bf16 v[160:163], a[84:87], a[52:55], v[160:163]
v_cvt_pk_bf16_f32 v130, v132, v133
v_cvt_pk_bf16_f32 v131, v134, v135
v_mfma_f32_16x16x32_bf16 v[160:163], a[88:91], a[56:59], v[160:163]
ds_read_b64_tr_b16 a[84:85], v222 offset:9352
ds_read_b64_tr_b16 a[86:87], v222 offset:13960
v_mfma_f32_16x16x32_bf16 v[152:155], a[88:91], a[40:43], v[152:155]
buffer_store_dwordx4 v[128:131], v244, s[20:23], s39 offen offset:3072
v_mfma_f32_16x16x32_bf16 v[144:147], a[88:91], a[24:27], v[144:147]
s_lshl2_add_u32 s28, s32, s95
v_add_f32 v59, 1.0, v59
v_mfma_f32_16x16x32_bf16 v[136:139], a[88:91], a[8:11], v[136:139]
v_rcp_f32 v58, v58
v_mfma_f32_16x16x32_bf16 v[136:139], a[92:95], a[12:15], v[136:139]
ds_read_b64_tr_b16 a[88:89], v222 offset:18568
ds_read_b64_tr_b16 a[90:91], v222 offset:23176
v_mfma_f32_16x16x32_bf16 v[144:147], a[92:95], a[28:31], v[144:147]
v_rcp_f32 v59, v59
v_mfma_f32_16x16x32_bf16 v[152:155], a[92:95], a[44:47], v[152:155]
v_mul_f32 v56, v56, v58
v_mul_f32 v57, v57, v59
v_mfma_f32_16x16x32_bf16 v[160:163], a[92:95], a[60:63], v[160:163]
v_cvt_pk_bf16_f32 v58, v56, v57
v_lshlrev_b32 v56, 16, v58
s_waitcnt lgkmcnt(8)
v_mfma_f32_16x16x32_bf16 v[164:167], a[64:67], a[112:115], v[164:167]
ds_read_b64_tr_b16 a[92:93], v222 offset:27784
ds_read_b64_tr_b16 a[94:95], v222 offset:32392
v_mfma_f32_16x16x32_bf16 v[156:159], a[64:67], a[96:99], v[156:159]
v_and_b32 v57, 0xffff0000, v58
v_accvgpr_read_b32 v19, a212
v_mfma_f32_16x16x32_bf16 v[148:151], a[64:67], a[208:211], v[148:151]
v_lshlrev_b32 v18, 16, v19
v_and_b32 v19, 0xffff0000, v19
v_mfma_f32_16x16x32_bf16 v[140:143], a[64:67], a[192:195], v[140:143]
v_accvgpr_read_b32 v21, a213
v_lshlrev_b32 v20, 16, v21
v_mfma_f32_16x16x32_bf16 v[140:143], a[68:71], a[196:199], v[140:143]
ds_read_b64_tr_b16 a[64:65], v220 offset:128
ds_read_b64_tr_b16 a[66:67], v220 offset:4736
v_mfma_f32_16x16x32_bf16 v[148:151], a[68:71], a[244:247], v[148:151]
v_and_b32 v21, 0xffff0000, v21
v_accvgpr_read_b32 v23, a214
v_mfma_f32_16x16x32_bf16 v[156:159], a[68:71], a[100:103], v[156:159]
v_lshlrev_b32 v22, 16, v23
v_and_b32 v23, 0xffff0000, v23
v_mfma_f32_16x16x32_bf16 v[164:167], a[68:71], a[116:119], v[164:167]
v_accvgpr_read_b32 v25, a215
v_lshlrev_b32 v24, 16, v25
v_mfma_f32_16x16x32_bf16 v[164:167], a[72:75], a[120:123], v[164:167]
ds_read_b64_tr_b16 a[68:69], v220 offset:9344
ds_read_b64_tr_b16 a[70:71], v220 offset:13952
v_mfma_f32_16x16x32_bf16 v[156:159], a[72:75], a[104:107], v[156:159]
v_and_b32 v25, 0xffff0000, v25
v_accvgpr_read_b32 v27, a216
v_mfma_f32_16x16x32_bf16 v[148:151], a[72:75], a[248:251], v[148:151]
v_lshlrev_b32 v26, 16, v27
v_and_b32 v27, 0xffff0000, v27
v_mfma_f32_16x16x32_bf16 v[140:143], a[72:75], a[200:203], v[140:143]
v_accvgpr_read_b32 v29, a217
v_lshlrev_b32 v28, 16, v29
s_waitcnt lgkmcnt(8)
v_mfma_f32_16x16x32_bf16 v[140:143], a[76:79], a[204:207], v[140:143]
ds_read_b64_tr_b16 a[72:73], v220 offset:18560
ds_read_b64_tr_b16 a[74:75], v220 offset:23168
v_mfma_f32_16x16x32_bf16 v[148:151], a[76:79], a[252:255], v[148:151]
v_and_b32 v29, 0xffff0000, v29
v_accvgpr_read_b32 v31, a218
v_mfma_f32_16x16x32_bf16 v[156:159], a[76:79], a[108:111], v[156:159]
v_lshlrev_b32 v30, 16, v31
v_and_b32 v31, 0xffff0000, v31
v_mfma_f32_16x16x32_bf16 v[164:167], a[76:79], a[124:127], v[164:167]
v_accvgpr_read_b32 v33, a219
v_lshlrev_b32 v32, 16, v33
v_mfma_f32_16x16x32_bf16 v[164:167], a[80:83], a[48:51], v[164:167]
ds_read_b64_tr_b16 a[76:77], v220 offset:27776
ds_read_b64_tr_b16 a[78:79], v220 offset:32384
v_mfma_f32_16x16x32_bf16 v[156:159], a[80:83], a[32:35], v[156:159]
v_and_b32 v33, 0xffff0000, v33
v_accvgpr_read_b32 v35, a220
v_mfma_f32_16x16x32_bf16 v[148:151], a[80:83], a[16:19], v[148:151]
s_waitcnt vmcnt(0)
buffer_store_dword v231, v254, s[20:23], s28 offen
v_mfma_f32_16x16x32_bf16 v[140:143], a[80:83], a[0:3], v[140:143]
v_lshlrev_b32 v34, 16, v35
v_and_b32 v35, 0xffff0000, v35
v_mfma_f32_16x16x32_bf16 v[140:143], a[84:87], a[4:7], v[140:143]
ds_read_b64_tr_b16 a[80:81], v223 offset:128
ds_read_b64_tr_b16 a[82:83], v223 offset:4736
v_mfma_f32_16x16x32_bf16 v[148:151], a[84:87], a[20:23], v[148:151]
v_accvgpr_read_b32 v37, a221
v_lshlrev_b32 v36, 16, v37
v_mfma_f32_16x16x32_bf16 v[156:159], a[84:87], a[36:39], v[156:159]
v_and_b32 v37, 0xffff0000, v37
v_mfma_f32_16x16x32_bf16 v[164:167], a[84:87], a[52:55], v[164:167]
s_mov_b32 s90, 0x3f80
s_mov_b32 s91, 0x3f800000
s_waitcnt lgkmcnt(8)
v_mfma_f32_16x16x32_bf16 v[164:167], a[88:91], a[56:59], v[164:167]
ds_read_b64_tr_b16 a[84:85], v223 offset:9344
ds_read_b64_tr_b16 a[86:87], v223 offset:13952
v_mfma_f32_16x16x32_bf16 v[156:159], a[88:91], a[40:43], v[156:159]
v_mov_b32 v66, 0
v_mov_b32 v67, 0
v_mfma_f32_16x16x32_bf16 v[148:151], a[88:91], a[24:27], v[148:151]
v_mov_b32 v68, 0
v_mov_b32 v69, 0
v_mfma_f32_16x16x32_bf16 v[140:143], a[88:91], a[8:11], v[140:143]
v_mfma_f32_16x16x32_bf16 v[140:143], a[92:95], a[12:15], v[140:143]
ds_read_b64_tr_b16 a[88:89], v223 offset:18560
ds_read_b64_tr_b16 a[90:91], v223 offset:23168
v_mfma_f32_16x16x32_bf16 v[148:151], a[92:95], a[28:31], v[148:151]
v_mfma_f32_16x16x32_bf16 v[156:159], a[92:95], a[44:47], v[156:159]
v_mfma_f32_16x16x32_bf16 v[164:167], a[92:95], a[60:63], v[164:167]
v_mfma_f32_16x16x32_bf16 v[192:195], a[64:67], a[112:115], v[192:195]
ds_read_b64_tr_b16 a[92:93], v223 offset:27776
ds_read_b64_tr_b16 a[94:95], v223 offset:32384
v_mfma_f32_16x16x32_bf16 v[184:187], a[64:67], a[96:99], v[184:187]
v_mfma_f32_16x16x32_bf16 v[176:179], a[64:67], a[208:211], v[176:179]
v_mfma_f32_16x16x32_bf16 v[168:171], a[64:67], a[192:195], v[168:171]
s_waitcnt lgkmcnt(8)
v_mfma_f32_16x16x32_bf16 v[168:171], a[68:71], a[196:199], v[168:171]
ds_read_b64_tr_b16 a[64:65], v220 offset:136
ds_read_b64_tr_b16 a[66:67], v220 offset:4744
v_mfma_f32_16x16x32_bf16 v[176:179], a[68:71], a[244:247], v[176:179]
v_mfma_f32_16x16x32_bf16 v[184:187], a[68:71], a[100:103], v[184:187]
v_mfma_f32_16x16x32_bf16 v[192:195], a[68:71], a[116:119], v[192:195]
v_mfma_f32_16x16x32_bf16 v[192:195], a[72:75], a[120:123], v[192:195]
ds_read_b64_tr_b16 a[68:69], v220 offset:9352
ds_read_b64_tr_b16 a[70:71], v220 offset:13960
v_mfma_f32_16x16x32_bf16 v[184:187], a[72:75], a[104:107], v[184:187]
s_add_u32 s39, s44, 8192
v_mfma_f32_16x16x32_bf16 v[176:179], a[72:75], a[248:251], v[176:179]
v_cvt_pk_bf16_f32 v144, v144, v145
v_cvt_pk_bf16_f32 v145, v146, v147
v_mfma_f32_16x16x32_bf16 v[168:171], a[72:75], a[200:203], v[168:171]
v_cvt_pk_bf16_f32 v146, v148, v149
v_cvt_pk_bf16_f32 v147, v150, v151
v_mfma_f32_16x16x32_bf16 v[168:171], a[76:79], a[204:207], v[168:171]
ds_read_b64_tr_b16 a[72:73], v220 offset:18568
ds_read_b64_tr_b16 a[74:75], v220 offset:23176
v_mfma_f32_16x16x32_bf16 v[176:179], a[76:79], a[252:255], v[176:179]
buffer_store_dwordx4 v[144:147], v244, s[20:23], s39 offen offset:1024
v_mfma_f32_16x16x32_bf16 v[184:187], a[76:79], a[108:111], v[184:187]
v_cvt_pk_bf16_f32 v152, v152, v153
v_cvt_pk_bf16_f32 v153, v154, v155
v_mfma_f32_16x16x32_bf16 v[192:195], a[76:79], a[124:127], v[192:195]
v_cvt_pk_bf16_f32 v154, v156, v157
v_cvt_pk_bf16_f32 v155, v158, v159
s_waitcnt lgkmcnt(8)
v_mfma_f32_16x16x32_bf16 v[192:195], a[80:83], a[48:51], v[192:195]
ds_read_b64_tr_b16 a[76:77], v220 offset:27784
ds_read_b64_tr_b16 a[78:79], v220 offset:32392
v_mfma_f32_16x16x32_bf16 v[184:187], a[80:83], a[32:35], v[184:187]
buffer_store_dwordx4 v[152:155], v244, s[20:23], s39 offen offset:2048
v_mfma_f32_16x16x32_bf16 v[176:179], a[80:83], a[16:19], v[176:179]
v_cvt_pk_bf16_f32 v160, v160, v161
v_cvt_pk_bf16_f32 v161, v162, v163
v_mfma_f32_16x16x32_bf16 v[168:171], a[80:83], a[0:3], v[168:171]
v_cvt_pk_bf16_f32 v162, v164, v165
v_cvt_pk_bf16_f32 v163, v166, v167
v_mfma_f32_16x16x32_bf16 v[168:171], a[84:87], a[4:7], v[168:171]
ds_read_b64_tr_b16 a[80:81], v223 offset:136
ds_read_b64_tr_b16 a[82:83], v223 offset:4744
v_mfma_f32_16x16x32_bf16 v[176:179], a[84:87], a[20:23], v[176:179]
buffer_store_dwordx4 v[160:163], v244, s[20:23], s39 offen offset:3072
v_mfma_f32_16x16x32_bf16 v[184:187], a[84:87], a[36:39], v[184:187]
buffer_load_dword v230, v229, s[20:23], s95 offen sc0 sc1
v_mfma_f32_16x16x32_bf16 v[192:195], a[84:87], a[52:55], v[192:195]
v_mfma_f32_16x16x32_bf16 v[192:195], a[88:91], a[56:59], v[192:195]
ds_read_b64_tr_b16 a[84:85], v223 offset:9352
ds_read_b64_tr_b16 a[86:87], v223 offset:13960
v_mfma_f32_16x16x32_bf16 v[184:187], a[88:91], a[40:43], v[184:187]
v_mfma_f32_16x16x32_bf16 v[176:179], a[88:91], a[24:27], v[176:179]
v_mfma_f32_16x16x32_bf16 v[168:171], a[88:91], a[8:11], v[168:171]
s_waitcnt lgkmcnt(8)
v_mfma_f32_16x16x32_bf16 v[168:171], a[92:95], a[12:15], v[168:171]
ds_read_b64_tr_b16 a[88:89], v223 offset:18568
ds_read_b64_tr_b16 a[90:91], v223 offset:23176
v_mfma_f32_16x16x32_bf16 v[176:179], a[92:95], a[28:31], v[176:179]
v_mfma_f32_16x16x32_bf16 v[184:187], a[92:95], a[44:47], v[184:187]
v_mfma_f32_16x16x32_bf16 v[192:195], a[92:95], a[60:63], v[192:195]
v_mfma_f32_16x16x32_bf16 v[196:199], a[64:67], a[112:115], v[196:199]
ds_read_b64_tr_b16 a[92:93], v223 offset:27784
ds_read_b64_tr_b16 a[94:95], v223 offset:32392
v_mfma_f32_16x16x32_bf16 v[188:191], a[64:67], a[96:99], v[188:191]
v_mfma_f32_16x16x32_bf16 v[180:183], a[64:67], a[208:211], v[180:183]
v_mfma_f32_16x16x32_bf16 v[172:175], a[64:67], a[192:195], v[172:175]
v_mfma_f32_16x16x32_bf16 v[172:175], a[68:71], a[196:199], v[172:175]
v_mfma_f32_16x16x32_bf16 v[180:183], a[68:71], a[244:247], v[180:183]
v_mfma_f32_16x16x32_bf16 v[188:191], a[68:71], a[100:103], v[188:191]
v_mfma_f32_16x16x32_bf16 v[196:199], a[68:71], a[116:119], v[196:199]
s_waitcnt lgkmcnt(8)
v_mfma_f32_16x16x32_bf16 v[196:199], a[72:75], a[120:123], v[196:199]
v_mfma_f32_16x16x32_bf16 v[188:191], a[72:75], a[104:107], v[188:191]
v_mfma_f32_16x16x32_bf16 v[180:183], a[72:75], a[248:251], v[180:183]
v_mfma_f32_16x16x32_bf16 v[172:175], a[72:75], a[200:203], v[172:175]
v_mfma_f32_16x16x32_bf16 v[172:175], a[76:79], a[204:207], v[172:175]
v_mfma_f32_16x16x32_bf16 v[180:183], a[76:79], a[252:255], v[180:183]
v_mfma_f32_16x16x32_bf16 v[188:191], a[76:79], a[108:111], v[188:191]
s_waitcnt vmcnt(0)
v_cmp_gt_u32 vcc, 1, v230
v_mfma_f32_16x16x32_bf16 v[196:199], a[76:79], a[124:127], v[196:199]
s_waitcnt lgkmcnt(6)
v_mfma_f32_16x16x32_bf16 v[196:199], a[80:83], a[48:51], v[196:199]
s_and_b32 s29, vcc_lo, 0xff
s_cbranch_scc1 SP_P1A
SP_P1A_RET:
v_mfma_f32_16x16x32_bf16 v[188:191], a[80:83], a[32:35], v[188:191]
buffer_load_dwordx4 v[104:107], v244, s[20:23], s65 offen offset:3072 sc0 sc1
v_mfma_f32_16x16x32_bf16 v[180:183], a[80:83], a[16:19], v[180:183]
buffer_load_dwordx4 v[108:111], v244, s[20:23], s66 offen offset:2048 sc0 sc1
v_mfma_f32_16x16x32_bf16 v[172:175], a[80:83], a[0:3], v[172:175]
buffer_load_dwordx4 v[112:115], v244, s[20:23], s67 offen offset:1024 sc0 sc1
s_waitcnt lgkmcnt(4)
v_mfma_f32_16x16x32_bf16 v[172:175], a[84:87], a[4:7], v[172:175]
buffer_load_dwordx4 v[116:119], v244, s[20:23], s68 offen offset:0 sc0 sc1
v_mfma_f32_16x16x32_bf16 v[180:183], a[84:87], a[20:23], v[180:183]
buffer_load_dwordx4 v[120:123], v244, s[20:23], s69 offen offset:3072 sc0 sc1
v_mfma_f32_16x16x32_bf16 v[188:191], a[84:87], a[36:39], v[188:191]
buffer_load_dwordx4 v[124:127], v244, s[20:23], s70 offen offset:2048 sc0 sc1
v_mfma_f32_16x16x32_bf16 v[196:199], a[84:87], a[52:55], v[196:199]
buffer_load_dwordx4 v[128:131], v244, s[20:23], s71 offen offset:1024 sc0 sc1
s_waitcnt lgkmcnt(2)
v_mfma_f32_16x16x32_bf16 v[196:199], a[88:91], a[56:59], v[196:199]
v_mfma_f32_16x16x32_bf16 v[188:191], a[88:91], a[40:43], v[188:191]
v_mfma_f32_16x16x32_bf16 v[180:183], a[88:91], a[24:27], v[180:183]
v_mfma_f32_16x16x32_bf16 v[172:175], a[88:91], a[8:11], v[172:175]
s_waitcnt lgkmcnt(0)
v_mfma_f32_16x16x32_bf16 v[172:175], a[92:95], a[12:15], v[172:175]
v_mfma_f32_16x16x32_bf16 v[180:183], a[92:95], a[28:31], v[180:183]
v_mfma_f32_16x16x32_bf16 v[188:191], a[92:95], a[44:47], v[188:191]
v_mfma_f32_16x16x32_bf16 v[196:199], a[92:95], a[60:63], v[196:199]
s_add_u32 s39, s44, 12288
s_nop 5
v_cvt_pk_bf16_f32 v168, v168, v169
v_cvt_pk_bf16_f32 v169, v170, v171
v_cvt_pk_bf16_f32 v170, v172, v173
v_cvt_pk_bf16_f32 v171, v174, v175
buffer_store_dwordx4 v[168:171], v244, s[20:23], s39 offen offset:0
v_cvt_pk_bf16_f32 v176, v176, v177
v_cvt_pk_bf16_f32 v177, v178, v179
v_cvt_pk_bf16_f32 v178, v180, v181
v_cvt_pk_bf16_f32 v179, v182, v183
buffer_store_dwordx4 v[176:179], v244, s[20:23], s39 offen offset:1024
v_cvt_pk_bf16_f32 v184, v184, v185
v_cvt_pk_bf16_f32 v185, v186, v187
v_cvt_pk_bf16_f32 v186, v188, v189
v_cvt_pk_bf16_f32 v187, v190, v191
buffer_store_dwordx4 v[184:187], v244, s[20:23], s39 offen offset:2048
v_cvt_pk_bf16_f32 v192, v192, v193
v_cvt_pk_bf16_f32 v193, v194, v195
v_cvt_pk_bf16_f32 v194, v196, v197
v_cvt_pk_bf16_f32 v195, v198, v199
buffer_store_dwordx4 v[192:195], v244, s[20:23], s39 offen offset:3072
buffer_load_dwordx2 v[200:201], v226, s[20:23], s72 offen offset:0 sc0 sc1
buffer_load_dwordx2 v[202:203], v226, s[20:23], s73 offen offset:512 sc0 sc1
buffer_load_dwordx2 v[204:205], v226, s[20:23], s74 offen offset:0 sc0 sc1
buffer_load_dwordx2 v[206:207], v226, s[20:23], s75 offen offset:512 sc0 sc1
buffer_load_dwordx2 v[208:209], v226, s[20:23], s84 offen offset:0 sc0 sc1
buffer_load_dwordx2 v[210:211], v226, s[20:23], s85 offen offset:512 sc0 sc1
buffer_load_dwordx2 v[212:213], v226, s[20:23], s86 offen offset:0 sc0 sc1
buffer_load_dwordx2 v[214:215], v226, s[20:23], s87 offen offset:512 sc0 sc1
s_waitcnt vmcnt(8)
buffer_store_dword v246, v254, s[20:23], s28 offen
buffer_load_dword v230, v229, s[20:23], s95 offen sc0 sc1
s_waitcnt vmcnt(20)
v_dot2c_f32_bf16 v72, s90, v104
v_dot2c_f32_bf16 v73, s91, v104
v_dot2c_f32_bf16 v74, s90, v105
v_dot2c_f32_bf16 v75, s91, v105
v_dot2c_f32_bf16 v76, s90, v106
v_dot2c_f32_bf16 v77, s91, v106
v_dot2c_f32_bf16 v78, s90, v107
v_dot2c_f32_bf16 v79, s91, v107
s_waitcnt vmcnt(19)
v_dot2c_f32_bf16 v72, s90, v108
v_dot2c_f32_bf16 v73, s91, v108
v_dot2c_f32_bf16 v74, s90, v109
v_dot2c_f32_bf16 v75, s91, v109
v_dot2c_f32_bf16 v76, s90, v110
v_dot2c_f32_bf16 v77, s91, v110
v_dot2c_f32_bf16 v78, s90, v111
v_dot2c_f32_bf16 v79, s91, v111
s_waitcnt vmcnt(18)
v_dot2c_f32_bf16 v72, s90, v112
v_dot2c_f32_bf16 v73, s91, v112
v_dot2c_f32_bf16 v74, s90, v113
v_dot2c_f32_bf16 v75, s91, v113
v_dot2c_f32_bf16 v76, s90, v114
v_dot2c_f32_bf16 v77, s91, v114
v_dot2c_f32_bf16 v78, s90, v115
v_dot2c_f32_bf16 v79, s91, v115
s_waitcnt vmcnt(17)
v_dot2c_f32_bf16 v72, s90, v116
v_dot2c_f32_bf16 v73, s91, v116
v_dot2c_f32_bf16 v74, s90, v117
v_dot2c_f32_bf16 v75, s91, v117
v_dot2c_f32_bf16 v76, s90, v118
v_dot2c_f32_bf16 v77, s91, v118
v_dot2c_f32_bf16 v78, s90, v119
v_dot2c_f32_bf16 v79, s91, v119
s_waitcnt vmcnt(16)
v_dot2c_f32_bf16 v72, s90, v120
v_dot2c_f32_bf16 v73, s91, v120
v_dot2c_f32_bf16 v74, s90, v121
v_dot2c_f32_bf16 v75, s91, v121
v_dot2c_f32_bf16 v76, s90, v122
v_dot2c_f32_bf16 v77, s91, v122
v_dot2c_f32_bf16 v78, s90, v123
v_dot2c_f32_bf16 v79, s91, v123
s_waitcnt vmcnt(15)
v_dot2c_f32_bf16 v72, s90, v124
v_dot2c_f32_bf16 v73, s91, v124
v_dot2c_f32_bf16 v74, s90, v125
STUB_16:
s_cbranch_execz HOP_RET2
v_dot2c_f32_bf16 v75, s91, v125
v_dot2c_f32_bf16 v76, s90, v126
v_dot2c_f32_bf16 v77, s91, v126
v_dot2c_f32_bf16 v78, s90, v127
v_dot2c_f32_bf16 v79, s91, v127
s_waitcnt vmcnt(14)
v_dot2c_f32_bf16 v72, s90, v128
v_dot2c_f32_bf16 v73, s91, v128
v_dot2c_f32_bf16 v74, s90, v129
v_dot2c_f32_bf16 v75, s91, v129
v_dot2c_f32_bf16 v76, s90, v130
v_dot2c_f32_bf16 v77, s91, v130
v_dot2c_f32_bf16 v78, s90, v131
v_dot2c_f32_bf16 v79, s91, v131
s_nop 2
v_cvt_pk_bf16_f32 v58, v72, v73
v_cvt_pk_bf16_f32 v59, v74, v75
v_cvt_pk_bf16_f32 v60, v76, v77
v_cvt_pk_bf16_f32 v61, v78, v79
v_lshlrev_b32 v72, 16, v58
v_and_b32 v73, 0xffff0000, v58
v_lshlrev_b32 v74, 16, v59
v_and_b32 v75, 0xffff0000, v59
v_lshlrev_b32 v76, 16, v60
v_and_b32 v77, 0xffff0000, v60
v_lshlrev_b32 v78, 16, v61
v_and_b32 v79, 0xffff0000, v61
v_pk_mul_f32 v[72:73], v[72:73], v[38:39]
v_pk_mul_f32 v[74:75], v[74:75], v[40:41]
v_pk_mul_f32 v[76:77], v[76:77], v[42:43]
v_pk_mul_f32 v[78:79], v[78:79], v[44:45]
v_cvt_pk_bf16_f32 v58, v72, v73
v_cvt_pk_bf16_f32 v59, v74, v75
v_cvt_pk_bf16_f32 v60, v76, v77
v_cvt_pk_bf16_f32 v61, v78, v79
v_lshlrev_b32 v72, 16, v58
v_and_b32 v73, 0xffff0000, v58
v_lshlrev_b32 v74, 16, v59
v_and_b32 v75, 0xffff0000, v59
v_lshlrev_b32 v76, 16, v60
v_and_b32 v77, 0xffff0000, v60
v_lshlrev_b32 v78, 16, v61
v_and_b32 v79, 0xffff0000, v61
v_pk_add_f32 v[72:73], v[72:73], v[18:19]
v_pk_add_f32 v[74:75], v[74:75], v[20:21]
v_pk_add_f32 v[76:77], v[76:77], v[22:23]
v_pk_add_f32 v[78:79], v[78:79], v[24:25]
v_cvt_pk_bf16_f32 v72, v72, v73
v_cvt_pk_bf16_f32 v73, v74, v75
v_cvt_pk_bf16_f32 v74, v76, v77
v_cvt_pk_bf16_f32 v75, v78, v79
buffer_store_dwordx4 v[72:75], v248, s[60:63], 0 offen
s_waitcnt vmcnt(1)
v_cmp_gt_u32 vcc, 2, v230
s_nop 0
s_and_b32 s29, vcc_lo, 0xff
s_cbranch_scc0 SP_P2A_RET
SP_P2A:
s_sleep 0
s_add_u32 s100, s100, 1
s_bitcmp1_b32 s100, 19
s_cbranch_scc1 K_END
buffer_load_dword v230, v229, s[20:23], s95 offen sc0 sc1
s_waitcnt vmcnt(0)
v_cmp_gt_u32 vcc, 2, v230
s_nop 0
s_and_b32 s29, vcc_lo, 0xff
s_cbranch_scc1 SP_P2A
SP_P2A_RET:
buffer_load_dwordx4 v[80:83], v243, s[20:23], s65 offen offset:3072 sc0 sc1
buffer_load_dwordx4 v[84:87], v243, s[20:23], s66 offen offset:2048 sc0 sc1
buffer_load_dwordx4 v[88:91], v243, s[20:23], s67 offen offset:1024 sc0 sc1
buffer_load_dwordx4 v[92:95], v243, s[20:23], s68 offen offset:0 sc0 sc1
buffer_load_dwordx4 v[96:99], v243, s[20:23], s69 offen offset:3072 sc0 sc1
buffer_load_dwordx4 v[100:103], v243, s[20:23], s70 offen offset:2048 sc0 sc1
buffer_load_dwordx4 v[132:135], v243, s[20:23], s71 offen offset:1024 sc0 sc1
s_waitcnt vmcnt(17)
v_dot2c_f32_bf16 v66, s90, v200
v_dot2c_f32_bf16 v67, s91, v200
v_dot2c_f32_bf16 v68, s90, v201
v_dot2c_f32_bf16 v69, s91, v201
s_waitcnt vmcnt(16)
v_dot2c_f32_bf16 v66, s90, v202
v_dot2c_f32_bf16 v67, s91, v202
v_dot2c_f32_bf16 v68, s90, v203
v_dot2c_f32_bf16 v69, s91, v203
s_waitcnt vmcnt(15)
v_dot2c_f32_bf16 v66, s90, v204
v_dot2c_f32_bf16 v67, s91, v204
v_dot2c_f32_bf16 v68, s90, v205
v_dot2c_f32_bf16 v69, s91, v205
s_waitcnt vmcnt(14)
v_dot2c_f32_bf16 v66, s90, v206
v_dot2c_f32_bf16 v67, s91, v206
v_dot2c_f32_bf16 v68, s90, v207
v_dot2c_f32_bf16 v69, s91, v207
s_waitcnt vmcnt(13)
v_dot2c_f32_bf16 v66, s90, v208
v_dot2c_f32_bf16 v67, s91, v208
v_dot2c_f32_bf16 v68, s90, v209
v_dot2c_f32_bf16 v69, s91, v209
s_waitcnt vmcnt(12)
v_dot2c_f32_bf16 v66, s90, v210
v_dot2c_f32_bf16 v67, s91, v210
v_dot2c_f32_bf16 v68, s90, v211
v_dot2c_f32_bf16 v69, s91, v211
s_waitcnt vmcnt(11)
v_dot2c_f32_bf16 v66, s90, v212
v_dot2c_f32_bf16 v67, s91, v212
v_dot2c_f32_bf16 v68, s90, v213
v_dot2c_f32_bf16 v69, s91, v213
s_waitcnt vmcnt(10)
v_dot2c_f32_bf16 v66, s90, v214
v_dot2c_f32_bf16 v67, s91, v214
v_dot2c_f32_bf16 v68, s90, v215
v_dot2c_f32_bf16 v69, s91, v215
s_nop 2
s_cmp_eq_u32 s34, 0
s_cselect_b32 s29, 0, 0x7fbffff0
v_cvt_pk_bf16_f32 v58, v66, v67
v_cvt_pk_bf16_f32 v59, v68, v69
v_lshlrev_b32 v66, 16, v58
v_and_b32 v67, 0xffff0000, v58
v_lshlrev_b32 v68, 16, v59
v_and_b32 v69, 0xffff0000, v59
v_pk_mul_f32 v[66:67], v[66:67], v[54:55]
v_pk_mul_f32 v[68:69], v[68:69], v[56:57]
v_cvt_pk_bf16_f32 v58, v66, v67
v_cvt_pk_bf16_f32 v59, v68, v69
v_lshlrev_b32 v66, 16, v58
v_and_b32 v67, 0xffff0000, v58
v_lshlrev_b32 v68, 16, v59
v_and_b32 v69, 0xffff0000, v59
v_pk_add_f32 v[66:67], v[66:67], v[34:35]
v_pk_add_f32 v[68:69], v[68:69], v[36:37]
v_cvt_pk_bf16_f32 v66, v66, v67
v_cvt_pk_bf16_f32 v67, v68, v69
buffer_store_dwordx2 v[66:67], v249, s[60:63], s29 offen
s_waitcnt vmcnt(7)
v_dot2c_f32_bf16 v136, s90, v80
v_dot2c_f32_bf16 v137, s91, v80
v_dot2c_f32_bf16 v138, s90, v81
v_dot2c_f32_bf16 v139, s91, v81
v_dot2c_f32_bf16 v140, s90, v82
v_dot2c_f32_bf16 v141, s91, v82
v_dot2c_f32_bf16 v142, s90, v83
v_dot2c_f32_bf16 v143, s91, v83
s_waitcnt vmcnt(6)
v_dot2c_f32_bf16 v136, s90, v84
v_dot2c_f32_bf16 v137, s91, v84
v_dot2c_f32_bf16 v138, s90, v85
v_dot2c_f32_bf16 v139, s91, v85
v_dot2c_f32_bf16 v140, s90, v86
v_dot2c_f32_bf16 v141, s91, v86
v_dot2c_f32_bf16 v142, s90, v87
v_dot2c_f32_bf16 v143, s91, v87
s_waitcnt vmcnt(5)
v_dot2c_f32_bf16 v136, s90, v88
v_dot2c_f32_bf16 v137, s91, v88
v_dot2c_f32_bf16 v138, s90, v89
v_dot2c_f32_bf16 v139, s91, v89
v_dot2c_f32_bf16 v140, s90, v90
v_dot2c_f32_bf16 v141, s91, v90
v_dot2c_f32_bf16 v142, s90, v91
v_dot2c_f32_bf16 v143, s91, v91
s_waitcnt vmcnt(4)
v_dot2c_f32_bf16 v136, s90, v92
v_dot2c_f32_bf16 v137, s91, v92
v_dot2c_f32_bf16 v138, s90, v93
v_dot2c_f32_bf16 v139, s91, v93
v_dot2c_f32_bf16 v140, s90, v94
v_dot2c_f32_bf16 v141, s91, v94
v_dot2c_f32_bf16 v142, s90, v95
v_dot2c_f32_bf16 v143, s91, v95
s_waitcnt vmcnt(3)
v_dot2c_f32_bf16 v136, s90, v96
v_dot2c_f32_bf16 v137, s91, v96
v_dot2c_f32_bf16 v138, s90, v97
v_dot2c_f32_bf16 v139, s91, v97
v_dot2c_f32_bf16 v140, s90, v98
v_dot2c_f32_bf16 v141, s91, v98
v_dot2c_f32_bf16 v142, s90, v99
v_dot2c_f32_bf16 v143, s91, v99
s_waitcnt vmcnt(2)
v_dot2c_f32_bf16 v136, s90, v100
v_dot2c_f32_bf16 v137, s91, v100
v_dot2c_f32_bf16 v138, s90, v101
v_dot2c_f32_bf16 v139, s91, v101
v_dot2c_f32_bf16 v140, s90, v102
v_dot2c_f32_bf16 v141, s91, v102
v_dot2c_f32_bf16 v142, s90, v103
v_dot2c_f32_bf16 v143, s91, v103
s_waitcnt vmcnt(1)
v_dot2c_f32_bf16 v136, s90, v132
v_dot2c_f32_bf16 v137, s91, v132
v_dot2c_f32_bf16 v138, s90, v133
v_dot2c_f32_bf16 v139, s91, v133
v_dot2c_f32_bf16 v140, s90, v134
v_dot2c_f32_bf16 v141, s91, v134
v_dot2c_f32_bf16 v142, s90, v135
v_dot2c_f32_bf16 v143, s91, v135
s_nop 2
v_cvt_pk_bf16_f32 v58, v136, v137
v_cvt_pk_bf16_f32 v59, v138, v139
v_cvt_pk_bf16_f32 v60, v140, v141
v_cvt_pk_bf16_f32 v61, v142, v143
v_lshlrev_b32 v136, 16, v58
v_and_b32 v137, 0xffff0000, v58
v_lshlrev_b32 v138, 16, v59
v_and_b32 v139, 0xffff0000, v59
v_lshlrev_b32 v140, 16, v60
v_and_b32 v141, 0xffff0000, v60
v_lshlrev_b32 v142, 16, v61
v_and_b32 v143, 0xffff0000, v61
v_pk_mul_f32 v[136:137], v[136:137], v[46:47]
v_pk_mul_f32 v[138:139], v[138:139], v[48:49]
v_pk_mul_f32 v[140:141], v[140:141], v[50:51]
v_pk_mul_f32 v[142:143], v[142:143], v[52:53]
v_cvt_pk_bf16_f32 v58, v136, v137
v_cvt_pk_bf16_f32 v59, v138, v139
v_cvt_pk_bf16_f32 v60, v140, v141
v_cvt_pk_bf16_f32 v61, v142, v143
v_lshlrev_b32 v136, 16, v58
v_and_b32 v137, 0xffff0000, v58
v_lshlrev_b32 v138, 16, v59
v_and_b32 v139, 0xffff0000, v59
v_lshlrev_b32 v140, 16, v60
v_and_b32 v141, 0xffff0000, v60
v_lshlrev_b32 v142, 16, v61
v_and_b32 v143, 0xffff0000, v61
v_pk_add_f32 v[136:137], v[136:137], v[26:27]
v_pk_add_f32 v[138:139], v[138:139], v[28:29]
v_pk_add_f32 v[140:141], v[140:141], v[30:31]
v_pk_add_f32 v[142:143], v[142:143], v[32:33]
v_cvt_pk_bf16_f32 v136, v136, v137
v_cvt_pk_bf16_f32 v137, v138, v139
v_cvt_pk_bf16_f32 v138, v140, v141
v_cvt_pk_bf16_f32 v139, v142, v143
buffer_store_dwordx4 v[136:139], v248, s[60:63], 0 offen offset:128
K_END:
s_endpgm
K_EVT:
STUB_17:
s_cbranch_execz HOP_RET2
s_sub_u32 s3, s33, 1
s_cmp_lt_u32 s2, 144
s_cbranch_scc0 EV_Y
s_mov_b32 s3, 0
s_cmp_eq_u32 s37, 0
s_cbranch_scc0 K_EVT_RET
s_mov_b32 s28, 0x243000
EV_INC:
v_mov_b32 v246, 0
v_mov_b32 v247, 1
s_mov_b64 exec, 1
buffer_atomic_add v247, v246, s[20:23], s28 offen sc1
s_mov_b64 exec, -1
s_branch K_EVT_RET
EV_Y:
s_cmp_eq_u32 s33, 4
s_cbranch_scc0 EV_Y4
v_mov_b32 v246, 0
s_mov_b32 s28, 0x243000
buffer_load_dword v247, v246, s[20:23], s28 offen sc0 sc1
s_branch K_EVT_RET
EV_Y4:
s_cmp_eq_u32 s33, 1
s_cbranch_scc0 EV_Y5
s_mov_b32 s28, 0x243080
s_bitcmp0_b32 s37, 0
s_cbranch_scc1 EV_INC
s_branch K_EVT_RET
EV_Y5:
s_sub_u32 s29, s2, 144
s_lshr_b32 s28, s37, 1
s_lshl1_add_u32 s29, s29, s28
s_cmp_eq_u32 s33, 3
s_cbranch_scc0 EV_Y3
v_readfirstlane_b32 s28, v247
s_cmp_ge_u32 s28, 144
s_cbranch_scc0 EV_Y4SP
EV_Y4OK:
v_lshrrev_b32 v246, 3, v1
v_mul_u32_u24 v246, 18432, v246
v_and_b32 v247, 7, v1
v_lshl_add_u32 v246, v247, 4, v246
s_lshl_b32 s28, s29, 7
s_and_b32 s29, s37, 1
s_mul_i32 s29, s29, 1327104
s_add_u32 s28, s28, s29
s_add_u32 s28, s28, 0x2000000
buffer_load_dwordx4 v[104:107], v246, s[20:23], s28 offen sc0 sc1
s_add_u32 s28, s28, 147456
buffer_load_dwordx4 v[108:111], v246, s[20:23], s28 offen sc0 sc1
s_add_u32 s28, s28, 147456
buffer_load_dwordx4 v[112:115], v246, s[20:23], s28 offen sc0 sc1
s_add_u32 s28, s28, 147456
buffer_load_dwordx4 v[116:119], v246, s[20:23], s28 offen sc0 sc1
s_add_u32 s28, s28, 147456
buffer_load_dwordx4 v[120:123], v246, s[20:23], s28 offen sc0 sc1
s_add_u32 s28, s28, 147456
buffer_load_dwordx4 v[124:127], v246, s[20:23], s28 offen sc0 sc1
s_add_u32 s28, s28, 147456
buffer_load_dwordx4 v[128:131], v246, s[20:23], s28 offen sc0 sc1
s_add_u32 s28, s28, 147456
buffer_load_dwordx4 v[132:135], v246, s[20:23], s28 offen sc0 sc1
s_add_u32 s28, s28, 147456
buffer_load_dwordx4 v[248:251], v246, s[20:23], s28 offen sc0 sc1
s_branch K_EVT_RET
EV_Y3:
STUB_18:
s_cbranch_execz HOP_RET2
v_pk_add_f32 v[104:105], v[104:105], v[108:109]
v_pk_add_f32 v[106:107], v[106:107], v[110:111]
v_pk_add_f32 v[112:113], v[112:113], v[116:117]
v_pk_add_f32 v[114:115], v[114:115], v[118:119]
v_pk_add_f32 v[120:121], v[120:121], v[124:125]
v_pk_add_f32 v[122:123], v[122:123], v[126:127]
v_pk_add_f32 v[128:129], v[128:129], v[132:133]
v_pk_add_f32 v[130:131], v[130:131], v[134:135]
v_pk_add_f32 v[104:105], v[104:105], v[112:113]
v_pk_add_f32 v[106:107], v[106:107], v[114:115]
v_pk_add_f32 v[120:121], v[120:121], v[128:129]
v_pk_add_f32 v[122:123], v[122:123], v[130:131]
v_pk_add_f32 v[104:105], v[104:105], v[248:249]
v_pk_add_f32 v[106:107], v[106:107], v[250:251]
v_pk_add_f32 v[104:105], v[104:105], v[120:121]
v_pk_add_f32 v[106:107], v[106:107], v[122:123]
v_and_b32 v246, 7, v1
s_lshr_b32 s28, s37, 1
s_lshl_b32 s28, s28, 7
v_add_f32_dpp v108, v104, v104 row_ror:8 row_mask:0xf bank_mask:0xf
v_add_f32_dpp v109, v105, v105 row_ror:8 row_mask:0xf bank_mask:0xf
v_add_f32_dpp v110, v106, v106 row_ror:8 row_mask:0xf bank_mask:0xf
v_add_f32_dpp v111, v107, v107 row_ror:8 row_mask:0xf bank_mask:0xf
v_mov_b32 v104, v108
v_mov_b32 v105, v109
v_mov_b32 v106, v110
v_mov_b32 v107, v111
v_permlane16_swap_b32 v104, v108
v_permlane16_swap_b32 v105, v109
v_permlane16_swap_b32 v106, v110
v_permlane16_swap_b32 v107, v111
v_add_f32 v108, v104, v108
v_add_f32 v109, v105, v109
v_add_f32 v110, v106, v110
v_add_f32 v111, v107, v111
v_mov_b32 v104, v108
v_mov_b32 v105, v109
v_mov_b32 v106, v110
v_mov_b32 v107, v111
v_permlane32_swap_b32 v104, v108
v_permlane32_swap_b32 v105, v109
v_permlane32_swap_b32 v106, v110
v_permlane32_swap_b32 v107, v111
v_add_f32 v108, v104, v108
v_add_f32 v109, v105, v109
v_add_f32 v110, v106, v110
v_add_f32 v111, v107, v111
v_lshlrev_b32 v247, 4, v246
v_add_u32 v247, s28, v247
s_bitcmp1_b32 s37, 0
s_cbranch_scc0 EV_YE
ds_write_b128 v247, v[108:111] offset:65024
s_waitcnt lgkmcnt(0)
s_barrier
s_branch K_EVT_RET
EV_YE:
s_barrier
ds_read_b128 v[104:107], v247 offset:65024
v_mul_u32_u24 v246, 0x480, v246
s_lshl_b32 s28, s29, 3
s_add_u32 s28, s28, 0x244000
s_waitcnt lgkmcnt(0)
v_pk_add_f32 v[104:105], v[104:105], v[108:109]
v_pk_add_f32 v[106:107], v[106:107], v[110:111]
v_cvt_pk_bf16_f32 v108, v104, v105
v_cvt_pk_bf16_f32 v109, v106, v107
v_lshlrev_b32 v104, 16, v108
v_and_b32 v105, 0xffff0000, v108
v_lshlrev_b32 v106, 16, v109
v_and_b32 v107, 0xffff0000, v109
v_mul_f32 v104, v104, v236
v_mul_f32 v105, v105, v236
v_mul_f32 v106, v106, v236
v_mul_f32 v107, v107, v236
v_cvt_pk_bf16_f32 v108, v104, v105
v_cvt_pk_bf16_f32 v109, v106, v107
s_mov_b64 exec, 0xff
buffer_store_dwordx2 v[108:109], v246, s[20:23], s28 offen sc0 sc1
s_mov_b64 exec, -1
s_branch K_EVT_RET
SP_CAND:
s_sleep 2
s_add_u32 s100, s100, 1
s_bitcmp1_b32 s100, 19
s_cbranch_scc1 K_END
s_mov_b32 s29, 0x242000
buffer_load_dwordx2 v[248:249], v250, s[20:23], s29 offen sc0 sc1
s_waitcnt vmcnt(0)
v_cmp_ne_u32 vcc, s47, v249
s_cbranch_vccnz SP_CAND
s_branch SP_CAND_RET
SP_FL:
s_sleep 2
s_add_u32 s100, s100, 1
s_bitcmp1_b32 s100, 19
s_cbranch_scc1 K_END
buffer_load_dword v253, v246, s[24:27], 0 offen sc0 sc1
s_waitcnt vmcnt(0)
v_and_b32 v253, 0x20202020, v253
v_cmp_ne_u32 vcc, 0x20202020, v253
s_cbranch_vccnz SP_FL
s_branch SP_FL_RET
SP_Y:
s_sleep 4
s_add_u32 s100, s100, 1
s_bitcmp1_b32 s100, 19
s_cbranch_scc1 K_END
s_mov_b32 s93, 0x243080
buffer_load_dword v246, v254, s[20:23], s93 offen sc0 sc1
s_waitcnt vmcnt(0)
v_readfirstlane_b32 s93, v246
s_cmp_lt_u32 s93, 144
s_cbranch_scc1 SP_Y
s_branch SP_Y_RET
SP_O1A:
s_sleep 1
s_add_u32 s100, s100, 1
s_bitcmp1_b32 s100, 19
s_cbranch_scc1 K_END
buffer_load_dword v230, v229, s[20:23], s94 offen sc0 sc1
s_waitcnt vmcnt(0)
v_cmp_gt_u32 vcc, 1, v230
s_bitcmp1_b32 vcc_lo, s39
s_cbranch_scc1 SP_O1A
s_branch SP_O1A_RET
SP_O2A:
s_sleep 1
s_add_u32 s100, s100, 1
s_bitcmp1_b32 s100, 19
s_cbranch_scc1 K_END
buffer_load_dword v230, v229, s[20:23], s94 offen sc0 sc1
s_waitcnt vmcnt(0)
v_cmp_gt_u32 vcc, 1, v230
s_and_b32 s29, vcc_lo, 15
s_cbranch_scc1 SP_O2A
s_branch SP_O2A_RET
SP_O3A:
s_sleep 1
s_add_u32 s100, s100, 1
s_bitcmp1_b32 s100, 19
s_cbranch_scc1 K_END
buffer_load_dword v230, v229, s[20:23], s94 offen sc0 sc1
s_waitcnt vmcnt(0)
v_cmp_gt_u32 vcc, 2, v230
s_and_b32 s29, vcc_lo, 15
s_cbranch_scc1 SP_O3A
s_branch SP_O3A_RET
SP_P1A:
s_sleep 1
s_add_u32 s100, s100, 1
s_bitcmp1_b32 s100, 19
s_cbranch_scc1 K_END
buffer_load_dword v230, v229, s[20:23], s95 offen sc0 sc1
s_waitcnt vmcnt(0)
v_cmp_gt_u32 vcc, 1, v230
s_and_b32 s29, vcc_lo, 0xff
s_cbranch_scc1 SP_P1A
s_branch SP_P1A_RET
EV_Y4SP:
s_sleep 8
s_add_u32 s100, s100, 1
s_bitcmp1_b32 s100, 19
s_cbranch_scc1 K_END
v_mov_b32 v246, 0
s_mov_b32 s28, 0x243000
buffer_load_dword v247, v246, s[20:23], s28 offen sc0 sc1
s_waitcnt vmcnt(0)
v_readfirstlane_b32 s28, v247
s_cmp_ge_u32 s28, 144
s_cbranch_scc0 EV_Y4SP
s_branch EV_Y4OK
K_HOT_END:
K_MIXED:
s_waitcnt lgkmcnt(0)
s_barrier
v_smfmac_f32_16x16x64_bf16 a[128:131], a[208:211], v[88:95], v245
v_smfmac_f32_16x16x64_bf16 a[132:135], a[208:211], v[96:103], v245
v_mfma_f32_16x16x32_bf16 a[0:3], a[176:179], v[88:91], a[0:3]
v_mfma_f32_16x16x32_bf16 a[16:19], a[180:183], v[88:91], a[16:19]
v_mfma_f32_16x16x32_bf16 a[32:35], a[184:187], v[88:91], a[32:35]
v_mfma_f32_16x16x32_bf16 a[48:51], a[188:191], v[88:91], a[48:51]
v_mfma_f32_16x16x32_bf16 a[64:67], a[192:195], v[88:91], a[64:67]
v_mfma_f32_16x16x32_bf16 a[80:83], a[196:199], v[88:91], a[80:83]
v_mfma_f32_16x16x32_bf16 a[96:99], a[200:203], v[88:91], a[96:99]
v_mfma_f32_16x16x32_bf16 a[112:115], a[204:207], v[88:91], a[112:115]
v_mfma_f32_16x16x32_bf16 a[4:7], a[176:179], v[92:95], a[4:7]
v_mfma_f32_16x16x32_bf16 a[20:23], a[180:183], v[92:95], a[20:23]
v_mfma_f32_16x16x32_bf16 a[36:39], a[184:187], v[92:95], a[36:39]
v_mfma_f32_16x16x32_bf16 a[52:55], a[188:191], v[92:95], a[52:55]
v_mfma_f32_16x16x32_bf16 a[68:71], a[192:195], v[92:95], a[68:71]
v_mfma_f32_16x16x32_bf16 a[84:87], a[196:199], v[92:95], a[84:87]
v_mfma_f32_16x16x32_bf16 a[100:103], a[200:203], v[92:95], a[100:103]
v_mfma_f32_16x16x32_bf16 a[116:119], a[204:207], v[92:95], a[116:119]
v_accvgpr_read_b32 v120, a128
v_accvgpr_read_b32 v124, a129
v_add_f32 v120, v120, v124
v_rcp_f32 v124, v120
s_add_u32 s50, s44, 0
v_mov_b32 v125, v124
v_accvgpr_read_b32 v104, a0
v_accvgpr_read_b32 v105, a1
v_accvgpr_read_b32 v106, a2
v_accvgpr_read_b32 v107, a3
v_accvgpr_read_b32 v108, a16
v_accvgpr_read_b32 v109, a17
v_accvgpr_read_b32 v110, a18
v_accvgpr_read_b32 v111, a19
v_pk_mul_f32 v[104:105], v[104:105], v[124:125]
v_pk_mul_f32 v[106:107], v[106:107], v[124:125]
v_pk_mul_f32 v[108:109], v[108:109], v[124:125]
v_pk_mul_f32 v[110:111], v[110:111], v[124:125]
v_cvt_pk_bf16_f32 v8, v104, v105
v_cvt_pk_bf16_f32 v9, v106, v107
v_cvt_pk_bf16_f32 v10, v108, v109
v_cvt_pk_bf16_f32 v11, v110, v111
buffer_store_dwordx4 v[8:11], v244, s[20:23], s50 offen offset:0 sc0 sc1
v_accvgpr_read_b32 v112, a32
v_accvgpr_read_b32 v113, a33
v_accvgpr_read_b32 v114, a34
v_accvgpr_read_b32 v115, a35
v_accvgpr_read_b32 v116, a48
v_accvgpr_read_b32 v117, a49
v_accvgpr_read_b32 v118, a50
v_accvgpr_read_b32 v119, a51
v_pk_mul_f32 v[112:113], v[112:113], v[124:125]
v_pk_mul_f32 v[114:115], v[114:115], v[124:125]
v_pk_mul_f32 v[116:117], v[116:117], v[124:125]
v_pk_mul_f32 v[118:119], v[118:119], v[124:125]
v_cvt_pk_bf16_f32 v12, v112, v113
v_cvt_pk_bf16_f32 v13, v114, v115
v_cvt_pk_bf16_f32 v14, v116, v117
v_cvt_pk_bf16_f32 v15, v118, v119
buffer_store_dwordx4 v[12:15], v244, s[20:23], s50 offen offset:1024 sc0 sc1
v_accvgpr_read_b32 v104, a64
v_accvgpr_read_b32 v105, a65
v_accvgpr_read_b32 v106, a66
v_accvgpr_read_b32 v107, a67
v_accvgpr_read_b32 v108, a80
v_accvgpr_read_b32 v109, a81
v_accvgpr_read_b32 v110, a82
v_accvgpr_read_b32 v111, a83
v_pk_mul_f32 v[104:105], v[104:105], v[124:125]
v_pk_mul_f32 v[106:107], v[106:107], v[124:125]
v_pk_mul_f32 v[108:109], v[108:109], v[124:125]
v_pk_mul_f32 v[110:111], v[110:111], v[124:125]
v_cvt_pk_bf16_f32 v16, v104, v105
v_cvt_pk_bf16_f32 v17, v106, v107
v_cvt_pk_bf16_f32 v18, v108, v109
v_cvt_pk_bf16_f32 v19, v110, v111
buffer_store_dwordx4 v[16:19], v244, s[20:23], s50 offen offset:2048 sc0 sc1
v_accvgpr_read_b32 v112, a96
v_accvgpr_read_b32 v113, a97
v_accvgpr_read_b32 v114, a98
v_accvgpr_read_b32 v115, a99
v_accvgpr_read_b32 v116, a112
v_accvgpr_read_b32 v117, a113
v_accvgpr_read_b32 v118, a114
v_accvgpr_read_b32 v119, a115
v_pk_mul_f32 v[112:113], v[112:113], v[124:125]
v_pk_mul_f32 v[114:115], v[114:115], v[124:125]
v_pk_mul_f32 v[116:117], v[116:117], v[124:125]
v_pk_mul_f32 v[118:119], v[118:119], v[124:125]
v_cvt_pk_bf16_f32 v20, v112, v113
v_cvt_pk_bf16_f32 v21, v114, v115
v_cvt_pk_bf16_f32 v22, v116, v117
v_cvt_pk_bf16_f32 v23, v118, v119
buffer_store_dwordx4 v[20:23], v244, s[20:23], s50 offen offset:3072 sc0 sc1
v_mfma_f32_16x16x32_bf16 a[8:11], a[176:179], v[96:99], a[8:11]
v_mfma_f32_16x16x32_bf16 a[24:27], a[180:183], v[96:99], a[24:27]
v_mfma_f32_16x16x32_bf16 a[40:43], a[184:187], v[96:99], a[40:43]
v_mfma_f32_16x16x32_bf16 a[56:59], a[188:191], v[96:99], a[56:59]
v_mfma_f32_16x16x32_bf16 a[72:75], a[192:195], v[96:99], a[72:75]
v_mfma_f32_16x16x32_bf16 a[88:91], a[196:199], v[96:99], a[88:91]
v_mfma_f32_16x16x32_bf16 a[104:107], a[200:203], v[96:99], a[104:107]
v_mfma_f32_16x16x32_bf16 a[120:123], a[204:207], v[96:99], a[120:123]
v_accvgpr_read_b32 v121, a130
v_accvgpr_read_b32 v126, a131
v_add_f32 v121, v121, v126
v_rcp_f32 v126, v121
s_add_u32 s50, s44, 4096
v_mov_b32 v127, v126
v_accvgpr_read_b32 v104, a4
v_accvgpr_read_b32 v105, a5
v_accvgpr_read_b32 v106, a6
v_accvgpr_read_b32 v107, a7
v_accvgpr_read_b32 v108, a20
v_accvgpr_read_b32 v109, a21
v_accvgpr_read_b32 v110, a22
v_accvgpr_read_b32 v111, a23
v_pk_mul_f32 v[104:105], v[104:105], v[126:127]
v_pk_mul_f32 v[106:107], v[106:107], v[126:127]
v_pk_mul_f32 v[108:109], v[108:109], v[126:127]
v_pk_mul_f32 v[110:111], v[110:111], v[126:127]
v_cvt_pk_bf16_f32 v24, v104, v105
v_cvt_pk_bf16_f32 v25, v106, v107
v_cvt_pk_bf16_f32 v26, v108, v109
v_cvt_pk_bf16_f32 v27, v110, v111
buffer_store_dwordx4 v[24:27], v244, s[20:23], s50 offen offset:0 sc0 sc1
v_accvgpr_read_b32 v112, a36
v_accvgpr_read_b32 v113, a37
v_accvgpr_read_b32 v114, a38
v_accvgpr_read_b32 v115, a39
v_accvgpr_read_b32 v116, a52
v_accvgpr_read_b32 v117, a53
v_accvgpr_read_b32 v118, a54
v_accvgpr_read_b32 v119, a55
v_pk_mul_f32 v[112:113], v[112:113], v[126:127]
v_pk_mul_f32 v[114:115], v[114:115], v[126:127]
v_pk_mul_f32 v[116:117], v[116:117], v[126:127]
v_pk_mul_f32 v[118:119], v[118:119], v[126:127]
v_cvt_pk_bf16_f32 v28, v112, v113
v_cvt_pk_bf16_f32 v29, v114, v115
v_cvt_pk_bf16_f32 v30, v116, v117
v_cvt_pk_bf16_f32 v31, v118, v119
buffer_store_dwordx4 v[28:31], v244, s[20:23], s50 offen offset:1024 sc0 sc1
v_accvgpr_read_b32 v104, a68
v_accvgpr_read_b32 v105, a69
v_accvgpr_read_b32 v106, a70
v_accvgpr_read_b32 v107, a71
v_accvgpr_read_b32 v108, a84
v_accvgpr_read_b32 v109, a85
v_accvgpr_read_b32 v110, a86
v_accvgpr_read_b32 v111, a87
v_pk_mul_f32 v[104:105], v[104:105], v[126:127]
v_pk_mul_f32 v[106:107], v[106:107], v[126:127]
v_pk_mul_f32 v[108:109], v[108:109], v[126:127]
v_pk_mul_f32 v[110:111], v[110:111], v[126:127]
v_cvt_pk_bf16_f32 v32, v104, v105
v_cvt_pk_bf16_f32 v33, v106, v107
v_cvt_pk_bf16_f32 v34, v108, v109
v_cvt_pk_bf16_f32 v35, v110, v111
buffer_store_dwordx4 v[32:35], v244, s[20:23], s50 offen offset:2048 sc0 sc1
v_accvgpr_read_b32 v112, a100
v_accvgpr_read_b32 v113, a101
v_accvgpr_read_b32 v114, a102
v_accvgpr_read_b32 v115, a103
v_accvgpr_read_b32 v116, a116
v_accvgpr_read_b32 v117, a117
v_accvgpr_read_b32 v118, a118
v_accvgpr_read_b32 v119, a119
v_pk_mul_f32 v[112:113], v[112:113], v[126:127]
v_pk_mul_f32 v[114:115], v[114:115], v[126:127]
v_pk_mul_f32 v[116:117], v[116:117], v[126:127]
v_pk_mul_f32 v[118:119], v[118:119], v[126:127]
v_cvt_pk_bf16_f32 v36, v112, v113
v_cvt_pk_bf16_f32 v37, v114, v115
v_cvt_pk_bf16_f32 v38, v116, v117
v_cvt_pk_bf16_f32 v39, v118, v119
buffer_store_dwordx4 v[36:39], v244, s[20:23], s50 offen offset:3072 sc0 sc1
v_mfma_f32_16x16x32_bf16 a[12:15], a[176:179], v[100:103], a[12:15]
v_mfma_f32_16x16x32_bf16 a[28:31], a[180:183], v[100:103], a[28:31]
v_mfma_f32_16x16x32_bf16 a[44:47], a[184:187], v[100:103], a[44:47]
v_mfma_f32_16x16x32_bf16 a[60:63], a[188:191], v[100:103], a[60:63]
v_mfma_f32_16x16x32_bf16 a[76:79], a[192:195], v[100:103], a[76:79]
v_mfma_f32_16x16x32_bf16 a[92:95], a[196:199], v[100:103], a[92:95]
v_mfma_f32_16x16x32_bf16 a[108:111], a[200:203], v[100:103], a[108:111]
v_mfma_f32_16x16x32_bf16 a[124:127], a[204:207], v[100:103], a[124:127]
v_accvgpr_read_b32 v122, a132
v_accvgpr_read_b32 v128, a133
v_add_f32 v122, v122, v128
v_rcp_f32 v128, v122
s_add_u32 s50, s44, 8192
v_mov_b32 v129, v128
v_accvgpr_read_b32 v104, a8
v_accvgpr_read_b32 v105, a9
v_accvgpr_read_b32 v106, a10
v_accvgpr_read_b32 v107, a11
v_accvgpr_read_b32 v108, a24
v_accvgpr_read_b32 v109, a25
v_accvgpr_read_b32 v110, a26
v_accvgpr_read_b32 v111, a27
v_pk_mul_f32 v[104:105], v[104:105], v[128:129]
v_pk_mul_f32 v[106:107], v[106:107], v[128:129]
v_pk_mul_f32 v[108:109], v[108:109], v[128:129]
v_pk_mul_f32 v[110:111], v[110:111], v[128:129]
v_cvt_pk_bf16_f32 v40, v104, v105
v_cvt_pk_bf16_f32 v41, v106, v107
v_cvt_pk_bf16_f32 v42, v108, v109
v_cvt_pk_bf16_f32 v43, v110, v111
buffer_store_dwordx4 v[40:43], v244, s[20:23], s50 offen offset:0 sc0 sc1
v_accvgpr_read_b32 v112, a40
v_accvgpr_read_b32 v113, a41
v_accvgpr_read_b32 v114, a42
v_accvgpr_read_b32 v115, a43
v_accvgpr_read_b32 v116, a56
v_accvgpr_read_b32 v117, a57
v_accvgpr_read_b32 v118, a58
v_accvgpr_read_b32 v119, a59
v_pk_mul_f32 v[112:113], v[112:113], v[128:129]
v_pk_mul_f32 v[114:115], v[114:115], v[128:129]
v_pk_mul_f32 v[116:117], v[116:117], v[128:129]
v_pk_mul_f32 v[118:119], v[118:119], v[128:129]
v_cvt_pk_bf16_f32 v44, v112, v113
v_cvt_pk_bf16_f32 v45, v114, v115
v_cvt_pk_bf16_f32 v46, v116, v117
v_cvt_pk_bf16_f32 v47, v118, v119
buffer_store_dwordx4 v[44:47], v244, s[20:23], s50 offen offset:1024 sc0 sc1
v_accvgpr_read_b32 v104, a72
v_accvgpr_read_b32 v105, a73
v_accvgpr_read_b32 v106, a74
v_accvgpr_read_b32 v107, a75
v_accvgpr_read_b32 v108, a88
v_accvgpr_read_b32 v109, a89
v_accvgpr_read_b32 v110, a90
v_accvgpr_read_b32 v111, a91
v_pk_mul_f32 v[104:105], v[104:105], v[128:129]
v_pk_mul_f32 v[106:107], v[106:107], v[128:129]
v_pk_mul_f32 v[108:109], v[108:109], v[128:129]
v_pk_mul_f32 v[110:111], v[110:111], v[128:129]
v_cvt_pk_bf16_f32 v48, v104, v105
v_cvt_pk_bf16_f32 v49, v106, v107
v_cvt_pk_bf16_f32 v50, v108, v109
v_cvt_pk_bf16_f32 v51, v110, v111
buffer_store_dwordx4 v[48:51], v244, s[20:23], s50 offen offset:2048 sc0 sc1
v_accvgpr_read_b32 v112, a104
v_accvgpr_read_b32 v113, a105
v_accvgpr_read_b32 v114, a106
v_accvgpr_read_b32 v115, a107
v_accvgpr_read_b32 v116, a120
v_accvgpr_read_b32 v117, a121
v_accvgpr_read_b32 v118, a122
v_accvgpr_read_b32 v119, a123
v_pk_mul_f32 v[112:113], v[112:113], v[128:129]
v_pk_mul_f32 v[114:115], v[114:115], v[128:129]
v_pk_mul_f32 v[116:117], v[116:117], v[128:129]
v_pk_mul_f32 v[118:119], v[118:119], v[128:129]
v_cvt_pk_bf16_f32 v52, v112, v113
v_cvt_pk_bf16_f32 v53, v114, v115
v_cvt_pk_bf16_f32 v54, v116, v117
v_cvt_pk_bf16_f32 v55, v118, v119
buffer_store_dwordx4 v[52:55], v244, s[20:23], s50 offen offset:3072 sc0 sc1
s_nop 7
v_accvgpr_read_b32 v123, a134
v_accvgpr_read_b32 v130, a135
v_add_f32 v123, v123, v130
v_rcp_f32 v130, v123
s_add_u32 s50, s44, 12288
v_mov_b32 v131, v130
v_accvgpr_read_b32 v104, a12
v_accvgpr_read_b32 v105, a13
v_accvgpr_read_b32 v106, a14
v_accvgpr_read_b32 v107, a15
v_accvgpr_read_b32 v108, a28
v_accvgpr_read_b32 v109, a29
v_accvgpr_read_b32 v110, a30
v_accvgpr_read_b32 v111, a31
v_pk_mul_f32 v[104:105], v[104:105], v[130:131]
v_pk_mul_f32 v[106:107], v[106:107], v[130:131]
v_pk_mul_f32 v[108:109], v[108:109], v[130:131]
v_pk_mul_f32 v[110:111], v[110:111], v[130:131]
v_cvt_pk_bf16_f32 v56, v104, v105
v_cvt_pk_bf16_f32 v57, v106, v107
v_cvt_pk_bf16_f32 v58, v108, v109
v_cvt_pk_bf16_f32 v59, v110, v111
buffer_store_dwordx4 v[56:59], v244, s[20:23], s50 offen offset:0 sc0 sc1
v_accvgpr_read_b32 v112, a44
v_accvgpr_read_b32 v113, a45
v_accvgpr_read_b32 v114, a46
v_accvgpr_read_b32 v115, a47
v_accvgpr_read_b32 v116, a60
v_accvgpr_read_b32 v117, a61
v_accvgpr_read_b32 v118, a62
v_accvgpr_read_b32 v119, a63
v_pk_mul_f32 v[112:113], v[112:113], v[130:131]
v_pk_mul_f32 v[114:115], v[114:115], v[130:131]
v_pk_mul_f32 v[116:117], v[116:117], v[130:131]
v_pk_mul_f32 v[118:119], v[118:119], v[130:131]
v_cvt_pk_bf16_f32 v60, v112, v113
v_cvt_pk_bf16_f32 v61, v114, v115
v_cvt_pk_bf16_f32 v62, v116, v117
v_cvt_pk_bf16_f32 v63, v118, v119
buffer_store_dwordx4 v[60:63], v244, s[20:23], s50 offen offset:1024 sc0 sc1
v_accvgpr_read_b32 v104, a76
v_accvgpr_read_b32 v105, a77
v_accvgpr_read_b32 v106, a78
v_accvgpr_read_b32 v107, a79
v_accvgpr_read_b32 v108, a92
v_accvgpr_read_b32 v109, a93
v_accvgpr_read_b32 v110, a94
v_accvgpr_read_b32 v111, a95
v_pk_mul_f32 v[104:105], v[104:105], v[130:131]
v_pk_mul_f32 v[106:107], v[106:107], v[130:131]
v_pk_mul_f32 v[108:109], v[108:109], v[130:131]
v_pk_mul_f32 v[110:111], v[110:111], v[130:131]
v_cvt_pk_bf16_f32 v64, v104, v105
v_cvt_pk_bf16_f32 v65, v106, v107
v_cvt_pk_bf16_f32 v66, v108, v109
v_cvt_pk_bf16_f32 v67, v110, v111
buffer_store_dwordx4 v[64:67], v244, s[20:23], s50 offen offset:2048 sc0 sc1
v_accvgpr_read_b32 v112, a108
v_accvgpr_read_b32 v113, a109
v_accvgpr_read_b32 v114, a110
v_accvgpr_read_b32 v115, a111
v_accvgpr_read_b32 v116, a124
v_accvgpr_read_b32 v117, a125
v_accvgpr_read_b32 v118, a126
v_accvgpr_read_b32 v119, a127
v_pk_mul_f32 v[112:113], v[112:113], v[130:131]
v_pk_mul_f32 v[114:115], v[114:115], v[130:131]
v_pk_mul_f32 v[116:117], v[116:117], v[130:131]
v_pk_mul_f32 v[118:119], v[118:119], v[130:131]
v_cvt_pk_bf16_f32 v68, v112, v113
v_cvt_pk_bf16_f32 v69, v114, v115
v_cvt_pk_bf16_f32 v70, v116, v117
v_cvt_pk_bf16_f32 v71, v118, v119
buffer_store_dwordx4 v[68:71], v244, s[20:23], s50 offen offset:3072 sc0 sc1
v_max3_f32 v104, v120, v121, v122
v_max_f32 v104, v104, v123
v_add_f32 v105, v120, v121
v_add_f32 v105, v105, v122
v_add_f32 v105, v105, v123
v_cmp_nge_f32 vcc, s42, v104
v_cmp_u_f32 s[28:29], v105, v105
s_or_b64 vcc, vcc, s[28:29]
s_cmp_lg_u64 vcc, 0
s_cselect_b32 s28, 1, 0
v_mov_b32 v104, s28
s_lshl_b32 s29, s37, 2
s_add_u32 s29, s29, 147968
v_mov_b32 v105, s29
v_mov_b32 v106, 147968
ds_write_b32 v105, v104
s_waitcnt vmcnt(16) lgkmcnt(0)
s_barrier
ds_read_b128 v[108:111], v106
ds_read_b64_tr_b16 a[64:65], v237 offset:0
ds_read_b64_tr_b16 a[66:67], v237 offset:4608
ds_read_b64_tr_b16 a[68:69], v237 offset:8
ds_read_b64_tr_b16 a[70:71], v237 offset:4616
ds_read_b64_tr_b16 a[72:73], v238 offset:0
ds_read_b64_tr_b16 a[74:75], v238 offset:4608
ds_read_b64_tr_b16 a[76:77], v238 offset:8
ds_read_b64_tr_b16 a[78:79], v238 offset:4616
ds_read_b64_tr_b16 a[80:81], v237 offset:128
ds_read_b64_tr_b16 a[82:83], v237 offset:4736
ds_read_b64_tr_b16 a[84:85], v237 offset:136
ds_read_b64_tr_b16 a[86:87], v237 offset:4744
ds_read_b64_tr_b16 a[88:89], v238 offset:128
ds_read_b64_tr_b16 a[90:91], v238 offset:4736
s_waitcnt lgkmcnt(14)
v_or_b32 v108, v108, v109
v_or3_b32 v108, v108, v110, v111
s_nop 0
v_readfirstlane_b32 s28, v108
s_cmp_gt_u32 s28, s43
s_cbranch_scc1 K_FALLBACK
s_waitcnt lgkmcnt(8)
v_mfma_f32_16x16x32_bf16 v[96:99], a[64:67], v[56:59], 0
ds_read_b64_tr_b16 a[92:93], v238 offset:136
ds_read_b64_tr_b16 a[94:95], v238 offset:4744
v_mfma_f32_16x16x32_bf16 v[88:91], a[64:67], v[40:43], 0
s_lshr_b32 s32, s35, 2
s_and_b32 s33, s35, 3
v_mfma_f32_16x16x32_bf16 v[80:83], a[64:67], v[24:27], 0
s_lshl_b32 s94, s36, 9
s_lshl_b32 s28, s32, 6
v_mfma_f32_16x16x32_bf16 v[72:75], a[64:67], v[8:11], 0
s_lshr_b32 s34, s32, 2
v_mfma_f32_16x16x32_bf16 v[76:79], a[68:71], v[8:11], 0
ds_read_b64_tr_b16 a[64:65], v239 offset:0
ds_read_b64_tr_b16 a[66:67], v239 offset:4608
v_mfma_f32_16x16x32_bf16 v[84:87], a[68:71], v[24:27], 0
s_add_u32 s94, s94, s28
s_lshl_b32 s28, s37, 4
v_mfma_f32_16x16x32_bf16 v[92:95], a[68:71], v[40:43], 0
s_add_u32 s94, s94, s28
s_add_u32 s94, s94, 0x248000
v_mfma_f32_16x16x32_bf16 v[100:103], a[68:71], v[56:59], 0
v_mov_b32 v231, 1
v_and_b32 v229, 7, v1
v_mfma_f32_16x16x32_bf16 v[128:131], a[72:75], v[56:59], 0
ds_read_b64_tr_b16 a[68:69], v237 offset:9216
ds_read_b64_tr_b16 a[70:71], v237 offset:13824
v_mfma_f32_16x16x32_bf16 v[120:123], a[72:75], v[40:43], 0
v_lshlrev_b32 v229, 2, v229
v_lshlrev_b32 v226, 3, v1
v_mfma_f32_16x16x32_bf16 v[112:115], a[72:75], v[24:27], 0
s_lshl2_add_u32 s29, s33, s94
v_mfma_f32_16x16x32_bf16 v[104:107], a[72:75], v[8:11], 0
s_waitcnt lgkmcnt(8)
v_mfma_f32_16x16x32_bf16 v[108:111], a[76:79], v[8:11], 0
ds_read_b64_tr_b16 a[72:73], v237 offset:9224
ds_read_b64_tr_b16 a[74:75], v237 offset:13832
v_mfma_f32_16x16x32_bf16 v[116:119], a[76:79], v[24:27], 0
v_mfma_f32_16x16x32_bf16 v[124:127], a[76:79], v[40:43], 0
v_mfma_f32_16x16x32_bf16 v[132:135], a[76:79], v[56:59], 0
v_mfma_f32_16x16x32_bf16 v[160:163], a[80:83], v[56:59], 0
ds_read_b64_tr_b16 a[76:77], v238 offset:9216
ds_read_b64_tr_b16 a[78:79], v238 offset:13824
v_mfma_f32_16x16x32_bf16 v[152:155], a[80:83], v[40:43], 0
v_mfma_f32_16x16x32_bf16 v[144:147], a[80:83], v[24:27], 0
v_mfma_f32_16x16x32_bf16 v[136:139], a[80:83], v[8:11], 0
v_mfma_f32_16x16x32_bf16 v[140:143], a[84:87], v[8:11], 0
ds_read_b64_tr_b16 a[80:81], v238 offset:9224
ds_read_b64_tr_b16 a[82:83], v238 offset:13832
v_mfma_f32_16x16x32_bf16 v[148:151], a[84:87], v[24:27], 0
s_waitcnt vmcnt(0)
buffer_store_dword v231, v254, s[20:23], s29 offen sc0 sc1
v_mfma_f32_16x16x32_bf16 v[156:159], a[84:87], v[40:43], 0
s_add_u32 s28, s35, 1
s_and_b32 s28, s28, 3
v_mfma_f32_16x16x32_bf16 v[164:167], a[84:87], v[56:59], 0
s_mul_i32 s28, s28, 36864
s_waitcnt lgkmcnt(8)
v_mfma_f32_16x16x32_bf16 v[192:195], a[88:91], v[56:59], 0
ds_read_b64_tr_b16 a[84:85], v237 offset:9344
ds_read_b64_tr_b16 a[86:87], v237 offset:13952
v_mfma_f32_16x16x32_bf16 v[184:187], a[88:91], v[40:43], 0
v_add_u32 v216, s28, v234
v_add_u32 v217, s28, v235
v_mfma_f32_16x16x32_bf16 v[176:179], a[88:91], v[24:27], 0
v_add_u32 v218, s28, v236
v_mfma_f32_16x16x32_bf16 v[168:171], a[88:91], v[8:11], 0
v_mfma_f32_16x16x32_bf16 v[172:175], a[92:95], v[8:11], 0
ds_read_b64_tr_b16 a[88:89], v237 offset:9352
ds_read_b64_tr_b16 a[90:91], v237 offset:13960
v_mfma_f32_16x16x32_bf16 v[180:183], a[92:95], v[24:27], 0
v_mfma_f32_16x16x32_bf16 v[188:191], a[92:95], v[40:43], 0
v_mfma_f32_16x16x32_bf16 v[196:199], a[92:95], v[56:59], 0
v_mfma_f32_16x16x32_bf16 v[212:215], a[64:67], v[56:59], 0
ds_read_b64_tr_b16 a[92:93], v238 offset:9344
ds_read_b64_tr_b16 a[94:95], v238 offset:13952
v_mfma_f32_16x16x32_bf16 v[208:211], a[64:67], v[40:43], 0
v_mfma_f32_16x16x32_bf16 v[204:207], a[64:67], v[24:27], 0
v_mfma_f32_16x16x32_bf16 v[200:203], a[64:67], v[8:11], 0
s_waitcnt lgkmcnt(8)
v_mfma_f32_16x16x32_bf16 v[72:75], a[68:71], v[12:15], v[72:75]
ds_read_b64_tr_b16 a[64:65], v238 offset:9352
ds_read_b64_tr_b16 a[66:67], v238 offset:13960
v_mfma_f32_16x16x32_bf16 v[80:83], a[68:71], v[28:31], v[80:83]
v_mfma_f32_16x16x32_bf16 v[88:91], a[68:71], v[44:47], v[88:91]
v_mfma_f32_16x16x32_bf16 v[96:99], a[68:71], v[60:63], v[96:99]
v_mfma_f32_16x16x32_bf16 v[100:103], a[72:75], v[60:63], v[100:103]
ds_read_b64_tr_b16 a[68:69], v239 offset:9216
ds_read_b64_tr_b16 a[70:71], v239 offset:13824
v_mfma_f32_16x16x32_bf16 v[92:95], a[72:75], v[44:47], v[92:95]
buffer_load_dword v230, v229, s[20:23], s94 offen sc0 sc1
v_mfma_f32_16x16x32_bf16 v[84:87], a[72:75], v[28:31], v[84:87]
s_add_u32 s39, s35, 1
s_and_b32 s39, s39, 3
v_mfma_f32_16x16x32_bf16 v[76:79], a[72:75], v[12:15], v[76:79]
s_add_u32 s28, s33, 1
s_and_b32 s28, s28, 3
v_mfma_f32_16x16x32_bf16 v[104:107], a[76:79], v[12:15], v[104:107]
ds_read_b64_tr_b16 a[72:73], v237 offset:18432
ds_read_b64_tr_b16 a[74:75], v237 offset:23040
v_mfma_f32_16x16x32_bf16 v[112:115], a[76:79], v[28:31], v[112:115]
s_sub_u32 s28, s28, s33
s_lshl_b32 s28, s28, 16
v_mfma_f32_16x16x32_bf16 v[120:123], a[76:79], v[44:47], v[120:123]
s_add_u32 s64, s28, s44
s_add_u32 s65, s64, 4096
v_mfma_f32_16x16x32_bf16 v[128:131], a[76:79], v[60:63], v[128:131]
s_add_u32 s66, s64, 8192
s_add_u32 s67, s64, 12288
s_waitcnt lgkmcnt(8)
v_mfma_f32_16x16x32_bf16 v[132:135], a[80:83], v[60:63], v[132:135]
ds_read_b64_tr_b16 a[76:77], v237 offset:18440
ds_read_b64_tr_b16 a[78:79], v237 offset:23048
v_mfma_f32_16x16x32_bf16 v[124:127], a[80:83], v[44:47], v[124:127]
s_add_u32 s28, s35, 2
s_and_b32 s28, s28, 3
v_mfma_f32_16x16x32_bf16 v[116:119], a[80:83], v[28:31], v[116:119]
s_mul_i32 s28, s28, 36864
v_mfma_f32_16x16x32_bf16 v[108:111], a[80:83], v[12:15], v[108:111]
v_add_u32 v219, s28, v234
v_add_u32 v220, s28, v235
v_mfma_f32_16x16x32_bf16 v[136:139], a[84:87], v[12:15], v[136:139]
ds_read_b64_tr_b16 a[80:81], v238 offset:18432
ds_read_b64_tr_b16 a[82:83], v238 offset:23040
v_mfma_f32_16x16x32_bf16 v[144:147], a[84:87], v[28:31], v[144:147]
v_add_u32 v221, s28, v236
v_mfma_f32_16x16x32_bf16 v[152:155], a[84:87], v[44:47], v[152:155]
s_add_u32 s28, s35, 3
s_and_b32 s28, s28, 3
v_mfma_f32_16x16x32_bf16 v[160:163], a[84:87], v[60:63], v[160:163]
s_mul_i32 s28, s28, 36864
v_mfma_f32_16x16x32_bf16 v[164:167], a[88:91], v[60:63], v[164:167]
ds_read_b64_tr_b16 a[84:85], v238 offset:18440
ds_read_b64_tr_b16 a[86:87], v238 offset:23048
v_mfma_f32_16x16x32_bf16 v[156:159], a[88:91], v[44:47], v[156:159]
v_add_u32 v222, s28, v234
v_add_u32 v223, s28, v235
v_mfma_f32_16x16x32_bf16 v[148:151], a[88:91], v[28:31], v[148:151]
v_add_u32 v224, s28, v236
v_mfma_f32_16x16x32_bf16 v[140:143], a[88:91], v[12:15], v[140:143]
s_waitcnt lgkmcnt(8)
v_mfma_f32_16x16x32_bf16 v[168:171], a[92:95], v[12:15], v[168:171]
ds_read_b64_tr_b16 a[88:89], v237 offset:18560
ds_read_b64_tr_b16 a[90:91], v237 offset:23168
v_mfma_f32_16x16x32_bf16 v[176:179], a[92:95], v[28:31], v[176:179]
v_mfma_f32_16x16x32_bf16 v[184:187], a[92:95], v[44:47], v[184:187]
s_waitcnt vmcnt(0)
v_cmp_gt_u32 vcc, 1, v230
v_mfma_f32_16x16x32_bf16 v[192:195], a[92:95], v[60:63], v[192:195]
v_mfma_f32_16x16x32_bf16 v[196:199], a[64:67], v[60:63], v[196:199]
ds_read_b64_tr_b16 a[92:93], v237 offset:18568
ds_read_b64_tr_b16 a[94:95], v237 offset:23176
v_mfma_f32_16x16x32_bf16 v[188:191], a[64:67], v[44:47], v[188:191]
s_bitcmp1_b32 vcc_lo, s39
s_cbranch_scc1 SP_O1B
SP_O1B_RET:
v_mfma_f32_16x16x32_bf16 v[180:183], a[64:67], v[28:31], v[180:183]
buffer_load_dwordx4 a[128:131], v244, s[20:23], s64 offen offset:0 sc0 sc1
v_mfma_f32_16x16x32_bf16 v[172:175], a[64:67], v[12:15], v[172:175]
v_mfma_f32_16x16x32_bf16 v[200:203], a[68:71], v[12:15], v[200:203]
ds_read_b64_tr_b16 a[64:65], v238 offset:18560
ds_read_b64_tr_b16 a[66:67], v238 offset:23168
v_mfma_f32_16x16x32_bf16 v[204:207], a[68:71], v[28:31], v[204:207]
v_mfma_f32_16x16x32_bf16 v[208:211], a[68:71], v[44:47], v[208:211]
buffer_load_dwordx4 a[144:147], v244, s[20:23], s65 offen offset:0 sc0 sc1
v_mfma_f32_16x16x32_bf16 v[212:215], a[68:71], v[60:63], v[212:215]
s_waitcnt lgkmcnt(8)
v_mfma_f32_16x16x32_bf16 v[96:99], a[72:75], v[64:67], v[96:99]
ds_read_b64_tr_b16 a[68:69], v238 offset:18568
ds_read_b64_tr_b16 a[70:71], v238 offset:23176
v_mfma_f32_16x16x32_bf16 v[88:91], a[72:75], v[48:51], v[88:91]
v_mfma_f32_16x16x32_bf16 v[80:83], a[72:75], v[32:35], v[80:83]
buffer_load_dwordx4 a[160:163], v244, s[20:23], s66 offen offset:0 sc0 sc1
v_mfma_f32_16x16x32_bf16 v[72:75], a[72:75], v[16:19], v[72:75]
v_mfma_f32_16x16x32_bf16 v[76:79], a[76:79], v[16:19], v[76:79]
ds_read_b64_tr_b16 a[72:73], v239 offset:18432
ds_read_b64_tr_b16 a[74:75], v239 offset:23040
v_mfma_f32_16x16x32_bf16 v[84:87], a[76:79], v[32:35], v[84:87]
v_mfma_f32_16x16x32_bf16 v[92:95], a[76:79], v[48:51], v[92:95]
buffer_load_dwordx4 a[176:179], v244, s[20:23], s67 offen offset:0 sc0 sc1
v_mfma_f32_16x16x32_bf16 v[100:103], a[76:79], v[64:67], v[100:103]
v_mfma_f32_16x16x32_bf16 v[128:131], a[80:83], v[64:67], v[128:131]
ds_read_b64_tr_b16 a[76:77], v237 offset:27648
ds_read_b64_tr_b16 a[78:79], v237 offset:32256
v_mfma_f32_16x16x32_bf16 v[120:123], a[80:83], v[48:51], v[120:123]
v_mfma_f32_16x16x32_bf16 v[112:115], a[80:83], v[32:35], v[112:115]
buffer_load_dwordx4 a[132:135], v244, s[20:23], s64 offen offset:1024 sc0 sc1
v_mfma_f32_16x16x32_bf16 v[104:107], a[80:83], v[16:19], v[104:107]
s_waitcnt lgkmcnt(8)
v_mfma_f32_16x16x32_bf16 v[108:111], a[84:87], v[16:19], v[108:111]
ds_read_b64_tr_b16 a[80:81], v237 offset:27656
ds_read_b64_tr_b16 a[82:83], v237 offset:32264
v_mfma_f32_16x16x32_bf16 v[116:119], a[84:87], v[32:35], v[116:119]
v_mfma_f32_16x16x32_bf16 v[124:127], a[84:87], v[48:51], v[124:127]
buffer_load_dwordx4 a[148:151], v244, s[20:23], s65 offen offset:1024 sc0 sc1
v_mfma_f32_16x16x32_bf16 v[132:135], a[84:87], v[64:67], v[132:135]
v_mfma_f32_16x16x32_bf16 v[160:163], a[88:91], v[64:67], v[160:163]
ds_read_b64_tr_b16 a[84:85], v238 offset:27648
ds_read_b64_tr_b16 a[86:87], v238 offset:32256
v_mfma_f32_16x16x32_bf16 v[152:155], a[88:91], v[48:51], v[152:155]
v_mfma_f32_16x16x32_bf16 v[144:147], a[88:91], v[32:35], v[144:147]
buffer_load_dwordx4 a[164:167], v244, s[20:23], s66 offen offset:1024 sc0 sc1
v_mfma_f32_16x16x32_bf16 v[136:139], a[88:91], v[16:19], v[136:139]
v_mfma_f32_16x16x32_bf16 v[140:143], a[92:95], v[16:19], v[140:143]
ds_read_b64_tr_b16 a[88:89], v238 offset:27656
ds_read_b64_tr_b16 a[90:91], v238 offset:32264
v_mfma_f32_16x16x32_bf16 v[148:151], a[92:95], v[32:35], v[148:151]
v_mfma_f32_16x16x32_bf16 v[156:159], a[92:95], v[48:51], v[156:159]
buffer_load_dwordx4 a[180:183], v244, s[20:23], s67 offen offset:1024 sc0 sc1
v_mfma_f32_16x16x32_bf16 v[164:167], a[92:95], v[64:67], v[164:167]
s_waitcnt lgkmcnt(8)
v_mfma_f32_16x16x32_bf16 v[192:195], a[64:67], v[64:67], v[192:195]
ds_read_b64_tr_b16 a[92:93], v237 offset:27776
ds_read_b64_tr_b16 a[94:95], v237 offset:32384
v_mfma_f32_16x16x32_bf16 v[184:187], a[64:67], v[48:51], v[184:187]
v_mfma_f32_16x16x32_bf16 v[176:179], a[64:67], v[32:35], v[176:179]
buffer_load_dwordx4 a[136:139], v244, s[20:23], s64 offen offset:2048 sc0 sc1
v_mfma_f32_16x16x32_bf16 v[168:171], a[64:67], v[16:19], v[168:171]
buffer_load_dword v230, v229, s[20:23], s94 offen sc0 sc1
v_mfma_f32_16x16x32_bf16 v[172:175], a[68:71], v[16:19], v[172:175]
ds_read_b64_tr_b16 a[64:65], v237 offset:27784
ds_read_b64_tr_b16 a[66:67], v237 offset:32392
v_mfma_f32_16x16x32_bf16 v[180:183], a[68:71], v[32:35], v[180:183]
v_mfma_f32_16x16x32_bf16 v[188:191], a[68:71], v[48:51], v[188:191]
v_mfma_f32_16x16x32_bf16 v[196:199], a[68:71], v[64:67], v[196:199]
buffer_load_dwordx4 a[152:155], v244, s[20:23], s65 offen offset:2048 sc0 sc1
v_mfma_f32_16x16x32_bf16 v[212:215], a[72:75], v[64:67], v[212:215]
ds_read_b64_tr_b16 a[68:69], v238 offset:27776
ds_read_b64_tr_b16 a[70:71], v238 offset:32384
v_mfma_f32_16x16x32_bf16 v[208:211], a[72:75], v[48:51], v[208:211]
v_mfma_f32_16x16x32_bf16 v[204:207], a[72:75], v[32:35], v[204:207]
v_mfma_f32_16x16x32_bf16 v[200:203], a[72:75], v[16:19], v[200:203]
buffer_load_dwordx4 a[168:171], v244, s[20:23], s66 offen offset:2048 sc0 sc1
s_waitcnt lgkmcnt(8)
v_mfma_f32_16x16x32_bf16 v[72:75], a[76:79], v[20:23], v[72:75]
ds_read_b64_tr_b16 a[72:73], v238 offset:27784
ds_read_b64_tr_b16 a[74:75], v238 offset:32392
v_mfma_f32_16x16x32_bf16 v[80:83], a[76:79], v[36:39], v[80:83]
v_mfma_f32_16x16x32_bf16 v[88:91], a[76:79], v[52:55], v[88:91]
v_mfma_f32_16x16x32_bf16 v[96:99], a[76:79], v[68:71], v[96:99]
buffer_load_dwordx4 a[184:187], v244, s[20:23], s67 offen offset:2048 sc0 sc1
v_mfma_f32_16x16x32_bf16 v[100:103], a[80:83], v[68:71], v[100:103]
ds_read_b64_tr_b16 a[76:77], v239 offset:27648
ds_read_b64_tr_b16 a[78:79], v239 offset:32256
v_mfma_f32_16x16x32_bf16 v[92:95], a[80:83], v[52:55], v[92:95]
v_mfma_f32_16x16x32_bf16 v[84:87], a[80:83], v[36:39], v[84:87]
v_mfma_f32_16x16x32_bf16 v[76:79], a[80:83], v[20:23], v[76:79]
buffer_load_dwordx4 a[140:143], v244, s[20:23], s64 offen offset:3072 sc0 sc1
v_mfma_f32_16x16x32_bf16 v[104:107], a[84:87], v[20:23], v[104:107]
ds_read_b64_tr_b16 a[80:81], v216 offset:0
ds_read_b64_tr_b16 a[82:83], v216 offset:4608
v_mfma_f32_16x16x32_bf16 v[112:115], a[84:87], v[36:39], v[112:115]
v_mfma_f32_16x16x32_bf16 v[120:123], a[84:87], v[52:55], v[120:123]
v_mfma_f32_16x16x32_bf16 v[128:131], a[84:87], v[68:71], v[128:131]
buffer_load_dwordx4 a[156:159], v244, s[20:23], s65 offen offset:3072 sc0 sc1
s_waitcnt lgkmcnt(8)
v_mfma_f32_16x16x32_bf16 v[132:135], a[88:91], v[68:71], v[132:135]
ds_read_b64_tr_b16 a[84:85], v216 offset:8
ds_read_b64_tr_b16 a[86:87], v216 offset:4616
v_mfma_f32_16x16x32_bf16 v[124:127], a[88:91], v[52:55], v[124:127]
v_mfma_f32_16x16x32_bf16 v[116:119], a[88:91], v[36:39], v[116:119]
v_mfma_f32_16x16x32_bf16 v[108:111], a[88:91], v[20:23], v[108:111]
buffer_load_dwordx4 a[172:175], v244, s[20:23], s66 offen offset:3072 sc0 sc1
v_mfma_f32_16x16x32_bf16 v[136:139], a[92:95], v[20:23], v[136:139]
ds_read_b64_tr_b16 a[88:89], v217 offset:0
ds_read_b64_tr_b16 a[90:91], v217 offset:4608
v_mfma_f32_16x16x32_bf16 v[144:147], a[92:95], v[36:39], v[144:147]
v_mfma_f32_16x16x32_bf16 v[152:155], a[92:95], v[52:55], v[152:155]
v_mfma_f32_16x16x32_bf16 v[160:163], a[92:95], v[68:71], v[160:163]
buffer_load_dwordx4 a[188:191], v244, s[20:23], s67 offen offset:3072 sc0 sc1
v_mfma_f32_16x16x32_bf16 v[164:167], a[64:67], v[68:71], v[164:167]
ds_read_b64_tr_b16 a[92:93], v217 offset:8
ds_read_b64_tr_b16 a[94:95], v217 offset:4616
v_mfma_f32_16x16x32_bf16 v[156:159], a[64:67], v[52:55], v[156:159]
s_add_u32 s28, s33, 2
s_and_b32 s28, s28, 3
v_mfma_f32_16x16x32_bf16 v[148:151], a[64:67], v[36:39], v[148:151]
s_sub_u32 s28, s28, s33
s_lshl_b32 s28, s28, 16
v_mfma_f32_16x16x32_bf16 v[140:143], a[64:67], v[20:23], v[140:143]
s_add_u32 s64, s28, s44
s_add_u32 s65, s64, 4096
s_waitcnt lgkmcnt(8)
v_mfma_f32_16x16x32_bf16 v[168:171], a[68:71], v[20:23], v[168:171]
ds_read_b64_tr_b16 a[64:65], v216 offset:128
ds_read_b64_tr_b16 a[66:67], v216 offset:4736
v_mfma_f32_16x16x32_bf16 v[176:179], a[68:71], v[36:39], v[176:179]
s_add_u32 s66, s64, 8192
s_add_u32 s67, s64, 12288
v_mfma_f32_16x16x32_bf16 v[184:187], a[68:71], v[52:55], v[184:187]
s_waitcnt vmcnt(7)
v_cmp_gt_u32 vcc, 1, v230
v_mfma_f32_16x16x32_bf16 v[192:195], a[68:71], v[68:71], v[192:195]
v_mfma_f32_16x16x32_bf16 v[196:199], a[72:75], v[68:71], v[196:199]
ds_read_b64_tr_b16 a[68:69], v216 offset:136
ds_read_b64_tr_b16 a[70:71], v216 offset:4744
v_mfma_f32_16x16x32_bf16 v[188:191], a[72:75], v[52:55], v[188:191]
s_and_b32 s29, vcc_lo, 15
s_cbranch_scc1 SP_O2B
SP_O2B_RET:
v_mfma_f32_16x16x32_bf16 v[180:183], a[72:75], v[36:39], v[180:183]
buffer_load_dwordx4 a[192:195], v244, s[20:23], s64 offen offset:0 sc0 sc1
v_mfma_f32_16x16x32_bf16 v[172:175], a[72:75], v[20:23], v[172:175]
v_mfma_f32_16x16x32_bf16 v[200:203], a[76:79], v[20:23], v[200:203]
ds_read_b64_tr_b16 a[72:73], v217 offset:128
ds_read_b64_tr_b16 a[74:75], v217 offset:4736
v_mfma_f32_16x16x32_bf16 v[204:207], a[76:79], v[36:39], v[204:207]
v_mfma_f32_16x16x32_bf16 v[208:211], a[76:79], v[52:55], v[208:211]
buffer_load_dwordx4 a[208:211], v244, s[20:23], s65 offen offset:0 sc0 sc1
v_mfma_f32_16x16x32_bf16 v[212:215], a[76:79], v[68:71], v[212:215]
s_waitcnt vmcnt(15)
s_waitcnt lgkmcnt(8)
v_mfma_f32_16x16x32_bf16 v[96:99], a[80:83], a[176:179], v[96:99]
ds_read_b64_tr_b16 a[76:77], v217 offset:136
ds_read_b64_tr_b16 a[78:79], v217 offset:4744
v_mfma_f32_16x16x32_bf16 v[88:91], a[80:83], a[160:163], v[88:91]
v_mfma_f32_16x16x32_bf16 v[80:83], a[80:83], a[144:147], v[80:83]
buffer_load_dwordx4 a[96:99], v244, s[20:23], s66 offen offset:0 sc0 sc1
v_mfma_f32_16x16x32_bf16 v[72:75], a[80:83], a[128:131], v[72:75]
v_accvgpr_read_b32 v39, a222
v_accvgpr_read_b32 v59, a232
v_mfma_f32_16x16x32_bf16 v[76:79], a[84:87], a[128:131], v[76:79]
ds_read_b64_tr_b16 a[80:81], v218 offset:0
ds_read_b64_tr_b16 a[82:83], v218 offset:4608
v_mfma_f32_16x16x32_bf16 v[84:87], a[84:87], a[144:147], v[84:87]
v_lshlrev_b32 v38, 16, v39
v_and_b32 v39, 0xffff0000, v39
v_mfma_f32_16x16x32_bf16 v[92:95], a[84:87], a[160:163], v[92:95]
buffer_load_dwordx4 a[112:115], v244, s[20:23], s67 offen offset:0 sc0 sc1
v_mfma_f32_16x16x32_bf16 v[100:103], a[84:87], a[176:179], v[100:103]
v_lshlrev_b32 v58, 16, v59
v_and_b32 v59, 0xffff0000, v59
v_mfma_f32_16x16x32_bf16 v[128:131], a[88:91], a[176:179], v[128:131]
ds_read_b64_tr_b16 a[84:85], v216 offset:9216
ds_read_b64_tr_b16 a[86:87], v216 offset:13824
v_mfma_f32_16x16x32_bf16 v[120:123], a[88:91], a[160:163], v[120:123]
v_add_f32 v38, v38, v58
v_add_f32 v39, v39, v59
v_mfma_f32_16x16x32_bf16 v[112:115], a[88:91], a[144:147], v[112:115]
buffer_load_dwordx4 a[196:199], v244, s[20:23], s64 offen offset:1024 sc0 sc1
v_mfma_f32_16x16x32_bf16 v[104:107], a[88:91], a[128:131], v[104:107]
v_cvt_pk_bf16_f32 v58, v38, v39
v_lshlrev_b32 v38, 16, v58
s_waitcnt lgkmcnt(8)
v_mfma_f32_16x16x32_bf16 v[108:111], a[92:95], a[128:131], v[108:111]
ds_read_b64_tr_b16 a[88:89], v216 offset:9224
ds_read_b64_tr_b16 a[90:91], v216 offset:13832
v_mfma_f32_16x16x32_bf16 v[116:119], a[92:95], a[144:147], v[116:119]
v_and_b32 v39, 0xffff0000, v58
v_mul_f32 v58, 0xbfb8aa3b, v38
v_mfma_f32_16x16x32_bf16 v[124:127], a[92:95], a[160:163], v[124:127]
buffer_load_dwordx4 a[244:247], v244, s[20:23], s65 offen offset:1024 sc0 sc1
v_mfma_f32_16x16x32_bf16 v[132:135], a[92:95], a[176:179], v[132:135]
v_mul_f32 v59, 0xbfb8aa3b, v39
v_mfma_f32_16x16x32_bf16 v[160:163], a[64:67], a[176:179], v[160:163]
ds_read_b64_tr_b16 a[92:93], v217 offset:9216
ds_read_b64_tr_b16 a[94:95], v217 offset:13824
v_mfma_f32_16x16x32_bf16 v[152:155], a[64:67], a[160:163], v[152:155]
v_exp_f32 v58, v58
v_mfma_f32_16x16x32_bf16 v[144:147], a[64:67], a[144:147], v[144:147]
buffer_load_dwordx4 a[100:103], v244, s[20:23], s66 offen offset:1024 sc0 sc1
v_mfma_f32_16x16x32_bf16 v[136:139], a[64:67], a[128:131], v[136:139]
v_exp_f32 v59, v59
v_mfma_f32_16x16x32_bf16 v[140:143], a[68:71], a[128:131], v[140:143]
ds_read_b64_tr_b16 a[64:65], v217 offset:9224
ds_read_b64_tr_b16 a[66:67], v217 offset:13832
v_mfma_f32_16x16x32_bf16 v[148:151], a[68:71], a[144:147], v[148:151]
v_add_f32 v58, 1.0, v58
v_add_f32 v59, 1.0, v59
v_mfma_f32_16x16x32_bf16 v[156:159], a[68:71], a[160:163], v[156:159]
buffer_load_dwordx4 a[116:119], v244, s[20:23], s67 offen offset:1024 sc0 sc1
v_mfma_f32_16x16x32_bf16 v[164:167], a[68:71], a[176:179], v[164:167]
v_rcp_f32 v58, v58
s_waitcnt lgkmcnt(8)
v_mfma_f32_16x16x32_bf16 v[192:195], a[72:75], a[176:179], v[192:195]
ds_read_b64_tr_b16 a[68:69], v216 offset:9344
ds_read_b64_tr_b16 a[70:71], v216 offset:13952
v_mfma_f32_16x16x32_bf16 v[184:187], a[72:75], a[160:163], v[184:187]
v_rcp_f32 v59, v59
v_mfma_f32_16x16x32_bf16 v[176:179], a[72:75], a[144:147], v[176:179]
buffer_load_dwordx4 a[200:203], v244, s[20:23], s64 offen offset:2048 sc0 sc1
v_mfma_f32_16x16x32_bf16 v[168:171], a[72:75], a[128:131], v[168:171]
v_mul_f32 v38, v38, v58
v_mul_f32 v39, v39, v59
v_mfma_f32_16x16x32_bf16 v[172:175], a[76:79], a[128:131], v[172:175]
ds_read_b64_tr_b16 a[72:73], v216 offset:9352
ds_read_b64_tr_b16 a[74:75], v216 offset:13960
v_mfma_f32_16x16x32_bf16 v[180:183], a[76:79], a[144:147], v[180:183]
v_cvt_pk_bf16_f32 v58, v38, v39
v_lshlrev_b32 v38, 16, v58
v_mfma_f32_16x16x32_bf16 v[188:191], a[76:79], a[160:163], v[188:191]
buffer_load_dwordx4 a[248:251], v244, s[20:23], s65 offen offset:2048 sc0 sc1
v_mfma_f32_16x16x32_bf16 v[196:199], a[76:79], a[176:179], v[196:199]
v_and_b32 v39, 0xffff0000, v58
v_accvgpr_read_b32 v41, a223
v_mfma_f32_16x16x32_bf16 v[212:215], a[80:83], a[176:179], v[212:215]
ds_read_b64_tr_b16 a[76:77], v217 offset:9344
ds_read_b64_tr_b16 a[78:79], v217 offset:13952
v_mfma_f32_16x16x32_bf16 v[208:211], a[80:83], a[160:163], v[208:211]
v_accvgpr_read_b32 v59, a233
v_lshlrev_b32 v40, 16, v41
v_mfma_f32_16x16x32_bf16 v[204:207], a[80:83], a[144:147], v[204:207]
buffer_load_dwordx4 a[104:107], v244, s[20:23], s66 offen offset:2048 sc0 sc1
v_mfma_f32_16x16x32_bf16 v[200:203], a[80:83], a[128:131], v[200:203]
v_and_b32 v41, 0xffff0000, v41
v_lshlrev_b32 v58, 16, v59
s_waitcnt vmcnt(20)
s_waitcnt lgkmcnt(8)
v_mfma_f32_16x16x32_bf16 v[72:75], a[84:87], a[132:135], v[72:75]
ds_read_b64_tr_b16 a[80:81], v217 offset:9352
ds_read_b64_tr_b16 a[82:83], v217 offset:13960
v_mfma_f32_16x16x32_bf16 v[80:83], a[84:87], a[148:151], v[80:83]
v_and_b32 v59, 0xffff0000, v59
v_add_f32 v40, v40, v58
v_mfma_f32_16x16x32_bf16 v[88:91], a[84:87], a[164:167], v[88:91]
buffer_load_dwordx4 a[120:123], v244, s[20:23], s67 offen offset:2048 sc0 sc1
v_mfma_f32_16x16x32_bf16 v[96:99], a[84:87], a[180:183], v[96:99]
v_add_f32 v41, v41, v59
v_cvt_pk_bf16_f32 v58, v40, v41
v_mfma_f32_16x16x32_bf16 v[100:103], a[88:91], a[180:183], v[100:103]
ds_read_b64_tr_b16 a[84:85], v218 offset:9216
ds_read_b64_tr_b16 a[86:87], v218 offset:13824
v_mfma_f32_16x16x32_bf16 v[92:95], a[88:91], a[164:167], v[92:95]
v_lshlrev_b32 v40, 16, v58
v_and_b32 v41, 0xffff0000, v58
v_mfma_f32_16x16x32_bf16 v[84:87], a[88:91], a[148:151], v[84:87]
buffer_load_dwordx4 a[204:207], v244, s[20:23], s64 offen offset:3072 sc0 sc1
v_mfma_f32_16x16x32_bf16 v[76:79], a[88:91], a[132:135], v[76:79]
v_mul_f32 v58, 0xbfb8aa3b, v40
v_mul_f32 v59, 0xbfb8aa3b, v41
v_mfma_f32_16x16x32_bf16 v[104:107], a[92:95], a[132:135], v[104:107]
ds_read_b64_tr_b16 a[88:89], v216 offset:18432
ds_read_b64_tr_b16 a[90:91], v216 offset:23040
v_mfma_f32_16x16x32_bf16 v[112:115], a[92:95], a[148:151], v[112:115]
v_exp_f32 v58, v58
v_mfma_f32_16x16x32_bf16 v[120:123], a[92:95], a[164:167], v[120:123]
buffer_load_dwordx4 a[252:255], v244, s[20:23], s65 offen offset:3072 sc0 sc1
v_mfma_f32_16x16x32_bf16 v[128:131], a[92:95], a[180:183], v[128:131]
v_exp_f32 v59, v59
s_waitcnt lgkmcnt(8)
v_mfma_f32_16x16x32_bf16 v[132:135], a[64:67], a[180:183], v[132:135]
ds_read_b64_tr_b16 a[92:93], v216 offset:18440
ds_read_b64_tr_b16 a[94:95], v216 offset:23048
v_mfma_f32_16x16x32_bf16 v[124:127], a[64:67], a[164:167], v[124:127]
v_add_f32 v58, 1.0, v58
v_add_f32 v59, 1.0, v59
v_mfma_f32_16x16x32_bf16 v[116:119], a[64:67], a[148:151], v[116:119]
buffer_load_dwordx4 a[108:111], v244, s[20:23], s66 offen offset:3072 sc0 sc1
v_mfma_f32_16x16x32_bf16 v[108:111], a[64:67], a[132:135], v[108:111]
v_rcp_f32 v58, v58
v_mfma_f32_16x16x32_bf16 v[136:139], a[68:71], a[132:135], v[136:139]
ds_read_b64_tr_b16 a[64:65], v217 offset:18432
ds_read_b64_tr_b16 a[66:67], v217 offset:23040
v_mfma_f32_16x16x32_bf16 v[144:147], a[68:71], a[148:151], v[144:147]
v_rcp_f32 v59, v59
v_mfma_f32_16x16x32_bf16 v[152:155], a[68:71], a[164:167], v[152:155]
buffer_load_dwordx4 a[124:127], v244, s[20:23], s67 offen offset:3072 sc0 sc1
v_mfma_f32_16x16x32_bf16 v[160:163], a[68:71], a[180:183], v[160:163]
s_add_u32 s28, s33, 3
s_and_b32 s28, s28, 3
v_mfma_f32_16x16x32_bf16 v[164:167], a[72:75], a[180:183], v[164:167]
ds_read_b64_tr_b16 a[68:69], v217 offset:18440
ds_read_b64_tr_b16 a[70:71], v217 offset:23048
v_mfma_f32_16x16x32_bf16 v[156:159], a[72:75], a[164:167], v[156:159]
s_sub_u32 s28, s28, s33
s_lshl_b32 s28, s28, 16
v_mfma_f32_16x16x32_bf16 v[148:151], a[72:75], a[148:151], v[148:151]
s_add_u32 s64, s28, s44
s_add_u32 s65, s64, 4096
v_mfma_f32_16x16x32_bf16 v[140:143], a[72:75], a[132:135], v[140:143]
s_add_u32 s66, s64, 8192
s_add_u32 s67, s64, 12288
s_waitcnt lgkmcnt(8)
v_mfma_f32_16x16x32_bf16 v[168:171], a[76:79], a[132:135], v[168:171]
ds_read_b64_tr_b16 a[72:73], v216 offset:18560
ds_read_b64_tr_b16 a[74:75], v216 offset:23168
v_mfma_f32_16x16x32_bf16 v[176:179], a[76:79], a[148:151], v[176:179]
buffer_load_dwordx4 a[0:3], v244, s[20:23], s64 offen offset:0 sc0 sc1
v_mfma_f32_16x16x32_bf16 v[184:187], a[76:79], a[164:167], v[184:187]
v_mul_f32 v40, v40, v58
v_mul_f32 v41, v41, v59
v_mfma_f32_16x16x32_bf16 v[192:195], a[76:79], a[180:183], v[192:195]
v_cvt_pk_bf16_f32 v58, v40, v41
v_lshlrev_b32 v40, 16, v58
v_mfma_f32_16x16x32_bf16 v[196:199], a[80:83], a[180:183], v[196:199]
ds_read_b64_tr_b16 a[76:77], v216 offset:18568
ds_read_b64_tr_b16 a[78:79], v216 offset:23176
v_mfma_f32_16x16x32_bf16 v[188:191], a[80:83], a[164:167], v[188:191]
buffer_load_dwordx4 a[16:19], v244, s[20:23], s65 offen offset:0 sc0 sc1
v_mfma_f32_16x16x32_bf16 v[180:183], a[80:83], a[148:151], v[180:183]
v_and_b32 v41, 0xffff0000, v58
v_accvgpr_read_b32 v43, a224
v_mfma_f32_16x16x32_bf16 v[172:175], a[80:83], a[132:135], v[172:175]
v_accvgpr_read_b32 v59, a234
v_lshlrev_b32 v42, 16, v43
v_mfma_f32_16x16x32_bf16 v[200:203], a[84:87], a[132:135], v[200:203]
ds_read_b64_tr_b16 a[80:81], v217 offset:18560
ds_read_b64_tr_b16 a[82:83], v217 offset:23168
v_mfma_f32_16x16x32_bf16 v[204:207], a[84:87], a[148:151], v[204:207]
buffer_load_dwordx4 a[32:35], v244, s[20:23], s66 offen offset:0 sc0 sc1
v_mfma_f32_16x16x32_bf16 v[208:211], a[84:87], a[164:167], v[208:211]
v_and_b32 v43, 0xffff0000, v43
v_lshlrev_b32 v58, 16, v59
v_mfma_f32_16x16x32_bf16 v[212:215], a[84:87], a[180:183], v[212:215]
v_and_b32 v59, 0xffff0000, v59
v_add_f32 v42, v42, v58
s_waitcnt vmcnt(23)
s_waitcnt lgkmcnt(8)
v_mfma_f32_16x16x32_bf16 v[96:99], a[88:91], a[184:187], v[96:99]
ds_read_b64_tr_b16 a[84:85], v217 offset:18568
ds_read_b64_tr_b16 a[86:87], v217 offset:23176
v_mfma_f32_16x16x32_bf16 v[88:91], a[88:91], a[168:171], v[88:91]
buffer_load_dwordx4 a[48:51], v244, s[20:23], s67 offen offset:0 sc0 sc1
v_mfma_f32_16x16x32_bf16 v[80:83], a[88:91], a[152:155], v[80:83]
v_add_f32 v43, v43, v59
v_cvt_pk_bf16_f32 v58, v42, v43
v_mfma_f32_16x16x32_bf16 v[72:75], a[88:91], a[136:139], v[72:75]
v_lshlrev_b32 v42, 16, v58
v_and_b32 v43, 0xffff0000, v58
v_mfma_f32_16x16x32_bf16 v[76:79], a[92:95], a[136:139], v[76:79]
ds_read_b64_tr_b16 a[88:89], v218 offset:18432
ds_read_b64_tr_b16 a[90:91], v218 offset:23040
v_mfma_f32_16x16x32_bf16 v[84:87], a[92:95], a[152:155], v[84:87]
buffer_load_dwordx4 a[4:7], v244, s[20:23], s64 offen offset:1024 sc0 sc1
v_mfma_f32_16x16x32_bf16 v[92:95], a[92:95], a[168:171], v[92:95]
v_mul_f32 v58, 0xbfb8aa3b, v42
v_mul_f32 v59, 0xbfb8aa3b, v43
v_mfma_f32_16x16x32_bf16 v[100:103], a[92:95], a[184:187], v[100:103]
v_exp_f32 v58, v58
v_mfma_f32_16x16x32_bf16 v[128:131], a[64:67], a[184:187], v[128:131]
ds_read_b64_tr_b16 a[92:93], v216 offset:27648
ds_read_b64_tr_b16 a[94:95], v216 offset:32256
v_mfma_f32_16x16x32_bf16 v[120:123], a[64:67], a[168:171], v[120:123]
buffer_load_dwordx4 a[20:23], v244, s[20:23], s65 offen offset:1024 sc0 sc1
v_mfma_f32_16x16x32_bf16 v[112:115], a[64:67], a[152:155], v[112:115]
v_exp_f32 v59, v59
v_mfma_f32_16x16x32_bf16 v[104:107], a[64:67], a[136:139], v[104:107]
v_add_f32 v58, 1.0, v58
v_add_f32 v59, 1.0, v59
s_waitcnt lgkmcnt(8)
v_mfma_f32_16x16x32_bf16 v[108:111], a[68:71], a[136:139], v[108:111]
ds_read_b64_tr_b16 a[64:65], v216 offset:27656
ds_read_b64_tr_b16 a[66:67], v216 offset:32264
v_mfma_f32_16x16x32_bf16 v[116:119], a[68:71], a[152:155], v[116:119]
buffer_load_dwordx4 a[36:39], v244, s[20:23], s66 offen offset:1024 sc0 sc1
v_mfma_f32_16x16x32_bf16 v[124:127], a[68:71], a[168:171], v[124:127]
v_rcp_f32 v58, v58
v_mfma_f32_16x16x32_bf16 v[132:135], a[68:71], a[184:187], v[132:135]
v_rcp_f32 v59, v59
v_mfma_f32_16x16x32_bf16 v[160:163], a[72:75], a[184:187], v[160:163]
ds_read_b64_tr_b16 a[68:69], v217 offset:27648
ds_read_b64_tr_b16 a[70:71], v217 offset:32256
v_mfma_f32_16x16x32_bf16 v[152:155], a[72:75], a[168:171], v[152:155]
buffer_load_dwordx4 a[52:55], v244, s[20:23], s67 offen offset:1024 sc0 sc1
v_mfma_f32_16x16x32_bf16 v[144:147], a[72:75], a[152:155], v[144:147]
v_mul_f32 v42, v42, v58
v_mul_f32 v43, v43, v59
v_mfma_f32_16x16x32_bf16 v[136:139], a[72:75], a[136:139], v[136:139]
v_cvt_pk_bf16_f32 v58, v42, v43
v_lshlrev_b32 v42, 16, v58
v_mfma_f32_16x16x32_bf16 v[140:143], a[76:79], a[136:139], v[140:143]
ds_read_b64_tr_b16 a[72:73], v217 offset:27656
ds_read_b64_tr_b16 a[74:75], v217 offset:32264
v_mfma_f32_16x16x32_bf16 v[148:151], a[76:79], a[152:155], v[148:151]
buffer_load_dwordx4 a[8:11], v244, s[20:23], s64 offen offset:2048 sc0 sc1
v_mfma_f32_16x16x32_bf16 v[156:159], a[76:79], a[168:171], v[156:159]
v_and_b32 v43, 0xffff0000, v58
v_accvgpr_read_b32 v45, a225
v_mfma_f32_16x16x32_bf16 v[164:167], a[76:79], a[184:187], v[164:167]
v_accvgpr_read_b32 v59, a235
v_lshlrev_b32 v44, 16, v45
s_waitcnt lgkmcnt(8)
v_mfma_f32_16x16x32_bf16 v[192:195], a[80:83], a[184:187], v[192:195]
ds_read_b64_tr_b16 a[76:77], v216 offset:27776
ds_read_b64_tr_b16 a[78:79], v216 offset:32384
v_mfma_f32_16x16x32_bf16 v[184:187], a[80:83], a[168:171], v[184:187]
buffer_load_dwordx4 a[24:27], v244, s[20:23], s65 offen offset:2048 sc0 sc1
v_mfma_f32_16x16x32_bf16 v[176:179], a[80:83], a[152:155], v[176:179]
v_and_b32 v45, 0xffff0000, v45
v_lshlrev_b32 v58, 16, v59
v_mfma_f32_16x16x32_bf16 v[168:171], a[80:83], a[136:139], v[168:171]
v_and_b32 v59, 0xffff0000, v59
v_add_f32 v44, v44, v58
v_mfma_f32_16x16x32_bf16 v[172:175], a[84:87], a[136:139], v[172:175]
ds_read_b64_tr_b16 a[80:81], v216 offset:27784
ds_read_b64_tr_b16 a[82:83], v216 offset:32392
v_mfma_f32_16x16x32_bf16 v[180:183], a[84:87], a[152:155], v[180:183]
buffer_load_dwordx4 a[40:43], v244, s[20:23], s66 offen offset:2048 sc0 sc1
v_mfma_f32_16x16x32_bf16 v[188:191], a[84:87], a[168:171], v[188:191]
v_add_f32 v45, v45, v59
v_cvt_pk_bf16_f32 v58, v44, v45
v_mfma_f32_16x16x32_bf16 v[196:199], a[84:87], a[184:187], v[196:199]
v_lshlrev_b32 v44, 16, v58
v_and_b32 v45, 0xffff0000, v58
v_mfma_f32_16x16x32_bf16 v[212:215], a[88:91], a[184:187], v[212:215]
ds_read_b64_tr_b16 a[84:85], v217 offset:27776
ds_read_b64_tr_b16 a[86:87], v217 offset:32384
v_mfma_f32_16x16x32_bf16 v[208:211], a[88:91], a[168:171], v[208:211]
buffer_load_dwordx4 a[56:59], v244, s[20:23], s67 offen offset:2048 sc0 sc1
v_mfma_f32_16x16x32_bf16 v[204:207], a[88:91], a[152:155], v[204:207]
v_mul_f32 v58, 0xbfb8aa3b, v44
v_mul_f32 v59, 0xbfb8aa3b, v45
v_mfma_f32_16x16x32_bf16 v[200:203], a[88:91], a[136:139], v[200:203]
v_exp_f32 v58, v58
s_waitcnt vmcnt(28)
s_waitcnt lgkmcnt(8)
v_mfma_f32_16x16x32_bf16 v[72:75], a[92:95], a[140:143], v[72:75]
ds_read_b64_tr_b16 a[88:89], v217 offset:27784
ds_read_b64_tr_b16 a[90:91], v217 offset:32392
v_mfma_f32_16x16x32_bf16 v[80:83], a[92:95], a[156:159], v[80:83]
buffer_load_dwordx4 a[12:15], v244, s[20:23], s64 offen offset:3072 sc0 sc1
v_mfma_f32_16x16x32_bf16 v[88:91], a[92:95], a[172:175], v[88:91]
v_exp_f32 v59, v59
v_mfma_f32_16x16x32_bf16 v[96:99], a[92:95], a[188:191], v[96:99]
v_add_f32 v58, 1.0, v58
v_add_f32 v59, 1.0, v59
v_mfma_f32_16x16x32_bf16 v[100:103], a[64:67], a[188:191], v[100:103]
ds_read_b64_tr_b16 a[92:93], v218 offset:27648
ds_read_b64_tr_b16 a[94:95], v218 offset:32256
v_mfma_f32_16x16x32_bf16 v[92:95], a[64:67], a[172:175], v[92:95]
buffer_load_dwordx4 a[28:31], v244, s[20:23], s65 offen offset:3072 sc0 sc1
v_mfma_f32_16x16x32_bf16 v[84:87], a[64:67], a[156:159], v[84:87]
v_rcp_f32 v58, v58
v_mfma_f32_16x16x32_bf16 v[76:79], a[64:67], a[140:143], v[76:79]
v_rcp_f32 v59, v59
v_mfma_f32_16x16x32_bf16 v[104:107], a[68:71], a[140:143], v[104:107]
ds_read_b64_tr_b16 a[64:65], v221 offset:0
ds_read_b64_tr_b16 a[66:67], v221 offset:4608
v_mfma_f32_16x16x32_bf16 v[112:115], a[68:71], a[156:159], v[112:115]
buffer_load_dwordx4 a[44:47], v244, s[20:23], s66 offen offset:3072 sc0 sc1
v_mfma_f32_16x16x32_bf16 v[120:123], a[68:71], a[172:175], v[120:123]
v_mul_f32 v44, v44, v58
v_mul_f32 v45, v45, v59
v_mfma_f32_16x16x32_bf16 v[128:131], a[68:71], a[188:191], v[128:131]
v_cvt_pk_bf16_f32 v58, v44, v45
v_lshlrev_b32 v44, 16, v58
s_waitcnt lgkmcnt(8)
v_mfma_f32_16x16x32_bf16 v[132:135], a[72:75], a[188:191], v[132:135]
ds_read_b64_tr_b16 a[68:69], v221 offset:9216
ds_read_b64_tr_b16 a[70:71], v221 offset:13824
v_mfma_f32_16x16x32_bf16 v[124:127], a[72:75], a[172:175], v[124:127]
buffer_load_dwordx4 a[60:63], v244, s[20:23], s67 offen offset:3072 sc0 sc1
v_mfma_f32_16x16x32_bf16 v[116:119], a[72:75], a[156:159], v[116:119]
s_lshl2_add_u32 s28, s36, s33
s_lshl2_add_u32 s28, s28, s37
v_mfma_f32_16x16x32_bf16 v[108:111], a[72:75], a[140:143], v[108:111]
s_lshl_b32 s95, s28, 5
s_add_u32 s95, s95, 0x24a000
v_mfma_f32_16x16x32_bf16 v[136:139], a[76:79], a[140:143], v[136:139]
ds_read_b64_tr_b16 a[72:73], v221 offset:18432
ds_read_b64_tr_b16 a[74:75], v221 offset:23040
v_mfma_f32_16x16x32_bf16 v[144:147], a[76:79], a[156:159], v[144:147]
s_lshl_b32 s28, s32, 18
s_sub_u32 s49, s44, s28
v_mfma_f32_16x16x32_bf16 v[152:155], a[76:79], a[172:175], v[152:155]
v_add_u32 v243, 0x2000, v244
v_mov_b32 v246, 2
v_mfma_f32_16x16x32_bf16 v[160:163], a[76:79], a[188:191], v[160:163]
s_lshl2_add_u32 s29, s33, s94
v_and_b32 v45, 0xffff0000, v58
v_mfma_f32_16x16x32_bf16 v[164:167], a[80:83], a[188:191], v[164:167]
ds_read_b64_tr_b16 a[76:77], v221 offset:27648
ds_read_b64_tr_b16 a[78:79], v221 offset:32256
v_mfma_f32_16x16x32_bf16 v[156:159], a[80:83], a[172:175], v[156:159]
v_accvgpr_read_b32 v47, a226
v_accvgpr_read_b32 v59, a236
v_mfma_f32_16x16x32_bf16 v[148:151], a[80:83], a[156:159], v[148:151]
v_lshlrev_b32 v46, 16, v47
v_and_b32 v47, 0xffff0000, v47
v_mfma_f32_16x16x32_bf16 v[140:143], a[80:83], a[140:143], v[140:143]
v_lshlrev_b32 v58, 16, v59
v_and_b32 v59, 0xffff0000, v59
s_waitcnt lgkmcnt(8)
v_mfma_f32_16x16x32_bf16 v[168:171], a[84:87], a[140:143], v[168:171]
ds_read_b64_tr_b16 a[80:81], v224 offset:0
ds_read_b64_tr_b16 a[82:83], v224 offset:4608
v_mfma_f32_16x16x32_bf16 v[176:179], a[84:87], a[156:159], v[176:179]
v_add_f32 v46, v46, v58
v_add_f32 v47, v47, v59
v_mfma_f32_16x16x32_bf16 v[184:187], a[84:87], a[172:175], v[184:187]
v_cvt_pk_bf16_f32 v58, v46, v47
v_lshlrev_b32 v46, 16, v58
v_mfma_f32_16x16x32_bf16 v[192:195], a[84:87], a[188:191], v[192:195]
v_and_b32 v47, 0xffff0000, v58
v_mul_f32 v58, 0xbfb8aa3b, v46
v_mfma_f32_16x16x32_bf16 v[196:199], a[88:91], a[188:191], v[196:199]
ds_read_b64_tr_b16 a[84:85], v224 offset:9216
ds_read_b64_tr_b16 a[86:87], v224 offset:13824
v_mfma_f32_16x16x32_bf16 v[188:191], a[88:91], a[172:175], v[188:191]
v_mul_f32 v59, 0xbfb8aa3b, v47
v_mfma_f32_16x16x32_bf16 v[180:183], a[88:91], a[156:159], v[180:183]
v_exp_f32 v58, v58
v_mfma_f32_16x16x32_bf16 v[172:175], a[88:91], a[140:143], v[172:175]
v_exp_f32 v59, v59
v_mfma_f32_16x16x32_bf16 v[200:203], a[92:95], a[140:143], v[200:203]
ds_read_b64_tr_b16 a[88:89], v224 offset:18432
ds_read_b64_tr_b16 a[90:91], v224 offset:23040
v_mfma_f32_16x16x32_bf16 v[204:207], a[92:95], a[156:159], v[204:207]
v_add_f32 v58, 1.0, v58
v_add_f32 v59, 1.0, v59
v_mfma_f32_16x16x32_bf16 v[208:211], a[92:95], a[172:175], v[208:211]
v_rcp_f32 v58, v58
v_mfma_f32_16x16x32_bf16 v[212:215], a[92:95], a[188:191], v[212:215]
v_rcp_f32 v59, v59
s_waitcnt vmcnt(28)
s_waitcnt lgkmcnt(8)
v_mfma_f32_16x16x32_bf16 v[212:215], a[64:67], a[112:115], v[212:215]
ds_read_b64_tr_b16 a[92:93], v224 offset:27648
ds_read_b64_tr_b16 a[94:95], v224 offset:32256
v_mfma_f32_16x16x32_bf16 v[208:211], a[64:67], a[96:99], v[208:211]
v_mul_f32 v46, v46, v58
v_mul_f32 v47, v47, v59
v_mfma_f32_16x16x32_bf16 v[204:207], a[64:67], a[208:211], v[204:207]
v_cvt_pk_bf16_f32 v58, v46, v47
v_lshlrev_b32 v46, 16, v58
v_mfma_f32_16x16x32_bf16 v[200:203], a[64:67], a[192:195], v[200:203]
v_and_b32 v47, 0xffff0000, v58
v_accvgpr_read_b32 v49, a227
s_waitcnt vmcnt(24)
v_mfma_f32_16x16x32_bf16 v[200:203], a[68:71], a[196:199], v[200:203]
ds_read_b64_tr_b16 a[64:65], v219 offset:0
ds_read_b64_tr_b16 a[66:67], v219 offset:4608
v_mfma_f32_16x16x32_bf16 v[204:207], a[68:71], a[244:247], v[204:207]
v_accvgpr_read_b32 v59, a237
v_lshlrev_b32 v48, 16, v49
v_mfma_f32_16x16x32_bf16 v[208:211], a[68:71], a[100:103], v[208:211]
v_and_b32 v49, 0xffff0000, v49
v_lshlrev_b32 v58, 16, v59
v_mfma_f32_16x16x32_bf16 v[212:215], a[68:71], a[116:119], v[212:215]
s_waitcnt vmcnt(0)
buffer_store_dword v246, v254, s[20:23], s29 offen sc0 sc1
s_waitcnt vmcnt(21)
v_mfma_f32_16x16x32_bf16 v[212:215], a[72:75], a[120:123], v[212:215]
ds_read_b64_tr_b16 a[68:69], v219 offset:9216
ds_read_b64_tr_b16 a[70:71], v219 offset:13824
v_mfma_f32_16x16x32_bf16 v[208:211], a[72:75], a[104:107], v[208:211]
s_add_u32 s28, s32, 0
s_and_b32 s28, s28, 7
v_mfma_f32_16x16x32_bf16 v[204:207], a[72:75], a[248:251], v[204:207]
s_xor_b32 s29, s28, s32
s_lshl_b32 s28, s28, 18
v_mfma_f32_16x16x32_bf16 v[200:203], a[72:75], a[200:203], v[200:203]
s_add_u32 s28, s28, s49
s_and_b32 s29, s29, 4
s_waitcnt vmcnt(17)
s_waitcnt lgkmcnt(8)
v_mfma_f32_16x16x32_bf16 v[200:203], a[76:79], a[204:207], v[200:203]
ds_read_b64_tr_b16 a[72:73], v219 offset:18432
ds_read_b64_tr_b16 a[74:75], v219 offset:23040
v_mfma_f32_16x16x32_bf16 v[204:207], a[76:79], a[252:255], v[204:207]
s_add_u32 s72, s28, 0
s_lshl_b32 s29, s29, 10
v_mfma_f32_16x16x32_bf16 v[208:211], a[76:79], a[108:111], v[208:211]
s_add_u32 s28, s32, 1
s_and_b32 s28, s28, 7
v_mfma_f32_16x16x32_bf16 v[212:215], a[76:79], a[124:127], v[212:215]
s_xor_b32 s29, s28, s32
s_lshl_b32 s28, s28, 18
s_waitcnt vmcnt(13)
v_mfma_f32_16x16x32_bf16 v[212:215], a[80:83], a[48:51], v[212:215]
ds_read_b64_tr_b16 a[76:77], v219 offset:27648
ds_read_b64_tr_b16 a[78:79], v219 offset:32256
v_mfma_f32_16x16x32_bf16 v[208:211], a[80:83], a[32:35], v[208:211]
s_add_u32 s28, s28, s49
s_and_b32 s29, s29, 4
v_mfma_f32_16x16x32_bf16 v[204:207], a[80:83], a[16:19], v[204:207]
s_add_u32 s73, s28, 8192
s_lshl_b32 s29, s29, 10
v_mfma_f32_16x16x32_bf16 v[200:203], a[80:83], a[0:3], v[200:203]
s_add_u32 s65, s28, s29
v_and_b32 v59, 0xffff0000, v59
s_waitcnt vmcnt(9)
v_mfma_f32_16x16x32_bf16 v[200:203], a[84:87], a[4:7], v[200:203]
ds_read_b64_tr_b16 a[80:81], v222 offset:0
ds_read_b64_tr_b16 a[82:83], v222 offset:4608
v_mfma_f32_16x16x32_bf16 v[204:207], a[84:87], a[20:23], v[204:207]
s_add_u32 s28, s32, 2
s_and_b32 s28, s28, 7
v_mfma_f32_16x16x32_bf16 v[208:211], a[84:87], a[36:39], v[208:211]
s_xor_b32 s29, s28, s32
s_lshl_b32 s28, s28, 18
v_mfma_f32_16x16x32_bf16 v[212:215], a[84:87], a[52:55], v[212:215]
s_add_u32 s28, s28, s49
s_and_b32 s29, s29, 4
s_waitcnt vmcnt(5)
s_waitcnt lgkmcnt(8)
v_mfma_f32_16x16x32_bf16 v[212:215], a[88:91], a[56:59], v[212:215]
ds_read_b64_tr_b16 a[84:85], v222 offset:9216
ds_read_b64_tr_b16 a[86:87], v222 offset:13824
v_mfma_f32_16x16x32_bf16 v[208:211], a[88:91], a[40:43], v[208:211]
s_add_u32 s74, s28, 8192
s_lshl_b32 s29, s29, 10
v_mfma_f32_16x16x32_bf16 v[204:207], a[88:91], a[24:27], v[204:207]
s_add_u32 s66, s28, s29
v_add_f32 v48, v48, v58
v_mfma_f32_16x16x32_bf16 v[200:203], a[88:91], a[8:11], v[200:203]
s_add_u32 s28, s32, 3
s_and_b32 s28, s28, 7
s_waitcnt vmcnt(1)
v_mfma_f32_16x16x32_bf16 v[200:203], a[92:95], a[12:15], v[200:203]
ds_read_b64_tr_b16 a[88:89], v222 offset:18432
ds_read_b64_tr_b16 a[90:91], v222 offset:23040
v_mfma_f32_16x16x32_bf16 v[204:207], a[92:95], a[28:31], v[204:207]
s_xor_b32 s29, s28, s32
s_lshl_b32 s28, s28, 18
v_mfma_f32_16x16x32_bf16 v[208:211], a[92:95], a[44:47], v[208:211]
s_add_u32 s28, s28, s49
s_and_b32 s29, s29, 4
v_mfma_f32_16x16x32_bf16 v[212:215], a[92:95], a[60:63], v[212:215]
s_add_u32 s75, s28, 0
s_lshl_b32 s29, s29, 10
v_mfma_f32_16x16x32_bf16 v[96:99], a[64:67], a[112:115], v[96:99]
ds_read_b64_tr_b16 a[92:93], v222 offset:27648
ds_read_b64_tr_b16 a[94:95], v222 offset:32256
v_mfma_f32_16x16x32_bf16 v[88:91], a[64:67], a[96:99], v[88:91]
s_add_u32 s67, s28, s29
v_add_f32 v49, v49, v59
v_mfma_f32_16x16x32_bf16 v[80:83], a[64:67], a[208:211], v[80:83]
buffer_load_dword v230, v229, s[20:23], s94 offen sc0 sc1
v_mfma_f32_16x16x32_bf16 v[72:75], a[64:67], a[192:195], v[72:75]
s_add_u32 s28, s32, 4
s_and_b32 s28, s28, 7
s_waitcnt lgkmcnt(8)
v_mfma_f32_16x16x32_bf16 v[72:75], a[68:71], a[196:199], v[72:75]
ds_read_b64_tr_b16 a[64:65], v219 offset:8
ds_read_b64_tr_b16 a[66:67], v219 offset:4616
v_mfma_f32_16x16x32_bf16 v[80:83], a[68:71], a[244:247], v[80:83]
s_xor_b32 s29, s28, s32
s_lshl_b32 s28, s28, 18
v_mfma_f32_16x16x32_bf16 v[88:91], a[68:71], a[100:103], v[88:91]
s_add_u32 s28, s28, s49
s_and_b32 s29, s29, 4
v_mfma_f32_16x16x32_bf16 v[96:99], a[68:71], a[116:119], v[96:99]
s_add_u32 s84, s28, 0
s_lshl_b32 s29, s29, 10
v_mfma_f32_16x16x32_bf16 v[96:99], a[72:75], a[120:123], v[96:99]
ds_read_b64_tr_b16 a[68:69], v219 offset:9224
ds_read_b64_tr_b16 a[70:71], v219 offset:13832
v_mfma_f32_16x16x32_bf16 v[88:91], a[72:75], a[104:107], v[88:91]
s_add_u32 s68, s28, s29
v_cvt_pk_bf16_f32 v58, v48, v49
v_mfma_f32_16x16x32_bf16 v[80:83], a[72:75], a[248:251], v[80:83]
s_add_u32 s28, s32, 5
s_and_b32 s28, s28, 7
v_mfma_f32_16x16x32_bf16 v[72:75], a[72:75], a[200:203], v[72:75]
s_xor_b32 s29, s28, s32
s_lshl_b32 s28, s28, 18
v_mfma_f32_16x16x32_bf16 v[72:75], a[76:79], a[204:207], v[72:75]
ds_read_b64_tr_b16 a[72:73], v219 offset:18440
ds_read_b64_tr_b16 a[74:75], v219 offset:23048
v_mfma_f32_16x16x32_bf16 v[80:83], a[76:79], a[252:255], v[80:83]
s_add_u32 s28, s28, s49
s_and_b32 s29, s29, 4
v_mfma_f32_16x16x32_bf16 v[88:91], a[76:79], a[108:111], v[88:91]
s_add_u32 s85, s28, 8192
s_lshl_b32 s29, s29, 10
v_mfma_f32_16x16x32_bf16 v[96:99], a[76:79], a[124:127], v[96:99]
s_add_u32 s69, s28, s29
v_lshlrev_b32 v48, 16, v58
s_waitcnt lgkmcnt(8)
v_mfma_f32_16x16x32_bf16 v[96:99], a[80:83], a[48:51], v[96:99]
ds_read_b64_tr_b16 a[76:77], v219 offset:27656
ds_read_b64_tr_b16 a[78:79], v219 offset:32264
v_mfma_f32_16x16x32_bf16 v[88:91], a[80:83], a[32:35], v[88:91]
s_add_u32 s28, s32, 6
s_and_b32 s28, s28, 7
v_mfma_f32_16x16x32_bf16 v[80:83], a[80:83], a[16:19], v[80:83]
s_xor_b32 s29, s28, s32
s_lshl_b32 s28, s28, 18
v_mfma_f32_16x16x32_bf16 v[72:75], a[80:83], a[0:3], v[72:75]
s_add_u32 s28, s28, s49
s_and_b32 s29, s29, 4
v_mfma_f32_16x16x32_bf16 v[72:75], a[84:87], a[4:7], v[72:75]
ds_read_b64_tr_b16 a[80:81], v222 offset:8
ds_read_b64_tr_b16 a[82:83], v222 offset:4616
v_mfma_f32_16x16x32_bf16 v[80:83], a[84:87], a[20:23], v[80:83]
s_add_u32 s86, s28, 8192
s_lshl_b32 s29, s29, 10
v_mfma_f32_16x16x32_bf16 v[88:91], a[84:87], a[36:39], v[88:91]
s_add_u32 s70, s28, s29
v_and_b32 v49, 0xffff0000, v58
v_mfma_f32_16x16x32_bf16 v[96:99], a[84:87], a[52:55], v[96:99]
s_add_u32 s28, s32, 7
s_and_b32 s28, s28, 7
v_mfma_f32_16x16x32_bf16 v[96:99], a[88:91], a[56:59], v[96:99]
ds_read_b64_tr_b16 a[84:85], v222 offset:9224
ds_read_b64_tr_b16 a[86:87], v222 offset:13832
v_mfma_f32_16x16x32_bf16 v[88:91], a[88:91], a[40:43], v[88:91]
s_xor_b32 s29, s28, s32
s_lshl_b32 s28, s28, 18
v_mfma_f32_16x16x32_bf16 v[80:83], a[88:91], a[24:27], v[80:83]
s_add_u32 s28, s28, s49
s_and_b32 s29, s29, 4
v_mfma_f32_16x16x32_bf16 v[72:75], a[88:91], a[8:11], v[72:75]
s_add_u32 s87, s28, 0
s_lshl_b32 s29, s29, 10
s_waitcnt lgkmcnt(8)
v_mfma_f32_16x16x32_bf16 v[72:75], a[92:95], a[12:15], v[72:75]
ds_read_b64_tr_b16 a[88:89], v222 offset:18440
ds_read_b64_tr_b16 a[90:91], v222 offset:23048
v_mfma_f32_16x16x32_bf16 v[80:83], a[92:95], a[28:31], v[80:83]
s_add_u32 s71, s28, s29
v_mul_f32 v58, 0xbfb8aa3b, v48
v_mfma_f32_16x16x32_bf16 v[88:91], a[92:95], a[44:47], v[88:91]
s_waitcnt vmcnt(0)
v_cmp_gt_u32 vcc, 2, v230
v_mfma_f32_16x16x32_bf16 v[96:99], a[92:95], a[60:63], v[96:99]
v_mul_f32 v59, 0xbfb8aa3b, v49
v_mfma_f32_16x16x32_bf16 v[100:103], a[64:67], a[112:115], v[100:103]
ds_read_b64_tr_b16 a[92:93], v222 offset:27656
ds_read_b64_tr_b16 a[94:95], v222 offset:32264
v_mfma_f32_16x16x32_bf16 v[92:95], a[64:67], a[96:99], v[92:95]
s_and_b32 s29, vcc_lo, 15
s_cbranch_scc1 SP_O3B
SP_O3B_RET:
v_mfma_f32_16x16x32_bf16 v[84:87], a[64:67], a[208:211], v[84:87]
s_add_u32 s39, s44, 8192
v_mfma_f32_16x16x32_bf16 v[76:79], a[64:67], a[192:195], v[76:79]
v_cvt_pk_bf16_f32 v200, v200, v201
v_cvt_pk_bf16_f32 v201, v202, v203
v_mfma_f32_16x16x32_bf16 v[76:79], a[68:71], a[196:199], v[76:79]
ds_read_b64_tr_b16 a[64:65], v220 offset:0
ds_read_b64_tr_b16 a[66:67], v220 offset:4608
v_mfma_f32_16x16x32_bf16 v[84:87], a[68:71], a[244:247], v[84:87]
buffer_store_dwordx2 v[200:201], v226, s[20:23], s44 offen offset:0 sc0 sc1
v_mfma_f32_16x16x32_bf16 v[92:95], a[68:71], a[100:103], v[92:95]
v_cvt_pk_bf16_f32 v204, v204, v205
v_cvt_pk_bf16_f32 v205, v206, v207
v_mfma_f32_16x16x32_bf16 v[100:103], a[68:71], a[116:119], v[100:103]
buffer_store_dwordx2 v[204:205], v226, s[20:23], s44 offen offset:512 sc0 sc1
s_waitcnt lgkmcnt(8)
v_mfma_f32_16x16x32_bf16 v[100:103], a[72:75], a[120:123], v[100:103]
ds_read_b64_tr_b16 a[68:69], v220 offset:9216
ds_read_b64_tr_b16 a[70:71], v220 offset:13824
v_mfma_f32_16x16x32_bf16 v[92:95], a[72:75], a[104:107], v[92:95]
v_cvt_pk_bf16_f32 v208, v208, v209
v_cvt_pk_bf16_f32 v209, v210, v211
v_mfma_f32_16x16x32_bf16 v[84:87], a[72:75], a[248:251], v[84:87]
buffer_store_dwordx2 v[208:209], v226, s[20:23], s39 offen offset:0 sc0 sc1
v_mfma_f32_16x16x32_bf16 v[76:79], a[72:75], a[200:203], v[76:79]
v_cvt_pk_bf16_f32 v212, v212, v213
v_cvt_pk_bf16_f32 v213, v214, v215
v_mfma_f32_16x16x32_bf16 v[76:79], a[76:79], a[204:207], v[76:79]
ds_read_b64_tr_b16 a[72:73], v220 offset:18432
ds_read_b64_tr_b16 a[74:75], v220 offset:23040
v_mfma_f32_16x16x32_bf16 v[84:87], a[76:79], a[252:255], v[84:87]
buffer_store_dwordx2 v[212:213], v226, s[20:23], s39 offen offset:512 sc0 sc1
v_mfma_f32_16x16x32_bf16 v[92:95], a[76:79], a[108:111], v[92:95]
v_exp_f32 v58, v58
v_mfma_f32_16x16x32_bf16 v[100:103], a[76:79], a[124:127], v[100:103]
v_exp_f32 v59, v59
v_mfma_f32_16x16x32_bf16 v[100:103], a[80:83], a[48:51], v[100:103]
ds_read_b64_tr_b16 a[76:77], v220 offset:27648
ds_read_b64_tr_b16 a[78:79], v220 offset:32256
v_mfma_f32_16x16x32_bf16 v[92:95], a[80:83], a[32:35], v[92:95]
v_add_f32 v58, 1.0, v58
v_add_f32 v59, 1.0, v59
v_mfma_f32_16x16x32_bf16 v[84:87], a[80:83], a[16:19], v[84:87]
v_rcp_f32 v58, v58
v_mfma_f32_16x16x32_bf16 v[76:79], a[80:83], a[0:3], v[76:79]
v_rcp_f32 v59, v59
s_waitcnt lgkmcnt(8)
v_mfma_f32_16x16x32_bf16 v[76:79], a[84:87], a[4:7], v[76:79]
ds_read_b64_tr_b16 a[80:81], v223 offset:0
ds_read_b64_tr_b16 a[82:83], v223 offset:4608
v_mfma_f32_16x16x32_bf16 v[84:87], a[84:87], a[20:23], v[84:87]
v_mul_f32 v48, v48, v58
v_mul_f32 v49, v49, v59
v_mfma_f32_16x16x32_bf16 v[92:95], a[84:87], a[36:39], v[92:95]
v_cvt_pk_bf16_f32 v58, v48, v49
v_lshlrev_b32 v48, 16, v58
v_mfma_f32_16x16x32_bf16 v[100:103], a[84:87], a[52:55], v[100:103]
v_and_b32 v49, 0xffff0000, v58
v_accvgpr_read_b32 v51, a228
v_mfma_f32_16x16x32_bf16 v[100:103], a[88:91], a[56:59], v[100:103]
ds_read_b64_tr_b16 a[84:85], v223 offset:9216
ds_read_b64_tr_b16 a[86:87], v223 offset:13824
v_mfma_f32_16x16x32_bf16 v[92:95], a[88:91], a[40:43], v[92:95]
v_accvgpr_read_b32 v59, a238
v_lshlrev_b32 v50, 16, v51
v_mfma_f32_16x16x32_bf16 v[84:87], a[88:91], a[24:27], v[84:87]
v_and_b32 v51, 0xffff0000, v51
v_lshlrev_b32 v58, 16, v59
v_mfma_f32_16x16x32_bf16 v[76:79], a[88:91], a[8:11], v[76:79]
v_and_b32 v59, 0xffff0000, v59
v_add_f32 v50, v50, v58
v_mfma_f32_16x16x32_bf16 v[76:79], a[92:95], a[12:15], v[76:79]
ds_read_b64_tr_b16 a[88:89], v223 offset:18432
ds_read_b64_tr_b16 a[90:91], v223 offset:23040
v_mfma_f32_16x16x32_bf16 v[84:87], a[92:95], a[28:31], v[84:87]
v_add_f32 v51, v51, v59
v_cvt_pk_bf16_f32 v58, v50, v51
v_mfma_f32_16x16x32_bf16 v[92:95], a[92:95], a[44:47], v[92:95]
v_lshlrev_b32 v50, 16, v58
v_and_b32 v51, 0xffff0000, v58
v_mfma_f32_16x16x32_bf16 v[100:103], a[92:95], a[60:63], v[100:103]
v_mul_f32 v58, 0xbfb8aa3b, v50
v_mul_f32 v59, 0xbfb8aa3b, v51
s_waitcnt lgkmcnt(8)
v_mfma_f32_16x16x32_bf16 v[128:131], a[64:67], a[112:115], v[128:131]
ds_read_b64_tr_b16 a[92:93], v223 offset:27648
ds_read_b64_tr_b16 a[94:95], v223 offset:32256
v_mfma_f32_16x16x32_bf16 v[120:123], a[64:67], a[96:99], v[120:123]
v_exp_f32 v58, v58
v_mfma_f32_16x16x32_bf16 v[112:115], a[64:67], a[208:211], v[112:115]
v_exp_f32 v59, v59
v_mfma_f32_16x16x32_bf16 v[104:107], a[64:67], a[192:195], v[104:107]
v_add_f32 v58, 1.0, v58
v_add_f32 v59, 1.0, v59
v_mfma_f32_16x16x32_bf16 v[104:107], a[68:71], a[196:199], v[104:107]
ds_read_b64_tr_b16 a[64:65], v220 offset:8
ds_read_b64_tr_b16 a[66:67], v220 offset:4616
v_mfma_f32_16x16x32_bf16 v[112:115], a[68:71], a[244:247], v[112:115]
v_rcp_f32 v58, v58
v_mfma_f32_16x16x32_bf16 v[120:123], a[68:71], a[100:103], v[120:123]
v_rcp_f32 v59, v59
v_mfma_f32_16x16x32_bf16 v[128:131], a[68:71], a[116:119], v[128:131]
v_mul_f32 v50, v50, v58
v_mul_f32 v51, v51, v59
v_mfma_f32_16x16x32_bf16 v[128:131], a[72:75], a[120:123], v[128:131]
ds_read_b64_tr_b16 a[68:69], v220 offset:9224
ds_read_b64_tr_b16 a[70:71], v220 offset:13832
v_mfma_f32_16x16x32_bf16 v[120:123], a[72:75], a[104:107], v[120:123]
s_add_u32 s39, s44, 0
v_cvt_pk_bf16_f32 v58, v50, v51
v_mfma_f32_16x16x32_bf16 v[112:115], a[72:75], a[248:251], v[112:115]
v_cvt_pk_bf16_f32 v80, v80, v81
v_cvt_pk_bf16_f32 v81, v82, v83
v_mfma_f32_16x16x32_bf16 v[104:107], a[72:75], a[200:203], v[104:107]
v_cvt_pk_bf16_f32 v82, v84, v85
v_cvt_pk_bf16_f32 v83, v86, v87
s_waitcnt lgkmcnt(8)
v_mfma_f32_16x16x32_bf16 v[104:107], a[76:79], a[204:207], v[104:107]
ds_read_b64_tr_b16 a[72:73], v220 offset:18440
ds_read_b64_tr_b16 a[74:75], v220 offset:23048
v_mfma_f32_16x16x32_bf16 v[112:115], a[76:79], a[252:255], v[112:115]
buffer_store_dwordx4 v[80:83], v244, s[20:23], s39 offen offset:1024 sc0 sc1
v_mfma_f32_16x16x32_bf16 v[120:123], a[76:79], a[108:111], v[120:123]
v_cvt_pk_bf16_f32 v88, v88, v89
v_cvt_pk_bf16_f32 v89, v90, v91
v_mfma_f32_16x16x32_bf16 v[128:131], a[76:79], a[124:127], v[128:131]
v_cvt_pk_bf16_f32 v90, v92, v93
v_cvt_pk_bf16_f32 v91, v94, v95
v_mfma_f32_16x16x32_bf16 v[128:131], a[80:83], a[48:51], v[128:131]
ds_read_b64_tr_b16 a[76:77], v220 offset:27656
ds_read_b64_tr_b16 a[78:79], v220 offset:32264
v_mfma_f32_16x16x32_bf16 v[120:123], a[80:83], a[32:35], v[120:123]
buffer_store_dwordx4 v[88:91], v244, s[20:23], s39 offen offset:2048 sc0 sc1
v_mfma_f32_16x16x32_bf16 v[112:115], a[80:83], a[16:19], v[112:115]
v_cvt_pk_bf16_f32 v96, v96, v97
v_cvt_pk_bf16_f32 v97, v98, v99
v_mfma_f32_16x16x32_bf16 v[104:107], a[80:83], a[0:3], v[104:107]
v_cvt_pk_bf16_f32 v98, v100, v101
v_cvt_pk_bf16_f32 v99, v102, v103
v_mfma_f32_16x16x32_bf16 v[104:107], a[84:87], a[4:7], v[104:107]
ds_read_b64_tr_b16 a[80:81], v223 offset:8
ds_read_b64_tr_b16 a[82:83], v223 offset:4616
v_mfma_f32_16x16x32_bf16 v[112:115], a[84:87], a[20:23], v[112:115]
buffer_store_dwordx4 v[96:99], v244, s[20:23], s39 offen offset:3072 sc0 sc1
v_mfma_f32_16x16x32_bf16 v[120:123], a[84:87], a[36:39], v[120:123]
v_lshlrev_b32 v50, 16, v58
v_and_b32 v51, 0xffff0000, v58
v_mfma_f32_16x16x32_bf16 v[128:131], a[84:87], a[52:55], v[128:131]
v_accvgpr_read_b32 v53, a229
v_accvgpr_read_b32 v59, a239
s_waitcnt lgkmcnt(8)
v_mfma_f32_16x16x32_bf16 v[128:131], a[88:91], a[56:59], v[128:131]
ds_read_b64_tr_b16 a[84:85], v223 offset:9224
ds_read_b64_tr_b16 a[86:87], v223 offset:13832
v_mfma_f32_16x16x32_bf16 v[120:123], a[88:91], a[40:43], v[120:123]
v_lshlrev_b32 v52, 16, v53
v_and_b32 v53, 0xffff0000, v53
v_mfma_f32_16x16x32_bf16 v[112:115], a[88:91], a[24:27], v[112:115]
v_lshlrev_b32 v58, 16, v59
v_and_b32 v59, 0xffff0000, v59
v_mfma_f32_16x16x32_bf16 v[104:107], a[88:91], a[8:11], v[104:107]
v_add_f32 v52, v52, v58
v_add_f32 v53, v53, v59
v_mfma_f32_16x16x32_bf16 v[104:107], a[92:95], a[12:15], v[104:107]
ds_read_b64_tr_b16 a[88:89], v223 offset:18440
ds_read_b64_tr_b16 a[90:91], v223 offset:23048
v_mfma_f32_16x16x32_bf16 v[112:115], a[92:95], a[28:31], v[112:115]
v_cvt_pk_bf16_f32 v58, v52, v53
v_lshlrev_b32 v52, 16, v58
v_mfma_f32_16x16x32_bf16 v[120:123], a[92:95], a[44:47], v[120:123]
v_and_b32 v53, 0xffff0000, v58
v_mul_f32 v58, 0xbfb8aa3b, v52
v_mfma_f32_16x16x32_bf16 v[128:131], a[92:95], a[60:63], v[128:131]
v_mul_f32 v59, 0xbfb8aa3b, v53
v_mfma_f32_16x16x32_bf16 v[132:135], a[64:67], a[112:115], v[132:135]
ds_read_b64_tr_b16 a[92:93], v223 offset:27656
ds_read_b64_tr_b16 a[94:95], v223 offset:32264
v_mfma_f32_16x16x32_bf16 v[124:127], a[64:67], a[96:99], v[124:127]
v_exp_f32 v58, v58
v_mfma_f32_16x16x32_bf16 v[116:119], a[64:67], a[208:211], v[116:119]
v_exp_f32 v59, v59
v_mfma_f32_16x16x32_bf16 v[108:111], a[64:67], a[192:195], v[108:111]
v_add_f32 v58, 1.0, v58
v_add_f32 v59, 1.0, v59
s_waitcnt lgkmcnt(8)
v_mfma_f32_16x16x32_bf16 v[108:111], a[68:71], a[196:199], v[108:111]
ds_read_b64_tr_b16 a[64:65], v219 offset:128
ds_read_b64_tr_b16 a[66:67], v219 offset:4736
v_mfma_f32_16x16x32_bf16 v[116:119], a[68:71], a[244:247], v[116:119]
v_rcp_f32 v58, v58
v_mfma_f32_16x16x32_bf16 v[124:127], a[68:71], a[100:103], v[124:127]
v_rcp_f32 v59, v59
v_mfma_f32_16x16x32_bf16 v[132:135], a[68:71], a[116:119], v[132:135]
v_mul_f32 v52, v52, v58
v_mul_f32 v53, v53, v59
v_mfma_f32_16x16x32_bf16 v[132:135], a[72:75], a[120:123], v[132:135]
ds_read_b64_tr_b16 a[68:69], v219 offset:9344
ds_read_b64_tr_b16 a[70:71], v219 offset:13952
v_mfma_f32_16x16x32_bf16 v[124:127], a[72:75], a[104:107], v[124:127]
v_cvt_pk_bf16_f32 v58, v52, v53
v_lshlrev_b32 v52, 16, v58
v_mfma_f32_16x16x32_bf16 v[116:119], a[72:75], a[248:251], v[116:119]
v_and_b32 v53, 0xffff0000, v58
v_accvgpr_read_b32 v55, a230
v_mfma_f32_16x16x32_bf16 v[108:111], a[72:75], a[200:203], v[108:111]
v_accvgpr_read_b32 v59, a240
v_lshlrev_b32 v54, 16, v55
v_mfma_f32_16x16x32_bf16 v[108:111], a[76:79], a[204:207], v[108:111]
ds_read_b64_tr_b16 a[72:73], v219 offset:18560
ds_read_b64_tr_b16 a[74:75], v219 offset:23168
v_mfma_f32_16x16x32_bf16 v[116:119], a[76:79], a[252:255], v[116:119]
v_and_b32 v55, 0xffff0000, v55
v_lshlrev_b32 v58, 16, v59
v_mfma_f32_16x16x32_bf16 v[124:127], a[76:79], a[108:111], v[124:127]
v_and_b32 v59, 0xffff0000, v59
v_add_f32 v54, v54, v58
v_mfma_f32_16x16x32_bf16 v[132:135], a[76:79], a[124:127], v[132:135]
v_add_f32 v55, v55, v59
v_cvt_pk_bf16_f32 v58, v54, v55
s_waitcnt lgkmcnt(8)
v_mfma_f32_16x16x32_bf16 v[132:135], a[80:83], a[48:51], v[132:135]
ds_read_b64_tr_b16 a[76:77], v219 offset:27776
ds_read_b64_tr_b16 a[78:79], v219 offset:32384
v_mfma_f32_16x16x32_bf16 v[124:127], a[80:83], a[32:35], v[124:127]
v_lshlrev_b32 v54, 16, v58
v_and_b32 v55, 0xffff0000, v58
v_mfma_f32_16x16x32_bf16 v[116:119], a[80:83], a[16:19], v[116:119]
v_mul_f32 v58, 0xbfb8aa3b, v54
v_mul_f32 v59, 0xbfb8aa3b, v55
v_mfma_f32_16x16x32_bf16 v[108:111], a[80:83], a[0:3], v[108:111]
v_exp_f32 v58, v58
v_mfma_f32_16x16x32_bf16 v[108:111], a[84:87], a[4:7], v[108:111]
ds_read_b64_tr_b16 a[80:81], v222 offset:128
ds_read_b64_tr_b16 a[82:83], v222 offset:4736
v_mfma_f32_16x16x32_bf16 v[116:119], a[84:87], a[20:23], v[116:119]
v_exp_f32 v59, v59
v_mfma_f32_16x16x32_bf16 v[124:127], a[84:87], a[36:39], v[124:127]
v_add_f32 v58, 1.0, v58
v_add_f32 v59, 1.0, v59
v_mfma_f32_16x16x32_bf16 v[132:135], a[84:87], a[52:55], v[132:135]
v_rcp_f32 v58, v58
v_mfma_f32_16x16x32_bf16 v[132:135], a[88:91], a[56:59], v[132:135]
ds_read_b64_tr_b16 a[84:85], v222 offset:9344
ds_read_b64_tr_b16 a[86:87], v222 offset:13952
v_mfma_f32_16x16x32_bf16 v[124:127], a[88:91], a[40:43], v[124:127]
v_rcp_f32 v59, v59
v_mfma_f32_16x16x32_bf16 v[116:119], a[88:91], a[24:27], v[116:119]
v_mul_f32 v54, v54, v58
v_mul_f32 v55, v55, v59
v_mfma_f32_16x16x32_bf16 v[108:111], a[88:91], a[8:11], v[108:111]
v_cvt_pk_bf16_f32 v58, v54, v55
v_lshlrev_b32 v54, 16, v58
s_waitcnt lgkmcnt(8)
v_mfma_f32_16x16x32_bf16 v[108:111], a[92:95], a[12:15], v[108:111]
ds_read_b64_tr_b16 a[88:89], v222 offset:18560
ds_read_b64_tr_b16 a[90:91], v222 offset:23168
v_mfma_f32_16x16x32_bf16 v[116:119], a[92:95], a[28:31], v[116:119]
v_and_b32 v55, 0xffff0000, v58
v_accvgpr_read_b32 v57, a231
v_mfma_f32_16x16x32_bf16 v[124:127], a[92:95], a[44:47], v[124:127]
v_accvgpr_read_b32 v59, a241
v_lshlrev_b32 v56, 16, v57
v_mfma_f32_16x16x32_bf16 v[132:135], a[92:95], a[60:63], v[132:135]
v_and_b32 v57, 0xffff0000, v57
v_lshlrev_b32 v58, 16, v59
v_mfma_f32_16x16x32_bf16 v[160:163], a[64:67], a[112:115], v[160:163]
ds_read_b64_tr_b16 a[92:93], v222 offset:27776
ds_read_b64_tr_b16 a[94:95], v222 offset:32384
v_mfma_f32_16x16x32_bf16 v[152:155], a[64:67], a[96:99], v[152:155]
v_and_b32 v59, 0xffff0000, v59
v_add_f32 v56, v56, v58
v_mfma_f32_16x16x32_bf16 v[144:147], a[64:67], a[208:211], v[144:147]
v_add_f32 v57, v57, v59
v_cvt_pk_bf16_f32 v58, v56, v57
v_mfma_f32_16x16x32_bf16 v[136:139], a[64:67], a[192:195], v[136:139]
v_lshlrev_b32 v56, 16, v58
v_and_b32 v57, 0xffff0000, v58
v_mfma_f32_16x16x32_bf16 v[136:139], a[68:71], a[196:199], v[136:139]
ds_read_b64_tr_b16 a[64:65], v219 offset:136
ds_read_b64_tr_b16 a[66:67], v219 offset:4744
v_mfma_f32_16x16x32_bf16 v[144:147], a[68:71], a[244:247], v[144:147]
v_mul_f32 v58, 0xbfb8aa3b, v56
v_mul_f32 v59, 0xbfb8aa3b, v57
v_mfma_f32_16x16x32_bf16 v[152:155], a[68:71], a[100:103], v[152:155]
v_exp_f32 v58, v58
v_mfma_f32_16x16x32_bf16 v[160:163], a[68:71], a[116:119], v[160:163]
v_exp_f32 v59, v59
s_waitcnt lgkmcnt(8)
v_mfma_f32_16x16x32_bf16 v[160:163], a[72:75], a[120:123], v[160:163]
ds_read_b64_tr_b16 a[68:69], v219 offset:9352
ds_read_b64_tr_b16 a[70:71], v219 offset:13960
v_mfma_f32_16x16x32_bf16 v[152:155], a[72:75], a[104:107], v[152:155]
s_add_u32 s39, s44, 4096
v_add_f32 v58, 1.0, v58
v_mfma_f32_16x16x32_bf16 v[144:147], a[72:75], a[248:251], v[144:147]
v_cvt_pk_bf16_f32 v104, v104, v105
v_cvt_pk_bf16_f32 v105, v106, v107
v_mfma_f32_16x16x32_bf16 v[136:139], a[72:75], a[200:203], v[136:139]
v_cvt_pk_bf16_f32 v106, v108, v109
v_cvt_pk_bf16_f32 v107, v110, v111
v_mfma_f32_16x16x32_bf16 v[136:139], a[76:79], a[204:207], v[136:139]
ds_read_b64_tr_b16 a[72:73], v219 offset:18568
ds_read_b64_tr_b16 a[74:75], v219 offset:23176
v_mfma_f32_16x16x32_bf16 v[144:147], a[76:79], a[252:255], v[144:147]
buffer_store_dwordx4 v[104:107], v244, s[20:23], s39 offen offset:0 sc0 sc1
v_mfma_f32_16x16x32_bf16 v[152:155], a[76:79], a[108:111], v[152:155]
v_cvt_pk_bf16_f32 v112, v112, v113
v_cvt_pk_bf16_f32 v113, v114, v115
v_mfma_f32_16x16x32_bf16 v[160:163], a[76:79], a[124:127], v[160:163]
v_cvt_pk_bf16_f32 v114, v116, v117
v_cvt_pk_bf16_f32 v115, v118, v119
v_mfma_f32_16x16x32_bf16 v[160:163], a[80:83], a[48:51], v[160:163]
ds_read_b64_tr_b16 a[76:77], v219 offset:27784
ds_read_b64_tr_b16 a[78:79], v219 offset:32392
v_mfma_f32_16x16x32_bf16 v[152:155], a[80:83], a[32:35], v[152:155]
buffer_store_dwordx4 v[112:115], v244, s[20:23], s39 offen offset:1024 sc0 sc1
v_mfma_f32_16x16x32_bf16 v[144:147], a[80:83], a[16:19], v[144:147]
v_cvt_pk_bf16_f32 v120, v120, v121
v_cvt_pk_bf16_f32 v121, v122, v123
v_mfma_f32_16x16x32_bf16 v[136:139], a[80:83], a[0:3], v[136:139]
v_cvt_pk_bf16_f32 v122, v124, v125
v_cvt_pk_bf16_f32 v123, v126, v127
s_waitcnt lgkmcnt(8)
v_mfma_f32_16x16x32_bf16 v[136:139], a[84:87], a[4:7], v[136:139]
ds_read_b64_tr_b16 a[80:81], v222 offset:136
ds_read_b64_tr_b16 a[82:83], v222 offset:4744
v_mfma_f32_16x16x32_bf16 v[144:147], a[84:87], a[20:23], v[144:147]
buffer_store_dwordx4 v[120:123], v244, s[20:23], s39 offen offset:2048 sc0 sc1
v_mfma_f32_16x16x32_bf16 v[152:155], a[84:87], a[36:39], v[152:155]
v_cvt_pk_bf16_f32 v128, v128, v129
v_cvt_pk_bf16_f32 v129, v130, v131
v_mfma_f32_16x16x32_bf16 v[160:163], a[84:87], a[52:55], v[160:163]
v_cvt_pk_bf16_f32 v130, v132, v133
v_cvt_pk_bf16_f32 v131, v134, v135
v_mfma_f32_16x16x32_bf16 v[160:163], a[88:91], a[56:59], v[160:163]
ds_read_b64_tr_b16 a[84:85], v222 offset:9352
ds_read_b64_tr_b16 a[86:87], v222 offset:13960
v_mfma_f32_16x16x32_bf16 v[152:155], a[88:91], a[40:43], v[152:155]
buffer_store_dwordx4 v[128:131], v244, s[20:23], s39 offen offset:3072 sc0 sc1
v_mfma_f32_16x16x32_bf16 v[144:147], a[88:91], a[24:27], v[144:147]
s_lshl2_add_u32 s28, s32, s95
v_add_f32 v59, 1.0, v59
v_mfma_f32_16x16x32_bf16 v[136:139], a[88:91], a[8:11], v[136:139]
v_rcp_f32 v58, v58
v_mfma_f32_16x16x32_bf16 v[136:139], a[92:95], a[12:15], v[136:139]
ds_read_b64_tr_b16 a[88:89], v222 offset:18568
ds_read_b64_tr_b16 a[90:91], v222 offset:23176
v_mfma_f32_16x16x32_bf16 v[144:147], a[92:95], a[28:31], v[144:147]
v_rcp_f32 v59, v59
v_mfma_f32_16x16x32_bf16 v[152:155], a[92:95], a[44:47], v[152:155]
v_mul_f32 v56, v56, v58
v_mul_f32 v57, v57, v59
v_mfma_f32_16x16x32_bf16 v[160:163], a[92:95], a[60:63], v[160:163]
v_cvt_pk_bf16_f32 v58, v56, v57
v_lshlrev_b32 v56, 16, v58
s_waitcnt lgkmcnt(8)
v_mfma_f32_16x16x32_bf16 v[164:167], a[64:67], a[112:115], v[164:167]
ds_read_b64_tr_b16 a[92:93], v222 offset:27784
ds_read_b64_tr_b16 a[94:95], v222 offset:32392
v_mfma_f32_16x16x32_bf16 v[156:159], a[64:67], a[96:99], v[156:159]
v_and_b32 v57, 0xffff0000, v58
v_accvgpr_read_b32 v19, a212
v_mfma_f32_16x16x32_bf16 v[148:151], a[64:67], a[208:211], v[148:151]
v_lshlrev_b32 v18, 16, v19
v_and_b32 v19, 0xffff0000, v19
v_mfma_f32_16x16x32_bf16 v[140:143], a[64:67], a[192:195], v[140:143]
v_accvgpr_read_b32 v21, a213
v_lshlrev_b32 v20, 16, v21
v_mfma_f32_16x16x32_bf16 v[140:143], a[68:71], a[196:199], v[140:143]
ds_read_b64_tr_b16 a[64:65], v220 offset:128
ds_read_b64_tr_b16 a[66:67], v220 offset:4736
v_mfma_f32_16x16x32_bf16 v[148:151], a[68:71], a[244:247], v[148:151]
v_and_b32 v21, 0xffff0000, v21
v_accvgpr_read_b32 v23, a214
v_mfma_f32_16x16x32_bf16 v[156:159], a[68:71], a[100:103], v[156:159]
v_lshlrev_b32 v22, 16, v23
v_and_b32 v23, 0xffff0000, v23
v_mfma_f32_16x16x32_bf16 v[164:167], a[68:71], a[116:119], v[164:167]
v_accvgpr_read_b32 v25, a215
v_lshlrev_b32 v24, 16, v25
v_mfma_f32_16x16x32_bf16 v[164:167], a[72:75], a[120:123], v[164:167]
ds_read_b64_tr_b16 a[68:69], v220 offset:9344
ds_read_b64_tr_b16 a[70:71], v220 offset:13952
v_mfma_f32_16x16x32_bf16 v[156:159], a[72:75], a[104:107], v[156:159]
v_and_b32 v25, 0xffff0000, v25
v_accvgpr_read_b32 v27, a216
v_mfma_f32_16x16x32_bf16 v[148:151], a[72:75], a[248:251], v[148:151]
v_lshlrev_b32 v26, 16, v27
v_and_b32 v27, 0xffff0000, v27
v_mfma_f32_16x16x32_bf16 v[140:143], a[72:75], a[200:203], v[140:143]
v_accvgpr_read_b32 v29, a217
v_lshlrev_b32 v28, 16, v29
s_waitcnt lgkmcnt(8)
v_mfma_f32_16x16x32_bf16 v[140:143], a[76:79], a[204:207], v[140:143]
ds_read_b64_tr_b16 a[72:73], v220 offset:18560
ds_read_b64_tr_b16 a[74:75], v220 offset:23168
v_mfma_f32_16x16x32_bf16 v[148:151], a[76:79], a[252:255], v[148:151]
v_and_b32 v29, 0xffff0000, v29
v_accvgpr_read_b32 v31, a218
v_mfma_f32_16x16x32_bf16 v[156:159], a[76:79], a[108:111], v[156:159]
v_lshlrev_b32 v30, 16, v31
v_and_b32 v31, 0xffff0000, v31
v_mfma_f32_16x16x32_bf16 v[164:167], a[76:79], a[124:127], v[164:167]
v_accvgpr_read_b32 v33, a219
v_lshlrev_b32 v32, 16, v33
v_mfma_f32_16x16x32_bf16 v[164:167], a[80:83], a[48:51], v[164:167]
ds_read_b64_tr_b16 a[76:77], v220 offset:27776
ds_read_b64_tr_b16 a[78:79], v220 offset:32384
v_mfma_f32_16x16x32_bf16 v[156:159], a[80:83], a[32:35], v[156:159]
v_and_b32 v33, 0xffff0000, v33
v_accvgpr_read_b32 v35, a220
v_mfma_f32_16x16x32_bf16 v[148:151], a[80:83], a[16:19], v[148:151]
s_waitcnt vmcnt(0)
buffer_store_dword v231, v254, s[20:23], s28 offen sc0 sc1
v_mfma_f32_16x16x32_bf16 v[140:143], a[80:83], a[0:3], v[140:143]
v_lshlrev_b32 v34, 16, v35
v_and_b32 v35, 0xffff0000, v35
v_mfma_f32_16x16x32_bf16 v[140:143], a[84:87], a[4:7], v[140:143]
ds_read_b64_tr_b16 a[80:81], v223 offset:128
ds_read_b64_tr_b16 a[82:83], v223 offset:4736
v_mfma_f32_16x16x32_bf16 v[148:151], a[84:87], a[20:23], v[148:151]
v_accvgpr_read_b32 v37, a221
v_lshlrev_b32 v36, 16, v37
v_mfma_f32_16x16x32_bf16 v[156:159], a[84:87], a[36:39], v[156:159]
v_and_b32 v37, 0xffff0000, v37
v_mfma_f32_16x16x32_bf16 v[164:167], a[84:87], a[52:55], v[164:167]
s_mov_b32 s90, 0x3f80
s_mov_b32 s91, 0x3f800000
s_waitcnt lgkmcnt(8)
v_mfma_f32_16x16x32_bf16 v[164:167], a[88:91], a[56:59], v[164:167]
ds_read_b64_tr_b16 a[84:85], v223 offset:9344
ds_read_b64_tr_b16 a[86:87], v223 offset:13952
v_mfma_f32_16x16x32_bf16 v[156:159], a[88:91], a[40:43], v[156:159]
v_mov_b32 v66, 0
v_mov_b32 v67, 0
v_mfma_f32_16x16x32_bf16 v[148:151], a[88:91], a[24:27], v[148:151]
v_mov_b32 v68, 0
v_mov_b32 v69, 0
v_mfma_f32_16x16x32_bf16 v[140:143], a[88:91], a[8:11], v[140:143]
v_mfma_f32_16x16x32_bf16 v[140:143], a[92:95], a[12:15], v[140:143]
ds_read_b64_tr_b16 a[88:89], v223 offset:18560
ds_read_b64_tr_b16 a[90:91], v223 offset:23168
v_mfma_f32_16x16x32_bf16 v[148:151], a[92:95], a[28:31], v[148:151]
v_mfma_f32_16x16x32_bf16 v[156:159], a[92:95], a[44:47], v[156:159]
v_mfma_f32_16x16x32_bf16 v[164:167], a[92:95], a[60:63], v[164:167]
v_mfma_f32_16x16x32_bf16 v[192:195], a[64:67], a[112:115], v[192:195]
ds_read_b64_tr_b16 a[92:93], v223 offset:27776
ds_read_b64_tr_b16 a[94:95], v223 offset:32384
v_mfma_f32_16x16x32_bf16 v[184:187], a[64:67], a[96:99], v[184:187]
v_mfma_f32_16x16x32_bf16 v[176:179], a[64:67], a[208:211], v[176:179]
v_mfma_f32_16x16x32_bf16 v[168:171], a[64:67], a[192:195], v[168:171]
s_waitcnt lgkmcnt(8)
v_mfma_f32_16x16x32_bf16 v[168:171], a[68:71], a[196:199], v[168:171]
ds_read_b64_tr_b16 a[64:65], v220 offset:136
ds_read_b64_tr_b16 a[66:67], v220 offset:4744
v_mfma_f32_16x16x32_bf16 v[176:179], a[68:71], a[244:247], v[176:179]
v_mfma_f32_16x16x32_bf16 v[184:187], a[68:71], a[100:103], v[184:187]
v_mfma_f32_16x16x32_bf16 v[192:195], a[68:71], a[116:119], v[192:195]
v_mfma_f32_16x16x32_bf16 v[192:195], a[72:75], a[120:123], v[192:195]
ds_read_b64_tr_b16 a[68:69], v220 offset:9352
ds_read_b64_tr_b16 a[70:71], v220 offset:13960
v_mfma_f32_16x16x32_bf16 v[184:187], a[72:75], a[104:107], v[184:187]
s_add_u32 s39, s44, 8192
v_mfma_f32_16x16x32_bf16 v[176:179], a[72:75], a[248:251], v[176:179]
v_cvt_pk_bf16_f32 v144, v144, v145
v_cvt_pk_bf16_f32 v145, v146, v147
v_mfma_f32_16x16x32_bf16 v[168:171], a[72:75], a[200:203], v[168:171]
v_cvt_pk_bf16_f32 v146, v148, v149
v_cvt_pk_bf16_f32 v147, v150, v151
v_mfma_f32_16x16x32_bf16 v[168:171], a[76:79], a[204:207], v[168:171]
ds_read_b64_tr_b16 a[72:73], v220 offset:18568
ds_read_b64_tr_b16 a[74:75], v220 offset:23176
v_mfma_f32_16x16x32_bf16 v[176:179], a[76:79], a[252:255], v[176:179]
buffer_store_dwordx4 v[144:147], v244, s[20:23], s39 offen offset:1024 sc0 sc1
v_mfma_f32_16x16x32_bf16 v[184:187], a[76:79], a[108:111], v[184:187]
v_cvt_pk_bf16_f32 v152, v152, v153
v_cvt_pk_bf16_f32 v153, v154, v155
v_mfma_f32_16x16x32_bf16 v[192:195], a[76:79], a[124:127], v[192:195]
v_cvt_pk_bf16_f32 v154, v156, v157
v_cvt_pk_bf16_f32 v155, v158, v159
s_waitcnt lgkmcnt(8)
v_mfma_f32_16x16x32_bf16 v[192:195], a[80:83], a[48:51], v[192:195]
ds_read_b64_tr_b16 a[76:77], v220 offset:27784
ds_read_b64_tr_b16 a[78:79], v220 offset:32392
v_mfma_f32_16x16x32_bf16 v[184:187], a[80:83], a[32:35], v[184:187]
buffer_store_dwordx4 v[152:155], v244, s[20:23], s39 offen offset:2048 sc0 sc1
v_mfma_f32_16x16x32_bf16 v[176:179], a[80:83], a[16:19], v[176:179]
v_cvt_pk_bf16_f32 v160, v160, v161
v_cvt_pk_bf16_f32 v161, v162, v163
v_mfma_f32_16x16x32_bf16 v[168:171], a[80:83], a[0:3], v[168:171]
v_cvt_pk_bf16_f32 v162, v164, v165
v_cvt_pk_bf16_f32 v163, v166, v167
v_mfma_f32_16x16x32_bf16 v[168:171], a[84:87], a[4:7], v[168:171]
ds_read_b64_tr_b16 a[80:81], v223 offset:136
ds_read_b64_tr_b16 a[82:83], v223 offset:4744
v_mfma_f32_16x16x32_bf16 v[176:179], a[84:87], a[20:23], v[176:179]
buffer_store_dwordx4 v[160:163], v244, s[20:23], s39 offen offset:3072 sc0 sc1
v_mfma_f32_16x16x32_bf16 v[184:187], a[84:87], a[36:39], v[184:187]
buffer_load_dword v230, v229, s[20:23], s95 offen sc0 sc1
v_mfma_f32_16x16x32_bf16 v[192:195], a[84:87], a[52:55], v[192:195]
v_mfma_f32_16x16x32_bf16 v[192:195], a[88:91], a[56:59], v[192:195]
ds_read_b64_tr_b16 a[84:85], v223 offset:9352
ds_read_b64_tr_b16 a[86:87], v223 offset:13960
v_mfma_f32_16x16x32_bf16 v[184:187], a[88:91], a[40:43], v[184:187]
v_mfma_f32_16x16x32_bf16 v[176:179], a[88:91], a[24:27], v[176:179]
v_mfma_f32_16x16x32_bf16 v[168:171], a[88:91], a[8:11], v[168:171]
s_waitcnt lgkmcnt(8)
v_mfma_f32_16x16x32_bf16 v[168:171], a[92:95], a[12:15], v[168:171]
ds_read_b64_tr_b16 a[88:89], v223 offset:18568
ds_read_b64_tr_b16 a[90:91], v223 offset:23176
v_mfma_f32_16x16x32_bf16 v[176:179], a[92:95], a[28:31], v[176:179]
v_mfma_f32_16x16x32_bf16 v[184:187], a[92:95], a[44:47], v[184:187]
v_mfma_f32_16x16x32_bf16 v[192:195], a[92:95], a[60:63], v[192:195]
v_mfma_f32_16x16x32_bf16 v[196:199], a[64:67], a[112:115], v[196:199]
ds_read_b64_tr_b16 a[92:93], v223 offset:27784
ds_read_b64_tr_b16 a[94:95], v223 offset:32392
v_mfma_f32_16x16x32_bf16 v[188:191], a[64:67], a[96:99], v[188:191]
v_mfma_f32_16x16x32_bf16 v[180:183], a[64:67], a[208:211], v[180:183]
v_mfma_f32_16x16x32_bf16 v[172:175], a[64:67], a[192:195], v[172:175]
v_mfma_f32_16x16x32_bf16 v[172:175], a[68:71], a[196:199], v[172:175]
v_mfma_f32_16x16x32_bf16 v[180:183], a[68:71], a[244:247], v[180:183]
v_mfma_f32_16x16x32_bf16 v[188:191], a[68:71], a[100:103], v[188:191]
v_mfma_f32_16x16x32_bf16 v[196:199], a[68:71], a[116:119], v[196:199]
s_waitcnt lgkmcnt(8)
v_mfma_f32_16x16x32_bf16 v[196:199], a[72:75], a[120:123], v[196:199]
v_mfma_f32_16x16x32_bf16 v[188:191], a[72:75], a[104:107], v[188:191]
v_mfma_f32_16x16x32_bf16 v[180:183], a[72:75], a[248:251], v[180:183]
v_mfma_f32_16x16x32_bf16 v[172:175], a[72:75], a[200:203], v[172:175]
v_mfma_f32_16x16x32_bf16 v[172:175], a[76:79], a[204:207], v[172:175]
v_mfma_f32_16x16x32_bf16 v[180:183], a[76:79], a[252:255], v[180:183]
v_mfma_f32_16x16x32_bf16 v[188:191], a[76:79], a[108:111], v[188:191]
s_waitcnt vmcnt(0)
v_cmp_gt_u32 vcc, 1, v230
v_mfma_f32_16x16x32_bf16 v[196:199], a[76:79], a[124:127], v[196:199]
s_waitcnt lgkmcnt(6)
v_mfma_f32_16x16x32_bf16 v[196:199], a[80:83], a[48:51], v[196:199]
s_and_b32 s29, vcc_lo, 0xff
s_cbranch_scc1 SP_P1B
SP_P1B_RET:
v_mfma_f32_16x16x32_bf16 v[188:191], a[80:83], a[32:35], v[188:191]
buffer_load_dwordx4 v[104:107], v244, s[20:23], s65 offen offset:3072 sc0 sc1
v_mfma_f32_16x16x32_bf16 v[180:183], a[80:83], a[16:19], v[180:183]
buffer_load_dwordx4 v[108:111], v244, s[20:23], s66 offen offset:2048 sc0 sc1
v_mfma_f32_16x16x32_bf16 v[172:175], a[80:83], a[0:3], v[172:175]
buffer_load_dwordx4 v[112:115], v244, s[20:23], s67 offen offset:1024 sc0 sc1
s_waitcnt lgkmcnt(4)
v_mfma_f32_16x16x32_bf16 v[172:175], a[84:87], a[4:7], v[172:175]
buffer_load_dwordx4 v[116:119], v244, s[20:23], s68 offen offset:0 sc0 sc1
v_mfma_f32_16x16x32_bf16 v[180:183], a[84:87], a[20:23], v[180:183]
buffer_load_dwordx4 v[120:123], v244, s[20:23], s69 offen offset:3072 sc0 sc1
v_mfma_f32_16x16x32_bf16 v[188:191], a[84:87], a[36:39], v[188:191]
buffer_load_dwordx4 v[124:127], v244, s[20:23], s70 offen offset:2048 sc0 sc1
v_mfma_f32_16x16x32_bf16 v[196:199], a[84:87], a[52:55], v[196:199]
buffer_load_dwordx4 v[128:131], v244, s[20:23], s71 offen offset:1024 sc0 sc1
s_waitcnt lgkmcnt(2)
v_mfma_f32_16x16x32_bf16 v[196:199], a[88:91], a[56:59], v[196:199]
v_mfma_f32_16x16x32_bf16 v[188:191], a[88:91], a[40:43], v[188:191]
v_mfma_f32_16x16x32_bf16 v[180:183], a[88:91], a[24:27], v[180:183]
v_mfma_f32_16x16x32_bf16 v[172:175], a[88:91], a[8:11], v[172:175]
s_waitcnt lgkmcnt(0)
v_mfma_f32_16x16x32_bf16 v[172:175], a[92:95], a[12:15], v[172:175]
v_mfma_f32_16x16x32_bf16 v[180:183], a[92:95], a[28:31], v[180:183]
v_mfma_f32_16x16x32_bf16 v[188:191], a[92:95], a[44:47], v[188:191]
v_mfma_f32_16x16x32_bf16 v[196:199], a[92:95], a[60:63], v[196:199]
s_add_u32 s39, s44, 12288
s_nop 5
v_cvt_pk_bf16_f32 v168, v168, v169
v_cvt_pk_bf16_f32 v169, v170, v171
v_cvt_pk_bf16_f32 v170, v172, v173
v_cvt_pk_bf16_f32 v171, v174, v175
buffer_store_dwordx4 v[168:171], v244, s[20:23], s39 offen offset:0 sc0 sc1
v_cvt_pk_bf16_f32 v176, v176, v177
v_cvt_pk_bf16_f32 v177, v178, v179
v_cvt_pk_bf16_f32 v178, v180, v181
v_cvt_pk_bf16_f32 v179, v182, v183
buffer_store_dwordx4 v[176:179], v244, s[20:23], s39 offen offset:1024 sc0 sc1
v_cvt_pk_bf16_f32 v184, v184, v185
v_cvt_pk_bf16_f32 v185, v186, v187
v_cvt_pk_bf16_f32 v186, v188, v189
v_cvt_pk_bf16_f32 v187, v190, v191
buffer_store_dwordx4 v[184:187], v244, s[20:23], s39 offen offset:2048 sc0 sc1
v_cvt_pk_bf16_f32 v192, v192, v193
v_cvt_pk_bf16_f32 v193, v194, v195
v_cvt_pk_bf16_f32 v194, v196, v197
v_cvt_pk_bf16_f32 v195, v198, v199
buffer_store_dwordx4 v[192:195], v244, s[20:23], s39 offen offset:3072 sc0 sc1
buffer_load_dwordx2 v[200:201], v226, s[20:23], s72 offen offset:0 sc0 sc1
buffer_load_dwordx2 v[202:203], v226, s[20:23], s73 offen offset:512 sc0 sc1
buffer_load_dwordx2 v[204:205], v226, s[20:23], s74 offen offset:0 sc0 sc1
buffer_load_dwordx2 v[206:207], v226, s[20:23], s75 offen offset:512 sc0 sc1
buffer_load_dwordx2 v[208:209], v226, s[20:23], s84 offen offset:0 sc0 sc1
buffer_load_dwordx2 v[210:211], v226, s[20:23], s85 offen offset:512 sc0 sc1
buffer_load_dwordx2 v[212:213], v226, s[20:23], s86 offen offset:0 sc0 sc1
buffer_load_dwordx2 v[214:215], v226, s[20:23], s87 offen offset:512 sc0 sc1
s_waitcnt vmcnt(8)
buffer_store_dword v246, v254, s[20:23], s28 offen sc0 sc1
buffer_load_dword v230, v229, s[20:23], s95 offen sc0 sc1
s_waitcnt vmcnt(20)
v_dot2c_f32_bf16 v72, s90, v104
v_dot2c_f32_bf16 v73, s91, v104
v_dot2c_f32_bf16 v74, s90, v105
v_dot2c_f32_bf16 v75, s91, v105
v_dot2c_f32_bf16 v76, s90, v106
v_dot2c_f32_bf16 v77, s91, v106
v_dot2c_f32_bf16 v78, s90, v107
v_dot2c_f32_bf16 v79, s91, v107
s_waitcnt vmcnt(19)
v_dot2c_f32_bf16 v72, s90, v108
v_dot2c_f32_bf16 v73, s91, v108
v_dot2c_f32_bf16 v74, s90, v109
v_dot2c_f32_bf16 v75, s91, v109
v_dot2c_f32_bf16 v76, s90, v110
v_dot2c_f32_bf16 v77, s91, v110
v_dot2c_f32_bf16 v78, s90, v111
v_dot2c_f32_bf16 v79, s91, v111
s_waitcnt vmcnt(18)
v_dot2c_f32_bf16 v72, s90, v112
v_dot2c_f32_bf16 v73, s91, v112
v_dot2c_f32_bf16 v74, s90, v113
v_dot2c_f32_bf16 v75, s91, v113
v_dot2c_f32_bf16 v76, s90, v114
v_dot2c_f32_bf16 v77, s91, v114
v_dot2c_f32_bf16 v78, s90, v115
v_dot2c_f32_bf16 v79, s91, v115
s_waitcnt vmcnt(17)
v_dot2c_f32_bf16 v72, s90, v116
v_dot2c_f32_bf16 v73, s91, v116
v_dot2c_f32_bf16 v74, s90, v117
v_dot2c_f32_bf16 v75, s91, v117
v_dot2c_f32_bf16 v76, s90, v118
v_dot2c_f32_bf16 v77, s91, v118
v_dot2c_f32_bf16 v78, s90, v119
v_dot2c_f32_bf16 v79, s91, v119
s_waitcnt vmcnt(16)
v_dot2c_f32_bf16 v72, s90, v120
v_dot2c_f32_bf16 v73, s91, v120
v_dot2c_f32_bf16 v74, s90, v121
v_dot2c_f32_bf16 v75, s91, v121
v_dot2c_f32_bf16 v76, s90, v122
v_dot2c_f32_bf16 v77, s91, v122
v_dot2c_f32_bf16 v78, s90, v123
v_dot2c_f32_bf16 v79, s91, v123
s_waitcnt vmcnt(15)
v_dot2c_f32_bf16 v72, s90, v124
v_dot2c_f32_bf16 v73, s91, v124
v_dot2c_f32_bf16 v74, s90, v125
v_dot2c_f32_bf16 v75, s91, v125
v_dot2c_f32_bf16 v76, s90, v126
v_dot2c_f32_bf16 v77, s91, v126
v_dot2c_f32_bf16 v78, s90, v127
v_dot2c_f32_bf16 v79, s91, v127
s_waitcnt vmcnt(14)
v_dot2c_f32_bf16 v72, s90, v128
v_dot2c_f32_bf16 v73, s91, v128
v_dot2c_f32_bf16 v74, s90, v129
v_dot2c_f32_bf16 v75, s91, v129
v_dot2c_f32_bf16 v76, s90, v130
v_dot2c_f32_bf16 v77, s91, v130
v_dot2c_f32_bf16 v78, s90, v131
v_dot2c_f32_bf16 v79, s91, v131
s_nop 2
v_cvt_pk_bf16_f32 v58, v72, v73
v_cvt_pk_bf16_f32 v59, v74, v75
v_cvt_pk_bf16_f32 v60, v76, v77
v_cvt_pk_bf16_f32 v61, v78, v79
v_lshlrev_b32 v72, 16, v58
v_and_b32 v73, 0xffff0000, v58
v_lshlrev_b32 v74, 16, v59
v_and_b32 v75, 0xffff0000, v59
v_lshlrev_b32 v76, 16, v60
v_and_b32 v77, 0xffff0000, v60
v_lshlrev_b32 v78, 16, v61
v_and_b32 v79, 0xffff0000, v61
v_pk_mul_f32 v[72:73], v[72:73], v[38:39]
v_pk_mul_f32 v[74:75], v[74:75], v[40:41]
v_pk_mul_f32 v[76:77], v[76:77], v[42:43]
v_pk_mul_f32 v[78:79], v[78:79], v[44:45]
v_cvt_pk_bf16_f32 v58, v72, v73
v_cvt_pk_bf16_f32 v59, v74, v75
v_cvt_pk_bf16_f32 v60, v76, v77
v_cvt_pk_bf16_f32 v61, v78, v79
v_lshlrev_b32 v72, 16, v58
v_and_b32 v73, 0xffff0000, v58
v_lshlrev_b32 v74, 16, v59
v_and_b32 v75, 0xffff0000, v59
v_lshlrev_b32 v76, 16, v60
v_and_b32 v77, 0xffff0000, v60
v_lshlrev_b32 v78, 16, v61
v_and_b32 v79, 0xffff0000, v61
v_pk_add_f32 v[72:73], v[72:73], v[18:19]
v_pk_add_f32 v[74:75], v[74:75], v[20:21]
v_pk_add_f32 v[76:77], v[76:77], v[22:23]
v_pk_add_f32 v[78:79], v[78:79], v[24:25]
v_cvt_pk_bf16_f32 v72, v72, v73
v_cvt_pk_bf16_f32 v73, v74, v75
v_cvt_pk_bf16_f32 v74, v76, v77
v_cvt_pk_bf16_f32 v75, v78, v79
buffer_store_dwordx4 v[72:75], v248, s[60:63], 0 offen
s_waitcnt vmcnt(1)
v_cmp_gt_u32 vcc, 2, v230
s_nop 0
s_and_b32 s29, vcc_lo, 0xff
s_cbranch_scc0 SP_P2B_RET
SP_P2B:
s_sleep 0
s_add_u32 s100, s100, 1
s_bitcmp1_b32 s100, 19
s_cbranch_scc1 K_END
buffer_load_dword v230, v229, s[20:23], s95 offen sc0 sc1
s_waitcnt vmcnt(0)
v_cmp_gt_u32 vcc, 2, v230
s_nop 0
s_and_b32 s29, vcc_lo, 0xff
s_cbranch_scc1 SP_P2B
SP_P2B_RET:
buffer_load_dwordx4 v[80:83], v243, s[20:23], s65 offen offset:3072 sc0 sc1
buffer_load_dwordx4 v[84:87], v243, s[20:23], s66 offen offset:2048 sc0 sc1
buffer_load_dwordx4 v[88:91], v243, s[20:23], s67 offen offset:1024 sc0 sc1
buffer_load_dwordx4 v[92:95], v243, s[20:23], s68 offen offset:0 sc0 sc1
buffer_load_dwordx4 v[96:99], v243, s[20:23], s69 offen offset:3072 sc0 sc1
buffer_load_dwordx4 v[100:103], v243, s[20:23], s70 offen offset:2048 sc0 sc1
buffer_load_dwordx4 v[132:135], v243, s[20:23], s71 offen offset:1024 sc0 sc1
s_waitcnt vmcnt(17)
v_dot2c_f32_bf16 v66, s90, v200
v_dot2c_f32_bf16 v67, s91, v200
v_dot2c_f32_bf16 v68, s90, v201
v_dot2c_f32_bf16 v69, s91, v201
s_waitcnt vmcnt(16)
v_dot2c_f32_bf16 v66, s90, v202
v_dot2c_f32_bf16 v67, s91, v202
v_dot2c_f32_bf16 v68, s90, v203
v_dot2c_f32_bf16 v69, s91, v203
s_waitcnt vmcnt(15)
v_dot2c_f32_bf16 v66, s90, v204
v_dot2c_f32_bf16 v67, s91, v204
v_dot2c_f32_bf16 v68, s90, v205
v_dot2c_f32_bf16 v69, s91, v205
s_waitcnt vmcnt(14)
v_dot2c_f32_bf16 v66, s90, v206
v_dot2c_f32_bf16 v67, s91, v206
v_dot2c_f32_bf16 v68, s90, v207
v_dot2c_f32_bf16 v69, s91, v207
s_waitcnt vmcnt(13)
v_dot2c_f32_bf16 v66, s90, v208
v_dot2c_f32_bf16 v67, s91, v208
v_dot2c_f32_bf16 v68, s90, v209
v_dot2c_f32_bf16 v69, s91, v209
s_waitcnt vmcnt(12)
v_dot2c_f32_bf16 v66, s90, v210
v_dot2c_f32_bf16 v67, s91, v210
v_dot2c_f32_bf16 v68, s90, v211
v_dot2c_f32_bf16 v69, s91, v211
s_waitcnt vmcnt(11)
v_dot2c_f32_bf16 v66, s90, v212
v_dot2c_f32_bf16 v67, s91, v212
v_dot2c_f32_bf16 v68, s90, v213
v_dot2c_f32_bf16 v69, s91, v213
s_waitcnt vmcnt(10)
v_dot2c_f32_bf16 v66, s90, v214
v_dot2c_f32_bf16 v67, s91, v214
v_dot2c_f32_bf16 v68, s90, v215
v_dot2c_f32_bf16 v69, s91, v215
s_nop 2
s_cmp_eq_u32 s34, 0
s_cselect_b32 s29, 0, 0x7fbffff0
v_cvt_pk_bf16_f32 v58, v66, v67
v_cvt_pk_bf16_f32 v59, v68, v69
v_lshlrev_b32 v66, 16, v58
v_and_b32 v67, 0xffff0000, v58
v_lshlrev_b32 v68, 16, v59
v_and_b32 v69, 0xffff0000, v59
v_pk_mul_f32 v[66:67], v[66:67], v[54:55]
v_pk_mul_f32 v[68:69], v[68:69], v[56:57]
v_cvt_pk_bf16_f32 v58, v66, v67
v_cvt_pk_bf16_f32 v59, v68, v69
v_lshlrev_b32 v66, 16, v58
v_and_b32 v67, 0xffff0000, v58
v_lshlrev_b32 v68, 16, v59
v_and_b32 v69, 0xffff0000, v59
v_pk_add_f32 v[66:67], v[66:67], v[34:35]
v_pk_add_f32 v[68:69], v[68:69], v[36:37]
v_cvt_pk_bf16_f32 v66, v66, v67
v_cvt_pk_bf16_f32 v67, v68, v69
buffer_store_dwordx2 v[66:67], v249, s[60:63], s29 offen
s_waitcnt vmcnt(7)
v_dot2c_f32_bf16 v136, s90, v80
v_dot2c_f32_bf16 v137, s91, v80
v_dot2c_f32_bf16 v138, s90, v81
v_dot2c_f32_bf16 v139, s91, v81
v_dot2c_f32_bf16 v140, s90, v82
v_dot2c_f32_bf16 v141, s91, v82
v_dot2c_f32_bf16 v142, s90, v83
v_dot2c_f32_bf16 v143, s91, v83
s_waitcnt vmcnt(6)
v_dot2c_f32_bf16 v136, s90, v84
v_dot2c_f32_bf16 v137, s91, v84
v_dot2c_f32_bf16 v138, s90, v85
v_dot2c_f32_bf16 v139, s91, v85
v_dot2c_f32_bf16 v140, s90, v86
v_dot2c_f32_bf16 v141, s91, v86
v_dot2c_f32_bf16 v142, s90, v87
v_dot2c_f32_bf16 v143, s91, v87
s_waitcnt vmcnt(5)
v_dot2c_f32_bf16 v136, s90, v88
v_dot2c_f32_bf16 v137, s91, v88
v_dot2c_f32_bf16 v138, s90, v89
v_dot2c_f32_bf16 v139, s91, v89
v_dot2c_f32_bf16 v140, s90, v90
v_dot2c_f32_bf16 v141, s91, v90
v_dot2c_f32_bf16 v142, s90, v91
v_dot2c_f32_bf16 v143, s91, v91
s_waitcnt vmcnt(4)
v_dot2c_f32_bf16 v136, s90, v92
v_dot2c_f32_bf16 v137, s91, v92
v_dot2c_f32_bf16 v138, s90, v93
v_dot2c_f32_bf16 v139, s91, v93
v_dot2c_f32_bf16 v140, s90, v94
v_dot2c_f32_bf16 v141, s91, v94
v_dot2c_f32_bf16 v142, s90, v95
v_dot2c_f32_bf16 v143, s91, v95
s_waitcnt vmcnt(3)
v_dot2c_f32_bf16 v136, s90, v96
v_dot2c_f32_bf16 v137, s91, v96
v_dot2c_f32_bf16 v138, s90, v97
v_dot2c_f32_bf16 v139, s91, v97
v_dot2c_f32_bf16 v140, s90, v98
v_dot2c_f32_bf16 v141, s91, v98
v_dot2c_f32_bf16 v142, s90, v99
v_dot2c_f32_bf16 v143, s91, v99
s_waitcnt vmcnt(2)
v_dot2c_f32_bf16 v136, s90, v100
v_dot2c_f32_bf16 v137, s91, v100
v_dot2c_f32_bf16 v138, s90, v101
v_dot2c_f32_bf16 v139, s91, v101
v_dot2c_f32_bf16 v140, s90, v102
v_dot2c_f32_bf16 v141, s91, v102
v_dot2c_f32_bf16 v142, s90, v103
v_dot2c_f32_bf16 v143, s91, v103
s_waitcnt vmcnt(1)
v_dot2c_f32_bf16 v136, s90, v132
v_dot2c_f32_bf16 v137, s91, v132
v_dot2c_f32_bf16 v138, s90, v133
v_dot2c_f32_bf16 v139, s91, v133
v_dot2c_f32_bf16 v140, s90, v134
v_dot2c_f32_bf16 v141, s91, v134
v_dot2c_f32_bf16 v142, s90, v135
v_dot2c_f32_bf16 v143, s91, v135
s_nop 2
v_cvt_pk_bf16_f32 v58, v136, v137
v_cvt_pk_bf16_f32 v59, v138, v139
v_cvt_pk_bf16_f32 v60, v140, v141
v_cvt_pk_bf16_f32 v61, v142, v143
v_lshlrev_b32 v136, 16, v58
v_and_b32 v137, 0xffff0000, v58
v_lshlrev_b32 v138, 16, v59
v_and_b32 v139, 0xffff0000, v59
v_lshlrev_b32 v140, 16, v60
v_and_b32 v141, 0xffff0000, v60
v_lshlrev_b32 v142, 16, v61
v_and_b32 v143, 0xffff0000, v61
v_pk_mul_f32 v[136:137], v[136:137], v[46:47]
v_pk_mul_f32 v[138:139], v[138:139], v[48:49]
v_pk_mul_f32 v[140:141], v[140:141], v[50:51]
v_pk_mul_f32 v[142:143], v[142:143], v[52:53]
v_cvt_pk_bf16_f32 v58, v136, v137
v_cvt_pk_bf16_f32 v59, v138, v139
v_cvt_pk_bf16_f32 v60, v140, v141
v_cvt_pk_bf16_f32 v61, v142, v143
v_lshlrev_b32 v136, 16, v58
v_and_b32 v137, 0xffff0000, v58
v_lshlrev_b32 v138, 16, v59
v_and_b32 v139, 0xffff0000, v59
v_lshlrev_b32 v140, 16, v60
v_and_b32 v141, 0xffff0000, v60
v_lshlrev_b32 v142, 16, v61
v_and_b32 v143, 0xffff0000, v61
v_pk_add_f32 v[136:137], v[136:137], v[26:27]
v_pk_add_f32 v[138:139], v[138:139], v[28:29]
v_pk_add_f32 v[140:141], v[140:141], v[30:31]
v_pk_add_f32 v[142:143], v[142:143], v[32:33]
v_cvt_pk_bf16_f32 v136, v136, v137
v_cvt_pk_bf16_f32 v137, v138, v139
v_cvt_pk_bf16_f32 v138, v140, v141
v_cvt_pk_bf16_f32 v139, v142, v143
buffer_store_dwordx4 v[136:139], v248, s[60:63], 0 offen offset:128
s_endpgm
SP_O1B:
s_sleep 1
s_add_u32 s100, s100, 1
s_bitcmp1_b32 s100, 19
s_cbranch_scc1 K_END
buffer_load_dword v230, v229, s[20:23], s94 offen sc0 sc1
s_waitcnt vmcnt(0)
v_cmp_gt_u32 vcc, 1, v230
s_bitcmp1_b32 vcc_lo, s39
s_cbranch_scc1 SP_O1B
s_branch SP_O1B_RET
SP_O2B:
s_sleep 1
s_add_u32 s100, s100, 1
s_bitcmp1_b32 s100, 19
s_cbranch_scc1 K_END
buffer_load_dword v230, v229, s[20:23], s94 offen sc0 sc1
s_waitcnt vmcnt(0)
v_cmp_gt_u32 vcc, 1, v230
s_and_b32 s29, vcc_lo, 15
s_cbranch_scc1 SP_O2B
s_branch SP_O2B_RET
SP_O3B:
s_sleep 1
s_add_u32 s100, s100, 1
s_bitcmp1_b32 s100, 19
s_cbranch_scc1 K_END
buffer_load_dword v230, v229, s[20:23], s94 offen sc0 sc1
s_waitcnt vmcnt(0)
v_cmp_gt_u32 vcc, 2, v230
s_and_b32 s29, vcc_lo, 15
s_cbranch_scc1 SP_O3B
s_branch SP_O3B_RET
SP_P1B:
s_sleep 1
s_add_u32 s100, s100, 1
s_bitcmp1_b32 s100, 19
s_cbranch_scc1 K_END
buffer_load_dword v230, v229, s[20:23], s95 offen sc0 sc1
s_waitcnt vmcnt(0)
v_cmp_gt_u32 vcc, 1, v230
s_and_b32 s29, vcc_lo, 0xff
s_cbranch_scc1 SP_P1B
s_branch SP_P1B_RET
F_NOTYET:
s_bitcmp1_b32 s51, 30
s_cbranch_scc1 F_BSENT
s_bitset1_b32 s51, 30
s_mov_b32 s46, 0x60
s_mov_b32 s50, s28
s_add_u32 s28, s45, 0x0
buffer_store_dwordx4 v[72:75], v169, s[20:23], s28 offen offset:0 sc0 sc1
buffer_store_dwordx4 v[76:79], v169, s[20:23], s28 offen offset:2048 sc0 sc1
s_add_u32 s28, s28, 4096
buffer_store_dwordx4 v[80:83], v169, s[20:23], s28 offen offset:0 sc0 sc1
buffer_store_dwordx4 v[84:87], v169, s[20:23], s28 offen offset:2048 sc0 sc1
s_add_u32 s28, s28, 4096
buffer_store_dwordx4 v[88:91], v169, s[20:23], s28 offen offset:0 sc0 sc1
buffer_store_dwordx4 v[92:95], v169, s[20:23], s28 offen offset:2048 sc0 sc1
s_add_u32 s28, s28, 4096
buffer_store_dwordx4 v[96:99], v169, s[20:23], s28 offen offset:0 sc0 sc1
buffer_store_dwordx4 v[100:103], v169, s[20:23], s28 offen offset:2048 sc0 sc1
s_add_u32 s28, s28, 4096
buffer_store_dwordx4 v[104:107], v169, s[20:23], s28 offen offset:0 sc0 sc1
s_lshl_b32 s28, s3, 2
s_add_u32 s28, s28, 0x240000
buffer_store_dword v65, v64, s[20:23], s28 offen sc0 sc1
s_mov_b32 s28, s50
s_or_b32 s29, s38, 0x40
v_mov_b32 v62, s29
v_mov_b32 v63, s35
s_lshl_b32 s29, s36, 5
s_waitcnt vmcnt(0)
s_mov_b64 exec, 1
buffer_store_byte v62, v63, s[24:27], s29 offen sc0 sc1
s_mov_b64 exec, -1
F_BSENT:
s_lshl_b32 s29, s36, 5
buffer_load_dword v62, v64, s[24:27], s29 offen sc0 sc1
s_waitcnt vmcnt(0)
v_and_b32 v63, 0x40404040, v62
v_cmp_ne_u32 vcc, 0x40404040, v63
s_cbranch_vccnz F_NOB
s_mul_i32 s29, s38, 0x01010101
v_and_b32 v62, 0x0f0f0f0f, v62
v_cmp_ne_u32 vcc, s29, v62
v_mov_b32 v60, 0
s_cbranch_vccnz F_GO
v_mov_b32 v60, 1
s_branch F_GO
F_NOB:
s_sleep 1
s_add_u32 s100, s100, 1
s_bitcmp1_b32 s100, 19
s_cbranch_scc1 K_END
s_branch F_POLL
Q_REDO:
s_mov_b32 s4, 0
s_mov_b32 s51, 0
s_waitcnt vmcnt(0) lgkmcnt(0)
s_branch Q_START
K_FALLBACK:
s_mov_b32 s43, 1
s_mov_b32 s3, 0
s_mov_b32 s86, 0x30000
s_mov_b32 s66, 0
s_mov_b32 s70, 0
s_mov_b32 s74, 0
s_waitcnt vmcnt(0) lgkmcnt(0)
s_barrier
v_mov_b32 v254, 0x7ffffff0
v_mov_b32 v136, 0xff800000
v_mov_b32 v140, 0xff800000
v_mov_b32 v144, 0xff800000
v_mov_b32 v148, 0xff800000
s_mov_b32 s32, 0
s_mov_b32 s33, 32
K_FBLOOP:
s_add_u32 m0, s30, 81920
s_nop 0
buffer_load_dwordx4 v228, s[8:11], s32 offen offset:0  lds
buffer_load_dwordx4 v229, s[8:11], s32 offen offset:1024  lds
buffer_load_dwordx4 v230, s[8:11], s32 offen offset:2048  lds
buffer_load_dwordx4 v231, s[8:11], s32 offen offset:3072  lds
s_waitcnt vmcnt(0)
s_barrier
ds_read_b128 a[144:147], v216 offset:16384
ds_read_b128 a[148:151], v217 offset:16384
ds_read_b128 a[152:155], v218 offset:16384
ds_read_b128 a[156:159], v219 offset:16384
ds_read_b128 a[160:163], v216 offset:20480
ds_read_b128 a[164:167], v217 offset:20480
ds_read_b128 a[168:171], v218 offset:20480
ds_read_b128 a[172:175], v219 offset:20480
s_waitcnt lgkmcnt(0)
v_mfma_f32_16x16x32_bf16 v[8:11], a[144:147], v[152:155], 0
v_mfma_f32_16x16x32_bf16 v[16:19], a[144:147], v[168:171], 0
v_mfma_f32_16x16x32_bf16 v[24:27], a[144:147], v[184:187], 0
v_mfma_f32_16x16x32_bf16 v[32:35], a[144:147], v[200:203], 0
v_mfma_f32_16x16x32_bf16 v[8:11], a[148:151], v[156:159], v[8:11]
v_mfma_f32_16x16x32_bf16 v[16:19], a[148:151], v[172:175], v[16:19]
v_mfma_f32_16x16x32_bf16 v[24:27], a[148:151], v[188:191], v[24:27]
v_mfma_f32_16x16x32_bf16 v[32:35], a[148:151], v[204:207], v[32:35]
v_mfma_f32_16x16x32_bf16 v[8:11], a[152:155], v[160:163], v[8:11]
v_mfma_f32_16x16x32_bf16 v[16:19], a[152:155], v[176:179], v[16:19]
v_mfma_f32_16x16x32_bf16 v[24:27], a[152:155], v[192:195], v[24:27]
v_mfma_f32_16x16x32_bf16 v[32:35], a[152:155], v[208:211], v[32:35]
v_mfma_f32_16x16x32_bf16 v[8:11], a[156:159], v[164:167], v[8:11]
v_mfma_f32_16x16x32_bf16 v[16:19], a[156:159], v[180:183], v[16:19]
v_mfma_f32_16x16x32_bf16 v[24:27], a[156:159], v[196:199], v[24:27]
v_mfma_f32_16x16x32_bf16 v[32:35], a[156:159], v[212:215], v[32:35]
v_mfma_f32_16x16x32_bf16 v[12:15], a[160:163], v[152:155], 0
v_mfma_f32_16x16x32_bf16 v[20:23], a[160:163], v[168:171], 0
v_mfma_f32_16x16x32_bf16 v[28:31], a[160:163], v[184:187], 0
v_mfma_f32_16x16x32_bf16 v[36:39], a[160:163], v[200:203], 0
v_mfma_f32_16x16x32_bf16 v[12:15], a[164:167], v[156:159], v[12:15]
v_mfma_f32_16x16x32_bf16 v[20:23], a[164:167], v[172:175], v[20:23]
v_mfma_f32_16x16x32_bf16 v[28:31], a[164:167], v[188:191], v[28:31]
v_mfma_f32_16x16x32_bf16 v[36:39], a[164:167], v[204:207], v[36:39]
v_mfma_f32_16x16x32_bf16 v[12:15], a[168:171], v[160:163], v[12:15]
v_mfma_f32_16x16x32_bf16 v[20:23], a[168:171], v[176:179], v[20:23]
v_mfma_f32_16x16x32_bf16 v[28:31], a[168:171], v[192:195], v[28:31]
v_mfma_f32_16x16x32_bf16 v[36:39], a[168:171], v[208:211], v[36:39]
v_mfma_f32_16x16x32_bf16 v[12:15], a[172:175], v[164:167], v[12:15]
v_mfma_f32_16x16x32_bf16 v[20:23], a[172:175], v[180:183], v[20:23]
v_mfma_f32_16x16x32_bf16 v[28:31], a[172:175], v[196:199], v[28:31]
v_mfma_f32_16x16x32_bf16 v[36:39], a[172:175], v[212:215], v[36:39]
s_nop 7
s_nop 3
v_max3_f32 v136, v136, v8, v9
v_max3_f32 v136, v136, v10, v11
v_max3_f32 v136, v136, v12, v13
v_max3_f32 v136, v136, v14, v15
v_max3_f32 v140, v140, v16, v17
v_max3_f32 v140, v140, v18, v19
v_max3_f32 v140, v140, v20, v21
v_max3_f32 v140, v140, v22, v23
v_max3_f32 v144, v144, v24, v25
v_max3_f32 v144, v144, v26, v27
v_max3_f32 v144, v144, v28, v29
v_max3_f32 v144, v144, v30, v31
v_max3_f32 v148, v148, v32, v33
v_max3_f32 v148, v148, v34, v35
v_max3_f32 v148, v148, v36, v37
v_max3_f32 v148, v148, v38, v39
ds_read_b128 a[144:147], v216 offset:24576
ds_read_b128 a[148:151], v217 offset:24576
ds_read_b128 a[152:155], v218 offset:24576
ds_read_b128 a[156:159], v219 offset:24576
ds_read_b128 a[160:163], v216 offset:28672
ds_read_b128 a[164:167], v217 offset:28672
ds_read_b128 a[168:171], v218 offset:28672
ds_read_b128 a[172:175], v219 offset:28672
s_waitcnt lgkmcnt(0)
v_mfma_f32_16x16x32_bf16 v[8:11], a[144:147], v[152:155], 0
v_mfma_f32_16x16x32_bf16 v[16:19], a[144:147], v[168:171], 0
v_mfma_f32_16x16x32_bf16 v[24:27], a[144:147], v[184:187], 0
v_mfma_f32_16x16x32_bf16 v[32:35], a[144:147], v[200:203], 0
v_mfma_f32_16x16x32_bf16 v[8:11], a[148:151], v[156:159], v[8:11]
v_mfma_f32_16x16x32_bf16 v[16:19], a[148:151], v[172:175], v[16:19]
v_mfma_f32_16x16x32_bf16 v[24:27], a[148:151], v[188:191], v[24:27]
v_mfma_f32_16x16x32_bf16 v[32:35], a[148:151], v[204:207], v[32:35]
v_mfma_f32_16x16x32_bf16 v[8:11], a[152:155], v[160:163], v[8:11]
v_mfma_f32_16x16x32_bf16 v[16:19], a[152:155], v[176:179], v[16:19]
v_mfma_f32_16x16x32_bf16 v[24:27], a[152:155], v[192:195], v[24:27]
v_mfma_f32_16x16x32_bf16 v[32:35], a[152:155], v[208:211], v[32:35]
v_mfma_f32_16x16x32_bf16 v[8:11], a[156:159], v[164:167], v[8:11]
v_mfma_f32_16x16x32_bf16 v[16:19], a[156:159], v[180:183], v[16:19]
v_mfma_f32_16x16x32_bf16 v[24:27], a[156:159], v[196:199], v[24:27]
v_mfma_f32_16x16x32_bf16 v[32:35], a[156:159], v[212:215], v[32:35]
v_mfma_f32_16x16x32_bf16 v[12:15], a[160:163], v[152:155], 0
v_mfma_f32_16x16x32_bf16 v[20:23], a[160:163], v[168:171], 0
v_mfma_f32_16x16x32_bf16 v[28:31], a[160:163], v[184:187], 0
v_mfma_f32_16x16x32_bf16 v[36:39], a[160:163], v[200:203], 0
v_mfma_f32_16x16x32_bf16 v[12:15], a[164:167], v[156:159], v[12:15]
v_mfma_f32_16x16x32_bf16 v[20:23], a[164:167], v[172:175], v[20:23]
v_mfma_f32_16x16x32_bf16 v[28:31], a[164:167], v[188:191], v[28:31]
v_mfma_f32_16x16x32_bf16 v[36:39], a[164:167], v[204:207], v[36:39]
v_mfma_f32_16x16x32_bf16 v[12:15], a[168:171], v[160:163], v[12:15]
v_mfma_f32_16x16x32_bf16 v[20:23], a[168:171], v[176:179], v[20:23]
v_mfma_f32_16x16x32_bf16 v[28:31], a[168:171], v[192:195], v[28:31]
v_mfma_f32_16x16x32_bf16 v[36:39], a[168:171], v[208:211], v[36:39]
v_mfma_f32_16x16x32_bf16 v[12:15], a[172:175], v[164:167], v[12:15]
v_mfma_f32_16x16x32_bf16 v[20:23], a[172:175], v[180:183], v[20:23]
v_mfma_f32_16x16x32_bf16 v[28:31], a[172:175], v[196:199], v[28:31]
v_mfma_f32_16x16x32_bf16 v[36:39], a[172:175], v[212:215], v[36:39]
s_nop 7
s_nop 3
v_max3_f32 v136, v136, v8, v9
v_max3_f32 v136, v136, v10, v11
v_max3_f32 v136, v136, v12, v13
v_max3_f32 v136, v136, v14, v15
v_max3_f32 v140, v140, v16, v17
v_max3_f32 v140, v140, v18, v19
v_max3_f32 v140, v140, v20, v21
v_max3_f32 v140, v140, v22, v23
v_max3_f32 v144, v144, v24, v25
v_max3_f32 v144, v144, v26, v27
v_max3_f32 v144, v144, v28, v29
v_max3_f32 v144, v144, v30, v31
v_max3_f32 v148, v148, v32, v33
v_max3_f32 v148, v148, v34, v35
v_max3_f32 v148, v148, v36, v37
v_max3_f32 v148, v148, v38, v39
s_barrier
s_add_u32 s32, s32, 16384
s_sub_u32 s33, s33, 1
s_cmp_lg_u32 s33, 0
s_cbranch_scc1 K_FBLOOP
v_mov_b32 v246, v136
s_nop 1
v_permlane16_swap_b32 v136, v246
v_max_f32 v136, v136, v246
v_mov_b32 v246, v136
s_nop 1
v_permlane32_swap_b32 v136, v246
v_max_f32 v136, v136, v246
v_sub_f32 v136, 0, v136
v_mov_b32 v137, v136
v_mov_b32 v138, v136
v_mov_b32 v139, v136
v_mov_b32 v246, v140
s_nop 1
v_permlane16_swap_b32 v140, v246
v_max_f32 v140, v140, v246
v_mov_b32 v246, v140
s_nop 1
v_permlane32_swap_b32 v140, v246
v_max_f32 v140, v140, v246
v_sub_f32 v140, 0, v140
v_mov_b32 v141, v140
v_mov_b32 v142, v140
v_mov_b32 v143, v140
v_mov_b32 v246, v144
s_nop 1
v_permlane16_swap_b32 v144, v246
v_max_f32 v144, v144, v246
v_mov_b32 v246, v144
s_nop 1
v_permlane32_swap_b32 v144, v246
v_max_f32 v144, v144, v246
v_sub_f32 v144, 0, v144
v_mov_b32 v145, v144
v_mov_b32 v146, v144
v_mov_b32 v147, v144
v_mov_b32 v246, v148
s_nop 1
v_permlane16_swap_b32 v148, v246
v_max_f32 v148, v148, v246
v_mov_b32 v246, v148
s_nop 1
v_permlane32_swap_b32 v148, v246
v_max_f32 v148, v148, v246
v_sub_f32 v148, 0, v148
v_mov_b32 v149, v148
v_mov_b32 v150, v148
v_mov_b32 v151, v148
s_add_u32 s32, s7, 0
s_add_u32 m0, s30, 81920
s_nop 0
buffer_load_dwordx4 v228, s[8:11], s32 offen offset:0  lds
buffer_load_dwordx4 v229, s[8:11], s32 offen offset:1024  lds
buffer_load_dwordx4 v230, s[8:11], s32 offen offset:2048  lds
buffer_load_dwordx4 v231, s[8:11], s32 offen offset:3072  lds
s_add_u32 s32, s7, 16384
s_add_u32 m0, s30, 114688
s_nop 0
buffer_load_dwordx4 v228, s[8:11], s32 offen offset:0  lds
buffer_load_dwordx4 v229, s[8:11], s32 offen offset:1024  lds
buffer_load_dwordx4 v230, s[8:11], s32 offen offset:2048  lds
buffer_load_dwordx4 v231, s[8:11], s32 offen offset:3072  lds
s_add_u32 s39, s7, 0
s_add_u32 m0, s30, 131072
s_nop 0
buffer_load_dwordx4 v232, s[12:15], s39 offen offset:0  lds
buffer_load_dwordx4 v233, s[12:15], s39 offen offset:1024  lds
buffer_load_dwordx4 v232, s[12:15], s39 offen offset:2048  lds
buffer_load_dwordx4 v233, s[12:15], s39 offen offset:3072  lds
s_add_u32 s32, s7, 32768
s_add_u32 m0, s30, 65536
s_nop 0
buffer_load_dwordx4 v228, s[8:11], s32 offen offset:0  lds
buffer_load_dwordx4 v229, s[8:11], s32 offen offset:1024  lds
buffer_load_dwordx4 v230, s[8:11], s32 offen offset:2048  lds
buffer_load_dwordx4 v231, s[8:11], s32 offen offset:3072  lds
s_add_u32 s39, s7, 16384
s_add_u32 m0, s30, 147456
s_nop 0
buffer_load_dwordx4 v232, s[12:15], s39 offen offset:0  lds
buffer_load_dwordx4 v233, s[12:15], s39 offen offset:1024  lds
buffer_load_dwordx4 v232, s[12:15], s39 offen offset:2048  lds
buffer_load_dwordx4 v233, s[12:15], s39 offen offset:3072  lds
s_waitcnt vmcnt(0)
s_barrier
ds_read_b128 a[144:147], v216 offset:16384
ds_read_b128 a[148:151], v217 offset:16384
ds_read_b128 a[152:155], v218 offset:16384
ds_read_b128 a[156:159], v219 offset:16384
ds_read_b128 a[160:163], v216 offset:20480
ds_read_b128 a[164:167], v217 offset:20480
ds_read_b128 a[168:171], v218 offset:20480
ds_read_b128 a[172:175], v219 offset:20480
s_add_u32 s32, s7, 32768
s_add_u32 s39, s7, 16384
s_mul_i32 s88, s37, 864
s_mov_b32 s87, s88
v_accvgpr_write_b32 a128, 0
v_accvgpr_write_b32 a129, 0
v_accvgpr_write_b32 a130, 0
v_accvgpr_write_b32 a131, 0
v_accvgpr_write_b32 a132, 0
v_accvgpr_write_b32 a133, 0
v_accvgpr_write_b32 a134, 0
v_accvgpr_write_b32 a135, 0
v_lshrrev_b32 v240, 2, v1
v_mul_u32_u24 v240, 0x2400, v240
v_and_b32 v246, 3, v1
v_lshl_add_u32 v240, v246, 4, v240
v_mul_u32_u24 v243, 3641, v1
v_lshrrev_b32 v243, 16, v243
v_mul_u32_u24 v243, 864, v243
v_add_u32 v243, v243, v244
s_waitcnt lgkmcnt(0)
v_mfma_f32_16x16x32_bf16 v[8:11], a[144:147], v[152:155], v[136:139]
v_mfma_f32_16x16x32_bf16 v[16:19], a[144:147], v[168:171], v[140:143]
v_mfma_f32_16x16x32_bf16 v[24:27], a[144:147], v[184:187], v[144:147]
v_mfma_f32_16x16x32_bf16 v[32:35], a[144:147], v[200:203], v[148:151]
ds_read_b128 a[144:147], v216 offset:24576
v_mfma_f32_16x16x32_bf16 v[8:11], a[148:151], v[156:159], v[8:11]
v_mfma_f32_16x16x32_bf16 v[16:19], a[148:151], v[172:175], v[16:19]
v_mfma_f32_16x16x32_bf16 v[24:27], a[148:151], v[188:191], v[24:27]
v_mfma_f32_16x16x32_bf16 v[32:35], a[148:151], v[204:207], v[32:35]
ds_read_b128 a[148:151], v217 offset:24576
v_mfma_f32_16x16x32_bf16 v[8:11], a[152:155], v[160:163], v[8:11]
v_mfma_f32_16x16x32_bf16 v[16:19], a[152:155], v[176:179], v[16:19]
v_mfma_f32_16x16x32_bf16 v[24:27], a[152:155], v[192:195], v[24:27]
v_mfma_f32_16x16x32_bf16 v[32:35], a[152:155], v[208:211], v[32:35]
ds_read_b128 a[152:155], v218 offset:24576
v_mfma_f32_16x16x32_bf16 v[8:11], a[156:159], v[164:167], v[8:11]
v_mfma_f32_16x16x32_bf16 v[16:19], a[156:159], v[180:183], v[16:19]
v_mfma_f32_16x16x32_bf16 v[24:27], a[156:159], v[196:199], v[24:27]
v_mfma_f32_16x16x32_bf16 v[32:35], a[156:159], v[212:215], v[32:35]
ds_read_b128 a[156:159], v219 offset:24576
v_mfma_f32_16x16x32_bf16 v[12:15], a[160:163], v[152:155], v[136:139]
v_mfma_f32_16x16x32_bf16 v[20:23], a[160:163], v[168:171], v[140:143]
v_mfma_f32_16x16x32_bf16 v[28:31], a[160:163], v[184:187], v[144:147]
v_mfma_f32_16x16x32_bf16 v[36:39], a[160:163], v[200:203], v[148:151]
ds_read_b128 a[160:163], v216 offset:28672
v_mfma_f32_16x16x32_bf16 v[12:15], a[164:167], v[156:159], v[12:15]
v_mfma_f32_16x16x32_bf16 v[20:23], a[164:167], v[172:175], v[20:23]
v_mfma_f32_16x16x32_bf16 v[28:31], a[164:167], v[188:191], v[28:31]
v_mfma_f32_16x16x32_bf16 v[36:39], a[164:167], v[204:207], v[36:39]
ds_read_b128 a[164:167], v217 offset:28672
v_mfma_f32_16x16x32_bf16 v[12:15], a[168:171], v[160:163], v[12:15]
v_mfma_f32_16x16x32_bf16 v[20:23], a[168:171], v[176:179], v[20:23]
v_mfma_f32_16x16x32_bf16 v[28:31], a[168:171], v[192:195], v[28:31]
v_mfma_f32_16x16x32_bf16 v[36:39], a[168:171], v[208:211], v[36:39]
ds_read_b128 a[168:171], v218 offset:28672
v_mfma_f32_16x16x32_bf16 v[12:15], a[172:175], v[164:167], v[12:15]
v_mfma_f32_16x16x32_bf16 v[20:23], a[172:175], v[180:183], v[20:23]
v_mfma_f32_16x16x32_bf16 v[28:31], a[172:175], v[196:199], v[28:31]
v_mfma_f32_16x16x32_bf16 v[36:39], a[172:175], v[212:215], v[36:39]
ds_read_b128 a[172:175], v219 offset:28672
s_nop 7
s_branch K_BODY0
K_CODE_END:
.section .rodata,"a"
.p2align 6
.amdhsa_kernel recurrent_scan__gqa_block_cached__moe_arch_mod__prompt_kernel
  .amdhsa_next_free_vgpr 512
  .amdhsa_next_free_sgpr 102
  .amdhsa_accum_offset 256
  .amdhsa_group_segment_fixed_size 0
  .amdhsa_kernarg_size 104
  .amdhsa_user_sgpr_count 2
  .amdhsa_user_sgpr_kernarg_segment_ptr 1
  .amdhsa_system_sgpr_workgroup_id_x 1
  .amdhsa_float_denorm_mode_32 3
.end_amdhsa_kernel
```

```asm
; @launch grid=(256,1,1) block=(256,1,1) lds=163840
.amdgcn_target "amdgcn-amd-amdhsa--gfx950"
.text
.globl recurrent_scan__gqa_block_cached__moe_arch_mod__prompt_kernel
.p2align 8
.type recurrent_scan__gqa_block_cached__moe_arch_mod__prompt_kernel,@function
recurrent_scan__gqa_block_cached__moe_arch_mod__prompt_kernel:
s_cmp_ge_u32 s2, 256
s_cbranch_scc1 K_END
s_mov_b32 s100, 0
s_load_dwordx16 s[64:79], s[0:1], 0
s_load_dwordx8 s[80:87], s[0:1], 64
s_load_dwordx2 s[88:89], s[0:1], 96
s_lshr_b32 s35, s2, 3
s_and_b32 s36, s2, 7
s_mul_i32 s5, s36, 9
s_lshr_b32 s5, s5, 2
s_lshl_b32 s3, s36, 8
s_lshl_b32 s28, s35, 3
s_add_u32 s3, s3, s28
v_lshrrev_b32 v5, 5, v0
v_add_u32 v5, s3, v5
v_and_b32 v6, 31, v0
v_mul_u32_u24 v7, 0x480, v5
v_lshl_add_u32 v7, v6, 2, v7
v_and_b32 v1, 63, v0
v_lshrrev_b32 v2, 6, v0
v_lshlrev_b32 v8, 2, v6
v_readfirstlane_b32 s37, v2
v_and_b32 v3, 15, v1
v_lshrrev_b32 v4, 4, v1
s_getpc_b64 s[96:97]
PC_a:
s_sub_u32 s96, s96, PC_a-recurrent_scan__gqa_block_cached__moe_arch_mod__prompt_kernel
s_subb_u32 s97, s97, 0
s_lshl_b32 s50, s35, 2
s_add_u32 s50, s50, s37
s_min_u32 s50, s50, ((K_HOT_END-recurrent_scan__gqa_block_cached__moe_arch_mod__prompt_kernel)>>10)-1
s_lshl_b32 s50, s50, 10
v_lshlrev_b32 v11, 4, v1
v_add_u32 v11, s50, v11
global_load_dwordx4 v[172:175], v11, s[96:97]
s_waitcnt lgkmcnt(0)
s_mov_b32 s52, s64
s_and_b32 s53, s65, 0xffff
s_mov_b32 s54, 0x240000
s_mov_b32 s55, 0x00020000
buffer_load_dword v18, v7, s[52:55], 0 offen offset:0
buffer_load_dword v19, v7, s[52:55], 0 offen offset:128
buffer_load_dword v20, v7, s[52:55], 0 offen offset:256
buffer_load_dword v21, v7, s[52:55], 0 offen offset:384
buffer_load_dword v22, v7, s[52:55], 0 offen offset:512
buffer_load_dword v23, v7, s[52:55], 0 offen offset:640
buffer_load_dword v24, v7, s[52:55], 0 offen offset:768
buffer_load_dword v25, v7, s[52:55], 0 offen offset:896
buffer_load_dword v26, v7, s[52:55], 0 offen offset:1024
s_mov_b32 s28, 0x24c000
s_load_dwordx2 s[6:7], s[88:89], s28
s_mov_b32 s92, s76
s_and_b32 s93, s77, 0xffff
s_mov_b32 s94, 0x480
s_mov_b32 s95, 0x00020000
buffer_load_dword v28, v8, s[92:95], 0 offen offset:0
buffer_load_dword v29, v8, s[92:95], 0 offen offset:128
buffer_load_dword v30, v8, s[92:95], 0 offen offset:256
buffer_load_dword v31, v8, s[92:95], 0 offen offset:384
buffer_load_dword v32, v8, s[92:95], 0 offen offset:512
buffer_load_dword v33, v8, s[92:95], 0 offen offset:640
buffer_load_dword v34, v8, s[92:95], 0 offen offset:768
buffer_load_dword v35, v8, s[92:95], 0 offen offset:896
buffer_load_dword v36, v8, s[92:95], 0 offen offset:1024
s_mov_b32 s20, s88
s_and_b32 s21, s89, 0xffff
s_mov_b32 s22, 0x8000000
s_mov_b32 s23, 0x00020000
s_lshr_b32 s45, s3, 4
s_mul_i32 s45, s45, 18432
s_and_b32 s29, s3, 15
s_lshl_b32 s29, s29, 4
s_add_u32 s45, s45, s29
v_lshrrev_b32 v9, 1, v0
v_lshlrev_b32 v9, 8, v9
v_and_b32 v10, 1, v0
v_lshl_add_u32 v9, v10, 6, v9
s_add_u32 s29, s45, 0x1800000
v_add_u32 v9, s29, v9
s_lshl_b32 s28, s36, 8
s_add_u32 s28, s28, 0x24ac00
v_lshlrev_b32 v10, 6, v0
v_add_u32 v10, s28, v10
v_cmp_lt_u32 vcc, 143, v0
s_lshl_b32 s29, s3, 2
s_add_u32 s29, s29, 0x1a40000
v_cndmask_b32 v9, v9, v10, vcc
v_mov_b32 v10, s29
v_cmp_lt_u32 vcc, 147, v0
s_nop 1
v_cndmask_b32 v9, v9, v10, vcc
buffer_load_dword v176, v9, s[20:23], 0 offen sc1
s_mov_b32 s16, s70
s_and_b32 s17, s71, 0xffff
s_mov_b32 s18, 0x480000
s_mov_b32 s19, 0x00020000
v_add_u32 v9, 0, v4
v_lshlrev_b32 v10, 1, v9
v_xor_b32 v10, v10, v3
v_lshlrev_b32 v10, 4, v10
v_lshl_add_u32 v238, v9, 13, v10
v_add_u32 v9, 4, v4
v_lshlrev_b32 v10, 1, v9
v_xor_b32 v10, v10, v3
v_lshlrev_b32 v10, 4, v10
v_lshl_add_u32 v239, v9, 13, v10
v_subrev_u32 v239, 1024, v239
s_cmp_eq_u32 s37, 0
s_cbranch_scc1 F_NOWQ
s_sub_u32 s28, s37, 1
s_lshl_b32 s49, s28, 11
s_lshl_b32 s28, s28, 16
s_lshl_b32 s34, s35, 8
s_add_u32 s34, s34, s28
s_lshl_b32 s28, s5, 18
s_add_u32 s34, s34, s28
s_add_u32 m0, s49, 65536
s_nop 0
buffer_load_dwordx4 v238, s[16:19], s34 offen offset:0 lds
buffer_load_dwordx4 v239, s[16:19], s34 offen offset:1024 lds
s_add_u32 s34, s34, 196608
s_sub_u32 s51, s34, 4718592
s_cselect_b32 s34, s34, s51
s_add_u32 m0, s49, 71680
s_nop 0
buffer_load_dwordx4 v238, s[16:19], s34 offen offset:0 lds
buffer_load_dwordx4 v239, s[16:19], s34 offen offset:1024 lds
s_add_u32 s34, s34, 196608
s_sub_u32 s51, s34, 4718592
s_cselect_b32 s34, s34, s51
s_add_u32 m0, s49, 77824
s_nop 0
buffer_load_dwordx4 v238, s[16:19], s34 offen offset:0 lds
buffer_load_dwordx4 v239, s[16:19], s34 offen offset:1024 lds
s_add_u32 s34, s34, 196608
s_sub_u32 s51, s34, 4718592
s_cselect_b32 s34, s34, s51
s_add_u32 m0, s49, 83968
s_nop 0
buffer_load_dwordx4 v238, s[16:19], s34 offen offset:0 lds
buffer_load_dwordx4 v239, s[16:19], s34 offen offset:1024 lds
s_add_u32 s34, s34, 196608
s_sub_u32 s51, s34, 4718592
s_cselect_b32 s34, s34, s51
F_NOWQ:
s_getreg_b32 s38, hwreg(HW_REG_XCC_ID, 0, 4)
s_mov_b32 s24, s86
s_and_b32 s25, s87, 0xffff
s_mov_b32 s26, 0x100
s_mov_b32 s27, 0x00020000
s_add_u32 s28, s2, s37
s_cbranch_scc1 F_NOX
s_cmp_eq_u32 s28, 0
s_cbranch_scc0 F_NOX
s_or_b32 s28, s38, 0x80
v_mov_b32 v9, s28
v_mov_b32 v10, 0
s_mov_b64 exec, 1
buffer_store_byte v9, v10, s[24:27], 0 offen sc0 sc1
s_mov_b64 exec, -1
s_waitcnt vmcnt(2)
F_NOX:
v_and_b32 v66, 7, v1
v_mul_u32_u24 v67, 1168, v66
v_lshrrev_b32 v68, 5, v1
v_lshl_add_u32 v67, v68, 6, v67
v_bfe_u32 v69, v1, 3, 2
v_lshl_add_u32 v67, v69, 3, v67
v_add_u32 v168, 0x24000, v67
v_lshlrev_b32 v70, 10, v68
v_lshl_add_u32 v71, v69, 4, v66
v_lshl_add_u32 v169, v71, 4, v70
v_lshlrev_b32 v244, 4, v1
v_bfe_u32 v9, v1, 2, 2
v_and_b32 v10, 3, v1
v_lshl_add_u32 v11, v4, 2, v9
v_and_b32 v12, 7, v11
v_lshrrev_b32 v14, 1, v10
v_xor_b32 v14, v14, v12
v_and_b32 v15, 1, v10
v_lshlrev_b32 v15, 4, v15
v_lshl_add_u32 v15, v11, 8, v15
v_add_u32 v15, 0x10000, v15
v_xor_b32 v16, 0, v14
v_lshl_add_u32 v234, v16, 5, v15
v_xor_b32 v16, 2, v14
v_lshl_add_u32 v235, v16, 5, v15
v_xor_b32 v16, 4, v14
v_lshl_add_u32 v236, v16, 5, v15
v_xor_b32 v16, 6, v14
v_lshl_add_u32 v237, v16, 5, v15
s_lshl2_add_u32 s50, s36, s37
s_lshr_b32 s29, s35, 2
s_add_u32 s28, s29, 0
s_and_b32 s28, s28, 3
s_lshl2_add_u32 s28, s50, s28
s_mul_i32 s28, s28, 18432
v_add_u32 v240, s28, v244
s_add_u32 s28, s29, 1
s_and_b32 s28, s28, 3
s_lshl2_add_u32 s28, s50, s28
s_mul_i32 s28, s28, 18432
v_add_u32 v241, s28, v244
s_add_u32 s28, s29, 2
s_and_b32 s28, s28, 3
s_lshl2_add_u32 s28, s50, s28
s_mul_i32 s28, s28, 18432
v_add_u32 v242, s28, v244
s_add_u32 s28, s29, 3
s_and_b32 s28, s28, 3
s_lshl2_add_u32 s28, s50, s28
s_mul_i32 s28, s28, 18432
v_add_u32 v243, s28, v244
s_mov_b32 s40, 0x3e0293ee
s_mov_b32 s41, 0x3e0293ee
s_mov_b32 s76, 0x3ae38e39
s_mov_b32 s77, 0x3727c5ac
s_mov_b32 s75, 0xffff0000
s_cmp_eq_u32 s37, 0
s_cbranch_scc0 F_W1
s_waitcnt vmcnt(10)
s_branch F_W2
F_W1:
s_waitcnt vmcnt(18)
F_W2:
v_lshlrev_b32 v40, 16, v18
v_and_b32 v41, s75, v18
v_lshlrev_b32 v42, 16, v19
v_and_b32 v43, s75, v19
v_lshlrev_b32 v44, 16, v20
v_and_b32 v45, s75, v20
v_lshlrev_b32 v46, 16, v21
v_and_b32 v47, s75, v21
v_lshlrev_b32 v48, 16, v22
v_and_b32 v49, s75, v22
v_lshlrev_b32 v50, 16, v23
v_and_b32 v51, s75, v23
v_lshlrev_b32 v52, 16, v24
v_and_b32 v53, s75, v24
v_lshlrev_b32 v54, 16, v25
v_and_b32 v55, s75, v25
v_lshlrev_b32 v56, 16, v26
v_and_b32 v57, s75, v26
v_pk_add_f32 v[60:61], v[40:41], v[42:43]
v_pk_add_f32 v[62:63], v[44:45], v[46:47]
v_pk_add_f32 v[60:61], v[60:61], v[48:49]
v_pk_add_f32 v[62:63], v[62:63], v[50:51]
v_pk_add_f32 v[60:61], v[60:61], v[52:53]
v_pk_add_f32 v[62:63], v[62:63], v[54:55]
v_pk_add_f32 v[60:61], v[60:61], v[56:57]
v_pk_add_f32 v[60:61], v[60:61], v[62:63]
v_add_f32 v60, v60, v61
s_nop 1
v_add_f32_dpp v61, v60, v60 row_ror:8 row_mask:0xf bank_mask:0xf
s_nop 1
v_add_f32_dpp v60, v61, v61 row_ror:4 row_mask:0xf bank_mask:0xf
s_nop 1
v_add_f32_dpp v61, v60, v60 row_ror:2 row_mask:0xf bank_mask:0xf
s_nop 1
v_add_f32_dpp v60, v61, v61 row_ror:1 row_mask:0xf bank_mask:0xf
v_mov_b32 v61, v60
s_nop 1
v_permlane16_swap_b32 v60, v61
v_add_f32 v60, v60, v61
v_mul_f32 v60, s76, v60
v_mov_b32 v61, v60
v_pk_add_f32 v[66:67], v[40:41], v[60:61] neg_lo:[0,1] neg_hi:[0,1]
v_pk_mul_f32 v[62:63], v[66:67], v[66:67]
v_pk_add_f32 v[68:69], v[42:43], v[60:61] neg_lo:[0,1] neg_hi:[0,1]
v_pk_fma_f32 v[62:63], v[68:69], v[68:69], v[62:63]
v_pk_add_f32 v[66:67], v[44:45], v[60:61] neg_lo:[0,1] neg_hi:[0,1]
v_pk_fma_f32 v[62:63], v[66:67], v[66:67], v[62:63]
v_pk_add_f32 v[68:69], v[46:47], v[60:61] neg_lo:[0,1] neg_hi:[0,1]
v_pk_fma_f32 v[62:63], v[68:69], v[68:69], v[62:63]
v_pk_add_f32 v[66:67], v[48:49], v[60:61] neg_lo:[0,1] neg_hi:[0,1]
v_pk_fma_f32 v[62:63], v[66:67], v[66:67], v[62:63]
v_pk_add_f32 v[68:69], v[50:51], v[60:61] neg_lo:[0,1] neg_hi:[0,1]
v_pk_fma_f32 v[62:63], v[68:69], v[68:69], v[62:63]
v_pk_add_f32 v[66:67], v[52:53], v[60:61] neg_lo:[0,1] neg_hi:[0,1]
v_pk_fma_f32 v[62:63], v[66:67], v[66:67], v[62:63]
v_pk_add_f32 v[68:69], v[54:55], v[60:61] neg_lo:[0,1] neg_hi:[0,1]
v_pk_fma_f32 v[62:63], v[68:69], v[68:69], v[62:63]
v_pk_add_f32 v[66:67], v[56:57], v[60:61] neg_lo:[0,1] neg_hi:[0,1]
v_pk_fma_f32 v[62:63], v[66:67], v[66:67], v[62:63]
v_add_f32 v61, v62, v63
s_nop 1
v_add_f32_dpp v62, v61, v61 row_ror:8 row_mask:0xf bank_mask:0xf
s_nop 1
v_add_f32_dpp v61, v62, v62 row_ror:4 row_mask:0xf bank_mask:0xf
s_nop 1
v_add_f32_dpp v62, v61, v61 row_ror:2 row_mask:0xf bank_mask:0xf
s_nop 1
v_add_f32_dpp v61, v62, v62 row_ror:1 row_mask:0xf bank_mask:0xf
v_mov_b32 v62, v61
s_nop 1
v_permlane16_swap_b32 v61, v62
v_add_f32 v61, v61, v62
v_mul_f32 v61, s76, v61
v_cvt_pk_bf16_f32 v60, v60, v60
v_lshlrev_b32 v60, 16, v60
v_cvt_pk_bf16_f32 v61, v61, v61
v_lshlrev_b32 v61, 16, v61
v_add_f32 v61, s77, v61
v_cvt_pk_bf16_f32 v61, v61, v61
v_lshlrev_b32 v61, 16, v61
v_sqrt_f32 v61, v61
s_nop 0
v_cvt_pk_bf16_f32 v61, v61, v61
v_lshlrev_b32 v61, 16, v61
v_rcp_f32 v62, v61
v_mov_b32 v63, 0
v_lshrrev_b32 v69, 5, v0
v_mul_u32_u24 v65, 1168, v69
v_lshl_add_u32 v65, v6, 2, v65
v_add_u32 v209, 0x24000, v65
s_cmp_eq_u32 s37, 0
s_cbranch_scc0 F_W3
s_waitcnt vmcnt(1)
F_W3:
s_waitcnt vmcnt(9)
v_mov_b32 v70, v60
v_mov_b32 v71, v60
v_mov_b32 v72, v61
v_mov_b32 v73, v61
v_mov_b32 v74, v62
v_mov_b32 v75, v62
v_pk_add_f32 v[40:41], v[40:41], v[70:71] neg_lo:[0,1] neg_hi:[0,1]
v_cvt_pk_bf16_f32 v68, v40, v41
v_lshlrev_b32 v40, 16, v68
v_and_b32 v41, s75, v68
v_pk_mul_f32 v[66:67], v[40:41], v[74:75]
v_pk_fma_f32 v[40:41], v[66:67], v[72:73], v[40:41] neg_lo:[1,0,0] neg_hi:[1,0,0]
v_pk_fma_f32 v[66:67], v[40:41], v[74:75], v[66:67]
v_cvt_pk_bf16_f32 v200, v66, v67
v_pk_mul_f32 v[66:67], v[66:67], s[40:41]
v_dot2_f32_bf16 v63, v200, v28, v63
v_cvt_pk_bf16_f32 v18, v66, v67
ds_write_b32 v209, v18 offset:0
v_pk_add_f32 v[42:43], v[42:43], v[70:71] neg_lo:[0,1] neg_hi:[0,1]
v_cvt_pk_bf16_f32 v68, v42, v43
v_lshlrev_b32 v42, 16, v68
v_and_b32 v43, s75, v68
v_pk_mul_f32 v[66:67], v[42:43], v[74:75]
v_pk_fma_f32 v[42:43], v[66:67], v[72:73], v[42:43] neg_lo:[1,0,0] neg_hi:[1,0,0]
v_pk_fma_f32 v[66:67], v[42:43], v[74:75], v[66:67]
v_cvt_pk_bf16_f32 v201, v66, v67
v_pk_mul_f32 v[66:67], v[66:67], s[40:41]
v_dot2_f32_bf16 v63, v201, v29, v63
v_cvt_pk_bf16_f32 v19, v66, v67
ds_write_b32 v209, v19 offset:128
v_pk_add_f32 v[44:45], v[44:45], v[70:71] neg_lo:[0,1] neg_hi:[0,1]
v_cvt_pk_bf16_f32 v68, v44, v45
v_lshlrev_b32 v44, 16, v68
v_and_b32 v45, s75, v68
v_pk_mul_f32 v[66:67], v[44:45], v[74:75]
v_pk_fma_f32 v[44:45], v[66:67], v[72:73], v[44:45] neg_lo:[1,0,0] neg_hi:[1,0,0]
v_pk_fma_f32 v[66:67], v[44:45], v[74:75], v[66:67]
v_cvt_pk_bf16_f32 v202, v66, v67
v_pk_mul_f32 v[66:67], v[66:67], s[40:41]
v_dot2_f32_bf16 v63, v202, v30, v63
v_cvt_pk_bf16_f32 v20, v66, v67
ds_write_b32 v209, v20 offset:256
v_pk_add_f32 v[46:47], v[46:47], v[70:71] neg_lo:[0,1] neg_hi:[0,1]
v_cvt_pk_bf16_f32 v68, v46, v47
v_lshlrev_b32 v46, 16, v68
v_and_b32 v47, s75, v68
v_pk_mul_f32 v[66:67], v[46:47], v[74:75]
v_pk_fma_f32 v[46:47], v[66:67], v[72:73], v[46:47] neg_lo:[1,0,0] neg_hi:[1,0,0]
v_pk_fma_f32 v[66:67], v[46:47], v[74:75], v[66:67]
v_cvt_pk_bf16_f32 v203, v66, v67
v_pk_mul_f32 v[66:67], v[66:67], s[40:41]
v_dot2_f32_bf16 v63, v203, v31, v63
v_cvt_pk_bf16_f32 v21, v66, v67
ds_write_b32 v209, v21 offset:384
v_pk_add_f32 v[48:49], v[48:49], v[70:71] neg_lo:[0,1] neg_hi:[0,1]
v_cvt_pk_bf16_f32 v68, v48, v49
v_lshlrev_b32 v48, 16, v68
v_and_b32 v49, s75, v68
v_pk_mul_f32 v[66:67], v[48:49], v[74:75]
v_pk_fma_f32 v[48:49], v[66:67], v[72:73], v[48:49] neg_lo:[1,0,0] neg_hi:[1,0,0]
v_pk_fma_f32 v[66:67], v[48:49], v[74:75], v[66:67]
v_cvt_pk_bf16_f32 v204, v66, v67
v_pk_mul_f32 v[66:67], v[66:67], s[40:41]
v_dot2_f32_bf16 v63, v204, v32, v63
v_cvt_pk_bf16_f32 v22, v66, v67
ds_write_b32 v209, v22 offset:512
v_pk_add_f32 v[50:51], v[50:51], v[70:71] neg_lo:[0,1] neg_hi:[0,1]
v_cvt_pk_bf16_f32 v68, v50, v51
v_lshlrev_b32 v50, 16, v68
v_and_b32 v51, s75, v68
v_pk_mul_f32 v[66:67], v[50:51], v[74:75]
v_pk_fma_f32 v[50:51], v[66:67], v[72:73], v[50:51] neg_lo:[1,0,0] neg_hi:[1,0,0]
v_pk_fma_f32 v[66:67], v[50:51], v[74:75], v[66:67]
v_cvt_pk_bf16_f32 v205, v66, v67
v_pk_mul_f32 v[66:67], v[66:67], s[40:41]
v_dot2_f32_bf16 v63, v205, v33, v63
v_cvt_pk_bf16_f32 v23, v66, v67
ds_write_b32 v209, v23 offset:640
v_pk_add_f32 v[52:53], v[52:53], v[70:71] neg_lo:[0,1] neg_hi:[0,1]
v_cvt_pk_bf16_f32 v68, v52, v53
v_lshlrev_b32 v52, 16, v68
v_and_b32 v53, s75, v68
v_pk_mul_f32 v[66:67], v[52:53], v[74:75]
v_pk_fma_f32 v[52:53], v[66:67], v[72:73], v[52:53] neg_lo:[1,0,0] neg_hi:[1,0,0]
v_pk_fma_f32 v[66:67], v[52:53], v[74:75], v[66:67]
v_cvt_pk_bf16_f32 v206, v66, v67
v_pk_mul_f32 v[66:67], v[66:67], s[40:41]
v_dot2_f32_bf16 v63, v206, v34, v63
v_cvt_pk_bf16_f32 v24, v66, v67
ds_write_b32 v209, v24 offset:768
v_pk_add_f32 v[54:55], v[54:55], v[70:71] neg_lo:[0,1] neg_hi:[0,1]
v_cvt_pk_bf16_f32 v68, v54, v55
v_lshlrev_b32 v54, 16, v68
v_and_b32 v55, s75, v68
v_pk_mul_f32 v[66:67], v[54:55], v[74:75]
v_pk_fma_f32 v[54:55], v[66:67], v[72:73], v[54:55] neg_lo:[1,0,0] neg_hi:[1,0,0]
v_pk_fma_f32 v[66:67], v[54:55], v[74:75], v[66:67]
v_cvt_pk_bf16_f32 v207, v66, v67
v_pk_mul_f32 v[66:67], v[66:67], s[40:41]
v_dot2_f32_bf16 v63, v207, v35, v63
v_cvt_pk_bf16_f32 v25, v66, v67
ds_write_b32 v209, v25 offset:896
v_pk_add_f32 v[56:57], v[56:57], v[70:71] neg_lo:[0,1] neg_hi:[0,1]
v_cvt_pk_bf16_f32 v68, v56, v57
v_lshlrev_b32 v56, 16, v68
v_and_b32 v57, s75, v68
v_pk_mul_f32 v[66:67], v[56:57], v[74:75]
v_pk_fma_f32 v[56:57], v[66:67], v[72:73], v[56:57] neg_lo:[1,0,0] neg_hi:[1,0,0]
v_pk_fma_f32 v[66:67], v[56:57], v[74:75], v[66:67]
v_cvt_pk_bf16_f32 v208, v66, v67
v_pk_mul_f32 v[66:67], v[66:67], s[40:41]
v_dot2_f32_bf16 v63, v208, v36, v63
v_cvt_pk_bf16_f32 v26, v66, v67
ds_write_b32 v209, v26 offset:1024
s_nop 2
s_nop 1
v_add_f32_dpp v62, v63, v63 row_ror:8 row_mask:0xf bank_mask:0xf
s_nop 1
v_add_f32_dpp v63, v62, v62 row_ror:4 row_mask:0xf bank_mask:0xf
s_nop 1
v_add_f32_dpp v62, v63, v63 row_ror:2 row_mask:0xf bank_mask:0xf
s_nop 1
v_add_f32_dpp v63, v62, v62 row_ror:1 row_mask:0xf bank_mask:0xf
v_mov_b32 v62, v63
s_nop 1
v_permlane16_swap_b32 v63, v62
v_add_f32 v63, v63, v62
v_cvt_pk_bf16_f32 v63, v63, v63
v_lshlrev_b32 v63, 16, v63
v_ashrrev_i32 v66, 31, v63
v_or_b32 v66, 0x80000000, v66
v_xor_b32 v63, v63, v66
v_and_b32 v63, s75, v63
v_sub_u32 v66, 0xffff, v5
v_or_b32 v63, v63, v66
v_lshlrev_b32 v66, 2, v69
v_add_u32 v66, 0x26480, v66
ds_write_b32 v66, v63
v_and_b32 v64, 7, v1
v_lshlrev_b32 v64, 2, v64
s_waitcnt lgkmcnt(0)
s_barrier
s_mul_i32 s101, s6, 0x9e3779b1
s_add_u32 s101, s101, 0x7f4a7c15
s_mul_i32 s47, s7, 0x85ebca6b
s_add_u32 s47, s47, 0x165667b1
s_cmp_eq_u32 s37, 0
s_cbranch_scc0 F_OTHER
ds_read2_b64 v[72:75], v168 offset0:0 offset1:4
ds_read2_b64 v[76:79], v168 offset0:16 offset1:20
ds_read2_b64 v[80:83], v168 offset0:32 offset1:36
ds_read2_b64 v[84:87], v168 offset0:48 offset1:52
ds_read2_b64 v[88:91], v168 offset0:64 offset1:68
ds_read2_b64 v[92:95], v168 offset0:80 offset1:84
ds_read2_b64 v[96:99], v168 offset0:96 offset1:100
ds_read2_b64 v[100:103], v168 offset0:112 offset1:116
ds_read2_b64 v[104:107], v168 offset0:128 offset1:132
v_add_u32 v65, 0x26480, v64
ds_read_b32 v65, v65
s_add_u32 s28, s45, 0x1800000
s_waitcnt lgkmcnt(9)
buffer_store_dwordx4 v[72:75], v169, s[20:23], s28 offen offset:0
s_waitcnt lgkmcnt(8)
buffer_store_dwordx4 v[76:79], v169, s[20:23], s28 offen offset:2048
s_add_u32 s28, s28, 4096
s_waitcnt lgkmcnt(7)
buffer_store_dwordx4 v[80:83], v169, s[20:23], s28 offen offset:0
s_waitcnt lgkmcnt(6)
buffer_store_dwordx4 v[84:87], v169, s[20:23], s28 offen offset:2048
s_add_u32 s28, s28, 4096
s_waitcnt lgkmcnt(5)
buffer_store_dwordx4 v[88:91], v169, s[20:23], s28 offen offset:0
s_waitcnt lgkmcnt(4)
buffer_store_dwordx4 v[92:95], v169, s[20:23], s28 offen offset:2048
s_add_u32 s28, s28, 4096
s_waitcnt lgkmcnt(3)
buffer_store_dwordx4 v[96:99], v169, s[20:23], s28 offen offset:0
s_waitcnt lgkmcnt(2)
buffer_store_dwordx4 v[100:103], v169, s[20:23], s28 offen offset:2048
s_add_u32 s28, s28, 4096
s_waitcnt lgkmcnt(1)
buffer_store_dwordx4 v[104:107], v169, s[20:23], s28 offen offset:0
s_lshl_b32 s28, s3, 2
s_add_u32 s28, s28, 0x1a40000
s_waitcnt lgkmcnt(0)
buffer_store_dword v65, v64, s[20:23], s28 offen
s_and_b32 s29, s101, -16
s_or_b32 s29, s29, s38
v_mov_b32 v58, s29
v_mov_b32 v59, s47
s_lshl_b32 s29, s35, 3
v_mov_b32 v61, s29
s_lshl_b32 s28, s36, 8
s_add_u32 s28, s28, 0x24d000
s_waitcnt vmcnt(0)
s_mov_b64 exec, 1
buffer_store_dwordx2 v[58:59], v61, s[20:23], s28 offen
s_mov_b64 exec, -1
s_branch F_JOIN
F_END0:
.p2align 12
K_P1:
F_OTHER:
STUB_0:
s_mov_b64 exec, 0
s_cmp_eq_u32 s37, 1
s_cbranch_scc1 STUB_A1
s_cmp_eq_u32 s37, 2
s_cbranch_scc1 STUB_A2
s_cmp_eq_u32 s37, 3
s_cbranch_scc1 STUB_A3
s_mov_b64 exec, -1
HOP_R1:
s_add_u32 m0, s49, 90112
s_nop 0
buffer_load_dwordx4 v238, s[16:19], s34 offen offset:0 lds
buffer_load_dwordx4 v239, s[16:19], s34 offen offset:1024 lds
s_add_u32 s34, s34, 196608
s_sub_u32 s51, s34, 4718592
s_cselect_b32 s34, s34, s51
s_add_u32 m0, s49, 96256
s_nop 0
buffer_load_dwordx4 v238, s[16:19], s34 offen offset:0 lds
buffer_load_dwordx4 v239, s[16:19], s34 offen offset:1024 lds
s_add_u32 s34, s34, 196608
s_sub_u32 s51, s34, 4718592
s_cselect_b32 s34, s34, s51
s_add_u32 m0, s49, 102400
s_nop 0
buffer_load_dwordx4 v238, s[16:19], s34 offen offset:0 lds
buffer_load_dwordx4 v239, s[16:19], s34 offen offset:1024 lds
s_add_u32 s34, s34, 196608
s_sub_u32 s51, s34, 4718592
s_cselect_b32 s34, s34, s51
s_add_u32 m0, s49, 108544
s_nop 0
buffer_load_dwordx4 v238, s[16:19], s34 offen offset:0 lds
buffer_load_dwordx4 v239, s[16:19], s34 offen offset:1024 lds
s_add_u32 s34, s34, 196608
s_sub_u32 s51, s34, 4718592
s_cselect_b32 s34, s34, s51
s_mov_b64 exec, 0
s_cmp_eq_u32 s37, 1
s_cbranch_scc1 STUB_B1
s_cmp_eq_u32 s37, 2
s_cbranch_scc1 STUB_B2
s_cmp_eq_u32 s37, 3
s_cbranch_scc1 STUB_B3
s_mov_b64 exec, -1
HOP_R2:
F_JOIN:
s_lshl_b32 s49, s37, 11
s_lshl_b32 s28, s37, 16
s_lshl_b32 s34, s35, 8
s_add_u32 s34, s34, s28
s_lshl_b32 s28, s5, 18
s_add_u32 s34, s34, s28
s_add_u32 s34, s34, 1572864
s_sub_u32 s51, s34, 4718592
s_cselect_b32 s34, s34, s51
s_lshl_b32 s30, s37, 12
s_lshl_b32 s31, s37, 10
s_lshl_b32 s92, s36, 5
s_add_u32 s92, s92, s35
s_lshl2_add_u32 s92, s92, s37
s_lshl_b32 s44, s92, 14
s_add_u32 s44, s44, 0x400000
s_mov_b32 s42, 0x5f800000
s_mov_b32 s43, 0
s_lshr_b32 s92, s35, 1
s_lshl_b32 s92, s92, 19
s_add_u32 s66, s66, s92
s_addc_u32 s67, s67, 0
s_add_u32 s68, s68, s92
s_addc_u32 s69, s69, 0
s_mov_b32 s8, s66
s_and_b32 s9, s67, 0xffff
s_mov_b32 s10, 0x80000
s_mov_b32 s11, 0x00020000
s_mov_b32 s12, s68
s_and_b32 s13, s69, 0xffff
s_mov_b32 s14, 0x80000
s_mov_b32 s15, 0x00020000
s_mov_b32 s56, s72
s_and_b32 s57, s73, 0xffff
s_mov_b32 s58, 0x480000
s_mov_b32 s59, 0x00020000
s_mov_b32 s60, s84
s_and_b32 s61, s85, 0xffff
s_mov_b32 s62, 0x240000
s_mov_b32 s63, 0x00020000
s_mov_b32 s64, s78
s_and_b32 s65, s79, 0xffff
s_mov_b32 s66, 0x510000
s_mov_b32 s67, 0x00020000
s_mov_b32 s68, s80
s_and_b32 s69, s81, 0xffff
s_mov_b32 s70, 0x510000
s_mov_b32 s71, 0x00020000
s_mov_b32 s72, s82
s_and_b32 s73, s83, 0xffff
s_mov_b32 s74, 0x510000
s_mov_b32 s75, 0x00020000
s_lshr_b32 s92, s35, 2
s_mul_i32 s89, s92, 589824
s_and_b32 s92, s35, 3
s_mul_i32 s92, s92, 288
s_add_u32 s89, s89, s92
s_cmp_eq_u32 s37, 0
s_cbranch_scc1 F_W0P
s_waitcnt vmcnt(0)
s_branch F_BAR2
HOP_RET1:
s_mov_b64 exec, -1
s_branch HOP_R1
HOP_RET2:
s_mov_b64 exec, -1
s_branch HOP_R2
F_W0P:
s_mov_b32 s46, 0x20
s_lshl_b32 s28, s36, 8
s_add_u32 s28, s28, 0x24d000
v_and_b32 v61, 31, v1
v_lshlrev_b32 v61, 3, v61
s_mov_b32 s51, 0
v_mov_b32 v60, 3
F_POLL:
buffer_load_dwordx2 v[62:63], v61, s[20:23], s28 offen sc0 sc1
s_waitcnt vmcnt(0)
v_cmp_ne_u64 vcc, v[62:63], v[58:59]
s_cbranch_vccz F_GO
s_add_u32 s51, s51, 1
s_and_b32 s29, s51, 31
s_cbranch_scc1 F_POLL
s_branch F_NOTYET
F_GO:
v_mov_b32 v61, 156864
ds_write_b32 v61, v60
s_waitcnt lgkmcnt(0)
F_BAR2:
s_barrier
s_lshl_b32 s7, s36, 31
s_mov_b32 s7, 0
v_mov_b32 v246, 156864
ds_read_b32 v246, v246
s_mov_b32 s4, 0x1800000
s_mov_b32 s51, 3
Q_START:
s_lshl_b32 s28, s5, 10
s_add_u32 s28, s28, s4
s_add_u32 s6, s4, 18432
buffer_load_dwordx4 a[0:3], v240, s[20:23], s28 offen sc0 sc1
buffer_load_dwordx4 a[4:7], v241, s[20:23], s28 offen sc0 sc1
buffer_load_dwordx4 a[8:11], v242, s[20:23], s28 offen sc0 sc1
buffer_load_dwordx4 a[12:15], v243, s[20:23], s28 offen sc0 sc1
s_waitcnt lgkmcnt(0)
v_readfirstlane_b32 s48, v246
ds_read_b64_tr_b16 a[144:145], v234 offset:0
ds_read_b64_tr_b16 a[146:147], v234 offset:4096
ds_read_b64_tr_b16 a[148:149], v234 offset:8
ds_read_b64_tr_b16 a[150:151], v234 offset:4104
ds_read_b64_tr_b16 a[152:153], v235 offset:0
ds_read_b64_tr_b16 a[154:155], v235 offset:4096
ds_read_b64_tr_b16 a[156:157], v235 offset:8
ds_read_b64_tr_b16 a[158:159], v235 offset:4104
ds_read_b64_tr_b16 a[160:161], v236 offset:0
ds_read_b64_tr_b16 a[162:163], v236 offset:4096
ds_read_b64_tr_b16 a[164:165], v236 offset:8
ds_read_b64_tr_b16 a[166:167], v236 offset:4104
ds_read_b64_tr_b16 a[168:169], v237 offset:0
ds_read_b64_tr_b16 a[170:171], v237 offset:4096
ds_read_b64_tr_b16 a[172:173], v237 offset:8
ds_read_b64_tr_b16 a[174:175], v237 offset:4104
s_cmp_lt_u32 s48, s51
s_cbranch_scc1 Q_REDO
s_add_u32 s28, s28, 1024
s_cmp_lt_u32 s28, s6
s_cselect_b32 s28, s28, s4
buffer_load_dwordx4 a[16:19], v240, s[20:23], s28 offen sc0 sc1
buffer_load_dwordx4 a[20:23], v241, s[20:23], s28 offen sc0 sc1
buffer_load_dwordx4 a[24:27], v242, s[20:23], s28 offen sc0 sc1
buffer_load_dwordx4 a[28:31], v243, s[20:23], s28 offen sc0 sc1
s_lshl_b32 s29, s36, 10
s_add_u32 s29, s29, s4
s_add_u32 s29, s29, 0x240000
buffer_load_dwordx4 v[136:139], v244, s[20:23], s29 offen sc0 sc1
s_add_u32 s28, s28, 1024
s_cmp_lt_u32 s28, s6
s_cselect_b32 s28, s28, s4
buffer_load_dwordx4 a[32:35], v240, s[20:23], s28 offen sc0 sc1
buffer_load_dwordx4 a[36:39], v241, s[20:23], s28 offen sc0 sc1
buffer_load_dwordx4 a[40:43], v242, s[20:23], s28 offen sc0 sc1
buffer_load_dwordx4 a[44:47], v243, s[20:23], s28 offen sc0 sc1
s_waitcnt vmcnt(9)
s_waitcnt lgkmcnt(8)
v_mfma_f32_16x16x32_bf16 v[8:11], a[144:147], a[0:3], 0
ds_read_b64_tr_b16 a[176:177], v234 offset:8192
v_mov_b32 v143, 0
v_mfma_f32_16x16x32_bf16 v[40:43], a[144:147], a[4:7], 0
ds_read_b64_tr_b16 a[178:179], v234 offset:12288
ds_write_b32 v209, v200 offset:0
v_mfma_f32_16x16x32_bf16 v[72:75], a[144:147], a[8:11], 0
s_add_u32 s28, s28, 1024
s_cmp_lt_u32 s28, s6
s_cselect_b32 s28, s28, s4
v_mfma_f32_16x16x32_bf16 v[104:107], a[144:147], a[12:15], 0
ds_read_b64_tr_b16 a[180:181], v234 offset:8200
ds_write_b32 v209, v201 offset:128
v_mfma_f32_16x16x32_bf16 v[108:111], a[148:151], a[12:15], 0
ds_read_b64_tr_b16 a[182:183], v234 offset:12296
ds_write_b32 v209, v202 offset:256
v_mfma_f32_16x16x32_bf16 v[76:79], a[148:151], a[8:11], 0
buffer_load_dwordx4 a[48:51], v240, s[20:23], s28 offen sc0 sc1
v_mfma_f32_16x16x32_bf16 v[44:47], a[148:151], a[4:7], 0
ds_read_b64_tr_b16 a[184:185], v235 offset:8192
ds_write_b32 v209, v203 offset:384
v_mfma_f32_16x16x32_bf16 v[12:15], a[148:151], a[0:3], 0
ds_read_b64_tr_b16 a[186:187], v235 offset:12288
ds_write_b32 v209, v204 offset:512
v_mfma_f32_16x16x32_bf16 v[16:19], a[152:155], a[0:3], 0
buffer_load_dwordx4 a[52:55], v241, s[20:23], s28 offen sc0 sc1
v_mfma_f32_16x16x32_bf16 v[48:51], a[152:155], a[4:7], 0
ds_read_b64_tr_b16 a[188:189], v235 offset:8200
ds_write_b32 v209, v205 offset:640
v_mfma_f32_16x16x32_bf16 v[80:83], a[152:155], a[8:11], 0
ds_read_b64_tr_b16 a[190:191], v235 offset:12296
ds_write_b32 v209, v206 offset:768
v_mfma_f32_16x16x32_bf16 v[112:115], a[152:155], a[12:15], 0
buffer_load_dwordx4 a[56:59], v242, s[20:23], s28 offen sc0 sc1
v_mfma_f32_16x16x32_bf16 v[116:119], a[156:159], a[12:15], 0
ds_read_b64_tr_b16 a[192:193], v236 offset:8192
ds_write_b32 v209, v207 offset:896
v_mfma_f32_16x16x32_bf16 v[84:87], a[156:159], a[8:11], 0
buffer_load_dwordx4 a[60:63], v243, s[20:23], s28 offen sc0 sc1
v_mfma_f32_16x16x32_bf16 v[52:55], a[156:159], a[4:7], 0
ds_read_b64_tr_b16 a[194:195], v236 offset:12288
ds_write_b32 v209, v208 offset:1024
v_mfma_f32_16x16x32_bf16 v[20:23], a[156:159], a[0:3], 0
ds_read_b64_tr_b16 a[196:197], v236 offset:8200
v_add_u32 v184, 0, v4
s_waitcnt lgkmcnt(8)
v_mfma_f32_16x16x32_bf16 v[24:27], a[160:163], a[0:3], 0
s_add_u32 s28, s28, 1024
s_cmp_lt_u32 s28, s6
s_cselect_b32 s28, s28, s4
v_mfma_f32_16x16x32_bf16 v[56:59], a[160:163], a[4:7], 0
ds_read_b64_tr_b16 a[198:199], v236 offset:12296
v_xor_b32 v184, v184, v3
v_mfma_f32_16x16x32_bf16 v[88:91], a[160:163], a[8:11], 0
ds_read_b64_tr_b16 a[200:201], v237 offset:8192
v_lshlrev_b32 v184, 4, v184
v_mfma_f32_16x16x32_bf16 v[120:123], a[160:163], a[12:15], 0
buffer_load_dwordx4 a[64:67], v240, s[20:23], s28 offen sc0 sc1
v_mfma_f32_16x16x32_bf16 v[124:127], a[164:167], a[12:15], 0
ds_read_b64_tr_b16 a[202:203], v237 offset:12288
v_lshl_add_u32 v184, v3, 8, v184
v_mfma_f32_16x16x32_bf16 v[92:95], a[164:167], a[8:11], 0
ds_read_b64_tr_b16 a[204:205], v237 offset:8200
v_add_u32 v216, 0x10000, v184
v_mfma_f32_16x16x32_bf16 v[60:63], a[164:167], a[4:7], 0
buffer_load_dwordx4 a[68:71], v241, s[20:23], s28 offen sc0 sc1
v_mfma_f32_16x16x32_bf16 v[28:31], a[164:167], a[0:3], 0
ds_read_b64_tr_b16 a[206:207], v237 offset:12296
v_add_u32 v184, 4, v4
v_mfma_f32_16x16x32_bf16 v[32:35], a[168:171], a[0:3], 0
buffer_load_dwordx4 a[72:75], v242, s[20:23], s28 offen sc0 sc1
v_mfma_f32_16x16x32_bf16 v[64:67], a[168:171], a[4:7], 0
buffer_load_dwordx4 a[76:79], v243, s[20:23], s28 offen sc0 sc1
v_mfma_f32_16x16x32_bf16 v[96:99], a[168:171], a[8:11], 0
s_add_u32 m0, s49, 114688
v_xor_b32 v184, v184, v3
v_mfma_f32_16x16x32_bf16 v[128:131], a[168:171], a[12:15], 0
buffer_load_dwordx4 v238, s[16:19], s34 offen offset:0 lds
v_mfma_f32_16x16x32_bf16 v[132:135], a[172:175], a[12:15], 0
buffer_load_dwordx4 v239, s[16:19], s34 offen offset:1024 lds
v_mfma_f32_16x16x32_bf16 v[100:103], a[172:175], a[8:11], 0
s_add_u32 s34, s34, 262144
s_sub_u32 s51, s34, 4718592
s_cselect_b32 s34, s34, s51
v_mfma_f32_16x16x32_bf16 v[68:71], a[172:175], a[4:7], 0
s_mov_b32 s90, 0x01010101
s_mov_b32 s91, 0x01010101
v_mfma_f32_16x16x32_bf16 v[36:39], a[172:175], a[0:3], 0
v_lshlrev_b32 v184, 4, v184
v_lshl_add_u32 v184, v3, 8, v184
s_waitcnt vmcnt(15)
v_mfma_f32_16x16x32_bf16 v[8:11], a[176:179], a[16:19], v[8:11]
ds_read_b64_tr_b16 a[144:145], v234 offset:16384
v_add_u32 v217, 0x10000, v184
v_mfma_f32_16x16x32_bf16 v[40:43], a[176:179], a[20:23], v[40:43]
ds_read_b64_tr_b16 a[146:147], v234 offset:20480
v_add_u32 v184, 8, v4
v_mfma_f32_16x16x32_bf16 v[72:75], a[176:179], a[24:27], v[72:75]
s_add_u32 s28, s28, 1024
s_cmp_lt_u32 s28, s6
s_cselect_b32 s28, s28, s4
v_mfma_f32_16x16x32_bf16 v[104:107], a[176:179], a[28:31], v[104:107]
ds_read_b64_tr_b16 a[148:149], v234 offset:16392
v_xor_b32 v184, v184, v3
v_mfma_f32_16x16x32_bf16 v[108:111], a[180:183], a[28:31], v[108:111]
ds_read_b64_tr_b16 a[150:151], v234 offset:20488
v_lshlrev_b32 v184, 4, v184
v_mfma_f32_16x16x32_bf16 v[76:79], a[180:183], a[24:27], v[76:79]
buffer_load_dwordx4 a[80:83], v240, s[20:23], s28 offen sc0 sc1
v_mfma_f32_16x16x32_bf16 v[44:47], a[180:183], a[20:23], v[44:47]
ds_read_b64_tr_b16 a[152:153], v235 offset:16384
v_lshl_add_u32 v184, v3, 8, v184
v_mfma_f32_16x16x32_bf16 v[12:15], a[180:183], a[16:19], v[12:15]
ds_read_b64_tr_b16 a[154:155], v235 offset:20480
v_add_u32 v218, 0x10000, v184
v_mfma_f32_16x16x32_bf16 v[16:19], a[184:187], a[16:19], v[16:19]
buffer_load_dwordx4 a[84:87], v241, s[20:23], s28 offen sc0 sc1
v_mfma_f32_16x16x32_bf16 v[48:51], a[184:187], a[20:23], v[48:51]
ds_read_b64_tr_b16 a[156:157], v235 offset:16392
v_add_u32 v184, 12, v4
v_mfma_f32_16x16x32_bf16 v[80:83], a[184:187], a[24:27], v[80:83]
ds_read_b64_tr_b16 a[158:159], v235 offset:20488
v_xor_b32 v184, v184, v3
v_mfma_f32_16x16x32_bf16 v[112:115], a[184:187], a[28:31], v[112:115]
buffer_load_dwordx4 a[88:91], v242, s[20:23], s28 offen sc0 sc1
s_waitcnt lgkmcnt(8)
v_mfma_f32_16x16x32_bf16 v[116:119], a[188:191], a[28:31], v[116:119]
ds_read_b64_tr_b16 a[160:161], v236 offset:16384
v_lshlrev_b32 v184, 4, v184
v_mfma_f32_16x16x32_bf16 v[84:87], a[188:191], a[24:27], v[84:87]
buffer_load_dwordx4 a[92:95], v243, s[20:23], s28 offen sc0 sc1
v_mfma_f32_16x16x32_bf16 v[52:55], a[188:191], a[20:23], v[52:55]
ds_read_b64_tr_b16 a[162:163], v236 offset:20480
v_lshl_add_u32 v184, v3, 8, v184
v_mfma_f32_16x16x32_bf16 v[20:23], a[188:191], a[16:19], v[20:23]
ds_read_b64_tr_b16 a[164:165], v236 offset:16392
v_add_u32 v219, 0x10000, v184
v_mfma_f32_16x16x32_bf16 v[24:27], a[192:195], a[16:19], v[24:27]
s_add_u32 m0, s49, 122880
v_bfe_u32 v184, v1, 2, 2
v_mfma_f32_16x16x32_bf16 v[56:59], a[192:195], a[20:23], v[56:59]
ds_read_b64_tr_b16 a[166:167], v236 offset:20488
v_and_b32 v185, 3, v1
v_mfma_f32_16x16x32_bf16 v[88:91], a[192:195], a[24:27], v[88:91]
ds_read_b64_tr_b16 a[168:169], v237 offset:16384
v_lshl_add_u32 v186, v4, 2, v184
v_mfma_f32_16x16x32_bf16 v[120:123], a[192:195], a[28:31], v[120:123]
s_waitcnt vmcnt(18)
v_max3_u32 v140, v136, v137, v138
v_mfma_f32_16x16x32_bf16 v[124:127], a[196:199], a[28:31], v[124:127]
ds_read_b64_tr_b16 a[170:171], v237 offset:20480
v_max_u32 v140, v140, v139
v_mfma_f32_16x16x32_bf16 v[92:95], a[196:199], a[24:27], v[92:95]
ds_read_b64_tr_b16 a[172:173], v237 offset:16392
v_and_b32 v187, 7, v186
v_mfma_f32_16x16x32_bf16 v[60:63], a[196:199], a[20:23], v[60:63]
buffer_load_dwordx4 v238, s[16:19], s34 offen offset:0 lds
v_mfma_f32_16x16x32_bf16 v[28:31], a[196:199], a[16:19], v[28:31]
ds_read_b64_tr_b16 a[174:175], v237 offset:20488
v_max_u32_dpp v141, v140, v140 row_ror:8 row_mask:0xf bank_mask:0xf
v_mfma_f32_16x16x32_bf16 v[32:35], a[200:203], a[16:19], v[32:35]
buffer_load_dwordx4 v239, s[16:19], s34 offen offset:1024 lds
v_mfma_f32_16x16x32_bf16 v[64:67], a[200:203], a[20:23], v[64:67]
v_max_u32_dpp v140, v141, v141 row_ror:4 row_mask:0xf bank_mask:0xf
v_lshlrev_b32 v188, 8, v186
v_mfma_f32_16x16x32_bf16 v[96:99], a[200:203], a[24:27], v[96:99]
s_add_u32 s34, s34, 262144
s_sub_u32 s51, s34, 4718592
s_cselect_b32 s34, s34, s51
v_mfma_f32_16x16x32_bf16 v[128:131], a[200:203], a[28:31], v[128:131]
v_max_u32_dpp v141, v140, v140 row_ror:2 row_mask:0xf bank_mask:0xf
v_lshl_add_u32 v188, v185, 3, v188
v_mfma_f32_16x16x32_bf16 v[132:135], a[204:207], a[28:31], v[132:135]
v_add_u32 v188, 0x18000, v188
v_xor_b32 v189, 0, v187
v_mfma_f32_16x16x32_bf16 v[100:103], a[204:207], a[24:27], v[100:103]
v_max_u32_dpp v140, v141, v141 row_ror:1 row_mask:0xf bank_mask:0xf
v_mov_b32 v141, v140
v_mfma_f32_16x16x32_bf16 v[68:71], a[204:207], a[20:23], v[68:71]
v_lshl_add_u32 v220, v189, 5, v188
v_xor_b32 v189, 1, v187
v_mfma_f32_16x16x32_bf16 v[36:39], a[204:207], a[16:19], v[36:39]
v_permlane16_swap_b32 v140, v141
v_max_u32 v140, v140, v141
s_waitcnt vmcnt(16)
s_waitcnt lgkmcnt(8)
v_mfma_f32_16x16x32_bf16 v[8:11], a[144:147], a[32:35], v[8:11]
ds_read_b64_tr_b16 a[176:177], v234 offset:24576
v_mov_b32 v141, v140
v_mfma_f32_16x16x32_bf16 v[40:43], a[144:147], a[36:39], v[40:43]
ds_read_b64_tr_b16 a[178:179], v234 offset:28672
v_lshl_add_u32 v221, v189, 5, v188
v_mfma_f32_16x16x32_bf16 v[72:75], a[144:147], a[40:43], v[72:75]
s_add_u32 s28, s28, 1024
s_cmp_lt_u32 s28, s6
s_cselect_b32 s28, s28, s4
v_mfma_f32_16x16x32_bf16 v[104:107], a[144:147], a[44:47], v[104:107]
ds_read_b64_tr_b16 a[180:181], v234 offset:24584
v_permlane32_swap_b32 v140, v141
v_mfma_f32_16x16x32_bf16 v[108:111], a[148:151], a[44:47], v[108:111]
ds_read_b64_tr_b16 a[182:183], v234 offset:28680
v_max_u32 v140, v140, v141
v_mfma_f32_16x16x32_bf16 v[76:79], a[148:151], a[40:43], v[76:79]
buffer_load_dwordx4 a[96:99], v240, s[20:23], s28 offen sc0 sc1
v_mfma_f32_16x16x32_bf16 v[44:47], a[148:151], a[36:39], v[44:47]
ds_read_b64_tr_b16 a[184:185], v235 offset:24576
v_add_u32 v143, v143, v140
v_mfma_f32_16x16x32_bf16 v[12:15], a[148:151], a[32:35], v[12:15]
ds_read_b64_tr_b16 a[186:187], v235 offset:28672
v_sub_u32 v136, v136, v140
v_mfma_f32_16x16x32_bf16 v[16:19], a[152:155], a[32:35], v[16:19]
buffer_load_dwordx4 a[100:103], v241, s[20:23], s28 offen sc0 sc1
v_mfma_f32_16x16x32_bf16 v[48:51], a[152:155], a[36:39], v[48:51]
ds_read_b64_tr_b16 a[188:189], v235 offset:24584
v_sub_u32 v137, v137, v140
v_mfma_f32_16x16x32_bf16 v[80:83], a[152:155], a[40:43], v[80:83]
ds_read_b64_tr_b16 a[190:191], v235 offset:28680
v_sub_u32 v138, v138, v140
v_mfma_f32_16x16x32_bf16 v[112:115], a[152:155], a[44:47], v[112:115]
buffer_load_dwordx4 a[104:107], v242, s[20:23], s28 offen sc0 sc1
v_mfma_f32_16x16x32_bf16 v[116:119], a[156:159], a[44:47], v[116:119]
ds_read_b64_tr_b16 a[192:193], v236 offset:24576
v_sub_u32 v139, v139, v140
v_mfma_f32_16x16x32_bf16 v[84:87], a[156:159], a[40:43], v[84:87]
buffer_load_dwordx4 a[108:111], v243, s[20:23], s28 offen sc0 sc1
v_mfma_f32_16x16x32_bf16 v[52:55], a[156:159], a[36:39], v[52:55]
ds_read_b64_tr_b16 a[194:195], v236 offset:28672
v_cndmask_b32 v142, v142, v143, s[90:91]
v_mfma_f32_16x16x32_bf16 v[20:23], a[156:159], a[32:35], v[20:23]
ds_read_b64_tr_b16 a[196:197], v236 offset:24584
s_lshl_b64 s[90:91], s[90:91], 1
s_waitcnt lgkmcnt(8)
v_mfma_f32_16x16x32_bf16 v[24:27], a[160:163], a[32:35], v[24:27]
s_add_u32 m0, s49, 131072
v_max3_u32 v140, v136, v137, v138
v_mfma_f32_16x16x32_bf16 v[56:59], a[160:163], a[36:39], v[56:59]
ds_read_b64_tr_b16 a[198:199], v236 offset:28680
v_max_u32 v140, v140, v139
v_mfma_f32_16x16x32_bf16 v[88:91], a[160:163], a[40:43], v[88:91]
ds_read_b64_tr_b16 a[200:201], v237 offset:24576
v_xor_b32 v189, 2, v187
v_mfma_f32_16x16x32_bf16 v[120:123], a[160:163], a[44:47], v[120:123]
v_max_u32_dpp v141, v140, v140 row_ror:8 row_mask:0xf bank_mask:0xf
v_lshl_add_u32 v222, v189, 5, v188
v_mfma_f32_16x16x32_bf16 v[124:127], a[164:167], a[44:47], v[124:127]
ds_read_b64_tr_b16 a[202:203], v237 offset:28672
v_xor_b32 v189, 3, v187
v_mfma_f32_16x16x32_bf16 v[92:95], a[164:167], a[40:43], v[92:95]
ds_read_b64_tr_b16 a[204:205], v237 offset:24584
v_max_u32_dpp v140, v141, v141 row_ror:4 row_mask:0xf bank_mask:0xf
v_mfma_f32_16x16x32_bf16 v[60:63], a[164:167], a[36:39], v[60:63]
buffer_load_dwordx4 v238, s[16:19], s34 offen offset:0 lds
v_mfma_f32_16x16x32_bf16 v[28:31], a[164:167], a[32:35], v[28:31]
ds_read_b64_tr_b16 a[206:207], v237 offset:28680
v_max_u32_dpp v141, v140, v140 row_ror:2 row_mask:0xf bank_mask:0xf
v_mfma_f32_16x16x32_bf16 v[32:35], a[168:171], a[32:35], v[32:35]
buffer_load_dwordx4 v239, s[16:19], s34 offen offset:1024 lds
v_mfma_f32_16x16x32_bf16 v[64:67], a[168:171], a[36:39], v[64:67]
v_max_u32_dpp v140, v141, v141 row_ror:1 row_mask:0xf bank_mask:0xf
v_mov_b32 v141, v140
v_mfma_f32_16x16x32_bf16 v[96:99], a[168:171], a[40:43], v[96:99]
s_add_u32 s34, s34, 262144
s_sub_u32 s51, s34, 4718592
s_cselect_b32 s34, s34, s51
v_mfma_f32_16x16x32_bf16 v[128:131], a[168:171], a[44:47], v[128:131]
v_permlane16_swap_b32 v140, v141
v_max_u32 v140, v140, v141
v_mfma_f32_16x16x32_bf16 v[132:135], a[172:175], a[44:47], v[132:135]
v_mov_b32 v141, v140
v_lshl_add_u32 v223, v189, 5, v188
v_mfma_f32_16x16x32_bf16 v[100:103], a[172:175], a[40:43], v[100:103]
v_xor_b32 v189, 4, v187
v_lshl_add_u32 v224, v189, 5, v188
v_mfma_f32_16x16x32_bf16 v[68:71], a[172:175], a[36:39], v[68:71]
v_permlane32_swap_b32 v140, v141
v_max_u32 v140, v140, v141
v_mfma_f32_16x16x32_bf16 v[36:39], a[172:175], a[32:35], v[36:39]
v_add_u32 v143, v143, v140
v_sub_u32 v136, v136, v140
s_waitcnt vmcnt(18)
v_mfma_f32_16x16x32_bf16 v[8:11], a[176:179], a[48:51], v[8:11]
ds_read_b64_tr_b16 a[144:145], v234 offset:32768
v_sub_u32 v137, v137, v140
v_mfma_f32_16x16x32_bf16 v[40:43], a[176:179], a[52:55], v[40:43]
ds_read_b64_tr_b16 a[146:147], v234 offset:36864
v_sub_u32 v138, v138, v140
v_mfma_f32_16x16x32_bf16 v[72:75], a[176:179], a[56:59], v[72:75]
s_add_u32 s28, s28, 1024
s_cmp_lt_u32 s28, s6
s_cselect_b32 s28, s28, s4
v_mfma_f32_16x16x32_bf16 v[104:107], a[176:179], a[60:63], v[104:107]
ds_read_b64_tr_b16 a[148:149], v234 offset:32776
v_sub_u32 v139, v139, v140
s_waitcnt lgkmcnt(8)
v_mfma_f32_16x16x32_bf16 v[108:111], a[180:183], a[60:63], v[108:111]
ds_read_b64_tr_b16 a[150:151], v234 offset:36872
v_cndmask_b32 v142, v142, v143, s[90:91]
v_mfma_f32_16x16x32_bf16 v[76:79], a[180:183], a[56:59], v[76:79]
buffer_load_dwordx4 a[112:115], v240, s[20:23], s28 offen sc0 sc1
v_mfma_f32_16x16x32_bf16 v[44:47], a[180:183], a[52:55], v[44:47]
ds_read_b64_tr_b16 a[152:153], v235 offset:32768
s_lshl_b64 s[90:91], s[90:91], 1
v_mfma_f32_16x16x32_bf16 v[12:15], a[180:183], a[48:51], v[12:15]
ds_read_b64_tr_b16 a[154:155], v235 offset:36864
v_max3_u32 v140, v136, v137, v138
v_mfma_f32_16x16x32_bf16 v[16:19], a[184:187], a[48:51], v[16:19]
buffer_load_dwordx4 a[116:119], v241, s[20:23], s28 offen sc0 sc1
v_mfma_f32_16x16x32_bf16 v[48:51], a[184:187], a[52:55], v[48:51]
ds_read_b64_tr_b16 a[156:157], v235 offset:32776
v_max_u32 v140, v140, v139
v_mfma_f32_16x16x32_bf16 v[80:83], a[184:187], a[56:59], v[80:83]
ds_read_b64_tr_b16 a[158:159], v235 offset:36872
v_xor_b32 v189, 5, v187
v_mfma_f32_16x16x32_bf16 v[112:115], a[184:187], a[60:63], v[112:115]
buffer_load_dwordx4 a[120:123], v242, s[20:23], s28 offen sc0 sc1
v_mfma_f32_16x16x32_bf16 v[116:119], a[188:191], a[60:63], v[116:119]
ds_read_b64_tr_b16 a[160:161], v236 offset:32768
v_max_u32_dpp v141, v140, v140 row_ror:8 row_mask:0xf bank_mask:0xf
v_mfma_f32_16x16x32_bf16 v[84:87], a[188:191], a[56:59], v[84:87]
buffer_load_dwordx4 a[124:127], v243, s[20:23], s28 offen sc0 sc1
v_mfma_f32_16x16x32_bf16 v[52:55], a[188:191], a[52:55], v[52:55]
ds_read_b64_tr_b16 a[162:163], v236 offset:36864
v_max_u32_dpp v140, v141, v141 row_ror:4 row_mask:0xf bank_mask:0xf
v_mfma_f32_16x16x32_bf16 v[20:23], a[188:191], a[48:51], v[20:23]
ds_read_b64_tr_b16 a[164:165], v236 offset:32776
v_lshl_add_u32 v225, v189, 5, v188
v_mfma_f32_16x16x32_bf16 v[24:27], a[192:195], a[48:51], v[24:27]
s_add_u32 m0, s49, 139264
v_max_u32_dpp v141, v140, v140 row_ror:2 row_mask:0xf bank_mask:0xf
v_mfma_f32_16x16x32_bf16 v[56:59], a[192:195], a[52:55], v[56:59]
ds_read_b64_tr_b16 a[166:167], v236 offset:36872
v_xor_b32 v189, 6, v187
v_mfma_f32_16x16x32_bf16 v[88:91], a[192:195], a[56:59], v[88:91]
ds_read_b64_tr_b16 a[168:169], v237 offset:32768
v_max_u32_dpp v140, v141, v141 row_ror:1 row_mask:0xf bank_mask:0xf
v_mfma_f32_16x16x32_bf16 v[120:123], a[192:195], a[60:63], v[120:123]
v_mov_b32 v141, v140
v_lshl_add_u32 v226, v189, 5, v188
s_waitcnt lgkmcnt(8)
v_mfma_f32_16x16x32_bf16 v[124:127], a[196:199], a[60:63], v[124:127]
ds_read_b64_tr_b16 a[170:171], v237 offset:36864
v_xor_b32 v189, 7, v187
v_mfma_f32_16x16x32_bf16 v[92:95], a[196:199], a[56:59], v[92:95]
ds_read_b64_tr_b16 a[172:173], v237 offset:32776
v_permlane16_swap_b32 v140, v141
v_mfma_f32_16x16x32_bf16 v[60:63], a[196:199], a[52:55], v[60:63]
buffer_load_dwordx4 v238, s[16:19], s34 offen offset:0 lds
v_mfma_f32_16x16x32_bf16 v[28:31], a[196:199], a[48:51], v[28:31]
ds_read_b64_tr_b16 a[174:175], v237 offset:36872
v_max_u32 v140, v140, v141
v_mfma_f32_16x16x32_bf16 v[32:35], a[200:203], a[48:51], v[32:35]
buffer_load_dwordx4 v239, s[16:19], s34 offen offset:1024 lds
v_mfma_f32_16x16x32_bf16 v[64:67], a[200:203], a[52:55], v[64:67]
v_mov_b32 v141, v140
v_lshl_add_u32 v227, v189, 5, v188
v_mfma_f32_16x16x32_bf16 v[96:99], a[200:203], a[56:59], v[96:99]
s_add_u32 s34, s34, 262144
s_sub_u32 s51, s34, 4718592
s_cselect_b32 s34, s34, s51
v_mfma_f32_16x16x32_bf16 v[128:131], a[200:203], a[60:63], v[128:131]
v_permlane32_swap_b32 v140, v141
v_max_u32 v140, v140, v141
v_mfma_f32_16x16x32_bf16 v[132:135], a[204:207], a[60:63], v[132:135]
v_add_u32 v143, v143, v140
v_sub_u32 v136, v136, v140
v_mfma_f32_16x16x32_bf16 v[100:103], a[204:207], a[56:59], v[100:103]
v_sub_u32 v137, v137, v140
v_sub_u32 v138, v138, v140
v_mfma_f32_16x16x32_bf16 v[68:71], a[204:207], a[52:55], v[68:71]
v_sub_u32 v139, v139, v140
v_cndmask_b32 v142, v142, v143, s[90:91]
v_mfma_f32_16x16x32_bf16 v[36:39], a[204:207], a[48:51], v[36:39]
s_lshl_b64 s[90:91], s[90:91], 1
v_add_u32 v184, 0, v4
s_waitcnt vmcnt(20)
v_mfma_f32_16x16x32_bf16 v[8:11], a[144:147], a[64:67], v[8:11]
ds_read_b64_tr_b16 a[176:177], v234 offset:40960
v_max3_u32 v140, v136, v137, v138
v_mfma_f32_16x16x32_bf16 v[40:43], a[144:147], a[68:71], v[40:43]
ds_read_b64_tr_b16 a[178:179], v234 offset:45056
v_max_u32 v140, v140, v139
v_mfma_f32_16x16x32_bf16 v[72:75], a[144:147], a[72:75], v[72:75]
s_add_u32 s28, s28, 1024
s_cmp_lt_u32 s28, s6
s_cselect_b32 s28, s28, s4
v_mfma_f32_16x16x32_bf16 v[104:107], a[144:147], a[76:79], v[104:107]
ds_read_b64_tr_b16 a[180:181], v234 offset:40968
v_max_u32_dpp v141, v140, v140 row_ror:8 row_mask:0xf bank_mask:0xf
v_mfma_f32_16x16x32_bf16 v[108:111], a[148:151], a[76:79], v[108:111]
ds_read_b64_tr_b16 a[182:183], v234 offset:45064
v_xor_b32 v184, v184, v3
v_mfma_f32_16x16x32_bf16 v[76:79], a[148:151], a[72:75], v[76:79]
buffer_load_dwordx4 a[0:3], v240, s[20:23], s28 offen sc0 sc1
v_mfma_f32_16x16x32_bf16 v[44:47], a[148:151], a[68:71], v[44:47]
ds_read_b64_tr_b16 a[184:185], v235 offset:40960
v_max_u32_dpp v140, v141, v141 row_ror:4 row_mask:0xf bank_mask:0xf
v_mfma_f32_16x16x32_bf16 v[12:15], a[148:151], a[64:67], v[12:15]
ds_read_b64_tr_b16 a[186:187], v235 offset:45056
v_lshlrev_b32 v184, 4, v184
s_waitcnt lgkmcnt(8)
v_mfma_f32_16x16x32_bf16 v[16:19], a[152:155], a[64:67], v[16:19]
buffer_load_dwordx4 a[4:7], v241, s[20:23], s28 offen sc0 sc1
v_mfma_f32_16x16x32_bf16 v[48:51], a[152:155], a[68:71], v[48:51]
ds_read_b64_tr_b16 a[188:189], v235 offset:40968
v_max_u32_dpp v141, v140, v140 row_ror:2 row_mask:0xf bank_mask:0xf
v_mfma_f32_16x16x32_bf16 v[80:83], a[152:155], a[72:75], v[80:83]
ds_read_b64_tr_b16 a[190:191], v235 offset:45064
v_lshl_add_u32 v184, v4, 8, v184
v_mfma_f32_16x16x32_bf16 v[112:115], a[152:155], a[76:79], v[112:115]
buffer_load_dwordx4 a[8:11], v242, s[20:23], s28 offen sc0 sc1
v_mfma_f32_16x16x32_bf16 v[116:119], a[156:159], a[76:79], v[116:119]
ds_read_b64_tr_b16 a[192:193], v236 offset:40960
v_max_u32_dpp v140, v141, v141 row_ror:1 row_mask:0xf bank_mask:0xf
v_mfma_f32_16x16x32_bf16 v[84:87], a[156:159], a[72:75], v[84:87]
buffer_load_dwordx4 a[12:15], v243, s[20:23], s28 offen sc0 sc1
v_mfma_f32_16x16x32_bf16 v[52:55], a[156:159], a[68:71], v[52:55]
ds_read_b64_tr_b16 a[194:195], v236 offset:45056
v_mov_b32 v141, v140
v_mfma_f32_16x16x32_bf16 v[20:23], a[156:159], a[64:67], v[20:23]
ds_read_b64_tr_b16 a[196:197], v236 offset:40968
v_add_u32 v228, s30, v184
v_mfma_f32_16x16x32_bf16 v[24:27], a[160:163], a[64:67], v[24:27]
s_add_u32 m0, s49, 0
v_permlane16_swap_b32 v140, v141
v_mfma_f32_16x16x32_bf16 v[56:59], a[160:163], a[68:71], v[56:59]
ds_read_b64_tr_b16 a[198:199], v236 offset:45064
v_max_u32 v140, v140, v141
v_mfma_f32_16x16x32_bf16 v[88:91], a[160:163], a[72:75], v[88:91]
STUB_1:
STUB_A1:
s_cbranch_execz STUB_4
ds_read_b64_tr_b16 a[200:201], v237 offset:40960
v_mov_b32 v141, v140
v_mfma_f32_16x16x32_bf16 v[120:123], a[160:163], a[76:79], v[120:123]
v_add_u32 v184, 4, v4
v_xor_b32 v184, v184, v3
v_mfma_f32_16x16x32_bf16 v[124:127], a[164:167], a[76:79], v[124:127]
ds_read_b64_tr_b16 a[202:203], v237 offset:45056
v_permlane32_swap_b32 v140, v141
v_mfma_f32_16x16x32_bf16 v[92:95], a[164:167], a[72:75], v[92:95]
ds_read_b64_tr_b16 a[204:205], v237 offset:40968
v_max_u32 v140, v140, v141
v_mfma_f32_16x16x32_bf16 v[60:63], a[164:167], a[68:71], v[60:63]
buffer_load_dwordx4 v238, s[16:19], s34 offen offset:0 lds
v_mfma_f32_16x16x32_bf16 v[28:31], a[164:167], a[64:67], v[28:31]
ds_read_b64_tr_b16 a[206:207], v237 offset:45064
v_add_u32 v143, v143, v140
v_mfma_f32_16x16x32_bf16 v[32:35], a[168:171], a[64:67], v[32:35]
buffer_load_dwordx4 v239, s[16:19], s34 offen offset:1024 lds
v_mfma_f32_16x16x32_bf16 v[64:67], a[168:171], a[68:71], v[64:67]
v_sub_u32 v136, v136, v140
v_sub_u32 v137, v137, v140
v_mfma_f32_16x16x32_bf16 v[96:99], a[168:171], a[72:75], v[96:99]
s_add_u32 s34, s34, 262144
s_sub_u32 s51, s34, 4718592
s_cselect_b32 s34, s34, s51
v_mfma_f32_16x16x32_bf16 v[128:131], a[168:171], a[76:79], v[128:131]
v_sub_u32 v138, v138, v140
v_sub_u32 v139, v139, v140
s_waitcnt lgkmcnt(8)
v_mfma_f32_16x16x32_bf16 v[132:135], a[172:175], a[76:79], v[132:135]
v_cndmask_b32 v142, v142, v143, s[90:91]
v_lshlrev_b32 v184, 4, v184
v_mfma_f32_16x16x32_bf16 v[100:103], a[172:175], a[72:75], v[100:103]
s_lshl_b64 s[90:91], s[90:91], 1
v_lshl_add_u32 v184, v4, 8, v184
v_mfma_f32_16x16x32_bf16 v[68:71], a[172:175], a[68:71], v[68:71]
v_max3_u32 v140, v136, v137, v138
v_max_u32 v140, v140, v139
v_mfma_f32_16x16x32_bf16 v[36:39], a[172:175], a[64:67], v[36:39]
v_add_u32 v229, s30, v184
v_add_u32 v184, 8, v4
s_waitcnt vmcnt(20)
v_mfma_f32_16x16x32_bf16 v[8:11], a[176:179], a[80:83], v[8:11]
v_max_u32_dpp v141, v140, v140 row_ror:8 row_mask:0xf bank_mask:0xf
v_xor_b32 v184, v184, v3
v_mfma_f32_16x16x32_bf16 v[40:43], a[176:179], a[84:87], v[40:43]
s_waitcnt vmcnt(12) lgkmcnt(0)
s_barrier
v_mfma_f32_16x16x32_bf16 v[72:75], a[176:179], a[88:91], v[72:75]
ds_read_b64_tr_b16 a[144:145], v234 offset:49152
v_max_u32_dpp v140, v141, v141 row_ror:4 row_mask:0xf bank_mask:0xf
v_mfma_f32_16x16x32_bf16 v[104:107], a[176:179], a[92:95], v[104:107]
ds_read_b64_tr_b16 a[146:147], v234 offset:53248
v_lshlrev_b32 v184, 4, v184
v_mfma_f32_16x16x32_bf16 v[108:111], a[180:183], a[92:95], v[108:111]
ds_read_b64_tr_b16 a[148:149], v234 offset:49160
v_max_u32_dpp v141, v140, v140 row_ror:2 row_mask:0xf bank_mask:0xf
v_mfma_f32_16x16x32_bf16 v[76:79], a[180:183], a[88:91], v[76:79]
s_add_u32 s28, s28, 1024
s_cmp_lt_u32 s28, s6
s_cselect_b32 s28, s28, s4
v_mfma_f32_16x16x32_bf16 v[44:47], a[180:183], a[84:87], v[44:47]
ds_read_b64_tr_b16 a[150:151], v234 offset:53256
v_max_u32_dpp v140, v141, v141 row_ror:1 row_mask:0xf bank_mask:0xf
v_mfma_f32_16x16x32_bf16 v[12:15], a[180:183], a[80:83], v[12:15]
ds_read_b64_tr_b16 a[152:153], v235 offset:49152
v_mov_b32 v141, v140
v_mfma_f32_16x16x32_bf16 v[16:19], a[184:187], a[80:83], v[16:19]
buffer_load_dwordx4 a[16:19], v240, s[20:23], s28 offen sc0 sc1
v_mfma_f32_16x16x32_bf16 v[48:51], a[184:187], a[84:87], v[48:51]
ds_read_b64_tr_b16 a[154:155], v235 offset:53248
v_permlane16_swap_b32 v140, v141
v_mfma_f32_16x16x32_bf16 v[80:83], a[184:187], a[88:91], v[80:83]
ds_read_b64_tr_b16 a[156:157], v235 offset:49160
v_max_u32 v140, v140, v141
v_mfma_f32_16x16x32_bf16 v[112:115], a[184:187], a[92:95], v[112:115]
buffer_load_dwordx4 a[20:23], v241, s[20:23], s28 offen sc0 sc1
v_mfma_f32_16x16x32_bf16 v[116:119], a[188:191], a[92:95], v[116:119]
ds_read_b64_tr_b16 a[158:159], v235 offset:53256
v_mov_b32 v141, v140
v_mfma_f32_16x16x32_bf16 v[84:87], a[188:191], a[88:91], v[84:87]
ds_read_b64_tr_b16 a[160:161], v236 offset:49152
v_lshl_add_u32 v184, v4, 8, v184
v_mfma_f32_16x16x32_bf16 v[52:55], a[188:191], a[84:87], v[52:55]
ds_read_b64_tr_b16 a[162:163], v236 offset:53248
v_permlane32_swap_b32 v140, v141
v_mfma_f32_16x16x32_bf16 v[20:23], a[188:191], a[80:83], v[20:23]
buffer_load_dwordx4 a[24:27], v242, s[20:23], s28 offen sc0 sc1
v_mfma_f32_16x16x32_bf16 v[24:27], a[192:195], a[80:83], v[24:27]
ds_read_b64_tr_b16 a[164:165], v236 offset:49160
v_max_u32 v140, v140, v141
v_mfma_f32_16x16x32_bf16 v[56:59], a[192:195], a[84:87], v[56:59]
ds_read_b64_tr_b16 a[166:167], v236 offset:53256
v_add_u32 v143, v143, v140
v_mfma_f32_16x16x32_bf16 v[88:91], a[192:195], a[88:91], v[88:91]
buffer_load_dwordx4 a[28:31], v243, s[20:23], s28 offen sc0 sc1
v_mfma_f32_16x16x32_bf16 v[120:123], a[192:195], a[92:95], v[120:123]
ds_read_b64_tr_b16 a[168:169], v237 offset:49152
s_add_u32 m0, s49, 8192
v_mfma_f32_16x16x32_bf16 v[124:127], a[196:199], a[92:95], v[124:127]
ds_read_b64_tr_b16 a[170:171], v237 offset:53248
v_sub_u32 v136, v136, v140
v_mfma_f32_16x16x32_bf16 v[92:95], a[196:199], a[88:91], v[92:95]
buffer_load_dwordx4 v238, s[16:19], s34 offen offset:0 lds
v_mfma_f32_16x16x32_bf16 v[60:63], a[196:199], a[84:87], v[60:63]
ds_read_b64_tr_b16 a[172:173], v237 offset:49160
v_sub_u32 v137, v137, v140
v_mfma_f32_16x16x32_bf16 v[28:31], a[196:199], a[80:83], v[28:31]
ds_read_b64_tr_b16 a[174:175], v237 offset:53256
v_sub_u32 v138, v138, v140
v_mfma_f32_16x16x32_bf16 v[32:35], a[200:203], a[80:83], v[32:35]
buffer_load_dwordx4 v239, s[16:19], s34 offen offset:1024 lds
v_mfma_f32_16x16x32_bf16 v[64:67], a[200:203], a[84:87], v[64:67]
v_sub_u32 v139, v139, v140
v_cndmask_b32 v142, v142, v143, s[90:91]
v_mfma_f32_16x16x32_bf16 v[96:99], a[200:203], a[88:91], v[96:99]
s_add_u32 s34, s34, 262144
s_sub_u32 s51, s34, 4718592
s_cselect_b32 s34, s34, s51
v_mfma_f32_16x16x32_bf16 v[128:131], a[200:203], a[92:95], v[128:131]
s_lshl_b64 s[90:91], s[90:91], 1
v_add_u32 v230, s30, v184
v_mfma_f32_16x16x32_bf16 v[132:135], a[204:207], a[92:95], v[132:135]
v_max3_u32 v140, v136, v137, v138
v_max_u32 v140, v140, v139
v_mfma_f32_16x16x32_bf16 v[100:103], a[204:207], a[88:91], v[100:103]
v_add_u32 v184, 12, v4
v_xor_b32 v184, v184, v3
v_mfma_f32_16x16x32_bf16 v[68:71], a[204:207], a[84:87], v[68:71]
v_max_u32_dpp v141, v140, v140 row_ror:8 row_mask:0xf bank_mask:0xf
v_mov_b32 v192, 0
v_mfma_f32_16x16x32_bf16 v[36:39], a[204:207], a[80:83], v[36:39]
buffer_load_dword v193, v192, s[24:27], 0 offen sc0 sc1
s_waitcnt vmcnt(21)
s_waitcnt lgkmcnt(8)
v_mfma_f32_16x16x32_bf16 v[8:11], a[144:147], a[96:99], v[8:11]
ds_read_b64_tr_b16 a[176:177], v234 offset:57344
v_max_u32_dpp v140, v141, v141 row_ror:4 row_mask:0xf bank_mask:0xf
v_mfma_f32_16x16x32_bf16 v[40:43], a[144:147], a[100:103], v[40:43]
ds_read_b64_tr_b16 a[178:179], v234 offset:61440
v_lshlrev_b32 v184, 4, v184
v_mfma_f32_16x16x32_bf16 v[72:75], a[144:147], a[104:107], v[72:75]
s_add_u32 s28, s28, 1024
s_cmp_lt_u32 s28, s6
s_cselect_b32 s28, s28, s4
v_mfma_f32_16x16x32_bf16 v[104:107], a[144:147], a[108:111], v[104:107]
ds_read_b64_tr_b16 a[180:181], v234 offset:57352
v_max_u32_dpp v141, v140, v140 row_ror:2 row_mask:0xf bank_mask:0xf
v_mfma_f32_16x16x32_bf16 v[108:111], a[148:151], a[108:111], v[108:111]
ds_read_b64_tr_b16 a[182:183], v234 offset:61448
v_lshl_add_u32 v184, v4, 8, v184
v_mfma_f32_16x16x32_bf16 v[76:79], a[148:151], a[104:107], v[76:79]
buffer_load_dwordx4 a[32:35], v240, s[20:23], s28 offen sc0 sc1
v_mfma_f32_16x16x32_bf16 v[44:47], a[148:151], a[100:103], v[44:47]
ds_read_b64_tr_b16 a[184:185], v235 offset:57344
v_max_u32_dpp v140, v141, v141 row_ror:1 row_mask:0xf bank_mask:0xf
v_mfma_f32_16x16x32_bf16 v[12:15], a[148:151], a[96:99], v[12:15]
ds_read_b64_tr_b16 a[186:187], v235 offset:61440
v_mov_b32 v141, v140
v_mfma_f32_16x16x32_bf16 v[16:19], a[152:155], a[96:99], v[16:19]
buffer_load_dwordx4 a[36:39], v241, s[20:23], s28 offen sc0 sc1
v_mfma_f32_16x16x32_bf16 v[48:51], a[152:155], a[100:103], v[48:51]
ds_read_b64_tr_b16 a[188:189], v235 offset:57352
v_permlane16_swap_b32 v140, v141
v_mfma_f32_16x16x32_bf16 v[80:83], a[152:155], a[104:107], v[80:83]
ds_read_b64_tr_b16 a[190:191], v235 offset:61448
v_max_u32 v140, v140, v141
v_mfma_f32_16x16x32_bf16 v[112:115], a[152:155], a[108:111], v[112:115]
buffer_load_dwordx4 a[40:43], v242, s[20:23], s28 offen sc0 sc1
v_mfma_f32_16x16x32_bf16 v[116:119], a[156:159], a[108:111], v[116:119]
ds_read_b64_tr_b16 a[192:193], v236 offset:57344
v_mov_b32 v141, v140
v_mfma_f32_16x16x32_bf16 v[84:87], a[156:159], a[104:107], v[84:87]
buffer_load_dwordx4 a[44:47], v243, s[20:23], s28 offen sc0 sc1
v_mfma_f32_16x16x32_bf16 v[52:55], a[156:159], a[100:103], v[52:55]
ds_read_b64_tr_b16 a[194:195], v236 offset:61440
v_permlane32_swap_b32 v140, v141
v_mfma_f32_16x16x32_bf16 v[20:23], a[156:159], a[96:99], v[20:23]
ds_read_b64_tr_b16 a[196:197], v236 offset:57352
v_max_u32 v140, v140, v141
s_waitcnt lgkmcnt(8)
v_mfma_f32_16x16x32_bf16 v[24:27], a[160:163], a[96:99], v[24:27]
s_add_u32 m0, s49, 16384
v_add_u32 v143, v143, v140
v_mfma_f32_16x16x32_bf16 v[56:59], a[160:163], a[100:103], v[56:59]
ds_read_b64_tr_b16 a[198:199], v236 offset:61448
v_sub_u32 v136, v136, v140
v_mfma_f32_16x16x32_bf16 v[88:91], a[160:163], a[104:107], v[88:91]
ds_read_b64_tr_b16 a[200:201], v237 offset:57344
v_sub_u32 v137, v137, v140
v_mfma_f32_16x16x32_bf16 v[120:123], a[160:163], a[108:111], v[120:123]
v_sub_u32 v138, v138, v140
v_sub_u32 v139, v139, v140
v_mfma_f32_16x16x32_bf16 v[124:127], a[164:167], a[108:111], v[124:127]
ds_read_b64_tr_b16 a[202:203], v237 offset:61440
v_cndmask_b32 v142, v142, v143, s[90:91]
v_mfma_f32_16x16x32_bf16 v[92:95], a[164:167], a[104:107], v[92:95]
ds_read_b64_tr_b16 a[204:205], v237 offset:57352
s_lshl_b64 s[90:91], s[90:91], 1
v_mfma_f32_16x16x32_bf16 v[60:63], a[164:167], a[100:103], v[60:63]
buffer_load_dwordx4 v238, s[16:19], s34 offen offset:0 lds
v_mfma_f32_16x16x32_bf16 v[28:31], a[164:167], a[96:99], v[28:31]
ds_read_b64_tr_b16 a[206:207], v237 offset:61448
v_max3_u32 v140, v136, v137, v138
v_mfma_f32_16x16x32_bf16 v[32:35], a[168:171], a[96:99], v[32:35]
buffer_load_dwordx4 v239, s[16:19], s34 offen offset:1024 lds
v_mfma_f32_16x16x32_bf16 v[64:67], a[168:171], a[100:103], v[64:67]
v_max_u32 v140, v140, v139
v_add_u32 v231, s30, v184
v_mfma_f32_16x16x32_bf16 v[96:99], a[168:171], a[104:107], v[96:99]
s_add_u32 s34, s34, 262144
s_sub_u32 s51, s34, 4718592
s_cselect_b32 s34, s34, s51
v_mfma_f32_16x16x32_bf16 v[128:131], a[168:171], a[108:111], v[128:131]
v_max_u32_dpp v141, v140, v140 row_ror:8 row_mask:0xf bank_mask:0xf
v_add_u32 v184, 0, v4
v_mfma_f32_16x16x32_bf16 v[132:135], a[172:175], a[108:111], v[132:135]
v_lshlrev_b32 v184, 1, v184
v_xor_b32 v184, v184, v3
v_mfma_f32_16x16x32_bf16 v[100:103], a[172:175], a[104:107], v[100:103]
v_max_u32_dpp v140, v141, v141 row_ror:4 row_mask:0xf bank_mask:0xf
v_lshlrev_b32 v184, 4, v184
v_mfma_f32_16x16x32_bf16 v[68:71], a[172:175], a[100:103], v[68:71]
v_lshl_add_u32 v184, v4, 8, v184
v_add_u32 v232, s30, v184
v_mfma_f32_16x16x32_bf16 v[36:39], a[172:175], a[96:99], v[36:39]
v_max_u32_dpp v141, v140, v140 row_ror:2 row_mask:0xf bank_mask:0xf
v_add_u32 v184, 4, v4
s_waitcnt vmcnt(21)
v_mfma_f32_16x16x32_bf16 v[8:11], a[176:179], a[112:115], v[8:11]
v_add_u32 v234, 0x10000, v234
v_add_u32 v235, 0x10000, v235
v_mfma_f32_16x16x32_bf16 v[40:43], a[176:179], a[116:119], v[40:43]
v_add_u32 v236, 0x10000, v236
v_add_u32 v237, 0x10000, v237
v_mfma_f32_16x16x32_bf16 v[72:75], a[176:179], a[120:123], v[72:75]
v_max_u32_dpp v140, v141, v141 row_ror:1 row_mask:0xf bank_mask:0xf
v_mov_b32 v141, v140
v_mfma_f32_16x16x32_bf16 v[104:107], a[176:179], a[124:127], v[104:107]
ds_read_b64_tr_b16 a[144:145], v234 offset:0
v_lshlrev_b32 v184, 1, v184
s_waitcnt lgkmcnt(8)
v_mfma_f32_16x16x32_bf16 v[108:111], a[180:183], a[124:127], v[108:111]
ds_read_b64_tr_b16 a[146:147], v234 offset:4096
v_permlane16_swap_b32 v140, v141
v_mfma_f32_16x16x32_bf16 v[76:79], a[180:183], a[120:123], v[76:79]
ds_read_b64_tr_b16 a[148:149], v234 offset:8
v_max_u32 v140, v140, v141
v_mfma_f32_16x16x32_bf16 v[44:47], a[180:183], a[116:119], v[44:47]
s_add_u32 s28, s28, 1024
s_cmp_lt_u32 s28, s6
s_cselect_b32 s28, s28, s4
v_mfma_f32_16x16x32_bf16 v[12:15], a[180:183], a[112:115], v[12:15]
ds_read_b64_tr_b16 a[150:151], v234 offset:4104
v_mov_b32 v141, v140
v_mfma_f32_16x16x32_bf16 v[16:19], a[184:187], a[112:115], v[16:19]
ds_read_b64_tr_b16 a[152:153], v235 offset:0
v_xor_b32 v184, v184, v3
v_mfma_f32_16x16x32_bf16 v[48:51], a[184:187], a[116:119], v[48:51]
ds_read_b64_tr_b16 a[154:155], v235 offset:4096
v_permlane32_swap_b32 v140, v141
v_mfma_f32_16x16x32_bf16 v[80:83], a[184:187], a[120:123], v[80:83]
buffer_load_dwordx4 a[48:51], v240, s[20:23], s28 offen sc0 sc1
v_mfma_f32_16x16x32_bf16 v[112:115], a[184:187], a[124:127], v[112:115]
ds_read_b64_tr_b16 a[156:157], v235 offset:8
v_max_u32 v140, v140, v141
v_mfma_f32_16x16x32_bf16 v[116:119], a[188:191], a[124:127], v[116:119]
ds_read_b64_tr_b16 a[158:159], v235 offset:4104
v_add_u32 v143, v143, v140
v_mfma_f32_16x16x32_bf16 v[84:87], a[188:191], a[120:123], v[84:87]
buffer_load_dwordx4 a[52:55], v241, s[20:23], s28 offen sc0 sc1
v_mfma_f32_16x16x32_bf16 v[52:55], a[188:191], a[116:119], v[52:55]
ds_read_b64_tr_b16 a[160:161], v236 offset:0
v_sub_u32 v136, v136, v140
v_mfma_f32_16x16x32_bf16 v[20:23], a[188:191], a[112:115], v[20:23]
ds_read_b64_tr_b16 a[162:163], v236 offset:4096
v_sub_u32 v137, v137, v140
s_waitcnt lgkmcnt(8)
v_mfma_f32_16x16x32_bf16 v[24:27], a[192:195], a[112:115], v[24:27]
ds_read_b64_tr_b16 a[164:165], v236 offset:8
v_sub_u32 v138, v138, v140
v_mfma_f32_16x16x32_bf16 v[56:59], a[192:195], a[116:119], v[56:59]
buffer_load_dwordx4 a[56:59], v242, s[20:23], s28 offen sc0 sc1
v_mfma_f32_16x16x32_bf16 v[88:91], a[192:195], a[120:123], v[88:91]
ds_read_b64_tr_b16 a[166:167], v236 offset:4104
v_sub_u32 v139, v139, v140
v_mfma_f32_16x16x32_bf16 v[120:123], a[192:195], a[124:127], v[120:123]
ds_read_b64_tr_b16 a[168:169], v237 offset:0
v_cndmask_b32 v142, v142, v143, s[90:91]
v_mfma_f32_16x16x32_bf16 v[124:127], a[196:199], a[124:127], v[124:127]
ds_read_b64_tr_b16 a[170:171], v237 offset:4096
s_lshl_b64 s[90:91], s[90:91], 1
v_mfma_f32_16x16x32_bf16 v[92:95], a[196:199], a[120:123], v[92:95]
buffer_load_dwordx4 a[60:63], v243, s[20:23], s28 offen sc0 sc1
v_mfma_f32_16x16x32_bf16 v[60:63], a[196:199], a[116:119], v[60:63]
ds_read_b64_tr_b16 a[172:173], v237 offset:8
s_add_u32 m0, s49, 24576
v_mfma_f32_16x16x32_bf16 v[28:31], a[196:199], a[112:115], v[28:31]
ds_read_b64_tr_b16 a[174:175], v237 offset:4104
v_max3_u32 v140, v136, v137, v138
v_mfma_f32_16x16x32_bf16 v[32:35], a[200:203], a[112:115], v[32:35]
buffer_load_dwordx4 v238, s[16:19], s34 offen offset:0 lds
v_mfma_f32_16x16x32_bf16 v[64:67], a[200:203], a[116:119], v[64:67]
buffer_load_dwordx4 v239, s[16:19], s34 offen offset:1024 lds
v_mfma_f32_16x16x32_bf16 v[96:99], a[200:203], a[120:123], v[96:99]
v_max_u32 v140, v140, v139
v_lshlrev_b32 v184, 4, v184
v_mfma_f32_16x16x32_bf16 v[128:131], a[200:203], a[124:127], v[128:131]
s_add_u32 s34, s34, 262144
s_sub_u32 s51, s34, 4718592
s_cselect_b32 s34, s34, s51
v_mfma_f32_16x16x32_bf16 v[132:135], a[204:207], a[124:127], v[132:135]
v_max_u32_dpp v141, v140, v140 row_ror:8 row_mask:0xf bank_mask:0xf
v_lshl_add_u32 v184, v4, 8, v184
v_mfma_f32_16x16x32_bf16 v[100:103], a[204:207], a[120:123], v[100:103]
v_add_u32 v233, s30, v184
v_bfe_u32 v184, v1, 1, 1
v_mfma_f32_16x16x32_bf16 v[68:71], a[204:207], a[116:119], v[68:71]
v_max_u32_dpp v140, v141, v141 row_ror:4 row_mask:0xf bank_mask:0xf
v_lshrrev_b32 v185, 5, v1
v_mfma_f32_16x16x32_bf16 v[36:39], a[204:207], a[112:115], v[36:39]
v_cmp_eq_u32 vcc, v184, v185
v_mov_b32 v186, 0x3f803f80
s_waitcnt vmcnt(21)
v_mfma_f32_16x16x32_bf16 v[8:11], a[144:147], a[0:3], v[8:11]
v_max_u32_dpp v141, v140, v140 row_ror:2 row_mask:0xf bank_mask:0xf
v_mfma_f32_16x16x32_bf16 v[40:43], a[144:147], a[4:7], v[40:43]
s_waitcnt vmcnt(13) lgkmcnt(0)
s_barrier
v_mfma_f32_16x16x32_bf16 v[72:75], a[144:147], a[8:11], v[72:75]
ds_read_b64_tr_b16 a[176:177], v234 offset:8192
v_max_u32_dpp v140, v141, v141 row_ror:1 row_mask:0xf bank_mask:0xf
v_mfma_f32_16x16x32_bf16 v[104:107], a[144:147], a[12:15], v[104:107]
ds_read_b64_tr_b16 a[178:179], v234 offset:12288
v_mov_b32 v141, v140
v_mfma_f32_16x16x32_bf16 v[108:111], a[148:151], a[12:15], v[108:111]
ds_read_b64_tr_b16 a[180:181], v234 offset:8200
v_cndmask_b32 v186, 0, v186, vcc
v_mfma_f32_16x16x32_bf16 v[76:79], a[148:151], a[8:11], v[76:79]
s_add_u32 s28, s28, 1024
s_cmp_lt_u32 s28, s6
s_cselect_b32 s28, s28, s4
v_mfma_f32_16x16x32_bf16 v[44:47], a[148:151], a[4:7], v[44:47]
ds_read_b64_tr_b16 a[182:183], v234 offset:12296
v_permlane16_swap_b32 v140, v141
v_mfma_f32_16x16x32_bf16 v[12:15], a[148:151], a[0:3], v[12:15]
ds_read_b64_tr_b16 a[184:185], v235 offset:8192
v_max_u32 v140, v140, v141
v_mfma_f32_16x16x32_bf16 v[16:19], a[152:155], a[0:3], v[16:19]
buffer_load_dwordx4 a[64:67], v240, s[20:23], s28 offen sc0 sc1
v_mfma_f32_16x16x32_bf16 v[48:51], a[152:155], a[4:7], v[48:51]
ds_read_b64_tr_b16 a[186:187], v235 offset:12288
v_mov_b32 v141, v140
v_mfma_f32_16x16x32_bf16 v[80:83], a[152:155], a[8:11], v[80:83]
ds_read_b64_tr_b16 a[188:189], v235 offset:8200
v_and_b32 v184, 1, v1
v_mfma_f32_16x16x32_bf16 v[112:115], a[152:155], a[12:15], v[112:115]
buffer_load_dwordx4 a[68:71], v241, s[20:23], s28 offen sc0 sc1
v_mfma_f32_16x16x32_bf16 v[116:119], a[156:159], a[12:15], v[116:119]
ds_read_b64_tr_b16 a[190:191], v235 offset:12296
v_permlane32_swap_b32 v140, v141
v_mfma_f32_16x16x32_bf16 v[84:87], a[156:159], a[8:11], v[84:87]
ds_read_b64_tr_b16 a[192:193], v236 offset:8192
v_max_u32 v140, v140, v141
v_mfma_f32_16x16x32_bf16 v[52:55], a[156:159], a[4:7], v[52:55]
ds_read_b64_tr_b16 a[194:195], v236 offset:12288
v_add_u32 v143, v143, v140
v_mfma_f32_16x16x32_bf16 v[20:23], a[156:159], a[0:3], v[20:23]
buffer_load_dwordx4 a[72:75], v242, s[20:23], s28 offen sc0 sc1
v_mfma_f32_16x16x32_bf16 v[24:27], a[160:163], a[0:3], v[24:27]
ds_read_b64_tr_b16 a[196:197], v236 offset:8200
v_cndmask_b32 v142, v142, v143, s[90:91]
v_mfma_f32_16x16x32_bf16 v[56:59], a[160:163], a[4:7], v[56:59]
ds_read_b64_tr_b16 a[198:199], v236 offset:12296
v_cmp_eq_u32 vcc, 1, v184
v_mfma_f32_16x16x32_bf16 v[88:91], a[160:163], a[8:11], v[88:91]
buffer_load_dwordx4 a[76:79], v243, s[20:23], s28 offen sc0 sc1
v_mfma_f32_16x16x32_bf16 v[120:123], a[160:163], a[12:15], v[120:123]
ds_read_b64_tr_b16 a[200:201], v237 offset:8192
s_add_u32 m0, s49, 32768
v_mfma_f32_16x16x32_bf16 v[124:127], a[164:167], a[12:15], v[124:127]
ds_read_b64_tr_b16 a[202:203], v237 offset:12288
v_mov_b32 v184, 0x44444444
v_mfma_f32_16x16x32_bf16 v[92:95], a[164:167], a[8:11], v[92:95]
buffer_load_dwordx4 v238, s[16:19], s34 offen offset:0 lds
v_mfma_f32_16x16x32_bf16 v[60:63], a[164:167], a[4:7], v[60:63]
ds_read_b64_tr_b16 a[204:205], v237 offset:8200
v_mov_b32 v185, 0xeeeeeeee
v_mfma_f32_16x16x32_bf16 v[28:31], a[164:167], a[0:3], v[28:31]
ds_read_b64_tr_b16 a[206:207], v237 offset:12296
v_mfma_f32_16x16x32_bf16 v[32:35], a[168:171], a[0:3], v[32:35]
buffer_load_dwordx4 v239, s[16:19], s34 offen offset:1024 lds
v_mfma_f32_16x16x32_bf16 v[64:67], a[168:171], a[4:7], v[64:67]
v_cndmask_b32 v245, v184, v185, vcc
v_accvgpr_write_b32 a208, v186
v_mfma_f32_16x16x32_bf16 v[96:99], a[168:171], a[8:11], v[96:99]
s_add_u32 s34, s34, 262144
s_sub_u32 s51, s34, 4718592
s_cselect_b32 s34, s34, s51
v_mfma_f32_16x16x32_bf16 v[128:131], a[168:171], a[12:15], v[128:131]
v_accvgpr_write_b32 a209, v186
v_accvgpr_write_b32 a210, v186
v_mfma_f32_16x16x32_bf16 v[132:135], a[172:175], a[12:15], v[132:135]
v_accvgpr_write_b32 a211, v186
v_mfma_f32_16x16x32_bf16 v[100:103], a[172:175], a[8:11], v[100:103]
s_lshl_b32 s92, s36, 9
s_lshr_b32 s93, s35, 2
v_mfma_f32_16x16x32_bf16 v[68:71], a[172:175], a[4:7], v[68:71]
s_and_b32 s94, s35, 3
s_lshl_b32 s95, s93, 6
v_mfma_f32_16x16x32_bf16 v[36:39], a[172:175], a[0:3], v[36:39]
s_add_u32 s95, s95, s92
s_lshl2_add_u32 s95, s94, s95
s_waitcnt vmcnt(21)
s_waitcnt lgkmcnt(8)
v_mfma_f32_16x16x32_bf16 v[8:11], a[176:179], a[16:19], v[8:11]
v_add_u32 v234, 0xfffe0000, v234
v_add_u32 v235, 0xfffe0000, v235
v_mfma_f32_16x16x32_bf16 v[40:43], a[176:179], a[20:23], v[40:43]
v_add_u32 v236, 0xfffe0000, v236
v_add_u32 v237, 0xfffe0000, v237
v_mfma_f32_16x16x32_bf16 v[72:75], a[176:179], a[24:27], v[72:75]
s_add_u32 s95, s95, 0x248000
v_mfma_f32_16x16x32_bf16 v[104:107], a[176:179], a[28:31], v[104:107]
ds_read_b64_tr_b16 a[144:145], v234 offset:0
v_lshlrev_b32 v170, 4, v1
v_mfma_f32_16x16x32_bf16 v[108:111], a[180:183], a[28:31], v[108:111]
ds_read_b64_tr_b16 a[146:147], v234 offset:4096
v_add_u32 v170, s95, v170
v_mfma_f32_16x16x32_bf16 v[76:79], a[180:183], a[24:27], v[76:79]
ds_read_b64_tr_b16 a[148:149], v234 offset:8
s_lshl_b32 s95, s94, 7
v_mfma_f32_16x16x32_bf16 v[44:47], a[180:183], a[20:23], v[44:47]
s_add_u32 s28, s28, 1024
s_cmp_lt_u32 s28, s6
s_cselect_b32 s28, s28, s4
v_mfma_f32_16x16x32_bf16 v[12:15], a[180:183], a[16:19], v[12:15]
ds_read_b64_tr_b16 a[150:151], v234 offset:4104
s_add_u32 s95, s95, s92
v_mfma_f32_16x16x32_bf16 v[16:19], a[184:187], a[16:19], v[16:19]
ds_read_b64_tr_b16 a[152:153], v235 offset:0
s_lshl2_add_u32 s95, s93, s95
v_mfma_f32_16x16x32_bf16 v[48:51], a[184:187], a[20:23], v[48:51]
ds_read_b64_tr_b16 a[154:155], v235 offset:4096
s_add_u32 s95, s95, 0x249f80
v_mfma_f32_16x16x32_bf16 v[80:83], a[184:187], a[24:27], v[80:83]
buffer_load_dwordx4 a[80:83], v240, s[20:23], s28 offen sc0 sc1
v_mfma_f32_16x16x32_bf16 v[112:115], a[184:187], a[28:31], v[112:115]
ds_read_b64_tr_b16 a[156:157], v235 offset:8
v_lshlrev_b32 v184, 5, v1
v_mfma_f32_16x16x32_bf16 v[116:119], a[188:191], a[28:31], v[116:119]
ds_read_b64_tr_b16 a[158:159], v235 offset:4104
v_add_u32 v184, s95, v184
v_mfma_f32_16x16x32_bf16 v[84:87], a[188:191], a[24:27], v[84:87]
buffer_load_dwordx4 a[84:87], v241, s[20:23], s28 offen sc0 sc1
v_mfma_f32_16x16x32_bf16 v[52:55], a[188:191], a[20:23], v[52:55]
ds_read_b64_tr_b16 a[160:161], v236 offset:0
v_cmp_lt_u32 vcc, 3, v1
v_mfma_f32_16x16x32_bf16 v[20:23], a[188:191], a[16:19], v[20:23]
ds_read_b64_tr_b16 a[162:163], v236 offset:4096
s_waitcnt lgkmcnt(8)
v_mfma_f32_16x16x32_bf16 v[24:27], a[192:195], a[16:19], v[24:27]
ds_read_b64_tr_b16 a[164:165], v236 offset:8
v_cndmask_b32 v170, v170, v184, vcc
v_mfma_f32_16x16x32_bf16 v[56:59], a[192:195], a[20:23], v[56:59]
buffer_load_dwordx4 a[88:91], v242, s[20:23], s28 offen sc0 sc1
v_mfma_f32_16x16x32_bf16 v[88:91], a[192:195], a[24:27], v[88:91]
ds_read_b64_tr_b16 a[166:167], v236 offset:4104
s_mov_b32 s95, 0x7fffbff0
v_mfma_f32_16x16x32_bf16 v[120:123], a[192:195], a[28:31], v[120:123]
ds_read_b64_tr_b16 a[168:169], v237 offset:0
v_mfma_f32_16x16x32_bf16 v[124:127], a[196:199], a[28:31], v[124:127]
ds_read_b64_tr_b16 a[170:171], v237 offset:4096
v_mfma_f32_16x16x32_bf16 v[92:95], a[196:199], a[24:27], v[92:95]
buffer_load_dwordx4 a[92:95], v243, s[20:23], s28 offen sc0 sc1
v_mfma_f32_16x16x32_bf16 v[60:63], a[196:199], a[20:23], v[60:63]
ds_read_b64_tr_b16 a[172:173], v237 offset:8
s_add_u32 m0, s49, 40960
v_mfma_f32_16x16x32_bf16 v[28:31], a[196:199], a[16:19], v[28:31]
ds_read_b64_tr_b16 a[174:175], v237 offset:4104
v_mfma_f32_16x16x32_bf16 v[32:35], a[200:203], a[16:19], v[32:35]
buffer_load_dwordx4 v238, s[16:19], s34 offen offset:0 lds
v_mfma_f32_16x16x32_bf16 v[64:67], a[200:203], a[20:23], v[64:67]
buffer_load_dwordx4 v239, s[16:19], s34 offen offset:1024 lds
v_mfma_f32_16x16x32_bf16 v[96:99], a[200:203], a[24:27], v[96:99]
s_cmp_eq_u32 s2, 0
s_cselect_b32 s95, 0x242c00, s95
v_mfma_f32_16x16x32_bf16 v[128:131], a[200:203], a[28:31], v[128:131]
s_add_u32 s34, s34, 262144
s_sub_u32 s51, s34, 4718592
s_cselect_b32 s34, s34, s51
v_mfma_f32_16x16x32_bf16 v[132:135], a[204:207], a[28:31], v[132:135]
v_lshlrev_b32 v184, 7, v1
v_add_u32 v184, s95, v184
v_mfma_f32_16x16x32_bf16 v[100:103], a[204:207], a[24:27], v[100:103]
v_cmp_lt_u32 vcc, 7, v1
v_mfma_f32_16x16x32_bf16 v[68:71], a[204:207], a[20:23], v[68:71]
v_mfma_f32_16x16x32_bf16 v[36:39], a[204:207], a[16:19], v[36:39]
v_cndmask_b32 v170, v170, v184, vcc
v_mov_b32 v184, 0x7ffffff0
s_waitcnt vmcnt(20)
v_mfma_f32_16x16x32_bf16 v[8:11], a[144:147], a[32:35], v[8:11]
ds_read_b64_tr_b16 a[176:177], v234 offset:8192
v_mov_b32 v171, 0
v_mfma_f32_16x16x32_bf16 v[40:43], a[144:147], a[36:39], v[40:43]
ds_read_b64_tr_b16 a[178:179], v234 offset:12288
v_cmp_lt_u32 vcc, 9, v0
v_mfma_f32_16x16x32_bf16 v[72:75], a[144:147], a[40:43], v[72:75]
s_add_u32 s28, s28, 1024
s_cmp_lt_u32 s28, s6
s_cselect_b32 s28, s28, s4
v_mfma_f32_16x16x32_bf16 v[104:107], a[144:147], a[44:47], v[104:107]
ds_read_b64_tr_b16 a[180:181], v234 offset:8200
v_cndmask_b32 v170, v170, v184, vcc
s_waitcnt lgkmcnt(8)
v_mfma_f32_16x16x32_bf16 v[108:111], a[148:151], a[44:47], v[108:111]
ds_read_b64_tr_b16 a[182:183], v234 offset:12296
v_mov_b32 v254, 0x7ffffff0
v_mfma_f32_16x16x32_bf16 v[76:79], a[148:151], a[40:43], v[76:79]
buffer_load_dwordx4 a[96:99], v240, s[20:23], s28 offen sc0 sc1
v_mfma_f32_16x16x32_bf16 v[44:47], a[148:151], a[36:39], v[44:47]
ds_read_b64_tr_b16 a[184:185], v235 offset:8192
s_lshl_b32 s92, s36, 5
v_mfma_f32_16x16x32_bf16 v[12:15], a[148:151], a[32:35], v[12:15]
ds_read_b64_tr_b16 a[186:187], v235 offset:12288
s_add_u32 s92, s92, s35
v_mfma_f32_16x16x32_bf16 v[16:19], a[152:155], a[32:35], v[16:19]
buffer_load_dwordx4 a[100:103], v241, s[20:23], s28 offen sc0 sc1
v_mfma_f32_16x16x32_bf16 v[48:51], a[152:155], a[36:39], v[48:51]
ds_read_b64_tr_b16 a[188:189], v235 offset:8200
v_mfma_f32_16x16x32_bf16 v[80:83], a[152:155], a[40:43], v[80:83]
ds_read_b64_tr_b16 a[190:191], v235 offset:12296
v_mfma_f32_16x16x32_bf16 v[112:115], a[152:155], a[44:47], v[112:115]
buffer_load_dwordx4 a[104:107], v242, s[20:23], s28 offen sc0 sc1
v_mfma_f32_16x16x32_bf16 v[116:119], a[156:159], a[44:47], v[116:119]
ds_read_b64_tr_b16 a[192:193], v236 offset:8192
v_mfma_f32_16x16x32_bf16 v[84:87], a[156:159], a[40:43], v[84:87]
buffer_load_dwordx4 a[108:111], v243, s[20:23], s28 offen sc0 sc1
v_mfma_f32_16x16x32_bf16 v[52:55], a[156:159], a[36:39], v[52:55]
ds_read_b64_tr_b16 a[194:195], v236 offset:12288
v_mfma_f32_16x16x32_bf16 v[20:23], a[156:159], a[32:35], v[20:23]
ds_read_b64_tr_b16 a[196:197], v236 offset:8200
v_mfma_f32_16x16x32_bf16 v[24:27], a[160:163], a[32:35], v[24:27]
s_add_u32 m0, s49, 49152
v_mfma_f32_16x16x32_bf16 v[56:59], a[160:163], a[36:39], v[56:59]
ds_read_b64_tr_b16 a[198:199], v236 offset:12296
v_mfma_f32_16x16x32_bf16 v[88:91], a[160:163], a[40:43], v[88:91]
ds_read_b64_tr_b16 a[200:201], v237 offset:8192
v_mfma_f32_16x16x32_bf16 v[120:123], a[160:163], a[44:47], v[120:123]
s_cmp_eq_u32 s37, 0
s_cselect_b32 s92, s92, 0x7ffffff0
s_waitcnt lgkmcnt(8)
v_mfma_f32_16x16x32_bf16 v[124:127], a[164:167], a[44:47], v[124:127]
ds_read_b64_tr_b16 a[202:203], v237 offset:12288
v_mfma_f32_16x16x32_bf16 v[92:95], a[164:167], a[40:43], v[92:95]
ds_read_b64_tr_b16 a[204:205], v237 offset:8200
v_writelane_b32 v254, s92, 0
v_mfma_f32_16x16x32_bf16 v[60:63], a[164:167], a[36:39], v[60:63]
buffer_load_dwordx4 v238, s[16:19], s34 offen offset:0 lds
v_mfma_f32_16x16x32_bf16 v[28:31], a[164:167], a[32:35], v[28:31]
ds_read_b64_tr_b16 a[206:207], v237 offset:12296
s_or_b32 s92, s38, s46
v_mfma_f32_16x16x32_bf16 v[32:35], a[168:171], a[32:35], v[32:35]
buffer_load_dwordx4 v239, s[16:19], s34 offen offset:1024 lds
v_mfma_f32_16x16x32_bf16 v[64:67], a[168:171], a[36:39], v[64:67]
v_mov_b32 v255, s92
v_add_u32 v184, 0, v0
v_mfma_f32_16x16x32_bf16 v[96:99], a[168:171], a[40:43], v[96:99]
s_add_u32 s34, s34, 262144
s_sub_u32 s51, s34, 4718592
s_cselect_b32 s34, s34, s51
v_mfma_f32_16x16x32_bf16 v[128:131], a[168:171], a[44:47], v[128:131]
v_mul_u32_u24 v185, 911, v184
v_lshrrev_b32 v185, 16, v185
v_mfma_f32_16x16x32_bf16 v[132:135], a[172:175], a[44:47], v[132:135]
v_add_u32 v184, v184, v185
v_lshlrev_b32 v184, 4, v184
v_mfma_f32_16x16x32_bf16 v[100:103], a[172:175], a[40:43], v[100:103]
v_add_u32 v178, 0x24000, v184
v_add_u32 v184, 256, v0
v_mfma_f32_16x16x32_bf16 v[68:71], a[172:175], a[36:39], v[68:71]
v_mul_u32_u24 v185, 911, v184
v_lshrrev_b32 v185, 16, v185
v_mfma_f32_16x16x32_bf16 v[36:39], a[172:175], a[32:35], v[36:39]
v_add_u32 v184, v184, v185
v_lshlrev_b32 v184, 4, v184
s_waitcnt vmcnt(20)
v_mfma_f32_16x16x32_bf16 v[8:11], a[176:179], a[48:51], v[8:11]
v_add_u32 v179, 0x24000, v184
v_add_u32 v184, 512, v0
v_mfma_f32_16x16x32_bf16 v[40:43], a[176:179], a[52:55], v[40:43]
STUB_2:
STUB_A2:
s_cbranch_execz STUB_5
s_waitcnt vmcnt(12) lgkmcnt(0)
s_barrier
v_mfma_f32_16x16x32_bf16 v[72:75], a[176:179], a[56:59], v[72:75]
ds_read_b64_tr_b16 a[144:145], v234 offset:16384
v_mul_u32_u24 v185, 911, v184
v_mfma_f32_16x16x32_bf16 v[104:107], a[176:179], a[60:63], v[104:107]
ds_read_b64_tr_b16 a[146:147], v234 offset:20480
v_lshrrev_b32 v185, 16, v185
v_mfma_f32_16x16x32_bf16 v[108:111], a[180:183], a[60:63], v[108:111]
ds_read_b64_tr_b16 a[148:149], v234 offset:16392
v_add_u32 v184, v184, v185
v_mfma_f32_16x16x32_bf16 v[76:79], a[180:183], a[56:59], v[76:79]
s_add_u32 s28, s28, 1024
s_cmp_lt_u32 s28, s6
s_cselect_b32 s28, s28, s4
v_mfma_f32_16x16x32_bf16 v[44:47], a[180:183], a[52:55], v[44:47]
ds_read_b64_tr_b16 a[150:151], v234 offset:20488
v_lshlrev_b32 v184, 4, v184
v_mfma_f32_16x16x32_bf16 v[12:15], a[180:183], a[48:51], v[12:15]
ds_read_b64_tr_b16 a[152:153], v235 offset:16384
v_add_u32 v180, 0x24000, v184
v_mfma_f32_16x16x32_bf16 v[16:19], a[184:187], a[48:51], v[16:19]
buffer_load_dwordx4 a[112:115], v240, s[20:23], s28 offen sc0 sc1
v_mfma_f32_16x16x32_bf16 v[48:51], a[184:187], a[52:55], v[48:51]
ds_read_b64_tr_b16 a[154:155], v235 offset:20480
v_mfma_f32_16x16x32_bf16 v[80:83], a[184:187], a[56:59], v[80:83]
ds_read_b64_tr_b16 a[156:157], v235 offset:16392
v_mfma_f32_16x16x32_bf16 v[112:115], a[184:187], a[60:63], v[112:115]
buffer_load_dwordx4 a[116:119], v241, s[20:23], s28 offen sc0 sc1
v_mfma_f32_16x16x32_bf16 v[116:119], a[188:191], a[60:63], v[116:119]
ds_read_b64_tr_b16 a[158:159], v235 offset:20488
v_mfma_f32_16x16x32_bf16 v[84:87], a[188:191], a[56:59], v[84:87]
ds_read_b64_tr_b16 a[160:161], v236 offset:16384
v_mfma_f32_16x16x32_bf16 v[52:55], a[188:191], a[52:55], v[52:55]
ds_read_b64_tr_b16 a[162:163], v236 offset:20480
v_mfma_f32_16x16x32_bf16 v[20:23], a[188:191], a[48:51], v[20:23]
buffer_load_dwordx4 a[120:123], v242, s[20:23], s28 offen sc0 sc1
v_mfma_f32_16x16x32_bf16 v[24:27], a[192:195], a[48:51], v[24:27]
ds_read_b64_tr_b16 a[164:165], v236 offset:16392
v_mfma_f32_16x16x32_bf16 v[56:59], a[192:195], a[52:55], v[56:59]
ds_read_b64_tr_b16 a[166:167], v236 offset:20488
v_mfma_f32_16x16x32_bf16 v[88:91], a[192:195], a[56:59], v[88:91]
buffer_load_dwordx4 a[124:127], v243, s[20:23], s28 offen sc0 sc1
v_mfma_f32_16x16x32_bf16 v[120:123], a[192:195], a[60:63], v[120:123]
ds_read_b64_tr_b16 a[168:169], v237 offset:16384
s_add_u32 m0, s49, 57344
v_mfma_f32_16x16x32_bf16 v[124:127], a[196:199], a[60:63], v[124:127]
ds_read_b64_tr_b16 a[170:171], v237 offset:20480
v_mfma_f32_16x16x32_bf16 v[92:95], a[196:199], a[56:59], v[92:95]
buffer_load_dwordx4 v238, s[16:19], s34 offen offset:0 lds
v_mfma_f32_16x16x32_bf16 v[60:63], a[196:199], a[52:55], v[60:63]
ds_read_b64_tr_b16 a[172:173], v237 offset:16392
v_mfma_f32_16x16x32_bf16 v[28:31], a[196:199], a[48:51], v[28:31]
ds_read_b64_tr_b16 a[174:175], v237 offset:20488
v_mfma_f32_16x16x32_bf16 v[32:35], a[200:203], a[48:51], v[32:35]
buffer_load_dwordx4 v239, s[16:19], s34 offen offset:1024 lds
v_mfma_f32_16x16x32_bf16 v[64:67], a[200:203], a[52:55], v[64:67]
s_waitcnt vmcnt(36)
v_readfirstlane_b32 s92, v193
v_mfma_f32_16x16x32_bf16 v[96:99], a[200:203], a[56:59], v[96:99]
s_add_u32 s34, s34, 262144
s_sub_u32 s51, s34, 4718592
s_cselect_b32 s34, s34, s51
v_mfma_f32_16x16x32_bf16 v[128:131], a[200:203], a[60:63], v[128:131]
s_and_b32 s93, s92, 0xf0
s_cbranch_scc0 SP_X0
SP_X0_RET:
v_mfma_f32_16x16x32_bf16 v[132:135], a[204:207], a[60:63], v[132:135]
s_add_u32 s92, s92, s36
s_and_b32 s92, s92, 7
v_mfma_f32_16x16x32_bf16 v[100:103], a[204:207], a[56:59], v[100:103]
s_lshl_b32 s92, s92, 2
s_lshr_b32 s92, 0x43726150, s92
v_mfma_f32_16x16x32_bf16 v[68:71], a[204:207], a[52:55], v[68:71]
s_and_b32 s92, s92, 7
s_lshl_b32 s93, s92, 5
v_mfma_f32_16x16x32_bf16 v[36:39], a[204:207], a[48:51], v[36:39]
s_add_u32 s40, s93, s35
s_lshr_b32 s93, s35, 1
s_waitcnt vmcnt(20)
s_waitcnt lgkmcnt(8)
v_mfma_f32_16x16x32_bf16 v[8:11], a[144:147], a[64:67], v[8:11]
ds_read_b64_tr_b16 a[176:177], v234 offset:24576
s_lshl2_add_u32 s93, s93, s92
v_mfma_f32_16x16x32_bf16 v[40:43], a[144:147], a[68:71], v[40:43]
ds_read_b64_tr_b16 a[178:179], v234 offset:28672
s_and_b32 s94, s35, 1
v_mfma_f32_16x16x32_bf16 v[72:75], a[144:147], a[72:75], v[72:75]
s_add_u32 s28, s28, 1024
s_cmp_lt_u32 s28, s6
s_cselect_b32 s28, s28, s4
v_mfma_f32_16x16x32_bf16 v[104:107], a[144:147], a[76:79], v[104:107]
ds_read_b64_tr_b16 a[180:181], v234 offset:24584
s_lshl1_add_u32 s93, s93, s94
v_mfma_f32_16x16x32_bf16 v[108:111], a[148:151], a[76:79], v[108:111]
ds_read_b64_tr_b16 a[182:183], v234 offset:28680
v_mfma_f32_16x16x32_bf16 v[76:79], a[148:151], a[72:75], v[76:79]
buffer_load_dwordx4 a[0:3], v240, s[20:23], s28 offen sc0 sc1
v_mfma_f32_16x16x32_bf16 v[44:47], a[148:151], a[68:71], v[44:47]
ds_read_b64_tr_b16 a[184:185], v235 offset:24576
v_mfma_f32_16x16x32_bf16 v[12:15], a[148:151], a[64:67], v[12:15]
ds_read_b64_tr_b16 a[186:187], v235 offset:28672
v_mfma_f32_16x16x32_bf16 v[16:19], a[152:155], a[64:67], v[16:19]
buffer_load_dwordx4 a[4:7], v241, s[20:23], s28 offen sc0 sc1
v_mfma_f32_16x16x32_bf16 v[48:51], a[152:155], a[68:71], v[48:51]
ds_read_b64_tr_b16 a[188:189], v235 offset:24584
v_mfma_f32_16x16x32_bf16 v[80:83], a[152:155], a[72:75], v[80:83]
ds_read_b64_tr_b16 a[190:191], v235 offset:28680
v_mfma_f32_16x16x32_bf16 v[112:115], a[152:155], a[76:79], v[112:115]
buffer_load_dwordx4 a[8:11], v242, s[20:23], s28 offen sc0 sc1
v_mfma_f32_16x16x32_bf16 v[116:119], a[156:159], a[76:79], v[116:119]
ds_read_b64_tr_b16 a[192:193], v236 offset:24576
v_mfma_f32_16x16x32_bf16 v[84:87], a[156:159], a[72:75], v[84:87]
buffer_load_dwordx4 a[12:15], v243, s[20:23], s28 offen sc0 sc1
v_mfma_f32_16x16x32_bf16 v[52:55], a[156:159], a[68:71], v[52:55]
ds_read_b64_tr_b16 a[194:195], v236 offset:28672
s_add_u32 s32, s7, 0
v_mfma_f32_16x16x32_bf16 v[20:23], a[156:159], a[64:67], v[20:23]
ds_read_b64_tr_b16 a[196:197], v236 offset:24584
s_waitcnt lgkmcnt(8)
v_mfma_f32_16x16x32_bf16 v[24:27], a[160:163], a[64:67], v[24:27]
s_add_u32 m0, s30, 81920
v_mfma_f32_16x16x32_bf16 v[56:59], a[160:163], a[68:71], v[56:59]
ds_read_b64_tr_b16 a[198:199], v236 offset:28680
v_mfma_f32_16x16x32_bf16 v[88:91], a[160:163], a[72:75], v[88:91]
ds_read_b64_tr_b16 a[200:201], v237 offset:24576
v_mfma_f32_16x16x32_bf16 v[120:123], a[160:163], a[76:79], v[120:123]
buffer_load_dwordx4 v228, s[8:11], s32 offen offset:0  lds
v_mfma_f32_16x16x32_bf16 v[124:127], a[164:167], a[76:79], v[124:127]
ds_read_b64_tr_b16 a[202:203], v237 offset:28672
v_mfma_f32_16x16x32_bf16 v[92:95], a[164:167], a[72:75], v[92:95]
ds_read_b64_tr_b16 a[204:205], v237 offset:24584
v_mfma_f32_16x16x32_bf16 v[60:63], a[164:167], a[68:71], v[60:63]
buffer_load_dwordx4 v229, s[8:11], s32 offen offset:1024  lds
v_mfma_f32_16x16x32_bf16 v[28:31], a[164:167], a[64:67], v[28:31]
ds_read_b64_tr_b16 a[206:207], v237 offset:28680
v_mfma_f32_16x16x32_bf16 v[32:35], a[168:171], a[64:67], v[32:35]
buffer_load_dwordx4 v230, s[8:11], s32 offen offset:2048  lds
v_mfma_f32_16x16x32_bf16 v[64:67], a[168:171], a[68:71], v[64:67]
s_cmp_lt_u32 s92, 4
s_cselect_b32 s40, s93, s40
v_mfma_f32_16x16x32_bf16 v[96:99], a[168:171], a[72:75], v[96:99]
s_mov_b32 s92, s40
s_lshl_b32 s84, s92, 6
v_mfma_f32_16x16x32_bf16 v[128:131], a[168:171], a[76:79], v[128:131]
buffer_load_dwordx4 v231, s[8:11], s32 offen offset:3072  lds
v_mfma_f32_16x16x32_bf16 v[132:135], a[172:175], a[76:79], v[132:135]
s_mul_i32 s93, s37, 147456
s_add_u32 s84, s84, s93
v_mfma_f32_16x16x32_bf16 v[100:103], a[172:175], a[72:75], v[100:103]
s_mul_i32 s85, s92, 36864
s_add_u32 s85, s85, s31
v_mfma_f32_16x16x32_bf16 v[68:71], a[172:175], a[68:71], v[68:71]
s_cmp_lt_u32 s40, 144
s_cselect_b32 s86, s31, 0x30000
s_cselect_b32 s84, s84, 0x40000000
s_cselect_b32 s85, s85, 0x40000000
v_mfma_f32_16x16x32_bf16 v[36:39], a[172:175], a[64:67], v[36:39]
s_waitcnt vmcnt(22)
v_mfma_f32_16x16x32_bf16 v[8:11], a[176:179], a[80:83], v[8:11]
ds_read_b64_tr_b16 a[144:145], v234 offset:32768
v_mfma_f32_16x16x32_bf16 v[40:43], a[176:179], a[84:87], v[40:43]
ds_read_b64_tr_b16 a[146:147], v234 offset:36864
v_mfma_f32_16x16x32_bf16 v[72:75], a[176:179], a[88:91], v[72:75]
s_add_u32 s28, s28, 1024
s_cmp_lt_u32 s28, s6
s_cselect_b32 s28, s28, s4
v_mfma_f32_16x16x32_bf16 v[104:107], a[176:179], a[92:95], v[104:107]
ds_read_b64_tr_b16 a[148:149], v234 offset:32776
s_waitcnt lgkmcnt(8)
v_mfma_f32_16x16x32_bf16 v[108:111], a[180:183], a[92:95], v[108:111]
ds_read_b64_tr_b16 a[150:151], v234 offset:36872
v_mfma_f32_16x16x32_bf16 v[76:79], a[180:183], a[88:91], v[76:79]
v_mfma_f32_16x16x32_bf16 v[44:47], a[180:183], a[84:87], v[44:47]
ds_read_b64_tr_b16 a[152:153], v235 offset:32768
v_mfma_f32_16x16x32_bf16 v[12:15], a[180:183], a[80:83], v[12:15]
ds_read_b64_tr_b16 a[154:155], v235 offset:36864
v_mfma_f32_16x16x32_bf16 v[16:19], a[184:187], a[80:83], v[16:19]
buffer_load_dwordx4 a[16:19], v240, s[20:23], s28 offen sc0 sc1
v_mfma_f32_16x16x32_bf16 v[48:51], a[184:187], a[84:87], v[48:51]
ds_read_b64_tr_b16 a[156:157], v235 offset:32776
v_mfma_f32_16x16x32_bf16 v[80:83], a[184:187], a[88:91], v[80:83]
ds_read_b64_tr_b16 a[158:159], v235 offset:36872
v_mfma_f32_16x16x32_bf16 v[112:115], a[184:187], a[92:95], v[112:115]
v_mfma_f32_16x16x32_bf16 v[116:119], a[188:191], a[92:95], v[116:119]
ds_read_b64_tr_b16 a[160:161], v236 offset:32768
v_mfma_f32_16x16x32_bf16 v[84:87], a[188:191], a[88:91], v[84:87]
buffer_load_dwordx4 a[20:23], v241, s[20:23], s28 offen sc0 sc1
v_mfma_f32_16x16x32_bf16 v[52:55], a[188:191], a[84:87], v[52:55]
ds_read_b64_tr_b16 a[162:163], v236 offset:36864
v_mfma_f32_16x16x32_bf16 v[20:23], a[188:191], a[80:83], v[20:23]
ds_read_b64_tr_b16 a[164:165], v236 offset:32776
v_mfma_f32_16x16x32_bf16 v[24:27], a[192:195], a[80:83], v[24:27]
v_mfma_f32_16x16x32_bf16 v[56:59], a[192:195], a[84:87], v[56:59]
ds_read_b64_tr_b16 a[166:167], v236 offset:36872
v_mfma_f32_16x16x32_bf16 v[88:91], a[192:195], a[88:91], v[88:91]
ds_read_b64_tr_b16 a[168:169], v237 offset:32768
v_mfma_f32_16x16x32_bf16 v[120:123], a[192:195], a[92:95], v[120:123]
buffer_load_dwordx4 a[24:27], v242, s[20:23], s28 offen sc0 sc1
s_waitcnt lgkmcnt(8)
v_mfma_f32_16x16x32_bf16 v[124:127], a[196:199], a[92:95], v[124:127]
ds_read_b64_tr_b16 a[170:171], v237 offset:36864
v_mfma_f32_16x16x32_bf16 v[92:95], a[196:199], a[88:91], v[92:95]
ds_read_b64_tr_b16 a[172:173], v237 offset:32776
v_mfma_f32_16x16x32_bf16 v[60:63], a[196:199], a[84:87], v[60:63]
v_lshlrev_b32 v136, 3, v1
v_mov_b32 v137, 0x7ffffff0
v_mfma_f32_16x16x32_bf16 v[28:31], a[196:199], a[80:83], v[28:31]
ds_read_b64_tr_b16 a[174:175], v237 offset:36872
v_mfma_f32_16x16x32_bf16 v[32:35], a[200:203], a[80:83], v[32:35]
buffer_load_dwordx4 a[28:31], v243, s[20:23], s28 offen sc0 sc1
v_mfma_f32_16x16x32_bf16 v[64:67], a[200:203], a[84:87], v[64:67]
v_cmp_lt_u32 vcc, 7, v1
v_mov_b32 v143, s47
v_mfma_f32_16x16x32_bf16 v[96:99], a[200:203], a[88:91], v[96:99]
v_mfma_f32_16x16x32_bf16 v[128:131], a[200:203], a[92:95], v[128:131]
v_cndmask_b32 v136, v136, v137, vcc
v_mfma_f32_16x16x32_bf16 v[132:135], a[204:207], a[92:95], v[132:135]
s_lshl_b32 s29, s36, 6
s_add_u32 s29, s29, 0x242000
v_mfma_f32_16x16x32_bf16 v[100:103], a[204:207], a[88:91], v[100:103]
s_add_u32 s50, s35, s37
s_cmp_eq_u32 s50, 0
s_cselect_b32 s29, s29, 0x7ffffff0
v_mfma_f32_16x16x32_bf16 v[68:71], a[204:207], a[84:87], v[68:71]
v_mfma_f32_16x16x32_bf16 v[36:39], a[204:207], a[80:83], v[36:39]
s_waitcnt vmcnt(20)
v_mfma_f32_16x16x32_bf16 v[8:11], a[144:147], a[96:99], v[8:11]
v_mfma_f32_16x16x32_bf16 v[40:43], a[144:147], a[100:103], v[40:43]
s_waitcnt vmcnt(12) lgkmcnt(0)
s_barrier
v_mfma_f32_16x16x32_bf16 v[72:75], a[144:147], a[104:107], v[72:75]
ds_read_b64_tr_b16 a[176:177], v234 offset:40960
s_add_u32 s32, s7, 16384
v_mfma_f32_16x16x32_bf16 v[104:107], a[144:147], a[108:111], v[104:107]
ds_read_b64_tr_b16 a[178:179], v234 offset:45056
v_mfma_f32_16x16x32_bf16 v[108:111], a[148:151], a[108:111], v[108:111]
ds_read_b64_tr_b16 a[180:181], v234 offset:40968
v_mfma_f32_16x16x32_bf16 v[76:79], a[148:151], a[104:107], v[76:79]
buffer_store_dwordx2 v[142:143], v136, s[20:23], s29 offen sc0 sc1
v_mfma_f32_16x16x32_bf16 v[44:47], a[148:151], a[100:103], v[44:47]
ds_read_b64_tr_b16 a[182:183], v234 offset:45064
s_add_u32 m0, s30, 114688
v_mfma_f32_16x16x32_bf16 v[12:15], a[148:151], a[96:99], v[12:15]
ds_read_b64_tr_b16 a[184:185], v235 offset:40960
v_mfma_f32_16x16x32_bf16 v[16:19], a[152:155], a[96:99], v[16:19]
buffer_store_dword v171, v170, s[20:23], 0 offen sc0 sc1
v_mfma_f32_16x16x32_bf16 v[48:51], a[152:155], a[100:103], v[48:51]
ds_read_b64_tr_b16 a[186:187], v235 offset:45056
ds_read_b128 v[152:155], v178
v_mfma_f32_16x16x32_bf16 v[80:83], a[152:155], a[104:107], v[80:83]
ds_read_b64_tr_b16 a[188:189], v235 offset:40968
ds_read_b128 v[156:159], v179
v_mfma_f32_16x16x32_bf16 v[112:115], a[152:155], a[108:111], v[112:115]
buffer_load_dwordx4 v228, s[8:11], s32 offen offset:0  lds
v_mfma_f32_16x16x32_bf16 v[116:119], a[156:159], a[108:111], v[116:119]
ds_read_b64_tr_b16 a[190:191], v235 offset:45064
ds_read_b128 v[160:163], v180
v_mfma_f32_16x16x32_bf16 v[84:87], a[156:159], a[104:107], v[84:87]
ds_read_b64_tr_b16 a[192:193], v236 offset:40960
v_mfma_f32_16x16x32_bf16 v[52:55], a[156:159], a[100:103], v[52:55]
ds_read_b64_tr_b16 a[194:195], v236 offset:45056
v_mfma_f32_16x16x32_bf16 v[20:23], a[156:159], a[96:99], v[20:23]
s_mul_i32 s45, s3, 1152
s_add_u32 s45, s45, s31
v_mfma_f32_16x16x32_bf16 v[24:27], a[160:163], a[96:99], v[24:27]
ds_read_b64_tr_b16 a[196:197], v236 offset:40968
s_add_u32 s45, s45, 0x1c00000
v_mfma_f32_16x16x32_bf16 v[56:59], a[160:163], a[100:103], v[56:59]
ds_read_b64_tr_b16 a[198:199], v236 offset:45064
v_mfma_f32_16x16x32_bf16 v[88:91], a[160:163], a[104:107], v[88:91]
buffer_load_dwordx4 v229, s[8:11], s32 offen offset:1024  lds
v_mfma_f32_16x16x32_bf16 v[120:123], a[160:163], a[108:111], v[120:123]
ds_read_b64_tr_b16 a[200:201], v237 offset:40960
v_mfma_f32_16x16x32_bf16 v[124:127], a[164:167], a[108:111], v[124:127]
ds_read_b64_tr_b16 a[202:203], v237 offset:45056
v_mfma_f32_16x16x32_bf16 v[92:95], a[164:167], a[104:107], v[92:95]
buffer_load_dwordx4 v230, s[8:11], s32 offen offset:2048  lds
v_mfma_f32_16x16x32_bf16 v[60:63], a[164:167], a[100:103], v[60:63]
ds_read_b64_tr_b16 a[204:205], v237 offset:40968
v_mfma_f32_16x16x32_bf16 v[28:31], a[164:167], a[96:99], v[28:31]
ds_read_b64_tr_b16 a[206:207], v237 offset:45064
v_mfma_f32_16x16x32_bf16 v[32:35], a[168:171], a[96:99], v[32:35]
s_waitcnt lgkmcnt(8)
buffer_store_dwordx4 v[152:155], v244, s[20:23], s45 offen sc0 sc1
v_mfma_f32_16x16x32_bf16 v[64:67], a[168:171], a[100:103], v[64:67]
buffer_load_dwordx4 v231, s[8:11], s32 offen offset:3072  lds
v_mfma_f32_16x16x32_bf16 v[96:99], a[168:171], a[104:107], v[96:99]
v_mfma_f32_16x16x32_bf16 v[128:131], a[168:171], a[108:111], v[128:131]
v_mfma_f32_16x16x32_bf16 v[132:135], a[172:175], a[108:111], v[132:135]
v_mfma_f32_16x16x32_bf16 v[100:103], a[172:175], a[104:107], v[100:103]
v_mfma_f32_16x16x32_bf16 v[68:71], a[172:175], a[100:103], v[68:71]
s_add_u32 s45, s45, 4096
buffer_store_dwordx4 v[156:159], v244, s[20:23], s45 offen sc0 sc1
v_mfma_f32_16x16x32_bf16 v[36:39], a[172:175], a[96:99], v[36:39]
s_waitcnt vmcnt(22)
v_mfma_f32_16x16x32_bf16 v[8:11], a[176:179], a[112:115], v[8:11]
ds_read_b64_tr_b16 a[144:145], v234 offset:49152
v_mfma_f32_16x16x32_bf16 v[40:43], a[176:179], a[116:119], v[40:43]
ds_read_b64_tr_b16 a[146:147], v234 offset:53248
v_mfma_f32_16x16x32_bf16 v[72:75], a[176:179], a[120:123], v[72:75]
v_mfma_f32_16x16x32_bf16 v[104:107], a[176:179], a[124:127], v[104:107]
ds_read_b64_tr_b16 a[148:149], v234 offset:49160
v_mfma_f32_16x16x32_bf16 v[108:111], a[180:183], a[124:127], v[108:111]
ds_read_b64_tr_b16 a[150:151], v234 offset:53256
v_mfma_f32_16x16x32_bf16 v[76:79], a[180:183], a[120:123], v[76:79]
s_add_u32 s45, s45, 4096
s_cmp_eq_u32 s37, 0
s_cselect_b32 s45, s45, 0x7ffffff0
buffer_store_dwordx4 v[160:163], v244, s[20:23], s45 offen sc0 sc1
v_mfma_f32_16x16x32_bf16 v[44:47], a[180:183], a[116:119], v[44:47]
ds_read_b64_tr_b16 a[152:153], v235 offset:49152
s_mul_i32 s88, s37, 864
v_mfma_f32_16x16x32_bf16 v[12:15], a[180:183], a[112:115], v[12:15]
ds_read_b64_tr_b16 a[154:155], v235 offset:53248
s_mov_b32 s87, s88
v_mfma_f32_16x16x32_bf16 v[16:19], a[184:187], a[112:115], v[16:19]
v_accvgpr_write_b32 a128, 0
v_accvgpr_write_b32 a129, 0
v_mfma_f32_16x16x32_bf16 v[48:51], a[184:187], a[116:119], v[48:51]
ds_read_b64_tr_b16 a[156:157], v235 offset:49160
v_accvgpr_write_b32 a130, 0
v_mfma_f32_16x16x32_bf16 v[80:83], a[184:187], a[120:123], v[80:83]
ds_read_b64_tr_b16 a[158:159], v235 offset:53256
v_accvgpr_write_b32 a131, 0
v_mfma_f32_16x16x32_bf16 v[112:115], a[184:187], a[124:127], v[112:115]
v_accvgpr_write_b32 a132, 0
v_accvgpr_write_b32 a133, 0
v_mfma_f32_16x16x32_bf16 v[116:119], a[188:191], a[124:127], v[116:119]
ds_read_b64_tr_b16 a[160:161], v236 offset:49152
v_accvgpr_write_b32 a134, 0
v_mfma_f32_16x16x32_bf16 v[84:87], a[188:191], a[120:123], v[84:87]
v_accvgpr_write_b32 a135, 0
v_lshrrev_b32 v240, 2, v1
v_mfma_f32_16x16x32_bf16 v[52:55], a[188:191], a[116:119], v[52:55]
ds_read_b64_tr_b16 a[162:163], v236 offset:53248
v_mul_u32_u24 v240, 0x2400, v240
v_mfma_f32_16x16x32_bf16 v[20:23], a[188:191], a[112:115], v[20:23]
ds_read_b64_tr_b16 a[164:165], v236 offset:49160
v_and_b32 v246, 3, v1
s_waitcnt lgkmcnt(8)
v_mfma_f32_16x16x32_bf16 v[24:27], a[192:195], a[112:115], v[24:27]
v_lshl_add_u32 v240, v246, 4, v240
v_mul_u32_u24 v243, 3641, v1
v_mfma_f32_16x16x32_bf16 v[56:59], a[192:195], a[116:119], v[56:59]
ds_read_b64_tr_b16 a[166:167], v236 offset:53256
v_lshrrev_b32 v243, 16, v243
v_mfma_f32_16x16x32_bf16 v[88:91], a[192:195], a[120:123], v[88:91]
ds_read_b64_tr_b16 a[168:169], v237 offset:49152
v_mul_u32_u24 v243, 864, v243
v_mfma_f32_16x16x32_bf16 v[120:123], a[192:195], a[124:127], v[120:123]
v_add_u32 v243, v243, v244
v_mfma_f32_16x16x32_bf16 v[124:127], a[196:199], a[124:127], v[124:127]
ds_read_b64_tr_b16 a[170:171], v237 offset:53248
s_sub_u32 s92, s40, 0
v_mfma_f32_16x16x32_bf16 v[92:95], a[196:199], a[120:123], v[92:95]
ds_read_b64_tr_b16 a[172:173], v237 offset:49160
v_mfma_f32_16x16x32_bf16 v[60:63], a[196:199], a[116:119], v[60:63]
s_cmp_lt_u32 s92, 72
s_cselect_b32 s3, 4, 0
v_mfma_f32_16x16x32_bf16 v[28:31], a[196:199], a[112:115], v[28:31]
ds_read_b64_tr_b16 a[174:175], v237 offset:53256
v_mfma_f32_16x16x32_bf16 v[32:35], a[200:203], a[112:115], v[32:35]
s_cmp_lt_u32 s40, 144
s_cselect_b32 s3, 5, s3
v_mfma_f32_16x16x32_bf16 v[64:67], a[200:203], a[116:119], v[64:67]
v_mfma_f32_16x16x32_bf16 v[96:99], a[200:203], a[120:123], v[96:99]
v_mfma_f32_16x16x32_bf16 v[128:131], a[200:203], a[124:127], v[128:131]
v_mfma_f32_16x16x32_bf16 v[132:135], a[204:207], a[124:127], v[132:135]
v_mfma_f32_16x16x32_bf16 v[100:103], a[204:207], a[120:123], v[100:103]
v_mfma_f32_16x16x32_bf16 v[68:71], a[204:207], a[116:119], v[68:71]
v_mfma_f32_16x16x32_bf16 v[36:39], a[204:207], a[112:115], v[36:39]
s_waitcnt vmcnt(17)
v_mfma_f32_16x16x32_bf16 v[8:11], a[144:147], a[0:3], v[8:11]
ds_read_b64_tr_b16 a[176:177], v234 offset:57344
s_add_u32 s39, s7, 0
v_mfma_f32_16x16x32_bf16 v[40:43], a[144:147], a[4:7], v[40:43]
ds_read_b64_tr_b16 a[178:179], v234 offset:61440
v_mfma_f32_16x16x32_bf16 v[72:75], a[144:147], a[8:11], v[72:75]
v_mfma_f32_16x16x32_bf16 v[104:107], a[144:147], a[12:15], v[104:107]
ds_read_b64_tr_b16 a[180:181], v234 offset:57352
s_waitcnt lgkmcnt(8)
v_mfma_f32_16x16x32_bf16 v[108:111], a[148:151], a[12:15], v[108:111]
ds_read_b64_tr_b16 a[182:183], v234 offset:61448
v_mfma_f32_16x16x32_bf16 v[76:79], a[148:151], a[8:11], v[76:79]
s_add_u32 m0, s30, 131072
v_mfma_f32_16x16x32_bf16 v[44:47], a[148:151], a[4:7], v[44:47]
ds_read_b64_tr_b16 a[184:185], v235 offset:57344
v_mfma_f32_16x16x32_bf16 v[12:15], a[148:151], a[0:3], v[12:15]
ds_read_b64_tr_b16 a[186:187], v235 offset:61440
v_mfma_f32_16x16x32_bf16 v[16:19], a[152:155], a[0:3], v[16:19]
v_mfma_f32_16x16x32_bf16 v[48:51], a[152:155], a[4:7], v[48:51]
ds_read_b64_tr_b16 a[188:189], v235 offset:57352
v_mfma_f32_16x16x32_bf16 v[80:83], a[152:155], a[8:11], v[80:83]
ds_read_b64_tr_b16 a[190:191], v235 offset:61448
v_mfma_f32_16x16x32_bf16 v[112:115], a[152:155], a[12:15], v[112:115]
buffer_load_dwordx4 v232, s[12:15], s39 offen offset:0  lds
v_mfma_f32_16x16x32_bf16 v[116:119], a[156:159], a[12:15], v[116:119]
ds_read_b64_tr_b16 a[192:193], v236 offset:57344
v_mfma_f32_16x16x32_bf16 v[84:87], a[156:159], a[8:11], v[84:87]
v_mfma_f32_16x16x32_bf16 v[52:55], a[156:159], a[4:7], v[52:55]
ds_read_b64_tr_b16 a[194:195], v236 offset:61440
v_mfma_f32_16x16x32_bf16 v[20:23], a[156:159], a[0:3], v[20:23]
ds_read_b64_tr_b16 a[196:197], v236 offset:57352
v_mfma_f32_16x16x32_bf16 v[24:27], a[160:163], a[0:3], v[24:27]
buffer_load_dwordx4 v233, s[12:15], s39 offen offset:1024  lds
v_mfma_f32_16x16x32_bf16 v[56:59], a[160:163], a[4:7], v[56:59]
ds_read_b64_tr_b16 a[198:199], v236 offset:61448
v_mfma_f32_16x16x32_bf16 v[88:91], a[160:163], a[8:11], v[88:91]
ds_read_b64_tr_b16 a[200:201], v237 offset:57344
v_mfma_f32_16x16x32_bf16 v[120:123], a[160:163], a[12:15], v[120:123]
s_waitcnt lgkmcnt(8)
v_mfma_f32_16x16x32_bf16 v[124:127], a[164:167], a[12:15], v[124:127]
ds_read_b64_tr_b16 a[202:203], v237 offset:61440
v_mfma_f32_16x16x32_bf16 v[92:95], a[164:167], a[8:11], v[92:95]
ds_read_b64_tr_b16 a[204:205], v237 offset:57352
v_mfma_f32_16x16x32_bf16 v[60:63], a[164:167], a[4:7], v[60:63]
buffer_load_dwordx4 v232, s[12:15], s39 offen offset:2048  lds
v_mfma_f32_16x16x32_bf16 v[28:31], a[164:167], a[0:3], v[28:31]
ds_read_b64_tr_b16 a[206:207], v237 offset:61448
v_mfma_f32_16x16x32_bf16 v[32:35], a[168:171], a[0:3], v[32:35]
v_mfma_f32_16x16x32_bf16 v[64:67], a[168:171], a[4:7], v[64:67]
buffer_load_dwordx4 v233, s[12:15], s39 offen offset:3072  lds
v_mfma_f32_16x16x32_bf16 v[96:99], a[168:171], a[8:11], v[96:99]
v_mfma_f32_16x16x32_bf16 v[128:131], a[168:171], a[12:15], v[128:131]
v_mfma_f32_16x16x32_bf16 v[132:135], a[172:175], a[12:15], v[132:135]
v_mfma_f32_16x16x32_bf16 v[100:103], a[172:175], a[8:11], v[100:103]
v_mfma_f32_16x16x32_bf16 v[68:71], a[172:175], a[4:7], v[68:71]
v_mfma_f32_16x16x32_bf16 v[36:39], a[172:175], a[0:3], v[36:39]
s_waitcnt vmcnt(13)
v_mfma_f32_16x16x32_bf16 v[8:11], a[176:179], a[16:19], v[8:11]
v_mfma_f32_16x16x32_bf16 v[12:15], a[180:183], a[16:19], v[12:15]
s_waitcnt vmcnt(17) lgkmcnt(0)
s_barrier
v_mfma_f32_16x16x32_bf16 v[16:19], a[184:187], a[16:19], v[16:19]
ds_read_b128 a[144:147], v216 offset:16384
ds_read_b128 a[148:151], v217 offset:16384
v_mfma_f32_16x16x32_bf16 v[20:23], a[188:191], a[16:19], v[20:23]
ds_read_b128 a[152:155], v218 offset:16384
ds_read_b128 a[156:159], v219 offset:16384
v_mfma_f32_16x16x32_bf16 v[24:27], a[192:195], a[16:19], v[24:27]
ds_read_b128 a[160:163], v216 offset:20480
ds_read_b128 a[164:167], v217 offset:20480
v_mfma_f32_16x16x32_bf16 v[28:31], a[196:199], a[16:19], v[28:31]
ds_read_b128 a[168:171], v218 offset:20480
ds_read_b128 a[172:175], v219 offset:20480
v_mfma_f32_16x16x32_bf16 v[32:35], a[200:203], a[16:19], v[32:35]
s_add_u32 s32, s7, 32768
v_mfma_f32_16x16x32_bf16 v[36:39], a[204:207], a[16:19], v[36:39]
s_add_u32 m0, s30, 65536
v_mfma_f32_16x16x32_bf16 v[40:43], a[176:179], a[20:23], v[40:43]
v_cvt_pk_bf16_f32 v152, v8, v9
v_cvt_pk_bf16_f32 v153, v10, v11
v_mfma_f32_16x16x32_bf16 v[44:47], a[180:183], a[20:23], v[44:47]
v_cvt_pk_bf16_f32 v154, v12, v13
v_cvt_pk_bf16_f32 v155, v14, v15
v_mfma_f32_16x16x32_bf16 v[48:51], a[184:187], a[20:23], v[48:51]
v_cvt_pk_bf16_f32 v156, v16, v17
v_cvt_pk_bf16_f32 v157, v18, v19
v_mfma_f32_16x16x32_bf16 v[52:55], a[188:191], a[20:23], v[52:55]
v_cvt_pk_bf16_f32 v158, v20, v21
v_cvt_pk_bf16_f32 v159, v22, v23
v_mfma_f32_16x16x32_bf16 v[56:59], a[192:195], a[20:23], v[56:59]
v_cvt_pk_bf16_f32 v160, v24, v25
v_cvt_pk_bf16_f32 v161, v26, v27
v_mfma_f32_16x16x32_bf16 v[60:63], a[196:199], a[20:23], v[60:63]
v_cvt_pk_bf16_f32 v162, v28, v29
v_cvt_pk_bf16_f32 v163, v30, v31
v_mfma_f32_16x16x32_bf16 v[64:67], a[200:203], a[20:23], v[64:67]
v_cvt_pk_bf16_f32 v164, v32, v33
v_cvt_pk_bf16_f32 v165, v34, v35
v_mfma_f32_16x16x32_bf16 v[68:71], a[204:207], a[20:23], v[68:71]
v_cvt_pk_bf16_f32 v166, v36, v37
v_cvt_pk_bf16_f32 v167, v38, v39
v_mfma_f32_16x16x32_bf16 v[72:75], a[176:179], a[24:27], v[72:75]
v_cvt_pk_bf16_f32 v168, v40, v41
v_cvt_pk_bf16_f32 v169, v42, v43
v_mfma_f32_16x16x32_bf16 v[76:79], a[180:183], a[24:27], v[76:79]
v_cvt_pk_bf16_f32 v170, v44, v45
v_cvt_pk_bf16_f32 v171, v46, v47
v_mfma_f32_16x16x32_bf16 v[80:83], a[184:187], a[24:27], v[80:83]
v_cvt_pk_bf16_f32 v172, v48, v49
v_cvt_pk_bf16_f32 v173, v50, v51
v_mfma_f32_16x16x32_bf16 v[84:87], a[188:191], a[24:27], v[84:87]
v_cvt_pk_bf16_f32 v174, v52, v53
v_cvt_pk_bf16_f32 v175, v54, v55
v_mfma_f32_16x16x32_bf16 v[88:91], a[192:195], a[24:27], v[88:91]
v_cvt_pk_bf16_f32 v176, v56, v57
v_cvt_pk_bf16_f32 v177, v58, v59
v_mfma_f32_16x16x32_bf16 v[92:95], a[196:199], a[24:27], v[92:95]
v_cvt_pk_bf16_f32 v178, v60, v61
v_cvt_pk_bf16_f32 v179, v62, v63
v_mfma_f32_16x16x32_bf16 v[96:99], a[200:203], a[24:27], v[96:99]
v_cvt_pk_bf16_f32 v180, v64, v65
v_cvt_pk_bf16_f32 v181, v66, v67
v_mfma_f32_16x16x32_bf16 v[100:103], a[204:207], a[24:27], v[100:103]
v_cvt_pk_bf16_f32 v182, v68, v69
v_cvt_pk_bf16_f32 v183, v70, v71
v_mfma_f32_16x16x32_bf16 v[104:107], a[176:179], a[28:31], v[104:107]
v_cvt_pk_bf16_f32 v184, v72, v73
v_cvt_pk_bf16_f32 v185, v74, v75
v_mfma_f32_16x16x32_bf16 v[108:111], a[180:183], a[28:31], v[108:111]
v_cvt_pk_bf16_f32 v186, v76, v77
v_cvt_pk_bf16_f32 v187, v78, v79
v_mfma_f32_16x16x32_bf16 v[112:115], a[184:187], a[28:31], v[112:115]
v_cvt_pk_bf16_f32 v188, v80, v81
v_cvt_pk_bf16_f32 v189, v82, v83
v_mfma_f32_16x16x32_bf16 v[116:119], a[188:191], a[28:31], v[116:119]
v_cvt_pk_bf16_f32 v190, v84, v85
v_cvt_pk_bf16_f32 v191, v86, v87
v_mfma_f32_16x16x32_bf16 v[120:123], a[192:195], a[28:31], v[120:123]
v_cvt_pk_bf16_f32 v192, v88, v89
v_cvt_pk_bf16_f32 v193, v90, v91
v_mfma_f32_16x16x32_bf16 v[124:127], a[196:199], a[28:31], v[124:127]
v_cvt_pk_bf16_f32 v194, v92, v93
v_cvt_pk_bf16_f32 v195, v94, v95
v_mfma_f32_16x16x32_bf16 v[128:131], a[200:203], a[28:31], v[128:131]
v_cvt_pk_bf16_f32 v196, v96, v97
v_cvt_pk_bf16_f32 v197, v98, v99
v_mfma_f32_16x16x32_bf16 v[132:135], a[204:207], a[28:31], v[132:135]
v_cvt_pk_bf16_f32 v198, v100, v101
v_cvt_pk_bf16_f32 v199, v102, v103
s_waitcnt lgkmcnt(7)
v_mfma_f32_16x16x32_bf16 v[8:11], a[144:147], v[152:155], 0
v_cvt_pk_bf16_f32 v200, v104, v105
v_cvt_pk_bf16_f32 v201, v106, v107
s_waitcnt lgkmcnt(6)
v_mfma_f32_16x16x32_bf16 v[8:11], a[148:151], v[156:159], v[8:11]
v_cvt_pk_bf16_f32 v202, v108, v109
v_cvt_pk_bf16_f32 v203, v110, v111
s_waitcnt lgkmcnt(5)
v_mfma_f32_16x16x32_bf16 v[8:11], a[152:155], v[160:163], v[8:11]
v_cvt_pk_bf16_f32 v204, v112, v113
v_cvt_pk_bf16_f32 v205, v114, v115
s_waitcnt lgkmcnt(4)
v_mfma_f32_16x16x32_bf16 v[8:11], a[156:159], v[164:167], v[8:11]
v_cvt_pk_bf16_f32 v206, v116, v117
v_cvt_pk_bf16_f32 v207, v118, v119
s_waitcnt lgkmcnt(3)
v_mfma_f32_16x16x32_bf16 v[12:15], a[160:163], v[152:155], 0
v_cvt_pk_bf16_f32 v208, v120, v121
v_cvt_pk_bf16_f32 v209, v122, v123
s_waitcnt lgkmcnt(2)
v_mfma_f32_16x16x32_bf16 v[12:15], a[164:167], v[156:159], v[12:15]
v_cvt_pk_bf16_f32 v210, v124, v125
v_cvt_pk_bf16_f32 v211, v126, v127
s_waitcnt lgkmcnt(1)
v_mfma_f32_16x16x32_bf16 v[12:15], a[168:171], v[160:163], v[12:15]
v_cvt_pk_bf16_f32 v212, v128, v129
v_cvt_pk_bf16_f32 v213, v130, v131
s_waitcnt lgkmcnt(0)
v_mfma_f32_16x16x32_bf16 v[12:15], a[172:175], v[164:167], v[12:15]
STUB_3:
STUB_A3:
s_cbranch_execz STUB_6
v_cvt_pk_bf16_f32 v214, v132, v133
v_cvt_pk_bf16_f32 v215, v134, v135
v_mfma_f32_16x16x32_bf16 v[16:19], a[144:147], v[168:171], 0
buffer_load_dwordx4 v228, s[8:11], s32 offen offset:0  lds
v_mfma_f32_16x16x32_bf16 v[16:19], a[148:151], v[172:175], v[16:19]
buffer_load_dwordx4 v229, s[8:11], s32 offen offset:1024  lds
v_mfma_f32_16x16x32_bf16 v[16:19], a[152:155], v[176:179], v[16:19]
buffer_load_dwordx4 v230, s[8:11], s32 offen offset:2048  lds
v_mfma_f32_16x16x32_bf16 v[16:19], a[156:159], v[180:183], v[16:19]
buffer_load_dwordx4 v231, s[8:11], s32 offen offset:3072  lds
v_max3_f32 v248, v8, v9, v10
v_mfma_f32_16x16x32_bf16 v[20:23], a[160:163], v[168:171], 0
s_add_u32 s39, s7, 16384
s_add_u32 m0, s30, 147456
v_mfma_f32_16x16x32_bf16 v[20:23], a[164:167], v[172:175], v[20:23]
buffer_load_dwordx4 v232, s[12:15], s39 offen offset:0  lds
v_mfma_f32_16x16x32_bf16 v[20:23], a[168:171], v[176:179], v[20:23]
buffer_load_dwordx4 v233, s[12:15], s39 offen offset:1024  lds
v_mfma_f32_16x16x32_bf16 v[20:23], a[172:175], v[180:183], v[20:23]
v_max3_f32 v248, v248, v11, v12
v_max3_f32 v248, v248, v13, v14
v_mfma_f32_16x16x32_bf16 v[24:27], a[144:147], v[184:187], 0
v_max_f32 v248, v248, v15
v_mov_b32 v249, v248
v_mfma_f32_16x16x32_bf16 v[24:27], a[148:151], v[188:191], v[24:27]
s_nop 0
v_permlane16_swap_b32 v248, v249
v_mfma_f32_16x16x32_bf16 v[24:27], a[152:155], v[192:195], v[24:27]
v_max_f32 v248, v248, v249
v_mov_b32 v249, v248
v_mfma_f32_16x16x32_bf16 v[24:27], a[156:159], v[196:199], v[24:27]
s_nop 0
v_permlane32_swap_b32 v248, v249
v_mfma_f32_16x16x32_bf16 v[28:31], a[160:163], v[184:187], 0
v_max_f32 v248, v248, v249
v_sub_f32 v136, 0, v248
v_sub_f32 v137, 0, v248
v_mfma_f32_16x16x32_bf16 v[28:31], a[164:167], v[188:191], v[28:31]
v_sub_f32 v138, 0, v248
v_sub_f32 v139, 0, v248
v_sub_f32 v8, v8, v248
v_mfma_f32_16x16x32_bf16 v[28:31], a[168:171], v[192:195], v[28:31]
v_sub_f32 v9, v9, v248
v_sub_f32 v10, v10, v248
v_sub_f32 v11, v11, v248
v_mfma_f32_16x16x32_bf16 v[28:31], a[172:175], v[196:199], v[28:31]
v_sub_f32 v12, v12, v248
v_sub_f32 v13, v13, v248
v_sub_f32 v14, v14, v248
v_mfma_f32_16x16x32_bf16 v[32:35], a[144:147], v[200:203], 0
v_sub_f32 v15, v15, v248
v_max3_f32 v250, v16, v17, v18
v_max3_f32 v250, v250, v19, v20
v_mfma_f32_16x16x32_bf16 v[32:35], a[148:151], v[204:207], v[32:35]
v_max3_f32 v250, v250, v21, v22
v_max_f32 v250, v250, v23
v_mov_b32 v251, v250
v_mfma_f32_16x16x32_bf16 v[32:35], a[152:155], v[208:211], v[32:35]
s_nop 0
v_permlane16_swap_b32 v250, v251
v_max_f32 v250, v250, v251
v_mfma_f32_16x16x32_bf16 v[32:35], a[156:159], v[212:215], v[32:35]
v_mov_b32 v251, v250
s_nop 1
v_permlane32_swap_b32 v250, v251
v_mfma_f32_16x16x32_bf16 v[36:39], a[160:163], v[200:203], 0
v_max_f32 v250, v250, v251
v_sub_f32 v140, 0, v250
v_sub_f32 v141, 0, v250
v_mfma_f32_16x16x32_bf16 v[36:39], a[164:167], v[204:207], v[36:39]
v_sub_f32 v142, 0, v250
v_sub_f32 v143, 0, v250
v_sub_f32 v16, v16, v250
v_mfma_f32_16x16x32_bf16 v[36:39], a[168:171], v[208:211], v[36:39]
v_sub_f32 v17, v17, v250
v_sub_f32 v18, v18, v250
v_sub_f32 v19, v19, v250
v_mfma_f32_16x16x32_bf16 v[36:39], a[172:175], v[212:215], v[36:39]
v_sub_f32 v20, v20, v250
v_sub_f32 v21, v21, v250
v_sub_f32 v22, v22, v250
ds_read_b128 a[144:147], v216 offset:24576
ds_read_b128 a[148:151], v217 offset:24576
ds_read_b128 a[152:155], v218 offset:24576
ds_read_b128 a[156:159], v219 offset:24576
ds_read_b128 a[160:163], v216 offset:28672
ds_read_b128 a[164:167], v217 offset:28672
ds_read_b128 a[168:171], v218 offset:28672
ds_read_b128 a[172:175], v219 offset:28672
buffer_load_dwordx4 v232, s[12:15], s39 offen offset:2048  lds
buffer_load_dwordx4 v233, s[12:15], s39 offen offset:3072  lds
s_add_u32 s32, s7, 32768
s_add_u32 s39, s7, 16384
v_sub_f32 v23, v23, v250
v_max3_f32 v248, v24, v25, v26
v_max3_f32 v248, v248, v27, v28
v_max3_f32 v248, v248, v29, v30
v_max_f32 v248, v248, v31
s_nop 3
v_max3_f32 v250, v32, v33, v34
v_max3_f32 v250, v250, v35, v36
v_max3_f32 v250, v250, v37, v38
v_max_f32 v250, v250, v39
v_mov_b32 v249, v248
v_mov_b32 v251, v250
s_nop 0
v_permlane16_swap_b32 v248, v249
v_permlane16_swap_b32 v250, v251
v_max_f32 v248, v248, v249
v_max_f32 v250, v250, v251
v_mov_b32 v249, v248
v_mov_b32 v251, v250
s_nop 0
v_permlane32_swap_b32 v248, v249
v_permlane32_swap_b32 v250, v251
v_max_f32 v248, v248, v249
v_max_f32 v250, v250, v251
v_sub_f32 v144, 0, v248
v_sub_f32 v148, 0, v250
v_sub_f32 v145, 0, v248
v_sub_f32 v149, 0, v250
v_sub_f32 v146, 0, v248
v_sub_f32 v150, 0, v250
v_sub_f32 v147, 0, v248
v_sub_f32 v151, 0, v250
v_sub_f32 v24, v24, v248
v_sub_f32 v32, v32, v250
v_sub_f32 v25, v25, v248
v_sub_f32 v33, v33, v250
v_sub_f32 v26, v26, v248
v_sub_f32 v34, v34, v250
v_sub_f32 v27, v27, v248
v_sub_f32 v35, v35, v250
v_sub_f32 v28, v28, v248
v_sub_f32 v36, v36, v250
v_sub_f32 v29, v29, v248
v_sub_f32 v37, v37, v250
v_sub_f32 v30, v30, v248
v_sub_f32 v38, v38, v250
v_sub_f32 v31, v31, v248
v_sub_f32 v39, v39, v250
K_BODY0:
s_waitcnt lgkmcnt(0)
v_mfma_f32_16x16x32_bf16 v[40:43], a[144:147], v[152:155], v[136:139]
v_exp_f32 v8, v8
v_exp_f32 v9, v9
v_mfma_f32_16x16x32_bf16 v[40:43], a[148:151], v[156:159], v[40:43]
v_cvt_pk_bf16_f32 v72, v8, v9
v_bfe_u32 v246, v1, 2, 2
v_exp_f32 v10, v10
v_mfma_f32_16x16x32_bf16 v[40:43], a[152:155], v[160:163], v[40:43]
v_lshl_add_u32 v241, v4, 3, v246
v_lshl_add_u32 v246, v4, 2, v246
v_exp_f32 v11, v11
v_mfma_f32_16x16x32_bf16 v[40:43], a[156:159], v[164:167], v[40:43]
v_cvt_pk_bf16_f32 v73, v10, v11
v_and_b32 v247, 3, v1
v_exp_f32 v12, v12
v_mfma_f32_16x16x32_bf16 v[48:51], a[156:159], v[180:183], v[140:143]
v_lshlrev_b32 v247, 3, v247
v_lshl_add_u32 v241, v241, 6, v247
v_exp_f32 v13, v13
v_mfma_f32_16x16x32_bf16 v[48:51], a[152:155], v[176:179], v[48:51]
s_and_b32 s28, s37, 1
v_cvt_pk_bf16_f32 v74, v12, v13
v_exp_f32 v14, v14
v_mfma_f32_16x16x32_bf16 v[48:51], a[148:151], v[172:175], v[48:51]
s_lshl_b32 s28, s28, 5
s_lshr_b32 s29, s37, 1
v_exp_f32 v15, v15
v_mfma_f32_16x16x32_bf16 v[48:51], a[144:147], v[168:171], v[48:51]
v_exp_f32 v16, v16
v_exp_f32 v17, v17
v_mfma_f32_16x16x32_bf16 v[56:59], a[144:147], v[184:187], v[144:147]
v_cvt_pk_bf16_f32 v75, v14, v15
v_cvt_pk_bf16_f32 v76, v16, v17
v_exp_f32 v18, v18
v_mfma_f32_16x16x32_bf16 v[56:59], a[148:151], v[188:191], v[56:59]
s_lshl_b32 s29, s29, 15
s_add_u32 s28, s28, s29
v_exp_f32 v19, v19
v_mfma_f32_16x16x32_bf16 v[56:59], a[152:155], v[192:195], v[56:59]
v_cvt_pk_bf16_f32 v77, v18, v19
v_add_u32 v241, s28, v241
v_exp_f32 v20, v20
v_mfma_f32_16x16x32_bf16 v[56:59], a[156:159], v[196:199], v[56:59]
v_mul_u32_u24 v242, 0x480, v246
v_add_u32 v242, v242, v247
v_exp_f32 v21, v21
v_mfma_f32_16x16x32_bf16 v[64:67], a[156:159], v[212:215], v[148:151]
s_waitcnt vmcnt(8) lgkmcnt(0)
s_barrier
v_exp_f32 v22, v22
v_mfma_f32_16x16x32_bf16 v[64:67], a[152:155], v[208:211], v[64:67]
ds_read_b64_tr_b16 a[176:177], v220 offset:32768
v_cvt_pk_bf16_f32 v78, v20, v21
v_exp_f32 v23, v23
v_mfma_f32_16x16x32_bf16 v[64:67], a[148:151], v[204:207], v[64:67]
v_exp_f32 v24, v24
v_exp_f32 v25, v25
v_mfma_f32_16x16x32_bf16 v[64:67], a[144:147], v[200:203], v[64:67]
v_cvt_pk_bf16_f32 v79, v22, v23
v_cvt_pk_bf16_f32 v80, v24, v25
v_exp_f32 v26, v26
v_mfma_f32_16x16x32_bf16 v[44:47], a[160:163], v[152:155], v[136:139]
ds_read_b64_tr_b16 a[178:179], v220 offset:36864
ds_read_b64_tr_b16 a[180:181], v221 offset:32768
v_exp_f32 v27, v27
v_mfma_f32_16x16x32_bf16 v[44:47], a[164:167], v[156:159], v[44:47]
ds_read_b64_tr_b16 a[182:183], v221 offset:36864
v_cvt_pk_bf16_f32 v81, v26, v27
v_exp_f32 v28, v28
v_mfma_f32_16x16x32_bf16 v[44:47], a[168:171], v[160:163], v[44:47]
ds_read_b64_tr_b16 a[184:185], v222 offset:32768
ds_read_b64_tr_b16 a[186:187], v222 offset:36864
v_exp_f32 v29, v29
v_mfma_f32_16x16x32_bf16 v[44:47], a[172:175], v[164:167], v[44:47]
ds_read_b64_tr_b16 a[188:189], v223 offset:32768
v_cvt_pk_bf16_f32 v82, v28, v29
v_exp_f32 v30, v30
v_mfma_f32_16x16x32_bf16 v[52:55], a[172:175], v[180:183], v[140:143]
ds_read_b64_tr_b16 a[190:191], v223 offset:36864
ds_read_b128 a[156:159], v219 offset:49152
v_exp_f32 v31, v31
v_mfma_f32_16x16x32_bf16 v[52:55], a[168:171], v[176:179], v[52:55]
v_exp_f32 v32, v32
v_exp_f32 v33, v33
v_mfma_f32_16x16x32_bf16 v[52:55], a[164:167], v[172:175], v[52:55]
v_cvt_pk_bf16_f32 v83, v30, v31
v_cvt_pk_bf16_f32 v84, v32, v33
v_exp_f32 v34, v34
v_mfma_f32_16x16x32_bf16 v[52:55], a[160:163], v[168:171], v[52:55]
ds_read_b64_tr_b16 a[192:193], v224 offset:32768
ds_read_b64_tr_b16 a[194:195], v224 offset:36864
v_exp_f32 v35, v35
v_mfma_f32_16x16x32_bf16 v[60:63], a[160:163], v[184:187], v[144:147]
ds_read_b128 a[152:155], v218 offset:49152
v_cvt_pk_bf16_f32 v85, v34, v35
v_exp_f32 v36, v36
v_mfma_f32_16x16x32_bf16 v[60:63], a[164:167], v[188:191], v[60:63]
ds_read_b128 a[148:151], v217 offset:49152
ds_read_b128 a[144:147], v216 offset:49152
v_exp_f32 v37, v37
v_mfma_f32_16x16x32_bf16 v[60:63], a[168:171], v[192:195], v[60:63]
ds_read_b64_tr_b16 a[196:197], v225 offset:32768
v_cvt_pk_bf16_f32 v86, v36, v37
v_exp_f32 v38, v38
v_mfma_f32_16x16x32_bf16 v[60:63], a[172:175], v[196:199], v[60:63]
ds_read_b64_tr_b16 a[198:199], v225 offset:36864
ds_read_b64_tr_b16 a[200:201], v226 offset:32768
v_exp_f32 v39, v39
v_mfma_f32_16x16x32_bf16 v[68:71], a[172:175], v[212:215], v[148:151]
ds_read_b64_tr_b16 a[202:203], v226 offset:36864
ds_read_b64_tr_b16 a[204:205], v227 offset:32768
ds_read_b64_tr_b16 a[206:207], v227 offset:36864
v_cvt_pk_bf16_f32 v87, v38, v39
v_mfma_f32_16x16x32_bf16 v[68:71], a[168:171], v[208:211], v[68:71]
ds_read_b128 a[172:175], v219 offset:53248
ds_read_b128 a[168:171], v218 offset:53248
s_add_u32 s32, s32, 16384
s_add_u32 m0, s30, 81920
v_mfma_f32_16x16x32_bf16 v[68:71], a[164:167], v[204:207], v[68:71]
ds_read_b128 a[164:167], v217 offset:53248
buffer_load_dwordx4 v228, s[8:11], s32 offen offset:0  lds
s_mul_i32 s28, s37, 288
v_mfma_f32_16x16x32_bf16 v[68:71], a[160:163], v[200:203], v[68:71]
ds_read_b128 a[160:163], v216 offset:53248
buffer_load_dwordx4 v229, s[8:11], s32 offen offset:1024  lds
s_add_u32 s28, s28, 8192
buffer_load_dwordx4 v230, s[8:11], s32 offen offset:2048  lds
buffer_load_dwordx4 v231, s[8:11], s32 offen offset:3072  lds
buffer_store_byte v255, v254, s[24:27], 0 offen sc0 sc1
s_waitcnt lgkmcnt(8)
v_mfma_f32_16x16x32_bf16 v[8:11], a[144:147], v[152:155], v[136:139]
v_exp_f32 v40, v40
v_mfma_f32_16x16x32_bf16 v[8:11], a[148:151], v[156:159], v[8:11]
v_exp_f32 v41, v41
v_mfma_f32_16x16x32_bf16 v[8:11], a[152:155], v[160:163], v[8:11]
v_cvt_pk_bf16_f32 v88, v40, v41
v_add_u32 v242, s28, v242
v_mfma_f32_16x16x32_bf16 v[8:11], a[156:159], v[164:167], v[8:11]
v_exp_f32 v42, v42
v_mfma_f32_16x16x32_bf16 v[16:19], a[156:159], v[180:183], v[140:143]
s_add_u32 s39, s39, 16384
v_mfma_f32_16x16x32_bf16 v[16:19], a[152:155], v[176:179], v[16:19]
v_exp_f32 v43, v43
v_mfma_f32_16x16x32_bf16 v[16:19], a[148:151], v[172:175], v[16:19]
v_cvt_pk_bf16_f32 v89, v42, v43
v_mfma_f32_16x16x32_bf16 v[16:19], a[144:147], v[168:171], v[16:19]
v_exp_f32 v44, v44
v_mfma_f32_16x16x32_bf16 v[24:27], a[144:147], v[184:187], v[144:147]
v_mfma_f32_16x16x32_bf16 v[24:27], a[148:151], v[188:191], v[24:27]
v_exp_f32 v45, v45
v_mfma_f32_16x16x32_bf16 v[24:27], a[152:155], v[192:195], v[24:27]
v_cvt_pk_bf16_f32 v90, v44, v45
v_mfma_f32_16x16x32_bf16 v[24:27], a[156:159], v[196:199], v[24:27]
v_exp_f32 v46, v46
v_mfma_f32_16x16x32_bf16 v[32:35], a[156:159], v[212:215], v[148:151]
ds_read_b128 a[156:159], v219 offset:57344
s_add_u32 m0, s30, 98304
v_mfma_f32_16x16x32_bf16 v[32:35], a[152:155], v[208:211], v[32:35]
v_exp_f32 v47, v47
v_mfma_f32_16x16x32_bf16 v[32:35], a[148:151], v[204:207], v[32:35]
ds_read_b128 a[152:155], v218 offset:57344
v_cvt_pk_bf16_f32 v91, v46, v47
v_mfma_f32_16x16x32_bf16 v[32:35], a[144:147], v[200:203], v[32:35]
v_exp_f32 v48, v48
v_mfma_f32_16x16x32_bf16 a[0:3], v[72:75], a[176:179], 0
ds_read_b128 a[148:151], v217 offset:57344
ds_read_b128 a[144:147], v216 offset:57344
v_mfma_f32_16x16x32_bf16 a[16:19], v[72:75], a[180:183], 0
v_exp_f32 v49, v49
v_mfma_f32_16x16x32_bf16 a[20:23], v[76:79], a[180:183], 0
v_cvt_pk_bf16_f32 v92, v48, v49
v_mfma_f32_16x16x32_bf16 a[4:7], v[76:79], a[176:179], 0
v_exp_f32 v50, v50
v_mfma_f32_16x16x32_bf16 a[8:11], v[80:83], a[176:179], 0
v_mfma_f32_16x16x32_bf16 a[24:27], v[80:83], a[180:183], 0
v_exp_f32 v51, v51
v_mfma_f32_16x16x32_bf16 a[28:31], v[84:87], a[180:183], 0
ds_read_b64_tr_b16 a[180:181], v221 offset:40960
v_cvt_pk_bf16_f32 v93, v50, v51
v_mfma_f32_16x16x32_bf16 a[12:15], v[84:87], a[176:179], 0
v_exp_f32 v52, v52
v_mfma_f32_16x16x32_bf16 a[44:47], v[84:87], a[184:187], 0
ds_read_b64_tr_b16 a[182:183], v221 offset:45056
ds_read_b64_tr_b16 a[176:177], v220 offset:40960
v_mfma_f32_16x16x32_bf16 a[60:63], v[84:87], a[188:191], 0
v_exp_f32 v53, v53
v_mfma_f32_16x16x32_bf16 a[56:59], v[80:83], a[188:191], 0
ds_read_b64_tr_b16 a[178:179], v220 offset:45056
v_cvt_pk_bf16_f32 v94, v52, v53
v_mfma_f32_16x16x32_bf16 a[40:43], v[80:83], a[184:187], 0
v_exp_f32 v54, v54
v_mfma_f32_16x16x32_bf16 a[36:39], v[76:79], a[184:187], 0
buffer_load_dwordx4 v232, s[12:15], s39 offen offset:0  lds
v_mfma_f32_16x16x32_bf16 a[52:55], v[76:79], a[188:191], 0
v_exp_f32 v55, v55
v_mfma_f32_16x16x32_bf16 a[48:51], v[72:75], a[188:191], 0
ds_read_b64_tr_b16 a[188:189], v223 offset:40960
v_cvt_pk_bf16_f32 v95, v54, v55
v_mfma_f32_16x16x32_bf16 a[32:35], v[72:75], a[184:187], 0
v_exp_f32 v56, v56
v_smfmac_f32_16x16x64_bf16 a[128:131], a[208:211], v[72:79], v245
ds_read_b64_tr_b16 a[190:191], v223 offset:45056
s_waitcnt lgkmcnt(8)
v_mfma_f32_16x16x32_bf16 v[12:15], a[160:163], v[152:155], v[136:139]
v_exp_f32 v57, v57
v_mfma_f32_16x16x32_bf16 v[12:15], a[164:167], v[156:159], v[12:15]
v_exp_f32 v58, v58
v_mfma_f32_16x16x32_bf16 v[12:15], a[168:171], v[160:163], v[12:15]
ds_read_b64_tr_b16 a[184:185], v222 offset:40960
v_cvt_pk_bf16_f32 v96, v56, v57
v_mfma_f32_16x16x32_bf16 v[12:15], a[172:175], v[164:167], v[12:15]
v_exp_f32 v59, v59
v_mfma_f32_16x16x32_bf16 v[20:23], a[172:175], v[180:183], v[140:143]
ds_read_b64_tr_b16 a[186:187], v222 offset:45056
v_cvt_pk_bf16_f32 v97, v58, v59
v_mfma_f32_16x16x32_bf16 v[20:23], a[168:171], v[176:179], v[20:23]
v_exp_f32 v60, v60
v_mfma_f32_16x16x32_bf16 v[20:23], a[164:167], v[172:175], v[20:23]
buffer_load_dwordx4 v233, s[12:15], s39 offen offset:1024  lds
v_mfma_f32_16x16x32_bf16 v[20:23], a[160:163], v[168:171], v[20:23]
v_exp_f32 v61, v61
v_mfma_f32_16x16x32_bf16 v[28:31], a[160:163], v[184:187], v[144:147]
v_cvt_pk_bf16_f32 v98, v60, v61
v_mfma_f32_16x16x32_bf16 v[28:31], a[164:167], v[188:191], v[28:31]
v_exp_f32 v62, v62
v_mfma_f32_16x16x32_bf16 v[28:31], a[168:171], v[192:195], v[28:31]
buffer_load_dwordx4 v232, s[12:15], s39 offen offset:2048  lds
v_mfma_f32_16x16x32_bf16 v[28:31], a[172:175], v[196:199], v[28:31]
v_exp_f32 v63, v63
v_mfma_f32_16x16x32_bf16 v[36:39], a[172:175], v[212:215], v[148:151]
ds_read_b128 a[172:175], v219 offset:61440
v_cvt_pk_bf16_f32 v99, v62, v63
v_mfma_f32_16x16x32_bf16 v[36:39], a[168:171], v[208:211], v[36:39]
v_exp_f32 v64, v64
v_mfma_f32_16x16x32_bf16 v[36:39], a[164:167], v[204:207], v[36:39]
ds_read_b128 a[168:171], v218 offset:61440
ds_read_b128 a[164:167], v217 offset:61440
v_mfma_f32_16x16x32_bf16 v[36:39], a[160:163], v[200:203], v[36:39]
v_exp_f32 v65, v65
v_mfma_f32_16x16x32_bf16 a[64:67], v[72:75], a[192:195], 0
ds_read_b128 a[160:163], v216 offset:61440
v_cvt_pk_bf16_f32 v100, v64, v65
v_mfma_f32_16x16x32_bf16 a[80:83], v[72:75], a[196:199], 0
v_exp_f32 v66, v66
v_mfma_f32_16x16x32_bf16 a[84:87], v[76:79], a[196:199], 0
buffer_load_dwordx4 v233, s[12:15], s39 offen offset:3072  lds
v_mfma_f32_16x16x32_bf16 a[68:71], v[76:79], a[192:195], 0
v_exp_f32 v67, v67
v_mfma_f32_16x16x32_bf16 a[72:75], v[80:83], a[192:195], 0
v_cvt_pk_bf16_f32 v101, v66, v67
v_mfma_f32_16x16x32_bf16 a[88:91], v[80:83], a[196:199], 0
v_exp_f32 v68, v68
v_mfma_f32_16x16x32_bf16 a[92:95], v[84:87], a[196:199], 0
ds_read_b64_tr_b16 a[196:197], v225 offset:40960
ds_read_b64_tr_b16 a[198:199], v225 offset:45056
v_mfma_f32_16x16x32_bf16 a[76:79], v[84:87], a[192:195], 0
v_exp_f32 v69, v69
v_mfma_f32_16x16x32_bf16 a[108:111], v[84:87], a[200:203], 0
ds_read_b64_tr_b16 a[192:193], v224 offset:40960
v_cvt_pk_bf16_f32 v102, v68, v69
v_mfma_f32_16x16x32_bf16 a[124:127], v[84:87], a[204:207], 0
v_exp_f32 v70, v70
v_mfma_f32_16x16x32_bf16 a[120:123], v[80:83], a[204:207], 0
ds_read_b64_tr_b16 a[194:195], v224 offset:45056
v_mfma_f32_16x16x32_bf16 a[104:107], v[80:83], a[200:203], 0
v_exp_f32 v71, v71
v_mfma_f32_16x16x32_bf16 a[100:103], v[76:79], a[200:203], 0
v_cvt_pk_bf16_f32 v103, v70, v71
v_mfma_f32_16x16x32_bf16 a[116:119], v[76:79], a[204:207], 0
v_mfma_f32_16x16x32_bf16 a[112:115], v[72:75], a[204:207], 0
ds_read_b64_tr_b16 a[204:205], v227 offset:40960
ds_read_b64_tr_b16 a[206:207], v227 offset:45056
v_mfma_f32_16x16x32_bf16 a[96:99], v[72:75], a[200:203], 0
ds_read_b64_tr_b16 a[200:201], v226 offset:40960
ds_read_b64_tr_b16 a[202:203], v226 offset:45056
v_smfmac_f32_16x16x64_bf16 a[132:135], a[208:211], v[80:87], v245
s_waitcnt lgkmcnt(8)
v_mfma_f32_16x16x32_bf16 v[40:43], a[144:147], v[152:155], v[136:139]
v_exp_f32 v8, v8
v_mfma_f32_16x16x32_bf16 v[40:43], a[148:151], v[156:159], v[40:43]
v_exp_f32 v9, v9
v_mfma_f32_16x16x32_bf16 v[40:43], a[152:155], v[160:163], v[40:43]
v_cvt_pk_bf16_f32 v72, v8, v9
v_lshlrev_b32 v250, 3, v1
v_mfma_f32_16x16x32_bf16 v[40:43], a[156:159], v[164:167], v[40:43]
v_exp_f32 v10, v10
v_mfma_f32_16x16x32_bf16 v[48:51], a[156:159], v[180:183], v[140:143]
v_mfma_f32_16x16x32_bf16 v[48:51], a[152:155], v[176:179], v[48:51]
v_exp_f32 v11, v11
v_mfma_f32_16x16x32_bf16 v[48:51], a[148:151], v[172:175], v[48:51]
v_cvt_pk_bf16_f32 v73, v10, v11
v_mfma_f32_16x16x32_bf16 v[48:51], a[144:147], v[168:171], v[48:51]
v_exp_f32 v12, v12
v_mfma_f32_16x16x32_bf16 v[56:59], a[144:147], v[184:187], v[144:147]
v_mfma_f32_16x16x32_bf16 v[56:59], a[148:151], v[188:191], v[56:59]
v_exp_f32 v13, v13
v_mfma_f32_16x16x32_bf16 v[56:59], a[152:155], v[192:195], v[56:59]
v_cvt_pk_bf16_f32 v74, v12, v13
v_mfma_f32_16x16x32_bf16 v[56:59], a[156:159], v[196:199], v[56:59]
v_exp_f32 v14, v14
v_mfma_f32_16x16x32_bf16 v[64:67], a[156:159], v[212:215], v[148:151]
s_waitcnt vmcnt(9) lgkmcnt(0)
s_barrier
v_mfma_f32_16x16x32_bf16 v[64:67], a[152:155], v[208:211], v[64:67]
v_exp_f32 v15, v15
v_mfma_f32_16x16x32_bf16 v[64:67], a[148:151], v[204:207], v[64:67]
ds_read_b128 a[156:159], v219 offset:0
v_cvt_pk_bf16_f32 v75, v14, v15
v_mfma_f32_16x16x32_bf16 v[64:67], a[144:147], v[200:203], v[64:67]
v_exp_f32 v16, v16
v_mfma_f32_16x16x32_bf16 a[0:3], v[88:91], a[176:179], a[0:3]
ds_read_b128 a[152:155], v218 offset:0
ds_read_b128 a[148:151], v217 offset:0
v_mfma_f32_16x16x32_bf16 a[16:19], v[88:91], a[180:183], a[16:19]
v_exp_f32 v17, v17
v_mfma_f32_16x16x32_bf16 a[20:23], v[92:95], a[180:183], a[20:23]
ds_read_b128 a[144:147], v216 offset:0
v_cvt_pk_bf16_f32 v76, v16, v17
v_mfma_f32_16x16x32_bf16 a[4:7], v[92:95], a[176:179], a[4:7]
v_exp_f32 v18, v18
v_mfma_f32_16x16x32_bf16 a[8:11], v[96:99], a[176:179], a[8:11]
s_add_u32 s32, s32, 16384
s_add_u32 m0, s30, 114688
v_mfma_f32_16x16x32_bf16 a[24:27], v[96:99], a[180:183], a[24:27]
v_exp_f32 v19, v19
v_mfma_f32_16x16x32_bf16 a[28:31], v[100:103], a[180:183], a[28:31]
ds_read_b64_tr_b16 a[180:181], v221 offset:49152
v_cvt_pk_bf16_f32 v77, v18, v19
v_mfma_f32_16x16x32_bf16 a[12:15], v[100:103], a[176:179], a[12:15]
v_exp_f32 v20, v20
v_mfma_f32_16x16x32_bf16 a[44:47], v[100:103], a[184:187], a[44:47]
ds_read_b64_tr_b16 a[182:183], v221 offset:53248
ds_read_b64_tr_b16 a[176:177], v220 offset:49152
v_mfma_f32_16x16x32_bf16 a[60:63], v[100:103], a[188:191], a[60:63]
v_exp_f32 v21, v21
v_mfma_f32_16x16x32_bf16 a[56:59], v[96:99], a[188:191], a[56:59]
ds_read_b64_tr_b16 a[178:179], v220 offset:53248
v_cvt_pk_bf16_f32 v78, v20, v21
v_mfma_f32_16x16x32_bf16 a[40:43], v[96:99], a[184:187], a[40:43]
v_exp_f32 v22, v22
v_mfma_f32_16x16x32_bf16 a[36:39], v[92:95], a[184:187], a[36:39]
buffer_load_dwordx4 v228, s[8:11], s32 offen offset:0  lds
v_mfma_f32_16x16x32_bf16 a[52:55], v[92:95], a[188:191], a[52:55]
v_exp_f32 v23, v23
v_mfma_f32_16x16x32_bf16 a[48:51], v[88:91], a[188:191], a[48:51]
ds_read_b64_tr_b16 a[188:189], v223 offset:49152
v_cvt_pk_bf16_f32 v79, v22, v23
v_mfma_f32_16x16x32_bf16 a[32:35], v[88:91], a[184:187], a[32:35]
v_exp_f32 v24, v24
v_smfmac_f32_16x16x64_bf16 a[128:131], a[208:211], v[88:95], v245
ds_read_b64_tr_b16 a[190:191], v223 offset:53248
v_mfma_f32_16x16x32_bf16 v[44:47], a[160:163], v[152:155], v[136:139]
v_exp_f32 v25, v25
v_mfma_f32_16x16x32_bf16 v[44:47], a[164:167], v[156:159], v[44:47]
v_exp_f32 v26, v26
v_mfma_f32_16x16x32_bf16 v[44:47], a[168:171], v[160:163], v[44:47]
ds_read_b64_tr_b16 a[184:185], v222 offset:49152
v_cvt_pk_bf16_f32 v80, v24, v25
v_mfma_f32_16x16x32_bf16 v[44:47], a[172:175], v[164:167], v[44:47]
v_exp_f32 v27, v27
v_mfma_f32_16x16x32_bf16 v[52:55], a[172:175], v[180:183], v[140:143]
ds_read_b64_tr_b16 a[186:187], v222 offset:53248
v_cvt_pk_bf16_f32 v81, v26, v27
v_mfma_f32_16x16x32_bf16 v[52:55], a[168:171], v[176:179], v[52:55]
v_exp_f32 v28, v28
v_mfma_f32_16x16x32_bf16 v[52:55], a[164:167], v[172:175], v[52:55]
buffer_load_dwordx4 v229, s[8:11], s32 offen offset:1024  lds
v_mfma_f32_16x16x32_bf16 v[52:55], a[160:163], v[168:171], v[52:55]
v_exp_f32 v29, v29
v_mfma_f32_16x16x32_bf16 v[60:63], a[160:163], v[184:187], v[144:147]
v_cvt_pk_bf16_f32 v82, v28, v29
v_mfma_f32_16x16x32_bf16 v[60:63], a[164:167], v[188:191], v[60:63]
v_exp_f32 v30, v30
v_mfma_f32_16x16x32_bf16 v[60:63], a[168:171], v[192:195], v[60:63]
buffer_load_dwordx4 v230, s[8:11], s32 offen offset:2048  lds
v_mfma_f32_16x16x32_bf16 v[60:63], a[172:175], v[196:199], v[60:63]
v_exp_f32 v31, v31
v_mfma_f32_16x16x32_bf16 v[68:71], a[172:175], v[212:215], v[148:151]
ds_read_b128 a[172:175], v219 offset:4096
v_cvt_pk_bf16_f32 v83, v30, v31
v_mfma_f32_16x16x32_bf16 v[68:71], a[168:171], v[208:211], v[68:71]
v_exp_f32 v32, v32
v_mfma_f32_16x16x32_bf16 v[68:71], a[164:167], v[204:207], v[68:71]
ds_read_b128 a[168:171], v218 offset:4096
ds_read_b128 a[164:167], v217 offset:4096
v_mfma_f32_16x16x32_bf16 v[68:71], a[160:163], v[200:203], v[68:71]
v_exp_f32 v33, v33
v_mfma_f32_16x16x32_bf16 a[64:67], v[88:91], a[192:195], a[64:67]
ds_read_b128 a[160:163], v216 offset:4096
v_cvt_pk_bf16_f32 v84, v32, v33
v_mfma_f32_16x16x32_bf16 a[80:83], v[88:91], a[196:199], a[80:83]
v_exp_f32 v34, v34
v_mfma_f32_16x16x32_bf16 a[84:87], v[92:95], a[196:199], a[84:87]
buffer_load_dwordx4 v231, s[8:11], s32 offen offset:3072  lds
v_mfma_f32_16x16x32_bf16 a[68:71], v[92:95], a[192:195], a[68:71]
v_exp_f32 v35, v35
v_mfma_f32_16x16x32_bf16 a[72:75], v[96:99], a[192:195], a[72:75]
v_cvt_pk_bf16_f32 v85, v34, v35
v_mfma_f32_16x16x32_bf16 a[88:91], v[96:99], a[196:199], a[88:91]
v_exp_f32 v36, v36
v_mfma_f32_16x16x32_bf16 a[92:95], v[100:103], a[196:199], a[92:95]
ds_read_b64_tr_b16 a[196:197], v225 offset:49152
ds_read_b64_tr_b16 a[198:199], v225 offset:53248
v_mfma_f32_16x16x32_bf16 a[76:79], v[100:103], a[192:195], a[76:79]
v_exp_f32 v37, v37
v_mfma_f32_16x16x32_bf16 a[108:111], v[100:103], a[200:203], a[108:111]
ds_read_b64_tr_b16 a[192:193], v224 offset:49152
v_cvt_pk_bf16_f32 v86, v36, v37
v_mfma_f32_16x16x32_bf16 a[124:127], v[100:103], a[204:207], a[124:127]
v_exp_f32 v38, v38
v_mfma_f32_16x16x32_bf16 a[120:123], v[96:99], a[204:207], a[120:123]
ds_read_b64_tr_b16 a[194:195], v224 offset:53248
v_mfma_f32_16x16x32_bf16 a[104:107], v[96:99], a[200:203], a[104:107]
v_exp_f32 v39, v39
v_mfma_f32_16x16x32_bf16 a[100:103], v[92:95], a[200:203], a[100:103]
v_cvt_pk_bf16_f32 v87, v38, v39
v_mfma_f32_16x16x32_bf16 a[116:119], v[92:95], a[204:207], a[116:119]
s_add_u32 m0, s86, 0
s_add_u32 s50, s84, 0
buffer_load_dwordx4 v240, s[64:67], s50 offen lds
v_mfma_f32_16x16x32_bf16 a[112:115], v[88:91], a[204:207], a[112:115]
ds_read_b64_tr_b16 a[204:205], v227 offset:49152
ds_read_b64_tr_b16 a[206:207], v227 offset:53248
v_mfma_f32_16x16x32_bf16 a[96:99], v[88:91], a[200:203], a[96:99]
ds_read_b64_tr_b16 a[200:201], v226 offset:49152
ds_read_b64_tr_b16 a[202:203], v226 offset:53248
v_smfmac_f32_16x16x64_bf16 a[132:135], a[208:211], v[96:103], v245
s_add_u32 m0, s86, 4096
s_add_u32 s50, s84, 589824
buffer_load_dwordx4 v240, s[64:67], s50 offen lds
s_waitcnt lgkmcnt(8)
v_mfma_f32_16x16x32_bf16 v[8:11], a[144:147], v[152:155], v[136:139]
v_exp_f32 v40, v40
v_mfma_f32_16x16x32_bf16 v[8:11], a[148:151], v[156:159], v[8:11]
v_exp_f32 v41, v41
v_mfma_f32_16x16x32_bf16 v[8:11], a[152:155], v[160:163], v[8:11]
v_cvt_pk_bf16_f32 v88, v40, v41
v_mfma_f32_16x16x32_bf16 v[8:11], a[156:159], v[164:167], v[8:11]
v_exp_f32 v42, v42
v_mfma_f32_16x16x32_bf16 v[16:19], a[156:159], v[180:183], v[140:143]
s_add_u32 s39, s39, 16384
v_mfma_f32_16x16x32_bf16 v[16:19], a[152:155], v[176:179], v[16:19]
v_exp_f32 v43, v43
v_mfma_f32_16x16x32_bf16 v[16:19], a[148:151], v[172:175], v[16:19]
v_cvt_pk_bf16_f32 v89, v42, v43
v_mfma_f32_16x16x32_bf16 v[16:19], a[144:147], v[168:171], v[16:19]
v_exp_f32 v44, v44
v_mfma_f32_16x16x32_bf16 v[24:27], a[144:147], v[184:187], v[144:147]
s_mov_b32 s29, 0x242000
buffer_load_dwordx2 v[248:249], v250, s[20:23], s29 offen sc0 sc1
v_mfma_f32_16x16x32_bf16 v[24:27], a[148:151], v[188:191], v[24:27]
v_exp_f32 v45, v45
v_mfma_f32_16x16x32_bf16 v[24:27], a[152:155], v[192:195], v[24:27]
s_add_u32 m0, s30, 131072
v_cvt_pk_bf16_f32 v90, v44, v45
v_mfma_f32_16x16x32_bf16 v[24:27], a[156:159], v[196:199], v[24:27]
v_exp_f32 v46, v46
v_mfma_f32_16x16x32_bf16 v[32:35], a[156:159], v[212:215], v[148:151]
ds_read_b128 a[156:159], v219 offset:8192
v_mfma_f32_16x16x32_bf16 v[32:35], a[152:155], v[208:211], v[32:35]
v_exp_f32 v47, v47
v_mfma_f32_16x16x32_bf16 v[32:35], a[148:151], v[204:207], v[32:35]
ds_read_b128 a[152:155], v218 offset:8192
v_cvt_pk_bf16_f32 v91, v46, v47
v_mfma_f32_16x16x32_bf16 v[32:35], a[144:147], v[200:203], v[32:35]
v_exp_f32 v48, v48
v_mfma_f32_16x16x32_bf16 a[0:3], v[72:75], a[176:179], a[0:3]
ds_read_b128 a[148:151], v217 offset:8192
ds_read_b128 a[144:147], v216 offset:8192
v_mfma_f32_16x16x32_bf16 a[16:19], v[72:75], a[180:183], a[16:19]
v_exp_f32 v49, v49
v_mfma_f32_16x16x32_bf16 a[20:23], v[76:79], a[180:183], a[20:23]
v_cvt_pk_bf16_f32 v92, v48, v49
v_mfma_f32_16x16x32_bf16 a[4:7], v[76:79], a[176:179], a[4:7]
v_exp_f32 v50, v50
STUB_4:
s_cbranch_execz STUB_7
v_mfma_f32_16x16x32_bf16 a[8:11], v[80:83], a[176:179], a[8:11]
buffer_load_dwordx4 v232, s[12:15], s39 offen offset:0  lds
v_mfma_f32_16x16x32_bf16 a[24:27], v[80:83], a[180:183], a[24:27]
v_exp_f32 v51, v51
v_mfma_f32_16x16x32_bf16 a[28:31], v[84:87], a[180:183], a[28:31]
ds_read_b64_tr_b16 a[180:181], v221 offset:57344
v_cvt_pk_bf16_f32 v93, v50, v51
v_mfma_f32_16x16x32_bf16 a[12:15], v[84:87], a[176:179], a[12:15]
v_exp_f32 v52, v52
v_mfma_f32_16x16x32_bf16 a[44:47], v[84:87], a[184:187], a[44:47]
ds_read_b64_tr_b16 a[182:183], v221 offset:61440
ds_read_b64_tr_b16 a[176:177], v220 offset:57344
v_mfma_f32_16x16x32_bf16 a[60:63], v[84:87], a[188:191], a[60:63]
v_exp_f32 v53, v53
v_mfma_f32_16x16x32_bf16 a[56:59], v[80:83], a[188:191], a[56:59]
ds_read_b64_tr_b16 a[178:179], v220 offset:61440
v_cvt_pk_bf16_f32 v94, v52, v53
v_mfma_f32_16x16x32_bf16 a[40:43], v[80:83], a[184:187], a[40:43]
v_exp_f32 v54, v54
v_mfma_f32_16x16x32_bf16 a[36:39], v[76:79], a[184:187], a[36:39]
buffer_load_dwordx4 v233, s[12:15], s39 offen offset:1024  lds
v_mfma_f32_16x16x32_bf16 a[52:55], v[76:79], a[188:191], a[52:55]
v_exp_f32 v55, v55
v_mfma_f32_16x16x32_bf16 a[48:51], v[72:75], a[188:191], a[48:51]
ds_read_b64_tr_b16 a[188:189], v223 offset:57344
v_cvt_pk_bf16_f32 v95, v54, v55
v_mfma_f32_16x16x32_bf16 a[32:35], v[72:75], a[184:187], a[32:35]
v_exp_f32 v56, v56
v_smfmac_f32_16x16x64_bf16 a[128:131], a[208:211], v[72:79], v245
ds_read_b64_tr_b16 a[190:191], v223 offset:61440
v_mfma_f32_16x16x32_bf16 v[12:15], a[160:163], v[152:155], v[136:139]
v_exp_f32 v57, v57
v_mfma_f32_16x16x32_bf16 v[12:15], a[164:167], v[156:159], v[12:15]
v_exp_f32 v58, v58
v_mfma_f32_16x16x32_bf16 v[12:15], a[168:171], v[160:163], v[12:15]
ds_read_b64_tr_b16 a[184:185], v222 offset:57344
v_cvt_pk_bf16_f32 v96, v56, v57
v_mfma_f32_16x16x32_bf16 v[12:15], a[172:175], v[164:167], v[12:15]
v_exp_f32 v59, v59
v_mfma_f32_16x16x32_bf16 v[20:23], a[172:175], v[180:183], v[140:143]
ds_read_b64_tr_b16 a[186:187], v222 offset:61440
v_cvt_pk_bf16_f32 v97, v58, v59
v_mfma_f32_16x16x32_bf16 v[20:23], a[168:171], v[176:179], v[20:23]
v_exp_f32 v60, v60
v_mfma_f32_16x16x32_bf16 v[20:23], a[164:167], v[172:175], v[20:23]
buffer_load_dwordx4 v232, s[12:15], s39 offen offset:2048  lds
v_mfma_f32_16x16x32_bf16 v[20:23], a[160:163], v[168:171], v[20:23]
v_exp_f32 v61, v61
v_mfma_f32_16x16x32_bf16 v[28:31], a[160:163], v[184:187], v[144:147]
v_cvt_pk_bf16_f32 v98, v60, v61
v_mfma_f32_16x16x32_bf16 v[28:31], a[164:167], v[188:191], v[28:31]
v_exp_f32 v62, v62
v_mfma_f32_16x16x32_bf16 v[28:31], a[168:171], v[192:195], v[28:31]
buffer_load_dwordx4 v233, s[12:15], s39 offen offset:3072  lds
v_mfma_f32_16x16x32_bf16 v[28:31], a[172:175], v[196:199], v[28:31]
v_exp_f32 v63, v63
v_mfma_f32_16x16x32_bf16 v[36:39], a[172:175], v[212:215], v[148:151]
ds_read_b128 a[172:175], v219 offset:12288
v_cvt_pk_bf16_f32 v99, v62, v63
v_mfma_f32_16x16x32_bf16 v[36:39], a[168:171], v[208:211], v[36:39]
v_exp_f32 v64, v64
v_mfma_f32_16x16x32_bf16 v[36:39], a[164:167], v[204:207], v[36:39]
ds_read_b128 a[168:171], v218 offset:12288
ds_read_b128 a[164:167], v217 offset:12288
v_mfma_f32_16x16x32_bf16 v[36:39], a[160:163], v[200:203], v[36:39]
v_exp_f32 v65, v65
s_waitcnt lgkmcnt(8)
v_mfma_f32_16x16x32_bf16 a[64:67], v[72:75], a[192:195], a[64:67]
ds_read_b128 a[160:163], v216 offset:12288
v_cvt_pk_bf16_f32 v100, v64, v65
v_mfma_f32_16x16x32_bf16 a[80:83], v[72:75], a[196:199], a[80:83]
v_exp_f32 v66, v66
v_mfma_f32_16x16x32_bf16 a[84:87], v[76:79], a[196:199], a[84:87]
s_add_u32 m0, s86, 8192
s_add_u32 s50, s84, 1179648
buffer_load_dwordx4 v240, s[64:67], s50 offen lds
v_mfma_f32_16x16x32_bf16 a[68:71], v[76:79], a[192:195], a[68:71]
v_exp_f32 v67, v67
v_mfma_f32_16x16x32_bf16 a[72:75], v[80:83], a[192:195], a[72:75]
v_cvt_pk_bf16_f32 v101, v66, v67
v_mfma_f32_16x16x32_bf16 a[88:91], v[80:83], a[196:199], a[88:91]
v_exp_f32 v68, v68
v_mfma_f32_16x16x32_bf16 a[92:95], v[84:87], a[196:199], a[92:95]
ds_read_b64_tr_b16 a[196:197], v225 offset:57344
ds_read_b64_tr_b16 a[198:199], v225 offset:61440
v_mfma_f32_16x16x32_bf16 a[76:79], v[84:87], a[192:195], a[76:79]
v_exp_f32 v69, v69
v_mfma_f32_16x16x32_bf16 a[108:111], v[84:87], a[200:203], a[108:111]
ds_read_b64_tr_b16 a[192:193], v224 offset:57344
v_cvt_pk_bf16_f32 v102, v68, v69
v_mfma_f32_16x16x32_bf16 a[124:127], v[84:87], a[204:207], a[124:127]
v_exp_f32 v70, v70
v_mfma_f32_16x16x32_bf16 a[120:123], v[80:83], a[204:207], a[120:123]
ds_read_b64_tr_b16 a[194:195], v224 offset:61440
v_mfma_f32_16x16x32_bf16 a[104:107], v[80:83], a[200:203], a[104:107]
v_exp_f32 v71, v71
v_mfma_f32_16x16x32_bf16 a[100:103], v[76:79], a[200:203], a[100:103]
v_cvt_pk_bf16_f32 v103, v70, v71
v_mfma_f32_16x16x32_bf16 a[116:119], v[76:79], a[204:207], a[116:119]
s_add_u32 m0, s86, 12288
s_add_u32 s50, s84, 1769472
buffer_load_dwordx4 v240, s[64:67], s50 offen lds
v_mfma_f32_16x16x32_bf16 a[112:115], v[72:75], a[204:207], a[112:115]
ds_read_b64_tr_b16 a[204:205], v227 offset:57344
ds_read_b64_tr_b16 a[206:207], v227 offset:61440
v_mfma_f32_16x16x32_bf16 a[96:99], v[72:75], a[200:203], a[96:99]
ds_read_b64_tr_b16 a[200:201], v226 offset:57344
ds_read_b64_tr_b16 a[202:203], v226 offset:61440
v_smfmac_f32_16x16x64_bf16 a[132:135], a[208:211], v[80:87], v245
v_mfma_f32_16x16x32_bf16 v[40:43], a[144:147], v[152:155], v[136:139]
v_exp_f32 v8, v8
v_mfma_f32_16x16x32_bf16 v[40:43], a[148:151], v[156:159], v[40:43]
v_exp_f32 v9, v9
v_mfma_f32_16x16x32_bf16 v[40:43], a[152:155], v[160:163], v[40:43]
v_cvt_pk_bf16_f32 v72, v8, v9
v_mfma_f32_16x16x32_bf16 v[40:43], a[156:159], v[164:167], v[40:43]
v_exp_f32 v10, v10
v_mfma_f32_16x16x32_bf16 v[48:51], a[156:159], v[180:183], v[140:143]
v_mfma_f32_16x16x32_bf16 v[48:51], a[152:155], v[176:179], v[48:51]
v_exp_f32 v11, v11
v_mfma_f32_16x16x32_bf16 v[48:51], a[148:151], v[172:175], v[48:51]
v_cvt_pk_bf16_f32 v73, v10, v11
v_mfma_f32_16x16x32_bf16 v[48:51], a[144:147], v[168:171], v[48:51]
v_exp_f32 v12, v12
v_mfma_f32_16x16x32_bf16 v[56:59], a[144:147], v[184:187], v[144:147]
v_mfma_f32_16x16x32_bf16 v[56:59], a[148:151], v[188:191], v[56:59]
v_exp_f32 v13, v13
v_mfma_f32_16x16x32_bf16 v[56:59], a[152:155], v[192:195], v[56:59]
v_cvt_pk_bf16_f32 v74, v12, v13
v_mfma_f32_16x16x32_bf16 v[56:59], a[156:159], v[196:199], v[56:59]
v_exp_f32 v14, v14
v_mfma_f32_16x16x32_bf16 v[64:67], a[156:159], v[212:215], v[148:151]
s_waitcnt vmcnt(13) lgkmcnt(0)
s_barrier
v_mfma_f32_16x16x32_bf16 v[64:67], a[152:155], v[208:211], v[64:67]
v_exp_f32 v15, v15
v_mfma_f32_16x16x32_bf16 v[64:67], a[148:151], v[204:207], v[64:67]
ds_read_b128 a[156:159], v219 offset:16384
v_cvt_pk_bf16_f32 v75, v14, v15
v_mfma_f32_16x16x32_bf16 v[64:67], a[144:147], v[200:203], v[64:67]
v_exp_f32 v16, v16
v_mfma_f32_16x16x32_bf16 a[0:3], v[88:91], a[176:179], a[0:3]
ds_read_b128 a[152:155], v218 offset:16384
ds_read_b128 a[148:151], v217 offset:16384
v_mfma_f32_16x16x32_bf16 a[16:19], v[88:91], a[180:183], a[16:19]
v_exp_f32 v17, v17
v_mfma_f32_16x16x32_bf16 a[20:23], v[92:95], a[180:183], a[20:23]
ds_read_b128 a[144:147], v216 offset:16384
v_cvt_pk_bf16_f32 v76, v16, v17
v_mfma_f32_16x16x32_bf16 a[4:7], v[92:95], a[176:179], a[4:7]
v_exp_f32 v18, v18
v_mfma_f32_16x16x32_bf16 a[8:11], v[96:99], a[176:179], a[8:11]
s_add_u32 s32, s32, 16384
s_add_u32 m0, s30, 65536
v_mfma_f32_16x16x32_bf16 a[24:27], v[96:99], a[180:183], a[24:27]
v_exp_f32 v19, v19
v_mfma_f32_16x16x32_bf16 a[28:31], v[100:103], a[180:183], a[28:31]
ds_read_b64_tr_b16 a[180:181], v221 offset:0
v_cvt_pk_bf16_f32 v77, v18, v19
v_mfma_f32_16x16x32_bf16 a[12:15], v[100:103], a[176:179], a[12:15]
v_exp_f32 v20, v20
v_mfma_f32_16x16x32_bf16 a[44:47], v[100:103], a[184:187], a[44:47]
ds_read_b64_tr_b16 a[182:183], v221 offset:4096
ds_read_b64_tr_b16 a[176:177], v220 offset:0
v_mfma_f32_16x16x32_bf16 a[60:63], v[100:103], a[188:191], a[60:63]
v_exp_f32 v21, v21
v_mfma_f32_16x16x32_bf16 a[56:59], v[96:99], a[188:191], a[56:59]
ds_read_b64_tr_b16 a[178:179], v220 offset:4096
v_cvt_pk_bf16_f32 v78, v20, v21
v_mfma_f32_16x16x32_bf16 a[40:43], v[96:99], a[184:187], a[40:43]
v_exp_f32 v22, v22
v_mfma_f32_16x16x32_bf16 a[36:39], v[92:95], a[184:187], a[36:39]
buffer_load_dwordx4 v228, s[8:11], s32 offen offset:0  lds
v_mfma_f32_16x16x32_bf16 a[52:55], v[92:95], a[188:191], a[52:55]
v_exp_f32 v23, v23
v_mfma_f32_16x16x32_bf16 a[48:51], v[88:91], a[188:191], a[48:51]
ds_read_b64_tr_b16 a[188:189], v223 offset:0
v_cvt_pk_bf16_f32 v79, v22, v23
v_mfma_f32_16x16x32_bf16 a[32:35], v[88:91], a[184:187], a[32:35]
v_exp_f32 v24, v24
v_smfmac_f32_16x16x64_bf16 a[128:131], a[208:211], v[88:95], v245
ds_read_b64_tr_b16 a[190:191], v223 offset:4096
v_mfma_f32_16x16x32_bf16 v[44:47], a[160:163], v[152:155], v[136:139]
v_exp_f32 v25, v25
v_mfma_f32_16x16x32_bf16 v[44:47], a[164:167], v[156:159], v[44:47]
v_exp_f32 v26, v26
v_mfma_f32_16x16x32_bf16 v[44:47], a[168:171], v[160:163], v[44:47]
ds_read_b64_tr_b16 a[184:185], v222 offset:0
v_cvt_pk_bf16_f32 v80, v24, v25
v_mfma_f32_16x16x32_bf16 v[44:47], a[172:175], v[164:167], v[44:47]
v_exp_f32 v27, v27
v_mfma_f32_16x16x32_bf16 v[52:55], a[172:175], v[180:183], v[140:143]
ds_read_b64_tr_b16 a[186:187], v222 offset:4096
v_cvt_pk_bf16_f32 v81, v26, v27
v_mfma_f32_16x16x32_bf16 v[52:55], a[168:171], v[176:179], v[52:55]
v_exp_f32 v28, v28
v_mfma_f32_16x16x32_bf16 v[52:55], a[164:167], v[172:175], v[52:55]
buffer_load_dwordx4 v229, s[8:11], s32 offen offset:1024  lds
v_mfma_f32_16x16x32_bf16 v[52:55], a[160:163], v[168:171], v[52:55]
v_exp_f32 v29, v29
v_mfma_f32_16x16x32_bf16 v[60:63], a[160:163], v[184:187], v[144:147]
v_cvt_pk_bf16_f32 v82, v28, v29
v_mfma_f32_16x16x32_bf16 v[60:63], a[164:167], v[188:191], v[60:63]
v_exp_f32 v30, v30
v_mfma_f32_16x16x32_bf16 v[60:63], a[168:171], v[192:195], v[60:63]
buffer_load_dwordx4 v230, s[8:11], s32 offen offset:2048  lds
v_mfma_f32_16x16x32_bf16 v[60:63], a[172:175], v[196:199], v[60:63]
v_exp_f32 v31, v31
v_mfma_f32_16x16x32_bf16 v[68:71], a[172:175], v[212:215], v[148:151]
ds_read_b128 a[172:175], v219 offset:20480
v_cvt_pk_bf16_f32 v83, v30, v31
v_mfma_f32_16x16x32_bf16 v[68:71], a[168:171], v[208:211], v[68:71]
v_exp_f32 v32, v32
v_mfma_f32_16x16x32_bf16 v[68:71], a[164:167], v[204:207], v[68:71]
ds_read_b128 a[168:171], v218 offset:20480
ds_read_b128 a[164:167], v217 offset:20480
v_mfma_f32_16x16x32_bf16 v[68:71], a[160:163], v[200:203], v[68:71]
v_exp_f32 v33, v33
v_mfma_f32_16x16x32_bf16 a[64:67], v[88:91], a[192:195], a[64:67]
ds_read_b128 a[160:163], v216 offset:20480
v_cvt_pk_bf16_f32 v84, v32, v33
v_mfma_f32_16x16x32_bf16 a[80:83], v[88:91], a[196:199], a[80:83]
v_exp_f32 v34, v34
v_mfma_f32_16x16x32_bf16 a[84:87], v[92:95], a[196:199], a[84:87]
buffer_load_dwordx4 v231, s[8:11], s32 offen offset:3072  lds
v_mfma_f32_16x16x32_bf16 a[68:71], v[92:95], a[192:195], a[68:71]
v_exp_f32 v35, v35
v_mfma_f32_16x16x32_bf16 a[72:75], v[96:99], a[192:195], a[72:75]
v_cvt_pk_bf16_f32 v85, v34, v35
v_mfma_f32_16x16x32_bf16 a[88:91], v[96:99], a[196:199], a[88:91]
v_exp_f32 v36, v36
v_mfma_f32_16x16x32_bf16 a[92:95], v[100:103], a[196:199], a[92:95]
ds_read_b64_tr_b16 a[196:197], v225 offset:0
ds_read_b64_tr_b16 a[198:199], v225 offset:4096
v_mfma_f32_16x16x32_bf16 a[76:79], v[100:103], a[192:195], a[76:79]
v_exp_f32 v37, v37
v_mfma_f32_16x16x32_bf16 a[108:111], v[100:103], a[200:203], a[108:111]
ds_read_b64_tr_b16 a[192:193], v224 offset:0
v_cvt_pk_bf16_f32 v86, v36, v37
v_mfma_f32_16x16x32_bf16 a[124:127], v[100:103], a[204:207], a[124:127]
v_exp_f32 v38, v38
v_mfma_f32_16x16x32_bf16 a[120:123], v[96:99], a[204:207], a[120:123]
ds_read_b64_tr_b16 a[194:195], v224 offset:4096
v_mfma_f32_16x16x32_bf16 a[104:107], v[96:99], a[200:203], a[104:107]
v_exp_f32 v39, v39
v_mfma_f32_16x16x32_bf16 a[100:103], v[92:95], a[200:203], a[100:103]
v_cvt_pk_bf16_f32 v87, v38, v39
v_mfma_f32_16x16x32_bf16 a[116:119], v[92:95], a[204:207], a[116:119]
s_add_u32 m0, s86, 16384
s_add_u32 s50, s84, 2359296
buffer_load_dwordx4 v240, s[64:67], s50 offen lds
v_mfma_f32_16x16x32_bf16 a[112:115], v[88:91], a[204:207], a[112:115]
ds_read_b64_tr_b16 a[204:205], v227 offset:0
ds_read_b64_tr_b16 a[206:207], v227 offset:4096
v_mfma_f32_16x16x32_bf16 a[96:99], v[88:91], a[200:203], a[96:99]
ds_read_b64_tr_b16 a[200:201], v226 offset:0
ds_read_b64_tr_b16 a[202:203], v226 offset:4096
v_smfmac_f32_16x16x64_bf16 a[132:135], a[208:211], v[96:103], v245
s_add_u32 m0, s86, 20480
s_add_u32 s50, s84, 2949120
buffer_load_dwordx4 v240, s[64:67], s50 offen lds
s_waitcnt lgkmcnt(8)
v_mfma_f32_16x16x32_bf16 v[8:11], a[144:147], v[152:155], v[136:139]
v_exp_f32 v40, v40
v_mfma_f32_16x16x32_bf16 v[8:11], a[148:151], v[156:159], v[8:11]
v_exp_f32 v41, v41
v_mfma_f32_16x16x32_bf16 v[8:11], a[152:155], v[160:163], v[8:11]
v_cvt_pk_bf16_f32 v88, v40, v41
v_mfma_f32_16x16x32_bf16 v[8:11], a[156:159], v[164:167], v[8:11]
v_exp_f32 v42, v42
v_mfma_f32_16x16x32_bf16 v[16:19], a[156:159], v[180:183], v[140:143]
s_add_u32 s39, s39, 16384
v_mfma_f32_16x16x32_bf16 v[16:19], a[152:155], v[176:179], v[16:19]
v_exp_f32 v43, v43
v_mfma_f32_16x16x32_bf16 v[16:19], a[148:151], v[172:175], v[16:19]
v_cvt_pk_bf16_f32 v89, v42, v43
v_mfma_f32_16x16x32_bf16 v[16:19], a[144:147], v[168:171], v[16:19]
v_exp_f32 v44, v44
v_mfma_f32_16x16x32_bf16 v[24:27], a[144:147], v[184:187], v[144:147]
v_mfma_f32_16x16x32_bf16 v[24:27], a[148:151], v[188:191], v[24:27]
v_exp_f32 v45, v45
v_mfma_f32_16x16x32_bf16 v[24:27], a[152:155], v[192:195], v[24:27]
s_add_u32 m0, s30, 147456
v_cvt_pk_bf16_f32 v90, v44, v45
v_mfma_f32_16x16x32_bf16 v[24:27], a[156:159], v[196:199], v[24:27]
v_exp_f32 v46, v46
v_mfma_f32_16x16x32_bf16 v[32:35], a[156:159], v[212:215], v[148:151]
ds_read_b128 a[156:159], v219 offset:24576
v_mfma_f32_16x16x32_bf16 v[32:35], a[152:155], v[208:211], v[32:35]
v_exp_f32 v47, v47
v_mfma_f32_16x16x32_bf16 v[32:35], a[148:151], v[204:207], v[32:35]
ds_read_b128 a[152:155], v218 offset:24576
v_cvt_pk_bf16_f32 v91, v46, v47
v_mfma_f32_16x16x32_bf16 v[32:35], a[144:147], v[200:203], v[32:35]
v_exp_f32 v48, v48
v_mfma_f32_16x16x32_bf16 a[0:3], v[72:75], a[176:179], a[0:3]
ds_read_b128 a[148:151], v217 offset:24576
ds_read_b128 a[144:147], v216 offset:24576
v_mfma_f32_16x16x32_bf16 a[16:19], v[72:75], a[180:183], a[16:19]
v_exp_f32 v49, v49
v_mfma_f32_16x16x32_bf16 a[20:23], v[76:79], a[180:183], a[20:23]
v_cvt_pk_bf16_f32 v92, v48, v49
v_mfma_f32_16x16x32_bf16 a[4:7], v[76:79], a[176:179], a[4:7]
v_exp_f32 v50, v50
v_mfma_f32_16x16x32_bf16 a[8:11], v[80:83], a[176:179], a[8:11]
buffer_load_dwordx4 v232, s[12:15], s39 offen offset:0  lds
v_mfma_f32_16x16x32_bf16 a[24:27], v[80:83], a[180:183], a[24:27]
v_exp_f32 v51, v51
v_mfma_f32_16x16x32_bf16 a[28:31], v[84:87], a[180:183], a[28:31]
ds_read_b64_tr_b16 a[180:181], v221 offset:8192
v_cvt_pk_bf16_f32 v93, v50, v51
v_mfma_f32_16x16x32_bf16 a[12:15], v[84:87], a[176:179], a[12:15]
v_exp_f32 v52, v52
v_mfma_f32_16x16x32_bf16 a[44:47], v[84:87], a[184:187], a[44:47]
ds_read_b64_tr_b16 a[182:183], v221 offset:12288
ds_read_b64_tr_b16 a[176:177], v220 offset:8192
v_mfma_f32_16x16x32_bf16 a[60:63], v[84:87], a[188:191], a[60:63]
v_exp_f32 v53, v53
v_mfma_f32_16x16x32_bf16 a[56:59], v[80:83], a[188:191], a[56:59]
ds_read_b64_tr_b16 a[178:179], v220 offset:12288
v_cvt_pk_bf16_f32 v94, v52, v53
v_mfma_f32_16x16x32_bf16 a[40:43], v[80:83], a[184:187], a[40:43]
v_exp_f32 v54, v54
v_mfma_f32_16x16x32_bf16 a[36:39], v[76:79], a[184:187], a[36:39]
buffer_load_dwordx4 v233, s[12:15], s39 offen offset:1024  lds
v_mfma_f32_16x16x32_bf16 a[52:55], v[76:79], a[188:191], a[52:55]
v_exp_f32 v55, v55
v_mfma_f32_16x16x32_bf16 a[48:51], v[72:75], a[188:191], a[48:51]
ds_read_b64_tr_b16 a[188:189], v223 offset:8192
v_cvt_pk_bf16_f32 v95, v54, v55
v_mfma_f32_16x16x32_bf16 a[32:35], v[72:75], a[184:187], a[32:35]
v_exp_f32 v56, v56
v_smfmac_f32_16x16x64_bf16 a[128:131], a[208:211], v[72:79], v245
ds_read_b64_tr_b16 a[190:191], v223 offset:12288
v_mfma_f32_16x16x32_bf16 v[12:15], a[160:163], v[152:155], v[136:139]
v_exp_f32 v57, v57
v_mfma_f32_16x16x32_bf16 v[12:15], a[164:167], v[156:159], v[12:15]
v_exp_f32 v58, v58
v_mfma_f32_16x16x32_bf16 v[12:15], a[168:171], v[160:163], v[12:15]
ds_read_b64_tr_b16 a[184:185], v222 offset:8192
v_cvt_pk_bf16_f32 v96, v56, v57
v_mfma_f32_16x16x32_bf16 v[12:15], a[172:175], v[164:167], v[12:15]
v_exp_f32 v59, v59
v_mfma_f32_16x16x32_bf16 v[20:23], a[172:175], v[180:183], v[140:143]
ds_read_b64_tr_b16 a[186:187], v222 offset:12288
v_cvt_pk_bf16_f32 v97, v58, v59
v_mfma_f32_16x16x32_bf16 v[20:23], a[168:171], v[176:179], v[20:23]
v_exp_f32 v60, v60
v_mfma_f32_16x16x32_bf16 v[20:23], a[164:167], v[172:175], v[20:23]
buffer_load_dwordx4 v232, s[12:15], s39 offen offset:2048  lds
v_mfma_f32_16x16x32_bf16 v[20:23], a[160:163], v[168:171], v[20:23]
v_exp_f32 v61, v61
v_mfma_f32_16x16x32_bf16 v[28:31], a[160:163], v[184:187], v[144:147]
v_cvt_pk_bf16_f32 v98, v60, v61
v_mfma_f32_16x16x32_bf16 v[28:31], a[164:167], v[188:191], v[28:31]
v_exp_f32 v62, v62
v_mfma_f32_16x16x32_bf16 v[28:31], a[168:171], v[192:195], v[28:31]
buffer_load_dwordx4 v233, s[12:15], s39 offen offset:3072  lds
v_mfma_f32_16x16x32_bf16 v[28:31], a[172:175], v[196:199], v[28:31]
v_exp_f32 v63, v63
v_mfma_f32_16x16x32_bf16 v[36:39], a[172:175], v[212:215], v[148:151]
ds_read_b128 a[172:175], v219 offset:28672
v_cvt_pk_bf16_f32 v99, v62, v63
v_mfma_f32_16x16x32_bf16 v[36:39], a[168:171], v[208:211], v[36:39]
v_exp_f32 v64, v64
v_mfma_f32_16x16x32_bf16 v[36:39], a[164:167], v[204:207], v[36:39]
ds_read_b128 a[168:171], v218 offset:28672
ds_read_b128 a[164:167], v217 offset:28672
v_mfma_f32_16x16x32_bf16 v[36:39], a[160:163], v[200:203], v[36:39]
v_exp_f32 v65, v65
s_waitcnt lgkmcnt(8)
v_mfma_f32_16x16x32_bf16 a[64:67], v[72:75], a[192:195], a[64:67]
ds_read_b128 a[160:163], v216 offset:28672
v_cvt_pk_bf16_f32 v100, v64, v65
v_mfma_f32_16x16x32_bf16 a[80:83], v[72:75], a[196:199], a[80:83]
v_exp_f32 v66, v66
v_mfma_f32_16x16x32_bf16 a[84:87], v[76:79], a[196:199], a[84:87]
s_add_u32 m0, s86, 24576
s_add_u32 s50, s84, 3538944
buffer_load_dwordx4 v240, s[64:67], s50 offen lds
v_mfma_f32_16x16x32_bf16 a[68:71], v[76:79], a[192:195], a[68:71]
v_exp_f32 v67, v67
v_mfma_f32_16x16x32_bf16 a[72:75], v[80:83], a[192:195], a[72:75]
v_cvt_pk_bf16_f32 v101, v66, v67
v_mfma_f32_16x16x32_bf16 a[88:91], v[80:83], a[196:199], a[88:91]
v_exp_f32 v68, v68
v_mfma_f32_16x16x32_bf16 a[92:95], v[84:87], a[196:199], a[92:95]
ds_read_b64_tr_b16 a[196:197], v225 offset:8192
ds_read_b64_tr_b16 a[198:199], v225 offset:12288
v_mfma_f32_16x16x32_bf16 a[76:79], v[84:87], a[192:195], a[76:79]
v_exp_f32 v69, v69
v_mfma_f32_16x16x32_bf16 a[108:111], v[84:87], a[200:203], a[108:111]
ds_read_b64_tr_b16 a[192:193], v224 offset:8192
v_cvt_pk_bf16_f32 v102, v68, v69
v_mfma_f32_16x16x32_bf16 a[124:127], v[84:87], a[204:207], a[124:127]
v_exp_f32 v70, v70
v_mfma_f32_16x16x32_bf16 a[120:123], v[80:83], a[204:207], a[120:123]
ds_read_b64_tr_b16 a[194:195], v224 offset:12288
v_mfma_f32_16x16x32_bf16 a[104:107], v[80:83], a[200:203], a[104:107]
v_exp_f32 v71, v71
v_mfma_f32_16x16x32_bf16 a[100:103], v[76:79], a[200:203], a[100:103]
v_cvt_pk_bf16_f32 v103, v70, v71
v_mfma_f32_16x16x32_bf16 a[116:119], v[76:79], a[204:207], a[116:119]
s_add_u32 m0, s86, 28672
s_add_u32 s50, s84, 4128768
buffer_load_dwordx4 v240, s[64:67], s50 offen lds
v_mfma_f32_16x16x32_bf16 a[112:115], v[72:75], a[204:207], a[112:115]
ds_read_b64_tr_b16 a[204:205], v227 offset:8192
ds_read_b64_tr_b16 a[206:207], v227 offset:12288
v_mfma_f32_16x16x32_bf16 a[96:99], v[72:75], a[200:203], a[96:99]
ds_read_b64_tr_b16 a[200:201], v226 offset:8192
ds_read_b64_tr_b16 a[202:203], v226 offset:12288
v_smfmac_f32_16x16x64_bf16 a[132:135], a[208:211], v[80:87], v245
v_mfma_f32_16x16x32_bf16 v[40:43], a[144:147], v[152:155], v[136:139]
v_exp_f32 v8, v8
v_mfma_f32_16x16x32_bf16 v[40:43], a[148:151], v[156:159], v[40:43]
v_exp_f32 v9, v9
v_mfma_f32_16x16x32_bf16 v[40:43], a[152:155], v[160:163], v[40:43]
v_cvt_pk_bf16_f32 v72, v8, v9
v_mfma_f32_16x16x32_bf16 v[40:43], a[156:159], v[164:167], v[40:43]
v_exp_f32 v10, v10
v_mfma_f32_16x16x32_bf16 v[48:51], a[156:159], v[180:183], v[140:143]
v_mfma_f32_16x16x32_bf16 v[48:51], a[152:155], v[176:179], v[48:51]
v_exp_f32 v11, v11
v_mfma_f32_16x16x32_bf16 v[48:51], a[148:151], v[172:175], v[48:51]
v_cvt_pk_bf16_f32 v73, v10, v11
v_mfma_f32_16x16x32_bf16 v[48:51], a[144:147], v[168:171], v[48:51]
v_exp_f32 v12, v12
v_mfma_f32_16x16x32_bf16 v[56:59], a[144:147], v[184:187], v[144:147]
v_mfma_f32_16x16x32_bf16 v[56:59], a[148:151], v[188:191], v[56:59]
v_exp_f32 v13, v13
v_mfma_f32_16x16x32_bf16 v[56:59], a[152:155], v[192:195], v[56:59]
v_cvt_pk_bf16_f32 v74, v12, v13
v_mfma_f32_16x16x32_bf16 v[56:59], a[156:159], v[196:199], v[56:59]
v_exp_f32 v14, v14
v_mfma_f32_16x16x32_bf16 v[64:67], a[156:159], v[212:215], v[148:151]
s_waitcnt vmcnt(12) lgkmcnt(0)
s_barrier
v_mfma_f32_16x16x32_bf16 v[64:67], a[152:155], v[208:211], v[64:67]
v_exp_f32 v15, v15
v_mfma_f32_16x16x32_bf16 v[64:67], a[148:151], v[204:207], v[64:67]
ds_read_b128 a[156:159], v219 offset:49152
v_cvt_pk_bf16_f32 v75, v14, v15
v_mfma_f32_16x16x32_bf16 v[64:67], a[144:147], v[200:203], v[64:67]
v_exp_f32 v16, v16
v_mfma_f32_16x16x32_bf16 a[0:3], v[88:91], a[176:179], a[0:3]
ds_read_b128 a[152:155], v218 offset:49152
ds_read_b128 a[148:151], v217 offset:49152
v_mfma_f32_16x16x32_bf16 a[16:19], v[88:91], a[180:183], a[16:19]
v_exp_f32 v17, v17
v_mfma_f32_16x16x32_bf16 a[20:23], v[92:95], a[180:183], a[20:23]
ds_read_b128 a[144:147], v216 offset:49152
v_cvt_pk_bf16_f32 v76, v16, v17
v_mfma_f32_16x16x32_bf16 a[4:7], v[92:95], a[176:179], a[4:7]
v_exp_f32 v18, v18
v_mfma_f32_16x16x32_bf16 a[8:11], v[96:99], a[176:179], a[8:11]
s_add_u32 s32, s32, 16384
s_add_u32 m0, s30, 81920
v_mfma_f32_16x16x32_bf16 a[24:27], v[96:99], a[180:183], a[24:27]
v_exp_f32 v19, v19
v_mfma_f32_16x16x32_bf16 a[28:31], v[100:103], a[180:183], a[28:31]
ds_read_b64_tr_b16 a[180:181], v221 offset:32768
v_cvt_pk_bf16_f32 v77, v18, v19
v_mfma_f32_16x16x32_bf16 a[12:15], v[100:103], a[176:179], a[12:15]
v_exp_f32 v20, v20
v_mfma_f32_16x16x32_bf16 a[44:47], v[100:103], a[184:187], a[44:47]
ds_read_b64_tr_b16 a[182:183], v221 offset:36864
ds_read_b64_tr_b16 a[176:177], v220 offset:32768
v_mfma_f32_16x16x32_bf16 a[60:63], v[100:103], a[188:191], a[60:63]
v_exp_f32 v21, v21
v_mfma_f32_16x16x32_bf16 a[56:59], v[96:99], a[188:191], a[56:59]
ds_read_b64_tr_b16 a[178:179], v220 offset:36864
v_cvt_pk_bf16_f32 v78, v20, v21
v_mfma_f32_16x16x32_bf16 a[40:43], v[96:99], a[184:187], a[40:43]
v_exp_f32 v22, v22
v_mfma_f32_16x16x32_bf16 a[36:39], v[92:95], a[184:187], a[36:39]
buffer_load_dwordx4 v228, s[8:11], s32 offen offset:0  lds
v_mfma_f32_16x16x32_bf16 a[52:55], v[92:95], a[188:191], a[52:55]
v_exp_f32 v23, v23
v_mfma_f32_16x16x32_bf16 a[48:51], v[88:91], a[188:191], a[48:51]
ds_read_b64_tr_b16 a[188:189], v223 offset:32768
v_cvt_pk_bf16_f32 v79, v22, v23
v_mfma_f32_16x16x32_bf16 a[32:35], v[88:91], a[184:187], a[32:35]
v_exp_f32 v24, v24
v_smfmac_f32_16x16x64_bf16 a[128:131], a[208:211], v[88:95], v245
ds_read_b64_tr_b16 a[190:191], v223 offset:36864
v_mfma_f32_16x16x32_bf16 v[44:47], a[160:163], v[152:155], v[136:139]
v_exp_f32 v25, v25
v_mfma_f32_16x16x32_bf16 v[44:47], a[164:167], v[156:159], v[44:47]
v_exp_f32 v26, v26
v_mfma_f32_16x16x32_bf16 v[44:47], a[168:171], v[160:163], v[44:47]
ds_read_b64_tr_b16 a[184:185], v222 offset:32768
v_cvt_pk_bf16_f32 v80, v24, v25
v_mfma_f32_16x16x32_bf16 v[44:47], a[172:175], v[164:167], v[44:47]
v_exp_f32 v27, v27
v_mfma_f32_16x16x32_bf16 v[52:55], a[172:175], v[180:183], v[140:143]
ds_read_b64_tr_b16 a[186:187], v222 offset:36864
v_cvt_pk_bf16_f32 v81, v26, v27
v_mfma_f32_16x16x32_bf16 v[52:55], a[168:171], v[176:179], v[52:55]
v_exp_f32 v28, v28
v_mfma_f32_16x16x32_bf16 v[52:55], a[164:167], v[172:175], v[52:55]
buffer_load_dwordx4 v229, s[8:11], s32 offen offset:1024  lds
v_mfma_f32_16x16x32_bf16 v[52:55], a[160:163], v[168:171], v[52:55]
v_exp_f32 v29, v29
v_mfma_f32_16x16x32_bf16 v[60:63], a[160:163], v[184:187], v[144:147]
v_cmp_ne_u32 vcc, s47, v249
s_cbranch_vccnz SP_CAND
SP_CAND_RET:
v_cvt_pk_bf16_f32 v82, v28, v29
v_mfma_f32_16x16x32_bf16 v[60:63], a[164:167], v[188:191], v[60:63]
v_mov_b32 v251, 0
v_exp_f32 v30, v30
v_mfma_f32_16x16x32_bf16 v[60:63], a[168:171], v[192:195], v[60:63]
buffer_load_dwordx4 v230, s[8:11], s32 offen offset:2048  lds
v_mfma_f32_16x16x32_bf16 v[60:63], a[172:175], v[196:199], v[60:63]
v_exp_f32 v31, v31
v_mfma_f32_16x16x32_bf16 v[68:71], a[172:175], v[212:215], v[148:151]
ds_read_b128 a[172:175], v219 offset:53248
v_cvt_pk_bf16_f32 v83, v30, v31
v_mfma_f32_16x16x32_bf16 v[68:71], a[168:171], v[208:211], v[68:71]
v_exp_f32 v32, v32
v_mfma_f32_16x16x32_bf16 v[68:71], a[164:167], v[204:207], v[68:71]
ds_read_b128 a[168:171], v218 offset:53248
ds_read_b128 a[164:167], v217 offset:53248
v_mfma_f32_16x16x32_bf16 v[68:71], a[160:163], v[200:203], v[68:71]
v_exp_f32 v33, v33
v_mfma_f32_16x16x32_bf16 a[64:67], v[88:91], a[192:195], a[64:67]
ds_read_b128 a[160:163], v216 offset:53248
v_cvt_pk_bf16_f32 v84, v32, v33
v_mfma_f32_16x16x32_bf16 a[80:83], v[88:91], a[196:199], a[80:83]
v_exp_f32 v34, v34
v_mfma_f32_16x16x32_bf16 a[84:87], v[92:95], a[196:199], a[84:87]
buffer_load_dwordx4 v231, s[8:11], s32 offen offset:3072  lds
v_mfma_f32_16x16x32_bf16 a[68:71], v[92:95], a[192:195], a[68:71]
v_exp_f32 v35, v35
v_mfma_f32_16x16x32_bf16 a[72:75], v[96:99], a[192:195], a[72:75]
s_mov_b32 s90, 0x01010101
s_mov_b32 s91, 0x01010101
v_cvt_pk_bf16_f32 v85, v34, v35
v_mfma_f32_16x16x32_bf16 a[88:91], v[96:99], a[196:199], a[88:91]
v_exp_f32 v36, v36
v_mfma_f32_16x16x32_bf16 a[92:95], v[100:103], a[196:199], a[92:95]
ds_read_b64_tr_b16 a[196:197], v225 offset:32768
ds_read_b64_tr_b16 a[198:199], v225 offset:36864
v_max_u32_dpp v250, v248, v248 row_ror:8 row_mask:0xf bank_mask:0xf
v_mfma_f32_16x16x32_bf16 a[76:79], v[100:103], a[192:195], a[76:79]
v_exp_f32 v37, v37
v_mfma_f32_16x16x32_bf16 a[108:111], v[100:103], a[200:203], a[108:111]
ds_read_b64_tr_b16 a[192:193], v224 offset:32768
v_cvt_pk_bf16_f32 v86, v36, v37
v_max_u32_dpp v249, v250, v250 row_ror:4 row_mask:0xf bank_mask:0xf
v_mfma_f32_16x16x32_bf16 a[124:127], v[100:103], a[204:207], a[124:127]
v_exp_f32 v38, v38
v_mfma_f32_16x16x32_bf16 a[120:123], v[96:99], a[204:207], a[120:123]
ds_read_b64_tr_b16 a[194:195], v224 offset:36864
v_max_u32_dpp v250, v249, v249 row_ror:2 row_mask:0xf bank_mask:0xf
v_mfma_f32_16x16x32_bf16 a[104:107], v[96:99], a[200:203], a[104:107]
v_exp_f32 v39, v39
v_mfma_f32_16x16x32_bf16 a[100:103], v[92:95], a[200:203], a[100:103]
v_cvt_pk_bf16_f32 v87, v38, v39
v_max_u32_dpp v249, v250, v250 row_ror:1 row_mask:0xf bank_mask:0xf
v_mov_b32 v250, v249
v_mfma_f32_16x16x32_bf16 a[116:119], v[92:95], a[204:207], a[116:119]
s_add_u32 m0, s86, 32768
s_add_u32 s50, s84, 0
buffer_load_dwordx4 v240, s[68:71], s50 offen lds
v_mfma_f32_16x16x32_bf16 a[112:115], v[88:91], a[204:207], a[112:115]
ds_read_b64_tr_b16 a[204:205], v227 offset:32768
ds_read_b64_tr_b16 a[206:207], v227 offset:36864
v_permlane16_swap_b32 v249, v250
v_mfma_f32_16x16x32_bf16 a[96:99], v[88:91], a[200:203], a[96:99]
ds_read_b64_tr_b16 a[200:201], v226 offset:32768
ds_read_b64_tr_b16 a[202:203], v226 offset:36864
v_max_u32 v249, v249, v250
v_smfmac_f32_16x16x64_bf16 a[132:135], a[208:211], v[96:103], v245
s_add_u32 m0, s86, 36864
s_add_u32 s50, s84, 589824
buffer_load_dwordx4 v240, s[68:71], s50 offen lds
STUB_5:
s_cbranch_execz STUB_8
s_waitcnt lgkmcnt(8)
v_mfma_f32_16x16x32_bf16 v[8:11], a[144:147], v[152:155], v[136:139]
v_mov_b32 v250, v249
v_exp_f32 v40, v40
v_mfma_f32_16x16x32_bf16 v[8:11], a[148:151], v[156:159], v[8:11]
v_exp_f32 v41, v41
v_mfma_f32_16x16x32_bf16 v[8:11], a[152:155], v[160:163], v[8:11]
v_cvt_pk_bf16_f32 v88, v40, v41
v_permlane32_swap_b32 v249, v250
v_max_u32 v249, v249, v250
v_mfma_f32_16x16x32_bf16 v[8:11], a[156:159], v[164:167], v[8:11]
v_exp_f32 v42, v42
v_mfma_f32_16x16x32_bf16 v[16:19], a[156:159], v[180:183], v[140:143]
s_add_u32 s39, s39, 16384
v_add_u32 v251, v251, v249
v_mfma_f32_16x16x32_bf16 v[16:19], a[152:155], v[176:179], v[16:19]
v_exp_f32 v43, v43
v_mfma_f32_16x16x32_bf16 v[16:19], a[148:151], v[172:175], v[16:19]
v_cvt_pk_bf16_f32 v89, v42, v43
v_sub_u32 v248, v248, v249
v_mfma_f32_16x16x32_bf16 v[16:19], a[144:147], v[168:171], v[16:19]
v_exp_f32 v44, v44
v_mfma_f32_16x16x32_bf16 v[24:27], a[144:147], v[184:187], v[144:147]
v_cndmask_b32 v252, v252, v251, s[90:91]
v_mfma_f32_16x16x32_bf16 v[24:27], a[148:151], v[188:191], v[24:27]
v_exp_f32 v45, v45
v_mfma_f32_16x16x32_bf16 v[24:27], a[152:155], v[192:195], v[24:27]
s_add_u32 m0, s30, 98304
v_cvt_pk_bf16_f32 v90, v44, v45
v_mfma_f32_16x16x32_bf16 v[24:27], a[156:159], v[196:199], v[24:27]
v_exp_f32 v46, v46
v_mfma_f32_16x16x32_bf16 v[32:35], a[156:159], v[212:215], v[148:151]
ds_read_b128 a[156:159], v219 offset:57344
v_readfirstlane_b32 s76, v251
v_mfma_f32_16x16x32_bf16 v[32:35], a[152:155], v[208:211], v[32:35]
v_exp_f32 v47, v47
v_mfma_f32_16x16x32_bf16 v[32:35], a[148:151], v[204:207], v[32:35]
ds_read_b128 a[152:155], v218 offset:57344
v_cvt_pk_bf16_f32 v91, v46, v47
v_mfma_f32_16x16x32_bf16 v[32:35], a[144:147], v[200:203], v[32:35]
v_exp_f32 v48, v48
v_mfma_f32_16x16x32_bf16 a[0:3], v[72:75], a[176:179], a[0:3]
ds_read_b128 a[148:151], v217 offset:57344
ds_read_b128 a[144:147], v216 offset:57344
v_mfma_f32_16x16x32_bf16 a[16:19], v[72:75], a[180:183], a[16:19]
v_exp_f32 v49, v49
v_mfma_f32_16x16x32_bf16 a[20:23], v[76:79], a[180:183], a[20:23]
s_lshl_b64 s[90:91], s[90:91], 1
v_cvt_pk_bf16_f32 v92, v48, v49
v_mfma_f32_16x16x32_bf16 a[4:7], v[76:79], a[176:179], a[4:7]
v_exp_f32 v50, v50
v_mfma_f32_16x16x32_bf16 a[8:11], v[80:83], a[176:179], a[8:11]
buffer_load_dwordx4 v232, s[12:15], s39 offen offset:0  lds
v_mfma_f32_16x16x32_bf16 a[24:27], v[80:83], a[180:183], a[24:27]
v_exp_f32 v51, v51
v_mfma_f32_16x16x32_bf16 a[28:31], v[84:87], a[180:183], a[28:31]
ds_read_b64_tr_b16 a[180:181], v221 offset:40960
v_cvt_pk_bf16_f32 v93, v50, v51
v_mfma_f32_16x16x32_bf16 a[12:15], v[84:87], a[176:179], a[12:15]
v_exp_f32 v52, v52
v_mfma_f32_16x16x32_bf16 a[44:47], v[84:87], a[184:187], a[44:47]
ds_read_b64_tr_b16 a[182:183], v221 offset:45056
ds_read_b64_tr_b16 a[176:177], v220 offset:40960
v_mfma_f32_16x16x32_bf16 a[60:63], v[84:87], a[188:191], a[60:63]
v_exp_f32 v53, v53
v_mfma_f32_16x16x32_bf16 a[56:59], v[80:83], a[188:191], a[56:59]
ds_read_b64_tr_b16 a[178:179], v220 offset:45056
v_cvt_pk_bf16_f32 v94, v52, v53
v_mfma_f32_16x16x32_bf16 a[40:43], v[80:83], a[184:187], a[40:43]
v_max_u32_dpp v250, v248, v248 row_ror:8 row_mask:0xf bank_mask:0xf
v_exp_f32 v54, v54
v_mfma_f32_16x16x32_bf16 a[36:39], v[76:79], a[184:187], a[36:39]
buffer_load_dwordx4 v233, s[12:15], s39 offen offset:1024  lds
v_mfma_f32_16x16x32_bf16 a[52:55], v[76:79], a[188:191], a[52:55]
v_exp_f32 v55, v55
v_mfma_f32_16x16x32_bf16 a[48:51], v[72:75], a[188:191], a[48:51]
ds_read_b64_tr_b16 a[188:189], v223 offset:40960
v_cvt_pk_bf16_f32 v95, v54, v55
v_mfma_f32_16x16x32_bf16 a[32:35], v[72:75], a[184:187], a[32:35]
v_exp_f32 v56, v56
v_smfmac_f32_16x16x64_bf16 a[128:131], a[208:211], v[72:79], v245
ds_read_b64_tr_b16 a[190:191], v223 offset:45056
v_max_u32_dpp v249, v250, v250 row_ror:4 row_mask:0xf bank_mask:0xf
v_mfma_f32_16x16x32_bf16 v[12:15], a[160:163], v[152:155], v[136:139]
v_exp_f32 v57, v57
v_mfma_f32_16x16x32_bf16 v[12:15], a[164:167], v[156:159], v[12:15]
v_exp_f32 v58, v58
v_mfma_f32_16x16x32_bf16 v[12:15], a[168:171], v[160:163], v[12:15]
ds_read_b64_tr_b16 a[184:185], v222 offset:40960
v_cvt_pk_bf16_f32 v96, v56, v57
v_mfma_f32_16x16x32_bf16 v[12:15], a[172:175], v[164:167], v[12:15]
v_max_u32_dpp v250, v249, v249 row_ror:2 row_mask:0xf bank_mask:0xf
v_exp_f32 v59, v59
v_mfma_f32_16x16x32_bf16 v[20:23], a[172:175], v[180:183], v[140:143]
ds_read_b64_tr_b16 a[186:187], v222 offset:45056
v_cvt_pk_bf16_f32 v97, v58, v59
v_mfma_f32_16x16x32_bf16 v[20:23], a[168:171], v[176:179], v[20:23]
v_exp_f32 v60, v60
v_mfma_f32_16x16x32_bf16 v[20:23], a[164:167], v[172:175], v[20:23]
buffer_load_dwordx4 v232, s[12:15], s39 offen offset:2048  lds
v_mfma_f32_16x16x32_bf16 v[20:23], a[160:163], v[168:171], v[20:23]
v_exp_f32 v61, v61
v_mfma_f32_16x16x32_bf16 v[28:31], a[160:163], v[184:187], v[144:147]
v_cvt_pk_bf16_f32 v98, v60, v61
v_max_u32_dpp v249, v250, v250 row_ror:1 row_mask:0xf bank_mask:0xf
v_mfma_f32_16x16x32_bf16 v[28:31], a[164:167], v[188:191], v[28:31]
v_exp_f32 v62, v62
v_mfma_f32_16x16x32_bf16 v[28:31], a[168:171], v[192:195], v[28:31]
buffer_load_dwordx4 v233, s[12:15], s39 offen offset:3072  lds
v_mfma_f32_16x16x32_bf16 v[28:31], a[172:175], v[196:199], v[28:31]
v_exp_f32 v63, v63
v_mfma_f32_16x16x32_bf16 v[36:39], a[172:175], v[212:215], v[148:151]
ds_read_b128 a[172:175], v219 offset:61440
v_cvt_pk_bf16_f32 v99, v62, v63
v_mov_b32 v250, v249
v_mfma_f32_16x16x32_bf16 v[36:39], a[168:171], v[208:211], v[36:39]
v_exp_f32 v64, v64
v_mfma_f32_16x16x32_bf16 v[36:39], a[164:167], v[204:207], v[36:39]
ds_read_b128 a[168:171], v218 offset:61440
ds_read_b128 a[164:167], v217 offset:61440
v_mfma_f32_16x16x32_bf16 v[36:39], a[160:163], v[200:203], v[36:39]
v_exp_f32 v65, v65
s_waitcnt lgkmcnt(8)
v_mfma_f32_16x16x32_bf16 a[64:67], v[72:75], a[192:195], a[64:67]
ds_read_b128 a[160:163], v216 offset:61440
v_cvt_pk_bf16_f32 v100, v64, v65
v_mfma_f32_16x16x32_bf16 a[80:83], v[72:75], a[196:199], a[80:83]
v_permlane16_swap_b32 v249, v250
v_exp_f32 v66, v66
v_mfma_f32_16x16x32_bf16 a[84:87], v[76:79], a[196:199], a[84:87]
s_add_u32 m0, s86, 40960
s_add_u32 s50, s84, 1179648
buffer_load_dwordx4 v240, s[68:71], s50 offen lds
v_mfma_f32_16x16x32_bf16 a[68:71], v[76:79], a[192:195], a[68:71]
v_exp_f32 v67, v67
v_mfma_f32_16x16x32_bf16 a[72:75], v[80:83], a[192:195], a[72:75]
v_cvt_pk_bf16_f32 v101, v66, v67
v_max_u32 v249, v249, v250
v_mfma_f32_16x16x32_bf16 a[88:91], v[80:83], a[196:199], a[88:91]
v_exp_f32 v68, v68
v_mfma_f32_16x16x32_bf16 a[92:95], v[84:87], a[196:199], a[92:95]
ds_read_b64_tr_b16 a[196:197], v225 offset:40960
ds_read_b64_tr_b16 a[198:199], v225 offset:45056
v_mfma_f32_16x16x32_bf16 a[76:79], v[84:87], a[192:195], a[76:79]
v_exp_f32 v69, v69
v_mfma_f32_16x16x32_bf16 a[108:111], v[84:87], a[200:203], a[108:111]
ds_read_b64_tr_b16 a[192:193], v224 offset:40960
v_cvt_pk_bf16_f32 v102, v68, v69
v_mfma_f32_16x16x32_bf16 a[124:127], v[84:87], a[204:207], a[124:127]
v_exp_f32 v70, v70
v_mfma_f32_16x16x32_bf16 a[120:123], v[80:83], a[204:207], a[120:123]
ds_read_b64_tr_b16 a[194:195], v224 offset:45056
v_mov_b32 v250, v249
v_mfma_f32_16x16x32_bf16 a[104:107], v[80:83], a[200:203], a[104:107]
v_exp_f32 v71, v71
v_mfma_f32_16x16x32_bf16 a[100:103], v[76:79], a[200:203], a[100:103]
v_cvt_pk_bf16_f32 v103, v70, v71
v_permlane32_swap_b32 v249, v250
v_mfma_f32_16x16x32_bf16 a[116:119], v[76:79], a[204:207], a[116:119]
s_add_u32 m0, s86, 45056
s_add_u32 s50, s84, 1769472
buffer_load_dwordx4 v240, s[68:71], s50 offen lds
v_mfma_f32_16x16x32_bf16 a[112:115], v[72:75], a[204:207], a[112:115]
ds_read_b64_tr_b16 a[204:205], v227 offset:40960
ds_read_b64_tr_b16 a[206:207], v227 offset:45056
v_mfma_f32_16x16x32_bf16 a[96:99], v[72:75], a[200:203], a[96:99]
ds_read_b64_tr_b16 a[200:201], v226 offset:40960
ds_read_b64_tr_b16 a[202:203], v226 offset:45056
v_smfmac_f32_16x16x64_bf16 a[132:135], a[208:211], v[80:87], v245
v_max_u32 v249, v249, v250
v_mfma_f32_16x16x32_bf16 v[40:43], a[144:147], v[152:155], v[136:139]
v_exp_f32 v8, v8
v_mfma_f32_16x16x32_bf16 v[40:43], a[148:151], v[156:159], v[40:43]
v_exp_f32 v9, v9
v_mfma_f32_16x16x32_bf16 v[40:43], a[152:155], v[160:163], v[40:43]
v_cvt_pk_bf16_f32 v72, v8, v9
v_lshlrev_b32 v246, 2, v1
v_mfma_f32_16x16x32_bf16 v[40:43], a[156:159], v[164:167], v[40:43]
v_exp_f32 v10, v10
v_mfma_f32_16x16x32_bf16 v[48:51], a[156:159], v[180:183], v[140:143]
v_add_u32 v251, v251, v249
v_sub_u32 v248, v248, v249
v_mfma_f32_16x16x32_bf16 v[48:51], a[152:155], v[176:179], v[48:51]
v_exp_f32 v11, v11
v_mfma_f32_16x16x32_bf16 v[48:51], a[148:151], v[172:175], v[48:51]
v_cvt_pk_bf16_f32 v73, v10, v11
v_cndmask_b32 v252, v252, v251, s[90:91]
v_mfma_f32_16x16x32_bf16 v[48:51], a[144:147], v[168:171], v[48:51]
v_exp_f32 v12, v12
v_mfma_f32_16x16x32_bf16 v[56:59], a[144:147], v[184:187], v[144:147]
v_readfirstlane_b32 s77, v251
v_mfma_f32_16x16x32_bf16 v[56:59], a[148:151], v[188:191], v[56:59]
v_exp_f32 v13, v13
v_mfma_f32_16x16x32_bf16 v[56:59], a[152:155], v[192:195], v[56:59]
s_lshl_b64 s[90:91], s[90:91], 1
v_cvt_pk_bf16_f32 v74, v12, v13
v_mfma_f32_16x16x32_bf16 v[56:59], a[156:159], v[196:199], v[56:59]
v_exp_f32 v14, v14
v_mfma_f32_16x16x32_bf16 v[64:67], a[156:159], v[212:215], v[148:151]
s_waitcnt vmcnt(12) lgkmcnt(0)
s_barrier
v_mfma_f32_16x16x32_bf16 v[64:67], a[152:155], v[208:211], v[64:67]
v_exp_f32 v15, v15
v_mfma_f32_16x16x32_bf16 v[64:67], a[148:151], v[204:207], v[64:67]
ds_read_b128 a[156:159], v219 offset:0
v_cvt_pk_bf16_f32 v75, v14, v15
v_mfma_f32_16x16x32_bf16 v[64:67], a[144:147], v[200:203], v[64:67]
v_exp_f32 v16, v16
v_mfma_f32_16x16x32_bf16 a[0:3], v[88:91], a[176:179], a[0:3]
ds_read_b128 a[152:155], v218 offset:0
ds_read_b128 a[148:151], v217 offset:0
v_mfma_f32_16x16x32_bf16 a[16:19], v[88:91], a[180:183], a[16:19]
v_exp_f32 v17, v17
v_mfma_f32_16x16x32_bf16 a[20:23], v[92:95], a[180:183], a[20:23]
ds_read_b128 a[144:147], v216 offset:0
v_cvt_pk_bf16_f32 v76, v16, v17
v_mfma_f32_16x16x32_bf16 a[4:7], v[92:95], a[176:179], a[4:7]
v_exp_f32 v18, v18
v_mfma_f32_16x16x32_bf16 a[8:11], v[96:99], a[176:179], a[8:11]
s_add_u32 s32, s32, 16384
s_add_u32 m0, s30, 114688
v_mfma_f32_16x16x32_bf16 a[24:27], v[96:99], a[180:183], a[24:27]
v_exp_f32 v19, v19
v_mfma_f32_16x16x32_bf16 a[28:31], v[100:103], a[180:183], a[28:31]
ds_read_b64_tr_b16 a[180:181], v221 offset:49152
v_cvt_pk_bf16_f32 v77, v18, v19
v_mfma_f32_16x16x32_bf16 a[12:15], v[100:103], a[176:179], a[12:15]
v_exp_f32 v20, v20
v_mfma_f32_16x16x32_bf16 a[44:47], v[100:103], a[184:187], a[44:47]
ds_read_b64_tr_b16 a[182:183], v221 offset:53248
ds_read_b64_tr_b16 a[176:177], v220 offset:49152
v_mfma_f32_16x16x32_bf16 a[60:63], v[100:103], a[188:191], a[60:63]
v_exp_f32 v21, v21
v_mfma_f32_16x16x32_bf16 a[56:59], v[96:99], a[188:191], a[56:59]
ds_read_b64_tr_b16 a[178:179], v220 offset:53248
v_cvt_pk_bf16_f32 v78, v20, v21
v_mfma_f32_16x16x32_bf16 a[40:43], v[96:99], a[184:187], a[40:43]
v_exp_f32 v22, v22
v_mfma_f32_16x16x32_bf16 a[36:39], v[92:95], a[184:187], a[36:39]
buffer_load_dwordx4 v228, s[8:11], s32 offen offset:0  lds
v_mfma_f32_16x16x32_bf16 a[52:55], v[92:95], a[188:191], a[52:55]
v_max_u32_dpp v250, v248, v248 row_ror:8 row_mask:0xf bank_mask:0xf
v_exp_f32 v23, v23
v_mfma_f32_16x16x32_bf16 a[48:51], v[88:91], a[188:191], a[48:51]
ds_read_b64_tr_b16 a[188:189], v223 offset:49152
v_cvt_pk_bf16_f32 v79, v22, v23
v_mfma_f32_16x16x32_bf16 a[32:35], v[88:91], a[184:187], a[32:35]
v_exp_f32 v24, v24
v_smfmac_f32_16x16x64_bf16 a[128:131], a[208:211], v[88:95], v245
ds_read_b64_tr_b16 a[190:191], v223 offset:53248
v_mfma_f32_16x16x32_bf16 v[44:47], a[160:163], v[152:155], v[136:139]
v_exp_f32 v25, v25
v_mfma_f32_16x16x32_bf16 v[44:47], a[164:167], v[156:159], v[44:47]
v_max_u32_dpp v249, v250, v250 row_ror:4 row_mask:0xf bank_mask:0xf
v_exp_f32 v26, v26
v_mfma_f32_16x16x32_bf16 v[44:47], a[168:171], v[160:163], v[44:47]
ds_read_b64_tr_b16 a[184:185], v222 offset:49152
v_cvt_pk_bf16_f32 v80, v24, v25
v_mfma_f32_16x16x32_bf16 v[44:47], a[172:175], v[164:167], v[44:47]
v_exp_f32 v27, v27
v_mfma_f32_16x16x32_bf16 v[52:55], a[172:175], v[180:183], v[140:143]
ds_read_b64_tr_b16 a[186:187], v222 offset:53248
v_cvt_pk_bf16_f32 v81, v26, v27
v_mfma_f32_16x16x32_bf16 v[52:55], a[168:171], v[176:179], v[52:55]
v_max_u32_dpp v250, v249, v249 row_ror:2 row_mask:0xf bank_mask:0xf
v_exp_f32 v28, v28
v_mfma_f32_16x16x32_bf16 v[52:55], a[164:167], v[172:175], v[52:55]
buffer_load_dwordx4 v229, s[8:11], s32 offen offset:1024  lds
v_mfma_f32_16x16x32_bf16 v[52:55], a[160:163], v[168:171], v[52:55]
v_exp_f32 v29, v29
v_mfma_f32_16x16x32_bf16 v[60:63], a[160:163], v[184:187], v[144:147]
v_cvt_pk_bf16_f32 v82, v28, v29
v_max_u32_dpp v249, v250, v250 row_ror:1 row_mask:0xf bank_mask:0xf
v_mfma_f32_16x16x32_bf16 v[60:63], a[164:167], v[188:191], v[60:63]
v_exp_f32 v30, v30
v_mfma_f32_16x16x32_bf16 v[60:63], a[168:171], v[192:195], v[60:63]
buffer_load_dwordx4 v230, s[8:11], s32 offen offset:2048  lds
v_mfma_f32_16x16x32_bf16 v[60:63], a[172:175], v[196:199], v[60:63]
v_exp_f32 v31, v31
v_mfma_f32_16x16x32_bf16 v[68:71], a[172:175], v[212:215], v[148:151]
ds_read_b128 a[172:175], v219 offset:4096
v_cvt_pk_bf16_f32 v83, v30, v31
v_mfma_f32_16x16x32_bf16 v[68:71], a[168:171], v[208:211], v[68:71]
v_exp_f32 v32, v32
v_mfma_f32_16x16x32_bf16 v[68:71], a[164:167], v[204:207], v[68:71]
ds_read_b128 a[168:171], v218 offset:4096
ds_read_b128 a[164:167], v217 offset:4096
v_mov_b32 v250, v249
v_mfma_f32_16x16x32_bf16 v[68:71], a[160:163], v[200:203], v[68:71]
v_exp_f32 v33, v33
v_mfma_f32_16x16x32_bf16 a[64:67], v[88:91], a[192:195], a[64:67]
ds_read_b128 a[160:163], v216 offset:4096
v_cvt_pk_bf16_f32 v84, v32, v33
v_mfma_f32_16x16x32_bf16 a[80:83], v[88:91], a[196:199], a[80:83]
v_exp_f32 v34, v34
v_mfma_f32_16x16x32_bf16 a[84:87], v[92:95], a[196:199], a[84:87]
buffer_load_dwordx4 v231, s[8:11], s32 offen offset:3072  lds
v_mfma_f32_16x16x32_bf16 a[68:71], v[92:95], a[192:195], a[68:71]
v_permlane16_swap_b32 v249, v250
v_exp_f32 v35, v35
v_mfma_f32_16x16x32_bf16 a[72:75], v[96:99], a[192:195], a[72:75]
v_cvt_pk_bf16_f32 v85, v34, v35
v_max_u32 v249, v249, v250
v_mfma_f32_16x16x32_bf16 a[88:91], v[96:99], a[196:199], a[88:91]
v_exp_f32 v36, v36
v_mfma_f32_16x16x32_bf16 a[92:95], v[100:103], a[196:199], a[92:95]
ds_read_b64_tr_b16 a[196:197], v225 offset:49152
ds_read_b64_tr_b16 a[198:199], v225 offset:53248
v_mfma_f32_16x16x32_bf16 a[76:79], v[100:103], a[192:195], a[76:79]
v_exp_f32 v37, v37
v_mfma_f32_16x16x32_bf16 a[108:111], v[100:103], a[200:203], a[108:111]
ds_read_b64_tr_b16 a[192:193], v224 offset:49152
v_cvt_pk_bf16_f32 v86, v36, v37
v_mfma_f32_16x16x32_bf16 a[124:127], v[100:103], a[204:207], a[124:127]
v_exp_f32 v38, v38
v_mfma_f32_16x16x32_bf16 a[120:123], v[96:99], a[204:207], a[120:123]
ds_read_b64_tr_b16 a[194:195], v224 offset:53248
v_mov_b32 v250, v249
v_mfma_f32_16x16x32_bf16 a[104:107], v[96:99], a[200:203], a[104:107]
v_exp_f32 v39, v39
v_mfma_f32_16x16x32_bf16 a[100:103], v[92:95], a[200:203], a[100:103]
v_cvt_pk_bf16_f32 v87, v38, v39
v_permlane32_swap_b32 v249, v250
v_mfma_f32_16x16x32_bf16 a[116:119], v[92:95], a[204:207], a[116:119]
s_add_u32 m0, s86, 49152
s_add_u32 s50, s84, 2359296
buffer_load_dwordx4 v240, s[68:71], s50 offen lds
v_mfma_f32_16x16x32_bf16 a[112:115], v[88:91], a[204:207], a[112:115]
ds_read_b64_tr_b16 a[204:205], v227 offset:49152
ds_read_b64_tr_b16 a[206:207], v227 offset:53248
v_mfma_f32_16x16x32_bf16 a[96:99], v[88:91], a[200:203], a[96:99]
ds_read_b64_tr_b16 a[200:201], v226 offset:49152
ds_read_b64_tr_b16 a[202:203], v226 offset:53248
v_smfmac_f32_16x16x64_bf16 a[132:135], a[208:211], v[96:103], v245
s_add_u32 m0, s86, 53248
s_add_u32 s50, s84, 2949120
buffer_load_dwordx4 v240, s[68:71], s50 offen lds
s_waitcnt lgkmcnt(8)
v_mfma_f32_16x16x32_bf16 v[8:11], a[144:147], v[152:155], v[136:139]
v_exp_f32 v40, v40
v_mfma_f32_16x16x32_bf16 v[8:11], a[148:151], v[156:159], v[8:11]
v_exp_f32 v41, v41
v_mfma_f32_16x16x32_bf16 v[8:11], a[152:155], v[160:163], v[8:11]
v_cvt_pk_bf16_f32 v88, v40, v41
v_max_u32 v249, v249, v250
v_mfma_f32_16x16x32_bf16 v[8:11], a[156:159], v[164:167], v[8:11]
v_exp_f32 v42, v42
v_mfma_f32_16x16x32_bf16 v[16:19], a[156:159], v[180:183], v[140:143]
s_add_u32 s39, s39, 16384
v_add_u32 v251, v251, v249
v_mfma_f32_16x16x32_bf16 v[16:19], a[152:155], v[176:179], v[16:19]
v_exp_f32 v43, v43
v_mfma_f32_16x16x32_bf16 v[16:19], a[148:151], v[172:175], v[16:19]
v_cvt_pk_bf16_f32 v89, v42, v43
v_sub_u32 v248, v248, v249
v_mfma_f32_16x16x32_bf16 v[16:19], a[144:147], v[168:171], v[16:19]
v_exp_f32 v44, v44
v_mfma_f32_16x16x32_bf16 v[24:27], a[144:147], v[184:187], v[144:147]
buffer_load_dword v253, v246, s[24:27], 0 offen sc0 sc1
v_mfma_f32_16x16x32_bf16 v[24:27], a[148:151], v[188:191], v[24:27]
v_exp_f32 v45, v45
v_mfma_f32_16x16x32_bf16 v[24:27], a[152:155], v[192:195], v[24:27]
s_add_u32 m0, s30, 131072
v_cvt_pk_bf16_f32 v90, v44, v45
v_mfma_f32_16x16x32_bf16 v[24:27], a[156:159], v[196:199], v[24:27]
v_exp_f32 v46, v46
v_mfma_f32_16x16x32_bf16 v[32:35], a[156:159], v[212:215], v[148:151]
ds_read_b128 a[156:159], v219 offset:8192
v_cndmask_b32 v252, v252, v251, s[90:91]
v_mfma_f32_16x16x32_bf16 v[32:35], a[152:155], v[208:211], v[32:35]
v_exp_f32 v47, v47
v_mfma_f32_16x16x32_bf16 v[32:35], a[148:151], v[204:207], v[32:35]
ds_read_b128 a[152:155], v218 offset:8192
v_cvt_pk_bf16_f32 v91, v46, v47
v_mfma_f32_16x16x32_bf16 v[32:35], a[144:147], v[200:203], v[32:35]
v_exp_f32 v48, v48
v_mfma_f32_16x16x32_bf16 a[0:3], v[72:75], a[176:179], a[0:3]
ds_read_b128 a[148:151], v217 offset:8192
ds_read_b128 a[144:147], v216 offset:8192
v_mfma_f32_16x16x32_bf16 a[16:19], v[72:75], a[180:183], a[16:19]
v_exp_f32 v49, v49
v_mfma_f32_16x16x32_bf16 a[20:23], v[76:79], a[180:183], a[20:23]
v_cvt_pk_bf16_f32 v92, v48, v49
v_readfirstlane_b32 s78, v251
v_mfma_f32_16x16x32_bf16 a[4:7], v[76:79], a[176:179], a[4:7]
v_exp_f32 v50, v50
v_mfma_f32_16x16x32_bf16 a[8:11], v[80:83], a[176:179], a[8:11]
buffer_load_dwordx4 v232, s[12:15], s39 offen offset:0  lds
v_mfma_f32_16x16x32_bf16 a[24:27], v[80:83], a[180:183], a[24:27]
v_exp_f32 v51, v51
v_mfma_f32_16x16x32_bf16 a[28:31], v[84:87], a[180:183], a[28:31]
ds_read_b64_tr_b16 a[180:181], v221 offset:57344
v_cvt_pk_bf16_f32 v93, v50, v51
v_mfma_f32_16x16x32_bf16 a[12:15], v[84:87], a[176:179], a[12:15]
v_exp_f32 v52, v52
v_mfma_f32_16x16x32_bf16 a[44:47], v[84:87], a[184:187], a[44:47]
ds_read_b64_tr_b16 a[182:183], v221 offset:61440
ds_read_b64_tr_b16 a[176:177], v220 offset:57344
v_mfma_f32_16x16x32_bf16 a[60:63], v[84:87], a[188:191], a[60:63]
v_exp_f32 v53, v53
v_mfma_f32_16x16x32_bf16 a[56:59], v[80:83], a[188:191], a[56:59]
ds_read_b64_tr_b16 a[178:179], v220 offset:61440
v_cvt_pk_bf16_f32 v94, v52, v53
v_mfma_f32_16x16x32_bf16 a[40:43], v[80:83], a[184:187], a[40:43]
s_lshl_b64 s[90:91], s[90:91], 1
v_exp_f32 v54, v54
v_mfma_f32_16x16x32_bf16 a[36:39], v[76:79], a[184:187], a[36:39]
buffer_load_dwordx4 v233, s[12:15], s39 offen offset:1024  lds
v_mfma_f32_16x16x32_bf16 a[52:55], v[76:79], a[188:191], a[52:55]
v_exp_f32 v55, v55
v_mfma_f32_16x16x32_bf16 a[48:51], v[72:75], a[188:191], a[48:51]
ds_read_b64_tr_b16 a[188:189], v223 offset:57344
v_cvt_pk_bf16_f32 v95, v54, v55
v_mfma_f32_16x16x32_bf16 a[32:35], v[72:75], a[184:187], a[32:35]
v_max_u32_dpp v250, v248, v248 row_ror:8 row_mask:0xf bank_mask:0xf
v_exp_f32 v56, v56
v_smfmac_f32_16x16x64_bf16 a[128:131], a[208:211], v[72:79], v245
ds_read_b64_tr_b16 a[190:191], v223 offset:61440
v_mfma_f32_16x16x32_bf16 v[12:15], a[160:163], v[152:155], v[136:139]
v_exp_f32 v57, v57
v_mfma_f32_16x16x32_bf16 v[12:15], a[164:167], v[156:159], v[12:15]
v_exp_f32 v58, v58
v_mfma_f32_16x16x32_bf16 v[12:15], a[168:171], v[160:163], v[12:15]
ds_read_b64_tr_b16 a[184:185], v222 offset:57344
v_cvt_pk_bf16_f32 v96, v56, v57
v_mfma_f32_16x16x32_bf16 v[12:15], a[172:175], v[164:167], v[12:15]
v_max_u32_dpp v249, v250, v250 row_ror:4 row_mask:0xf bank_mask:0xf
v_exp_f32 v59, v59
v_mfma_f32_16x16x32_bf16 v[20:23], a[172:175], v[180:183], v[140:143]
ds_read_b64_tr_b16 a[186:187], v222 offset:61440
v_cvt_pk_bf16_f32 v97, v58, v59
v_mfma_f32_16x16x32_bf16 v[20:23], a[168:171], v[176:179], v[20:23]
v_exp_f32 v60, v60
v_mfma_f32_16x16x32_bf16 v[20:23], a[164:167], v[172:175], v[20:23]
buffer_load_dwordx4 v232, s[12:15], s39 offen offset:2048  lds
v_mfma_f32_16x16x32_bf16 v[20:23], a[160:163], v[168:171], v[20:23]
v_exp_f32 v61, v61
v_mfma_f32_16x16x32_bf16 v[28:31], a[160:163], v[184:187], v[144:147]
v_cvt_pk_bf16_f32 v98, v60, v61
v_max_u32_dpp v250, v249, v249 row_ror:2 row_mask:0xf bank_mask:0xf
v_mfma_f32_16x16x32_bf16 v[28:31], a[164:167], v[188:191], v[28:31]
v_exp_f32 v62, v62
v_mfma_f32_16x16x32_bf16 v[28:31], a[168:171], v[192:195], v[28:31]
buffer_load_dwordx4 v233, s[12:15], s39 offen offset:3072  lds
v_mfma_f32_16x16x32_bf16 v[28:31], a[172:175], v[196:199], v[28:31]
v_exp_f32 v63, v63
v_mfma_f32_16x16x32_bf16 v[36:39], a[172:175], v[212:215], v[148:151]
ds_read_b128 a[172:175], v219 offset:12288
v_cvt_pk_bf16_f32 v99, v62, v63
v_max_u32_dpp v249, v250, v250 row_ror:1 row_mask:0xf bank_mask:0xf
v_mfma_f32_16x16x32_bf16 v[36:39], a[168:171], v[208:211], v[36:39]
v_exp_f32 v64, v64
v_mfma_f32_16x16x32_bf16 v[36:39], a[164:167], v[204:207], v[36:39]
ds_read_b128 a[168:171], v218 offset:12288
ds_read_b128 a[164:167], v217 offset:12288
v_mfma_f32_16x16x32_bf16 v[36:39], a[160:163], v[200:203], v[36:39]
v_exp_f32 v65, v65
s_waitcnt lgkmcnt(8)
v_mfma_f32_16x16x32_bf16 a[64:67], v[72:75], a[192:195], a[64:67]
ds_read_b128 a[160:163], v216 offset:12288
v_cvt_pk_bf16_f32 v100, v64, v65
v_mfma_f32_16x16x32_bf16 a[80:83], v[72:75], a[196:199], a[80:83]
v_mov_b32 v250, v249
v_exp_f32 v66, v66
v_mfma_f32_16x16x32_bf16 a[84:87], v[76:79], a[196:199], a[84:87]
s_add_u32 m0, s86, 57344
s_add_u32 s50, s84, 3538944
buffer_load_dwordx4 v240, s[68:71], s50 offen lds
v_mfma_f32_16x16x32_bf16 a[68:71], v[76:79], a[192:195], a[68:71]
v_exp_f32 v67, v67
v_mfma_f32_16x16x32_bf16 a[72:75], v[80:83], a[192:195], a[72:75]
v_cvt_pk_bf16_f32 v101, v66, v67
v_permlane16_swap_b32 v249, v250
v_mfma_f32_16x16x32_bf16 a[88:91], v[80:83], a[196:199], a[88:91]
v_exp_f32 v68, v68
v_mfma_f32_16x16x32_bf16 a[92:95], v[84:87], a[196:199], a[92:95]
ds_read_b64_tr_b16 a[196:197], v225 offset:57344
ds_read_b64_tr_b16 a[198:199], v225 offset:61440
v_mfma_f32_16x16x32_bf16 a[76:79], v[84:87], a[192:195], a[76:79]
v_exp_f32 v69, v69
v_mfma_f32_16x16x32_bf16 a[108:111], v[84:87], a[200:203], a[108:111]
ds_read_b64_tr_b16 a[192:193], v224 offset:57344
v_cvt_pk_bf16_f32 v102, v68, v69
v_mfma_f32_16x16x32_bf16 a[124:127], v[84:87], a[204:207], a[124:127]
v_exp_f32 v70, v70
v_mfma_f32_16x16x32_bf16 a[120:123], v[80:83], a[204:207], a[120:123]
ds_read_b64_tr_b16 a[194:195], v224 offset:61440
v_max_u32 v249, v249, v250
v_mfma_f32_16x16x32_bf16 a[104:107], v[80:83], a[200:203], a[104:107]
v_exp_f32 v71, v71
v_mfma_f32_16x16x32_bf16 a[100:103], v[76:79], a[200:203], a[100:103]
v_cvt_pk_bf16_f32 v103, v70, v71
v_mov_b32 v250, v249
v_mfma_f32_16x16x32_bf16 a[116:119], v[76:79], a[204:207], a[116:119]
s_add_u32 m0, s86, 61440
s_add_u32 s50, s84, 4128768
buffer_load_dwordx4 v240, s[68:71], s50 offen lds
v_mfma_f32_16x16x32_bf16 a[112:115], v[72:75], a[204:207], a[112:115]
ds_read_b64_tr_b16 a[204:205], v227 offset:57344
ds_read_b64_tr_b16 a[206:207], v227 offset:61440
v_mfma_f32_16x16x32_bf16 a[96:99], v[72:75], a[200:203], a[96:99]
ds_read_b64_tr_b16 a[200:201], v226 offset:57344
ds_read_b64_tr_b16 a[202:203], v226 offset:61440
v_smfmac_f32_16x16x64_bf16 a[132:135], a[208:211], v[80:87], v245
v_permlane32_swap_b32 v249, v250
v_mfma_f32_16x16x32_bf16 v[40:43], a[144:147], v[152:155], v[136:139]
v_exp_f32 v8, v8
v_mfma_f32_16x16x32_bf16 v[40:43], a[148:151], v[156:159], v[40:43]
v_exp_f32 v9, v9
v_mfma_f32_16x16x32_bf16 v[40:43], a[152:155], v[160:163], v[40:43]
v_cvt_pk_bf16_f32 v72, v8, v9
v_max_u32 v249, v249, v250
v_mfma_f32_16x16x32_bf16 v[40:43], a[156:159], v[164:167], v[40:43]
v_exp_f32 v10, v10
v_mfma_f32_16x16x32_bf16 v[48:51], a[156:159], v[180:183], v[140:143]
v_add_u32 v251, v251, v249
v_sub_u32 v248, v248, v249
v_mfma_f32_16x16x32_bf16 v[48:51], a[152:155], v[176:179], v[48:51]
v_exp_f32 v11, v11
v_mfma_f32_16x16x32_bf16 v[48:51], a[148:151], v[172:175], v[48:51]
v_cvt_pk_bf16_f32 v73, v10, v11
v_cndmask_b32 v252, v252, v251, s[90:91]
v_mfma_f32_16x16x32_bf16 v[48:51], a[144:147], v[168:171], v[48:51]
v_exp_f32 v12, v12
v_mfma_f32_16x16x32_bf16 v[56:59], a[144:147], v[184:187], v[144:147]
v_readfirstlane_b32 s79, v251
v_mfma_f32_16x16x32_bf16 v[56:59], a[148:151], v[188:191], v[56:59]
v_exp_f32 v13, v13
v_mfma_f32_16x16x32_bf16 v[56:59], a[152:155], v[192:195], v[56:59]
s_lshl_b64 s[90:91], s[90:91], 1
v_cvt_pk_bf16_f32 v74, v12, v13
v_mfma_f32_16x16x32_bf16 v[56:59], a[156:159], v[196:199], v[56:59]
v_exp_f32 v14, v14
v_mfma_f32_16x16x32_bf16 v[64:67], a[156:159], v[212:215], v[148:151]
s_waitcnt vmcnt(13) lgkmcnt(0)
s_barrier
v_mfma_f32_16x16x32_bf16 v[64:67], a[152:155], v[208:211], v[64:67]
v_exp_f32 v15, v15
v_mfma_f32_16x16x32_bf16 v[64:67], a[148:151], v[204:207], v[64:67]
ds_read_b128 a[156:159], v219 offset:16384
v_cvt_pk_bf16_f32 v75, v14, v15
v_mfma_f32_16x16x32_bf16 v[64:67], a[144:147], v[200:203], v[64:67]
v_exp_f32 v16, v16
v_mfma_f32_16x16x32_bf16 a[0:3], v[88:91], a[176:179], a[0:3]
ds_read_b128 a[152:155], v218 offset:16384
ds_read_b128 a[148:151], v217 offset:16384
v_mfma_f32_16x16x32_bf16 a[16:19], v[88:91], a[180:183], a[16:19]
v_exp_f32 v17, v17
v_mfma_f32_16x16x32_bf16 a[20:23], v[92:95], a[180:183], a[20:23]
ds_read_b128 a[144:147], v216 offset:16384
v_cvt_pk_bf16_f32 v76, v16, v17
v_mfma_f32_16x16x32_bf16 a[4:7], v[92:95], a[176:179], a[4:7]
v_exp_f32 v18, v18
v_mfma_f32_16x16x32_bf16 a[8:11], v[96:99], a[176:179], a[8:11]
s_add_u32 s32, s32, 16384
v_max_u32_dpp v250, v248, v248 row_ror:8 row_mask:0xf bank_mask:0xf
v_mfma_f32_16x16x32_bf16 a[24:27], v[96:99], a[180:183], a[24:27]
v_exp_f32 v19, v19
v_mfma_f32_16x16x32_bf16 a[28:31], v[100:103], a[180:183], a[28:31]
ds_read_b64_tr_b16 a[180:181], v221 offset:0
v_cvt_pk_bf16_f32 v77, v18, v19
v_mfma_f32_16x16x32_bf16 a[12:15], v[100:103], a[176:179], a[12:15]
v_exp_f32 v20, v20
v_mfma_f32_16x16x32_bf16 a[44:47], v[100:103], a[184:187], a[44:47]
ds_read_b64_tr_b16 a[182:183], v221 offset:4096
ds_read_b64_tr_b16 a[176:177], v220 offset:0
v_mfma_f32_16x16x32_bf16 a[60:63], v[100:103], a[188:191], a[60:63]
v_exp_f32 v21, v21
v_mfma_f32_16x16x32_bf16 a[56:59], v[96:99], a[188:191], a[56:59]
ds_read_b64_tr_b16 a[178:179], v220 offset:4096
v_cvt_pk_bf16_f32 v78, v20, v21
v_mfma_f32_16x16x32_bf16 a[40:43], v[96:99], a[184:187], a[40:43]
v_exp_f32 v22, v22
v_mfma_f32_16x16x32_bf16 a[36:39], v[92:95], a[184:187], a[36:39]
s_add_u32 m0, s30, 65536
v_max_u32_dpp v249, v250, v250 row_ror:4 row_mask:0xf bank_mask:0xf
v_mfma_f32_16x16x32_bf16 a[52:55], v[92:95], a[188:191], a[52:55]
v_exp_f32 v23, v23
v_mfma_f32_16x16x32_bf16 a[48:51], v[88:91], a[188:191], a[48:51]
ds_read_b64_tr_b16 a[188:189], v223 offset:0
v_cvt_pk_bf16_f32 v79, v22, v23
v_mfma_f32_16x16x32_bf16 a[32:35], v[88:91], a[184:187], a[32:35]
v_exp_f32 v24, v24
v_smfmac_f32_16x16x64_bf16 a[128:131], a[208:211], v[88:95], v245
ds_read_b64_tr_b16 a[190:191], v223 offset:4096
v_mfma_f32_16x16x32_bf16 v[44:47], a[160:163], v[152:155], v[136:139]
v_exp_f32 v25, v25
v_mfma_f32_16x16x32_bf16 v[44:47], a[164:167], v[156:159], v[44:47]
v_exp_f32 v26, v26
v_mfma_f32_16x16x32_bf16 v[44:47], a[168:171], v[160:163], v[44:47]
ds_read_b64_tr_b16 a[184:185], v222 offset:0
v_cvt_pk_bf16_f32 v80, v24, v25
STUB_6:
s_cbranch_execz STUB_9
v_mfma_f32_16x16x32_bf16 v[44:47], a[172:175], v[164:167], v[44:47]
v_exp_f32 v27, v27
v_mfma_f32_16x16x32_bf16 v[52:55], a[172:175], v[180:183], v[140:143]
ds_read_b64_tr_b16 a[186:187], v222 offset:4096
v_cvt_pk_bf16_f32 v81, v26, v27
v_mfma_f32_16x16x32_bf16 v[52:55], a[168:171], v[176:179], v[52:55]
v_exp_f32 v28, v28
v_mfma_f32_16x16x32_bf16 v[52:55], a[164:167], v[172:175], v[52:55]
buffer_load_dwordx4 v228, s[8:11], s32 offen offset:0  lds
v_mfma_f32_16x16x32_bf16 v[52:55], a[160:163], v[168:171], v[52:55]
v_exp_f32 v29, v29
v_mfma_f32_16x16x32_bf16 v[60:63], a[160:163], v[184:187], v[144:147]
v_cvt_pk_bf16_f32 v82, v28, v29
v_max_u32_dpp v250, v249, v249 row_ror:2 row_mask:0xf bank_mask:0xf
v_mfma_f32_16x16x32_bf16 v[60:63], a[164:167], v[188:191], v[60:63]
v_exp_f32 v30, v30
v_mfma_f32_16x16x32_bf16 v[60:63], a[168:171], v[192:195], v[60:63]
buffer_load_dwordx4 v229, s[8:11], s32 offen offset:1024  lds
v_mfma_f32_16x16x32_bf16 v[60:63], a[172:175], v[196:199], v[60:63]
v_exp_f32 v31, v31
v_mfma_f32_16x16x32_bf16 v[68:71], a[172:175], v[212:215], v[148:151]
ds_read_b128 a[172:175], v219 offset:20480
v_cvt_pk_bf16_f32 v83, v30, v31
v_mfma_f32_16x16x32_bf16 v[68:71], a[168:171], v[208:211], v[68:71]
v_exp_f32 v32, v32
v_mfma_f32_16x16x32_bf16 v[68:71], a[164:167], v[204:207], v[68:71]
ds_read_b128 a[168:171], v218 offset:20480
ds_read_b128 a[164:167], v217 offset:20480
v_max_u32_dpp v249, v250, v250 row_ror:1 row_mask:0xf bank_mask:0xf
v_mfma_f32_16x16x32_bf16 v[68:71], a[160:163], v[200:203], v[68:71]
v_exp_f32 v33, v33
v_mfma_f32_16x16x32_bf16 a[64:67], v[88:91], a[192:195], a[64:67]
ds_read_b128 a[160:163], v216 offset:20480
v_cvt_pk_bf16_f32 v84, v32, v33
v_mfma_f32_16x16x32_bf16 a[80:83], v[88:91], a[196:199], a[80:83]
v_exp_f32 v34, v34
v_mfma_f32_16x16x32_bf16 a[84:87], v[92:95], a[196:199], a[84:87]
buffer_load_dwordx4 v230, s[8:11], s32 offen offset:2048  lds
v_mfma_f32_16x16x32_bf16 a[68:71], v[92:95], a[192:195], a[68:71]
v_mov_b32 v250, v249
v_exp_f32 v35, v35
v_mfma_f32_16x16x32_bf16 a[72:75], v[96:99], a[192:195], a[72:75]
v_cvt_pk_bf16_f32 v85, v34, v35
v_mfma_f32_16x16x32_bf16 a[88:91], v[96:99], a[196:199], a[88:91]
v_exp_f32 v36, v36
v_mfma_f32_16x16x32_bf16 a[92:95], v[100:103], a[196:199], a[92:95]
ds_read_b64_tr_b16 a[196:197], v225 offset:0
ds_read_b64_tr_b16 a[198:199], v225 offset:4096
v_mfma_f32_16x16x32_bf16 a[76:79], v[100:103], a[192:195], a[76:79]
v_permlane16_swap_b32 v249, v250
v_exp_f32 v37, v37
v_mfma_f32_16x16x32_bf16 a[108:111], v[100:103], a[200:203], a[108:111]
ds_read_b64_tr_b16 a[192:193], v224 offset:0
v_cvt_pk_bf16_f32 v86, v36, v37
v_mfma_f32_16x16x32_bf16 a[124:127], v[100:103], a[204:207], a[124:127]
v_exp_f32 v38, v38
v_mfma_f32_16x16x32_bf16 a[120:123], v[96:99], a[204:207], a[120:123]
ds_read_b64_tr_b16 a[194:195], v224 offset:4096
v_max_u32 v249, v249, v250
v_mfma_f32_16x16x32_bf16 a[104:107], v[96:99], a[200:203], a[104:107]
v_exp_f32 v39, v39
v_mfma_f32_16x16x32_bf16 a[100:103], v[92:95], a[200:203], a[100:103]
v_cvt_pk_bf16_f32 v87, v38, v39
v_mov_b32 v250, v249
v_mfma_f32_16x16x32_bf16 a[116:119], v[92:95], a[204:207], a[116:119]
buffer_load_dwordx4 v231, s[8:11], s32 offen offset:3072  lds
v_mfma_f32_16x16x32_bf16 a[112:115], v[88:91], a[204:207], a[112:115]
ds_read_b64_tr_b16 a[204:205], v227 offset:0
ds_read_b64_tr_b16 a[206:207], v227 offset:4096
v_mfma_f32_16x16x32_bf16 a[96:99], v[88:91], a[200:203], a[96:99]
ds_read_b64_tr_b16 a[200:201], v226 offset:0
ds_read_b64_tr_b16 a[202:203], v226 offset:4096
v_smfmac_f32_16x16x64_bf16 a[132:135], a[208:211], v[96:103], v245
v_permlane32_swap_b32 v249, v250
s_waitcnt lgkmcnt(8)
v_mfma_f32_16x16x32_bf16 v[8:11], a[144:147], v[152:155], v[136:139]
v_exp_f32 v40, v40
v_mfma_f32_16x16x32_bf16 v[8:11], a[148:151], v[156:159], v[8:11]
v_exp_f32 v41, v41
v_mfma_f32_16x16x32_bf16 v[8:11], a[152:155], v[160:163], v[8:11]
v_cvt_pk_bf16_f32 v88, v40, v41
v_max_u32 v249, v249, v250
v_mfma_f32_16x16x32_bf16 v[8:11], a[156:159], v[164:167], v[8:11]
v_exp_f32 v42, v42
v_mfma_f32_16x16x32_bf16 v[16:19], a[156:159], v[180:183], v[140:143]
s_add_u32 s39, s39, 16384
v_add_u32 v251, v251, v249
v_mfma_f32_16x16x32_bf16 v[16:19], a[152:155], v[176:179], v[16:19]
v_exp_f32 v43, v43
v_mfma_f32_16x16x32_bf16 v[16:19], a[148:151], v[172:175], v[16:19]
v_cvt_pk_bf16_f32 v89, v42, v43
v_sub_u32 v248, v248, v249
v_mfma_f32_16x16x32_bf16 v[16:19], a[144:147], v[168:171], v[16:19]
v_exp_f32 v44, v44
v_mfma_f32_16x16x32_bf16 v[24:27], a[144:147], v[184:187], v[144:147]
v_cndmask_b32 v252, v252, v251, s[90:91]
v_mfma_f32_16x16x32_bf16 v[24:27], a[148:151], v[188:191], v[24:27]
v_exp_f32 v45, v45
v_mfma_f32_16x16x32_bf16 v[24:27], a[152:155], v[192:195], v[24:27]
v_cvt_pk_bf16_f32 v90, v44, v45
v_readfirstlane_b32 s80, v251
v_mfma_f32_16x16x32_bf16 v[24:27], a[156:159], v[196:199], v[24:27]
v_exp_f32 v46, v46
v_mfma_f32_16x16x32_bf16 v[32:35], a[156:159], v[212:215], v[148:151]
ds_read_b128 a[156:159], v219 offset:24576
s_add_u32 m0, s30, 147456
v_mfma_f32_16x16x32_bf16 v[32:35], a[152:155], v[208:211], v[32:35]
v_exp_f32 v47, v47
v_mfma_f32_16x16x32_bf16 v[32:35], a[148:151], v[204:207], v[32:35]
ds_read_b128 a[152:155], v218 offset:24576
v_cvt_pk_bf16_f32 v91, v46, v47
v_mfma_f32_16x16x32_bf16 v[32:35], a[144:147], v[200:203], v[32:35]
v_exp_f32 v48, v48
v_mfma_f32_16x16x32_bf16 a[0:3], v[72:75], a[176:179], a[0:3]
ds_read_b128 a[148:151], v217 offset:24576
ds_read_b128 a[144:147], v216 offset:24576
v_mfma_f32_16x16x32_bf16 a[16:19], v[72:75], a[180:183], a[16:19]
v_exp_f32 v49, v49
v_mfma_f32_16x16x32_bf16 a[20:23], v[76:79], a[180:183], a[20:23]
s_lshl_b64 s[90:91], s[90:91], 1
v_cvt_pk_bf16_f32 v92, v48, v49
v_mfma_f32_16x16x32_bf16 a[4:7], v[76:79], a[176:179], a[4:7]
v_exp_f32 v50, v50
v_mfma_f32_16x16x32_bf16 a[8:11], v[80:83], a[176:179], a[8:11]
v_max_u32_dpp v250, v248, v248 row_ror:8 row_mask:0xf bank_mask:0xf
v_mfma_f32_16x16x32_bf16 a[24:27], v[80:83], a[180:183], a[24:27]
v_exp_f32 v51, v51
v_mfma_f32_16x16x32_bf16 a[28:31], v[84:87], a[180:183], a[28:31]
ds_read_b64_tr_b16 a[180:181], v221 offset:8192
v_cvt_pk_bf16_f32 v93, v50, v51
v_mfma_f32_16x16x32_bf16 a[12:15], v[84:87], a[176:179], a[12:15]
v_exp_f32 v52, v52
v_mfma_f32_16x16x32_bf16 a[44:47], v[84:87], a[184:187], a[44:47]
ds_read_b64_tr_b16 a[182:183], v221 offset:12288
ds_read_b64_tr_b16 a[176:177], v220 offset:8192
v_mfma_f32_16x16x32_bf16 a[60:63], v[84:87], a[188:191], a[60:63]
v_exp_f32 v53, v53
v_mfma_f32_16x16x32_bf16 a[56:59], v[80:83], a[188:191], a[56:59]
ds_read_b64_tr_b16 a[178:179], v220 offset:12288
v_cvt_pk_bf16_f32 v94, v52, v53
v_mfma_f32_16x16x32_bf16 a[40:43], v[80:83], a[184:187], a[40:43]
v_exp_f32 v54, v54
v_mfma_f32_16x16x32_bf16 a[36:39], v[76:79], a[184:187], a[36:39]
buffer_load_dwordx4 v232, s[12:15], s39 offen offset:0  lds
v_mfma_f32_16x16x32_bf16 a[52:55], v[76:79], a[188:191], a[52:55]
v_exp_f32 v55, v55
v_mfma_f32_16x16x32_bf16 a[48:51], v[72:75], a[188:191], a[48:51]
ds_read_b64_tr_b16 a[188:189], v223 offset:8192
v_cvt_pk_bf16_f32 v95, v54, v55
v_mfma_f32_16x16x32_bf16 a[32:35], v[72:75], a[184:187], a[32:35]
v_exp_f32 v56, v56
v_smfmac_f32_16x16x64_bf16 a[128:131], a[208:211], v[72:79], v245
ds_read_b64_tr_b16 a[190:191], v223 offset:12288
v_mfma_f32_16x16x32_bf16 v[12:15], a[160:163], v[152:155], v[136:139]
v_exp_f32 v57, v57
v_mfma_f32_16x16x32_bf16 v[12:15], a[164:167], v[156:159], v[12:15]
v_exp_f32 v58, v58
v_mfma_f32_16x16x32_bf16 v[12:15], a[168:171], v[160:163], v[12:15]
ds_read_b64_tr_b16 a[184:185], v222 offset:8192
v_cvt_pk_bf16_f32 v96, v56, v57
v_mfma_f32_16x16x32_bf16 v[12:15], a[172:175], v[164:167], v[12:15]
v_exp_f32 v59, v59
v_mfma_f32_16x16x32_bf16 v[20:23], a[172:175], v[180:183], v[140:143]
ds_read_b64_tr_b16 a[186:187], v222 offset:12288
v_cvt_pk_bf16_f32 v97, v58, v59
v_mfma_f32_16x16x32_bf16 v[20:23], a[168:171], v[176:179], v[20:23]
v_exp_f32 v60, v60
v_mfma_f32_16x16x32_bf16 v[20:23], a[164:167], v[172:175], v[20:23]
buffer_load_dwordx4 v233, s[12:15], s39 offen offset:1024  lds
v_mfma_f32_16x16x32_bf16 v[20:23], a[160:163], v[168:171], v[20:23]
v_max_u32_dpp v249, v250, v250 row_ror:4 row_mask:0xf bank_mask:0xf
v_exp_f32 v61, v61
v_mfma_f32_16x16x32_bf16 v[28:31], a[160:163], v[184:187], v[144:147]
v_cvt_pk_bf16_f32 v98, v60, v61
v_mfma_f32_16x16x32_bf16 v[28:31], a[164:167], v[188:191], v[28:31]
v_exp_f32 v62, v62
v_mfma_f32_16x16x32_bf16 v[28:31], a[168:171], v[192:195], v[28:31]
buffer_load_dwordx4 v232, s[12:15], s39 offen offset:2048  lds
v_mfma_f32_16x16x32_bf16 v[28:31], a[172:175], v[196:199], v[28:31]
v_exp_f32 v63, v63
v_mfma_f32_16x16x32_bf16 v[36:39], a[172:175], v[212:215], v[148:151]
ds_read_b128 a[172:175], v219 offset:28672
v_cvt_pk_bf16_f32 v99, v62, v63
v_max_u32_dpp v250, v249, v249 row_ror:2 row_mask:0xf bank_mask:0xf
v_mfma_f32_16x16x32_bf16 v[36:39], a[168:171], v[208:211], v[36:39]
v_exp_f32 v64, v64
v_mfma_f32_16x16x32_bf16 v[36:39], a[164:167], v[204:207], v[36:39]
ds_read_b128 a[168:171], v218 offset:28672
ds_read_b128 a[164:167], v217 offset:28672
v_mfma_f32_16x16x32_bf16 v[36:39], a[160:163], v[200:203], v[36:39]
v_exp_f32 v65, v65
s_waitcnt lgkmcnt(8)
v_mfma_f32_16x16x32_bf16 a[64:67], v[72:75], a[192:195], a[64:67]
ds_read_b128 a[160:163], v216 offset:28672
v_cvt_pk_bf16_f32 v100, v64, v65
v_max_u32_dpp v249, v250, v250 row_ror:1 row_mask:0xf bank_mask:0xf
v_mfma_f32_16x16x32_bf16 a[80:83], v[72:75], a[196:199], a[80:83]
v_exp_f32 v66, v66
v_mfma_f32_16x16x32_bf16 a[84:87], v[76:79], a[196:199], a[84:87]
buffer_load_dwordx4 v233, s[12:15], s39 offen offset:3072  lds
v_mfma_f32_16x16x32_bf16 a[68:71], v[76:79], a[192:195], a[68:71]
v_exp_f32 v67, v67
v_mfma_f32_16x16x32_bf16 a[72:75], v[80:83], a[192:195], a[72:75]
v_cvt_pk_bf16_f32 v101, v66, v67
v_mov_b32 v250, v249
v_mfma_f32_16x16x32_bf16 a[88:91], v[80:83], a[196:199], a[88:91]
v_exp_f32 v68, v68
v_mfma_f32_16x16x32_bf16 a[92:95], v[84:87], a[196:199], a[92:95]
ds_read_b64_tr_b16 a[196:197], v225 offset:8192
ds_read_b64_tr_b16 a[198:199], v225 offset:12288
v_mfma_f32_16x16x32_bf16 a[76:79], v[84:87], a[192:195], a[76:79]
v_exp_f32 v69, v69
v_mfma_f32_16x16x32_bf16 a[108:111], v[84:87], a[200:203], a[108:111]
ds_read_b64_tr_b16 a[192:193], v224 offset:8192
v_cvt_pk_bf16_f32 v102, v68, v69
v_mfma_f32_16x16x32_bf16 a[124:127], v[84:87], a[204:207], a[124:127]
v_exp_f32 v70, v70
v_mfma_f32_16x16x32_bf16 a[120:123], v[80:83], a[204:207], a[120:123]
ds_read_b64_tr_b16 a[194:195], v224 offset:12288
v_permlane16_swap_b32 v249, v250
v_mfma_f32_16x16x32_bf16 a[104:107], v[80:83], a[200:203], a[104:107]
v_exp_f32 v71, v71
v_mfma_f32_16x16x32_bf16 a[100:103], v[76:79], a[200:203], a[100:103]
v_cvt_pk_bf16_f32 v103, v70, v71
v_max_u32 v249, v249, v250
v_mfma_f32_16x16x32_bf16 a[116:119], v[76:79], a[204:207], a[116:119]
v_mov_b32 v250, v249
v_mfma_f32_16x16x32_bf16 a[112:115], v[72:75], a[204:207], a[112:115]
ds_read_b64_tr_b16 a[204:205], v227 offset:8192
ds_read_b64_tr_b16 a[206:207], v227 offset:12288
v_mfma_f32_16x16x32_bf16 a[96:99], v[72:75], a[200:203], a[96:99]
ds_read_b64_tr_b16 a[200:201], v226 offset:8192
ds_read_b64_tr_b16 a[202:203], v226 offset:12288
v_smfmac_f32_16x16x64_bf16 a[132:135], a[208:211], v[80:87], v245
v_permlane32_swap_b32 v249, v250
v_mfma_f32_16x16x32_bf16 v[40:43], a[144:147], v[152:155], v[136:139]
v_exp_f32 v8, v8
v_mfma_f32_16x16x32_bf16 v[40:43], a[148:151], v[156:159], v[40:43]
v_exp_f32 v9, v9
v_mfma_f32_16x16x32_bf16 v[40:43], a[152:155], v[160:163], v[40:43]
v_cvt_pk_bf16_f32 v72, v8, v9
v_max_u32 v249, v249, v250
v_mfma_f32_16x16x32_bf16 v[40:43], a[156:159], v[164:167], v[40:43]
v_exp_f32 v10, v10
v_mfma_f32_16x16x32_bf16 v[48:51], a[156:159], v[180:183], v[140:143]
v_add_u32 v251, v251, v249
v_sub_u32 v248, v248, v249
v_mfma_f32_16x16x32_bf16 v[48:51], a[152:155], v[176:179], v[48:51]
v_exp_f32 v11, v11
v_mfma_f32_16x16x32_bf16 v[48:51], a[148:151], v[172:175], v[48:51]
v_cvt_pk_bf16_f32 v73, v10, v11
v_cndmask_b32 v252, v252, v251, s[90:91]
v_mfma_f32_16x16x32_bf16 v[48:51], a[144:147], v[168:171], v[48:51]
v_exp_f32 v12, v12
v_mfma_f32_16x16x32_bf16 v[56:59], a[144:147], v[184:187], v[144:147]
v_readfirstlane_b32 s81, v251
v_mfma_f32_16x16x32_bf16 v[56:59], a[148:151], v[188:191], v[56:59]
v_exp_f32 v13, v13
v_mfma_f32_16x16x32_bf16 v[56:59], a[152:155], v[192:195], v[56:59]
s_lshl_b64 s[90:91], s[90:91], 1
v_cvt_pk_bf16_f32 v74, v12, v13
v_mfma_f32_16x16x32_bf16 v[56:59], a[156:159], v[196:199], v[56:59]
v_exp_f32 v14, v14
v_mfma_f32_16x16x32_bf16 v[64:67], a[156:159], v[212:215], v[148:151]
s_waitcnt vmcnt(8) lgkmcnt(0)
s_barrier
v_mfma_f32_16x16x32_bf16 v[64:67], a[152:155], v[208:211], v[64:67]
ds_read_b64_tr_b16 a[212:213], v241 offset:0
v_exp_f32 v15, v15
v_mfma_f32_16x16x32_bf16 v[64:67], a[148:151], v[204:207], v[64:67]
ds_read_b128 a[156:159], v219 offset:49152
ds_read_b64_tr_b16 a[214:215], v241 offset:256
v_cvt_pk_bf16_f32 v75, v14, v15
v_mfma_f32_16x16x32_bf16 v[64:67], a[144:147], v[200:203], v[64:67]
ds_read_b64_tr_b16 a[216:217], v241 offset:2048
v_exp_f32 v16, v16
v_mfma_f32_16x16x32_bf16 a[0:3], v[88:91], a[176:179], a[0:3]
ds_read_b128 a[152:155], v218 offset:49152
ds_read_b128 a[148:151], v217 offset:49152
ds_read_b64_tr_b16 a[218:219], v241 offset:2304
v_mfma_f32_16x16x32_bf16 a[16:19], v[88:91], a[180:183], a[16:19]
ds_read_b64_tr_b16 a[220:221], v241 offset:4096
v_exp_f32 v17, v17
v_mfma_f32_16x16x32_bf16 a[20:23], v[92:95], a[180:183], a[20:23]
ds_read_b128 a[144:147], v216 offset:49152
ds_read_b64_tr_b16 a[222:223], v241 offset:4352
v_cvt_pk_bf16_f32 v76, v16, v17
v_mfma_f32_16x16x32_bf16 a[4:7], v[92:95], a[176:179], a[4:7]
ds_read_b64_tr_b16 a[224:225], v241 offset:6144
v_exp_f32 v18, v18
v_mfma_f32_16x16x32_bf16 a[8:11], v[96:99], a[176:179], a[8:11]
s_add_u32 s32, s32, 16384
ds_read_b64_tr_b16 a[226:227], v241 offset:6400
ds_read_b64_tr_b16 a[228:229], v241 offset:8192
v_mfma_f32_16x16x32_bf16 a[24:27], v[96:99], a[180:183], a[24:27]
ds_read_b64_tr_b16 a[230:231], v241 offset:8448
v_exp_f32 v19, v19
v_mfma_f32_16x16x32_bf16 a[28:31], v[100:103], a[180:183], a[28:31]
ds_read_b64_tr_b16 a[180:181], v221 offset:32768
ds_read_b64_tr_b16 a[232:233], v241 offset:10240
v_cvt_pk_bf16_f32 v77, v18, v19
v_mfma_f32_16x16x32_bf16 a[12:15], v[100:103], a[176:179], a[12:15]
ds_read_b64_tr_b16 a[234:235], v241 offset:10496
v_exp_f32 v20, v20
v_mfma_f32_16x16x32_bf16 a[44:47], v[100:103], a[184:187], a[44:47]
ds_read_b64_tr_b16 a[182:183], v221 offset:36864
ds_read_b64_tr_b16 a[176:177], v220 offset:32768
ds_read_b64_tr_b16 a[236:237], v241 offset:12288
v_mfma_f32_16x16x32_bf16 a[60:63], v[100:103], a[188:191], a[60:63]
ds_read_b64_tr_b16 a[238:239], v241 offset:12544
v_exp_f32 v21, v21
v_mfma_f32_16x16x32_bf16 a[56:59], v[96:99], a[188:191], a[56:59]
ds_read_b64_tr_b16 a[178:179], v220 offset:36864
ds_read_b64_tr_b16 a[240:241], v241 offset:14336
v_cvt_pk_bf16_f32 v78, v20, v21
v_mfma_f32_16x16x32_bf16 a[40:43], v[96:99], a[184:187], a[40:43]
ds_read_b64_tr_b16 a[242:243], v241 offset:14592
v_exp_f32 v22, v22
v_mfma_f32_16x16x32_bf16 a[36:39], v[92:95], a[184:187], a[36:39]
s_add_u32 m0, s30, 81920
ds_read_b64_tr_b16 a[244:245], v241 offset:16384
ds_read_b64_tr_b16 a[246:247], v241 offset:16640
v_mfma_f32_16x16x32_bf16 a[52:55], v[92:95], a[188:191], a[52:55]
ds_read_b64_tr_b16 a[248:249], v241 offset:18432
v_exp_f32 v23, v23
v_mfma_f32_16x16x32_bf16 a[48:51], v[88:91], a[188:191], a[48:51]
ds_read_b64_tr_b16 a[188:189], v223 offset:32768
ds_read_b64_tr_b16 a[250:251], v241 offset:18688
v_cvt_pk_bf16_f32 v79, v22, v23
v_mfma_f32_16x16x32_bf16 a[32:35], v[88:91], a[184:187], a[32:35]
ds_read_b64_tr_b16 a[252:253], v241 offset:20480
v_exp_f32 v24, v24
v_smfmac_f32_16x16x64_bf16 a[128:131], a[208:211], v[88:95], v245
ds_read_b64_tr_b16 a[190:191], v223 offset:36864
ds_read_b64_tr_b16 a[254:255], v241 offset:20736
v_mfma_f32_16x16x32_bf16 v[44:47], a[160:163], v[152:155], v[136:139]
ds_read_b64_tr_b16 a[136:137], v241 offset:22528
v_exp_f32 v25, v25
v_mfma_f32_16x16x32_bf16 v[44:47], a[164:167], v[156:159], v[44:47]
v_exp_f32 v26, v26
v_mfma_f32_16x16x32_bf16 v[44:47], a[168:171], v[160:163], v[44:47]
ds_read_b64_tr_b16 a[184:185], v222 offset:32768
v_cvt_pk_bf16_f32 v80, v24, v25
v_mfma_f32_16x16x32_bf16 v[44:47], a[172:175], v[164:167], v[44:47]
ds_read_b64_tr_b16 a[138:139], v241 offset:22784
v_exp_f32 v27, v27
v_mfma_f32_16x16x32_bf16 v[52:55], a[172:175], v[180:183], v[140:143]
ds_read_b64_tr_b16 a[186:187], v222 offset:36864
v_cvt_pk_bf16_f32 v81, v26, v27
v_mfma_f32_16x16x32_bf16 v[52:55], a[168:171], v[176:179], v[52:55]
v_max_u32_dpp v250, v248, v248 row_ror:8 row_mask:0xf bank_mask:0xf
v_exp_f32 v28, v28
v_mfma_f32_16x16x32_bf16 v[52:55], a[164:167], v[172:175], v[52:55]
buffer_load_dwordx4 v228, s[8:11], s32 offen offset:0  lds
v_mfma_f32_16x16x32_bf16 v[52:55], a[160:163], v[168:171], v[52:55]
ds_read_b64_tr_b16 a[140:141], v241 offset:24576
v_exp_f32 v29, v29
v_mfma_f32_16x16x32_bf16 v[60:63], a[160:163], v[184:187], v[144:147]
ds_read_b64_tr_b16 a[142:143], v241 offset:24832
v_cvt_pk_bf16_f32 v82, v28, v29
v_mfma_f32_16x16x32_bf16 v[60:63], a[164:167], v[188:191], v[60:63]
v_exp_f32 v30, v30
v_mfma_f32_16x16x32_bf16 v[60:63], a[168:171], v[192:195], v[60:63]
buffer_load_dwordx4 v229, s[8:11], s32 offen offset:1024  lds
v_max_u32_dpp v249, v250, v250 row_ror:4 row_mask:0xf bank_mask:0xf
v_mfma_f32_16x16x32_bf16 v[60:63], a[172:175], v[196:199], v[60:63]
v_exp_f32 v31, v31
v_mfma_f32_16x16x32_bf16 v[68:71], a[172:175], v[212:215], v[148:151]
ds_read_b128 a[172:175], v219 offset:53248
v_cvt_pk_bf16_f32 v83, v30, v31
v_mfma_f32_16x16x32_bf16 v[68:71], a[168:171], v[208:211], v[68:71]
v_exp_f32 v32, v32
v_mfma_f32_16x16x32_bf16 v[68:71], a[164:167], v[204:207], v[68:71]
ds_read_b128 a[168:171], v218 offset:53248
ds_read_b128 a[164:167], v217 offset:53248
v_max_u32_dpp v250, v249, v249 row_ror:2 row_mask:0xf bank_mask:0xf
v_mfma_f32_16x16x32_bf16 v[68:71], a[160:163], v[200:203], v[68:71]
v_exp_f32 v33, v33
v_mfma_f32_16x16x32_bf16 a[64:67], v[88:91], a[192:195], a[64:67]
ds_read_b128 a[160:163], v216 offset:53248
ds_read_b64_tr_b16 v[104:105], v241 offset:26624
v_cvt_pk_bf16_f32 v84, v32, v33
v_mfma_f32_16x16x32_bf16 a[80:83], v[88:91], a[196:199], a[80:83]
v_exp_f32 v34, v34
v_mfma_f32_16x16x32_bf16 a[84:87], v[92:95], a[196:199], a[84:87]
buffer_load_dwordx4 v230, s[8:11], s32 offen offset:2048  lds
v_mfma_f32_16x16x32_bf16 a[68:71], v[92:95], a[192:195], a[68:71]
v_max_u32_dpp v249, v250, v250 row_ror:1 row_mask:0xf bank_mask:0xf
v_exp_f32 v35, v35
v_mfma_f32_16x16x32_bf16 a[72:75], v[96:99], a[192:195], a[72:75]
ds_read_b64_tr_b16 v[106:107], v241 offset:26880
v_cvt_pk_bf16_f32 v85, v34, v35
v_mfma_f32_16x16x32_bf16 a[88:91], v[96:99], a[196:199], a[88:91]
v_exp_f32 v36, v36
v_mfma_f32_16x16x32_bf16 a[92:95], v[100:103], a[196:199], a[92:95]
ds_read_b64_tr_b16 a[196:197], v225 offset:32768
ds_read_b64_tr_b16 a[198:199], v225 offset:36864
v_mfma_f32_16x16x32_bf16 a[76:79], v[100:103], a[192:195], a[76:79]
v_mov_b32 v250, v249
v_exp_f32 v37, v37
v_mfma_f32_16x16x32_bf16 a[108:111], v[100:103], a[200:203], a[108:111]
ds_read_b64_tr_b16 a[192:193], v224 offset:32768
v_cvt_pk_bf16_f32 v86, v36, v37
v_mfma_f32_16x16x32_bf16 a[124:127], v[100:103], a[204:207], a[124:127]
ds_read_b64_tr_b16 v[108:109], v241 offset:28672
v_exp_f32 v38, v38
v_mfma_f32_16x16x32_bf16 a[120:123], v[96:99], a[204:207], a[120:123]
ds_read_b64_tr_b16 a[194:195], v224 offset:36864
ds_read_b64_tr_b16 v[110:111], v241 offset:28928
v_mfma_f32_16x16x32_bf16 a[104:107], v[96:99], a[200:203], a[104:107]
v_exp_f32 v39, v39
v_mfma_f32_16x16x32_bf16 a[100:103], v[92:95], a[200:203], a[100:103]
ds_read_b64_tr_b16 v[112:113], v241 offset:30720
v_cvt_pk_bf16_f32 v87, v38, v39
v_permlane16_swap_b32 v249, v250
v_mfma_f32_16x16x32_bf16 a[116:119], v[92:95], a[204:207], a[116:119]
buffer_load_dwordx4 v231, s[8:11], s32 offen offset:3072  lds
v_mfma_f32_16x16x32_bf16 a[112:115], v[88:91], a[204:207], a[112:115]
ds_read_b64_tr_b16 a[204:205], v227 offset:32768
ds_read_b64_tr_b16 a[206:207], v227 offset:36864
v_mfma_f32_16x16x32_bf16 a[96:99], v[88:91], a[200:203], a[96:99]
ds_read_b64_tr_b16 a[200:201], v226 offset:32768
ds_read_b64_tr_b16 a[202:203], v226 offset:36864
v_smfmac_f32_16x16x64_bf16 a[132:135], a[208:211], v[96:103], v245
ds_read_b64_tr_b16 v[114:115], v241 offset:30976
v_max_u32 v249, v249, v250
s_waitcnt lgkmcnt(8)
v_mfma_f32_16x16x32_bf16 v[8:11], a[144:147], v[152:155], v[136:139]
v_exp_f32 v40, v40
v_mfma_f32_16x16x32_bf16 v[8:11], a[148:151], v[156:159], v[8:11]
v_exp_f32 v41, v41
v_mfma_f32_16x16x32_bf16 v[8:11], a[152:155], v[160:163], v[8:11]
v_and_b32 v253, 0x20202020, v253
v_cvt_pk_bf16_f32 v88, v40, v41
v_mfma_f32_16x16x32_bf16 v[8:11], a[156:159], v[164:167], v[8:11]
v_exp_f32 v42, v42
v_mfma_f32_16x16x32_bf16 v[16:19], a[156:159], v[180:183], v[140:143]
s_add_u32 s39, s39, 16384
v_mov_b32 v250, v249
v_mfma_f32_16x16x32_bf16 v[16:19], a[152:155], v[176:179], v[16:19]
v_exp_f32 v43, v43
v_mfma_f32_16x16x32_bf16 v[16:19], a[148:151], v[172:175], v[16:19]
v_cvt_pk_bf16_f32 v89, v42, v43
v_permlane32_swap_b32 v249, v250
v_mfma_f32_16x16x32_bf16 v[16:19], a[144:147], v[168:171], v[16:19]
v_exp_f32 v44, v44
v_mfma_f32_16x16x32_bf16 v[24:27], a[144:147], v[184:187], v[144:147]
v_cmp_ne_u32 vcc, 0x20202020, v253
s_cbranch_vccnz SP_FL
SP_FL_RET:
v_mfma_f32_16x16x32_bf16 v[24:27], a[148:151], v[188:191], v[24:27]
v_exp_f32 v45, v45
v_mfma_f32_16x16x32_bf16 v[24:27], a[152:155], v[192:195], v[24:27]
v_cvt_pk_bf16_f32 v90, v44, v45
v_mov_b32 v246, s101
v_mfma_f32_16x16x32_bf16 v[24:27], a[156:159], v[196:199], v[24:27]
v_exp_f32 v46, v46
v_mfma_f32_16x16x32_bf16 v[32:35], a[156:159], v[212:215], v[148:151]
ds_read_b128 a[156:159], v219 offset:57344
s_add_u32 m0, s30, 98304
v_mfma_f32_16x16x32_bf16 v[32:35], a[152:155], v[208:211], v[32:35]
v_max_u32 v249, v249, v250
v_exp_f32 v47, v47
v_mfma_f32_16x16x32_bf16 v[32:35], a[148:151], v[204:207], v[32:35]
ds_read_b128 a[152:155], v218 offset:57344
v_cvt_pk_bf16_f32 v91, v46, v47
v_mfma_f32_16x16x32_bf16 v[32:35], a[144:147], v[200:203], v[32:35]
v_exp_f32 v48, v48
v_mfma_f32_16x16x32_bf16 a[0:3], v[72:75], a[176:179], a[0:3]
ds_read_b128 a[148:151], v217 offset:57344
ds_read_b128 a[144:147], v216 offset:57344
v_mfma_f32_16x16x32_bf16 a[16:19], v[72:75], a[180:183], a[16:19]
v_add_u32 v251, v251, v249
v_exp_f32 v49, v49
v_mfma_f32_16x16x32_bf16 a[20:23], v[76:79], a[180:183], a[20:23]
v_cvt_pk_bf16_f32 v92, v48, v49
v_mov_b32 v247, s47
v_mfma_f32_16x16x32_bf16 a[4:7], v[76:79], a[176:179], a[4:7]
v_exp_f32 v50, v50
v_mfma_f32_16x16x32_bf16 a[8:11], v[80:83], a[176:179], a[8:11]
v_mov_b32 v253, 0
v_sub_u32 v248, v248, v249
v_mfma_f32_16x16x32_bf16 a[24:27], v[80:83], a[180:183], a[24:27]
v_exp_f32 v51, v51
v_mfma_f32_16x16x32_bf16 a[28:31], v[84:87], a[180:183], a[28:31]
ds_read_b64_tr_b16 a[180:181], v221 offset:40960
v_cvt_pk_bf16_f32 v93, v50, v51
v_mfma_f32_16x16x32_bf16 a[12:15], v[84:87], a[176:179], a[12:15]
v_exp_f32 v52, v52
v_mfma_f32_16x16x32_bf16 a[44:47], v[84:87], a[184:187], a[44:47]
ds_read_b64_tr_b16 a[182:183], v221 offset:45056
ds_read_b64_tr_b16 a[176:177], v220 offset:40960
v_mfma_f32_16x16x32_bf16 a[60:63], v[84:87], a[188:191], a[60:63]
v_exp_f32 v53, v53
v_mfma_f32_16x16x32_bf16 a[56:59], v[80:83], a[188:191], a[56:59]
ds_read_b64_tr_b16 a[178:179], v220 offset:45056
v_cvt_pk_bf16_f32 v94, v52, v53
v_mfma_f32_16x16x32_bf16 a[40:43], v[80:83], a[184:187], a[40:43]
v_cndmask_b32 v252, v252, v251, s[90:91]
v_exp_f32 v54, v54
v_mfma_f32_16x16x32_bf16 a[36:39], v[76:79], a[184:187], a[36:39]
buffer_load_dwordx4 v232, s[12:15], s39 offen offset:0  lds
v_mfma_f32_16x16x32_bf16 a[52:55], v[76:79], a[188:191], a[52:55]
v_exp_f32 v55, v55
v_mfma_f32_16x16x32_bf16 a[48:51], v[72:75], a[188:191], a[48:51]
ds_read_b64_tr_b16 a[188:189], v223 offset:40960
v_cvt_pk_bf16_f32 v95, v54, v55
v_mfma_f32_16x16x32_bf16 a[32:35], v[72:75], a[184:187], a[32:35]
v_readfirstlane_b32 s82, v251
v_exp_f32 v56, v56
v_smfmac_f32_16x16x64_bf16 a[128:131], a[208:211], v[72:79], v245
ds_read_b64_tr_b16 a[190:191], v223 offset:45056
v_mfma_f32_16x16x32_bf16 v[12:15], a[160:163], v[152:155], v[136:139]
v_exp_f32 v57, v57
v_mfma_f32_16x16x32_bf16 v[12:15], a[164:167], v[156:159], v[12:15]
v_exp_f32 v58, v58
v_mfma_f32_16x16x32_bf16 v[12:15], a[168:171], v[160:163], v[12:15]
ds_read_b64_tr_b16 a[184:185], v222 offset:40960
v_cvt_pk_bf16_f32 v96, v56, v57
v_mfma_f32_16x16x32_bf16 v[12:15], a[172:175], v[164:167], v[12:15]
s_lshl_b64 s[90:91], s[90:91], 1
v_exp_f32 v59, v59
v_mfma_f32_16x16x32_bf16 v[20:23], a[172:175], v[180:183], v[140:143]
ds_read_b64_tr_b16 a[186:187], v222 offset:45056
v_cvt_pk_bf16_f32 v97, v58, v59
v_mfma_f32_16x16x32_bf16 v[20:23], a[168:171], v[176:179], v[20:23]
s_add_u32 s29, s2, s37
v_exp_f32 v60, v60
v_mfma_f32_16x16x32_bf16 v[20:23], a[164:167], v[172:175], v[20:23]
buffer_load_dwordx4 v233, s[12:15], s39 offen offset:1024  lds
v_mfma_f32_16x16x32_bf16 v[20:23], a[160:163], v[168:171], v[20:23]
v_max_u32_dpp v250, v248, v248 row_ror:8 row_mask:0xf bank_mask:0xf
v_exp_f32 v61, v61
v_mfma_f32_16x16x32_bf16 v[28:31], a[160:163], v[184:187], v[144:147]
v_cvt_pk_bf16_f32 v98, v60, v61
v_mfma_f32_16x16x32_bf16 v[28:31], a[164:167], v[188:191], v[28:31]
v_exp_f32 v62, v62
v_mfma_f32_16x16x32_bf16 v[28:31], a[168:171], v[192:195], v[28:31]
buffer_load_dwordx4 v232, s[12:15], s39 offen offset:2048  lds
v_mfma_f32_16x16x32_bf16 v[28:31], a[172:175], v[196:199], v[28:31]
v_exp_f32 v63, v63
v_mfma_f32_16x16x32_bf16 v[36:39], a[172:175], v[212:215], v[148:151]
ds_read_b128 a[172:175], v219 offset:61440
v_cvt_pk_bf16_f32 v99, v62, v63
v_max_u32_dpp v249, v250, v250 row_ror:4 row_mask:0xf bank_mask:0xf
v_mfma_f32_16x16x32_bf16 v[36:39], a[168:171], v[208:211], v[36:39]
v_exp_f32 v64, v64
v_mfma_f32_16x16x32_bf16 v[36:39], a[164:167], v[204:207], v[36:39]
ds_read_b128 a[168:171], v218 offset:61440
ds_read_b128 a[164:167], v217 offset:61440
v_mfma_f32_16x16x32_bf16 v[36:39], a[160:163], v[200:203], v[36:39]
v_exp_f32 v65, v65
s_waitcnt lgkmcnt(8)
v_mfma_f32_16x16x32_bf16 a[64:67], v[72:75], a[192:195], a[64:67]
ds_read_b128 a[160:163], v216 offset:61440
v_cvt_pk_bf16_f32 v100, v64, v65
v_max_u32_dpp v250, v249, v249 row_ror:2 row_mask:0xf bank_mask:0xf
v_mfma_f32_16x16x32_bf16 a[80:83], v[72:75], a[196:199], a[80:83]
v_exp_f32 v66, v66
v_mfma_f32_16x16x32_bf16 a[84:87], v[76:79], a[196:199], a[84:87]
buffer_load_dwordx4 v233, s[12:15], s39 offen offset:3072  lds
v_mfma_f32_16x16x32_bf16 a[68:71], v[76:79], a[192:195], a[68:71]
v_exp_f32 v67, v67
v_mfma_f32_16x16x32_bf16 a[72:75], v[80:83], a[192:195], a[72:75]
s_cmp_eq_u32 s29, 0
s_cselect_b32 s29, 0x24c000, -16
v_cvt_pk_bf16_f32 v101, v66, v67
v_mfma_f32_16x16x32_bf16 a[88:91], v[80:83], a[196:199], a[88:91]
v_max_u32_dpp v249, v250, v250 row_ror:1 row_mask:0xf bank_mask:0xf
v_exp_f32 v68, v68
v_mfma_f32_16x16x32_bf16 a[92:95], v[84:87], a[196:199], a[92:95]
ds_read_b64_tr_b16 a[196:197], v225 offset:40960
ds_read_b64_tr_b16 a[198:199], v225 offset:45056
v_mfma_f32_16x16x32_bf16 a[76:79], v[84:87], a[192:195], a[76:79]
v_exp_f32 v69, v69
v_mfma_f32_16x16x32_bf16 a[108:111], v[84:87], a[200:203], a[108:111]
ds_read_b64_tr_b16 a[192:193], v224 offset:40960
v_cvt_pk_bf16_f32 v102, v68, v69
v_mfma_f32_16x16x32_bf16 a[124:127], v[84:87], a[204:207], a[124:127]
v_mov_b32 v250, v249
v_exp_f32 v70, v70
v_mfma_f32_16x16x32_bf16 a[120:123], v[80:83], a[204:207], a[120:123]
ds_read_b64_tr_b16 a[194:195], v224 offset:45056
buffer_store_dwordx2 v[246:247], v253, s[20:23], s29 offen
v_mfma_f32_16x16x32_bf16 a[104:107], v[80:83], a[200:203], a[104:107]
v_exp_f32 v71, v71
v_mfma_f32_16x16x32_bf16 a[100:103], v[76:79], a[200:203], a[100:103]
v_cvt_pk_bf16_f32 v103, v70, v71
v_permlane16_swap_b32 v249, v250
STUB_7:
s_cbranch_execz HOP_RET1
v_mfma_f32_16x16x32_bf16 a[116:119], v[76:79], a[204:207], a[116:119]
v_max_u32 v249, v249, v250
v_mov_b32 v250, v249
v_mfma_f32_16x16x32_bf16 a[112:115], v[72:75], a[204:207], a[112:115]
ds_read_b64_tr_b16 a[204:205], v227 offset:40960
ds_read_b64_tr_b16 a[206:207], v227 offset:45056
v_mfma_f32_16x16x32_bf16 a[96:99], v[72:75], a[200:203], a[96:99]
ds_read_b64_tr_b16 a[200:201], v226 offset:40960
ds_read_b64_tr_b16 a[202:203], v226 offset:45056
v_smfmac_f32_16x16x64_bf16 a[132:135], a[208:211], v[80:87], v245
v_permlane32_swap_b32 v249, v250
v_mfma_f32_16x16x32_bf16 v[40:43], a[144:147], v[152:155], v[136:139]
v_exp_f32 v8, v8
v_mfma_f32_16x16x32_bf16 v[40:43], a[148:151], v[156:159], v[40:43]
v_exp_f32 v9, v9
v_mfma_f32_16x16x32_bf16 v[40:43], a[152:155], v[160:163], v[40:43]
v_cvt_pk_bf16_f32 v72, v8, v9
v_max_u32 v249, v249, v250
v_mfma_f32_16x16x32_bf16 v[40:43], a[156:159], v[164:167], v[40:43]
v_exp_f32 v10, v10
v_mfma_f32_16x16x32_bf16 v[48:51], a[156:159], v[180:183], v[140:143]
v_add_u32 v251, v251, v249
v_cndmask_b32 v252, v252, v251, s[90:91]
v_mfma_f32_16x16x32_bf16 v[48:51], a[152:155], v[176:179], v[48:51]
v_exp_f32 v11, v11
v_mfma_f32_16x16x32_bf16 v[48:51], a[148:151], v[172:175], v[48:51]
v_cvt_pk_bf16_f32 v73, v10, v11
v_readfirstlane_b32 s83, v251
v_mfma_f32_16x16x32_bf16 v[48:51], a[144:147], v[168:171], v[48:51]
v_exp_f32 v12, v12
v_mfma_f32_16x16x32_bf16 v[56:59], a[144:147], v[184:187], v[144:147]
v_mov_b32 v236, v252
v_mfma_f32_16x16x32_bf16 v[56:59], a[148:151], v[188:191], v[56:59]
v_exp_f32 v13, v13
v_mfma_f32_16x16x32_bf16 v[56:59], a[152:155], v[192:195], v[56:59]
v_cvt_pk_bf16_f32 v74, v12, v13
v_and_b32 v252, 0xffff, v252
v_mfma_f32_16x16x32_bf16 v[56:59], a[156:159], v[196:199], v[56:59]
v_exp_f32 v14, v14
v_mfma_f32_16x16x32_bf16 v[64:67], a[156:159], v[212:215], v[148:151]
s_waitcnt vmcnt(9) lgkmcnt(0)
s_barrier
v_mfma_f32_16x16x32_bf16 v[64:67], a[152:155], v[208:211], v[64:67]
v_exp_f32 v15, v15
v_mfma_f32_16x16x32_bf16 v[64:67], a[148:151], v[204:207], v[64:67]
ds_read_b128 a[156:159], v219 offset:0
v_cvt_pk_bf16_f32 v75, v14, v15
v_mfma_f32_16x16x32_bf16 v[64:67], a[144:147], v[200:203], v[64:67]
v_exp_f32 v16, v16
v_mfma_f32_16x16x32_bf16 a[0:3], v[88:91], a[176:179], a[0:3]
ds_read_b128 a[152:155], v218 offset:0
ds_read_b128 a[148:151], v217 offset:0
v_mfma_f32_16x16x32_bf16 a[16:19], v[88:91], a[180:183], a[16:19]
v_exp_f32 v17, v17
v_mfma_f32_16x16x32_bf16 a[20:23], v[92:95], a[180:183], a[20:23]
ds_read_b128 a[144:147], v216 offset:0
v_cvt_pk_bf16_f32 v76, v16, v17
v_mfma_f32_16x16x32_bf16 a[4:7], v[92:95], a[176:179], a[4:7]
v_exp_f32 v18, v18
v_mfma_f32_16x16x32_bf16 a[8:11], v[96:99], a[176:179], a[8:11]
s_add_u32 s32, s32, 16384
s_add_u32 m0, s30, 114688
v_mfma_f32_16x16x32_bf16 a[24:27], v[96:99], a[180:183], a[24:27]
v_exp_f32 v19, v19
v_mfma_f32_16x16x32_bf16 a[28:31], v[100:103], a[180:183], a[28:31]
ds_read_b64_tr_b16 a[180:181], v221 offset:49152
v_cvt_pk_bf16_f32 v77, v18, v19
v_mfma_f32_16x16x32_bf16 a[12:15], v[100:103], a[176:179], a[12:15]
v_exp_f32 v20, v20
v_mfma_f32_16x16x32_bf16 a[44:47], v[100:103], a[184:187], a[44:47]
ds_read_b64_tr_b16 a[182:183], v221 offset:53248
ds_read_b64_tr_b16 a[176:177], v220 offset:49152
v_mfma_f32_16x16x32_bf16 a[60:63], v[100:103], a[188:191], a[60:63]
v_exp_f32 v21, v21
v_mfma_f32_16x16x32_bf16 a[56:59], v[96:99], a[188:191], a[56:59]
ds_read_b64_tr_b16 a[178:179], v220 offset:53248
v_cvt_pk_bf16_f32 v78, v20, v21
v_mfma_f32_16x16x32_bf16 a[40:43], v[96:99], a[184:187], a[40:43]
v_exp_f32 v22, v22
v_mfma_f32_16x16x32_bf16 a[36:39], v[92:95], a[184:187], a[36:39]
buffer_load_dwordx4 v228, s[8:11], s32 offen offset:0  lds
v_mfma_f32_16x16x32_bf16 a[52:55], v[92:95], a[188:191], a[52:55]
v_exp_f32 v23, v23
v_mfma_f32_16x16x32_bf16 a[48:51], v[88:91], a[188:191], a[48:51]
ds_read_b64_tr_b16 a[188:189], v223 offset:49152
v_cvt_pk_bf16_f32 v79, v22, v23
v_mfma_f32_16x16x32_bf16 a[32:35], v[88:91], a[184:187], a[32:35]
v_exp_f32 v24, v24
v_smfmac_f32_16x16x64_bf16 a[128:131], a[208:211], v[88:95], v245
ds_read_b64_tr_b16 a[190:191], v223 offset:53248
v_mfma_f32_16x16x32_bf16 v[44:47], a[160:163], v[152:155], v[136:139]
v_exp_f32 v25, v25
v_mfma_f32_16x16x32_bf16 v[44:47], a[164:167], v[156:159], v[44:47]
v_exp_f32 v26, v26
v_mfma_f32_16x16x32_bf16 v[44:47], a[168:171], v[160:163], v[44:47]
ds_read_b64_tr_b16 a[184:185], v222 offset:49152
v_cvt_pk_bf16_f32 v80, v24, v25
v_mfma_f32_16x16x32_bf16 v[44:47], a[172:175], v[164:167], v[44:47]
v_exp_f32 v27, v27
v_mfma_f32_16x16x32_bf16 v[52:55], a[172:175], v[180:183], v[140:143]
ds_read_b64_tr_b16 a[186:187], v222 offset:53248
v_cvt_pk_bf16_f32 v81, v26, v27
v_mfma_f32_16x16x32_bf16 v[52:55], a[168:171], v[176:179], v[52:55]
v_exp_f32 v28, v28
v_mfma_f32_16x16x32_bf16 v[52:55], a[164:167], v[172:175], v[52:55]
buffer_load_dwordx4 v229, s[8:11], s32 offen offset:1024  lds
v_mfma_f32_16x16x32_bf16 v[52:55], a[160:163], v[168:171], v[52:55]
v_exp_f32 v29, v29
v_mfma_f32_16x16x32_bf16 v[60:63], a[160:163], v[184:187], v[144:147]
v_cvt_pk_bf16_f32 v82, v28, v29
v_sub_u32 v252, 0xffff, v252
v_mfma_f32_16x16x32_bf16 v[60:63], a[164:167], v[188:191], v[60:63]
v_exp_f32 v30, v30
v_mfma_f32_16x16x32_bf16 v[60:63], a[168:171], v[192:195], v[60:63]
buffer_load_dwordx4 v230, s[8:11], s32 offen offset:2048  lds
v_mfma_f32_16x16x32_bf16 v[60:63], a[172:175], v[196:199], v[60:63]
v_exp_f32 v31, v31
v_mfma_f32_16x16x32_bf16 v[68:71], a[172:175], v[212:215], v[148:151]
ds_read_b128 a[172:175], v219 offset:4096
v_cvt_pk_bf16_f32 v83, v30, v31
v_mfma_f32_16x16x32_bf16 v[68:71], a[168:171], v[208:211], v[68:71]
v_exp_f32 v32, v32
v_mfma_f32_16x16x32_bf16 v[68:71], a[164:167], v[204:207], v[68:71]
ds_read_b128 a[168:171], v218 offset:4096
ds_read_b128 a[164:167], v217 offset:4096
v_mul_u32_u24 v252, 0x480, v252
v_mfma_f32_16x16x32_bf16 v[68:71], a[160:163], v[200:203], v[68:71]
v_exp_f32 v33, v33
v_mfma_f32_16x16x32_bf16 a[64:67], v[88:91], a[192:195], a[64:67]
ds_read_b128 a[160:163], v216 offset:4096
v_cvt_pk_bf16_f32 v84, v32, v33
v_mfma_f32_16x16x32_bf16 a[80:83], v[88:91], a[196:199], a[80:83]
v_exp_f32 v34, v34
v_mfma_f32_16x16x32_bf16 a[84:87], v[92:95], a[196:199], a[84:87]
buffer_load_dwordx4 v231, s[8:11], s32 offen offset:3072  lds
v_lshrrev_b32 v249, 3, v0
v_mfma_f32_16x16x32_bf16 a[68:71], v[92:95], a[192:195], a[68:71]
v_exp_f32 v35, v35
v_mfma_f32_16x16x32_bf16 a[72:75], v[96:99], a[192:195], a[72:75]
v_cvt_pk_bf16_f32 v85, v34, v35
v_lshl_add_u32 v252, v249, 4, v252
v_mfma_f32_16x16x32_bf16 a[88:91], v[96:99], a[196:199], a[88:91]
v_exp_f32 v36, v36
v_mfma_f32_16x16x32_bf16 a[92:95], v[100:103], a[196:199], a[92:95]
ds_read_b64_tr_b16 a[196:197], v225 offset:49152
ds_read_b64_tr_b16 a[198:199], v225 offset:53248
v_mfma_f32_16x16x32_bf16 a[76:79], v[100:103], a[192:195], a[76:79]
v_exp_f32 v37, v37
v_mfma_f32_16x16x32_bf16 a[108:111], v[100:103], a[200:203], a[108:111]
ds_read_b64_tr_b16 a[192:193], v224 offset:49152
v_cvt_pk_bf16_f32 v86, v36, v37
v_mfma_f32_16x16x32_bf16 a[124:127], v[100:103], a[204:207], a[124:127]
v_exp_f32 v38, v38
v_mfma_f32_16x16x32_bf16 a[120:123], v[96:99], a[204:207], a[120:123]
ds_read_b64_tr_b16 a[194:195], v224 offset:53248
v_mfma_f32_16x16x32_bf16 a[104:107], v[96:99], a[200:203], a[104:107]
v_exp_f32 v39, v39
v_mfma_f32_16x16x32_bf16 a[100:103], v[92:95], a[200:203], a[100:103]
v_cvt_pk_bf16_f32 v87, v38, v39
v_mfma_f32_16x16x32_bf16 a[116:119], v[92:95], a[204:207], a[116:119]
s_add_u32 m0, s86, 0
s_add_u32 s50, s84, 4718592
buffer_load_dwordx4 v240, s[64:67], s50 offen lds
v_mfma_f32_16x16x32_bf16 a[112:115], v[88:91], a[204:207], a[112:115]
ds_read_b64_tr_b16 a[204:205], v227 offset:49152
ds_read_b64_tr_b16 a[206:207], v227 offset:53248
v_mfma_f32_16x16x32_bf16 a[96:99], v[88:91], a[200:203], a[96:99]
ds_read_b64_tr_b16 a[200:201], v226 offset:49152
ds_read_b64_tr_b16 a[202:203], v226 offset:53248
v_smfmac_f32_16x16x64_bf16 a[132:135], a[208:211], v[96:103], v245
s_add_u32 m0, s86, 4096
s_add_u32 s50, s84, 4718592
buffer_load_dwordx4 v240, s[68:71], s50 offen lds
s_add_u32 m0, s86, 8192
s_add_u32 s50, s85, 0
buffer_load_dwordx4 v244, s[72:75], s50 offen lds
s_add_u32 m0, s86, 12288
s_add_u32 s50, s85, 4096
buffer_load_dwordx4 v244, s[72:75], s50 offen lds
s_waitcnt lgkmcnt(8)
v_mfma_f32_16x16x32_bf16 v[8:11], a[144:147], v[152:155], v[136:139]
v_exp_f32 v40, v40
v_mfma_f32_16x16x32_bf16 v[8:11], a[148:151], v[156:159], v[8:11]
v_ashrrev_i32 v246, 31, v236
v_exp_f32 v41, v41
v_mfma_f32_16x16x32_bf16 v[8:11], a[152:155], v[160:163], v[8:11]
v_cvt_pk_bf16_f32 v88, v40, v41
v_not_b32 v246, v246
v_mfma_f32_16x16x32_bf16 v[8:11], a[156:159], v[164:167], v[8:11]
v_exp_f32 v42, v42
v_mfma_f32_16x16x32_bf16 v[16:19], a[156:159], v[180:183], v[140:143]
s_add_u32 s39, s39, 16384
v_or_b32 v246, 0x80000000, v246
v_mfma_f32_16x16x32_bf16 v[16:19], a[152:155], v[176:179], v[16:19]
v_exp_f32 v43, v43
v_mfma_f32_16x16x32_bf16 v[16:19], a[148:151], v[172:175], v[16:19]
v_cvt_pk_bf16_f32 v89, v42, v43
v_xor_b32 v236, v236, v246
v_mfma_f32_16x16x32_bf16 v[16:19], a[144:147], v[168:171], v[16:19]
v_exp_f32 v44, v44
v_mfma_f32_16x16x32_bf16 v[24:27], a[144:147], v[184:187], v[144:147]
s_add_u32 m0, s30, 131072
v_and_b32 v236, 0xffff0000, v236
v_mfma_f32_16x16x32_bf16 v[24:27], a[148:151], v[188:191], v[24:27]
v_exp_f32 v45, v45
v_mfma_f32_16x16x32_bf16 v[24:27], a[152:155], v[192:195], v[24:27]
v_cvt_pk_bf16_f32 v90, v44, v45
v_mul_f32 v236, 0xbfb8aa3b, v236
v_mfma_f32_16x16x32_bf16 v[24:27], a[156:159], v[196:199], v[24:27]
v_exp_f32 v46, v46
v_mfma_f32_16x16x32_bf16 v[32:35], a[156:159], v[212:215], v[148:151]
ds_read_b128 a[156:159], v219 offset:8192
v_mfma_f32_16x16x32_bf16 v[32:35], a[152:155], v[208:211], v[32:35]
v_exp_f32 v47, v47
v_mfma_f32_16x16x32_bf16 v[32:35], a[148:151], v[204:207], v[32:35]
ds_read_b128 a[152:155], v218 offset:8192
v_cvt_pk_bf16_f32 v91, v46, v47
v_mfma_f32_16x16x32_bf16 v[32:35], a[144:147], v[200:203], v[32:35]
v_exp_f32 v48, v48
v_mfma_f32_16x16x32_bf16 a[0:3], v[72:75], a[176:179], a[0:3]
ds_read_b128 a[148:151], v217 offset:8192
ds_read_b128 a[144:147], v216 offset:8192
v_mfma_f32_16x16x32_bf16 a[16:19], v[72:75], a[180:183], a[16:19]
v_exp_f32 v49, v49
v_mfma_f32_16x16x32_bf16 a[20:23], v[76:79], a[180:183], a[20:23]
v_cvt_pk_bf16_f32 v92, v48, v49
v_mfma_f32_16x16x32_bf16 a[4:7], v[76:79], a[176:179], a[4:7]
v_exp_f32 v50, v50
v_mfma_f32_16x16x32_bf16 a[8:11], v[80:83], a[176:179], a[8:11]
buffer_load_dwordx4 v232, s[12:15], s39 offen offset:0  lds
v_mfma_f32_16x16x32_bf16 a[24:27], v[80:83], a[180:183], a[24:27]
v_exp_f32 v51, v51
v_mfma_f32_16x16x32_bf16 a[28:31], v[84:87], a[180:183], a[28:31]
ds_read_b64_tr_b16 a[180:181], v221 offset:57344
v_cvt_pk_bf16_f32 v93, v50, v51
v_mfma_f32_16x16x32_bf16 a[12:15], v[84:87], a[176:179], a[12:15]
v_exp_f32 v52, v52
v_mfma_f32_16x16x32_bf16 a[44:47], v[84:87], a[184:187], a[44:47]
ds_read_b64_tr_b16 a[182:183], v221 offset:61440
ds_read_b64_tr_b16 a[176:177], v220 offset:57344
v_mfma_f32_16x16x32_bf16 a[60:63], v[84:87], a[188:191], a[60:63]
v_exp_f32 v53, v53
v_mfma_f32_16x16x32_bf16 a[56:59], v[80:83], a[188:191], a[56:59]
ds_read_b64_tr_b16 a[178:179], v220 offset:61440
v_cvt_pk_bf16_f32 v94, v52, v53
v_mfma_f32_16x16x32_bf16 a[40:43], v[80:83], a[184:187], a[40:43]
v_exp_f32 v54, v54
v_mfma_f32_16x16x32_bf16 a[36:39], v[76:79], a[184:187], a[36:39]
buffer_load_dwordx4 v233, s[12:15], s39 offen offset:1024  lds
v_mfma_f32_16x16x32_bf16 a[52:55], v[76:79], a[188:191], a[52:55]
v_exp_f32 v55, v55
v_mfma_f32_16x16x32_bf16 a[48:51], v[72:75], a[188:191], a[48:51]
ds_read_b64_tr_b16 a[188:189], v223 offset:57344
v_cvt_pk_bf16_f32 v95, v54, v55
v_mfma_f32_16x16x32_bf16 a[32:35], v[72:75], a[184:187], a[32:35]
v_exp_f32 v56, v56
v_smfmac_f32_16x16x64_bf16 a[128:131], a[208:211], v[72:79], v245
ds_read_b64_tr_b16 a[190:191], v223 offset:61440
v_mfma_f32_16x16x32_bf16 v[12:15], a[160:163], v[152:155], v[136:139]
v_exp_f32 v57, v57
v_mfma_f32_16x16x32_bf16 v[12:15], a[164:167], v[156:159], v[12:15]
v_exp_f32 v58, v58
v_mfma_f32_16x16x32_bf16 v[12:15], a[168:171], v[160:163], v[12:15]
ds_read_b64_tr_b16 a[184:185], v222 offset:57344
v_cvt_pk_bf16_f32 v96, v56, v57
v_mfma_f32_16x16x32_bf16 v[12:15], a[172:175], v[164:167], v[12:15]
v_exp_f32 v59, v59
v_mfma_f32_16x16x32_bf16 v[20:23], a[172:175], v[180:183], v[140:143]
ds_read_b64_tr_b16 a[186:187], v222 offset:61440
v_cvt_pk_bf16_f32 v97, v58, v59
v_mfma_f32_16x16x32_bf16 v[20:23], a[168:171], v[176:179], v[20:23]
v_exp_f32 v60, v60
v_mfma_f32_16x16x32_bf16 v[20:23], a[164:167], v[172:175], v[20:23]
buffer_load_dwordx4 v232, s[12:15], s39 offen offset:2048  lds
v_mfma_f32_16x16x32_bf16 v[20:23], a[160:163], v[168:171], v[20:23]
v_exp_f32 v61, v61
v_mfma_f32_16x16x32_bf16 v[28:31], a[160:163], v[184:187], v[144:147]
v_cvt_pk_bf16_f32 v98, v60, v61
v_exp_f32 v236, v236
v_mfma_f32_16x16x32_bf16 v[28:31], a[164:167], v[188:191], v[28:31]
v_add_f32 v236, 1.0, v236
v_exp_f32 v62, v62
v_mfma_f32_16x16x32_bf16 v[28:31], a[168:171], v[192:195], v[28:31]
buffer_load_dwordx4 v233, s[12:15], s39 offen offset:3072  lds
v_mfma_f32_16x16x32_bf16 v[28:31], a[172:175], v[196:199], v[28:31]
v_exp_f32 v63, v63
v_mfma_f32_16x16x32_bf16 v[36:39], a[172:175], v[212:215], v[148:151]
ds_read_b128 a[172:175], v219 offset:12288
v_cvt_pk_bf16_f32 v99, v62, v63
v_mfma_f32_16x16x32_bf16 v[36:39], a[168:171], v[208:211], v[36:39]
v_exp_f32 v64, v64
v_mfma_f32_16x16x32_bf16 v[36:39], a[164:167], v[204:207], v[36:39]
ds_read_b128 a[168:171], v218 offset:12288
ds_read_b128 a[164:167], v217 offset:12288
v_mfma_f32_16x16x32_bf16 v[36:39], a[160:163], v[200:203], v[36:39]
v_exp_f32 v65, v65
s_waitcnt lgkmcnt(8)
v_mfma_f32_16x16x32_bf16 a[64:67], v[72:75], a[192:195], a[64:67]
ds_read_b128 a[160:163], v216 offset:12288
v_cvt_pk_bf16_f32 v100, v64, v65
v_mfma_f32_16x16x32_bf16 a[80:83], v[72:75], a[196:199], a[80:83]
v_exp_f32 v66, v66
v_mfma_f32_16x16x32_bf16 a[84:87], v[76:79], a[196:199], a[84:87]
s_add_u32 m0, s86, 45056
s_mov_b32 s50, 29360128
buffer_load_dwordx4 v252, s[20:23], s50 offen sc0 sc1 lds
v_mfma_f32_16x16x32_bf16 a[68:71], v[76:79], a[192:195], a[68:71]
v_exp_f32 v67, v67
v_mfma_f32_16x16x32_bf16 a[72:75], v[80:83], a[192:195], a[72:75]
v_cvt_pk_bf16_f32 v101, v66, v67
v_rcp_f32 v236, v236
v_mfma_f32_16x16x32_bf16 a[88:91], v[80:83], a[196:199], a[88:91]
v_cvt_pk_bf16_f32 v236, v236, v236
v_exp_f32 v68, v68
v_mfma_f32_16x16x32_bf16 a[92:95], v[84:87], a[196:199], a[92:95]
ds_read_b64_tr_b16 a[196:197], v225 offset:57344
ds_read_b64_tr_b16 a[198:199], v225 offset:61440
v_mfma_f32_16x16x32_bf16 a[76:79], v[84:87], a[192:195], a[76:79]
v_lshlrev_b32 v236, 16, v236
v_exp_f32 v69, v69
v_mfma_f32_16x16x32_bf16 a[108:111], v[84:87], a[200:203], a[108:111]
ds_read_b64_tr_b16 a[192:193], v224 offset:57344
v_cvt_pk_bf16_f32 v102, v68, v69
v_mfma_f32_16x16x32_bf16 a[124:127], v[84:87], a[204:207], a[124:127]
v_exp_f32 v70, v70
v_mfma_f32_16x16x32_bf16 a[120:123], v[80:83], a[204:207], a[120:123]
ds_read_b64_tr_b16 a[194:195], v224 offset:61440
v_mfma_f32_16x16x32_bf16 a[104:107], v[80:83], a[200:203], a[104:107]
v_exp_f32 v71, v71
v_mfma_f32_16x16x32_bf16 a[100:103], v[76:79], a[200:203], a[100:103]
v_cvt_pk_bf16_f32 v103, v70, v71
v_mfma_f32_16x16x32_bf16 a[116:119], v[76:79], a[204:207], a[116:119]
s_add_u32 m0, s86, 49152
s_mov_b32 s50, 29360640
buffer_load_dwordx4 v252, s[20:23], s50 offen sc0 sc1 lds
v_mfma_f32_16x16x32_bf16 a[112:115], v[72:75], a[204:207], a[112:115]
ds_read_b64_tr_b16 a[204:205], v227 offset:57344
ds_read_b64_tr_b16 a[206:207], v227 offset:61440
v_mfma_f32_16x16x32_bf16 a[96:99], v[72:75], a[200:203], a[96:99]
ds_read_b64_tr_b16 a[200:201], v226 offset:57344
ds_read_b64_tr_b16 a[202:203], v226 offset:61440
v_smfmac_f32_16x16x64_bf16 a[132:135], a[208:211], v[80:87], v245
s_add_u32 m0, s86, 53248
s_mov_b32 s50, 29361152
buffer_load_dwordx4 v252, s[20:23], s50 offen sc0 sc1 lds
s_add_u32 m0, s86, 16384
s_add_u32 s50, s85, 8192
buffer_load_dwordx4 v244, s[72:75], s50 offen lds
s_mov_b32 s33, 7
s_cmp_lt_u32 s86, 0x10000
s_cbranch_scc0 K_LOOPIN
v_mfma_f32_16x16x32_bf16 v[40:43], a[144:147], v[152:155], v[136:139]
v_exp_f32 v8, v8
v_mfma_f32_16x16x32_bf16 v[40:43], a[148:151], v[156:159], v[40:43]
v_exp_f32 v9, v9
v_mfma_f32_16x16x32_bf16 v[40:43], a[152:155], v[160:163], v[40:43]
s_lshr_b32 s28, s37, 1
v_cvt_pk_bf16_f32 v72, v8, v9
v_mfma_f32_16x16x32_bf16 v[40:43], a[156:159], v[164:167], v[40:43]
v_exp_f32 v10, v10
v_mfma_f32_16x16x32_bf16 v[48:51], a[156:159], v[180:183], v[140:143]
s_mul_i32 s28, s28, 28672
v_mfma_f32_16x16x32_bf16 v[48:51], a[152:155], v[176:179], v[48:51]
v_exp_f32 v11, v11
v_mfma_f32_16x16x32_bf16 v[48:51], a[148:151], v[172:175], v[48:51]
v_cvt_pk_bf16_f32 v73, v10, v11
v_subrev_u32 v241, s28, v241
v_mfma_f32_16x16x32_bf16 v[48:51], a[144:147], v[168:171], v[48:51]
v_exp_f32 v12, v12
v_mfma_f32_16x16x32_bf16 v[56:59], a[144:147], v[184:187], v[144:147]
v_and_b32 v239, 7, v1
v_lshl_add_u32 v239, v4, 3, v239
v_mfma_f32_16x16x32_bf16 v[56:59], a[148:151], v[188:191], v[56:59]
v_exp_f32 v13, v13
v_mfma_f32_16x16x32_bf16 v[56:59], a[152:155], v[192:195], v[56:59]
v_cvt_pk_bf16_f32 v74, v12, v13
v_lshlrev_b32 v239, 4, v239
v_mfma_f32_16x16x32_bf16 v[56:59], a[156:159], v[196:199], v[56:59]
v_exp_f32 v14, v14
v_mfma_f32_16x16x32_bf16 v[64:67], a[156:159], v[212:215], v[148:151]
s_waitcnt vmcnt(16) lgkmcnt(0)
s_barrier
v_mfma_f32_16x16x32_bf16 v[64:67], a[152:155], v[208:211], v[64:67]
v_exp_f32 v15, v15
v_mfma_f32_16x16x32_bf16 v[64:67], a[148:151], v[204:207], v[64:67]
ds_read_b128 a[156:159], v219 offset:16384
v_cvt_pk_bf16_f32 v75, v14, v15
v_mfma_f32_16x16x32_bf16 v[64:67], a[144:147], v[200:203], v[64:67]
v_exp_f32 v16, v16
v_mfma_f32_16x16x32_bf16 a[0:3], v[88:91], a[176:179], a[0:3]
ds_read_b128 a[152:155], v218 offset:16384
ds_read_b128 a[148:151], v217 offset:16384
v_mfma_f32_16x16x32_bf16 a[16:19], v[88:91], a[180:183], a[16:19]
v_exp_f32 v17, v17
v_mfma_f32_16x16x32_bf16 a[20:23], v[92:95], a[180:183], a[20:23]
ds_read_b128 a[144:147], v216 offset:16384
v_cvt_pk_bf16_f32 v76, v16, v17
v_mfma_f32_16x16x32_bf16 a[4:7], v[92:95], a[176:179], a[4:7]
v_exp_f32 v18, v18
v_mfma_f32_16x16x32_bf16 a[8:11], v[96:99], a[176:179], a[8:11]
s_add_u32 s32, s32, 16384
s_add_u32 m0, s30, 65536
v_mfma_f32_16x16x32_bf16 a[24:27], v[96:99], a[180:183], a[24:27]
v_exp_f32 v19, v19
v_mfma_f32_16x16x32_bf16 a[28:31], v[100:103], a[180:183], a[28:31]
ds_read_b64_tr_b16 a[180:181], v221 offset:0
v_cvt_pk_bf16_f32 v77, v18, v19
v_mfma_f32_16x16x32_bf16 a[12:15], v[100:103], a[176:179], a[12:15]
v_exp_f32 v20, v20
v_mfma_f32_16x16x32_bf16 a[44:47], v[100:103], a[184:187], a[44:47]
ds_read_b64_tr_b16 a[182:183], v221 offset:4096
ds_read_b64_tr_b16 a[176:177], v220 offset:0
v_mfma_f32_16x16x32_bf16 a[60:63], v[100:103], a[188:191], a[60:63]
v_exp_f32 v21, v21
v_mfma_f32_16x16x32_bf16 a[56:59], v[96:99], a[188:191], a[56:59]
ds_read_b64_tr_b16 a[178:179], v220 offset:4096
v_cvt_pk_bf16_f32 v78, v20, v21
v_mfma_f32_16x16x32_bf16 a[40:43], v[96:99], a[184:187], a[40:43]
v_exp_f32 v22, v22
v_mfma_f32_16x16x32_bf16 a[36:39], v[92:95], a[184:187], a[36:39]
buffer_load_dwordx4 v228, s[8:11], s32 offen offset:0  lds
v_mfma_f32_16x16x32_bf16 a[52:55], v[92:95], a[188:191], a[52:55]
v_exp_f32 v23, v23
v_mfma_f32_16x16x32_bf16 a[48:51], v[88:91], a[188:191], a[48:51]
ds_read_b64_tr_b16 a[188:189], v223 offset:0
v_cvt_pk_bf16_f32 v79, v22, v23
v_mfma_f32_16x16x32_bf16 a[32:35], v[88:91], a[184:187], a[32:35]
v_exp_f32 v24, v24
v_smfmac_f32_16x16x64_bf16 a[128:131], a[208:211], v[88:95], v245
ds_read_b64_tr_b16 a[190:191], v223 offset:4096
v_mfma_f32_16x16x32_bf16 v[44:47], a[160:163], v[152:155], v[136:139]
v_exp_f32 v25, v25
v_mfma_f32_16x16x32_bf16 v[44:47], a[164:167], v[156:159], v[44:47]
v_exp_f32 v26, v26
v_mfma_f32_16x16x32_bf16 v[44:47], a[168:171], v[160:163], v[44:47]
ds_read_b64_tr_b16 a[184:185], v222 offset:0
v_cvt_pk_bf16_f32 v80, v24, v25
v_mfma_f32_16x16x32_bf16 v[44:47], a[172:175], v[164:167], v[44:47]
v_exp_f32 v27, v27
v_mfma_f32_16x16x32_bf16 v[52:55], a[172:175], v[180:183], v[140:143]
ds_read_b64_tr_b16 a[186:187], v222 offset:4096
v_cvt_pk_bf16_f32 v81, v26, v27
v_mfma_f32_16x16x32_bf16 v[52:55], a[168:171], v[176:179], v[52:55]
v_exp_f32 v28, v28
v_mfma_f32_16x16x32_bf16 v[52:55], a[164:167], v[172:175], v[52:55]
buffer_load_dwordx4 v229, s[8:11], s32 offen offset:1024  lds
v_mfma_f32_16x16x32_bf16 v[52:55], a[160:163], v[168:171], v[52:55]
v_exp_f32 v29, v29
v_mfma_f32_16x16x32_bf16 v[60:63], a[160:163], v[184:187], v[144:147]
v_cvt_pk_bf16_f32 v82, v28, v29
v_add_u32 v237, s31, v244
v_mfma_f32_16x16x32_bf16 v[60:63], a[164:167], v[188:191], v[60:63]
v_exp_f32 v30, v30
v_mfma_f32_16x16x32_bf16 v[60:63], a[168:171], v[192:195], v[60:63]
buffer_load_dwordx4 v230, s[8:11], s32 offen offset:2048  lds
v_mfma_f32_16x16x32_bf16 v[60:63], a[172:175], v[196:199], v[60:63]
v_exp_f32 v31, v31
v_mfma_f32_16x16x32_bf16 v[68:71], a[172:175], v[212:215], v[148:151]
ds_read_b128 a[172:175], v219 offset:20480
v_cvt_pk_bf16_f32 v83, v30, v31
v_mfma_f32_16x16x32_bf16 v[68:71], a[168:171], v[208:211], v[68:71]
v_exp_f32 v32, v32
v_mfma_f32_16x16x32_bf16 v[68:71], a[164:167], v[204:207], v[68:71]
ds_read_b128 a[168:171], v218 offset:20480
ds_read_b128 a[164:167], v217 offset:20480
v_mfma_f32_16x16x32_bf16 v[68:71], a[160:163], v[200:203], v[68:71]
v_exp_f32 v33, v33
v_mfma_f32_16x16x32_bf16 a[64:67], v[88:91], a[192:195], a[64:67]
ds_read_b128 a[160:163], v216 offset:20480
v_cvt_pk_bf16_f32 v84, v32, v33
v_mfma_f32_16x16x32_bf16 a[80:83], v[88:91], a[196:199], a[80:83]
v_exp_f32 v34, v34
v_mfma_f32_16x16x32_bf16 a[84:87], v[92:95], a[196:199], a[84:87]
buffer_load_dwordx4 v231, s[8:11], s32 offen offset:3072  lds
v_mfma_f32_16x16x32_bf16 a[68:71], v[92:95], a[192:195], a[68:71]
v_exp_f32 v35, v35
v_mfma_f32_16x16x32_bf16 a[72:75], v[96:99], a[192:195], a[72:75]
v_cvt_pk_bf16_f32 v85, v34, v35
v_lshl_add_u32 v238, v4, 3, v3
v_mfma_f32_16x16x32_bf16 a[88:91], v[96:99], a[196:199], a[88:91]
v_exp_f32 v36, v36
v_mfma_f32_16x16x32_bf16 a[92:95], v[100:103], a[196:199], a[92:95]
ds_read_b64_tr_b16 a[196:197], v225 offset:0
ds_read_b64_tr_b16 a[198:199], v225 offset:4096
v_mfma_f32_16x16x32_bf16 a[76:79], v[100:103], a[192:195], a[76:79]
v_exp_f32 v37, v37
v_mfma_f32_16x16x32_bf16 a[108:111], v[100:103], a[200:203], a[108:111]
ds_read_b64_tr_b16 a[192:193], v224 offset:0
v_cvt_pk_bf16_f32 v86, v36, v37
v_mfma_f32_16x16x32_bf16 a[124:127], v[100:103], a[204:207], a[124:127]
v_exp_f32 v38, v38
v_mfma_f32_16x16x32_bf16 a[120:123], v[96:99], a[204:207], a[120:123]
ds_read_b64_tr_b16 a[194:195], v224 offset:4096
v_lshlrev_b32 v238, 4, v238
v_mfma_f32_16x16x32_bf16 a[104:107], v[96:99], a[200:203], a[104:107]
v_exp_f32 v39, v39
v_mfma_f32_16x16x32_bf16 a[100:103], v[92:95], a[200:203], a[100:103]
v_cvt_pk_bf16_f32 v87, v38, v39
v_mov_b32 v246, 0x7ffffff0
v_mfma_f32_16x16x32_bf16 a[116:119], v[92:95], a[204:207], a[116:119]
s_add_u32 m0, s86, 20480
s_add_u32 s50, s85, 12288
buffer_load_dwordx4 v244, s[72:75], s50 offen lds
v_mfma_f32_16x16x32_bf16 a[112:115], v[88:91], a[204:207], a[112:115]
ds_read_b64_tr_b16 a[204:205], v227 offset:0
ds_read_b64_tr_b16 a[206:207], v227 offset:4096
v_mfma_f32_16x16x32_bf16 a[96:99], v[88:91], a[200:203], a[96:99]
ds_read_b64_tr_b16 a[200:201], v226 offset:0
ds_read_b64_tr_b16 a[202:203], v226 offset:4096
v_smfmac_f32_16x16x64_bf16 a[132:135], a[208:211], v[96:103], v245
s_add_u32 m0, s86, 24576
s_add_u32 s50, s85, 16384
buffer_load_dwordx4 v244, s[72:75], s50 offen lds
s_add_u32 m0, s86, 28672
s_add_u32 s50, s85, 20480
buffer_load_dwordx4 v244, s[72:75], s50 offen lds
s_waitcnt lgkmcnt(8)
v_mfma_f32_16x16x32_bf16 v[8:11], a[144:147], v[152:155], v[136:139]
v_exp_f32 v40, v40
v_mfma_f32_16x16x32_bf16 v[8:11], a[148:151], v[156:159], v[8:11]
v_exp_f32 v41, v41
v_mfma_f32_16x16x32_bf16 v[8:11], a[152:155], v[160:163], v[8:11]
v_cvt_pk_bf16_f32 v88, v40, v41
v_cmp_lt_u32 vcc, 7, v3
v_mfma_f32_16x16x32_bf16 v[8:11], a[156:159], v[164:167], v[8:11]
v_exp_f32 v42, v42
v_mfma_f32_16x16x32_bf16 v[16:19], a[156:159], v[180:183], v[140:143]
s_add_u32 s39, s39, 16384
v_cndmask_b32 v238, v238, v246, vcc
v_mfma_f32_16x16x32_bf16 v[16:19], a[152:155], v[176:179], v[16:19]
v_exp_f32 v43, v43
v_mfma_f32_16x16x32_bf16 v[16:19], a[148:151], v[172:175], v[16:19]
s_mul_i32 s28, s40, 18432
v_cvt_pk_bf16_f32 v89, v42, v43
v_mfma_f32_16x16x32_bf16 v[16:19], a[144:147], v[168:171], v[16:19]
v_exp_f32 v44, v44
v_mfma_f32_16x16x32_bf16 v[24:27], a[144:147], v[184:187], v[144:147]
s_mul_i32 s29, s37, 4608
s_add_u32 s28, s28, s29
v_mfma_f32_16x16x32_bf16 v[24:27], a[148:151], v[188:191], v[24:27]
v_exp_f32 v45, v45
v_mfma_f32_16x16x32_bf16 v[24:27], a[152:155], v[192:195], v[24:27]
s_add_u32 m0, s30, 147456
v_cvt_pk_bf16_f32 v90, v44, v45
v_mfma_f32_16x16x32_bf16 v[24:27], a[156:159], v[196:199], v[24:27]
v_exp_f32 v46, v46
v_mfma_f32_16x16x32_bf16 v[32:35], a[156:159], v[212:215], v[148:151]
ds_read_b128 a[156:159], v219 offset:24576
s_add_u32 s28, s28, 0x2000000
v_mfma_f32_16x16x32_bf16 v[32:35], a[152:155], v[208:211], v[32:35]
v_exp_f32 v47, v47
v_mfma_f32_16x16x32_bf16 v[32:35], a[148:151], v[204:207], v[32:35]
ds_read_b128 a[152:155], v218 offset:24576
v_cvt_pk_bf16_f32 v91, v46, v47
v_mfma_f32_16x16x32_bf16 v[32:35], a[144:147], v[200:203], v[32:35]
v_exp_f32 v48, v48
v_mfma_f32_16x16x32_bf16 a[0:3], v[72:75], a[176:179], a[0:3]
ds_read_b128 a[148:151], v217 offset:24576
ds_read_b128 a[144:147], v216 offset:24576
v_mfma_f32_16x16x32_bf16 a[16:19], v[72:75], a[180:183], a[16:19]
v_exp_f32 v49, v49
v_mfma_f32_16x16x32_bf16 a[20:23], v[76:79], a[180:183], a[20:23]
v_cvt_pk_bf16_f32 v92, v48, v49
v_mfma_f32_16x16x32_bf16 a[4:7], v[76:79], a[176:179], a[4:7]
v_exp_f32 v50, v50
v_mfma_f32_16x16x32_bf16 a[8:11], v[80:83], a[176:179], a[8:11]
buffer_load_dwordx4 v232, s[12:15], s39 offen offset:0  lds
v_mfma_f32_16x16x32_bf16 a[24:27], v[80:83], a[180:183], a[24:27]
v_exp_f32 v51, v51
v_mfma_f32_16x16x32_bf16 a[28:31], v[84:87], a[180:183], a[28:31]
ds_read_b64_tr_b16 a[180:181], v221 offset:8192
v_cvt_pk_bf16_f32 v93, v50, v51
v_mfma_f32_16x16x32_bf16 a[12:15], v[84:87], a[176:179], a[12:15]
v_exp_f32 v52, v52
v_mfma_f32_16x16x32_bf16 a[44:47], v[84:87], a[184:187], a[44:47]
ds_read_b64_tr_b16 a[182:183], v221 offset:12288
ds_read_b64_tr_b16 a[176:177], v220 offset:8192
v_mfma_f32_16x16x32_bf16 a[60:63], v[84:87], a[188:191], a[60:63]
v_exp_f32 v53, v53
v_mfma_f32_16x16x32_bf16 a[56:59], v[80:83], a[188:191], a[56:59]
ds_read_b64_tr_b16 a[178:179], v220 offset:12288
v_cvt_pk_bf16_f32 v94, v52, v53
v_mfma_f32_16x16x32_bf16 a[40:43], v[80:83], a[184:187], a[40:43]
v_exp_f32 v54, v54
v_mfma_f32_16x16x32_bf16 a[36:39], v[76:79], a[184:187], a[36:39]
STUB_8:
s_cbranch_execz HOP_RET1
buffer_load_dwordx4 v233, s[12:15], s39 offen offset:1024  lds
v_mfma_f32_16x16x32_bf16 a[52:55], v[76:79], a[188:191], a[52:55]
v_exp_f32 v55, v55
v_mfma_f32_16x16x32_bf16 a[48:51], v[72:75], a[188:191], a[48:51]
ds_read_b64_tr_b16 a[188:189], v223 offset:8192
v_cvt_pk_bf16_f32 v95, v54, v55
v_mfma_f32_16x16x32_bf16 a[32:35], v[72:75], a[184:187], a[32:35]
v_exp_f32 v56, v56
v_smfmac_f32_16x16x64_bf16 a[128:131], a[208:211], v[72:79], v245
ds_read_b64_tr_b16 a[190:191], v223 offset:12288
v_mfma_f32_16x16x32_bf16 v[12:15], a[160:163], v[152:155], v[136:139]
v_exp_f32 v57, v57
v_mfma_f32_16x16x32_bf16 v[12:15], a[164:167], v[156:159], v[12:15]
v_exp_f32 v58, v58
v_mfma_f32_16x16x32_bf16 v[12:15], a[168:171], v[160:163], v[12:15]
ds_read_b64_tr_b16 a[184:185], v222 offset:8192
v_cvt_pk_bf16_f32 v96, v56, v57
v_mfma_f32_16x16x32_bf16 v[12:15], a[172:175], v[164:167], v[12:15]
v_exp_f32 v59, v59
v_mfma_f32_16x16x32_bf16 v[20:23], a[172:175], v[180:183], v[140:143]
ds_read_b64_tr_b16 a[186:187], v222 offset:12288
v_cvt_pk_bf16_f32 v97, v58, v59
v_mfma_f32_16x16x32_bf16 v[20:23], a[168:171], v[176:179], v[20:23]
v_exp_f32 v60, v60
v_mfma_f32_16x16x32_bf16 v[20:23], a[164:167], v[172:175], v[20:23]
buffer_load_dwordx4 v232, s[12:15], s39 offen offset:2048  lds
v_mfma_f32_16x16x32_bf16 v[20:23], a[160:163], v[168:171], v[20:23]
v_exp_f32 v61, v61
v_mfma_f32_16x16x32_bf16 v[28:31], a[160:163], v[184:187], v[144:147]
v_cvt_pk_bf16_f32 v98, v60, v61
v_mfma_f32_16x16x32_bf16 v[28:31], a[164:167], v[188:191], v[28:31]
v_exp_f32 v62, v62
v_mfma_f32_16x16x32_bf16 v[28:31], a[168:171], v[192:195], v[28:31]
buffer_load_dwordx4 v233, s[12:15], s39 offen offset:3072  lds
v_mfma_f32_16x16x32_bf16 v[28:31], a[172:175], v[196:199], v[28:31]
v_exp_f32 v63, v63
v_mfma_f32_16x16x32_bf16 v[36:39], a[172:175], v[212:215], v[148:151]
ds_read_b128 a[172:175], v219 offset:28672
v_cvt_pk_bf16_f32 v99, v62, v63
v_mfma_f32_16x16x32_bf16 v[36:39], a[168:171], v[208:211], v[36:39]
v_exp_f32 v64, v64
v_mfma_f32_16x16x32_bf16 v[36:39], a[164:167], v[204:207], v[36:39]
ds_read_b128 a[168:171], v218 offset:28672
ds_read_b128 a[164:167], v217 offset:28672
v_mfma_f32_16x16x32_bf16 v[36:39], a[160:163], v[200:203], v[36:39]
v_exp_f32 v65, v65
s_waitcnt lgkmcnt(8)
v_mfma_f32_16x16x32_bf16 a[64:67], v[72:75], a[192:195], a[64:67]
ds_read_b128 a[160:163], v216 offset:28672
v_cvt_pk_bf16_f32 v100, v64, v65
v_mfma_f32_16x16x32_bf16 a[80:83], v[72:75], a[196:199], a[80:83]
v_exp_f32 v66, v66
v_mfma_f32_16x16x32_bf16 a[84:87], v[76:79], a[196:199], a[84:87]
s_add_u32 m0, s86, 32768
s_add_u32 s50, s85, 24576
buffer_load_dwordx4 v244, s[72:75], s50 offen lds
v_mfma_f32_16x16x32_bf16 a[68:71], v[76:79], a[192:195], a[68:71]
v_exp_f32 v67, v67
v_mfma_f32_16x16x32_bf16 a[72:75], v[80:83], a[192:195], a[72:75]
s_cmp_lt_u32 s37, 2
s_cselect_b64 s[90:91], -1, 0
v_cvt_pk_bf16_f32 v101, v66, v67
v_mfma_f32_16x16x32_bf16 a[88:91], v[80:83], a[196:199], a[88:91]
v_exp_f32 v68, v68
v_mfma_f32_16x16x32_bf16 a[92:95], v[84:87], a[196:199], a[92:95]
ds_read_b64_tr_b16 a[196:197], v225 offset:8192
ds_read_b64_tr_b16 a[198:199], v225 offset:12288
v_mfma_f32_16x16x32_bf16 a[76:79], v[84:87], a[192:195], a[76:79]
v_exp_f32 v69, v69
v_mfma_f32_16x16x32_bf16 a[108:111], v[84:87], a[200:203], a[108:111]
ds_read_b64_tr_b16 a[192:193], v224 offset:8192
v_cvt_pk_bf16_f32 v102, v68, v69
v_mfma_f32_16x16x32_bf16 a[124:127], v[84:87], a[204:207], a[124:127]
v_exp_f32 v70, v70
v_mfma_f32_16x16x32_bf16 a[120:123], v[80:83], a[204:207], a[120:123]
ds_read_b64_tr_b16 a[194:195], v224 offset:12288
v_mfma_f32_16x16x32_bf16 a[104:107], v[80:83], a[200:203], a[104:107]
v_exp_f32 v71, v71
v_mfma_f32_16x16x32_bf16 a[100:103], v[76:79], a[200:203], a[100:103]
v_cvt_pk_bf16_f32 v103, v70, v71
v_mfma_f32_16x16x32_bf16 a[116:119], v[76:79], a[204:207], a[116:119]
s_add_u32 m0, s86, 36864
s_add_u32 s50, s85, 28672
buffer_load_dwordx4 v244, s[72:75], s50 offen lds
v_mfma_f32_16x16x32_bf16 a[112:115], v[72:75], a[204:207], a[112:115]
ds_read_b64_tr_b16 a[204:205], v227 offset:8192
ds_read_b64_tr_b16 a[206:207], v227 offset:12288
v_mfma_f32_16x16x32_bf16 a[96:99], v[72:75], a[200:203], a[96:99]
ds_read_b64_tr_b16 a[200:201], v226 offset:8192
ds_read_b64_tr_b16 a[202:203], v226 offset:12288
v_smfmac_f32_16x16x64_bf16 a[132:135], a[208:211], v[80:87], v245
s_add_u32 m0, s86, 40960
s_add_u32 s50, s85, 32768
buffer_load_dwordx4 v244, s[72:75], s50 offen lds
v_mfma_f32_16x16x32_bf16 v[40:43], a[144:147], v[152:155], v[136:139]
v_exp_f32 v8, v8
v_mfma_f32_16x16x32_bf16 v[40:43], a[148:151], v[156:159], v[40:43]
v_exp_f32 v9, v9
v_mfma_f32_16x16x32_bf16 v[40:43], a[152:155], v[160:163], v[40:43]
v_cvt_pk_bf16_f32 v72, v8, v9
v_mfma_f32_16x16x32_bf16 v[40:43], a[156:159], v[164:167], v[40:43]
v_exp_f32 v10, v10
v_mfma_f32_16x16x32_bf16 v[48:51], a[156:159], v[180:183], v[140:143]
v_mfma_f32_16x16x32_bf16 v[48:51], a[152:155], v[176:179], v[48:51]
v_exp_f32 v11, v11
v_mfma_f32_16x16x32_bf16 v[48:51], a[148:151], v[172:175], v[48:51]
v_cvt_pk_bf16_f32 v73, v10, v11
v_mfma_f32_16x16x32_bf16 v[48:51], a[144:147], v[168:171], v[48:51]
v_exp_f32 v12, v12
v_mfma_f32_16x16x32_bf16 v[56:59], a[144:147], v[184:187], v[144:147]
v_mfma_f32_16x16x32_bf16 v[56:59], a[148:151], v[188:191], v[56:59]
v_exp_f32 v13, v13
v_mfma_f32_16x16x32_bf16 v[56:59], a[152:155], v[192:195], v[56:59]
v_cvt_pk_bf16_f32 v74, v12, v13
v_mfma_f32_16x16x32_bf16 v[56:59], a[156:159], v[196:199], v[56:59]
v_exp_f32 v14, v14
v_mfma_f32_16x16x32_bf16 v[64:67], a[156:159], v[212:215], v[148:151]
s_waitcnt vmcnt(14) lgkmcnt(0)
s_barrier
v_mfma_f32_16x16x32_bf16 v[64:67], a[152:155], v[208:211], v[64:67]
ds_read_b128 v[124:127], v239 offset:45056
v_exp_f32 v15, v15
v_mfma_f32_16x16x32_bf16 v[64:67], a[148:151], v[204:207], v[64:67]
ds_read_b128 a[156:159], v219 offset:49152
ds_read_b128 v[128:131], v239 offset:45568
v_cvt_pk_bf16_f32 v75, v14, v15
v_mfma_f32_16x16x32_bf16 v[64:67], a[144:147], v[200:203], v[64:67]
ds_read_b128 v[248:251], v239 offset:46080
v_exp_f32 v16, v16
v_mfma_f32_16x16x32_bf16 a[0:3], v[88:91], a[176:179], a[0:3]
ds_read_b128 a[152:155], v218 offset:49152
ds_read_b128 a[148:151], v217 offset:49152
ds_read_b128 v[252:255], v239 offset:46592
v_mfma_f32_16x16x32_bf16 a[16:19], v[88:91], a[180:183], a[16:19]
ds_read_b64_tr_b16 v[116:117], v241 offset:0
v_exp_f32 v17, v17
v_mfma_f32_16x16x32_bf16 a[20:23], v[92:95], a[180:183], a[20:23]
ds_read_b128 a[144:147], v216 offset:49152
ds_read_b64_tr_b16 v[118:119], v241 offset:256
v_cvt_pk_bf16_f32 v76, v16, v17
v_mfma_f32_16x16x32_bf16 a[4:7], v[92:95], a[176:179], a[4:7]
ds_read_b64_tr_b16 v[120:121], v241 offset:2048
v_exp_f32 v18, v18
v_mfma_f32_16x16x32_bf16 a[8:11], v[96:99], a[176:179], a[8:11]
s_add_u32 s32, s32, 16384
ds_read_b64_tr_b16 v[122:123], v241 offset:2304
v_mfma_f32_16x16x32_bf16 a[24:27], v[96:99], a[180:183], a[24:27]
v_exp_f32 v19, v19
v_mfma_f32_16x16x32_bf16 a[28:31], v[100:103], a[180:183], a[28:31]
ds_read_b64_tr_b16 a[180:181], v221 offset:32768
v_cvt_pk_bf16_f32 v77, v18, v19
v_mfma_f32_16x16x32_bf16 a[12:15], v[100:103], a[176:179], a[12:15]
v_exp_f32 v20, v20
v_mfma_f32_16x16x32_bf16 a[44:47], v[100:103], a[184:187], a[44:47]
ds_read_b64_tr_b16 a[182:183], v221 offset:36864
ds_read_b64_tr_b16 a[176:177], v220 offset:32768
v_mfma_f32_16x16x32_bf16 a[60:63], v[100:103], a[188:191], a[60:63]
v_exp_f32 v21, v21
v_mfma_f32_16x16x32_bf16 a[56:59], v[96:99], a[188:191], a[56:59]
ds_read_b64_tr_b16 a[178:179], v220 offset:36864
v_cvt_pk_bf16_f32 v78, v20, v21
s_waitcnt lgkmcnt(8)
v_mfma_f32_16x16x32_bf16 v[132:135], a[212:215], v[124:127], 0
s_add_u32 m0, s30, 81920
ds_read_b128 v[124:127], v239 offset:47104
v_mfma_f32_16x16x32_bf16 a[40:43], v[96:99], a[184:187], a[40:43]
v_exp_f32 v22, v22
v_mfma_f32_16x16x32_bf16 a[36:39], v[92:95], a[184:187], a[36:39]
v_mfma_f32_16x16x32_bf16 v[132:135], a[216:219], v[128:131], v[132:135]
ds_read_b128 v[128:131], v239 offset:47616
v_mfma_f32_16x16x32_bf16 a[52:55], v[92:95], a[188:191], a[52:55]
v_exp_f32 v23, v23
v_mfma_f32_16x16x32_bf16 a[48:51], v[88:91], a[188:191], a[48:51]
ds_read_b64_tr_b16 a[188:189], v223 offset:32768
v_cvt_pk_bf16_f32 v79, v22, v23
v_mfma_f32_16x16x32_bf16 v[132:135], a[220:223], v[248:251], v[132:135]
ds_read_b64_tr_b16 a[190:191], v223 offset:36864
ds_read_b128 v[248:251], v239 offset:48128
v_mfma_f32_16x16x32_bf16 a[32:35], v[88:91], a[184:187], a[32:35]
v_exp_f32 v24, v24
v_smfmac_f32_16x16x64_bf16 a[128:131], a[208:211], v[88:95], v245
ds_read_b64_tr_b16 a[184:185], v222 offset:32768
v_mfma_f32_16x16x32_bf16 v[132:135], a[224:227], v[252:255], v[132:135]
ds_read_b64_tr_b16 a[186:187], v222 offset:36864
ds_read_b128 v[252:255], v239 offset:48640
v_mfma_f32_16x16x32_bf16 v[44:47], a[160:163], v[152:155], v[136:139]
v_exp_f32 v25, v25
v_mfma_f32_16x16x32_bf16 v[44:47], a[164:167], v[156:159], v[44:47]
v_exp_f32 v26, v26
s_waitcnt lgkmcnt(7)
v_mfma_f32_16x16x32_bf16 v[132:135], a[228:231], v[124:127], v[132:135]
ds_read_b128 v[124:127], v239 offset:49152
v_cvt_pk_bf16_f32 v80, v24, v25
v_mfma_f32_16x16x32_bf16 v[44:47], a[168:171], v[160:163], v[44:47]
buffer_load_dwordx4 v228, s[8:11], s32 offen offset:0  lds
v_mfma_f32_16x16x32_bf16 v[44:47], a[172:175], v[164:167], v[44:47]
v_exp_f32 v27, v27
s_waitcnt lgkmcnt(7)
v_mfma_f32_16x16x32_bf16 v[132:135], a[232:235], v[128:131], v[132:135]
ds_read_b128 v[128:131], v239 offset:49664
v_mfma_f32_16x16x32_bf16 v[52:55], a[172:175], v[180:183], v[140:143]
v_cvt_pk_bf16_f32 v81, v26, v27
v_mfma_f32_16x16x32_bf16 v[52:55], a[168:171], v[176:179], v[52:55]
v_exp_f32 v28, v28
s_waitcnt lgkmcnt(5)
v_mfma_f32_16x16x32_bf16 v[132:135], a[236:239], v[248:251], v[132:135]
buffer_load_dwordx4 v229, s[8:11], s32 offen offset:1024  lds
ds_read_b128 v[248:251], v239 offset:50176
v_mfma_f32_16x16x32_bf16 v[52:55], a[164:167], v[172:175], v[52:55]
v_mfma_f32_16x16x32_bf16 v[52:55], a[160:163], v[168:171], v[52:55]
v_exp_f32 v29, v29
s_waitcnt lgkmcnt(3)
v_mfma_f32_16x16x32_bf16 v[132:135], a[240:243], v[252:255], v[132:135]
ds_read_b128 v[252:255], v239 offset:50688
v_mfma_f32_16x16x32_bf16 v[60:63], a[160:163], v[184:187], v[144:147]
v_cvt_pk_bf16_f32 v82, v28, v29
v_mfma_f32_16x16x32_bf16 v[60:63], a[164:167], v[188:191], v[60:63]
v_exp_f32 v30, v30
s_waitcnt lgkmcnt(3)
v_mfma_f32_16x16x32_bf16 v[132:135], a[244:247], v[124:127], v[132:135]
ds_read_b128 v[124:127], v239 offset:51200
v_mfma_f32_16x16x32_bf16 v[60:63], a[168:171], v[192:195], v[60:63]
v_mfma_f32_16x16x32_bf16 v[60:63], a[172:175], v[196:199], v[60:63]
v_exp_f32 v31, v31
s_waitcnt lgkmcnt(3)
v_mfma_f32_16x16x32_bf16 v[132:135], a[248:251], v[128:131], v[132:135]
buffer_load_dwordx4 v230, s[8:11], s32 offen offset:2048  lds
ds_read_b128 v[128:131], v239 offset:51712
v_mfma_f32_16x16x32_bf16 v[68:71], a[172:175], v[212:215], v[148:151]
ds_read_b128 a[172:175], v219 offset:53248
v_cvt_pk_bf16_f32 v83, v30, v31
v_mfma_f32_16x16x32_bf16 v[68:71], a[168:171], v[208:211], v[68:71]
v_exp_f32 v32, v32
s_waitcnt lgkmcnt(4)
v_mfma_f32_16x16x32_bf16 v[132:135], a[252:255], v[248:251], v[132:135]
ds_read_b128 a[168:171], v218 offset:53248
ds_read_b128 v[248:251], v239 offset:52224
v_mfma_f32_16x16x32_bf16 v[68:71], a[164:167], v[204:207], v[68:71]
ds_read_b128 a[164:167], v217 offset:53248
v_mfma_f32_16x16x32_bf16 v[68:71], a[160:163], v[200:203], v[68:71]
v_exp_f32 v33, v33
s_waitcnt lgkmcnt(6)
v_mfma_f32_16x16x32_bf16 v[132:135], a[136:139], v[252:255], v[132:135]
ds_read_b128 a[160:163], v216 offset:53248
ds_read_b128 v[252:255], v239 offset:52736
v_mfma_f32_16x16x32_bf16 a[64:67], v[88:91], a[192:195], a[64:67]
v_cvt_pk_bf16_f32 v84, v32, v33
v_mfma_f32_16x16x32_bf16 a[80:83], v[88:91], a[196:199], a[80:83]
v_exp_f32 v34, v34
s_waitcnt lgkmcnt(7)
v_mfma_f32_16x16x32_bf16 v[132:135], a[140:143], v[124:127], v[132:135]
ds_read_b128 v[124:127], v239 offset:53248
v_mfma_f32_16x16x32_bf16 a[84:87], v[92:95], a[196:199], a[84:87]
buffer_load_dwordx4 v231, s[8:11], s32 offen offset:3072  lds
v_mfma_f32_16x16x32_bf16 a[68:71], v[92:95], a[192:195], a[68:71]
v_exp_f32 v35, v35
s_waitcnt lgkmcnt(7)
v_mfma_f32_16x16x32_bf16 v[132:135], v[104:107], v[128:131], v[132:135]
ds_read_b128 v[128:131], v239 offset:53760
v_mfma_f32_16x16x32_bf16 a[72:75], v[96:99], a[192:195], a[72:75]
v_cvt_pk_bf16_f32 v85, v34, v35
v_mfma_f32_16x16x32_bf16 a[88:91], v[96:99], a[196:199], a[88:91]
v_exp_f32 v36, v36
s_waitcnt lgkmcnt(5)
v_mfma_f32_16x16x32_bf16 v[132:135], v[108:111], v[248:251], v[132:135]
v_mfma_f32_16x16x32_bf16 a[92:95], v[100:103], a[196:199], a[92:95]
ds_read_b64_tr_b16 a[196:197], v225 offset:32768
ds_read_b64_tr_b16 a[198:199], v225 offset:36864
v_mfma_f32_16x16x32_bf16 a[76:79], v[100:103], a[192:195], a[76:79]
v_exp_f32 v37, v37
s_waitcnt lgkmcnt(4)
v_mfma_f32_16x16x32_bf16 v[132:135], v[112:115], v[252:255], v[132:135]
ds_read_b64_tr_b16 a[192:193], v224 offset:32768
ds_read_b64_tr_b16 a[194:195], v224 offset:36864
v_mfma_f32_16x16x32_bf16 a[108:111], v[100:103], a[200:203], a[108:111]
v_cvt_pk_bf16_f32 v86, v36, v37
v_mfma_f32_16x16x32_bf16 a[124:127], v[100:103], a[204:207], a[124:127]
v_exp_f32 v38, v38
s_waitcnt lgkmcnt(5)
v_mfma_f32_16x16x32_bf16 v[132:135], v[116:119], v[124:127], v[132:135]
v_mfma_f32_16x16x32_bf16 a[120:123], v[96:99], a[204:207], a[120:123]
v_mfma_f32_16x16x32_bf16 a[104:107], v[96:99], a[200:203], a[104:107]
v_exp_f32 v39, v39
s_waitcnt lgkmcnt(4)
v_mfma_f32_16x16x32_bf16 v[132:135], v[120:123], v[128:131], v[132:135]
v_mfma_f32_16x16x32_bf16 a[100:103], v[92:95], a[200:203], a[100:103]
v_cvt_pk_bf16_f32 v87, v38, v39
v_mfma_f32_16x16x32_bf16 a[116:119], v[92:95], a[204:207], a[116:119]
v_mfma_f32_16x16x32_bf16 a[112:115], v[88:91], a[204:207], a[112:115]
ds_read_b64_tr_b16 a[204:205], v227 offset:32768
ds_read_b64_tr_b16 a[206:207], v227 offset:36864
v_mfma_f32_16x16x32_bf16 a[96:99], v[88:91], a[200:203], a[96:99]
ds_read_b64_tr_b16 a[200:201], v226 offset:32768
ds_read_b64_tr_b16 a[202:203], v226 offset:36864
v_smfmac_f32_16x16x64_bf16 a[132:135], a[208:211], v[96:103], v245
v_mfma_f32_16x16x32_bf16 v[8:11], a[144:147], v[152:155], v[136:139]
v_exp_f32 v40, v40
v_mfma_f32_16x16x32_bf16 v[8:11], a[148:151], v[156:159], v[8:11]
v_exp_f32 v41, v41
v_mfma_f32_16x16x32_bf16 v[8:11], a[152:155], v[160:163], v[8:11]
v_cvt_pk_bf16_f32 v88, v40, v41
v_cvt_pk_bf16_f32 v104, v132, v133
v_cvt_pk_bf16_f32 v105, v134, v135
v_mfma_f32_16x16x32_bf16 v[8:11], a[156:159], v[164:167], v[8:11]
v_lshlrev_b32 v132, 16, v104
v_exp_f32 v42, v42
v_mfma_f32_16x16x32_bf16 v[16:19], a[156:159], v[180:183], v[140:143]
s_add_u32 s39, s39, 16384
v_and_b32 v133, 0xffff0000, v104
v_lshlrev_b32 v134, 16, v105
v_mfma_f32_16x16x32_bf16 v[16:19], a[152:155], v[176:179], v[16:19]
v_and_b32 v135, 0xffff0000, v105
v_exp_f32 v43, v43
v_mfma_f32_16x16x32_bf16 v[16:19], a[148:151], v[172:175], v[16:19]
v_cvt_pk_bf16_f32 v89, v42, v43
v_mul_f32 v104, 0xbfb8aa3b, v132
v_mul_f32 v105, 0xbfb8aa3b, v133
v_mfma_f32_16x16x32_bf16 v[16:19], a[144:147], v[168:171], v[16:19]
v_mul_f32 v106, 0xbfb8aa3b, v134
v_exp_f32 v44, v44
v_mfma_f32_16x16x32_bf16 v[24:27], a[144:147], v[184:187], v[144:147]
v_mul_f32 v107, 0xbfb8aa3b, v135
v_exp_f32 v104, v104
v_mfma_f32_16x16x32_bf16 v[24:27], a[148:151], v[188:191], v[24:27]
v_exp_f32 v45, v45
v_mfma_f32_16x16x32_bf16 v[24:27], a[152:155], v[192:195], v[24:27]
v_cvt_pk_bf16_f32 v90, v44, v45
v_exp_f32 v105, v105
v_mfma_f32_16x16x32_bf16 v[24:27], a[156:159], v[196:199], v[24:27]
v_exp_f32 v46, v46
v_mfma_f32_16x16x32_bf16 v[32:35], a[156:159], v[212:215], v[148:151]
ds_read_b128 a[156:159], v219 offset:57344
s_add_u32 m0, s30, 98304
v_mfma_f32_16x16x32_bf16 v[32:35], a[152:155], v[208:211], v[32:35]
v_exp_f32 v47, v47
v_mfma_f32_16x16x32_bf16 v[32:35], a[148:151], v[204:207], v[32:35]
ds_read_b128 a[152:155], v218 offset:57344
v_cvt_pk_bf16_f32 v91, v46, v47
v_mfma_f32_16x16x32_bf16 v[32:35], a[144:147], v[200:203], v[32:35]
v_exp_f32 v48, v48
v_mfma_f32_16x16x32_bf16 a[0:3], v[72:75], a[176:179], a[0:3]
ds_read_b128 a[148:151], v217 offset:57344
ds_read_b128 a[144:147], v216 offset:57344
v_mfma_f32_16x16x32_bf16 a[16:19], v[72:75], a[180:183], a[16:19]
v_exp_f32 v49, v49
v_mfma_f32_16x16x32_bf16 a[20:23], v[76:79], a[180:183], a[20:23]
v_cvt_pk_bf16_f32 v92, v48, v49
v_exp_f32 v106, v106
v_mfma_f32_16x16x32_bf16 a[4:7], v[76:79], a[176:179], a[4:7]
v_exp_f32 v50, v50
v_mfma_f32_16x16x32_bf16 a[8:11], v[80:83], a[176:179], a[8:11]
v_exp_f32 v107, v107
v_mfma_f32_16x16x32_bf16 a[24:27], v[80:83], a[180:183], a[24:27]
v_add_f32 v104, 1.0, v104
v_exp_f32 v51, v51
v_mfma_f32_16x16x32_bf16 a[28:31], v[84:87], a[180:183], a[28:31]
ds_read_b64_tr_b16 a[180:181], v221 offset:40960
v_cvt_pk_bf16_f32 v93, v50, v51
v_add_f32 v105, 1.0, v105
v_mfma_f32_16x16x32_bf16 a[12:15], v[84:87], a[176:179], a[12:15]
v_add_f32 v106, 1.0, v106
v_exp_f32 v52, v52
v_mfma_f32_16x16x32_bf16 a[44:47], v[84:87], a[184:187], a[44:47]
ds_read_b64_tr_b16 a[182:183], v221 offset:45056
ds_read_b64_tr_b16 a[176:177], v220 offset:40960
v_add_f32 v107, 1.0, v107
v_mfma_f32_16x16x32_bf16 a[60:63], v[84:87], a[188:191], a[60:63]
v_exp_f32 v53, v53
v_mfma_f32_16x16x32_bf16 a[56:59], v[80:83], a[188:191], a[56:59]
ds_read_b64_tr_b16 a[178:179], v220 offset:45056
v_cvt_pk_bf16_f32 v94, v52, v53
v_mfma_f32_16x16x32_bf16 a[40:43], v[80:83], a[184:187], a[40:43]
v_exp_f32 v54, v54
v_mfma_f32_16x16x32_bf16 a[36:39], v[76:79], a[184:187], a[36:39]
buffer_load_dwordx4 v232, s[12:15], s39 offen offset:0  lds
v_mfma_f32_16x16x32_bf16 a[52:55], v[76:79], a[188:191], a[52:55]
v_exp_f32 v55, v55
v_mfma_f32_16x16x32_bf16 a[48:51], v[72:75], a[188:191], a[48:51]
ds_read_b64_tr_b16 a[188:189], v223 offset:40960
v_cvt_pk_bf16_f32 v95, v54, v55
v_mfma_f32_16x16x32_bf16 a[32:35], v[72:75], a[184:187], a[32:35]
v_exp_f32 v56, v56
v_smfmac_f32_16x16x64_bf16 a[128:131], a[208:211], v[72:79], v245
ds_read_b64_tr_b16 a[190:191], v223 offset:45056
v_mfma_f32_16x16x32_bf16 v[12:15], a[160:163], v[152:155], v[136:139]
v_exp_f32 v57, v57
v_mfma_f32_16x16x32_bf16 v[12:15], a[164:167], v[156:159], v[12:15]
v_exp_f32 v58, v58
v_mfma_f32_16x16x32_bf16 v[12:15], a[168:171], v[160:163], v[12:15]
ds_read_b64_tr_b16 a[184:185], v222 offset:40960
v_cvt_pk_bf16_f32 v96, v56, v57
v_mfma_f32_16x16x32_bf16 v[12:15], a[172:175], v[164:167], v[12:15]
v_exp_f32 v59, v59
v_mfma_f32_16x16x32_bf16 v[20:23], a[172:175], v[180:183], v[140:143]
ds_read_b64_tr_b16 a[186:187], v222 offset:45056
v_cvt_pk_bf16_f32 v97, v58, v59
v_mfma_f32_16x16x32_bf16 v[20:23], a[168:171], v[176:179], v[20:23]
v_exp_f32 v60, v60
v_mfma_f32_16x16x32_bf16 v[20:23], a[164:167], v[172:175], v[20:23]
buffer_load_dwordx4 v233, s[12:15], s39 offen offset:1024  lds
v_mfma_f32_16x16x32_bf16 v[20:23], a[160:163], v[168:171], v[20:23]
v_exp_f32 v61, v61
v_mfma_f32_16x16x32_bf16 v[28:31], a[160:163], v[184:187], v[144:147]
v_cvt_pk_bf16_f32 v98, v60, v61
v_rcp_f32 v104, v104
v_mfma_f32_16x16x32_bf16 v[28:31], a[164:167], v[188:191], v[28:31]
v_exp_f32 v62, v62
v_mfma_f32_16x16x32_bf16 v[28:31], a[168:171], v[192:195], v[28:31]
buffer_load_dwordx4 v232, s[12:15], s39 offen offset:2048  lds
v_mfma_f32_16x16x32_bf16 v[28:31], a[172:175], v[196:199], v[28:31]
v_exp_f32 v63, v63
v_mfma_f32_16x16x32_bf16 v[36:39], a[172:175], v[212:215], v[148:151]
ds_read_b128 a[172:175], v219 offset:61440
v_cvt_pk_bf16_f32 v99, v62, v63
v_mfma_f32_16x16x32_bf16 v[36:39], a[168:171], v[208:211], v[36:39]
v_exp_f32 v64, v64
v_mfma_f32_16x16x32_bf16 v[36:39], a[164:167], v[204:207], v[36:39]
ds_read_b128 a[168:171], v218 offset:61440
ds_read_b128 a[164:167], v217 offset:61440
v_mfma_f32_16x16x32_bf16 v[36:39], a[160:163], v[200:203], v[36:39]
v_exp_f32 v65, v65
s_waitcnt lgkmcnt(8)
v_mfma_f32_16x16x32_bf16 a[64:67], v[72:75], a[192:195], a[64:67]
ds_read_b128 a[160:163], v216 offset:61440
v_cvt_pk_bf16_f32 v100, v64, v65
v_mfma_f32_16x16x32_bf16 a[80:83], v[72:75], a[196:199], a[80:83]
v_exp_f32 v66, v66
v_mfma_f32_16x16x32_bf16 a[84:87], v[76:79], a[196:199], a[84:87]
buffer_load_dwordx4 v233, s[12:15], s39 offen offset:3072  lds
v_mfma_f32_16x16x32_bf16 a[68:71], v[76:79], a[192:195], a[68:71]
v_exp_f32 v67, v67
v_mfma_f32_16x16x32_bf16 a[72:75], v[80:83], a[192:195], a[72:75]
v_cvt_pk_bf16_f32 v101, v66, v67
v_rcp_f32 v105, v105
v_mfma_f32_16x16x32_bf16 a[88:91], v[80:83], a[196:199], a[88:91]
v_exp_f32 v68, v68
v_mfma_f32_16x16x32_bf16 a[92:95], v[84:87], a[196:199], a[92:95]
ds_read_b64_tr_b16 a[196:197], v225 offset:40960
ds_read_b64_tr_b16 a[198:199], v225 offset:45056
v_mfma_f32_16x16x32_bf16 a[76:79], v[84:87], a[192:195], a[76:79]
v_exp_f32 v69, v69
v_mfma_f32_16x16x32_bf16 a[108:111], v[84:87], a[200:203], a[108:111]
ds_read_b64_tr_b16 a[192:193], v224 offset:40960
v_cvt_pk_bf16_f32 v102, v68, v69
v_mfma_f32_16x16x32_bf16 a[124:127], v[84:87], a[204:207], a[124:127]
v_exp_f32 v70, v70
v_mfma_f32_16x16x32_bf16 a[120:123], v[80:83], a[204:207], a[120:123]
ds_read_b64_tr_b16 a[194:195], v224 offset:45056
v_rcp_f32 v106, v106
v_mfma_f32_16x16x32_bf16 a[104:107], v[80:83], a[200:203], a[104:107]
v_exp_f32 v71, v71
v_mfma_f32_16x16x32_bf16 a[100:103], v[76:79], a[200:203], a[100:103]
v_cvt_pk_bf16_f32 v103, v70, v71
v_rcp_f32 v107, v107
v_mfma_f32_16x16x32_bf16 a[116:119], v[76:79], a[204:207], a[116:119]
v_mul_f32 v104, v132, v104
v_mul_f32 v105, v133, v105
v_mul_f32 v106, v134, v106
v_mfma_f32_16x16x32_bf16 a[112:115], v[72:75], a[204:207], a[112:115]
ds_read_b64_tr_b16 a[204:205], v227 offset:40960
ds_read_b64_tr_b16 a[206:207], v227 offset:45056
v_mul_f32 v107, v135, v107
v_mfma_f32_16x16x32_bf16 a[96:99], v[72:75], a[200:203], a[96:99]
ds_read_b64_tr_b16 a[200:201], v226 offset:40960
ds_read_b64_tr_b16 a[202:203], v226 offset:45056
v_cvt_pk_bf16_f32 v108, v104, v105
v_smfmac_f32_16x16x64_bf16 a[132:135], a[208:211], v[80:87], v245
v_cvt_pk_bf16_f32 v109, v106, v107
v_lshlrev_b32 v104, 16, v108
v_and_b32 v105, 0xffff0000, v108
v_lshlrev_b32 v106, 16, v109
v_and_b32 v107, 0xffff0000, v109
v_cndmask_b32 v132, v132, v104, s[90:91]
v_cndmask_b32 v133, v133, v105, s[90:91]
v_cndmask_b32 v134, v134, v106, s[90:91]
v_cndmask_b32 v135, v135, v107, s[90:91]
ds_write_b128 v237, v[132:135] offset:54272
v_mfma_f32_16x16x32_bf16 v[40:43], a[144:147], v[152:155], v[136:139]
v_exp_f32 v8, v8
v_mfma_f32_16x16x32_bf16 v[40:43], a[148:151], v[156:159], v[40:43]
v_exp_f32 v9, v9
v_mfma_f32_16x16x32_bf16 v[40:43], a[152:155], v[160:163], v[40:43]
v_cvt_pk_bf16_f32 v72, v8, v9
v_mfma_f32_16x16x32_bf16 v[40:43], a[156:159], v[164:167], v[40:43]
v_exp_f32 v10, v10
v_mfma_f32_16x16x32_bf16 v[48:51], a[156:159], v[180:183], v[140:143]
v_mfma_f32_16x16x32_bf16 v[48:51], a[152:155], v[176:179], v[48:51]
v_exp_f32 v11, v11
v_mfma_f32_16x16x32_bf16 v[48:51], a[148:151], v[172:175], v[48:51]
v_cvt_pk_bf16_f32 v73, v10, v11
v_mfma_f32_16x16x32_bf16 v[48:51], a[144:147], v[168:171], v[48:51]
v_exp_f32 v12, v12
v_mfma_f32_16x16x32_bf16 v[56:59], a[144:147], v[184:187], v[144:147]
v_mfma_f32_16x16x32_bf16 v[56:59], a[148:151], v[188:191], v[56:59]
v_exp_f32 v13, v13
v_mfma_f32_16x16x32_bf16 v[56:59], a[152:155], v[192:195], v[56:59]
v_cvt_pk_bf16_f32 v74, v12, v13
v_mfma_f32_16x16x32_bf16 v[56:59], a[156:159], v[196:199], v[56:59]
v_exp_f32 v14, v14
v_mfma_f32_16x16x32_bf16 v[64:67], a[156:159], v[212:215], v[148:151]
s_waitcnt vmcnt(8) lgkmcnt(0)
s_barrier
v_mfma_f32_16x16x32_bf16 v[64:67], a[152:155], v[208:211], v[64:67]
ds_read_b128 v[104:107], v244 offset:54272
v_exp_f32 v15, v15
v_mfma_f32_16x16x32_bf16 v[64:67], a[148:151], v[204:207], v[64:67]
ds_read_b128 a[156:159], v219 offset:0
ds_read_b128 v[108:111], v244 offset:55296
v_cvt_pk_bf16_f32 v75, v14, v15
v_mfma_f32_16x16x32_bf16 v[64:67], a[144:147], v[200:203], v[64:67]
ds_read_b128 v[112:115], v244 offset:56320
v_exp_f32 v16, v16
v_mfma_f32_16x16x32_bf16 a[0:3], v[88:91], a[176:179], a[0:3]
ds_read_b128 a[152:155], v218 offset:0
ds_read_b128 a[148:151], v217 offset:0
ds_read_b128 v[116:119], v244 offset:57344
v_mfma_f32_16x16x32_bf16 a[16:19], v[88:91], a[180:183], a[16:19]
ds_read_b64_tr_b16 a[212:213], v242 offset:0
v_exp_f32 v17, v17
v_mfma_f32_16x16x32_bf16 a[20:23], v[92:95], a[180:183], a[20:23]
ds_read_b128 a[144:147], v216 offset:0
ds_read_b64_tr_b16 a[214:215], v242 offset:18432
v_cvt_pk_bf16_f32 v76, v16, v17
v_mfma_f32_16x16x32_bf16 a[4:7], v[92:95], a[176:179], a[4:7]
ds_read_b64_tr_b16 a[216:217], v242 offset:32
v_exp_f32 v18, v18
v_mfma_f32_16x16x32_bf16 a[8:11], v[96:99], a[176:179], a[8:11]
s_add_u32 s32, s32, 16384
ds_read_b64_tr_b16 a[218:219], v242 offset:18464
ds_read_b64_tr_b16 a[220:221], v242 offset:64
v_mfma_f32_16x16x32_bf16 a[24:27], v[96:99], a[180:183], a[24:27]
ds_read_b64_tr_b16 a[222:223], v242 offset:18496
v_exp_f32 v19, v19
v_mfma_f32_16x16x32_bf16 a[28:31], v[100:103], a[180:183], a[28:31]
ds_read_b64_tr_b16 a[180:181], v221 offset:49152
ds_read_b64_tr_b16 a[224:225], v242 offset:96
v_cvt_pk_bf16_f32 v77, v18, v19
v_mfma_f32_16x16x32_bf16 a[12:15], v[100:103], a[176:179], a[12:15]
ds_read_b64_tr_b16 a[226:227], v242 offset:18528
v_exp_f32 v20, v20
v_mfma_f32_16x16x32_bf16 a[44:47], v[100:103], a[184:187], a[44:47]
ds_read_b64_tr_b16 a[182:183], v221 offset:53248
ds_read_b64_tr_b16 a[176:177], v220 offset:49152
ds_read_b64_tr_b16 a[228:229], v242 offset:128
v_mfma_f32_16x16x32_bf16 a[60:63], v[100:103], a[188:191], a[60:63]
ds_read_b64_tr_b16 a[230:231], v242 offset:18560
v_exp_f32 v21, v21
v_mfma_f32_16x16x32_bf16 a[56:59], v[96:99], a[188:191], a[56:59]
ds_read_b64_tr_b16 a[178:179], v220 offset:53248
ds_read_b64_tr_b16 a[232:233], v242 offset:160
v_cvt_pk_bf16_f32 v78, v20, v21
v_mfma_f32_16x16x32_bf16 a[40:43], v[96:99], a[184:187], a[40:43]
ds_read_b64_tr_b16 a[234:235], v242 offset:18592
v_exp_f32 v22, v22
v_mfma_f32_16x16x32_bf16 a[36:39], v[92:95], a[184:187], a[36:39]
s_add_u32 m0, s30, 114688
ds_read_b64_tr_b16 a[236:237], v242 offset:192
ds_read_b64_tr_b16 a[238:239], v242 offset:18624
v_mfma_f32_16x16x32_bf16 a[52:55], v[92:95], a[188:191], a[52:55]
ds_read_b64_tr_b16 a[240:241], v242 offset:224
v_exp_f32 v23, v23
v_mfma_f32_16x16x32_bf16 a[48:51], v[88:91], a[188:191], a[48:51]
ds_read_b64_tr_b16 a[188:189], v223 offset:49152
ds_read_b64_tr_b16 a[242:243], v242 offset:18656
v_cvt_pk_bf16_f32 v79, v22, v23
v_mfma_f32_16x16x32_bf16 a[32:35], v[88:91], a[184:187], a[32:35]
ds_read_b64_tr_b16 a[244:245], v242 offset:256
v_exp_f32 v24, v24
v_smfmac_f32_16x16x64_bf16 a[128:131], a[208:211], v[88:95], v245
ds_read_b64_tr_b16 a[190:191], v223 offset:53248
ds_read_b64_tr_b16 a[246:247], v242 offset:18688
v_mfma_f32_16x16x32_bf16 v[44:47], a[160:163], v[152:155], v[136:139]
s_waitcnt lgkmcnt(8)
v_mul_f32 v104, v104, v112
v_exp_f32 v25, v25
v_mfma_f32_16x16x32_bf16 v[44:47], a[164:167], v[156:159], v[44:47]
v_mul_f32 v105, v105, v113
v_exp_f32 v26, v26
v_mfma_f32_16x16x32_bf16 v[44:47], a[168:171], v[160:163], v[44:47]
ds_read_b64_tr_b16 a[184:185], v222 offset:49152
v_cvt_pk_bf16_f32 v80, v24, v25
v_mul_f32 v106, v106, v114
v_mfma_f32_16x16x32_bf16 v[44:47], a[172:175], v[164:167], v[44:47]
v_mul_f32 v107, v107, v115
v_exp_f32 v27, v27
v_mfma_f32_16x16x32_bf16 v[52:55], a[172:175], v[180:183], v[140:143]
STUB_9:
s_cbranch_execz HOP_RET1
ds_read_b64_tr_b16 a[186:187], v222 offset:53248
v_cvt_pk_bf16_f32 v81, v26, v27
v_mul_f32 v108, v108, v116
v_mfma_f32_16x16x32_bf16 v[52:55], a[168:171], v[176:179], v[52:55]
v_mul_f32 v109, v109, v117
v_exp_f32 v28, v28
v_mfma_f32_16x16x32_bf16 v[52:55], a[164:167], v[172:175], v[52:55]
buffer_load_dwordx4 v228, s[8:11], s32 offen offset:0  lds
v_mul_f32 v110, v110, v118
v_mfma_f32_16x16x32_bf16 v[52:55], a[160:163], v[168:171], v[52:55]
v_mul_f32 v111, v111, v119
v_exp_f32 v29, v29
v_mfma_f32_16x16x32_bf16 v[60:63], a[160:163], v[184:187], v[144:147]
v_cvt_pk_bf16_f32 v82, v28, v29
v_cvt_pk_bf16_f32 v120, v104, v105
v_cvt_pk_bf16_f32 v121, v106, v107
v_mfma_f32_16x16x32_bf16 v[60:63], a[164:167], v[188:191], v[60:63]
v_cvt_pk_bf16_f32 v122, v108, v109
v_exp_f32 v30, v30
v_mfma_f32_16x16x32_bf16 v[60:63], a[168:171], v[192:195], v[60:63]
buffer_load_dwordx4 v229, s[8:11], s32 offen offset:1024  lds
v_cvt_pk_bf16_f32 v123, v110, v111
v_mfma_f32_16x16x32_bf16 v[60:63], a[172:175], v[196:199], v[60:63]
v_exp_f32 v31, v31
v_mfma_f32_16x16x32_bf16 v[68:71], a[172:175], v[212:215], v[148:151]
ds_read_b128 a[172:175], v219 offset:4096
v_cvt_pk_bf16_f32 v83, v30, v31
v_mfma_f32_16x16x32_bf16 a[248:251], a[212:215], v[120:123], 0
buffer_load_dwordx4 v230, s[8:11], s32 offen offset:2048  lds
v_mfma_f32_16x16x32_bf16 v[68:71], a[168:171], v[208:211], v[68:71]
v_exp_f32 v32, v32
v_mfma_f32_16x16x32_bf16 a[212:215], a[216:219], v[120:123], 0
ds_read_b128 a[168:171], v218 offset:4096
v_mfma_f32_16x16x32_bf16 v[68:71], a[164:167], v[204:207], v[68:71]
ds_read_b128 a[164:167], v217 offset:4096
v_mfma_f32_16x16x32_bf16 a[216:219], a[220:223], v[120:123], 0
v_mfma_f32_16x16x32_bf16 v[68:71], a[160:163], v[200:203], v[68:71]
v_exp_f32 v33, v33
v_mfma_f32_16x16x32_bf16 a[220:223], a[224:227], v[120:123], 0
ds_read_b128 a[160:163], v216 offset:4096
v_mfma_f32_16x16x32_bf16 a[64:67], v[88:91], a[192:195], a[64:67]
v_cvt_pk_bf16_f32 v84, v32, v33
v_mfma_f32_16x16x32_bf16 a[224:227], a[228:231], v[120:123], 0
v_mfma_f32_16x16x32_bf16 a[80:83], v[88:91], a[196:199], a[80:83]
v_exp_f32 v34, v34
v_mfma_f32_16x16x32_bf16 a[228:231], a[232:235], v[120:123], 0
v_mfma_f32_16x16x32_bf16 a[84:87], v[92:95], a[196:199], a[84:87]
buffer_load_dwordx4 v231, s[8:11], s32 offen offset:3072  lds
s_waitcnt lgkmcnt(8)
v_mfma_f32_16x16x32_bf16 a[232:235], a[236:239], v[120:123], 0
v_mfma_f32_16x16x32_bf16 a[68:71], v[92:95], a[192:195], a[68:71]
v_exp_f32 v35, v35
v_mfma_f32_16x16x32_bf16 a[236:239], a[240:243], v[120:123], 0
v_mfma_f32_16x16x32_bf16 a[72:75], v[96:99], a[192:195], a[72:75]
v_cvt_pk_bf16_f32 v85, v34, v35
s_waitcnt lgkmcnt(6)
v_mfma_f32_16x16x32_bf16 a[240:243], a[244:247], v[120:123], 0
v_mfma_f32_16x16x32_bf16 a[88:91], v[96:99], a[196:199], a[88:91]
v_exp_f32 v36, v36
v_mfma_f32_16x16x32_bf16 a[92:95], v[100:103], a[196:199], a[92:95]
ds_read_b64_tr_b16 a[196:197], v225 offset:49152
ds_read_b64_tr_b16 a[198:199], v225 offset:53248
v_mfma_f32_16x16x32_bf16 a[76:79], v[100:103], a[192:195], a[76:79]
v_exp_f32 v37, v37
v_mfma_f32_16x16x32_bf16 a[108:111], v[100:103], a[200:203], a[108:111]
ds_read_b64_tr_b16 a[192:193], v224 offset:49152
v_cvt_pk_bf16_f32 v86, v36, v37
v_mfma_f32_16x16x32_bf16 a[124:127], v[100:103], a[204:207], a[124:127]
v_exp_f32 v38, v38
v_mfma_f32_16x16x32_bf16 a[120:123], v[96:99], a[204:207], a[120:123]
ds_read_b64_tr_b16 a[194:195], v224 offset:53248
v_mfma_f32_16x16x32_bf16 a[104:107], v[96:99], a[200:203], a[104:107]
v_exp_f32 v39, v39
v_mfma_f32_16x16x32_bf16 a[100:103], v[92:95], a[200:203], a[100:103]
buffer_store_dwordx4 a[248:251], v238, s[20:23], s28 offen offset:0 sc0 sc1
v_cvt_pk_bf16_f32 v87, v38, v39
v_mfma_f32_16x16x32_bf16 a[116:119], v[92:95], a[204:207], a[116:119]
v_mfma_f32_16x16x32_bf16 a[112:115], v[88:91], a[204:207], a[112:115]
ds_read_b64_tr_b16 a[204:205], v227 offset:49152
ds_read_b64_tr_b16 a[206:207], v227 offset:53248
v_mfma_f32_16x16x32_bf16 a[96:99], v[88:91], a[200:203], a[96:99]
ds_read_b64_tr_b16 a[200:201], v226 offset:49152
ds_read_b64_tr_b16 a[202:203], v226 offset:53248
v_smfmac_f32_16x16x64_bf16 a[132:135], a[208:211], v[96:103], v245
buffer_store_dwordx4 a[212:215], v238, s[20:23], s28 offen offset:512 sc0 sc1
v_mfma_f32_16x16x32_bf16 v[8:11], a[144:147], v[152:155], v[136:139]
v_exp_f32 v40, v40
v_mfma_f32_16x16x32_bf16 v[8:11], a[148:151], v[156:159], v[8:11]
v_exp_f32 v41, v41
v_mfma_f32_16x16x32_bf16 v[8:11], a[152:155], v[160:163], v[8:11]
buffer_store_dwordx4 a[216:219], v238, s[20:23], s28 offen offset:1024 sc0 sc1
v_cvt_pk_bf16_f32 v88, v40, v41
v_mfma_f32_16x16x32_bf16 v[8:11], a[156:159], v[164:167], v[8:11]
v_exp_f32 v42, v42
v_mfma_f32_16x16x32_bf16 v[16:19], a[156:159], v[180:183], v[140:143]
s_add_u32 s39, s39, 16384
buffer_store_dwordx4 a[220:223], v238, s[20:23], s28 offen offset:1536 sc0 sc1
v_mfma_f32_16x16x32_bf16 v[16:19], a[152:155], v[176:179], v[16:19]
v_exp_f32 v43, v43
v_mfma_f32_16x16x32_bf16 v[16:19], a[148:151], v[172:175], v[16:19]
v_cvt_pk_bf16_f32 v89, v42, v43
v_mfma_f32_16x16x32_bf16 v[16:19], a[144:147], v[168:171], v[16:19]
v_exp_f32 v44, v44
v_mfma_f32_16x16x32_bf16 v[24:27], a[144:147], v[184:187], v[144:147]
buffer_store_dwordx4 a[224:227], v238, s[20:23], s28 offen offset:2048 sc0 sc1
v_mfma_f32_16x16x32_bf16 v[24:27], a[148:151], v[188:191], v[24:27]
v_exp_f32 v45, v45
v_mfma_f32_16x16x32_bf16 v[24:27], a[152:155], v[192:195], v[24:27]
v_cvt_pk_bf16_f32 v90, v44, v45
v_mfma_f32_16x16x32_bf16 v[24:27], a[156:159], v[196:199], v[24:27]
v_exp_f32 v46, v46
v_mfma_f32_16x16x32_bf16 v[32:35], a[156:159], v[212:215], v[148:151]
ds_read_b128 a[156:159], v219 offset:8192
s_add_u32 m0, s30, 131072
v_mfma_f32_16x16x32_bf16 v[32:35], a[152:155], v[208:211], v[32:35]
v_exp_f32 v47, v47
v_mfma_f32_16x16x32_bf16 v[32:35], a[148:151], v[204:207], v[32:35]
ds_read_b128 a[152:155], v218 offset:8192
v_cvt_pk_bf16_f32 v91, v46, v47
v_mfma_f32_16x16x32_bf16 v[32:35], a[144:147], v[200:203], v[32:35]
v_exp_f32 v48, v48
v_mfma_f32_16x16x32_bf16 a[0:3], v[72:75], a[176:179], a[0:3]
ds_read_b128 a[148:151], v217 offset:8192
ds_read_b128 a[144:147], v216 offset:8192
v_mfma_f32_16x16x32_bf16 a[16:19], v[72:75], a[180:183], a[16:19]
v_exp_f32 v49, v49
v_mfma_f32_16x16x32_bf16 a[20:23], v[76:79], a[180:183], a[20:23]
v_cvt_pk_bf16_f32 v92, v48, v49
v_mfma_f32_16x16x32_bf16 a[4:7], v[76:79], a[176:179], a[4:7]
v_exp_f32 v50, v50
v_mfma_f32_16x16x32_bf16 a[8:11], v[80:83], a[176:179], a[8:11]
buffer_store_dwordx4 a[228:231], v238, s[20:23], s28 offen offset:2560 sc0 sc1
v_mfma_f32_16x16x32_bf16 a[24:27], v[80:83], a[180:183], a[24:27]
v_exp_f32 v51, v51
v_mfma_f32_16x16x32_bf16 a[28:31], v[84:87], a[180:183], a[28:31]
ds_read_b64_tr_b16 a[180:181], v221 offset:57344
v_cvt_pk_bf16_f32 v93, v50, v51
v_mfma_f32_16x16x32_bf16 a[12:15], v[84:87], a[176:179], a[12:15]
v_exp_f32 v52, v52
s_waitcnt lgkmcnt(8)
v_mfma_f32_16x16x32_bf16 a[44:47], v[84:87], a[184:187], a[44:47]
ds_read_b64_tr_b16 a[182:183], v221 offset:61440
ds_read_b64_tr_b16 a[176:177], v220 offset:57344
v_mfma_f32_16x16x32_bf16 a[60:63], v[84:87], a[188:191], a[60:63]
v_exp_f32 v53, v53
v_mfma_f32_16x16x32_bf16 a[56:59], v[80:83], a[188:191], a[56:59]
ds_read_b64_tr_b16 a[178:179], v220 offset:61440
v_cvt_pk_bf16_f32 v94, v52, v53
v_mfma_f32_16x16x32_bf16 a[40:43], v[80:83], a[184:187], a[40:43]
v_exp_f32 v54, v54
v_mfma_f32_16x16x32_bf16 a[36:39], v[76:79], a[184:187], a[36:39]
buffer_load_dwordx4 v232, s[12:15], s39 offen offset:0  lds
v_mfma_f32_16x16x32_bf16 a[52:55], v[76:79], a[188:191], a[52:55]
v_exp_f32 v55, v55
v_mfma_f32_16x16x32_bf16 a[48:51], v[72:75], a[188:191], a[48:51]
ds_read_b64_tr_b16 a[188:189], v223 offset:57344
v_cvt_pk_bf16_f32 v95, v54, v55
v_mfma_f32_16x16x32_bf16 a[32:35], v[72:75], a[184:187], a[32:35]
v_exp_f32 v56, v56
v_smfmac_f32_16x16x64_bf16 a[128:131], a[208:211], v[72:79], v245
ds_read_b64_tr_b16 a[190:191], v223 offset:61440
v_mfma_f32_16x16x32_bf16 v[12:15], a[160:163], v[152:155], v[136:139]
v_exp_f32 v57, v57
v_mfma_f32_16x16x32_bf16 v[12:15], a[164:167], v[156:159], v[12:15]
v_exp_f32 v58, v58
v_mfma_f32_16x16x32_bf16 v[12:15], a[168:171], v[160:163], v[12:15]
ds_read_b64_tr_b16 a[184:185], v222 offset:57344
v_cvt_pk_bf16_f32 v96, v56, v57
v_mfma_f32_16x16x32_bf16 v[12:15], a[172:175], v[164:167], v[12:15]
v_exp_f32 v59, v59
v_mfma_f32_16x16x32_bf16 v[20:23], a[172:175], v[180:183], v[140:143]
ds_read_b64_tr_b16 a[186:187], v222 offset:61440
v_cvt_pk_bf16_f32 v97, v58, v59
v_mfma_f32_16x16x32_bf16 v[20:23], a[168:171], v[176:179], v[20:23]
v_exp_f32 v60, v60
v_mfma_f32_16x16x32_bf16 v[20:23], a[164:167], v[172:175], v[20:23]
buffer_load_dwordx4 v233, s[12:15], s39 offen offset:1024  lds
v_mfma_f32_16x16x32_bf16 v[20:23], a[160:163], v[168:171], v[20:23]
v_exp_f32 v61, v61
v_mfma_f32_16x16x32_bf16 v[28:31], a[160:163], v[184:187], v[144:147]
buffer_store_dwordx4 a[232:235], v238, s[20:23], s28 offen offset:3072 sc0 sc1
v_cvt_pk_bf16_f32 v98, v60, v61
v_mfma_f32_16x16x32_bf16 v[28:31], a[164:167], v[188:191], v[28:31]
v_exp_f32 v62, v62
v_mfma_f32_16x16x32_bf16 v[28:31], a[168:171], v[192:195], v[28:31]
buffer_load_dwordx4 v232, s[12:15], s39 offen offset:2048  lds
v_mfma_f32_16x16x32_bf16 v[28:31], a[172:175], v[196:199], v[28:31]
v_exp_f32 v63, v63
v_mfma_f32_16x16x32_bf16 v[36:39], a[172:175], v[212:215], v[148:151]
ds_read_b128 a[172:175], v219 offset:12288
v_cvt_pk_bf16_f32 v99, v62, v63
v_mfma_f32_16x16x32_bf16 v[36:39], a[168:171], v[208:211], v[36:39]
v_exp_f32 v64, v64
v_mfma_f32_16x16x32_bf16 v[36:39], a[164:167], v[204:207], v[36:39]
ds_read_b128 a[168:171], v218 offset:12288
ds_read_b128 a[164:167], v217 offset:12288
v_mfma_f32_16x16x32_bf16 v[36:39], a[160:163], v[200:203], v[36:39]
v_exp_f32 v65, v65
v_mfma_f32_16x16x32_bf16 a[64:67], v[72:75], a[192:195], a[64:67]
ds_read_b128 a[160:163], v216 offset:12288
v_cvt_pk_bf16_f32 v100, v64, v65
v_mfma_f32_16x16x32_bf16 a[80:83], v[72:75], a[196:199], a[80:83]
v_exp_f32 v66, v66
v_mfma_f32_16x16x32_bf16 a[84:87], v[76:79], a[196:199], a[84:87]
buffer_load_dwordx4 v233, s[12:15], s39 offen offset:3072  lds
v_mfma_f32_16x16x32_bf16 a[68:71], v[76:79], a[192:195], a[68:71]
v_exp_f32 v67, v67
v_mfma_f32_16x16x32_bf16 a[72:75], v[80:83], a[192:195], a[72:75]
buffer_store_dwordx4 a[236:239], v238, s[20:23], s28 offen offset:3584 sc0 sc1
v_cvt_pk_bf16_f32 v101, v66, v67
v_mfma_f32_16x16x32_bf16 a[88:91], v[80:83], a[196:199], a[88:91]
v_exp_f32 v68, v68
v_mfma_f32_16x16x32_bf16 a[92:95], v[84:87], a[196:199], a[92:95]
ds_read_b64_tr_b16 a[196:197], v225 offset:57344
ds_read_b64_tr_b16 a[198:199], v225 offset:61440
v_mfma_f32_16x16x32_bf16 a[76:79], v[84:87], a[192:195], a[76:79]
v_exp_f32 v69, v69
s_waitcnt lgkmcnt(8)
v_mfma_f32_16x16x32_bf16 a[108:111], v[84:87], a[200:203], a[108:111]
ds_read_b64_tr_b16 a[192:193], v224 offset:57344
v_cvt_pk_bf16_f32 v102, v68, v69
v_mfma_f32_16x16x32_bf16 a[124:127], v[84:87], a[204:207], a[124:127]
v_exp_f32 v70, v70
v_mfma_f32_16x16x32_bf16 a[120:123], v[80:83], a[204:207], a[120:123]
ds_read_b64_tr_b16 a[194:195], v224 offset:61440
v_mfma_f32_16x16x32_bf16 a[104:107], v[80:83], a[200:203], a[104:107]
v_exp_f32 v71, v71
v_mfma_f32_16x16x32_bf16 a[100:103], v[76:79], a[200:203], a[100:103]
v_cvt_pk_bf16_f32 v103, v70, v71
v_mfma_f32_16x16x32_bf16 a[116:119], v[76:79], a[204:207], a[116:119]
s_add_u32 s28, s28, 4096
buffer_store_dwordx4 a[240:243], v238, s[20:23], s28 offen offset:0 sc0 sc1
v_mfma_f32_16x16x32_bf16 a[112:115], v[72:75], a[204:207], a[112:115]
ds_read_b64_tr_b16 a[204:205], v227 offset:57344
ds_read_b64_tr_b16 a[206:207], v227 offset:61440
v_mfma_f32_16x16x32_bf16 a[96:99], v[72:75], a[200:203], a[96:99]
ds_read_b64_tr_b16 a[200:201], v226 offset:57344
ds_read_b64_tr_b16 a[202:203], v226 offset:61440
v_smfmac_f32_16x16x64_bf16 a[132:135], a[208:211], v[80:87], v245
s_mov_b32 s33, 6
K_LOOPIN:
s_waitcnt lgkmcnt(0)
v_lshlrev_b32 v241, 4, v1
s_mov_b32 s46, s44
.p2align 6
K_LOOP:
s_cmp_eq_u32 s33, s3
s_cbranch_scc1 K_EVT
K_EVT_RET:
v_mfma_f32_16x16x32_bf16 v[40:43], a[144:147], v[152:155], v[136:139]
v_exp_f32 v8, v8
v_mfma_f32_16x16x32_bf16 v[40:43], a[148:151], v[156:159], v[40:43]
v_exp_f32 v9, v9
v_mfma_f32_16x16x32_bf16 v[40:43], a[152:155], v[160:163], v[40:43]
v_cvt_pk_bf16_f32 v72, v8, v9
v_mfma_f32_16x16x32_bf16 v[40:43], a[156:159], v[164:167], v[40:43]
v_exp_f32 v10, v10
v_mfma_f32_16x16x32_bf16 v[48:51], a[156:159], v[180:183], v[140:143]
v_mfma_f32_16x16x32_bf16 v[48:51], a[152:155], v[176:179], v[48:51]
v_exp_f32 v11, v11
v_mfma_f32_16x16x32_bf16 v[48:51], a[148:151], v[172:175], v[48:51]
v_cvt_pk_bf16_f32 v73, v10, v11
v_mfma_f32_16x16x32_bf16 v[48:51], a[144:147], v[168:171], v[48:51]
v_exp_f32 v12, v12
v_mfma_f32_16x16x32_bf16 v[56:59], a[144:147], v[184:187], v[144:147]
v_mfma_f32_16x16x32_bf16 v[56:59], a[148:151], v[188:191], v[56:59]
v_exp_f32 v13, v13
v_mfma_f32_16x16x32_bf16 v[56:59], a[152:155], v[192:195], v[56:59]
v_cvt_pk_bf16_f32 v74, v12, v13
v_mfma_f32_16x16x32_bf16 v[56:59], a[156:159], v[196:199], v[56:59]
v_exp_f32 v14, v14
v_mfma_f32_16x16x32_bf16 v[64:67], a[156:159], v[212:215], v[148:151]
s_waitcnt vmcnt(10) lgkmcnt(0)
s_barrier
v_mfma_f32_16x16x32_bf16 v[64:67], a[152:155], v[208:211], v[64:67]
v_exp_f32 v15, v15
v_mfma_f32_16x16x32_bf16 v[64:67], a[148:151], v[204:207], v[64:67]
ds_read_b128 a[156:159], v219 offset:16384
v_cvt_pk_bf16_f32 v75, v14, v15
v_mfma_f32_16x16x32_bf16 v[64:67], a[144:147], v[200:203], v[64:67]
v_exp_f32 v16, v16
v_mfma_f32_16x16x32_bf16 a[0:3], v[88:91], a[176:179], a[0:3]
ds_read_b128 a[152:155], v218 offset:16384
ds_read_b128 a[148:151], v217 offset:16384
v_mfma_f32_16x16x32_bf16 a[16:19], v[88:91], a[180:183], a[16:19]
v_exp_f32 v17, v17
v_mfma_f32_16x16x32_bf16 a[20:23], v[92:95], a[180:183], a[20:23]
ds_read_b128 a[144:147], v216 offset:16384
v_cvt_pk_bf16_f32 v76, v16, v17
v_mfma_f32_16x16x32_bf16 a[4:7], v[92:95], a[176:179], a[4:7]
v_exp_f32 v18, v18
v_mfma_f32_16x16x32_bf16 a[8:11], v[96:99], a[176:179], a[8:11]
s_add_u32 s32, s32, 16384
s_add_u32 m0, s30, 65536
v_mfma_f32_16x16x32_bf16 a[24:27], v[96:99], a[180:183], a[24:27]
v_exp_f32 v19, v19
v_mfma_f32_16x16x32_bf16 a[28:31], v[100:103], a[180:183], a[28:31]
ds_read_b64_tr_b16 a[180:181], v221 offset:0
v_cvt_pk_bf16_f32 v77, v18, v19
v_mfma_f32_16x16x32_bf16 a[12:15], v[100:103], a[176:179], a[12:15]
v_exp_f32 v20, v20
v_mfma_f32_16x16x32_bf16 a[44:47], v[100:103], a[184:187], a[44:47]
ds_read_b64_tr_b16 a[182:183], v221 offset:4096
ds_read_b64_tr_b16 a[176:177], v220 offset:0
v_mfma_f32_16x16x32_bf16 a[60:63], v[100:103], a[188:191], a[60:63]
v_exp_f32 v21, v21
v_mfma_f32_16x16x32_bf16 a[56:59], v[96:99], a[188:191], a[56:59]
ds_read_b64_tr_b16 a[178:179], v220 offset:4096
v_cvt_pk_bf16_f32 v78, v20, v21
v_mfma_f32_16x16x32_bf16 a[40:43], v[96:99], a[184:187], a[40:43]
v_exp_f32 v22, v22
v_mfma_f32_16x16x32_bf16 a[36:39], v[92:95], a[184:187], a[36:39]
buffer_load_dwordx4 v228, s[8:11], s32 offen offset:0  lds
v_mfma_f32_16x16x32_bf16 a[52:55], v[92:95], a[188:191], a[52:55]
v_exp_f32 v23, v23
v_mfma_f32_16x16x32_bf16 a[48:51], v[88:91], a[188:191], a[48:51]
ds_read_b64_tr_b16 a[188:189], v223 offset:0
v_cvt_pk_bf16_f32 v79, v22, v23
v_mfma_f32_16x16x32_bf16 a[32:35], v[88:91], a[184:187], a[32:35]
v_exp_f32 v24, v24
v_smfmac_f32_16x16x64_bf16 a[128:131], a[208:211], v[88:95], v245
ds_read_b64_tr_b16 a[190:191], v223 offset:4096
v_mfma_f32_16x16x32_bf16 v[44:47], a[160:163], v[152:155], v[136:139]
v_exp_f32 v25, v25
v_mfma_f32_16x16x32_bf16 v[44:47], a[164:167], v[156:159], v[44:47]
v_exp_f32 v26, v26
v_mfma_f32_16x16x32_bf16 v[44:47], a[168:171], v[160:163], v[44:47]
ds_read_b64_tr_b16 a[184:185], v222 offset:0
v_cvt_pk_bf16_f32 v80, v24, v25
v_mfma_f32_16x16x32_bf16 v[44:47], a[172:175], v[164:167], v[44:47]
v_exp_f32 v27, v27
v_mfma_f32_16x16x32_bf16 v[52:55], a[172:175], v[180:183], v[140:143]
ds_read_b64_tr_b16 a[186:187], v222 offset:4096
v_cvt_pk_bf16_f32 v81, v26, v27
v_mfma_f32_16x16x32_bf16 v[52:55], a[168:171], v[176:179], v[52:55]
v_exp_f32 v28, v28
v_mfma_f32_16x16x32_bf16 v[52:55], a[164:167], v[172:175], v[52:55]
buffer_load_dwordx4 v229, s[8:11], s32 offen offset:1024  lds
v_mfma_f32_16x16x32_bf16 v[52:55], a[160:163], v[168:171], v[52:55]
v_exp_f32 v29, v29
v_mfma_f32_16x16x32_bf16 v[60:63], a[160:163], v[184:187], v[144:147]
v_cvt_pk_bf16_f32 v82, v28, v29
v_mfma_f32_16x16x32_bf16 v[60:63], a[164:167], v[188:191], v[60:63]
v_exp_f32 v30, v30
v_mfma_f32_16x16x32_bf16 v[60:63], a[168:171], v[192:195], v[60:63]
buffer_load_dwordx4 v230, s[8:11], s32 offen offset:2048  lds
v_mfma_f32_16x16x32_bf16 v[60:63], a[172:175], v[196:199], v[60:63]
v_exp_f32 v31, v31
v_mfma_f32_16x16x32_bf16 v[68:71], a[172:175], v[212:215], v[148:151]
ds_read_b128 a[172:175], v219 offset:20480
v_cvt_pk_bf16_f32 v83, v30, v31
v_mfma_f32_16x16x32_bf16 v[68:71], a[168:171], v[208:211], v[68:71]
v_exp_f32 v32, v32
v_mfma_f32_16x16x32_bf16 v[68:71], a[164:167], v[204:207], v[68:71]
ds_read_b128 a[168:171], v218 offset:20480
ds_read_b128 a[164:167], v217 offset:20480
v_mfma_f32_16x16x32_bf16 v[68:71], a[160:163], v[200:203], v[68:71]
v_exp_f32 v33, v33
v_mfma_f32_16x16x32_bf16 a[64:67], v[88:91], a[192:195], a[64:67]
ds_read_b128 a[160:163], v216 offset:20480
v_cvt_pk_bf16_f32 v84, v32, v33
v_mfma_f32_16x16x32_bf16 a[80:83], v[88:91], a[196:199], a[80:83]
v_exp_f32 v34, v34
v_mfma_f32_16x16x32_bf16 a[84:87], v[92:95], a[196:199], a[84:87]
buffer_load_dwordx4 v231, s[8:11], s32 offen offset:3072  lds
v_mfma_f32_16x16x32_bf16 a[68:71], v[92:95], a[192:195], a[68:71]
v_exp_f32 v35, v35
v_mfma_f32_16x16x32_bf16 a[72:75], v[96:99], a[192:195], a[72:75]
v_cvt_pk_bf16_f32 v85, v34, v35
v_mfma_f32_16x16x32_bf16 a[88:91], v[96:99], a[196:199], a[88:91]
v_exp_f32 v36, v36
v_mfma_f32_16x16x32_bf16 a[92:95], v[100:103], a[196:199], a[92:95]
ds_read_b64_tr_b16 a[196:197], v225 offset:0
ds_read_b64_tr_b16 a[198:199], v225 offset:4096
v_mfma_f32_16x16x32_bf16 a[76:79], v[100:103], a[192:195], a[76:79]
v_exp_f32 v37, v37
v_mfma_f32_16x16x32_bf16 a[108:111], v[100:103], a[200:203], a[108:111]
ds_read_b64_tr_b16 a[192:193], v224 offset:0
v_cvt_pk_bf16_f32 v86, v36, v37
v_mfma_f32_16x16x32_bf16 a[124:127], v[100:103], a[204:207], a[124:127]
v_exp_f32 v38, v38
v_mfma_f32_16x16x32_bf16 a[120:123], v[96:99], a[204:207], a[120:123]
ds_read_b64_tr_b16 a[194:195], v224 offset:4096
v_mfma_f32_16x16x32_bf16 a[104:107], v[96:99], a[200:203], a[104:107]
v_exp_f32 v39, v39
v_mfma_f32_16x16x32_bf16 a[100:103], v[92:95], a[200:203], a[100:103]
v_cvt_pk_bf16_f32 v87, v38, v39
v_mfma_f32_16x16x32_bf16 a[116:119], v[92:95], a[204:207], a[116:119]
s_mov_b32 m0, s87
s_lshl2_add_u32 s50, s87, s89
buffer_load_dwordx4 v243, s[56:59], s50 offen  lds
v_mfma_f32_16x16x32_bf16 a[112:115], v[88:91], a[204:207], a[112:115]
ds_read_b64_tr_b16 a[204:205], v227 offset:0
ds_read_b64_tr_b16 a[206:207], v227 offset:4096
v_mfma_f32_16x16x32_bf16 a[96:99], v[88:91], a[200:203], a[96:99]
ds_read_b64_tr_b16 a[200:201], v226 offset:0
ds_read_b64_tr_b16 a[202:203], v226 offset:4096
v_smfmac_f32_16x16x64_bf16 a[132:135], a[208:211], v[96:103], v245
s_add_u32 s87, s87, 3456
s_min_u32 s87, s87, 63936
s_waitcnt lgkmcnt(8)
v_mfma_f32_16x16x32_bf16 v[8:11], a[144:147], v[152:155], v[136:139]
v_exp_f32 v40, v40
v_mfma_f32_16x16x32_bf16 v[8:11], a[148:151], v[156:159], v[8:11]
v_exp_f32 v41, v41
v_mfma_f32_16x16x32_bf16 v[8:11], a[152:155], v[160:163], v[8:11]
v_cvt_pk_bf16_f32 v88, v40, v41
v_mfma_f32_16x16x32_bf16 v[8:11], a[156:159], v[164:167], v[8:11]
v_exp_f32 v42, v42
v_mfma_f32_16x16x32_bf16 v[16:19], a[156:159], v[180:183], v[140:143]
s_add_u32 s39, s39, 16384
v_mfma_f32_16x16x32_bf16 v[16:19], a[152:155], v[176:179], v[16:19]
v_exp_f32 v43, v43
v_mfma_f32_16x16x32_bf16 v[16:19], a[148:151], v[172:175], v[16:19]
v_cvt_pk_bf16_f32 v89, v42, v43
v_mfma_f32_16x16x32_bf16 v[16:19], a[144:147], v[168:171], v[16:19]
v_exp_f32 v44, v44
v_mfma_f32_16x16x32_bf16 v[24:27], a[144:147], v[184:187], v[144:147]
v_mfma_f32_16x16x32_bf16 v[24:27], a[148:151], v[188:191], v[24:27]
v_exp_f32 v45, v45
v_mfma_f32_16x16x32_bf16 v[24:27], a[152:155], v[192:195], v[24:27]
s_add_u32 m0, s30, 147456
v_cvt_pk_bf16_f32 v90, v44, v45
v_mfma_f32_16x16x32_bf16 v[24:27], a[156:159], v[196:199], v[24:27]
v_exp_f32 v46, v46
v_mfma_f32_16x16x32_bf16 v[32:35], a[156:159], v[212:215], v[148:151]
ds_read_b128 a[156:159], v219 offset:24576
v_mfma_f32_16x16x32_bf16 v[32:35], a[152:155], v[208:211], v[32:35]
v_exp_f32 v47, v47
v_mfma_f32_16x16x32_bf16 v[32:35], a[148:151], v[204:207], v[32:35]
ds_read_b128 a[152:155], v218 offset:24576
v_cvt_pk_bf16_f32 v91, v46, v47
v_mfma_f32_16x16x32_bf16 v[32:35], a[144:147], v[200:203], v[32:35]
v_exp_f32 v48, v48
v_mfma_f32_16x16x32_bf16 a[0:3], v[72:75], a[176:179], a[0:3]
ds_read_b128 a[148:151], v217 offset:24576
ds_read_b128 a[144:147], v216 offset:24576
v_mfma_f32_16x16x32_bf16 a[16:19], v[72:75], a[180:183], a[16:19]
v_exp_f32 v49, v49
v_mfma_f32_16x16x32_bf16 a[20:23], v[76:79], a[180:183], a[20:23]
v_cvt_pk_bf16_f32 v92, v48, v49
v_mfma_f32_16x16x32_bf16 a[4:7], v[76:79], a[176:179], a[4:7]
v_exp_f32 v50, v50
v_mfma_f32_16x16x32_bf16 a[8:11], v[80:83], a[176:179], a[8:11]
buffer_load_dwordx4 v232, s[12:15], s39 offen offset:0  lds
v_mfma_f32_16x16x32_bf16 a[24:27], v[80:83], a[180:183], a[24:27]
v_exp_f32 v51, v51
v_mfma_f32_16x16x32_bf16 a[28:31], v[84:87], a[180:183], a[28:31]
ds_read_b64_tr_b16 a[180:181], v221 offset:8192
v_cvt_pk_bf16_f32 v93, v50, v51
v_mfma_f32_16x16x32_bf16 a[12:15], v[84:87], a[176:179], a[12:15]
v_exp_f32 v52, v52
v_mfma_f32_16x16x32_bf16 a[44:47], v[84:87], a[184:187], a[44:47]
ds_read_b64_tr_b16 a[182:183], v221 offset:12288
ds_read_b64_tr_b16 a[176:177], v220 offset:8192
v_mfma_f32_16x16x32_bf16 a[60:63], v[84:87], a[188:191], a[60:63]
v_exp_f32 v53, v53
v_mfma_f32_16x16x32_bf16 a[56:59], v[80:83], a[188:191], a[56:59]
ds_read_b64_tr_b16 a[178:179], v220 offset:12288
v_cvt_pk_bf16_f32 v94, v52, v53
v_mfma_f32_16x16x32_bf16 a[40:43], v[80:83], a[184:187], a[40:43]
v_exp_f32 v54, v54
v_mfma_f32_16x16x32_bf16 a[36:39], v[76:79], a[184:187], a[36:39]
buffer_load_dwordx4 v233, s[12:15], s39 offen offset:1024  lds
v_mfma_f32_16x16x32_bf16 a[52:55], v[76:79], a[188:191], a[52:55]
v_exp_f32 v55, v55
v_mfma_f32_16x16x32_bf16 a[48:51], v[72:75], a[188:191], a[48:51]
ds_read_b64_tr_b16 a[188:189], v223 offset:8192
v_cvt_pk_bf16_f32 v95, v54, v55
v_mfma_f32_16x16x32_bf16 a[32:35], v[72:75], a[184:187], a[32:35]
v_exp_f32 v56, v56
v_smfmac_f32_16x16x64_bf16 a[128:131], a[208:211], v[72:79], v245
ds_read_b64_tr_b16 a[190:191], v223 offset:12288
v_mfma_f32_16x16x32_bf16 v[12:15], a[160:163], v[152:155], v[136:139]
v_exp_f32 v57, v57
v_mfma_f32_16x16x32_bf16 v[12:15], a[164:167], v[156:159], v[12:15]
v_exp_f32 v58, v58
v_mfma_f32_16x16x32_bf16 v[12:15], a[168:171], v[160:163], v[12:15]
ds_read_b64_tr_b16 a[184:185], v222 offset:8192
v_cvt_pk_bf16_f32 v96, v56, v57
v_mfma_f32_16x16x32_bf16 v[12:15], a[172:175], v[164:167], v[12:15]
v_exp_f32 v59, v59
v_mfma_f32_16x16x32_bf16 v[20:23], a[172:175], v[180:183], v[140:143]
ds_read_b64_tr_b16 a[186:187], v222 offset:12288
v_cvt_pk_bf16_f32 v97, v58, v59
v_mfma_f32_16x16x32_bf16 v[20:23], a[168:171], v[176:179], v[20:23]
v_exp_f32 v60, v60
v_mfma_f32_16x16x32_bf16 v[20:23], a[164:167], v[172:175], v[20:23]
buffer_load_dwordx4 v232, s[12:15], s39 offen offset:2048  lds
v_mfma_f32_16x16x32_bf16 v[20:23], a[160:163], v[168:171], v[20:23]
v_exp_f32 v61, v61
v_mfma_f32_16x16x32_bf16 v[28:31], a[160:163], v[184:187], v[144:147]
v_cvt_pk_bf16_f32 v98, v60, v61
v_mfma_f32_16x16x32_bf16 v[28:31], a[164:167], v[188:191], v[28:31]
v_exp_f32 v62, v62
v_mfma_f32_16x16x32_bf16 v[28:31], a[168:171], v[192:195], v[28:31]
buffer_load_dwordx4 v233, s[12:15], s39 offen offset:3072  lds
v_mfma_f32_16x16x32_bf16 v[28:31], a[172:175], v[196:199], v[28:31]
v_exp_f32 v63, v63
v_mfma_f32_16x16x32_bf16 v[36:39], a[172:175], v[212:215], v[148:151]
ds_read_b128 a[172:175], v219 offset:28672
v_cvt_pk_bf16_f32 v99, v62, v63
v_mfma_f32_16x16x32_bf16 v[36:39], a[168:171], v[208:211], v[36:39]
v_exp_f32 v64, v64
v_mfma_f32_16x16x32_bf16 v[36:39], a[164:167], v[204:207], v[36:39]
ds_read_b128 a[168:171], v218 offset:28672
ds_read_b128 a[164:167], v217 offset:28672
v_mfma_f32_16x16x32_bf16 v[36:39], a[160:163], v[200:203], v[36:39]
v_exp_f32 v65, v65
s_waitcnt lgkmcnt(8)
v_mfma_f32_16x16x32_bf16 a[64:67], v[72:75], a[192:195], a[64:67]
ds_read_b128 a[160:163], v216 offset:28672
v_cvt_pk_bf16_f32 v100, v64, v65
v_mfma_f32_16x16x32_bf16 a[80:83], v[72:75], a[196:199], a[80:83]
v_exp_f32 v66, v66
v_mfma_f32_16x16x32_bf16 a[84:87], v[76:79], a[196:199], a[84:87]
buffer_load_dword v242, v241, s[20:23], s46 offen sc1
v_mfma_f32_16x16x32_bf16 a[68:71], v[76:79], a[192:195], a[68:71]
v_exp_f32 v67, v67
v_mfma_f32_16x16x32_bf16 a[72:75], v[80:83], a[192:195], a[72:75]
v_cvt_pk_bf16_f32 v101, v66, v67
v_add_u32 v241, 1024, v241
v_mfma_f32_16x16x32_bf16 a[88:91], v[80:83], a[196:199], a[88:91]
v_exp_f32 v68, v68
v_mfma_f32_16x16x32_bf16 a[92:95], v[84:87], a[196:199], a[92:95]
ds_read_b64_tr_b16 a[196:197], v225 offset:8192
ds_read_b64_tr_b16 a[198:199], v225 offset:12288
v_mfma_f32_16x16x32_bf16 a[76:79], v[84:87], a[192:195], a[76:79]
v_exp_f32 v69, v69
v_mfma_f32_16x16x32_bf16 a[108:111], v[84:87], a[200:203], a[108:111]
ds_read_b64_tr_b16 a[192:193], v224 offset:8192
v_cvt_pk_bf16_f32 v102, v68, v69
v_mfma_f32_16x16x32_bf16 a[124:127], v[84:87], a[204:207], a[124:127]
v_exp_f32 v70, v70
v_mfma_f32_16x16x32_bf16 a[120:123], v[80:83], a[204:207], a[120:123]
ds_read_b64_tr_b16 a[194:195], v224 offset:12288
v_and_b32 v241, 0x3fff, v241
v_mfma_f32_16x16x32_bf16 a[104:107], v[80:83], a[200:203], a[104:107]
v_exp_f32 v71, v71
v_mfma_f32_16x16x32_bf16 a[100:103], v[76:79], a[200:203], a[100:103]
v_cvt_pk_bf16_f32 v103, v70, v71
v_mfma_f32_16x16x32_bf16 a[116:119], v[76:79], a[204:207], a[116:119]
v_mfma_f32_16x16x32_bf16 a[112:115], v[72:75], a[204:207], a[112:115]
ds_read_b64_tr_b16 a[204:205], v227 offset:8192
ds_read_b64_tr_b16 a[206:207], v227 offset:12288
v_mfma_f32_16x16x32_bf16 a[96:99], v[72:75], a[200:203], a[96:99]
ds_read_b64_tr_b16 a[200:201], v226 offset:8192
ds_read_b64_tr_b16 a[202:203], v226 offset:12288
v_smfmac_f32_16x16x64_bf16 a[132:135], a[208:211], v[80:87], v245
v_mfma_f32_16x16x32_bf16 v[40:43], a[144:147], v[152:155], v[136:139]
v_exp_f32 v8, v8
v_mfma_f32_16x16x32_bf16 v[40:43], a[148:151], v[156:159], v[40:43]
v_exp_f32 v9, v9
v_mfma_f32_16x16x32_bf16 v[40:43], a[152:155], v[160:163], v[40:43]
v_cvt_pk_bf16_f32 v72, v8, v9
v_mfma_f32_16x16x32_bf16 v[40:43], a[156:159], v[164:167], v[40:43]
v_exp_f32 v10, v10
v_mfma_f32_16x16x32_bf16 v[48:51], a[156:159], v[180:183], v[140:143]
v_mfma_f32_16x16x32_bf16 v[48:51], a[152:155], v[176:179], v[48:51]
v_exp_f32 v11, v11
v_mfma_f32_16x16x32_bf16 v[48:51], a[148:151], v[172:175], v[48:51]
v_cvt_pk_bf16_f32 v73, v10, v11
v_mfma_f32_16x16x32_bf16 v[48:51], a[144:147], v[168:171], v[48:51]
v_exp_f32 v12, v12
v_mfma_f32_16x16x32_bf16 v[56:59], a[144:147], v[184:187], v[144:147]
v_mfma_f32_16x16x32_bf16 v[56:59], a[148:151], v[188:191], v[56:59]
v_exp_f32 v13, v13
v_mfma_f32_16x16x32_bf16 v[56:59], a[152:155], v[192:195], v[56:59]
v_cvt_pk_bf16_f32 v74, v12, v13
v_mfma_f32_16x16x32_bf16 v[56:59], a[156:159], v[196:199], v[56:59]
v_exp_f32 v14, v14
v_mfma_f32_16x16x32_bf16 v[64:67], a[156:159], v[212:215], v[148:151]
s_waitcnt vmcnt(10) lgkmcnt(0)
s_barrier
v_mfma_f32_16x16x32_bf16 v[64:67], a[152:155], v[208:211], v[64:67]
v_exp_f32 v15, v15
v_mfma_f32_16x16x32_bf16 v[64:67], a[148:151], v[204:207], v[64:67]
ds_read_b128 a[156:159], v219 offset:49152
v_cvt_pk_bf16_f32 v75, v14, v15
v_mfma_f32_16x16x32_bf16 v[64:67], a[144:147], v[200:203], v[64:67]
v_exp_f32 v16, v16
v_mfma_f32_16x16x32_bf16 a[0:3], v[88:91], a[176:179], a[0:3]
ds_read_b128 a[152:155], v218 offset:49152
ds_read_b128 a[148:151], v217 offset:49152
v_mfma_f32_16x16x32_bf16 a[16:19], v[88:91], a[180:183], a[16:19]
STUB_10:
STUB_B1:
s_cbranch_execz STUB_13
v_exp_f32 v17, v17
v_mfma_f32_16x16x32_bf16 a[20:23], v[92:95], a[180:183], a[20:23]
ds_read_b128 a[144:147], v216 offset:49152
v_cvt_pk_bf16_f32 v76, v16, v17
v_mfma_f32_16x16x32_bf16 a[4:7], v[92:95], a[176:179], a[4:7]
v_exp_f32 v18, v18
v_mfma_f32_16x16x32_bf16 a[8:11], v[96:99], a[176:179], a[8:11]
s_add_u32 s32, s32, 16384
s_add_u32 m0, s30, 81920
v_mfma_f32_16x16x32_bf16 a[24:27], v[96:99], a[180:183], a[24:27]
v_exp_f32 v19, v19
v_mfma_f32_16x16x32_bf16 a[28:31], v[100:103], a[180:183], a[28:31]
ds_read_b64_tr_b16 a[180:181], v221 offset:32768
v_cvt_pk_bf16_f32 v77, v18, v19
v_mfma_f32_16x16x32_bf16 a[12:15], v[100:103], a[176:179], a[12:15]
v_exp_f32 v20, v20
v_mfma_f32_16x16x32_bf16 a[44:47], v[100:103], a[184:187], a[44:47]
ds_read_b64_tr_b16 a[182:183], v221 offset:36864
ds_read_b64_tr_b16 a[176:177], v220 offset:32768
v_mfma_f32_16x16x32_bf16 a[60:63], v[100:103], a[188:191], a[60:63]
v_exp_f32 v21, v21
v_mfma_f32_16x16x32_bf16 a[56:59], v[96:99], a[188:191], a[56:59]
ds_read_b64_tr_b16 a[178:179], v220 offset:36864
v_cvt_pk_bf16_f32 v78, v20, v21
v_mfma_f32_16x16x32_bf16 a[40:43], v[96:99], a[184:187], a[40:43]
v_exp_f32 v22, v22
v_mfma_f32_16x16x32_bf16 a[36:39], v[92:95], a[184:187], a[36:39]
buffer_load_dwordx4 v228, s[8:11], s32 offen offset:0  lds
v_mfma_f32_16x16x32_bf16 a[52:55], v[92:95], a[188:191], a[52:55]
v_exp_f32 v23, v23
v_mfma_f32_16x16x32_bf16 a[48:51], v[88:91], a[188:191], a[48:51]
ds_read_b64_tr_b16 a[188:189], v223 offset:32768
v_cvt_pk_bf16_f32 v79, v22, v23
v_mfma_f32_16x16x32_bf16 a[32:35], v[88:91], a[184:187], a[32:35]
v_exp_f32 v24, v24
v_smfmac_f32_16x16x64_bf16 a[128:131], a[208:211], v[88:95], v245
ds_read_b64_tr_b16 a[190:191], v223 offset:36864
v_mfma_f32_16x16x32_bf16 v[44:47], a[160:163], v[152:155], v[136:139]
v_exp_f32 v25, v25
v_mfma_f32_16x16x32_bf16 v[44:47], a[164:167], v[156:159], v[44:47]
v_exp_f32 v26, v26
v_mfma_f32_16x16x32_bf16 v[44:47], a[168:171], v[160:163], v[44:47]
ds_read_b64_tr_b16 a[184:185], v222 offset:32768
v_cvt_pk_bf16_f32 v80, v24, v25
v_mfma_f32_16x16x32_bf16 v[44:47], a[172:175], v[164:167], v[44:47]
v_exp_f32 v27, v27
v_mfma_f32_16x16x32_bf16 v[52:55], a[172:175], v[180:183], v[140:143]
ds_read_b64_tr_b16 a[186:187], v222 offset:36864
v_cvt_pk_bf16_f32 v81, v26, v27
v_mfma_f32_16x16x32_bf16 v[52:55], a[168:171], v[176:179], v[52:55]
v_exp_f32 v28, v28
v_mfma_f32_16x16x32_bf16 v[52:55], a[164:167], v[172:175], v[52:55]
buffer_load_dwordx4 v229, s[8:11], s32 offen offset:1024  lds
v_mfma_f32_16x16x32_bf16 v[52:55], a[160:163], v[168:171], v[52:55]
v_exp_f32 v29, v29
v_mfma_f32_16x16x32_bf16 v[60:63], a[160:163], v[184:187], v[144:147]
v_cvt_pk_bf16_f32 v82, v28, v29
v_mfma_f32_16x16x32_bf16 v[60:63], a[164:167], v[188:191], v[60:63]
v_exp_f32 v30, v30
v_mfma_f32_16x16x32_bf16 v[60:63], a[168:171], v[192:195], v[60:63]
buffer_load_dwordx4 v230, s[8:11], s32 offen offset:2048  lds
v_mfma_f32_16x16x32_bf16 v[60:63], a[172:175], v[196:199], v[60:63]
v_exp_f32 v31, v31
v_mfma_f32_16x16x32_bf16 v[68:71], a[172:175], v[212:215], v[148:151]
ds_read_b128 a[172:175], v219 offset:53248
v_cvt_pk_bf16_f32 v83, v30, v31
v_mfma_f32_16x16x32_bf16 v[68:71], a[168:171], v[208:211], v[68:71]
v_exp_f32 v32, v32
v_mfma_f32_16x16x32_bf16 v[68:71], a[164:167], v[204:207], v[68:71]
ds_read_b128 a[168:171], v218 offset:53248
ds_read_b128 a[164:167], v217 offset:53248
v_mfma_f32_16x16x32_bf16 v[68:71], a[160:163], v[200:203], v[68:71]
v_exp_f32 v33, v33
v_mfma_f32_16x16x32_bf16 a[64:67], v[88:91], a[192:195], a[64:67]
ds_read_b128 a[160:163], v216 offset:53248
v_cvt_pk_bf16_f32 v84, v32, v33
v_mfma_f32_16x16x32_bf16 a[80:83], v[88:91], a[196:199], a[80:83]
v_exp_f32 v34, v34
v_mfma_f32_16x16x32_bf16 a[84:87], v[92:95], a[196:199], a[84:87]
buffer_load_dwordx4 v231, s[8:11], s32 offen offset:3072  lds
v_mfma_f32_16x16x32_bf16 a[68:71], v[92:95], a[192:195], a[68:71]
v_exp_f32 v35, v35
v_mfma_f32_16x16x32_bf16 a[72:75], v[96:99], a[192:195], a[72:75]
v_cvt_pk_bf16_f32 v85, v34, v35
v_mfma_f32_16x16x32_bf16 a[88:91], v[96:99], a[196:199], a[88:91]
v_exp_f32 v36, v36
v_mfma_f32_16x16x32_bf16 a[92:95], v[100:103], a[196:199], a[92:95]
ds_read_b64_tr_b16 a[196:197], v225 offset:32768
ds_read_b64_tr_b16 a[198:199], v225 offset:36864
v_mfma_f32_16x16x32_bf16 a[76:79], v[100:103], a[192:195], a[76:79]
v_exp_f32 v37, v37
v_mfma_f32_16x16x32_bf16 a[108:111], v[100:103], a[200:203], a[108:111]
ds_read_b64_tr_b16 a[192:193], v224 offset:32768
v_cvt_pk_bf16_f32 v86, v36, v37
v_mfma_f32_16x16x32_bf16 a[124:127], v[100:103], a[204:207], a[124:127]
v_exp_f32 v38, v38
v_mfma_f32_16x16x32_bf16 a[120:123], v[96:99], a[204:207], a[120:123]
ds_read_b64_tr_b16 a[194:195], v224 offset:36864
v_mfma_f32_16x16x32_bf16 a[104:107], v[96:99], a[200:203], a[104:107]
v_exp_f32 v39, v39
v_mfma_f32_16x16x32_bf16 a[100:103], v[92:95], a[200:203], a[100:103]
v_cvt_pk_bf16_f32 v87, v38, v39
v_mfma_f32_16x16x32_bf16 a[116:119], v[92:95], a[204:207], a[116:119]
s_mov_b32 m0, s87
s_lshl2_add_u32 s50, s87, s89
buffer_load_dwordx4 v243, s[56:59], s50 offen  lds
v_mfma_f32_16x16x32_bf16 a[112:115], v[88:91], a[204:207], a[112:115]
ds_read_b64_tr_b16 a[204:205], v227 offset:32768
ds_read_b64_tr_b16 a[206:207], v227 offset:36864
v_mfma_f32_16x16x32_bf16 a[96:99], v[88:91], a[200:203], a[96:99]
ds_read_b64_tr_b16 a[200:201], v226 offset:32768
ds_read_b64_tr_b16 a[202:203], v226 offset:36864
v_smfmac_f32_16x16x64_bf16 a[132:135], a[208:211], v[96:103], v245
s_add_u32 s87, s87, 3456
s_min_u32 s87, s87, 63936
s_waitcnt lgkmcnt(8)
v_mfma_f32_16x16x32_bf16 v[8:11], a[144:147], v[152:155], v[136:139]
v_exp_f32 v40, v40
v_mfma_f32_16x16x32_bf16 v[8:11], a[148:151], v[156:159], v[8:11]
v_exp_f32 v41, v41
v_mfma_f32_16x16x32_bf16 v[8:11], a[152:155], v[160:163], v[8:11]
v_cvt_pk_bf16_f32 v88, v40, v41
v_mfma_f32_16x16x32_bf16 v[8:11], a[156:159], v[164:167], v[8:11]
v_exp_f32 v42, v42
v_mfma_f32_16x16x32_bf16 v[16:19], a[156:159], v[180:183], v[140:143]
s_add_u32 s39, s39, 16384
v_mfma_f32_16x16x32_bf16 v[16:19], a[152:155], v[176:179], v[16:19]
v_exp_f32 v43, v43
v_mfma_f32_16x16x32_bf16 v[16:19], a[148:151], v[172:175], v[16:19]
v_cvt_pk_bf16_f32 v89, v42, v43
v_mfma_f32_16x16x32_bf16 v[16:19], a[144:147], v[168:171], v[16:19]
v_exp_f32 v44, v44
v_mfma_f32_16x16x32_bf16 v[24:27], a[144:147], v[184:187], v[144:147]
v_mfma_f32_16x16x32_bf16 v[24:27], a[148:151], v[188:191], v[24:27]
v_exp_f32 v45, v45
v_mfma_f32_16x16x32_bf16 v[24:27], a[152:155], v[192:195], v[24:27]
s_add_u32 m0, s30, 98304
v_cvt_pk_bf16_f32 v90, v44, v45
v_mfma_f32_16x16x32_bf16 v[24:27], a[156:159], v[196:199], v[24:27]
v_exp_f32 v46, v46
v_mfma_f32_16x16x32_bf16 v[32:35], a[156:159], v[212:215], v[148:151]
ds_read_b128 a[156:159], v219 offset:57344
v_mfma_f32_16x16x32_bf16 v[32:35], a[152:155], v[208:211], v[32:35]
v_exp_f32 v47, v47
v_mfma_f32_16x16x32_bf16 v[32:35], a[148:151], v[204:207], v[32:35]
ds_read_b128 a[152:155], v218 offset:57344
v_cvt_pk_bf16_f32 v91, v46, v47
v_mfma_f32_16x16x32_bf16 v[32:35], a[144:147], v[200:203], v[32:35]
v_exp_f32 v48, v48
v_mfma_f32_16x16x32_bf16 a[0:3], v[72:75], a[176:179], a[0:3]
ds_read_b128 a[148:151], v217 offset:57344
ds_read_b128 a[144:147], v216 offset:57344
v_mfma_f32_16x16x32_bf16 a[16:19], v[72:75], a[180:183], a[16:19]
v_exp_f32 v49, v49
v_mfma_f32_16x16x32_bf16 a[20:23], v[76:79], a[180:183], a[20:23]
v_cvt_pk_bf16_f32 v92, v48, v49
v_mfma_f32_16x16x32_bf16 a[4:7], v[76:79], a[176:179], a[4:7]
v_exp_f32 v50, v50
v_mfma_f32_16x16x32_bf16 a[8:11], v[80:83], a[176:179], a[8:11]
buffer_load_dwordx4 v232, s[12:15], s39 offen offset:0  lds
v_mfma_f32_16x16x32_bf16 a[24:27], v[80:83], a[180:183], a[24:27]
v_exp_f32 v51, v51
v_mfma_f32_16x16x32_bf16 a[28:31], v[84:87], a[180:183], a[28:31]
ds_read_b64_tr_b16 a[180:181], v221 offset:40960
v_cvt_pk_bf16_f32 v93, v50, v51
v_mfma_f32_16x16x32_bf16 a[12:15], v[84:87], a[176:179], a[12:15]
v_exp_f32 v52, v52
v_mfma_f32_16x16x32_bf16 a[44:47], v[84:87], a[184:187], a[44:47]
ds_read_b64_tr_b16 a[182:183], v221 offset:45056
ds_read_b64_tr_b16 a[176:177], v220 offset:40960
v_mfma_f32_16x16x32_bf16 a[60:63], v[84:87], a[188:191], a[60:63]
v_exp_f32 v53, v53
v_mfma_f32_16x16x32_bf16 a[56:59], v[80:83], a[188:191], a[56:59]
ds_read_b64_tr_b16 a[178:179], v220 offset:45056
v_cvt_pk_bf16_f32 v94, v52, v53
v_mfma_f32_16x16x32_bf16 a[40:43], v[80:83], a[184:187], a[40:43]
v_exp_f32 v54, v54
v_mfma_f32_16x16x32_bf16 a[36:39], v[76:79], a[184:187], a[36:39]
buffer_load_dwordx4 v233, s[12:15], s39 offen offset:1024  lds
v_mfma_f32_16x16x32_bf16 a[52:55], v[76:79], a[188:191], a[52:55]
v_exp_f32 v55, v55
v_mfma_f32_16x16x32_bf16 a[48:51], v[72:75], a[188:191], a[48:51]
ds_read_b64_tr_b16 a[188:189], v223 offset:40960
v_cvt_pk_bf16_f32 v95, v54, v55
v_mfma_f32_16x16x32_bf16 a[32:35], v[72:75], a[184:187], a[32:35]
v_exp_f32 v56, v56
v_smfmac_f32_16x16x64_bf16 a[128:131], a[208:211], v[72:79], v245
ds_read_b64_tr_b16 a[190:191], v223 offset:45056
v_mfma_f32_16x16x32_bf16 v[12:15], a[160:163], v[152:155], v[136:139]
v_exp_f32 v57, v57
v_mfma_f32_16x16x32_bf16 v[12:15], a[164:167], v[156:159], v[12:15]
v_exp_f32 v58, v58
v_mfma_f32_16x16x32_bf16 v[12:15], a[168:171], v[160:163], v[12:15]
ds_read_b64_tr_b16 a[184:185], v222 offset:40960
v_cvt_pk_bf16_f32 v96, v56, v57
v_mfma_f32_16x16x32_bf16 v[12:15], a[172:175], v[164:167], v[12:15]
v_exp_f32 v59, v59
v_mfma_f32_16x16x32_bf16 v[20:23], a[172:175], v[180:183], v[140:143]
ds_read_b64_tr_b16 a[186:187], v222 offset:45056
v_cvt_pk_bf16_f32 v97, v58, v59
v_mfma_f32_16x16x32_bf16 v[20:23], a[168:171], v[176:179], v[20:23]
v_exp_f32 v60, v60
v_mfma_f32_16x16x32_bf16 v[20:23], a[164:167], v[172:175], v[20:23]
buffer_load_dwordx4 v232, s[12:15], s39 offen offset:2048  lds
v_mfma_f32_16x16x32_bf16 v[20:23], a[160:163], v[168:171], v[20:23]
v_exp_f32 v61, v61
v_mfma_f32_16x16x32_bf16 v[28:31], a[160:163], v[184:187], v[144:147]
v_cvt_pk_bf16_f32 v98, v60, v61
v_mfma_f32_16x16x32_bf16 v[28:31], a[164:167], v[188:191], v[28:31]
v_exp_f32 v62, v62
v_mfma_f32_16x16x32_bf16 v[28:31], a[168:171], v[192:195], v[28:31]
buffer_load_dwordx4 v233, s[12:15], s39 offen offset:3072  lds
v_mfma_f32_16x16x32_bf16 v[28:31], a[172:175], v[196:199], v[28:31]
v_exp_f32 v63, v63
v_mfma_f32_16x16x32_bf16 v[36:39], a[172:175], v[212:215], v[148:151]
ds_read_b128 a[172:175], v219 offset:61440
v_cvt_pk_bf16_f32 v99, v62, v63
v_mfma_f32_16x16x32_bf16 v[36:39], a[168:171], v[208:211], v[36:39]
v_exp_f32 v64, v64
v_mfma_f32_16x16x32_bf16 v[36:39], a[164:167], v[204:207], v[36:39]
ds_read_b128 a[168:171], v218 offset:61440
ds_read_b128 a[164:167], v217 offset:61440
v_mfma_f32_16x16x32_bf16 v[36:39], a[160:163], v[200:203], v[36:39]
v_exp_f32 v65, v65
s_waitcnt lgkmcnt(8)
v_mfma_f32_16x16x32_bf16 a[64:67], v[72:75], a[192:195], a[64:67]
ds_read_b128 a[160:163], v216 offset:61440
v_cvt_pk_bf16_f32 v100, v64, v65
v_mfma_f32_16x16x32_bf16 a[80:83], v[72:75], a[196:199], a[80:83]
v_exp_f32 v66, v66
v_mfma_f32_16x16x32_bf16 a[84:87], v[76:79], a[196:199], a[84:87]
buffer_load_dword v242, v241, s[20:23], s46 offen sc1
v_mfma_f32_16x16x32_bf16 a[68:71], v[76:79], a[192:195], a[68:71]
v_exp_f32 v67, v67
v_mfma_f32_16x16x32_bf16 a[72:75], v[80:83], a[192:195], a[72:75]
v_cvt_pk_bf16_f32 v101, v66, v67
v_add_u32 v241, 1024, v241
v_mfma_f32_16x16x32_bf16 a[88:91], v[80:83], a[196:199], a[88:91]
v_exp_f32 v68, v68
v_mfma_f32_16x16x32_bf16 a[92:95], v[84:87], a[196:199], a[92:95]
ds_read_b64_tr_b16 a[196:197], v225 offset:40960
ds_read_b64_tr_b16 a[198:199], v225 offset:45056
v_mfma_f32_16x16x32_bf16 a[76:79], v[84:87], a[192:195], a[76:79]
v_exp_f32 v69, v69
v_mfma_f32_16x16x32_bf16 a[108:111], v[84:87], a[200:203], a[108:111]
ds_read_b64_tr_b16 a[192:193], v224 offset:40960
v_cvt_pk_bf16_f32 v102, v68, v69
v_mfma_f32_16x16x32_bf16 a[124:127], v[84:87], a[204:207], a[124:127]
v_exp_f32 v70, v70
v_mfma_f32_16x16x32_bf16 a[120:123], v[80:83], a[204:207], a[120:123]
ds_read_b64_tr_b16 a[194:195], v224 offset:45056
v_and_b32 v241, 0x3fff, v241
v_mfma_f32_16x16x32_bf16 a[104:107], v[80:83], a[200:203], a[104:107]
v_exp_f32 v71, v71
v_mfma_f32_16x16x32_bf16 a[100:103], v[76:79], a[200:203], a[100:103]
v_cvt_pk_bf16_f32 v103, v70, v71
v_mfma_f32_16x16x32_bf16 a[116:119], v[76:79], a[204:207], a[116:119]
v_mfma_f32_16x16x32_bf16 a[112:115], v[72:75], a[204:207], a[112:115]
ds_read_b64_tr_b16 a[204:205], v227 offset:40960
ds_read_b64_tr_b16 a[206:207], v227 offset:45056
v_mfma_f32_16x16x32_bf16 a[96:99], v[72:75], a[200:203], a[96:99]
ds_read_b64_tr_b16 a[200:201], v226 offset:40960
ds_read_b64_tr_b16 a[202:203], v226 offset:45056
v_smfmac_f32_16x16x64_bf16 a[132:135], a[208:211], v[80:87], v245
v_mfma_f32_16x16x32_bf16 v[40:43], a[144:147], v[152:155], v[136:139]
v_exp_f32 v8, v8
v_mfma_f32_16x16x32_bf16 v[40:43], a[148:151], v[156:159], v[40:43]
v_exp_f32 v9, v9
v_mfma_f32_16x16x32_bf16 v[40:43], a[152:155], v[160:163], v[40:43]
v_cvt_pk_bf16_f32 v72, v8, v9
v_mfma_f32_16x16x32_bf16 v[40:43], a[156:159], v[164:167], v[40:43]
v_exp_f32 v10, v10
v_mfma_f32_16x16x32_bf16 v[48:51], a[156:159], v[180:183], v[140:143]
v_mfma_f32_16x16x32_bf16 v[48:51], a[152:155], v[176:179], v[48:51]
v_exp_f32 v11, v11
v_mfma_f32_16x16x32_bf16 v[48:51], a[148:151], v[172:175], v[48:51]
v_cvt_pk_bf16_f32 v73, v10, v11
v_mfma_f32_16x16x32_bf16 v[48:51], a[144:147], v[168:171], v[48:51]
v_exp_f32 v12, v12
v_mfma_f32_16x16x32_bf16 v[56:59], a[144:147], v[184:187], v[144:147]
v_mfma_f32_16x16x32_bf16 v[56:59], a[148:151], v[188:191], v[56:59]
v_exp_f32 v13, v13
v_mfma_f32_16x16x32_bf16 v[56:59], a[152:155], v[192:195], v[56:59]
v_cvt_pk_bf16_f32 v74, v12, v13
v_mfma_f32_16x16x32_bf16 v[56:59], a[156:159], v[196:199], v[56:59]
v_exp_f32 v14, v14
v_mfma_f32_16x16x32_bf16 v[64:67], a[156:159], v[212:215], v[148:151]
s_waitcnt vmcnt(10) lgkmcnt(0)
s_barrier
v_mfma_f32_16x16x32_bf16 v[64:67], a[152:155], v[208:211], v[64:67]
v_exp_f32 v15, v15
v_mfma_f32_16x16x32_bf16 v[64:67], a[148:151], v[204:207], v[64:67]
ds_read_b128 a[156:159], v219 offset:0
v_cvt_pk_bf16_f32 v75, v14, v15
v_mfma_f32_16x16x32_bf16 v[64:67], a[144:147], v[200:203], v[64:67]
v_exp_f32 v16, v16
v_mfma_f32_16x16x32_bf16 a[0:3], v[88:91], a[176:179], a[0:3]
ds_read_b128 a[152:155], v218 offset:0
ds_read_b128 a[148:151], v217 offset:0
v_mfma_f32_16x16x32_bf16 a[16:19], v[88:91], a[180:183], a[16:19]
v_exp_f32 v17, v17
v_mfma_f32_16x16x32_bf16 a[20:23], v[92:95], a[180:183], a[20:23]
ds_read_b128 a[144:147], v216 offset:0
v_cvt_pk_bf16_f32 v76, v16, v17
v_mfma_f32_16x16x32_bf16 a[4:7], v[92:95], a[176:179], a[4:7]
v_exp_f32 v18, v18
v_mfma_f32_16x16x32_bf16 a[8:11], v[96:99], a[176:179], a[8:11]
s_add_u32 s32, s32, 16384
s_add_u32 m0, s30, 114688
v_mfma_f32_16x16x32_bf16 a[24:27], v[96:99], a[180:183], a[24:27]
v_exp_f32 v19, v19
v_mfma_f32_16x16x32_bf16 a[28:31], v[100:103], a[180:183], a[28:31]
ds_read_b64_tr_b16 a[180:181], v221 offset:49152
v_cvt_pk_bf16_f32 v77, v18, v19
v_mfma_f32_16x16x32_bf16 a[12:15], v[100:103], a[176:179], a[12:15]
v_exp_f32 v20, v20
v_mfma_f32_16x16x32_bf16 a[44:47], v[100:103], a[184:187], a[44:47]
ds_read_b64_tr_b16 a[182:183], v221 offset:53248
ds_read_b64_tr_b16 a[176:177], v220 offset:49152
v_mfma_f32_16x16x32_bf16 a[60:63], v[100:103], a[188:191], a[60:63]
v_exp_f32 v21, v21
v_mfma_f32_16x16x32_bf16 a[56:59], v[96:99], a[188:191], a[56:59]
ds_read_b64_tr_b16 a[178:179], v220 offset:53248
v_cvt_pk_bf16_f32 v78, v20, v21
v_mfma_f32_16x16x32_bf16 a[40:43], v[96:99], a[184:187], a[40:43]
v_exp_f32 v22, v22
v_mfma_f32_16x16x32_bf16 a[36:39], v[92:95], a[184:187], a[36:39]
buffer_load_dwordx4 v228, s[8:11], s32 offen offset:0  lds
v_mfma_f32_16x16x32_bf16 a[52:55], v[92:95], a[188:191], a[52:55]
v_exp_f32 v23, v23
v_mfma_f32_16x16x32_bf16 a[48:51], v[88:91], a[188:191], a[48:51]
ds_read_b64_tr_b16 a[188:189], v223 offset:49152
v_cvt_pk_bf16_f32 v79, v22, v23
v_mfma_f32_16x16x32_bf16 a[32:35], v[88:91], a[184:187], a[32:35]
v_exp_f32 v24, v24
v_smfmac_f32_16x16x64_bf16 a[128:131], a[208:211], v[88:95], v245
ds_read_b64_tr_b16 a[190:191], v223 offset:53248
v_mfma_f32_16x16x32_bf16 v[44:47], a[160:163], v[152:155], v[136:139]
v_exp_f32 v25, v25
v_mfma_f32_16x16x32_bf16 v[44:47], a[164:167], v[156:159], v[44:47]
v_exp_f32 v26, v26
v_mfma_f32_16x16x32_bf16 v[44:47], a[168:171], v[160:163], v[44:47]
ds_read_b64_tr_b16 a[184:185], v222 offset:49152
v_cvt_pk_bf16_f32 v80, v24, v25
v_mfma_f32_16x16x32_bf16 v[44:47], a[172:175], v[164:167], v[44:47]
v_exp_f32 v27, v27
v_mfma_f32_16x16x32_bf16 v[52:55], a[172:175], v[180:183], v[140:143]
ds_read_b64_tr_b16 a[186:187], v222 offset:53248
v_cvt_pk_bf16_f32 v81, v26, v27
v_mfma_f32_16x16x32_bf16 v[52:55], a[168:171], v[176:179], v[52:55]
v_exp_f32 v28, v28
v_mfma_f32_16x16x32_bf16 v[52:55], a[164:167], v[172:175], v[52:55]
buffer_load_dwordx4 v229, s[8:11], s32 offen offset:1024  lds
v_mfma_f32_16x16x32_bf16 v[52:55], a[160:163], v[168:171], v[52:55]
v_exp_f32 v29, v29
v_mfma_f32_16x16x32_bf16 v[60:63], a[160:163], v[184:187], v[144:147]
v_cvt_pk_bf16_f32 v82, v28, v29
v_mfma_f32_16x16x32_bf16 v[60:63], a[164:167], v[188:191], v[60:63]
v_exp_f32 v30, v30
v_mfma_f32_16x16x32_bf16 v[60:63], a[168:171], v[192:195], v[60:63]
buffer_load_dwordx4 v230, s[8:11], s32 offen offset:2048  lds
v_mfma_f32_16x16x32_bf16 v[60:63], a[172:175], v[196:199], v[60:63]
v_exp_f32 v31, v31
v_mfma_f32_16x16x32_bf16 v[68:71], a[172:175], v[212:215], v[148:151]
ds_read_b128 a[172:175], v219 offset:4096
v_cvt_pk_bf16_f32 v83, v30, v31
v_mfma_f32_16x16x32_bf16 v[68:71], a[168:171], v[208:211], v[68:71]
v_exp_f32 v32, v32
v_mfma_f32_16x16x32_bf16 v[68:71], a[164:167], v[204:207], v[68:71]
ds_read_b128 a[168:171], v218 offset:4096
ds_read_b128 a[164:167], v217 offset:4096
v_mfma_f32_16x16x32_bf16 v[68:71], a[160:163], v[200:203], v[68:71]
v_exp_f32 v33, v33
v_mfma_f32_16x16x32_bf16 a[64:67], v[88:91], a[192:195], a[64:67]
ds_read_b128 a[160:163], v216 offset:4096
v_cvt_pk_bf16_f32 v84, v32, v33
v_mfma_f32_16x16x32_bf16 a[80:83], v[88:91], a[196:199], a[80:83]
v_exp_f32 v34, v34
v_mfma_f32_16x16x32_bf16 a[84:87], v[92:95], a[196:199], a[84:87]
buffer_load_dwordx4 v231, s[8:11], s32 offen offset:3072  lds
v_mfma_f32_16x16x32_bf16 a[68:71], v[92:95], a[192:195], a[68:71]
v_exp_f32 v35, v35
v_mfma_f32_16x16x32_bf16 a[72:75], v[96:99], a[192:195], a[72:75]
v_cvt_pk_bf16_f32 v85, v34, v35
v_mfma_f32_16x16x32_bf16 a[88:91], v[96:99], a[196:199], a[88:91]
v_exp_f32 v36, v36
v_mfma_f32_16x16x32_bf16 a[92:95], v[100:103], a[196:199], a[92:95]
ds_read_b64_tr_b16 a[196:197], v225 offset:49152
ds_read_b64_tr_b16 a[198:199], v225 offset:53248
v_mfma_f32_16x16x32_bf16 a[76:79], v[100:103], a[192:195], a[76:79]
v_exp_f32 v37, v37
v_mfma_f32_16x16x32_bf16 a[108:111], v[100:103], a[200:203], a[108:111]
ds_read_b64_tr_b16 a[192:193], v224 offset:49152
v_cvt_pk_bf16_f32 v86, v36, v37
v_mfma_f32_16x16x32_bf16 a[124:127], v[100:103], a[204:207], a[124:127]
v_exp_f32 v38, v38
v_mfma_f32_16x16x32_bf16 a[120:123], v[96:99], a[204:207], a[120:123]
ds_read_b64_tr_b16 a[194:195], v224 offset:53248
v_mfma_f32_16x16x32_bf16 a[104:107], v[96:99], a[200:203], a[104:107]
v_exp_f32 v39, v39
v_mfma_f32_16x16x32_bf16 a[100:103], v[92:95], a[200:203], a[100:103]
v_cvt_pk_bf16_f32 v87, v38, v39
v_mfma_f32_16x16x32_bf16 a[116:119], v[92:95], a[204:207], a[116:119]
s_mov_b32 m0, s87
s_lshl2_add_u32 s50, s87, s89
buffer_load_dwordx4 v243, s[56:59], s50 offen  lds
v_mfma_f32_16x16x32_bf16 a[112:115], v[88:91], a[204:207], a[112:115]
ds_read_b64_tr_b16 a[204:205], v227 offset:49152
ds_read_b64_tr_b16 a[206:207], v227 offset:53248
v_mfma_f32_16x16x32_bf16 a[96:99], v[88:91], a[200:203], a[96:99]
ds_read_b64_tr_b16 a[200:201], v226 offset:49152
ds_read_b64_tr_b16 a[202:203], v226 offset:53248
v_smfmac_f32_16x16x64_bf16 a[132:135], a[208:211], v[96:103], v245
s_add_u32 s87, s87, 3456
s_min_u32 s87, s87, 63936
s_waitcnt lgkmcnt(8)
v_mfma_f32_16x16x32_bf16 v[8:11], a[144:147], v[152:155], v[136:139]
v_exp_f32 v40, v40
v_mfma_f32_16x16x32_bf16 v[8:11], a[148:151], v[156:159], v[8:11]
v_exp_f32 v41, v41
v_mfma_f32_16x16x32_bf16 v[8:11], a[152:155], v[160:163], v[8:11]
v_cvt_pk_bf16_f32 v88, v40, v41
v_mfma_f32_16x16x32_bf16 v[8:11], a[156:159], v[164:167], v[8:11]
v_exp_f32 v42, v42
v_mfma_f32_16x16x32_bf16 v[16:19], a[156:159], v[180:183], v[140:143]
s_add_u32 s39, s39, 16384
v_mfma_f32_16x16x32_bf16 v[16:19], a[152:155], v[176:179], v[16:19]
v_exp_f32 v43, v43
v_mfma_f32_16x16x32_bf16 v[16:19], a[148:151], v[172:175], v[16:19]
v_cvt_pk_bf16_f32 v89, v42, v43
v_mfma_f32_16x16x32_bf16 v[16:19], a[144:147], v[168:171], v[16:19]
v_exp_f32 v44, v44
v_mfma_f32_16x16x32_bf16 v[24:27], a[144:147], v[184:187], v[144:147]
v_mfma_f32_16x16x32_bf16 v[24:27], a[148:151], v[188:191], v[24:27]
v_exp_f32 v45, v45
v_mfma_f32_16x16x32_bf16 v[24:27], a[152:155], v[192:195], v[24:27]
s_add_u32 m0, s30, 131072
v_cvt_pk_bf16_f32 v90, v44, v45
v_mfma_f32_16x16x32_bf16 v[24:27], a[156:159], v[196:199], v[24:27]
v_exp_f32 v46, v46
v_mfma_f32_16x16x32_bf16 v[32:35], a[156:159], v[212:215], v[148:151]
ds_read_b128 a[156:159], v219 offset:8192
v_mfma_f32_16x16x32_bf16 v[32:35], a[152:155], v[208:211], v[32:35]
v_exp_f32 v47, v47
v_mfma_f32_16x16x32_bf16 v[32:35], a[148:151], v[204:207], v[32:35]
ds_read_b128 a[152:155], v218 offset:8192
v_cvt_pk_bf16_f32 v91, v46, v47
v_mfma_f32_16x16x32_bf16 v[32:35], a[144:147], v[200:203], v[32:35]
v_exp_f32 v48, v48
v_mfma_f32_16x16x32_bf16 a[0:3], v[72:75], a[176:179], a[0:3]
ds_read_b128 a[148:151], v217 offset:8192
ds_read_b128 a[144:147], v216 offset:8192
v_mfma_f32_16x16x32_bf16 a[16:19], v[72:75], a[180:183], a[16:19]
v_exp_f32 v49, v49
v_mfma_f32_16x16x32_bf16 a[20:23], v[76:79], a[180:183], a[20:23]
v_cvt_pk_bf16_f32 v92, v48, v49
v_mfma_f32_16x16x32_bf16 a[4:7], v[76:79], a[176:179], a[4:7]
v_exp_f32 v50, v50
v_mfma_f32_16x16x32_bf16 a[8:11], v[80:83], a[176:179], a[8:11]
buffer_load_dwordx4 v232, s[12:15], s39 offen offset:0  lds
v_mfma_f32_16x16x32_bf16 a[24:27], v[80:83], a[180:183], a[24:27]
v_exp_f32 v51, v51
v_mfma_f32_16x16x32_bf16 a[28:31], v[84:87], a[180:183], a[28:31]
ds_read_b64_tr_b16 a[180:181], v221 offset:57344
v_cvt_pk_bf16_f32 v93, v50, v51
v_mfma_f32_16x16x32_bf16 a[12:15], v[84:87], a[176:179], a[12:15]
v_exp_f32 v52, v52
v_mfma_f32_16x16x32_bf16 a[44:47], v[84:87], a[184:187], a[44:47]
ds_read_b64_tr_b16 a[182:183], v221 offset:61440
ds_read_b64_tr_b16 a[176:177], v220 offset:57344
v_mfma_f32_16x16x32_bf16 a[60:63], v[84:87], a[188:191], a[60:63]
v_exp_f32 v53, v53
v_mfma_f32_16x16x32_bf16 a[56:59], v[80:83], a[188:191], a[56:59]
ds_read_b64_tr_b16 a[178:179], v220 offset:61440
v_cvt_pk_bf16_f32 v94, v52, v53
v_mfma_f32_16x16x32_bf16 a[40:43], v[80:83], a[184:187], a[40:43]
v_exp_f32 v54, v54
v_mfma_f32_16x16x32_bf16 a[36:39], v[76:79], a[184:187], a[36:39]
buffer_load_dwordx4 v233, s[12:15], s39 offen offset:1024  lds
v_mfma_f32_16x16x32_bf16 a[52:55], v[76:79], a[188:191], a[52:55]
v_exp_f32 v55, v55
v_mfma_f32_16x16x32_bf16 a[48:51], v[72:75], a[188:191], a[48:51]
ds_read_b64_tr_b16 a[188:189], v223 offset:57344
v_cvt_pk_bf16_f32 v95, v54, v55
v_mfma_f32_16x16x32_bf16 a[32:35], v[72:75], a[184:187], a[32:35]
v_exp_f32 v56, v56
v_smfmac_f32_16x16x64_bf16 a[128:131], a[208:211], v[72:79], v245
ds_read_b64_tr_b16 a[190:191], v223 offset:61440
v_mfma_f32_16x16x32_bf16 v[12:15], a[160:163], v[152:155], v[136:139]
v_exp_f32 v57, v57
v_mfma_f32_16x16x32_bf16 v[12:15], a[164:167], v[156:159], v[12:15]
v_exp_f32 v58, v58
v_mfma_f32_16x16x32_bf16 v[12:15], a[168:171], v[160:163], v[12:15]
ds_read_b64_tr_b16 a[184:185], v222 offset:57344
v_cvt_pk_bf16_f32 v96, v56, v57
v_mfma_f32_16x16x32_bf16 v[12:15], a[172:175], v[164:167], v[12:15]
v_exp_f32 v59, v59
v_mfma_f32_16x16x32_bf16 v[20:23], a[172:175], v[180:183], v[140:143]
ds_read_b64_tr_b16 a[186:187], v222 offset:61440
v_cvt_pk_bf16_f32 v97, v58, v59
v_mfma_f32_16x16x32_bf16 v[20:23], a[168:171], v[176:179], v[20:23]
v_exp_f32 v60, v60
v_mfma_f32_16x16x32_bf16 v[20:23], a[164:167], v[172:175], v[20:23]
buffer_load_dwordx4 v232, s[12:15], s39 offen offset:2048  lds
v_mfma_f32_16x16x32_bf16 v[20:23], a[160:163], v[168:171], v[20:23]
v_exp_f32 v61, v61
v_mfma_f32_16x16x32_bf16 v[28:31], a[160:163], v[184:187], v[144:147]
v_cvt_pk_bf16_f32 v98, v60, v61
v_mfma_f32_16x16x32_bf16 v[28:31], a[164:167], v[188:191], v[28:31]
v_exp_f32 v62, v62
v_mfma_f32_16x16x32_bf16 v[28:31], a[168:171], v[192:195], v[28:31]
buffer_load_dwordx4 v233, s[12:15], s39 offen offset:3072  lds
v_mfma_f32_16x16x32_bf16 v[28:31], a[172:175], v[196:199], v[28:31]
v_exp_f32 v63, v63
v_mfma_f32_16x16x32_bf16 v[36:39], a[172:175], v[212:215], v[148:151]
ds_read_b128 a[172:175], v219 offset:12288
v_cvt_pk_bf16_f32 v99, v62, v63
v_mfma_f32_16x16x32_bf16 v[36:39], a[168:171], v[208:211], v[36:39]
v_exp_f32 v64, v64
v_mfma_f32_16x16x32_bf16 v[36:39], a[164:167], v[204:207], v[36:39]
ds_read_b128 a[168:171], v218 offset:12288
ds_read_b128 a[164:167], v217 offset:12288
v_mfma_f32_16x16x32_bf16 v[36:39], a[160:163], v[200:203], v[36:39]
v_exp_f32 v65, v65
s_waitcnt lgkmcnt(8)
v_mfma_f32_16x16x32_bf16 a[64:67], v[72:75], a[192:195], a[64:67]
ds_read_b128 a[160:163], v216 offset:12288
v_cvt_pk_bf16_f32 v100, v64, v65
v_mfma_f32_16x16x32_bf16 a[80:83], v[72:75], a[196:199], a[80:83]
v_exp_f32 v66, v66
v_mfma_f32_16x16x32_bf16 a[84:87], v[76:79], a[196:199], a[84:87]
buffer_load_dword v242, v241, s[20:23], s46 offen sc1
v_mfma_f32_16x16x32_bf16 a[68:71], v[76:79], a[192:195], a[68:71]
v_exp_f32 v67, v67
v_mfma_f32_16x16x32_bf16 a[72:75], v[80:83], a[192:195], a[72:75]
v_cvt_pk_bf16_f32 v101, v66, v67
v_add_u32 v241, 1024, v241
v_mfma_f32_16x16x32_bf16 a[88:91], v[80:83], a[196:199], a[88:91]
v_exp_f32 v68, v68
v_mfma_f32_16x16x32_bf16 a[92:95], v[84:87], a[196:199], a[92:95]
ds_read_b64_tr_b16 a[196:197], v225 offset:57344
ds_read_b64_tr_b16 a[198:199], v225 offset:61440
v_mfma_f32_16x16x32_bf16 a[76:79], v[84:87], a[192:195], a[76:79]
v_exp_f32 v69, v69
v_mfma_f32_16x16x32_bf16 a[108:111], v[84:87], a[200:203], a[108:111]
ds_read_b64_tr_b16 a[192:193], v224 offset:57344
v_cvt_pk_bf16_f32 v102, v68, v69
v_mfma_f32_16x16x32_bf16 a[124:127], v[84:87], a[204:207], a[124:127]
v_exp_f32 v70, v70
v_mfma_f32_16x16x32_bf16 a[120:123], v[80:83], a[204:207], a[120:123]
ds_read_b64_tr_b16 a[194:195], v224 offset:61440
v_and_b32 v241, 0x3fff, v241
v_mfma_f32_16x16x32_bf16 a[104:107], v[80:83], a[200:203], a[104:107]
v_exp_f32 v71, v71
v_mfma_f32_16x16x32_bf16 a[100:103], v[76:79], a[200:203], a[100:103]
v_cvt_pk_bf16_f32 v103, v70, v71
v_mfma_f32_16x16x32_bf16 a[116:119], v[76:79], a[204:207], a[116:119]
v_mfma_f32_16x16x32_bf16 a[112:115], v[72:75], a[204:207], a[112:115]
ds_read_b64_tr_b16 a[204:205], v227 offset:57344
ds_read_b64_tr_b16 a[206:207], v227 offset:61440
v_mfma_f32_16x16x32_bf16 a[96:99], v[72:75], a[200:203], a[96:99]
ds_read_b64_tr_b16 a[200:201], v226 offset:57344
ds_read_b64_tr_b16 a[202:203], v226 offset:61440
v_smfmac_f32_16x16x64_bf16 a[132:135], a[208:211], v[80:87], v245
s_sub_u32 s33, s33, 1
s_cmp_lg_u32 s33, 0
s_cbranch_scc1 K_LOOP
K_LAST:
v_mfma_f32_16x16x32_bf16 v[40:43], a[144:147], v[152:155], v[136:139]
v_and_b32 v246, 15, v1
v_exp_f32 v8, v8
v_mfma_f32_16x16x32_bf16 v[40:43], a[148:151], v[156:159], v[40:43]
v_lshrrev_b32 v247, 3, v246
v_exp_f32 v9, v9
v_mfma_f32_16x16x32_bf16 v[40:43], a[152:155], v[160:163], v[40:43]
v_cvt_pk_bf16_f32 v72, v8, v9
v_and_b32 v246, 7, v246
v_lshlrev_b32 v246, 6, v246
v_mfma_f32_16x16x32_bf16 v[40:43], a[156:159], v[164:167], v[40:43]
v_lshl_add_u32 v246, v247, 13, v246
v_exp_f32 v10, v10
v_mfma_f32_16x16x32_bf16 v[48:51], a[156:159], v[180:183], v[140:143]
STUB_11:
STUB_B2:
s_cbranch_execz STUB_14
s_lshl_b32 s28, s36, 9
s_add_u32 s28, s28, 0x248000
v_mfma_f32_16x16x32_bf16 v[48:51], a[152:155], v[176:179], v[48:51]
v_exp_f32 v11, v11
v_mfma_f32_16x16x32_bf16 v[48:51], a[148:151], v[172:175], v[48:51]
v_cvt_pk_bf16_f32 v73, v10, v11
v_mfma_f32_16x16x32_bf16 v[48:51], a[144:147], v[168:171], v[48:51]
v_exp_f32 v12, v12
v_mfma_f32_16x16x32_bf16 v[56:59], a[144:147], v[184:187], v[144:147]
v_mfma_f32_16x16x32_bf16 v[56:59], a[148:151], v[188:191], v[56:59]
v_exp_f32 v13, v13
v_mfma_f32_16x16x32_bf16 v[56:59], a[152:155], v[192:195], v[56:59]
v_cvt_pk_bf16_f32 v74, v12, v13
v_mfma_f32_16x16x32_bf16 v[56:59], a[156:159], v[196:199], v[56:59]
v_exp_f32 v14, v14
v_mfma_f32_16x16x32_bf16 v[64:67], a[156:159], v[212:215], v[148:151]
s_waitcnt vmcnt(10) lgkmcnt(0)
s_barrier
v_mfma_f32_16x16x32_bf16 v[64:67], a[152:155], v[208:211], v[64:67]
v_exp_f32 v15, v15
v_mfma_f32_16x16x32_bf16 v[64:67], a[148:151], v[204:207], v[64:67]
ds_read_b128 a[156:159], v219 offset:16384
v_cvt_pk_bf16_f32 v75, v14, v15
v_mfma_f32_16x16x32_bf16 v[64:67], a[144:147], v[200:203], v[64:67]
v_exp_f32 v16, v16
v_mfma_f32_16x16x32_bf16 a[0:3], v[88:91], a[176:179], a[0:3]
ds_read_b128 a[152:155], v218 offset:16384
ds_read_b128 a[148:151], v217 offset:16384
v_mfma_f32_16x16x32_bf16 a[16:19], v[88:91], a[180:183], a[16:19]
v_exp_f32 v17, v17
v_mfma_f32_16x16x32_bf16 a[20:23], v[92:95], a[180:183], a[20:23]
ds_read_b128 a[144:147], v216 offset:16384
v_cvt_pk_bf16_f32 v76, v16, v17
v_mfma_f32_16x16x32_bf16 a[4:7], v[92:95], a[176:179], a[4:7]
v_exp_f32 v18, v18
v_mfma_f32_16x16x32_bf16 a[8:11], v[96:99], a[176:179], a[8:11]
s_add_u32 m0, s88, 62208
s_lshl2_add_u32 s50, m0, s89
buffer_load_dwordx4 v243, s[56:59], s50 offen  lds
v_mfma_f32_16x16x32_bf16 a[24:27], v[96:99], a[180:183], a[24:27]
v_exp_f32 v19, v19
v_mfma_f32_16x16x32_bf16 a[28:31], v[100:103], a[180:183], a[28:31]
ds_read_b64_tr_b16 a[180:181], v221 offset:0
v_cvt_pk_bf16_f32 v77, v18, v19
v_mfma_f32_16x16x32_bf16 a[12:15], v[100:103], a[176:179], a[12:15]
v_exp_f32 v20, v20
v_mfma_f32_16x16x32_bf16 a[44:47], v[100:103], a[184:187], a[44:47]
ds_read_b64_tr_b16 a[182:183], v221 offset:4096
ds_read_b64_tr_b16 a[176:177], v220 offset:0
v_mfma_f32_16x16x32_bf16 a[60:63], v[100:103], a[188:191], a[60:63]
v_exp_f32 v21, v21
v_mfma_f32_16x16x32_bf16 a[56:59], v[96:99], a[188:191], a[56:59]
ds_read_b64_tr_b16 a[178:179], v220 offset:4096
v_cvt_pk_bf16_f32 v78, v20, v21
v_mfma_f32_16x16x32_bf16 a[40:43], v[96:99], a[184:187], a[40:43]
v_exp_f32 v22, v22
v_mfma_f32_16x16x32_bf16 a[36:39], v[92:95], a[184:187], a[36:39]
buffer_load_dword v242, v246, s[20:23], s28 offen sc1
v_mfma_f32_16x16x32_bf16 a[52:55], v[92:95], a[188:191], a[52:55]
v_bfe_u32 v246, v1, 2, 2
v_exp_f32 v23, v23
v_mfma_f32_16x16x32_bf16 a[48:51], v[88:91], a[188:191], a[48:51]
ds_read_b64_tr_b16 a[188:189], v223 offset:0
v_cvt_pk_bf16_f32 v79, v22, v23
v_lshl_add_u32 v246, v4, 2, v246
v_mfma_f32_16x16x32_bf16 a[32:35], v[88:91], a[184:187], a[32:35]
v_mul_u32_u24 v246, 288, v246
v_exp_f32 v24, v24
v_smfmac_f32_16x16x64_bf16 a[128:131], a[208:211], v[88:95], v245
ds_read_b64_tr_b16 a[190:191], v223 offset:4096
v_and_b32 v247, 3, v1
v_mfma_f32_16x16x32_bf16 v[44:47], a[160:163], v[152:155], v[136:139]
v_lshl_add_u32 v236, v247, 3, v246
v_exp_f32 v25, v25
v_mfma_f32_16x16x32_bf16 v[44:47], a[164:167], v[156:159], v[44:47]
v_add_u32 v236, 256, v236
v_exp_f32 v26, v26
v_mfma_f32_16x16x32_bf16 v[44:47], a[168:171], v[160:163], v[44:47]
ds_read_b64_tr_b16 a[184:185], v222 offset:0
v_cvt_pk_bf16_f32 v80, v24, v25
v_lshl_add_u32 v246, v247, 4, v246
v_mfma_f32_16x16x32_bf16 v[44:47], a[172:175], v[164:167], v[44:47]
v_exp_f32 v27, v27
v_mfma_f32_16x16x32_bf16 v[52:55], a[172:175], v[180:183], v[140:143]
ds_read_b64_tr_b16 a[186:187], v222 offset:4096
v_cvt_pk_bf16_f32 v81, v26, v27
v_mfma_f32_16x16x32_bf16 v[52:55], a[168:171], v[176:179], v[52:55]
v_exp_f32 v28, v28
v_mfma_f32_16x16x32_bf16 v[52:55], a[164:167], v[172:175], v[52:55]
s_add_u32 m0, s88, 65664
s_lshl2_add_u32 s50, m0, s89
buffer_load_dwordx4 v243, s[56:59], s50 offen  lds
v_mfma_f32_16x16x32_bf16 v[52:55], a[160:163], v[168:171], v[52:55]
v_exp_f32 v29, v29
v_mfma_f32_16x16x32_bf16 v[60:63], a[160:163], v[184:187], v[144:147]
s_lshr_b32 s28, s35, 4
s_lshl_b32 s28, s28, 6
v_cvt_pk_bf16_f32 v82, v28, v29
v_mfma_f32_16x16x32_bf16 v[60:63], a[164:167], v[188:191], v[60:63]
v_add_u32 v234, s28, v246
v_exp_f32 v30, v30
v_mfma_f32_16x16x32_bf16 v[60:63], a[168:171], v[192:195], v[60:63]
s_xor_b32 s28, s28, 64
v_mfma_f32_16x16x32_bf16 v[60:63], a[172:175], v[196:199], v[60:63]
v_add_u32 v235, s28, v246
v_exp_f32 v31, v31
v_mfma_f32_16x16x32_bf16 v[68:71], a[172:175], v[212:215], v[148:151]
ds_read_b128 a[172:175], v219 offset:20480
v_cvt_pk_bf16_f32 v83, v30, v31
v_mfma_f32_16x16x32_bf16 v[68:71], a[168:171], v[208:211], v[68:71]
v_exp_f32 v32, v32
v_mfma_f32_16x16x32_bf16 v[68:71], a[164:167], v[204:207], v[68:71]
ds_read_b128 a[168:171], v218 offset:20480
ds_read_b128 a[164:167], v217 offset:20480
v_mfma_f32_16x16x32_bf16 v[68:71], a[160:163], v[200:203], v[68:71]
v_exp_f32 v33, v33
v_mfma_f32_16x16x32_bf16 a[64:67], v[88:91], a[192:195], a[64:67]
ds_read_b128 a[160:163], v216 offset:20480
v_cvt_pk_bf16_f32 v84, v32, v33
v_mfma_f32_16x16x32_bf16 a[80:83], v[88:91], a[196:199], a[80:83]
v_exp_f32 v34, v34
v_mfma_f32_16x16x32_bf16 a[84:87], v[92:95], a[196:199], a[84:87]
s_add_u32 m0, s88, 69120
s_lshl2_add_u32 s50, m0, s89
buffer_load_dwordx4 v243, s[56:59], s50 offen  lds
v_mfma_f32_16x16x32_bf16 a[68:71], v[92:95], a[192:195], a[68:71]
v_exp_f32 v35, v35
v_mfma_f32_16x16x32_bf16 a[72:75], v[96:99], a[192:195], a[72:75]
s_add_u32 s28, s35, 0
s_and_b32 s28, s28, 3
v_cvt_pk_bf16_f32 v85, v34, v35
v_mfma_f32_16x16x32_bf16 a[88:91], v[96:99], a[196:199], a[88:91]
s_mul_i32 s28, s28, 36864
v_exp_f32 v36, v36
v_mfma_f32_16x16x32_bf16 a[92:95], v[100:103], a[196:199], a[92:95]
ds_read_b64_tr_b16 a[196:197], v225 offset:0
ds_read_b64_tr_b16 a[198:199], v225 offset:4096
v_add_u32 v237, s28, v234
v_mfma_f32_16x16x32_bf16 a[76:79], v[100:103], a[192:195], a[76:79]
v_add_u32 v238, s28, v235
v_exp_f32 v37, v37
v_mfma_f32_16x16x32_bf16 a[108:111], v[100:103], a[200:203], a[108:111]
ds_read_b64_tr_b16 a[192:193], v224 offset:0
v_cvt_pk_bf16_f32 v86, v36, v37
v_add_u32 v239, s28, v236
v_mfma_f32_16x16x32_bf16 a[124:127], v[100:103], a[204:207], a[124:127]
v_mov_b32 v254, 0x7ffffff0
v_exp_f32 v38, v38
v_mfma_f32_16x16x32_bf16 a[120:123], v[96:99], a[204:207], a[120:123]
ds_read_b64_tr_b16 a[194:195], v224 offset:4096
s_lshl2_add_u32 s92, s36, s37
s_bfe_u32 s93, s35, 0x20002
v_mfma_f32_16x16x32_bf16 a[104:107], v[96:99], a[200:203], a[104:107]
s_lshl2_add_u32 s92, s92, s93
v_exp_f32 v39, v39
v_mfma_f32_16x16x32_bf16 a[100:103], v[92:95], a[200:203], a[100:103]
s_lshl_b32 s93, s92, 4
v_cvt_pk_bf16_f32 v87, v38, v39
v_mfma_f32_16x16x32_bf16 a[116:119], v[92:95], a[204:207], a[116:119]
v_add_u32 v132, s93, v3
v_writelane_b32 v254, 0, 0
v_mfma_f32_16x16x32_bf16 a[112:115], v[88:91], a[204:207], a[112:115]
ds_read_b64_tr_b16 a[204:205], v227 offset:0
ds_read_b64_tr_b16 a[206:207], v227 offset:4096
s_and_b32 s93, s35, 3
v_mfma_f32_16x16x32_bf16 a[96:99], v[88:91], a[200:203], a[96:99]
ds_read_b64_tr_b16 a[200:201], v226 offset:0
ds_read_b64_tr_b16 a[202:203], v226 offset:4096
s_mul_i32 s93, s93, 144
v_smfmac_f32_16x16x64_bf16 a[132:135], a[208:211], v[96:103], v245
v_lshlrev_b32 v251, 2, v4
v_add_u32 v251, s93, v251
s_waitcnt lgkmcnt(8)
v_mfma_f32_16x16x32_bf16 v[8:11], a[144:147], v[152:155], v[136:139]
v_add_u32 v251, 128, v251
v_exp_f32 v40, v40
v_mfma_f32_16x16x32_bf16 v[8:11], a[148:151], v[156:159], v[8:11]
v_lshlrev_b32 v250, 3, v4
v_exp_f32 v41, v41
v_mfma_f32_16x16x32_bf16 v[8:11], a[152:155], v[160:163], v[8:11]
s_lshr_b32 s90, s35, 4
s_lshl_b32 s90, s90, 5
v_cvt_pk_bf16_f32 v88, v40, v41
v_mfma_f32_16x16x32_bf16 v[8:11], a[156:159], v[164:167], v[8:11]
s_add_u32 s93, s93, s90
v_exp_f32 v42, v42
v_mfma_f32_16x16x32_bf16 v[16:19], a[156:159], v[180:183], v[140:143]
s_add_u32 s39, s39, 16384
v_add_u32 v250, s93, v250
v_lshlrev_b32 v250, 1, v250
v_mfma_f32_16x16x32_bf16 v[16:19], a[152:155], v[176:179], v[16:19]
v_lshlrev_b32 v251, 1, v251
v_exp_f32 v43, v43
v_mfma_f32_16x16x32_bf16 v[16:19], a[148:151], v[172:175], v[16:19]
v_cvt_pk_bf16_f32 v89, v42, v43
v_mul_u32_u24 v133, 0x480, v132
v_add_u32 v248, v133, v250
v_mfma_f32_16x16x32_bf16 v[16:19], a[144:147], v[168:171], v[16:19]
v_add_u32 v249, v133, v251
v_exp_f32 v44, v44
v_mfma_f32_16x16x32_bf16 v[24:27], a[144:147], v[184:187], v[144:147]
v_mov_b32 v135, 0x7fffbff0
v_mfma_f32_16x16x32_bf16 v[24:27], a[148:151], v[188:191], v[24:27]
v_exp_f32 v45, v45
v_mfma_f32_16x16x32_bf16 v[24:27], a[152:155], v[192:195], v[24:27]
s_add_u32 m0, s30, 147456
v_cvt_pk_bf16_f32 v90, v44, v45
v_mfma_f32_16x16x32_bf16 v[24:27], a[156:159], v[196:199], v[24:27]
v_exp_f32 v46, v46
v_mfma_f32_16x16x32_bf16 v[32:35], a[156:159], v[212:215], v[148:151]
ds_read_b128 a[156:159], v219 offset:24576
v_mfma_f32_16x16x32_bf16 v[32:35], a[152:155], v[208:211], v[32:35]
v_exp_f32 v47, v47
v_mfma_f32_16x16x32_bf16 v[32:35], a[148:151], v[204:207], v[32:35]
ds_read_b128 a[152:155], v218 offset:24576
v_cvt_pk_bf16_f32 v91, v46, v47
v_mfma_f32_16x16x32_bf16 v[32:35], a[144:147], v[200:203], v[32:35]
v_exp_f32 v48, v48
v_mfma_f32_16x16x32_bf16 a[0:3], v[72:75], a[176:179], a[0:3]
ds_read_b128 a[148:151], v217 offset:24576
ds_read_b128 a[144:147], v216 offset:24576
v_mfma_f32_16x16x32_bf16 a[16:19], v[72:75], a[180:183], a[16:19]
v_exp_f32 v49, v49
v_mfma_f32_16x16x32_bf16 a[20:23], v[76:79], a[180:183], a[20:23]
v_cvt_pk_bf16_f32 v92, v48, v49
v_mfma_f32_16x16x32_bf16 a[4:7], v[76:79], a[176:179], a[4:7]
v_exp_f32 v50, v50
v_mfma_f32_16x16x32_bf16 a[8:11], v[80:83], a[176:179], a[8:11]
buffer_load_dwordx4 v232, s[12:15], s39 offen offset:0  lds
v_mfma_f32_16x16x32_bf16 a[24:27], v[80:83], a[180:183], a[24:27]
v_exp_f32 v51, v51
v_mfma_f32_16x16x32_bf16 a[28:31], v[84:87], a[180:183], a[28:31]
ds_read_b64_tr_b16 a[180:181], v221 offset:8192
v_cvt_pk_bf16_f32 v93, v50, v51
v_mfma_f32_16x16x32_bf16 a[12:15], v[84:87], a[176:179], a[12:15]
v_exp_f32 v52, v52
v_mfma_f32_16x16x32_bf16 a[44:47], v[84:87], a[184:187], a[44:47]
ds_read_b64_tr_b16 a[182:183], v221 offset:12288
ds_read_b64_tr_b16 a[176:177], v220 offset:8192
v_mfma_f32_16x16x32_bf16 a[60:63], v[84:87], a[188:191], a[60:63]
v_exp_f32 v53, v53
v_mfma_f32_16x16x32_bf16 a[56:59], v[80:83], a[188:191], a[56:59]
ds_read_b64_tr_b16 a[178:179], v220 offset:12288
v_cvt_pk_bf16_f32 v94, v52, v53
v_mfma_f32_16x16x32_bf16 a[40:43], v[80:83], a[184:187], a[40:43]
v_exp_f32 v54, v54
v_mfma_f32_16x16x32_bf16 a[36:39], v[76:79], a[184:187], a[36:39]
buffer_load_dwordx4 v233, s[12:15], s39 offen offset:1024  lds
v_mfma_f32_16x16x32_bf16 a[52:55], v[76:79], a[188:191], a[52:55]
v_exp_f32 v55, v55
v_mfma_f32_16x16x32_bf16 a[48:51], v[72:75], a[188:191], a[48:51]
ds_read_b64_tr_b16 a[188:189], v223 offset:8192
v_cvt_pk_bf16_f32 v95, v54, v55
v_mfma_f32_16x16x32_bf16 a[32:35], v[72:75], a[184:187], a[32:35]
v_exp_f32 v56, v56
v_smfmac_f32_16x16x64_bf16 a[128:131], a[208:211], v[72:79], v245
ds_read_b64_tr_b16 a[190:191], v223 offset:12288
v_mfma_f32_16x16x32_bf16 v[12:15], a[160:163], v[152:155], v[136:139]
v_exp_f32 v57, v57
v_mfma_f32_16x16x32_bf16 v[12:15], a[164:167], v[156:159], v[12:15]
v_exp_f32 v58, v58
v_mfma_f32_16x16x32_bf16 v[12:15], a[168:171], v[160:163], v[12:15]
ds_read_b64_tr_b16 a[184:185], v222 offset:8192
v_cvt_pk_bf16_f32 v96, v56, v57
v_mfma_f32_16x16x32_bf16 v[12:15], a[172:175], v[164:167], v[12:15]
v_exp_f32 v59, v59
v_mfma_f32_16x16x32_bf16 v[20:23], a[172:175], v[180:183], v[140:143]
ds_read_b64_tr_b16 a[186:187], v222 offset:12288
v_cvt_pk_bf16_f32 v97, v58, v59
v_mfma_f32_16x16x32_bf16 v[20:23], a[168:171], v[176:179], v[20:23]
v_exp_f32 v60, v60
v_mfma_f32_16x16x32_bf16 v[20:23], a[164:167], v[172:175], v[20:23]
buffer_load_dwordx4 v232, s[12:15], s39 offen offset:2048  lds
v_mfma_f32_16x16x32_bf16 v[20:23], a[160:163], v[168:171], v[20:23]
v_exp_f32 v61, v61
v_mfma_f32_16x16x32_bf16 v[28:31], a[160:163], v[184:187], v[144:147]
v_cvt_pk_bf16_f32 v98, v60, v61
v_mfma_f32_16x16x32_bf16 v[28:31], a[164:167], v[188:191], v[28:31]
v_exp_f32 v62, v62
v_mfma_f32_16x16x32_bf16 v[28:31], a[168:171], v[192:195], v[28:31]
buffer_load_dwordx4 v233, s[12:15], s39 offen offset:3072  lds
v_mfma_f32_16x16x32_bf16 v[28:31], a[172:175], v[196:199], v[28:31]
v_exp_f32 v63, v63
v_mfma_f32_16x16x32_bf16 v[36:39], a[172:175], v[212:215], v[148:151]
ds_read_b128 a[172:175], v219 offset:28672
v_cvt_pk_bf16_f32 v99, v62, v63
v_mfma_f32_16x16x32_bf16 v[36:39], a[168:171], v[208:211], v[36:39]
v_exp_f32 v64, v64
v_mfma_f32_16x16x32_bf16 v[36:39], a[164:167], v[204:207], v[36:39]
ds_read_b128 a[168:171], v218 offset:28672
ds_read_b128 a[164:167], v217 offset:28672
v_mfma_f32_16x16x32_bf16 v[36:39], a[160:163], v[200:203], v[36:39]
v_exp_f32 v65, v65
s_waitcnt lgkmcnt(8)
v_mfma_f32_16x16x32_bf16 a[64:67], v[72:75], a[192:195], a[64:67]
ds_read_b128 a[160:163], v216 offset:28672
v_cvt_pk_bf16_f32 v100, v64, v65
v_mfma_f32_16x16x32_bf16 a[80:83], v[72:75], a[196:199], a[80:83]
v_exp_f32 v66, v66
v_mfma_f32_16x16x32_bf16 a[84:87], v[76:79], a[196:199], a[84:87]
s_add_u32 m0, s88, 72576
s_lshl2_add_u32 s50, m0, s89
buffer_load_dwordx4 v243, s[56:59], s50 offen  lds
v_mfma_f32_16x16x32_bf16 a[68:71], v[76:79], a[192:195], a[68:71]
v_exp_f32 v67, v67
v_mfma_f32_16x16x32_bf16 a[72:75], v[80:83], a[192:195], a[72:75]
v_cvt_pk_bf16_f32 v101, v66, v67
v_mfma_f32_16x16x32_bf16 a[88:91], v[80:83], a[196:199], a[88:91]
v_exp_f32 v68, v68
v_mfma_f32_16x16x32_bf16 a[92:95], v[84:87], a[196:199], a[92:95]
ds_read_b64_tr_b16 a[196:197], v225 offset:8192
ds_read_b64_tr_b16 a[198:199], v225 offset:12288
v_mfma_f32_16x16x32_bf16 a[76:79], v[84:87], a[192:195], a[76:79]
v_exp_f32 v69, v69
v_mfma_f32_16x16x32_bf16 a[108:111], v[84:87], a[200:203], a[108:111]
ds_read_b64_tr_b16 a[192:193], v224 offset:8192
v_cvt_pk_bf16_f32 v102, v68, v69
v_mfma_f32_16x16x32_bf16 a[124:127], v[84:87], a[204:207], a[124:127]
v_exp_f32 v70, v70
v_mfma_f32_16x16x32_bf16 a[120:123], v[80:83], a[204:207], a[120:123]
ds_read_b64_tr_b16 a[194:195], v224 offset:12288
v_mfma_f32_16x16x32_bf16 a[104:107], v[80:83], a[200:203], a[104:107]
v_exp_f32 v71, v71
v_mfma_f32_16x16x32_bf16 a[100:103], v[76:79], a[200:203], a[100:103]
v_cvt_pk_bf16_f32 v103, v70, v71
v_mfma_f32_16x16x32_bf16 a[116:119], v[76:79], a[204:207], a[116:119]
s_add_u32 m0, s88, 76032
s_lshl2_add_u32 s50, m0, s89
buffer_load_dwordx4 v243, s[56:59], s50 offen  lds
v_mfma_f32_16x16x32_bf16 a[112:115], v[72:75], a[204:207], a[112:115]
ds_read_b64_tr_b16 a[204:205], v227 offset:8192
ds_read_b64_tr_b16 a[206:207], v227 offset:12288
v_mfma_f32_16x16x32_bf16 a[96:99], v[72:75], a[200:203], a[96:99]
ds_read_b64_tr_b16 a[200:201], v226 offset:8192
ds_read_b64_tr_b16 a[202:203], v226 offset:12288
v_smfmac_f32_16x16x64_bf16 a[132:135], a[208:211], v[80:87], v245
s_mov_b32 s93, 0x243080
buffer_load_dword v246, v254, s[20:23], s93 offen sc0 sc1
v_mfma_f32_16x16x32_bf16 v[40:43], a[144:147], v[152:155], v[136:139]
s_mov_b32 s92, 0x1c00000
v_exp_f32 v8, v8
v_mfma_f32_16x16x32_bf16 v[40:43], a[148:151], v[156:159], v[40:43]
v_exp_f32 v9, v9
v_mfma_f32_16x16x32_bf16 v[40:43], a[152:155], v[160:163], v[40:43]
v_cvt_pk_bf16_f32 v72, v8, v9
v_mfma_f32_16x16x32_bf16 v[40:43], a[156:159], v[164:167], v[40:43]
v_exp_f32 v10, v10
v_mfma_f32_16x16x32_bf16 v[48:51], a[156:159], v[180:183], v[140:143]
v_mfma_f32_16x16x32_bf16 v[48:51], a[152:155], v[176:179], v[48:51]
v_exp_f32 v11, v11
v_mfma_f32_16x16x32_bf16 v[48:51], a[148:151], v[172:175], v[48:51]
v_cvt_pk_bf16_f32 v73, v10, v11
v_mfma_f32_16x16x32_bf16 v[48:51], a[144:147], v[168:171], v[48:51]
v_exp_f32 v12, v12
v_mfma_f32_16x16x32_bf16 v[56:59], a[144:147], v[184:187], v[144:147]
v_mfma_f32_16x16x32_bf16 v[56:59], a[148:151], v[188:191], v[56:59]
v_exp_f32 v13, v13
v_mfma_f32_16x16x32_bf16 v[56:59], a[152:155], v[192:195], v[56:59]
v_cvt_pk_bf16_f32 v74, v12, v13
v_mfma_f32_16x16x32_bf16 v[56:59], a[156:159], v[196:199], v[56:59]
v_exp_f32 v14, v14
v_mfma_f32_16x16x32_bf16 v[64:67], a[156:159], v[212:215], v[148:151]
s_waitcnt vmcnt(11) lgkmcnt(0)
s_barrier
v_mfma_f32_16x16x32_bf16 v[64:67], a[152:155], v[208:211], v[64:67]
v_exp_f32 v15, v15
v_mfma_f32_16x16x32_bf16 v[64:67], a[148:151], v[204:207], v[64:67]
ds_read_b128 a[156:159], v219 offset:49152
v_cvt_pk_bf16_f32 v75, v14, v15
v_mfma_f32_16x16x32_bf16 v[64:67], a[144:147], v[200:203], v[64:67]
v_exp_f32 v16, v16
v_mfma_f32_16x16x32_bf16 a[0:3], v[88:91], a[176:179], a[0:3]
ds_read_b128 a[152:155], v218 offset:49152
ds_read_b128 a[148:151], v217 offset:49152
v_mfma_f32_16x16x32_bf16 a[16:19], v[88:91], a[180:183], a[16:19]
v_exp_f32 v17, v17
v_mfma_f32_16x16x32_bf16 a[20:23], v[92:95], a[180:183], a[20:23]
ds_read_b128 a[144:147], v216 offset:49152
v_cvt_pk_bf16_f32 v76, v16, v17
v_mfma_f32_16x16x32_bf16 a[4:7], v[92:95], a[176:179], a[4:7]
v_exp_f32 v18, v18
v_mfma_f32_16x16x32_bf16 a[8:11], v[96:99], a[176:179], a[8:11]
s_add_u32 m0, s88, 79488
s_lshl2_add_u32 s50, m0, s89
buffer_load_dwordx4 v243, s[56:59], s50 offen  lds
v_mfma_f32_16x16x32_bf16 a[24:27], v[96:99], a[180:183], a[24:27]
v_exp_f32 v19, v19
v_mfma_f32_16x16x32_bf16 a[28:31], v[100:103], a[180:183], a[28:31]
ds_read_b64_tr_b16 a[180:181], v221 offset:32768
v_cvt_pk_bf16_f32 v77, v18, v19
v_mfma_f32_16x16x32_bf16 a[12:15], v[100:103], a[176:179], a[12:15]
v_exp_f32 v20, v20
v_mfma_f32_16x16x32_bf16 a[44:47], v[100:103], a[184:187], a[44:47]
ds_read_b64_tr_b16 a[182:183], v221 offset:36864
ds_read_b64_tr_b16 a[176:177], v220 offset:32768
v_mfma_f32_16x16x32_bf16 a[60:63], v[100:103], a[188:191], a[60:63]
v_exp_f32 v21, v21
v_mfma_f32_16x16x32_bf16 a[56:59], v[96:99], a[188:191], a[56:59]
ds_read_b64_tr_b16 a[178:179], v220 offset:36864
v_cvt_pk_bf16_f32 v78, v20, v21
v_mfma_f32_16x16x32_bf16 a[40:43], v[96:99], a[184:187], a[40:43]
v_exp_f32 v22, v22
v_mfma_f32_16x16x32_bf16 a[36:39], v[92:95], a[184:187], a[36:39]
s_add_u32 m0, s88, 82944
s_lshl2_add_u32 s50, m0, s89
buffer_load_dwordx4 v243, s[56:59], s50 offen  lds
v_mfma_f32_16x16x32_bf16 a[52:55], v[92:95], a[188:191], a[52:55]
v_exp_f32 v23, v23
v_mfma_f32_16x16x32_bf16 a[48:51], v[88:91], a[188:191], a[48:51]
ds_read_b64_tr_b16 a[188:189], v223 offset:32768
v_cvt_pk_bf16_f32 v79, v22, v23
v_mfma_f32_16x16x32_bf16 a[32:35], v[88:91], a[184:187], a[32:35]
v_exp_f32 v24, v24
v_smfmac_f32_16x16x64_bf16 a[128:131], a[208:211], v[88:95], v245
ds_read_b64_tr_b16 a[190:191], v223 offset:36864
v_mfma_f32_16x16x32_bf16 v[44:47], a[160:163], v[152:155], v[136:139]
v_exp_f32 v25, v25
v_mfma_f32_16x16x32_bf16 v[44:47], a[164:167], v[156:159], v[44:47]
v_exp_f32 v26, v26
v_mfma_f32_16x16x32_bf16 v[44:47], a[168:171], v[160:163], v[44:47]
ds_read_b64_tr_b16 a[184:185], v222 offset:32768
v_cvt_pk_bf16_f32 v80, v24, v25
v_mfma_f32_16x16x32_bf16 v[44:47], a[172:175], v[164:167], v[44:47]
v_exp_f32 v27, v27
v_mfma_f32_16x16x32_bf16 v[52:55], a[172:175], v[180:183], v[140:143]
ds_read_b64_tr_b16 a[186:187], v222 offset:36864
v_cvt_pk_bf16_f32 v81, v26, v27
v_mfma_f32_16x16x32_bf16 v[52:55], a[168:171], v[176:179], v[52:55]
v_exp_f32 v28, v28
v_mfma_f32_16x16x32_bf16 v[52:55], a[164:167], v[172:175], v[52:55]
s_add_u32 m0, s88, 86400
s_lshl2_add_u32 s50, m0, s89
buffer_load_dwordx4 v243, s[56:59], s50 offen  lds
v_mfma_f32_16x16x32_bf16 v[52:55], a[160:163], v[168:171], v[52:55]
v_exp_f32 v29, v29
v_mfma_f32_16x16x32_bf16 v[60:63], a[160:163], v[184:187], v[144:147]
buffer_load_dwordx4 a[222:225], v248, s[20:23], s92 offen offset:0 sc0 sc1
v_cvt_pk_bf16_f32 v82, v28, v29
v_mfma_f32_16x16x32_bf16 v[60:63], a[164:167], v[188:191], v[60:63]
v_exp_f32 v30, v30
v_mfma_f32_16x16x32_bf16 v[60:63], a[168:171], v[192:195], v[60:63]
s_add_u32 m0, s88, 89856
s_lshl2_add_u32 s50, m0, s89
buffer_load_dwordx4 v243, s[56:59], s50 offen  lds
v_mfma_f32_16x16x32_bf16 v[60:63], a[172:175], v[196:199], v[60:63]
v_exp_f32 v31, v31
v_mfma_f32_16x16x32_bf16 v[68:71], a[172:175], v[212:215], v[148:151]
ds_read_b128 a[172:175], v219 offset:53248
v_cvt_pk_bf16_f32 v83, v30, v31
v_mfma_f32_16x16x32_bf16 v[68:71], a[168:171], v[208:211], v[68:71]
v_exp_f32 v32, v32
v_mfma_f32_16x16x32_bf16 v[68:71], a[164:167], v[204:207], v[68:71]
ds_read_b128 a[168:171], v218 offset:53248
ds_read_b128 a[164:167], v217 offset:53248
v_mfma_f32_16x16x32_bf16 v[68:71], a[160:163], v[200:203], v[68:71]
v_exp_f32 v33, v33
v_mfma_f32_16x16x32_bf16 a[64:67], v[88:91], a[192:195], a[64:67]
ds_read_b128 a[160:163], v216 offset:53248
v_cvt_pk_bf16_f32 v84, v32, v33
v_mfma_f32_16x16x32_bf16 a[80:83], v[88:91], a[196:199], a[80:83]
v_exp_f32 v34, v34
v_mfma_f32_16x16x32_bf16 a[84:87], v[92:95], a[196:199], a[84:87]
s_add_u32 m0, s88, 93312
s_lshl2_add_u32 s50, m0, s89
buffer_load_dwordx4 v243, s[56:59], s50 offen  lds
v_mfma_f32_16x16x32_bf16 a[68:71], v[92:95], a[192:195], a[68:71]
v_exp_f32 v35, v35
v_mfma_f32_16x16x32_bf16 a[72:75], v[96:99], a[192:195], a[72:75]
buffer_load_dwordx4 a[226:229], v248, s[20:23], s92 offen offset:128 sc0 sc1
v_cvt_pk_bf16_f32 v85, v34, v35
v_mfma_f32_16x16x32_bf16 a[88:91], v[96:99], a[196:199], a[88:91]
v_exp_f32 v36, v36
v_mfma_f32_16x16x32_bf16 a[92:95], v[100:103], a[196:199], a[92:95]
ds_read_b64_tr_b16 a[196:197], v225 offset:32768
ds_read_b64_tr_b16 a[198:199], v225 offset:36864
v_mfma_f32_16x16x32_bf16 a[76:79], v[100:103], a[192:195], a[76:79]
v_exp_f32 v37, v37
v_mfma_f32_16x16x32_bf16 a[108:111], v[100:103], a[200:203], a[108:111]
ds_read_b64_tr_b16 a[192:193], v224 offset:32768
v_cvt_pk_bf16_f32 v86, v36, v37
v_mfma_f32_16x16x32_bf16 a[124:127], v[100:103], a[204:207], a[124:127]
v_exp_f32 v38, v38
v_mfma_f32_16x16x32_bf16 a[120:123], v[96:99], a[204:207], a[120:123]
ds_read_b64_tr_b16 a[194:195], v224 offset:36864
v_mfma_f32_16x16x32_bf16 a[104:107], v[96:99], a[200:203], a[104:107]
v_exp_f32 v39, v39
v_mfma_f32_16x16x32_bf16 a[100:103], v[92:95], a[200:203], a[100:103]
v_cvt_pk_bf16_f32 v87, v38, v39
v_mfma_f32_16x16x32_bf16 a[116:119], v[92:95], a[204:207], a[116:119]
v_mfma_f32_16x16x32_bf16 a[112:115], v[88:91], a[204:207], a[112:115]
ds_read_b64_tr_b16 a[204:205], v227 offset:32768
ds_read_b64_tr_b16 a[206:207], v227 offset:36864
v_mfma_f32_16x16x32_bf16 a[96:99], v[88:91], a[200:203], a[96:99]
ds_read_b64_tr_b16 a[200:201], v226 offset:32768
ds_read_b64_tr_b16 a[202:203], v226 offset:36864
v_smfmac_f32_16x16x64_bf16 a[132:135], a[208:211], v[96:103], v245
buffer_load_dwordx2 a[230:231], v249, s[20:23], s92 offen sc0 sc1
s_waitcnt lgkmcnt(8)
v_mfma_f32_16x16x32_bf16 v[8:11], a[144:147], v[152:155], v[136:139]
v_exp_f32 v40, v40
v_mfma_f32_16x16x32_bf16 v[8:11], a[148:151], v[156:159], v[8:11]
v_exp_f32 v41, v41
v_mfma_f32_16x16x32_bf16 v[8:11], a[152:155], v[160:163], v[8:11]
v_cvt_pk_bf16_f32 v88, v40, v41
v_mfma_f32_16x16x32_bf16 v[8:11], a[156:159], v[164:167], v[8:11]
v_exp_f32 v42, v42
v_mfma_f32_16x16x32_bf16 v[16:19], a[156:159], v[180:183], v[140:143]
s_add_u32 m0, s88, 96768
s_lshl2_add_u32 s50, m0, s89
buffer_load_dwordx4 v243, s[56:59], s50 offen  lds
v_mfma_f32_16x16x32_bf16 v[16:19], a[152:155], v[176:179], v[16:19]
v_exp_f32 v43, v43
v_mfma_f32_16x16x32_bf16 v[16:19], a[148:151], v[172:175], v[16:19]
v_cvt_pk_bf16_f32 v89, v42, v43
v_mfma_f32_16x16x32_bf16 v[16:19], a[144:147], v[168:171], v[16:19]
v_exp_f32 v44, v44
v_mfma_f32_16x16x32_bf16 v[24:27], a[144:147], v[184:187], v[144:147]
v_mfma_f32_16x16x32_bf16 v[24:27], a[148:151], v[188:191], v[24:27]
v_exp_f32 v45, v45
v_mfma_f32_16x16x32_bf16 v[24:27], a[152:155], v[192:195], v[24:27]
buffer_load_dwordx4 a[212:215], v248, s[52:55], 0 offen offset:0
v_cvt_pk_bf16_f32 v90, v44, v45
v_mfma_f32_16x16x32_bf16 v[24:27], a[156:159], v[196:199], v[24:27]
v_exp_f32 v46, v46
v_mfma_f32_16x16x32_bf16 v[32:35], a[156:159], v[212:215], v[148:151]
ds_read_b128 a[156:159], v219 offset:57344
v_mfma_f32_16x16x32_bf16 v[32:35], a[152:155], v[208:211], v[32:35]
v_exp_f32 v47, v47
v_mfma_f32_16x16x32_bf16 v[32:35], a[148:151], v[204:207], v[32:35]
ds_read_b128 a[152:155], v218 offset:57344
v_cvt_pk_bf16_f32 v91, v46, v47
v_mfma_f32_16x16x32_bf16 v[32:35], a[144:147], v[200:203], v[32:35]
v_exp_f32 v48, v48
v_mfma_f32_16x16x32_bf16 a[0:3], v[72:75], a[176:179], a[0:3]
ds_read_b128 a[148:151], v217 offset:57344
ds_read_b128 a[144:147], v216 offset:57344
v_mfma_f32_16x16x32_bf16 a[16:19], v[72:75], a[180:183], a[16:19]
v_exp_f32 v49, v49
v_mfma_f32_16x16x32_bf16 a[20:23], v[76:79], a[180:183], a[20:23]
v_cvt_pk_bf16_f32 v92, v48, v49
v_mfma_f32_16x16x32_bf16 a[4:7], v[76:79], a[176:179], a[4:7]
v_exp_f32 v50, v50
v_mfma_f32_16x16x32_bf16 a[8:11], v[80:83], a[176:179], a[8:11]
s_add_u32 m0, s88, 100224
s_lshl2_add_u32 s50, m0, s89
buffer_load_dwordx4 v243, s[56:59], s50 offen  lds
v_mfma_f32_16x16x32_bf16 a[24:27], v[80:83], a[180:183], a[24:27]
v_exp_f32 v51, v51
v_mfma_f32_16x16x32_bf16 a[28:31], v[84:87], a[180:183], a[28:31]
ds_read_b64_tr_b16 a[180:181], v221 offset:40960
v_cvt_pk_bf16_f32 v93, v50, v51
v_mfma_f32_16x16x32_bf16 a[12:15], v[84:87], a[176:179], a[12:15]
v_exp_f32 v52, v52
v_mfma_f32_16x16x32_bf16 a[44:47], v[84:87], a[184:187], a[44:47]
ds_read_b64_tr_b16 a[182:183], v221 offset:45056
ds_read_b64_tr_b16 a[176:177], v220 offset:40960
v_mfma_f32_16x16x32_bf16 a[60:63], v[84:87], a[188:191], a[60:63]
v_exp_f32 v53, v53
v_mfma_f32_16x16x32_bf16 a[56:59], v[80:83], a[188:191], a[56:59]
ds_read_b64_tr_b16 a[178:179], v220 offset:45056
v_cvt_pk_bf16_f32 v94, v52, v53
v_mfma_f32_16x16x32_bf16 a[40:43], v[80:83], a[184:187], a[40:43]
v_exp_f32 v54, v54
v_mfma_f32_16x16x32_bf16 a[36:39], v[76:79], a[184:187], a[36:39]
s_add_u32 m0, s88, 103680
s_lshl2_add_u32 s50, m0, s89
buffer_load_dwordx4 v243, s[56:59], s50 offen  lds
v_mfma_f32_16x16x32_bf16 a[52:55], v[76:79], a[188:191], a[52:55]
v_exp_f32 v55, v55
v_mfma_f32_16x16x32_bf16 a[48:51], v[72:75], a[188:191], a[48:51]
ds_read_b64_tr_b16 a[188:189], v223 offset:40960
v_cvt_pk_bf16_f32 v95, v54, v55
v_mfma_f32_16x16x32_bf16 a[32:35], v[72:75], a[184:187], a[32:35]
v_exp_f32 v56, v56
v_smfmac_f32_16x16x64_bf16 a[128:131], a[208:211], v[72:79], v245
ds_read_b64_tr_b16 a[190:191], v223 offset:45056
v_mfma_f32_16x16x32_bf16 v[12:15], a[160:163], v[152:155], v[136:139]
v_exp_f32 v57, v57
v_mfma_f32_16x16x32_bf16 v[12:15], a[164:167], v[156:159], v[12:15]
v_exp_f32 v58, v58
v_mfma_f32_16x16x32_bf16 v[12:15], a[168:171], v[160:163], v[12:15]
ds_read_b64_tr_b16 a[184:185], v222 offset:40960
v_cvt_pk_bf16_f32 v96, v56, v57
v_mfma_f32_16x16x32_bf16 v[12:15], a[172:175], v[164:167], v[12:15]
v_exp_f32 v59, v59
v_mfma_f32_16x16x32_bf16 v[20:23], a[172:175], v[180:183], v[140:143]
ds_read_b64_tr_b16 a[186:187], v222 offset:45056
v_cvt_pk_bf16_f32 v97, v58, v59
v_mfma_f32_16x16x32_bf16 v[20:23], a[168:171], v[176:179], v[20:23]
v_exp_f32 v60, v60
v_mfma_f32_16x16x32_bf16 v[20:23], a[164:167], v[172:175], v[20:23]
s_add_u32 m0, s88, 107136
STUB_12:
STUB_B3:
s_cbranch_execz STUB_15
s_lshl2_add_u32 s50, m0, s89
buffer_load_dwordx4 v243, s[56:59], s50 offen  lds
v_mfma_f32_16x16x32_bf16 v[20:23], a[160:163], v[168:171], v[20:23]
v_exp_f32 v61, v61
v_mfma_f32_16x16x32_bf16 v[28:31], a[160:163], v[184:187], v[144:147]
buffer_load_dwordx4 a[216:219], v248, s[52:55], 0 offen offset:128
v_cvt_pk_bf16_f32 v98, v60, v61
v_mfma_f32_16x16x32_bf16 v[28:31], a[164:167], v[188:191], v[28:31]
v_exp_f32 v62, v62
v_mfma_f32_16x16x32_bf16 v[28:31], a[168:171], v[192:195], v[28:31]
v_mfma_f32_16x16x32_bf16 v[28:31], a[172:175], v[196:199], v[28:31]
v_exp_f32 v63, v63
v_mfma_f32_16x16x32_bf16 v[36:39], a[172:175], v[212:215], v[148:151]
ds_read_b128 a[172:175], v219 offset:61440
v_cvt_pk_bf16_f32 v99, v62, v63
v_mfma_f32_16x16x32_bf16 v[36:39], a[168:171], v[208:211], v[36:39]
v_exp_f32 v64, v64
v_mfma_f32_16x16x32_bf16 v[36:39], a[164:167], v[204:207], v[36:39]
ds_read_b128 a[168:171], v218 offset:61440
ds_read_b128 a[164:167], v217 offset:61440
v_mfma_f32_16x16x32_bf16 v[36:39], a[160:163], v[200:203], v[36:39]
v_exp_f32 v65, v65
s_waitcnt lgkmcnt(8)
v_mfma_f32_16x16x32_bf16 a[64:67], v[72:75], a[192:195], a[64:67]
ds_read_b128 a[160:163], v216 offset:61440
v_cvt_pk_bf16_f32 v100, v64, v65
v_mfma_f32_16x16x32_bf16 a[80:83], v[72:75], a[196:199], a[80:83]
v_exp_f32 v66, v66
v_mfma_f32_16x16x32_bf16 a[84:87], v[76:79], a[196:199], a[84:87]
s_add_u32 m0, s88, 110592
s_lshl2_add_u32 s50, m0, s89
buffer_load_dwordx4 v243, s[56:59], s50 offen  lds
v_mfma_f32_16x16x32_bf16 a[68:71], v[76:79], a[192:195], a[68:71]
v_exp_f32 v67, v67
v_mfma_f32_16x16x32_bf16 a[72:75], v[80:83], a[192:195], a[72:75]
buffer_load_dwordx2 a[220:221], v249, s[52:55], 0 offen
v_cvt_pk_bf16_f32 v101, v66, v67
v_mfma_f32_16x16x32_bf16 a[88:91], v[80:83], a[196:199], a[88:91]
v_sub_u32 v133, 0xffff, v132
v_exp_f32 v68, v68
v_mfma_f32_16x16x32_bf16 a[92:95], v[84:87], a[196:199], a[92:95]
ds_read_b64_tr_b16 a[196:197], v225 offset:40960
ds_read_b64_tr_b16 a[198:199], v225 offset:45056
s_and_b32 s93, s76, 0xffff
v_mfma_f32_16x16x32_bf16 a[76:79], v[84:87], a[192:195], a[76:79]
v_cmp_eq_u32 s[90:91], s93, v133
v_exp_f32 v69, v69
v_mfma_f32_16x16x32_bf16 a[108:111], v[84:87], a[200:203], a[108:111]
ds_read_b64_tr_b16 a[192:193], v224 offset:40960
v_cvt_pk_bf16_f32 v102, v68, v69
v_mov_b32 v134, 0
v_mfma_f32_16x16x32_bf16 a[124:127], v[84:87], a[204:207], a[124:127]
v_cndmask_b32 v135, v135, v134, s[90:91]
v_exp_f32 v70, v70
v_mfma_f32_16x16x32_bf16 a[120:123], v[80:83], a[204:207], a[120:123]
ds_read_b64_tr_b16 a[194:195], v224 offset:45056
s_and_b32 s93, s77, 0xffff
v_mfma_f32_16x16x32_bf16 a[104:107], v[80:83], a[200:203], a[104:107]
v_cmp_eq_u32 s[90:91], s93, v133
v_exp_f32 v71, v71
v_mfma_f32_16x16x32_bf16 a[100:103], v[76:79], a[200:203], a[100:103]
v_cvt_pk_bf16_f32 v103, v70, v71
v_mov_b32 v134, 1152
v_mfma_f32_16x16x32_bf16 a[116:119], v[76:79], a[204:207], a[116:119]
v_cndmask_b32 v135, v135, v134, s[90:91]
v_mfma_f32_16x16x32_bf16 a[112:115], v[72:75], a[204:207], a[112:115]
ds_read_b64_tr_b16 a[204:205], v227 offset:40960
ds_read_b64_tr_b16 a[206:207], v227 offset:45056
s_and_b32 s93, s78, 0xffff
v_mfma_f32_16x16x32_bf16 a[96:99], v[72:75], a[200:203], a[96:99]
ds_read_b64_tr_b16 a[200:201], v226 offset:40960
ds_read_b64_tr_b16 a[202:203], v226 offset:45056
v_cmp_eq_u32 s[90:91], s93, v133
v_smfmac_f32_16x16x64_bf16 a[132:135], a[208:211], v[80:87], v245
v_mov_b32 v134, 2304
v_mfma_f32_16x16x32_bf16 v[40:43], a[144:147], v[152:155], v[136:139]
v_cndmask_b32 v135, v135, v134, s[90:91]
v_exp_f32 v8, v8
v_mfma_f32_16x16x32_bf16 v[40:43], a[148:151], v[156:159], v[40:43]
s_and_b32 s93, s79, 0xffff
v_exp_f32 v9, v9
v_mfma_f32_16x16x32_bf16 v[40:43], a[152:155], v[160:163], v[40:43]
v_cvt_pk_bf16_f32 v72, v8, v9
v_cmp_eq_u32 s[90:91], s93, v133
v_mov_b32 v134, 3456
v_mfma_f32_16x16x32_bf16 v[40:43], a[156:159], v[164:167], v[40:43]
v_cndmask_b32 v135, v135, v134, s[90:91]
v_exp_f32 v10, v10
v_mfma_f32_16x16x32_bf16 v[48:51], a[156:159], v[180:183], v[140:143]
s_and_b32 s93, s80, 0xffff
v_mfma_f32_16x16x32_bf16 v[48:51], a[152:155], v[176:179], v[48:51]
v_cmp_eq_u32 s[90:91], s93, v133
v_exp_f32 v11, v11
v_mfma_f32_16x16x32_bf16 v[48:51], a[148:151], v[172:175], v[48:51]
v_cvt_pk_bf16_f32 v73, v10, v11
v_mov_b32 v134, 4608
v_mfma_f32_16x16x32_bf16 v[48:51], a[144:147], v[168:171], v[48:51]
v_cndmask_b32 v135, v135, v134, s[90:91]
v_exp_f32 v12, v12
v_mfma_f32_16x16x32_bf16 v[56:59], a[144:147], v[184:187], v[144:147]
s_and_b32 s93, s81, 0xffff
v_mfma_f32_16x16x32_bf16 v[56:59], a[148:151], v[188:191], v[56:59]
v_cmp_eq_u32 s[90:91], s93, v133
v_exp_f32 v13, v13
v_mfma_f32_16x16x32_bf16 v[56:59], a[152:155], v[192:195], v[56:59]
v_cvt_pk_bf16_f32 v74, v12, v13
v_mov_b32 v134, 5760
v_mfma_f32_16x16x32_bf16 v[56:59], a[156:159], v[196:199], v[56:59]
v_cndmask_b32 v135, v135, v134, s[90:91]
v_exp_f32 v14, v14
v_mfma_f32_16x16x32_bf16 v[64:67], a[156:159], v[212:215], v[148:151]
s_waitcnt vmcnt(16) lgkmcnt(0)
s_barrier
s_and_b32 s93, s82, 0xffff
v_mfma_f32_16x16x32_bf16 v[64:67], a[152:155], v[208:211], v[64:67]
v_cmp_eq_u32 s[90:91], s93, v133
v_exp_f32 v15, v15
v_mfma_f32_16x16x32_bf16 v[64:67], a[148:151], v[204:207], v[64:67]
v_cvt_pk_bf16_f32 v75, v14, v15
v_mov_b32 v134, 6912
v_mfma_f32_16x16x32_bf16 v[64:67], a[144:147], v[200:203], v[64:67]
v_cndmask_b32 v135, v135, v134, s[90:91]
v_exp_f32 v16, v16
v_mfma_f32_16x16x32_bf16 a[0:3], v[88:91], a[176:179], a[0:3]
s_add_u32 m0, s88, 114048
s_lshl2_add_u32 s50, m0, s89
buffer_load_dwordx4 v243, s[56:59], s50 offen  lds
v_mfma_f32_16x16x32_bf16 a[16:19], v[88:91], a[180:183], a[16:19]
s_and_b32 s93, s83, 0xffff
v_exp_f32 v17, v17
v_mfma_f32_16x16x32_bf16 a[20:23], v[92:95], a[180:183], a[20:23]
v_cvt_pk_bf16_f32 v76, v16, v17
v_cmp_eq_u32 s[90:91], s93, v133
v_mov_b32 v134, 8064
v_mfma_f32_16x16x32_bf16 a[4:7], v[92:95], a[176:179], a[4:7]
v_cndmask_b32 v135, v135, v134, s[90:91]
v_exp_f32 v18, v18
v_mfma_f32_16x16x32_bf16 a[8:11], v[96:99], a[176:179], a[8:11]
v_add_u32 v250, v250, v135
v_add_u32 v251, v251, v135
v_mfma_f32_16x16x32_bf16 a[24:27], v[96:99], a[180:183], a[24:27]
v_exp_f32 v19, v19
v_mfma_f32_16x16x32_bf16 a[28:31], v[100:103], a[180:183], a[28:31]
ds_read_b64_tr_b16 a[180:181], v221 offset:49152
v_cvt_pk_bf16_f32 v77, v18, v19
v_lshrrev_b32 v134, 14, v135
v_mfma_f32_16x16x32_bf16 a[12:15], v[100:103], a[176:179], a[12:15]
v_exp_f32 v20, v20
v_mfma_f32_16x16x32_bf16 a[44:47], v[100:103], a[184:187], a[44:47]
ds_read_b64_tr_b16 a[182:183], v221 offset:53248
ds_read_b64_tr_b16 a[176:177], v220 offset:49152
v_mfma_f32_16x16x32_bf16 a[60:63], v[100:103], a[188:191], a[60:63]
v_exp_f32 v21, v21
v_mfma_f32_16x16x32_bf16 a[56:59], v[96:99], a[188:191], a[56:59]
ds_read_b64_tr_b16 a[178:179], v220 offset:53248
v_cvt_pk_bf16_f32 v78, v20, v21
v_mfma_f32_16x16x32_bf16 a[40:43], v[96:99], a[184:187], a[40:43]
v_cmp_eq_u32 s[90:91], 0, v134
v_exp_f32 v22, v22
v_mfma_f32_16x16x32_bf16 a[36:39], v[92:95], a[184:187], a[36:39]
s_add_u32 m0, s88, 117504
s_lshl2_add_u32 s50, m0, s89
buffer_load_dwordx4 v243, s[56:59], s50 offen  lds
v_mfma_f32_16x16x32_bf16 a[52:55], v[92:95], a[188:191], a[52:55]
v_exp_f32 v23, v23
v_mfma_f32_16x16x32_bf16 a[48:51], v[88:91], a[188:191], a[48:51]
ds_read_b64_tr_b16 a[188:189], v223 offset:49152
v_cvt_pk_bf16_f32 v79, v22, v23
v_mfma_f32_16x16x32_bf16 a[32:35], v[88:91], a[184:187], a[32:35]
v_exp_f32 v24, v24
v_smfmac_f32_16x16x64_bf16 a[128:131], a[208:211], v[88:95], v245
ds_read_b64_tr_b16 a[190:191], v223 offset:53248
v_mfma_f32_16x16x32_bf16 v[44:47], a[160:163], v[152:155], v[136:139]
v_exp_f32 v25, v25
v_mfma_f32_16x16x32_bf16 v[44:47], a[164:167], v[156:159], v[44:47]
v_exp_f32 v26, v26
v_mfma_f32_16x16x32_bf16 v[44:47], a[168:171], v[160:163], v[44:47]
ds_read_b64_tr_b16 a[184:185], v222 offset:49152
v_cvt_pk_bf16_f32 v80, v24, v25
v_mfma_f32_16x16x32_bf16 v[44:47], a[172:175], v[164:167], v[44:47]
v_exp_f32 v27, v27
v_mfma_f32_16x16x32_bf16 v[52:55], a[172:175], v[180:183], v[140:143]
ds_read_b64_tr_b16 a[186:187], v222 offset:53248
v_cvt_pk_bf16_f32 v81, v26, v27
v_mfma_f32_16x16x32_bf16 v[52:55], a[168:171], v[176:179], v[52:55]
v_exp_f32 v28, v28
v_mfma_f32_16x16x32_bf16 v[52:55], a[164:167], v[172:175], v[52:55]
s_add_u32 m0, s88, 120960
s_lshl2_add_u32 s50, m0, s89
buffer_load_dwordx4 v243, s[56:59], s50 offen  lds
v_mfma_f32_16x16x32_bf16 v[52:55], a[160:163], v[168:171], v[52:55]
v_exp_f32 v29, v29
v_mfma_f32_16x16x32_bf16 v[60:63], a[160:163], v[184:187], v[144:147]
v_cvt_pk_bf16_f32 v82, v28, v29
s_waitcnt vmcnt(19)
v_readfirstlane_b32 s93, v246
v_mfma_f32_16x16x32_bf16 v[60:63], a[164:167], v[188:191], v[60:63]
v_exp_f32 v30, v30
v_mfma_f32_16x16x32_bf16 v[60:63], a[168:171], v[192:195], v[60:63]
s_add_u32 m0, s88, 124416
s_lshl2_add_u32 s50, m0, s89
buffer_load_dwordx4 v243, s[56:59], s50 offen  lds
v_mfma_f32_16x16x32_bf16 v[60:63], a[172:175], v[196:199], v[60:63]
v_exp_f32 v31, v31
v_mfma_f32_16x16x32_bf16 v[68:71], a[172:175], v[212:215], v[148:151]
s_cmp_eq_u64 s[90:91], 0
s_cselect_b32 s93, 144, s93
v_cvt_pk_bf16_f32 v83, v30, v31
v_mfma_f32_16x16x32_bf16 v[68:71], a[168:171], v[208:211], v[68:71]
v_exp_f32 v32, v32
v_mfma_f32_16x16x32_bf16 v[68:71], a[164:167], v[204:207], v[68:71]
s_add_u32 m0, s88, 127872
s_lshl2_add_u32 s50, m0, s89
buffer_load_dwordx4 v243, s[56:59], s50 offen  lds
v_mfma_f32_16x16x32_bf16 v[68:71], a[160:163], v[200:203], v[68:71]
v_exp_f32 v33, v33
v_mfma_f32_16x16x32_bf16 a[64:67], v[88:91], a[192:195], a[64:67]
v_cvt_pk_bf16_f32 v84, v32, v33
v_mfma_f32_16x16x32_bf16 a[80:83], v[88:91], a[196:199], a[80:83]
v_exp_f32 v34, v34
v_mfma_f32_16x16x32_bf16 a[84:87], v[92:95], a[196:199], a[84:87]
s_add_u32 m0, s88, 131328
s_lshl2_add_u32 s50, m0, s89
buffer_load_dwordx4 v243, s[56:59], s50 offen  lds
v_mfma_f32_16x16x32_bf16 a[68:71], v[92:95], a[192:195], a[68:71]
v_exp_f32 v35, v35
v_mfma_f32_16x16x32_bf16 a[72:75], v[96:99], a[192:195], a[72:75]
s_cmp_lt_u32 s93, 144
s_cbranch_scc1 SP_Y
SP_Y_RET:
v_cvt_pk_bf16_f32 v85, v34, v35
v_mfma_f32_16x16x32_bf16 a[88:91], v[96:99], a[196:199], a[88:91]
v_exp_f32 v36, v36
v_mfma_f32_16x16x32_bf16 a[92:95], v[100:103], a[196:199], a[92:95]
ds_read_b64_tr_b16 a[196:197], v225 offset:49152
ds_read_b64_tr_b16 a[198:199], v225 offset:53248
v_mfma_f32_16x16x32_bf16 a[76:79], v[100:103], a[192:195], a[76:79]
v_exp_f32 v37, v37
v_mfma_f32_16x16x32_bf16 a[108:111], v[100:103], a[200:203], a[108:111]
ds_read_b64_tr_b16 a[192:193], v224 offset:49152
v_cvt_pk_bf16_f32 v86, v36, v37
v_mfma_f32_16x16x32_bf16 a[124:127], v[100:103], a[204:207], a[124:127]
v_exp_f32 v38, v38
v_mfma_f32_16x16x32_bf16 a[120:123], v[96:99], a[204:207], a[120:123]
ds_read_b64_tr_b16 a[194:195], v224 offset:53248
s_mov_b32 s93, 0x244000
v_mfma_f32_16x16x32_bf16 a[104:107], v[96:99], a[200:203], a[104:107]
v_exp_f32 v39, v39
v_mfma_f32_16x16x32_bf16 a[100:103], v[92:95], a[200:203], a[100:103]
v_cvt_pk_bf16_f32 v87, v38, v39
v_mfma_f32_16x16x32_bf16 a[116:119], v[92:95], a[204:207], a[116:119]
s_add_u32 m0, s88, 134784
s_lshl2_add_u32 s50, m0, s89
buffer_load_dwordx4 v243, s[56:59], s50 offen  lds
v_mfma_f32_16x16x32_bf16 a[112:115], v[88:91], a[204:207], a[112:115]
ds_read_b64_tr_b16 a[204:205], v227 offset:49152
ds_read_b64_tr_b16 a[206:207], v227 offset:53248
v_mfma_f32_16x16x32_bf16 a[96:99], v[88:91], a[200:203], a[96:99]
ds_read_b64_tr_b16 a[200:201], v226 offset:49152
ds_read_b64_tr_b16 a[202:203], v226 offset:53248
v_smfmac_f32_16x16x64_bf16 a[132:135], a[208:211], v[96:103], v245
buffer_load_dwordx4 a[232:235], v250, s[20:23], s93 offen offset:0 sc0 sc1
s_waitcnt lgkmcnt(8)
v_mfma_f32_16x16x32_bf16 a[0:3], v[72:75], a[176:179], a[0:3]
v_exp_f32 v40, v40
v_exp_f32 v41, v41
v_mfma_f32_16x16x32_bf16 a[4:7], v[76:79], a[176:179], a[4:7]
v_cvt_pk_bf16_f32 v88, v40, v41
v_exp_f32 v42, v42
v_mfma_f32_16x16x32_bf16 a[8:11], v[80:83], a[176:179], a[8:11]
buffer_load_dwordx4 a[236:239], v250, s[20:23], s93 offen offset:128 sc0 sc1
v_exp_f32 v43, v43
v_mfma_f32_16x16x32_bf16 a[12:15], v[84:87], a[176:179], a[12:15]
ds_read_b64_tr_b16 a[176:177], v220 offset:57344
v_cvt_pk_bf16_f32 v89, v42, v43
v_exp_f32 v44, v44
v_mfma_f32_16x16x32_bf16 a[28:31], v[84:87], a[180:183], a[28:31]
ds_read_b64_tr_b16 a[178:179], v220 offset:61440
v_exp_f32 v45, v45
v_mfma_f32_16x16x32_bf16 a[24:27], v[80:83], a[180:183], a[24:27]
v_cvt_pk_bf16_f32 v90, v44, v45
v_exp_f32 v46, v46
v_mfma_f32_16x16x32_bf16 a[20:23], v[76:79], a[180:183], a[20:23]
buffer_load_dwordx2 a[240:241], v251, s[20:23], s93 offen sc0 sc1
v_exp_f32 v47, v47
v_mfma_f32_16x16x32_bf16 a[16:19], v[72:75], a[180:183], a[16:19]
ds_read_b64_tr_b16 a[180:181], v221 offset:57344
v_cvt_pk_bf16_f32 v91, v46, v47
v_exp_f32 v48, v48
v_mfma_f32_16x16x32_bf16 a[32:35], v[72:75], a[184:187], a[32:35]
ds_read_b64_tr_b16 a[182:183], v221 offset:61440
v_exp_f32 v49, v49
v_mfma_f32_16x16x32_bf16 a[36:39], v[76:79], a[184:187], a[36:39]
v_cvt_pk_bf16_f32 v92, v48, v49
v_exp_f32 v50, v50
v_mfma_f32_16x16x32_bf16 a[40:43], v[80:83], a[184:187], a[40:43]
v_exp_f32 v51, v51
v_mfma_f32_16x16x32_bf16 a[44:47], v[84:87], a[184:187], a[44:47]
ds_read_b64_tr_b16 a[184:185], v222 offset:57344
v_cvt_pk_bf16_f32 v93, v50, v51
v_exp_f32 v52, v52
v_mfma_f32_16x16x32_bf16 a[60:63], v[84:87], a[188:191], a[60:63]
ds_read_b64_tr_b16 a[186:187], v222 offset:61440
v_exp_f32 v53, v53
v_mfma_f32_16x16x32_bf16 a[56:59], v[80:83], a[188:191], a[56:59]
v_cvt_pk_bf16_f32 v94, v52, v53
v_exp_f32 v54, v54
v_mfma_f32_16x16x32_bf16 a[52:55], v[76:79], a[188:191], a[52:55]
v_exp_f32 v55, v55
v_mfma_f32_16x16x32_bf16 a[48:51], v[72:75], a[188:191], a[48:51]
v_exp_f32 v56, v56
v_exp_f32 v57, v57
v_smfmac_f32_16x16x64_bf16 a[128:131], a[208:211], v[72:79], v245
v_cvt_pk_bf16_f32 v95, v54, v55
v_cvt_pk_bf16_f32 v96, v56, v57
v_exp_f32 v58, v58
s_waitcnt lgkmcnt(8)
v_mfma_f32_16x16x32_bf16 a[64:67], v[72:75], a[192:195], a[64:67]
ds_read_b64_tr_b16 a[188:189], v223 offset:57344
ds_read_b64_tr_b16 a[190:191], v223 offset:61440
v_exp_f32 v59, v59
v_mfma_f32_16x16x32_bf16 a[68:71], v[76:79], a[192:195], a[68:71]
v_cvt_pk_bf16_f32 v97, v58, v59
v_exp_f32 v60, v60
v_mfma_f32_16x16x32_bf16 a[72:75], v[80:83], a[192:195], a[72:75]
v_exp_f32 v61, v61
v_mfma_f32_16x16x32_bf16 a[76:79], v[84:87], a[192:195], a[76:79]
ds_read_b64_tr_b16 a[192:193], v224 offset:57344
v_cvt_pk_bf16_f32 v98, v60, v61
v_exp_f32 v62, v62
v_mfma_f32_16x16x32_bf16 a[92:95], v[84:87], a[196:199], a[92:95]
ds_read_b64_tr_b16 a[194:195], v224 offset:61440
v_exp_f32 v63, v63
v_mfma_f32_16x16x32_bf16 a[88:91], v[80:83], a[196:199], a[88:91]
v_cvt_pk_bf16_f32 v99, v62, v63
v_exp_f32 v64, v64
v_mfma_f32_16x16x32_bf16 a[84:87], v[76:79], a[196:199], a[84:87]
v_exp_f32 v65, v65
v_mfma_f32_16x16x32_bf16 a[80:83], v[72:75], a[196:199], a[80:83]
ds_read_b64_tr_b16 a[196:197], v225 offset:57344
v_cvt_pk_bf16_f32 v100, v64, v65
v_exp_f32 v66, v66
s_waitcnt lgkmcnt(8)
v_mfma_f32_16x16x32_bf16 a[96:99], v[72:75], a[200:203], a[96:99]
ds_read_b64_tr_b16 a[198:199], v225 offset:61440
v_exp_f32 v67, v67
v_mfma_f32_16x16x32_bf16 a[100:103], v[76:79], a[200:203], a[100:103]
v_cvt_pk_bf16_f32 v101, v66, v67
v_exp_f32 v68, v68
v_mfma_f32_16x16x32_bf16 a[104:107], v[80:83], a[200:203], a[104:107]
v_exp_f32 v69, v69
v_mfma_f32_16x16x32_bf16 a[108:111], v[84:87], a[200:203], a[108:111]
ds_read_b64_tr_b16 a[200:201], v226 offset:57344
v_cvt_pk_bf16_f32 v102, v68, v69
v_exp_f32 v70, v70
v_mfma_f32_16x16x32_bf16 a[124:127], v[84:87], a[204:207], a[124:127]
ds_read_b64_tr_b16 a[202:203], v226 offset:61440
v_exp_f32 v71, v71
v_mfma_f32_16x16x32_bf16 a[120:123], v[80:83], a[204:207], a[120:123]
v_cvt_pk_bf16_f32 v103, v70, v71
v_mfma_f32_16x16x32_bf16 a[116:119], v[76:79], a[204:207], a[116:119]
s_add_u32 m0, s88, 138240
s_lshl2_add_u32 s50, m0, s89
buffer_load_dwordx4 v243, s[56:59], s50 offen  lds
v_mfma_f32_16x16x32_bf16 a[112:115], v[72:75], a[204:207], a[112:115]
ds_read_b64_tr_b16 a[204:205], v227 offset:57344
ds_read_b64_tr_b16 a[206:207], v227 offset:61440
v_smfmac_f32_16x16x64_bf16 a[132:135], a[208:211], v[80:87], v245
s_add_u32 m0, s88, 141696
s_lshl2_add_u32 s50, m0, s89
buffer_load_dwordx4 v243, s[56:59], s50 offen  lds
s_add_u32 m0, s88, 145152
s_min_u32 m0, m0, 146880
s_lshl2_add_u32 s50, m0, s89
s_cmp_ge_u32 s37, 2
s_cselect_b32 exec_hi, 15, -1
buffer_load_dwordx4 v243, s[56:59], s50 offen  lds
s_mov_b32 exec_hi, -1
K_TAIL:
s_cmp_eq_u32 s48, 0
s_cbranch_scc1 K_MIXED
s_waitcnt lgkmcnt(0)
s_barrier
s_add_u32 s28, s30, 147456
v_smfmac_f32_16x16x64_bf16 a[128:131], a[208:211], v[88:95], v245
v_lshrrev_b32 v132, 1, v1
v_and_b32 v132, 8, v132
v_smfmac_f32_16x16x64_bf16 a[132:135], a[208:211], v[96:103], v245
v_xor_b32 v132, v132, v1
v_lshlrev_b32 v132, 4, v132
v_mfma_f32_16x16x32_bf16 a[0:3], v[88:91], a[176:179], a[0:3]
v_add_u32 v132, s28, v132
v_lshlrev_b32 v133, 3, v1
v_mfma_f32_16x16x32_bf16 a[16:19], v[88:91], a[180:183], a[16:19]
v_and_b32 v133, 8, v133
v_lshrrev_b32 v134, 2, v1
v_mfma_f32_16x16x32_bf16 a[32:35], v[88:91], a[184:187], a[32:35]
v_xor_b32 v133, v133, v134
v_and_b32 v134, 3, v1
v_mfma_f32_16x16x32_bf16 a[48:51], v[88:91], a[188:191], a[48:51]
v_lshl_add_u32 v133, v134, 4, v133
v_lshlrev_b32 v133, 4, v133
v_mfma_f32_16x16x32_bf16 a[64:67], v[88:91], a[192:195], a[64:67]
v_add_u32 v133, s28, v133
v_lshlrev_b32 v134, 2, v3
v_mfma_f32_16x16x32_bf16 a[80:83], v[88:91], a[196:199], a[80:83]
v_add_u32 v134, s28, v134
v_lshlrev_b32 v135, 4, v4
v_mfma_f32_16x16x32_bf16 a[96:99], v[88:91], a[200:203], a[96:99]
v_add_u32 v135, s28, v135
v_mfma_f32_16x16x32_bf16 a[112:115], v[88:91], a[204:207], a[112:115]
v_mfma_f32_16x16x32_bf16 a[4:7], v[92:95], a[176:179], a[4:7]
v_accvgpr_read_b32 v120, a128
v_accvgpr_read_b32 v124, a129
v_accvgpr_read_b32 v121, a130
v_mfma_f32_16x16x32_bf16 a[20:23], v[92:95], a[180:183], a[20:23]
v_accvgpr_read_b32 v125, a131
v_accvgpr_read_b32 v122, a132
v_accvgpr_read_b32 v126, a133
v_mfma_f32_16x16x32_bf16 a[36:39], v[92:95], a[184:187], a[36:39]
v_accvgpr_read_b32 v123, a134
v_accvgpr_read_b32 v127, a135
v_add_f32 v120, v120, v124
v_mfma_f32_16x16x32_bf16 a[52:55], v[92:95], a[188:191], a[52:55]
v_add_f32 v121, v121, v125
v_add_f32 v122, v122, v126
v_add_f32 v123, v123, v127
v_mfma_f32_16x16x32_bf16 a[68:71], v[92:95], a[192:195], a[68:71]
v_rcp_f32 v124, v120
v_rcp_f32 v125, v121
v_rcp_f32 v126, v122
v_mfma_f32_16x16x32_bf16 a[84:87], v[92:95], a[196:199], a[84:87]
v_rcp_f32 v127, v123
ds_write_b32 v134, v124 offset:0
ds_write_b32 v134, v125 offset:64
v_mfma_f32_16x16x32_bf16 a[100:103], v[92:95], a[200:203], a[100:103]
ds_write_b32 v134, v126 offset:128
ds_write_b32 v134, v127 offset:192
ds_read_b128 v[72:75], v135 offset:0
v_mfma_f32_16x16x32_bf16 a[116:119], v[92:95], a[204:207], a[116:119]
ds_read_b128 v[76:79], v135 offset:64
ds_read_b128 v[80:83], v135 offset:128
ds_read_b128 v[84:87], v135 offset:192
s_add_u32 s92, s44, 4096
s_add_u32 s93, s44, 8192
s_add_u32 s51, s44, 12288
v_mfma_f32_16x16x32_bf16 a[8:11], v[96:99], a[176:179], a[8:11]
v_accvgpr_read_b32 v104, a0
v_accvgpr_read_b32 v105, a1
v_accvgpr_read_b32 v106, a2
v_accvgpr_read_b32 v107, a3
v_mfma_f32_16x16x32_bf16 a[24:27], v[96:99], a[180:183], a[24:27]
v_accvgpr_read_b32 v108, a16
v_accvgpr_read_b32 v109, a17
v_accvgpr_read_b32 v110, a18
v_accvgpr_read_b32 v111, a19
s_waitcnt lgkmcnt(0)
v_pk_mul_f32 v[104:105], v[104:105], v[72:73]
v_pk_mul_f32 v[106:107], v[106:107], v[74:75]
v_pk_mul_f32 v[108:109], v[108:109], v[72:73]
v_pk_mul_f32 v[110:111], v[110:111], v[74:75]
v_cvt_pk_bf16_f32 v104, v104, v105
v_cvt_pk_bf16_f32 v105, v106, v107
v_cvt_pk_bf16_f32 v106, v108, v109
v_cvt_pk_bf16_f32 v107, v110, v111
v_mfma_f32_16x16x32_bf16 a[40:43], v[96:99], a[184:187], a[40:43]
v_accvgpr_read_b32 v112, a32
v_accvgpr_read_b32 v113, a33
v_accvgpr_read_b32 v114, a34
v_accvgpr_read_b32 v115, a35
ds_write_b128 v132, v[104:107] offset:0
v_mfma_f32_16x16x32_bf16 a[56:59], v[96:99], a[188:191], a[56:59]
v_accvgpr_read_b32 v116, a48
v_accvgpr_read_b32 v117, a49
v_accvgpr_read_b32 v118, a50
v_accvgpr_read_b32 v119, a51
ds_read_b64_tr_b16 v[8:9], v133 offset:0
ds_read_b64_tr_b16 v[10:11], v133 offset:8
v_pk_mul_f32 v[112:113], v[112:113], v[72:73]
v_pk_mul_f32 v[114:115], v[114:115], v[74:75]
v_pk_mul_f32 v[116:117], v[116:117], v[72:73]
v_pk_mul_f32 v[118:119], v[118:119], v[74:75]
v_cvt_pk_bf16_f32 v112, v112, v113
v_cvt_pk_bf16_f32 v113, v114, v115
v_cvt_pk_bf16_f32 v114, v116, v117
v_cvt_pk_bf16_f32 v115, v118, v119
v_mfma_f32_16x16x32_bf16 a[72:75], v[96:99], a[192:195], a[72:75]
v_accvgpr_read_b32 v104, a64
v_accvgpr_read_b32 v105, a65
v_accvgpr_read_b32 v106, a66
v_accvgpr_read_b32 v107, a67
ds_write_b128 v132, v[112:115] offset:1024
v_mfma_f32_16x16x32_bf16 a[88:91], v[96:99], a[196:199], a[88:91]
v_accvgpr_read_b32 v108, a80
v_accvgpr_read_b32 v109, a81
v_accvgpr_read_b32 v110, a82
v_accvgpr_read_b32 v111, a83
ds_read_b64_tr_b16 v[12:13], v133 offset:1024
ds_read_b64_tr_b16 v[14:15], v133 offset:1032
v_pk_mul_f32 v[104:105], v[104:105], v[72:73]
v_pk_mul_f32 v[106:107], v[106:107], v[74:75]
v_pk_mul_f32 v[108:109], v[108:109], v[72:73]
v_pk_mul_f32 v[110:111], v[110:111], v[74:75]
s_waitcnt lgkmcnt(3)
buffer_store_dwordx4 v[8:11], v244, s[20:23], s44 offen offset:0
v_cvt_pk_bf16_f32 v104, v104, v105
v_cvt_pk_bf16_f32 v105, v106, v107
v_cvt_pk_bf16_f32 v106, v108, v109
v_cvt_pk_bf16_f32 v107, v110, v111
v_mfma_f32_16x16x32_bf16 a[104:107], v[96:99], a[200:203], a[104:107]
v_accvgpr_read_b32 v112, a96
v_accvgpr_read_b32 v113, a97
v_accvgpr_read_b32 v114, a98
v_accvgpr_read_b32 v115, a99
ds_write_b128 v132, v[104:107] offset:2048
v_mfma_f32_16x16x32_bf16 a[120:123], v[96:99], a[204:207], a[120:123]
v_accvgpr_read_b32 v116, a112
v_accvgpr_read_b32 v117, a113
v_accvgpr_read_b32 v118, a114
v_accvgpr_read_b32 v119, a115
ds_read_b64_tr_b16 v[16:17], v133 offset:2048
ds_read_b64_tr_b16 v[18:19], v133 offset:2056
v_pk_mul_f32 v[112:113], v[112:113], v[72:73]
v_pk_mul_f32 v[114:115], v[114:115], v[74:75]
v_pk_mul_f32 v[116:117], v[116:117], v[72:73]
v_pk_mul_f32 v[118:119], v[118:119], v[74:75]
v_cvt_pk_bf16_f32 v112, v112, v113
v_cvt_pk_bf16_f32 v113, v114, v115
v_cvt_pk_bf16_f32 v114, v116, v117
v_cvt_pk_bf16_f32 v115, v118, v119
v_mfma_f32_16x16x32_bf16 a[12:15], v[100:103], a[176:179], a[12:15]
v_accvgpr_read_b32 v104, a4
v_accvgpr_read_b32 v105, a5
v_accvgpr_read_b32 v106, a6
v_accvgpr_read_b32 v107, a7
ds_write_b128 v132, v[112:115] offset:3072
v_mfma_f32_16x16x32_bf16 a[28:31], v[100:103], a[180:183], a[28:31]
v_accvgpr_read_b32 v108, a20
v_accvgpr_read_b32 v109, a21
v_accvgpr_read_b32 v110, a22
v_accvgpr_read_b32 v111, a23
ds_read_b64_tr_b16 v[20:21], v133 offset:3072
ds_read_b64_tr_b16 v[22:23], v133 offset:3080
v_pk_mul_f32 v[104:105], v[104:105], v[76:77]
v_pk_mul_f32 v[106:107], v[106:107], v[78:79]
v_pk_mul_f32 v[108:109], v[108:109], v[76:77]
v_pk_mul_f32 v[110:111], v[110:111], v[78:79]
s_waitcnt lgkmcnt(3)
buffer_store_dwordx4 v[16:19], v244, s[20:23], s44 offen offset:2048
v_cvt_pk_bf16_f32 v104, v104, v105
v_cvt_pk_bf16_f32 v105, v106, v107
v_cvt_pk_bf16_f32 v106, v108, v109
v_cvt_pk_bf16_f32 v107, v110, v111
v_mfma_f32_16x16x32_bf16 a[44:47], v[100:103], a[184:187], a[44:47]
v_accvgpr_read_b32 v112, a36
v_accvgpr_read_b32 v113, a37
v_accvgpr_read_b32 v114, a38
v_accvgpr_read_b32 v115, a39
ds_write_b128 v132, v[104:107] offset:0
v_mfma_f32_16x16x32_bf16 a[60:63], v[100:103], a[188:191], a[60:63]
v_accvgpr_read_b32 v116, a52
v_accvgpr_read_b32 v117, a53
v_accvgpr_read_b32 v118, a54
v_accvgpr_read_b32 v119, a55
ds_read_b64_tr_b16 v[24:25], v133 offset:0
ds_read_b64_tr_b16 v[26:27], v133 offset:8
v_pk_mul_f32 v[112:113], v[112:113], v[76:77]
v_pk_mul_f32 v[114:115], v[114:115], v[78:79]
v_pk_mul_f32 v[116:117], v[116:117], v[76:77]
v_pk_mul_f32 v[118:119], v[118:119], v[78:79]
v_cvt_pk_bf16_f32 v112, v112, v113
v_cvt_pk_bf16_f32 v113, v114, v115
v_cvt_pk_bf16_f32 v114, v116, v117
v_cvt_pk_bf16_f32 v115, v118, v119
v_mfma_f32_16x16x32_bf16 a[76:79], v[100:103], a[192:195], a[76:79]
v_accvgpr_read_b32 v104, a68
v_accvgpr_read_b32 v105, a69
v_accvgpr_read_b32 v106, a70
v_accvgpr_read_b32 v107, a71
ds_write_b128 v132, v[112:115] offset:1024
v_mfma_f32_16x16x32_bf16 a[92:95], v[100:103], a[196:199], a[92:95]
STUB_13:
s_cbranch_execz STUB_16
v_accvgpr_read_b32 v108, a84
v_accvgpr_read_b32 v109, a85
v_accvgpr_read_b32 v110, a86
v_accvgpr_read_b32 v111, a87
ds_read_b64_tr_b16 v[28:29], v133 offset:1024
ds_read_b64_tr_b16 v[30:31], v133 offset:1032
v_pk_mul_f32 v[104:105], v[104:105], v[76:77]
v_pk_mul_f32 v[106:107], v[106:107], v[78:79]
v_pk_mul_f32 v[108:109], v[108:109], v[76:77]
v_pk_mul_f32 v[110:111], v[110:111], v[78:79]
s_waitcnt lgkmcnt(3)
buffer_store_dwordx4 v[24:27], v244, s[20:23], s92 offen offset:0
v_cvt_pk_bf16_f32 v104, v104, v105
v_cvt_pk_bf16_f32 v105, v106, v107
v_cvt_pk_bf16_f32 v106, v108, v109
v_cvt_pk_bf16_f32 v107, v110, v111
v_mfma_f32_16x16x32_bf16 a[108:111], v[100:103], a[200:203], a[108:111]
v_accvgpr_read_b32 v112, a100
v_accvgpr_read_b32 v113, a101
v_accvgpr_read_b32 v114, a102
v_accvgpr_read_b32 v115, a103
ds_write_b128 v132, v[104:107] offset:2048
v_mfma_f32_16x16x32_bf16 a[124:127], v[100:103], a[204:207], a[124:127]
v_accvgpr_read_b32 v116, a116
v_accvgpr_read_b32 v117, a117
v_accvgpr_read_b32 v118, a118
v_accvgpr_read_b32 v119, a119
ds_read_b64_tr_b16 v[32:33], v133 offset:2048
ds_read_b64_tr_b16 v[34:35], v133 offset:2056
v_pk_mul_f32 v[112:113], v[112:113], v[76:77]
v_pk_mul_f32 v[114:115], v[114:115], v[78:79]
v_pk_mul_f32 v[116:117], v[116:117], v[76:77]
v_pk_mul_f32 v[118:119], v[118:119], v[78:79]
v_cvt_pk_bf16_f32 v112, v112, v113
v_cvt_pk_bf16_f32 v113, v114, v115
v_cvt_pk_bf16_f32 v114, v116, v117
v_cvt_pk_bf16_f32 v115, v118, v119
v_accvgpr_read_b32 v104, a8
v_accvgpr_read_b32 v105, a9
v_accvgpr_read_b32 v106, a10
v_accvgpr_read_b32 v107, a11
ds_write_b128 v132, v[112:115] offset:3072
v_accvgpr_read_b32 v108, a24
v_accvgpr_read_b32 v109, a25
v_accvgpr_read_b32 v110, a26
v_accvgpr_read_b32 v111, a27
ds_read_b64_tr_b16 v[36:37], v133 offset:3072
ds_read_b64_tr_b16 v[38:39], v133 offset:3080
v_pk_mul_f32 v[104:105], v[104:105], v[80:81]
v_pk_mul_f32 v[106:107], v[106:107], v[82:83]
v_pk_mul_f32 v[108:109], v[108:109], v[80:81]
v_pk_mul_f32 v[110:111], v[110:111], v[82:83]
s_waitcnt lgkmcnt(3)
buffer_store_dwordx4 v[32:35], v244, s[20:23], s92 offen offset:2048
v_cvt_pk_bf16_f32 v104, v104, v105
v_cvt_pk_bf16_f32 v105, v106, v107
v_cvt_pk_bf16_f32 v106, v108, v109
v_cvt_pk_bf16_f32 v107, v110, v111
v_accvgpr_read_b32 v112, a40
v_accvgpr_read_b32 v113, a41
v_accvgpr_read_b32 v114, a42
v_accvgpr_read_b32 v115, a43
ds_write_b128 v132, v[104:107] offset:0
v_accvgpr_read_b32 v116, a56
v_accvgpr_read_b32 v117, a57
v_accvgpr_read_b32 v118, a58
v_accvgpr_read_b32 v119, a59
ds_read_b64_tr_b16 v[40:41], v133 offset:0
ds_read_b64_tr_b16 v[42:43], v133 offset:8
v_pk_mul_f32 v[112:113], v[112:113], v[80:81]
v_pk_mul_f32 v[114:115], v[114:115], v[82:83]
v_pk_mul_f32 v[116:117], v[116:117], v[80:81]
v_pk_mul_f32 v[118:119], v[118:119], v[82:83]
v_cvt_pk_bf16_f32 v112, v112, v113
v_cvt_pk_bf16_f32 v113, v114, v115
v_cvt_pk_bf16_f32 v114, v116, v117
v_cvt_pk_bf16_f32 v115, v118, v119
v_accvgpr_read_b32 v104, a72
v_accvgpr_read_b32 v105, a73
v_accvgpr_read_b32 v106, a74
v_accvgpr_read_b32 v107, a75
ds_write_b128 v132, v[112:115] offset:1024
v_accvgpr_read_b32 v108, a88
v_accvgpr_read_b32 v109, a89
v_accvgpr_read_b32 v110, a90
v_accvgpr_read_b32 v111, a91
ds_read_b64_tr_b16 v[44:45], v133 offset:1024
ds_read_b64_tr_b16 v[46:47], v133 offset:1032
v_pk_mul_f32 v[104:105], v[104:105], v[80:81]
v_pk_mul_f32 v[106:107], v[106:107], v[82:83]
v_pk_mul_f32 v[108:109], v[108:109], v[80:81]
v_pk_mul_f32 v[110:111], v[110:111], v[82:83]
s_waitcnt lgkmcnt(3)
buffer_store_dwordx4 v[40:43], v244, s[20:23], s93 offen offset:0
v_cvt_pk_bf16_f32 v104, v104, v105
v_cvt_pk_bf16_f32 v105, v106, v107
v_cvt_pk_bf16_f32 v106, v108, v109
v_cvt_pk_bf16_f32 v107, v110, v111
v_accvgpr_read_b32 v112, a104
v_accvgpr_read_b32 v113, a105
v_accvgpr_read_b32 v114, a106
v_accvgpr_read_b32 v115, a107
ds_write_b128 v132, v[104:107] offset:2048
v_accvgpr_read_b32 v116, a120
v_accvgpr_read_b32 v117, a121
v_accvgpr_read_b32 v118, a122
v_accvgpr_read_b32 v119, a123
ds_read_b64_tr_b16 v[48:49], v133 offset:2048
ds_read_b64_tr_b16 v[50:51], v133 offset:2056
v_pk_mul_f32 v[112:113], v[112:113], v[80:81]
v_pk_mul_f32 v[114:115], v[114:115], v[82:83]
v_pk_mul_f32 v[116:117], v[116:117], v[80:81]
v_pk_mul_f32 v[118:119], v[118:119], v[82:83]
v_cvt_pk_bf16_f32 v112, v112, v113
v_cvt_pk_bf16_f32 v113, v114, v115
v_cvt_pk_bf16_f32 v114, v116, v117
v_cvt_pk_bf16_f32 v115, v118, v119
v_accvgpr_read_b32 v104, a12
v_accvgpr_read_b32 v105, a13
v_accvgpr_read_b32 v106, a14
v_accvgpr_read_b32 v107, a15
ds_write_b128 v132, v[112:115] offset:3072
v_accvgpr_read_b32 v108, a28
v_accvgpr_read_b32 v109, a29
v_accvgpr_read_b32 v110, a30
v_accvgpr_read_b32 v111, a31
ds_read_b64_tr_b16 v[52:53], v133 offset:3072
ds_read_b64_tr_b16 v[54:55], v133 offset:3080
v_pk_mul_f32 v[104:105], v[104:105], v[84:85]
v_pk_mul_f32 v[106:107], v[106:107], v[86:87]
v_pk_mul_f32 v[108:109], v[108:109], v[84:85]
v_pk_mul_f32 v[110:111], v[110:111], v[86:87]
s_waitcnt lgkmcnt(3)
buffer_store_dwordx4 v[48:51], v244, s[20:23], s93 offen offset:2048
v_cvt_pk_bf16_f32 v104, v104, v105
v_cvt_pk_bf16_f32 v105, v106, v107
v_cvt_pk_bf16_f32 v106, v108, v109
v_cvt_pk_bf16_f32 v107, v110, v111
v_accvgpr_read_b32 v112, a44
v_accvgpr_read_b32 v113, a45
v_accvgpr_read_b32 v114, a46
v_accvgpr_read_b32 v115, a47
ds_write_b128 v132, v[104:107] offset:0
v_accvgpr_read_b32 v116, a60
v_accvgpr_read_b32 v117, a61
v_accvgpr_read_b32 v118, a62
v_accvgpr_read_b32 v119, a63
ds_read_b64_tr_b16 v[56:57], v133 offset:0
ds_read_b64_tr_b16 v[58:59], v133 offset:8
v_pk_mul_f32 v[112:113], v[112:113], v[84:85]
v_pk_mul_f32 v[114:115], v[114:115], v[86:87]
v_pk_mul_f32 v[116:117], v[116:117], v[84:85]
v_pk_mul_f32 v[118:119], v[118:119], v[86:87]
v_cvt_pk_bf16_f32 v112, v112, v113
v_cvt_pk_bf16_f32 v113, v114, v115
v_cvt_pk_bf16_f32 v114, v116, v117
v_cvt_pk_bf16_f32 v115, v118, v119
v_accvgpr_read_b32 v104, a76
v_accvgpr_read_b32 v105, a77
v_accvgpr_read_b32 v106, a78
v_accvgpr_read_b32 v107, a79
ds_write_b128 v132, v[112:115] offset:1024
v_accvgpr_read_b32 v108, a92
v_accvgpr_read_b32 v109, a93
v_accvgpr_read_b32 v110, a94
v_accvgpr_read_b32 v111, a95
ds_read_b64_tr_b16 v[60:61], v133 offset:1024
ds_read_b64_tr_b16 v[62:63], v133 offset:1032
v_pk_mul_f32 v[104:105], v[104:105], v[84:85]
v_pk_mul_f32 v[106:107], v[106:107], v[86:87]
v_pk_mul_f32 v[108:109], v[108:109], v[84:85]
v_pk_mul_f32 v[110:111], v[110:111], v[86:87]
s_waitcnt lgkmcnt(3)
buffer_store_dwordx4 v[56:59], v244, s[20:23], s51 offen offset:0
v_cvt_pk_bf16_f32 v104, v104, v105
v_cvt_pk_bf16_f32 v105, v106, v107
v_cvt_pk_bf16_f32 v106, v108, v109
v_cvt_pk_bf16_f32 v107, v110, v111
v_accvgpr_read_b32 v112, a108
v_accvgpr_read_b32 v113, a109
v_accvgpr_read_b32 v114, a110
v_accvgpr_read_b32 v115, a111
ds_write_b128 v132, v[104:107] offset:2048
v_accvgpr_read_b32 v116, a124
v_accvgpr_read_b32 v117, a125
v_accvgpr_read_b32 v118, a126
v_accvgpr_read_b32 v119, a127
ds_read_b64_tr_b16 v[64:65], v133 offset:2048
ds_read_b64_tr_b16 v[66:67], v133 offset:2056
v_pk_mul_f32 v[112:113], v[112:113], v[84:85]
v_pk_mul_f32 v[114:115], v[114:115], v[86:87]
v_pk_mul_f32 v[116:117], v[116:117], v[84:85]
v_pk_mul_f32 v[118:119], v[118:119], v[86:87]
v_cvt_pk_bf16_f32 v112, v112, v113
v_cvt_pk_bf16_f32 v113, v114, v115
v_cvt_pk_bf16_f32 v114, v116, v117
v_cvt_pk_bf16_f32 v115, v118, v119
ds_write_b128 v132, v[112:115] offset:3072
ds_read_b64_tr_b16 v[68:69], v133 offset:3072
ds_read_b64_tr_b16 v[70:71], v133 offset:3080
s_waitcnt lgkmcnt(3)
buffer_store_dwordx4 v[64:67], v244, s[20:23], s51 offen offset:2048
v_max3_f32 v104, v120, v121, v122
v_max_f32 v104, v104, v123
v_add_f32 v105, v120, v121
v_add_f32 v105, v105, v122
v_add_f32 v105, v105, v123
v_cmp_nge_f32 vcc, s42, v104
v_cmp_u_f32 s[28:29], v105, v105
s_or_b64 vcc, vcc, s[28:29]
s_cmp_lg_u64 vcc, 0
s_cselect_b32 s28, 1, 0
v_mov_b32 v104, s28
v_mov_b32 v106, 147456
s_waitcnt lgkmcnt(0)
ds_write_b32 v134, v104
s_waitcnt vmcnt(8) lgkmcnt(0)
s_barrier
ds_read2st64_b32 v[110:111], v106 offset0:32 offset1:48
ds_read2st64_b32 v[108:109], v106 offset0:0 offset1:16
ds_read_b64_tr_b16 a[64:65], v237 offset:0
ds_read_b64_tr_b16 a[66:67], v237 offset:4608
ds_read_b64_tr_b16 a[68:69], v237 offset:8
ds_read_b64_tr_b16 a[70:71], v237 offset:4616
ds_read_b64_tr_b16 a[72:73], v238 offset:0
ds_read_b64_tr_b16 a[74:75], v238 offset:4608
ds_read_b64_tr_b16 a[76:77], v238 offset:8
ds_read_b64_tr_b16 a[78:79], v238 offset:4616
ds_read_b64_tr_b16 a[80:81], v237 offset:128
ds_read_b64_tr_b16 a[82:83], v237 offset:4736
ds_read_b64_tr_b16 a[84:85], v237 offset:136
ds_read_b64_tr_b16 a[86:87], v237 offset:4744
ds_read_b64_tr_b16 a[88:89], v238 offset:128
ds_read_b64_tr_b16 a[90:91], v238 offset:4736
s_waitcnt lgkmcnt(14)
v_or_b32 v108, v108, v109
v_or3_b32 v108, v108, v110, v111
s_nop 0
v_readfirstlane_b32 s28, v108
s_cmp_gt_u32 s28, s43
s_cbranch_scc1 K_FALLBACK
s_waitcnt lgkmcnt(8)
v_mfma_f32_16x16x32_bf16 v[96:99], a[64:67], v[56:59], 0
ds_read_b64_tr_b16 a[92:93], v238 offset:136
ds_read_b64_tr_b16 a[94:95], v238 offset:4744
v_mfma_f32_16x16x32_bf16 v[88:91], a[64:67], v[40:43], 0
buffer_store_dwordx4 v[12:15], v244, s[20:23], s44 offen offset:1024
v_mfma_f32_16x16x32_bf16 v[80:83], a[64:67], v[24:27], 0
v_mfma_f32_16x16x32_bf16 v[72:75], a[64:67], v[8:11], 0
v_mfma_f32_16x16x32_bf16 v[76:79], a[68:71], v[8:11], 0
ds_read_b64_tr_b16 a[64:65], v239 offset:0
ds_read_b64_tr_b16 a[66:67], v239 offset:4608
v_mfma_f32_16x16x32_bf16 v[84:87], a[68:71], v[24:27], 0
buffer_store_dwordx4 v[20:23], v244, s[20:23], s44 offen offset:3072
v_mfma_f32_16x16x32_bf16 v[92:95], a[68:71], v[40:43], 0
v_mfma_f32_16x16x32_bf16 v[100:103], a[68:71], v[56:59], 0
v_mfma_f32_16x16x32_bf16 v[128:131], a[72:75], v[56:59], 0
ds_read_b64_tr_b16 a[68:69], v237 offset:9216
ds_read_b64_tr_b16 a[70:71], v237 offset:13824
v_mfma_f32_16x16x32_bf16 v[120:123], a[72:75], v[40:43], 0
buffer_store_dwordx4 v[28:31], v244, s[20:23], s92 offen offset:1024
v_mfma_f32_16x16x32_bf16 v[112:115], a[72:75], v[24:27], 0
v_mfma_f32_16x16x32_bf16 v[104:107], a[72:75], v[8:11], 0
s_waitcnt lgkmcnt(8)
v_mfma_f32_16x16x32_bf16 v[108:111], a[76:79], v[8:11], 0
ds_read_b64_tr_b16 a[72:73], v237 offset:9224
ds_read_b64_tr_b16 a[74:75], v237 offset:13832
v_mfma_f32_16x16x32_bf16 v[116:119], a[76:79], v[24:27], 0
buffer_store_dwordx4 v[36:39], v244, s[20:23], s92 offen offset:3072
v_mfma_f32_16x16x32_bf16 v[124:127], a[76:79], v[40:43], 0
v_mfma_f32_16x16x32_bf16 v[132:135], a[76:79], v[56:59], 0
v_mfma_f32_16x16x32_bf16 v[160:163], a[80:83], v[56:59], 0
ds_read_b64_tr_b16 a[76:77], v238 offset:9216
ds_read_b64_tr_b16 a[78:79], v238 offset:13824
v_mfma_f32_16x16x32_bf16 v[152:155], a[80:83], v[40:43], 0
buffer_store_dwordx4 v[44:47], v244, s[20:23], s93 offen offset:1024
v_mfma_f32_16x16x32_bf16 v[144:147], a[80:83], v[24:27], 0
v_mfma_f32_16x16x32_bf16 v[136:139], a[80:83], v[8:11], 0
v_mfma_f32_16x16x32_bf16 v[140:143], a[84:87], v[8:11], 0
ds_read_b64_tr_b16 a[80:81], v238 offset:9224
ds_read_b64_tr_b16 a[82:83], v238 offset:13832
v_mfma_f32_16x16x32_bf16 v[148:151], a[84:87], v[24:27], 0
buffer_store_dwordx4 v[52:55], v244, s[20:23], s93 offen offset:3072
v_mfma_f32_16x16x32_bf16 v[156:159], a[84:87], v[40:43], 0
v_mfma_f32_16x16x32_bf16 v[164:167], a[84:87], v[56:59], 0
s_waitcnt lgkmcnt(8)
v_mfma_f32_16x16x32_bf16 v[192:195], a[88:91], v[56:59], 0
ds_read_b64_tr_b16 a[84:85], v237 offset:9344
ds_read_b64_tr_b16 a[86:87], v237 offset:13952
v_mfma_f32_16x16x32_bf16 v[184:187], a[88:91], v[40:43], 0
buffer_store_dwordx4 v[60:63], v244, s[20:23], s51 offen offset:1024
v_mfma_f32_16x16x32_bf16 v[176:179], a[88:91], v[24:27], 0
v_mfma_f32_16x16x32_bf16 v[168:171], a[88:91], v[8:11], 0
v_mfma_f32_16x16x32_bf16 v[172:175], a[92:95], v[8:11], 0
ds_read_b64_tr_b16 a[88:89], v237 offset:9352
ds_read_b64_tr_b16 a[90:91], v237 offset:13960
v_mfma_f32_16x16x32_bf16 v[180:183], a[92:95], v[24:27], 0
buffer_store_dwordx4 v[68:71], v244, s[20:23], s51 offen offset:3072
v_mfma_f32_16x16x32_bf16 v[188:191], a[92:95], v[40:43], 0
s_lshr_b32 s32, s35, 2
s_and_b32 s33, s35, 3
v_mfma_f32_16x16x32_bf16 v[196:199], a[92:95], v[56:59], 0
s_lshl_b32 s94, s36, 9
s_lshl_b32 s28, s32, 6
v_mfma_f32_16x16x32_bf16 v[212:215], a[64:67], v[56:59], 0
ds_read_b64_tr_b16 a[92:93], v238 offset:9344
ds_read_b64_tr_b16 a[94:95], v238 offset:13952
v_mfma_f32_16x16x32_bf16 v[208:211], a[64:67], v[40:43], 0
s_lshr_b32 s34, s32, 2
v_mfma_f32_16x16x32_bf16 v[204:207], a[64:67], v[24:27], 0
s_add_u32 s94, s94, s28
s_lshl_b32 s28, s37, 4
v_mfma_f32_16x16x32_bf16 v[200:203], a[64:67], v[8:11], 0
s_add_u32 s94, s94, s28
s_add_u32 s94, s94, 0x248000
s_waitcnt lgkmcnt(8)
v_mfma_f32_16x16x32_bf16 v[72:75], a[68:71], v[12:15], v[72:75]
ds_read_b64_tr_b16 a[64:65], v238 offset:9352
ds_read_b64_tr_b16 a[66:67], v238 offset:13960
v_mfma_f32_16x16x32_bf16 v[80:83], a[68:71], v[28:31], v[80:83]
v_mov_b32 v231, 1
v_and_b32 v229, 7, v1
v_mfma_f32_16x16x32_bf16 v[88:91], a[68:71], v[44:47], v[88:91]
v_lshlrev_b32 v229, 2, v229
v_lshlrev_b32 v226, 3, v1
v_mfma_f32_16x16x32_bf16 v[96:99], a[68:71], v[60:63], v[96:99]
s_lshl2_add_u32 s29, s33, s94
v_mfma_f32_16x16x32_bf16 v[100:103], a[72:75], v[60:63], v[100:103]
ds_read_b64_tr_b16 a[68:69], v239 offset:9216
ds_read_b64_tr_b16 a[70:71], v239 offset:13824
v_mfma_f32_16x16x32_bf16 v[92:95], a[72:75], v[44:47], v[92:95]
s_waitcnt vmcnt(0)
buffer_store_dword v231, v254, s[20:23], s29 offen
v_mfma_f32_16x16x32_bf16 v[84:87], a[72:75], v[28:31], v[84:87]
s_add_u32 s28, s35, 1
s_and_b32 s28, s28, 3
v_mfma_f32_16x16x32_bf16 v[76:79], a[72:75], v[12:15], v[76:79]
s_mul_i32 s28, s28, 36864
v_mfma_f32_16x16x32_bf16 v[104:107], a[76:79], v[12:15], v[104:107]
ds_read_b64_tr_b16 a[72:73], v237 offset:18432
ds_read_b64_tr_b16 a[74:75], v237 offset:23040
v_mfma_f32_16x16x32_bf16 v[112:115], a[76:79], v[28:31], v[112:115]
v_add_u32 v216, s28, v234
v_add_u32 v217, s28, v235
v_mfma_f32_16x16x32_bf16 v[120:123], a[76:79], v[44:47], v[120:123]
v_add_u32 v218, s28, v236
v_mfma_f32_16x16x32_bf16 v[128:131], a[76:79], v[60:63], v[128:131]
s_waitcnt lgkmcnt(8)
v_mfma_f32_16x16x32_bf16 v[132:135], a[80:83], v[60:63], v[132:135]
ds_read_b64_tr_b16 a[76:77], v237 offset:18440
ds_read_b64_tr_b16 a[78:79], v237 offset:23048
v_mfma_f32_16x16x32_bf16 v[124:127], a[80:83], v[44:47], v[124:127]
v_mfma_f32_16x16x32_bf16 v[116:119], a[80:83], v[28:31], v[116:119]
v_mfma_f32_16x16x32_bf16 v[108:111], a[80:83], v[12:15], v[108:111]
v_mfma_f32_16x16x32_bf16 v[136:139], a[84:87], v[12:15], v[136:139]
ds_read_b64_tr_b16 a[80:81], v238 offset:18432
ds_read_b64_tr_b16 a[82:83], v238 offset:23040
v_mfma_f32_16x16x32_bf16 v[144:147], a[84:87], v[28:31], v[144:147]
buffer_load_dword v230, v229, s[20:23], s94 offen sc0 sc1
v_mfma_f32_16x16x32_bf16 v[152:155], a[84:87], v[44:47], v[152:155]
s_add_u32 s39, s35, 1
s_and_b32 s39, s39, 3
v_mfma_f32_16x16x32_bf16 v[160:163], a[84:87], v[60:63], v[160:163]
s_add_u32 s28, s33, 1
s_and_b32 s28, s28, 3
v_mfma_f32_16x16x32_bf16 v[164:167], a[88:91], v[60:63], v[164:167]
ds_read_b64_tr_b16 a[84:85], v238 offset:18440
ds_read_b64_tr_b16 a[86:87], v238 offset:23048
v_mfma_f32_16x16x32_bf16 v[156:159], a[88:91], v[44:47], v[156:159]
s_sub_u32 s28, s28, s33
s_lshl_b32 s28, s28, 16
v_mfma_f32_16x16x32_bf16 v[148:151], a[88:91], v[28:31], v[148:151]
s_add_u32 s64, s28, s44
s_add_u32 s65, s64, 4096
v_mfma_f32_16x16x32_bf16 v[140:143], a[88:91], v[12:15], v[140:143]
s_add_u32 s66, s64, 8192
s_add_u32 s67, s64, 12288
s_waitcnt lgkmcnt(8)
v_mfma_f32_16x16x32_bf16 v[168:171], a[92:95], v[12:15], v[168:171]
ds_read_b64_tr_b16 a[88:89], v237 offset:18560
ds_read_b64_tr_b16 a[90:91], v237 offset:23168
v_mfma_f32_16x16x32_bf16 v[176:179], a[92:95], v[28:31], v[176:179]
s_add_u32 s28, s35, 2
s_and_b32 s28, s28, 3
v_mfma_f32_16x16x32_bf16 v[184:187], a[92:95], v[44:47], v[184:187]
s_mul_i32 s28, s28, 36864
v_mfma_f32_16x16x32_bf16 v[192:195], a[92:95], v[60:63], v[192:195]
v_add_u32 v219, s28, v234
v_add_u32 v220, s28, v235
v_mfma_f32_16x16x32_bf16 v[196:199], a[64:67], v[60:63], v[196:199]
ds_read_b64_tr_b16 a[92:93], v237 offset:18568
ds_read_b64_tr_b16 a[94:95], v237 offset:23176
v_mfma_f32_16x16x32_bf16 v[188:191], a[64:67], v[44:47], v[188:191]
v_add_u32 v221, s28, v236
v_mfma_f32_16x16x32_bf16 v[180:183], a[64:67], v[28:31], v[180:183]
s_add_u32 s28, s35, 3
s_and_b32 s28, s28, 3
v_mfma_f32_16x16x32_bf16 v[172:175], a[64:67], v[12:15], v[172:175]
s_mul_i32 s28, s28, 36864
v_mfma_f32_16x16x32_bf16 v[200:203], a[68:71], v[12:15], v[200:203]
ds_read_b64_tr_b16 a[64:65], v238 offset:18560
ds_read_b64_tr_b16 a[66:67], v238 offset:23168
v_mfma_f32_16x16x32_bf16 v[204:207], a[68:71], v[28:31], v[204:207]
v_add_u32 v222, s28, v234
v_add_u32 v223, s28, v235
v_mfma_f32_16x16x32_bf16 v[208:211], a[68:71], v[44:47], v[208:211]
v_add_u32 v224, s28, v236
v_mfma_f32_16x16x32_bf16 v[212:215], a[68:71], v[60:63], v[212:215]
s_waitcnt lgkmcnt(8)
v_mfma_f32_16x16x32_bf16 v[96:99], a[72:75], v[64:67], v[96:99]
ds_read_b64_tr_b16 a[68:69], v238 offset:18568
ds_read_b64_tr_b16 a[70:71], v238 offset:23176
v_mfma_f32_16x16x32_bf16 v[88:91], a[72:75], v[48:51], v[88:91]
v_mfma_f32_16x16x32_bf16 v[80:83], a[72:75], v[32:35], v[80:83]
s_waitcnt vmcnt(0)
v_cmp_gt_u32 vcc, 1, v230
v_mfma_f32_16x16x32_bf16 v[72:75], a[72:75], v[16:19], v[72:75]
v_mfma_f32_16x16x32_bf16 v[76:79], a[76:79], v[16:19], v[76:79]
ds_read_b64_tr_b16 a[72:73], v239 offset:18432
ds_read_b64_tr_b16 a[74:75], v239 offset:23040
v_mfma_f32_16x16x32_bf16 v[84:87], a[76:79], v[32:35], v[84:87]
s_bitcmp1_b32 vcc_lo, s39
s_cbranch_scc1 SP_O1A
SP_O1A_RET:
v_mfma_f32_16x16x32_bf16 v[92:95], a[76:79], v[48:51], v[92:95]
buffer_load_dwordx4 a[128:131], v244, s[20:23], s64 offen offset:0 sc0 sc1
v_mfma_f32_16x16x32_bf16 v[100:103], a[76:79], v[64:67], v[100:103]
v_mfma_f32_16x16x32_bf16 v[128:131], a[80:83], v[64:67], v[128:131]
ds_read_b64_tr_b16 a[76:77], v237 offset:27648
ds_read_b64_tr_b16 a[78:79], v237 offset:32256
v_mfma_f32_16x16x32_bf16 v[120:123], a[80:83], v[48:51], v[120:123]
v_mfma_f32_16x16x32_bf16 v[112:115], a[80:83], v[32:35], v[112:115]
buffer_load_dwordx4 a[144:147], v244, s[20:23], s65 offen offset:0 sc0 sc1
v_mfma_f32_16x16x32_bf16 v[104:107], a[80:83], v[16:19], v[104:107]
s_waitcnt lgkmcnt(8)
v_mfma_f32_16x16x32_bf16 v[108:111], a[84:87], v[16:19], v[108:111]
ds_read_b64_tr_b16 a[80:81], v237 offset:27656
ds_read_b64_tr_b16 a[82:83], v237 offset:32264
v_mfma_f32_16x16x32_bf16 v[116:119], a[84:87], v[32:35], v[116:119]
v_mfma_f32_16x16x32_bf16 v[124:127], a[84:87], v[48:51], v[124:127]
buffer_load_dwordx4 a[160:163], v244, s[20:23], s66 offen offset:0 sc0 sc1
v_mfma_f32_16x16x32_bf16 v[132:135], a[84:87], v[64:67], v[132:135]
v_mfma_f32_16x16x32_bf16 v[160:163], a[88:91], v[64:67], v[160:163]
ds_read_b64_tr_b16 a[84:85], v238 offset:27648
ds_read_b64_tr_b16 a[86:87], v238 offset:32256
v_mfma_f32_16x16x32_bf16 v[152:155], a[88:91], v[48:51], v[152:155]
v_mfma_f32_16x16x32_bf16 v[144:147], a[88:91], v[32:35], v[144:147]
buffer_load_dwordx4 a[176:179], v244, s[20:23], s67 offen offset:0 sc0 sc1
v_mfma_f32_16x16x32_bf16 v[136:139], a[88:91], v[16:19], v[136:139]
v_mfma_f32_16x16x32_bf16 v[140:143], a[92:95], v[16:19], v[140:143]
ds_read_b64_tr_b16 a[88:89], v238 offset:27656
ds_read_b64_tr_b16 a[90:91], v238 offset:32264
v_mfma_f32_16x16x32_bf16 v[148:151], a[92:95], v[32:35], v[148:151]
v_mfma_f32_16x16x32_bf16 v[156:159], a[92:95], v[48:51], v[156:159]
buffer_load_dwordx4 a[132:135], v244, s[20:23], s64 offen offset:1024 sc0 sc1
v_mfma_f32_16x16x32_bf16 v[164:167], a[92:95], v[64:67], v[164:167]
s_waitcnt lgkmcnt(8)
v_mfma_f32_16x16x32_bf16 v[192:195], a[64:67], v[64:67], v[192:195]
ds_read_b64_tr_b16 a[92:93], v237 offset:27776
ds_read_b64_tr_b16 a[94:95], v237 offset:32384
v_mfma_f32_16x16x32_bf16 v[184:187], a[64:67], v[48:51], v[184:187]
v_mfma_f32_16x16x32_bf16 v[176:179], a[64:67], v[32:35], v[176:179]
buffer_load_dwordx4 a[148:151], v244, s[20:23], s65 offen offset:1024 sc0 sc1
v_mfma_f32_16x16x32_bf16 v[168:171], a[64:67], v[16:19], v[168:171]
v_mfma_f32_16x16x32_bf16 v[172:175], a[68:71], v[16:19], v[172:175]
ds_read_b64_tr_b16 a[64:65], v237 offset:27784
ds_read_b64_tr_b16 a[66:67], v237 offset:32392
v_mfma_f32_16x16x32_bf16 v[180:183], a[68:71], v[32:35], v[180:183]
v_mfma_f32_16x16x32_bf16 v[188:191], a[68:71], v[48:51], v[188:191]
buffer_load_dwordx4 a[164:167], v244, s[20:23], s66 offen offset:1024 sc0 sc1
v_mfma_f32_16x16x32_bf16 v[196:199], a[68:71], v[64:67], v[196:199]
v_mfma_f32_16x16x32_bf16 v[212:215], a[72:75], v[64:67], v[212:215]
ds_read_b64_tr_b16 a[68:69], v238 offset:27776
ds_read_b64_tr_b16 a[70:71], v238 offset:32384
v_mfma_f32_16x16x32_bf16 v[208:211], a[72:75], v[48:51], v[208:211]
v_mfma_f32_16x16x32_bf16 v[204:207], a[72:75], v[32:35], v[204:207]
buffer_load_dwordx4 a[180:183], v244, s[20:23], s67 offen offset:1024 sc0 sc1
v_mfma_f32_16x16x32_bf16 v[200:203], a[72:75], v[16:19], v[200:203]
s_waitcnt lgkmcnt(8)
v_mfma_f32_16x16x32_bf16 v[72:75], a[76:79], v[20:23], v[72:75]
ds_read_b64_tr_b16 a[72:73], v238 offset:27784
ds_read_b64_tr_b16 a[74:75], v238 offset:32392
v_mfma_f32_16x16x32_bf16 v[80:83], a[76:79], v[36:39], v[80:83]
v_mfma_f32_16x16x32_bf16 v[88:91], a[76:79], v[52:55], v[88:91]
buffer_load_dwordx4 a[136:139], v244, s[20:23], s64 offen offset:2048 sc0 sc1
v_mfma_f32_16x16x32_bf16 v[96:99], a[76:79], v[68:71], v[96:99]
buffer_load_dword v230, v229, s[20:23], s94 offen sc0 sc1
v_mfma_f32_16x16x32_bf16 v[100:103], a[80:83], v[68:71], v[100:103]
ds_read_b64_tr_b16 a[76:77], v239 offset:27648
ds_read_b64_tr_b16 a[78:79], v239 offset:32256
v_mfma_f32_16x16x32_bf16 v[92:95], a[80:83], v[52:55], v[92:95]
v_mfma_f32_16x16x32_bf16 v[84:87], a[80:83], v[36:39], v[84:87]
v_mfma_f32_16x16x32_bf16 v[76:79], a[80:83], v[20:23], v[76:79]
buffer_load_dwordx4 a[152:155], v244, s[20:23], s65 offen offset:2048 sc0 sc1
v_mfma_f32_16x16x32_bf16 v[104:107], a[84:87], v[20:23], v[104:107]
ds_read_b64_tr_b16 a[80:81], v216 offset:0
ds_read_b64_tr_b16 a[82:83], v216 offset:4608
v_mfma_f32_16x16x32_bf16 v[112:115], a[84:87], v[36:39], v[112:115]
v_mfma_f32_16x16x32_bf16 v[120:123], a[84:87], v[52:55], v[120:123]
v_mfma_f32_16x16x32_bf16 v[128:131], a[84:87], v[68:71], v[128:131]
buffer_load_dwordx4 a[168:171], v244, s[20:23], s66 offen offset:2048 sc0 sc1
s_waitcnt lgkmcnt(8)
v_mfma_f32_16x16x32_bf16 v[132:135], a[88:91], v[68:71], v[132:135]
ds_read_b64_tr_b16 a[84:85], v216 offset:8
ds_read_b64_tr_b16 a[86:87], v216 offset:4616
v_mfma_f32_16x16x32_bf16 v[124:127], a[88:91], v[52:55], v[124:127]
v_mfma_f32_16x16x32_bf16 v[116:119], a[88:91], v[36:39], v[116:119]
v_mfma_f32_16x16x32_bf16 v[108:111], a[88:91], v[20:23], v[108:111]
buffer_load_dwordx4 a[184:187], v244, s[20:23], s67 offen offset:2048 sc0 sc1
v_mfma_f32_16x16x32_bf16 v[136:139], a[92:95], v[20:23], v[136:139]
ds_read_b64_tr_b16 a[88:89], v217 offset:0
ds_read_b64_tr_b16 a[90:91], v217 offset:4608
v_mfma_f32_16x16x32_bf16 v[144:147], a[92:95], v[36:39], v[144:147]
v_mfma_f32_16x16x32_bf16 v[152:155], a[92:95], v[52:55], v[152:155]
v_mfma_f32_16x16x32_bf16 v[160:163], a[92:95], v[68:71], v[160:163]
buffer_load_dwordx4 a[140:143], v244, s[20:23], s64 offen offset:3072 sc0 sc1
v_mfma_f32_16x16x32_bf16 v[164:167], a[64:67], v[68:71], v[164:167]
ds_read_b64_tr_b16 a[92:93], v217 offset:8
ds_read_b64_tr_b16 a[94:95], v217 offset:4616
v_mfma_f32_16x16x32_bf16 v[156:159], a[64:67], v[52:55], v[156:159]
v_mfma_f32_16x16x32_bf16 v[148:151], a[64:67], v[36:39], v[148:151]
v_mfma_f32_16x16x32_bf16 v[140:143], a[64:67], v[20:23], v[140:143]
buffer_load_dwordx4 a[156:159], v244, s[20:23], s65 offen offset:3072 sc0 sc1
s_waitcnt lgkmcnt(8)
v_mfma_f32_16x16x32_bf16 v[168:171], a[68:71], v[20:23], v[168:171]
ds_read_b64_tr_b16 a[64:65], v216 offset:128
ds_read_b64_tr_b16 a[66:67], v216 offset:4736
v_mfma_f32_16x16x32_bf16 v[176:179], a[68:71], v[36:39], v[176:179]
v_mfma_f32_16x16x32_bf16 v[184:187], a[68:71], v[52:55], v[184:187]
v_mfma_f32_16x16x32_bf16 v[192:195], a[68:71], v[68:71], v[192:195]
buffer_load_dwordx4 a[172:175], v244, s[20:23], s66 offen offset:3072 sc0 sc1
v_mfma_f32_16x16x32_bf16 v[196:199], a[72:75], v[68:71], v[196:199]
ds_read_b64_tr_b16 a[68:69], v216 offset:136
ds_read_b64_tr_b16 a[70:71], v216 offset:4744
v_mfma_f32_16x16x32_bf16 v[188:191], a[72:75], v[52:55], v[188:191]
v_mfma_f32_16x16x32_bf16 v[180:183], a[72:75], v[36:39], v[180:183]
v_mfma_f32_16x16x32_bf16 v[172:175], a[72:75], v[20:23], v[172:175]
buffer_load_dwordx4 a[188:191], v244, s[20:23], s67 offen offset:3072 sc0 sc1
v_mfma_f32_16x16x32_bf16 v[200:203], a[76:79], v[20:23], v[200:203]
ds_read_b64_tr_b16 a[72:73], v217 offset:128
ds_read_b64_tr_b16 a[74:75], v217 offset:4736
v_mfma_f32_16x16x32_bf16 v[204:207], a[76:79], v[36:39], v[204:207]
s_add_u32 s28, s33, 2
s_and_b32 s28, s28, 3
v_mfma_f32_16x16x32_bf16 v[208:211], a[76:79], v[52:55], v[208:211]
s_sub_u32 s28, s28, s33
s_lshl_b32 s28, s28, 16
v_mfma_f32_16x16x32_bf16 v[212:215], a[76:79], v[68:71], v[212:215]
s_add_u32 s64, s28, s44
s_add_u32 s65, s64, 4096
s_waitcnt vmcnt(13)
s_waitcnt lgkmcnt(8)
v_mfma_f32_16x16x32_bf16 v[96:99], a[80:83], a[176:179], v[96:99]
ds_read_b64_tr_b16 a[76:77], v217 offset:136
STUB_14:
s_cbranch_execz STUB_17
ds_read_b64_tr_b16 a[78:79], v217 offset:4744
v_mfma_f32_16x16x32_bf16 v[88:91], a[80:83], a[160:163], v[88:91]
s_add_u32 s66, s64, 8192
s_add_u32 s67, s64, 12288
v_mfma_f32_16x16x32_bf16 v[80:83], a[80:83], a[144:147], v[80:83]
s_waitcnt vmcnt(7)
v_cmp_gt_u32 vcc, 1, v230
v_mfma_f32_16x16x32_bf16 v[72:75], a[80:83], a[128:131], v[72:75]
v_accvgpr_read_b32 v39, a222
v_accvgpr_read_b32 v59, a232
v_mfma_f32_16x16x32_bf16 v[76:79], a[84:87], a[128:131], v[76:79]
ds_read_b64_tr_b16 a[80:81], v218 offset:0
ds_read_b64_tr_b16 a[82:83], v218 offset:4608
v_mfma_f32_16x16x32_bf16 v[84:87], a[84:87], a[144:147], v[84:87]
s_and_b32 s29, vcc_lo, 15
s_cbranch_scc1 SP_O2A
SP_O2A_RET:
v_mfma_f32_16x16x32_bf16 v[92:95], a[84:87], a[160:163], v[92:95]
buffer_load_dwordx4 a[192:195], v244, s[20:23], s64 offen offset:0 sc0 sc1
v_mfma_f32_16x16x32_bf16 v[100:103], a[84:87], a[176:179], v[100:103]
v_lshlrev_b32 v38, 16, v39
v_and_b32 v39, 0xffff0000, v39
v_mfma_f32_16x16x32_bf16 v[128:131], a[88:91], a[176:179], v[128:131]
ds_read_b64_tr_b16 a[84:85], v216 offset:9216
ds_read_b64_tr_b16 a[86:87], v216 offset:13824
v_mfma_f32_16x16x32_bf16 v[120:123], a[88:91], a[160:163], v[120:123]
v_lshlrev_b32 v58, 16, v59
v_and_b32 v59, 0xffff0000, v59
v_mfma_f32_16x16x32_bf16 v[112:115], a[88:91], a[144:147], v[112:115]
buffer_load_dwordx4 a[208:211], v244, s[20:23], s65 offen offset:0 sc0 sc1
v_mfma_f32_16x16x32_bf16 v[104:107], a[88:91], a[128:131], v[104:107]
v_add_f32 v38, v38, v58
v_add_f32 v39, v39, v59
s_waitcnt lgkmcnt(8)
v_mfma_f32_16x16x32_bf16 v[108:111], a[92:95], a[128:131], v[108:111]
ds_read_b64_tr_b16 a[88:89], v216 offset:9224
ds_read_b64_tr_b16 a[90:91], v216 offset:13832
v_mfma_f32_16x16x32_bf16 v[116:119], a[92:95], a[144:147], v[116:119]
v_cvt_pk_bf16_f32 v58, v38, v39
v_lshlrev_b32 v38, 16, v58
v_mfma_f32_16x16x32_bf16 v[124:127], a[92:95], a[160:163], v[124:127]
buffer_load_dwordx4 a[96:99], v244, s[20:23], s66 offen offset:0 sc0 sc1
v_mfma_f32_16x16x32_bf16 v[132:135], a[92:95], a[176:179], v[132:135]
v_and_b32 v39, 0xffff0000, v58
v_mul_f32 v58, 0xbfb8aa3b, v38
v_mfma_f32_16x16x32_bf16 v[160:163], a[64:67], a[176:179], v[160:163]
ds_read_b64_tr_b16 a[92:93], v217 offset:9216
ds_read_b64_tr_b16 a[94:95], v217 offset:13824
v_mfma_f32_16x16x32_bf16 v[152:155], a[64:67], a[160:163], v[152:155]
v_mul_f32 v59, 0xbfb8aa3b, v39
v_mfma_f32_16x16x32_bf16 v[144:147], a[64:67], a[144:147], v[144:147]
buffer_load_dwordx4 a[112:115], v244, s[20:23], s67 offen offset:0 sc0 sc1
v_mfma_f32_16x16x32_bf16 v[136:139], a[64:67], a[128:131], v[136:139]
v_exp_f32 v58, v58
v_mfma_f32_16x16x32_bf16 v[140:143], a[68:71], a[128:131], v[140:143]
ds_read_b64_tr_b16 a[64:65], v217 offset:9224
ds_read_b64_tr_b16 a[66:67], v217 offset:13832
v_mfma_f32_16x16x32_bf16 v[148:151], a[68:71], a[144:147], v[148:151]
v_exp_f32 v59, v59
v_mfma_f32_16x16x32_bf16 v[156:159], a[68:71], a[160:163], v[156:159]
buffer_load_dwordx4 a[196:199], v244, s[20:23], s64 offen offset:1024 sc0 sc1
v_mfma_f32_16x16x32_bf16 v[164:167], a[68:71], a[176:179], v[164:167]
v_add_f32 v58, 1.0, v58
v_add_f32 v59, 1.0, v59
s_waitcnt lgkmcnt(8)
v_mfma_f32_16x16x32_bf16 v[192:195], a[72:75], a[176:179], v[192:195]
ds_read_b64_tr_b16 a[68:69], v216 offset:9344
ds_read_b64_tr_b16 a[70:71], v216 offset:13952
v_mfma_f32_16x16x32_bf16 v[184:187], a[72:75], a[160:163], v[184:187]
v_rcp_f32 v58, v58
v_mfma_f32_16x16x32_bf16 v[176:179], a[72:75], a[144:147], v[176:179]
buffer_load_dwordx4 a[244:247], v244, s[20:23], s65 offen offset:1024 sc0 sc1
v_mfma_f32_16x16x32_bf16 v[168:171], a[72:75], a[128:131], v[168:171]
v_rcp_f32 v59, v59
v_mfma_f32_16x16x32_bf16 v[172:175], a[76:79], a[128:131], v[172:175]
ds_read_b64_tr_b16 a[72:73], v216 offset:9352
ds_read_b64_tr_b16 a[74:75], v216 offset:13960
v_mfma_f32_16x16x32_bf16 v[180:183], a[76:79], a[144:147], v[180:183]
v_mul_f32 v38, v38, v58
v_mul_f32 v39, v39, v59
v_mfma_f32_16x16x32_bf16 v[188:191], a[76:79], a[160:163], v[188:191]
buffer_load_dwordx4 a[100:103], v244, s[20:23], s66 offen offset:1024 sc0 sc1
v_mfma_f32_16x16x32_bf16 v[196:199], a[76:79], a[176:179], v[196:199]
v_cvt_pk_bf16_f32 v58, v38, v39
v_lshlrev_b32 v38, 16, v58
v_mfma_f32_16x16x32_bf16 v[212:215], a[80:83], a[176:179], v[212:215]
ds_read_b64_tr_b16 a[76:77], v217 offset:9344
ds_read_b64_tr_b16 a[78:79], v217 offset:13952
v_mfma_f32_16x16x32_bf16 v[208:211], a[80:83], a[160:163], v[208:211]
v_and_b32 v39, 0xffff0000, v58
v_accvgpr_read_b32 v41, a223
v_mfma_f32_16x16x32_bf16 v[204:207], a[80:83], a[144:147], v[204:207]
buffer_load_dwordx4 a[116:119], v244, s[20:23], s67 offen offset:1024 sc0 sc1
v_mfma_f32_16x16x32_bf16 v[200:203], a[80:83], a[128:131], v[200:203]
v_accvgpr_read_b32 v59, a233
v_lshlrev_b32 v40, 16, v41
s_waitcnt vmcnt(17)
s_waitcnt lgkmcnt(8)
v_mfma_f32_16x16x32_bf16 v[72:75], a[84:87], a[132:135], v[72:75]
ds_read_b64_tr_b16 a[80:81], v217 offset:9352
ds_read_b64_tr_b16 a[82:83], v217 offset:13960
v_mfma_f32_16x16x32_bf16 v[80:83], a[84:87], a[148:151], v[80:83]
v_and_b32 v41, 0xffff0000, v41
v_lshlrev_b32 v58, 16, v59
v_mfma_f32_16x16x32_bf16 v[88:91], a[84:87], a[164:167], v[88:91]
buffer_load_dwordx4 a[200:203], v244, s[20:23], s64 offen offset:2048 sc0 sc1
v_mfma_f32_16x16x32_bf16 v[96:99], a[84:87], a[180:183], v[96:99]
v_and_b32 v59, 0xffff0000, v59
v_add_f32 v40, v40, v58
v_mfma_f32_16x16x32_bf16 v[100:103], a[88:91], a[180:183], v[100:103]
ds_read_b64_tr_b16 a[84:85], v218 offset:9216
ds_read_b64_tr_b16 a[86:87], v218 offset:13824
v_mfma_f32_16x16x32_bf16 v[92:95], a[88:91], a[164:167], v[92:95]
v_add_f32 v41, v41, v59
v_cvt_pk_bf16_f32 v58, v40, v41
v_mfma_f32_16x16x32_bf16 v[84:87], a[88:91], a[148:151], v[84:87]
buffer_load_dwordx4 a[248:251], v244, s[20:23], s65 offen offset:2048 sc0 sc1
v_mfma_f32_16x16x32_bf16 v[76:79], a[88:91], a[132:135], v[76:79]
v_lshlrev_b32 v40, 16, v58
v_and_b32 v41, 0xffff0000, v58
v_mfma_f32_16x16x32_bf16 v[104:107], a[92:95], a[132:135], v[104:107]
ds_read_b64_tr_b16 a[88:89], v216 offset:18432
ds_read_b64_tr_b16 a[90:91], v216 offset:23040
v_mfma_f32_16x16x32_bf16 v[112:115], a[92:95], a[148:151], v[112:115]
v_mul_f32 v58, 0xbfb8aa3b, v40
v_mul_f32 v59, 0xbfb8aa3b, v41
v_mfma_f32_16x16x32_bf16 v[120:123], a[92:95], a[164:167], v[120:123]
buffer_load_dwordx4 a[104:107], v244, s[20:23], s66 offen offset:2048 sc0 sc1
v_mfma_f32_16x16x32_bf16 v[128:131], a[92:95], a[180:183], v[128:131]
v_exp_f32 v58, v58
s_waitcnt lgkmcnt(8)
v_mfma_f32_16x16x32_bf16 v[132:135], a[64:67], a[180:183], v[132:135]
ds_read_b64_tr_b16 a[92:93], v216 offset:18440
ds_read_b64_tr_b16 a[94:95], v216 offset:23048
v_mfma_f32_16x16x32_bf16 v[124:127], a[64:67], a[164:167], v[124:127]
v_exp_f32 v59, v59
v_mfma_f32_16x16x32_bf16 v[116:119], a[64:67], a[148:151], v[116:119]
buffer_load_dwordx4 a[120:123], v244, s[20:23], s67 offen offset:2048 sc0 sc1
v_mfma_f32_16x16x32_bf16 v[108:111], a[64:67], a[132:135], v[108:111]
v_add_f32 v58, 1.0, v58
v_add_f32 v59, 1.0, v59
v_mfma_f32_16x16x32_bf16 v[136:139], a[68:71], a[132:135], v[136:139]
ds_read_b64_tr_b16 a[64:65], v217 offset:18432
ds_read_b64_tr_b16 a[66:67], v217 offset:23040
v_mfma_f32_16x16x32_bf16 v[144:147], a[68:71], a[148:151], v[144:147]
v_rcp_f32 v58, v58
v_mfma_f32_16x16x32_bf16 v[152:155], a[68:71], a[164:167], v[152:155]
buffer_load_dwordx4 a[204:207], v244, s[20:23], s64 offen offset:3072 sc0 sc1
v_mfma_f32_16x16x32_bf16 v[160:163], a[68:71], a[180:183], v[160:163]
v_rcp_f32 v59, v59
v_mfma_f32_16x16x32_bf16 v[164:167], a[72:75], a[180:183], v[164:167]
ds_read_b64_tr_b16 a[68:69], v217 offset:18440
ds_read_b64_tr_b16 a[70:71], v217 offset:23048
v_mfma_f32_16x16x32_bf16 v[156:159], a[72:75], a[164:167], v[156:159]
v_mul_f32 v40, v40, v58
v_mul_f32 v41, v41, v59
v_mfma_f32_16x16x32_bf16 v[148:151], a[72:75], a[148:151], v[148:151]
buffer_load_dwordx4 a[252:255], v244, s[20:23], s65 offen offset:3072 sc0 sc1
v_mfma_f32_16x16x32_bf16 v[140:143], a[72:75], a[132:135], v[140:143]
v_cvt_pk_bf16_f32 v58, v40, v41
v_lshlrev_b32 v40, 16, v58
s_waitcnt lgkmcnt(8)
v_mfma_f32_16x16x32_bf16 v[168:171], a[76:79], a[132:135], v[168:171]
ds_read_b64_tr_b16 a[72:73], v216 offset:18560
ds_read_b64_tr_b16 a[74:75], v216 offset:23168
v_mfma_f32_16x16x32_bf16 v[176:179], a[76:79], a[148:151], v[176:179]
v_and_b32 v41, 0xffff0000, v58
v_accvgpr_read_b32 v43, a224
v_mfma_f32_16x16x32_bf16 v[184:187], a[76:79], a[164:167], v[184:187]
buffer_load_dwordx4 a[108:111], v244, s[20:23], s66 offen offset:3072 sc0 sc1
v_mfma_f32_16x16x32_bf16 v[192:195], a[76:79], a[180:183], v[192:195]
v_accvgpr_read_b32 v59, a234
v_lshlrev_b32 v42, 16, v43
v_mfma_f32_16x16x32_bf16 v[196:199], a[80:83], a[180:183], v[196:199]
ds_read_b64_tr_b16 a[76:77], v216 offset:18568
ds_read_b64_tr_b16 a[78:79], v216 offset:23176
v_mfma_f32_16x16x32_bf16 v[188:191], a[80:83], a[164:167], v[188:191]
v_and_b32 v43, 0xffff0000, v43
v_lshlrev_b32 v58, 16, v59
v_mfma_f32_16x16x32_bf16 v[180:183], a[80:83], a[148:151], v[180:183]
buffer_load_dwordx4 a[124:127], v244, s[20:23], s67 offen offset:3072 sc0 sc1
v_mfma_f32_16x16x32_bf16 v[172:175], a[80:83], a[132:135], v[172:175]
s_add_u32 s28, s33, 3
s_and_b32 s28, s28, 3
v_mfma_f32_16x16x32_bf16 v[200:203], a[84:87], a[132:135], v[200:203]
ds_read_b64_tr_b16 a[80:81], v217 offset:18560
ds_read_b64_tr_b16 a[82:83], v217 offset:23168
v_mfma_f32_16x16x32_bf16 v[204:207], a[84:87], a[148:151], v[204:207]
s_sub_u32 s28, s28, s33
s_lshl_b32 s28, s28, 16
v_mfma_f32_16x16x32_bf16 v[208:211], a[84:87], a[164:167], v[208:211]
s_add_u32 s64, s28, s44
s_add_u32 s65, s64, 4096
v_mfma_f32_16x16x32_bf16 v[212:215], a[84:87], a[180:183], v[212:215]
s_add_u32 s66, s64, 8192
s_add_u32 s67, s64, 12288
s_waitcnt vmcnt(20)
s_waitcnt lgkmcnt(8)
v_mfma_f32_16x16x32_bf16 v[96:99], a[88:91], a[184:187], v[96:99]
ds_read_b64_tr_b16 a[84:85], v217 offset:18568
ds_read_b64_tr_b16 a[86:87], v217 offset:23176
v_mfma_f32_16x16x32_bf16 v[88:91], a[88:91], a[168:171], v[88:91]
buffer_load_dwordx4 a[0:3], v244, s[20:23], s64 offen offset:0 sc0 sc1
v_mfma_f32_16x16x32_bf16 v[80:83], a[88:91], a[152:155], v[80:83]
v_and_b32 v59, 0xffff0000, v59
v_add_f32 v42, v42, v58
v_mfma_f32_16x16x32_bf16 v[72:75], a[88:91], a[136:139], v[72:75]
v_add_f32 v43, v43, v59
v_cvt_pk_bf16_f32 v58, v42, v43
v_mfma_f32_16x16x32_bf16 v[76:79], a[92:95], a[136:139], v[76:79]
ds_read_b64_tr_b16 a[88:89], v218 offset:18432
ds_read_b64_tr_b16 a[90:91], v218 offset:23040
v_mfma_f32_16x16x32_bf16 v[84:87], a[92:95], a[152:155], v[84:87]
buffer_load_dwordx4 a[16:19], v244, s[20:23], s65 offen offset:0 sc0 sc1
v_mfma_f32_16x16x32_bf16 v[92:95], a[92:95], a[168:171], v[92:95]
v_lshlrev_b32 v42, 16, v58
v_and_b32 v43, 0xffff0000, v58
v_mfma_f32_16x16x32_bf16 v[100:103], a[92:95], a[184:187], v[100:103]
v_mul_f32 v58, 0xbfb8aa3b, v42
v_mul_f32 v59, 0xbfb8aa3b, v43
v_mfma_f32_16x16x32_bf16 v[128:131], a[64:67], a[184:187], v[128:131]
ds_read_b64_tr_b16 a[92:93], v216 offset:27648
ds_read_b64_tr_b16 a[94:95], v216 offset:32256
v_mfma_f32_16x16x32_bf16 v[120:123], a[64:67], a[168:171], v[120:123]
buffer_load_dwordx4 a[32:35], v244, s[20:23], s66 offen offset:0 sc0 sc1
v_mfma_f32_16x16x32_bf16 v[112:115], a[64:67], a[152:155], v[112:115]
v_exp_f32 v58, v58
v_mfma_f32_16x16x32_bf16 v[104:107], a[64:67], a[136:139], v[104:107]
v_exp_f32 v59, v59
s_waitcnt lgkmcnt(8)
v_mfma_f32_16x16x32_bf16 v[108:111], a[68:71], a[136:139], v[108:111]
ds_read_b64_tr_b16 a[64:65], v216 offset:27656
ds_read_b64_tr_b16 a[66:67], v216 offset:32264
v_mfma_f32_16x16x32_bf16 v[116:119], a[68:71], a[152:155], v[116:119]
buffer_load_dwordx4 a[48:51], v244, s[20:23], s67 offen offset:0 sc0 sc1
v_mfma_f32_16x16x32_bf16 v[124:127], a[68:71], a[168:171], v[124:127]
v_add_f32 v58, 1.0, v58
v_add_f32 v59, 1.0, v59
v_mfma_f32_16x16x32_bf16 v[132:135], a[68:71], a[184:187], v[132:135]
v_rcp_f32 v58, v58
v_mfma_f32_16x16x32_bf16 v[160:163], a[72:75], a[184:187], v[160:163]
ds_read_b64_tr_b16 a[68:69], v217 offset:27648
ds_read_b64_tr_b16 a[70:71], v217 offset:32256
v_mfma_f32_16x16x32_bf16 v[152:155], a[72:75], a[168:171], v[152:155]
buffer_load_dwordx4 a[4:7], v244, s[20:23], s64 offen offset:1024 sc0 sc1
v_mfma_f32_16x16x32_bf16 v[144:147], a[72:75], a[152:155], v[144:147]
v_rcp_f32 v59, v59
v_mfma_f32_16x16x32_bf16 v[136:139], a[72:75], a[136:139], v[136:139]
v_mul_f32 v42, v42, v58
v_mul_f32 v43, v43, v59
v_mfma_f32_16x16x32_bf16 v[140:143], a[76:79], a[136:139], v[140:143]
ds_read_b64_tr_b16 a[72:73], v217 offset:27656
ds_read_b64_tr_b16 a[74:75], v217 offset:32264
v_mfma_f32_16x16x32_bf16 v[148:151], a[76:79], a[152:155], v[148:151]
buffer_load_dwordx4 a[20:23], v244, s[20:23], s65 offen offset:1024 sc0 sc1
v_mfma_f32_16x16x32_bf16 v[156:159], a[76:79], a[168:171], v[156:159]
v_cvt_pk_bf16_f32 v58, v42, v43
v_lshlrev_b32 v42, 16, v58
v_mfma_f32_16x16x32_bf16 v[164:167], a[76:79], a[184:187], v[164:167]
v_and_b32 v43, 0xffff0000, v58
v_accvgpr_read_b32 v45, a225
s_waitcnt lgkmcnt(8)
v_mfma_f32_16x16x32_bf16 v[192:195], a[80:83], a[184:187], v[192:195]
ds_read_b64_tr_b16 a[76:77], v216 offset:27776
ds_read_b64_tr_b16 a[78:79], v216 offset:32384
v_mfma_f32_16x16x32_bf16 v[184:187], a[80:83], a[168:171], v[184:187]
buffer_load_dwordx4 a[36:39], v244, s[20:23], s66 offen offset:1024 sc0 sc1
v_mfma_f32_16x16x32_bf16 v[176:179], a[80:83], a[152:155], v[176:179]
v_accvgpr_read_b32 v59, a235
v_lshlrev_b32 v44, 16, v45
v_mfma_f32_16x16x32_bf16 v[168:171], a[80:83], a[136:139], v[168:171]
v_and_b32 v45, 0xffff0000, v45
v_lshlrev_b32 v58, 16, v59
v_mfma_f32_16x16x32_bf16 v[172:175], a[84:87], a[136:139], v[172:175]
ds_read_b64_tr_b16 a[80:81], v216 offset:27784
ds_read_b64_tr_b16 a[82:83], v216 offset:32392
v_mfma_f32_16x16x32_bf16 v[180:183], a[84:87], a[152:155], v[180:183]
buffer_load_dwordx4 a[52:55], v244, s[20:23], s67 offen offset:1024 sc0 sc1
v_mfma_f32_16x16x32_bf16 v[188:191], a[84:87], a[168:171], v[188:191]
v_and_b32 v59, 0xffff0000, v59
v_add_f32 v44, v44, v58
v_mfma_f32_16x16x32_bf16 v[196:199], a[84:87], a[184:187], v[196:199]
v_add_f32 v45, v45, v59
v_cvt_pk_bf16_f32 v58, v44, v45
v_mfma_f32_16x16x32_bf16 v[212:215], a[88:91], a[184:187], v[212:215]
ds_read_b64_tr_b16 a[84:85], v217 offset:27776
ds_read_b64_tr_b16 a[86:87], v217 offset:32384
v_mfma_f32_16x16x32_bf16 v[208:211], a[88:91], a[168:171], v[208:211]
buffer_load_dwordx4 a[8:11], v244, s[20:23], s64 offen offset:2048 sc0 sc1
v_mfma_f32_16x16x32_bf16 v[204:207], a[88:91], a[152:155], v[204:207]
v_lshlrev_b32 v44, 16, v58
v_and_b32 v45, 0xffff0000, v58
v_mfma_f32_16x16x32_bf16 v[200:203], a[88:91], a[136:139], v[200:203]
v_mul_f32 v58, 0xbfb8aa3b, v44
v_mul_f32 v59, 0xbfb8aa3b, v45
s_waitcnt vmcnt(25)
s_waitcnt lgkmcnt(8)
v_mfma_f32_16x16x32_bf16 v[72:75], a[92:95], a[140:143], v[72:75]
ds_read_b64_tr_b16 a[88:89], v217 offset:27784
ds_read_b64_tr_b16 a[90:91], v217 offset:32392
v_mfma_f32_16x16x32_bf16 v[80:83], a[92:95], a[156:159], v[80:83]
buffer_load_dwordx4 a[24:27], v244, s[20:23], s65 offen offset:2048 sc0 sc1
v_mfma_f32_16x16x32_bf16 v[88:91], a[92:95], a[172:175], v[88:91]
v_exp_f32 v58, v58
v_mfma_f32_16x16x32_bf16 v[96:99], a[92:95], a[188:191], v[96:99]
v_exp_f32 v59, v59
v_mfma_f32_16x16x32_bf16 v[100:103], a[64:67], a[188:191], v[100:103]
ds_read_b64_tr_b16 a[92:93], v218 offset:27648
ds_read_b64_tr_b16 a[94:95], v218 offset:32256
v_mfma_f32_16x16x32_bf16 v[92:95], a[64:67], a[172:175], v[92:95]
buffer_load_dwordx4 a[40:43], v244, s[20:23], s66 offen offset:2048 sc0 sc1
v_mfma_f32_16x16x32_bf16 v[84:87], a[64:67], a[156:159], v[84:87]
v_add_f32 v58, 1.0, v58
v_add_f32 v59, 1.0, v59
v_mfma_f32_16x16x32_bf16 v[76:79], a[64:67], a[140:143], v[76:79]
v_rcp_f32 v58, v58
v_mfma_f32_16x16x32_bf16 v[104:107], a[68:71], a[140:143], v[104:107]
ds_read_b64_tr_b16 a[64:65], v221 offset:0
ds_read_b64_tr_b16 a[66:67], v221 offset:4608
v_mfma_f32_16x16x32_bf16 v[112:115], a[68:71], a[156:159], v[112:115]
buffer_load_dwordx4 a[56:59], v244, s[20:23], s67 offen offset:2048 sc0 sc1
v_mfma_f32_16x16x32_bf16 v[120:123], a[68:71], a[172:175], v[120:123]
v_rcp_f32 v59, v59
v_mfma_f32_16x16x32_bf16 v[128:131], a[68:71], a[188:191], v[128:131]
v_mul_f32 v44, v44, v58
v_mul_f32 v45, v45, v59
s_waitcnt lgkmcnt(8)
v_mfma_f32_16x16x32_bf16 v[132:135], a[72:75], a[188:191], v[132:135]
ds_read_b64_tr_b16 a[68:69], v221 offset:9216
ds_read_b64_tr_b16 a[70:71], v221 offset:13824
v_mfma_f32_16x16x32_bf16 v[124:127], a[72:75], a[172:175], v[124:127]
buffer_load_dwordx4 a[12:15], v244, s[20:23], s64 offen offset:3072 sc0 sc1
v_mfma_f32_16x16x32_bf16 v[116:119], a[72:75], a[156:159], v[116:119]
v_cvt_pk_bf16_f32 v58, v44, v45
v_lshlrev_b32 v44, 16, v58
v_mfma_f32_16x16x32_bf16 v[108:111], a[72:75], a[140:143], v[108:111]
v_and_b32 v45, 0xffff0000, v58
v_accvgpr_read_b32 v47, a226
v_mfma_f32_16x16x32_bf16 v[136:139], a[76:79], a[140:143], v[136:139]
ds_read_b64_tr_b16 a[72:73], v221 offset:18432
ds_read_b64_tr_b16 a[74:75], v221 offset:23040
v_mfma_f32_16x16x32_bf16 v[144:147], a[76:79], a[156:159], v[144:147]
buffer_load_dwordx4 a[28:31], v244, s[20:23], s65 offen offset:3072 sc0 sc1
v_mfma_f32_16x16x32_bf16 v[152:155], a[76:79], a[172:175], v[152:155]
v_accvgpr_read_b32 v59, a236
v_lshlrev_b32 v46, 16, v47
v_mfma_f32_16x16x32_bf16 v[160:163], a[76:79], a[188:191], v[160:163]
v_and_b32 v47, 0xffff0000, v47
v_lshlrev_b32 v58, 16, v59
v_mfma_f32_16x16x32_bf16 v[164:167], a[80:83], a[188:191], v[164:167]
ds_read_b64_tr_b16 a[76:77], v221 offset:27648
ds_read_b64_tr_b16 a[78:79], v221 offset:32256
v_mfma_f32_16x16x32_bf16 v[156:159], a[80:83], a[172:175], v[156:159]
buffer_load_dwordx4 a[44:47], v244, s[20:23], s66 offen offset:3072 sc0 sc1
v_mfma_f32_16x16x32_bf16 v[148:151], a[80:83], a[156:159], v[148:151]
v_and_b32 v59, 0xffff0000, v59
v_add_f32 v46, v46, v58
v_mfma_f32_16x16x32_bf16 v[140:143], a[80:83], a[140:143], v[140:143]
v_add_f32 v47, v47, v59
v_cvt_pk_bf16_f32 v58, v46, v47
s_waitcnt lgkmcnt(8)
v_mfma_f32_16x16x32_bf16 v[168:171], a[84:87], a[140:143], v[168:171]
ds_read_b64_tr_b16 a[80:81], v224 offset:0
ds_read_b64_tr_b16 a[82:83], v224 offset:4608
v_mfma_f32_16x16x32_bf16 v[176:179], a[84:87], a[156:159], v[176:179]
buffer_load_dwordx4 a[60:63], v244, s[20:23], s67 offen offset:3072 sc0 sc1
v_mfma_f32_16x16x32_bf16 v[184:187], a[84:87], a[172:175], v[184:187]
s_lshl2_add_u32 s28, s36, s33
s_lshl2_add_u32 s28, s28, s37
v_mfma_f32_16x16x32_bf16 v[192:195], a[84:87], a[188:191], v[192:195]
s_lshl_b32 s95, s28, 5
s_add_u32 s95, s95, 0x24a000
v_mfma_f32_16x16x32_bf16 v[196:199], a[88:91], a[188:191], v[196:199]
ds_read_b64_tr_b16 a[84:85], v224 offset:9216
ds_read_b64_tr_b16 a[86:87], v224 offset:13824
v_mfma_f32_16x16x32_bf16 v[188:191], a[88:91], a[172:175], v[188:191]
s_lshl_b32 s28, s32, 18
s_sub_u32 s49, s44, s28
v_mfma_f32_16x16x32_bf16 v[180:183], a[88:91], a[156:159], v[180:183]
v_add_u32 v243, 0x2000, v244
v_mov_b32 v246, 2
v_mfma_f32_16x16x32_bf16 v[172:175], a[88:91], a[140:143], v[172:175]
s_lshl2_add_u32 s29, s33, s94
v_lshlrev_b32 v46, 16, v58
v_mfma_f32_16x16x32_bf16 v[200:203], a[92:95], a[140:143], v[200:203]
ds_read_b64_tr_b16 a[88:89], v224 offset:18432
ds_read_b64_tr_b16 a[90:91], v224 offset:23040
v_mfma_f32_16x16x32_bf16 v[204:207], a[92:95], a[156:159], v[204:207]
v_and_b32 v47, 0xffff0000, v58
v_mul_f32 v58, 0xbfb8aa3b, v46
v_mfma_f32_16x16x32_bf16 v[208:211], a[92:95], a[172:175], v[208:211]
v_mul_f32 v59, 0xbfb8aa3b, v47
v_mfma_f32_16x16x32_bf16 v[212:215], a[92:95], a[188:191], v[212:215]
v_exp_f32 v58, v58
s_waitcnt vmcnt(28)
s_waitcnt lgkmcnt(8)
v_mfma_f32_16x16x32_bf16 v[212:215], a[64:67], a[112:115], v[212:215]
ds_read_b64_tr_b16 a[92:93], v224 offset:27648
ds_read_b64_tr_b16 a[94:95], v224 offset:32256
v_mfma_f32_16x16x32_bf16 v[208:211], a[64:67], a[96:99], v[208:211]
v_exp_f32 v59, v59
v_mfma_f32_16x16x32_bf16 v[204:207], a[64:67], a[208:211], v[204:207]
v_add_f32 v58, 1.0, v58
v_add_f32 v59, 1.0, v59
v_mfma_f32_16x16x32_bf16 v[200:203], a[64:67], a[192:195], v[200:203]
v_rcp_f32 v58, v58
s_waitcnt vmcnt(24)
v_mfma_f32_16x16x32_bf16 v[200:203], a[68:71], a[196:199], v[200:203]
ds_read_b64_tr_b16 a[64:65], v219 offset:0
ds_read_b64_tr_b16 a[66:67], v219 offset:4608
v_mfma_f32_16x16x32_bf16 v[204:207], a[68:71], a[244:247], v[204:207]
v_rcp_f32 v59, v59
v_mfma_f32_16x16x32_bf16 v[208:211], a[68:71], a[100:103], v[208:211]
v_mul_f32 v46, v46, v58
v_mul_f32 v47, v47, v59
v_mfma_f32_16x16x32_bf16 v[212:215], a[68:71], a[116:119], v[212:215]
v_cvt_pk_bf16_f32 v58, v46, v47
v_lshlrev_b32 v46, 16, v58
s_waitcnt vmcnt(20)
v_mfma_f32_16x16x32_bf16 v[212:215], a[72:75], a[120:123], v[212:215]
ds_read_b64_tr_b16 a[68:69], v219 offset:9216
ds_read_b64_tr_b16 a[70:71], v219 offset:13824
v_mfma_f32_16x16x32_bf16 v[208:211], a[72:75], a[104:107], v[208:211]
v_and_b32 v47, 0xffff0000, v58
v_accvgpr_read_b32 v49, a227
v_mfma_f32_16x16x32_bf16 v[204:207], a[72:75], a[248:251], v[204:207]
v_accvgpr_read_b32 v59, a237
v_lshlrev_b32 v48, 16, v49
v_mfma_f32_16x16x32_bf16 v[200:203], a[72:75], a[200:203], v[200:203]
v_and_b32 v49, 0xffff0000, v49
v_lshlrev_b32 v58, 16, v59
s_waitcnt vmcnt(16)
s_waitcnt lgkmcnt(8)
v_mfma_f32_16x16x32_bf16 v[200:203], a[76:79], a[204:207], v[200:203]
ds_read_b64_tr_b16 a[72:73], v219 offset:18432
ds_read_b64_tr_b16 a[74:75], v219 offset:23040
v_mfma_f32_16x16x32_bf16 v[204:207], a[76:79], a[252:255], v[204:207]
v_and_b32 v59, 0xffff0000, v59
v_add_f32 v48, v48, v58
v_mfma_f32_16x16x32_bf16 v[208:211], a[76:79], a[108:111], v[208:211]
v_add_f32 v49, v49, v59
v_cvt_pk_bf16_f32 v58, v48, v49
v_mfma_f32_16x16x32_bf16 v[212:215], a[76:79], a[124:127], v[212:215]
v_lshlrev_b32 v48, 16, v58
v_and_b32 v49, 0xffff0000, v58
s_waitcnt vmcnt(12)
v_mfma_f32_16x16x32_bf16 v[212:215], a[80:83], a[48:51], v[212:215]
ds_read_b64_tr_b16 a[76:77], v219 offset:27648
ds_read_b64_tr_b16 a[78:79], v219 offset:32256
v_mfma_f32_16x16x32_bf16 v[208:211], a[80:83], a[32:35], v[208:211]
v_mul_f32 v58, 0xbfb8aa3b, v48
v_mul_f32 v59, 0xbfb8aa3b, v49
v_mfma_f32_16x16x32_bf16 v[204:207], a[80:83], a[16:19], v[204:207]
v_exp_f32 v58, v58
v_mfma_f32_16x16x32_bf16 v[200:203], a[80:83], a[0:3], v[200:203]
s_waitcnt vmcnt(0)
buffer_store_dword v246, v254, s[20:23], s29 offen
s_waitcnt vmcnt(9)
v_mfma_f32_16x16x32_bf16 v[200:203], a[84:87], a[4:7], v[200:203]
ds_read_b64_tr_b16 a[80:81], v222 offset:0
ds_read_b64_tr_b16 a[82:83], v222 offset:4608
v_mfma_f32_16x16x32_bf16 v[204:207], a[84:87], a[20:23], v[204:207]
s_add_u32 s28, s32, 0
s_and_b32 s28, s28, 7
v_mfma_f32_16x16x32_bf16 v[208:211], a[84:87], a[36:39], v[208:211]
s_xor_b32 s29, s28, s32
s_lshl_b32 s28, s28, 18
v_mfma_f32_16x16x32_bf16 v[212:215], a[84:87], a[52:55], v[212:215]
s_add_u32 s28, s28, s49
s_and_b32 s29, s29, 4
s_waitcnt vmcnt(5)
s_waitcnt lgkmcnt(8)
v_mfma_f32_16x16x32_bf16 v[212:215], a[88:91], a[56:59], v[212:215]
ds_read_b64_tr_b16 a[84:85], v222 offset:9216
ds_read_b64_tr_b16 a[86:87], v222 offset:13824
v_mfma_f32_16x16x32_bf16 v[208:211], a[88:91], a[40:43], v[208:211]
s_add_u32 s72, s28, 0
s_lshl_b32 s29, s29, 10
v_mfma_f32_16x16x32_bf16 v[204:207], a[88:91], a[24:27], v[204:207]
s_add_u32 s28, s32, 1
s_and_b32 s28, s28, 7
v_mfma_f32_16x16x32_bf16 v[200:203], a[88:91], a[8:11], v[200:203]
s_xor_b32 s29, s28, s32
s_lshl_b32 s28, s28, 18
s_waitcnt vmcnt(1)
v_mfma_f32_16x16x32_bf16 v[200:203], a[92:95], a[12:15], v[200:203]
ds_read_b64_tr_b16 a[88:89], v222 offset:18432
ds_read_b64_tr_b16 a[90:91], v222 offset:23040
v_mfma_f32_16x16x32_bf16 v[204:207], a[92:95], a[28:31], v[204:207]
s_add_u32 s28, s28, s49
s_and_b32 s29, s29, 4
v_mfma_f32_16x16x32_bf16 v[208:211], a[92:95], a[44:47], v[208:211]
s_add_u32 s73, s28, 8192
s_lshl_b32 s29, s29, 10
v_mfma_f32_16x16x32_bf16 v[212:215], a[92:95], a[60:63], v[212:215]
s_add_u32 s65, s28, s29
v_mfma_f32_16x16x32_bf16 v[96:99], a[64:67], a[112:115], v[96:99]
ds_read_b64_tr_b16 a[92:93], v222 offset:27648
ds_read_b64_tr_b16 a[94:95], v222 offset:32256
v_mfma_f32_16x16x32_bf16 v[88:91], a[64:67], a[96:99], v[88:91]
s_add_u32 s28, s32, 2
s_and_b32 s28, s28, 7
v_mfma_f32_16x16x32_bf16 v[80:83], a[64:67], a[208:211], v[80:83]
s_xor_b32 s29, s28, s32
s_lshl_b32 s28, s28, 18
v_mfma_f32_16x16x32_bf16 v[72:75], a[64:67], a[192:195], v[72:75]
s_add_u32 s28, s28, s49
s_and_b32 s29, s29, 4
s_waitcnt lgkmcnt(8)
v_mfma_f32_16x16x32_bf16 v[72:75], a[68:71], a[196:199], v[72:75]
ds_read_b64_tr_b16 a[64:65], v219 offset:8
ds_read_b64_tr_b16 a[66:67], v219 offset:4616
v_mfma_f32_16x16x32_bf16 v[80:83], a[68:71], a[244:247], v[80:83]
s_add_u32 s74, s28, 8192
s_lshl_b32 s29, s29, 10
v_mfma_f32_16x16x32_bf16 v[88:91], a[68:71], a[100:103], v[88:91]
s_add_u32 s66, s28, s29
v_mfma_f32_16x16x32_bf16 v[96:99], a[68:71], a[116:119], v[96:99]
s_add_u32 s28, s32, 3
s_and_b32 s28, s28, 7
v_mfma_f32_16x16x32_bf16 v[96:99], a[72:75], a[120:123], v[96:99]
ds_read_b64_tr_b16 a[68:69], v219 offset:9224
ds_read_b64_tr_b16 a[70:71], v219 offset:13832
v_mfma_f32_16x16x32_bf16 v[88:91], a[72:75], a[104:107], v[88:91]
s_xor_b32 s29, s28, s32
s_lshl_b32 s28, s28, 18
v_mfma_f32_16x16x32_bf16 v[80:83], a[72:75], a[248:251], v[80:83]
s_add_u32 s28, s28, s49
s_and_b32 s29, s29, 4
v_mfma_f32_16x16x32_bf16 v[72:75], a[72:75], a[200:203], v[72:75]
s_add_u32 s75, s28, 0
s_lshl_b32 s29, s29, 10
v_mfma_f32_16x16x32_bf16 v[72:75], a[76:79], a[204:207], v[72:75]
ds_read_b64_tr_b16 a[72:73], v219 offset:18440
ds_read_b64_tr_b16 a[74:75], v219 offset:23048
v_mfma_f32_16x16x32_bf16 v[80:83], a[76:79], a[252:255], v[80:83]
s_add_u32 s67, s28, s29
v_mfma_f32_16x16x32_bf16 v[88:91], a[76:79], a[108:111], v[88:91]
buffer_load_dword v230, v229, s[20:23], s94 offen sc0 sc1
v_mfma_f32_16x16x32_bf16 v[96:99], a[76:79], a[124:127], v[96:99]
s_add_u32 s28, s32, 4
s_and_b32 s28, s28, 7
s_waitcnt lgkmcnt(8)
v_mfma_f32_16x16x32_bf16 v[96:99], a[80:83], a[48:51], v[96:99]
ds_read_b64_tr_b16 a[76:77], v219 offset:27656
ds_read_b64_tr_b16 a[78:79], v219 offset:32264
v_mfma_f32_16x16x32_bf16 v[88:91], a[80:83], a[32:35], v[88:91]
s_xor_b32 s29, s28, s32
s_lshl_b32 s28, s28, 18
v_mfma_f32_16x16x32_bf16 v[80:83], a[80:83], a[16:19], v[80:83]
s_add_u32 s28, s28, s49
s_and_b32 s29, s29, 4
v_mfma_f32_16x16x32_bf16 v[72:75], a[80:83], a[0:3], v[72:75]
s_add_u32 s84, s28, 0
s_lshl_b32 s29, s29, 10
v_mfma_f32_16x16x32_bf16 v[72:75], a[84:87], a[4:7], v[72:75]
ds_read_b64_tr_b16 a[80:81], v222 offset:8
ds_read_b64_tr_b16 a[82:83], v222 offset:4616
v_mfma_f32_16x16x32_bf16 v[80:83], a[84:87], a[20:23], v[80:83]
s_add_u32 s68, s28, s29
v_mfma_f32_16x16x32_bf16 v[88:91], a[84:87], a[36:39], v[88:91]
s_add_u32 s28, s32, 5
s_and_b32 s28, s28, 7
v_mfma_f32_16x16x32_bf16 v[96:99], a[84:87], a[52:55], v[96:99]
s_xor_b32 s29, s28, s32
s_lshl_b32 s28, s28, 18
v_mfma_f32_16x16x32_bf16 v[96:99], a[88:91], a[56:59], v[96:99]
ds_read_b64_tr_b16 a[84:85], v222 offset:9224
ds_read_b64_tr_b16 a[86:87], v222 offset:13832
v_mfma_f32_16x16x32_bf16 v[88:91], a[88:91], a[40:43], v[88:91]
s_add_u32 s28, s28, s49
s_and_b32 s29, s29, 4
v_mfma_f32_16x16x32_bf16 v[80:83], a[88:91], a[24:27], v[80:83]
s_add_u32 s85, s28, 8192
s_lshl_b32 s29, s29, 10
v_mfma_f32_16x16x32_bf16 v[72:75], a[88:91], a[8:11], v[72:75]
s_add_u32 s69, s28, s29
s_waitcnt lgkmcnt(8)
v_mfma_f32_16x16x32_bf16 v[72:75], a[92:95], a[12:15], v[72:75]
ds_read_b64_tr_b16 a[88:89], v222 offset:18440
ds_read_b64_tr_b16 a[90:91], v222 offset:23048
v_mfma_f32_16x16x32_bf16 v[80:83], a[92:95], a[28:31], v[80:83]
s_add_u32 s28, s32, 6
s_and_b32 s28, s28, 7
v_mfma_f32_16x16x32_bf16 v[88:91], a[92:95], a[44:47], v[88:91]
s_xor_b32 s29, s28, s32
s_lshl_b32 s28, s28, 18
v_mfma_f32_16x16x32_bf16 v[96:99], a[92:95], a[60:63], v[96:99]
s_add_u32 s28, s28, s49
s_and_b32 s29, s29, 4
v_mfma_f32_16x16x32_bf16 v[100:103], a[64:67], a[112:115], v[100:103]
ds_read_b64_tr_b16 a[92:93], v222 offset:27656
ds_read_b64_tr_b16 a[94:95], v222 offset:32264
v_mfma_f32_16x16x32_bf16 v[92:95], a[64:67], a[96:99], v[92:95]
s_add_u32 s86, s28, 8192
s_lshl_b32 s29, s29, 10
v_mfma_f32_16x16x32_bf16 v[84:87], a[64:67], a[208:211], v[84:87]
s_add_u32 s70, s28, s29
v_mfma_f32_16x16x32_bf16 v[76:79], a[64:67], a[192:195], v[76:79]
s_add_u32 s28, s32, 7
s_and_b32 s28, s28, 7
v_mfma_f32_16x16x32_bf16 v[76:79], a[68:71], a[196:199], v[76:79]
ds_read_b64_tr_b16 a[64:65], v220 offset:0
STUB_15:
s_cbranch_execz STUB_18
ds_read_b64_tr_b16 a[66:67], v220 offset:4608
v_mfma_f32_16x16x32_bf16 v[84:87], a[68:71], a[244:247], v[84:87]
s_xor_b32 s29, s28, s32
s_lshl_b32 s28, s28, 18
v_mfma_f32_16x16x32_bf16 v[92:95], a[68:71], a[100:103], v[92:95]
s_add_u32 s28, s28, s49
s_and_b32 s29, s29, 4
v_mfma_f32_16x16x32_bf16 v[100:103], a[68:71], a[116:119], v[100:103]
s_add_u32 s87, s28, 0
s_lshl_b32 s29, s29, 10
s_waitcnt lgkmcnt(8)
v_mfma_f32_16x16x32_bf16 v[100:103], a[72:75], a[120:123], v[100:103]
ds_read_b64_tr_b16 a[68:69], v220 offset:9216
ds_read_b64_tr_b16 a[70:71], v220 offset:13824
v_mfma_f32_16x16x32_bf16 v[92:95], a[72:75], a[104:107], v[92:95]
s_add_u32 s71, s28, s29
v_mfma_f32_16x16x32_bf16 v[84:87], a[72:75], a[248:251], v[84:87]
s_waitcnt vmcnt(0)
v_cmp_gt_u32 vcc, 2, v230
v_mfma_f32_16x16x32_bf16 v[76:79], a[72:75], a[200:203], v[76:79]
v_exp_f32 v59, v59
v_mfma_f32_16x16x32_bf16 v[76:79], a[76:79], a[204:207], v[76:79]
ds_read_b64_tr_b16 a[72:73], v220 offset:18432
ds_read_b64_tr_b16 a[74:75], v220 offset:23040
v_mfma_f32_16x16x32_bf16 v[84:87], a[76:79], a[252:255], v[84:87]
s_and_b32 s29, vcc_lo, 15
s_cbranch_scc1 SP_O3A
SP_O3A_RET:
v_mfma_f32_16x16x32_bf16 v[92:95], a[76:79], a[108:111], v[92:95]
s_add_u32 s39, s44, 8192
v_add_f32 v58, 1.0, v58
v_mfma_f32_16x16x32_bf16 v[100:103], a[76:79], a[124:127], v[100:103]
v_cvt_pk_bf16_f32 v200, v200, v201
v_cvt_pk_bf16_f32 v201, v202, v203
v_mfma_f32_16x16x32_bf16 v[100:103], a[80:83], a[48:51], v[100:103]
ds_read_b64_tr_b16 a[76:77], v220 offset:27648
ds_read_b64_tr_b16 a[78:79], v220 offset:32256
v_mfma_f32_16x16x32_bf16 v[92:95], a[80:83], a[32:35], v[92:95]
buffer_store_dwordx2 v[200:201], v226, s[20:23], s44 offen offset:0
v_mfma_f32_16x16x32_bf16 v[84:87], a[80:83], a[16:19], v[84:87]
v_cvt_pk_bf16_f32 v204, v204, v205
v_cvt_pk_bf16_f32 v205, v206, v207
v_mfma_f32_16x16x32_bf16 v[76:79], a[80:83], a[0:3], v[76:79]
buffer_store_dwordx2 v[204:205], v226, s[20:23], s44 offen offset:512
s_waitcnt lgkmcnt(8)
v_mfma_f32_16x16x32_bf16 v[76:79], a[84:87], a[4:7], v[76:79]
ds_read_b64_tr_b16 a[80:81], v223 offset:0
ds_read_b64_tr_b16 a[82:83], v223 offset:4608
v_mfma_f32_16x16x32_bf16 v[84:87], a[84:87], a[20:23], v[84:87]
v_cvt_pk_bf16_f32 v208, v208, v209
v_cvt_pk_bf16_f32 v209, v210, v211
v_mfma_f32_16x16x32_bf16 v[92:95], a[84:87], a[36:39], v[92:95]
buffer_store_dwordx2 v[208:209], v226, s[20:23], s39 offen offset:0
v_mfma_f32_16x16x32_bf16 v[100:103], a[84:87], a[52:55], v[100:103]
v_cvt_pk_bf16_f32 v212, v212, v213
v_cvt_pk_bf16_f32 v213, v214, v215
v_mfma_f32_16x16x32_bf16 v[100:103], a[88:91], a[56:59], v[100:103]
ds_read_b64_tr_b16 a[84:85], v223 offset:9216
ds_read_b64_tr_b16 a[86:87], v223 offset:13824
v_mfma_f32_16x16x32_bf16 v[92:95], a[88:91], a[40:43], v[92:95]
buffer_store_dwordx2 v[212:213], v226, s[20:23], s39 offen offset:512
v_mfma_f32_16x16x32_bf16 v[84:87], a[88:91], a[24:27], v[84:87]
v_add_f32 v59, 1.0, v59
v_mfma_f32_16x16x32_bf16 v[76:79], a[88:91], a[8:11], v[76:79]
v_rcp_f32 v58, v58
v_mfma_f32_16x16x32_bf16 v[76:79], a[92:95], a[12:15], v[76:79]
ds_read_b64_tr_b16 a[88:89], v223 offset:18432
ds_read_b64_tr_b16 a[90:91], v223 offset:23040
v_mfma_f32_16x16x32_bf16 v[84:87], a[92:95], a[28:31], v[84:87]
v_rcp_f32 v59, v59
v_mfma_f32_16x16x32_bf16 v[92:95], a[92:95], a[44:47], v[92:95]
v_mul_f32 v48, v48, v58
v_mul_f32 v49, v49, v59
v_mfma_f32_16x16x32_bf16 v[100:103], a[92:95], a[60:63], v[100:103]
v_cvt_pk_bf16_f32 v58, v48, v49
v_lshlrev_b32 v48, 16, v58
s_waitcnt lgkmcnt(8)
v_mfma_f32_16x16x32_bf16 v[128:131], a[64:67], a[112:115], v[128:131]
ds_read_b64_tr_b16 a[92:93], v223 offset:27648
ds_read_b64_tr_b16 a[94:95], v223 offset:32256
v_mfma_f32_16x16x32_bf16 v[120:123], a[64:67], a[96:99], v[120:123]
v_and_b32 v49, 0xffff0000, v58
v_accvgpr_read_b32 v51, a228
v_mfma_f32_16x16x32_bf16 v[112:115], a[64:67], a[208:211], v[112:115]
v_accvgpr_read_b32 v59, a238
v_lshlrev_b32 v50, 16, v51
v_mfma_f32_16x16x32_bf16 v[104:107], a[64:67], a[192:195], v[104:107]
v_and_b32 v51, 0xffff0000, v51
v_lshlrev_b32 v58, 16, v59
v_mfma_f32_16x16x32_bf16 v[104:107], a[68:71], a[196:199], v[104:107]
ds_read_b64_tr_b16 a[64:65], v220 offset:8
ds_read_b64_tr_b16 a[66:67], v220 offset:4616
v_mfma_f32_16x16x32_bf16 v[112:115], a[68:71], a[244:247], v[112:115]
v_and_b32 v59, 0xffff0000, v59
v_add_f32 v50, v50, v58
v_mfma_f32_16x16x32_bf16 v[120:123], a[68:71], a[100:103], v[120:123]
v_add_f32 v51, v51, v59
v_cvt_pk_bf16_f32 v58, v50, v51
v_mfma_f32_16x16x32_bf16 v[128:131], a[68:71], a[116:119], v[128:131]
v_lshlrev_b32 v50, 16, v58
v_and_b32 v51, 0xffff0000, v58
v_mfma_f32_16x16x32_bf16 v[128:131], a[72:75], a[120:123], v[128:131]
ds_read_b64_tr_b16 a[68:69], v220 offset:9224
ds_read_b64_tr_b16 a[70:71], v220 offset:13832
v_mfma_f32_16x16x32_bf16 v[120:123], a[72:75], a[104:107], v[120:123]
s_add_u32 s39, s44, 0
v_mul_f32 v58, 0xbfb8aa3b, v50
v_mfma_f32_16x16x32_bf16 v[112:115], a[72:75], a[248:251], v[112:115]
v_cvt_pk_bf16_f32 v80, v80, v81
v_cvt_pk_bf16_f32 v81, v82, v83
v_mfma_f32_16x16x32_bf16 v[104:107], a[72:75], a[200:203], v[104:107]
v_cvt_pk_bf16_f32 v82, v84, v85
v_cvt_pk_bf16_f32 v83, v86, v87
s_waitcnt lgkmcnt(8)
v_mfma_f32_16x16x32_bf16 v[104:107], a[76:79], a[204:207], v[104:107]
ds_read_b64_tr_b16 a[72:73], v220 offset:18440
ds_read_b64_tr_b16 a[74:75], v220 offset:23048
v_mfma_f32_16x16x32_bf16 v[112:115], a[76:79], a[252:255], v[112:115]
buffer_store_dwordx4 v[80:83], v244, s[20:23], s39 offen offset:1024
v_mfma_f32_16x16x32_bf16 v[120:123], a[76:79], a[108:111], v[120:123]
v_cvt_pk_bf16_f32 v88, v88, v89
v_cvt_pk_bf16_f32 v89, v90, v91
v_mfma_f32_16x16x32_bf16 v[128:131], a[76:79], a[124:127], v[128:131]
v_cvt_pk_bf16_f32 v90, v92, v93
v_cvt_pk_bf16_f32 v91, v94, v95
v_mfma_f32_16x16x32_bf16 v[128:131], a[80:83], a[48:51], v[128:131]
ds_read_b64_tr_b16 a[76:77], v220 offset:27656
ds_read_b64_tr_b16 a[78:79], v220 offset:32264
v_mfma_f32_16x16x32_bf16 v[120:123], a[80:83], a[32:35], v[120:123]
buffer_store_dwordx4 v[88:91], v244, s[20:23], s39 offen offset:2048
v_mfma_f32_16x16x32_bf16 v[112:115], a[80:83], a[16:19], v[112:115]
v_cvt_pk_bf16_f32 v96, v96, v97
v_cvt_pk_bf16_f32 v97, v98, v99
v_mfma_f32_16x16x32_bf16 v[104:107], a[80:83], a[0:3], v[104:107]
v_cvt_pk_bf16_f32 v98, v100, v101
v_cvt_pk_bf16_f32 v99, v102, v103
v_mfma_f32_16x16x32_bf16 v[104:107], a[84:87], a[4:7], v[104:107]
ds_read_b64_tr_b16 a[80:81], v223 offset:8
ds_read_b64_tr_b16 a[82:83], v223 offset:4616
v_mfma_f32_16x16x32_bf16 v[112:115], a[84:87], a[20:23], v[112:115]
buffer_store_dwordx4 v[96:99], v244, s[20:23], s39 offen offset:3072
v_mfma_f32_16x16x32_bf16 v[120:123], a[84:87], a[36:39], v[120:123]
v_mul_f32 v59, 0xbfb8aa3b, v51
v_mfma_f32_16x16x32_bf16 v[128:131], a[84:87], a[52:55], v[128:131]
v_exp_f32 v58, v58
s_waitcnt lgkmcnt(8)
v_mfma_f32_16x16x32_bf16 v[128:131], a[88:91], a[56:59], v[128:131]
ds_read_b64_tr_b16 a[84:85], v223 offset:9224
ds_read_b64_tr_b16 a[86:87], v223 offset:13832
v_mfma_f32_16x16x32_bf16 v[120:123], a[88:91], a[40:43], v[120:123]
v_exp_f32 v59, v59
v_mfma_f32_16x16x32_bf16 v[112:115], a[88:91], a[24:27], v[112:115]
v_add_f32 v58, 1.0, v58
v_add_f32 v59, 1.0, v59
v_mfma_f32_16x16x32_bf16 v[104:107], a[88:91], a[8:11], v[104:107]
v_rcp_f32 v58, v58
v_mfma_f32_16x16x32_bf16 v[104:107], a[92:95], a[12:15], v[104:107]
ds_read_b64_tr_b16 a[88:89], v223 offset:18440
ds_read_b64_tr_b16 a[90:91], v223 offset:23048
v_mfma_f32_16x16x32_bf16 v[112:115], a[92:95], a[28:31], v[112:115]
v_rcp_f32 v59, v59
v_mfma_f32_16x16x32_bf16 v[120:123], a[92:95], a[44:47], v[120:123]
v_mul_f32 v50, v50, v58
v_mul_f32 v51, v51, v59
v_mfma_f32_16x16x32_bf16 v[128:131], a[92:95], a[60:63], v[128:131]
v_cvt_pk_bf16_f32 v58, v50, v51
v_lshlrev_b32 v50, 16, v58
v_mfma_f32_16x16x32_bf16 v[132:135], a[64:67], a[112:115], v[132:135]
ds_read_b64_tr_b16 a[92:93], v223 offset:27656
ds_read_b64_tr_b16 a[94:95], v223 offset:32264
v_mfma_f32_16x16x32_bf16 v[124:127], a[64:67], a[96:99], v[124:127]
v_and_b32 v51, 0xffff0000, v58
v_accvgpr_read_b32 v53, a229
v_mfma_f32_16x16x32_bf16 v[116:119], a[64:67], a[208:211], v[116:119]
v_accvgpr_read_b32 v59, a239
v_lshlrev_b32 v52, 16, v53
v_mfma_f32_16x16x32_bf16 v[108:111], a[64:67], a[192:195], v[108:111]
v_and_b32 v53, 0xffff0000, v53
v_lshlrev_b32 v58, 16, v59
s_waitcnt lgkmcnt(8)
v_mfma_f32_16x16x32_bf16 v[108:111], a[68:71], a[196:199], v[108:111]
ds_read_b64_tr_b16 a[64:65], v219 offset:128
ds_read_b64_tr_b16 a[66:67], v219 offset:4736
v_mfma_f32_16x16x32_bf16 v[116:119], a[68:71], a[244:247], v[116:119]
v_and_b32 v59, 0xffff0000, v59
v_add_f32 v52, v52, v58
v_mfma_f32_16x16x32_bf16 v[124:127], a[68:71], a[100:103], v[124:127]
v_add_f32 v53, v53, v59
v_cvt_pk_bf16_f32 v58, v52, v53
v_mfma_f32_16x16x32_bf16 v[132:135], a[68:71], a[116:119], v[132:135]
v_lshlrev_b32 v52, 16, v58
v_and_b32 v53, 0xffff0000, v58
v_mfma_f32_16x16x32_bf16 v[132:135], a[72:75], a[120:123], v[132:135]
ds_read_b64_tr_b16 a[68:69], v219 offset:9344
ds_read_b64_tr_b16 a[70:71], v219 offset:13952
v_mfma_f32_16x16x32_bf16 v[124:127], a[72:75], a[104:107], v[124:127]
v_mul_f32 v58, 0xbfb8aa3b, v52
v_mul_f32 v59, 0xbfb8aa3b, v53
v_mfma_f32_16x16x32_bf16 v[116:119], a[72:75], a[248:251], v[116:119]
v_exp_f32 v58, v58
v_mfma_f32_16x16x32_bf16 v[108:111], a[72:75], a[200:203], v[108:111]
v_exp_f32 v59, v59
v_mfma_f32_16x16x32_bf16 v[108:111], a[76:79], a[204:207], v[108:111]
ds_read_b64_tr_b16 a[72:73], v219 offset:18560
ds_read_b64_tr_b16 a[74:75], v219 offset:23168
v_mfma_f32_16x16x32_bf16 v[116:119], a[76:79], a[252:255], v[116:119]
v_add_f32 v58, 1.0, v58
v_add_f32 v59, 1.0, v59
v_mfma_f32_16x16x32_bf16 v[124:127], a[76:79], a[108:111], v[124:127]
v_rcp_f32 v58, v58
v_mfma_f32_16x16x32_bf16 v[132:135], a[76:79], a[124:127], v[132:135]
v_rcp_f32 v59, v59
s_waitcnt lgkmcnt(8)
v_mfma_f32_16x16x32_bf16 v[132:135], a[80:83], a[48:51], v[132:135]
ds_read_b64_tr_b16 a[76:77], v219 offset:27776
ds_read_b64_tr_b16 a[78:79], v219 offset:32384
v_mfma_f32_16x16x32_bf16 v[124:127], a[80:83], a[32:35], v[124:127]
v_mul_f32 v52, v52, v58
v_mul_f32 v53, v53, v59
v_mfma_f32_16x16x32_bf16 v[116:119], a[80:83], a[16:19], v[116:119]
v_cvt_pk_bf16_f32 v58, v52, v53
v_lshlrev_b32 v52, 16, v58
v_mfma_f32_16x16x32_bf16 v[108:111], a[80:83], a[0:3], v[108:111]
v_and_b32 v53, 0xffff0000, v58
v_accvgpr_read_b32 v55, a230
v_mfma_f32_16x16x32_bf16 v[108:111], a[84:87], a[4:7], v[108:111]
ds_read_b64_tr_b16 a[80:81], v222 offset:128
ds_read_b64_tr_b16 a[82:83], v222 offset:4736
v_mfma_f32_16x16x32_bf16 v[116:119], a[84:87], a[20:23], v[116:119]
v_accvgpr_read_b32 v59, a240
v_lshlrev_b32 v54, 16, v55
v_mfma_f32_16x16x32_bf16 v[124:127], a[84:87], a[36:39], v[124:127]
v_and_b32 v55, 0xffff0000, v55
v_lshlrev_b32 v58, 16, v59
v_mfma_f32_16x16x32_bf16 v[132:135], a[84:87], a[52:55], v[132:135]
v_and_b32 v59, 0xffff0000, v59
v_add_f32 v54, v54, v58
v_mfma_f32_16x16x32_bf16 v[132:135], a[88:91], a[56:59], v[132:135]
ds_read_b64_tr_b16 a[84:85], v222 offset:9344
ds_read_b64_tr_b16 a[86:87], v222 offset:13952
v_mfma_f32_16x16x32_bf16 v[124:127], a[88:91], a[40:43], v[124:127]
v_add_f32 v55, v55, v59
v_cvt_pk_bf16_f32 v58, v54, v55
v_mfma_f32_16x16x32_bf16 v[116:119], a[88:91], a[24:27], v[116:119]
v_lshlrev_b32 v54, 16, v58
v_and_b32 v55, 0xffff0000, v58
v_mfma_f32_16x16x32_bf16 v[108:111], a[88:91], a[8:11], v[108:111]
v_mul_f32 v58, 0xbfb8aa3b, v54
v_mul_f32 v59, 0xbfb8aa3b, v55
s_waitcnt lgkmcnt(8)
v_mfma_f32_16x16x32_bf16 v[108:111], a[92:95], a[12:15], v[108:111]
ds_read_b64_tr_b16 a[88:89], v222 offset:18560
ds_read_b64_tr_b16 a[90:91], v222 offset:23168
v_mfma_f32_16x16x32_bf16 v[116:119], a[92:95], a[28:31], v[116:119]
v_exp_f32 v58, v58
v_mfma_f32_16x16x32_bf16 v[124:127], a[92:95], a[44:47], v[124:127]
v_exp_f32 v59, v59
v_mfma_f32_16x16x32_bf16 v[132:135], a[92:95], a[60:63], v[132:135]
v_add_f32 v58, 1.0, v58
v_add_f32 v59, 1.0, v59
v_mfma_f32_16x16x32_bf16 v[160:163], a[64:67], a[112:115], v[160:163]
ds_read_b64_tr_b16 a[92:93], v222 offset:27776
ds_read_b64_tr_b16 a[94:95], v222 offset:32384
v_mfma_f32_16x16x32_bf16 v[152:155], a[64:67], a[96:99], v[152:155]
v_rcp_f32 v58, v58
v_mfma_f32_16x16x32_bf16 v[144:147], a[64:67], a[208:211], v[144:147]
v_rcp_f32 v59, v59
v_mfma_f32_16x16x32_bf16 v[136:139], a[64:67], a[192:195], v[136:139]
v_mul_f32 v54, v54, v58
v_mul_f32 v55, v55, v59
v_mfma_f32_16x16x32_bf16 v[136:139], a[68:71], a[196:199], v[136:139]
ds_read_b64_tr_b16 a[64:65], v219 offset:136
ds_read_b64_tr_b16 a[66:67], v219 offset:4744
v_mfma_f32_16x16x32_bf16 v[144:147], a[68:71], a[244:247], v[144:147]
v_cvt_pk_bf16_f32 v58, v54, v55
v_lshlrev_b32 v54, 16, v58
v_mfma_f32_16x16x32_bf16 v[152:155], a[68:71], a[100:103], v[152:155]
v_and_b32 v55, 0xffff0000, v58
v_accvgpr_read_b32 v57, a231
v_mfma_f32_16x16x32_bf16 v[160:163], a[68:71], a[116:119], v[160:163]
v_accvgpr_read_b32 v59, a241
v_lshlrev_b32 v56, 16, v57
s_waitcnt lgkmcnt(8)
v_mfma_f32_16x16x32_bf16 v[160:163], a[72:75], a[120:123], v[160:163]
ds_read_b64_tr_b16 a[68:69], v219 offset:9352
ds_read_b64_tr_b16 a[70:71], v219 offset:13960
v_mfma_f32_16x16x32_bf16 v[152:155], a[72:75], a[104:107], v[152:155]
s_add_u32 s39, s44, 4096
v_and_b32 v57, 0xffff0000, v57
v_mfma_f32_16x16x32_bf16 v[144:147], a[72:75], a[248:251], v[144:147]
v_cvt_pk_bf16_f32 v104, v104, v105
v_cvt_pk_bf16_f32 v105, v106, v107
v_mfma_f32_16x16x32_bf16 v[136:139], a[72:75], a[200:203], v[136:139]
v_cvt_pk_bf16_f32 v106, v108, v109
v_cvt_pk_bf16_f32 v107, v110, v111
v_mfma_f32_16x16x32_bf16 v[136:139], a[76:79], a[204:207], v[136:139]
ds_read_b64_tr_b16 a[72:73], v219 offset:18568
ds_read_b64_tr_b16 a[74:75], v219 offset:23176
v_mfma_f32_16x16x32_bf16 v[144:147], a[76:79], a[252:255], v[144:147]
buffer_store_dwordx4 v[104:107], v244, s[20:23], s39 offen offset:0
v_mfma_f32_16x16x32_bf16 v[152:155], a[76:79], a[108:111], v[152:155]
v_cvt_pk_bf16_f32 v112, v112, v113
v_cvt_pk_bf16_f32 v113, v114, v115
v_mfma_f32_16x16x32_bf16 v[160:163], a[76:79], a[124:127], v[160:163]
v_cvt_pk_bf16_f32 v114, v116, v117
v_cvt_pk_bf16_f32 v115, v118, v119
v_mfma_f32_16x16x32_bf16 v[160:163], a[80:83], a[48:51], v[160:163]
ds_read_b64_tr_b16 a[76:77], v219 offset:27784
ds_read_b64_tr_b16 a[78:79], v219 offset:32392
v_mfma_f32_16x16x32_bf16 v[152:155], a[80:83], a[32:35], v[152:155]
buffer_store_dwordx4 v[112:115], v244, s[20:23], s39 offen offset:1024
v_mfma_f32_16x16x32_bf16 v[144:147], a[80:83], a[16:19], v[144:147]
v_cvt_pk_bf16_f32 v120, v120, v121
v_cvt_pk_bf16_f32 v121, v122, v123
v_mfma_f32_16x16x32_bf16 v[136:139], a[80:83], a[0:3], v[136:139]
v_cvt_pk_bf16_f32 v122, v124, v125
v_cvt_pk_bf16_f32 v123, v126, v127
s_waitcnt lgkmcnt(8)
v_mfma_f32_16x16x32_bf16 v[136:139], a[84:87], a[4:7], v[136:139]
ds_read_b64_tr_b16 a[80:81], v222 offset:136
ds_read_b64_tr_b16 a[82:83], v222 offset:4744
v_mfma_f32_16x16x32_bf16 v[144:147], a[84:87], a[20:23], v[144:147]
buffer_store_dwordx4 v[120:123], v244, s[20:23], s39 offen offset:2048
v_mfma_f32_16x16x32_bf16 v[152:155], a[84:87], a[36:39], v[152:155]
v_cvt_pk_bf16_f32 v128, v128, v129
v_cvt_pk_bf16_f32 v129, v130, v131
v_mfma_f32_16x16x32_bf16 v[160:163], a[84:87], a[52:55], v[160:163]
v_cvt_pk_bf16_f32 v130, v132, v133
v_cvt_pk_bf16_f32 v131, v134, v135
v_mfma_f32_16x16x32_bf16 v[160:163], a[88:91], a[56:59], v[160:163]
ds_read_b64_tr_b16 a[84:85], v222 offset:9352
ds_read_b64_tr_b16 a[86:87], v222 offset:13960
v_mfma_f32_16x16x32_bf16 v[152:155], a[88:91], a[40:43], v[152:155]
buffer_store_dwordx4 v[128:131], v244, s[20:23], s39 offen offset:3072
v_mfma_f32_16x16x32_bf16 v[144:147], a[88:91], a[24:27], v[144:147]
s_lshl2_add_u32 s28, s32, s95
v_lshlrev_b32 v58, 16, v59
v_mfma_f32_16x16x32_bf16 v[136:139], a[88:91], a[8:11], v[136:139]
v_and_b32 v59, 0xffff0000, v59
v_add_f32 v56, v56, v58
v_mfma_f32_16x16x32_bf16 v[136:139], a[92:95], a[12:15], v[136:139]
ds_read_b64_tr_b16 a[88:89], v222 offset:18568
ds_read_b64_tr_b16 a[90:91], v222 offset:23176
v_mfma_f32_16x16x32_bf16 v[144:147], a[92:95], a[28:31], v[144:147]
v_add_f32 v57, v57, v59
v_cvt_pk_bf16_f32 v58, v56, v57
v_mfma_f32_16x16x32_bf16 v[152:155], a[92:95], a[44:47], v[152:155]
v_lshlrev_b32 v56, 16, v58
v_and_b32 v57, 0xffff0000, v58
v_mfma_f32_16x16x32_bf16 v[160:163], a[92:95], a[60:63], v[160:163]
v_mul_f32 v58, 0xbfb8aa3b, v56
v_mul_f32 v59, 0xbfb8aa3b, v57
s_waitcnt lgkmcnt(8)
v_mfma_f32_16x16x32_bf16 v[164:167], a[64:67], a[112:115], v[164:167]
ds_read_b64_tr_b16 a[92:93], v222 offset:27784
ds_read_b64_tr_b16 a[94:95], v222 offset:32392
v_mfma_f32_16x16x32_bf16 v[156:159], a[64:67], a[96:99], v[156:159]
v_exp_f32 v58, v58
v_mfma_f32_16x16x32_bf16 v[148:151], a[64:67], a[208:211], v[148:151]
v_exp_f32 v59, v59
v_mfma_f32_16x16x32_bf16 v[140:143], a[64:67], a[192:195], v[140:143]
v_add_f32 v58, 1.0, v58
v_add_f32 v59, 1.0, v59
v_mfma_f32_16x16x32_bf16 v[140:143], a[68:71], a[196:199], v[140:143]
ds_read_b64_tr_b16 a[64:65], v220 offset:128
ds_read_b64_tr_b16 a[66:67], v220 offset:4736
v_mfma_f32_16x16x32_bf16 v[148:151], a[68:71], a[244:247], v[148:151]
v_rcp_f32 v58, v58
v_mfma_f32_16x16x32_bf16 v[156:159], a[68:71], a[100:103], v[156:159]
v_rcp_f32 v59, v59
v_mfma_f32_16x16x32_bf16 v[164:167], a[68:71], a[116:119], v[164:167]
v_mul_f32 v56, v56, v58
v_mul_f32 v57, v57, v59
v_mfma_f32_16x16x32_bf16 v[164:167], a[72:75], a[120:123], v[164:167]
ds_read_b64_tr_b16 a[68:69], v220 offset:9344
ds_read_b64_tr_b16 a[70:71], v220 offset:13952
v_mfma_f32_16x16x32_bf16 v[156:159], a[72:75], a[104:107], v[156:159]
v_cvt_pk_bf16_f32 v58, v56, v57
v_lshlrev_b32 v56, 16, v58
v_mfma_f32_16x16x32_bf16 v[148:151], a[72:75], a[248:251], v[148:151]
v_and_b32 v57, 0xffff0000, v58
v_accvgpr_read_b32 v19, a212
v_mfma_f32_16x16x32_bf16 v[140:143], a[72:75], a[200:203], v[140:143]
v_lshlrev_b32 v18, 16, v19
v_and_b32 v19, 0xffff0000, v19
s_waitcnt lgkmcnt(8)
v_mfma_f32_16x16x32_bf16 v[140:143], a[76:79], a[204:207], v[140:143]
ds_read_b64_tr_b16 a[72:73], v220 offset:18560
ds_read_b64_tr_b16 a[74:75], v220 offset:23168
v_mfma_f32_16x16x32_bf16 v[148:151], a[76:79], a[252:255], v[148:151]
v_accvgpr_read_b32 v21, a213
v_lshlrev_b32 v20, 16, v21
v_mfma_f32_16x16x32_bf16 v[156:159], a[76:79], a[108:111], v[156:159]
v_and_b32 v21, 0xffff0000, v21
v_accvgpr_read_b32 v23, a214
v_mfma_f32_16x16x32_bf16 v[164:167], a[76:79], a[124:127], v[164:167]
v_lshlrev_b32 v22, 16, v23
v_and_b32 v23, 0xffff0000, v23
v_mfma_f32_16x16x32_bf16 v[164:167], a[80:83], a[48:51], v[164:167]
ds_read_b64_tr_b16 a[76:77], v220 offset:27776
ds_read_b64_tr_b16 a[78:79], v220 offset:32384
v_mfma_f32_16x16x32_bf16 v[156:159], a[80:83], a[32:35], v[156:159]
v_accvgpr_read_b32 v25, a215
v_lshlrev_b32 v24, 16, v25
v_mfma_f32_16x16x32_bf16 v[148:151], a[80:83], a[16:19], v[148:151]
s_waitcnt vmcnt(0)
buffer_store_dword v231, v254, s[20:23], s28 offen
v_mfma_f32_16x16x32_bf16 v[140:143], a[80:83], a[0:3], v[140:143]
v_and_b32 v25, 0xffff0000, v25
v_accvgpr_read_b32 v27, a216
v_mfma_f32_16x16x32_bf16 v[140:143], a[84:87], a[4:7], v[140:143]
ds_read_b64_tr_b16 a[80:81], v223 offset:128
ds_read_b64_tr_b16 a[82:83], v223 offset:4736
v_mfma_f32_16x16x32_bf16 v[148:151], a[84:87], a[20:23], v[148:151]
v_lshlrev_b32 v26, 16, v27
v_and_b32 v27, 0xffff0000, v27
v_mfma_f32_16x16x32_bf16 v[156:159], a[84:87], a[36:39], v[156:159]
v_accvgpr_read_b32 v29, a217
v_lshlrev_b32 v28, 16, v29
v_mfma_f32_16x16x32_bf16 v[164:167], a[84:87], a[52:55], v[164:167]
v_and_b32 v29, 0xffff0000, v29
v_accvgpr_read_b32 v31, a218
s_waitcnt lgkmcnt(8)
v_mfma_f32_16x16x32_bf16 v[164:167], a[88:91], a[56:59], v[164:167]
ds_read_b64_tr_b16 a[84:85], v223 offset:9344
ds_read_b64_tr_b16 a[86:87], v223 offset:13952
v_mfma_f32_16x16x32_bf16 v[156:159], a[88:91], a[40:43], v[156:159]
v_lshlrev_b32 v30, 16, v31
v_and_b32 v31, 0xffff0000, v31
v_mfma_f32_16x16x32_bf16 v[148:151], a[88:91], a[24:27], v[148:151]
v_accvgpr_read_b32 v33, a219
v_lshlrev_b32 v32, 16, v33
v_mfma_f32_16x16x32_bf16 v[140:143], a[88:91], a[8:11], v[140:143]
v_and_b32 v33, 0xffff0000, v33
v_accvgpr_read_b32 v35, a220
v_mfma_f32_16x16x32_bf16 v[140:143], a[92:95], a[12:15], v[140:143]
ds_read_b64_tr_b16 a[88:89], v223 offset:18560
ds_read_b64_tr_b16 a[90:91], v223 offset:23168
v_mfma_f32_16x16x32_bf16 v[148:151], a[92:95], a[28:31], v[148:151]
v_lshlrev_b32 v34, 16, v35
v_and_b32 v35, 0xffff0000, v35
v_mfma_f32_16x16x32_bf16 v[156:159], a[92:95], a[44:47], v[156:159]
v_accvgpr_read_b32 v37, a221
v_lshlrev_b32 v36, 16, v37
v_mfma_f32_16x16x32_bf16 v[164:167], a[92:95], a[60:63], v[164:167]
v_and_b32 v37, 0xffff0000, v37
v_mfma_f32_16x16x32_bf16 v[192:195], a[64:67], a[112:115], v[192:195]
ds_read_b64_tr_b16 a[92:93], v223 offset:27776
ds_read_b64_tr_b16 a[94:95], v223 offset:32384
v_mfma_f32_16x16x32_bf16 v[184:187], a[64:67], a[96:99], v[184:187]
s_mov_b32 s90, 0x3f80
s_mov_b32 s91, 0x3f800000
v_mfma_f32_16x16x32_bf16 v[176:179], a[64:67], a[208:211], v[176:179]
v_mov_b32 v66, 0
v_mov_b32 v67, 0
v_mfma_f32_16x16x32_bf16 v[168:171], a[64:67], a[192:195], v[168:171]
v_mov_b32 v68, 0
v_mov_b32 v69, 0
s_waitcnt lgkmcnt(8)
v_mfma_f32_16x16x32_bf16 v[168:171], a[68:71], a[196:199], v[168:171]
ds_read_b64_tr_b16 a[64:65], v220 offset:136
ds_read_b64_tr_b16 a[66:67], v220 offset:4744
v_mfma_f32_16x16x32_bf16 v[176:179], a[68:71], a[244:247], v[176:179]
v_mfma_f32_16x16x32_bf16 v[184:187], a[68:71], a[100:103], v[184:187]
v_mfma_f32_16x16x32_bf16 v[192:195], a[68:71], a[116:119], v[192:195]
v_mfma_f32_16x16x32_bf16 v[192:195], a[72:75], a[120:123], v[192:195]
ds_read_b64_tr_b16 a[68:69], v220 offset:9352
ds_read_b64_tr_b16 a[70:71], v220 offset:13960
v_mfma_f32_16x16x32_bf16 v[184:187], a[72:75], a[104:107], v[184:187]
s_add_u32 s39, s44, 8192
v_mfma_f32_16x16x32_bf16 v[176:179], a[72:75], a[248:251], v[176:179]
v_cvt_pk_bf16_f32 v144, v144, v145
v_cvt_pk_bf16_f32 v145, v146, v147
v_mfma_f32_16x16x32_bf16 v[168:171], a[72:75], a[200:203], v[168:171]
v_cvt_pk_bf16_f32 v146, v148, v149
v_cvt_pk_bf16_f32 v147, v150, v151
v_mfma_f32_16x16x32_bf16 v[168:171], a[76:79], a[204:207], v[168:171]
ds_read_b64_tr_b16 a[72:73], v220 offset:18568
ds_read_b64_tr_b16 a[74:75], v220 offset:23176
v_mfma_f32_16x16x32_bf16 v[176:179], a[76:79], a[252:255], v[176:179]
buffer_store_dwordx4 v[144:147], v244, s[20:23], s39 offen offset:1024
v_mfma_f32_16x16x32_bf16 v[184:187], a[76:79], a[108:111], v[184:187]
v_cvt_pk_bf16_f32 v152, v152, v153
v_cvt_pk_bf16_f32 v153, v154, v155
v_mfma_f32_16x16x32_bf16 v[192:195], a[76:79], a[124:127], v[192:195]
v_cvt_pk_bf16_f32 v154, v156, v157
v_cvt_pk_bf16_f32 v155, v158, v159
s_waitcnt lgkmcnt(8)
v_mfma_f32_16x16x32_bf16 v[192:195], a[80:83], a[48:51], v[192:195]
ds_read_b64_tr_b16 a[76:77], v220 offset:27784
ds_read_b64_tr_b16 a[78:79], v220 offset:32392
v_mfma_f32_16x16x32_bf16 v[184:187], a[80:83], a[32:35], v[184:187]
buffer_store_dwordx4 v[152:155], v244, s[20:23], s39 offen offset:2048
v_mfma_f32_16x16x32_bf16 v[176:179], a[80:83], a[16:19], v[176:179]
v_cvt_pk_bf16_f32 v160, v160, v161
v_cvt_pk_bf16_f32 v161, v162, v163
v_mfma_f32_16x16x32_bf16 v[168:171], a[80:83], a[0:3], v[168:171]
v_cvt_pk_bf16_f32 v162, v164, v165
v_cvt_pk_bf16_f32 v163, v166, v167
v_mfma_f32_16x16x32_bf16 v[168:171], a[84:87], a[4:7], v[168:171]
ds_read_b64_tr_b16 a[80:81], v223 offset:136
ds_read_b64_tr_b16 a[82:83], v223 offset:4744
v_mfma_f32_16x16x32_bf16 v[176:179], a[84:87], a[20:23], v[176:179]
buffer_store_dwordx4 v[160:163], v244, s[20:23], s39 offen offset:3072
v_mfma_f32_16x16x32_bf16 v[184:187], a[84:87], a[36:39], v[184:187]
buffer_load_dword v230, v229, s[20:23], s95 offen sc0 sc1
v_mfma_f32_16x16x32_bf16 v[192:195], a[84:87], a[52:55], v[192:195]
v_mfma_f32_16x16x32_bf16 v[192:195], a[88:91], a[56:59], v[192:195]
ds_read_b64_tr_b16 a[84:85], v223 offset:9352
ds_read_b64_tr_b16 a[86:87], v223 offset:13960
v_mfma_f32_16x16x32_bf16 v[184:187], a[88:91], a[40:43], v[184:187]
v_mfma_f32_16x16x32_bf16 v[176:179], a[88:91], a[24:27], v[176:179]
v_mfma_f32_16x16x32_bf16 v[168:171], a[88:91], a[8:11], v[168:171]
s_waitcnt lgkmcnt(8)
v_mfma_f32_16x16x32_bf16 v[168:171], a[92:95], a[12:15], v[168:171]
ds_read_b64_tr_b16 a[88:89], v223 offset:18568
ds_read_b64_tr_b16 a[90:91], v223 offset:23176
v_mfma_f32_16x16x32_bf16 v[176:179], a[92:95], a[28:31], v[176:179]
v_mfma_f32_16x16x32_bf16 v[184:187], a[92:95], a[44:47], v[184:187]
v_mfma_f32_16x16x32_bf16 v[192:195], a[92:95], a[60:63], v[192:195]
v_mfma_f32_16x16x32_bf16 v[196:199], a[64:67], a[112:115], v[196:199]
ds_read_b64_tr_b16 a[92:93], v223 offset:27784
ds_read_b64_tr_b16 a[94:95], v223 offset:32392
v_mfma_f32_16x16x32_bf16 v[188:191], a[64:67], a[96:99], v[188:191]
v_mfma_f32_16x16x32_bf16 v[180:183], a[64:67], a[208:211], v[180:183]
v_mfma_f32_16x16x32_bf16 v[172:175], a[64:67], a[192:195], v[172:175]
v_mfma_f32_16x16x32_bf16 v[172:175], a[68:71], a[196:199], v[172:175]
v_mfma_f32_16x16x32_bf16 v[180:183], a[68:71], a[244:247], v[180:183]
v_mfma_f32_16x16x32_bf16 v[188:191], a[68:71], a[100:103], v[188:191]
v_mfma_f32_16x16x32_bf16 v[196:199], a[68:71], a[116:119], v[196:199]
s_waitcnt lgkmcnt(8)
v_mfma_f32_16x16x32_bf16 v[196:199], a[72:75], a[120:123], v[196:199]
v_mfma_f32_16x16x32_bf16 v[188:191], a[72:75], a[104:107], v[188:191]
v_mfma_f32_16x16x32_bf16 v[180:183], a[72:75], a[248:251], v[180:183]
v_mfma_f32_16x16x32_bf16 v[172:175], a[72:75], a[200:203], v[172:175]
v_mfma_f32_16x16x32_bf16 v[172:175], a[76:79], a[204:207], v[172:175]
v_mfma_f32_16x16x32_bf16 v[180:183], a[76:79], a[252:255], v[180:183]
v_mfma_f32_16x16x32_bf16 v[188:191], a[76:79], a[108:111], v[188:191]
s_waitcnt vmcnt(0)
v_cmp_gt_u32 vcc, 1, v230
v_mfma_f32_16x16x32_bf16 v[196:199], a[76:79], a[124:127], v[196:199]
s_waitcnt lgkmcnt(6)
v_mfma_f32_16x16x32_bf16 v[196:199], a[80:83], a[48:51], v[196:199]
s_and_b32 s29, vcc_lo, 0xff
s_cbranch_scc1 SP_P1A
SP_P1A_RET:
v_mfma_f32_16x16x32_bf16 v[188:191], a[80:83], a[32:35], v[188:191]
buffer_load_dwordx4 v[104:107], v244, s[20:23], s65 offen offset:3072 sc0 sc1
v_mfma_f32_16x16x32_bf16 v[180:183], a[80:83], a[16:19], v[180:183]
buffer_load_dwordx4 v[108:111], v244, s[20:23], s66 offen offset:2048 sc0 sc1
v_mfma_f32_16x16x32_bf16 v[172:175], a[80:83], a[0:3], v[172:175]
buffer_load_dwordx4 v[112:115], v244, s[20:23], s67 offen offset:1024 sc0 sc1
s_waitcnt lgkmcnt(4)
v_mfma_f32_16x16x32_bf16 v[172:175], a[84:87], a[4:7], v[172:175]
buffer_load_dwordx4 v[116:119], v244, s[20:23], s68 offen offset:0 sc0 sc1
v_mfma_f32_16x16x32_bf16 v[180:183], a[84:87], a[20:23], v[180:183]
buffer_load_dwordx4 v[120:123], v244, s[20:23], s69 offen offset:3072 sc0 sc1
v_mfma_f32_16x16x32_bf16 v[188:191], a[84:87], a[36:39], v[188:191]
buffer_load_dwordx4 v[124:127], v244, s[20:23], s70 offen offset:2048 sc0 sc1
v_mfma_f32_16x16x32_bf16 v[196:199], a[84:87], a[52:55], v[196:199]
buffer_load_dwordx4 v[128:131], v244, s[20:23], s71 offen offset:1024 sc0 sc1
s_waitcnt lgkmcnt(2)
v_mfma_f32_16x16x32_bf16 v[196:199], a[88:91], a[56:59], v[196:199]
v_mfma_f32_16x16x32_bf16 v[188:191], a[88:91], a[40:43], v[188:191]
v_mfma_f32_16x16x32_bf16 v[180:183], a[88:91], a[24:27], v[180:183]
v_mfma_f32_16x16x32_bf16 v[172:175], a[88:91], a[8:11], v[172:175]
s_waitcnt lgkmcnt(0)
v_mfma_f32_16x16x32_bf16 v[172:175], a[92:95], a[12:15], v[172:175]
v_mfma_f32_16x16x32_bf16 v[180:183], a[92:95], a[28:31], v[180:183]
v_mfma_f32_16x16x32_bf16 v[188:191], a[92:95], a[44:47], v[188:191]
v_mfma_f32_16x16x32_bf16 v[196:199], a[92:95], a[60:63], v[196:199]
s_add_u32 s39, s44, 12288
STUB_16:
s_cbranch_execz HOP_RET2
s_nop 5
v_cvt_pk_bf16_f32 v168, v168, v169
v_cvt_pk_bf16_f32 v169, v170, v171
v_cvt_pk_bf16_f32 v170, v172, v173
v_cvt_pk_bf16_f32 v171, v174, v175
buffer_store_dwordx4 v[168:171], v244, s[20:23], s39 offen offset:0
v_cvt_pk_bf16_f32 v176, v176, v177
v_cvt_pk_bf16_f32 v177, v178, v179
v_cvt_pk_bf16_f32 v178, v180, v181
v_cvt_pk_bf16_f32 v179, v182, v183
buffer_store_dwordx4 v[176:179], v244, s[20:23], s39 offen offset:1024
v_cvt_pk_bf16_f32 v184, v184, v185
v_cvt_pk_bf16_f32 v185, v186, v187
v_cvt_pk_bf16_f32 v186, v188, v189
v_cvt_pk_bf16_f32 v187, v190, v191
buffer_store_dwordx4 v[184:187], v244, s[20:23], s39 offen offset:2048
v_cvt_pk_bf16_f32 v192, v192, v193
v_cvt_pk_bf16_f32 v193, v194, v195
v_cvt_pk_bf16_f32 v194, v196, v197
v_cvt_pk_bf16_f32 v195, v198, v199
buffer_store_dwordx4 v[192:195], v244, s[20:23], s39 offen offset:3072
buffer_load_dwordx2 v[200:201], v226, s[20:23], s72 offen offset:0 sc0 sc1
buffer_load_dwordx2 v[202:203], v226, s[20:23], s73 offen offset:512 sc0 sc1
buffer_load_dwordx2 v[204:205], v226, s[20:23], s74 offen offset:0 sc0 sc1
buffer_load_dwordx2 v[206:207], v226, s[20:23], s75 offen offset:512 sc0 sc1
buffer_load_dwordx2 v[208:209], v226, s[20:23], s84 offen offset:0 sc0 sc1
buffer_load_dwordx2 v[210:211], v226, s[20:23], s85 offen offset:512 sc0 sc1
buffer_load_dwordx2 v[212:213], v226, s[20:23], s86 offen offset:0 sc0 sc1
buffer_load_dwordx2 v[214:215], v226, s[20:23], s87 offen offset:512 sc0 sc1
s_waitcnt vmcnt(8)
buffer_store_dword v246, v254, s[20:23], s28 offen
buffer_load_dword v230, v229, s[20:23], s95 offen sc0 sc1
s_waitcnt vmcnt(20)
v_dot2c_f32_bf16 v72, s90, v104
v_dot2c_f32_bf16 v73, s91, v104
v_dot2c_f32_bf16 v74, s90, v105
v_dot2c_f32_bf16 v75, s91, v105
v_dot2c_f32_bf16 v76, s90, v106
v_dot2c_f32_bf16 v77, s91, v106
v_dot2c_f32_bf16 v78, s90, v107
v_dot2c_f32_bf16 v79, s91, v107
s_waitcnt vmcnt(19)
v_dot2c_f32_bf16 v72, s90, v108
v_dot2c_f32_bf16 v73, s91, v108
v_dot2c_f32_bf16 v74, s90, v109
v_dot2c_f32_bf16 v75, s91, v109
v_dot2c_f32_bf16 v76, s90, v110
v_dot2c_f32_bf16 v77, s91, v110
v_dot2c_f32_bf16 v78, s90, v111
v_dot2c_f32_bf16 v79, s91, v111
s_waitcnt vmcnt(18)
v_dot2c_f32_bf16 v72, s90, v112
v_dot2c_f32_bf16 v73, s91, v112
v_dot2c_f32_bf16 v74, s90, v113
v_dot2c_f32_bf16 v75, s91, v113
v_dot2c_f32_bf16 v76, s90, v114
v_dot2c_f32_bf16 v77, s91, v114
v_dot2c_f32_bf16 v78, s90, v115
v_dot2c_f32_bf16 v79, s91, v115
s_waitcnt vmcnt(17)
v_dot2c_f32_bf16 v72, s90, v116
v_dot2c_f32_bf16 v73, s91, v116
v_dot2c_f32_bf16 v74, s90, v117
v_dot2c_f32_bf16 v75, s91, v117
v_dot2c_f32_bf16 v76, s90, v118
v_dot2c_f32_bf16 v77, s91, v118
v_dot2c_f32_bf16 v78, s90, v119
v_dot2c_f32_bf16 v79, s91, v119
s_waitcnt vmcnt(16)
v_dot2c_f32_bf16 v72, s90, v120
v_dot2c_f32_bf16 v73, s91, v120
v_dot2c_f32_bf16 v74, s90, v121
v_dot2c_f32_bf16 v75, s91, v121
v_dot2c_f32_bf16 v76, s90, v122
v_dot2c_f32_bf16 v77, s91, v122
v_dot2c_f32_bf16 v78, s90, v123
v_dot2c_f32_bf16 v79, s91, v123
s_waitcnt vmcnt(15)
v_dot2c_f32_bf16 v72, s90, v124
v_dot2c_f32_bf16 v73, s91, v124
v_dot2c_f32_bf16 v74, s90, v125
v_dot2c_f32_bf16 v75, s91, v125
v_dot2c_f32_bf16 v76, s90, v126
v_dot2c_f32_bf16 v77, s91, v126
v_dot2c_f32_bf16 v78, s90, v127
v_dot2c_f32_bf16 v79, s91, v127
s_waitcnt vmcnt(14)
v_dot2c_f32_bf16 v72, s90, v128
v_dot2c_f32_bf16 v73, s91, v128
v_dot2c_f32_bf16 v74, s90, v129
v_dot2c_f32_bf16 v75, s91, v129
v_dot2c_f32_bf16 v76, s90, v130
v_dot2c_f32_bf16 v77, s91, v130
v_dot2c_f32_bf16 v78, s90, v131
v_dot2c_f32_bf16 v79, s91, v131
s_nop 2
v_cvt_pk_bf16_f32 v58, v72, v73
v_cvt_pk_bf16_f32 v59, v74, v75
v_cvt_pk_bf16_f32 v60, v76, v77
v_cvt_pk_bf16_f32 v61, v78, v79
v_lshlrev_b32 v72, 16, v58
v_and_b32 v73, 0xffff0000, v58
v_lshlrev_b32 v74, 16, v59
v_and_b32 v75, 0xffff0000, v59
v_lshlrev_b32 v76, 16, v60
v_and_b32 v77, 0xffff0000, v60
v_lshlrev_b32 v78, 16, v61
v_and_b32 v79, 0xffff0000, v61
v_pk_mul_f32 v[72:73], v[72:73], v[38:39]
v_pk_mul_f32 v[74:75], v[74:75], v[40:41]
v_pk_mul_f32 v[76:77], v[76:77], v[42:43]
v_pk_mul_f32 v[78:79], v[78:79], v[44:45]
v_cvt_pk_bf16_f32 v58, v72, v73
v_cvt_pk_bf16_f32 v59, v74, v75
v_cvt_pk_bf16_f32 v60, v76, v77
v_cvt_pk_bf16_f32 v61, v78, v79
v_lshlrev_b32 v72, 16, v58
v_and_b32 v73, 0xffff0000, v58
v_lshlrev_b32 v74, 16, v59
v_and_b32 v75, 0xffff0000, v59
v_lshlrev_b32 v76, 16, v60
v_and_b32 v77, 0xffff0000, v60
v_lshlrev_b32 v78, 16, v61
v_and_b32 v79, 0xffff0000, v61
v_pk_add_f32 v[72:73], v[72:73], v[18:19]
v_pk_add_f32 v[74:75], v[74:75], v[20:21]
v_pk_add_f32 v[76:77], v[76:77], v[22:23]
v_pk_add_f32 v[78:79], v[78:79], v[24:25]
v_cvt_pk_bf16_f32 v72, v72, v73
v_cvt_pk_bf16_f32 v73, v74, v75
v_cvt_pk_bf16_f32 v74, v76, v77
v_cvt_pk_bf16_f32 v75, v78, v79
buffer_store_dwordx4 v[72:75], v248, s[60:63], 0 offen
s_waitcnt vmcnt(1)
v_cmp_gt_u32 vcc, 2, v230
s_nop 0
s_and_b32 s29, vcc_lo, 0xff
s_cbranch_scc0 SP_P2A_RET
SP_P2A:
s_sleep 0
s_add_u32 s100, s100, 1
s_bitcmp1_b32 s100, 19
s_cbranch_scc1 K_END
buffer_load_dword v230, v229, s[20:23], s95 offen sc0 sc1
s_waitcnt vmcnt(0)
v_cmp_gt_u32 vcc, 2, v230
s_nop 0
s_and_b32 s29, vcc_lo, 0xff
s_cbranch_scc1 SP_P2A
SP_P2A_RET:
buffer_load_dwordx4 v[80:83], v243, s[20:23], s65 offen offset:3072 sc0 sc1
buffer_load_dwordx4 v[84:87], v243, s[20:23], s66 offen offset:2048 sc0 sc1
buffer_load_dwordx4 v[88:91], v243, s[20:23], s67 offen offset:1024 sc0 sc1
buffer_load_dwordx4 v[92:95], v243, s[20:23], s68 offen offset:0 sc0 sc1
buffer_load_dwordx4 v[96:99], v243, s[20:23], s69 offen offset:3072 sc0 sc1
buffer_load_dwordx4 v[100:103], v243, s[20:23], s70 offen offset:2048 sc0 sc1
buffer_load_dwordx4 v[132:135], v243, s[20:23], s71 offen offset:1024 sc0 sc1
s_waitcnt vmcnt(17)
v_dot2c_f32_bf16 v66, s90, v200
v_dot2c_f32_bf16 v67, s91, v200
v_dot2c_f32_bf16 v68, s90, v201
v_dot2c_f32_bf16 v69, s91, v201
s_waitcnt vmcnt(16)
v_dot2c_f32_bf16 v66, s90, v202
v_dot2c_f32_bf16 v67, s91, v202
v_dot2c_f32_bf16 v68, s90, v203
v_dot2c_f32_bf16 v69, s91, v203
s_waitcnt vmcnt(15)
v_dot2c_f32_bf16 v66, s90, v204
v_dot2c_f32_bf16 v67, s91, v204
v_dot2c_f32_bf16 v68, s90, v205
v_dot2c_f32_bf16 v69, s91, v205
s_waitcnt vmcnt(14)
v_dot2c_f32_bf16 v66, s90, v206
v_dot2c_f32_bf16 v67, s91, v206
v_dot2c_f32_bf16 v68, s90, v207
v_dot2c_f32_bf16 v69, s91, v207
s_waitcnt vmcnt(13)
v_dot2c_f32_bf16 v66, s90, v208
v_dot2c_f32_bf16 v67, s91, v208
v_dot2c_f32_bf16 v68, s90, v209
v_dot2c_f32_bf16 v69, s91, v209
s_waitcnt vmcnt(12)
v_dot2c_f32_bf16 v66, s90, v210
v_dot2c_f32_bf16 v67, s91, v210
v_dot2c_f32_bf16 v68, s90, v211
v_dot2c_f32_bf16 v69, s91, v211
s_waitcnt vmcnt(11)
v_dot2c_f32_bf16 v66, s90, v212
v_dot2c_f32_bf16 v67, s91, v212
v_dot2c_f32_bf16 v68, s90, v213
v_dot2c_f32_bf16 v69, s91, v213
s_waitcnt vmcnt(10)
v_dot2c_f32_bf16 v66, s90, v214
v_dot2c_f32_bf16 v67, s91, v214
v_dot2c_f32_bf16 v68, s90, v215
v_dot2c_f32_bf16 v69, s91, v215
s_nop 2
s_cmp_eq_u32 s34, 0
s_cselect_b32 s29, 0, 0x7fbffff0
v_cvt_pk_bf16_f32 v58, v66, v67
v_cvt_pk_bf16_f32 v59, v68, v69
v_lshlrev_b32 v66, 16, v58
v_and_b32 v67, 0xffff0000, v58
v_lshlrev_b32 v68, 16, v59
v_and_b32 v69, 0xffff0000, v59
v_pk_mul_f32 v[66:67], v[66:67], v[54:55]
v_pk_mul_f32 v[68:69], v[68:69], v[56:57]
v_cvt_pk_bf16_f32 v58, v66, v67
v_cvt_pk_bf16_f32 v59, v68, v69
v_lshlrev_b32 v66, 16, v58
v_and_b32 v67, 0xffff0000, v58
v_lshlrev_b32 v68, 16, v59
v_and_b32 v69, 0xffff0000, v59
v_pk_add_f32 v[66:67], v[66:67], v[34:35]
v_pk_add_f32 v[68:69], v[68:69], v[36:37]
v_cvt_pk_bf16_f32 v66, v66, v67
v_cvt_pk_bf16_f32 v67, v68, v69
buffer_store_dwordx2 v[66:67], v249, s[60:63], s29 offen
s_waitcnt vmcnt(7)
v_dot2c_f32_bf16 v136, s90, v80
v_dot2c_f32_bf16 v137, s91, v80
v_dot2c_f32_bf16 v138, s90, v81
v_dot2c_f32_bf16 v139, s91, v81
v_dot2c_f32_bf16 v140, s90, v82
v_dot2c_f32_bf16 v141, s91, v82
v_dot2c_f32_bf16 v142, s90, v83
v_dot2c_f32_bf16 v143, s91, v83
s_waitcnt vmcnt(6)
v_dot2c_f32_bf16 v136, s90, v84
v_dot2c_f32_bf16 v137, s91, v84
v_dot2c_f32_bf16 v138, s90, v85
v_dot2c_f32_bf16 v139, s91, v85
v_dot2c_f32_bf16 v140, s90, v86
v_dot2c_f32_bf16 v141, s91, v86
v_dot2c_f32_bf16 v142, s90, v87
v_dot2c_f32_bf16 v143, s91, v87
s_waitcnt vmcnt(5)
v_dot2c_f32_bf16 v136, s90, v88
v_dot2c_f32_bf16 v137, s91, v88
v_dot2c_f32_bf16 v138, s90, v89
v_dot2c_f32_bf16 v139, s91, v89
v_dot2c_f32_bf16 v140, s90, v90
v_dot2c_f32_bf16 v141, s91, v90
v_dot2c_f32_bf16 v142, s90, v91
v_dot2c_f32_bf16 v143, s91, v91
s_waitcnt vmcnt(4)
v_dot2c_f32_bf16 v136, s90, v92
v_dot2c_f32_bf16 v137, s91, v92
v_dot2c_f32_bf16 v138, s90, v93
v_dot2c_f32_bf16 v139, s91, v93
v_dot2c_f32_bf16 v140, s90, v94
v_dot2c_f32_bf16 v141, s91, v94
v_dot2c_f32_bf16 v142, s90, v95
v_dot2c_f32_bf16 v143, s91, v95
s_waitcnt vmcnt(3)
v_dot2c_f32_bf16 v136, s90, v96
v_dot2c_f32_bf16 v137, s91, v96
v_dot2c_f32_bf16 v138, s90, v97
v_dot2c_f32_bf16 v139, s91, v97
v_dot2c_f32_bf16 v140, s90, v98
v_dot2c_f32_bf16 v141, s91, v98
v_dot2c_f32_bf16 v142, s90, v99
v_dot2c_f32_bf16 v143, s91, v99
s_waitcnt vmcnt(2)
v_dot2c_f32_bf16 v136, s90, v100
v_dot2c_f32_bf16 v137, s91, v100
v_dot2c_f32_bf16 v138, s90, v101
v_dot2c_f32_bf16 v139, s91, v101
v_dot2c_f32_bf16 v140, s90, v102
v_dot2c_f32_bf16 v141, s91, v102
v_dot2c_f32_bf16 v142, s90, v103
v_dot2c_f32_bf16 v143, s91, v103
s_waitcnt vmcnt(1)
v_dot2c_f32_bf16 v136, s90, v132
v_dot2c_f32_bf16 v137, s91, v132
v_dot2c_f32_bf16 v138, s90, v133
v_dot2c_f32_bf16 v139, s91, v133
v_dot2c_f32_bf16 v140, s90, v134
v_dot2c_f32_bf16 v141, s91, v134
v_dot2c_f32_bf16 v142, s90, v135
v_dot2c_f32_bf16 v143, s91, v135
s_nop 2
v_cvt_pk_bf16_f32 v58, v136, v137
v_cvt_pk_bf16_f32 v59, v138, v139
v_cvt_pk_bf16_f32 v60, v140, v141
v_cvt_pk_bf16_f32 v61, v142, v143
v_lshlrev_b32 v136, 16, v58
v_and_b32 v137, 0xffff0000, v58
v_lshlrev_b32 v138, 16, v59
v_and_b32 v139, 0xffff0000, v59
v_lshlrev_b32 v140, 16, v60
v_and_b32 v141, 0xffff0000, v60
v_lshlrev_b32 v142, 16, v61
v_and_b32 v143, 0xffff0000, v61
v_pk_mul_f32 v[136:137], v[136:137], v[46:47]
v_pk_mul_f32 v[138:139], v[138:139], v[48:49]
v_pk_mul_f32 v[140:141], v[140:141], v[50:51]
v_pk_mul_f32 v[142:143], v[142:143], v[52:53]
v_cvt_pk_bf16_f32 v58, v136, v137
v_cvt_pk_bf16_f32 v59, v138, v139
v_cvt_pk_bf16_f32 v60, v140, v141
v_cvt_pk_bf16_f32 v61, v142, v143
v_lshlrev_b32 v136, 16, v58
v_and_b32 v137, 0xffff0000, v58
v_lshlrev_b32 v138, 16, v59
v_and_b32 v139, 0xffff0000, v59
v_lshlrev_b32 v140, 16, v60
v_and_b32 v141, 0xffff0000, v60
v_lshlrev_b32 v142, 16, v61
v_and_b32 v143, 0xffff0000, v61
v_pk_add_f32 v[136:137], v[136:137], v[26:27]
v_pk_add_f32 v[138:139], v[138:139], v[28:29]
v_pk_add_f32 v[140:141], v[140:141], v[30:31]
v_pk_add_f32 v[142:143], v[142:143], v[32:33]
v_cvt_pk_bf16_f32 v136, v136, v137
v_cvt_pk_bf16_f32 v137, v138, v139
v_cvt_pk_bf16_f32 v138, v140, v141
v_cvt_pk_bf16_f32 v139, v142, v143
buffer_store_dwordx4 v[136:139], v248, s[60:63], 0 offen offset:128
K_END:
s_endpgm
K_EVT:
STUB_17:
s_cbranch_execz HOP_RET2
s_sub_u32 s3, s33, 1
s_cmp_eq_u32 s33, 5
s_cbranch_scc0 EV_Y
s_sub_u32 s28, s40, 0
s_cmp_lt_u32 s28, 72
s_cselect_b32 s3, 4, 0
s_cmp_eq_u32 s37, 0
s_cbranch_scc0 K_EVT_RET
s_mov_b32 s28, 0x243000
EV_INC:
v_mov_b32 v246, 0
v_mov_b32 v247, 1
s_mov_b64 exec, 1
buffer_atomic_add v247, v246, s[20:23], s28 offen sc1
s_mov_b64 exec, -1
s_branch K_EVT_RET
EV_Y:
s_cmp_eq_u32 s33, 4
s_cbranch_scc0 EV_Y4
v_mov_b32 v246, 0
s_mov_b32 s28, 0x243000
buffer_load_dword v247, v246, s[20:23], s28 offen sc0 sc1
s_branch K_EVT_RET
EV_Y4:
s_cmp_eq_u32 s33, 1
s_cbranch_scc0 EV_Y5
s_mov_b32 s28, 0x243080
s_bitcmp0_b32 s37, 0
s_cbranch_scc1 EV_INC
s_branch K_EVT_RET
EV_Y5:
s_sub_u32 s29, s40, 0
s_lshr_b32 s28, s37, 1
s_lshl1_add_u32 s29, s29, s28
s_cmp_eq_u32 s33, 3
s_cbranch_scc0 EV_Y3
v_readfirstlane_b32 s28, v247
s_cmp_ge_u32 s28, 144
s_cbranch_scc0 EV_Y4SP
EV_Y4OK:
v_lshrrev_b32 v246, 3, v1
v_mul_u32_u24 v246, 18432, v246
v_and_b32 v247, 7, v1
v_lshl_add_u32 v246, v247, 4, v246
s_lshl_b32 s28, s29, 7
s_and_b32 s29, s37, 1
s_mul_i32 s29, s29, 1327104
s_add_u32 s28, s28, s29
s_add_u32 s28, s28, 0x2000000
buffer_load_dwordx4 v[104:107], v246, s[20:23], s28 offen sc0 sc1
s_add_u32 s28, s28, 147456
buffer_load_dwordx4 v[108:111], v246, s[20:23], s28 offen sc0 sc1
s_add_u32 s28, s28, 147456
buffer_load_dwordx4 v[112:115], v246, s[20:23], s28 offen sc0 sc1
s_add_u32 s28, s28, 147456
buffer_load_dwordx4 v[116:119], v246, s[20:23], s28 offen sc0 sc1
s_add_u32 s28, s28, 147456
buffer_load_dwordx4 v[120:123], v246, s[20:23], s28 offen sc0 sc1
s_add_u32 s28, s28, 147456
buffer_load_dwordx4 v[124:127], v246, s[20:23], s28 offen sc0 sc1
s_add_u32 s28, s28, 147456
buffer_load_dwordx4 v[128:131], v246, s[20:23], s28 offen sc0 sc1
s_add_u32 s28, s28, 147456
buffer_load_dwordx4 v[132:135], v246, s[20:23], s28 offen sc0 sc1
s_add_u32 s28, s28, 147456
buffer_load_dwordx4 v[248:251], v246, s[20:23], s28 offen sc0 sc1
s_branch K_EVT_RET
EV_Y3:
STUB_18:
s_cbranch_execz HOP_RET2
v_pk_add_f32 v[104:105], v[104:105], v[108:109]
v_pk_add_f32 v[106:107], v[106:107], v[110:111]
v_pk_add_f32 v[112:113], v[112:113], v[116:117]
v_pk_add_f32 v[114:115], v[114:115], v[118:119]
v_pk_add_f32 v[120:121], v[120:121], v[124:125]
v_pk_add_f32 v[122:123], v[122:123], v[126:127]
v_pk_add_f32 v[128:129], v[128:129], v[132:133]
v_pk_add_f32 v[130:131], v[130:131], v[134:135]
v_pk_add_f32 v[104:105], v[104:105], v[112:113]
v_pk_add_f32 v[106:107], v[106:107], v[114:115]
v_pk_add_f32 v[120:121], v[120:121], v[128:129]
v_pk_add_f32 v[122:123], v[122:123], v[130:131]
v_pk_add_f32 v[104:105], v[104:105], v[248:249]
v_pk_add_f32 v[106:107], v[106:107], v[250:251]
v_pk_add_f32 v[104:105], v[104:105], v[120:121]
v_pk_add_f32 v[106:107], v[106:107], v[122:123]
v_and_b32 v246, 7, v1
s_lshr_b32 s28, s37, 1
s_lshl_b32 s28, s28, 7
v_add_f32_dpp v108, v104, v104 row_ror:8 row_mask:0xf bank_mask:0xf
v_add_f32_dpp v109, v105, v105 row_ror:8 row_mask:0xf bank_mask:0xf
v_add_f32_dpp v110, v106, v106 row_ror:8 row_mask:0xf bank_mask:0xf
v_add_f32_dpp v111, v107, v107 row_ror:8 row_mask:0xf bank_mask:0xf
v_mov_b32 v104, v108
v_mov_b32 v105, v109
v_mov_b32 v106, v110
v_mov_b32 v107, v111
v_permlane16_swap_b32 v104, v108
v_permlane16_swap_b32 v105, v109
v_permlane16_swap_b32 v106, v110
v_permlane16_swap_b32 v107, v111
v_add_f32 v108, v104, v108
v_add_f32 v109, v105, v109
v_add_f32 v110, v106, v110
v_add_f32 v111, v107, v111
v_mov_b32 v104, v108
v_mov_b32 v105, v109
v_mov_b32 v106, v110
v_mov_b32 v107, v111
v_permlane32_swap_b32 v104, v108
v_permlane32_swap_b32 v105, v109
v_permlane32_swap_b32 v106, v110
v_permlane32_swap_b32 v107, v111
v_add_f32 v108, v104, v108
v_add_f32 v109, v105, v109
v_add_f32 v110, v106, v110
v_add_f32 v111, v107, v111
v_lshlrev_b32 v247, 4, v246
v_add_u32 v247, s28, v247
s_bitcmp1_b32 s37, 0
s_cbranch_scc0 EV_YE
ds_write_b128 v247, v[108:111] offset:65024
s_waitcnt lgkmcnt(0)
s_barrier
s_branch K_EVT_RET
EV_YE:
s_barrier
ds_read_b128 v[104:107], v247 offset:65024
v_mul_u32_u24 v246, 0x480, v246
s_lshl_b32 s28, s29, 3
s_add_u32 s28, s28, 0x244000
s_waitcnt lgkmcnt(0)
v_pk_add_f32 v[104:105], v[104:105], v[108:109]
v_pk_add_f32 v[106:107], v[106:107], v[110:111]
v_cvt_pk_bf16_f32 v108, v104, v105
v_cvt_pk_bf16_f32 v109, v106, v107
v_lshlrev_b32 v104, 16, v108
v_and_b32 v105, 0xffff0000, v108
v_lshlrev_b32 v106, 16, v109
v_and_b32 v107, 0xffff0000, v109
v_mul_f32 v104, v104, v236
v_mul_f32 v105, v105, v236
v_mul_f32 v106, v106, v236
v_mul_f32 v107, v107, v236
v_cvt_pk_bf16_f32 v108, v104, v105
v_cvt_pk_bf16_f32 v109, v106, v107
s_mov_b64 exec, 0xff
buffer_store_dwordx2 v[108:109], v246, s[20:23], s28 offen sc0 sc1
s_mov_b64 exec, -1
s_branch K_EVT_RET
SP_X0:
s_sleep 2
s_add_u32 s100, s100, 1
s_bitcmp1_b32 s100, 19
s_cbranch_scc1 K_END
buffer_load_dword v193, v192, s[24:27], 0 offen sc0 sc1
s_waitcnt vmcnt(0)
v_readfirstlane_b32 s92, v193
s_and_b32 s93, s92, 0xf0
s_cbranch_scc0 SP_X0
s_branch SP_X0_RET
SP_CAND:
s_sleep 2
s_add_u32 s100, s100, 1
s_bitcmp1_b32 s100, 19
s_cbranch_scc1 K_END
s_mov_b32 s29, 0x242000
buffer_load_dwordx2 v[248:249], v250, s[20:23], s29 offen sc0 sc1
s_waitcnt vmcnt(0)
v_cmp_ne_u32 vcc, s47, v249
s_cbranch_vccnz SP_CAND
s_branch SP_CAND_RET
SP_FL:
s_sleep 2
s_add_u32 s100, s100, 1
s_bitcmp1_b32 s100, 19
s_cbranch_scc1 K_END
buffer_load_dword v253, v246, s[24:27], 0 offen sc0 sc1
s_waitcnt vmcnt(0)
v_and_b32 v253, 0x20202020, v253
v_cmp_ne_u32 vcc, 0x20202020, v253
s_cbranch_vccnz SP_FL
s_branch SP_FL_RET
SP_Y:
s_sleep 4
s_add_u32 s100, s100, 1
s_bitcmp1_b32 s100, 19
s_cbranch_scc1 K_END
s_mov_b32 s93, 0x243080
buffer_load_dword v246, v254, s[20:23], s93 offen sc0 sc1
s_waitcnt vmcnt(0)
v_readfirstlane_b32 s93, v246
s_cmp_lt_u32 s93, 144
s_cbranch_scc1 SP_Y
s_branch SP_Y_RET
SP_O1A:
s_sleep 1
s_add_u32 s100, s100, 1
s_bitcmp1_b32 s100, 19
s_cbranch_scc1 K_END
buffer_load_dword v230, v229, s[20:23], s94 offen sc0 sc1
s_waitcnt vmcnt(0)
v_cmp_gt_u32 vcc, 1, v230
s_bitcmp1_b32 vcc_lo, s39
s_cbranch_scc1 SP_O1A
s_branch SP_O1A_RET
SP_O2A:
s_sleep 1
s_add_u32 s100, s100, 1
s_bitcmp1_b32 s100, 19
s_cbranch_scc1 K_END
buffer_load_dword v230, v229, s[20:23], s94 offen sc0 sc1
s_waitcnt vmcnt(0)
v_cmp_gt_u32 vcc, 1, v230
s_and_b32 s29, vcc_lo, 15
s_cbranch_scc1 SP_O2A
s_branch SP_O2A_RET
SP_O3A:
s_sleep 1
s_add_u32 s100, s100, 1
s_bitcmp1_b32 s100, 19
s_cbranch_scc1 K_END
buffer_load_dword v230, v229, s[20:23], s94 offen sc0 sc1
s_waitcnt vmcnt(0)
v_cmp_gt_u32 vcc, 2, v230
s_and_b32 s29, vcc_lo, 15
s_cbranch_scc1 SP_O3A
s_branch SP_O3A_RET
SP_P1A:
s_sleep 1
s_add_u32 s100, s100, 1
s_bitcmp1_b32 s100, 19
s_cbranch_scc1 K_END
buffer_load_dword v230, v229, s[20:23], s95 offen sc0 sc1
s_waitcnt vmcnt(0)
v_cmp_gt_u32 vcc, 1, v230
s_and_b32 s29, vcc_lo, 0xff
s_cbranch_scc1 SP_P1A
s_branch SP_P1A_RET
EV_Y4SP:
s_sleep 8
s_add_u32 s100, s100, 1
s_bitcmp1_b32 s100, 19
s_cbranch_scc1 K_END
v_mov_b32 v246, 0
s_mov_b32 s28, 0x243000
buffer_load_dword v247, v246, s[20:23], s28 offen sc0 sc1
s_waitcnt vmcnt(0)
v_readfirstlane_b32 s28, v247
s_cmp_ge_u32 s28, 144
s_cbranch_scc0 EV_Y4SP
s_branch EV_Y4OK
K_HOT_END:
K_MIXED:
s_waitcnt lgkmcnt(0)
s_barrier
s_add_u32 s28, s30, 147456
v_smfmac_f32_16x16x64_bf16 a[128:131], a[208:211], v[88:95], v245
v_lshrrev_b32 v132, 1, v1
v_and_b32 v132, 8, v132
v_smfmac_f32_16x16x64_bf16 a[132:135], a[208:211], v[96:103], v245
v_xor_b32 v132, v132, v1
v_lshlrev_b32 v132, 4, v132
v_mfma_f32_16x16x32_bf16 a[0:3], v[88:91], a[176:179], a[0:3]
v_add_u32 v132, s28, v132
v_lshlrev_b32 v133, 3, v1
v_mfma_f32_16x16x32_bf16 a[16:19], v[88:91], a[180:183], a[16:19]
v_and_b32 v133, 8, v133
v_lshrrev_b32 v134, 2, v1
v_mfma_f32_16x16x32_bf16 a[32:35], v[88:91], a[184:187], a[32:35]
v_xor_b32 v133, v133, v134
v_and_b32 v134, 3, v1
v_mfma_f32_16x16x32_bf16 a[48:51], v[88:91], a[188:191], a[48:51]
v_lshl_add_u32 v133, v134, 4, v133
v_lshlrev_b32 v133, 4, v133
v_mfma_f32_16x16x32_bf16 a[64:67], v[88:91], a[192:195], a[64:67]
v_add_u32 v133, s28, v133
v_lshlrev_b32 v134, 2, v3
v_mfma_f32_16x16x32_bf16 a[80:83], v[88:91], a[196:199], a[80:83]
v_add_u32 v134, s28, v134
v_lshlrev_b32 v135, 4, v4
v_mfma_f32_16x16x32_bf16 a[96:99], v[88:91], a[200:203], a[96:99]
v_add_u32 v135, s28, v135
v_mfma_f32_16x16x32_bf16 a[112:115], v[88:91], a[204:207], a[112:115]
v_mfma_f32_16x16x32_bf16 a[4:7], v[92:95], a[176:179], a[4:7]
v_accvgpr_read_b32 v120, a128
v_accvgpr_read_b32 v124, a129
v_accvgpr_read_b32 v121, a130
v_mfma_f32_16x16x32_bf16 a[20:23], v[92:95], a[180:183], a[20:23]
v_accvgpr_read_b32 v125, a131
v_accvgpr_read_b32 v122, a132
v_accvgpr_read_b32 v126, a133
v_mfma_f32_16x16x32_bf16 a[36:39], v[92:95], a[184:187], a[36:39]
v_accvgpr_read_b32 v123, a134
v_accvgpr_read_b32 v127, a135
v_add_f32 v120, v120, v124
v_mfma_f32_16x16x32_bf16 a[52:55], v[92:95], a[188:191], a[52:55]
v_add_f32 v121, v121, v125
v_add_f32 v122, v122, v126
v_add_f32 v123, v123, v127
v_mfma_f32_16x16x32_bf16 a[68:71], v[92:95], a[192:195], a[68:71]
v_rcp_f32 v124, v120
v_rcp_f32 v125, v121
v_rcp_f32 v126, v122
v_mfma_f32_16x16x32_bf16 a[84:87], v[92:95], a[196:199], a[84:87]
v_rcp_f32 v127, v123
ds_write_b32 v134, v124 offset:0
ds_write_b32 v134, v125 offset:64
v_mfma_f32_16x16x32_bf16 a[100:103], v[92:95], a[200:203], a[100:103]
ds_write_b32 v134, v126 offset:128
ds_write_b32 v134, v127 offset:192
ds_read_b128 v[72:75], v135 offset:0
v_mfma_f32_16x16x32_bf16 a[116:119], v[92:95], a[204:207], a[116:119]
ds_read_b128 v[76:79], v135 offset:64
ds_read_b128 v[80:83], v135 offset:128
ds_read_b128 v[84:87], v135 offset:192
s_add_u32 s92, s44, 4096
s_add_u32 s93, s44, 8192
s_add_u32 s51, s44, 12288
v_mfma_f32_16x16x32_bf16 a[8:11], v[96:99], a[176:179], a[8:11]
v_accvgpr_read_b32 v104, a0
v_accvgpr_read_b32 v105, a1
v_accvgpr_read_b32 v106, a2
v_accvgpr_read_b32 v107, a3
v_mfma_f32_16x16x32_bf16 a[24:27], v[96:99], a[180:183], a[24:27]
v_accvgpr_read_b32 v108, a16
v_accvgpr_read_b32 v109, a17
v_accvgpr_read_b32 v110, a18
v_accvgpr_read_b32 v111, a19
s_waitcnt lgkmcnt(0)
v_pk_mul_f32 v[104:105], v[104:105], v[72:73]
v_pk_mul_f32 v[106:107], v[106:107], v[74:75]
v_pk_mul_f32 v[108:109], v[108:109], v[72:73]
v_pk_mul_f32 v[110:111], v[110:111], v[74:75]
v_cvt_pk_bf16_f32 v104, v104, v105
v_cvt_pk_bf16_f32 v105, v106, v107
v_cvt_pk_bf16_f32 v106, v108, v109
v_cvt_pk_bf16_f32 v107, v110, v111
v_mfma_f32_16x16x32_bf16 a[40:43], v[96:99], a[184:187], a[40:43]
v_accvgpr_read_b32 v112, a32
v_accvgpr_read_b32 v113, a33
v_accvgpr_read_b32 v114, a34
v_accvgpr_read_b32 v115, a35
ds_write_b128 v132, v[104:107] offset:0
v_mfma_f32_16x16x32_bf16 a[56:59], v[96:99], a[188:191], a[56:59]
v_accvgpr_read_b32 v116, a48
v_accvgpr_read_b32 v117, a49
v_accvgpr_read_b32 v118, a50
v_accvgpr_read_b32 v119, a51
ds_read_b64_tr_b16 v[8:9], v133 offset:0
ds_read_b64_tr_b16 v[10:11], v133 offset:8
v_pk_mul_f32 v[112:113], v[112:113], v[72:73]
v_pk_mul_f32 v[114:115], v[114:115], v[74:75]
v_pk_mul_f32 v[116:117], v[116:117], v[72:73]
v_pk_mul_f32 v[118:119], v[118:119], v[74:75]
v_cvt_pk_bf16_f32 v112, v112, v113
v_cvt_pk_bf16_f32 v113, v114, v115
v_cvt_pk_bf16_f32 v114, v116, v117
v_cvt_pk_bf16_f32 v115, v118, v119
v_mfma_f32_16x16x32_bf16 a[72:75], v[96:99], a[192:195], a[72:75]
v_accvgpr_read_b32 v104, a64
v_accvgpr_read_b32 v105, a65
v_accvgpr_read_b32 v106, a66
v_accvgpr_read_b32 v107, a67
ds_write_b128 v132, v[112:115] offset:1024
v_mfma_f32_16x16x32_bf16 a[88:91], v[96:99], a[196:199], a[88:91]
v_accvgpr_read_b32 v108, a80
v_accvgpr_read_b32 v109, a81
v_accvgpr_read_b32 v110, a82
v_accvgpr_read_b32 v111, a83
ds_read_b64_tr_b16 v[12:13], v133 offset:1024
ds_read_b64_tr_b16 v[14:15], v133 offset:1032
v_pk_mul_f32 v[104:105], v[104:105], v[72:73]
v_pk_mul_f32 v[106:107], v[106:107], v[74:75]
v_pk_mul_f32 v[108:109], v[108:109], v[72:73]
v_pk_mul_f32 v[110:111], v[110:111], v[74:75]
s_waitcnt lgkmcnt(3)
buffer_store_dwordx4 v[8:11], v244, s[20:23], s44 offen offset:0 sc0 sc1
v_cvt_pk_bf16_f32 v104, v104, v105
v_cvt_pk_bf16_f32 v105, v106, v107
v_cvt_pk_bf16_f32 v106, v108, v109
v_cvt_pk_bf16_f32 v107, v110, v111
v_mfma_f32_16x16x32_bf16 a[104:107], v[96:99], a[200:203], a[104:107]
v_accvgpr_read_b32 v112, a96
v_accvgpr_read_b32 v113, a97
v_accvgpr_read_b32 v114, a98
v_accvgpr_read_b32 v115, a99
ds_write_b128 v132, v[104:107] offset:2048
v_mfma_f32_16x16x32_bf16 a[120:123], v[96:99], a[204:207], a[120:123]
v_accvgpr_read_b32 v116, a112
v_accvgpr_read_b32 v117, a113
v_accvgpr_read_b32 v118, a114
v_accvgpr_read_b32 v119, a115
ds_read_b64_tr_b16 v[16:17], v133 offset:2048
ds_read_b64_tr_b16 v[18:19], v133 offset:2056
v_pk_mul_f32 v[112:113], v[112:113], v[72:73]
v_pk_mul_f32 v[114:115], v[114:115], v[74:75]
v_pk_mul_f32 v[116:117], v[116:117], v[72:73]
v_pk_mul_f32 v[118:119], v[118:119], v[74:75]
v_cvt_pk_bf16_f32 v112, v112, v113
v_cvt_pk_bf16_f32 v113, v114, v115
v_cvt_pk_bf16_f32 v114, v116, v117
v_cvt_pk_bf16_f32 v115, v118, v119
v_mfma_f32_16x16x32_bf16 a[12:15], v[100:103], a[176:179], a[12:15]
v_accvgpr_read_b32 v104, a4
v_accvgpr_read_b32 v105, a5
v_accvgpr_read_b32 v106, a6
v_accvgpr_read_b32 v107, a7
ds_write_b128 v132, v[112:115] offset:3072
v_mfma_f32_16x16x32_bf16 a[28:31], v[100:103], a[180:183], a[28:31]
v_accvgpr_read_b32 v108, a20
v_accvgpr_read_b32 v109, a21
v_accvgpr_read_b32 v110, a22
v_accvgpr_read_b32 v111, a23
ds_read_b64_tr_b16 v[20:21], v133 offset:3072
ds_read_b64_tr_b16 v[22:23], v133 offset:3080
v_pk_mul_f32 v[104:105], v[104:105], v[76:77]
v_pk_mul_f32 v[106:107], v[106:107], v[78:79]
v_pk_mul_f32 v[108:109], v[108:109], v[76:77]
v_pk_mul_f32 v[110:111], v[110:111], v[78:79]
s_waitcnt lgkmcnt(3)
buffer_store_dwordx4 v[16:19], v244, s[20:23], s44 offen offset:2048 sc0 sc1
v_cvt_pk_bf16_f32 v104, v104, v105
v_cvt_pk_bf16_f32 v105, v106, v107
v_cvt_pk_bf16_f32 v106, v108, v109
v_cvt_pk_bf16_f32 v107, v110, v111
v_mfma_f32_16x16x32_bf16 a[44:47], v[100:103], a[184:187], a[44:47]
v_accvgpr_read_b32 v112, a36
v_accvgpr_read_b32 v113, a37
v_accvgpr_read_b32 v114, a38
v_accvgpr_read_b32 v115, a39
ds_write_b128 v132, v[104:107] offset:0
v_mfma_f32_16x16x32_bf16 a[60:63], v[100:103], a[188:191], a[60:63]
v_accvgpr_read_b32 v116, a52
v_accvgpr_read_b32 v117, a53
v_accvgpr_read_b32 v118, a54
v_accvgpr_read_b32 v119, a55
ds_read_b64_tr_b16 v[24:25], v133 offset:0
ds_read_b64_tr_b16 v[26:27], v133 offset:8
v_pk_mul_f32 v[112:113], v[112:113], v[76:77]
v_pk_mul_f32 v[114:115], v[114:115], v[78:79]
v_pk_mul_f32 v[116:117], v[116:117], v[76:77]
v_pk_mul_f32 v[118:119], v[118:119], v[78:79]
v_cvt_pk_bf16_f32 v112, v112, v113
v_cvt_pk_bf16_f32 v113, v114, v115
v_cvt_pk_bf16_f32 v114, v116, v117
v_cvt_pk_bf16_f32 v115, v118, v119
v_mfma_f32_16x16x32_bf16 a[76:79], v[100:103], a[192:195], a[76:79]
v_accvgpr_read_b32 v104, a68
v_accvgpr_read_b32 v105, a69
v_accvgpr_read_b32 v106, a70
v_accvgpr_read_b32 v107, a71
ds_write_b128 v132, v[112:115] offset:1024
v_mfma_f32_16x16x32_bf16 a[92:95], v[100:103], a[196:199], a[92:95]
v_accvgpr_read_b32 v108, a84
v_accvgpr_read_b32 v109, a85
v_accvgpr_read_b32 v110, a86
v_accvgpr_read_b32 v111, a87
ds_read_b64_tr_b16 v[28:29], v133 offset:1024
ds_read_b64_tr_b16 v[30:31], v133 offset:1032
v_pk_mul_f32 v[104:105], v[104:105], v[76:77]
v_pk_mul_f32 v[106:107], v[106:107], v[78:79]
v_pk_mul_f32 v[108:109], v[108:109], v[76:77]
v_pk_mul_f32 v[110:111], v[110:111], v[78:79]
s_waitcnt lgkmcnt(3)
buffer_store_dwordx4 v[24:27], v244, s[20:23], s92 offen offset:0 sc0 sc1
v_cvt_pk_bf16_f32 v104, v104, v105
v_cvt_pk_bf16_f32 v105, v106, v107
v_cvt_pk_bf16_f32 v106, v108, v109
v_cvt_pk_bf16_f32 v107, v110, v111
v_mfma_f32_16x16x32_bf16 a[108:111], v[100:103], a[200:203], a[108:111]
v_accvgpr_read_b32 v112, a100
v_accvgpr_read_b32 v113, a101
v_accvgpr_read_b32 v114, a102
v_accvgpr_read_b32 v115, a103
ds_write_b128 v132, v[104:107] offset:2048
v_mfma_f32_16x16x32_bf16 a[124:127], v[100:103], a[204:207], a[124:127]
v_accvgpr_read_b32 v116, a116
v_accvgpr_read_b32 v117, a117
v_accvgpr_read_b32 v118, a118
v_accvgpr_read_b32 v119, a119
ds_read_b64_tr_b16 v[32:33], v133 offset:2048
ds_read_b64_tr_b16 v[34:35], v133 offset:2056
v_pk_mul_f32 v[112:113], v[112:113], v[76:77]
v_pk_mul_f32 v[114:115], v[114:115], v[78:79]
v_pk_mul_f32 v[116:117], v[116:117], v[76:77]
v_pk_mul_f32 v[118:119], v[118:119], v[78:79]
v_cvt_pk_bf16_f32 v112, v112, v113
v_cvt_pk_bf16_f32 v113, v114, v115
v_cvt_pk_bf16_f32 v114, v116, v117
v_cvt_pk_bf16_f32 v115, v118, v119
v_accvgpr_read_b32 v104, a8
v_accvgpr_read_b32 v105, a9
v_accvgpr_read_b32 v106, a10
v_accvgpr_read_b32 v107, a11
ds_write_b128 v132, v[112:115] offset:3072
v_accvgpr_read_b32 v108, a24
v_accvgpr_read_b32 v109, a25
v_accvgpr_read_b32 v110, a26
v_accvgpr_read_b32 v111, a27
ds_read_b64_tr_b16 v[36:37], v133 offset:3072
ds_read_b64_tr_b16 v[38:39], v133 offset:3080
v_pk_mul_f32 v[104:105], v[104:105], v[80:81]
v_pk_mul_f32 v[106:107], v[106:107], v[82:83]
v_pk_mul_f32 v[108:109], v[108:109], v[80:81]
v_pk_mul_f32 v[110:111], v[110:111], v[82:83]
s_waitcnt lgkmcnt(3)
buffer_store_dwordx4 v[32:35], v244, s[20:23], s92 offen offset:2048 sc0 sc1
v_cvt_pk_bf16_f32 v104, v104, v105
v_cvt_pk_bf16_f32 v105, v106, v107
v_cvt_pk_bf16_f32 v106, v108, v109
v_cvt_pk_bf16_f32 v107, v110, v111
v_accvgpr_read_b32 v112, a40
v_accvgpr_read_b32 v113, a41
v_accvgpr_read_b32 v114, a42
v_accvgpr_read_b32 v115, a43
ds_write_b128 v132, v[104:107] offset:0
v_accvgpr_read_b32 v116, a56
v_accvgpr_read_b32 v117, a57
v_accvgpr_read_b32 v118, a58
v_accvgpr_read_b32 v119, a59
ds_read_b64_tr_b16 v[40:41], v133 offset:0
ds_read_b64_tr_b16 v[42:43], v133 offset:8
v_pk_mul_f32 v[112:113], v[112:113], v[80:81]
v_pk_mul_f32 v[114:115], v[114:115], v[82:83]
v_pk_mul_f32 v[116:117], v[116:117], v[80:81]
v_pk_mul_f32 v[118:119], v[118:119], v[82:83]
v_cvt_pk_bf16_f32 v112, v112, v113
v_cvt_pk_bf16_f32 v113, v114, v115
v_cvt_pk_bf16_f32 v114, v116, v117
v_cvt_pk_bf16_f32 v115, v118, v119
v_accvgpr_read_b32 v104, a72
v_accvgpr_read_b32 v105, a73
v_accvgpr_read_b32 v106, a74
v_accvgpr_read_b32 v107, a75
ds_write_b128 v132, v[112:115] offset:1024
v_accvgpr_read_b32 v108, a88
v_accvgpr_read_b32 v109, a89
v_accvgpr_read_b32 v110, a90
v_accvgpr_read_b32 v111, a91
ds_read_b64_tr_b16 v[44:45], v133 offset:1024
ds_read_b64_tr_b16 v[46:47], v133 offset:1032
v_pk_mul_f32 v[104:105], v[104:105], v[80:81]
v_pk_mul_f32 v[106:107], v[106:107], v[82:83]
v_pk_mul_f32 v[108:109], v[108:109], v[80:81]
v_pk_mul_f32 v[110:111], v[110:111], v[82:83]
s_waitcnt lgkmcnt(3)
buffer_store_dwordx4 v[40:43], v244, s[20:23], s93 offen offset:0 sc0 sc1
v_cvt_pk_bf16_f32 v104, v104, v105
v_cvt_pk_bf16_f32 v105, v106, v107
v_cvt_pk_bf16_f32 v106, v108, v109
v_cvt_pk_bf16_f32 v107, v110, v111
v_accvgpr_read_b32 v112, a104
v_accvgpr_read_b32 v113, a105
v_accvgpr_read_b32 v114, a106
v_accvgpr_read_b32 v115, a107
ds_write_b128 v132, v[104:107] offset:2048
v_accvgpr_read_b32 v116, a120
v_accvgpr_read_b32 v117, a121
v_accvgpr_read_b32 v118, a122
v_accvgpr_read_b32 v119, a123
ds_read_b64_tr_b16 v[48:49], v133 offset:2048
ds_read_b64_tr_b16 v[50:51], v133 offset:2056
v_pk_mul_f32 v[112:113], v[112:113], v[80:81]
v_pk_mul_f32 v[114:115], v[114:115], v[82:83]
v_pk_mul_f32 v[116:117], v[116:117], v[80:81]
v_pk_mul_f32 v[118:119], v[118:119], v[82:83]
v_cvt_pk_bf16_f32 v112, v112, v113
v_cvt_pk_bf16_f32 v113, v114, v115
v_cvt_pk_bf16_f32 v114, v116, v117
v_cvt_pk_bf16_f32 v115, v118, v119
v_accvgpr_read_b32 v104, a12
v_accvgpr_read_b32 v105, a13
v_accvgpr_read_b32 v106, a14
v_accvgpr_read_b32 v107, a15
ds_write_b128 v132, v[112:115] offset:3072
v_accvgpr_read_b32 v108, a28
v_accvgpr_read_b32 v109, a29
v_accvgpr_read_b32 v110, a30
v_accvgpr_read_b32 v111, a31
ds_read_b64_tr_b16 v[52:53], v133 offset:3072
ds_read_b64_tr_b16 v[54:55], v133 offset:3080
v_pk_mul_f32 v[104:105], v[104:105], v[84:85]
v_pk_mul_f32 v[106:107], v[106:107], v[86:87]
v_pk_mul_f32 v[108:109], v[108:109], v[84:85]
v_pk_mul_f32 v[110:111], v[110:111], v[86:87]
s_waitcnt lgkmcnt(3)
buffer_store_dwordx4 v[48:51], v244, s[20:23], s93 offen offset:2048 sc0 sc1
v_cvt_pk_bf16_f32 v104, v104, v105
v_cvt_pk_bf16_f32 v105, v106, v107
v_cvt_pk_bf16_f32 v106, v108, v109
v_cvt_pk_bf16_f32 v107, v110, v111
v_accvgpr_read_b32 v112, a44
v_accvgpr_read_b32 v113, a45
v_accvgpr_read_b32 v114, a46
v_accvgpr_read_b32 v115, a47
ds_write_b128 v132, v[104:107] offset:0
v_accvgpr_read_b32 v116, a60
v_accvgpr_read_b32 v117, a61
v_accvgpr_read_b32 v118, a62
v_accvgpr_read_b32 v119, a63
ds_read_b64_tr_b16 v[56:57], v133 offset:0
ds_read_b64_tr_b16 v[58:59], v133 offset:8
v_pk_mul_f32 v[112:113], v[112:113], v[84:85]
v_pk_mul_f32 v[114:115], v[114:115], v[86:87]
v_pk_mul_f32 v[116:117], v[116:117], v[84:85]
v_pk_mul_f32 v[118:119], v[118:119], v[86:87]
v_cvt_pk_bf16_f32 v112, v112, v113
v_cvt_pk_bf16_f32 v113, v114, v115
v_cvt_pk_bf16_f32 v114, v116, v117
v_cvt_pk_bf16_f32 v115, v118, v119
v_accvgpr_read_b32 v104, a76
v_accvgpr_read_b32 v105, a77
v_accvgpr_read_b32 v106, a78
v_accvgpr_read_b32 v107, a79
ds_write_b128 v132, v[112:115] offset:1024
v_accvgpr_read_b32 v108, a92
v_accvgpr_read_b32 v109, a93
v_accvgpr_read_b32 v110, a94
v_accvgpr_read_b32 v111, a95
ds_read_b64_tr_b16 v[60:61], v133 offset:1024
ds_read_b64_tr_b16 v[62:63], v133 offset:1032
v_pk_mul_f32 v[104:105], v[104:105], v[84:85]
v_pk_mul_f32 v[106:107], v[106:107], v[86:87]
v_pk_mul_f32 v[108:109], v[108:109], v[84:85]
v_pk_mul_f32 v[110:111], v[110:111], v[86:87]
s_waitcnt lgkmcnt(3)
buffer_store_dwordx4 v[56:59], v244, s[20:23], s51 offen offset:0 sc0 sc1
v_cvt_pk_bf16_f32 v104, v104, v105
v_cvt_pk_bf16_f32 v105, v106, v107
v_cvt_pk_bf16_f32 v106, v108, v109
v_cvt_pk_bf16_f32 v107, v110, v111
v_accvgpr_read_b32 v112, a108
v_accvgpr_read_b32 v113, a109
v_accvgpr_read_b32 v114, a110
v_accvgpr_read_b32 v115, a111
ds_write_b128 v132, v[104:107] offset:2048
v_accvgpr_read_b32 v116, a124
v_accvgpr_read_b32 v117, a125
v_accvgpr_read_b32 v118, a126
v_accvgpr_read_b32 v119, a127
ds_read_b64_tr_b16 v[64:65], v133 offset:2048
ds_read_b64_tr_b16 v[66:67], v133 offset:2056
v_pk_mul_f32 v[112:113], v[112:113], v[84:85]
v_pk_mul_f32 v[114:115], v[114:115], v[86:87]
v_pk_mul_f32 v[116:117], v[116:117], v[84:85]
v_pk_mul_f32 v[118:119], v[118:119], v[86:87]
v_cvt_pk_bf16_f32 v112, v112, v113
v_cvt_pk_bf16_f32 v113, v114, v115
v_cvt_pk_bf16_f32 v114, v116, v117
v_cvt_pk_bf16_f32 v115, v118, v119
ds_write_b128 v132, v[112:115] offset:3072
ds_read_b64_tr_b16 v[68:69], v133 offset:3072
ds_read_b64_tr_b16 v[70:71], v133 offset:3080
s_waitcnt lgkmcnt(3)
buffer_store_dwordx4 v[64:67], v244, s[20:23], s51 offen offset:2048 sc0 sc1
v_max3_f32 v104, v120, v121, v122
v_max_f32 v104, v104, v123
v_add_f32 v105, v120, v121
v_add_f32 v105, v105, v122
v_add_f32 v105, v105, v123
v_cmp_nge_f32 vcc, s42, v104
v_cmp_u_f32 s[28:29], v105, v105
s_or_b64 vcc, vcc, s[28:29]
s_cmp_lg_u64 vcc, 0
s_cselect_b32 s28, 1, 0
v_mov_b32 v104, s28
v_mov_b32 v106, 147456
s_waitcnt lgkmcnt(0)
ds_write_b32 v134, v104
s_waitcnt vmcnt(8) lgkmcnt(0)
s_barrier
ds_read2st64_b32 v[110:111], v106 offset0:32 offset1:48
ds_read2st64_b32 v[108:109], v106 offset0:0 offset1:16
ds_read_b64_tr_b16 a[64:65], v237 offset:0
ds_read_b64_tr_b16 a[66:67], v237 offset:4608
ds_read_b64_tr_b16 a[68:69], v237 offset:8
ds_read_b64_tr_b16 a[70:71], v237 offset:4616
ds_read_b64_tr_b16 a[72:73], v238 offset:0
ds_read_b64_tr_b16 a[74:75], v238 offset:4608
ds_read_b64_tr_b16 a[76:77], v238 offset:8
ds_read_b64_tr_b16 a[78:79], v238 offset:4616
ds_read_b64_tr_b16 a[80:81], v237 offset:128
ds_read_b64_tr_b16 a[82:83], v237 offset:4736
ds_read_b64_tr_b16 a[84:85], v237 offset:136
ds_read_b64_tr_b16 a[86:87], v237 offset:4744
ds_read_b64_tr_b16 a[88:89], v238 offset:128
ds_read_b64_tr_b16 a[90:91], v238 offset:4736
s_waitcnt lgkmcnt(14)
v_or_b32 v108, v108, v109
v_or3_b32 v108, v108, v110, v111
s_nop 0
v_readfirstlane_b32 s28, v108
s_cmp_gt_u32 s28, s43
s_cbranch_scc1 K_FALLBACK
s_waitcnt lgkmcnt(8)
v_mfma_f32_16x16x32_bf16 v[96:99], a[64:67], v[56:59], 0
ds_read_b64_tr_b16 a[92:93], v238 offset:136
ds_read_b64_tr_b16 a[94:95], v238 offset:4744
v_mfma_f32_16x16x32_bf16 v[88:91], a[64:67], v[40:43], 0
buffer_store_dwordx4 v[12:15], v244, s[20:23], s44 offen offset:1024 sc0 sc1
v_mfma_f32_16x16x32_bf16 v[80:83], a[64:67], v[24:27], 0
v_mfma_f32_16x16x32_bf16 v[72:75], a[64:67], v[8:11], 0
v_mfma_f32_16x16x32_bf16 v[76:79], a[68:71], v[8:11], 0
ds_read_b64_tr_b16 a[64:65], v239 offset:0
ds_read_b64_tr_b16 a[66:67], v239 offset:4608
v_mfma_f32_16x16x32_bf16 v[84:87], a[68:71], v[24:27], 0
buffer_store_dwordx4 v[20:23], v244, s[20:23], s44 offen offset:3072 sc0 sc1
v_mfma_f32_16x16x32_bf16 v[92:95], a[68:71], v[40:43], 0
v_mfma_f32_16x16x32_bf16 v[100:103], a[68:71], v[56:59], 0
v_mfma_f32_16x16x32_bf16 v[128:131], a[72:75], v[56:59], 0
ds_read_b64_tr_b16 a[68:69], v237 offset:9216
ds_read_b64_tr_b16 a[70:71], v237 offset:13824
v_mfma_f32_16x16x32_bf16 v[120:123], a[72:75], v[40:43], 0
buffer_store_dwordx4 v[28:31], v244, s[20:23], s92 offen offset:1024 sc0 sc1
v_mfma_f32_16x16x32_bf16 v[112:115], a[72:75], v[24:27], 0
v_mfma_f32_16x16x32_bf16 v[104:107], a[72:75], v[8:11], 0
s_waitcnt lgkmcnt(8)
v_mfma_f32_16x16x32_bf16 v[108:111], a[76:79], v[8:11], 0
ds_read_b64_tr_b16 a[72:73], v237 offset:9224
ds_read_b64_tr_b16 a[74:75], v237 offset:13832
v_mfma_f32_16x16x32_bf16 v[116:119], a[76:79], v[24:27], 0
buffer_store_dwordx4 v[36:39], v244, s[20:23], s92 offen offset:3072 sc0 sc1
v_mfma_f32_16x16x32_bf16 v[124:127], a[76:79], v[40:43], 0
v_mfma_f32_16x16x32_bf16 v[132:135], a[76:79], v[56:59], 0
v_mfma_f32_16x16x32_bf16 v[160:163], a[80:83], v[56:59], 0
ds_read_b64_tr_b16 a[76:77], v238 offset:9216
ds_read_b64_tr_b16 a[78:79], v238 offset:13824
v_mfma_f32_16x16x32_bf16 v[152:155], a[80:83], v[40:43], 0
buffer_store_dwordx4 v[44:47], v244, s[20:23], s93 offen offset:1024 sc0 sc1
v_mfma_f32_16x16x32_bf16 v[144:147], a[80:83], v[24:27], 0
v_mfma_f32_16x16x32_bf16 v[136:139], a[80:83], v[8:11], 0
v_mfma_f32_16x16x32_bf16 v[140:143], a[84:87], v[8:11], 0
ds_read_b64_tr_b16 a[80:81], v238 offset:9224
ds_read_b64_tr_b16 a[82:83], v238 offset:13832
v_mfma_f32_16x16x32_bf16 v[148:151], a[84:87], v[24:27], 0
buffer_store_dwordx4 v[52:55], v244, s[20:23], s93 offen offset:3072 sc0 sc1
v_mfma_f32_16x16x32_bf16 v[156:159], a[84:87], v[40:43], 0
v_mfma_f32_16x16x32_bf16 v[164:167], a[84:87], v[56:59], 0
s_waitcnt lgkmcnt(8)
v_mfma_f32_16x16x32_bf16 v[192:195], a[88:91], v[56:59], 0
ds_read_b64_tr_b16 a[84:85], v237 offset:9344
ds_read_b64_tr_b16 a[86:87], v237 offset:13952
v_mfma_f32_16x16x32_bf16 v[184:187], a[88:91], v[40:43], 0
buffer_store_dwordx4 v[60:63], v244, s[20:23], s51 offen offset:1024 sc0 sc1
v_mfma_f32_16x16x32_bf16 v[176:179], a[88:91], v[24:27], 0
v_mfma_f32_16x16x32_bf16 v[168:171], a[88:91], v[8:11], 0
v_mfma_f32_16x16x32_bf16 v[172:175], a[92:95], v[8:11], 0
ds_read_b64_tr_b16 a[88:89], v237 offset:9352
ds_read_b64_tr_b16 a[90:91], v237 offset:13960
v_mfma_f32_16x16x32_bf16 v[180:183], a[92:95], v[24:27], 0
buffer_store_dwordx4 v[68:71], v244, s[20:23], s51 offen offset:3072 sc0 sc1
v_mfma_f32_16x16x32_bf16 v[188:191], a[92:95], v[40:43], 0
s_lshr_b32 s32, s35, 2
s_and_b32 s33, s35, 3
v_mfma_f32_16x16x32_bf16 v[196:199], a[92:95], v[56:59], 0
s_lshl_b32 s94, s36, 9
s_lshl_b32 s28, s32, 6
v_mfma_f32_16x16x32_bf16 v[212:215], a[64:67], v[56:59], 0
ds_read_b64_tr_b16 a[92:93], v238 offset:9344
ds_read_b64_tr_b16 a[94:95], v238 offset:13952
v_mfma_f32_16x16x32_bf16 v[208:211], a[64:67], v[40:43], 0
s_lshr_b32 s34, s32, 2
v_mfma_f32_16x16x32_bf16 v[204:207], a[64:67], v[24:27], 0
s_add_u32 s94, s94, s28
s_lshl_b32 s28, s37, 4
v_mfma_f32_16x16x32_bf16 v[200:203], a[64:67], v[8:11], 0
s_add_u32 s94, s94, s28
s_add_u32 s94, s94, 0x248000
s_waitcnt lgkmcnt(8)
v_mfma_f32_16x16x32_bf16 v[72:75], a[68:71], v[12:15], v[72:75]
ds_read_b64_tr_b16 a[64:65], v238 offset:9352
ds_read_b64_tr_b16 a[66:67], v238 offset:13960
v_mfma_f32_16x16x32_bf16 v[80:83], a[68:71], v[28:31], v[80:83]
v_mov_b32 v231, 1
v_and_b32 v229, 7, v1
v_mfma_f32_16x16x32_bf16 v[88:91], a[68:71], v[44:47], v[88:91]
v_lshlrev_b32 v229, 2, v229
v_lshlrev_b32 v226, 3, v1
v_mfma_f32_16x16x32_bf16 v[96:99], a[68:71], v[60:63], v[96:99]
s_lshl2_add_u32 s29, s33, s94
v_mfma_f32_16x16x32_bf16 v[100:103], a[72:75], v[60:63], v[100:103]
ds_read_b64_tr_b16 a[68:69], v239 offset:9216
ds_read_b64_tr_b16 a[70:71], v239 offset:13824
v_mfma_f32_16x16x32_bf16 v[92:95], a[72:75], v[44:47], v[92:95]
s_waitcnt vmcnt(0)
buffer_store_dword v231, v254, s[20:23], s29 offen sc0 sc1
v_mfma_f32_16x16x32_bf16 v[84:87], a[72:75], v[28:31], v[84:87]
s_add_u32 s28, s35, 1
s_and_b32 s28, s28, 3
v_mfma_f32_16x16x32_bf16 v[76:79], a[72:75], v[12:15], v[76:79]
s_mul_i32 s28, s28, 36864
v_mfma_f32_16x16x32_bf16 v[104:107], a[76:79], v[12:15], v[104:107]
ds_read_b64_tr_b16 a[72:73], v237 offset:18432
ds_read_b64_tr_b16 a[74:75], v237 offset:23040
v_mfma_f32_16x16x32_bf16 v[112:115], a[76:79], v[28:31], v[112:115]
v_add_u32 v216, s28, v234
v_add_u32 v217, s28, v235
v_mfma_f32_16x16x32_bf16 v[120:123], a[76:79], v[44:47], v[120:123]
v_add_u32 v218, s28, v236
v_mfma_f32_16x16x32_bf16 v[128:131], a[76:79], v[60:63], v[128:131]
s_waitcnt lgkmcnt(8)
v_mfma_f32_16x16x32_bf16 v[132:135], a[80:83], v[60:63], v[132:135]
ds_read_b64_tr_b16 a[76:77], v237 offset:18440
ds_read_b64_tr_b16 a[78:79], v237 offset:23048
v_mfma_f32_16x16x32_bf16 v[124:127], a[80:83], v[44:47], v[124:127]
v_mfma_f32_16x16x32_bf16 v[116:119], a[80:83], v[28:31], v[116:119]
v_mfma_f32_16x16x32_bf16 v[108:111], a[80:83], v[12:15], v[108:111]
v_mfma_f32_16x16x32_bf16 v[136:139], a[84:87], v[12:15], v[136:139]
ds_read_b64_tr_b16 a[80:81], v238 offset:18432
ds_read_b64_tr_b16 a[82:83], v238 offset:23040
v_mfma_f32_16x16x32_bf16 v[144:147], a[84:87], v[28:31], v[144:147]
buffer_load_dword v230, v229, s[20:23], s94 offen sc0 sc1
v_mfma_f32_16x16x32_bf16 v[152:155], a[84:87], v[44:47], v[152:155]
s_add_u32 s39, s35, 1
s_and_b32 s39, s39, 3
v_mfma_f32_16x16x32_bf16 v[160:163], a[84:87], v[60:63], v[160:163]
s_add_u32 s28, s33, 1
s_and_b32 s28, s28, 3
v_mfma_f32_16x16x32_bf16 v[164:167], a[88:91], v[60:63], v[164:167]
ds_read_b64_tr_b16 a[84:85], v238 offset:18440
ds_read_b64_tr_b16 a[86:87], v238 offset:23048
v_mfma_f32_16x16x32_bf16 v[156:159], a[88:91], v[44:47], v[156:159]
s_sub_u32 s28, s28, s33
s_lshl_b32 s28, s28, 16
v_mfma_f32_16x16x32_bf16 v[148:151], a[88:91], v[28:31], v[148:151]
s_add_u32 s64, s28, s44
s_add_u32 s65, s64, 4096
v_mfma_f32_16x16x32_bf16 v[140:143], a[88:91], v[12:15], v[140:143]
s_add_u32 s66, s64, 8192
s_add_u32 s67, s64, 12288
s_waitcnt lgkmcnt(8)
v_mfma_f32_16x16x32_bf16 v[168:171], a[92:95], v[12:15], v[168:171]
ds_read_b64_tr_b16 a[88:89], v237 offset:18560
ds_read_b64_tr_b16 a[90:91], v237 offset:23168
v_mfma_f32_16x16x32_bf16 v[176:179], a[92:95], v[28:31], v[176:179]
s_add_u32 s28, s35, 2
s_and_b32 s28, s28, 3
v_mfma_f32_16x16x32_bf16 v[184:187], a[92:95], v[44:47], v[184:187]
s_mul_i32 s28, s28, 36864
v_mfma_f32_16x16x32_bf16 v[192:195], a[92:95], v[60:63], v[192:195]
v_add_u32 v219, s28, v234
v_add_u32 v220, s28, v235
v_mfma_f32_16x16x32_bf16 v[196:199], a[64:67], v[60:63], v[196:199]
ds_read_b64_tr_b16 a[92:93], v237 offset:18568
ds_read_b64_tr_b16 a[94:95], v237 offset:23176
v_mfma_f32_16x16x32_bf16 v[188:191], a[64:67], v[44:47], v[188:191]
v_add_u32 v221, s28, v236
v_mfma_f32_16x16x32_bf16 v[180:183], a[64:67], v[28:31], v[180:183]
s_add_u32 s28, s35, 3
s_and_b32 s28, s28, 3
v_mfma_f32_16x16x32_bf16 v[172:175], a[64:67], v[12:15], v[172:175]
s_mul_i32 s28, s28, 36864
v_mfma_f32_16x16x32_bf16 v[200:203], a[68:71], v[12:15], v[200:203]
ds_read_b64_tr_b16 a[64:65], v238 offset:18560
ds_read_b64_tr_b16 a[66:67], v238 offset:23168
v_mfma_f32_16x16x32_bf16 v[204:207], a[68:71], v[28:31], v[204:207]
v_add_u32 v222, s28, v234
v_add_u32 v223, s28, v235
v_mfma_f32_16x16x32_bf16 v[208:211], a[68:71], v[44:47], v[208:211]
v_add_u32 v224, s28, v236
v_mfma_f32_16x16x32_bf16 v[212:215], a[68:71], v[60:63], v[212:215]
s_waitcnt lgkmcnt(8)
v_mfma_f32_16x16x32_bf16 v[96:99], a[72:75], v[64:67], v[96:99]
ds_read_b64_tr_b16 a[68:69], v238 offset:18568
ds_read_b64_tr_b16 a[70:71], v238 offset:23176
v_mfma_f32_16x16x32_bf16 v[88:91], a[72:75], v[48:51], v[88:91]
v_mfma_f32_16x16x32_bf16 v[80:83], a[72:75], v[32:35], v[80:83]
s_waitcnt vmcnt(0)
v_cmp_gt_u32 vcc, 1, v230
v_mfma_f32_16x16x32_bf16 v[72:75], a[72:75], v[16:19], v[72:75]
v_mfma_f32_16x16x32_bf16 v[76:79], a[76:79], v[16:19], v[76:79]
ds_read_b64_tr_b16 a[72:73], v239 offset:18432
ds_read_b64_tr_b16 a[74:75], v239 offset:23040
v_mfma_f32_16x16x32_bf16 v[84:87], a[76:79], v[32:35], v[84:87]
s_bitcmp1_b32 vcc_lo, s39
s_cbranch_scc1 SP_O1B
SP_O1B_RET:
v_mfma_f32_16x16x32_bf16 v[92:95], a[76:79], v[48:51], v[92:95]
buffer_load_dwordx4 a[128:131], v244, s[20:23], s64 offen offset:0 sc0 sc1
v_mfma_f32_16x16x32_bf16 v[100:103], a[76:79], v[64:67], v[100:103]
v_mfma_f32_16x16x32_bf16 v[128:131], a[80:83], v[64:67], v[128:131]
ds_read_b64_tr_b16 a[76:77], v237 offset:27648
ds_read_b64_tr_b16 a[78:79], v237 offset:32256
v_mfma_f32_16x16x32_bf16 v[120:123], a[80:83], v[48:51], v[120:123]
v_mfma_f32_16x16x32_bf16 v[112:115], a[80:83], v[32:35], v[112:115]
buffer_load_dwordx4 a[144:147], v244, s[20:23], s65 offen offset:0 sc0 sc1
v_mfma_f32_16x16x32_bf16 v[104:107], a[80:83], v[16:19], v[104:107]
s_waitcnt lgkmcnt(8)
v_mfma_f32_16x16x32_bf16 v[108:111], a[84:87], v[16:19], v[108:111]
ds_read_b64_tr_b16 a[80:81], v237 offset:27656
ds_read_b64_tr_b16 a[82:83], v237 offset:32264
v_mfma_f32_16x16x32_bf16 v[116:119], a[84:87], v[32:35], v[116:119]
v_mfma_f32_16x16x32_bf16 v[124:127], a[84:87], v[48:51], v[124:127]
buffer_load_dwordx4 a[160:163], v244, s[20:23], s66 offen offset:0 sc0 sc1
v_mfma_f32_16x16x32_bf16 v[132:135], a[84:87], v[64:67], v[132:135]
v_mfma_f32_16x16x32_bf16 v[160:163], a[88:91], v[64:67], v[160:163]
ds_read_b64_tr_b16 a[84:85], v238 offset:27648
ds_read_b64_tr_b16 a[86:87], v238 offset:32256
v_mfma_f32_16x16x32_bf16 v[152:155], a[88:91], v[48:51], v[152:155]
v_mfma_f32_16x16x32_bf16 v[144:147], a[88:91], v[32:35], v[144:147]
buffer_load_dwordx4 a[176:179], v244, s[20:23], s67 offen offset:0 sc0 sc1
v_mfma_f32_16x16x32_bf16 v[136:139], a[88:91], v[16:19], v[136:139]
v_mfma_f32_16x16x32_bf16 v[140:143], a[92:95], v[16:19], v[140:143]
ds_read_b64_tr_b16 a[88:89], v238 offset:27656
ds_read_b64_tr_b16 a[90:91], v238 offset:32264
v_mfma_f32_16x16x32_bf16 v[148:151], a[92:95], v[32:35], v[148:151]
v_mfma_f32_16x16x32_bf16 v[156:159], a[92:95], v[48:51], v[156:159]
buffer_load_dwordx4 a[132:135], v244, s[20:23], s64 offen offset:1024 sc0 sc1
v_mfma_f32_16x16x32_bf16 v[164:167], a[92:95], v[64:67], v[164:167]
s_waitcnt lgkmcnt(8)
v_mfma_f32_16x16x32_bf16 v[192:195], a[64:67], v[64:67], v[192:195]
ds_read_b64_tr_b16 a[92:93], v237 offset:27776
ds_read_b64_tr_b16 a[94:95], v237 offset:32384
v_mfma_f32_16x16x32_bf16 v[184:187], a[64:67], v[48:51], v[184:187]
v_mfma_f32_16x16x32_bf16 v[176:179], a[64:67], v[32:35], v[176:179]
buffer_load_dwordx4 a[148:151], v244, s[20:23], s65 offen offset:1024 sc0 sc1
v_mfma_f32_16x16x32_bf16 v[168:171], a[64:67], v[16:19], v[168:171]
v_mfma_f32_16x16x32_bf16 v[172:175], a[68:71], v[16:19], v[172:175]
ds_read_b64_tr_b16 a[64:65], v237 offset:27784
ds_read_b64_tr_b16 a[66:67], v237 offset:32392
v_mfma_f32_16x16x32_bf16 v[180:183], a[68:71], v[32:35], v[180:183]
v_mfma_f32_16x16x32_bf16 v[188:191], a[68:71], v[48:51], v[188:191]
buffer_load_dwordx4 a[164:167], v244, s[20:23], s66 offen offset:1024 sc0 sc1
v_mfma_f32_16x16x32_bf16 v[196:199], a[68:71], v[64:67], v[196:199]
v_mfma_f32_16x16x32_bf16 v[212:215], a[72:75], v[64:67], v[212:215]
ds_read_b64_tr_b16 a[68:69], v238 offset:27776
ds_read_b64_tr_b16 a[70:71], v238 offset:32384
v_mfma_f32_16x16x32_bf16 v[208:211], a[72:75], v[48:51], v[208:211]
v_mfma_f32_16x16x32_bf16 v[204:207], a[72:75], v[32:35], v[204:207]
buffer_load_dwordx4 a[180:183], v244, s[20:23], s67 offen offset:1024 sc0 sc1
v_mfma_f32_16x16x32_bf16 v[200:203], a[72:75], v[16:19], v[200:203]
s_waitcnt lgkmcnt(8)
v_mfma_f32_16x16x32_bf16 v[72:75], a[76:79], v[20:23], v[72:75]
ds_read_b64_tr_b16 a[72:73], v238 offset:27784
ds_read_b64_tr_b16 a[74:75], v238 offset:32392
v_mfma_f32_16x16x32_bf16 v[80:83], a[76:79], v[36:39], v[80:83]
v_mfma_f32_16x16x32_bf16 v[88:91], a[76:79], v[52:55], v[88:91]
buffer_load_dwordx4 a[136:139], v244, s[20:23], s64 offen offset:2048 sc0 sc1
v_mfma_f32_16x16x32_bf16 v[96:99], a[76:79], v[68:71], v[96:99]
buffer_load_dword v230, v229, s[20:23], s94 offen sc0 sc1
v_mfma_f32_16x16x32_bf16 v[100:103], a[80:83], v[68:71], v[100:103]
ds_read_b64_tr_b16 a[76:77], v239 offset:27648
ds_read_b64_tr_b16 a[78:79], v239 offset:32256
v_mfma_f32_16x16x32_bf16 v[92:95], a[80:83], v[52:55], v[92:95]
v_mfma_f32_16x16x32_bf16 v[84:87], a[80:83], v[36:39], v[84:87]
v_mfma_f32_16x16x32_bf16 v[76:79], a[80:83], v[20:23], v[76:79]
buffer_load_dwordx4 a[152:155], v244, s[20:23], s65 offen offset:2048 sc0 sc1
v_mfma_f32_16x16x32_bf16 v[104:107], a[84:87], v[20:23], v[104:107]
ds_read_b64_tr_b16 a[80:81], v216 offset:0
ds_read_b64_tr_b16 a[82:83], v216 offset:4608
v_mfma_f32_16x16x32_bf16 v[112:115], a[84:87], v[36:39], v[112:115]
v_mfma_f32_16x16x32_bf16 v[120:123], a[84:87], v[52:55], v[120:123]
v_mfma_f32_16x16x32_bf16 v[128:131], a[84:87], v[68:71], v[128:131]
buffer_load_dwordx4 a[168:171], v244, s[20:23], s66 offen offset:2048 sc0 sc1
s_waitcnt lgkmcnt(8)
v_mfma_f32_16x16x32_bf16 v[132:135], a[88:91], v[68:71], v[132:135]
ds_read_b64_tr_b16 a[84:85], v216 offset:8
ds_read_b64_tr_b16 a[86:87], v216 offset:4616
v_mfma_f32_16x16x32_bf16 v[124:127], a[88:91], v[52:55], v[124:127]
v_mfma_f32_16x16x32_bf16 v[116:119], a[88:91], v[36:39], v[116:119]
v_mfma_f32_16x16x32_bf16 v[108:111], a[88:91], v[20:23], v[108:111]
buffer_load_dwordx4 a[184:187], v244, s[20:23], s67 offen offset:2048 sc0 sc1
v_mfma_f32_16x16x32_bf16 v[136:139], a[92:95], v[20:23], v[136:139]
ds_read_b64_tr_b16 a[88:89], v217 offset:0
ds_read_b64_tr_b16 a[90:91], v217 offset:4608
v_mfma_f32_16x16x32_bf16 v[144:147], a[92:95], v[36:39], v[144:147]
v_mfma_f32_16x16x32_bf16 v[152:155], a[92:95], v[52:55], v[152:155]
v_mfma_f32_16x16x32_bf16 v[160:163], a[92:95], v[68:71], v[160:163]
buffer_load_dwordx4 a[140:143], v244, s[20:23], s64 offen offset:3072 sc0 sc1
v_mfma_f32_16x16x32_bf16 v[164:167], a[64:67], v[68:71], v[164:167]
ds_read_b64_tr_b16 a[92:93], v217 offset:8
ds_read_b64_tr_b16 a[94:95], v217 offset:4616
v_mfma_f32_16x16x32_bf16 v[156:159], a[64:67], v[52:55], v[156:159]
v_mfma_f32_16x16x32_bf16 v[148:151], a[64:67], v[36:39], v[148:151]
v_mfma_f32_16x16x32_bf16 v[140:143], a[64:67], v[20:23], v[140:143]
buffer_load_dwordx4 a[156:159], v244, s[20:23], s65 offen offset:3072 sc0 sc1
s_waitcnt lgkmcnt(8)
v_mfma_f32_16x16x32_bf16 v[168:171], a[68:71], v[20:23], v[168:171]
ds_read_b64_tr_b16 a[64:65], v216 offset:128
ds_read_b64_tr_b16 a[66:67], v216 offset:4736
v_mfma_f32_16x16x32_bf16 v[176:179], a[68:71], v[36:39], v[176:179]
v_mfma_f32_16x16x32_bf16 v[184:187], a[68:71], v[52:55], v[184:187]
v_mfma_f32_16x16x32_bf16 v[192:195], a[68:71], v[68:71], v[192:195]
buffer_load_dwordx4 a[172:175], v244, s[20:23], s66 offen offset:3072 sc0 sc1
v_mfma_f32_16x16x32_bf16 v[196:199], a[72:75], v[68:71], v[196:199]
ds_read_b64_tr_b16 a[68:69], v216 offset:136
ds_read_b64_tr_b16 a[70:71], v216 offset:4744
v_mfma_f32_16x16x32_bf16 v[188:191], a[72:75], v[52:55], v[188:191]
v_mfma_f32_16x16x32_bf16 v[180:183], a[72:75], v[36:39], v[180:183]
v_mfma_f32_16x16x32_bf16 v[172:175], a[72:75], v[20:23], v[172:175]
buffer_load_dwordx4 a[188:191], v244, s[20:23], s67 offen offset:3072 sc0 sc1
v_mfma_f32_16x16x32_bf16 v[200:203], a[76:79], v[20:23], v[200:203]
ds_read_b64_tr_b16 a[72:73], v217 offset:128
ds_read_b64_tr_b16 a[74:75], v217 offset:4736
v_mfma_f32_16x16x32_bf16 v[204:207], a[76:79], v[36:39], v[204:207]
s_add_u32 s28, s33, 2
s_and_b32 s28, s28, 3
v_mfma_f32_16x16x32_bf16 v[208:211], a[76:79], v[52:55], v[208:211]
s_sub_u32 s28, s28, s33
s_lshl_b32 s28, s28, 16
v_mfma_f32_16x16x32_bf16 v[212:215], a[76:79], v[68:71], v[212:215]
s_add_u32 s64, s28, s44
s_add_u32 s65, s64, 4096
s_waitcnt vmcnt(13)
s_waitcnt lgkmcnt(8)
v_mfma_f32_16x16x32_bf16 v[96:99], a[80:83], a[176:179], v[96:99]
ds_read_b64_tr_b16 a[76:77], v217 offset:136
ds_read_b64_tr_b16 a[78:79], v217 offset:4744
v_mfma_f32_16x16x32_bf16 v[88:91], a[80:83], a[160:163], v[88:91]
s_add_u32 s66, s64, 8192
s_add_u32 s67, s64, 12288
v_mfma_f32_16x16x32_bf16 v[80:83], a[80:83], a[144:147], v[80:83]
s_waitcnt vmcnt(7)
v_cmp_gt_u32 vcc, 1, v230
v_mfma_f32_16x16x32_bf16 v[72:75], a[80:83], a[128:131], v[72:75]
v_accvgpr_read_b32 v39, a222
v_accvgpr_read_b32 v59, a232
v_mfma_f32_16x16x32_bf16 v[76:79], a[84:87], a[128:131], v[76:79]
ds_read_b64_tr_b16 a[80:81], v218 offset:0
ds_read_b64_tr_b16 a[82:83], v218 offset:4608
v_mfma_f32_16x16x32_bf16 v[84:87], a[84:87], a[144:147], v[84:87]
s_and_b32 s29, vcc_lo, 15
s_cbranch_scc1 SP_O2B
SP_O2B_RET:
v_mfma_f32_16x16x32_bf16 v[92:95], a[84:87], a[160:163], v[92:95]
buffer_load_dwordx4 a[192:195], v244, s[20:23], s64 offen offset:0 sc0 sc1
v_mfma_f32_16x16x32_bf16 v[100:103], a[84:87], a[176:179], v[100:103]
v_lshlrev_b32 v38, 16, v39
v_and_b32 v39, 0xffff0000, v39
v_mfma_f32_16x16x32_bf16 v[128:131], a[88:91], a[176:179], v[128:131]
ds_read_b64_tr_b16 a[84:85], v216 offset:9216
ds_read_b64_tr_b16 a[86:87], v216 offset:13824
v_mfma_f32_16x16x32_bf16 v[120:123], a[88:91], a[160:163], v[120:123]
v_lshlrev_b32 v58, 16, v59
v_and_b32 v59, 0xffff0000, v59
v_mfma_f32_16x16x32_bf16 v[112:115], a[88:91], a[144:147], v[112:115]
buffer_load_dwordx4 a[208:211], v244, s[20:23], s65 offen offset:0 sc0 sc1
v_mfma_f32_16x16x32_bf16 v[104:107], a[88:91], a[128:131], v[104:107]
v_add_f32 v38, v38, v58
v_add_f32 v39, v39, v59
s_waitcnt lgkmcnt(8)
v_mfma_f32_16x16x32_bf16 v[108:111], a[92:95], a[128:131], v[108:111]
ds_read_b64_tr_b16 a[88:89], v216 offset:9224
ds_read_b64_tr_b16 a[90:91], v216 offset:13832
v_mfma_f32_16x16x32_bf16 v[116:119], a[92:95], a[144:147], v[116:119]
v_cvt_pk_bf16_f32 v58, v38, v39
v_lshlrev_b32 v38, 16, v58
v_mfma_f32_16x16x32_bf16 v[124:127], a[92:95], a[160:163], v[124:127]
buffer_load_dwordx4 a[96:99], v244, s[20:23], s66 offen offset:0 sc0 sc1
v_mfma_f32_16x16x32_bf16 v[132:135], a[92:95], a[176:179], v[132:135]
v_and_b32 v39, 0xffff0000, v58
v_mul_f32 v58, 0xbfb8aa3b, v38
v_mfma_f32_16x16x32_bf16 v[160:163], a[64:67], a[176:179], v[160:163]
ds_read_b64_tr_b16 a[92:93], v217 offset:9216
ds_read_b64_tr_b16 a[94:95], v217 offset:13824
v_mfma_f32_16x16x32_bf16 v[152:155], a[64:67], a[160:163], v[152:155]
v_mul_f32 v59, 0xbfb8aa3b, v39
v_mfma_f32_16x16x32_bf16 v[144:147], a[64:67], a[144:147], v[144:147]
buffer_load_dwordx4 a[112:115], v244, s[20:23], s67 offen offset:0 sc0 sc1
v_mfma_f32_16x16x32_bf16 v[136:139], a[64:67], a[128:131], v[136:139]
v_exp_f32 v58, v58
v_mfma_f32_16x16x32_bf16 v[140:143], a[68:71], a[128:131], v[140:143]
ds_read_b64_tr_b16 a[64:65], v217 offset:9224
ds_read_b64_tr_b16 a[66:67], v217 offset:13832
v_mfma_f32_16x16x32_bf16 v[148:151], a[68:71], a[144:147], v[148:151]
v_exp_f32 v59, v59
v_mfma_f32_16x16x32_bf16 v[156:159], a[68:71], a[160:163], v[156:159]
buffer_load_dwordx4 a[196:199], v244, s[20:23], s64 offen offset:1024 sc0 sc1
v_mfma_f32_16x16x32_bf16 v[164:167], a[68:71], a[176:179], v[164:167]
v_add_f32 v58, 1.0, v58
v_add_f32 v59, 1.0, v59
s_waitcnt lgkmcnt(8)
v_mfma_f32_16x16x32_bf16 v[192:195], a[72:75], a[176:179], v[192:195]
ds_read_b64_tr_b16 a[68:69], v216 offset:9344
ds_read_b64_tr_b16 a[70:71], v216 offset:13952
v_mfma_f32_16x16x32_bf16 v[184:187], a[72:75], a[160:163], v[184:187]
v_rcp_f32 v58, v58
v_mfma_f32_16x16x32_bf16 v[176:179], a[72:75], a[144:147], v[176:179]
buffer_load_dwordx4 a[244:247], v244, s[20:23], s65 offen offset:1024 sc0 sc1
v_mfma_f32_16x16x32_bf16 v[168:171], a[72:75], a[128:131], v[168:171]
v_rcp_f32 v59, v59
v_mfma_f32_16x16x32_bf16 v[172:175], a[76:79], a[128:131], v[172:175]
ds_read_b64_tr_b16 a[72:73], v216 offset:9352
ds_read_b64_tr_b16 a[74:75], v216 offset:13960
v_mfma_f32_16x16x32_bf16 v[180:183], a[76:79], a[144:147], v[180:183]
v_mul_f32 v38, v38, v58
v_mul_f32 v39, v39, v59
v_mfma_f32_16x16x32_bf16 v[188:191], a[76:79], a[160:163], v[188:191]
buffer_load_dwordx4 a[100:103], v244, s[20:23], s66 offen offset:1024 sc0 sc1
v_mfma_f32_16x16x32_bf16 v[196:199], a[76:79], a[176:179], v[196:199]
v_cvt_pk_bf16_f32 v58, v38, v39
v_lshlrev_b32 v38, 16, v58
v_mfma_f32_16x16x32_bf16 v[212:215], a[80:83], a[176:179], v[212:215]
ds_read_b64_tr_b16 a[76:77], v217 offset:9344
ds_read_b64_tr_b16 a[78:79], v217 offset:13952
v_mfma_f32_16x16x32_bf16 v[208:211], a[80:83], a[160:163], v[208:211]
v_and_b32 v39, 0xffff0000, v58
v_accvgpr_read_b32 v41, a223
v_mfma_f32_16x16x32_bf16 v[204:207], a[80:83], a[144:147], v[204:207]
buffer_load_dwordx4 a[116:119], v244, s[20:23], s67 offen offset:1024 sc0 sc1
v_mfma_f32_16x16x32_bf16 v[200:203], a[80:83], a[128:131], v[200:203]
v_accvgpr_read_b32 v59, a233
v_lshlrev_b32 v40, 16, v41
s_waitcnt vmcnt(17)
s_waitcnt lgkmcnt(8)
v_mfma_f32_16x16x32_bf16 v[72:75], a[84:87], a[132:135], v[72:75]
ds_read_b64_tr_b16 a[80:81], v217 offset:9352
ds_read_b64_tr_b16 a[82:83], v217 offset:13960
v_mfma_f32_16x16x32_bf16 v[80:83], a[84:87], a[148:151], v[80:83]
v_and_b32 v41, 0xffff0000, v41
v_lshlrev_b32 v58, 16, v59
v_mfma_f32_16x16x32_bf16 v[88:91], a[84:87], a[164:167], v[88:91]
buffer_load_dwordx4 a[200:203], v244, s[20:23], s64 offen offset:2048 sc0 sc1
v_mfma_f32_16x16x32_bf16 v[96:99], a[84:87], a[180:183], v[96:99]
v_and_b32 v59, 0xffff0000, v59
v_add_f32 v40, v40, v58
v_mfma_f32_16x16x32_bf16 v[100:103], a[88:91], a[180:183], v[100:103]
ds_read_b64_tr_b16 a[84:85], v218 offset:9216
ds_read_b64_tr_b16 a[86:87], v218 offset:13824
v_mfma_f32_16x16x32_bf16 v[92:95], a[88:91], a[164:167], v[92:95]
v_add_f32 v41, v41, v59
v_cvt_pk_bf16_f32 v58, v40, v41
v_mfma_f32_16x16x32_bf16 v[84:87], a[88:91], a[148:151], v[84:87]
buffer_load_dwordx4 a[248:251], v244, s[20:23], s65 offen offset:2048 sc0 sc1
v_mfma_f32_16x16x32_bf16 v[76:79], a[88:91], a[132:135], v[76:79]
v_lshlrev_b32 v40, 16, v58
v_and_b32 v41, 0xffff0000, v58
v_mfma_f32_16x16x32_bf16 v[104:107], a[92:95], a[132:135], v[104:107]
ds_read_b64_tr_b16 a[88:89], v216 offset:18432
ds_read_b64_tr_b16 a[90:91], v216 offset:23040
v_mfma_f32_16x16x32_bf16 v[112:115], a[92:95], a[148:151], v[112:115]
v_mul_f32 v58, 0xbfb8aa3b, v40
v_mul_f32 v59, 0xbfb8aa3b, v41
v_mfma_f32_16x16x32_bf16 v[120:123], a[92:95], a[164:167], v[120:123]
buffer_load_dwordx4 a[104:107], v244, s[20:23], s66 offen offset:2048 sc0 sc1
v_mfma_f32_16x16x32_bf16 v[128:131], a[92:95], a[180:183], v[128:131]
v_exp_f32 v58, v58
s_waitcnt lgkmcnt(8)
v_mfma_f32_16x16x32_bf16 v[132:135], a[64:67], a[180:183], v[132:135]
ds_read_b64_tr_b16 a[92:93], v216 offset:18440
ds_read_b64_tr_b16 a[94:95], v216 offset:23048
v_mfma_f32_16x16x32_bf16 v[124:127], a[64:67], a[164:167], v[124:127]
v_exp_f32 v59, v59
v_mfma_f32_16x16x32_bf16 v[116:119], a[64:67], a[148:151], v[116:119]
buffer_load_dwordx4 a[120:123], v244, s[20:23], s67 offen offset:2048 sc0 sc1
v_mfma_f32_16x16x32_bf16 v[108:111], a[64:67], a[132:135], v[108:111]
v_add_f32 v58, 1.0, v58
v_add_f32 v59, 1.0, v59
v_mfma_f32_16x16x32_bf16 v[136:139], a[68:71], a[132:135], v[136:139]
ds_read_b64_tr_b16 a[64:65], v217 offset:18432
ds_read_b64_tr_b16 a[66:67], v217 offset:23040
v_mfma_f32_16x16x32_bf16 v[144:147], a[68:71], a[148:151], v[144:147]
v_rcp_f32 v58, v58
v_mfma_f32_16x16x32_bf16 v[152:155], a[68:71], a[164:167], v[152:155]
buffer_load_dwordx4 a[204:207], v244, s[20:23], s64 offen offset:3072 sc0 sc1
v_mfma_f32_16x16x32_bf16 v[160:163], a[68:71], a[180:183], v[160:163]
v_rcp_f32 v59, v59
v_mfma_f32_16x16x32_bf16 v[164:167], a[72:75], a[180:183], v[164:167]
ds_read_b64_tr_b16 a[68:69], v217 offset:18440
ds_read_b64_tr_b16 a[70:71], v217 offset:23048
v_mfma_f32_16x16x32_bf16 v[156:159], a[72:75], a[164:167], v[156:159]
v_mul_f32 v40, v40, v58
v_mul_f32 v41, v41, v59
v_mfma_f32_16x16x32_bf16 v[148:151], a[72:75], a[148:151], v[148:151]
buffer_load_dwordx4 a[252:255], v244, s[20:23], s65 offen offset:3072 sc0 sc1
v_mfma_f32_16x16x32_bf16 v[140:143], a[72:75], a[132:135], v[140:143]
v_cvt_pk_bf16_f32 v58, v40, v41
v_lshlrev_b32 v40, 16, v58
s_waitcnt lgkmcnt(8)
v_mfma_f32_16x16x32_bf16 v[168:171], a[76:79], a[132:135], v[168:171]
ds_read_b64_tr_b16 a[72:73], v216 offset:18560
ds_read_b64_tr_b16 a[74:75], v216 offset:23168
v_mfma_f32_16x16x32_bf16 v[176:179], a[76:79], a[148:151], v[176:179]
v_and_b32 v41, 0xffff0000, v58
v_accvgpr_read_b32 v43, a224
v_mfma_f32_16x16x32_bf16 v[184:187], a[76:79], a[164:167], v[184:187]
buffer_load_dwordx4 a[108:111], v244, s[20:23], s66 offen offset:3072 sc0 sc1
v_mfma_f32_16x16x32_bf16 v[192:195], a[76:79], a[180:183], v[192:195]
v_accvgpr_read_b32 v59, a234
v_lshlrev_b32 v42, 16, v43
v_mfma_f32_16x16x32_bf16 v[196:199], a[80:83], a[180:183], v[196:199]
ds_read_b64_tr_b16 a[76:77], v216 offset:18568
ds_read_b64_tr_b16 a[78:79], v216 offset:23176
v_mfma_f32_16x16x32_bf16 v[188:191], a[80:83], a[164:167], v[188:191]
v_and_b32 v43, 0xffff0000, v43
v_lshlrev_b32 v58, 16, v59
v_mfma_f32_16x16x32_bf16 v[180:183], a[80:83], a[148:151], v[180:183]
buffer_load_dwordx4 a[124:127], v244, s[20:23], s67 offen offset:3072 sc0 sc1
v_mfma_f32_16x16x32_bf16 v[172:175], a[80:83], a[132:135], v[172:175]
s_add_u32 s28, s33, 3
s_and_b32 s28, s28, 3
v_mfma_f32_16x16x32_bf16 v[200:203], a[84:87], a[132:135], v[200:203]
ds_read_b64_tr_b16 a[80:81], v217 offset:18560
ds_read_b64_tr_b16 a[82:83], v217 offset:23168
v_mfma_f32_16x16x32_bf16 v[204:207], a[84:87], a[148:151], v[204:207]
s_sub_u32 s28, s28, s33
s_lshl_b32 s28, s28, 16
v_mfma_f32_16x16x32_bf16 v[208:211], a[84:87], a[164:167], v[208:211]
s_add_u32 s64, s28, s44
s_add_u32 s65, s64, 4096
v_mfma_f32_16x16x32_bf16 v[212:215], a[84:87], a[180:183], v[212:215]
s_add_u32 s66, s64, 8192
s_add_u32 s67, s64, 12288
s_waitcnt vmcnt(20)
s_waitcnt lgkmcnt(8)
v_mfma_f32_16x16x32_bf16 v[96:99], a[88:91], a[184:187], v[96:99]
ds_read_b64_tr_b16 a[84:85], v217 offset:18568
ds_read_b64_tr_b16 a[86:87], v217 offset:23176
v_mfma_f32_16x16x32_bf16 v[88:91], a[88:91], a[168:171], v[88:91]
buffer_load_dwordx4 a[0:3], v244, s[20:23], s64 offen offset:0 sc0 sc1
v_mfma_f32_16x16x32_bf16 v[80:83], a[88:91], a[152:155], v[80:83]
v_and_b32 v59, 0xffff0000, v59
v_add_f32 v42, v42, v58
v_mfma_f32_16x16x32_bf16 v[72:75], a[88:91], a[136:139], v[72:75]
v_add_f32 v43, v43, v59
v_cvt_pk_bf16_f32 v58, v42, v43
v_mfma_f32_16x16x32_bf16 v[76:79], a[92:95], a[136:139], v[76:79]
ds_read_b64_tr_b16 a[88:89], v218 offset:18432
ds_read_b64_tr_b16 a[90:91], v218 offset:23040
v_mfma_f32_16x16x32_bf16 v[84:87], a[92:95], a[152:155], v[84:87]
buffer_load_dwordx4 a[16:19], v244, s[20:23], s65 offen offset:0 sc0 sc1
v_mfma_f32_16x16x32_bf16 v[92:95], a[92:95], a[168:171], v[92:95]
v_lshlrev_b32 v42, 16, v58
v_and_b32 v43, 0xffff0000, v58
v_mfma_f32_16x16x32_bf16 v[100:103], a[92:95], a[184:187], v[100:103]
v_mul_f32 v58, 0xbfb8aa3b, v42
v_mul_f32 v59, 0xbfb8aa3b, v43
v_mfma_f32_16x16x32_bf16 v[128:131], a[64:67], a[184:187], v[128:131]
ds_read_b64_tr_b16 a[92:93], v216 offset:27648
ds_read_b64_tr_b16 a[94:95], v216 offset:32256
v_mfma_f32_16x16x32_bf16 v[120:123], a[64:67], a[168:171], v[120:123]
buffer_load_dwordx4 a[32:35], v244, s[20:23], s66 offen offset:0 sc0 sc1
v_mfma_f32_16x16x32_bf16 v[112:115], a[64:67], a[152:155], v[112:115]
v_exp_f32 v58, v58
v_mfma_f32_16x16x32_bf16 v[104:107], a[64:67], a[136:139], v[104:107]
v_exp_f32 v59, v59
s_waitcnt lgkmcnt(8)
v_mfma_f32_16x16x32_bf16 v[108:111], a[68:71], a[136:139], v[108:111]
ds_read_b64_tr_b16 a[64:65], v216 offset:27656
ds_read_b64_tr_b16 a[66:67], v216 offset:32264
v_mfma_f32_16x16x32_bf16 v[116:119], a[68:71], a[152:155], v[116:119]
buffer_load_dwordx4 a[48:51], v244, s[20:23], s67 offen offset:0 sc0 sc1
v_mfma_f32_16x16x32_bf16 v[124:127], a[68:71], a[168:171], v[124:127]
v_add_f32 v58, 1.0, v58
v_add_f32 v59, 1.0, v59
v_mfma_f32_16x16x32_bf16 v[132:135], a[68:71], a[184:187], v[132:135]
v_rcp_f32 v58, v58
v_mfma_f32_16x16x32_bf16 v[160:163], a[72:75], a[184:187], v[160:163]
ds_read_b64_tr_b16 a[68:69], v217 offset:27648
ds_read_b64_tr_b16 a[70:71], v217 offset:32256
v_mfma_f32_16x16x32_bf16 v[152:155], a[72:75], a[168:171], v[152:155]
buffer_load_dwordx4 a[4:7], v244, s[20:23], s64 offen offset:1024 sc0 sc1
v_mfma_f32_16x16x32_bf16 v[144:147], a[72:75], a[152:155], v[144:147]
v_rcp_f32 v59, v59
v_mfma_f32_16x16x32_bf16 v[136:139], a[72:75], a[136:139], v[136:139]
v_mul_f32 v42, v42, v58
v_mul_f32 v43, v43, v59
v_mfma_f32_16x16x32_bf16 v[140:143], a[76:79], a[136:139], v[140:143]
ds_read_b64_tr_b16 a[72:73], v217 offset:27656
ds_read_b64_tr_b16 a[74:75], v217 offset:32264
v_mfma_f32_16x16x32_bf16 v[148:151], a[76:79], a[152:155], v[148:151]
buffer_load_dwordx4 a[20:23], v244, s[20:23], s65 offen offset:1024 sc0 sc1
v_mfma_f32_16x16x32_bf16 v[156:159], a[76:79], a[168:171], v[156:159]
v_cvt_pk_bf16_f32 v58, v42, v43
v_lshlrev_b32 v42, 16, v58
v_mfma_f32_16x16x32_bf16 v[164:167], a[76:79], a[184:187], v[164:167]
v_and_b32 v43, 0xffff0000, v58
v_accvgpr_read_b32 v45, a225
s_waitcnt lgkmcnt(8)
v_mfma_f32_16x16x32_bf16 v[192:195], a[80:83], a[184:187], v[192:195]
ds_read_b64_tr_b16 a[76:77], v216 offset:27776
ds_read_b64_tr_b16 a[78:79], v216 offset:32384
v_mfma_f32_16x16x32_bf16 v[184:187], a[80:83], a[168:171], v[184:187]
buffer_load_dwordx4 a[36:39], v244, s[20:23], s66 offen offset:1024 sc0 sc1
v_mfma_f32_16x16x32_bf16 v[176:179], a[80:83], a[152:155], v[176:179]
v_accvgpr_read_b32 v59, a235
v_lshlrev_b32 v44, 16, v45
v_mfma_f32_16x16x32_bf16 v[168:171], a[80:83], a[136:139], v[168:171]
v_and_b32 v45, 0xffff0000, v45
v_lshlrev_b32 v58, 16, v59
v_mfma_f32_16x16x32_bf16 v[172:175], a[84:87], a[136:139], v[172:175]
ds_read_b64_tr_b16 a[80:81], v216 offset:27784
ds_read_b64_tr_b16 a[82:83], v216 offset:32392
v_mfma_f32_16x16x32_bf16 v[180:183], a[84:87], a[152:155], v[180:183]
buffer_load_dwordx4 a[52:55], v244, s[20:23], s67 offen offset:1024 sc0 sc1
v_mfma_f32_16x16x32_bf16 v[188:191], a[84:87], a[168:171], v[188:191]
v_and_b32 v59, 0xffff0000, v59
v_add_f32 v44, v44, v58
v_mfma_f32_16x16x32_bf16 v[196:199], a[84:87], a[184:187], v[196:199]
v_add_f32 v45, v45, v59
v_cvt_pk_bf16_f32 v58, v44, v45
v_mfma_f32_16x16x32_bf16 v[212:215], a[88:91], a[184:187], v[212:215]
ds_read_b64_tr_b16 a[84:85], v217 offset:27776
ds_read_b64_tr_b16 a[86:87], v217 offset:32384
v_mfma_f32_16x16x32_bf16 v[208:211], a[88:91], a[168:171], v[208:211]
buffer_load_dwordx4 a[8:11], v244, s[20:23], s64 offen offset:2048 sc0 sc1
v_mfma_f32_16x16x32_bf16 v[204:207], a[88:91], a[152:155], v[204:207]
v_lshlrev_b32 v44, 16, v58
v_and_b32 v45, 0xffff0000, v58
v_mfma_f32_16x16x32_bf16 v[200:203], a[88:91], a[136:139], v[200:203]
v_mul_f32 v58, 0xbfb8aa3b, v44
v_mul_f32 v59, 0xbfb8aa3b, v45
s_waitcnt vmcnt(25)
s_waitcnt lgkmcnt(8)
v_mfma_f32_16x16x32_bf16 v[72:75], a[92:95], a[140:143], v[72:75]
ds_read_b64_tr_b16 a[88:89], v217 offset:27784
ds_read_b64_tr_b16 a[90:91], v217 offset:32392
v_mfma_f32_16x16x32_bf16 v[80:83], a[92:95], a[156:159], v[80:83]
buffer_load_dwordx4 a[24:27], v244, s[20:23], s65 offen offset:2048 sc0 sc1
v_mfma_f32_16x16x32_bf16 v[88:91], a[92:95], a[172:175], v[88:91]
v_exp_f32 v58, v58
v_mfma_f32_16x16x32_bf16 v[96:99], a[92:95], a[188:191], v[96:99]
v_exp_f32 v59, v59
v_mfma_f32_16x16x32_bf16 v[100:103], a[64:67], a[188:191], v[100:103]
ds_read_b64_tr_b16 a[92:93], v218 offset:27648
ds_read_b64_tr_b16 a[94:95], v218 offset:32256
v_mfma_f32_16x16x32_bf16 v[92:95], a[64:67], a[172:175], v[92:95]
buffer_load_dwordx4 a[40:43], v244, s[20:23], s66 offen offset:2048 sc0 sc1
v_mfma_f32_16x16x32_bf16 v[84:87], a[64:67], a[156:159], v[84:87]
v_add_f32 v58, 1.0, v58
v_add_f32 v59, 1.0, v59
v_mfma_f32_16x16x32_bf16 v[76:79], a[64:67], a[140:143], v[76:79]
v_rcp_f32 v58, v58
v_mfma_f32_16x16x32_bf16 v[104:107], a[68:71], a[140:143], v[104:107]
ds_read_b64_tr_b16 a[64:65], v221 offset:0
ds_read_b64_tr_b16 a[66:67], v221 offset:4608
v_mfma_f32_16x16x32_bf16 v[112:115], a[68:71], a[156:159], v[112:115]
buffer_load_dwordx4 a[56:59], v244, s[20:23], s67 offen offset:2048 sc0 sc1
v_mfma_f32_16x16x32_bf16 v[120:123], a[68:71], a[172:175], v[120:123]
v_rcp_f32 v59, v59
v_mfma_f32_16x16x32_bf16 v[128:131], a[68:71], a[188:191], v[128:131]
v_mul_f32 v44, v44, v58
v_mul_f32 v45, v45, v59
s_waitcnt lgkmcnt(8)
v_mfma_f32_16x16x32_bf16 v[132:135], a[72:75], a[188:191], v[132:135]
ds_read_b64_tr_b16 a[68:69], v221 offset:9216
ds_read_b64_tr_b16 a[70:71], v221 offset:13824
v_mfma_f32_16x16x32_bf16 v[124:127], a[72:75], a[172:175], v[124:127]
buffer_load_dwordx4 a[12:15], v244, s[20:23], s64 offen offset:3072 sc0 sc1
v_mfma_f32_16x16x32_bf16 v[116:119], a[72:75], a[156:159], v[116:119]
v_cvt_pk_bf16_f32 v58, v44, v45
v_lshlrev_b32 v44, 16, v58
v_mfma_f32_16x16x32_bf16 v[108:111], a[72:75], a[140:143], v[108:111]
v_and_b32 v45, 0xffff0000, v58
v_accvgpr_read_b32 v47, a226
v_mfma_f32_16x16x32_bf16 v[136:139], a[76:79], a[140:143], v[136:139]
ds_read_b64_tr_b16 a[72:73], v221 offset:18432
ds_read_b64_tr_b16 a[74:75], v221 offset:23040
v_mfma_f32_16x16x32_bf16 v[144:147], a[76:79], a[156:159], v[144:147]
buffer_load_dwordx4 a[28:31], v244, s[20:23], s65 offen offset:3072 sc0 sc1
v_mfma_f32_16x16x32_bf16 v[152:155], a[76:79], a[172:175], v[152:155]
v_accvgpr_read_b32 v59, a236
v_lshlrev_b32 v46, 16, v47
v_mfma_f32_16x16x32_bf16 v[160:163], a[76:79], a[188:191], v[160:163]
v_and_b32 v47, 0xffff0000, v47
v_lshlrev_b32 v58, 16, v59
v_mfma_f32_16x16x32_bf16 v[164:167], a[80:83], a[188:191], v[164:167]
ds_read_b64_tr_b16 a[76:77], v221 offset:27648
ds_read_b64_tr_b16 a[78:79], v221 offset:32256
v_mfma_f32_16x16x32_bf16 v[156:159], a[80:83], a[172:175], v[156:159]
buffer_load_dwordx4 a[44:47], v244, s[20:23], s66 offen offset:3072 sc0 sc1
v_mfma_f32_16x16x32_bf16 v[148:151], a[80:83], a[156:159], v[148:151]
v_and_b32 v59, 0xffff0000, v59
v_add_f32 v46, v46, v58
v_mfma_f32_16x16x32_bf16 v[140:143], a[80:83], a[140:143], v[140:143]
v_add_f32 v47, v47, v59
v_cvt_pk_bf16_f32 v58, v46, v47
s_waitcnt lgkmcnt(8)
v_mfma_f32_16x16x32_bf16 v[168:171], a[84:87], a[140:143], v[168:171]
ds_read_b64_tr_b16 a[80:81], v224 offset:0
ds_read_b64_tr_b16 a[82:83], v224 offset:4608
v_mfma_f32_16x16x32_bf16 v[176:179], a[84:87], a[156:159], v[176:179]
buffer_load_dwordx4 a[60:63], v244, s[20:23], s67 offen offset:3072 sc0 sc1
v_mfma_f32_16x16x32_bf16 v[184:187], a[84:87], a[172:175], v[184:187]
s_lshl2_add_u32 s28, s36, s33
s_lshl2_add_u32 s28, s28, s37
v_mfma_f32_16x16x32_bf16 v[192:195], a[84:87], a[188:191], v[192:195]
s_lshl_b32 s95, s28, 5
s_add_u32 s95, s95, 0x24a000
v_mfma_f32_16x16x32_bf16 v[196:199], a[88:91], a[188:191], v[196:199]
ds_read_b64_tr_b16 a[84:85], v224 offset:9216
ds_read_b64_tr_b16 a[86:87], v224 offset:13824
v_mfma_f32_16x16x32_bf16 v[188:191], a[88:91], a[172:175], v[188:191]
s_lshl_b32 s28, s32, 18
s_sub_u32 s49, s44, s28
v_mfma_f32_16x16x32_bf16 v[180:183], a[88:91], a[156:159], v[180:183]
v_add_u32 v243, 0x2000, v244
v_mov_b32 v246, 2
v_mfma_f32_16x16x32_bf16 v[172:175], a[88:91], a[140:143], v[172:175]
s_lshl2_add_u32 s29, s33, s94
v_lshlrev_b32 v46, 16, v58
v_mfma_f32_16x16x32_bf16 v[200:203], a[92:95], a[140:143], v[200:203]
ds_read_b64_tr_b16 a[88:89], v224 offset:18432
ds_read_b64_tr_b16 a[90:91], v224 offset:23040
v_mfma_f32_16x16x32_bf16 v[204:207], a[92:95], a[156:159], v[204:207]
v_and_b32 v47, 0xffff0000, v58
v_mul_f32 v58, 0xbfb8aa3b, v46
v_mfma_f32_16x16x32_bf16 v[208:211], a[92:95], a[172:175], v[208:211]
v_mul_f32 v59, 0xbfb8aa3b, v47
v_mfma_f32_16x16x32_bf16 v[212:215], a[92:95], a[188:191], v[212:215]
v_exp_f32 v58, v58
s_waitcnt vmcnt(28)
s_waitcnt lgkmcnt(8)
v_mfma_f32_16x16x32_bf16 v[212:215], a[64:67], a[112:115], v[212:215]
ds_read_b64_tr_b16 a[92:93], v224 offset:27648
ds_read_b64_tr_b16 a[94:95], v224 offset:32256
v_mfma_f32_16x16x32_bf16 v[208:211], a[64:67], a[96:99], v[208:211]
v_exp_f32 v59, v59
v_mfma_f32_16x16x32_bf16 v[204:207], a[64:67], a[208:211], v[204:207]
v_add_f32 v58, 1.0, v58
v_add_f32 v59, 1.0, v59
v_mfma_f32_16x16x32_bf16 v[200:203], a[64:67], a[192:195], v[200:203]
v_rcp_f32 v58, v58
s_waitcnt vmcnt(24)
v_mfma_f32_16x16x32_bf16 v[200:203], a[68:71], a[196:199], v[200:203]
ds_read_b64_tr_b16 a[64:65], v219 offset:0
ds_read_b64_tr_b16 a[66:67], v219 offset:4608
v_mfma_f32_16x16x32_bf16 v[204:207], a[68:71], a[244:247], v[204:207]
v_rcp_f32 v59, v59
v_mfma_f32_16x16x32_bf16 v[208:211], a[68:71], a[100:103], v[208:211]
v_mul_f32 v46, v46, v58
v_mul_f32 v47, v47, v59
v_mfma_f32_16x16x32_bf16 v[212:215], a[68:71], a[116:119], v[212:215]
v_cvt_pk_bf16_f32 v58, v46, v47
v_lshlrev_b32 v46, 16, v58
s_waitcnt vmcnt(20)
v_mfma_f32_16x16x32_bf16 v[212:215], a[72:75], a[120:123], v[212:215]
ds_read_b64_tr_b16 a[68:69], v219 offset:9216
ds_read_b64_tr_b16 a[70:71], v219 offset:13824
v_mfma_f32_16x16x32_bf16 v[208:211], a[72:75], a[104:107], v[208:211]
v_and_b32 v47, 0xffff0000, v58
v_accvgpr_read_b32 v49, a227
v_mfma_f32_16x16x32_bf16 v[204:207], a[72:75], a[248:251], v[204:207]
v_accvgpr_read_b32 v59, a237
v_lshlrev_b32 v48, 16, v49
v_mfma_f32_16x16x32_bf16 v[200:203], a[72:75], a[200:203], v[200:203]
v_and_b32 v49, 0xffff0000, v49
v_lshlrev_b32 v58, 16, v59
s_waitcnt vmcnt(16)
s_waitcnt lgkmcnt(8)
v_mfma_f32_16x16x32_bf16 v[200:203], a[76:79], a[204:207], v[200:203]
ds_read_b64_tr_b16 a[72:73], v219 offset:18432
ds_read_b64_tr_b16 a[74:75], v219 offset:23040
v_mfma_f32_16x16x32_bf16 v[204:207], a[76:79], a[252:255], v[204:207]
v_and_b32 v59, 0xffff0000, v59
v_add_f32 v48, v48, v58
v_mfma_f32_16x16x32_bf16 v[208:211], a[76:79], a[108:111], v[208:211]
v_add_f32 v49, v49, v59
v_cvt_pk_bf16_f32 v58, v48, v49
v_mfma_f32_16x16x32_bf16 v[212:215], a[76:79], a[124:127], v[212:215]
v_lshlrev_b32 v48, 16, v58
v_and_b32 v49, 0xffff0000, v58
s_waitcnt vmcnt(12)
v_mfma_f32_16x16x32_bf16 v[212:215], a[80:83], a[48:51], v[212:215]
ds_read_b64_tr_b16 a[76:77], v219 offset:27648
ds_read_b64_tr_b16 a[78:79], v219 offset:32256
v_mfma_f32_16x16x32_bf16 v[208:211], a[80:83], a[32:35], v[208:211]
v_mul_f32 v58, 0xbfb8aa3b, v48
v_mul_f32 v59, 0xbfb8aa3b, v49
v_mfma_f32_16x16x32_bf16 v[204:207], a[80:83], a[16:19], v[204:207]
v_exp_f32 v58, v58
v_mfma_f32_16x16x32_bf16 v[200:203], a[80:83], a[0:3], v[200:203]
s_waitcnt vmcnt(0)
buffer_store_dword v246, v254, s[20:23], s29 offen sc0 sc1
s_waitcnt vmcnt(9)
v_mfma_f32_16x16x32_bf16 v[200:203], a[84:87], a[4:7], v[200:203]
ds_read_b64_tr_b16 a[80:81], v222 offset:0
ds_read_b64_tr_b16 a[82:83], v222 offset:4608
v_mfma_f32_16x16x32_bf16 v[204:207], a[84:87], a[20:23], v[204:207]
s_add_u32 s28, s32, 0
s_and_b32 s28, s28, 7
v_mfma_f32_16x16x32_bf16 v[208:211], a[84:87], a[36:39], v[208:211]
s_xor_b32 s29, s28, s32
s_lshl_b32 s28, s28, 18
v_mfma_f32_16x16x32_bf16 v[212:215], a[84:87], a[52:55], v[212:215]
s_add_u32 s28, s28, s49
s_and_b32 s29, s29, 4
s_waitcnt vmcnt(5)
s_waitcnt lgkmcnt(8)
v_mfma_f32_16x16x32_bf16 v[212:215], a[88:91], a[56:59], v[212:215]
ds_read_b64_tr_b16 a[84:85], v222 offset:9216
ds_read_b64_tr_b16 a[86:87], v222 offset:13824
v_mfma_f32_16x16x32_bf16 v[208:211], a[88:91], a[40:43], v[208:211]
s_add_u32 s72, s28, 0
s_lshl_b32 s29, s29, 10
v_mfma_f32_16x16x32_bf16 v[204:207], a[88:91], a[24:27], v[204:207]
s_add_u32 s28, s32, 1
s_and_b32 s28, s28, 7
v_mfma_f32_16x16x32_bf16 v[200:203], a[88:91], a[8:11], v[200:203]
s_xor_b32 s29, s28, s32
s_lshl_b32 s28, s28, 18
s_waitcnt vmcnt(1)
v_mfma_f32_16x16x32_bf16 v[200:203], a[92:95], a[12:15], v[200:203]
ds_read_b64_tr_b16 a[88:89], v222 offset:18432
ds_read_b64_tr_b16 a[90:91], v222 offset:23040
v_mfma_f32_16x16x32_bf16 v[204:207], a[92:95], a[28:31], v[204:207]
s_add_u32 s28, s28, s49
s_and_b32 s29, s29, 4
v_mfma_f32_16x16x32_bf16 v[208:211], a[92:95], a[44:47], v[208:211]
s_add_u32 s73, s28, 8192
s_lshl_b32 s29, s29, 10
v_mfma_f32_16x16x32_bf16 v[212:215], a[92:95], a[60:63], v[212:215]
s_add_u32 s65, s28, s29
v_mfma_f32_16x16x32_bf16 v[96:99], a[64:67], a[112:115], v[96:99]
ds_read_b64_tr_b16 a[92:93], v222 offset:27648
ds_read_b64_tr_b16 a[94:95], v222 offset:32256
v_mfma_f32_16x16x32_bf16 v[88:91], a[64:67], a[96:99], v[88:91]
s_add_u32 s28, s32, 2
s_and_b32 s28, s28, 7
v_mfma_f32_16x16x32_bf16 v[80:83], a[64:67], a[208:211], v[80:83]
s_xor_b32 s29, s28, s32
s_lshl_b32 s28, s28, 18
v_mfma_f32_16x16x32_bf16 v[72:75], a[64:67], a[192:195], v[72:75]
s_add_u32 s28, s28, s49
s_and_b32 s29, s29, 4
s_waitcnt lgkmcnt(8)
v_mfma_f32_16x16x32_bf16 v[72:75], a[68:71], a[196:199], v[72:75]
ds_read_b64_tr_b16 a[64:65], v219 offset:8
ds_read_b64_tr_b16 a[66:67], v219 offset:4616
v_mfma_f32_16x16x32_bf16 v[80:83], a[68:71], a[244:247], v[80:83]
s_add_u32 s74, s28, 8192
s_lshl_b32 s29, s29, 10
v_mfma_f32_16x16x32_bf16 v[88:91], a[68:71], a[100:103], v[88:91]
s_add_u32 s66, s28, s29
v_mfma_f32_16x16x32_bf16 v[96:99], a[68:71], a[116:119], v[96:99]
s_add_u32 s28, s32, 3
s_and_b32 s28, s28, 7
v_mfma_f32_16x16x32_bf16 v[96:99], a[72:75], a[120:123], v[96:99]
ds_read_b64_tr_b16 a[68:69], v219 offset:9224
ds_read_b64_tr_b16 a[70:71], v219 offset:13832
v_mfma_f32_16x16x32_bf16 v[88:91], a[72:75], a[104:107], v[88:91]
s_xor_b32 s29, s28, s32
s_lshl_b32 s28, s28, 18
v_mfma_f32_16x16x32_bf16 v[80:83], a[72:75], a[248:251], v[80:83]
s_add_u32 s28, s28, s49
s_and_b32 s29, s29, 4
v_mfma_f32_16x16x32_bf16 v[72:75], a[72:75], a[200:203], v[72:75]
s_add_u32 s75, s28, 0
s_lshl_b32 s29, s29, 10
v_mfma_f32_16x16x32_bf16 v[72:75], a[76:79], a[204:207], v[72:75]
ds_read_b64_tr_b16 a[72:73], v219 offset:18440
ds_read_b64_tr_b16 a[74:75], v219 offset:23048
v_mfma_f32_16x16x32_bf16 v[80:83], a[76:79], a[252:255], v[80:83]
s_add_u32 s67, s28, s29
v_mfma_f32_16x16x32_bf16 v[88:91], a[76:79], a[108:111], v[88:91]
buffer_load_dword v230, v229, s[20:23], s94 offen sc0 sc1
v_mfma_f32_16x16x32_bf16 v[96:99], a[76:79], a[124:127], v[96:99]
s_add_u32 s28, s32, 4
s_and_b32 s28, s28, 7
s_waitcnt lgkmcnt(8)
v_mfma_f32_16x16x32_bf16 v[96:99], a[80:83], a[48:51], v[96:99]
ds_read_b64_tr_b16 a[76:77], v219 offset:27656
ds_read_b64_tr_b16 a[78:79], v219 offset:32264
v_mfma_f32_16x16x32_bf16 v[88:91], a[80:83], a[32:35], v[88:91]
s_xor_b32 s29, s28, s32
s_lshl_b32 s28, s28, 18
v_mfma_f32_16x16x32_bf16 v[80:83], a[80:83], a[16:19], v[80:83]
s_add_u32 s28, s28, s49
s_and_b32 s29, s29, 4
v_mfma_f32_16x16x32_bf16 v[72:75], a[80:83], a[0:3], v[72:75]
s_add_u32 s84, s28, 0
s_lshl_b32 s29, s29, 10
v_mfma_f32_16x16x32_bf16 v[72:75], a[84:87], a[4:7], v[72:75]
ds_read_b64_tr_b16 a[80:81], v222 offset:8
ds_read_b64_tr_b16 a[82:83], v222 offset:4616
v_mfma_f32_16x16x32_bf16 v[80:83], a[84:87], a[20:23], v[80:83]
s_add_u32 s68, s28, s29
v_mfma_f32_16x16x32_bf16 v[88:91], a[84:87], a[36:39], v[88:91]
s_add_u32 s28, s32, 5
s_and_b32 s28, s28, 7
v_mfma_f32_16x16x32_bf16 v[96:99], a[84:87], a[52:55], v[96:99]
s_xor_b32 s29, s28, s32
s_lshl_b32 s28, s28, 18
v_mfma_f32_16x16x32_bf16 v[96:99], a[88:91], a[56:59], v[96:99]
ds_read_b64_tr_b16 a[84:85], v222 offset:9224
ds_read_b64_tr_b16 a[86:87], v222 offset:13832
v_mfma_f32_16x16x32_bf16 v[88:91], a[88:91], a[40:43], v[88:91]
s_add_u32 s28, s28, s49
s_and_b32 s29, s29, 4
v_mfma_f32_16x16x32_bf16 v[80:83], a[88:91], a[24:27], v[80:83]
s_add_u32 s85, s28, 8192
s_lshl_b32 s29, s29, 10
v_mfma_f32_16x16x32_bf16 v[72:75], a[88:91], a[8:11], v[72:75]
s_add_u32 s69, s28, s29
s_waitcnt lgkmcnt(8)
v_mfma_f32_16x16x32_bf16 v[72:75], a[92:95], a[12:15], v[72:75]
ds_read_b64_tr_b16 a[88:89], v222 offset:18440
ds_read_b64_tr_b16 a[90:91], v222 offset:23048
v_mfma_f32_16x16x32_bf16 v[80:83], a[92:95], a[28:31], v[80:83]
s_add_u32 s28, s32, 6
s_and_b32 s28, s28, 7
v_mfma_f32_16x16x32_bf16 v[88:91], a[92:95], a[44:47], v[88:91]
s_xor_b32 s29, s28, s32
s_lshl_b32 s28, s28, 18
v_mfma_f32_16x16x32_bf16 v[96:99], a[92:95], a[60:63], v[96:99]
s_add_u32 s28, s28, s49
s_and_b32 s29, s29, 4
v_mfma_f32_16x16x32_bf16 v[100:103], a[64:67], a[112:115], v[100:103]
ds_read_b64_tr_b16 a[92:93], v222 offset:27656
ds_read_b64_tr_b16 a[94:95], v222 offset:32264
v_mfma_f32_16x16x32_bf16 v[92:95], a[64:67], a[96:99], v[92:95]
s_add_u32 s86, s28, 8192
s_lshl_b32 s29, s29, 10
v_mfma_f32_16x16x32_bf16 v[84:87], a[64:67], a[208:211], v[84:87]
s_add_u32 s70, s28, s29
v_mfma_f32_16x16x32_bf16 v[76:79], a[64:67], a[192:195], v[76:79]
s_add_u32 s28, s32, 7
s_and_b32 s28, s28, 7
v_mfma_f32_16x16x32_bf16 v[76:79], a[68:71], a[196:199], v[76:79]
ds_read_b64_tr_b16 a[64:65], v220 offset:0
ds_read_b64_tr_b16 a[66:67], v220 offset:4608
v_mfma_f32_16x16x32_bf16 v[84:87], a[68:71], a[244:247], v[84:87]
s_xor_b32 s29, s28, s32
s_lshl_b32 s28, s28, 18
v_mfma_f32_16x16x32_bf16 v[92:95], a[68:71], a[100:103], v[92:95]
s_add_u32 s28, s28, s49
s_and_b32 s29, s29, 4
v_mfma_f32_16x16x32_bf16 v[100:103], a[68:71], a[116:119], v[100:103]
s_add_u32 s87, s28, 0
s_lshl_b32 s29, s29, 10
s_waitcnt lgkmcnt(8)
v_mfma_f32_16x16x32_bf16 v[100:103], a[72:75], a[120:123], v[100:103]
ds_read_b64_tr_b16 a[68:69], v220 offset:9216
ds_read_b64_tr_b16 a[70:71], v220 offset:13824
v_mfma_f32_16x16x32_bf16 v[92:95], a[72:75], a[104:107], v[92:95]
s_add_u32 s71, s28, s29
v_mfma_f32_16x16x32_bf16 v[84:87], a[72:75], a[248:251], v[84:87]
s_waitcnt vmcnt(0)
v_cmp_gt_u32 vcc, 2, v230
v_mfma_f32_16x16x32_bf16 v[76:79], a[72:75], a[200:203], v[76:79]
v_exp_f32 v59, v59
v_mfma_f32_16x16x32_bf16 v[76:79], a[76:79], a[204:207], v[76:79]
ds_read_b64_tr_b16 a[72:73], v220 offset:18432
ds_read_b64_tr_b16 a[74:75], v220 offset:23040
v_mfma_f32_16x16x32_bf16 v[84:87], a[76:79], a[252:255], v[84:87]
s_and_b32 s29, vcc_lo, 15
s_cbranch_scc1 SP_O3B
SP_O3B_RET:
v_mfma_f32_16x16x32_bf16 v[92:95], a[76:79], a[108:111], v[92:95]
s_add_u32 s39, s44, 8192
v_add_f32 v58, 1.0, v58
v_mfma_f32_16x16x32_bf16 v[100:103], a[76:79], a[124:127], v[100:103]
v_cvt_pk_bf16_f32 v200, v200, v201
v_cvt_pk_bf16_f32 v201, v202, v203
v_mfma_f32_16x16x32_bf16 v[100:103], a[80:83], a[48:51], v[100:103]
ds_read_b64_tr_b16 a[76:77], v220 offset:27648
ds_read_b64_tr_b16 a[78:79], v220 offset:32256
v_mfma_f32_16x16x32_bf16 v[92:95], a[80:83], a[32:35], v[92:95]
buffer_store_dwordx2 v[200:201], v226, s[20:23], s44 offen offset:0 sc0 sc1
v_mfma_f32_16x16x32_bf16 v[84:87], a[80:83], a[16:19], v[84:87]
v_cvt_pk_bf16_f32 v204, v204, v205
v_cvt_pk_bf16_f32 v205, v206, v207
v_mfma_f32_16x16x32_bf16 v[76:79], a[80:83], a[0:3], v[76:79]
buffer_store_dwordx2 v[204:205], v226, s[20:23], s44 offen offset:512 sc0 sc1
s_waitcnt lgkmcnt(8)
v_mfma_f32_16x16x32_bf16 v[76:79], a[84:87], a[4:7], v[76:79]
ds_read_b64_tr_b16 a[80:81], v223 offset:0
ds_read_b64_tr_b16 a[82:83], v223 offset:4608
v_mfma_f32_16x16x32_bf16 v[84:87], a[84:87], a[20:23], v[84:87]
v_cvt_pk_bf16_f32 v208, v208, v209
v_cvt_pk_bf16_f32 v209, v210, v211
v_mfma_f32_16x16x32_bf16 v[92:95], a[84:87], a[36:39], v[92:95]
buffer_store_dwordx2 v[208:209], v226, s[20:23], s39 offen offset:0 sc0 sc1
v_mfma_f32_16x16x32_bf16 v[100:103], a[84:87], a[52:55], v[100:103]
v_cvt_pk_bf16_f32 v212, v212, v213
v_cvt_pk_bf16_f32 v213, v214, v215
v_mfma_f32_16x16x32_bf16 v[100:103], a[88:91], a[56:59], v[100:103]
ds_read_b64_tr_b16 a[84:85], v223 offset:9216
ds_read_b64_tr_b16 a[86:87], v223 offset:13824
v_mfma_f32_16x16x32_bf16 v[92:95], a[88:91], a[40:43], v[92:95]
buffer_store_dwordx2 v[212:213], v226, s[20:23], s39 offen offset:512 sc0 sc1
v_mfma_f32_16x16x32_bf16 v[84:87], a[88:91], a[24:27], v[84:87]
v_add_f32 v59, 1.0, v59
v_mfma_f32_16x16x32_bf16 v[76:79], a[88:91], a[8:11], v[76:79]
v_rcp_f32 v58, v58
v_mfma_f32_16x16x32_bf16 v[76:79], a[92:95], a[12:15], v[76:79]
ds_read_b64_tr_b16 a[88:89], v223 offset:18432
ds_read_b64_tr_b16 a[90:91], v223 offset:23040
v_mfma_f32_16x16x32_bf16 v[84:87], a[92:95], a[28:31], v[84:87]
v_rcp_f32 v59, v59
v_mfma_f32_16x16x32_bf16 v[92:95], a[92:95], a[44:47], v[92:95]
v_mul_f32 v48, v48, v58
v_mul_f32 v49, v49, v59
v_mfma_f32_16x16x32_bf16 v[100:103], a[92:95], a[60:63], v[100:103]
v_cvt_pk_bf16_f32 v58, v48, v49
v_lshlrev_b32 v48, 16, v58
s_waitcnt lgkmcnt(8)
v_mfma_f32_16x16x32_bf16 v[128:131], a[64:67], a[112:115], v[128:131]
ds_read_b64_tr_b16 a[92:93], v223 offset:27648
ds_read_b64_tr_b16 a[94:95], v223 offset:32256
v_mfma_f32_16x16x32_bf16 v[120:123], a[64:67], a[96:99], v[120:123]
v_and_b32 v49, 0xffff0000, v58
v_accvgpr_read_b32 v51, a228
v_mfma_f32_16x16x32_bf16 v[112:115], a[64:67], a[208:211], v[112:115]
v_accvgpr_read_b32 v59, a238
v_lshlrev_b32 v50, 16, v51
v_mfma_f32_16x16x32_bf16 v[104:107], a[64:67], a[192:195], v[104:107]
v_and_b32 v51, 0xffff0000, v51
v_lshlrev_b32 v58, 16, v59
v_mfma_f32_16x16x32_bf16 v[104:107], a[68:71], a[196:199], v[104:107]
ds_read_b64_tr_b16 a[64:65], v220 offset:8
ds_read_b64_tr_b16 a[66:67], v220 offset:4616
v_mfma_f32_16x16x32_bf16 v[112:115], a[68:71], a[244:247], v[112:115]
v_and_b32 v59, 0xffff0000, v59
v_add_f32 v50, v50, v58
v_mfma_f32_16x16x32_bf16 v[120:123], a[68:71], a[100:103], v[120:123]
v_add_f32 v51, v51, v59
v_cvt_pk_bf16_f32 v58, v50, v51
v_mfma_f32_16x16x32_bf16 v[128:131], a[68:71], a[116:119], v[128:131]
v_lshlrev_b32 v50, 16, v58
v_and_b32 v51, 0xffff0000, v58
v_mfma_f32_16x16x32_bf16 v[128:131], a[72:75], a[120:123], v[128:131]
ds_read_b64_tr_b16 a[68:69], v220 offset:9224
ds_read_b64_tr_b16 a[70:71], v220 offset:13832
v_mfma_f32_16x16x32_bf16 v[120:123], a[72:75], a[104:107], v[120:123]
s_add_u32 s39, s44, 0
v_mul_f32 v58, 0xbfb8aa3b, v50
v_mfma_f32_16x16x32_bf16 v[112:115], a[72:75], a[248:251], v[112:115]
v_cvt_pk_bf16_f32 v80, v80, v81
v_cvt_pk_bf16_f32 v81, v82, v83
v_mfma_f32_16x16x32_bf16 v[104:107], a[72:75], a[200:203], v[104:107]
v_cvt_pk_bf16_f32 v82, v84, v85
v_cvt_pk_bf16_f32 v83, v86, v87
s_waitcnt lgkmcnt(8)
v_mfma_f32_16x16x32_bf16 v[104:107], a[76:79], a[204:207], v[104:107]
ds_read_b64_tr_b16 a[72:73], v220 offset:18440
ds_read_b64_tr_b16 a[74:75], v220 offset:23048
v_mfma_f32_16x16x32_bf16 v[112:115], a[76:79], a[252:255], v[112:115]
buffer_store_dwordx4 v[80:83], v244, s[20:23], s39 offen offset:1024 sc0 sc1
v_mfma_f32_16x16x32_bf16 v[120:123], a[76:79], a[108:111], v[120:123]
v_cvt_pk_bf16_f32 v88, v88, v89
v_cvt_pk_bf16_f32 v89, v90, v91
v_mfma_f32_16x16x32_bf16 v[128:131], a[76:79], a[124:127], v[128:131]
v_cvt_pk_bf16_f32 v90, v92, v93
v_cvt_pk_bf16_f32 v91, v94, v95
v_mfma_f32_16x16x32_bf16 v[128:131], a[80:83], a[48:51], v[128:131]
ds_read_b64_tr_b16 a[76:77], v220 offset:27656
ds_read_b64_tr_b16 a[78:79], v220 offset:32264
v_mfma_f32_16x16x32_bf16 v[120:123], a[80:83], a[32:35], v[120:123]
buffer_store_dwordx4 v[88:91], v244, s[20:23], s39 offen offset:2048 sc0 sc1
v_mfma_f32_16x16x32_bf16 v[112:115], a[80:83], a[16:19], v[112:115]
v_cvt_pk_bf16_f32 v96, v96, v97
v_cvt_pk_bf16_f32 v97, v98, v99
v_mfma_f32_16x16x32_bf16 v[104:107], a[80:83], a[0:3], v[104:107]
v_cvt_pk_bf16_f32 v98, v100, v101
v_cvt_pk_bf16_f32 v99, v102, v103
v_mfma_f32_16x16x32_bf16 v[104:107], a[84:87], a[4:7], v[104:107]
ds_read_b64_tr_b16 a[80:81], v223 offset:8
ds_read_b64_tr_b16 a[82:83], v223 offset:4616
v_mfma_f32_16x16x32_bf16 v[112:115], a[84:87], a[20:23], v[112:115]
buffer_store_dwordx4 v[96:99], v244, s[20:23], s39 offen offset:3072 sc0 sc1
v_mfma_f32_16x16x32_bf16 v[120:123], a[84:87], a[36:39], v[120:123]
v_mul_f32 v59, 0xbfb8aa3b, v51
v_mfma_f32_16x16x32_bf16 v[128:131], a[84:87], a[52:55], v[128:131]
v_exp_f32 v58, v58
s_waitcnt lgkmcnt(8)
v_mfma_f32_16x16x32_bf16 v[128:131], a[88:91], a[56:59], v[128:131]
ds_read_b64_tr_b16 a[84:85], v223 offset:9224
ds_read_b64_tr_b16 a[86:87], v223 offset:13832
v_mfma_f32_16x16x32_bf16 v[120:123], a[88:91], a[40:43], v[120:123]
v_exp_f32 v59, v59
v_mfma_f32_16x16x32_bf16 v[112:115], a[88:91], a[24:27], v[112:115]
v_add_f32 v58, 1.0, v58
v_add_f32 v59, 1.0, v59
v_mfma_f32_16x16x32_bf16 v[104:107], a[88:91], a[8:11], v[104:107]
v_rcp_f32 v58, v58
v_mfma_f32_16x16x32_bf16 v[104:107], a[92:95], a[12:15], v[104:107]
ds_read_b64_tr_b16 a[88:89], v223 offset:18440
ds_read_b64_tr_b16 a[90:91], v223 offset:23048
v_mfma_f32_16x16x32_bf16 v[112:115], a[92:95], a[28:31], v[112:115]
v_rcp_f32 v59, v59
v_mfma_f32_16x16x32_bf16 v[120:123], a[92:95], a[44:47], v[120:123]
v_mul_f32 v50, v50, v58
v_mul_f32 v51, v51, v59
v_mfma_f32_16x16x32_bf16 v[128:131], a[92:95], a[60:63], v[128:131]
v_cvt_pk_bf16_f32 v58, v50, v51
v_lshlrev_b32 v50, 16, v58
v_mfma_f32_16x16x32_bf16 v[132:135], a[64:67], a[112:115], v[132:135]
ds_read_b64_tr_b16 a[92:93], v223 offset:27656
ds_read_b64_tr_b16 a[94:95], v223 offset:32264
v_mfma_f32_16x16x32_bf16 v[124:127], a[64:67], a[96:99], v[124:127]
v_and_b32 v51, 0xffff0000, v58
v_accvgpr_read_b32 v53, a229
v_mfma_f32_16x16x32_bf16 v[116:119], a[64:67], a[208:211], v[116:119]
v_accvgpr_read_b32 v59, a239
v_lshlrev_b32 v52, 16, v53
v_mfma_f32_16x16x32_bf16 v[108:111], a[64:67], a[192:195], v[108:111]
v_and_b32 v53, 0xffff0000, v53
v_lshlrev_b32 v58, 16, v59
s_waitcnt lgkmcnt(8)
v_mfma_f32_16x16x32_bf16 v[108:111], a[68:71], a[196:199], v[108:111]
ds_read_b64_tr_b16 a[64:65], v219 offset:128
ds_read_b64_tr_b16 a[66:67], v219 offset:4736
v_mfma_f32_16x16x32_bf16 v[116:119], a[68:71], a[244:247], v[116:119]
v_and_b32 v59, 0xffff0000, v59
v_add_f32 v52, v52, v58
v_mfma_f32_16x16x32_bf16 v[124:127], a[68:71], a[100:103], v[124:127]
v_add_f32 v53, v53, v59
v_cvt_pk_bf16_f32 v58, v52, v53
v_mfma_f32_16x16x32_bf16 v[132:135], a[68:71], a[116:119], v[132:135]
v_lshlrev_b32 v52, 16, v58
v_and_b32 v53, 0xffff0000, v58
v_mfma_f32_16x16x32_bf16 v[132:135], a[72:75], a[120:123], v[132:135]
ds_read_b64_tr_b16 a[68:69], v219 offset:9344
ds_read_b64_tr_b16 a[70:71], v219 offset:13952
v_mfma_f32_16x16x32_bf16 v[124:127], a[72:75], a[104:107], v[124:127]
v_mul_f32 v58, 0xbfb8aa3b, v52
v_mul_f32 v59, 0xbfb8aa3b, v53
v_mfma_f32_16x16x32_bf16 v[116:119], a[72:75], a[248:251], v[116:119]
v_exp_f32 v58, v58
v_mfma_f32_16x16x32_bf16 v[108:111], a[72:75], a[200:203], v[108:111]
v_exp_f32 v59, v59
v_mfma_f32_16x16x32_bf16 v[108:111], a[76:79], a[204:207], v[108:111]
ds_read_b64_tr_b16 a[72:73], v219 offset:18560
ds_read_b64_tr_b16 a[74:75], v219 offset:23168
v_mfma_f32_16x16x32_bf16 v[116:119], a[76:79], a[252:255], v[116:119]
v_add_f32 v58, 1.0, v58
v_add_f32 v59, 1.0, v59
v_mfma_f32_16x16x32_bf16 v[124:127], a[76:79], a[108:111], v[124:127]
v_rcp_f32 v58, v58
v_mfma_f32_16x16x32_bf16 v[132:135], a[76:79], a[124:127], v[132:135]
v_rcp_f32 v59, v59
s_waitcnt lgkmcnt(8)
v_mfma_f32_16x16x32_bf16 v[132:135], a[80:83], a[48:51], v[132:135]
ds_read_b64_tr_b16 a[76:77], v219 offset:27776
ds_read_b64_tr_b16 a[78:79], v219 offset:32384
v_mfma_f32_16x16x32_bf16 v[124:127], a[80:83], a[32:35], v[124:127]
v_mul_f32 v52, v52, v58
v_mul_f32 v53, v53, v59
v_mfma_f32_16x16x32_bf16 v[116:119], a[80:83], a[16:19], v[116:119]
v_cvt_pk_bf16_f32 v58, v52, v53
v_lshlrev_b32 v52, 16, v58
v_mfma_f32_16x16x32_bf16 v[108:111], a[80:83], a[0:3], v[108:111]
v_and_b32 v53, 0xffff0000, v58
v_accvgpr_read_b32 v55, a230
v_mfma_f32_16x16x32_bf16 v[108:111], a[84:87], a[4:7], v[108:111]
ds_read_b64_tr_b16 a[80:81], v222 offset:128
ds_read_b64_tr_b16 a[82:83], v222 offset:4736
v_mfma_f32_16x16x32_bf16 v[116:119], a[84:87], a[20:23], v[116:119]
v_accvgpr_read_b32 v59, a240
v_lshlrev_b32 v54, 16, v55
v_mfma_f32_16x16x32_bf16 v[124:127], a[84:87], a[36:39], v[124:127]
v_and_b32 v55, 0xffff0000, v55
v_lshlrev_b32 v58, 16, v59
v_mfma_f32_16x16x32_bf16 v[132:135], a[84:87], a[52:55], v[132:135]
v_and_b32 v59, 0xffff0000, v59
v_add_f32 v54, v54, v58
v_mfma_f32_16x16x32_bf16 v[132:135], a[88:91], a[56:59], v[132:135]
ds_read_b64_tr_b16 a[84:85], v222 offset:9344
ds_read_b64_tr_b16 a[86:87], v222 offset:13952
v_mfma_f32_16x16x32_bf16 v[124:127], a[88:91], a[40:43], v[124:127]
v_add_f32 v55, v55, v59
v_cvt_pk_bf16_f32 v58, v54, v55
v_mfma_f32_16x16x32_bf16 v[116:119], a[88:91], a[24:27], v[116:119]
v_lshlrev_b32 v54, 16, v58
v_and_b32 v55, 0xffff0000, v58
v_mfma_f32_16x16x32_bf16 v[108:111], a[88:91], a[8:11], v[108:111]
v_mul_f32 v58, 0xbfb8aa3b, v54
v_mul_f32 v59, 0xbfb8aa3b, v55
s_waitcnt lgkmcnt(8)
v_mfma_f32_16x16x32_bf16 v[108:111], a[92:95], a[12:15], v[108:111]
ds_read_b64_tr_b16 a[88:89], v222 offset:18560
ds_read_b64_tr_b16 a[90:91], v222 offset:23168
v_mfma_f32_16x16x32_bf16 v[116:119], a[92:95], a[28:31], v[116:119]
v_exp_f32 v58, v58
v_mfma_f32_16x16x32_bf16 v[124:127], a[92:95], a[44:47], v[124:127]
v_exp_f32 v59, v59
v_mfma_f32_16x16x32_bf16 v[132:135], a[92:95], a[60:63], v[132:135]
v_add_f32 v58, 1.0, v58
v_add_f32 v59, 1.0, v59
v_mfma_f32_16x16x32_bf16 v[160:163], a[64:67], a[112:115], v[160:163]
ds_read_b64_tr_b16 a[92:93], v222 offset:27776
ds_read_b64_tr_b16 a[94:95], v222 offset:32384
v_mfma_f32_16x16x32_bf16 v[152:155], a[64:67], a[96:99], v[152:155]
v_rcp_f32 v58, v58
v_mfma_f32_16x16x32_bf16 v[144:147], a[64:67], a[208:211], v[144:147]
v_rcp_f32 v59, v59
v_mfma_f32_16x16x32_bf16 v[136:139], a[64:67], a[192:195], v[136:139]
v_mul_f32 v54, v54, v58
v_mul_f32 v55, v55, v59
v_mfma_f32_16x16x32_bf16 v[136:139], a[68:71], a[196:199], v[136:139]
ds_read_b64_tr_b16 a[64:65], v219 offset:136
ds_read_b64_tr_b16 a[66:67], v219 offset:4744
v_mfma_f32_16x16x32_bf16 v[144:147], a[68:71], a[244:247], v[144:147]
v_cvt_pk_bf16_f32 v58, v54, v55
v_lshlrev_b32 v54, 16, v58
v_mfma_f32_16x16x32_bf16 v[152:155], a[68:71], a[100:103], v[152:155]
v_and_b32 v55, 0xffff0000, v58
v_accvgpr_read_b32 v57, a231
v_mfma_f32_16x16x32_bf16 v[160:163], a[68:71], a[116:119], v[160:163]
v_accvgpr_read_b32 v59, a241
v_lshlrev_b32 v56, 16, v57
s_waitcnt lgkmcnt(8)
v_mfma_f32_16x16x32_bf16 v[160:163], a[72:75], a[120:123], v[160:163]
ds_read_b64_tr_b16 a[68:69], v219 offset:9352
ds_read_b64_tr_b16 a[70:71], v219 offset:13960
v_mfma_f32_16x16x32_bf16 v[152:155], a[72:75], a[104:107], v[152:155]
s_add_u32 s39, s44, 4096
v_and_b32 v57, 0xffff0000, v57
v_mfma_f32_16x16x32_bf16 v[144:147], a[72:75], a[248:251], v[144:147]
v_cvt_pk_bf16_f32 v104, v104, v105
v_cvt_pk_bf16_f32 v105, v106, v107
v_mfma_f32_16x16x32_bf16 v[136:139], a[72:75], a[200:203], v[136:139]
v_cvt_pk_bf16_f32 v106, v108, v109
v_cvt_pk_bf16_f32 v107, v110, v111
v_mfma_f32_16x16x32_bf16 v[136:139], a[76:79], a[204:207], v[136:139]
ds_read_b64_tr_b16 a[72:73], v219 offset:18568
ds_read_b64_tr_b16 a[74:75], v219 offset:23176
v_mfma_f32_16x16x32_bf16 v[144:147], a[76:79], a[252:255], v[144:147]
buffer_store_dwordx4 v[104:107], v244, s[20:23], s39 offen offset:0 sc0 sc1
v_mfma_f32_16x16x32_bf16 v[152:155], a[76:79], a[108:111], v[152:155]
v_cvt_pk_bf16_f32 v112, v112, v113
v_cvt_pk_bf16_f32 v113, v114, v115
v_mfma_f32_16x16x32_bf16 v[160:163], a[76:79], a[124:127], v[160:163]
v_cvt_pk_bf16_f32 v114, v116, v117
v_cvt_pk_bf16_f32 v115, v118, v119
v_mfma_f32_16x16x32_bf16 v[160:163], a[80:83], a[48:51], v[160:163]
ds_read_b64_tr_b16 a[76:77], v219 offset:27784
ds_read_b64_tr_b16 a[78:79], v219 offset:32392
v_mfma_f32_16x16x32_bf16 v[152:155], a[80:83], a[32:35], v[152:155]
buffer_store_dwordx4 v[112:115], v244, s[20:23], s39 offen offset:1024 sc0 sc1
v_mfma_f32_16x16x32_bf16 v[144:147], a[80:83], a[16:19], v[144:147]
v_cvt_pk_bf16_f32 v120, v120, v121
v_cvt_pk_bf16_f32 v121, v122, v123
v_mfma_f32_16x16x32_bf16 v[136:139], a[80:83], a[0:3], v[136:139]
v_cvt_pk_bf16_f32 v122, v124, v125
v_cvt_pk_bf16_f32 v123, v126, v127
s_waitcnt lgkmcnt(8)
v_mfma_f32_16x16x32_bf16 v[136:139], a[84:87], a[4:7], v[136:139]
ds_read_b64_tr_b16 a[80:81], v222 offset:136
ds_read_b64_tr_b16 a[82:83], v222 offset:4744
v_mfma_f32_16x16x32_bf16 v[144:147], a[84:87], a[20:23], v[144:147]
buffer_store_dwordx4 v[120:123], v244, s[20:23], s39 offen offset:2048 sc0 sc1
v_mfma_f32_16x16x32_bf16 v[152:155], a[84:87], a[36:39], v[152:155]
v_cvt_pk_bf16_f32 v128, v128, v129
v_cvt_pk_bf16_f32 v129, v130, v131
v_mfma_f32_16x16x32_bf16 v[160:163], a[84:87], a[52:55], v[160:163]
v_cvt_pk_bf16_f32 v130, v132, v133
v_cvt_pk_bf16_f32 v131, v134, v135
v_mfma_f32_16x16x32_bf16 v[160:163], a[88:91], a[56:59], v[160:163]
ds_read_b64_tr_b16 a[84:85], v222 offset:9352
ds_read_b64_tr_b16 a[86:87], v222 offset:13960
v_mfma_f32_16x16x32_bf16 v[152:155], a[88:91], a[40:43], v[152:155]
buffer_store_dwordx4 v[128:131], v244, s[20:23], s39 offen offset:3072 sc0 sc1
v_mfma_f32_16x16x32_bf16 v[144:147], a[88:91], a[24:27], v[144:147]
s_lshl2_add_u32 s28, s32, s95
v_lshlrev_b32 v58, 16, v59
v_mfma_f32_16x16x32_bf16 v[136:139], a[88:91], a[8:11], v[136:139]
v_and_b32 v59, 0xffff0000, v59
v_add_f32 v56, v56, v58
v_mfma_f32_16x16x32_bf16 v[136:139], a[92:95], a[12:15], v[136:139]
ds_read_b64_tr_b16 a[88:89], v222 offset:18568
ds_read_b64_tr_b16 a[90:91], v222 offset:23176
v_mfma_f32_16x16x32_bf16 v[144:147], a[92:95], a[28:31], v[144:147]
v_add_f32 v57, v57, v59
v_cvt_pk_bf16_f32 v58, v56, v57
v_mfma_f32_16x16x32_bf16 v[152:155], a[92:95], a[44:47], v[152:155]
v_lshlrev_b32 v56, 16, v58
v_and_b32 v57, 0xffff0000, v58
v_mfma_f32_16x16x32_bf16 v[160:163], a[92:95], a[60:63], v[160:163]
v_mul_f32 v58, 0xbfb8aa3b, v56
v_mul_f32 v59, 0xbfb8aa3b, v57
s_waitcnt lgkmcnt(8)
v_mfma_f32_16x16x32_bf16 v[164:167], a[64:67], a[112:115], v[164:167]
ds_read_b64_tr_b16 a[92:93], v222 offset:27784
ds_read_b64_tr_b16 a[94:95], v222 offset:32392
v_mfma_f32_16x16x32_bf16 v[156:159], a[64:67], a[96:99], v[156:159]
v_exp_f32 v58, v58
v_mfma_f32_16x16x32_bf16 v[148:151], a[64:67], a[208:211], v[148:151]
v_exp_f32 v59, v59
v_mfma_f32_16x16x32_bf16 v[140:143], a[64:67], a[192:195], v[140:143]
v_add_f32 v58, 1.0, v58
v_add_f32 v59, 1.0, v59
v_mfma_f32_16x16x32_bf16 v[140:143], a[68:71], a[196:199], v[140:143]
ds_read_b64_tr_b16 a[64:65], v220 offset:128
ds_read_b64_tr_b16 a[66:67], v220 offset:4736
v_mfma_f32_16x16x32_bf16 v[148:151], a[68:71], a[244:247], v[148:151]
v_rcp_f32 v58, v58
v_mfma_f32_16x16x32_bf16 v[156:159], a[68:71], a[100:103], v[156:159]
v_rcp_f32 v59, v59
v_mfma_f32_16x16x32_bf16 v[164:167], a[68:71], a[116:119], v[164:167]
v_mul_f32 v56, v56, v58
v_mul_f32 v57, v57, v59
v_mfma_f32_16x16x32_bf16 v[164:167], a[72:75], a[120:123], v[164:167]
ds_read_b64_tr_b16 a[68:69], v220 offset:9344
ds_read_b64_tr_b16 a[70:71], v220 offset:13952
v_mfma_f32_16x16x32_bf16 v[156:159], a[72:75], a[104:107], v[156:159]
v_cvt_pk_bf16_f32 v58, v56, v57
v_lshlrev_b32 v56, 16, v58
v_mfma_f32_16x16x32_bf16 v[148:151], a[72:75], a[248:251], v[148:151]
v_and_b32 v57, 0xffff0000, v58
v_accvgpr_read_b32 v19, a212
v_mfma_f32_16x16x32_bf16 v[140:143], a[72:75], a[200:203], v[140:143]
v_lshlrev_b32 v18, 16, v19
v_and_b32 v19, 0xffff0000, v19
s_waitcnt lgkmcnt(8)
v_mfma_f32_16x16x32_bf16 v[140:143], a[76:79], a[204:207], v[140:143]
ds_read_b64_tr_b16 a[72:73], v220 offset:18560
ds_read_b64_tr_b16 a[74:75], v220 offset:23168
v_mfma_f32_16x16x32_bf16 v[148:151], a[76:79], a[252:255], v[148:151]
v_accvgpr_read_b32 v21, a213
v_lshlrev_b32 v20, 16, v21
v_mfma_f32_16x16x32_bf16 v[156:159], a[76:79], a[108:111], v[156:159]
v_and_b32 v21, 0xffff0000, v21
v_accvgpr_read_b32 v23, a214
v_mfma_f32_16x16x32_bf16 v[164:167], a[76:79], a[124:127], v[164:167]
v_lshlrev_b32 v22, 16, v23
v_and_b32 v23, 0xffff0000, v23
v_mfma_f32_16x16x32_bf16 v[164:167], a[80:83], a[48:51], v[164:167]
ds_read_b64_tr_b16 a[76:77], v220 offset:27776
ds_read_b64_tr_b16 a[78:79], v220 offset:32384
v_mfma_f32_16x16x32_bf16 v[156:159], a[80:83], a[32:35], v[156:159]
v_accvgpr_read_b32 v25, a215
v_lshlrev_b32 v24, 16, v25
v_mfma_f32_16x16x32_bf16 v[148:151], a[80:83], a[16:19], v[148:151]
s_waitcnt vmcnt(0)
buffer_store_dword v231, v254, s[20:23], s28 offen sc0 sc1
v_mfma_f32_16x16x32_bf16 v[140:143], a[80:83], a[0:3], v[140:143]
v_and_b32 v25, 0xffff0000, v25
v_accvgpr_read_b32 v27, a216
v_mfma_f32_16x16x32_bf16 v[140:143], a[84:87], a[4:7], v[140:143]
ds_read_b64_tr_b16 a[80:81], v223 offset:128
ds_read_b64_tr_b16 a[82:83], v223 offset:4736
v_mfma_f32_16x16x32_bf16 v[148:151], a[84:87], a[20:23], v[148:151]
v_lshlrev_b32 v26, 16, v27
v_and_b32 v27, 0xffff0000, v27
v_mfma_f32_16x16x32_bf16 v[156:159], a[84:87], a[36:39], v[156:159]
v_accvgpr_read_b32 v29, a217
v_lshlrev_b32 v28, 16, v29
v_mfma_f32_16x16x32_bf16 v[164:167], a[84:87], a[52:55], v[164:167]
v_and_b32 v29, 0xffff0000, v29
v_accvgpr_read_b32 v31, a218
s_waitcnt lgkmcnt(8)
v_mfma_f32_16x16x32_bf16 v[164:167], a[88:91], a[56:59], v[164:167]
ds_read_b64_tr_b16 a[84:85], v223 offset:9344
ds_read_b64_tr_b16 a[86:87], v223 offset:13952
v_mfma_f32_16x16x32_bf16 v[156:159], a[88:91], a[40:43], v[156:159]
v_lshlrev_b32 v30, 16, v31
v_and_b32 v31, 0xffff0000, v31
v_mfma_f32_16x16x32_bf16 v[148:151], a[88:91], a[24:27], v[148:151]
v_accvgpr_read_b32 v33, a219
v_lshlrev_b32 v32, 16, v33
v_mfma_f32_16x16x32_bf16 v[140:143], a[88:91], a[8:11], v[140:143]
v_and_b32 v33, 0xffff0000, v33
v_accvgpr_read_b32 v35, a220
v_mfma_f32_16x16x32_bf16 v[140:143], a[92:95], a[12:15], v[140:143]
ds_read_b64_tr_b16 a[88:89], v223 offset:18560
ds_read_b64_tr_b16 a[90:91], v223 offset:23168
v_mfma_f32_16x16x32_bf16 v[148:151], a[92:95], a[28:31], v[148:151]
v_lshlrev_b32 v34, 16, v35
v_and_b32 v35, 0xffff0000, v35
v_mfma_f32_16x16x32_bf16 v[156:159], a[92:95], a[44:47], v[156:159]
v_accvgpr_read_b32 v37, a221
v_lshlrev_b32 v36, 16, v37
v_mfma_f32_16x16x32_bf16 v[164:167], a[92:95], a[60:63], v[164:167]
v_and_b32 v37, 0xffff0000, v37
v_mfma_f32_16x16x32_bf16 v[192:195], a[64:67], a[112:115], v[192:195]
ds_read_b64_tr_b16 a[92:93], v223 offset:27776
ds_read_b64_tr_b16 a[94:95], v223 offset:32384
v_mfma_f32_16x16x32_bf16 v[184:187], a[64:67], a[96:99], v[184:187]
s_mov_b32 s90, 0x3f80
s_mov_b32 s91, 0x3f800000
v_mfma_f32_16x16x32_bf16 v[176:179], a[64:67], a[208:211], v[176:179]
v_mov_b32 v66, 0
v_mov_b32 v67, 0
v_mfma_f32_16x16x32_bf16 v[168:171], a[64:67], a[192:195], v[168:171]
v_mov_b32 v68, 0
v_mov_b32 v69, 0
s_waitcnt lgkmcnt(8)
v_mfma_f32_16x16x32_bf16 v[168:171], a[68:71], a[196:199], v[168:171]
ds_read_b64_tr_b16 a[64:65], v220 offset:136
ds_read_b64_tr_b16 a[66:67], v220 offset:4744
v_mfma_f32_16x16x32_bf16 v[176:179], a[68:71], a[244:247], v[176:179]
v_mfma_f32_16x16x32_bf16 v[184:187], a[68:71], a[100:103], v[184:187]
v_mfma_f32_16x16x32_bf16 v[192:195], a[68:71], a[116:119], v[192:195]
v_mfma_f32_16x16x32_bf16 v[192:195], a[72:75], a[120:123], v[192:195]
ds_read_b64_tr_b16 a[68:69], v220 offset:9352
ds_read_b64_tr_b16 a[70:71], v220 offset:13960
v_mfma_f32_16x16x32_bf16 v[184:187], a[72:75], a[104:107], v[184:187]
s_add_u32 s39, s44, 8192
v_mfma_f32_16x16x32_bf16 v[176:179], a[72:75], a[248:251], v[176:179]
v_cvt_pk_bf16_f32 v144, v144, v145
v_cvt_pk_bf16_f32 v145, v146, v147
v_mfma_f32_16x16x32_bf16 v[168:171], a[72:75], a[200:203], v[168:171]
v_cvt_pk_bf16_f32 v146, v148, v149
v_cvt_pk_bf16_f32 v147, v150, v151
v_mfma_f32_16x16x32_bf16 v[168:171], a[76:79], a[204:207], v[168:171]
ds_read_b64_tr_b16 a[72:73], v220 offset:18568
ds_read_b64_tr_b16 a[74:75], v220 offset:23176
v_mfma_f32_16x16x32_bf16 v[176:179], a[76:79], a[252:255], v[176:179]
buffer_store_dwordx4 v[144:147], v244, s[20:23], s39 offen offset:1024 sc0 sc1
v_mfma_f32_16x16x32_bf16 v[184:187], a[76:79], a[108:111], v[184:187]
v_cvt_pk_bf16_f32 v152, v152, v153
v_cvt_pk_bf16_f32 v153, v154, v155
v_mfma_f32_16x16x32_bf16 v[192:195], a[76:79], a[124:127], v[192:195]
v_cvt_pk_bf16_f32 v154, v156, v157
v_cvt_pk_bf16_f32 v155, v158, v159
s_waitcnt lgkmcnt(8)
v_mfma_f32_16x16x32_bf16 v[192:195], a[80:83], a[48:51], v[192:195]
ds_read_b64_tr_b16 a[76:77], v220 offset:27784
ds_read_b64_tr_b16 a[78:79], v220 offset:32392
v_mfma_f32_16x16x32_bf16 v[184:187], a[80:83], a[32:35], v[184:187]
buffer_store_dwordx4 v[152:155], v244, s[20:23], s39 offen offset:2048 sc0 sc1
v_mfma_f32_16x16x32_bf16 v[176:179], a[80:83], a[16:19], v[176:179]
v_cvt_pk_bf16_f32 v160, v160, v161
v_cvt_pk_bf16_f32 v161, v162, v163
v_mfma_f32_16x16x32_bf16 v[168:171], a[80:83], a[0:3], v[168:171]
v_cvt_pk_bf16_f32 v162, v164, v165
v_cvt_pk_bf16_f32 v163, v166, v167
v_mfma_f32_16x16x32_bf16 v[168:171], a[84:87], a[4:7], v[168:171]
ds_read_b64_tr_b16 a[80:81], v223 offset:136
ds_read_b64_tr_b16 a[82:83], v223 offset:4744
v_mfma_f32_16x16x32_bf16 v[176:179], a[84:87], a[20:23], v[176:179]
buffer_store_dwordx4 v[160:163], v244, s[20:23], s39 offen offset:3072 sc0 sc1
v_mfma_f32_16x16x32_bf16 v[184:187], a[84:87], a[36:39], v[184:187]
buffer_load_dword v230, v229, s[20:23], s95 offen sc0 sc1
v_mfma_f32_16x16x32_bf16 v[192:195], a[84:87], a[52:55], v[192:195]
v_mfma_f32_16x16x32_bf16 v[192:195], a[88:91], a[56:59], v[192:195]
ds_read_b64_tr_b16 a[84:85], v223 offset:9352
ds_read_b64_tr_b16 a[86:87], v223 offset:13960
v_mfma_f32_16x16x32_bf16 v[184:187], a[88:91], a[40:43], v[184:187]
v_mfma_f32_16x16x32_bf16 v[176:179], a[88:91], a[24:27], v[176:179]
v_mfma_f32_16x16x32_bf16 v[168:171], a[88:91], a[8:11], v[168:171]
s_waitcnt lgkmcnt(8)
v_mfma_f32_16x16x32_bf16 v[168:171], a[92:95], a[12:15], v[168:171]
ds_read_b64_tr_b16 a[88:89], v223 offset:18568
ds_read_b64_tr_b16 a[90:91], v223 offset:23176
v_mfma_f32_16x16x32_bf16 v[176:179], a[92:95], a[28:31], v[176:179]
v_mfma_f32_16x16x32_bf16 v[184:187], a[92:95], a[44:47], v[184:187]
v_mfma_f32_16x16x32_bf16 v[192:195], a[92:95], a[60:63], v[192:195]
v_mfma_f32_16x16x32_bf16 v[196:199], a[64:67], a[112:115], v[196:199]
ds_read_b64_tr_b16 a[92:93], v223 offset:27784
ds_read_b64_tr_b16 a[94:95], v223 offset:32392
v_mfma_f32_16x16x32_bf16 v[188:191], a[64:67], a[96:99], v[188:191]
v_mfma_f32_16x16x32_bf16 v[180:183], a[64:67], a[208:211], v[180:183]
v_mfma_f32_16x16x32_bf16 v[172:175], a[64:67], a[192:195], v[172:175]
v_mfma_f32_16x16x32_bf16 v[172:175], a[68:71], a[196:199], v[172:175]
v_mfma_f32_16x16x32_bf16 v[180:183], a[68:71], a[244:247], v[180:183]
v_mfma_f32_16x16x32_bf16 v[188:191], a[68:71], a[100:103], v[188:191]
v_mfma_f32_16x16x32_bf16 v[196:199], a[68:71], a[116:119], v[196:199]
s_waitcnt lgkmcnt(8)
v_mfma_f32_16x16x32_bf16 v[196:199], a[72:75], a[120:123], v[196:199]
v_mfma_f32_16x16x32_bf16 v[188:191], a[72:75], a[104:107], v[188:191]
v_mfma_f32_16x16x32_bf16 v[180:183], a[72:75], a[248:251], v[180:183]
v_mfma_f32_16x16x32_bf16 v[172:175], a[72:75], a[200:203], v[172:175]
v_mfma_f32_16x16x32_bf16 v[172:175], a[76:79], a[204:207], v[172:175]
v_mfma_f32_16x16x32_bf16 v[180:183], a[76:79], a[252:255], v[180:183]
v_mfma_f32_16x16x32_bf16 v[188:191], a[76:79], a[108:111], v[188:191]
s_waitcnt vmcnt(0)
v_cmp_gt_u32 vcc, 1, v230
v_mfma_f32_16x16x32_bf16 v[196:199], a[76:79], a[124:127], v[196:199]
s_waitcnt lgkmcnt(6)
v_mfma_f32_16x16x32_bf16 v[196:199], a[80:83], a[48:51], v[196:199]
s_and_b32 s29, vcc_lo, 0xff
s_cbranch_scc1 SP_P1B
SP_P1B_RET:
v_mfma_f32_16x16x32_bf16 v[188:191], a[80:83], a[32:35], v[188:191]
buffer_load_dwordx4 v[104:107], v244, s[20:23], s65 offen offset:3072 sc0 sc1
v_mfma_f32_16x16x32_bf16 v[180:183], a[80:83], a[16:19], v[180:183]
buffer_load_dwordx4 v[108:111], v244, s[20:23], s66 offen offset:2048 sc0 sc1
v_mfma_f32_16x16x32_bf16 v[172:175], a[80:83], a[0:3], v[172:175]
buffer_load_dwordx4 v[112:115], v244, s[20:23], s67 offen offset:1024 sc0 sc1
s_waitcnt lgkmcnt(4)
v_mfma_f32_16x16x32_bf16 v[172:175], a[84:87], a[4:7], v[172:175]
buffer_load_dwordx4 v[116:119], v244, s[20:23], s68 offen offset:0 sc0 sc1
v_mfma_f32_16x16x32_bf16 v[180:183], a[84:87], a[20:23], v[180:183]
buffer_load_dwordx4 v[120:123], v244, s[20:23], s69 offen offset:3072 sc0 sc1
v_mfma_f32_16x16x32_bf16 v[188:191], a[84:87], a[36:39], v[188:191]
buffer_load_dwordx4 v[124:127], v244, s[20:23], s70 offen offset:2048 sc0 sc1
v_mfma_f32_16x16x32_bf16 v[196:199], a[84:87], a[52:55], v[196:199]
buffer_load_dwordx4 v[128:131], v244, s[20:23], s71 offen offset:1024 sc0 sc1
s_waitcnt lgkmcnt(2)
v_mfma_f32_16x16x32_bf16 v[196:199], a[88:91], a[56:59], v[196:199]
v_mfma_f32_16x16x32_bf16 v[188:191], a[88:91], a[40:43], v[188:191]
v_mfma_f32_16x16x32_bf16 v[180:183], a[88:91], a[24:27], v[180:183]
v_mfma_f32_16x16x32_bf16 v[172:175], a[88:91], a[8:11], v[172:175]
s_waitcnt lgkmcnt(0)
v_mfma_f32_16x16x32_bf16 v[172:175], a[92:95], a[12:15], v[172:175]
v_mfma_f32_16x16x32_bf16 v[180:183], a[92:95], a[28:31], v[180:183]
v_mfma_f32_16x16x32_bf16 v[188:191], a[92:95], a[44:47], v[188:191]
v_mfma_f32_16x16x32_bf16 v[196:199], a[92:95], a[60:63], v[196:199]
s_add_u32 s39, s44, 12288
s_nop 5
v_cvt_pk_bf16_f32 v168, v168, v169
v_cvt_pk_bf16_f32 v169, v170, v171
v_cvt_pk_bf16_f32 v170, v172, v173
v_cvt_pk_bf16_f32 v171, v174, v175
buffer_store_dwordx4 v[168:171], v244, s[20:23], s39 offen offset:0 sc0 sc1
v_cvt_pk_bf16_f32 v176, v176, v177
v_cvt_pk_bf16_f32 v177, v178, v179
v_cvt_pk_bf16_f32 v178, v180, v181
v_cvt_pk_bf16_f32 v179, v182, v183
buffer_store_dwordx4 v[176:179], v244, s[20:23], s39 offen offset:1024 sc0 sc1
v_cvt_pk_bf16_f32 v184, v184, v185
v_cvt_pk_bf16_f32 v185, v186, v187
v_cvt_pk_bf16_f32 v186, v188, v189
v_cvt_pk_bf16_f32 v187, v190, v191
buffer_store_dwordx4 v[184:187], v244, s[20:23], s39 offen offset:2048 sc0 sc1
v_cvt_pk_bf16_f32 v192, v192, v193
v_cvt_pk_bf16_f32 v193, v194, v195
v_cvt_pk_bf16_f32 v194, v196, v197
v_cvt_pk_bf16_f32 v195, v198, v199
buffer_store_dwordx4 v[192:195], v244, s[20:23], s39 offen offset:3072 sc0 sc1
buffer_load_dwordx2 v[200:201], v226, s[20:23], s72 offen offset:0 sc0 sc1
buffer_load_dwordx2 v[202:203], v226, s[20:23], s73 offen offset:512 sc0 sc1
buffer_load_dwordx2 v[204:205], v226, s[20:23], s74 offen offset:0 sc0 sc1
buffer_load_dwordx2 v[206:207], v226, s[20:23], s75 offen offset:512 sc0 sc1
buffer_load_dwordx2 v[208:209], v226, s[20:23], s84 offen offset:0 sc0 sc1
buffer_load_dwordx2 v[210:211], v226, s[20:23], s85 offen offset:512 sc0 sc1
buffer_load_dwordx2 v[212:213], v226, s[20:23], s86 offen offset:0 sc0 sc1
buffer_load_dwordx2 v[214:215], v226, s[20:23], s87 offen offset:512 sc0 sc1
s_waitcnt vmcnt(8)
buffer_store_dword v246, v254, s[20:23], s28 offen sc0 sc1
buffer_load_dword v230, v229, s[20:23], s95 offen sc0 sc1
s_waitcnt vmcnt(20)
v_dot2c_f32_bf16 v72, s90, v104
v_dot2c_f32_bf16 v73, s91, v104
v_dot2c_f32_bf16 v74, s90, v105
v_dot2c_f32_bf16 v75, s91, v105
v_dot2c_f32_bf16 v76, s90, v106
v_dot2c_f32_bf16 v77, s91, v106
v_dot2c_f32_bf16 v78, s90, v107
v_dot2c_f32_bf16 v79, s91, v107
s_waitcnt vmcnt(19)
v_dot2c_f32_bf16 v72, s90, v108
v_dot2c_f32_bf16 v73, s91, v108
v_dot2c_f32_bf16 v74, s90, v109
v_dot2c_f32_bf16 v75, s91, v109
v_dot2c_f32_bf16 v76, s90, v110
v_dot2c_f32_bf16 v77, s91, v110
v_dot2c_f32_bf16 v78, s90, v111
v_dot2c_f32_bf16 v79, s91, v111
s_waitcnt vmcnt(18)
v_dot2c_f32_bf16 v72, s90, v112
v_dot2c_f32_bf16 v73, s91, v112
v_dot2c_f32_bf16 v74, s90, v113
v_dot2c_f32_bf16 v75, s91, v113
v_dot2c_f32_bf16 v76, s90, v114
v_dot2c_f32_bf16 v77, s91, v114
v_dot2c_f32_bf16 v78, s90, v115
v_dot2c_f32_bf16 v79, s91, v115
s_waitcnt vmcnt(17)
v_dot2c_f32_bf16 v72, s90, v116
v_dot2c_f32_bf16 v73, s91, v116
v_dot2c_f32_bf16 v74, s90, v117
v_dot2c_f32_bf16 v75, s91, v117
v_dot2c_f32_bf16 v76, s90, v118
v_dot2c_f32_bf16 v77, s91, v118
v_dot2c_f32_bf16 v78, s90, v119
v_dot2c_f32_bf16 v79, s91, v119
s_waitcnt vmcnt(16)
v_dot2c_f32_bf16 v72, s90, v120
v_dot2c_f32_bf16 v73, s91, v120
v_dot2c_f32_bf16 v74, s90, v121
v_dot2c_f32_bf16 v75, s91, v121
v_dot2c_f32_bf16 v76, s90, v122
v_dot2c_f32_bf16 v77, s91, v122
v_dot2c_f32_bf16 v78, s90, v123
v_dot2c_f32_bf16 v79, s91, v123
s_waitcnt vmcnt(15)
v_dot2c_f32_bf16 v72, s90, v124
v_dot2c_f32_bf16 v73, s91, v124
v_dot2c_f32_bf16 v74, s90, v125
v_dot2c_f32_bf16 v75, s91, v125
v_dot2c_f32_bf16 v76, s90, v126
v_dot2c_f32_bf16 v77, s91, v126
v_dot2c_f32_bf16 v78, s90, v127
v_dot2c_f32_bf16 v79, s91, v127
s_waitcnt vmcnt(14)
v_dot2c_f32_bf16 v72, s90, v128
v_dot2c_f32_bf16 v73, s91, v128
v_dot2c_f32_bf16 v74, s90, v129
v_dot2c_f32_bf16 v75, s91, v129
v_dot2c_f32_bf16 v76, s90, v130
v_dot2c_f32_bf16 v77, s91, v130
v_dot2c_f32_bf16 v78, s90, v131
v_dot2c_f32_bf16 v79, s91, v131
s_nop 2
v_cvt_pk_bf16_f32 v58, v72, v73
v_cvt_pk_bf16_f32 v59, v74, v75
v_cvt_pk_bf16_f32 v60, v76, v77
v_cvt_pk_bf16_f32 v61, v78, v79
v_lshlrev_b32 v72, 16, v58
v_and_b32 v73, 0xffff0000, v58
v_lshlrev_b32 v74, 16, v59
v_and_b32 v75, 0xffff0000, v59
v_lshlrev_b32 v76, 16, v60
v_and_b32 v77, 0xffff0000, v60
v_lshlrev_b32 v78, 16, v61
v_and_b32 v79, 0xffff0000, v61
v_pk_mul_f32 v[72:73], v[72:73], v[38:39]
v_pk_mul_f32 v[74:75], v[74:75], v[40:41]
v_pk_mul_f32 v[76:77], v[76:77], v[42:43]
v_pk_mul_f32 v[78:79], v[78:79], v[44:45]
v_cvt_pk_bf16_f32 v58, v72, v73
v_cvt_pk_bf16_f32 v59, v74, v75
v_cvt_pk_bf16_f32 v60, v76, v77
v_cvt_pk_bf16_f32 v61, v78, v79
v_lshlrev_b32 v72, 16, v58
v_and_b32 v73, 0xffff0000, v58
v_lshlrev_b32 v74, 16, v59
v_and_b32 v75, 0xffff0000, v59
v_lshlrev_b32 v76, 16, v60
v_and_b32 v77, 0xffff0000, v60
v_lshlrev_b32 v78, 16, v61
v_and_b32 v79, 0xffff0000, v61
v_pk_add_f32 v[72:73], v[72:73], v[18:19]
v_pk_add_f32 v[74:75], v[74:75], v[20:21]
v_pk_add_f32 v[76:77], v[76:77], v[22:23]
v_pk_add_f32 v[78:79], v[78:79], v[24:25]
v_cvt_pk_bf16_f32 v72, v72, v73
v_cvt_pk_bf16_f32 v73, v74, v75
v_cvt_pk_bf16_f32 v74, v76, v77
v_cvt_pk_bf16_f32 v75, v78, v79
buffer_store_dwordx4 v[72:75], v248, s[60:63], 0 offen
s_waitcnt vmcnt(1)
v_cmp_gt_u32 vcc, 2, v230
s_nop 0
s_and_b32 s29, vcc_lo, 0xff
s_cbranch_scc0 SP_P2B_RET
SP_P2B:
s_sleep 0
s_add_u32 s100, s100, 1
s_bitcmp1_b32 s100, 19
s_cbranch_scc1 K_END
buffer_load_dword v230, v229, s[20:23], s95 offen sc0 sc1
s_waitcnt vmcnt(0)
v_cmp_gt_u32 vcc, 2, v230
s_nop 0
s_and_b32 s29, vcc_lo, 0xff
s_cbranch_scc1 SP_P2B
SP_P2B_RET:
buffer_load_dwordx4 v[80:83], v243, s[20:23], s65 offen offset:3072 sc0 sc1
buffer_load_dwordx4 v[84:87], v243, s[20:23], s66 offen offset:2048 sc0 sc1
buffer_load_dwordx4 v[88:91], v243, s[20:23], s67 offen offset:1024 sc0 sc1
buffer_load_dwordx4 v[92:95], v243, s[20:23], s68 offen offset:0 sc0 sc1
buffer_load_dwordx4 v[96:99], v243, s[20:23], s69 offen offset:3072 sc0 sc1
buffer_load_dwordx4 v[100:103], v243, s[20:23], s70 offen offset:2048 sc0 sc1
buffer_load_dwordx4 v[132:135], v243, s[20:23], s71 offen offset:1024 sc0 sc1
s_waitcnt vmcnt(17)
v_dot2c_f32_bf16 v66, s90, v200
v_dot2c_f32_bf16 v67, s91, v200
v_dot2c_f32_bf16 v68, s90, v201
v_dot2c_f32_bf16 v69, s91, v201
s_waitcnt vmcnt(16)
v_dot2c_f32_bf16 v66, s90, v202
v_dot2c_f32_bf16 v67, s91, v202
v_dot2c_f32_bf16 v68, s90, v203
v_dot2c_f32_bf16 v69, s91, v203
s_waitcnt vmcnt(15)
v_dot2c_f32_bf16 v66, s90, v204
v_dot2c_f32_bf16 v67, s91, v204
v_dot2c_f32_bf16 v68, s90, v205
v_dot2c_f32_bf16 v69, s91, v205
s_waitcnt vmcnt(14)
v_dot2c_f32_bf16 v66, s90, v206
v_dot2c_f32_bf16 v67, s91, v206
v_dot2c_f32_bf16 v68, s90, v207
v_dot2c_f32_bf16 v69, s91, v207
s_waitcnt vmcnt(13)
v_dot2c_f32_bf16 v66, s90, v208
v_dot2c_f32_bf16 v67, s91, v208
v_dot2c_f32_bf16 v68, s90, v209
v_dot2c_f32_bf16 v69, s91, v209
s_waitcnt vmcnt(12)
v_dot2c_f32_bf16 v66, s90, v210
v_dot2c_f32_bf16 v67, s91, v210
v_dot2c_f32_bf16 v68, s90, v211
v_dot2c_f32_bf16 v69, s91, v211
s_waitcnt vmcnt(11)
v_dot2c_f32_bf16 v66, s90, v212
v_dot2c_f32_bf16 v67, s91, v212
v_dot2c_f32_bf16 v68, s90, v213
v_dot2c_f32_bf16 v69, s91, v213
s_waitcnt vmcnt(10)
v_dot2c_f32_bf16 v66, s90, v214
v_dot2c_f32_bf16 v67, s91, v214
v_dot2c_f32_bf16 v68, s90, v215
v_dot2c_f32_bf16 v69, s91, v215
s_nop 2
s_cmp_eq_u32 s34, 0
s_cselect_b32 s29, 0, 0x7fbffff0
v_cvt_pk_bf16_f32 v58, v66, v67
v_cvt_pk_bf16_f32 v59, v68, v69
v_lshlrev_b32 v66, 16, v58
v_and_b32 v67, 0xffff0000, v58
v_lshlrev_b32 v68, 16, v59
v_and_b32 v69, 0xffff0000, v59
v_pk_mul_f32 v[66:67], v[66:67], v[54:55]
v_pk_mul_f32 v[68:69], v[68:69], v[56:57]
v_cvt_pk_bf16_f32 v58, v66, v67
v_cvt_pk_bf16_f32 v59, v68, v69
v_lshlrev_b32 v66, 16, v58
v_and_b32 v67, 0xffff0000, v58
v_lshlrev_b32 v68, 16, v59
v_and_b32 v69, 0xffff0000, v59
v_pk_add_f32 v[66:67], v[66:67], v[34:35]
v_pk_add_f32 v[68:69], v[68:69], v[36:37]
v_cvt_pk_bf16_f32 v66, v66, v67
v_cvt_pk_bf16_f32 v67, v68, v69
buffer_store_dwordx2 v[66:67], v249, s[60:63], s29 offen
s_waitcnt vmcnt(7)
v_dot2c_f32_bf16 v136, s90, v80
v_dot2c_f32_bf16 v137, s91, v80
v_dot2c_f32_bf16 v138, s90, v81
v_dot2c_f32_bf16 v139, s91, v81
v_dot2c_f32_bf16 v140, s90, v82
v_dot2c_f32_bf16 v141, s91, v82
v_dot2c_f32_bf16 v142, s90, v83
v_dot2c_f32_bf16 v143, s91, v83
s_waitcnt vmcnt(6)
v_dot2c_f32_bf16 v136, s90, v84
v_dot2c_f32_bf16 v137, s91, v84
v_dot2c_f32_bf16 v138, s90, v85
v_dot2c_f32_bf16 v139, s91, v85
v_dot2c_f32_bf16 v140, s90, v86
v_dot2c_f32_bf16 v141, s91, v86
v_dot2c_f32_bf16 v142, s90, v87
v_dot2c_f32_bf16 v143, s91, v87
s_waitcnt vmcnt(5)
v_dot2c_f32_bf16 v136, s90, v88
v_dot2c_f32_bf16 v137, s91, v88
v_dot2c_f32_bf16 v138, s90, v89
v_dot2c_f32_bf16 v139, s91, v89
v_dot2c_f32_bf16 v140, s90, v90
v_dot2c_f32_bf16 v141, s91, v90
v_dot2c_f32_bf16 v142, s90, v91
v_dot2c_f32_bf16 v143, s91, v91
s_waitcnt vmcnt(4)
v_dot2c_f32_bf16 v136, s90, v92
v_dot2c_f32_bf16 v137, s91, v92
v_dot2c_f32_bf16 v138, s90, v93
v_dot2c_f32_bf16 v139, s91, v93
v_dot2c_f32_bf16 v140, s90, v94
v_dot2c_f32_bf16 v141, s91, v94
v_dot2c_f32_bf16 v142, s90, v95
v_dot2c_f32_bf16 v143, s91, v95
s_waitcnt vmcnt(3)
v_dot2c_f32_bf16 v136, s90, v96
v_dot2c_f32_bf16 v137, s91, v96
v_dot2c_f32_bf16 v138, s90, v97
v_dot2c_f32_bf16 v139, s91, v97
v_dot2c_f32_bf16 v140, s90, v98
v_dot2c_f32_bf16 v141, s91, v98
v_dot2c_f32_bf16 v142, s90, v99
v_dot2c_f32_bf16 v143, s91, v99
s_waitcnt vmcnt(2)
v_dot2c_f32_bf16 v136, s90, v100
v_dot2c_f32_bf16 v137, s91, v100
v_dot2c_f32_bf16 v138, s90, v101
v_dot2c_f32_bf16 v139, s91, v101
v_dot2c_f32_bf16 v140, s90, v102
v_dot2c_f32_bf16 v141, s91, v102
v_dot2c_f32_bf16 v142, s90, v103
v_dot2c_f32_bf16 v143, s91, v103
s_waitcnt vmcnt(1)
v_dot2c_f32_bf16 v136, s90, v132
v_dot2c_f32_bf16 v137, s91, v132
v_dot2c_f32_bf16 v138, s90, v133
v_dot2c_f32_bf16 v139, s91, v133
v_dot2c_f32_bf16 v140, s90, v134
v_dot2c_f32_bf16 v141, s91, v134
v_dot2c_f32_bf16 v142, s90, v135
v_dot2c_f32_bf16 v143, s91, v135
s_nop 2
v_cvt_pk_bf16_f32 v58, v136, v137
v_cvt_pk_bf16_f32 v59, v138, v139
v_cvt_pk_bf16_f32 v60, v140, v141
v_cvt_pk_bf16_f32 v61, v142, v143
v_lshlrev_b32 v136, 16, v58
v_and_b32 v137, 0xffff0000, v58
v_lshlrev_b32 v138, 16, v59
v_and_b32 v139, 0xffff0000, v59
v_lshlrev_b32 v140, 16, v60
v_and_b32 v141, 0xffff0000, v60
v_lshlrev_b32 v142, 16, v61
v_and_b32 v143, 0xffff0000, v61
v_pk_mul_f32 v[136:137], v[136:137], v[46:47]
v_pk_mul_f32 v[138:139], v[138:139], v[48:49]
v_pk_mul_f32 v[140:141], v[140:141], v[50:51]
v_pk_mul_f32 v[142:143], v[142:143], v[52:53]
v_cvt_pk_bf16_f32 v58, v136, v137
v_cvt_pk_bf16_f32 v59, v138, v139
v_cvt_pk_bf16_f32 v60, v140, v141
v_cvt_pk_bf16_f32 v61, v142, v143
v_lshlrev_b32 v136, 16, v58
v_and_b32 v137, 0xffff0000, v58
v_lshlrev_b32 v138, 16, v59
v_and_b32 v139, 0xffff0000, v59
v_lshlrev_b32 v140, 16, v60
v_and_b32 v141, 0xffff0000, v60
v_lshlrev_b32 v142, 16, v61
v_and_b32 v143, 0xffff0000, v61
v_pk_add_f32 v[136:137], v[136:137], v[26:27]
v_pk_add_f32 v[138:139], v[138:139], v[28:29]
v_pk_add_f32 v[140:141], v[140:141], v[30:31]
v_pk_add_f32 v[142:143], v[142:143], v[32:33]
v_cvt_pk_bf16_f32 v136, v136, v137
v_cvt_pk_bf16_f32 v137, v138, v139
v_cvt_pk_bf16_f32 v138, v140, v141
v_cvt_pk_bf16_f32 v139, v142, v143
buffer_store_dwordx4 v[136:139], v248, s[60:63], 0 offen offset:128
s_endpgm
SP_O1B:
s_sleep 1
s_add_u32 s100, s100, 1
s_bitcmp1_b32 s100, 19
s_cbranch_scc1 K_END
buffer_load_dword v230, v229, s[20:23], s94 offen sc0 sc1
s_waitcnt vmcnt(0)
v_cmp_gt_u32 vcc, 1, v230
s_bitcmp1_b32 vcc_lo, s39
s_cbranch_scc1 SP_O1B
s_branch SP_O1B_RET
SP_O2B:
s_sleep 1
s_add_u32 s100, s100, 1
s_bitcmp1_b32 s100, 19
s_cbranch_scc1 K_END
buffer_load_dword v230, v229, s[20:23], s94 offen sc0 sc1
s_waitcnt vmcnt(0)
v_cmp_gt_u32 vcc, 1, v230
s_and_b32 s29, vcc_lo, 15
s_cbranch_scc1 SP_O2B
s_branch SP_O2B_RET
SP_O3B:
s_sleep 1
s_add_u32 s100, s100, 1
s_bitcmp1_b32 s100, 19
s_cbranch_scc1 K_END
buffer_load_dword v230, v229, s[20:23], s94 offen sc0 sc1
s_waitcnt vmcnt(0)
v_cmp_gt_u32 vcc, 2, v230
s_and_b32 s29, vcc_lo, 15
s_cbranch_scc1 SP_O3B
s_branch SP_O3B_RET
SP_P1B:
s_sleep 1
s_add_u32 s100, s100, 1
s_bitcmp1_b32 s100, 19
s_cbranch_scc1 K_END
buffer_load_dword v230, v229, s[20:23], s95 offen sc0 sc1
s_waitcnt vmcnt(0)
v_cmp_gt_u32 vcc, 1, v230
s_and_b32 s29, vcc_lo, 0xff
s_cbranch_scc1 SP_P1B
s_branch SP_P1B_RET
F_NOTYET:
s_bitcmp1_b32 s51, 30
s_cbranch_scc1 F_BSENT
s_bitset1_b32 s51, 30
s_mov_b32 s46, 0x60
s_mov_b32 s50, s28
s_add_u32 s28, s45, 0x0
buffer_store_dwordx4 v[72:75], v169, s[20:23], s28 offen offset:0 sc0 sc1
buffer_store_dwordx4 v[76:79], v169, s[20:23], s28 offen offset:2048 sc0 sc1
s_add_u32 s28, s28, 4096
buffer_store_dwordx4 v[80:83], v169, s[20:23], s28 offen offset:0 sc0 sc1
buffer_store_dwordx4 v[84:87], v169, s[20:23], s28 offen offset:2048 sc0 sc1
s_add_u32 s28, s28, 4096
buffer_store_dwordx4 v[88:91], v169, s[20:23], s28 offen offset:0 sc0 sc1
buffer_store_dwordx4 v[92:95], v169, s[20:23], s28 offen offset:2048 sc0 sc1
s_add_u32 s28, s28, 4096
buffer_store_dwordx4 v[96:99], v169, s[20:23], s28 offen offset:0 sc0 sc1
buffer_store_dwordx4 v[100:103], v169, s[20:23], s28 offen offset:2048 sc0 sc1
s_add_u32 s28, s28, 4096
buffer_store_dwordx4 v[104:107], v169, s[20:23], s28 offen offset:0 sc0 sc1
s_lshl_b32 s28, s3, 2
s_add_u32 s28, s28, 0x240000
buffer_store_dword v65, v64, s[20:23], s28 offen sc0 sc1
s_mov_b32 s28, s50
s_or_b32 s29, s38, 0x40
v_mov_b32 v62, s29
v_mov_b32 v63, s35
s_lshl_b32 s29, s36, 5
s_waitcnt vmcnt(0)
s_mov_b64 exec, 1
buffer_store_byte v62, v63, s[24:27], s29 offen sc0 sc1
s_mov_b64 exec, -1
F_BSENT:
s_lshl_b32 s29, s36, 5
buffer_load_dword v62, v64, s[24:27], s29 offen sc0 sc1
s_waitcnt vmcnt(0)
v_and_b32 v63, 0x40404040, v62
v_cmp_ne_u32 vcc, 0x40404040, v63
s_cbranch_vccnz F_NOB
s_mul_i32 s29, s38, 0x01010101
v_and_b32 v62, 0x0f0f0f0f, v62
v_cmp_ne_u32 vcc, s29, v62
v_mov_b32 v60, 0
s_cbranch_vccnz F_GO
v_mov_b32 v60, 1
s_branch F_GO
F_NOB:
s_sleep 1
s_add_u32 s100, s100, 1
s_bitcmp1_b32 s100, 19
s_cbranch_scc1 K_END
s_branch F_POLL
Q_REDO:
s_mov_b32 s4, 0
s_mov_b32 s51, 0
s_waitcnt vmcnt(0) lgkmcnt(0)
s_branch Q_START
K_FALLBACK:
s_mov_b32 s43, 1
s_mov_b32 s3, 0
s_mov_b32 s86, 0x30000
s_mov_b32 s66, 0
s_mov_b32 s70, 0
s_mov_b32 s74, 0
s_waitcnt vmcnt(0) lgkmcnt(0)
s_barrier
v_mov_b32 v254, 0x7ffffff0
v_mov_b32 v136, 0xff800000
v_mov_b32 v140, 0xff800000
v_mov_b32 v144, 0xff800000
v_mov_b32 v148, 0xff800000
s_mov_b32 s32, 0
s_mov_b32 s33, 32
K_FBLOOP:
s_add_u32 m0, s30, 81920
s_nop 0
buffer_load_dwordx4 v228, s[8:11], s32 offen offset:0  lds
buffer_load_dwordx4 v229, s[8:11], s32 offen offset:1024  lds
buffer_load_dwordx4 v230, s[8:11], s32 offen offset:2048  lds
buffer_load_dwordx4 v231, s[8:11], s32 offen offset:3072  lds
s_waitcnt vmcnt(0)
s_barrier
ds_read_b128 a[144:147], v216 offset:16384
ds_read_b128 a[148:151], v217 offset:16384
ds_read_b128 a[152:155], v218 offset:16384
ds_read_b128 a[156:159], v219 offset:16384
ds_read_b128 a[160:163], v216 offset:20480
ds_read_b128 a[164:167], v217 offset:20480
ds_read_b128 a[168:171], v218 offset:20480
ds_read_b128 a[172:175], v219 offset:20480
s_waitcnt lgkmcnt(0)
v_mfma_f32_16x16x32_bf16 v[8:11], a[144:147], v[152:155], 0
v_mfma_f32_16x16x32_bf16 v[16:19], a[144:147], v[168:171], 0
v_mfma_f32_16x16x32_bf16 v[24:27], a[144:147], v[184:187], 0
v_mfma_f32_16x16x32_bf16 v[32:35], a[144:147], v[200:203], 0
v_mfma_f32_16x16x32_bf16 v[8:11], a[148:151], v[156:159], v[8:11]
v_mfma_f32_16x16x32_bf16 v[16:19], a[148:151], v[172:175], v[16:19]
v_mfma_f32_16x16x32_bf16 v[24:27], a[148:151], v[188:191], v[24:27]
v_mfma_f32_16x16x32_bf16 v[32:35], a[148:151], v[204:207], v[32:35]
v_mfma_f32_16x16x32_bf16 v[8:11], a[152:155], v[160:163], v[8:11]
v_mfma_f32_16x16x32_bf16 v[16:19], a[152:155], v[176:179], v[16:19]
v_mfma_f32_16x16x32_bf16 v[24:27], a[152:155], v[192:195], v[24:27]
v_mfma_f32_16x16x32_bf16 v[32:35], a[152:155], v[208:211], v[32:35]
v_mfma_f32_16x16x32_bf16 v[8:11], a[156:159], v[164:167], v[8:11]
v_mfma_f32_16x16x32_bf16 v[16:19], a[156:159], v[180:183], v[16:19]
v_mfma_f32_16x16x32_bf16 v[24:27], a[156:159], v[196:199], v[24:27]
v_mfma_f32_16x16x32_bf16 v[32:35], a[156:159], v[212:215], v[32:35]
v_mfma_f32_16x16x32_bf16 v[12:15], a[160:163], v[152:155], 0
v_mfma_f32_16x16x32_bf16 v[20:23], a[160:163], v[168:171], 0
v_mfma_f32_16x16x32_bf16 v[28:31], a[160:163], v[184:187], 0
v_mfma_f32_16x16x32_bf16 v[36:39], a[160:163], v[200:203], 0
v_mfma_f32_16x16x32_bf16 v[12:15], a[164:167], v[156:159], v[12:15]
v_mfma_f32_16x16x32_bf16 v[20:23], a[164:167], v[172:175], v[20:23]
v_mfma_f32_16x16x32_bf16 v[28:31], a[164:167], v[188:191], v[28:31]
v_mfma_f32_16x16x32_bf16 v[36:39], a[164:167], v[204:207], v[36:39]
v_mfma_f32_16x16x32_bf16 v[12:15], a[168:171], v[160:163], v[12:15]
v_mfma_f32_16x16x32_bf16 v[20:23], a[168:171], v[176:179], v[20:23]
v_mfma_f32_16x16x32_bf16 v[28:31], a[168:171], v[192:195], v[28:31]
v_mfma_f32_16x16x32_bf16 v[36:39], a[168:171], v[208:211], v[36:39]
v_mfma_f32_16x16x32_bf16 v[12:15], a[172:175], v[164:167], v[12:15]
v_mfma_f32_16x16x32_bf16 v[20:23], a[172:175], v[180:183], v[20:23]
v_mfma_f32_16x16x32_bf16 v[28:31], a[172:175], v[196:199], v[28:31]
v_mfma_f32_16x16x32_bf16 v[36:39], a[172:175], v[212:215], v[36:39]
s_nop 7
s_nop 3
v_max3_f32 v136, v136, v8, v9
v_max3_f32 v136, v136, v10, v11
v_max3_f32 v136, v136, v12, v13
v_max3_f32 v136, v136, v14, v15
v_max3_f32 v140, v140, v16, v17
v_max3_f32 v140, v140, v18, v19
v_max3_f32 v140, v140, v20, v21
v_max3_f32 v140, v140, v22, v23
v_max3_f32 v144, v144, v24, v25
v_max3_f32 v144, v144, v26, v27
v_max3_f32 v144, v144, v28, v29
v_max3_f32 v144, v144, v30, v31
v_max3_f32 v148, v148, v32, v33
v_max3_f32 v148, v148, v34, v35
v_max3_f32 v148, v148, v36, v37
v_max3_f32 v148, v148, v38, v39
ds_read_b128 a[144:147], v216 offset:24576
ds_read_b128 a[148:151], v217 offset:24576
ds_read_b128 a[152:155], v218 offset:24576
ds_read_b128 a[156:159], v219 offset:24576
ds_read_b128 a[160:163], v216 offset:28672
ds_read_b128 a[164:167], v217 offset:28672
ds_read_b128 a[168:171], v218 offset:28672
ds_read_b128 a[172:175], v219 offset:28672
s_waitcnt lgkmcnt(0)
v_mfma_f32_16x16x32_bf16 v[8:11], a[144:147], v[152:155], 0
v_mfma_f32_16x16x32_bf16 v[16:19], a[144:147], v[168:171], 0
v_mfma_f32_16x16x32_bf16 v[24:27], a[144:147], v[184:187], 0
v_mfma_f32_16x16x32_bf16 v[32:35], a[144:147], v[200:203], 0
v_mfma_f32_16x16x32_bf16 v[8:11], a[148:151], v[156:159], v[8:11]
v_mfma_f32_16x16x32_bf16 v[16:19], a[148:151], v[172:175], v[16:19]
v_mfma_f32_16x16x32_bf16 v[24:27], a[148:151], v[188:191], v[24:27]
v_mfma_f32_16x16x32_bf16 v[32:35], a[148:151], v[204:207], v[32:35]
v_mfma_f32_16x16x32_bf16 v[8:11], a[152:155], v[160:163], v[8:11]
v_mfma_f32_16x16x32_bf16 v[16:19], a[152:155], v[176:179], v[16:19]
v_mfma_f32_16x16x32_bf16 v[24:27], a[152:155], v[192:195], v[24:27]
v_mfma_f32_16x16x32_bf16 v[32:35], a[152:155], v[208:211], v[32:35]
v_mfma_f32_16x16x32_bf16 v[8:11], a[156:159], v[164:167], v[8:11]
v_mfma_f32_16x16x32_bf16 v[16:19], a[156:159], v[180:183], v[16:19]
v_mfma_f32_16x16x32_bf16 v[24:27], a[156:159], v[196:199], v[24:27]
v_mfma_f32_16x16x32_bf16 v[32:35], a[156:159], v[212:215], v[32:35]
v_mfma_f32_16x16x32_bf16 v[12:15], a[160:163], v[152:155], 0
v_mfma_f32_16x16x32_bf16 v[20:23], a[160:163], v[168:171], 0
v_mfma_f32_16x16x32_bf16 v[28:31], a[160:163], v[184:187], 0
v_mfma_f32_16x16x32_bf16 v[36:39], a[160:163], v[200:203], 0
v_mfma_f32_16x16x32_bf16 v[12:15], a[164:167], v[156:159], v[12:15]
v_mfma_f32_16x16x32_bf16 v[20:23], a[164:167], v[172:175], v[20:23]
v_mfma_f32_16x16x32_bf16 v[28:31], a[164:167], v[188:191], v[28:31]
v_mfma_f32_16x16x32_bf16 v[36:39], a[164:167], v[204:207], v[36:39]
v_mfma_f32_16x16x32_bf16 v[12:15], a[168:171], v[160:163], v[12:15]
v_mfma_f32_16x16x32_bf16 v[20:23], a[168:171], v[176:179], v[20:23]
v_mfma_f32_16x16x32_bf16 v[28:31], a[168:171], v[192:195], v[28:31]
v_mfma_f32_16x16x32_bf16 v[36:39], a[168:171], v[208:211], v[36:39]
v_mfma_f32_16x16x32_bf16 v[12:15], a[172:175], v[164:167], v[12:15]
v_mfma_f32_16x16x32_bf16 v[20:23], a[172:175], v[180:183], v[20:23]
v_mfma_f32_16x16x32_bf16 v[28:31], a[172:175], v[196:199], v[28:31]
v_mfma_f32_16x16x32_bf16 v[36:39], a[172:175], v[212:215], v[36:39]
s_nop 7
s_nop 3
v_max3_f32 v136, v136, v8, v9
v_max3_f32 v136, v136, v10, v11
v_max3_f32 v136, v136, v12, v13
v_max3_f32 v136, v136, v14, v15
v_max3_f32 v140, v140, v16, v17
v_max3_f32 v140, v140, v18, v19
v_max3_f32 v140, v140, v20, v21
v_max3_f32 v140, v140, v22, v23
v_max3_f32 v144, v144, v24, v25
v_max3_f32 v144, v144, v26, v27
v_max3_f32 v144, v144, v28, v29
v_max3_f32 v144, v144, v30, v31
v_max3_f32 v148, v148, v32, v33
v_max3_f32 v148, v148, v34, v35
v_max3_f32 v148, v148, v36, v37
v_max3_f32 v148, v148, v38, v39
s_barrier
s_add_u32 s32, s32, 16384
s_sub_u32 s33, s33, 1
s_cmp_lg_u32 s33, 0
s_cbranch_scc1 K_FBLOOP
v_mov_b32 v246, v136
s_nop 1
v_permlane16_swap_b32 v136, v246
v_max_f32 v136, v136, v246
v_mov_b32 v246, v136
s_nop 1
v_permlane32_swap_b32 v136, v246
v_max_f32 v136, v136, v246
v_sub_f32 v136, 0, v136
v_mov_b32 v137, v136
v_mov_b32 v138, v136
v_mov_b32 v139, v136
v_mov_b32 v246, v140
s_nop 1
v_permlane16_swap_b32 v140, v246
v_max_f32 v140, v140, v246
v_mov_b32 v246, v140
s_nop 1
v_permlane32_swap_b32 v140, v246
v_max_f32 v140, v140, v246
v_sub_f32 v140, 0, v140
v_mov_b32 v141, v140
v_mov_b32 v142, v140
v_mov_b32 v143, v140
v_mov_b32 v246, v144
s_nop 1
v_permlane16_swap_b32 v144, v246
v_max_f32 v144, v144, v246
v_mov_b32 v246, v144
s_nop 1
v_permlane32_swap_b32 v144, v246
v_max_f32 v144, v144, v246
v_sub_f32 v144, 0, v144
v_mov_b32 v145, v144
v_mov_b32 v146, v144
v_mov_b32 v147, v144
v_mov_b32 v246, v148
s_nop 1
v_permlane16_swap_b32 v148, v246
v_max_f32 v148, v148, v246
v_mov_b32 v246, v148
s_nop 1
v_permlane32_swap_b32 v148, v246
v_max_f32 v148, v148, v246
v_sub_f32 v148, 0, v148
v_mov_b32 v149, v148
v_mov_b32 v150, v148
v_mov_b32 v151, v148
s_add_u32 s32, s7, 0
s_add_u32 m0, s30, 81920
s_nop 0
buffer_load_dwordx4 v228, s[8:11], s32 offen offset:0  lds
buffer_load_dwordx4 v229, s[8:11], s32 offen offset:1024  lds
buffer_load_dwordx4 v230, s[8:11], s32 offen offset:2048  lds
buffer_load_dwordx4 v231, s[8:11], s32 offen offset:3072  lds
s_add_u32 s32, s7, 16384
s_add_u32 m0, s30, 114688
s_nop 0
buffer_load_dwordx4 v228, s[8:11], s32 offen offset:0  lds
buffer_load_dwordx4 v229, s[8:11], s32 offen offset:1024  lds
buffer_load_dwordx4 v230, s[8:11], s32 offen offset:2048  lds
buffer_load_dwordx4 v231, s[8:11], s32 offen offset:3072  lds
s_add_u32 s39, s7, 0
s_add_u32 m0, s30, 131072
s_nop 0
buffer_load_dwordx4 v232, s[12:15], s39 offen offset:0  lds
buffer_load_dwordx4 v233, s[12:15], s39 offen offset:1024  lds
buffer_load_dwordx4 v232, s[12:15], s39 offen offset:2048  lds
buffer_load_dwordx4 v233, s[12:15], s39 offen offset:3072  lds
s_add_u32 s32, s7, 32768
s_add_u32 m0, s30, 65536
s_nop 0
buffer_load_dwordx4 v228, s[8:11], s32 offen offset:0  lds
buffer_load_dwordx4 v229, s[8:11], s32 offen offset:1024  lds
buffer_load_dwordx4 v230, s[8:11], s32 offen offset:2048  lds
buffer_load_dwordx4 v231, s[8:11], s32 offen offset:3072  lds
s_add_u32 s39, s7, 16384
s_add_u32 m0, s30, 147456
s_nop 0
buffer_load_dwordx4 v232, s[12:15], s39 offen offset:0  lds
buffer_load_dwordx4 v233, s[12:15], s39 offen offset:1024  lds
buffer_load_dwordx4 v232, s[12:15], s39 offen offset:2048  lds
buffer_load_dwordx4 v233, s[12:15], s39 offen offset:3072  lds
s_waitcnt vmcnt(0)
s_barrier
ds_read_b128 a[144:147], v216 offset:16384
ds_read_b128 a[148:151], v217 offset:16384
ds_read_b128 a[152:155], v218 offset:16384
ds_read_b128 a[156:159], v219 offset:16384
ds_read_b128 a[160:163], v216 offset:20480
ds_read_b128 a[164:167], v217 offset:20480
ds_read_b128 a[168:171], v218 offset:20480
ds_read_b128 a[172:175], v219 offset:20480
s_add_u32 s32, s7, 32768
s_add_u32 s39, s7, 16384
s_mul_i32 s88, s37, 864
s_mov_b32 s87, s88
v_accvgpr_write_b32 a128, 0
v_accvgpr_write_b32 a129, 0
v_accvgpr_write_b32 a130, 0
v_accvgpr_write_b32 a131, 0
v_accvgpr_write_b32 a132, 0
v_accvgpr_write_b32 a133, 0
v_accvgpr_write_b32 a134, 0
v_accvgpr_write_b32 a135, 0
v_lshrrev_b32 v240, 2, v1
v_mul_u32_u24 v240, 0x2400, v240
v_and_b32 v246, 3, v1
v_lshl_add_u32 v240, v246, 4, v240
v_mul_u32_u24 v243, 3641, v1
v_lshrrev_b32 v243, 16, v243
v_mul_u32_u24 v243, 864, v243
v_add_u32 v243, v243, v244
s_waitcnt lgkmcnt(0)
v_mfma_f32_16x16x32_bf16 v[8:11], a[144:147], v[152:155], v[136:139]
v_mfma_f32_16x16x32_bf16 v[16:19], a[144:147], v[168:171], v[140:143]
v_mfma_f32_16x16x32_bf16 v[24:27], a[144:147], v[184:187], v[144:147]
v_mfma_f32_16x16x32_bf16 v[32:35], a[144:147], v[200:203], v[148:151]
ds_read_b128 a[144:147], v216 offset:24576
v_mfma_f32_16x16x32_bf16 v[8:11], a[148:151], v[156:159], v[8:11]
v_mfma_f32_16x16x32_bf16 v[16:19], a[148:151], v[172:175], v[16:19]
v_mfma_f32_16x16x32_bf16 v[24:27], a[148:151], v[188:191], v[24:27]
v_mfma_f32_16x16x32_bf16 v[32:35], a[148:151], v[204:207], v[32:35]
ds_read_b128 a[148:151], v217 offset:24576
v_mfma_f32_16x16x32_bf16 v[8:11], a[152:155], v[160:163], v[8:11]
v_mfma_f32_16x16x32_bf16 v[16:19], a[152:155], v[176:179], v[16:19]
v_mfma_f32_16x16x32_bf16 v[24:27], a[152:155], v[192:195], v[24:27]
v_mfma_f32_16x16x32_bf16 v[32:35], a[152:155], v[208:211], v[32:35]
ds_read_b128 a[152:155], v218 offset:24576
v_mfma_f32_16x16x32_bf16 v[8:11], a[156:159], v[164:167], v[8:11]
v_mfma_f32_16x16x32_bf16 v[16:19], a[156:159], v[180:183], v[16:19]
v_mfma_f32_16x16x32_bf16 v[24:27], a[156:159], v[196:199], v[24:27]
v_mfma_f32_16x16x32_bf16 v[32:35], a[156:159], v[212:215], v[32:35]
ds_read_b128 a[156:159], v219 offset:24576
v_mfma_f32_16x16x32_bf16 v[12:15], a[160:163], v[152:155], v[136:139]
v_mfma_f32_16x16x32_bf16 v[20:23], a[160:163], v[168:171], v[140:143]
v_mfma_f32_16x16x32_bf16 v[28:31], a[160:163], v[184:187], v[144:147]
v_mfma_f32_16x16x32_bf16 v[36:39], a[160:163], v[200:203], v[148:151]
ds_read_b128 a[160:163], v216 offset:28672
v_mfma_f32_16x16x32_bf16 v[12:15], a[164:167], v[156:159], v[12:15]
v_mfma_f32_16x16x32_bf16 v[20:23], a[164:167], v[172:175], v[20:23]
v_mfma_f32_16x16x32_bf16 v[28:31], a[164:167], v[188:191], v[28:31]
v_mfma_f32_16x16x32_bf16 v[36:39], a[164:167], v[204:207], v[36:39]
ds_read_b128 a[164:167], v217 offset:28672
v_mfma_f32_16x16x32_bf16 v[12:15], a[168:171], v[160:163], v[12:15]
v_mfma_f32_16x16x32_bf16 v[20:23], a[168:171], v[176:179], v[20:23]
v_mfma_f32_16x16x32_bf16 v[28:31], a[168:171], v[192:195], v[28:31]
v_mfma_f32_16x16x32_bf16 v[36:39], a[168:171], v[208:211], v[36:39]
ds_read_b128 a[168:171], v218 offset:28672
v_mfma_f32_16x16x32_bf16 v[12:15], a[172:175], v[164:167], v[12:15]
v_mfma_f32_16x16x32_bf16 v[20:23], a[172:175], v[180:183], v[20:23]
v_mfma_f32_16x16x32_bf16 v[28:31], a[172:175], v[196:199], v[28:31]
v_mfma_f32_16x16x32_bf16 v[36:39], a[172:175], v[212:215], v[36:39]
ds_read_b128 a[172:175], v219 offset:28672
s_nop 7
s_branch K_BODY0
K_CODE_END:
.section .rodata,"a"
.p2align 6
.amdhsa_kernel recurrent_scan__gqa_block_cached__moe_arch_mod__prompt_kernel
  .amdhsa_next_free_vgpr 512
  .amdhsa_next_free_sgpr 102
  .amdhsa_accum_offset 256
  .amdhsa_group_segment_fixed_size 0
  .amdhsa_kernarg_size 104
  .amdhsa_user_sgpr_count 2
  .amdhsa_user_sgpr_kernarg_segment_ptr 1
  .amdhsa_system_sgpr_workgroup_id_x 1
  .amdhsa_float_denorm_mode_32 3
.end_amdhsa_kernel
```

```asm
; @launch grid=(256,1,1) block=(256,1,1) lds=163840
.amdgcn_target "amdgcn-amd-amdhsa--gfx950"
.text
.globl recurrent_scan__gqa_block_cached__moe_arch_mod__prompt_kernel
.p2align 8
.type recurrent_scan__gqa_block_cached__moe_arch_mod__prompt_kernel,@function
recurrent_scan__gqa_block_cached__moe_arch_mod__prompt_kernel:
s_cmp_ge_u32 s2, 256
s_cbranch_scc1 K_END
s_mov_b32 s100, 0
s_load_dwordx16 s[64:79], s[0:1], 0
s_load_dwordx8 s[80:87], s[0:1], 64
s_load_dwordx2 s[88:89], s[0:1], 96
s_lshr_b32 s35, s2, 3
s_and_b32 s36, s2, 7
s_mul_i32 s5, s36, 9
s_lshr_b32 s5, s5, 2
s_lshl_b32 s3, s36, 8
s_lshl_b32 s28, s35, 3
s_add_u32 s3, s3, s28
v_lshrrev_b32 v5, 5, v0
v_add_u32 v5, s3, v5
v_and_b32 v6, 31, v0
v_mul_u32_u24 v7, 0x480, v5
v_lshl_add_u32 v7, v6, 2, v7
v_and_b32 v1, 63, v0
v_lshrrev_b32 v2, 6, v0
v_lshlrev_b32 v8, 2, v6
v_readfirstlane_b32 s37, v2
v_and_b32 v3, 15, v1
v_lshrrev_b32 v4, 4, v1
s_getpc_b64 s[96:97]
PC_a:
s_sub_u32 s96, s96, PC_a-recurrent_scan__gqa_block_cached__moe_arch_mod__prompt_kernel
s_subb_u32 s97, s97, 0
s_lshl_b32 s50, s35, 2
s_add_u32 s50, s50, s37
s_min_u32 s50, s50, ((K_HOT_END-recurrent_scan__gqa_block_cached__moe_arch_mod__prompt_kernel)>>10)-1
s_lshl_b32 s50, s50, 10
v_lshlrev_b32 v11, 4, v1
v_add_u32 v11, s50, v11
global_load_dwordx4 v[172:175], v11, s[96:97]
s_waitcnt lgkmcnt(0)
s_mov_b32 s52, s64
s_and_b32 s53, s65, 0xffff
s_mov_b32 s54, 0x240000
s_mov_b32 s55, 0x00020000
buffer_load_dword v18, v7, s[52:55], 0 offen offset:0
buffer_load_dword v19, v7, s[52:55], 0 offen offset:128
buffer_load_dword v20, v7, s[52:55], 0 offen offset:256
buffer_load_dword v21, v7, s[52:55], 0 offen offset:384
buffer_load_dword v22, v7, s[52:55], 0 offen offset:512
buffer_load_dword v23, v7, s[52:55], 0 offen offset:640
buffer_load_dword v24, v7, s[52:55], 0 offen offset:768
buffer_load_dword v25, v7, s[52:55], 0 offen offset:896
buffer_load_dword v26, v7, s[52:55], 0 offen offset:1024
s_mov_b32 s28, 0x24c000
s_load_dwordx2 s[6:7], s[88:89], s28
s_mov_b32 s92, s76
s_and_b32 s93, s77, 0xffff
s_mov_b32 s94, 0x480
s_mov_b32 s95, 0x00020000
buffer_load_dword v28, v8, s[92:95], 0 offen offset:0
buffer_load_dword v29, v8, s[92:95], 0 offen offset:128
buffer_load_dword v30, v8, s[92:95], 0 offen offset:256
buffer_load_dword v31, v8, s[92:95], 0 offen offset:384
buffer_load_dword v32, v8, s[92:95], 0 offen offset:512
buffer_load_dword v33, v8, s[92:95], 0 offen offset:640
buffer_load_dword v34, v8, s[92:95], 0 offen offset:768
buffer_load_dword v35, v8, s[92:95], 0 offen offset:896
buffer_load_dword v36, v8, s[92:95], 0 offen offset:1024
s_mov_b32 s20, s88
s_and_b32 s21, s89, 0xffff
s_mov_b32 s22, 0x8000000
s_mov_b32 s23, 0x00020000
s_lshr_b32 s45, s3, 4
s_mul_i32 s45, s45, 18432
s_and_b32 s29, s3, 15
s_lshl_b32 s29, s29, 4
s_add_u32 s45, s45, s29
v_lshrrev_b32 v9, 1, v0
v_lshlrev_b32 v9, 8, v9
v_and_b32 v10, 1, v0
v_lshl_add_u32 v9, v10, 6, v9
s_add_u32 s29, s45, 0x1800000
v_add_u32 v9, s29, v9
s_lshl_b32 s28, s36, 8
s_add_u32 s28, s28, 0x24ac00
v_lshlrev_b32 v10, 6, v0
v_add_u32 v10, s28, v10
v_cmp_lt_u32 vcc, 143, v0
s_lshl_b32 s29, s3, 2
s_add_u32 s29, s29, 0x1a40000
v_cndmask_b32 v9, v9, v10, vcc
v_mov_b32 v10, s29
v_cmp_lt_u32 vcc, 147, v0
s_nop 1
v_cndmask_b32 v9, v9, v10, vcc
buffer_load_dword v176, v9, s[20:23], 0 offen sc1
s_mov_b32 s16, s70
s_and_b32 s17, s71, 0xffff
s_mov_b32 s18, 0x480000
s_mov_b32 s19, 0x00020000
v_add_u32 v9, 0, v4
v_lshlrev_b32 v10, 1, v9
v_xor_b32 v10, v10, v3
v_lshlrev_b32 v10, 4, v10
v_lshl_add_u32 v238, v9, 13, v10
v_add_u32 v9, 4, v4
v_lshlrev_b32 v10, 1, v9
v_xor_b32 v10, v10, v3
v_lshlrev_b32 v10, 4, v10
v_lshl_add_u32 v239, v9, 13, v10
v_subrev_u32 v239, 1024, v239
s_cmp_eq_u32 s37, 0
s_cbranch_scc1 F_NOWQ
s_sub_u32 s28, s37, 1
s_lshl_b32 s49, s28, 11
s_lshl_b32 s28, s28, 16
s_lshl_b32 s34, s35, 8
s_add_u32 s34, s34, s28
s_lshl_b32 s28, s5, 18
s_add_u32 s34, s34, s28
s_add_u32 m0, s49, 65536
s_nop 0
buffer_load_dwordx4 v238, s[16:19], s34 offen offset:0 lds
buffer_load_dwordx4 v239, s[16:19], s34 offen offset:1024 lds
s_add_u32 s34, s34, 196608
s_sub_u32 s51, s34, 4718592
s_cselect_b32 s34, s34, s51
s_add_u32 m0, s49, 71680
s_nop 0
buffer_load_dwordx4 v238, s[16:19], s34 offen offset:0 lds
buffer_load_dwordx4 v239, s[16:19], s34 offen offset:1024 lds
s_add_u32 s34, s34, 196608
s_sub_u32 s51, s34, 4718592
s_cselect_b32 s34, s34, s51
s_add_u32 m0, s49, 77824
s_nop 0
buffer_load_dwordx4 v238, s[16:19], s34 offen offset:0 lds
buffer_load_dwordx4 v239, s[16:19], s34 offen offset:1024 lds
s_add_u32 s34, s34, 196608
s_sub_u32 s51, s34, 4718592
s_cselect_b32 s34, s34, s51
s_add_u32 m0, s49, 83968
s_nop 0
buffer_load_dwordx4 v238, s[16:19], s34 offen offset:0 lds
buffer_load_dwordx4 v239, s[16:19], s34 offen offset:1024 lds
s_add_u32 s34, s34, 196608
s_sub_u32 s51, s34, 4718592
s_cselect_b32 s34, s34, s51
s_add_u32 m0, s49, 90112
s_nop 0
buffer_load_dwordx4 v238, s[16:19], s34 offen offset:0 lds
buffer_load_dwordx4 v239, s[16:19], s34 offen offset:1024 lds
s_add_u32 s34, s34, 196608
s_sub_u32 s51, s34, 4718592
s_cselect_b32 s34, s34, s51
F_NOWQ:
s_getreg_b32 s38, hwreg(HW_REG_XCC_ID, 0, 4)
s_mov_b32 s24, s86
s_and_b32 s25, s87, 0xffff
s_mov_b32 s26, 0x100
s_mov_b32 s27, 0x00020000
s_add_u32 s28, s2, s37
s_cbranch_scc1 F_NOX
s_cmp_eq_u32 s28, 0
s_cbranch_scc0 F_NOX
s_or_b32 s28, s38, 0x80
v_mov_b32 v9, s28
v_mov_b32 v10, 0
s_mov_b64 exec, 1
buffer_store_byte v9, v10, s[24:27], 0 offen sc0 sc1
s_mov_b64 exec, -1
s_waitcnt vmcnt(2)
F_NOX:
v_and_b32 v66, 7, v1
v_mul_u32_u24 v67, 1168, v66
v_lshrrev_b32 v68, 5, v1
v_lshl_add_u32 v67, v68, 6, v67
v_bfe_u32 v69, v1, 3, 2
v_lshl_add_u32 v67, v69, 3, v67
v_add_u32 v168, 0x24000, v67
v_lshlrev_b32 v70, 10, v68
v_lshl_add_u32 v71, v69, 4, v66
v_lshl_add_u32 v169, v71, 4, v70
v_lshlrev_b32 v244, 4, v1
v_bfe_u32 v9, v1, 2, 2
v_and_b32 v10, 3, v1
v_lshl_add_u32 v11, v4, 2, v9
v_and_b32 v12, 7, v11
v_lshrrev_b32 v14, 1, v10
v_xor_b32 v14, v14, v12
v_and_b32 v15, 1, v10
v_lshlrev_b32 v15, 4, v15
v_lshl_add_u32 v15, v11, 8, v15
v_add_u32 v15, 0x10000, v15
v_xor_b32 v16, 0, v14
v_lshl_add_u32 v234, v16, 5, v15
v_xor_b32 v16, 2, v14
v_lshl_add_u32 v235, v16, 5, v15
v_xor_b32 v16, 4, v14
v_lshl_add_u32 v236, v16, 5, v15
v_xor_b32 v16, 6, v14
v_lshl_add_u32 v237, v16, 5, v15
s_lshl2_add_u32 s50, s36, s37
s_lshr_b32 s29, s35, 2
s_add_u32 s28, s29, 0
s_and_b32 s28, s28, 3
s_lshl2_add_u32 s28, s50, s28
s_mul_i32 s28, s28, 18432
v_add_u32 v240, s28, v244
s_add_u32 s28, s29, 1
s_and_b32 s28, s28, 3
s_lshl2_add_u32 s28, s50, s28
s_mul_i32 s28, s28, 18432
v_add_u32 v241, s28, v244
s_add_u32 s28, s29, 2
s_and_b32 s28, s28, 3
s_lshl2_add_u32 s28, s50, s28
s_mul_i32 s28, s28, 18432
v_add_u32 v242, s28, v244
s_add_u32 s28, s29, 3
s_and_b32 s28, s28, 3
s_lshl2_add_u32 s28, s50, s28
s_mul_i32 s28, s28, 18432
v_add_u32 v243, s28, v244
s_mov_b32 s40, 0x3e0293ee
s_mov_b32 s41, 0x3e0293ee
s_mov_b32 s76, 0x3ae38e39
s_mov_b32 s77, 0x3727c5ac
s_mov_b32 s75, 0xffff0000
s_cmp_eq_u32 s37, 0
s_cbranch_scc0 F_W1
s_waitcnt vmcnt(10)
s_branch F_W2
F_W1:
s_waitcnt vmcnt(20)
F_W2:
v_lshlrev_b32 v40, 16, v18
v_and_b32 v41, s75, v18
v_lshlrev_b32 v42, 16, v19
v_and_b32 v43, s75, v19
v_lshlrev_b32 v44, 16, v20
v_and_b32 v45, s75, v20
v_lshlrev_b32 v46, 16, v21
v_and_b32 v47, s75, v21
v_lshlrev_b32 v48, 16, v22
v_and_b32 v49, s75, v22
v_lshlrev_b32 v50, 16, v23
v_and_b32 v51, s75, v23
v_lshlrev_b32 v52, 16, v24
v_and_b32 v53, s75, v24
v_lshlrev_b32 v54, 16, v25
v_and_b32 v55, s75, v25
v_lshlrev_b32 v56, 16, v26
v_and_b32 v57, s75, v26
v_pk_add_f32 v[60:61], v[40:41], v[42:43]
v_pk_add_f32 v[62:63], v[44:45], v[46:47]
v_pk_add_f32 v[60:61], v[60:61], v[48:49]
v_pk_add_f32 v[62:63], v[62:63], v[50:51]
v_pk_add_f32 v[60:61], v[60:61], v[52:53]
v_pk_add_f32 v[62:63], v[62:63], v[54:55]
v_pk_add_f32 v[60:61], v[60:61], v[56:57]
v_pk_add_f32 v[60:61], v[60:61], v[62:63]
v_add_f32 v60, v60, v61
s_nop 1
v_add_f32_dpp v61, v60, v60 row_ror:8 row_mask:0xf bank_mask:0xf
s_nop 1
v_add_f32_dpp v60, v61, v61 row_ror:4 row_mask:0xf bank_mask:0xf
s_nop 1
v_add_f32_dpp v61, v60, v60 row_ror:2 row_mask:0xf bank_mask:0xf
s_nop 1
v_add_f32_dpp v60, v61, v61 row_ror:1 row_mask:0xf bank_mask:0xf
v_mov_b32 v61, v60
s_nop 1
v_permlane16_swap_b32 v60, v61
v_add_f32 v60, v60, v61
v_mul_f32 v60, s76, v60
v_mov_b32 v61, v60
v_pk_add_f32 v[66:67], v[40:41], v[60:61] neg_lo:[0,1] neg_hi:[0,1]
v_pk_mul_f32 v[62:63], v[66:67], v[66:67]
v_pk_add_f32 v[68:69], v[42:43], v[60:61] neg_lo:[0,1] neg_hi:[0,1]
v_pk_fma_f32 v[62:63], v[68:69], v[68:69], v[62:63]
v_pk_add_f32 v[66:67], v[44:45], v[60:61] neg_lo:[0,1] neg_hi:[0,1]
v_pk_fma_f32 v[62:63], v[66:67], v[66:67], v[62:63]
v_pk_add_f32 v[68:69], v[46:47], v[60:61] neg_lo:[0,1] neg_hi:[0,1]
v_pk_fma_f32 v[62:63], v[68:69], v[68:69], v[62:63]
v_pk_add_f32 v[66:67], v[48:49], v[60:61] neg_lo:[0,1] neg_hi:[0,1]
v_pk_fma_f32 v[62:63], v[66:67], v[66:67], v[62:63]
v_pk_add_f32 v[68:69], v[50:51], v[60:61] neg_lo:[0,1] neg_hi:[0,1]
v_pk_fma_f32 v[62:63], v[68:69], v[68:69], v[62:63]
v_pk_add_f32 v[66:67], v[52:53], v[60:61] neg_lo:[0,1] neg_hi:[0,1]
v_pk_fma_f32 v[62:63], v[66:67], v[66:67], v[62:63]
v_pk_add_f32 v[68:69], v[54:55], v[60:61] neg_lo:[0,1] neg_hi:[0,1]
v_pk_fma_f32 v[62:63], v[68:69], v[68:69], v[62:63]
v_pk_add_f32 v[66:67], v[56:57], v[60:61] neg_lo:[0,1] neg_hi:[0,1]
v_pk_fma_f32 v[62:63], v[66:67], v[66:67], v[62:63]
v_add_f32 v61, v62, v63
s_nop 1
v_add_f32_dpp v62, v61, v61 row_ror:8 row_mask:0xf bank_mask:0xf
s_nop 1
v_add_f32_dpp v61, v62, v62 row_ror:4 row_mask:0xf bank_mask:0xf
s_nop 1
v_add_f32_dpp v62, v61, v61 row_ror:2 row_mask:0xf bank_mask:0xf
s_nop 1
v_add_f32_dpp v61, v62, v62 row_ror:1 row_mask:0xf bank_mask:0xf
v_mov_b32 v62, v61
s_nop 1
v_permlane16_swap_b32 v61, v62
v_add_f32 v61, v61, v62
v_mul_f32 v61, s76, v61
v_cvt_pk_bf16_f32 v60, v60, v60
v_lshlrev_b32 v60, 16, v60
v_cvt_pk_bf16_f32 v61, v61, v61
v_lshlrev_b32 v61, 16, v61
v_add_f32 v61, s77, v61
v_cvt_pk_bf16_f32 v61, v61, v61
v_lshlrev_b32 v61, 16, v61
v_sqrt_f32 v61, v61
s_nop 0
v_cvt_pk_bf16_f32 v61, v61, v61
v_lshlrev_b32 v61, 16, v61
v_rcp_f32 v62, v61
v_mov_b32 v63, 0
v_lshrrev_b32 v69, 5, v0
v_mul_u32_u24 v65, 1168, v69
v_lshl_add_u32 v65, v6, 2, v65
v_add_u32 v209, 0x24000, v65
s_cmp_eq_u32 s37, 0
s_cbranch_scc0 F_W3
s_waitcnt vmcnt(1)
F_W3:
s_waitcnt vmcnt(11)
v_mov_b32 v70, v60
v_mov_b32 v71, v60
v_mov_b32 v72, v61
v_mov_b32 v73, v61
v_mov_b32 v74, v62
v_mov_b32 v75, v62
v_pk_add_f32 v[40:41], v[40:41], v[70:71] neg_lo:[0,1] neg_hi:[0,1]
v_cvt_pk_bf16_f32 v68, v40, v41
v_lshlrev_b32 v40, 16, v68
v_and_b32 v41, s75, v68
v_pk_mul_f32 v[66:67], v[40:41], v[74:75]
v_pk_fma_f32 v[40:41], v[66:67], v[72:73], v[40:41] neg_lo:[1,0,0] neg_hi:[1,0,0]
v_pk_fma_f32 v[66:67], v[40:41], v[74:75], v[66:67]
v_cvt_pk_bf16_f32 v200, v66, v67
v_pk_mul_f32 v[66:67], v[66:67], s[40:41]
v_dot2_f32_bf16 v63, v200, v28, v63
v_cvt_pk_bf16_f32 v18, v66, v67
ds_write_b32 v209, v18 offset:0
v_pk_add_f32 v[42:43], v[42:43], v[70:71] neg_lo:[0,1] neg_hi:[0,1]
v_cvt_pk_bf16_f32 v68, v42, v43
v_lshlrev_b32 v42, 16, v68
v_and_b32 v43, s75, v68
v_pk_mul_f32 v[66:67], v[42:43], v[74:75]
v_pk_fma_f32 v[42:43], v[66:67], v[72:73], v[42:43] neg_lo:[1,0,0] neg_hi:[1,0,0]
v_pk_fma_f32 v[66:67], v[42:43], v[74:75], v[66:67]
v_cvt_pk_bf16_f32 v201, v66, v67
v_pk_mul_f32 v[66:67], v[66:67], s[40:41]
v_dot2_f32_bf16 v63, v201, v29, v63
v_cvt_pk_bf16_f32 v19, v66, v67
ds_write_b32 v209, v19 offset:128
v_pk_add_f32 v[44:45], v[44:45], v[70:71] neg_lo:[0,1] neg_hi:[0,1]
v_cvt_pk_bf16_f32 v68, v44, v45
v_lshlrev_b32 v44, 16, v68
v_and_b32 v45, s75, v68
v_pk_mul_f32 v[66:67], v[44:45], v[74:75]
v_pk_fma_f32 v[44:45], v[66:67], v[72:73], v[44:45] neg_lo:[1,0,0] neg_hi:[1,0,0]
v_pk_fma_f32 v[66:67], v[44:45], v[74:75], v[66:67]
v_cvt_pk_bf16_f32 v202, v66, v67
v_pk_mul_f32 v[66:67], v[66:67], s[40:41]
v_dot2_f32_bf16 v63, v202, v30, v63
v_cvt_pk_bf16_f32 v20, v66, v67
ds_write_b32 v209, v20 offset:256
v_pk_add_f32 v[46:47], v[46:47], v[70:71] neg_lo:[0,1] neg_hi:[0,1]
v_cvt_pk_bf16_f32 v68, v46, v47
v_lshlrev_b32 v46, 16, v68
v_and_b32 v47, s75, v68
v_pk_mul_f32 v[66:67], v[46:47], v[74:75]
v_pk_fma_f32 v[46:47], v[66:67], v[72:73], v[46:47] neg_lo:[1,0,0] neg_hi:[1,0,0]
v_pk_fma_f32 v[66:67], v[46:47], v[74:75], v[66:67]
v_cvt_pk_bf16_f32 v203, v66, v67
v_pk_mul_f32 v[66:67], v[66:67], s[40:41]
v_dot2_f32_bf16 v63, v203, v31, v63
v_cvt_pk_bf16_f32 v21, v66, v67
ds_write_b32 v209, v21 offset:384
v_pk_add_f32 v[48:49], v[48:49], v[70:71] neg_lo:[0,1] neg_hi:[0,1]
v_cvt_pk_bf16_f32 v68, v48, v49
v_lshlrev_b32 v48, 16, v68
v_and_b32 v49, s75, v68
v_pk_mul_f32 v[66:67], v[48:49], v[74:75]
v_pk_fma_f32 v[48:49], v[66:67], v[72:73], v[48:49] neg_lo:[1,0,0] neg_hi:[1,0,0]
v_pk_fma_f32 v[66:67], v[48:49], v[74:75], v[66:67]
v_cvt_pk_bf16_f32 v204, v66, v67
v_pk_mul_f32 v[66:67], v[66:67], s[40:41]
v_dot2_f32_bf16 v63, v204, v32, v63
v_cvt_pk_bf16_f32 v22, v66, v67
ds_write_b32 v209, v22 offset:512
v_pk_add_f32 v[50:51], v[50:51], v[70:71] neg_lo:[0,1] neg_hi:[0,1]
v_cvt_pk_bf16_f32 v68, v50, v51
v_lshlrev_b32 v50, 16, v68
v_and_b32 v51, s75, v68
v_pk_mul_f32 v[66:67], v[50:51], v[74:75]
v_pk_fma_f32 v[50:51], v[66:67], v[72:73], v[50:51] neg_lo:[1,0,0] neg_hi:[1,0,0]
v_pk_fma_f32 v[66:67], v[50:51], v[74:75], v[66:67]
v_cvt_pk_bf16_f32 v205, v66, v67
v_pk_mul_f32 v[66:67], v[66:67], s[40:41]
v_dot2_f32_bf16 v63, v205, v33, v63
v_cvt_pk_bf16_f32 v23, v66, v67
ds_write_b32 v209, v23 offset:640
v_pk_add_f32 v[52:53], v[52:53], v[70:71] neg_lo:[0,1] neg_hi:[0,1]
v_cvt_pk_bf16_f32 v68, v52, v53
v_lshlrev_b32 v52, 16, v68
v_and_b32 v53, s75, v68
v_pk_mul_f32 v[66:67], v[52:53], v[74:75]
v_pk_fma_f32 v[52:53], v[66:67], v[72:73], v[52:53] neg_lo:[1,0,0] neg_hi:[1,0,0]
v_pk_fma_f32 v[66:67], v[52:53], v[74:75], v[66:67]
v_cvt_pk_bf16_f32 v206, v66, v67
v_pk_mul_f32 v[66:67], v[66:67], s[40:41]
v_dot2_f32_bf16 v63, v206, v34, v63
v_cvt_pk_bf16_f32 v24, v66, v67
ds_write_b32 v209, v24 offset:768
v_pk_add_f32 v[54:55], v[54:55], v[70:71] neg_lo:[0,1] neg_hi:[0,1]
v_cvt_pk_bf16_f32 v68, v54, v55
v_lshlrev_b32 v54, 16, v68
v_and_b32 v55, s75, v68
v_pk_mul_f32 v[66:67], v[54:55], v[74:75]
v_pk_fma_f32 v[54:55], v[66:67], v[72:73], v[54:55] neg_lo:[1,0,0] neg_hi:[1,0,0]
v_pk_fma_f32 v[66:67], v[54:55], v[74:75], v[66:67]
v_cvt_pk_bf16_f32 v207, v66, v67
v_pk_mul_f32 v[66:67], v[66:67], s[40:41]
v_dot2_f32_bf16 v63, v207, v35, v63
v_cvt_pk_bf16_f32 v25, v66, v67
ds_write_b32 v209, v25 offset:896
v_pk_add_f32 v[56:57], v[56:57], v[70:71] neg_lo:[0,1] neg_hi:[0,1]
v_cvt_pk_bf16_f32 v68, v56, v57
v_lshlrev_b32 v56, 16, v68
v_and_b32 v57, s75, v68
v_pk_mul_f32 v[66:67], v[56:57], v[74:75]
v_pk_fma_f32 v[56:57], v[66:67], v[72:73], v[56:57] neg_lo:[1,0,0] neg_hi:[1,0,0]
v_pk_fma_f32 v[66:67], v[56:57], v[74:75], v[66:67]
v_cvt_pk_bf16_f32 v208, v66, v67
v_pk_mul_f32 v[66:67], v[66:67], s[40:41]
v_dot2_f32_bf16 v63, v208, v36, v63
v_cvt_pk_bf16_f32 v26, v66, v67
ds_write_b32 v209, v26 offset:1024
s_nop 2
s_nop 1
v_add_f32_dpp v62, v63, v63 row_ror:8 row_mask:0xf bank_mask:0xf
s_nop 1
v_add_f32_dpp v63, v62, v62 row_ror:4 row_mask:0xf bank_mask:0xf
s_nop 1
v_add_f32_dpp v62, v63, v63 row_ror:2 row_mask:0xf bank_mask:0xf
s_nop 1
v_add_f32_dpp v63, v62, v62 row_ror:1 row_mask:0xf bank_mask:0xf
v_mov_b32 v62, v63
s_nop 1
v_permlane16_swap_b32 v63, v62
v_add_f32 v63, v63, v62
v_cvt_pk_bf16_f32 v63, v63, v63
v_lshlrev_b32 v63, 16, v63
v_ashrrev_i32 v66, 31, v63
v_or_b32 v66, 0x80000000, v66
v_xor_b32 v63, v63, v66
v_and_b32 v63, s75, v63
v_sub_u32 v66, 0xffff, v5
v_or_b32 v63, v63, v66
v_lshlrev_b32 v66, 2, v69
v_add_u32 v66, 0x26480, v66
ds_write_b32 v66, v63
v_and_b32 v64, 7, v1
v_lshlrev_b32 v64, 2, v64
s_waitcnt lgkmcnt(0)
s_barrier
s_mul_i32 s101, s6, 0x9e3779b1
s_add_u32 s101, s101, 0x7f4a7c15
s_mul_i32 s47, s7, 0x85ebca6b
s_add_u32 s47, s47, 0x165667b1
s_cmp_eq_u32 s37, 0
s_cbranch_scc0 F_OTHER
ds_read2_b64 v[72:75], v168 offset0:0 offset1:4
ds_read2_b64 v[76:79], v168 offset0:16 offset1:20
ds_read2_b64 v[80:83], v168 offset0:32 offset1:36
ds_read2_b64 v[84:87], v168 offset0:48 offset1:52
ds_read2_b64 v[88:91], v168 offset0:64 offset1:68
ds_read2_b64 v[92:95], v168 offset0:80 offset1:84
ds_read2_b64 v[96:99], v168 offset0:96 offset1:100
ds_read2_b64 v[100:103], v168 offset0:112 offset1:116
ds_read2_b64 v[104:107], v168 offset0:128 offset1:132
v_add_u32 v65, 0x26480, v64
ds_read_b32 v65, v65
s_add_u32 s28, s45, 0x1800000
s_waitcnt lgkmcnt(9)
buffer_store_dwordx4 v[72:75], v169, s[20:23], s28 offen offset:0
s_waitcnt lgkmcnt(8)
buffer_store_dwordx4 v[76:79], v169, s[20:23], s28 offen offset:2048
s_add_u32 s28, s28, 4096
s_waitcnt lgkmcnt(7)
buffer_store_dwordx4 v[80:83], v169, s[20:23], s28 offen offset:0
s_waitcnt lgkmcnt(6)
buffer_store_dwordx4 v[84:87], v169, s[20:23], s28 offen offset:2048
s_add_u32 s28, s28, 4096
s_waitcnt lgkmcnt(5)
buffer_store_dwordx4 v[88:91], v169, s[20:23], s28 offen offset:0
s_waitcnt lgkmcnt(4)
buffer_store_dwordx4 v[92:95], v169, s[20:23], s28 offen offset:2048
s_add_u32 s28, s28, 4096
s_waitcnt lgkmcnt(3)
buffer_store_dwordx4 v[96:99], v169, s[20:23], s28 offen offset:0
s_waitcnt lgkmcnt(2)
buffer_store_dwordx4 v[100:103], v169, s[20:23], s28 offen offset:2048
s_add_u32 s28, s28, 4096
s_waitcnt lgkmcnt(1)
buffer_store_dwordx4 v[104:107], v169, s[20:23], s28 offen offset:0
s_lshl_b32 s28, s3, 2
s_add_u32 s28, s28, 0x1a40000
s_waitcnt lgkmcnt(0)
buffer_store_dword v65, v64, s[20:23], s28 offen
s_and_b32 s29, s101, -16
s_or_b32 s29, s29, s38
v_mov_b32 v58, s29
v_mov_b32 v59, s47
s_lshl_b32 s29, s35, 3
v_mov_b32 v61, s29
s_lshl_b32 s28, s36, 8
s_add_u32 s28, s28, 0x24d000
s_waitcnt vmcnt(0)
s_mov_b64 exec, 1
buffer_store_dwordx2 v[58:59], v61, s[20:23], s28 offen
s_mov_b64 exec, -1
s_branch F_JOIN
F_END0:
.p2align 12
K_P1:
F_OTHER:
STUB_0:
s_mov_b64 exec, 0
s_cmp_eq_u32 s37, 1
s_cbranch_scc1 STUB_A1
s_cmp_eq_u32 s37, 2
s_cbranch_scc1 STUB_A2
s_cmp_eq_u32 s37, 3
s_cbranch_scc1 STUB_A3
s_mov_b64 exec, -1
HOP_R1:
s_add_u32 m0, s49, 96256
s_nop 0
buffer_load_dwordx4 v238, s[16:19], s34 offen offset:0 lds
buffer_load_dwordx4 v239, s[16:19], s34 offen offset:1024 lds
s_add_u32 s34, s34, 196608
s_sub_u32 s51, s34, 4718592
s_cselect_b32 s34, s34, s51
s_add_u32 m0, s49, 102400
s_nop 0
buffer_load_dwordx4 v238, s[16:19], s34 offen offset:0 lds
buffer_load_dwordx4 v239, s[16:19], s34 offen offset:1024 lds
s_add_u32 s34, s34, 196608
s_sub_u32 s51, s34, 4718592
s_cselect_b32 s34, s34, s51
s_add_u32 m0, s49, 108544
s_nop 0
buffer_load_dwordx4 v238, s[16:19], s34 offen offset:0 lds
buffer_load_dwordx4 v239, s[16:19], s34 offen offset:1024 lds
s_add_u32 s34, s34, 196608
s_sub_u32 s51, s34, 4718592
s_cselect_b32 s34, s34, s51
s_mov_b64 exec, 0
s_cmp_eq_u32 s37, 1
s_cbranch_scc1 STUB_B1
s_cmp_eq_u32 s37, 2
s_cbranch_scc1 STUB_B2
s_cmp_eq_u32 s37, 3
s_cbranch_scc1 STUB_B3
s_mov_b64 exec, -1
HOP_R2:
F_JOIN:
s_lshl_b32 s49, s37, 11
s_lshl_b32 s28, s37, 16
s_lshl_b32 s34, s35, 8
s_add_u32 s34, s34, s28
s_lshl_b32 s28, s5, 18
s_add_u32 s34, s34, s28
s_add_u32 s34, s34, 1572864
s_sub_u32 s51, s34, 4718592
s_cselect_b32 s34, s34, s51
s_lshl_b32 s30, s37, 12
s_lshl_b32 s31, s37, 10
s_lshl_b32 s92, s36, 5
s_add_u32 s92, s92, s35
s_lshl2_add_u32 s92, s92, s37
s_lshl_b32 s44, s92, 14
s_add_u32 s44, s44, 0x400000
s_mov_b32 s42, 0x5f800000
s_mov_b32 s43, 0
s_lshr_b32 s92, s35, 1
s_lshl_b32 s92, s92, 19
s_add_u32 s66, s66, s92
s_addc_u32 s67, s67, 0
s_add_u32 s68, s68, s92
s_addc_u32 s69, s69, 0
s_mov_b32 s8, s66
s_and_b32 s9, s67, 0xffff
s_mov_b32 s10, 0x80000
s_mov_b32 s11, 0x00020000
s_mov_b32 s12, s68
s_and_b32 s13, s69, 0xffff
s_mov_b32 s14, 0x80000
s_mov_b32 s15, 0x00020000
s_mov_b32 s56, s72
s_and_b32 s57, s73, 0xffff
s_mov_b32 s58, 0x480000
s_mov_b32 s59, 0x00020000
s_mov_b32 s60, s84
s_and_b32 s61, s85, 0xffff
s_mov_b32 s62, 0x240000
s_mov_b32 s63, 0x00020000
s_mov_b32 s64, s78
s_and_b32 s65, s79, 0xffff
s_mov_b32 s66, 0x510000
s_mov_b32 s67, 0x00020000
s_mov_b32 s68, s80
s_and_b32 s69, s81, 0xffff
s_mov_b32 s70, 0x510000
s_mov_b32 s71, 0x00020000
s_mov_b32 s72, s82
s_and_b32 s73, s83, 0xffff
s_mov_b32 s74, 0x510000
s_mov_b32 s75, 0x00020000
s_lshr_b32 s92, s35, 2
s_mul_i32 s89, s92, 589824
s_and_b32 s92, s35, 3
s_mul_i32 s92, s92, 288
s_add_u32 s89, s89, s92
s_cmp_eq_u32 s37, 0
s_cbranch_scc1 F_W0P
s_waitcnt vmcnt(0)
s_branch F_BAR2
HOP_RET1:
s_mov_b64 exec, -1
s_branch HOP_R1
HOP_RET2:
s_mov_b64 exec, -1
s_branch HOP_R2
F_W0P:
s_mov_b32 s46, 0x20
s_lshl_b32 s28, s36, 8
s_add_u32 s28, s28, 0x24d000
v_and_b32 v61, 31, v1
v_lshlrev_b32 v61, 3, v61
s_mov_b32 s51, 0
v_mov_b32 v60, 3
F_POLL:
buffer_load_dwordx2 v[62:63], v61, s[20:23], s28 offen sc0 sc1
s_waitcnt vmcnt(0)
v_cmp_ne_u64 vcc, v[62:63], v[58:59]
s_cbranch_vccz F_GO
s_add_u32 s51, s51, 1
s_and_b32 s29, s51, 31
s_cbranch_scc1 F_POLL
s_branch F_NOTYET
F_GO:
v_mov_b32 v61, 156864
ds_write_b32 v61, v60
s_waitcnt lgkmcnt(0)
F_BAR2:
s_barrier
s_lshl_b32 s7, s36, 31
s_mov_b32 s7, 0
v_mov_b32 v246, 156864
ds_read_b32 v246, v246
s_mov_b32 s4, 0x1800000
s_mov_b32 s51, 3
Q_START:
s_lshl_b32 s28, s5, 10
s_add_u32 s28, s28, s4
s_add_u32 s6, s4, 18432
buffer_load_dwordx4 a[0:3], v240, s[20:23], s28 offen sc0 sc1
buffer_load_dwordx4 a[4:7], v241, s[20:23], s28 offen sc0 sc1
buffer_load_dwordx4 a[8:11], v242, s[20:23], s28 offen sc0 sc1
buffer_load_dwordx4 a[12:15], v243, s[20:23], s28 offen sc0 sc1
s_waitcnt lgkmcnt(0)
v_readfirstlane_b32 s48, v246
ds_read_b64_tr_b16 a[144:145], v234 offset:0
ds_read_b64_tr_b16 a[146:147], v234 offset:4096
ds_read_b64_tr_b16 a[148:149], v234 offset:8
ds_read_b64_tr_b16 a[150:151], v234 offset:4104
ds_read_b64_tr_b16 a[152:153], v235 offset:0
ds_read_b64_tr_b16 a[154:155], v235 offset:4096
ds_read_b64_tr_b16 a[156:157], v235 offset:8
ds_read_b64_tr_b16 a[158:159], v235 offset:4104
ds_read_b64_tr_b16 a[160:161], v236 offset:0
ds_read_b64_tr_b16 a[162:163], v236 offset:4096
ds_read_b64_tr_b16 a[164:165], v236 offset:8
ds_read_b64_tr_b16 a[166:167], v236 offset:4104
ds_read_b64_tr_b16 a[168:169], v237 offset:0
ds_read_b64_tr_b16 a[170:171], v237 offset:4096
ds_read_b64_tr_b16 a[172:173], v237 offset:8
ds_read_b64_tr_b16 a[174:175], v237 offset:4104
s_cmp_lt_u32 s48, s51
s_cbranch_scc1 Q_REDO
s_add_u32 s28, s28, 1024
s_cmp_lt_u32 s28, s6
s_cselect_b32 s28, s28, s4
buffer_load_dwordx4 a[16:19], v240, s[20:23], s28 offen sc0 sc1
buffer_load_dwordx4 a[20:23], v241, s[20:23], s28 offen sc0 sc1
buffer_load_dwordx4 a[24:27], v242, s[20:23], s28 offen sc0 sc1
buffer_load_dwordx4 a[28:31], v243, s[20:23], s28 offen sc0 sc1
s_lshl_b32 s29, s36, 10
s_add_u32 s29, s29, s4
s_add_u32 s29, s29, 0x240000
buffer_load_dwordx4 v[136:139], v244, s[20:23], s29 offen sc0 sc1
s_add_u32 s28, s28, 1024
s_cmp_lt_u32 s28, s6
s_cselect_b32 s28, s28, s4
buffer_load_dwordx4 a[32:35], v240, s[20:23], s28 offen sc0 sc1
buffer_load_dwordx4 a[36:39], v241, s[20:23], s28 offen sc0 sc1
buffer_load_dwordx4 a[40:43], v242, s[20:23], s28 offen sc0 sc1
buffer_load_dwordx4 a[44:47], v243, s[20:23], s28 offen sc0 sc1
s_waitcnt vmcnt(9)
s_waitcnt lgkmcnt(8)
v_mfma_f32_16x16x32_bf16 v[8:11], a[144:147], a[0:3], 0
ds_read_b64_tr_b16 a[176:177], v234 offset:8192
v_mov_b32 v143, 0
v_mfma_f32_16x16x32_bf16 v[40:43], a[144:147], a[4:7], 0
ds_read_b64_tr_b16 a[178:179], v234 offset:12288
ds_write_b32 v209, v200 offset:0
v_mfma_f32_16x16x32_bf16 v[72:75], a[144:147], a[8:11], 0
s_add_u32 s28, s28, 1024
s_cmp_lt_u32 s28, s6
s_cselect_b32 s28, s28, s4
v_mfma_f32_16x16x32_bf16 v[104:107], a[144:147], a[12:15], 0
ds_read_b64_tr_b16 a[180:181], v234 offset:8200
ds_write_b32 v209, v201 offset:128
v_mfma_f32_16x16x32_bf16 v[108:111], a[148:151], a[12:15], 0
ds_read_b64_tr_b16 a[182:183], v234 offset:12296
ds_write_b32 v209, v202 offset:256
v_mfma_f32_16x16x32_bf16 v[76:79], a[148:151], a[8:11], 0
buffer_load_dwordx4 a[48:51], v240, s[20:23], s28 offen sc0 sc1
v_mfma_f32_16x16x32_bf16 v[44:47], a[148:151], a[4:7], 0
ds_read_b64_tr_b16 a[184:185], v235 offset:8192
ds_write_b32 v209, v203 offset:384
v_mfma_f32_16x16x32_bf16 v[12:15], a[148:151], a[0:3], 0
ds_read_b64_tr_b16 a[186:187], v235 offset:12288
ds_write_b32 v209, v204 offset:512
v_mfma_f32_16x16x32_bf16 v[16:19], a[152:155], a[0:3], 0
buffer_load_dwordx4 a[52:55], v241, s[20:23], s28 offen sc0 sc1
v_mfma_f32_16x16x32_bf16 v[48:51], a[152:155], a[4:7], 0
ds_read_b64_tr_b16 a[188:189], v235 offset:8200
ds_write_b32 v209, v205 offset:640
v_mfma_f32_16x16x32_bf16 v[80:83], a[152:155], a[8:11], 0
ds_read_b64_tr_b16 a[190:191], v235 offset:12296
ds_write_b32 v209, v206 offset:768
v_mfma_f32_16x16x32_bf16 v[112:115], a[152:155], a[12:15], 0
buffer_load_dwordx4 a[56:59], v242, s[20:23], s28 offen sc0 sc1
v_mfma_f32_16x16x32_bf16 v[116:119], a[156:159], a[12:15], 0
ds_read_b64_tr_b16 a[192:193], v236 offset:8192
ds_write_b32 v209, v207 offset:896
v_mfma_f32_16x16x32_bf16 v[84:87], a[156:159], a[8:11], 0
buffer_load_dwordx4 a[60:63], v243, s[20:23], s28 offen sc0 sc1
v_mfma_f32_16x16x32_bf16 v[52:55], a[156:159], a[4:7], 0
ds_read_b64_tr_b16 a[194:195], v236 offset:12288
ds_write_b32 v209, v208 offset:1024
v_mfma_f32_16x16x32_bf16 v[20:23], a[156:159], a[0:3], 0
ds_read_b64_tr_b16 a[196:197], v236 offset:8200
v_add_u32 v184, 0, v4
s_waitcnt lgkmcnt(8)
v_mfma_f32_16x16x32_bf16 v[24:27], a[160:163], a[0:3], 0
s_add_u32 s28, s28, 1024
s_cmp_lt_u32 s28, s6
s_cselect_b32 s28, s28, s4
v_mfma_f32_16x16x32_bf16 v[56:59], a[160:163], a[4:7], 0
ds_read_b64_tr_b16 a[198:199], v236 offset:12296
v_xor_b32 v184, v184, v3
v_mfma_f32_16x16x32_bf16 v[88:91], a[160:163], a[8:11], 0
ds_read_b64_tr_b16 a[200:201], v237 offset:8192
v_lshlrev_b32 v184, 4, v184
v_mfma_f32_16x16x32_bf16 v[120:123], a[160:163], a[12:15], 0
buffer_load_dwordx4 a[64:67], v240, s[20:23], s28 offen sc0 sc1
v_mfma_f32_16x16x32_bf16 v[124:127], a[164:167], a[12:15], 0
ds_read_b64_tr_b16 a[202:203], v237 offset:12288
v_lshl_add_u32 v184, v3, 8, v184
v_mfma_f32_16x16x32_bf16 v[92:95], a[164:167], a[8:11], 0
ds_read_b64_tr_b16 a[204:205], v237 offset:8200
v_add_u32 v216, 0x10000, v184
v_mfma_f32_16x16x32_bf16 v[60:63], a[164:167], a[4:7], 0
buffer_load_dwordx4 a[68:71], v241, s[20:23], s28 offen sc0 sc1
v_mfma_f32_16x16x32_bf16 v[28:31], a[164:167], a[0:3], 0
ds_read_b64_tr_b16 a[206:207], v237 offset:12296
v_add_u32 v184, 4, v4
v_mfma_f32_16x16x32_bf16 v[32:35], a[168:171], a[0:3], 0
buffer_load_dwordx4 a[72:75], v242, s[20:23], s28 offen sc0 sc1
v_mfma_f32_16x16x32_bf16 v[64:67], a[168:171], a[4:7], 0
buffer_load_dwordx4 a[76:79], v243, s[20:23], s28 offen sc0 sc1
v_mfma_f32_16x16x32_bf16 v[96:99], a[168:171], a[8:11], 0
s_add_u32 m0, s49, 114688
v_xor_b32 v184, v184, v3
v_mfma_f32_16x16x32_bf16 v[128:131], a[168:171], a[12:15], 0
buffer_load_dwordx4 v238, s[16:19], s34 offen offset:0 lds
v_mfma_f32_16x16x32_bf16 v[132:135], a[172:175], a[12:15], 0
buffer_load_dwordx4 v239, s[16:19], s34 offen offset:1024 lds
v_mfma_f32_16x16x32_bf16 v[100:103], a[172:175], a[8:11], 0
s_add_u32 s34, s34, 262144
s_sub_u32 s51, s34, 4718592
s_cselect_b32 s34, s34, s51
v_mfma_f32_16x16x32_bf16 v[68:71], a[172:175], a[4:7], 0
s_mov_b32 s90, 0x01010101
s_mov_b32 s91, 0x01010101
v_mfma_f32_16x16x32_bf16 v[36:39], a[172:175], a[0:3], 0
v_lshlrev_b32 v184, 4, v184
v_lshl_add_u32 v184, v3, 8, v184
s_waitcnt vmcnt(15)
v_mfma_f32_16x16x32_bf16 v[8:11], a[176:179], a[16:19], v[8:11]
ds_read_b64_tr_b16 a[144:145], v234 offset:16384
v_add_u32 v217, 0x10000, v184
v_mfma_f32_16x16x32_bf16 v[40:43], a[176:179], a[20:23], v[40:43]
ds_read_b64_tr_b16 a[146:147], v234 offset:20480
v_add_u32 v184, 8, v4
v_mfma_f32_16x16x32_bf16 v[72:75], a[176:179], a[24:27], v[72:75]
s_add_u32 s28, s28, 1024
s_cmp_lt_u32 s28, s6
s_cselect_b32 s28, s28, s4
v_mfma_f32_16x16x32_bf16 v[104:107], a[176:179], a[28:31], v[104:107]
ds_read_b64_tr_b16 a[148:149], v234 offset:16392
v_xor_b32 v184, v184, v3
v_mfma_f32_16x16x32_bf16 v[108:111], a[180:183], a[28:31], v[108:111]
ds_read_b64_tr_b16 a[150:151], v234 offset:20488
v_lshlrev_b32 v184, 4, v184
v_mfma_f32_16x16x32_bf16 v[76:79], a[180:183], a[24:27], v[76:79]
buffer_load_dwordx4 a[80:83], v240, s[20:23], s28 offen sc0 sc1
v_mfma_f32_16x16x32_bf16 v[44:47], a[180:183], a[20:23], v[44:47]
ds_read_b64_tr_b16 a[152:153], v235 offset:16384
v_lshl_add_u32 v184, v3, 8, v184
v_mfma_f32_16x16x32_bf16 v[12:15], a[180:183], a[16:19], v[12:15]
ds_read_b64_tr_b16 a[154:155], v235 offset:20480
v_add_u32 v218, 0x10000, v184
v_mfma_f32_16x16x32_bf16 v[16:19], a[184:187], a[16:19], v[16:19]
buffer_load_dwordx4 a[84:87], v241, s[20:23], s28 offen sc0 sc1
v_mfma_f32_16x16x32_bf16 v[48:51], a[184:187], a[20:23], v[48:51]
ds_read_b64_tr_b16 a[156:157], v235 offset:16392
v_add_u32 v184, 12, v4
v_mfma_f32_16x16x32_bf16 v[80:83], a[184:187], a[24:27], v[80:83]
ds_read_b64_tr_b16 a[158:159], v235 offset:20488
v_xor_b32 v184, v184, v3
v_mfma_f32_16x16x32_bf16 v[112:115], a[184:187], a[28:31], v[112:115]
buffer_load_dwordx4 a[88:91], v242, s[20:23], s28 offen sc0 sc1
s_waitcnt lgkmcnt(8)
v_mfma_f32_16x16x32_bf16 v[116:119], a[188:191], a[28:31], v[116:119]
ds_read_b64_tr_b16 a[160:161], v236 offset:16384
v_lshlrev_b32 v184, 4, v184
v_mfma_f32_16x16x32_bf16 v[84:87], a[188:191], a[24:27], v[84:87]
buffer_load_dwordx4 a[92:95], v243, s[20:23], s28 offen sc0 sc1
v_mfma_f32_16x16x32_bf16 v[52:55], a[188:191], a[20:23], v[52:55]
ds_read_b64_tr_b16 a[162:163], v236 offset:20480
v_lshl_add_u32 v184, v3, 8, v184
v_mfma_f32_16x16x32_bf16 v[20:23], a[188:191], a[16:19], v[20:23]
ds_read_b64_tr_b16 a[164:165], v236 offset:16392
v_add_u32 v219, 0x10000, v184
v_mfma_f32_16x16x32_bf16 v[24:27], a[192:195], a[16:19], v[24:27]
s_add_u32 m0, s49, 122880
v_bfe_u32 v184, v1, 2, 2
v_mfma_f32_16x16x32_bf16 v[56:59], a[192:195], a[20:23], v[56:59]
ds_read_b64_tr_b16 a[166:167], v236 offset:20488
v_and_b32 v185, 3, v1
v_mfma_f32_16x16x32_bf16 v[88:91], a[192:195], a[24:27], v[88:91]
ds_read_b64_tr_b16 a[168:169], v237 offset:16384
v_lshl_add_u32 v186, v4, 2, v184
v_mfma_f32_16x16x32_bf16 v[120:123], a[192:195], a[28:31], v[120:123]
s_waitcnt vmcnt(18)
v_max3_u32 v140, v136, v137, v138
v_mfma_f32_16x16x32_bf16 v[124:127], a[196:199], a[28:31], v[124:127]
ds_read_b64_tr_b16 a[170:171], v237 offset:20480
v_max_u32 v140, v140, v139
v_mfma_f32_16x16x32_bf16 v[92:95], a[196:199], a[24:27], v[92:95]
ds_read_b64_tr_b16 a[172:173], v237 offset:16392
v_and_b32 v187, 7, v186
v_mfma_f32_16x16x32_bf16 v[60:63], a[196:199], a[20:23], v[60:63]
buffer_load_dwordx4 v238, s[16:19], s34 offen offset:0 lds
v_mfma_f32_16x16x32_bf16 v[28:31], a[196:199], a[16:19], v[28:31]
ds_read_b64_tr_b16 a[174:175], v237 offset:20488
v_max_u32_dpp v141, v140, v140 row_ror:8 row_mask:0xf bank_mask:0xf
v_mfma_f32_16x16x32_bf16 v[32:35], a[200:203], a[16:19], v[32:35]
buffer_load_dwordx4 v239, s[16:19], s34 offen offset:1024 lds
v_mfma_f32_16x16x32_bf16 v[64:67], a[200:203], a[20:23], v[64:67]
v_max_u32_dpp v140, v141, v141 row_ror:4 row_mask:0xf bank_mask:0xf
v_lshlrev_b32 v188, 8, v186
v_mfma_f32_16x16x32_bf16 v[96:99], a[200:203], a[24:27], v[96:99]
s_add_u32 s34, s34, 262144
s_sub_u32 s51, s34, 4718592
s_cselect_b32 s34, s34, s51
v_mfma_f32_16x16x32_bf16 v[128:131], a[200:203], a[28:31], v[128:131]
v_max_u32_dpp v141, v140, v140 row_ror:2 row_mask:0xf bank_mask:0xf
v_lshl_add_u32 v188, v185, 3, v188
v_mfma_f32_16x16x32_bf16 v[132:135], a[204:207], a[28:31], v[132:135]
v_add_u32 v188, 0x18000, v188
v_xor_b32 v189, 0, v187
v_mfma_f32_16x16x32_bf16 v[100:103], a[204:207], a[24:27], v[100:103]
v_max_u32_dpp v140, v141, v141 row_ror:1 row_mask:0xf bank_mask:0xf
v_mov_b32 v141, v140
v_mfma_f32_16x16x32_bf16 v[68:71], a[204:207], a[20:23], v[68:71]
v_lshl_add_u32 v220, v189, 5, v188
v_xor_b32 v189, 1, v187
v_mfma_f32_16x16x32_bf16 v[36:39], a[204:207], a[16:19], v[36:39]
v_permlane16_swap_b32 v140, v141
v_max_u32 v140, v140, v141
s_waitcnt vmcnt(16)
s_waitcnt lgkmcnt(8)
v_mfma_f32_16x16x32_bf16 v[8:11], a[144:147], a[32:35], v[8:11]
ds_read_b64_tr_b16 a[176:177], v234 offset:24576
v_mov_b32 v141, v140
v_mfma_f32_16x16x32_bf16 v[40:43], a[144:147], a[36:39], v[40:43]
ds_read_b64_tr_b16 a[178:179], v234 offset:28672
v_lshl_add_u32 v221, v189, 5, v188
v_mfma_f32_16x16x32_bf16 v[72:75], a[144:147], a[40:43], v[72:75]
s_add_u32 s28, s28, 1024
s_cmp_lt_u32 s28, s6
s_cselect_b32 s28, s28, s4
v_mfma_f32_16x16x32_bf16 v[104:107], a[144:147], a[44:47], v[104:107]
ds_read_b64_tr_b16 a[180:181], v234 offset:24584
v_permlane32_swap_b32 v140, v141
v_mfma_f32_16x16x32_bf16 v[108:111], a[148:151], a[44:47], v[108:111]
ds_read_b64_tr_b16 a[182:183], v234 offset:28680
v_max_u32 v140, v140, v141
v_mfma_f32_16x16x32_bf16 v[76:79], a[148:151], a[40:43], v[76:79]
buffer_load_dwordx4 a[96:99], v240, s[20:23], s28 offen sc0 sc1
v_mfma_f32_16x16x32_bf16 v[44:47], a[148:151], a[36:39], v[44:47]
ds_read_b64_tr_b16 a[184:185], v235 offset:24576
v_add_u32 v143, v143, v140
v_mfma_f32_16x16x32_bf16 v[12:15], a[148:151], a[32:35], v[12:15]
ds_read_b64_tr_b16 a[186:187], v235 offset:28672
v_sub_u32 v136, v136, v140
v_mfma_f32_16x16x32_bf16 v[16:19], a[152:155], a[32:35], v[16:19]
buffer_load_dwordx4 a[100:103], v241, s[20:23], s28 offen sc0 sc1
v_mfma_f32_16x16x32_bf16 v[48:51], a[152:155], a[36:39], v[48:51]
ds_read_b64_tr_b16 a[188:189], v235 offset:24584
v_sub_u32 v137, v137, v140
v_mfma_f32_16x16x32_bf16 v[80:83], a[152:155], a[40:43], v[80:83]
ds_read_b64_tr_b16 a[190:191], v235 offset:28680
v_sub_u32 v138, v138, v140
v_mfma_f32_16x16x32_bf16 v[112:115], a[152:155], a[44:47], v[112:115]
buffer_load_dwordx4 a[104:107], v242, s[20:23], s28 offen sc0 sc1
v_mfma_f32_16x16x32_bf16 v[116:119], a[156:159], a[44:47], v[116:119]
ds_read_b64_tr_b16 a[192:193], v236 offset:24576
v_sub_u32 v139, v139, v140
v_mfma_f32_16x16x32_bf16 v[84:87], a[156:159], a[40:43], v[84:87]
buffer_load_dwordx4 a[108:111], v243, s[20:23], s28 offen sc0 sc1
v_mfma_f32_16x16x32_bf16 v[52:55], a[156:159], a[36:39], v[52:55]
ds_read_b64_tr_b16 a[194:195], v236 offset:28672
v_cndmask_b32 v142, v142, v143, s[90:91]
v_mfma_f32_16x16x32_bf16 v[20:23], a[156:159], a[32:35], v[20:23]
ds_read_b64_tr_b16 a[196:197], v236 offset:24584
s_lshl_b64 s[90:91], s[90:91], 1
s_waitcnt lgkmcnt(8)
v_mfma_f32_16x16x32_bf16 v[24:27], a[160:163], a[32:35], v[24:27]
s_add_u32 m0, s49, 131072
v_max3_u32 v140, v136, v137, v138
v_mfma_f32_16x16x32_bf16 v[56:59], a[160:163], a[36:39], v[56:59]
ds_read_b64_tr_b16 a[198:199], v236 offset:28680
v_max_u32 v140, v140, v139
v_mfma_f32_16x16x32_bf16 v[88:91], a[160:163], a[40:43], v[88:91]
ds_read_b64_tr_b16 a[200:201], v237 offset:24576
v_xor_b32 v189, 2, v187
v_mfma_f32_16x16x32_bf16 v[120:123], a[160:163], a[44:47], v[120:123]
v_max_u32_dpp v141, v140, v140 row_ror:8 row_mask:0xf bank_mask:0xf
v_lshl_add_u32 v222, v189, 5, v188
v_mfma_f32_16x16x32_bf16 v[124:127], a[164:167], a[44:47], v[124:127]
ds_read_b64_tr_b16 a[202:203], v237 offset:28672
v_xor_b32 v189, 3, v187
v_mfma_f32_16x16x32_bf16 v[92:95], a[164:167], a[40:43], v[92:95]
ds_read_b64_tr_b16 a[204:205], v237 offset:24584
v_max_u32_dpp v140, v141, v141 row_ror:4 row_mask:0xf bank_mask:0xf
v_mfma_f32_16x16x32_bf16 v[60:63], a[164:167], a[36:39], v[60:63]
buffer_load_dwordx4 v238, s[16:19], s34 offen offset:0 lds
v_mfma_f32_16x16x32_bf16 v[28:31], a[164:167], a[32:35], v[28:31]
ds_read_b64_tr_b16 a[206:207], v237 offset:28680
v_max_u32_dpp v141, v140, v140 row_ror:2 row_mask:0xf bank_mask:0xf
v_mfma_f32_16x16x32_bf16 v[32:35], a[168:171], a[32:35], v[32:35]
buffer_load_dwordx4 v239, s[16:19], s34 offen offset:1024 lds
v_mfma_f32_16x16x32_bf16 v[64:67], a[168:171], a[36:39], v[64:67]
v_max_u32_dpp v140, v141, v141 row_ror:1 row_mask:0xf bank_mask:0xf
v_mov_b32 v141, v140
v_mfma_f32_16x16x32_bf16 v[96:99], a[168:171], a[40:43], v[96:99]
s_add_u32 s34, s34, 262144
s_sub_u32 s51, s34, 4718592
s_cselect_b32 s34, s34, s51
v_mfma_f32_16x16x32_bf16 v[128:131], a[168:171], a[44:47], v[128:131]
v_permlane16_swap_b32 v140, v141
v_max_u32 v140, v140, v141
v_mfma_f32_16x16x32_bf16 v[132:135], a[172:175], a[44:47], v[132:135]
v_mov_b32 v141, v140
v_lshl_add_u32 v223, v189, 5, v188
v_mfma_f32_16x16x32_bf16 v[100:103], a[172:175], a[40:43], v[100:103]
v_xor_b32 v189, 4, v187
v_lshl_add_u32 v224, v189, 5, v188
v_mfma_f32_16x16x32_bf16 v[68:71], a[172:175], a[36:39], v[68:71]
v_permlane32_swap_b32 v140, v141
v_max_u32 v140, v140, v141
v_mfma_f32_16x16x32_bf16 v[36:39], a[172:175], a[32:35], v[36:39]
v_add_u32 v143, v143, v140
v_sub_u32 v136, v136, v140
s_waitcnt vmcnt(18)
v_mfma_f32_16x16x32_bf16 v[8:11], a[176:179], a[48:51], v[8:11]
ds_read_b64_tr_b16 a[144:145], v234 offset:32768
v_sub_u32 v137, v137, v140
v_mfma_f32_16x16x32_bf16 v[40:43], a[176:179], a[52:55], v[40:43]
ds_read_b64_tr_b16 a[146:147], v234 offset:36864
v_sub_u32 v138, v138, v140
v_mfma_f32_16x16x32_bf16 v[72:75], a[176:179], a[56:59], v[72:75]
s_add_u32 s28, s28, 1024
s_cmp_lt_u32 s28, s6
s_cselect_b32 s28, s28, s4
v_mfma_f32_16x16x32_bf16 v[104:107], a[176:179], a[60:63], v[104:107]
ds_read_b64_tr_b16 a[148:149], v234 offset:32776
v_sub_u32 v139, v139, v140
s_waitcnt lgkmcnt(8)
v_mfma_f32_16x16x32_bf16 v[108:111], a[180:183], a[60:63], v[108:111]
ds_read_b64_tr_b16 a[150:151], v234 offset:36872
v_cndmask_b32 v142, v142, v143, s[90:91]
v_mfma_f32_16x16x32_bf16 v[76:79], a[180:183], a[56:59], v[76:79]
buffer_load_dwordx4 a[112:115], v240, s[20:23], s28 offen sc0 sc1
v_mfma_f32_16x16x32_bf16 v[44:47], a[180:183], a[52:55], v[44:47]
ds_read_b64_tr_b16 a[152:153], v235 offset:32768
s_lshl_b64 s[90:91], s[90:91], 1
v_mfma_f32_16x16x32_bf16 v[12:15], a[180:183], a[48:51], v[12:15]
ds_read_b64_tr_b16 a[154:155], v235 offset:36864
v_max3_u32 v140, v136, v137, v138
v_mfma_f32_16x16x32_bf16 v[16:19], a[184:187], a[48:51], v[16:19]
buffer_load_dwordx4 a[116:119], v241, s[20:23], s28 offen sc0 sc1
v_mfma_f32_16x16x32_bf16 v[48:51], a[184:187], a[52:55], v[48:51]
ds_read_b64_tr_b16 a[156:157], v235 offset:32776
v_max_u32 v140, v140, v139
v_mfma_f32_16x16x32_bf16 v[80:83], a[184:187], a[56:59], v[80:83]
ds_read_b64_tr_b16 a[158:159], v235 offset:36872
v_xor_b32 v189, 5, v187
v_mfma_f32_16x16x32_bf16 v[112:115], a[184:187], a[60:63], v[112:115]
buffer_load_dwordx4 a[120:123], v242, s[20:23], s28 offen sc0 sc1
v_mfma_f32_16x16x32_bf16 v[116:119], a[188:191], a[60:63], v[116:119]
ds_read_b64_tr_b16 a[160:161], v236 offset:32768
v_max_u32_dpp v141, v140, v140 row_ror:8 row_mask:0xf bank_mask:0xf
v_mfma_f32_16x16x32_bf16 v[84:87], a[188:191], a[56:59], v[84:87]
buffer_load_dwordx4 a[124:127], v243, s[20:23], s28 offen sc0 sc1
v_mfma_f32_16x16x32_bf16 v[52:55], a[188:191], a[52:55], v[52:55]
ds_read_b64_tr_b16 a[162:163], v236 offset:36864
v_max_u32_dpp v140, v141, v141 row_ror:4 row_mask:0xf bank_mask:0xf
v_mfma_f32_16x16x32_bf16 v[20:23], a[188:191], a[48:51], v[20:23]
ds_read_b64_tr_b16 a[164:165], v236 offset:32776
v_lshl_add_u32 v225, v189, 5, v188
v_mfma_f32_16x16x32_bf16 v[24:27], a[192:195], a[48:51], v[24:27]
s_add_u32 m0, s49, 139264
v_max_u32_dpp v141, v140, v140 row_ror:2 row_mask:0xf bank_mask:0xf
v_mfma_f32_16x16x32_bf16 v[56:59], a[192:195], a[52:55], v[56:59]
ds_read_b64_tr_b16 a[166:167], v236 offset:36872
v_xor_b32 v189, 6, v187
v_mfma_f32_16x16x32_bf16 v[88:91], a[192:195], a[56:59], v[88:91]
ds_read_b64_tr_b16 a[168:169], v237 offset:32768
v_max_u32_dpp v140, v141, v141 row_ror:1 row_mask:0xf bank_mask:0xf
v_mfma_f32_16x16x32_bf16 v[120:123], a[192:195], a[60:63], v[120:123]
v_mov_b32 v141, v140
v_lshl_add_u32 v226, v189, 5, v188
s_waitcnt lgkmcnt(8)
v_mfma_f32_16x16x32_bf16 v[124:127], a[196:199], a[60:63], v[124:127]
ds_read_b64_tr_b16 a[170:171], v237 offset:36864
v_xor_b32 v189, 7, v187
v_mfma_f32_16x16x32_bf16 v[92:95], a[196:199], a[56:59], v[92:95]
ds_read_b64_tr_b16 a[172:173], v237 offset:32776
v_permlane16_swap_b32 v140, v141
v_mfma_f32_16x16x32_bf16 v[60:63], a[196:199], a[52:55], v[60:63]
buffer_load_dwordx4 v238, s[16:19], s34 offen offset:0 lds
v_mfma_f32_16x16x32_bf16 v[28:31], a[196:199], a[48:51], v[28:31]
ds_read_b64_tr_b16 a[174:175], v237 offset:36872
v_max_u32 v140, v140, v141
v_mfma_f32_16x16x32_bf16 v[32:35], a[200:203], a[48:51], v[32:35]
buffer_load_dwordx4 v239, s[16:19], s34 offen offset:1024 lds
v_mfma_f32_16x16x32_bf16 v[64:67], a[200:203], a[52:55], v[64:67]
v_mov_b32 v141, v140
v_lshl_add_u32 v227, v189, 5, v188
v_mfma_f32_16x16x32_bf16 v[96:99], a[200:203], a[56:59], v[96:99]
s_add_u32 s34, s34, 262144
s_sub_u32 s51, s34, 4718592
s_cselect_b32 s34, s34, s51
v_mfma_f32_16x16x32_bf16 v[128:131], a[200:203], a[60:63], v[128:131]
v_permlane32_swap_b32 v140, v141
v_max_u32 v140, v140, v141
v_mfma_f32_16x16x32_bf16 v[132:135], a[204:207], a[60:63], v[132:135]
v_add_u32 v143, v143, v140
v_sub_u32 v136, v136, v140
v_mfma_f32_16x16x32_bf16 v[100:103], a[204:207], a[56:59], v[100:103]
v_sub_u32 v137, v137, v140
v_sub_u32 v138, v138, v140
v_mfma_f32_16x16x32_bf16 v[68:71], a[204:207], a[52:55], v[68:71]
v_sub_u32 v139, v139, v140
v_cndmask_b32 v142, v142, v143, s[90:91]
v_mfma_f32_16x16x32_bf16 v[36:39], a[204:207], a[48:51], v[36:39]
s_lshl_b64 s[90:91], s[90:91], 1
v_add_u32 v184, 0, v4
s_waitcnt vmcnt(20)
v_mfma_f32_16x16x32_bf16 v[8:11], a[144:147], a[64:67], v[8:11]
ds_read_b64_tr_b16 a[176:177], v234 offset:40960
v_max3_u32 v140, v136, v137, v138
v_mfma_f32_16x16x32_bf16 v[40:43], a[144:147], a[68:71], v[40:43]
ds_read_b64_tr_b16 a[178:179], v234 offset:45056
v_max_u32 v140, v140, v139
v_mfma_f32_16x16x32_bf16 v[72:75], a[144:147], a[72:75], v[72:75]
s_add_u32 s28, s28, 1024
s_cmp_lt_u32 s28, s6
s_cselect_b32 s28, s28, s4
v_mfma_f32_16x16x32_bf16 v[104:107], a[144:147], a[76:79], v[104:107]
ds_read_b64_tr_b16 a[180:181], v234 offset:40968
v_max_u32_dpp v141, v140, v140 row_ror:8 row_mask:0xf bank_mask:0xf
v_mfma_f32_16x16x32_bf16 v[108:111], a[148:151], a[76:79], v[108:111]
ds_read_b64_tr_b16 a[182:183], v234 offset:45064
v_xor_b32 v184, v184, v3
v_mfma_f32_16x16x32_bf16 v[76:79], a[148:151], a[72:75], v[76:79]
buffer_load_dwordx4 a[0:3], v240, s[20:23], s28 offen sc0 sc1
v_mfma_f32_16x16x32_bf16 v[44:47], a[148:151], a[68:71], v[44:47]
ds_read_b64_tr_b16 a[184:185], v235 offset:40960
v_max_u32_dpp v140, v141, v141 row_ror:4 row_mask:0xf bank_mask:0xf
v_mfma_f32_16x16x32_bf16 v[12:15], a[148:151], a[64:67], v[12:15]
ds_read_b64_tr_b16 a[186:187], v235 offset:45056
v_lshlrev_b32 v184, 4, v184
s_waitcnt lgkmcnt(8)
v_mfma_f32_16x16x32_bf16 v[16:19], a[152:155], a[64:67], v[16:19]
buffer_load_dwordx4 a[4:7], v241, s[20:23], s28 offen sc0 sc1
v_mfma_f32_16x16x32_bf16 v[48:51], a[152:155], a[68:71], v[48:51]
ds_read_b64_tr_b16 a[188:189], v235 offset:40968
v_max_u32_dpp v141, v140, v140 row_ror:2 row_mask:0xf bank_mask:0xf
v_mfma_f32_16x16x32_bf16 v[80:83], a[152:155], a[72:75], v[80:83]
ds_read_b64_tr_b16 a[190:191], v235 offset:45064
v_lshl_add_u32 v184, v4, 8, v184
v_mfma_f32_16x16x32_bf16 v[112:115], a[152:155], a[76:79], v[112:115]
buffer_load_dwordx4 a[8:11], v242, s[20:23], s28 offen sc0 sc1
v_mfma_f32_16x16x32_bf16 v[116:119], a[156:159], a[76:79], v[116:119]
ds_read_b64_tr_b16 a[192:193], v236 offset:40960
v_max_u32_dpp v140, v141, v141 row_ror:1 row_mask:0xf bank_mask:0xf
v_mfma_f32_16x16x32_bf16 v[84:87], a[156:159], a[72:75], v[84:87]
buffer_load_dwordx4 a[12:15], v243, s[20:23], s28 offen sc0 sc1
v_mfma_f32_16x16x32_bf16 v[52:55], a[156:159], a[68:71], v[52:55]
ds_read_b64_tr_b16 a[194:195], v236 offset:45056
v_mov_b32 v141, v140
v_mfma_f32_16x16x32_bf16 v[20:23], a[156:159], a[64:67], v[20:23]
ds_read_b64_tr_b16 a[196:197], v236 offset:40968
v_add_u32 v228, s30, v184
v_mfma_f32_16x16x32_bf16 v[24:27], a[160:163], a[64:67], v[24:27]
s_add_u32 m0, s49, 0
v_permlane16_swap_b32 v140, v141
v_mfma_f32_16x16x32_bf16 v[56:59], a[160:163], a[68:71], v[56:59]
ds_read_b64_tr_b16 a[198:199], v236 offset:45064
v_max_u32 v140, v140, v141
v_mfma_f32_16x16x32_bf16 v[88:91], a[160:163], a[72:75], v[88:91]
ds_read_b64_tr_b16 a[200:201], v237 offset:40960
v_mov_b32 v141, v140
v_mfma_f32_16x16x32_bf16 v[120:123], a[160:163], a[76:79], v[120:123]
v_add_u32 v184, 4, v4
v_xor_b32 v184, v184, v3
v_mfma_f32_16x16x32_bf16 v[124:127], a[164:167], a[76:79], v[124:127]
ds_read_b64_tr_b16 a[202:203], v237 offset:45056
v_permlane32_swap_b32 v140, v141
STUB_1:
STUB_A1:
s_cbranch_execz STUB_4
v_mfma_f32_16x16x32_bf16 v[92:95], a[164:167], a[72:75], v[92:95]
ds_read_b64_tr_b16 a[204:205], v237 offset:40968
v_max_u32 v140, v140, v141
v_mfma_f32_16x16x32_bf16 v[60:63], a[164:167], a[68:71], v[60:63]
buffer_load_dwordx4 v238, s[16:19], s34 offen offset:0 lds
v_mfma_f32_16x16x32_bf16 v[28:31], a[164:167], a[64:67], v[28:31]
ds_read_b64_tr_b16 a[206:207], v237 offset:45064
v_add_u32 v143, v143, v140
v_mfma_f32_16x16x32_bf16 v[32:35], a[168:171], a[64:67], v[32:35]
buffer_load_dwordx4 v239, s[16:19], s34 offen offset:1024 lds
v_mfma_f32_16x16x32_bf16 v[64:67], a[168:171], a[68:71], v[64:67]
v_sub_u32 v136, v136, v140
v_sub_u32 v137, v137, v140
v_mfma_f32_16x16x32_bf16 v[96:99], a[168:171], a[72:75], v[96:99]
s_add_u32 s34, s34, 262144
s_sub_u32 s51, s34, 4718592
s_cselect_b32 s34, s34, s51
v_mfma_f32_16x16x32_bf16 v[128:131], a[168:171], a[76:79], v[128:131]
v_sub_u32 v138, v138, v140
v_sub_u32 v139, v139, v140
s_waitcnt lgkmcnt(8)
v_mfma_f32_16x16x32_bf16 v[132:135], a[172:175], a[76:79], v[132:135]
v_cndmask_b32 v142, v142, v143, s[90:91]
v_lshlrev_b32 v184, 4, v184
v_mfma_f32_16x16x32_bf16 v[100:103], a[172:175], a[72:75], v[100:103]
s_lshl_b64 s[90:91], s[90:91], 1
v_lshl_add_u32 v184, v4, 8, v184
v_mfma_f32_16x16x32_bf16 v[68:71], a[172:175], a[68:71], v[68:71]
v_max3_u32 v140, v136, v137, v138
v_max_u32 v140, v140, v139
v_mfma_f32_16x16x32_bf16 v[36:39], a[172:175], a[64:67], v[36:39]
v_add_u32 v229, s30, v184
v_add_u32 v184, 8, v4
s_waitcnt vmcnt(20)
v_mfma_f32_16x16x32_bf16 v[8:11], a[176:179], a[80:83], v[8:11]
v_max_u32_dpp v141, v140, v140 row_ror:8 row_mask:0xf bank_mask:0xf
v_xor_b32 v184, v184, v3
v_mfma_f32_16x16x32_bf16 v[40:43], a[176:179], a[84:87], v[40:43]
s_waitcnt vmcnt(12) lgkmcnt(0)
s_barrier
v_mfma_f32_16x16x32_bf16 v[72:75], a[176:179], a[88:91], v[72:75]
ds_read_b64_tr_b16 a[144:145], v234 offset:49152
v_max_u32_dpp v140, v141, v141 row_ror:4 row_mask:0xf bank_mask:0xf
v_mfma_f32_16x16x32_bf16 v[104:107], a[176:179], a[92:95], v[104:107]
ds_read_b64_tr_b16 a[146:147], v234 offset:53248
v_lshlrev_b32 v184, 4, v184
v_mfma_f32_16x16x32_bf16 v[108:111], a[180:183], a[92:95], v[108:111]
ds_read_b64_tr_b16 a[148:149], v234 offset:49160
v_max_u32_dpp v141, v140, v140 row_ror:2 row_mask:0xf bank_mask:0xf
v_mfma_f32_16x16x32_bf16 v[76:79], a[180:183], a[88:91], v[76:79]
s_add_u32 s28, s28, 1024
s_cmp_lt_u32 s28, s6
s_cselect_b32 s28, s28, s4
v_mfma_f32_16x16x32_bf16 v[44:47], a[180:183], a[84:87], v[44:47]
ds_read_b64_tr_b16 a[150:151], v234 offset:53256
v_max_u32_dpp v140, v141, v141 row_ror:1 row_mask:0xf bank_mask:0xf
v_mfma_f32_16x16x32_bf16 v[12:15], a[180:183], a[80:83], v[12:15]
ds_read_b64_tr_b16 a[152:153], v235 offset:49152
v_mov_b32 v141, v140
v_mfma_f32_16x16x32_bf16 v[16:19], a[184:187], a[80:83], v[16:19]
buffer_load_dwordx4 a[16:19], v240, s[20:23], s28 offen sc0 sc1
v_mfma_f32_16x16x32_bf16 v[48:51], a[184:187], a[84:87], v[48:51]
ds_read_b64_tr_b16 a[154:155], v235 offset:53248
v_permlane16_swap_b32 v140, v141
v_mfma_f32_16x16x32_bf16 v[80:83], a[184:187], a[88:91], v[80:83]
ds_read_b64_tr_b16 a[156:157], v235 offset:49160
v_max_u32 v140, v140, v141
v_mfma_f32_16x16x32_bf16 v[112:115], a[184:187], a[92:95], v[112:115]
buffer_load_dwordx4 a[20:23], v241, s[20:23], s28 offen sc0 sc1
v_mfma_f32_16x16x32_bf16 v[116:119], a[188:191], a[92:95], v[116:119]
ds_read_b64_tr_b16 a[158:159], v235 offset:53256
v_mov_b32 v141, v140
v_mfma_f32_16x16x32_bf16 v[84:87], a[188:191], a[88:91], v[84:87]
ds_read_b64_tr_b16 a[160:161], v236 offset:49152
v_lshl_add_u32 v184, v4, 8, v184
v_mfma_f32_16x16x32_bf16 v[52:55], a[188:191], a[84:87], v[52:55]
ds_read_b64_tr_b16 a[162:163], v236 offset:53248
v_permlane32_swap_b32 v140, v141
v_mfma_f32_16x16x32_bf16 v[20:23], a[188:191], a[80:83], v[20:23]
buffer_load_dwordx4 a[24:27], v242, s[20:23], s28 offen sc0 sc1
v_mfma_f32_16x16x32_bf16 v[24:27], a[192:195], a[80:83], v[24:27]
ds_read_b64_tr_b16 a[164:165], v236 offset:49160
v_max_u32 v140, v140, v141
v_mfma_f32_16x16x32_bf16 v[56:59], a[192:195], a[84:87], v[56:59]
ds_read_b64_tr_b16 a[166:167], v236 offset:53256
v_add_u32 v143, v143, v140
v_mfma_f32_16x16x32_bf16 v[88:91], a[192:195], a[88:91], v[88:91]
buffer_load_dwordx4 a[28:31], v243, s[20:23], s28 offen sc0 sc1
v_mfma_f32_16x16x32_bf16 v[120:123], a[192:195], a[92:95], v[120:123]
ds_read_b64_tr_b16 a[168:169], v237 offset:49152
s_add_u32 m0, s49, 8192
v_mfma_f32_16x16x32_bf16 v[124:127], a[196:199], a[92:95], v[124:127]
ds_read_b64_tr_b16 a[170:171], v237 offset:53248
v_sub_u32 v136, v136, v140
v_mfma_f32_16x16x32_bf16 v[92:95], a[196:199], a[88:91], v[92:95]
buffer_load_dwordx4 v238, s[16:19], s34 offen offset:0 lds
v_mfma_f32_16x16x32_bf16 v[60:63], a[196:199], a[84:87], v[60:63]
ds_read_b64_tr_b16 a[172:173], v237 offset:49160
v_sub_u32 v137, v137, v140
v_mfma_f32_16x16x32_bf16 v[28:31], a[196:199], a[80:83], v[28:31]
ds_read_b64_tr_b16 a[174:175], v237 offset:53256
v_sub_u32 v138, v138, v140
v_mfma_f32_16x16x32_bf16 v[32:35], a[200:203], a[80:83], v[32:35]
buffer_load_dwordx4 v239, s[16:19], s34 offen offset:1024 lds
v_mfma_f32_16x16x32_bf16 v[64:67], a[200:203], a[84:87], v[64:67]
v_sub_u32 v139, v139, v140
v_cndmask_b32 v142, v142, v143, s[90:91]
v_mfma_f32_16x16x32_bf16 v[96:99], a[200:203], a[88:91], v[96:99]
s_add_u32 s34, s34, 262144
s_sub_u32 s51, s34, 4718592
s_cselect_b32 s34, s34, s51
v_mfma_f32_16x16x32_bf16 v[128:131], a[200:203], a[92:95], v[128:131]
s_lshl_b64 s[90:91], s[90:91], 1
v_add_u32 v230, s30, v184
v_mfma_f32_16x16x32_bf16 v[132:135], a[204:207], a[92:95], v[132:135]
v_max3_u32 v140, v136, v137, v138
v_max_u32 v140, v140, v139
v_mfma_f32_16x16x32_bf16 v[100:103], a[204:207], a[88:91], v[100:103]
v_add_u32 v184, 12, v4
v_xor_b32 v184, v184, v3
v_mfma_f32_16x16x32_bf16 v[68:71], a[204:207], a[84:87], v[68:71]
v_max_u32_dpp v141, v140, v140 row_ror:8 row_mask:0xf bank_mask:0xf
v_mov_b32 v192, 0
v_mfma_f32_16x16x32_bf16 v[36:39], a[204:207], a[80:83], v[36:39]
buffer_load_dword v193, v192, s[24:27], 0 offen sc0 sc1
s_waitcnt vmcnt(21)
s_waitcnt lgkmcnt(8)
v_mfma_f32_16x16x32_bf16 v[8:11], a[144:147], a[96:99], v[8:11]
ds_read_b64_tr_b16 a[176:177], v234 offset:57344
v_max_u32_dpp v140, v141, v141 row_ror:4 row_mask:0xf bank_mask:0xf
v_mfma_f32_16x16x32_bf16 v[40:43], a[144:147], a[100:103], v[40:43]
ds_read_b64_tr_b16 a[178:179], v234 offset:61440
v_lshlrev_b32 v184, 4, v184
v_mfma_f32_16x16x32_bf16 v[72:75], a[144:147], a[104:107], v[72:75]
s_add_u32 s28, s28, 1024
s_cmp_lt_u32 s28, s6
s_cselect_b32 s28, s28, s4
v_mfma_f32_16x16x32_bf16 v[104:107], a[144:147], a[108:111], v[104:107]
ds_read_b64_tr_b16 a[180:181], v234 offset:57352
v_max_u32_dpp v141, v140, v140 row_ror:2 row_mask:0xf bank_mask:0xf
v_mfma_f32_16x16x32_bf16 v[108:111], a[148:151], a[108:111], v[108:111]
ds_read_b64_tr_b16 a[182:183], v234 offset:61448
v_lshl_add_u32 v184, v4, 8, v184
v_mfma_f32_16x16x32_bf16 v[76:79], a[148:151], a[104:107], v[76:79]
buffer_load_dwordx4 a[32:35], v240, s[20:23], s28 offen sc0 sc1
v_mfma_f32_16x16x32_bf16 v[44:47], a[148:151], a[100:103], v[44:47]
ds_read_b64_tr_b16 a[184:185], v235 offset:57344
v_max_u32_dpp v140, v141, v141 row_ror:1 row_mask:0xf bank_mask:0xf
v_mfma_f32_16x16x32_bf16 v[12:15], a[148:151], a[96:99], v[12:15]
ds_read_b64_tr_b16 a[186:187], v235 offset:61440
v_mov_b32 v141, v140
v_mfma_f32_16x16x32_bf16 v[16:19], a[152:155], a[96:99], v[16:19]
buffer_load_dwordx4 a[36:39], v241, s[20:23], s28 offen sc0 sc1
v_mfma_f32_16x16x32_bf16 v[48:51], a[152:155], a[100:103], v[48:51]
ds_read_b64_tr_b16 a[188:189], v235 offset:57352
v_permlane16_swap_b32 v140, v141
v_mfma_f32_16x16x32_bf16 v[80:83], a[152:155], a[104:107], v[80:83]
ds_read_b64_tr_b16 a[190:191], v235 offset:61448
v_max_u32 v140, v140, v141
v_mfma_f32_16x16x32_bf16 v[112:115], a[152:155], a[108:111], v[112:115]
buffer_load_dwordx4 a[40:43], v242, s[20:23], s28 offen sc0 sc1
v_mfma_f32_16x16x32_bf16 v[116:119], a[156:159], a[108:111], v[116:119]
ds_read_b64_tr_b16 a[192:193], v236 offset:57344
v_mov_b32 v141, v140
v_mfma_f32_16x16x32_bf16 v[84:87], a[156:159], a[104:107], v[84:87]
buffer_load_dwordx4 a[44:47], v243, s[20:23], s28 offen sc0 sc1
v_mfma_f32_16x16x32_bf16 v[52:55], a[156:159], a[100:103], v[52:55]
ds_read_b64_tr_b16 a[194:195], v236 offset:61440
v_permlane32_swap_b32 v140, v141
v_mfma_f32_16x16x32_bf16 v[20:23], a[156:159], a[96:99], v[20:23]
ds_read_b64_tr_b16 a[196:197], v236 offset:57352
v_max_u32 v140, v140, v141
s_waitcnt lgkmcnt(8)
v_mfma_f32_16x16x32_bf16 v[24:27], a[160:163], a[96:99], v[24:27]
s_add_u32 m0, s49, 16384
v_add_u32 v143, v143, v140
v_mfma_f32_16x16x32_bf16 v[56:59], a[160:163], a[100:103], v[56:59]
ds_read_b64_tr_b16 a[198:199], v236 offset:61448
v_sub_u32 v136, v136, v140
v_mfma_f32_16x16x32_bf16 v[88:91], a[160:163], a[104:107], v[88:91]
ds_read_b64_tr_b16 a[200:201], v237 offset:57344
v_sub_u32 v137, v137, v140
v_mfma_f32_16x16x32_bf16 v[120:123], a[160:163], a[108:111], v[120:123]
v_sub_u32 v138, v138, v140
v_sub_u32 v139, v139, v140
v_mfma_f32_16x16x32_bf16 v[124:127], a[164:167], a[108:111], v[124:127]
ds_read_b64_tr_b16 a[202:203], v237 offset:61440
v_cndmask_b32 v142, v142, v143, s[90:91]
v_mfma_f32_16x16x32_bf16 v[92:95], a[164:167], a[104:107], v[92:95]
ds_read_b64_tr_b16 a[204:205], v237 offset:57352
s_lshl_b64 s[90:91], s[90:91], 1
v_mfma_f32_16x16x32_bf16 v[60:63], a[164:167], a[100:103], v[60:63]
buffer_load_dwordx4 v238, s[16:19], s34 offen offset:0 lds
v_mfma_f32_16x16x32_bf16 v[28:31], a[164:167], a[96:99], v[28:31]
ds_read_b64_tr_b16 a[206:207], v237 offset:61448
v_max3_u32 v140, v136, v137, v138
v_mfma_f32_16x16x32_bf16 v[32:35], a[168:171], a[96:99], v[32:35]
buffer_load_dwordx4 v239, s[16:19], s34 offen offset:1024 lds
v_mfma_f32_16x16x32_bf16 v[64:67], a[168:171], a[100:103], v[64:67]
v_max_u32 v140, v140, v139
v_add_u32 v231, s30, v184
v_mfma_f32_16x16x32_bf16 v[96:99], a[168:171], a[104:107], v[96:99]
s_add_u32 s34, s34, 262144
s_sub_u32 s51, s34, 4718592
s_cselect_b32 s34, s34, s51
v_mfma_f32_16x16x32_bf16 v[128:131], a[168:171], a[108:111], v[128:131]
v_max_u32_dpp v141, v140, v140 row_ror:8 row_mask:0xf bank_mask:0xf
v_add_u32 v184, 0, v4
v_mfma_f32_16x16x32_bf16 v[132:135], a[172:175], a[108:111], v[132:135]
v_lshlrev_b32 v184, 1, v184
v_xor_b32 v184, v184, v3
v_mfma_f32_16x16x32_bf16 v[100:103], a[172:175], a[104:107], v[100:103]
v_max_u32_dpp v140, v141, v141 row_ror:4 row_mask:0xf bank_mask:0xf
v_lshlrev_b32 v184, 4, v184
v_mfma_f32_16x16x32_bf16 v[68:71], a[172:175], a[100:103], v[68:71]
v_lshl_add_u32 v184, v4, 8, v184
v_add_u32 v232, s30, v184
v_mfma_f32_16x16x32_bf16 v[36:39], a[172:175], a[96:99], v[36:39]
v_max_u32_dpp v141, v140, v140 row_ror:2 row_mask:0xf bank_mask:0xf
v_add_u32 v184, 4, v4
s_waitcnt vmcnt(21)
v_mfma_f32_16x16x32_bf16 v[8:11], a[176:179], a[112:115], v[8:11]
v_add_u32 v234, 0x10000, v234
v_add_u32 v235, 0x10000, v235
v_mfma_f32_16x16x32_bf16 v[40:43], a[176:179], a[116:119], v[40:43]
v_add_u32 v236, 0x10000, v236
v_add_u32 v237, 0x10000, v237
v_mfma_f32_16x16x32_bf16 v[72:75], a[176:179], a[120:123], v[72:75]
v_max_u32_dpp v140, v141, v141 row_ror:1 row_mask:0xf bank_mask:0xf
v_mov_b32 v141, v140
v_mfma_f32_16x16x32_bf16 v[104:107], a[176:179], a[124:127], v[104:107]
ds_read_b64_tr_b16 a[144:145], v234 offset:0
v_lshlrev_b32 v184, 1, v184
s_waitcnt lgkmcnt(8)
v_mfma_f32_16x16x32_bf16 v[108:111], a[180:183], a[124:127], v[108:111]
ds_read_b64_tr_b16 a[146:147], v234 offset:4096
v_permlane16_swap_b32 v140, v141
v_mfma_f32_16x16x32_bf16 v[76:79], a[180:183], a[120:123], v[76:79]
ds_read_b64_tr_b16 a[148:149], v234 offset:8
v_max_u32 v140, v140, v141
v_mfma_f32_16x16x32_bf16 v[44:47], a[180:183], a[116:119], v[44:47]
s_add_u32 s28, s28, 1024
s_cmp_lt_u32 s28, s6
s_cselect_b32 s28, s28, s4
v_mfma_f32_16x16x32_bf16 v[12:15], a[180:183], a[112:115], v[12:15]
ds_read_b64_tr_b16 a[150:151], v234 offset:4104
v_mov_b32 v141, v140
v_mfma_f32_16x16x32_bf16 v[16:19], a[184:187], a[112:115], v[16:19]
ds_read_b64_tr_b16 a[152:153], v235 offset:0
v_xor_b32 v184, v184, v3
v_mfma_f32_16x16x32_bf16 v[48:51], a[184:187], a[116:119], v[48:51]
ds_read_b64_tr_b16 a[154:155], v235 offset:4096
v_permlane32_swap_b32 v140, v141
v_mfma_f32_16x16x32_bf16 v[80:83], a[184:187], a[120:123], v[80:83]
buffer_load_dwordx4 a[48:51], v240, s[20:23], s28 offen sc0 sc1
v_mfma_f32_16x16x32_bf16 v[112:115], a[184:187], a[124:127], v[112:115]
ds_read_b64_tr_b16 a[156:157], v235 offset:8
v_max_u32 v140, v140, v141
v_mfma_f32_16x16x32_bf16 v[116:119], a[188:191], a[124:127], v[116:119]
ds_read_b64_tr_b16 a[158:159], v235 offset:4104
v_add_u32 v143, v143, v140
v_mfma_f32_16x16x32_bf16 v[84:87], a[188:191], a[120:123], v[84:87]
buffer_load_dwordx4 a[52:55], v241, s[20:23], s28 offen sc0 sc1
v_mfma_f32_16x16x32_bf16 v[52:55], a[188:191], a[116:119], v[52:55]
ds_read_b64_tr_b16 a[160:161], v236 offset:0
v_sub_u32 v136, v136, v140
v_mfma_f32_16x16x32_bf16 v[20:23], a[188:191], a[112:115], v[20:23]
ds_read_b64_tr_b16 a[162:163], v236 offset:4096
v_sub_u32 v137, v137, v140
s_waitcnt lgkmcnt(8)
v_mfma_f32_16x16x32_bf16 v[24:27], a[192:195], a[112:115], v[24:27]
ds_read_b64_tr_b16 a[164:165], v236 offset:8
v_sub_u32 v138, v138, v140
v_mfma_f32_16x16x32_bf16 v[56:59], a[192:195], a[116:119], v[56:59]
buffer_load_dwordx4 a[56:59], v242, s[20:23], s28 offen sc0 sc1
v_mfma_f32_16x16x32_bf16 v[88:91], a[192:195], a[120:123], v[88:91]
ds_read_b64_tr_b16 a[166:167], v236 offset:4104
v_sub_u32 v139, v139, v140
v_mfma_f32_16x16x32_bf16 v[120:123], a[192:195], a[124:127], v[120:123]
ds_read_b64_tr_b16 a[168:169], v237 offset:0
v_cndmask_b32 v142, v142, v143, s[90:91]
v_mfma_f32_16x16x32_bf16 v[124:127], a[196:199], a[124:127], v[124:127]
ds_read_b64_tr_b16 a[170:171], v237 offset:4096
s_lshl_b64 s[90:91], s[90:91], 1
v_mfma_f32_16x16x32_bf16 v[92:95], a[196:199], a[120:123], v[92:95]
buffer_load_dwordx4 a[60:63], v243, s[20:23], s28 offen sc0 sc1
v_mfma_f32_16x16x32_bf16 v[60:63], a[196:199], a[116:119], v[60:63]
ds_read_b64_tr_b16 a[172:173], v237 offset:8
s_add_u32 m0, s49, 24576
v_mfma_f32_16x16x32_bf16 v[28:31], a[196:199], a[112:115], v[28:31]
ds_read_b64_tr_b16 a[174:175], v237 offset:4104
v_max3_u32 v140, v136, v137, v138
v_mfma_f32_16x16x32_bf16 v[32:35], a[200:203], a[112:115], v[32:35]
buffer_load_dwordx4 v238, s[16:19], s34 offen offset:0 lds
v_mfma_f32_16x16x32_bf16 v[64:67], a[200:203], a[116:119], v[64:67]
buffer_load_dwordx4 v239, s[16:19], s34 offen offset:1024 lds
v_mfma_f32_16x16x32_bf16 v[96:99], a[200:203], a[120:123], v[96:99]
v_max_u32 v140, v140, v139
v_lshlrev_b32 v184, 4, v184
v_mfma_f32_16x16x32_bf16 v[128:131], a[200:203], a[124:127], v[128:131]
s_add_u32 s34, s34, 262144
s_sub_u32 s51, s34, 4718592
s_cselect_b32 s34, s34, s51
v_mfma_f32_16x16x32_bf16 v[132:135], a[204:207], a[124:127], v[132:135]
v_max_u32_dpp v141, v140, v140 row_ror:8 row_mask:0xf bank_mask:0xf
v_lshl_add_u32 v184, v4, 8, v184
v_mfma_f32_16x16x32_bf16 v[100:103], a[204:207], a[120:123], v[100:103]
v_add_u32 v233, s30, v184
v_bfe_u32 v184, v1, 1, 1
v_mfma_f32_16x16x32_bf16 v[68:71], a[204:207], a[116:119], v[68:71]
v_max_u32_dpp v140, v141, v141 row_ror:4 row_mask:0xf bank_mask:0xf
v_lshrrev_b32 v185, 5, v1
v_mfma_f32_16x16x32_bf16 v[36:39], a[204:207], a[112:115], v[36:39]
v_cmp_eq_u32 vcc, v184, v185
v_mov_b32 v186, 0x3f803f80
s_waitcnt vmcnt(21)
v_mfma_f32_16x16x32_bf16 v[8:11], a[144:147], a[0:3], v[8:11]
v_max_u32_dpp v141, v140, v140 row_ror:2 row_mask:0xf bank_mask:0xf
v_mfma_f32_16x16x32_bf16 v[40:43], a[144:147], a[4:7], v[40:43]
s_waitcnt vmcnt(13) lgkmcnt(0)
s_barrier
v_mfma_f32_16x16x32_bf16 v[72:75], a[144:147], a[8:11], v[72:75]
ds_read_b64_tr_b16 a[176:177], v234 offset:8192
v_max_u32_dpp v140, v141, v141 row_ror:1 row_mask:0xf bank_mask:0xf
v_mfma_f32_16x16x32_bf16 v[104:107], a[144:147], a[12:15], v[104:107]
ds_read_b64_tr_b16 a[178:179], v234 offset:12288
v_mov_b32 v141, v140
v_mfma_f32_16x16x32_bf16 v[108:111], a[148:151], a[12:15], v[108:111]
ds_read_b64_tr_b16 a[180:181], v234 offset:8200
v_cndmask_b32 v186, 0, v186, vcc
v_mfma_f32_16x16x32_bf16 v[76:79], a[148:151], a[8:11], v[76:79]
s_add_u32 s28, s28, 1024
s_cmp_lt_u32 s28, s6
s_cselect_b32 s28, s28, s4
v_mfma_f32_16x16x32_bf16 v[44:47], a[148:151], a[4:7], v[44:47]
ds_read_b64_tr_b16 a[182:183], v234 offset:12296
v_permlane16_swap_b32 v140, v141
v_mfma_f32_16x16x32_bf16 v[12:15], a[148:151], a[0:3], v[12:15]
ds_read_b64_tr_b16 a[184:185], v235 offset:8192
v_max_u32 v140, v140, v141
v_mfma_f32_16x16x32_bf16 v[16:19], a[152:155], a[0:3], v[16:19]
buffer_load_dwordx4 a[64:67], v240, s[20:23], s28 offen sc0 sc1
v_mfma_f32_16x16x32_bf16 v[48:51], a[152:155], a[4:7], v[48:51]
ds_read_b64_tr_b16 a[186:187], v235 offset:12288
v_mov_b32 v141, v140
v_mfma_f32_16x16x32_bf16 v[80:83], a[152:155], a[8:11], v[80:83]
ds_read_b64_tr_b16 a[188:189], v235 offset:8200
v_and_b32 v184, 1, v1
v_mfma_f32_16x16x32_bf16 v[112:115], a[152:155], a[12:15], v[112:115]
buffer_load_dwordx4 a[68:71], v241, s[20:23], s28 offen sc0 sc1
v_mfma_f32_16x16x32_bf16 v[116:119], a[156:159], a[12:15], v[116:119]
ds_read_b64_tr_b16 a[190:191], v235 offset:12296
v_permlane32_swap_b32 v140, v141
v_mfma_f32_16x16x32_bf16 v[84:87], a[156:159], a[8:11], v[84:87]
ds_read_b64_tr_b16 a[192:193], v236 offset:8192
v_max_u32 v140, v140, v141
v_mfma_f32_16x16x32_bf16 v[52:55], a[156:159], a[4:7], v[52:55]
ds_read_b64_tr_b16 a[194:195], v236 offset:12288
v_add_u32 v143, v143, v140
v_mfma_f32_16x16x32_bf16 v[20:23], a[156:159], a[0:3], v[20:23]
buffer_load_dwordx4 a[72:75], v242, s[20:23], s28 offen sc0 sc1
v_mfma_f32_16x16x32_bf16 v[24:27], a[160:163], a[0:3], v[24:27]
ds_read_b64_tr_b16 a[196:197], v236 offset:8200
v_cndmask_b32 v142, v142, v143, s[90:91]
v_mfma_f32_16x16x32_bf16 v[56:59], a[160:163], a[4:7], v[56:59]
ds_read_b64_tr_b16 a[198:199], v236 offset:12296
v_cmp_eq_u32 vcc, 1, v184
v_mfma_f32_16x16x32_bf16 v[88:91], a[160:163], a[8:11], v[88:91]
buffer_load_dwordx4 a[76:79], v243, s[20:23], s28 offen sc0 sc1
v_mfma_f32_16x16x32_bf16 v[120:123], a[160:163], a[12:15], v[120:123]
ds_read_b64_tr_b16 a[200:201], v237 offset:8192
s_add_u32 m0, s49, 32768
v_mfma_f32_16x16x32_bf16 v[124:127], a[164:167], a[12:15], v[124:127]
ds_read_b64_tr_b16 a[202:203], v237 offset:12288
v_mov_b32 v184, 0x44444444
v_mfma_f32_16x16x32_bf16 v[92:95], a[164:167], a[8:11], v[92:95]
buffer_load_dwordx4 v238, s[16:19], s34 offen offset:0 lds
v_mfma_f32_16x16x32_bf16 v[60:63], a[164:167], a[4:7], v[60:63]
ds_read_b64_tr_b16 a[204:205], v237 offset:8200
v_mov_b32 v185, 0xeeeeeeee
v_mfma_f32_16x16x32_bf16 v[28:31], a[164:167], a[0:3], v[28:31]
ds_read_b64_tr_b16 a[206:207], v237 offset:12296
v_mfma_f32_16x16x32_bf16 v[32:35], a[168:171], a[0:3], v[32:35]
buffer_load_dwordx4 v239, s[16:19], s34 offen offset:1024 lds
v_mfma_f32_16x16x32_bf16 v[64:67], a[168:171], a[4:7], v[64:67]
v_cndmask_b32 v245, v184, v185, vcc
v_accvgpr_write_b32 a208, v186
v_mfma_f32_16x16x32_bf16 v[96:99], a[168:171], a[8:11], v[96:99]
s_add_u32 s34, s34, 262144
s_sub_u32 s51, s34, 4718592
s_cselect_b32 s34, s34, s51
v_mfma_f32_16x16x32_bf16 v[128:131], a[168:171], a[12:15], v[128:131]
v_accvgpr_write_b32 a209, v186
v_accvgpr_write_b32 a210, v186
v_mfma_f32_16x16x32_bf16 v[132:135], a[172:175], a[12:15], v[132:135]
v_accvgpr_write_b32 a211, v186
v_mfma_f32_16x16x32_bf16 v[100:103], a[172:175], a[8:11], v[100:103]
s_lshl_b32 s92, s36, 9
s_lshr_b32 s93, s35, 2
v_mfma_f32_16x16x32_bf16 v[68:71], a[172:175], a[4:7], v[68:71]
s_and_b32 s94, s35, 3
s_lshl_b32 s95, s93, 6
v_mfma_f32_16x16x32_bf16 v[36:39], a[172:175], a[0:3], v[36:39]
s_add_u32 s95, s95, s92
s_lshl2_add_u32 s95, s94, s95
s_waitcnt vmcnt(21)
s_waitcnt lgkmcnt(8)
v_mfma_f32_16x16x32_bf16 v[8:11], a[176:179], a[16:19], v[8:11]
v_add_u32 v234, 0xfffe0000, v234
v_add_u32 v235, 0xfffe0000, v235
v_mfma_f32_16x16x32_bf16 v[40:43], a[176:179], a[20:23], v[40:43]
v_add_u32 v236, 0xfffe0000, v236
v_add_u32 v237, 0xfffe0000, v237
v_mfma_f32_16x16x32_bf16 v[72:75], a[176:179], a[24:27], v[72:75]
s_add_u32 s95, s95, 0x248000
v_mfma_f32_16x16x32_bf16 v[104:107], a[176:179], a[28:31], v[104:107]
ds_read_b64_tr_b16 a[144:145], v234 offset:0
v_lshlrev_b32 v170, 4, v1
v_mfma_f32_16x16x32_bf16 v[108:111], a[180:183], a[28:31], v[108:111]
ds_read_b64_tr_b16 a[146:147], v234 offset:4096
v_add_u32 v170, s95, v170
v_mfma_f32_16x16x32_bf16 v[76:79], a[180:183], a[24:27], v[76:79]
ds_read_b64_tr_b16 a[148:149], v234 offset:8
s_lshl_b32 s95, s94, 7
v_mfma_f32_16x16x32_bf16 v[44:47], a[180:183], a[20:23], v[44:47]
s_add_u32 s28, s28, 1024
s_cmp_lt_u32 s28, s6
s_cselect_b32 s28, s28, s4
v_mfma_f32_16x16x32_bf16 v[12:15], a[180:183], a[16:19], v[12:15]
ds_read_b64_tr_b16 a[150:151], v234 offset:4104
s_add_u32 s95, s95, s92
v_mfma_f32_16x16x32_bf16 v[16:19], a[184:187], a[16:19], v[16:19]
ds_read_b64_tr_b16 a[152:153], v235 offset:0
s_lshl2_add_u32 s95, s93, s95
v_mfma_f32_16x16x32_bf16 v[48:51], a[184:187], a[20:23], v[48:51]
ds_read_b64_tr_b16 a[154:155], v235 offset:4096
s_add_u32 s95, s95, 0x249f80
v_mfma_f32_16x16x32_bf16 v[80:83], a[184:187], a[24:27], v[80:83]
buffer_load_dwordx4 a[80:83], v240, s[20:23], s28 offen sc0 sc1
v_mfma_f32_16x16x32_bf16 v[112:115], a[184:187], a[28:31], v[112:115]
ds_read_b64_tr_b16 a[156:157], v235 offset:8
v_lshlrev_b32 v184, 5, v1
v_mfma_f32_16x16x32_bf16 v[116:119], a[188:191], a[28:31], v[116:119]
ds_read_b64_tr_b16 a[158:159], v235 offset:4104
v_add_u32 v184, s95, v184
v_mfma_f32_16x16x32_bf16 v[84:87], a[188:191], a[24:27], v[84:87]
buffer_load_dwordx4 a[84:87], v241, s[20:23], s28 offen sc0 sc1
v_mfma_f32_16x16x32_bf16 v[52:55], a[188:191], a[20:23], v[52:55]
ds_read_b64_tr_b16 a[160:161], v236 offset:0
v_cmp_lt_u32 vcc, 3, v1
v_mfma_f32_16x16x32_bf16 v[20:23], a[188:191], a[16:19], v[20:23]
ds_read_b64_tr_b16 a[162:163], v236 offset:4096
s_waitcnt lgkmcnt(8)
v_mfma_f32_16x16x32_bf16 v[24:27], a[192:195], a[16:19], v[24:27]
ds_read_b64_tr_b16 a[164:165], v236 offset:8
v_cndmask_b32 v170, v170, v184, vcc
v_mfma_f32_16x16x32_bf16 v[56:59], a[192:195], a[20:23], v[56:59]
buffer_load_dwordx4 a[88:91], v242, s[20:23], s28 offen sc0 sc1
v_mfma_f32_16x16x32_bf16 v[88:91], a[192:195], a[24:27], v[88:91]
ds_read_b64_tr_b16 a[166:167], v236 offset:4104
s_mov_b32 s95, 0x7fffbff0
v_mfma_f32_16x16x32_bf16 v[120:123], a[192:195], a[28:31], v[120:123]
ds_read_b64_tr_b16 a[168:169], v237 offset:0
v_mfma_f32_16x16x32_bf16 v[124:127], a[196:199], a[28:31], v[124:127]
ds_read_b64_tr_b16 a[170:171], v237 offset:4096
v_mfma_f32_16x16x32_bf16 v[92:95], a[196:199], a[24:27], v[92:95]
buffer_load_dwordx4 a[92:95], v243, s[20:23], s28 offen sc0 sc1
v_mfma_f32_16x16x32_bf16 v[60:63], a[196:199], a[20:23], v[60:63]
ds_read_b64_tr_b16 a[172:173], v237 offset:8
s_add_u32 m0, s49, 40960
v_mfma_f32_16x16x32_bf16 v[28:31], a[196:199], a[16:19], v[28:31]
ds_read_b64_tr_b16 a[174:175], v237 offset:4104
v_mfma_f32_16x16x32_bf16 v[32:35], a[200:203], a[16:19], v[32:35]
buffer_load_dwordx4 v238, s[16:19], s34 offen offset:0 lds
v_mfma_f32_16x16x32_bf16 v[64:67], a[200:203], a[20:23], v[64:67]
buffer_load_dwordx4 v239, s[16:19], s34 offen offset:1024 lds
v_mfma_f32_16x16x32_bf16 v[96:99], a[200:203], a[24:27], v[96:99]
s_cmp_eq_u32 s2, 0
s_cselect_b32 s95, 0x242c00, s95
v_mfma_f32_16x16x32_bf16 v[128:131], a[200:203], a[28:31], v[128:131]
s_add_u32 s34, s34, 262144
s_sub_u32 s51, s34, 4718592
s_cselect_b32 s34, s34, s51
v_mfma_f32_16x16x32_bf16 v[132:135], a[204:207], a[28:31], v[132:135]
v_lshlrev_b32 v184, 7, v1
v_add_u32 v184, s95, v184
v_mfma_f32_16x16x32_bf16 v[100:103], a[204:207], a[24:27], v[100:103]
v_cmp_lt_u32 vcc, 7, v1
v_mfma_f32_16x16x32_bf16 v[68:71], a[204:207], a[20:23], v[68:71]
v_mfma_f32_16x16x32_bf16 v[36:39], a[204:207], a[16:19], v[36:39]
v_cndmask_b32 v170, v170, v184, vcc
v_mov_b32 v184, 0x7ffffff0
s_waitcnt vmcnt(20)
v_mfma_f32_16x16x32_bf16 v[8:11], a[144:147], a[32:35], v[8:11]
ds_read_b64_tr_b16 a[176:177], v234 offset:8192
v_mov_b32 v171, 0
v_mfma_f32_16x16x32_bf16 v[40:43], a[144:147], a[36:39], v[40:43]
ds_read_b64_tr_b16 a[178:179], v234 offset:12288
v_cmp_lt_u32 vcc, 9, v0
v_mfma_f32_16x16x32_bf16 v[72:75], a[144:147], a[40:43], v[72:75]
s_add_u32 s28, s28, 1024
s_cmp_lt_u32 s28, s6
s_cselect_b32 s28, s28, s4
v_mfma_f32_16x16x32_bf16 v[104:107], a[144:147], a[44:47], v[104:107]
ds_read_b64_tr_b16 a[180:181], v234 offset:8200
v_cndmask_b32 v170, v170, v184, vcc
s_waitcnt lgkmcnt(8)
v_mfma_f32_16x16x32_bf16 v[108:111], a[148:151], a[44:47], v[108:111]
ds_read_b64_tr_b16 a[182:183], v234 offset:12296
v_mov_b32 v254, 0x7ffffff0
v_mfma_f32_16x16x32_bf16 v[76:79], a[148:151], a[40:43], v[76:79]
buffer_load_dwordx4 a[96:99], v240, s[20:23], s28 offen sc0 sc1
v_mfma_f32_16x16x32_bf16 v[44:47], a[148:151], a[36:39], v[44:47]
ds_read_b64_tr_b16 a[184:185], v235 offset:8192
s_lshl_b32 s92, s36, 5
v_mfma_f32_16x16x32_bf16 v[12:15], a[148:151], a[32:35], v[12:15]
ds_read_b64_tr_b16 a[186:187], v235 offset:12288
s_add_u32 s92, s92, s35
v_mfma_f32_16x16x32_bf16 v[16:19], a[152:155], a[32:35], v[16:19]
buffer_load_dwordx4 a[100:103], v241, s[20:23], s28 offen sc0 sc1
v_mfma_f32_16x16x32_bf16 v[48:51], a[152:155], a[36:39], v[48:51]
ds_read_b64_tr_b16 a[188:189], v235 offset:8200
v_mfma_f32_16x16x32_bf16 v[80:83], a[152:155], a[40:43], v[80:83]
ds_read_b64_tr_b16 a[190:191], v235 offset:12296
v_mfma_f32_16x16x32_bf16 v[112:115], a[152:155], a[44:47], v[112:115]
buffer_load_dwordx4 a[104:107], v242, s[20:23], s28 offen sc0 sc1
v_mfma_f32_16x16x32_bf16 v[116:119], a[156:159], a[44:47], v[116:119]
ds_read_b64_tr_b16 a[192:193], v236 offset:8192
v_mfma_f32_16x16x32_bf16 v[84:87], a[156:159], a[40:43], v[84:87]
buffer_load_dwordx4 a[108:111], v243, s[20:23], s28 offen sc0 sc1
v_mfma_f32_16x16x32_bf16 v[52:55], a[156:159], a[36:39], v[52:55]
ds_read_b64_tr_b16 a[194:195], v236 offset:12288
v_mfma_f32_16x16x32_bf16 v[20:23], a[156:159], a[32:35], v[20:23]
ds_read_b64_tr_b16 a[196:197], v236 offset:8200
v_mfma_f32_16x16x32_bf16 v[24:27], a[160:163], a[32:35], v[24:27]
s_add_u32 m0, s49, 49152
v_mfma_f32_16x16x32_bf16 v[56:59], a[160:163], a[36:39], v[56:59]
ds_read_b64_tr_b16 a[198:199], v236 offset:12296
v_mfma_f32_16x16x32_bf16 v[88:91], a[160:163], a[40:43], v[88:91]
ds_read_b64_tr_b16 a[200:201], v237 offset:8192
v_mfma_f32_16x16x32_bf16 v[120:123], a[160:163], a[44:47], v[120:123]
s_cmp_eq_u32 s37, 0
s_cselect_b32 s92, s92, 0x7ffffff0
s_waitcnt lgkmcnt(8)
v_mfma_f32_16x16x32_bf16 v[124:127], a[164:167], a[44:47], v[124:127]
ds_read_b64_tr_b16 a[202:203], v237 offset:12288
v_mfma_f32_16x16x32_bf16 v[92:95], a[164:167], a[40:43], v[92:95]
ds_read_b64_tr_b16 a[204:205], v237 offset:8200
v_writelane_b32 v254, s92, 0
v_mfma_f32_16x16x32_bf16 v[60:63], a[164:167], a[36:39], v[60:63]
buffer_load_dwordx4 v238, s[16:19], s34 offen offset:0 lds
v_mfma_f32_16x16x32_bf16 v[28:31], a[164:167], a[32:35], v[28:31]
ds_read_b64_tr_b16 a[206:207], v237 offset:12296
s_or_b32 s92, s38, s46
v_mfma_f32_16x16x32_bf16 v[32:35], a[168:171], a[32:35], v[32:35]
buffer_load_dwordx4 v239, s[16:19], s34 offen offset:1024 lds
v_mfma_f32_16x16x32_bf16 v[64:67], a[168:171], a[36:39], v[64:67]
v_mov_b32 v255, s92
v_add_u32 v184, 0, v0
v_mfma_f32_16x16x32_bf16 v[96:99], a[168:171], a[40:43], v[96:99]
s_add_u32 s34, s34, 262144
s_sub_u32 s51, s34, 4718592
s_cselect_b32 s34, s34, s51
v_mfma_f32_16x16x32_bf16 v[128:131], a[168:171], a[44:47], v[128:131]
v_mul_u32_u24 v185, 911, v184
v_lshrrev_b32 v185, 16, v185
v_mfma_f32_16x16x32_bf16 v[132:135], a[172:175], a[44:47], v[132:135]
v_add_u32 v184, v184, v185
v_lshlrev_b32 v184, 4, v184
v_mfma_f32_16x16x32_bf16 v[100:103], a[172:175], a[40:43], v[100:103]
v_add_u32 v178, 0x24000, v184
v_add_u32 v184, 256, v0
v_mfma_f32_16x16x32_bf16 v[68:71], a[172:175], a[36:39], v[68:71]
v_mul_u32_u24 v185, 911, v184
v_lshrrev_b32 v185, 16, v185
v_mfma_f32_16x16x32_bf16 v[36:39], a[172:175], a[32:35], v[36:39]
v_add_u32 v184, v184, v185
v_lshlrev_b32 v184, 4, v184
s_waitcnt vmcnt(20)
v_mfma_f32_16x16x32_bf16 v[8:11], a[176:179], a[48:51], v[8:11]
v_add_u32 v179, 0x24000, v184
v_add_u32 v184, 512, v0
v_mfma_f32_16x16x32_bf16 v[40:43], a[176:179], a[52:55], v[40:43]
s_waitcnt vmcnt(12) lgkmcnt(0)
s_barrier
v_mfma_f32_16x16x32_bf16 v[72:75], a[176:179], a[56:59], v[72:75]
ds_read_b64_tr_b16 a[144:145], v234 offset:16384
v_mul_u32_u24 v185, 911, v184
v_mfma_f32_16x16x32_bf16 v[104:107], a[176:179], a[60:63], v[104:107]
ds_read_b64_tr_b16 a[146:147], v234 offset:20480
STUB_2:
STUB_A2:
s_cbranch_execz STUB_5
v_lshrrev_b32 v185, 16, v185
v_mfma_f32_16x16x32_bf16 v[108:111], a[180:183], a[60:63], v[108:111]
ds_read_b64_tr_b16 a[148:149], v234 offset:16392
v_add_u32 v184, v184, v185
v_mfma_f32_16x16x32_bf16 v[76:79], a[180:183], a[56:59], v[76:79]
s_add_u32 s28, s28, 1024
s_cmp_lt_u32 s28, s6
s_cselect_b32 s28, s28, s4
v_mfma_f32_16x16x32_bf16 v[44:47], a[180:183], a[52:55], v[44:47]
ds_read_b64_tr_b16 a[150:151], v234 offset:20488
v_lshlrev_b32 v184, 4, v184
v_mfma_f32_16x16x32_bf16 v[12:15], a[180:183], a[48:51], v[12:15]
ds_read_b64_tr_b16 a[152:153], v235 offset:16384
v_add_u32 v180, 0x24000, v184
v_mfma_f32_16x16x32_bf16 v[16:19], a[184:187], a[48:51], v[16:19]
buffer_load_dwordx4 a[112:115], v240, s[20:23], s28 offen sc0 sc1
v_mfma_f32_16x16x32_bf16 v[48:51], a[184:187], a[52:55], v[48:51]
ds_read_b64_tr_b16 a[154:155], v235 offset:20480
v_mfma_f32_16x16x32_bf16 v[80:83], a[184:187], a[56:59], v[80:83]
ds_read_b64_tr_b16 a[156:157], v235 offset:16392
v_mfma_f32_16x16x32_bf16 v[112:115], a[184:187], a[60:63], v[112:115]
buffer_load_dwordx4 a[116:119], v241, s[20:23], s28 offen sc0 sc1
v_mfma_f32_16x16x32_bf16 v[116:119], a[188:191], a[60:63], v[116:119]
ds_read_b64_tr_b16 a[158:159], v235 offset:20488
v_mfma_f32_16x16x32_bf16 v[84:87], a[188:191], a[56:59], v[84:87]
ds_read_b64_tr_b16 a[160:161], v236 offset:16384
v_mfma_f32_16x16x32_bf16 v[52:55], a[188:191], a[52:55], v[52:55]
ds_read_b64_tr_b16 a[162:163], v236 offset:20480
v_mfma_f32_16x16x32_bf16 v[20:23], a[188:191], a[48:51], v[20:23]
buffer_load_dwordx4 a[120:123], v242, s[20:23], s28 offen sc0 sc1
v_mfma_f32_16x16x32_bf16 v[24:27], a[192:195], a[48:51], v[24:27]
ds_read_b64_tr_b16 a[164:165], v236 offset:16392
v_mfma_f32_16x16x32_bf16 v[56:59], a[192:195], a[52:55], v[56:59]
ds_read_b64_tr_b16 a[166:167], v236 offset:20488
v_mfma_f32_16x16x32_bf16 v[88:91], a[192:195], a[56:59], v[88:91]
buffer_load_dwordx4 a[124:127], v243, s[20:23], s28 offen sc0 sc1
v_mfma_f32_16x16x32_bf16 v[120:123], a[192:195], a[60:63], v[120:123]
ds_read_b64_tr_b16 a[168:169], v237 offset:16384
s_add_u32 m0, s49, 57344
v_mfma_f32_16x16x32_bf16 v[124:127], a[196:199], a[60:63], v[124:127]
ds_read_b64_tr_b16 a[170:171], v237 offset:20480
v_mfma_f32_16x16x32_bf16 v[92:95], a[196:199], a[56:59], v[92:95]
buffer_load_dwordx4 v238, s[16:19], s34 offen offset:0 lds
v_mfma_f32_16x16x32_bf16 v[60:63], a[196:199], a[52:55], v[60:63]
ds_read_b64_tr_b16 a[172:173], v237 offset:16392
v_mfma_f32_16x16x32_bf16 v[28:31], a[196:199], a[48:51], v[28:31]
ds_read_b64_tr_b16 a[174:175], v237 offset:20488
v_mfma_f32_16x16x32_bf16 v[32:35], a[200:203], a[48:51], v[32:35]
buffer_load_dwordx4 v239, s[16:19], s34 offen offset:1024 lds
v_mfma_f32_16x16x32_bf16 v[64:67], a[200:203], a[52:55], v[64:67]
s_waitcnt vmcnt(36)
v_readfirstlane_b32 s92, v193
v_mfma_f32_16x16x32_bf16 v[96:99], a[200:203], a[56:59], v[96:99]
s_add_u32 s34, s34, 262144
s_sub_u32 s51, s34, 4718592
s_cselect_b32 s34, s34, s51
v_mfma_f32_16x16x32_bf16 v[128:131], a[200:203], a[60:63], v[128:131]
s_and_b32 s93, s92, 0xf0
s_cbranch_scc0 SP_X0
SP_X0_RET:
v_mfma_f32_16x16x32_bf16 v[132:135], a[204:207], a[60:63], v[132:135]
s_add_u32 s92, s92, s36
s_and_b32 s92, s92, 7
v_mfma_f32_16x16x32_bf16 v[100:103], a[204:207], a[56:59], v[100:103]
s_lshl_b32 s92, s92, 2
s_lshr_b32 s92, 0x63724150, s92
v_mfma_f32_16x16x32_bf16 v[68:71], a[204:207], a[52:55], v[68:71]
s_and_b32 s92, s92, 7
s_lshl_b32 s93, s92, 5
v_mfma_f32_16x16x32_bf16 v[36:39], a[204:207], a[48:51], v[36:39]
s_add_u32 s40, s93, s35
s_lshr_b32 s93, s35, 1
s_waitcnt vmcnt(20)
s_waitcnt lgkmcnt(8)
v_mfma_f32_16x16x32_bf16 v[8:11], a[144:147], a[64:67], v[8:11]
ds_read_b64_tr_b16 a[176:177], v234 offset:24576
s_lshl2_add_u32 s93, s93, s92
v_mfma_f32_16x16x32_bf16 v[40:43], a[144:147], a[68:71], v[40:43]
ds_read_b64_tr_b16 a[178:179], v234 offset:28672
s_and_b32 s94, s35, 1
v_mfma_f32_16x16x32_bf16 v[72:75], a[144:147], a[72:75], v[72:75]
s_add_u32 s28, s28, 1024
s_cmp_lt_u32 s28, s6
s_cselect_b32 s28, s28, s4
v_mfma_f32_16x16x32_bf16 v[104:107], a[144:147], a[76:79], v[104:107]
ds_read_b64_tr_b16 a[180:181], v234 offset:24584
s_lshl1_add_u32 s93, s93, s94
v_mfma_f32_16x16x32_bf16 v[108:111], a[148:151], a[76:79], v[108:111]
ds_read_b64_tr_b16 a[182:183], v234 offset:28680
v_mfma_f32_16x16x32_bf16 v[76:79], a[148:151], a[72:75], v[76:79]
buffer_load_dwordx4 a[0:3], v240, s[20:23], s28 offen sc0 sc1
v_mfma_f32_16x16x32_bf16 v[44:47], a[148:151], a[68:71], v[44:47]
ds_read_b64_tr_b16 a[184:185], v235 offset:24576
v_mfma_f32_16x16x32_bf16 v[12:15], a[148:151], a[64:67], v[12:15]
ds_read_b64_tr_b16 a[186:187], v235 offset:28672
v_mfma_f32_16x16x32_bf16 v[16:19], a[152:155], a[64:67], v[16:19]
buffer_load_dwordx4 a[4:7], v241, s[20:23], s28 offen sc0 sc1
v_mfma_f32_16x16x32_bf16 v[48:51], a[152:155], a[68:71], v[48:51]
ds_read_b64_tr_b16 a[188:189], v235 offset:24584
v_mfma_f32_16x16x32_bf16 v[80:83], a[152:155], a[72:75], v[80:83]
ds_read_b64_tr_b16 a[190:191], v235 offset:28680
v_mfma_f32_16x16x32_bf16 v[112:115], a[152:155], a[76:79], v[112:115]
buffer_load_dwordx4 a[8:11], v242, s[20:23], s28 offen sc0 sc1
v_mfma_f32_16x16x32_bf16 v[116:119], a[156:159], a[76:79], v[116:119]
ds_read_b64_tr_b16 a[192:193], v236 offset:24576
v_mfma_f32_16x16x32_bf16 v[84:87], a[156:159], a[72:75], v[84:87]
buffer_load_dwordx4 a[12:15], v243, s[20:23], s28 offen sc0 sc1
v_mfma_f32_16x16x32_bf16 v[52:55], a[156:159], a[68:71], v[52:55]
ds_read_b64_tr_b16 a[194:195], v236 offset:28672
s_add_u32 s32, s7, 0
v_mfma_f32_16x16x32_bf16 v[20:23], a[156:159], a[64:67], v[20:23]
ds_read_b64_tr_b16 a[196:197], v236 offset:24584
s_waitcnt lgkmcnt(8)
v_mfma_f32_16x16x32_bf16 v[24:27], a[160:163], a[64:67], v[24:27]
s_add_u32 m0, s30, 81920
v_mfma_f32_16x16x32_bf16 v[56:59], a[160:163], a[68:71], v[56:59]
ds_read_b64_tr_b16 a[198:199], v236 offset:28680
v_mfma_f32_16x16x32_bf16 v[88:91], a[160:163], a[72:75], v[88:91]
ds_read_b64_tr_b16 a[200:201], v237 offset:24576
v_mfma_f32_16x16x32_bf16 v[120:123], a[160:163], a[76:79], v[120:123]
buffer_load_dwordx4 v228, s[8:11], s32 offen offset:0  lds
v_mfma_f32_16x16x32_bf16 v[124:127], a[164:167], a[76:79], v[124:127]
ds_read_b64_tr_b16 a[202:203], v237 offset:28672
v_mfma_f32_16x16x32_bf16 v[92:95], a[164:167], a[72:75], v[92:95]
ds_read_b64_tr_b16 a[204:205], v237 offset:24584
v_mfma_f32_16x16x32_bf16 v[60:63], a[164:167], a[68:71], v[60:63]
buffer_load_dwordx4 v229, s[8:11], s32 offen offset:1024  lds
v_mfma_f32_16x16x32_bf16 v[28:31], a[164:167], a[64:67], v[28:31]
ds_read_b64_tr_b16 a[206:207], v237 offset:28680
v_mfma_f32_16x16x32_bf16 v[32:35], a[168:171], a[64:67], v[32:35]
buffer_load_dwordx4 v230, s[8:11], s32 offen offset:2048  lds
v_mfma_f32_16x16x32_bf16 v[64:67], a[168:171], a[68:71], v[64:67]
s_cmp_lt_u32 s92, 4
s_cselect_b32 s40, s93, s40
v_mfma_f32_16x16x32_bf16 v[96:99], a[168:171], a[72:75], v[96:99]
s_mov_b32 s92, s40
s_lshl_b32 s84, s92, 6
v_mfma_f32_16x16x32_bf16 v[128:131], a[168:171], a[76:79], v[128:131]
buffer_load_dwordx4 v231, s[8:11], s32 offen offset:3072  lds
v_mfma_f32_16x16x32_bf16 v[132:135], a[172:175], a[76:79], v[132:135]
s_mul_i32 s93, s37, 147456
s_add_u32 s84, s84, s93
v_mfma_f32_16x16x32_bf16 v[100:103], a[172:175], a[72:75], v[100:103]
s_mul_i32 s85, s92, 36864
s_add_u32 s85, s85, s31
v_mfma_f32_16x16x32_bf16 v[68:71], a[172:175], a[68:71], v[68:71]
s_cmp_lt_u32 s40, 144
s_cselect_b32 s86, s31, 0x30000
s_cselect_b32 s84, s84, 0x40000000
s_cselect_b32 s85, s85, 0x40000000
v_mfma_f32_16x16x32_bf16 v[36:39], a[172:175], a[64:67], v[36:39]
s_waitcnt vmcnt(22)
v_mfma_f32_16x16x32_bf16 v[8:11], a[176:179], a[80:83], v[8:11]
ds_read_b64_tr_b16 a[144:145], v234 offset:32768
v_mfma_f32_16x16x32_bf16 v[40:43], a[176:179], a[84:87], v[40:43]
ds_read_b64_tr_b16 a[146:147], v234 offset:36864
v_mfma_f32_16x16x32_bf16 v[72:75], a[176:179], a[88:91], v[72:75]
s_add_u32 s28, s28, 1024
s_cmp_lt_u32 s28, s6
s_cselect_b32 s28, s28, s4
v_mfma_f32_16x16x32_bf16 v[104:107], a[176:179], a[92:95], v[104:107]
ds_read_b64_tr_b16 a[148:149], v234 offset:32776
s_waitcnt lgkmcnt(8)
v_mfma_f32_16x16x32_bf16 v[108:111], a[180:183], a[92:95], v[108:111]
ds_read_b64_tr_b16 a[150:151], v234 offset:36872
v_mfma_f32_16x16x32_bf16 v[76:79], a[180:183], a[88:91], v[76:79]
v_mfma_f32_16x16x32_bf16 v[44:47], a[180:183], a[84:87], v[44:47]
ds_read_b64_tr_b16 a[152:153], v235 offset:32768
v_mfma_f32_16x16x32_bf16 v[12:15], a[180:183], a[80:83], v[12:15]
ds_read_b64_tr_b16 a[154:155], v235 offset:36864
v_mfma_f32_16x16x32_bf16 v[16:19], a[184:187], a[80:83], v[16:19]
buffer_load_dwordx4 a[16:19], v240, s[20:23], s28 offen sc0 sc1
v_mfma_f32_16x16x32_bf16 v[48:51], a[184:187], a[84:87], v[48:51]
ds_read_b64_tr_b16 a[156:157], v235 offset:32776
v_mfma_f32_16x16x32_bf16 v[80:83], a[184:187], a[88:91], v[80:83]
ds_read_b64_tr_b16 a[158:159], v235 offset:36872
v_mfma_f32_16x16x32_bf16 v[112:115], a[184:187], a[92:95], v[112:115]
v_mfma_f32_16x16x32_bf16 v[116:119], a[188:191], a[92:95], v[116:119]
ds_read_b64_tr_b16 a[160:161], v236 offset:32768
v_mfma_f32_16x16x32_bf16 v[84:87], a[188:191], a[88:91], v[84:87]
buffer_load_dwordx4 a[20:23], v241, s[20:23], s28 offen sc0 sc1
v_mfma_f32_16x16x32_bf16 v[52:55], a[188:191], a[84:87], v[52:55]
ds_read_b64_tr_b16 a[162:163], v236 offset:36864
v_mfma_f32_16x16x32_bf16 v[20:23], a[188:191], a[80:83], v[20:23]
ds_read_b64_tr_b16 a[164:165], v236 offset:32776
v_mfma_f32_16x16x32_bf16 v[24:27], a[192:195], a[80:83], v[24:27]
v_mfma_f32_16x16x32_bf16 v[56:59], a[192:195], a[84:87], v[56:59]
ds_read_b64_tr_b16 a[166:167], v236 offset:36872
v_mfma_f32_16x16x32_bf16 v[88:91], a[192:195], a[88:91], v[88:91]
ds_read_b64_tr_b16 a[168:169], v237 offset:32768
v_mfma_f32_16x16x32_bf16 v[120:123], a[192:195], a[92:95], v[120:123]
buffer_load_dwordx4 a[24:27], v242, s[20:23], s28 offen sc0 sc1
s_waitcnt lgkmcnt(8)
v_mfma_f32_16x16x32_bf16 v[124:127], a[196:199], a[92:95], v[124:127]
ds_read_b64_tr_b16 a[170:171], v237 offset:36864
v_mfma_f32_16x16x32_bf16 v[92:95], a[196:199], a[88:91], v[92:95]
ds_read_b64_tr_b16 a[172:173], v237 offset:32776
v_mfma_f32_16x16x32_bf16 v[60:63], a[196:199], a[84:87], v[60:63]
v_lshlrev_b32 v136, 3, v1
v_mov_b32 v137, 0x7ffffff0
v_mfma_f32_16x16x32_bf16 v[28:31], a[196:199], a[80:83], v[28:31]
ds_read_b64_tr_b16 a[174:175], v237 offset:36872
v_mfma_f32_16x16x32_bf16 v[32:35], a[200:203], a[80:83], v[32:35]
buffer_load_dwordx4 a[28:31], v243, s[20:23], s28 offen sc0 sc1
v_mfma_f32_16x16x32_bf16 v[64:67], a[200:203], a[84:87], v[64:67]
v_cmp_lt_u32 vcc, 7, v1
v_mov_b32 v143, s47
v_mfma_f32_16x16x32_bf16 v[96:99], a[200:203], a[88:91], v[96:99]
v_mfma_f32_16x16x32_bf16 v[128:131], a[200:203], a[92:95], v[128:131]
v_cndmask_b32 v136, v136, v137, vcc
v_mfma_f32_16x16x32_bf16 v[132:135], a[204:207], a[92:95], v[132:135]
s_lshl_b32 s29, s36, 6
s_add_u32 s29, s29, 0x242000
v_mfma_f32_16x16x32_bf16 v[100:103], a[204:207], a[88:91], v[100:103]
s_add_u32 s50, s35, s37
s_cmp_eq_u32 s50, 0
s_cselect_b32 s29, s29, 0x7ffffff0
v_mfma_f32_16x16x32_bf16 v[68:71], a[204:207], a[84:87], v[68:71]
v_mfma_f32_16x16x32_bf16 v[36:39], a[204:207], a[80:83], v[36:39]
s_waitcnt vmcnt(20)
v_mfma_f32_16x16x32_bf16 v[8:11], a[144:147], a[96:99], v[8:11]
v_mfma_f32_16x16x32_bf16 v[40:43], a[144:147], a[100:103], v[40:43]
s_waitcnt vmcnt(12) lgkmcnt(0)
s_barrier
v_mfma_f32_16x16x32_bf16 v[72:75], a[144:147], a[104:107], v[72:75]
ds_read_b64_tr_b16 a[176:177], v234 offset:40960
s_add_u32 s32, s7, 16384
v_mfma_f32_16x16x32_bf16 v[104:107], a[144:147], a[108:111], v[104:107]
ds_read_b64_tr_b16 a[178:179], v234 offset:45056
v_mfma_f32_16x16x32_bf16 v[108:111], a[148:151], a[108:111], v[108:111]
ds_read_b64_tr_b16 a[180:181], v234 offset:40968
v_mfma_f32_16x16x32_bf16 v[76:79], a[148:151], a[104:107], v[76:79]
buffer_store_dwordx2 v[142:143], v136, s[20:23], s29 offen sc0 sc1
v_mfma_f32_16x16x32_bf16 v[44:47], a[148:151], a[100:103], v[44:47]
ds_read_b64_tr_b16 a[182:183], v234 offset:45064
s_add_u32 m0, s30, 114688
v_mfma_f32_16x16x32_bf16 v[12:15], a[148:151], a[96:99], v[12:15]
ds_read_b64_tr_b16 a[184:185], v235 offset:40960
v_mfma_f32_16x16x32_bf16 v[16:19], a[152:155], a[96:99], v[16:19]
buffer_store_dword v171, v170, s[20:23], 0 offen sc0 sc1
v_mfma_f32_16x16x32_bf16 v[48:51], a[152:155], a[100:103], v[48:51]
ds_read_b64_tr_b16 a[186:187], v235 offset:45056
ds_read_b128 v[152:155], v178
v_mfma_f32_16x16x32_bf16 v[80:83], a[152:155], a[104:107], v[80:83]
ds_read_b64_tr_b16 a[188:189], v235 offset:40968
ds_read_b128 v[156:159], v179
v_mfma_f32_16x16x32_bf16 v[112:115], a[152:155], a[108:111], v[112:115]
buffer_load_dwordx4 v228, s[8:11], s32 offen offset:0  lds
v_mfma_f32_16x16x32_bf16 v[116:119], a[156:159], a[108:111], v[116:119]
ds_read_b64_tr_b16 a[190:191], v235 offset:45064
ds_read_b128 v[160:163], v180
v_mfma_f32_16x16x32_bf16 v[84:87], a[156:159], a[104:107], v[84:87]
ds_read_b64_tr_b16 a[192:193], v236 offset:40960
v_mfma_f32_16x16x32_bf16 v[52:55], a[156:159], a[100:103], v[52:55]
ds_read_b64_tr_b16 a[194:195], v236 offset:45056
v_mfma_f32_16x16x32_bf16 v[20:23], a[156:159], a[96:99], v[20:23]
s_mul_i32 s45, s3, 1152
s_add_u32 s45, s45, s31
v_mfma_f32_16x16x32_bf16 v[24:27], a[160:163], a[96:99], v[24:27]
ds_read_b64_tr_b16 a[196:197], v236 offset:40968
s_add_u32 s45, s45, 0x1c00000
v_mfma_f32_16x16x32_bf16 v[56:59], a[160:163], a[100:103], v[56:59]
ds_read_b64_tr_b16 a[198:199], v236 offset:45064
v_mfma_f32_16x16x32_bf16 v[88:91], a[160:163], a[104:107], v[88:91]
buffer_load_dwordx4 v229, s[8:11], s32 offen offset:1024  lds
v_mfma_f32_16x16x32_bf16 v[120:123], a[160:163], a[108:111], v[120:123]
ds_read_b64_tr_b16 a[200:201], v237 offset:40960
v_mfma_f32_16x16x32_bf16 v[124:127], a[164:167], a[108:111], v[124:127]
ds_read_b64_tr_b16 a[202:203], v237 offset:45056
v_mfma_f32_16x16x32_bf16 v[92:95], a[164:167], a[104:107], v[92:95]
buffer_load_dwordx4 v230, s[8:11], s32 offen offset:2048  lds
v_mfma_f32_16x16x32_bf16 v[60:63], a[164:167], a[100:103], v[60:63]
ds_read_b64_tr_b16 a[204:205], v237 offset:40968
v_mfma_f32_16x16x32_bf16 v[28:31], a[164:167], a[96:99], v[28:31]
ds_read_b64_tr_b16 a[206:207], v237 offset:45064
v_mfma_f32_16x16x32_bf16 v[32:35], a[168:171], a[96:99], v[32:35]
s_waitcnt lgkmcnt(8)
buffer_store_dwordx4 v[152:155], v244, s[20:23], s45 offen sc0 sc1
v_mfma_f32_16x16x32_bf16 v[64:67], a[168:171], a[100:103], v[64:67]
buffer_load_dwordx4 v231, s[8:11], s32 offen offset:3072  lds
v_mfma_f32_16x16x32_bf16 v[96:99], a[168:171], a[104:107], v[96:99]
v_mfma_f32_16x16x32_bf16 v[128:131], a[168:171], a[108:111], v[128:131]
v_mfma_f32_16x16x32_bf16 v[132:135], a[172:175], a[108:111], v[132:135]
v_mfma_f32_16x16x32_bf16 v[100:103], a[172:175], a[104:107], v[100:103]
v_mfma_f32_16x16x32_bf16 v[68:71], a[172:175], a[100:103], v[68:71]
s_add_u32 s45, s45, 4096
buffer_store_dwordx4 v[156:159], v244, s[20:23], s45 offen sc0 sc1
v_mfma_f32_16x16x32_bf16 v[36:39], a[172:175], a[96:99], v[36:39]
s_waitcnt vmcnt(22)
v_mfma_f32_16x16x32_bf16 v[8:11], a[176:179], a[112:115], v[8:11]
ds_read_b64_tr_b16 a[144:145], v234 offset:49152
v_mfma_f32_16x16x32_bf16 v[40:43], a[176:179], a[116:119], v[40:43]
ds_read_b64_tr_b16 a[146:147], v234 offset:53248
v_mfma_f32_16x16x32_bf16 v[72:75], a[176:179], a[120:123], v[72:75]
v_mfma_f32_16x16x32_bf16 v[104:107], a[176:179], a[124:127], v[104:107]
ds_read_b64_tr_b16 a[148:149], v234 offset:49160
v_mfma_f32_16x16x32_bf16 v[108:111], a[180:183], a[124:127], v[108:111]
ds_read_b64_tr_b16 a[150:151], v234 offset:53256
v_mfma_f32_16x16x32_bf16 v[76:79], a[180:183], a[120:123], v[76:79]
s_add_u32 s45, s45, 4096
s_cmp_eq_u32 s37, 0
s_cselect_b32 s45, s45, 0x7ffffff0
buffer_store_dwordx4 v[160:163], v244, s[20:23], s45 offen sc0 sc1
v_mfma_f32_16x16x32_bf16 v[44:47], a[180:183], a[116:119], v[44:47]
ds_read_b64_tr_b16 a[152:153], v235 offset:49152
s_mul_i32 s88, s37, 864
v_mfma_f32_16x16x32_bf16 v[12:15], a[180:183], a[112:115], v[12:15]
ds_read_b64_tr_b16 a[154:155], v235 offset:53248
s_mov_b32 s87, s88
v_mfma_f32_16x16x32_bf16 v[16:19], a[184:187], a[112:115], v[16:19]
v_accvgpr_write_b32 a128, 0
v_accvgpr_write_b32 a129, 0
v_mfma_f32_16x16x32_bf16 v[48:51], a[184:187], a[116:119], v[48:51]
ds_read_b64_tr_b16 a[156:157], v235 offset:49160
v_accvgpr_write_b32 a130, 0
v_mfma_f32_16x16x32_bf16 v[80:83], a[184:187], a[120:123], v[80:83]
ds_read_b64_tr_b16 a[158:159], v235 offset:53256
v_accvgpr_write_b32 a131, 0
v_mfma_f32_16x16x32_bf16 v[112:115], a[184:187], a[124:127], v[112:115]
v_accvgpr_write_b32 a132, 0
v_accvgpr_write_b32 a133, 0
v_mfma_f32_16x16x32_bf16 v[116:119], a[188:191], a[124:127], v[116:119]
ds_read_b64_tr_b16 a[160:161], v236 offset:49152
v_accvgpr_write_b32 a134, 0
v_mfma_f32_16x16x32_bf16 v[84:87], a[188:191], a[120:123], v[84:87]
v_accvgpr_write_b32 a135, 0
v_lshrrev_b32 v240, 2, v1
v_mfma_f32_16x16x32_bf16 v[52:55], a[188:191], a[116:119], v[52:55]
ds_read_b64_tr_b16 a[162:163], v236 offset:53248
v_mul_u32_u24 v240, 0x2400, v240
v_mfma_f32_16x16x32_bf16 v[20:23], a[188:191], a[112:115], v[20:23]
ds_read_b64_tr_b16 a[164:165], v236 offset:49160
v_and_b32 v246, 3, v1
s_waitcnt lgkmcnt(8)
v_mfma_f32_16x16x32_bf16 v[24:27], a[192:195], a[112:115], v[24:27]
v_lshl_add_u32 v240, v246, 4, v240
v_mul_u32_u24 v243, 3641, v1
v_mfma_f32_16x16x32_bf16 v[56:59], a[192:195], a[116:119], v[56:59]
ds_read_b64_tr_b16 a[166:167], v236 offset:53256
v_lshrrev_b32 v243, 16, v243
v_mfma_f32_16x16x32_bf16 v[88:91], a[192:195], a[120:123], v[88:91]
ds_read_b64_tr_b16 a[168:169], v237 offset:49152
v_mul_u32_u24 v243, 864, v243
v_mfma_f32_16x16x32_bf16 v[120:123], a[192:195], a[124:127], v[120:123]
v_add_u32 v243, v243, v244
v_mfma_f32_16x16x32_bf16 v[124:127], a[196:199], a[124:127], v[124:127]
ds_read_b64_tr_b16 a[170:171], v237 offset:53248
s_sub_u32 s92, s40, 0
v_mfma_f32_16x16x32_bf16 v[92:95], a[196:199], a[120:123], v[92:95]
ds_read_b64_tr_b16 a[172:173], v237 offset:49160
v_mfma_f32_16x16x32_bf16 v[60:63], a[196:199], a[116:119], v[60:63]
s_cmp_lt_u32 s92, 72
s_cselect_b32 s3, 4, 0
v_mfma_f32_16x16x32_bf16 v[28:31], a[196:199], a[112:115], v[28:31]
ds_read_b64_tr_b16 a[174:175], v237 offset:53256
v_mfma_f32_16x16x32_bf16 v[32:35], a[200:203], a[112:115], v[32:35]
s_cmp_lt_u32 s40, 144
s_cselect_b32 s3, 5, s3
v_mfma_f32_16x16x32_bf16 v[64:67], a[200:203], a[116:119], v[64:67]
v_mfma_f32_16x16x32_bf16 v[96:99], a[200:203], a[120:123], v[96:99]
v_mfma_f32_16x16x32_bf16 v[128:131], a[200:203], a[124:127], v[128:131]
v_mfma_f32_16x16x32_bf16 v[132:135], a[204:207], a[124:127], v[132:135]
v_mfma_f32_16x16x32_bf16 v[100:103], a[204:207], a[120:123], v[100:103]
v_mfma_f32_16x16x32_bf16 v[68:71], a[204:207], a[116:119], v[68:71]
v_mfma_f32_16x16x32_bf16 v[36:39], a[204:207], a[112:115], v[36:39]
s_waitcnt vmcnt(17)
v_mfma_f32_16x16x32_bf16 v[8:11], a[144:147], a[0:3], v[8:11]
ds_read_b64_tr_b16 a[176:177], v234 offset:57344
s_add_u32 s39, s7, 0
v_mfma_f32_16x16x32_bf16 v[40:43], a[144:147], a[4:7], v[40:43]
ds_read_b64_tr_b16 a[178:179], v234 offset:61440
v_mfma_f32_16x16x32_bf16 v[72:75], a[144:147], a[8:11], v[72:75]
v_mfma_f32_16x16x32_bf16 v[104:107], a[144:147], a[12:15], v[104:107]
ds_read_b64_tr_b16 a[180:181], v234 offset:57352
s_waitcnt lgkmcnt(8)
v_mfma_f32_16x16x32_bf16 v[108:111], a[148:151], a[12:15], v[108:111]
ds_read_b64_tr_b16 a[182:183], v234 offset:61448
v_mfma_f32_16x16x32_bf16 v[76:79], a[148:151], a[8:11], v[76:79]
s_add_u32 m0, s30, 131072
v_mfma_f32_16x16x32_bf16 v[44:47], a[148:151], a[4:7], v[44:47]
ds_read_b64_tr_b16 a[184:185], v235 offset:57344
v_mfma_f32_16x16x32_bf16 v[12:15], a[148:151], a[0:3], v[12:15]
ds_read_b64_tr_b16 a[186:187], v235 offset:61440
v_mfma_f32_16x16x32_bf16 v[16:19], a[152:155], a[0:3], v[16:19]
v_mfma_f32_16x16x32_bf16 v[48:51], a[152:155], a[4:7], v[48:51]
ds_read_b64_tr_b16 a[188:189], v235 offset:57352
v_mfma_f32_16x16x32_bf16 v[80:83], a[152:155], a[8:11], v[80:83]
ds_read_b64_tr_b16 a[190:191], v235 offset:61448
v_mfma_f32_16x16x32_bf16 v[112:115], a[152:155], a[12:15], v[112:115]
buffer_load_dwordx4 v232, s[12:15], s39 offen offset:0  lds
v_mfma_f32_16x16x32_bf16 v[116:119], a[156:159], a[12:15], v[116:119]
ds_read_b64_tr_b16 a[192:193], v236 offset:57344
v_mfma_f32_16x16x32_bf16 v[84:87], a[156:159], a[8:11], v[84:87]
v_mfma_f32_16x16x32_bf16 v[52:55], a[156:159], a[4:7], v[52:55]
ds_read_b64_tr_b16 a[194:195], v236 offset:61440
v_mfma_f32_16x16x32_bf16 v[20:23], a[156:159], a[0:3], v[20:23]
ds_read_b64_tr_b16 a[196:197], v236 offset:57352
v_mfma_f32_16x16x32_bf16 v[24:27], a[160:163], a[0:3], v[24:27]
buffer_load_dwordx4 v233, s[12:15], s39 offen offset:1024  lds
v_mfma_f32_16x16x32_bf16 v[56:59], a[160:163], a[4:7], v[56:59]
ds_read_b64_tr_b16 a[198:199], v236 offset:61448
v_mfma_f32_16x16x32_bf16 v[88:91], a[160:163], a[8:11], v[88:91]
ds_read_b64_tr_b16 a[200:201], v237 offset:57344
v_mfma_f32_16x16x32_bf16 v[120:123], a[160:163], a[12:15], v[120:123]
s_waitcnt lgkmcnt(8)
v_mfma_f32_16x16x32_bf16 v[124:127], a[164:167], a[12:15], v[124:127]
ds_read_b64_tr_b16 a[202:203], v237 offset:61440
v_mfma_f32_16x16x32_bf16 v[92:95], a[164:167], a[8:11], v[92:95]
ds_read_b64_tr_b16 a[204:205], v237 offset:57352
v_mfma_f32_16x16x32_bf16 v[60:63], a[164:167], a[4:7], v[60:63]
buffer_load_dwordx4 v232, s[12:15], s39 offen offset:2048  lds
v_mfma_f32_16x16x32_bf16 v[28:31], a[164:167], a[0:3], v[28:31]
ds_read_b64_tr_b16 a[206:207], v237 offset:61448
v_mfma_f32_16x16x32_bf16 v[32:35], a[168:171], a[0:3], v[32:35]
v_mfma_f32_16x16x32_bf16 v[64:67], a[168:171], a[4:7], v[64:67]
buffer_load_dwordx4 v233, s[12:15], s39 offen offset:3072  lds
v_mfma_f32_16x16x32_bf16 v[96:99], a[168:171], a[8:11], v[96:99]
v_mfma_f32_16x16x32_bf16 v[128:131], a[168:171], a[12:15], v[128:131]
v_mfma_f32_16x16x32_bf16 v[132:135], a[172:175], a[12:15], v[132:135]
v_mfma_f32_16x16x32_bf16 v[100:103], a[172:175], a[8:11], v[100:103]
v_mfma_f32_16x16x32_bf16 v[68:71], a[172:175], a[4:7], v[68:71]
v_mfma_f32_16x16x32_bf16 v[36:39], a[172:175], a[0:3], v[36:39]
s_waitcnt vmcnt(13)
v_mfma_f32_16x16x32_bf16 v[8:11], a[176:179], a[16:19], v[8:11]
v_mfma_f32_16x16x32_bf16 v[12:15], a[180:183], a[16:19], v[12:15]
s_waitcnt vmcnt(17) lgkmcnt(0)
s_barrier
v_mfma_f32_16x16x32_bf16 v[16:19], a[184:187], a[16:19], v[16:19]
ds_read_b128 a[144:147], v216 offset:16384
ds_read_b128 a[148:151], v217 offset:16384
v_mfma_f32_16x16x32_bf16 v[20:23], a[188:191], a[16:19], v[20:23]
ds_read_b128 a[152:155], v218 offset:16384
ds_read_b128 a[156:159], v219 offset:16384
v_mfma_f32_16x16x32_bf16 v[24:27], a[192:195], a[16:19], v[24:27]
ds_read_b128 a[160:163], v216 offset:20480
ds_read_b128 a[164:167], v217 offset:20480
v_mfma_f32_16x16x32_bf16 v[28:31], a[196:199], a[16:19], v[28:31]
ds_read_b128 a[168:171], v218 offset:20480
ds_read_b128 a[172:175], v219 offset:20480
v_mfma_f32_16x16x32_bf16 v[32:35], a[200:203], a[16:19], v[32:35]
s_add_u32 s32, s7, 32768
v_mfma_f32_16x16x32_bf16 v[36:39], a[204:207], a[16:19], v[36:39]
s_add_u32 m0, s30, 65536
v_mfma_f32_16x16x32_bf16 v[40:43], a[176:179], a[20:23], v[40:43]
v_cvt_pk_bf16_f32 v152, v8, v9
v_cvt_pk_bf16_f32 v153, v10, v11
v_mfma_f32_16x16x32_bf16 v[44:47], a[180:183], a[20:23], v[44:47]
v_cvt_pk_bf16_f32 v154, v12, v13
v_cvt_pk_bf16_f32 v155, v14, v15
v_mfma_f32_16x16x32_bf16 v[48:51], a[184:187], a[20:23], v[48:51]
v_cvt_pk_bf16_f32 v156, v16, v17
v_cvt_pk_bf16_f32 v157, v18, v19
v_mfma_f32_16x16x32_bf16 v[52:55], a[188:191], a[20:23], v[52:55]
v_cvt_pk_bf16_f32 v158, v20, v21
v_cvt_pk_bf16_f32 v159, v22, v23
v_mfma_f32_16x16x32_bf16 v[56:59], a[192:195], a[20:23], v[56:59]
v_cvt_pk_bf16_f32 v160, v24, v25
v_cvt_pk_bf16_f32 v161, v26, v27
v_mfma_f32_16x16x32_bf16 v[60:63], a[196:199], a[20:23], v[60:63]
v_cvt_pk_bf16_f32 v162, v28, v29
v_cvt_pk_bf16_f32 v163, v30, v31
v_mfma_f32_16x16x32_bf16 v[64:67], a[200:203], a[20:23], v[64:67]
v_cvt_pk_bf16_f32 v164, v32, v33
v_cvt_pk_bf16_f32 v165, v34, v35
v_mfma_f32_16x16x32_bf16 v[68:71], a[204:207], a[20:23], v[68:71]
v_cvt_pk_bf16_f32 v166, v36, v37
v_cvt_pk_bf16_f32 v167, v38, v39
v_mfma_f32_16x16x32_bf16 v[72:75], a[176:179], a[24:27], v[72:75]
v_cvt_pk_bf16_f32 v168, v40, v41
v_cvt_pk_bf16_f32 v169, v42, v43
v_mfma_f32_16x16x32_bf16 v[76:79], a[180:183], a[24:27], v[76:79]
v_cvt_pk_bf16_f32 v170, v44, v45
v_cvt_pk_bf16_f32 v171, v46, v47
v_mfma_f32_16x16x32_bf16 v[80:83], a[184:187], a[24:27], v[80:83]
v_cvt_pk_bf16_f32 v172, v48, v49
v_cvt_pk_bf16_f32 v173, v50, v51
v_mfma_f32_16x16x32_bf16 v[84:87], a[188:191], a[24:27], v[84:87]
v_cvt_pk_bf16_f32 v174, v52, v53
v_cvt_pk_bf16_f32 v175, v54, v55
v_mfma_f32_16x16x32_bf16 v[88:91], a[192:195], a[24:27], v[88:91]
v_cvt_pk_bf16_f32 v176, v56, v57
v_cvt_pk_bf16_f32 v177, v58, v59
v_mfma_f32_16x16x32_bf16 v[92:95], a[196:199], a[24:27], v[92:95]
v_cvt_pk_bf16_f32 v178, v60, v61
v_cvt_pk_bf16_f32 v179, v62, v63
v_mfma_f32_16x16x32_bf16 v[96:99], a[200:203], a[24:27], v[96:99]
v_cvt_pk_bf16_f32 v180, v64, v65
v_cvt_pk_bf16_f32 v181, v66, v67
v_mfma_f32_16x16x32_bf16 v[100:103], a[204:207], a[24:27], v[100:103]
v_cvt_pk_bf16_f32 v182, v68, v69
v_cvt_pk_bf16_f32 v183, v70, v71
v_mfma_f32_16x16x32_bf16 v[104:107], a[176:179], a[28:31], v[104:107]
v_cvt_pk_bf16_f32 v184, v72, v73
v_cvt_pk_bf16_f32 v185, v74, v75
v_mfma_f32_16x16x32_bf16 v[108:111], a[180:183], a[28:31], v[108:111]
v_cvt_pk_bf16_f32 v186, v76, v77
v_cvt_pk_bf16_f32 v187, v78, v79
v_mfma_f32_16x16x32_bf16 v[112:115], a[184:187], a[28:31], v[112:115]
v_cvt_pk_bf16_f32 v188, v80, v81
v_cvt_pk_bf16_f32 v189, v82, v83
v_mfma_f32_16x16x32_bf16 v[116:119], a[188:191], a[28:31], v[116:119]
v_cvt_pk_bf16_f32 v190, v84, v85
v_cvt_pk_bf16_f32 v191, v86, v87
v_mfma_f32_16x16x32_bf16 v[120:123], a[192:195], a[28:31], v[120:123]
v_cvt_pk_bf16_f32 v192, v88, v89
v_cvt_pk_bf16_f32 v193, v90, v91
v_mfma_f32_16x16x32_bf16 v[124:127], a[196:199], a[28:31], v[124:127]
v_cvt_pk_bf16_f32 v194, v92, v93
v_cvt_pk_bf16_f32 v195, v94, v95
v_mfma_f32_16x16x32_bf16 v[128:131], a[200:203], a[28:31], v[128:131]
v_cvt_pk_bf16_f32 v196, v96, v97
v_cvt_pk_bf16_f32 v197, v98, v99
v_mfma_f32_16x16x32_bf16 v[132:135], a[204:207], a[28:31], v[132:135]
v_cvt_pk_bf16_f32 v198, v100, v101
v_cvt_pk_bf16_f32 v199, v102, v103
s_waitcnt lgkmcnt(7)
v_mfma_f32_16x16x32_bf16 v[8:11], a[144:147], v[152:155], 0
v_cvt_pk_bf16_f32 v200, v104, v105
v_cvt_pk_bf16_f32 v201, v106, v107
s_waitcnt lgkmcnt(6)
v_mfma_f32_16x16x32_bf16 v[8:11], a[148:151], v[156:159], v[8:11]
v_cvt_pk_bf16_f32 v202, v108, v109
v_cvt_pk_bf16_f32 v203, v110, v111
s_waitcnt lgkmcnt(5)
v_mfma_f32_16x16x32_bf16 v[8:11], a[152:155], v[160:163], v[8:11]
v_cvt_pk_bf16_f32 v204, v112, v113
v_cvt_pk_bf16_f32 v205, v114, v115
s_waitcnt lgkmcnt(4)
v_mfma_f32_16x16x32_bf16 v[8:11], a[156:159], v[164:167], v[8:11]
v_cvt_pk_bf16_f32 v206, v116, v117
v_cvt_pk_bf16_f32 v207, v118, v119
s_waitcnt lgkmcnt(3)
v_mfma_f32_16x16x32_bf16 v[12:15], a[160:163], v[152:155], 0
v_cvt_pk_bf16_f32 v208, v120, v121
v_cvt_pk_bf16_f32 v209, v122, v123
s_waitcnt lgkmcnt(2)
v_mfma_f32_16x16x32_bf16 v[12:15], a[164:167], v[156:159], v[12:15]
v_cvt_pk_bf16_f32 v210, v124, v125
v_cvt_pk_bf16_f32 v211, v126, v127
s_waitcnt lgkmcnt(1)
v_mfma_f32_16x16x32_bf16 v[12:15], a[168:171], v[160:163], v[12:15]
v_cvt_pk_bf16_f32 v212, v128, v129
v_cvt_pk_bf16_f32 v213, v130, v131
s_waitcnt lgkmcnt(0)
v_mfma_f32_16x16x32_bf16 v[12:15], a[172:175], v[164:167], v[12:15]
v_cvt_pk_bf16_f32 v214, v132, v133
v_cvt_pk_bf16_f32 v215, v134, v135
v_mfma_f32_16x16x32_bf16 v[16:19], a[144:147], v[168:171], 0
buffer_load_dwordx4 v228, s[8:11], s32 offen offset:0  lds
v_mfma_f32_16x16x32_bf16 v[16:19], a[148:151], v[172:175], v[16:19]
buffer_load_dwordx4 v229, s[8:11], s32 offen offset:1024  lds
STUB_3:
STUB_A3:
s_cbranch_execz STUB_6
v_mfma_f32_16x16x32_bf16 v[16:19], a[152:155], v[176:179], v[16:19]
buffer_load_dwordx4 v230, s[8:11], s32 offen offset:2048  lds
v_mfma_f32_16x16x32_bf16 v[16:19], a[156:159], v[180:183], v[16:19]
buffer_load_dwordx4 v231, s[8:11], s32 offen offset:3072  lds
v_max3_f32 v248, v8, v9, v10
v_mfma_f32_16x16x32_bf16 v[20:23], a[160:163], v[168:171], 0
s_add_u32 s39, s7, 16384
s_add_u32 m0, s30, 147456
v_mfma_f32_16x16x32_bf16 v[20:23], a[164:167], v[172:175], v[20:23]
buffer_load_dwordx4 v232, s[12:15], s39 offen offset:0  lds
v_mfma_f32_16x16x32_bf16 v[20:23], a[168:171], v[176:179], v[20:23]
buffer_load_dwordx4 v233, s[12:15], s39 offen offset:1024  lds
v_mfma_f32_16x16x32_bf16 v[20:23], a[172:175], v[180:183], v[20:23]
v_max3_f32 v248, v248, v11, v12
v_max3_f32 v248, v248, v13, v14
v_mfma_f32_16x16x32_bf16 v[24:27], a[144:147], v[184:187], 0
v_max_f32 v248, v248, v15
v_mov_b32 v249, v248
v_mfma_f32_16x16x32_bf16 v[24:27], a[148:151], v[188:191], v[24:27]
s_nop 0
v_permlane16_swap_b32 v248, v249
v_mfma_f32_16x16x32_bf16 v[24:27], a[152:155], v[192:195], v[24:27]
v_max_f32 v248, v248, v249
v_mov_b32 v249, v248
v_mfma_f32_16x16x32_bf16 v[24:27], a[156:159], v[196:199], v[24:27]
s_nop 0
v_permlane32_swap_b32 v248, v249
v_mfma_f32_16x16x32_bf16 v[28:31], a[160:163], v[184:187], 0
v_max_f32 v248, v248, v249
v_sub_f32 v136, 0, v248
v_sub_f32 v137, 0, v248
v_mfma_f32_16x16x32_bf16 v[28:31], a[164:167], v[188:191], v[28:31]
v_sub_f32 v138, 0, v248
v_sub_f32 v139, 0, v248
v_sub_f32 v8, v8, v248
v_mfma_f32_16x16x32_bf16 v[28:31], a[168:171], v[192:195], v[28:31]
v_sub_f32 v9, v9, v248
v_sub_f32 v10, v10, v248
v_sub_f32 v11, v11, v248
v_mfma_f32_16x16x32_bf16 v[28:31], a[172:175], v[196:199], v[28:31]
v_sub_f32 v12, v12, v248
v_sub_f32 v13, v13, v248
v_sub_f32 v14, v14, v248
v_mfma_f32_16x16x32_bf16 v[32:35], a[144:147], v[200:203], 0
v_sub_f32 v15, v15, v248
v_max3_f32 v250, v16, v17, v18
v_max3_f32 v250, v250, v19, v20
v_mfma_f32_16x16x32_bf16 v[32:35], a[148:151], v[204:207], v[32:35]
v_max3_f32 v250, v250, v21, v22
v_max_f32 v250, v250, v23
v_mov_b32 v251, v250
v_mfma_f32_16x16x32_bf16 v[32:35], a[152:155], v[208:211], v[32:35]
s_nop 0
v_permlane16_swap_b32 v250, v251
v_max_f32 v250, v250, v251
v_mfma_f32_16x16x32_bf16 v[32:35], a[156:159], v[212:215], v[32:35]
v_mov_b32 v251, v250
s_nop 1
v_permlane32_swap_b32 v250, v251
v_mfma_f32_16x16x32_bf16 v[36:39], a[160:163], v[200:203], 0
v_max_f32 v250, v250, v251
v_sub_f32 v140, 0, v250
v_sub_f32 v141, 0, v250
v_mfma_f32_16x16x32_bf16 v[36:39], a[164:167], v[204:207], v[36:39]
v_sub_f32 v142, 0, v250
v_sub_f32 v143, 0, v250
v_sub_f32 v16, v16, v250
v_mfma_f32_16x16x32_bf16 v[36:39], a[168:171], v[208:211], v[36:39]
v_sub_f32 v17, v17, v250
v_sub_f32 v18, v18, v250
v_sub_f32 v19, v19, v250
v_mfma_f32_16x16x32_bf16 v[36:39], a[172:175], v[212:215], v[36:39]
v_sub_f32 v20, v20, v250
v_sub_f32 v21, v21, v250
v_sub_f32 v22, v22, v250
ds_read_b128 a[144:147], v216 offset:24576
ds_read_b128 a[148:151], v217 offset:24576
ds_read_b128 a[152:155], v218 offset:24576
ds_read_b128 a[156:159], v219 offset:24576
ds_read_b128 a[160:163], v216 offset:28672
ds_read_b128 a[164:167], v217 offset:28672
ds_read_b128 a[168:171], v218 offset:28672
ds_read_b128 a[172:175], v219 offset:28672
buffer_load_dwordx4 v232, s[12:15], s39 offen offset:2048  lds
buffer_load_dwordx4 v233, s[12:15], s39 offen offset:3072  lds
s_add_u32 s32, s7, 32768
s_add_u32 s39, s7, 16384
v_sub_f32 v23, v23, v250
v_max3_f32 v248, v24, v25, v26
v_max3_f32 v248, v248, v27, v28
v_max3_f32 v248, v248, v29, v30
v_max_f32 v248, v248, v31
s_nop 3
v_max3_f32 v250, v32, v33, v34
v_max3_f32 v250, v250, v35, v36
v_max3_f32 v250, v250, v37, v38
v_max_f32 v250, v250, v39
v_mov_b32 v249, v248
v_mov_b32 v251, v250
s_nop 0
v_permlane16_swap_b32 v248, v249
v_permlane16_swap_b32 v250, v251
v_max_f32 v248, v248, v249
v_max_f32 v250, v250, v251
v_mov_b32 v249, v248
v_mov_b32 v251, v250
s_nop 0
v_permlane32_swap_b32 v248, v249
v_permlane32_swap_b32 v250, v251
v_max_f32 v248, v248, v249
v_max_f32 v250, v250, v251
v_sub_f32 v144, 0, v248
v_sub_f32 v148, 0, v250
v_sub_f32 v145, 0, v248
v_sub_f32 v149, 0, v250
v_sub_f32 v146, 0, v248
v_sub_f32 v150, 0, v250
v_sub_f32 v147, 0, v248
v_sub_f32 v151, 0, v250
v_sub_f32 v24, v24, v248
v_sub_f32 v32, v32, v250
v_sub_f32 v25, v25, v248
v_sub_f32 v33, v33, v250
v_sub_f32 v26, v26, v248
v_sub_f32 v34, v34, v250
v_sub_f32 v27, v27, v248
v_sub_f32 v35, v35, v250
v_sub_f32 v28, v28, v248
v_sub_f32 v36, v36, v250
v_sub_f32 v29, v29, v248
v_sub_f32 v37, v37, v250
v_sub_f32 v30, v30, v248
v_sub_f32 v38, v38, v250
v_sub_f32 v31, v31, v248
v_sub_f32 v39, v39, v250
K_BODY0:
s_waitcnt lgkmcnt(0)
v_mfma_f32_16x16x32_bf16 v[40:43], a[144:147], v[152:155], v[136:139]
v_exp_f32 v8, v8
v_exp_f32 v9, v9
v_mfma_f32_16x16x32_bf16 v[40:43], a[148:151], v[156:159], v[40:43]
v_cvt_pk_bf16_f32 v72, v8, v9
v_bfe_u32 v246, v1, 2, 2
v_exp_f32 v10, v10
v_mfma_f32_16x16x32_bf16 v[40:43], a[152:155], v[160:163], v[40:43]
v_lshl_add_u32 v241, v4, 3, v246
v_lshl_add_u32 v246, v4, 2, v246
v_exp_f32 v11, v11
v_mfma_f32_16x16x32_bf16 v[40:43], a[156:159], v[164:167], v[40:43]
v_cvt_pk_bf16_f32 v73, v10, v11
v_and_b32 v247, 3, v1
v_exp_f32 v12, v12
v_mfma_f32_16x16x32_bf16 v[48:51], a[156:159], v[180:183], v[140:143]
v_lshlrev_b32 v247, 3, v247
v_lshl_add_u32 v241, v241, 6, v247
v_exp_f32 v13, v13
v_mfma_f32_16x16x32_bf16 v[48:51], a[152:155], v[176:179], v[48:51]
s_and_b32 s28, s37, 1
v_cvt_pk_bf16_f32 v74, v12, v13
v_exp_f32 v14, v14
v_mfma_f32_16x16x32_bf16 v[48:51], a[148:151], v[172:175], v[48:51]
s_lshl_b32 s28, s28, 5
s_lshr_b32 s29, s37, 1
v_exp_f32 v15, v15
v_mfma_f32_16x16x32_bf16 v[48:51], a[144:147], v[168:171], v[48:51]
v_exp_f32 v16, v16
v_exp_f32 v17, v17
v_mfma_f32_16x16x32_bf16 v[56:59], a[144:147], v[184:187], v[144:147]
v_cvt_pk_bf16_f32 v75, v14, v15
v_cvt_pk_bf16_f32 v76, v16, v17
v_exp_f32 v18, v18
v_mfma_f32_16x16x32_bf16 v[56:59], a[148:151], v[188:191], v[56:59]
s_lshl_b32 s29, s29, 15
s_add_u32 s28, s28, s29
v_exp_f32 v19, v19
v_mfma_f32_16x16x32_bf16 v[56:59], a[152:155], v[192:195], v[56:59]
v_cvt_pk_bf16_f32 v77, v18, v19
v_add_u32 v241, s28, v241
v_exp_f32 v20, v20
v_mfma_f32_16x16x32_bf16 v[56:59], a[156:159], v[196:199], v[56:59]
v_mul_u32_u24 v242, 0x480, v246
v_add_u32 v242, v242, v247
v_exp_f32 v21, v21
v_mfma_f32_16x16x32_bf16 v[64:67], a[156:159], v[212:215], v[148:151]
s_waitcnt vmcnt(8) lgkmcnt(0)
s_barrier
v_exp_f32 v22, v22
v_mfma_f32_16x16x32_bf16 v[64:67], a[152:155], v[208:211], v[64:67]
ds_read_b64_tr_b16 a[176:177], v220 offset:32768
v_cvt_pk_bf16_f32 v78, v20, v21
v_exp_f32 v23, v23
v_mfma_f32_16x16x32_bf16 v[64:67], a[148:151], v[204:207], v[64:67]
v_exp_f32 v24, v24
v_exp_f32 v25, v25
v_mfma_f32_16x16x32_bf16 v[64:67], a[144:147], v[200:203], v[64:67]
v_cvt_pk_bf16_f32 v79, v22, v23
v_cvt_pk_bf16_f32 v80, v24, v25
v_exp_f32 v26, v26
v_mfma_f32_16x16x32_bf16 v[44:47], a[160:163], v[152:155], v[136:139]
ds_read_b64_tr_b16 a[178:179], v220 offset:36864
ds_read_b64_tr_b16 a[180:181], v221 offset:32768
v_exp_f32 v27, v27
v_mfma_f32_16x16x32_bf16 v[44:47], a[164:167], v[156:159], v[44:47]
ds_read_b64_tr_b16 a[182:183], v221 offset:36864
v_cvt_pk_bf16_f32 v81, v26, v27
v_exp_f32 v28, v28
v_mfma_f32_16x16x32_bf16 v[44:47], a[168:171], v[160:163], v[44:47]
ds_read_b64_tr_b16 a[184:185], v222 offset:32768
ds_read_b64_tr_b16 a[186:187], v222 offset:36864
v_exp_f32 v29, v29
v_mfma_f32_16x16x32_bf16 v[44:47], a[172:175], v[164:167], v[44:47]
ds_read_b64_tr_b16 a[188:189], v223 offset:32768
v_cvt_pk_bf16_f32 v82, v28, v29
v_exp_f32 v30, v30
v_mfma_f32_16x16x32_bf16 v[52:55], a[172:175], v[180:183], v[140:143]
ds_read_b64_tr_b16 a[190:191], v223 offset:36864
ds_read_b128 a[156:159], v219 offset:49152
v_exp_f32 v31, v31
v_mfma_f32_16x16x32_bf16 v[52:55], a[168:171], v[176:179], v[52:55]
v_exp_f32 v32, v32
v_exp_f32 v33, v33
v_mfma_f32_16x16x32_bf16 v[52:55], a[164:167], v[172:175], v[52:55]
v_cvt_pk_bf16_f32 v83, v30, v31
v_cvt_pk_bf16_f32 v84, v32, v33
v_exp_f32 v34, v34
v_mfma_f32_16x16x32_bf16 v[52:55], a[160:163], v[168:171], v[52:55]
ds_read_b64_tr_b16 a[192:193], v224 offset:32768
ds_read_b64_tr_b16 a[194:195], v224 offset:36864
v_exp_f32 v35, v35
v_mfma_f32_16x16x32_bf16 v[60:63], a[160:163], v[184:187], v[144:147]
ds_read_b128 a[152:155], v218 offset:49152
v_cvt_pk_bf16_f32 v85, v34, v35
v_exp_f32 v36, v36
v_mfma_f32_16x16x32_bf16 v[60:63], a[164:167], v[188:191], v[60:63]
ds_read_b128 a[148:151], v217 offset:49152
ds_read_b128 a[144:147], v216 offset:49152
v_exp_f32 v37, v37
v_mfma_f32_16x16x32_bf16 v[60:63], a[168:171], v[192:195], v[60:63]
ds_read_b64_tr_b16 a[196:197], v225 offset:32768
v_cvt_pk_bf16_f32 v86, v36, v37
v_exp_f32 v38, v38
v_mfma_f32_16x16x32_bf16 v[60:63], a[172:175], v[196:199], v[60:63]
ds_read_b64_tr_b16 a[198:199], v225 offset:36864
ds_read_b64_tr_b16 a[200:201], v226 offset:32768
v_exp_f32 v39, v39
v_mfma_f32_16x16x32_bf16 v[68:71], a[172:175], v[212:215], v[148:151]
ds_read_b64_tr_b16 a[202:203], v226 offset:36864
ds_read_b64_tr_b16 a[204:205], v227 offset:32768
ds_read_b64_tr_b16 a[206:207], v227 offset:36864
v_cvt_pk_bf16_f32 v87, v38, v39
v_mfma_f32_16x16x32_bf16 v[68:71], a[168:171], v[208:211], v[68:71]
ds_read_b128 a[172:175], v219 offset:53248
ds_read_b128 a[168:171], v218 offset:53248
s_add_u32 s32, s32, 16384
s_add_u32 m0, s30, 81920
v_mfma_f32_16x16x32_bf16 v[68:71], a[164:167], v[204:207], v[68:71]
ds_read_b128 a[164:167], v217 offset:53248
buffer_load_dwordx4 v228, s[8:11], s32 offen offset:0  lds
s_mul_i32 s28, s37, 288
v_mfma_f32_16x16x32_bf16 v[68:71], a[160:163], v[200:203], v[68:71]
ds_read_b128 a[160:163], v216 offset:53248
buffer_load_dwordx4 v229, s[8:11], s32 offen offset:1024  lds
s_add_u32 s28, s28, 8192
buffer_load_dwordx4 v230, s[8:11], s32 offen offset:2048  lds
buffer_load_dwordx4 v231, s[8:11], s32 offen offset:3072  lds
buffer_store_byte v255, v254, s[24:27], 0 offen sc0 sc1
s_waitcnt lgkmcnt(8)
v_mfma_f32_16x16x32_bf16 v[8:11], a[144:147], v[152:155], v[136:139]
v_exp_f32 v40, v40
v_mfma_f32_16x16x32_bf16 v[8:11], a[148:151], v[156:159], v[8:11]
v_exp_f32 v41, v41
v_mfma_f32_16x16x32_bf16 v[8:11], a[152:155], v[160:163], v[8:11]
v_cvt_pk_bf16_f32 v88, v40, v41
v_add_u32 v242, s28, v242
v_mfma_f32_16x16x32_bf16 v[8:11], a[156:159], v[164:167], v[8:11]
v_exp_f32 v42, v42
v_mfma_f32_16x16x32_bf16 v[16:19], a[156:159], v[180:183], v[140:143]
s_add_u32 s39, s39, 16384
v_mfma_f32_16x16x32_bf16 v[16:19], a[152:155], v[176:179], v[16:19]
v_exp_f32 v43, v43
v_mfma_f32_16x16x32_bf16 v[16:19], a[148:151], v[172:175], v[16:19]
v_cvt_pk_bf16_f32 v89, v42, v43
v_mfma_f32_16x16x32_bf16 v[16:19], a[144:147], v[168:171], v[16:19]
v_exp_f32 v44, v44
v_mfma_f32_16x16x32_bf16 v[24:27], a[144:147], v[184:187], v[144:147]
v_mfma_f32_16x16x32_bf16 v[24:27], a[148:151], v[188:191], v[24:27]
v_exp_f32 v45, v45
v_mfma_f32_16x16x32_bf16 v[24:27], a[152:155], v[192:195], v[24:27]
v_cvt_pk_bf16_f32 v90, v44, v45
v_mfma_f32_16x16x32_bf16 v[24:27], a[156:159], v[196:199], v[24:27]
v_exp_f32 v46, v46
v_mfma_f32_16x16x32_bf16 v[32:35], a[156:159], v[212:215], v[148:151]
ds_read_b128 a[156:159], v219 offset:57344
s_add_u32 m0, s30, 98304
v_mfma_f32_16x16x32_bf16 v[32:35], a[152:155], v[208:211], v[32:35]
v_exp_f32 v47, v47
v_mfma_f32_16x16x32_bf16 v[32:35], a[148:151], v[204:207], v[32:35]
ds_read_b128 a[152:155], v218 offset:57344
v_cvt_pk_bf16_f32 v91, v46, v47
v_mfma_f32_16x16x32_bf16 v[32:35], a[144:147], v[200:203], v[32:35]
v_exp_f32 v48, v48
v_mfma_f32_16x16x32_bf16 a[0:3], v[72:75], a[176:179], 0
ds_read_b128 a[148:151], v217 offset:57344
ds_read_b128 a[144:147], v216 offset:57344
v_mfma_f32_16x16x32_bf16 a[16:19], v[72:75], a[180:183], 0
v_exp_f32 v49, v49
v_mfma_f32_16x16x32_bf16 a[20:23], v[76:79], a[180:183], 0
v_cvt_pk_bf16_f32 v92, v48, v49
v_mfma_f32_16x16x32_bf16 a[4:7], v[76:79], a[176:179], 0
v_exp_f32 v50, v50
v_mfma_f32_16x16x32_bf16 a[8:11], v[80:83], a[176:179], 0
v_mfma_f32_16x16x32_bf16 a[24:27], v[80:83], a[180:183], 0
v_exp_f32 v51, v51
v_mfma_f32_16x16x32_bf16 a[28:31], v[84:87], a[180:183], 0
ds_read_b64_tr_b16 a[180:181], v221 offset:40960
v_cvt_pk_bf16_f32 v93, v50, v51
v_mfma_f32_16x16x32_bf16 a[12:15], v[84:87], a[176:179], 0
v_exp_f32 v52, v52
v_mfma_f32_16x16x32_bf16 a[44:47], v[84:87], a[184:187], 0
ds_read_b64_tr_b16 a[182:183], v221 offset:45056
ds_read_b64_tr_b16 a[176:177], v220 offset:40960
v_mfma_f32_16x16x32_bf16 a[60:63], v[84:87], a[188:191], 0
v_exp_f32 v53, v53
v_mfma_f32_16x16x32_bf16 a[56:59], v[80:83], a[188:191], 0
ds_read_b64_tr_b16 a[178:179], v220 offset:45056
v_cvt_pk_bf16_f32 v94, v52, v53
v_mfma_f32_16x16x32_bf16 a[40:43], v[80:83], a[184:187], 0
v_exp_f32 v54, v54
v_mfma_f32_16x16x32_bf16 a[36:39], v[76:79], a[184:187], 0
buffer_load_dwordx4 v232, s[12:15], s39 offen offset:0  lds
v_mfma_f32_16x16x32_bf16 a[52:55], v[76:79], a[188:191], 0
v_exp_f32 v55, v55
v_mfma_f32_16x16x32_bf16 a[48:51], v[72:75], a[188:191], 0
ds_read_b64_tr_b16 a[188:189], v223 offset:40960
v_cvt_pk_bf16_f32 v95, v54, v55
v_mfma_f32_16x16x32_bf16 a[32:35], v[72:75], a[184:187], 0
v_exp_f32 v56, v56
v_smfmac_f32_16x16x64_bf16 a[128:131], a[208:211], v[72:79], v245
ds_read_b64_tr_b16 a[190:191], v223 offset:45056
s_waitcnt lgkmcnt(8)
v_mfma_f32_16x16x32_bf16 v[12:15], a[160:163], v[152:155], v[136:139]
v_exp_f32 v57, v57
v_mfma_f32_16x16x32_bf16 v[12:15], a[164:167], v[156:159], v[12:15]
v_exp_f32 v58, v58
v_mfma_f32_16x16x32_bf16 v[12:15], a[168:171], v[160:163], v[12:15]
ds_read_b64_tr_b16 a[184:185], v222 offset:40960
v_cvt_pk_bf16_f32 v96, v56, v57
v_mfma_f32_16x16x32_bf16 v[12:15], a[172:175], v[164:167], v[12:15]
v_exp_f32 v59, v59
v_mfma_f32_16x16x32_bf16 v[20:23], a[172:175], v[180:183], v[140:143]
ds_read_b64_tr_b16 a[186:187], v222 offset:45056
v_cvt_pk_bf16_f32 v97, v58, v59
v_mfma_f32_16x16x32_bf16 v[20:23], a[168:171], v[176:179], v[20:23]
v_exp_f32 v60, v60
v_mfma_f32_16x16x32_bf16 v[20:23], a[164:167], v[172:175], v[20:23]
buffer_load_dwordx4 v233, s[12:15], s39 offen offset:1024  lds
v_mfma_f32_16x16x32_bf16 v[20:23], a[160:163], v[168:171], v[20:23]
v_exp_f32 v61, v61
v_mfma_f32_16x16x32_bf16 v[28:31], a[160:163], v[184:187], v[144:147]
v_cvt_pk_bf16_f32 v98, v60, v61
v_mfma_f32_16x16x32_bf16 v[28:31], a[164:167], v[188:191], v[28:31]
v_exp_f32 v62, v62
v_mfma_f32_16x16x32_bf16 v[28:31], a[168:171], v[192:195], v[28:31]
buffer_load_dwordx4 v232, s[12:15], s39 offen offset:2048  lds
v_mfma_f32_16x16x32_bf16 v[28:31], a[172:175], v[196:199], v[28:31]
v_exp_f32 v63, v63
v_mfma_f32_16x16x32_bf16 v[36:39], a[172:175], v[212:215], v[148:151]
ds_read_b128 a[172:175], v219 offset:61440
v_cvt_pk_bf16_f32 v99, v62, v63
v_mfma_f32_16x16x32_bf16 v[36:39], a[168:171], v[208:211], v[36:39]
v_exp_f32 v64, v64
v_mfma_f32_16x16x32_bf16 v[36:39], a[164:167], v[204:207], v[36:39]
ds_read_b128 a[168:171], v218 offset:61440
ds_read_b128 a[164:167], v217 offset:61440
v_mfma_f32_16x16x32_bf16 v[36:39], a[160:163], v[200:203], v[36:39]
v_exp_f32 v65, v65
v_mfma_f32_16x16x32_bf16 a[64:67], v[72:75], a[192:195], 0
ds_read_b128 a[160:163], v216 offset:61440
v_cvt_pk_bf16_f32 v100, v64, v65
v_mfma_f32_16x16x32_bf16 a[80:83], v[72:75], a[196:199], 0
v_exp_f32 v66, v66
v_mfma_f32_16x16x32_bf16 a[84:87], v[76:79], a[196:199], 0
buffer_load_dwordx4 v233, s[12:15], s39 offen offset:3072  lds
v_mfma_f32_16x16x32_bf16 a[68:71], v[76:79], a[192:195], 0
v_exp_f32 v67, v67
v_mfma_f32_16x16x32_bf16 a[72:75], v[80:83], a[192:195], 0
v_cvt_pk_bf16_f32 v101, v66, v67
v_mfma_f32_16x16x32_bf16 a[88:91], v[80:83], a[196:199], 0
v_exp_f32 v68, v68
v_mfma_f32_16x16x32_bf16 a[92:95], v[84:87], a[196:199], 0
ds_read_b64_tr_b16 a[196:197], v225 offset:40960
ds_read_b64_tr_b16 a[198:199], v225 offset:45056
v_mfma_f32_16x16x32_bf16 a[76:79], v[84:87], a[192:195], 0
v_exp_f32 v69, v69
v_mfma_f32_16x16x32_bf16 a[108:111], v[84:87], a[200:203], 0
ds_read_b64_tr_b16 a[192:193], v224 offset:40960
v_cvt_pk_bf16_f32 v102, v68, v69
v_mfma_f32_16x16x32_bf16 a[124:127], v[84:87], a[204:207], 0
v_exp_f32 v70, v70
v_mfma_f32_16x16x32_bf16 a[120:123], v[80:83], a[204:207], 0
ds_read_b64_tr_b16 a[194:195], v224 offset:45056
v_mfma_f32_16x16x32_bf16 a[104:107], v[80:83], a[200:203], 0
v_exp_f32 v71, v71
v_mfma_f32_16x16x32_bf16 a[100:103], v[76:79], a[200:203], 0
v_cvt_pk_bf16_f32 v103, v70, v71
v_mfma_f32_16x16x32_bf16 a[116:119], v[76:79], a[204:207], 0
v_mfma_f32_16x16x32_bf16 a[112:115], v[72:75], a[204:207], 0
ds_read_b64_tr_b16 a[204:205], v227 offset:40960
ds_read_b64_tr_b16 a[206:207], v227 offset:45056
v_mfma_f32_16x16x32_bf16 a[96:99], v[72:75], a[200:203], 0
ds_read_b64_tr_b16 a[200:201], v226 offset:40960
ds_read_b64_tr_b16 a[202:203], v226 offset:45056
v_smfmac_f32_16x16x64_bf16 a[132:135], a[208:211], v[80:87], v245
s_waitcnt lgkmcnt(8)
v_mfma_f32_16x16x32_bf16 v[40:43], a[144:147], v[152:155], v[136:139]
v_exp_f32 v8, v8
v_mfma_f32_16x16x32_bf16 v[40:43], a[148:151], v[156:159], v[40:43]
v_exp_f32 v9, v9
v_mfma_f32_16x16x32_bf16 v[40:43], a[152:155], v[160:163], v[40:43]
v_cvt_pk_bf16_f32 v72, v8, v9
v_lshlrev_b32 v250, 3, v1
v_mfma_f32_16x16x32_bf16 v[40:43], a[156:159], v[164:167], v[40:43]
v_exp_f32 v10, v10
v_mfma_f32_16x16x32_bf16 v[48:51], a[156:159], v[180:183], v[140:143]
v_mfma_f32_16x16x32_bf16 v[48:51], a[152:155], v[176:179], v[48:51]
v_exp_f32 v11, v11
v_mfma_f32_16x16x32_bf16 v[48:51], a[148:151], v[172:175], v[48:51]
v_cvt_pk_bf16_f32 v73, v10, v11
v_mfma_f32_16x16x32_bf16 v[48:51], a[144:147], v[168:171], v[48:51]
v_exp_f32 v12, v12
v_mfma_f32_16x16x32_bf16 v[56:59], a[144:147], v[184:187], v[144:147]
v_mfma_f32_16x16x32_bf16 v[56:59], a[148:151], v[188:191], v[56:59]
v_exp_f32 v13, v13
v_mfma_f32_16x16x32_bf16 v[56:59], a[152:155], v[192:195], v[56:59]
v_cvt_pk_bf16_f32 v74, v12, v13
v_mfma_f32_16x16x32_bf16 v[56:59], a[156:159], v[196:199], v[56:59]
v_exp_f32 v14, v14
v_mfma_f32_16x16x32_bf16 v[64:67], a[156:159], v[212:215], v[148:151]
s_waitcnt vmcnt(9) lgkmcnt(0)
s_barrier
v_mfma_f32_16x16x32_bf16 v[64:67], a[152:155], v[208:211], v[64:67]
v_exp_f32 v15, v15
v_mfma_f32_16x16x32_bf16 v[64:67], a[148:151], v[204:207], v[64:67]
ds_read_b128 a[156:159], v219 offset:0
v_cvt_pk_bf16_f32 v75, v14, v15
v_mfma_f32_16x16x32_bf16 v[64:67], a[144:147], v[200:203], v[64:67]
v_exp_f32 v16, v16
v_mfma_f32_16x16x32_bf16 a[0:3], v[88:91], a[176:179], a[0:3]
ds_read_b128 a[152:155], v218 offset:0
ds_read_b128 a[148:151], v217 offset:0
v_mfma_f32_16x16x32_bf16 a[16:19], v[88:91], a[180:183], a[16:19]
v_exp_f32 v17, v17
v_mfma_f32_16x16x32_bf16 a[20:23], v[92:95], a[180:183], a[20:23]
ds_read_b128 a[144:147], v216 offset:0
v_cvt_pk_bf16_f32 v76, v16, v17
v_mfma_f32_16x16x32_bf16 a[4:7], v[92:95], a[176:179], a[4:7]
v_exp_f32 v18, v18
v_mfma_f32_16x16x32_bf16 a[8:11], v[96:99], a[176:179], a[8:11]
s_add_u32 s32, s32, 16384
s_add_u32 m0, s30, 114688
v_mfma_f32_16x16x32_bf16 a[24:27], v[96:99], a[180:183], a[24:27]
v_exp_f32 v19, v19
v_mfma_f32_16x16x32_bf16 a[28:31], v[100:103], a[180:183], a[28:31]
ds_read_b64_tr_b16 a[180:181], v221 offset:49152
v_cvt_pk_bf16_f32 v77, v18, v19
v_mfma_f32_16x16x32_bf16 a[12:15], v[100:103], a[176:179], a[12:15]
v_exp_f32 v20, v20
v_mfma_f32_16x16x32_bf16 a[44:47], v[100:103], a[184:187], a[44:47]
ds_read_b64_tr_b16 a[182:183], v221 offset:53248
ds_read_b64_tr_b16 a[176:177], v220 offset:49152
v_mfma_f32_16x16x32_bf16 a[60:63], v[100:103], a[188:191], a[60:63]
v_exp_f32 v21, v21
v_mfma_f32_16x16x32_bf16 a[56:59], v[96:99], a[188:191], a[56:59]
ds_read_b64_tr_b16 a[178:179], v220 offset:53248
v_cvt_pk_bf16_f32 v78, v20, v21
v_mfma_f32_16x16x32_bf16 a[40:43], v[96:99], a[184:187], a[40:43]
v_exp_f32 v22, v22
v_mfma_f32_16x16x32_bf16 a[36:39], v[92:95], a[184:187], a[36:39]
buffer_load_dwordx4 v228, s[8:11], s32 offen offset:0  lds
v_mfma_f32_16x16x32_bf16 a[52:55], v[92:95], a[188:191], a[52:55]
v_exp_f32 v23, v23
v_mfma_f32_16x16x32_bf16 a[48:51], v[88:91], a[188:191], a[48:51]
ds_read_b64_tr_b16 a[188:189], v223 offset:49152
v_cvt_pk_bf16_f32 v79, v22, v23
v_mfma_f32_16x16x32_bf16 a[32:35], v[88:91], a[184:187], a[32:35]
v_exp_f32 v24, v24
v_smfmac_f32_16x16x64_bf16 a[128:131], a[208:211], v[88:95], v245
ds_read_b64_tr_b16 a[190:191], v223 offset:53248
v_mfma_f32_16x16x32_bf16 v[44:47], a[160:163], v[152:155], v[136:139]
v_exp_f32 v25, v25
v_mfma_f32_16x16x32_bf16 v[44:47], a[164:167], v[156:159], v[44:47]
v_exp_f32 v26, v26
v_mfma_f32_16x16x32_bf16 v[44:47], a[168:171], v[160:163], v[44:47]
ds_read_b64_tr_b16 a[184:185], v222 offset:49152
v_cvt_pk_bf16_f32 v80, v24, v25
v_mfma_f32_16x16x32_bf16 v[44:47], a[172:175], v[164:167], v[44:47]
v_exp_f32 v27, v27
v_mfma_f32_16x16x32_bf16 v[52:55], a[172:175], v[180:183], v[140:143]
ds_read_b64_tr_b16 a[186:187], v222 offset:53248
v_cvt_pk_bf16_f32 v81, v26, v27
v_mfma_f32_16x16x32_bf16 v[52:55], a[168:171], v[176:179], v[52:55]
v_exp_f32 v28, v28
v_mfma_f32_16x16x32_bf16 v[52:55], a[164:167], v[172:175], v[52:55]
buffer_load_dwordx4 v229, s[8:11], s32 offen offset:1024  lds
v_mfma_f32_16x16x32_bf16 v[52:55], a[160:163], v[168:171], v[52:55]
v_exp_f32 v29, v29
v_mfma_f32_16x16x32_bf16 v[60:63], a[160:163], v[184:187], v[144:147]
v_cvt_pk_bf16_f32 v82, v28, v29
v_mfma_f32_16x16x32_bf16 v[60:63], a[164:167], v[188:191], v[60:63]
v_exp_f32 v30, v30
v_mfma_f32_16x16x32_bf16 v[60:63], a[168:171], v[192:195], v[60:63]
buffer_load_dwordx4 v230, s[8:11], s32 offen offset:2048  lds
v_mfma_f32_16x16x32_bf16 v[60:63], a[172:175], v[196:199], v[60:63]
v_exp_f32 v31, v31
v_mfma_f32_16x16x32_bf16 v[68:71], a[172:175], v[212:215], v[148:151]
ds_read_b128 a[172:175], v219 offset:4096
v_cvt_pk_bf16_f32 v83, v30, v31
v_mfma_f32_16x16x32_bf16 v[68:71], a[168:171], v[208:211], v[68:71]
v_exp_f32 v32, v32
v_mfma_f32_16x16x32_bf16 v[68:71], a[164:167], v[204:207], v[68:71]
ds_read_b128 a[168:171], v218 offset:4096
ds_read_b128 a[164:167], v217 offset:4096
v_mfma_f32_16x16x32_bf16 v[68:71], a[160:163], v[200:203], v[68:71]
v_exp_f32 v33, v33
v_mfma_f32_16x16x32_bf16 a[64:67], v[88:91], a[192:195], a[64:67]
ds_read_b128 a[160:163], v216 offset:4096
v_cvt_pk_bf16_f32 v84, v32, v33
v_mfma_f32_16x16x32_bf16 a[80:83], v[88:91], a[196:199], a[80:83]
v_exp_f32 v34, v34
v_mfma_f32_16x16x32_bf16 a[84:87], v[92:95], a[196:199], a[84:87]
buffer_load_dwordx4 v231, s[8:11], s32 offen offset:3072  lds
v_mfma_f32_16x16x32_bf16 a[68:71], v[92:95], a[192:195], a[68:71]
v_exp_f32 v35, v35
v_mfma_f32_16x16x32_bf16 a[72:75], v[96:99], a[192:195], a[72:75]
v_cvt_pk_bf16_f32 v85, v34, v35
v_mfma_f32_16x16x32_bf16 a[88:91], v[96:99], a[196:199], a[88:91]
v_exp_f32 v36, v36
v_mfma_f32_16x16x32_bf16 a[92:95], v[100:103], a[196:199], a[92:95]
ds_read_b64_tr_b16 a[196:197], v225 offset:49152
ds_read_b64_tr_b16 a[198:199], v225 offset:53248
v_mfma_f32_16x16x32_bf16 a[76:79], v[100:103], a[192:195], a[76:79]
v_exp_f32 v37, v37
v_mfma_f32_16x16x32_bf16 a[108:111], v[100:103], a[200:203], a[108:111]
ds_read_b64_tr_b16 a[192:193], v224 offset:49152
v_cvt_pk_bf16_f32 v86, v36, v37
v_mfma_f32_16x16x32_bf16 a[124:127], v[100:103], a[204:207], a[124:127]
v_exp_f32 v38, v38
v_mfma_f32_16x16x32_bf16 a[120:123], v[96:99], a[204:207], a[120:123]
ds_read_b64_tr_b16 a[194:195], v224 offset:53248
v_mfma_f32_16x16x32_bf16 a[104:107], v[96:99], a[200:203], a[104:107]
v_exp_f32 v39, v39
v_mfma_f32_16x16x32_bf16 a[100:103], v[92:95], a[200:203], a[100:103]
v_cvt_pk_bf16_f32 v87, v38, v39
v_mfma_f32_16x16x32_bf16 a[116:119], v[92:95], a[204:207], a[116:119]
s_add_u32 m0, s86, 0
s_add_u32 s50, s84, 0
buffer_load_dwordx4 v240, s[64:67], s50 offen lds
v_mfma_f32_16x16x32_bf16 a[112:115], v[88:91], a[204:207], a[112:115]
ds_read_b64_tr_b16 a[204:205], v227 offset:49152
ds_read_b64_tr_b16 a[206:207], v227 offset:53248
v_mfma_f32_16x16x32_bf16 a[96:99], v[88:91], a[200:203], a[96:99]
ds_read_b64_tr_b16 a[200:201], v226 offset:49152
ds_read_b64_tr_b16 a[202:203], v226 offset:53248
v_smfmac_f32_16x16x64_bf16 a[132:135], a[208:211], v[96:103], v245
s_add_u32 m0, s86, 4096
s_add_u32 s50, s84, 589824
buffer_load_dwordx4 v240, s[64:67], s50 offen lds
s_waitcnt lgkmcnt(8)
v_mfma_f32_16x16x32_bf16 v[8:11], a[144:147], v[152:155], v[136:139]
v_exp_f32 v40, v40
v_mfma_f32_16x16x32_bf16 v[8:11], a[148:151], v[156:159], v[8:11]
v_exp_f32 v41, v41
v_mfma_f32_16x16x32_bf16 v[8:11], a[152:155], v[160:163], v[8:11]
v_cvt_pk_bf16_f32 v88, v40, v41
v_mfma_f32_16x16x32_bf16 v[8:11], a[156:159], v[164:167], v[8:11]
v_exp_f32 v42, v42
v_mfma_f32_16x16x32_bf16 v[16:19], a[156:159], v[180:183], v[140:143]
s_add_u32 s39, s39, 16384
v_mfma_f32_16x16x32_bf16 v[16:19], a[152:155], v[176:179], v[16:19]
v_exp_f32 v43, v43
v_mfma_f32_16x16x32_bf16 v[16:19], a[148:151], v[172:175], v[16:19]
v_cvt_pk_bf16_f32 v89, v42, v43
v_mfma_f32_16x16x32_bf16 v[16:19], a[144:147], v[168:171], v[16:19]
v_exp_f32 v44, v44
v_mfma_f32_16x16x32_bf16 v[24:27], a[144:147], v[184:187], v[144:147]
s_mov_b32 s29, 0x242000
buffer_load_dwordx2 v[248:249], v250, s[20:23], s29 offen sc0 sc1
v_mfma_f32_16x16x32_bf16 v[24:27], a[148:151], v[188:191], v[24:27]
v_exp_f32 v45, v45
v_mfma_f32_16x16x32_bf16 v[24:27], a[152:155], v[192:195], v[24:27]
s_add_u32 m0, s30, 131072
v_cvt_pk_bf16_f32 v90, v44, v45
v_mfma_f32_16x16x32_bf16 v[24:27], a[156:159], v[196:199], v[24:27]
v_exp_f32 v46, v46
v_mfma_f32_16x16x32_bf16 v[32:35], a[156:159], v[212:215], v[148:151]
ds_read_b128 a[156:159], v219 offset:8192
v_mfma_f32_16x16x32_bf16 v[32:35], a[152:155], v[208:211], v[32:35]
v_exp_f32 v47, v47
v_mfma_f32_16x16x32_bf16 v[32:35], a[148:151], v[204:207], v[32:35]
ds_read_b128 a[152:155], v218 offset:8192
v_cvt_pk_bf16_f32 v91, v46, v47
v_mfma_f32_16x16x32_bf16 v[32:35], a[144:147], v[200:203], v[32:35]
v_exp_f32 v48, v48
v_mfma_f32_16x16x32_bf16 a[0:3], v[72:75], a[176:179], a[0:3]
ds_read_b128 a[148:151], v217 offset:8192
ds_read_b128 a[144:147], v216 offset:8192
v_mfma_f32_16x16x32_bf16 a[16:19], v[72:75], a[180:183], a[16:19]
v_exp_f32 v49, v49
v_mfma_f32_16x16x32_bf16 a[20:23], v[76:79], a[180:183], a[20:23]
v_cvt_pk_bf16_f32 v92, v48, v49
v_mfma_f32_16x16x32_bf16 a[4:7], v[76:79], a[176:179], a[4:7]
v_exp_f32 v50, v50
v_mfma_f32_16x16x32_bf16 a[8:11], v[80:83], a[176:179], a[8:11]
buffer_load_dwordx4 v232, s[12:15], s39 offen offset:0  lds
v_mfma_f32_16x16x32_bf16 a[24:27], v[80:83], a[180:183], a[24:27]
v_exp_f32 v51, v51
v_mfma_f32_16x16x32_bf16 a[28:31], v[84:87], a[180:183], a[28:31]
ds_read_b64_tr_b16 a[180:181], v221 offset:57344
v_cvt_pk_bf16_f32 v93, v50, v51
STUB_4:
s_cbranch_execz STUB_7
v_mfma_f32_16x16x32_bf16 a[12:15], v[84:87], a[176:179], a[12:15]
v_exp_f32 v52, v52
v_mfma_f32_16x16x32_bf16 a[44:47], v[84:87], a[184:187], a[44:47]
ds_read_b64_tr_b16 a[182:183], v221 offset:61440
ds_read_b64_tr_b16 a[176:177], v220 offset:57344
v_mfma_f32_16x16x32_bf16 a[60:63], v[84:87], a[188:191], a[60:63]
v_exp_f32 v53, v53
v_mfma_f32_16x16x32_bf16 a[56:59], v[80:83], a[188:191], a[56:59]
ds_read_b64_tr_b16 a[178:179], v220 offset:61440
v_cvt_pk_bf16_f32 v94, v52, v53
v_mfma_f32_16x16x32_bf16 a[40:43], v[80:83], a[184:187], a[40:43]
v_exp_f32 v54, v54
v_mfma_f32_16x16x32_bf16 a[36:39], v[76:79], a[184:187], a[36:39]
buffer_load_dwordx4 v233, s[12:15], s39 offen offset:1024  lds
v_mfma_f32_16x16x32_bf16 a[52:55], v[76:79], a[188:191], a[52:55]
v_exp_f32 v55, v55
v_mfma_f32_16x16x32_bf16 a[48:51], v[72:75], a[188:191], a[48:51]
ds_read_b64_tr_b16 a[188:189], v223 offset:57344
v_cvt_pk_bf16_f32 v95, v54, v55
v_mfma_f32_16x16x32_bf16 a[32:35], v[72:75], a[184:187], a[32:35]
v_exp_f32 v56, v56
v_smfmac_f32_16x16x64_bf16 a[128:131], a[208:211], v[72:79], v245
ds_read_b64_tr_b16 a[190:191], v223 offset:61440
v_mfma_f32_16x16x32_bf16 v[12:15], a[160:163], v[152:155], v[136:139]
v_exp_f32 v57, v57
v_mfma_f32_16x16x32_bf16 v[12:15], a[164:167], v[156:159], v[12:15]
v_exp_f32 v58, v58
v_mfma_f32_16x16x32_bf16 v[12:15], a[168:171], v[160:163], v[12:15]
ds_read_b64_tr_b16 a[184:185], v222 offset:57344
v_cvt_pk_bf16_f32 v96, v56, v57
v_mfma_f32_16x16x32_bf16 v[12:15], a[172:175], v[164:167], v[12:15]
v_exp_f32 v59, v59
v_mfma_f32_16x16x32_bf16 v[20:23], a[172:175], v[180:183], v[140:143]
ds_read_b64_tr_b16 a[186:187], v222 offset:61440
v_cvt_pk_bf16_f32 v97, v58, v59
v_mfma_f32_16x16x32_bf16 v[20:23], a[168:171], v[176:179], v[20:23]
v_exp_f32 v60, v60
v_mfma_f32_16x16x32_bf16 v[20:23], a[164:167], v[172:175], v[20:23]
buffer_load_dwordx4 v232, s[12:15], s39 offen offset:2048  lds
v_mfma_f32_16x16x32_bf16 v[20:23], a[160:163], v[168:171], v[20:23]
v_exp_f32 v61, v61
v_mfma_f32_16x16x32_bf16 v[28:31], a[160:163], v[184:187], v[144:147]
v_cvt_pk_bf16_f32 v98, v60, v61
v_mfma_f32_16x16x32_bf16 v[28:31], a[164:167], v[188:191], v[28:31]
v_exp_f32 v62, v62
v_mfma_f32_16x16x32_bf16 v[28:31], a[168:171], v[192:195], v[28:31]
buffer_load_dwordx4 v233, s[12:15], s39 offen offset:3072  lds
v_mfma_f32_16x16x32_bf16 v[28:31], a[172:175], v[196:199], v[28:31]
v_exp_f32 v63, v63
v_mfma_f32_16x16x32_bf16 v[36:39], a[172:175], v[212:215], v[148:151]
ds_read_b128 a[172:175], v219 offset:12288
v_cvt_pk_bf16_f32 v99, v62, v63
v_mfma_f32_16x16x32_bf16 v[36:39], a[168:171], v[208:211], v[36:39]
v_exp_f32 v64, v64
v_mfma_f32_16x16x32_bf16 v[36:39], a[164:167], v[204:207], v[36:39]
ds_read_b128 a[168:171], v218 offset:12288
ds_read_b128 a[164:167], v217 offset:12288
v_mfma_f32_16x16x32_bf16 v[36:39], a[160:163], v[200:203], v[36:39]
v_exp_f32 v65, v65
s_waitcnt lgkmcnt(8)
v_mfma_f32_16x16x32_bf16 a[64:67], v[72:75], a[192:195], a[64:67]
ds_read_b128 a[160:163], v216 offset:12288
v_cvt_pk_bf16_f32 v100, v64, v65
v_mfma_f32_16x16x32_bf16 a[80:83], v[72:75], a[196:199], a[80:83]
v_exp_f32 v66, v66
v_mfma_f32_16x16x32_bf16 a[84:87], v[76:79], a[196:199], a[84:87]
s_add_u32 m0, s86, 8192
s_add_u32 s50, s84, 1179648
buffer_load_dwordx4 v240, s[64:67], s50 offen lds
v_mfma_f32_16x16x32_bf16 a[68:71], v[76:79], a[192:195], a[68:71]
v_exp_f32 v67, v67
v_mfma_f32_16x16x32_bf16 a[72:75], v[80:83], a[192:195], a[72:75]
v_cvt_pk_bf16_f32 v101, v66, v67
v_mfma_f32_16x16x32_bf16 a[88:91], v[80:83], a[196:199], a[88:91]
v_exp_f32 v68, v68
v_mfma_f32_16x16x32_bf16 a[92:95], v[84:87], a[196:199], a[92:95]
ds_read_b64_tr_b16 a[196:197], v225 offset:57344
ds_read_b64_tr_b16 a[198:199], v225 offset:61440
v_mfma_f32_16x16x32_bf16 a[76:79], v[84:87], a[192:195], a[76:79]
v_exp_f32 v69, v69
v_mfma_f32_16x16x32_bf16 a[108:111], v[84:87], a[200:203], a[108:111]
ds_read_b64_tr_b16 a[192:193], v224 offset:57344
v_cvt_pk_bf16_f32 v102, v68, v69
v_mfma_f32_16x16x32_bf16 a[124:127], v[84:87], a[204:207], a[124:127]
v_exp_f32 v70, v70
v_mfma_f32_16x16x32_bf16 a[120:123], v[80:83], a[204:207], a[120:123]
ds_read_b64_tr_b16 a[194:195], v224 offset:61440
v_mfma_f32_16x16x32_bf16 a[104:107], v[80:83], a[200:203], a[104:107]
v_exp_f32 v71, v71
v_mfma_f32_16x16x32_bf16 a[100:103], v[76:79], a[200:203], a[100:103]
v_cvt_pk_bf16_f32 v103, v70, v71
v_mfma_f32_16x16x32_bf16 a[116:119], v[76:79], a[204:207], a[116:119]
s_add_u32 m0, s86, 12288
s_add_u32 s50, s84, 1769472
buffer_load_dwordx4 v240, s[64:67], s50 offen lds
v_mfma_f32_16x16x32_bf16 a[112:115], v[72:75], a[204:207], a[112:115]
ds_read_b64_tr_b16 a[204:205], v227 offset:57344
ds_read_b64_tr_b16 a[206:207], v227 offset:61440
v_mfma_f32_16x16x32_bf16 a[96:99], v[72:75], a[200:203], a[96:99]
ds_read_b64_tr_b16 a[200:201], v226 offset:57344
ds_read_b64_tr_b16 a[202:203], v226 offset:61440
v_smfmac_f32_16x16x64_bf16 a[132:135], a[208:211], v[80:87], v245
v_mfma_f32_16x16x32_bf16 v[40:43], a[144:147], v[152:155], v[136:139]
v_exp_f32 v8, v8
v_mfma_f32_16x16x32_bf16 v[40:43], a[148:151], v[156:159], v[40:43]
v_exp_f32 v9, v9
v_mfma_f32_16x16x32_bf16 v[40:43], a[152:155], v[160:163], v[40:43]
v_cvt_pk_bf16_f32 v72, v8, v9
v_mfma_f32_16x16x32_bf16 v[40:43], a[156:159], v[164:167], v[40:43]
v_exp_f32 v10, v10
v_mfma_f32_16x16x32_bf16 v[48:51], a[156:159], v[180:183], v[140:143]
v_mfma_f32_16x16x32_bf16 v[48:51], a[152:155], v[176:179], v[48:51]
v_exp_f32 v11, v11
v_mfma_f32_16x16x32_bf16 v[48:51], a[148:151], v[172:175], v[48:51]
v_cvt_pk_bf16_f32 v73, v10, v11
v_mfma_f32_16x16x32_bf16 v[48:51], a[144:147], v[168:171], v[48:51]
v_exp_f32 v12, v12
v_mfma_f32_16x16x32_bf16 v[56:59], a[144:147], v[184:187], v[144:147]
v_mfma_f32_16x16x32_bf16 v[56:59], a[148:151], v[188:191], v[56:59]
v_exp_f32 v13, v13
v_mfma_f32_16x16x32_bf16 v[56:59], a[152:155], v[192:195], v[56:59]
v_cvt_pk_bf16_f32 v74, v12, v13
v_mfma_f32_16x16x32_bf16 v[56:59], a[156:159], v[196:199], v[56:59]
v_exp_f32 v14, v14
v_mfma_f32_16x16x32_bf16 v[64:67], a[156:159], v[212:215], v[148:151]
s_waitcnt vmcnt(13) lgkmcnt(0)
s_barrier
v_mfma_f32_16x16x32_bf16 v[64:67], a[152:155], v[208:211], v[64:67]
v_exp_f32 v15, v15
v_mfma_f32_16x16x32_bf16 v[64:67], a[148:151], v[204:207], v[64:67]
ds_read_b128 a[156:159], v219 offset:16384
v_cvt_pk_bf16_f32 v75, v14, v15
v_mfma_f32_16x16x32_bf16 v[64:67], a[144:147], v[200:203], v[64:67]
v_exp_f32 v16, v16
v_mfma_f32_16x16x32_bf16 a[0:3], v[88:91], a[176:179], a[0:3]
ds_read_b128 a[152:155], v218 offset:16384
ds_read_b128 a[148:151], v217 offset:16384
v_mfma_f32_16x16x32_bf16 a[16:19], v[88:91], a[180:183], a[16:19]
v_exp_f32 v17, v17
v_mfma_f32_16x16x32_bf16 a[20:23], v[92:95], a[180:183], a[20:23]
ds_read_b128 a[144:147], v216 offset:16384
v_cvt_pk_bf16_f32 v76, v16, v17
v_mfma_f32_16x16x32_bf16 a[4:7], v[92:95], a[176:179], a[4:7]
v_exp_f32 v18, v18
v_mfma_f32_16x16x32_bf16 a[8:11], v[96:99], a[176:179], a[8:11]
s_add_u32 s32, s32, 16384
s_add_u32 m0, s30, 65536
v_mfma_f32_16x16x32_bf16 a[24:27], v[96:99], a[180:183], a[24:27]
v_exp_f32 v19, v19
v_mfma_f32_16x16x32_bf16 a[28:31], v[100:103], a[180:183], a[28:31]
ds_read_b64_tr_b16 a[180:181], v221 offset:0
v_cvt_pk_bf16_f32 v77, v18, v19
v_mfma_f32_16x16x32_bf16 a[12:15], v[100:103], a[176:179], a[12:15]
v_exp_f32 v20, v20
v_mfma_f32_16x16x32_bf16 a[44:47], v[100:103], a[184:187], a[44:47]
ds_read_b64_tr_b16 a[182:183], v221 offset:4096
ds_read_b64_tr_b16 a[176:177], v220 offset:0
v_mfma_f32_16x16x32_bf16 a[60:63], v[100:103], a[188:191], a[60:63]
v_exp_f32 v21, v21
v_mfma_f32_16x16x32_bf16 a[56:59], v[96:99], a[188:191], a[56:59]
ds_read_b64_tr_b16 a[178:179], v220 offset:4096
v_cvt_pk_bf16_f32 v78, v20, v21
v_mfma_f32_16x16x32_bf16 a[40:43], v[96:99], a[184:187], a[40:43]
v_exp_f32 v22, v22
v_mfma_f32_16x16x32_bf16 a[36:39], v[92:95], a[184:187], a[36:39]
buffer_load_dwordx4 v228, s[8:11], s32 offen offset:0  lds
v_mfma_f32_16x16x32_bf16 a[52:55], v[92:95], a[188:191], a[52:55]
v_exp_f32 v23, v23
v_mfma_f32_16x16x32_bf16 a[48:51], v[88:91], a[188:191], a[48:51]
ds_read_b64_tr_b16 a[188:189], v223 offset:0
v_cvt_pk_bf16_f32 v79, v22, v23
v_mfma_f32_16x16x32_bf16 a[32:35], v[88:91], a[184:187], a[32:35]
v_exp_f32 v24, v24
v_smfmac_f32_16x16x64_bf16 a[128:131], a[208:211], v[88:95], v245
ds_read_b64_tr_b16 a[190:191], v223 offset:4096
v_mfma_f32_16x16x32_bf16 v[44:47], a[160:163], v[152:155], v[136:139]
v_exp_f32 v25, v25
v_mfma_f32_16x16x32_bf16 v[44:47], a[164:167], v[156:159], v[44:47]
v_exp_f32 v26, v26
v_mfma_f32_16x16x32_bf16 v[44:47], a[168:171], v[160:163], v[44:47]
ds_read_b64_tr_b16 a[184:185], v222 offset:0
v_cvt_pk_bf16_f32 v80, v24, v25
v_mfma_f32_16x16x32_bf16 v[44:47], a[172:175], v[164:167], v[44:47]
v_exp_f32 v27, v27
v_mfma_f32_16x16x32_bf16 v[52:55], a[172:175], v[180:183], v[140:143]
ds_read_b64_tr_b16 a[186:187], v222 offset:4096
v_cvt_pk_bf16_f32 v81, v26, v27
v_mfma_f32_16x16x32_bf16 v[52:55], a[168:171], v[176:179], v[52:55]
v_exp_f32 v28, v28
v_mfma_f32_16x16x32_bf16 v[52:55], a[164:167], v[172:175], v[52:55]
buffer_load_dwordx4 v229, s[8:11], s32 offen offset:1024  lds
v_mfma_f32_16x16x32_bf16 v[52:55], a[160:163], v[168:171], v[52:55]
v_exp_f32 v29, v29
v_mfma_f32_16x16x32_bf16 v[60:63], a[160:163], v[184:187], v[144:147]
v_cvt_pk_bf16_f32 v82, v28, v29
v_mfma_f32_16x16x32_bf16 v[60:63], a[164:167], v[188:191], v[60:63]
v_exp_f32 v30, v30
v_mfma_f32_16x16x32_bf16 v[60:63], a[168:171], v[192:195], v[60:63]
buffer_load_dwordx4 v230, s[8:11], s32 offen offset:2048  lds
v_mfma_f32_16x16x32_bf16 v[60:63], a[172:175], v[196:199], v[60:63]
v_exp_f32 v31, v31
v_mfma_f32_16x16x32_bf16 v[68:71], a[172:175], v[212:215], v[148:151]
ds_read_b128 a[172:175], v219 offset:20480
v_cvt_pk_bf16_f32 v83, v30, v31
v_mfma_f32_16x16x32_bf16 v[68:71], a[168:171], v[208:211], v[68:71]
v_exp_f32 v32, v32
v_mfma_f32_16x16x32_bf16 v[68:71], a[164:167], v[204:207], v[68:71]
ds_read_b128 a[168:171], v218 offset:20480
ds_read_b128 a[164:167], v217 offset:20480
v_mfma_f32_16x16x32_bf16 v[68:71], a[160:163], v[200:203], v[68:71]
v_exp_f32 v33, v33
v_mfma_f32_16x16x32_bf16 a[64:67], v[88:91], a[192:195], a[64:67]
ds_read_b128 a[160:163], v216 offset:20480
v_cvt_pk_bf16_f32 v84, v32, v33
v_mfma_f32_16x16x32_bf16 a[80:83], v[88:91], a[196:199], a[80:83]
v_exp_f32 v34, v34
v_mfma_f32_16x16x32_bf16 a[84:87], v[92:95], a[196:199], a[84:87]
buffer_load_dwordx4 v231, s[8:11], s32 offen offset:3072  lds
v_mfma_f32_16x16x32_bf16 a[68:71], v[92:95], a[192:195], a[68:71]
v_exp_f32 v35, v35
v_mfma_f32_16x16x32_bf16 a[72:75], v[96:99], a[192:195], a[72:75]
v_cvt_pk_bf16_f32 v85, v34, v35
v_mfma_f32_16x16x32_bf16 a[88:91], v[96:99], a[196:199], a[88:91]
v_exp_f32 v36, v36
v_mfma_f32_16x16x32_bf16 a[92:95], v[100:103], a[196:199], a[92:95]
ds_read_b64_tr_b16 a[196:197], v225 offset:0
ds_read_b64_tr_b16 a[198:199], v225 offset:4096
v_mfma_f32_16x16x32_bf16 a[76:79], v[100:103], a[192:195], a[76:79]
v_exp_f32 v37, v37
v_mfma_f32_16x16x32_bf16 a[108:111], v[100:103], a[200:203], a[108:111]
ds_read_b64_tr_b16 a[192:193], v224 offset:0
v_cvt_pk_bf16_f32 v86, v36, v37
v_mfma_f32_16x16x32_bf16 a[124:127], v[100:103], a[204:207], a[124:127]
v_exp_f32 v38, v38
v_mfma_f32_16x16x32_bf16 a[120:123], v[96:99], a[204:207], a[120:123]
ds_read_b64_tr_b16 a[194:195], v224 offset:4096
v_mfma_f32_16x16x32_bf16 a[104:107], v[96:99], a[200:203], a[104:107]
v_exp_f32 v39, v39
v_mfma_f32_16x16x32_bf16 a[100:103], v[92:95], a[200:203], a[100:103]
v_cvt_pk_bf16_f32 v87, v38, v39
v_mfma_f32_16x16x32_bf16 a[116:119], v[92:95], a[204:207], a[116:119]
s_add_u32 m0, s86, 16384
s_add_u32 s50, s84, 2359296
buffer_load_dwordx4 v240, s[64:67], s50 offen lds
v_mfma_f32_16x16x32_bf16 a[112:115], v[88:91], a[204:207], a[112:115]
ds_read_b64_tr_b16 a[204:205], v227 offset:0
ds_read_b64_tr_b16 a[206:207], v227 offset:4096
v_mfma_f32_16x16x32_bf16 a[96:99], v[88:91], a[200:203], a[96:99]
ds_read_b64_tr_b16 a[200:201], v226 offset:0
ds_read_b64_tr_b16 a[202:203], v226 offset:4096
v_smfmac_f32_16x16x64_bf16 a[132:135], a[208:211], v[96:103], v245
s_add_u32 m0, s86, 20480
s_add_u32 s50, s84, 2949120
buffer_load_dwordx4 v240, s[64:67], s50 offen lds
s_waitcnt lgkmcnt(8)
v_mfma_f32_16x16x32_bf16 v[8:11], a[144:147], v[152:155], v[136:139]
v_exp_f32 v40, v40
v_mfma_f32_16x16x32_bf16 v[8:11], a[148:151], v[156:159], v[8:11]
v_exp_f32 v41, v41
v_mfma_f32_16x16x32_bf16 v[8:11], a[152:155], v[160:163], v[8:11]
v_cvt_pk_bf16_f32 v88, v40, v41
v_mfma_f32_16x16x32_bf16 v[8:11], a[156:159], v[164:167], v[8:11]
v_exp_f32 v42, v42
v_mfma_f32_16x16x32_bf16 v[16:19], a[156:159], v[180:183], v[140:143]
s_add_u32 s39, s39, 16384
v_mfma_f32_16x16x32_bf16 v[16:19], a[152:155], v[176:179], v[16:19]
v_exp_f32 v43, v43
v_mfma_f32_16x16x32_bf16 v[16:19], a[148:151], v[172:175], v[16:19]
v_cvt_pk_bf16_f32 v89, v42, v43
v_mfma_f32_16x16x32_bf16 v[16:19], a[144:147], v[168:171], v[16:19]
v_exp_f32 v44, v44
v_mfma_f32_16x16x32_bf16 v[24:27], a[144:147], v[184:187], v[144:147]
v_mfma_f32_16x16x32_bf16 v[24:27], a[148:151], v[188:191], v[24:27]
v_exp_f32 v45, v45
v_mfma_f32_16x16x32_bf16 v[24:27], a[152:155], v[192:195], v[24:27]
s_add_u32 m0, s30, 147456
v_cvt_pk_bf16_f32 v90, v44, v45
v_mfma_f32_16x16x32_bf16 v[24:27], a[156:159], v[196:199], v[24:27]
v_exp_f32 v46, v46
v_mfma_f32_16x16x32_bf16 v[32:35], a[156:159], v[212:215], v[148:151]
ds_read_b128 a[156:159], v219 offset:24576
v_mfma_f32_16x16x32_bf16 v[32:35], a[152:155], v[208:211], v[32:35]
v_exp_f32 v47, v47
v_mfma_f32_16x16x32_bf16 v[32:35], a[148:151], v[204:207], v[32:35]
ds_read_b128 a[152:155], v218 offset:24576
v_cvt_pk_bf16_f32 v91, v46, v47
v_mfma_f32_16x16x32_bf16 v[32:35], a[144:147], v[200:203], v[32:35]
v_exp_f32 v48, v48
v_mfma_f32_16x16x32_bf16 a[0:3], v[72:75], a[176:179], a[0:3]
ds_read_b128 a[148:151], v217 offset:24576
ds_read_b128 a[144:147], v216 offset:24576
v_mfma_f32_16x16x32_bf16 a[16:19], v[72:75], a[180:183], a[16:19]
v_exp_f32 v49, v49
v_mfma_f32_16x16x32_bf16 a[20:23], v[76:79], a[180:183], a[20:23]
v_cvt_pk_bf16_f32 v92, v48, v49
v_mfma_f32_16x16x32_bf16 a[4:7], v[76:79], a[176:179], a[4:7]
v_exp_f32 v50, v50
v_mfma_f32_16x16x32_bf16 a[8:11], v[80:83], a[176:179], a[8:11]
buffer_load_dwordx4 v232, s[12:15], s39 offen offset:0  lds
v_mfma_f32_16x16x32_bf16 a[24:27], v[80:83], a[180:183], a[24:27]
v_exp_f32 v51, v51
v_mfma_f32_16x16x32_bf16 a[28:31], v[84:87], a[180:183], a[28:31]
ds_read_b64_tr_b16 a[180:181], v221 offset:8192
v_cvt_pk_bf16_f32 v93, v50, v51
v_mfma_f32_16x16x32_bf16 a[12:15], v[84:87], a[176:179], a[12:15]
v_exp_f32 v52, v52
v_mfma_f32_16x16x32_bf16 a[44:47], v[84:87], a[184:187], a[44:47]
ds_read_b64_tr_b16 a[182:183], v221 offset:12288
ds_read_b64_tr_b16 a[176:177], v220 offset:8192
v_mfma_f32_16x16x32_bf16 a[60:63], v[84:87], a[188:191], a[60:63]
v_exp_f32 v53, v53
v_mfma_f32_16x16x32_bf16 a[56:59], v[80:83], a[188:191], a[56:59]
ds_read_b64_tr_b16 a[178:179], v220 offset:12288
v_cvt_pk_bf16_f32 v94, v52, v53
v_mfma_f32_16x16x32_bf16 a[40:43], v[80:83], a[184:187], a[40:43]
v_exp_f32 v54, v54
v_mfma_f32_16x16x32_bf16 a[36:39], v[76:79], a[184:187], a[36:39]
buffer_load_dwordx4 v233, s[12:15], s39 offen offset:1024  lds
v_mfma_f32_16x16x32_bf16 a[52:55], v[76:79], a[188:191], a[52:55]
v_exp_f32 v55, v55
v_mfma_f32_16x16x32_bf16 a[48:51], v[72:75], a[188:191], a[48:51]
ds_read_b64_tr_b16 a[188:189], v223 offset:8192
v_cvt_pk_bf16_f32 v95, v54, v55
v_mfma_f32_16x16x32_bf16 a[32:35], v[72:75], a[184:187], a[32:35]
v_exp_f32 v56, v56
v_smfmac_f32_16x16x64_bf16 a[128:131], a[208:211], v[72:79], v245
ds_read_b64_tr_b16 a[190:191], v223 offset:12288
v_mfma_f32_16x16x32_bf16 v[12:15], a[160:163], v[152:155], v[136:139]
v_exp_f32 v57, v57
v_mfma_f32_16x16x32_bf16 v[12:15], a[164:167], v[156:159], v[12:15]
v_exp_f32 v58, v58
v_mfma_f32_16x16x32_bf16 v[12:15], a[168:171], v[160:163], v[12:15]
ds_read_b64_tr_b16 a[184:185], v222 offset:8192
v_cvt_pk_bf16_f32 v96, v56, v57
v_mfma_f32_16x16x32_bf16 v[12:15], a[172:175], v[164:167], v[12:15]
v_exp_f32 v59, v59
v_mfma_f32_16x16x32_bf16 v[20:23], a[172:175], v[180:183], v[140:143]
ds_read_b64_tr_b16 a[186:187], v222 offset:12288
v_cvt_pk_bf16_f32 v97, v58, v59
v_mfma_f32_16x16x32_bf16 v[20:23], a[168:171], v[176:179], v[20:23]
v_exp_f32 v60, v60
v_mfma_f32_16x16x32_bf16 v[20:23], a[164:167], v[172:175], v[20:23]
buffer_load_dwordx4 v232, s[12:15], s39 offen offset:2048  lds
v_mfma_f32_16x16x32_bf16 v[20:23], a[160:163], v[168:171], v[20:23]
v_exp_f32 v61, v61
v_mfma_f32_16x16x32_bf16 v[28:31], a[160:163], v[184:187], v[144:147]
v_cvt_pk_bf16_f32 v98, v60, v61
v_mfma_f32_16x16x32_bf16 v[28:31], a[164:167], v[188:191], v[28:31]
v_exp_f32 v62, v62
v_mfma_f32_16x16x32_bf16 v[28:31], a[168:171], v[192:195], v[28:31]
buffer_load_dwordx4 v233, s[12:15], s39 offen offset:3072  lds
v_mfma_f32_16x16x32_bf16 v[28:31], a[172:175], v[196:199], v[28:31]
v_exp_f32 v63, v63
v_mfma_f32_16x16x32_bf16 v[36:39], a[172:175], v[212:215], v[148:151]
ds_read_b128 a[172:175], v219 offset:28672
v_cvt_pk_bf16_f32 v99, v62, v63
v_mfma_f32_16x16x32_bf16 v[36:39], a[168:171], v[208:211], v[36:39]
v_exp_f32 v64, v64
v_mfma_f32_16x16x32_bf16 v[36:39], a[164:167], v[204:207], v[36:39]
ds_read_b128 a[168:171], v218 offset:28672
ds_read_b128 a[164:167], v217 offset:28672
v_mfma_f32_16x16x32_bf16 v[36:39], a[160:163], v[200:203], v[36:39]
v_exp_f32 v65, v65
s_waitcnt lgkmcnt(8)
v_mfma_f32_16x16x32_bf16 a[64:67], v[72:75], a[192:195], a[64:67]
ds_read_b128 a[160:163], v216 offset:28672
v_cvt_pk_bf16_f32 v100, v64, v65
v_mfma_f32_16x16x32_bf16 a[80:83], v[72:75], a[196:199], a[80:83]
v_exp_f32 v66, v66
v_mfma_f32_16x16x32_bf16 a[84:87], v[76:79], a[196:199], a[84:87]
s_add_u32 m0, s86, 24576
s_add_u32 s50, s84, 3538944
buffer_load_dwordx4 v240, s[64:67], s50 offen lds
v_mfma_f32_16x16x32_bf16 a[68:71], v[76:79], a[192:195], a[68:71]
v_exp_f32 v67, v67
v_mfma_f32_16x16x32_bf16 a[72:75], v[80:83], a[192:195], a[72:75]
v_cvt_pk_bf16_f32 v101, v66, v67
v_mfma_f32_16x16x32_bf16 a[88:91], v[80:83], a[196:199], a[88:91]
v_exp_f32 v68, v68
v_mfma_f32_16x16x32_bf16 a[92:95], v[84:87], a[196:199], a[92:95]
ds_read_b64_tr_b16 a[196:197], v225 offset:8192
ds_read_b64_tr_b16 a[198:199], v225 offset:12288
v_mfma_f32_16x16x32_bf16 a[76:79], v[84:87], a[192:195], a[76:79]
v_exp_f32 v69, v69
v_mfma_f32_16x16x32_bf16 a[108:111], v[84:87], a[200:203], a[108:111]
ds_read_b64_tr_b16 a[192:193], v224 offset:8192
v_cvt_pk_bf16_f32 v102, v68, v69
v_mfma_f32_16x16x32_bf16 a[124:127], v[84:87], a[204:207], a[124:127]
v_exp_f32 v70, v70
v_mfma_f32_16x16x32_bf16 a[120:123], v[80:83], a[204:207], a[120:123]
ds_read_b64_tr_b16 a[194:195], v224 offset:12288
v_mfma_f32_16x16x32_bf16 a[104:107], v[80:83], a[200:203], a[104:107]
v_exp_f32 v71, v71
v_mfma_f32_16x16x32_bf16 a[100:103], v[76:79], a[200:203], a[100:103]
v_cvt_pk_bf16_f32 v103, v70, v71
v_mfma_f32_16x16x32_bf16 a[116:119], v[76:79], a[204:207], a[116:119]
s_add_u32 m0, s86, 28672
s_add_u32 s50, s84, 4128768
buffer_load_dwordx4 v240, s[64:67], s50 offen lds
v_mfma_f32_16x16x32_bf16 a[112:115], v[72:75], a[204:207], a[112:115]
ds_read_b64_tr_b16 a[204:205], v227 offset:8192
ds_read_b64_tr_b16 a[206:207], v227 offset:12288
v_mfma_f32_16x16x32_bf16 a[96:99], v[72:75], a[200:203], a[96:99]
ds_read_b64_tr_b16 a[200:201], v226 offset:8192
ds_read_b64_tr_b16 a[202:203], v226 offset:12288
v_smfmac_f32_16x16x64_bf16 a[132:135], a[208:211], v[80:87], v245
v_mfma_f32_16x16x32_bf16 v[40:43], a[144:147], v[152:155], v[136:139]
v_exp_f32 v8, v8
v_mfma_f32_16x16x32_bf16 v[40:43], a[148:151], v[156:159], v[40:43]
v_exp_f32 v9, v9
v_mfma_f32_16x16x32_bf16 v[40:43], a[152:155], v[160:163], v[40:43]
v_cvt_pk_bf16_f32 v72, v8, v9
v_mfma_f32_16x16x32_bf16 v[40:43], a[156:159], v[164:167], v[40:43]
v_exp_f32 v10, v10
v_mfma_f32_16x16x32_bf16 v[48:51], a[156:159], v[180:183], v[140:143]
v_mfma_f32_16x16x32_bf16 v[48:51], a[152:155], v[176:179], v[48:51]
v_exp_f32 v11, v11
v_mfma_f32_16x16x32_bf16 v[48:51], a[148:151], v[172:175], v[48:51]
v_cvt_pk_bf16_f32 v73, v10, v11
v_mfma_f32_16x16x32_bf16 v[48:51], a[144:147], v[168:171], v[48:51]
v_exp_f32 v12, v12
v_mfma_f32_16x16x32_bf16 v[56:59], a[144:147], v[184:187], v[144:147]
v_mfma_f32_16x16x32_bf16 v[56:59], a[148:151], v[188:191], v[56:59]
v_exp_f32 v13, v13
v_mfma_f32_16x16x32_bf16 v[56:59], a[152:155], v[192:195], v[56:59]
v_cvt_pk_bf16_f32 v74, v12, v13
v_mfma_f32_16x16x32_bf16 v[56:59], a[156:159], v[196:199], v[56:59]
v_exp_f32 v14, v14
v_mfma_f32_16x16x32_bf16 v[64:67], a[156:159], v[212:215], v[148:151]
s_waitcnt vmcnt(12) lgkmcnt(0)
s_barrier
v_mfma_f32_16x16x32_bf16 v[64:67], a[152:155], v[208:211], v[64:67]
v_exp_f32 v15, v15
v_mfma_f32_16x16x32_bf16 v[64:67], a[148:151], v[204:207], v[64:67]
ds_read_b128 a[156:159], v219 offset:49152
v_cvt_pk_bf16_f32 v75, v14, v15
v_mfma_f32_16x16x32_bf16 v[64:67], a[144:147], v[200:203], v[64:67]
v_exp_f32 v16, v16
v_mfma_f32_16x16x32_bf16 a[0:3], v[88:91], a[176:179], a[0:3]
ds_read_b128 a[152:155], v218 offset:49152
ds_read_b128 a[148:151], v217 offset:49152
v_mfma_f32_16x16x32_bf16 a[16:19], v[88:91], a[180:183], a[16:19]
v_exp_f32 v17, v17
v_mfma_f32_16x16x32_bf16 a[20:23], v[92:95], a[180:183], a[20:23]
ds_read_b128 a[144:147], v216 offset:49152
v_cvt_pk_bf16_f32 v76, v16, v17
v_mfma_f32_16x16x32_bf16 a[4:7], v[92:95], a[176:179], a[4:7]
v_exp_f32 v18, v18
v_mfma_f32_16x16x32_bf16 a[8:11], v[96:99], a[176:179], a[8:11]
s_add_u32 s32, s32, 16384
s_add_u32 m0, s30, 81920
v_mfma_f32_16x16x32_bf16 a[24:27], v[96:99], a[180:183], a[24:27]
v_exp_f32 v19, v19
v_mfma_f32_16x16x32_bf16 a[28:31], v[100:103], a[180:183], a[28:31]
ds_read_b64_tr_b16 a[180:181], v221 offset:32768
v_cvt_pk_bf16_f32 v77, v18, v19
v_mfma_f32_16x16x32_bf16 a[12:15], v[100:103], a[176:179], a[12:15]
v_exp_f32 v20, v20
v_mfma_f32_16x16x32_bf16 a[44:47], v[100:103], a[184:187], a[44:47]
ds_read_b64_tr_b16 a[182:183], v221 offset:36864
ds_read_b64_tr_b16 a[176:177], v220 offset:32768
v_mfma_f32_16x16x32_bf16 a[60:63], v[100:103], a[188:191], a[60:63]
v_exp_f32 v21, v21
v_mfma_f32_16x16x32_bf16 a[56:59], v[96:99], a[188:191], a[56:59]
ds_read_b64_tr_b16 a[178:179], v220 offset:36864
v_cvt_pk_bf16_f32 v78, v20, v21
v_mfma_f32_16x16x32_bf16 a[40:43], v[96:99], a[184:187], a[40:43]
v_exp_f32 v22, v22
v_mfma_f32_16x16x32_bf16 a[36:39], v[92:95], a[184:187], a[36:39]
buffer_load_dwordx4 v228, s[8:11], s32 offen offset:0  lds
v_mfma_f32_16x16x32_bf16 a[52:55], v[92:95], a[188:191], a[52:55]
v_exp_f32 v23, v23
v_mfma_f32_16x16x32_bf16 a[48:51], v[88:91], a[188:191], a[48:51]
ds_read_b64_tr_b16 a[188:189], v223 offset:32768
v_cvt_pk_bf16_f32 v79, v22, v23
v_mfma_f32_16x16x32_bf16 a[32:35], v[88:91], a[184:187], a[32:35]
v_exp_f32 v24, v24
v_smfmac_f32_16x16x64_bf16 a[128:131], a[208:211], v[88:95], v245
ds_read_b64_tr_b16 a[190:191], v223 offset:36864
v_mfma_f32_16x16x32_bf16 v[44:47], a[160:163], v[152:155], v[136:139]
v_exp_f32 v25, v25
v_mfma_f32_16x16x32_bf16 v[44:47], a[164:167], v[156:159], v[44:47]
v_exp_f32 v26, v26
v_mfma_f32_16x16x32_bf16 v[44:47], a[168:171], v[160:163], v[44:47]
ds_read_b64_tr_b16 a[184:185], v222 offset:32768
v_cvt_pk_bf16_f32 v80, v24, v25
v_mfma_f32_16x16x32_bf16 v[44:47], a[172:175], v[164:167], v[44:47]
v_exp_f32 v27, v27
v_mfma_f32_16x16x32_bf16 v[52:55], a[172:175], v[180:183], v[140:143]
ds_read_b64_tr_b16 a[186:187], v222 offset:36864
v_cvt_pk_bf16_f32 v81, v26, v27
v_mfma_f32_16x16x32_bf16 v[52:55], a[168:171], v[176:179], v[52:55]
v_exp_f32 v28, v28
v_mfma_f32_16x16x32_bf16 v[52:55], a[164:167], v[172:175], v[52:55]
buffer_load_dwordx4 v229, s[8:11], s32 offen offset:1024  lds
v_mfma_f32_16x16x32_bf16 v[52:55], a[160:163], v[168:171], v[52:55]
v_exp_f32 v29, v29
v_mfma_f32_16x16x32_bf16 v[60:63], a[160:163], v[184:187], v[144:147]
v_cmp_ne_u32 vcc, s47, v249
s_cbranch_vccnz SP_CAND
SP_CAND_RET:
v_cvt_pk_bf16_f32 v82, v28, v29
v_mfma_f32_16x16x32_bf16 v[60:63], a[164:167], v[188:191], v[60:63]
v_mov_b32 v251, 0
v_exp_f32 v30, v30
v_mfma_f32_16x16x32_bf16 v[60:63], a[168:171], v[192:195], v[60:63]
buffer_load_dwordx4 v230, s[8:11], s32 offen offset:2048  lds
v_mfma_f32_16x16x32_bf16 v[60:63], a[172:175], v[196:199], v[60:63]
v_exp_f32 v31, v31
v_mfma_f32_16x16x32_bf16 v[68:71], a[172:175], v[212:215], v[148:151]
ds_read_b128 a[172:175], v219 offset:53248
v_cvt_pk_bf16_f32 v83, v30, v31
v_mfma_f32_16x16x32_bf16 v[68:71], a[168:171], v[208:211], v[68:71]
v_exp_f32 v32, v32
v_mfma_f32_16x16x32_bf16 v[68:71], a[164:167], v[204:207], v[68:71]
ds_read_b128 a[168:171], v218 offset:53248
ds_read_b128 a[164:167], v217 offset:53248
v_mfma_f32_16x16x32_bf16 v[68:71], a[160:163], v[200:203], v[68:71]
v_exp_f32 v33, v33
v_mfma_f32_16x16x32_bf16 a[64:67], v[88:91], a[192:195], a[64:67]
ds_read_b128 a[160:163], v216 offset:53248
v_cvt_pk_bf16_f32 v84, v32, v33
v_mfma_f32_16x16x32_bf16 a[80:83], v[88:91], a[196:199], a[80:83]
v_exp_f32 v34, v34
v_mfma_f32_16x16x32_bf16 a[84:87], v[92:95], a[196:199], a[84:87]
buffer_load_dwordx4 v231, s[8:11], s32 offen offset:3072  lds
v_mfma_f32_16x16x32_bf16 a[68:71], v[92:95], a[192:195], a[68:71]
v_exp_f32 v35, v35
v_mfma_f32_16x16x32_bf16 a[72:75], v[96:99], a[192:195], a[72:75]
s_mov_b32 s90, 0x01010101
s_mov_b32 s91, 0x01010101
v_cvt_pk_bf16_f32 v85, v34, v35
v_mfma_f32_16x16x32_bf16 a[88:91], v[96:99], a[196:199], a[88:91]
v_exp_f32 v36, v36
v_mfma_f32_16x16x32_bf16 a[92:95], v[100:103], a[196:199], a[92:95]
ds_read_b64_tr_b16 a[196:197], v225 offset:32768
ds_read_b64_tr_b16 a[198:199], v225 offset:36864
v_max_u32_dpp v250, v248, v248 row_ror:8 row_mask:0xf bank_mask:0xf
v_mfma_f32_16x16x32_bf16 a[76:79], v[100:103], a[192:195], a[76:79]
v_exp_f32 v37, v37
v_mfma_f32_16x16x32_bf16 a[108:111], v[100:103], a[200:203], a[108:111]
ds_read_b64_tr_b16 a[192:193], v224 offset:32768
v_cvt_pk_bf16_f32 v86, v36, v37
v_max_u32_dpp v249, v250, v250 row_ror:4 row_mask:0xf bank_mask:0xf
v_mfma_f32_16x16x32_bf16 a[124:127], v[100:103], a[204:207], a[124:127]
v_exp_f32 v38, v38
v_mfma_f32_16x16x32_bf16 a[120:123], v[96:99], a[204:207], a[120:123]
ds_read_b64_tr_b16 a[194:195], v224 offset:36864
v_max_u32_dpp v250, v249, v249 row_ror:2 row_mask:0xf bank_mask:0xf
v_mfma_f32_16x16x32_bf16 a[104:107], v[96:99], a[200:203], a[104:107]
v_exp_f32 v39, v39
v_mfma_f32_16x16x32_bf16 a[100:103], v[92:95], a[200:203], a[100:103]
v_cvt_pk_bf16_f32 v87, v38, v39
v_max_u32_dpp v249, v250, v250 row_ror:1 row_mask:0xf bank_mask:0xf
v_mov_b32 v250, v249
v_mfma_f32_16x16x32_bf16 a[116:119], v[92:95], a[204:207], a[116:119]
s_add_u32 m0, s86, 32768
s_add_u32 s50, s84, 0
buffer_load_dwordx4 v240, s[68:71], s50 offen lds
v_mfma_f32_16x16x32_bf16 a[112:115], v[88:91], a[204:207], a[112:115]
ds_read_b64_tr_b16 a[204:205], v227 offset:32768
ds_read_b64_tr_b16 a[206:207], v227 offset:36864
v_permlane16_swap_b32 v249, v250
v_mfma_f32_16x16x32_bf16 a[96:99], v[88:91], a[200:203], a[96:99]
ds_read_b64_tr_b16 a[200:201], v226 offset:32768
ds_read_b64_tr_b16 a[202:203], v226 offset:36864
v_max_u32 v249, v249, v250
v_smfmac_f32_16x16x64_bf16 a[132:135], a[208:211], v[96:103], v245
s_add_u32 m0, s86, 36864
s_add_u32 s50, s84, 589824
buffer_load_dwordx4 v240, s[68:71], s50 offen lds
s_waitcnt lgkmcnt(8)
v_mfma_f32_16x16x32_bf16 v[8:11], a[144:147], v[152:155], v[136:139]
v_mov_b32 v250, v249
v_exp_f32 v40, v40
v_mfma_f32_16x16x32_bf16 v[8:11], a[148:151], v[156:159], v[8:11]
v_exp_f32 v41, v41
v_mfma_f32_16x16x32_bf16 v[8:11], a[152:155], v[160:163], v[8:11]
v_cvt_pk_bf16_f32 v88, v40, v41
STUB_5:
s_cbranch_execz STUB_8
v_permlane32_swap_b32 v249, v250
v_max_u32 v249, v249, v250
v_mfma_f32_16x16x32_bf16 v[8:11], a[156:159], v[164:167], v[8:11]
v_exp_f32 v42, v42
v_mfma_f32_16x16x32_bf16 v[16:19], a[156:159], v[180:183], v[140:143]
s_add_u32 s39, s39, 16384
v_add_u32 v251, v251, v249
v_mfma_f32_16x16x32_bf16 v[16:19], a[152:155], v[176:179], v[16:19]
v_exp_f32 v43, v43
v_mfma_f32_16x16x32_bf16 v[16:19], a[148:151], v[172:175], v[16:19]
v_cvt_pk_bf16_f32 v89, v42, v43
v_sub_u32 v248, v248, v249
v_mfma_f32_16x16x32_bf16 v[16:19], a[144:147], v[168:171], v[16:19]
v_exp_f32 v44, v44
v_mfma_f32_16x16x32_bf16 v[24:27], a[144:147], v[184:187], v[144:147]
v_cndmask_b32 v252, v252, v251, s[90:91]
v_mfma_f32_16x16x32_bf16 v[24:27], a[148:151], v[188:191], v[24:27]
v_exp_f32 v45, v45
v_mfma_f32_16x16x32_bf16 v[24:27], a[152:155], v[192:195], v[24:27]
s_add_u32 m0, s30, 98304
v_cvt_pk_bf16_f32 v90, v44, v45
v_mfma_f32_16x16x32_bf16 v[24:27], a[156:159], v[196:199], v[24:27]
v_exp_f32 v46, v46
v_mfma_f32_16x16x32_bf16 v[32:35], a[156:159], v[212:215], v[148:151]
ds_read_b128 a[156:159], v219 offset:57344
v_readfirstlane_b32 s76, v251
v_mfma_f32_16x16x32_bf16 v[32:35], a[152:155], v[208:211], v[32:35]
v_exp_f32 v47, v47
v_mfma_f32_16x16x32_bf16 v[32:35], a[148:151], v[204:207], v[32:35]
ds_read_b128 a[152:155], v218 offset:57344
v_cvt_pk_bf16_f32 v91, v46, v47
v_mfma_f32_16x16x32_bf16 v[32:35], a[144:147], v[200:203], v[32:35]
v_exp_f32 v48, v48
v_mfma_f32_16x16x32_bf16 a[0:3], v[72:75], a[176:179], a[0:3]
ds_read_b128 a[148:151], v217 offset:57344
ds_read_b128 a[144:147], v216 offset:57344
v_mfma_f32_16x16x32_bf16 a[16:19], v[72:75], a[180:183], a[16:19]
v_exp_f32 v49, v49
v_mfma_f32_16x16x32_bf16 a[20:23], v[76:79], a[180:183], a[20:23]
s_lshl_b64 s[90:91], s[90:91], 1
v_cvt_pk_bf16_f32 v92, v48, v49
v_mfma_f32_16x16x32_bf16 a[4:7], v[76:79], a[176:179], a[4:7]
v_exp_f32 v50, v50
v_mfma_f32_16x16x32_bf16 a[8:11], v[80:83], a[176:179], a[8:11]
buffer_load_dwordx4 v232, s[12:15], s39 offen offset:0  lds
v_mfma_f32_16x16x32_bf16 a[24:27], v[80:83], a[180:183], a[24:27]
v_exp_f32 v51, v51
v_mfma_f32_16x16x32_bf16 a[28:31], v[84:87], a[180:183], a[28:31]
ds_read_b64_tr_b16 a[180:181], v221 offset:40960
v_cvt_pk_bf16_f32 v93, v50, v51
v_mfma_f32_16x16x32_bf16 a[12:15], v[84:87], a[176:179], a[12:15]
v_exp_f32 v52, v52
v_mfma_f32_16x16x32_bf16 a[44:47], v[84:87], a[184:187], a[44:47]
ds_read_b64_tr_b16 a[182:183], v221 offset:45056
ds_read_b64_tr_b16 a[176:177], v220 offset:40960
v_mfma_f32_16x16x32_bf16 a[60:63], v[84:87], a[188:191], a[60:63]
v_exp_f32 v53, v53
v_mfma_f32_16x16x32_bf16 a[56:59], v[80:83], a[188:191], a[56:59]
ds_read_b64_tr_b16 a[178:179], v220 offset:45056
v_cvt_pk_bf16_f32 v94, v52, v53
v_mfma_f32_16x16x32_bf16 a[40:43], v[80:83], a[184:187], a[40:43]
v_max_u32_dpp v250, v248, v248 row_ror:8 row_mask:0xf bank_mask:0xf
v_exp_f32 v54, v54
v_mfma_f32_16x16x32_bf16 a[36:39], v[76:79], a[184:187], a[36:39]
buffer_load_dwordx4 v233, s[12:15], s39 offen offset:1024  lds
v_mfma_f32_16x16x32_bf16 a[52:55], v[76:79], a[188:191], a[52:55]
v_exp_f32 v55, v55
v_mfma_f32_16x16x32_bf16 a[48:51], v[72:75], a[188:191], a[48:51]
ds_read_b64_tr_b16 a[188:189], v223 offset:40960
v_cvt_pk_bf16_f32 v95, v54, v55
v_mfma_f32_16x16x32_bf16 a[32:35], v[72:75], a[184:187], a[32:35]
v_exp_f32 v56, v56
v_smfmac_f32_16x16x64_bf16 a[128:131], a[208:211], v[72:79], v245
ds_read_b64_tr_b16 a[190:191], v223 offset:45056
v_max_u32_dpp v249, v250, v250 row_ror:4 row_mask:0xf bank_mask:0xf
v_mfma_f32_16x16x32_bf16 v[12:15], a[160:163], v[152:155], v[136:139]
v_exp_f32 v57, v57
v_mfma_f32_16x16x32_bf16 v[12:15], a[164:167], v[156:159], v[12:15]
v_exp_f32 v58, v58
v_mfma_f32_16x16x32_bf16 v[12:15], a[168:171], v[160:163], v[12:15]
ds_read_b64_tr_b16 a[184:185], v222 offset:40960
v_cvt_pk_bf16_f32 v96, v56, v57
v_mfma_f32_16x16x32_bf16 v[12:15], a[172:175], v[164:167], v[12:15]
v_max_u32_dpp v250, v249, v249 row_ror:2 row_mask:0xf bank_mask:0xf
v_exp_f32 v59, v59
v_mfma_f32_16x16x32_bf16 v[20:23], a[172:175], v[180:183], v[140:143]
ds_read_b64_tr_b16 a[186:187], v222 offset:45056
v_cvt_pk_bf16_f32 v97, v58, v59
v_mfma_f32_16x16x32_bf16 v[20:23], a[168:171], v[176:179], v[20:23]
v_exp_f32 v60, v60
v_mfma_f32_16x16x32_bf16 v[20:23], a[164:167], v[172:175], v[20:23]
buffer_load_dwordx4 v232, s[12:15], s39 offen offset:2048  lds
v_mfma_f32_16x16x32_bf16 v[20:23], a[160:163], v[168:171], v[20:23]
v_exp_f32 v61, v61
v_mfma_f32_16x16x32_bf16 v[28:31], a[160:163], v[184:187], v[144:147]
v_cvt_pk_bf16_f32 v98, v60, v61
v_max_u32_dpp v249, v250, v250 row_ror:1 row_mask:0xf bank_mask:0xf
v_mfma_f32_16x16x32_bf16 v[28:31], a[164:167], v[188:191], v[28:31]
v_exp_f32 v62, v62
v_mfma_f32_16x16x32_bf16 v[28:31], a[168:171], v[192:195], v[28:31]
buffer_load_dwordx4 v233, s[12:15], s39 offen offset:3072  lds
v_mfma_f32_16x16x32_bf16 v[28:31], a[172:175], v[196:199], v[28:31]
v_exp_f32 v63, v63
v_mfma_f32_16x16x32_bf16 v[36:39], a[172:175], v[212:215], v[148:151]
ds_read_b128 a[172:175], v219 offset:61440
v_cvt_pk_bf16_f32 v99, v62, v63
v_mov_b32 v250, v249
v_mfma_f32_16x16x32_bf16 v[36:39], a[168:171], v[208:211], v[36:39]
v_exp_f32 v64, v64
v_mfma_f32_16x16x32_bf16 v[36:39], a[164:167], v[204:207], v[36:39]
ds_read_b128 a[168:171], v218 offset:61440
ds_read_b128 a[164:167], v217 offset:61440
v_mfma_f32_16x16x32_bf16 v[36:39], a[160:163], v[200:203], v[36:39]
v_exp_f32 v65, v65
s_waitcnt lgkmcnt(8)
v_mfma_f32_16x16x32_bf16 a[64:67], v[72:75], a[192:195], a[64:67]
ds_read_b128 a[160:163], v216 offset:61440
v_cvt_pk_bf16_f32 v100, v64, v65
v_mfma_f32_16x16x32_bf16 a[80:83], v[72:75], a[196:199], a[80:83]
v_permlane16_swap_b32 v249, v250
v_exp_f32 v66, v66
v_mfma_f32_16x16x32_bf16 a[84:87], v[76:79], a[196:199], a[84:87]
s_add_u32 m0, s86, 40960
s_add_u32 s50, s84, 1179648
buffer_load_dwordx4 v240, s[68:71], s50 offen lds
v_mfma_f32_16x16x32_bf16 a[68:71], v[76:79], a[192:195], a[68:71]
v_exp_f32 v67, v67
v_mfma_f32_16x16x32_bf16 a[72:75], v[80:83], a[192:195], a[72:75]
v_cvt_pk_bf16_f32 v101, v66, v67
v_max_u32 v249, v249, v250
v_mfma_f32_16x16x32_bf16 a[88:91], v[80:83], a[196:199], a[88:91]
v_exp_f32 v68, v68
v_mfma_f32_16x16x32_bf16 a[92:95], v[84:87], a[196:199], a[92:95]
ds_read_b64_tr_b16 a[196:197], v225 offset:40960
ds_read_b64_tr_b16 a[198:199], v225 offset:45056
v_mfma_f32_16x16x32_bf16 a[76:79], v[84:87], a[192:195], a[76:79]
v_exp_f32 v69, v69
v_mfma_f32_16x16x32_bf16 a[108:111], v[84:87], a[200:203], a[108:111]
ds_read_b64_tr_b16 a[192:193], v224 offset:40960
v_cvt_pk_bf16_f32 v102, v68, v69
v_mfma_f32_16x16x32_bf16 a[124:127], v[84:87], a[204:207], a[124:127]
v_exp_f32 v70, v70
v_mfma_f32_16x16x32_bf16 a[120:123], v[80:83], a[204:207], a[120:123]
ds_read_b64_tr_b16 a[194:195], v224 offset:45056
v_mov_b32 v250, v249
v_mfma_f32_16x16x32_bf16 a[104:107], v[80:83], a[200:203], a[104:107]
v_exp_f32 v71, v71
v_mfma_f32_16x16x32_bf16 a[100:103], v[76:79], a[200:203], a[100:103]
v_cvt_pk_bf16_f32 v103, v70, v71
v_permlane32_swap_b32 v249, v250
v_mfma_f32_16x16x32_bf16 a[116:119], v[76:79], a[204:207], a[116:119]
s_add_u32 m0, s86, 45056
s_add_u32 s50, s84, 1769472
buffer_load_dwordx4 v240, s[68:71], s50 offen lds
v_mfma_f32_16x16x32_bf16 a[112:115], v[72:75], a[204:207], a[112:115]
ds_read_b64_tr_b16 a[204:205], v227 offset:40960
ds_read_b64_tr_b16 a[206:207], v227 offset:45056
v_mfma_f32_16x16x32_bf16 a[96:99], v[72:75], a[200:203], a[96:99]
ds_read_b64_tr_b16 a[200:201], v226 offset:40960
ds_read_b64_tr_b16 a[202:203], v226 offset:45056
v_smfmac_f32_16x16x64_bf16 a[132:135], a[208:211], v[80:87], v245
v_max_u32 v249, v249, v250
v_mfma_f32_16x16x32_bf16 v[40:43], a[144:147], v[152:155], v[136:139]
v_exp_f32 v8, v8
v_mfma_f32_16x16x32_bf16 v[40:43], a[148:151], v[156:159], v[40:43]
v_exp_f32 v9, v9
v_mfma_f32_16x16x32_bf16 v[40:43], a[152:155], v[160:163], v[40:43]
v_cvt_pk_bf16_f32 v72, v8, v9
v_lshlrev_b32 v246, 2, v1
v_mfma_f32_16x16x32_bf16 v[40:43], a[156:159], v[164:167], v[40:43]
v_exp_f32 v10, v10
v_mfma_f32_16x16x32_bf16 v[48:51], a[156:159], v[180:183], v[140:143]
v_add_u32 v251, v251, v249
v_sub_u32 v248, v248, v249
v_mfma_f32_16x16x32_bf16 v[48:51], a[152:155], v[176:179], v[48:51]
v_exp_f32 v11, v11
v_mfma_f32_16x16x32_bf16 v[48:51], a[148:151], v[172:175], v[48:51]
v_cvt_pk_bf16_f32 v73, v10, v11
v_cndmask_b32 v252, v252, v251, s[90:91]
v_mfma_f32_16x16x32_bf16 v[48:51], a[144:147], v[168:171], v[48:51]
v_exp_f32 v12, v12
v_mfma_f32_16x16x32_bf16 v[56:59], a[144:147], v[184:187], v[144:147]
v_readfirstlane_b32 s77, v251
v_mfma_f32_16x16x32_bf16 v[56:59], a[148:151], v[188:191], v[56:59]
v_exp_f32 v13, v13
v_mfma_f32_16x16x32_bf16 v[56:59], a[152:155], v[192:195], v[56:59]
s_lshl_b64 s[90:91], s[90:91], 1
v_cvt_pk_bf16_f32 v74, v12, v13
v_mfma_f32_16x16x32_bf16 v[56:59], a[156:159], v[196:199], v[56:59]
v_exp_f32 v14, v14
v_mfma_f32_16x16x32_bf16 v[64:67], a[156:159], v[212:215], v[148:151]
s_waitcnt vmcnt(12) lgkmcnt(0)
s_barrier
v_mfma_f32_16x16x32_bf16 v[64:67], a[152:155], v[208:211], v[64:67]
v_exp_f32 v15, v15
v_mfma_f32_16x16x32_bf16 v[64:67], a[148:151], v[204:207], v[64:67]
ds_read_b128 a[156:159], v219 offset:0
v_cvt_pk_bf16_f32 v75, v14, v15
v_mfma_f32_16x16x32_bf16 v[64:67], a[144:147], v[200:203], v[64:67]
v_exp_f32 v16, v16
v_mfma_f32_16x16x32_bf16 a[0:3], v[88:91], a[176:179], a[0:3]
ds_read_b128 a[152:155], v218 offset:0
ds_read_b128 a[148:151], v217 offset:0
v_mfma_f32_16x16x32_bf16 a[16:19], v[88:91], a[180:183], a[16:19]
v_exp_f32 v17, v17
v_mfma_f32_16x16x32_bf16 a[20:23], v[92:95], a[180:183], a[20:23]
ds_read_b128 a[144:147], v216 offset:0
v_cvt_pk_bf16_f32 v76, v16, v17
v_mfma_f32_16x16x32_bf16 a[4:7], v[92:95], a[176:179], a[4:7]
v_exp_f32 v18, v18
v_mfma_f32_16x16x32_bf16 a[8:11], v[96:99], a[176:179], a[8:11]
s_add_u32 s32, s32, 16384
s_add_u32 m0, s30, 114688
v_mfma_f32_16x16x32_bf16 a[24:27], v[96:99], a[180:183], a[24:27]
v_exp_f32 v19, v19
v_mfma_f32_16x16x32_bf16 a[28:31], v[100:103], a[180:183], a[28:31]
ds_read_b64_tr_b16 a[180:181], v221 offset:49152
v_cvt_pk_bf16_f32 v77, v18, v19
v_mfma_f32_16x16x32_bf16 a[12:15], v[100:103], a[176:179], a[12:15]
v_exp_f32 v20, v20
v_mfma_f32_16x16x32_bf16 a[44:47], v[100:103], a[184:187], a[44:47]
ds_read_b64_tr_b16 a[182:183], v221 offset:53248
ds_read_b64_tr_b16 a[176:177], v220 offset:49152
v_mfma_f32_16x16x32_bf16 a[60:63], v[100:103], a[188:191], a[60:63]
v_exp_f32 v21, v21
v_mfma_f32_16x16x32_bf16 a[56:59], v[96:99], a[188:191], a[56:59]
ds_read_b64_tr_b16 a[178:179], v220 offset:53248
v_cvt_pk_bf16_f32 v78, v20, v21
v_mfma_f32_16x16x32_bf16 a[40:43], v[96:99], a[184:187], a[40:43]
v_exp_f32 v22, v22
v_mfma_f32_16x16x32_bf16 a[36:39], v[92:95], a[184:187], a[36:39]
buffer_load_dwordx4 v228, s[8:11], s32 offen offset:0  lds
v_mfma_f32_16x16x32_bf16 a[52:55], v[92:95], a[188:191], a[52:55]
v_max_u32_dpp v250, v248, v248 row_ror:8 row_mask:0xf bank_mask:0xf
v_exp_f32 v23, v23
v_mfma_f32_16x16x32_bf16 a[48:51], v[88:91], a[188:191], a[48:51]
ds_read_b64_tr_b16 a[188:189], v223 offset:49152
v_cvt_pk_bf16_f32 v79, v22, v23
v_mfma_f32_16x16x32_bf16 a[32:35], v[88:91], a[184:187], a[32:35]
v_exp_f32 v24, v24
v_smfmac_f32_16x16x64_bf16 a[128:131], a[208:211], v[88:95], v245
ds_read_b64_tr_b16 a[190:191], v223 offset:53248
v_mfma_f32_16x16x32_bf16 v[44:47], a[160:163], v[152:155], v[136:139]
v_exp_f32 v25, v25
v_mfma_f32_16x16x32_bf16 v[44:47], a[164:167], v[156:159], v[44:47]
v_max_u32_dpp v249, v250, v250 row_ror:4 row_mask:0xf bank_mask:0xf
v_exp_f32 v26, v26
v_mfma_f32_16x16x32_bf16 v[44:47], a[168:171], v[160:163], v[44:47]
ds_read_b64_tr_b16 a[184:185], v222 offset:49152
v_cvt_pk_bf16_f32 v80, v24, v25
v_mfma_f32_16x16x32_bf16 v[44:47], a[172:175], v[164:167], v[44:47]
v_exp_f32 v27, v27
v_mfma_f32_16x16x32_bf16 v[52:55], a[172:175], v[180:183], v[140:143]
ds_read_b64_tr_b16 a[186:187], v222 offset:53248
v_cvt_pk_bf16_f32 v81, v26, v27
v_mfma_f32_16x16x32_bf16 v[52:55], a[168:171], v[176:179], v[52:55]
v_max_u32_dpp v250, v249, v249 row_ror:2 row_mask:0xf bank_mask:0xf
v_exp_f32 v28, v28
v_mfma_f32_16x16x32_bf16 v[52:55], a[164:167], v[172:175], v[52:55]
buffer_load_dwordx4 v229, s[8:11], s32 offen offset:1024  lds
v_mfma_f32_16x16x32_bf16 v[52:55], a[160:163], v[168:171], v[52:55]
v_exp_f32 v29, v29
v_mfma_f32_16x16x32_bf16 v[60:63], a[160:163], v[184:187], v[144:147]
v_cvt_pk_bf16_f32 v82, v28, v29
v_max_u32_dpp v249, v250, v250 row_ror:1 row_mask:0xf bank_mask:0xf
v_mfma_f32_16x16x32_bf16 v[60:63], a[164:167], v[188:191], v[60:63]
v_exp_f32 v30, v30
v_mfma_f32_16x16x32_bf16 v[60:63], a[168:171], v[192:195], v[60:63]
buffer_load_dwordx4 v230, s[8:11], s32 offen offset:2048  lds
v_mfma_f32_16x16x32_bf16 v[60:63], a[172:175], v[196:199], v[60:63]
v_exp_f32 v31, v31
v_mfma_f32_16x16x32_bf16 v[68:71], a[172:175], v[212:215], v[148:151]
ds_read_b128 a[172:175], v219 offset:4096
v_cvt_pk_bf16_f32 v83, v30, v31
v_mfma_f32_16x16x32_bf16 v[68:71], a[168:171], v[208:211], v[68:71]
v_exp_f32 v32, v32
v_mfma_f32_16x16x32_bf16 v[68:71], a[164:167], v[204:207], v[68:71]
ds_read_b128 a[168:171], v218 offset:4096
ds_read_b128 a[164:167], v217 offset:4096
v_mov_b32 v250, v249
v_mfma_f32_16x16x32_bf16 v[68:71], a[160:163], v[200:203], v[68:71]
v_exp_f32 v33, v33
v_mfma_f32_16x16x32_bf16 a[64:67], v[88:91], a[192:195], a[64:67]
ds_read_b128 a[160:163], v216 offset:4096
v_cvt_pk_bf16_f32 v84, v32, v33
v_mfma_f32_16x16x32_bf16 a[80:83], v[88:91], a[196:199], a[80:83]
v_exp_f32 v34, v34
v_mfma_f32_16x16x32_bf16 a[84:87], v[92:95], a[196:199], a[84:87]
buffer_load_dwordx4 v231, s[8:11], s32 offen offset:3072  lds
v_mfma_f32_16x16x32_bf16 a[68:71], v[92:95], a[192:195], a[68:71]
v_permlane16_swap_b32 v249, v250
v_exp_f32 v35, v35
v_mfma_f32_16x16x32_bf16 a[72:75], v[96:99], a[192:195], a[72:75]
v_cvt_pk_bf16_f32 v85, v34, v35
v_max_u32 v249, v249, v250
v_mfma_f32_16x16x32_bf16 a[88:91], v[96:99], a[196:199], a[88:91]
v_exp_f32 v36, v36
v_mfma_f32_16x16x32_bf16 a[92:95], v[100:103], a[196:199], a[92:95]
ds_read_b64_tr_b16 a[196:197], v225 offset:49152
ds_read_b64_tr_b16 a[198:199], v225 offset:53248
v_mfma_f32_16x16x32_bf16 a[76:79], v[100:103], a[192:195], a[76:79]
v_exp_f32 v37, v37
v_mfma_f32_16x16x32_bf16 a[108:111], v[100:103], a[200:203], a[108:111]
ds_read_b64_tr_b16 a[192:193], v224 offset:49152
v_cvt_pk_bf16_f32 v86, v36, v37
v_mfma_f32_16x16x32_bf16 a[124:127], v[100:103], a[204:207], a[124:127]
v_exp_f32 v38, v38
v_mfma_f32_16x16x32_bf16 a[120:123], v[96:99], a[204:207], a[120:123]
ds_read_b64_tr_b16 a[194:195], v224 offset:53248
v_mov_b32 v250, v249
v_mfma_f32_16x16x32_bf16 a[104:107], v[96:99], a[200:203], a[104:107]
v_exp_f32 v39, v39
v_mfma_f32_16x16x32_bf16 a[100:103], v[92:95], a[200:203], a[100:103]
v_cvt_pk_bf16_f32 v87, v38, v39
v_permlane32_swap_b32 v249, v250
v_mfma_f32_16x16x32_bf16 a[116:119], v[92:95], a[204:207], a[116:119]
s_add_u32 m0, s86, 49152
s_add_u32 s50, s84, 2359296
buffer_load_dwordx4 v240, s[68:71], s50 offen lds
v_mfma_f32_16x16x32_bf16 a[112:115], v[88:91], a[204:207], a[112:115]
ds_read_b64_tr_b16 a[204:205], v227 offset:49152
ds_read_b64_tr_b16 a[206:207], v227 offset:53248
v_mfma_f32_16x16x32_bf16 a[96:99], v[88:91], a[200:203], a[96:99]
ds_read_b64_tr_b16 a[200:201], v226 offset:49152
ds_read_b64_tr_b16 a[202:203], v226 offset:53248
v_smfmac_f32_16x16x64_bf16 a[132:135], a[208:211], v[96:103], v245
s_add_u32 m0, s86, 53248
s_add_u32 s50, s84, 2949120
buffer_load_dwordx4 v240, s[68:71], s50 offen lds
s_waitcnt lgkmcnt(8)
v_mfma_f32_16x16x32_bf16 v[8:11], a[144:147], v[152:155], v[136:139]
v_exp_f32 v40, v40
v_mfma_f32_16x16x32_bf16 v[8:11], a[148:151], v[156:159], v[8:11]
v_exp_f32 v41, v41
v_mfma_f32_16x16x32_bf16 v[8:11], a[152:155], v[160:163], v[8:11]
v_cvt_pk_bf16_f32 v88, v40, v41
v_max_u32 v249, v249, v250
v_mfma_f32_16x16x32_bf16 v[8:11], a[156:159], v[164:167], v[8:11]
v_exp_f32 v42, v42
v_mfma_f32_16x16x32_bf16 v[16:19], a[156:159], v[180:183], v[140:143]
s_add_u32 s39, s39, 16384
v_add_u32 v251, v251, v249
v_mfma_f32_16x16x32_bf16 v[16:19], a[152:155], v[176:179], v[16:19]
v_exp_f32 v43, v43
v_mfma_f32_16x16x32_bf16 v[16:19], a[148:151], v[172:175], v[16:19]
v_cvt_pk_bf16_f32 v89, v42, v43
v_sub_u32 v248, v248, v249
v_mfma_f32_16x16x32_bf16 v[16:19], a[144:147], v[168:171], v[16:19]
v_exp_f32 v44, v44
v_mfma_f32_16x16x32_bf16 v[24:27], a[144:147], v[184:187], v[144:147]
buffer_load_dword v253, v246, s[24:27], 0 offen sc0 sc1
v_mfma_f32_16x16x32_bf16 v[24:27], a[148:151], v[188:191], v[24:27]
v_exp_f32 v45, v45
v_mfma_f32_16x16x32_bf16 v[24:27], a[152:155], v[192:195], v[24:27]
s_add_u32 m0, s30, 131072
v_cvt_pk_bf16_f32 v90, v44, v45
v_mfma_f32_16x16x32_bf16 v[24:27], a[156:159], v[196:199], v[24:27]
v_exp_f32 v46, v46
v_mfma_f32_16x16x32_bf16 v[32:35], a[156:159], v[212:215], v[148:151]
ds_read_b128 a[156:159], v219 offset:8192
v_cndmask_b32 v252, v252, v251, s[90:91]
v_mfma_f32_16x16x32_bf16 v[32:35], a[152:155], v[208:211], v[32:35]
v_exp_f32 v47, v47
v_mfma_f32_16x16x32_bf16 v[32:35], a[148:151], v[204:207], v[32:35]
ds_read_b128 a[152:155], v218 offset:8192
v_cvt_pk_bf16_f32 v91, v46, v47
v_mfma_f32_16x16x32_bf16 v[32:35], a[144:147], v[200:203], v[32:35]
v_exp_f32 v48, v48
v_mfma_f32_16x16x32_bf16 a[0:3], v[72:75], a[176:179], a[0:3]
ds_read_b128 a[148:151], v217 offset:8192
ds_read_b128 a[144:147], v216 offset:8192
v_mfma_f32_16x16x32_bf16 a[16:19], v[72:75], a[180:183], a[16:19]
v_exp_f32 v49, v49
v_mfma_f32_16x16x32_bf16 a[20:23], v[76:79], a[180:183], a[20:23]
v_cvt_pk_bf16_f32 v92, v48, v49
v_readfirstlane_b32 s78, v251
v_mfma_f32_16x16x32_bf16 a[4:7], v[76:79], a[176:179], a[4:7]
v_exp_f32 v50, v50
v_mfma_f32_16x16x32_bf16 a[8:11], v[80:83], a[176:179], a[8:11]
buffer_load_dwordx4 v232, s[12:15], s39 offen offset:0  lds
v_mfma_f32_16x16x32_bf16 a[24:27], v[80:83], a[180:183], a[24:27]
v_exp_f32 v51, v51
v_mfma_f32_16x16x32_bf16 a[28:31], v[84:87], a[180:183], a[28:31]
ds_read_b64_tr_b16 a[180:181], v221 offset:57344
v_cvt_pk_bf16_f32 v93, v50, v51
v_mfma_f32_16x16x32_bf16 a[12:15], v[84:87], a[176:179], a[12:15]
v_exp_f32 v52, v52
v_mfma_f32_16x16x32_bf16 a[44:47], v[84:87], a[184:187], a[44:47]
ds_read_b64_tr_b16 a[182:183], v221 offset:61440
ds_read_b64_tr_b16 a[176:177], v220 offset:57344
v_mfma_f32_16x16x32_bf16 a[60:63], v[84:87], a[188:191], a[60:63]
v_exp_f32 v53, v53
v_mfma_f32_16x16x32_bf16 a[56:59], v[80:83], a[188:191], a[56:59]
ds_read_b64_tr_b16 a[178:179], v220 offset:61440
v_cvt_pk_bf16_f32 v94, v52, v53
v_mfma_f32_16x16x32_bf16 a[40:43], v[80:83], a[184:187], a[40:43]
s_lshl_b64 s[90:91], s[90:91], 1
v_exp_f32 v54, v54
v_mfma_f32_16x16x32_bf16 a[36:39], v[76:79], a[184:187], a[36:39]
buffer_load_dwordx4 v233, s[12:15], s39 offen offset:1024  lds
v_mfma_f32_16x16x32_bf16 a[52:55], v[76:79], a[188:191], a[52:55]
v_exp_f32 v55, v55
v_mfma_f32_16x16x32_bf16 a[48:51], v[72:75], a[188:191], a[48:51]
ds_read_b64_tr_b16 a[188:189], v223 offset:57344
v_cvt_pk_bf16_f32 v95, v54, v55
v_mfma_f32_16x16x32_bf16 a[32:35], v[72:75], a[184:187], a[32:35]
v_max_u32_dpp v250, v248, v248 row_ror:8 row_mask:0xf bank_mask:0xf
v_exp_f32 v56, v56
v_smfmac_f32_16x16x64_bf16 a[128:131], a[208:211], v[72:79], v245
ds_read_b64_tr_b16 a[190:191], v223 offset:61440
v_mfma_f32_16x16x32_bf16 v[12:15], a[160:163], v[152:155], v[136:139]
v_exp_f32 v57, v57
v_mfma_f32_16x16x32_bf16 v[12:15], a[164:167], v[156:159], v[12:15]
v_exp_f32 v58, v58
v_mfma_f32_16x16x32_bf16 v[12:15], a[168:171], v[160:163], v[12:15]
ds_read_b64_tr_b16 a[184:185], v222 offset:57344
v_cvt_pk_bf16_f32 v96, v56, v57
v_mfma_f32_16x16x32_bf16 v[12:15], a[172:175], v[164:167], v[12:15]
v_max_u32_dpp v249, v250, v250 row_ror:4 row_mask:0xf bank_mask:0xf
v_exp_f32 v59, v59
v_mfma_f32_16x16x32_bf16 v[20:23], a[172:175], v[180:183], v[140:143]
ds_read_b64_tr_b16 a[186:187], v222 offset:61440
v_cvt_pk_bf16_f32 v97, v58, v59
v_mfma_f32_16x16x32_bf16 v[20:23], a[168:171], v[176:179], v[20:23]
v_exp_f32 v60, v60
v_mfma_f32_16x16x32_bf16 v[20:23], a[164:167], v[172:175], v[20:23]
buffer_load_dwordx4 v232, s[12:15], s39 offen offset:2048  lds
v_mfma_f32_16x16x32_bf16 v[20:23], a[160:163], v[168:171], v[20:23]
v_exp_f32 v61, v61
v_mfma_f32_16x16x32_bf16 v[28:31], a[160:163], v[184:187], v[144:147]
v_cvt_pk_bf16_f32 v98, v60, v61
v_max_u32_dpp v250, v249, v249 row_ror:2 row_mask:0xf bank_mask:0xf
v_mfma_f32_16x16x32_bf16 v[28:31], a[164:167], v[188:191], v[28:31]
v_exp_f32 v62, v62
v_mfma_f32_16x16x32_bf16 v[28:31], a[168:171], v[192:195], v[28:31]
buffer_load_dwordx4 v233, s[12:15], s39 offen offset:3072  lds
v_mfma_f32_16x16x32_bf16 v[28:31], a[172:175], v[196:199], v[28:31]
v_exp_f32 v63, v63
v_mfma_f32_16x16x32_bf16 v[36:39], a[172:175], v[212:215], v[148:151]
ds_read_b128 a[172:175], v219 offset:12288
v_cvt_pk_bf16_f32 v99, v62, v63
v_max_u32_dpp v249, v250, v250 row_ror:1 row_mask:0xf bank_mask:0xf
v_mfma_f32_16x16x32_bf16 v[36:39], a[168:171], v[208:211], v[36:39]
v_exp_f32 v64, v64
v_mfma_f32_16x16x32_bf16 v[36:39], a[164:167], v[204:207], v[36:39]
ds_read_b128 a[168:171], v218 offset:12288
ds_read_b128 a[164:167], v217 offset:12288
v_mfma_f32_16x16x32_bf16 v[36:39], a[160:163], v[200:203], v[36:39]
v_exp_f32 v65, v65
s_waitcnt lgkmcnt(8)
v_mfma_f32_16x16x32_bf16 a[64:67], v[72:75], a[192:195], a[64:67]
ds_read_b128 a[160:163], v216 offset:12288
v_cvt_pk_bf16_f32 v100, v64, v65
v_mfma_f32_16x16x32_bf16 a[80:83], v[72:75], a[196:199], a[80:83]
v_mov_b32 v250, v249
v_exp_f32 v66, v66
v_mfma_f32_16x16x32_bf16 a[84:87], v[76:79], a[196:199], a[84:87]
s_add_u32 m0, s86, 57344
s_add_u32 s50, s84, 3538944
buffer_load_dwordx4 v240, s[68:71], s50 offen lds
v_mfma_f32_16x16x32_bf16 a[68:71], v[76:79], a[192:195], a[68:71]
v_exp_f32 v67, v67
v_mfma_f32_16x16x32_bf16 a[72:75], v[80:83], a[192:195], a[72:75]
v_cvt_pk_bf16_f32 v101, v66, v67
v_permlane16_swap_b32 v249, v250
v_mfma_f32_16x16x32_bf16 a[88:91], v[80:83], a[196:199], a[88:91]
v_exp_f32 v68, v68
v_mfma_f32_16x16x32_bf16 a[92:95], v[84:87], a[196:199], a[92:95]
ds_read_b64_tr_b16 a[196:197], v225 offset:57344
ds_read_b64_tr_b16 a[198:199], v225 offset:61440
v_mfma_f32_16x16x32_bf16 a[76:79], v[84:87], a[192:195], a[76:79]
v_exp_f32 v69, v69
v_mfma_f32_16x16x32_bf16 a[108:111], v[84:87], a[200:203], a[108:111]
ds_read_b64_tr_b16 a[192:193], v224 offset:57344
v_cvt_pk_bf16_f32 v102, v68, v69
v_mfma_f32_16x16x32_bf16 a[124:127], v[84:87], a[204:207], a[124:127]
v_exp_f32 v70, v70
v_mfma_f32_16x16x32_bf16 a[120:123], v[80:83], a[204:207], a[120:123]
ds_read_b64_tr_b16 a[194:195], v224 offset:61440
v_max_u32 v249, v249, v250
v_mfma_f32_16x16x32_bf16 a[104:107], v[80:83], a[200:203], a[104:107]
v_exp_f32 v71, v71
v_mfma_f32_16x16x32_bf16 a[100:103], v[76:79], a[200:203], a[100:103]
v_cvt_pk_bf16_f32 v103, v70, v71
v_mov_b32 v250, v249
v_mfma_f32_16x16x32_bf16 a[116:119], v[76:79], a[204:207], a[116:119]
s_add_u32 m0, s86, 61440
s_add_u32 s50, s84, 4128768
buffer_load_dwordx4 v240, s[68:71], s50 offen lds
v_mfma_f32_16x16x32_bf16 a[112:115], v[72:75], a[204:207], a[112:115]
ds_read_b64_tr_b16 a[204:205], v227 offset:57344
ds_read_b64_tr_b16 a[206:207], v227 offset:61440
v_mfma_f32_16x16x32_bf16 a[96:99], v[72:75], a[200:203], a[96:99]
ds_read_b64_tr_b16 a[200:201], v226 offset:57344
ds_read_b64_tr_b16 a[202:203], v226 offset:61440
v_smfmac_f32_16x16x64_bf16 a[132:135], a[208:211], v[80:87], v245
v_permlane32_swap_b32 v249, v250
v_mfma_f32_16x16x32_bf16 v[40:43], a[144:147], v[152:155], v[136:139]
v_exp_f32 v8, v8
v_mfma_f32_16x16x32_bf16 v[40:43], a[148:151], v[156:159], v[40:43]
v_exp_f32 v9, v9
v_mfma_f32_16x16x32_bf16 v[40:43], a[152:155], v[160:163], v[40:43]
v_cvt_pk_bf16_f32 v72, v8, v9
v_max_u32 v249, v249, v250
v_mfma_f32_16x16x32_bf16 v[40:43], a[156:159], v[164:167], v[40:43]
v_exp_f32 v10, v10
v_mfma_f32_16x16x32_bf16 v[48:51], a[156:159], v[180:183], v[140:143]
v_add_u32 v251, v251, v249
v_sub_u32 v248, v248, v249
v_mfma_f32_16x16x32_bf16 v[48:51], a[152:155], v[176:179], v[48:51]
v_exp_f32 v11, v11
v_mfma_f32_16x16x32_bf16 v[48:51], a[148:151], v[172:175], v[48:51]
v_cvt_pk_bf16_f32 v73, v10, v11
v_cndmask_b32 v252, v252, v251, s[90:91]
v_mfma_f32_16x16x32_bf16 v[48:51], a[144:147], v[168:171], v[48:51]
v_exp_f32 v12, v12
v_mfma_f32_16x16x32_bf16 v[56:59], a[144:147], v[184:187], v[144:147]
v_readfirstlane_b32 s79, v251
v_mfma_f32_16x16x32_bf16 v[56:59], a[148:151], v[188:191], v[56:59]
v_exp_f32 v13, v13
v_mfma_f32_16x16x32_bf16 v[56:59], a[152:155], v[192:195], v[56:59]
s_lshl_b64 s[90:91], s[90:91], 1
v_cvt_pk_bf16_f32 v74, v12, v13
v_mfma_f32_16x16x32_bf16 v[56:59], a[156:159], v[196:199], v[56:59]
v_exp_f32 v14, v14
v_mfma_f32_16x16x32_bf16 v[64:67], a[156:159], v[212:215], v[148:151]
s_waitcnt vmcnt(13) lgkmcnt(0)
s_barrier
v_mfma_f32_16x16x32_bf16 v[64:67], a[152:155], v[208:211], v[64:67]
v_exp_f32 v15, v15
v_mfma_f32_16x16x32_bf16 v[64:67], a[148:151], v[204:207], v[64:67]
ds_read_b128 a[156:159], v219 offset:16384
v_cvt_pk_bf16_f32 v75, v14, v15
v_mfma_f32_16x16x32_bf16 v[64:67], a[144:147], v[200:203], v[64:67]
v_exp_f32 v16, v16
v_mfma_f32_16x16x32_bf16 a[0:3], v[88:91], a[176:179], a[0:3]
ds_read_b128 a[152:155], v218 offset:16384
ds_read_b128 a[148:151], v217 offset:16384
v_mfma_f32_16x16x32_bf16 a[16:19], v[88:91], a[180:183], a[16:19]
v_exp_f32 v17, v17
v_mfma_f32_16x16x32_bf16 a[20:23], v[92:95], a[180:183], a[20:23]
ds_read_b128 a[144:147], v216 offset:16384
v_cvt_pk_bf16_f32 v76, v16, v17
v_mfma_f32_16x16x32_bf16 a[4:7], v[92:95], a[176:179], a[4:7]
v_exp_f32 v18, v18
v_mfma_f32_16x16x32_bf16 a[8:11], v[96:99], a[176:179], a[8:11]
s_add_u32 s32, s32, 16384
v_max_u32_dpp v250, v248, v248 row_ror:8 row_mask:0xf bank_mask:0xf
v_mfma_f32_16x16x32_bf16 a[24:27], v[96:99], a[180:183], a[24:27]
v_exp_f32 v19, v19
v_mfma_f32_16x16x32_bf16 a[28:31], v[100:103], a[180:183], a[28:31]
ds_read_b64_tr_b16 a[180:181], v221 offset:0
v_cvt_pk_bf16_f32 v77, v18, v19
v_mfma_f32_16x16x32_bf16 a[12:15], v[100:103], a[176:179], a[12:15]
v_exp_f32 v20, v20
v_mfma_f32_16x16x32_bf16 a[44:47], v[100:103], a[184:187], a[44:47]
ds_read_b64_tr_b16 a[182:183], v221 offset:4096
ds_read_b64_tr_b16 a[176:177], v220 offset:0
v_mfma_f32_16x16x32_bf16 a[60:63], v[100:103], a[188:191], a[60:63]
v_exp_f32 v21, v21
v_mfma_f32_16x16x32_bf16 a[56:59], v[96:99], a[188:191], a[56:59]
ds_read_b64_tr_b16 a[178:179], v220 offset:4096
v_cvt_pk_bf16_f32 v78, v20, v21
v_mfma_f32_16x16x32_bf16 a[40:43], v[96:99], a[184:187], a[40:43]
v_exp_f32 v22, v22
v_mfma_f32_16x16x32_bf16 a[36:39], v[92:95], a[184:187], a[36:39]
s_add_u32 m0, s30, 65536
v_max_u32_dpp v249, v250, v250 row_ror:4 row_mask:0xf bank_mask:0xf
v_mfma_f32_16x16x32_bf16 a[52:55], v[92:95], a[188:191], a[52:55]
v_exp_f32 v23, v23
v_mfma_f32_16x16x32_bf16 a[48:51], v[88:91], a[188:191], a[48:51]
ds_read_b64_tr_b16 a[188:189], v223 offset:0
v_cvt_pk_bf16_f32 v79, v22, v23
v_mfma_f32_16x16x32_bf16 a[32:35], v[88:91], a[184:187], a[32:35]
v_exp_f32 v24, v24
v_smfmac_f32_16x16x64_bf16 a[128:131], a[208:211], v[88:95], v245
ds_read_b64_tr_b16 a[190:191], v223 offset:4096
v_mfma_f32_16x16x32_bf16 v[44:47], a[160:163], v[152:155], v[136:139]
v_exp_f32 v25, v25
v_mfma_f32_16x16x32_bf16 v[44:47], a[164:167], v[156:159], v[44:47]
v_exp_f32 v26, v26
v_mfma_f32_16x16x32_bf16 v[44:47], a[168:171], v[160:163], v[44:47]
ds_read_b64_tr_b16 a[184:185], v222 offset:0
v_cvt_pk_bf16_f32 v80, v24, v25
v_mfma_f32_16x16x32_bf16 v[44:47], a[172:175], v[164:167], v[44:47]
v_exp_f32 v27, v27
v_mfma_f32_16x16x32_bf16 v[52:55], a[172:175], v[180:183], v[140:143]
ds_read_b64_tr_b16 a[186:187], v222 offset:4096
v_cvt_pk_bf16_f32 v81, v26, v27
v_mfma_f32_16x16x32_bf16 v[52:55], a[168:171], v[176:179], v[52:55]
v_exp_f32 v28, v28
STUB_6:
s_cbranch_execz STUB_9
v_mfma_f32_16x16x32_bf16 v[52:55], a[164:167], v[172:175], v[52:55]
buffer_load_dwordx4 v228, s[8:11], s32 offen offset:0  lds
v_mfma_f32_16x16x32_bf16 v[52:55], a[160:163], v[168:171], v[52:55]
v_exp_f32 v29, v29
v_mfma_f32_16x16x32_bf16 v[60:63], a[160:163], v[184:187], v[144:147]
v_cvt_pk_bf16_f32 v82, v28, v29
v_max_u32_dpp v250, v249, v249 row_ror:2 row_mask:0xf bank_mask:0xf
v_mfma_f32_16x16x32_bf16 v[60:63], a[164:167], v[188:191], v[60:63]
v_exp_f32 v30, v30
v_mfma_f32_16x16x32_bf16 v[60:63], a[168:171], v[192:195], v[60:63]
buffer_load_dwordx4 v229, s[8:11], s32 offen offset:1024  lds
v_mfma_f32_16x16x32_bf16 v[60:63], a[172:175], v[196:199], v[60:63]
v_exp_f32 v31, v31
v_mfma_f32_16x16x32_bf16 v[68:71], a[172:175], v[212:215], v[148:151]
ds_read_b128 a[172:175], v219 offset:20480
v_cvt_pk_bf16_f32 v83, v30, v31
v_mfma_f32_16x16x32_bf16 v[68:71], a[168:171], v[208:211], v[68:71]
v_exp_f32 v32, v32
v_mfma_f32_16x16x32_bf16 v[68:71], a[164:167], v[204:207], v[68:71]
ds_read_b128 a[168:171], v218 offset:20480
ds_read_b128 a[164:167], v217 offset:20480
v_max_u32_dpp v249, v250, v250 row_ror:1 row_mask:0xf bank_mask:0xf
v_mfma_f32_16x16x32_bf16 v[68:71], a[160:163], v[200:203], v[68:71]
v_exp_f32 v33, v33
v_mfma_f32_16x16x32_bf16 a[64:67], v[88:91], a[192:195], a[64:67]
ds_read_b128 a[160:163], v216 offset:20480
v_cvt_pk_bf16_f32 v84, v32, v33
v_mfma_f32_16x16x32_bf16 a[80:83], v[88:91], a[196:199], a[80:83]
v_exp_f32 v34, v34
v_mfma_f32_16x16x32_bf16 a[84:87], v[92:95], a[196:199], a[84:87]
buffer_load_dwordx4 v230, s[8:11], s32 offen offset:2048  lds
v_mfma_f32_16x16x32_bf16 a[68:71], v[92:95], a[192:195], a[68:71]
v_mov_b32 v250, v249
v_exp_f32 v35, v35
v_mfma_f32_16x16x32_bf16 a[72:75], v[96:99], a[192:195], a[72:75]
v_cvt_pk_bf16_f32 v85, v34, v35
v_mfma_f32_16x16x32_bf16 a[88:91], v[96:99], a[196:199], a[88:91]
v_exp_f32 v36, v36
v_mfma_f32_16x16x32_bf16 a[92:95], v[100:103], a[196:199], a[92:95]
ds_read_b64_tr_b16 a[196:197], v225 offset:0
ds_read_b64_tr_b16 a[198:199], v225 offset:4096
v_mfma_f32_16x16x32_bf16 a[76:79], v[100:103], a[192:195], a[76:79]
v_permlane16_swap_b32 v249, v250
v_exp_f32 v37, v37
v_mfma_f32_16x16x32_bf16 a[108:111], v[100:103], a[200:203], a[108:111]
ds_read_b64_tr_b16 a[192:193], v224 offset:0
v_cvt_pk_bf16_f32 v86, v36, v37
v_mfma_f32_16x16x32_bf16 a[124:127], v[100:103], a[204:207], a[124:127]
v_exp_f32 v38, v38
v_mfma_f32_16x16x32_bf16 a[120:123], v[96:99], a[204:207], a[120:123]
ds_read_b64_tr_b16 a[194:195], v224 offset:4096
v_max_u32 v249, v249, v250
v_mfma_f32_16x16x32_bf16 a[104:107], v[96:99], a[200:203], a[104:107]
v_exp_f32 v39, v39
v_mfma_f32_16x16x32_bf16 a[100:103], v[92:95], a[200:203], a[100:103]
v_cvt_pk_bf16_f32 v87, v38, v39
v_mov_b32 v250, v249
v_mfma_f32_16x16x32_bf16 a[116:119], v[92:95], a[204:207], a[116:119]
buffer_load_dwordx4 v231, s[8:11], s32 offen offset:3072  lds
v_mfma_f32_16x16x32_bf16 a[112:115], v[88:91], a[204:207], a[112:115]
ds_read_b64_tr_b16 a[204:205], v227 offset:0
ds_read_b64_tr_b16 a[206:207], v227 offset:4096
v_mfma_f32_16x16x32_bf16 a[96:99], v[88:91], a[200:203], a[96:99]
ds_read_b64_tr_b16 a[200:201], v226 offset:0
ds_read_b64_tr_b16 a[202:203], v226 offset:4096
v_smfmac_f32_16x16x64_bf16 a[132:135], a[208:211], v[96:103], v245
v_permlane32_swap_b32 v249, v250
s_waitcnt lgkmcnt(8)
v_mfma_f32_16x16x32_bf16 v[8:11], a[144:147], v[152:155], v[136:139]
v_exp_f32 v40, v40
v_mfma_f32_16x16x32_bf16 v[8:11], a[148:151], v[156:159], v[8:11]
v_exp_f32 v41, v41
v_mfma_f32_16x16x32_bf16 v[8:11], a[152:155], v[160:163], v[8:11]
v_cvt_pk_bf16_f32 v88, v40, v41
v_max_u32 v249, v249, v250
v_mfma_f32_16x16x32_bf16 v[8:11], a[156:159], v[164:167], v[8:11]
v_exp_f32 v42, v42
v_mfma_f32_16x16x32_bf16 v[16:19], a[156:159], v[180:183], v[140:143]
s_add_u32 s39, s39, 16384
v_add_u32 v251, v251, v249
v_mfma_f32_16x16x32_bf16 v[16:19], a[152:155], v[176:179], v[16:19]
v_exp_f32 v43, v43
v_mfma_f32_16x16x32_bf16 v[16:19], a[148:151], v[172:175], v[16:19]
v_cvt_pk_bf16_f32 v89, v42, v43
v_sub_u32 v248, v248, v249
v_mfma_f32_16x16x32_bf16 v[16:19], a[144:147], v[168:171], v[16:19]
v_exp_f32 v44, v44
v_mfma_f32_16x16x32_bf16 v[24:27], a[144:147], v[184:187], v[144:147]
v_cndmask_b32 v252, v252, v251, s[90:91]
v_mfma_f32_16x16x32_bf16 v[24:27], a[148:151], v[188:191], v[24:27]
v_exp_f32 v45, v45
v_mfma_f32_16x16x32_bf16 v[24:27], a[152:155], v[192:195], v[24:27]
v_cvt_pk_bf16_f32 v90, v44, v45
v_readfirstlane_b32 s80, v251
v_mfma_f32_16x16x32_bf16 v[24:27], a[156:159], v[196:199], v[24:27]
v_exp_f32 v46, v46
v_mfma_f32_16x16x32_bf16 v[32:35], a[156:159], v[212:215], v[148:151]
ds_read_b128 a[156:159], v219 offset:24576
s_add_u32 m0, s30, 147456
v_mfma_f32_16x16x32_bf16 v[32:35], a[152:155], v[208:211], v[32:35]
v_exp_f32 v47, v47
v_mfma_f32_16x16x32_bf16 v[32:35], a[148:151], v[204:207], v[32:35]
ds_read_b128 a[152:155], v218 offset:24576
v_cvt_pk_bf16_f32 v91, v46, v47
v_mfma_f32_16x16x32_bf16 v[32:35], a[144:147], v[200:203], v[32:35]
v_exp_f32 v48, v48
v_mfma_f32_16x16x32_bf16 a[0:3], v[72:75], a[176:179], a[0:3]
ds_read_b128 a[148:151], v217 offset:24576
ds_read_b128 a[144:147], v216 offset:24576
v_mfma_f32_16x16x32_bf16 a[16:19], v[72:75], a[180:183], a[16:19]
v_exp_f32 v49, v49
v_mfma_f32_16x16x32_bf16 a[20:23], v[76:79], a[180:183], a[20:23]
s_lshl_b64 s[90:91], s[90:91], 1
v_cvt_pk_bf16_f32 v92, v48, v49
v_mfma_f32_16x16x32_bf16 a[4:7], v[76:79], a[176:179], a[4:7]
v_exp_f32 v50, v50
v_mfma_f32_16x16x32_bf16 a[8:11], v[80:83], a[176:179], a[8:11]
v_max_u32_dpp v250, v248, v248 row_ror:8 row_mask:0xf bank_mask:0xf
v_mfma_f32_16x16x32_bf16 a[24:27], v[80:83], a[180:183], a[24:27]
v_exp_f32 v51, v51
v_mfma_f32_16x16x32_bf16 a[28:31], v[84:87], a[180:183], a[28:31]
ds_read_b64_tr_b16 a[180:181], v221 offset:8192
v_cvt_pk_bf16_f32 v93, v50, v51
v_mfma_f32_16x16x32_bf16 a[12:15], v[84:87], a[176:179], a[12:15]
v_exp_f32 v52, v52
v_mfma_f32_16x16x32_bf16 a[44:47], v[84:87], a[184:187], a[44:47]
ds_read_b64_tr_b16 a[182:183], v221 offset:12288
ds_read_b64_tr_b16 a[176:177], v220 offset:8192
v_mfma_f32_16x16x32_bf16 a[60:63], v[84:87], a[188:191], a[60:63]
v_exp_f32 v53, v53
v_mfma_f32_16x16x32_bf16 a[56:59], v[80:83], a[188:191], a[56:59]
ds_read_b64_tr_b16 a[178:179], v220 offset:12288
v_cvt_pk_bf16_f32 v94, v52, v53
v_mfma_f32_16x16x32_bf16 a[40:43], v[80:83], a[184:187], a[40:43]
v_exp_f32 v54, v54
v_mfma_f32_16x16x32_bf16 a[36:39], v[76:79], a[184:187], a[36:39]
buffer_load_dwordx4 v232, s[12:15], s39 offen offset:0  lds
v_mfma_f32_16x16x32_bf16 a[52:55], v[76:79], a[188:191], a[52:55]
v_exp_f32 v55, v55
v_mfma_f32_16x16x32_bf16 a[48:51], v[72:75], a[188:191], a[48:51]
ds_read_b64_tr_b16 a[188:189], v223 offset:8192
v_cvt_pk_bf16_f32 v95, v54, v55
v_mfma_f32_16x16x32_bf16 a[32:35], v[72:75], a[184:187], a[32:35]
v_exp_f32 v56, v56
v_smfmac_f32_16x16x64_bf16 a[128:131], a[208:211], v[72:79], v245
ds_read_b64_tr_b16 a[190:191], v223 offset:12288
v_mfma_f32_16x16x32_bf16 v[12:15], a[160:163], v[152:155], v[136:139]
v_exp_f32 v57, v57
v_mfma_f32_16x16x32_bf16 v[12:15], a[164:167], v[156:159], v[12:15]
v_exp_f32 v58, v58
v_mfma_f32_16x16x32_bf16 v[12:15], a[168:171], v[160:163], v[12:15]
ds_read_b64_tr_b16 a[184:185], v222 offset:8192
v_cvt_pk_bf16_f32 v96, v56, v57
v_mfma_f32_16x16x32_bf16 v[12:15], a[172:175], v[164:167], v[12:15]
v_exp_f32 v59, v59
v_mfma_f32_16x16x32_bf16 v[20:23], a[172:175], v[180:183], v[140:143]
ds_read_b64_tr_b16 a[186:187], v222 offset:12288
v_cvt_pk_bf16_f32 v97, v58, v59
v_mfma_f32_16x16x32_bf16 v[20:23], a[168:171], v[176:179], v[20:23]
v_exp_f32 v60, v60
v_mfma_f32_16x16x32_bf16 v[20:23], a[164:167], v[172:175], v[20:23]
buffer_load_dwordx4 v233, s[12:15], s39 offen offset:1024  lds
v_mfma_f32_16x16x32_bf16 v[20:23], a[160:163], v[168:171], v[20:23]
v_max_u32_dpp v249, v250, v250 row_ror:4 row_mask:0xf bank_mask:0xf
v_exp_f32 v61, v61
v_mfma_f32_16x16x32_bf16 v[28:31], a[160:163], v[184:187], v[144:147]
v_cvt_pk_bf16_f32 v98, v60, v61
v_mfma_f32_16x16x32_bf16 v[28:31], a[164:167], v[188:191], v[28:31]
v_exp_f32 v62, v62
v_mfma_f32_16x16x32_bf16 v[28:31], a[168:171], v[192:195], v[28:31]
buffer_load_dwordx4 v232, s[12:15], s39 offen offset:2048  lds
v_mfma_f32_16x16x32_bf16 v[28:31], a[172:175], v[196:199], v[28:31]
v_exp_f32 v63, v63
v_mfma_f32_16x16x32_bf16 v[36:39], a[172:175], v[212:215], v[148:151]
ds_read_b128 a[172:175], v219 offset:28672
v_cvt_pk_bf16_f32 v99, v62, v63
v_max_u32_dpp v250, v249, v249 row_ror:2 row_mask:0xf bank_mask:0xf
v_mfma_f32_16x16x32_bf16 v[36:39], a[168:171], v[208:211], v[36:39]
v_exp_f32 v64, v64
v_mfma_f32_16x16x32_bf16 v[36:39], a[164:167], v[204:207], v[36:39]
ds_read_b128 a[168:171], v218 offset:28672
ds_read_b128 a[164:167], v217 offset:28672
v_mfma_f32_16x16x32_bf16 v[36:39], a[160:163], v[200:203], v[36:39]
v_exp_f32 v65, v65
s_waitcnt lgkmcnt(8)
v_mfma_f32_16x16x32_bf16 a[64:67], v[72:75], a[192:195], a[64:67]
ds_read_b128 a[160:163], v216 offset:28672
v_cvt_pk_bf16_f32 v100, v64, v65
v_max_u32_dpp v249, v250, v250 row_ror:1 row_mask:0xf bank_mask:0xf
v_mfma_f32_16x16x32_bf16 a[80:83], v[72:75], a[196:199], a[80:83]
v_exp_f32 v66, v66
v_mfma_f32_16x16x32_bf16 a[84:87], v[76:79], a[196:199], a[84:87]
buffer_load_dwordx4 v233, s[12:15], s39 offen offset:3072  lds
v_mfma_f32_16x16x32_bf16 a[68:71], v[76:79], a[192:195], a[68:71]
v_exp_f32 v67, v67
v_mfma_f32_16x16x32_bf16 a[72:75], v[80:83], a[192:195], a[72:75]
v_cvt_pk_bf16_f32 v101, v66, v67
v_mov_b32 v250, v249
v_mfma_f32_16x16x32_bf16 a[88:91], v[80:83], a[196:199], a[88:91]
v_exp_f32 v68, v68
v_mfma_f32_16x16x32_bf16 a[92:95], v[84:87], a[196:199], a[92:95]
ds_read_b64_tr_b16 a[196:197], v225 offset:8192
ds_read_b64_tr_b16 a[198:199], v225 offset:12288
v_mfma_f32_16x16x32_bf16 a[76:79], v[84:87], a[192:195], a[76:79]
v_exp_f32 v69, v69
v_mfma_f32_16x16x32_bf16 a[108:111], v[84:87], a[200:203], a[108:111]
ds_read_b64_tr_b16 a[192:193], v224 offset:8192
v_cvt_pk_bf16_f32 v102, v68, v69
v_mfma_f32_16x16x32_bf16 a[124:127], v[84:87], a[204:207], a[124:127]
v_exp_f32 v70, v70
v_mfma_f32_16x16x32_bf16 a[120:123], v[80:83], a[204:207], a[120:123]
ds_read_b64_tr_b16 a[194:195], v224 offset:12288
v_permlane16_swap_b32 v249, v250
v_mfma_f32_16x16x32_bf16 a[104:107], v[80:83], a[200:203], a[104:107]
v_exp_f32 v71, v71
v_mfma_f32_16x16x32_bf16 a[100:103], v[76:79], a[200:203], a[100:103]
v_cvt_pk_bf16_f32 v103, v70, v71
v_max_u32 v249, v249, v250
v_mfma_f32_16x16x32_bf16 a[116:119], v[76:79], a[204:207], a[116:119]
v_mov_b32 v250, v249
v_mfma_f32_16x16x32_bf16 a[112:115], v[72:75], a[204:207], a[112:115]
ds_read_b64_tr_b16 a[204:205], v227 offset:8192
ds_read_b64_tr_b16 a[206:207], v227 offset:12288
v_mfma_f32_16x16x32_bf16 a[96:99], v[72:75], a[200:203], a[96:99]
ds_read_b64_tr_b16 a[200:201], v226 offset:8192
ds_read_b64_tr_b16 a[202:203], v226 offset:12288
v_smfmac_f32_16x16x64_bf16 a[132:135], a[208:211], v[80:87], v245
v_permlane32_swap_b32 v249, v250
v_mfma_f32_16x16x32_bf16 v[40:43], a[144:147], v[152:155], v[136:139]
v_exp_f32 v8, v8
v_mfma_f32_16x16x32_bf16 v[40:43], a[148:151], v[156:159], v[40:43]
v_exp_f32 v9, v9
v_mfma_f32_16x16x32_bf16 v[40:43], a[152:155], v[160:163], v[40:43]
v_cvt_pk_bf16_f32 v72, v8, v9
v_max_u32 v249, v249, v250
v_mfma_f32_16x16x32_bf16 v[40:43], a[156:159], v[164:167], v[40:43]
v_exp_f32 v10, v10
v_mfma_f32_16x16x32_bf16 v[48:51], a[156:159], v[180:183], v[140:143]
v_add_u32 v251, v251, v249
v_sub_u32 v248, v248, v249
v_mfma_f32_16x16x32_bf16 v[48:51], a[152:155], v[176:179], v[48:51]
v_exp_f32 v11, v11
v_mfma_f32_16x16x32_bf16 v[48:51], a[148:151], v[172:175], v[48:51]
v_cvt_pk_bf16_f32 v73, v10, v11
v_cndmask_b32 v252, v252, v251, s[90:91]
v_mfma_f32_16x16x32_bf16 v[48:51], a[144:147], v[168:171], v[48:51]
v_exp_f32 v12, v12
v_mfma_f32_16x16x32_bf16 v[56:59], a[144:147], v[184:187], v[144:147]
v_readfirstlane_b32 s81, v251
v_mfma_f32_16x16x32_bf16 v[56:59], a[148:151], v[188:191], v[56:59]
v_exp_f32 v13, v13
v_mfma_f32_16x16x32_bf16 v[56:59], a[152:155], v[192:195], v[56:59]
s_lshl_b64 s[90:91], s[90:91], 1
v_cvt_pk_bf16_f32 v74, v12, v13
v_mfma_f32_16x16x32_bf16 v[56:59], a[156:159], v[196:199], v[56:59]
v_exp_f32 v14, v14
v_mfma_f32_16x16x32_bf16 v[64:67], a[156:159], v[212:215], v[148:151]
s_waitcnt vmcnt(8) lgkmcnt(0)
s_barrier
v_mfma_f32_16x16x32_bf16 v[64:67], a[152:155], v[208:211], v[64:67]
ds_read_b64_tr_b16 a[212:213], v241 offset:0
v_exp_f32 v15, v15
v_mfma_f32_16x16x32_bf16 v[64:67], a[148:151], v[204:207], v[64:67]
ds_read_b128 a[156:159], v219 offset:49152
ds_read_b64_tr_b16 a[214:215], v241 offset:256
v_cvt_pk_bf16_f32 v75, v14, v15
v_mfma_f32_16x16x32_bf16 v[64:67], a[144:147], v[200:203], v[64:67]
ds_read_b64_tr_b16 a[216:217], v241 offset:2048
v_exp_f32 v16, v16
v_mfma_f32_16x16x32_bf16 a[0:3], v[88:91], a[176:179], a[0:3]
ds_read_b128 a[152:155], v218 offset:49152
ds_read_b128 a[148:151], v217 offset:49152
ds_read_b64_tr_b16 a[218:219], v241 offset:2304
v_mfma_f32_16x16x32_bf16 a[16:19], v[88:91], a[180:183], a[16:19]
ds_read_b64_tr_b16 a[220:221], v241 offset:4096
v_exp_f32 v17, v17
v_mfma_f32_16x16x32_bf16 a[20:23], v[92:95], a[180:183], a[20:23]
ds_read_b128 a[144:147], v216 offset:49152
ds_read_b64_tr_b16 a[222:223], v241 offset:4352
v_cvt_pk_bf16_f32 v76, v16, v17
v_mfma_f32_16x16x32_bf16 a[4:7], v[92:95], a[176:179], a[4:7]
ds_read_b64_tr_b16 a[224:225], v241 offset:6144
v_exp_f32 v18, v18
v_mfma_f32_16x16x32_bf16 a[8:11], v[96:99], a[176:179], a[8:11]
s_add_u32 s32, s32, 16384
ds_read_b64_tr_b16 a[226:227], v241 offset:6400
ds_read_b64_tr_b16 a[228:229], v241 offset:8192
v_mfma_f32_16x16x32_bf16 a[24:27], v[96:99], a[180:183], a[24:27]
ds_read_b64_tr_b16 a[230:231], v241 offset:8448
v_exp_f32 v19, v19
v_mfma_f32_16x16x32_bf16 a[28:31], v[100:103], a[180:183], a[28:31]
ds_read_b64_tr_b16 a[180:181], v221 offset:32768
ds_read_b64_tr_b16 a[232:233], v241 offset:10240
v_cvt_pk_bf16_f32 v77, v18, v19
v_mfma_f32_16x16x32_bf16 a[12:15], v[100:103], a[176:179], a[12:15]
ds_read_b64_tr_b16 a[234:235], v241 offset:10496
v_exp_f32 v20, v20
v_mfma_f32_16x16x32_bf16 a[44:47], v[100:103], a[184:187], a[44:47]
ds_read_b64_tr_b16 a[182:183], v221 offset:36864
ds_read_b64_tr_b16 a[176:177], v220 offset:32768
ds_read_b64_tr_b16 a[236:237], v241 offset:12288
v_mfma_f32_16x16x32_bf16 a[60:63], v[100:103], a[188:191], a[60:63]
ds_read_b64_tr_b16 a[238:239], v241 offset:12544
v_exp_f32 v21, v21
v_mfma_f32_16x16x32_bf16 a[56:59], v[96:99], a[188:191], a[56:59]
ds_read_b64_tr_b16 a[178:179], v220 offset:36864
ds_read_b64_tr_b16 a[240:241], v241 offset:14336
v_cvt_pk_bf16_f32 v78, v20, v21
v_mfma_f32_16x16x32_bf16 a[40:43], v[96:99], a[184:187], a[40:43]
ds_read_b64_tr_b16 a[242:243], v241 offset:14592
v_exp_f32 v22, v22
v_mfma_f32_16x16x32_bf16 a[36:39], v[92:95], a[184:187], a[36:39]
s_add_u32 m0, s30, 81920
ds_read_b64_tr_b16 a[244:245], v241 offset:16384
ds_read_b64_tr_b16 a[246:247], v241 offset:16640
v_mfma_f32_16x16x32_bf16 a[52:55], v[92:95], a[188:191], a[52:55]
ds_read_b64_tr_b16 a[248:249], v241 offset:18432
v_exp_f32 v23, v23
v_mfma_f32_16x16x32_bf16 a[48:51], v[88:91], a[188:191], a[48:51]
ds_read_b64_tr_b16 a[188:189], v223 offset:32768
ds_read_b64_tr_b16 a[250:251], v241 offset:18688
v_cvt_pk_bf16_f32 v79, v22, v23
v_mfma_f32_16x16x32_bf16 a[32:35], v[88:91], a[184:187], a[32:35]
ds_read_b64_tr_b16 a[252:253], v241 offset:20480
v_exp_f32 v24, v24
v_smfmac_f32_16x16x64_bf16 a[128:131], a[208:211], v[88:95], v245
ds_read_b64_tr_b16 a[190:191], v223 offset:36864
ds_read_b64_tr_b16 a[254:255], v241 offset:20736
v_mfma_f32_16x16x32_bf16 v[44:47], a[160:163], v[152:155], v[136:139]
ds_read_b64_tr_b16 a[136:137], v241 offset:22528
v_exp_f32 v25, v25
v_mfma_f32_16x16x32_bf16 v[44:47], a[164:167], v[156:159], v[44:47]
v_exp_f32 v26, v26
v_mfma_f32_16x16x32_bf16 v[44:47], a[168:171], v[160:163], v[44:47]
ds_read_b64_tr_b16 a[184:185], v222 offset:32768
v_cvt_pk_bf16_f32 v80, v24, v25
v_mfma_f32_16x16x32_bf16 v[44:47], a[172:175], v[164:167], v[44:47]
ds_read_b64_tr_b16 a[138:139], v241 offset:22784
v_exp_f32 v27, v27
v_mfma_f32_16x16x32_bf16 v[52:55], a[172:175], v[180:183], v[140:143]
ds_read_b64_tr_b16 a[186:187], v222 offset:36864
v_cvt_pk_bf16_f32 v81, v26, v27
v_mfma_f32_16x16x32_bf16 v[52:55], a[168:171], v[176:179], v[52:55]
v_max_u32_dpp v250, v248, v248 row_ror:8 row_mask:0xf bank_mask:0xf
v_exp_f32 v28, v28
v_mfma_f32_16x16x32_bf16 v[52:55], a[164:167], v[172:175], v[52:55]
buffer_load_dwordx4 v228, s[8:11], s32 offen offset:0  lds
v_mfma_f32_16x16x32_bf16 v[52:55], a[160:163], v[168:171], v[52:55]
ds_read_b64_tr_b16 a[140:141], v241 offset:24576
v_exp_f32 v29, v29
v_mfma_f32_16x16x32_bf16 v[60:63], a[160:163], v[184:187], v[144:147]
ds_read_b64_tr_b16 a[142:143], v241 offset:24832
v_cvt_pk_bf16_f32 v82, v28, v29
v_mfma_f32_16x16x32_bf16 v[60:63], a[164:167], v[188:191], v[60:63]
v_exp_f32 v30, v30
v_mfma_f32_16x16x32_bf16 v[60:63], a[168:171], v[192:195], v[60:63]
buffer_load_dwordx4 v229, s[8:11], s32 offen offset:1024  lds
v_max_u32_dpp v249, v250, v250 row_ror:4 row_mask:0xf bank_mask:0xf
v_mfma_f32_16x16x32_bf16 v[60:63], a[172:175], v[196:199], v[60:63]
v_exp_f32 v31, v31
v_mfma_f32_16x16x32_bf16 v[68:71], a[172:175], v[212:215], v[148:151]
ds_read_b128 a[172:175], v219 offset:53248
v_cvt_pk_bf16_f32 v83, v30, v31
v_mfma_f32_16x16x32_bf16 v[68:71], a[168:171], v[208:211], v[68:71]
v_exp_f32 v32, v32
v_mfma_f32_16x16x32_bf16 v[68:71], a[164:167], v[204:207], v[68:71]
ds_read_b128 a[168:171], v218 offset:53248
ds_read_b128 a[164:167], v217 offset:53248
v_max_u32_dpp v250, v249, v249 row_ror:2 row_mask:0xf bank_mask:0xf
v_mfma_f32_16x16x32_bf16 v[68:71], a[160:163], v[200:203], v[68:71]
v_exp_f32 v33, v33
v_mfma_f32_16x16x32_bf16 a[64:67], v[88:91], a[192:195], a[64:67]
ds_read_b128 a[160:163], v216 offset:53248
ds_read_b64_tr_b16 v[104:105], v241 offset:26624
v_cvt_pk_bf16_f32 v84, v32, v33
v_mfma_f32_16x16x32_bf16 a[80:83], v[88:91], a[196:199], a[80:83]
v_exp_f32 v34, v34
v_mfma_f32_16x16x32_bf16 a[84:87], v[92:95], a[196:199], a[84:87]
buffer_load_dwordx4 v230, s[8:11], s32 offen offset:2048  lds
v_mfma_f32_16x16x32_bf16 a[68:71], v[92:95], a[192:195], a[68:71]
v_max_u32_dpp v249, v250, v250 row_ror:1 row_mask:0xf bank_mask:0xf
v_exp_f32 v35, v35
v_mfma_f32_16x16x32_bf16 a[72:75], v[96:99], a[192:195], a[72:75]
ds_read_b64_tr_b16 v[106:107], v241 offset:26880
v_cvt_pk_bf16_f32 v85, v34, v35
v_mfma_f32_16x16x32_bf16 a[88:91], v[96:99], a[196:199], a[88:91]
v_exp_f32 v36, v36
v_mfma_f32_16x16x32_bf16 a[92:95], v[100:103], a[196:199], a[92:95]
ds_read_b64_tr_b16 a[196:197], v225 offset:32768
ds_read_b64_tr_b16 a[198:199], v225 offset:36864
v_mfma_f32_16x16x32_bf16 a[76:79], v[100:103], a[192:195], a[76:79]
v_mov_b32 v250, v249
v_exp_f32 v37, v37
v_mfma_f32_16x16x32_bf16 a[108:111], v[100:103], a[200:203], a[108:111]
ds_read_b64_tr_b16 a[192:193], v224 offset:32768
v_cvt_pk_bf16_f32 v86, v36, v37
v_mfma_f32_16x16x32_bf16 a[124:127], v[100:103], a[204:207], a[124:127]
ds_read_b64_tr_b16 v[108:109], v241 offset:28672
v_exp_f32 v38, v38
v_mfma_f32_16x16x32_bf16 a[120:123], v[96:99], a[204:207], a[120:123]
ds_read_b64_tr_b16 a[194:195], v224 offset:36864
ds_read_b64_tr_b16 v[110:111], v241 offset:28928
v_mfma_f32_16x16x32_bf16 a[104:107], v[96:99], a[200:203], a[104:107]
v_exp_f32 v39, v39
v_mfma_f32_16x16x32_bf16 a[100:103], v[92:95], a[200:203], a[100:103]
ds_read_b64_tr_b16 v[112:113], v241 offset:30720
v_cvt_pk_bf16_f32 v87, v38, v39
v_permlane16_swap_b32 v249, v250
v_mfma_f32_16x16x32_bf16 a[116:119], v[92:95], a[204:207], a[116:119]
buffer_load_dwordx4 v231, s[8:11], s32 offen offset:3072  lds
v_mfma_f32_16x16x32_bf16 a[112:115], v[88:91], a[204:207], a[112:115]
ds_read_b64_tr_b16 a[204:205], v227 offset:32768
ds_read_b64_tr_b16 a[206:207], v227 offset:36864
v_mfma_f32_16x16x32_bf16 a[96:99], v[88:91], a[200:203], a[96:99]
ds_read_b64_tr_b16 a[200:201], v226 offset:32768
ds_read_b64_tr_b16 a[202:203], v226 offset:36864
v_smfmac_f32_16x16x64_bf16 a[132:135], a[208:211], v[96:103], v245
ds_read_b64_tr_b16 v[114:115], v241 offset:30976
v_max_u32 v249, v249, v250
s_waitcnt lgkmcnt(8)
v_mfma_f32_16x16x32_bf16 v[8:11], a[144:147], v[152:155], v[136:139]
v_exp_f32 v40, v40
v_mfma_f32_16x16x32_bf16 v[8:11], a[148:151], v[156:159], v[8:11]
v_exp_f32 v41, v41
v_mfma_f32_16x16x32_bf16 v[8:11], a[152:155], v[160:163], v[8:11]
v_and_b32 v253, 0x20202020, v253
v_cvt_pk_bf16_f32 v88, v40, v41
v_mfma_f32_16x16x32_bf16 v[8:11], a[156:159], v[164:167], v[8:11]
v_exp_f32 v42, v42
v_mfma_f32_16x16x32_bf16 v[16:19], a[156:159], v[180:183], v[140:143]
s_add_u32 s39, s39, 16384
v_mov_b32 v250, v249
v_mfma_f32_16x16x32_bf16 v[16:19], a[152:155], v[176:179], v[16:19]
v_exp_f32 v43, v43
v_mfma_f32_16x16x32_bf16 v[16:19], a[148:151], v[172:175], v[16:19]
v_cvt_pk_bf16_f32 v89, v42, v43
v_permlane32_swap_b32 v249, v250
v_mfma_f32_16x16x32_bf16 v[16:19], a[144:147], v[168:171], v[16:19]
v_exp_f32 v44, v44
v_mfma_f32_16x16x32_bf16 v[24:27], a[144:147], v[184:187], v[144:147]
v_cmp_ne_u32 vcc, 0x20202020, v253
s_cbranch_vccnz SP_FL
SP_FL_RET:
v_mfma_f32_16x16x32_bf16 v[24:27], a[148:151], v[188:191], v[24:27]
v_exp_f32 v45, v45
v_mfma_f32_16x16x32_bf16 v[24:27], a[152:155], v[192:195], v[24:27]
v_cvt_pk_bf16_f32 v90, v44, v45
v_mov_b32 v246, s101
v_mfma_f32_16x16x32_bf16 v[24:27], a[156:159], v[196:199], v[24:27]
v_exp_f32 v46, v46
v_mfma_f32_16x16x32_bf16 v[32:35], a[156:159], v[212:215], v[148:151]
ds_read_b128 a[156:159], v219 offset:57344
s_add_u32 m0, s30, 98304
v_mfma_f32_16x16x32_bf16 v[32:35], a[152:155], v[208:211], v[32:35]
v_max_u32 v249, v249, v250
v_exp_f32 v47, v47
v_mfma_f32_16x16x32_bf16 v[32:35], a[148:151], v[204:207], v[32:35]
ds_read_b128 a[152:155], v218 offset:57344
v_cvt_pk_bf16_f32 v91, v46, v47
v_mfma_f32_16x16x32_bf16 v[32:35], a[144:147], v[200:203], v[32:35]
v_exp_f32 v48, v48
v_mfma_f32_16x16x32_bf16 a[0:3], v[72:75], a[176:179], a[0:3]
ds_read_b128 a[148:151], v217 offset:57344
ds_read_b128 a[144:147], v216 offset:57344
v_mfma_f32_16x16x32_bf16 a[16:19], v[72:75], a[180:183], a[16:19]
v_add_u32 v251, v251, v249
v_exp_f32 v49, v49
v_mfma_f32_16x16x32_bf16 a[20:23], v[76:79], a[180:183], a[20:23]
v_cvt_pk_bf16_f32 v92, v48, v49
v_mov_b32 v247, s47
v_mfma_f32_16x16x32_bf16 a[4:7], v[76:79], a[176:179], a[4:7]
v_exp_f32 v50, v50
v_mfma_f32_16x16x32_bf16 a[8:11], v[80:83], a[176:179], a[8:11]
v_mov_b32 v253, 0
v_sub_u32 v248, v248, v249
v_mfma_f32_16x16x32_bf16 a[24:27], v[80:83], a[180:183], a[24:27]
v_exp_f32 v51, v51
v_mfma_f32_16x16x32_bf16 a[28:31], v[84:87], a[180:183], a[28:31]
ds_read_b64_tr_b16 a[180:181], v221 offset:40960
v_cvt_pk_bf16_f32 v93, v50, v51
v_mfma_f32_16x16x32_bf16 a[12:15], v[84:87], a[176:179], a[12:15]
v_exp_f32 v52, v52
v_mfma_f32_16x16x32_bf16 a[44:47], v[84:87], a[184:187], a[44:47]
ds_read_b64_tr_b16 a[182:183], v221 offset:45056
ds_read_b64_tr_b16 a[176:177], v220 offset:40960
v_mfma_f32_16x16x32_bf16 a[60:63], v[84:87], a[188:191], a[60:63]
v_exp_f32 v53, v53
v_mfma_f32_16x16x32_bf16 a[56:59], v[80:83], a[188:191], a[56:59]
ds_read_b64_tr_b16 a[178:179], v220 offset:45056
v_cvt_pk_bf16_f32 v94, v52, v53
v_mfma_f32_16x16x32_bf16 a[40:43], v[80:83], a[184:187], a[40:43]
v_cndmask_b32 v252, v252, v251, s[90:91]
v_exp_f32 v54, v54
v_mfma_f32_16x16x32_bf16 a[36:39], v[76:79], a[184:187], a[36:39]
buffer_load_dwordx4 v232, s[12:15], s39 offen offset:0  lds
v_mfma_f32_16x16x32_bf16 a[52:55], v[76:79], a[188:191], a[52:55]
v_exp_f32 v55, v55
v_mfma_f32_16x16x32_bf16 a[48:51], v[72:75], a[188:191], a[48:51]
ds_read_b64_tr_b16 a[188:189], v223 offset:40960
v_cvt_pk_bf16_f32 v95, v54, v55
v_mfma_f32_16x16x32_bf16 a[32:35], v[72:75], a[184:187], a[32:35]
v_readfirstlane_b32 s82, v251
v_exp_f32 v56, v56
v_smfmac_f32_16x16x64_bf16 a[128:131], a[208:211], v[72:79], v245
ds_read_b64_tr_b16 a[190:191], v223 offset:45056
v_mfma_f32_16x16x32_bf16 v[12:15], a[160:163], v[152:155], v[136:139]
v_exp_f32 v57, v57
v_mfma_f32_16x16x32_bf16 v[12:15], a[164:167], v[156:159], v[12:15]
v_exp_f32 v58, v58
v_mfma_f32_16x16x32_bf16 v[12:15], a[168:171], v[160:163], v[12:15]
ds_read_b64_tr_b16 a[184:185], v222 offset:40960
v_cvt_pk_bf16_f32 v96, v56, v57
v_mfma_f32_16x16x32_bf16 v[12:15], a[172:175], v[164:167], v[12:15]
s_lshl_b64 s[90:91], s[90:91], 1
v_exp_f32 v59, v59
v_mfma_f32_16x16x32_bf16 v[20:23], a[172:175], v[180:183], v[140:143]
ds_read_b64_tr_b16 a[186:187], v222 offset:45056
v_cvt_pk_bf16_f32 v97, v58, v59
v_mfma_f32_16x16x32_bf16 v[20:23], a[168:171], v[176:179], v[20:23]
s_add_u32 s29, s2, s37
v_exp_f32 v60, v60
v_mfma_f32_16x16x32_bf16 v[20:23], a[164:167], v[172:175], v[20:23]
buffer_load_dwordx4 v233, s[12:15], s39 offen offset:1024  lds
v_mfma_f32_16x16x32_bf16 v[20:23], a[160:163], v[168:171], v[20:23]
v_max_u32_dpp v250, v248, v248 row_ror:8 row_mask:0xf bank_mask:0xf
v_exp_f32 v61, v61
v_mfma_f32_16x16x32_bf16 v[28:31], a[160:163], v[184:187], v[144:147]
v_cvt_pk_bf16_f32 v98, v60, v61
v_mfma_f32_16x16x32_bf16 v[28:31], a[164:167], v[188:191], v[28:31]
v_exp_f32 v62, v62
v_mfma_f32_16x16x32_bf16 v[28:31], a[168:171], v[192:195], v[28:31]
buffer_load_dwordx4 v232, s[12:15], s39 offen offset:2048  lds
v_mfma_f32_16x16x32_bf16 v[28:31], a[172:175], v[196:199], v[28:31]
v_exp_f32 v63, v63
v_mfma_f32_16x16x32_bf16 v[36:39], a[172:175], v[212:215], v[148:151]
ds_read_b128 a[172:175], v219 offset:61440
v_cvt_pk_bf16_f32 v99, v62, v63
v_max_u32_dpp v249, v250, v250 row_ror:4 row_mask:0xf bank_mask:0xf
v_mfma_f32_16x16x32_bf16 v[36:39], a[168:171], v[208:211], v[36:39]
v_exp_f32 v64, v64
v_mfma_f32_16x16x32_bf16 v[36:39], a[164:167], v[204:207], v[36:39]
ds_read_b128 a[168:171], v218 offset:61440
ds_read_b128 a[164:167], v217 offset:61440
v_mfma_f32_16x16x32_bf16 v[36:39], a[160:163], v[200:203], v[36:39]
v_exp_f32 v65, v65
s_waitcnt lgkmcnt(8)
v_mfma_f32_16x16x32_bf16 a[64:67], v[72:75], a[192:195], a[64:67]
ds_read_b128 a[160:163], v216 offset:61440
v_cvt_pk_bf16_f32 v100, v64, v65
v_max_u32_dpp v250, v249, v249 row_ror:2 row_mask:0xf bank_mask:0xf
v_mfma_f32_16x16x32_bf16 a[80:83], v[72:75], a[196:199], a[80:83]
v_exp_f32 v66, v66
v_mfma_f32_16x16x32_bf16 a[84:87], v[76:79], a[196:199], a[84:87]
buffer_load_dwordx4 v233, s[12:15], s39 offen offset:3072  lds
v_mfma_f32_16x16x32_bf16 a[68:71], v[76:79], a[192:195], a[68:71]
v_exp_f32 v67, v67
v_mfma_f32_16x16x32_bf16 a[72:75], v[80:83], a[192:195], a[72:75]
s_cmp_eq_u32 s29, 0
s_cselect_b32 s29, 0x24c000, -16
v_cvt_pk_bf16_f32 v101, v66, v67
v_mfma_f32_16x16x32_bf16 a[88:91], v[80:83], a[196:199], a[88:91]
v_max_u32_dpp v249, v250, v250 row_ror:1 row_mask:0xf bank_mask:0xf
v_exp_f32 v68, v68
v_mfma_f32_16x16x32_bf16 a[92:95], v[84:87], a[196:199], a[92:95]
ds_read_b64_tr_b16 a[196:197], v225 offset:40960
ds_read_b64_tr_b16 a[198:199], v225 offset:45056
v_mfma_f32_16x16x32_bf16 a[76:79], v[84:87], a[192:195], a[76:79]
v_exp_f32 v69, v69
v_mfma_f32_16x16x32_bf16 a[108:111], v[84:87], a[200:203], a[108:111]
ds_read_b64_tr_b16 a[192:193], v224 offset:40960
v_cvt_pk_bf16_f32 v102, v68, v69
v_mfma_f32_16x16x32_bf16 a[124:127], v[84:87], a[204:207], a[124:127]
v_mov_b32 v250, v249
v_exp_f32 v70, v70
v_mfma_f32_16x16x32_bf16 a[120:123], v[80:83], a[204:207], a[120:123]
ds_read_b64_tr_b16 a[194:195], v224 offset:45056
buffer_store_dwordx2 v[246:247], v253, s[20:23], s29 offen
v_mfma_f32_16x16x32_bf16 a[104:107], v[80:83], a[200:203], a[104:107]
v_exp_f32 v71, v71
v_mfma_f32_16x16x32_bf16 a[100:103], v[76:79], a[200:203], a[100:103]
v_cvt_pk_bf16_f32 v103, v70, v71
v_permlane16_swap_b32 v249, v250
v_mfma_f32_16x16x32_bf16 a[116:119], v[76:79], a[204:207], a[116:119]
v_max_u32 v249, v249, v250
v_mov_b32 v250, v249
v_mfma_f32_16x16x32_bf16 a[112:115], v[72:75], a[204:207], a[112:115]
ds_read_b64_tr_b16 a[204:205], v227 offset:40960
ds_read_b64_tr_b16 a[206:207], v227 offset:45056
v_mfma_f32_16x16x32_bf16 a[96:99], v[72:75], a[200:203], a[96:99]
STUB_7:
s_cbranch_execz STUB_10
ds_read_b64_tr_b16 a[200:201], v226 offset:40960
ds_read_b64_tr_b16 a[202:203], v226 offset:45056
v_smfmac_f32_16x16x64_bf16 a[132:135], a[208:211], v[80:87], v245
v_permlane32_swap_b32 v249, v250
v_mfma_f32_16x16x32_bf16 v[40:43], a[144:147], v[152:155], v[136:139]
v_exp_f32 v8, v8
v_mfma_f32_16x16x32_bf16 v[40:43], a[148:151], v[156:159], v[40:43]
v_exp_f32 v9, v9
v_mfma_f32_16x16x32_bf16 v[40:43], a[152:155], v[160:163], v[40:43]
v_cvt_pk_bf16_f32 v72, v8, v9
v_max_u32 v249, v249, v250
v_mfma_f32_16x16x32_bf16 v[40:43], a[156:159], v[164:167], v[40:43]
v_exp_f32 v10, v10
v_mfma_f32_16x16x32_bf16 v[48:51], a[156:159], v[180:183], v[140:143]
v_add_u32 v251, v251, v249
v_cndmask_b32 v252, v252, v251, s[90:91]
v_mfma_f32_16x16x32_bf16 v[48:51], a[152:155], v[176:179], v[48:51]
v_exp_f32 v11, v11
v_mfma_f32_16x16x32_bf16 v[48:51], a[148:151], v[172:175], v[48:51]
v_cvt_pk_bf16_f32 v73, v10, v11
v_readfirstlane_b32 s83, v251
v_mfma_f32_16x16x32_bf16 v[48:51], a[144:147], v[168:171], v[48:51]
v_exp_f32 v12, v12
v_mfma_f32_16x16x32_bf16 v[56:59], a[144:147], v[184:187], v[144:147]
v_mov_b32 v236, v252
v_mfma_f32_16x16x32_bf16 v[56:59], a[148:151], v[188:191], v[56:59]
v_exp_f32 v13, v13
v_mfma_f32_16x16x32_bf16 v[56:59], a[152:155], v[192:195], v[56:59]
v_cvt_pk_bf16_f32 v74, v12, v13
v_and_b32 v252, 0xffff, v252
v_mfma_f32_16x16x32_bf16 v[56:59], a[156:159], v[196:199], v[56:59]
v_exp_f32 v14, v14
v_mfma_f32_16x16x32_bf16 v[64:67], a[156:159], v[212:215], v[148:151]
s_waitcnt vmcnt(9) lgkmcnt(0)
s_barrier
v_mfma_f32_16x16x32_bf16 v[64:67], a[152:155], v[208:211], v[64:67]
v_exp_f32 v15, v15
v_mfma_f32_16x16x32_bf16 v[64:67], a[148:151], v[204:207], v[64:67]
ds_read_b128 a[156:159], v219 offset:0
v_cvt_pk_bf16_f32 v75, v14, v15
v_mfma_f32_16x16x32_bf16 v[64:67], a[144:147], v[200:203], v[64:67]
v_exp_f32 v16, v16
v_mfma_f32_16x16x32_bf16 a[0:3], v[88:91], a[176:179], a[0:3]
ds_read_b128 a[152:155], v218 offset:0
ds_read_b128 a[148:151], v217 offset:0
v_mfma_f32_16x16x32_bf16 a[16:19], v[88:91], a[180:183], a[16:19]
v_exp_f32 v17, v17
v_mfma_f32_16x16x32_bf16 a[20:23], v[92:95], a[180:183], a[20:23]
ds_read_b128 a[144:147], v216 offset:0
v_cvt_pk_bf16_f32 v76, v16, v17
v_mfma_f32_16x16x32_bf16 a[4:7], v[92:95], a[176:179], a[4:7]
v_exp_f32 v18, v18
v_mfma_f32_16x16x32_bf16 a[8:11], v[96:99], a[176:179], a[8:11]
s_add_u32 s32, s32, 16384
s_add_u32 m0, s30, 114688
v_mfma_f32_16x16x32_bf16 a[24:27], v[96:99], a[180:183], a[24:27]
v_exp_f32 v19, v19
v_mfma_f32_16x16x32_bf16 a[28:31], v[100:103], a[180:183], a[28:31]
ds_read_b64_tr_b16 a[180:181], v221 offset:49152
v_cvt_pk_bf16_f32 v77, v18, v19
v_mfma_f32_16x16x32_bf16 a[12:15], v[100:103], a[176:179], a[12:15]
v_exp_f32 v20, v20
v_mfma_f32_16x16x32_bf16 a[44:47], v[100:103], a[184:187], a[44:47]
ds_read_b64_tr_b16 a[182:183], v221 offset:53248
ds_read_b64_tr_b16 a[176:177], v220 offset:49152
v_mfma_f32_16x16x32_bf16 a[60:63], v[100:103], a[188:191], a[60:63]
v_exp_f32 v21, v21
v_mfma_f32_16x16x32_bf16 a[56:59], v[96:99], a[188:191], a[56:59]
ds_read_b64_tr_b16 a[178:179], v220 offset:53248
v_cvt_pk_bf16_f32 v78, v20, v21
v_mfma_f32_16x16x32_bf16 a[40:43], v[96:99], a[184:187], a[40:43]
v_exp_f32 v22, v22
v_mfma_f32_16x16x32_bf16 a[36:39], v[92:95], a[184:187], a[36:39]
buffer_load_dwordx4 v228, s[8:11], s32 offen offset:0  lds
v_mfma_f32_16x16x32_bf16 a[52:55], v[92:95], a[188:191], a[52:55]
v_exp_f32 v23, v23
v_mfma_f32_16x16x32_bf16 a[48:51], v[88:91], a[188:191], a[48:51]
ds_read_b64_tr_b16 a[188:189], v223 offset:49152
v_cvt_pk_bf16_f32 v79, v22, v23
v_mfma_f32_16x16x32_bf16 a[32:35], v[88:91], a[184:187], a[32:35]
v_exp_f32 v24, v24
v_smfmac_f32_16x16x64_bf16 a[128:131], a[208:211], v[88:95], v245
ds_read_b64_tr_b16 a[190:191], v223 offset:53248
v_mfma_f32_16x16x32_bf16 v[44:47], a[160:163], v[152:155], v[136:139]
v_exp_f32 v25, v25
v_mfma_f32_16x16x32_bf16 v[44:47], a[164:167], v[156:159], v[44:47]
v_exp_f32 v26, v26
v_mfma_f32_16x16x32_bf16 v[44:47], a[168:171], v[160:163], v[44:47]
ds_read_b64_tr_b16 a[184:185], v222 offset:49152
v_cvt_pk_bf16_f32 v80, v24, v25
v_mfma_f32_16x16x32_bf16 v[44:47], a[172:175], v[164:167], v[44:47]
v_exp_f32 v27, v27
v_mfma_f32_16x16x32_bf16 v[52:55], a[172:175], v[180:183], v[140:143]
ds_read_b64_tr_b16 a[186:187], v222 offset:53248
v_cvt_pk_bf16_f32 v81, v26, v27
v_mfma_f32_16x16x32_bf16 v[52:55], a[168:171], v[176:179], v[52:55]
v_exp_f32 v28, v28
v_mfma_f32_16x16x32_bf16 v[52:55], a[164:167], v[172:175], v[52:55]
buffer_load_dwordx4 v229, s[8:11], s32 offen offset:1024  lds
v_mfma_f32_16x16x32_bf16 v[52:55], a[160:163], v[168:171], v[52:55]
v_exp_f32 v29, v29
v_mfma_f32_16x16x32_bf16 v[60:63], a[160:163], v[184:187], v[144:147]
v_cvt_pk_bf16_f32 v82, v28, v29
v_sub_u32 v252, 0xffff, v252
v_mfma_f32_16x16x32_bf16 v[60:63], a[164:167], v[188:191], v[60:63]
v_exp_f32 v30, v30
v_mfma_f32_16x16x32_bf16 v[60:63], a[168:171], v[192:195], v[60:63]
buffer_load_dwordx4 v230, s[8:11], s32 offen offset:2048  lds
v_mfma_f32_16x16x32_bf16 v[60:63], a[172:175], v[196:199], v[60:63]
v_exp_f32 v31, v31
v_mfma_f32_16x16x32_bf16 v[68:71], a[172:175], v[212:215], v[148:151]
ds_read_b128 a[172:175], v219 offset:4096
v_cvt_pk_bf16_f32 v83, v30, v31
v_mfma_f32_16x16x32_bf16 v[68:71], a[168:171], v[208:211], v[68:71]
v_exp_f32 v32, v32
v_mfma_f32_16x16x32_bf16 v[68:71], a[164:167], v[204:207], v[68:71]
ds_read_b128 a[168:171], v218 offset:4096
ds_read_b128 a[164:167], v217 offset:4096
v_mul_u32_u24 v252, 0x480, v252
v_mfma_f32_16x16x32_bf16 v[68:71], a[160:163], v[200:203], v[68:71]
v_exp_f32 v33, v33
v_mfma_f32_16x16x32_bf16 a[64:67], v[88:91], a[192:195], a[64:67]
ds_read_b128 a[160:163], v216 offset:4096
v_cvt_pk_bf16_f32 v84, v32, v33
v_mfma_f32_16x16x32_bf16 a[80:83], v[88:91], a[196:199], a[80:83]
v_exp_f32 v34, v34
v_mfma_f32_16x16x32_bf16 a[84:87], v[92:95], a[196:199], a[84:87]
buffer_load_dwordx4 v231, s[8:11], s32 offen offset:3072  lds
v_lshrrev_b32 v249, 3, v0
v_mfma_f32_16x16x32_bf16 a[68:71], v[92:95], a[192:195], a[68:71]
v_exp_f32 v35, v35
v_mfma_f32_16x16x32_bf16 a[72:75], v[96:99], a[192:195], a[72:75]
v_cvt_pk_bf16_f32 v85, v34, v35
v_lshl_add_u32 v252, v249, 4, v252
v_mfma_f32_16x16x32_bf16 a[88:91], v[96:99], a[196:199], a[88:91]
v_exp_f32 v36, v36
v_mfma_f32_16x16x32_bf16 a[92:95], v[100:103], a[196:199], a[92:95]
ds_read_b64_tr_b16 a[196:197], v225 offset:49152
ds_read_b64_tr_b16 a[198:199], v225 offset:53248
v_mfma_f32_16x16x32_bf16 a[76:79], v[100:103], a[192:195], a[76:79]
v_exp_f32 v37, v37
v_mfma_f32_16x16x32_bf16 a[108:111], v[100:103], a[200:203], a[108:111]
ds_read_b64_tr_b16 a[192:193], v224 offset:49152
v_cvt_pk_bf16_f32 v86, v36, v37
v_mfma_f32_16x16x32_bf16 a[124:127], v[100:103], a[204:207], a[124:127]
v_exp_f32 v38, v38
v_mfma_f32_16x16x32_bf16 a[120:123], v[96:99], a[204:207], a[120:123]
ds_read_b64_tr_b16 a[194:195], v224 offset:53248
v_mfma_f32_16x16x32_bf16 a[104:107], v[96:99], a[200:203], a[104:107]
v_exp_f32 v39, v39
v_mfma_f32_16x16x32_bf16 a[100:103], v[92:95], a[200:203], a[100:103]
v_cvt_pk_bf16_f32 v87, v38, v39
v_mfma_f32_16x16x32_bf16 a[116:119], v[92:95], a[204:207], a[116:119]
s_add_u32 m0, s86, 0
s_add_u32 s50, s84, 4718592
buffer_load_dwordx4 v240, s[64:67], s50 offen lds
v_mfma_f32_16x16x32_bf16 a[112:115], v[88:91], a[204:207], a[112:115]
ds_read_b64_tr_b16 a[204:205], v227 offset:49152
ds_read_b64_tr_b16 a[206:207], v227 offset:53248
v_mfma_f32_16x16x32_bf16 a[96:99], v[88:91], a[200:203], a[96:99]
ds_read_b64_tr_b16 a[200:201], v226 offset:49152
ds_read_b64_tr_b16 a[202:203], v226 offset:53248
v_smfmac_f32_16x16x64_bf16 a[132:135], a[208:211], v[96:103], v245
s_add_u32 m0, s86, 4096
s_add_u32 s50, s84, 4718592
buffer_load_dwordx4 v240, s[68:71], s50 offen lds
s_add_u32 m0, s86, 8192
s_add_u32 s50, s85, 0
buffer_load_dwordx4 v244, s[72:75], s50 offen lds
s_add_u32 m0, s86, 12288
s_add_u32 s50, s85, 4096
buffer_load_dwordx4 v244, s[72:75], s50 offen lds
s_waitcnt lgkmcnt(8)
v_mfma_f32_16x16x32_bf16 v[8:11], a[144:147], v[152:155], v[136:139]
v_exp_f32 v40, v40
v_mfma_f32_16x16x32_bf16 v[8:11], a[148:151], v[156:159], v[8:11]
v_ashrrev_i32 v246, 31, v236
v_exp_f32 v41, v41
v_mfma_f32_16x16x32_bf16 v[8:11], a[152:155], v[160:163], v[8:11]
v_cvt_pk_bf16_f32 v88, v40, v41
v_not_b32 v246, v246
v_mfma_f32_16x16x32_bf16 v[8:11], a[156:159], v[164:167], v[8:11]
v_exp_f32 v42, v42
v_mfma_f32_16x16x32_bf16 v[16:19], a[156:159], v[180:183], v[140:143]
s_add_u32 s39, s39, 16384
v_or_b32 v246, 0x80000000, v246
v_mfma_f32_16x16x32_bf16 v[16:19], a[152:155], v[176:179], v[16:19]
v_exp_f32 v43, v43
v_mfma_f32_16x16x32_bf16 v[16:19], a[148:151], v[172:175], v[16:19]
v_cvt_pk_bf16_f32 v89, v42, v43
v_xor_b32 v236, v236, v246
v_mfma_f32_16x16x32_bf16 v[16:19], a[144:147], v[168:171], v[16:19]
v_exp_f32 v44, v44
v_mfma_f32_16x16x32_bf16 v[24:27], a[144:147], v[184:187], v[144:147]
s_add_u32 m0, s30, 131072
v_and_b32 v236, 0xffff0000, v236
v_mfma_f32_16x16x32_bf16 v[24:27], a[148:151], v[188:191], v[24:27]
v_exp_f32 v45, v45
v_mfma_f32_16x16x32_bf16 v[24:27], a[152:155], v[192:195], v[24:27]
v_cvt_pk_bf16_f32 v90, v44, v45
v_mul_f32 v236, 0xbfb8aa3b, v236
v_mfma_f32_16x16x32_bf16 v[24:27], a[156:159], v[196:199], v[24:27]
v_exp_f32 v46, v46
v_mfma_f32_16x16x32_bf16 v[32:35], a[156:159], v[212:215], v[148:151]
ds_read_b128 a[156:159], v219 offset:8192
v_mfma_f32_16x16x32_bf16 v[32:35], a[152:155], v[208:211], v[32:35]
v_exp_f32 v47, v47
v_mfma_f32_16x16x32_bf16 v[32:35], a[148:151], v[204:207], v[32:35]
ds_read_b128 a[152:155], v218 offset:8192
v_cvt_pk_bf16_f32 v91, v46, v47
v_mfma_f32_16x16x32_bf16 v[32:35], a[144:147], v[200:203], v[32:35]
v_exp_f32 v48, v48
v_mfma_f32_16x16x32_bf16 a[0:3], v[72:75], a[176:179], a[0:3]
ds_read_b128 a[148:151], v217 offset:8192
ds_read_b128 a[144:147], v216 offset:8192
v_mfma_f32_16x16x32_bf16 a[16:19], v[72:75], a[180:183], a[16:19]
v_exp_f32 v49, v49
v_mfma_f32_16x16x32_bf16 a[20:23], v[76:79], a[180:183], a[20:23]
v_cvt_pk_bf16_f32 v92, v48, v49
v_mfma_f32_16x16x32_bf16 a[4:7], v[76:79], a[176:179], a[4:7]
v_exp_f32 v50, v50
v_mfma_f32_16x16x32_bf16 a[8:11], v[80:83], a[176:179], a[8:11]
buffer_load_dwordx4 v232, s[12:15], s39 offen offset:0  lds
v_mfma_f32_16x16x32_bf16 a[24:27], v[80:83], a[180:183], a[24:27]
v_exp_f32 v51, v51
v_mfma_f32_16x16x32_bf16 a[28:31], v[84:87], a[180:183], a[28:31]
ds_read_b64_tr_b16 a[180:181], v221 offset:57344
v_cvt_pk_bf16_f32 v93, v50, v51
v_mfma_f32_16x16x32_bf16 a[12:15], v[84:87], a[176:179], a[12:15]
v_exp_f32 v52, v52
v_mfma_f32_16x16x32_bf16 a[44:47], v[84:87], a[184:187], a[44:47]
ds_read_b64_tr_b16 a[182:183], v221 offset:61440
ds_read_b64_tr_b16 a[176:177], v220 offset:57344
v_mfma_f32_16x16x32_bf16 a[60:63], v[84:87], a[188:191], a[60:63]
v_exp_f32 v53, v53
v_mfma_f32_16x16x32_bf16 a[56:59], v[80:83], a[188:191], a[56:59]
ds_read_b64_tr_b16 a[178:179], v220 offset:61440
v_cvt_pk_bf16_f32 v94, v52, v53
v_mfma_f32_16x16x32_bf16 a[40:43], v[80:83], a[184:187], a[40:43]
v_exp_f32 v54, v54
v_mfma_f32_16x16x32_bf16 a[36:39], v[76:79], a[184:187], a[36:39]
buffer_load_dwordx4 v233, s[12:15], s39 offen offset:1024  lds
v_mfma_f32_16x16x32_bf16 a[52:55], v[76:79], a[188:191], a[52:55]
v_exp_f32 v55, v55
v_mfma_f32_16x16x32_bf16 a[48:51], v[72:75], a[188:191], a[48:51]
ds_read_b64_tr_b16 a[188:189], v223 offset:57344
v_cvt_pk_bf16_f32 v95, v54, v55
v_mfma_f32_16x16x32_bf16 a[32:35], v[72:75], a[184:187], a[32:35]
v_exp_f32 v56, v56
v_smfmac_f32_16x16x64_bf16 a[128:131], a[208:211], v[72:79], v245
ds_read_b64_tr_b16 a[190:191], v223 offset:61440
v_mfma_f32_16x16x32_bf16 v[12:15], a[160:163], v[152:155], v[136:139]
v_exp_f32 v57, v57
v_mfma_f32_16x16x32_bf16 v[12:15], a[164:167], v[156:159], v[12:15]
v_exp_f32 v58, v58
v_mfma_f32_16x16x32_bf16 v[12:15], a[168:171], v[160:163], v[12:15]
ds_read_b64_tr_b16 a[184:185], v222 offset:57344
v_cvt_pk_bf16_f32 v96, v56, v57
v_mfma_f32_16x16x32_bf16 v[12:15], a[172:175], v[164:167], v[12:15]
v_exp_f32 v59, v59
v_mfma_f32_16x16x32_bf16 v[20:23], a[172:175], v[180:183], v[140:143]
ds_read_b64_tr_b16 a[186:187], v222 offset:61440
v_cvt_pk_bf16_f32 v97, v58, v59
v_mfma_f32_16x16x32_bf16 v[20:23], a[168:171], v[176:179], v[20:23]
v_exp_f32 v60, v60
v_mfma_f32_16x16x32_bf16 v[20:23], a[164:167], v[172:175], v[20:23]
buffer_load_dwordx4 v232, s[12:15], s39 offen offset:2048  lds
v_mfma_f32_16x16x32_bf16 v[20:23], a[160:163], v[168:171], v[20:23]
v_exp_f32 v61, v61
v_mfma_f32_16x16x32_bf16 v[28:31], a[160:163], v[184:187], v[144:147]
v_cvt_pk_bf16_f32 v98, v60, v61
v_exp_f32 v236, v236
v_mfma_f32_16x16x32_bf16 v[28:31], a[164:167], v[188:191], v[28:31]
v_add_f32 v236, 1.0, v236
v_exp_f32 v62, v62
v_mfma_f32_16x16x32_bf16 v[28:31], a[168:171], v[192:195], v[28:31]
buffer_load_dwordx4 v233, s[12:15], s39 offen offset:3072  lds
v_mfma_f32_16x16x32_bf16 v[28:31], a[172:175], v[196:199], v[28:31]
v_exp_f32 v63, v63
v_mfma_f32_16x16x32_bf16 v[36:39], a[172:175], v[212:215], v[148:151]
ds_read_b128 a[172:175], v219 offset:12288
v_cvt_pk_bf16_f32 v99, v62, v63
v_mfma_f32_16x16x32_bf16 v[36:39], a[168:171], v[208:211], v[36:39]
v_exp_f32 v64, v64
v_mfma_f32_16x16x32_bf16 v[36:39], a[164:167], v[204:207], v[36:39]
ds_read_b128 a[168:171], v218 offset:12288
ds_read_b128 a[164:167], v217 offset:12288
v_mfma_f32_16x16x32_bf16 v[36:39], a[160:163], v[200:203], v[36:39]
v_exp_f32 v65, v65
s_waitcnt lgkmcnt(8)
v_mfma_f32_16x16x32_bf16 a[64:67], v[72:75], a[192:195], a[64:67]
ds_read_b128 a[160:163], v216 offset:12288
v_cvt_pk_bf16_f32 v100, v64, v65
v_mfma_f32_16x16x32_bf16 a[80:83], v[72:75], a[196:199], a[80:83]
v_exp_f32 v66, v66
v_mfma_f32_16x16x32_bf16 a[84:87], v[76:79], a[196:199], a[84:87]
s_add_u32 m0, s86, 45056
s_mov_b32 s50, 29360128
buffer_load_dwordx4 v252, s[20:23], s50 offen sc0 sc1 lds
v_mfma_f32_16x16x32_bf16 a[68:71], v[76:79], a[192:195], a[68:71]
v_exp_f32 v67, v67
v_mfma_f32_16x16x32_bf16 a[72:75], v[80:83], a[192:195], a[72:75]
v_cvt_pk_bf16_f32 v101, v66, v67
v_rcp_f32 v236, v236
v_mfma_f32_16x16x32_bf16 a[88:91], v[80:83], a[196:199], a[88:91]
v_cvt_pk_bf16_f32 v236, v236, v236
v_exp_f32 v68, v68
v_mfma_f32_16x16x32_bf16 a[92:95], v[84:87], a[196:199], a[92:95]
ds_read_b64_tr_b16 a[196:197], v225 offset:57344
ds_read_b64_tr_b16 a[198:199], v225 offset:61440
v_mfma_f32_16x16x32_bf16 a[76:79], v[84:87], a[192:195], a[76:79]
v_lshlrev_b32 v236, 16, v236
v_exp_f32 v69, v69
v_mfma_f32_16x16x32_bf16 a[108:111], v[84:87], a[200:203], a[108:111]
ds_read_b64_tr_b16 a[192:193], v224 offset:57344
v_cvt_pk_bf16_f32 v102, v68, v69
v_mfma_f32_16x16x32_bf16 a[124:127], v[84:87], a[204:207], a[124:127]
v_exp_f32 v70, v70
v_mfma_f32_16x16x32_bf16 a[120:123], v[80:83], a[204:207], a[120:123]
ds_read_b64_tr_b16 a[194:195], v224 offset:61440
v_mfma_f32_16x16x32_bf16 a[104:107], v[80:83], a[200:203], a[104:107]
v_exp_f32 v71, v71
v_mfma_f32_16x16x32_bf16 a[100:103], v[76:79], a[200:203], a[100:103]
v_cvt_pk_bf16_f32 v103, v70, v71
v_mfma_f32_16x16x32_bf16 a[116:119], v[76:79], a[204:207], a[116:119]
s_add_u32 m0, s86, 49152
s_mov_b32 s50, 29360640
buffer_load_dwordx4 v252, s[20:23], s50 offen sc0 sc1 lds
v_mfma_f32_16x16x32_bf16 a[112:115], v[72:75], a[204:207], a[112:115]
ds_read_b64_tr_b16 a[204:205], v227 offset:57344
ds_read_b64_tr_b16 a[206:207], v227 offset:61440
v_mfma_f32_16x16x32_bf16 a[96:99], v[72:75], a[200:203], a[96:99]
ds_read_b64_tr_b16 a[200:201], v226 offset:57344
ds_read_b64_tr_b16 a[202:203], v226 offset:61440
v_smfmac_f32_16x16x64_bf16 a[132:135], a[208:211], v[80:87], v245
s_add_u32 m0, s86, 53248
s_mov_b32 s50, 29361152
buffer_load_dwordx4 v252, s[20:23], s50 offen sc0 sc1 lds
s_add_u32 m0, s86, 16384
s_add_u32 s50, s85, 8192
buffer_load_dwordx4 v244, s[72:75], s50 offen lds
s_mov_b32 s33, 7
s_cmp_lt_u32 s86, 0x10000
s_cbranch_scc0 K_LOOPIN
v_mfma_f32_16x16x32_bf16 v[40:43], a[144:147], v[152:155], v[136:139]
v_exp_f32 v8, v8
v_mfma_f32_16x16x32_bf16 v[40:43], a[148:151], v[156:159], v[40:43]
v_exp_f32 v9, v9
v_mfma_f32_16x16x32_bf16 v[40:43], a[152:155], v[160:163], v[40:43]
s_lshr_b32 s28, s37, 1
v_cvt_pk_bf16_f32 v72, v8, v9
v_mfma_f32_16x16x32_bf16 v[40:43], a[156:159], v[164:167], v[40:43]
v_exp_f32 v10, v10
v_mfma_f32_16x16x32_bf16 v[48:51], a[156:159], v[180:183], v[140:143]
s_mul_i32 s28, s28, 28672
v_mfma_f32_16x16x32_bf16 v[48:51], a[152:155], v[176:179], v[48:51]
v_exp_f32 v11, v11
v_mfma_f32_16x16x32_bf16 v[48:51], a[148:151], v[172:175], v[48:51]
v_cvt_pk_bf16_f32 v73, v10, v11
v_subrev_u32 v241, s28, v241
v_mfma_f32_16x16x32_bf16 v[48:51], a[144:147], v[168:171], v[48:51]
v_exp_f32 v12, v12
v_mfma_f32_16x16x32_bf16 v[56:59], a[144:147], v[184:187], v[144:147]
v_and_b32 v239, 7, v1
v_lshl_add_u32 v239, v4, 3, v239
v_mfma_f32_16x16x32_bf16 v[56:59], a[148:151], v[188:191], v[56:59]
v_exp_f32 v13, v13
v_mfma_f32_16x16x32_bf16 v[56:59], a[152:155], v[192:195], v[56:59]
v_cvt_pk_bf16_f32 v74, v12, v13
v_lshlrev_b32 v239, 4, v239
v_mfma_f32_16x16x32_bf16 v[56:59], a[156:159], v[196:199], v[56:59]
v_exp_f32 v14, v14
v_mfma_f32_16x16x32_bf16 v[64:67], a[156:159], v[212:215], v[148:151]
s_waitcnt vmcnt(16) lgkmcnt(0)
s_barrier
v_mfma_f32_16x16x32_bf16 v[64:67], a[152:155], v[208:211], v[64:67]
v_exp_f32 v15, v15
v_mfma_f32_16x16x32_bf16 v[64:67], a[148:151], v[204:207], v[64:67]
ds_read_b128 a[156:159], v219 offset:16384
v_cvt_pk_bf16_f32 v75, v14, v15
v_mfma_f32_16x16x32_bf16 v[64:67], a[144:147], v[200:203], v[64:67]
v_exp_f32 v16, v16
v_mfma_f32_16x16x32_bf16 a[0:3], v[88:91], a[176:179], a[0:3]
ds_read_b128 a[152:155], v218 offset:16384
ds_read_b128 a[148:151], v217 offset:16384
v_mfma_f32_16x16x32_bf16 a[16:19], v[88:91], a[180:183], a[16:19]
v_exp_f32 v17, v17
v_mfma_f32_16x16x32_bf16 a[20:23], v[92:95], a[180:183], a[20:23]
ds_read_b128 a[144:147], v216 offset:16384
v_cvt_pk_bf16_f32 v76, v16, v17
v_mfma_f32_16x16x32_bf16 a[4:7], v[92:95], a[176:179], a[4:7]
v_exp_f32 v18, v18
v_mfma_f32_16x16x32_bf16 a[8:11], v[96:99], a[176:179], a[8:11]
s_add_u32 s32, s32, 16384
s_add_u32 m0, s30, 65536
v_mfma_f32_16x16x32_bf16 a[24:27], v[96:99], a[180:183], a[24:27]
v_exp_f32 v19, v19
v_mfma_f32_16x16x32_bf16 a[28:31], v[100:103], a[180:183], a[28:31]
ds_read_b64_tr_b16 a[180:181], v221 offset:0
v_cvt_pk_bf16_f32 v77, v18, v19
v_mfma_f32_16x16x32_bf16 a[12:15], v[100:103], a[176:179], a[12:15]
v_exp_f32 v20, v20
v_mfma_f32_16x16x32_bf16 a[44:47], v[100:103], a[184:187], a[44:47]
ds_read_b64_tr_b16 a[182:183], v221 offset:4096
ds_read_b64_tr_b16 a[176:177], v220 offset:0
v_mfma_f32_16x16x32_bf16 a[60:63], v[100:103], a[188:191], a[60:63]
v_exp_f32 v21, v21
v_mfma_f32_16x16x32_bf16 a[56:59], v[96:99], a[188:191], a[56:59]
ds_read_b64_tr_b16 a[178:179], v220 offset:4096
v_cvt_pk_bf16_f32 v78, v20, v21
v_mfma_f32_16x16x32_bf16 a[40:43], v[96:99], a[184:187], a[40:43]
v_exp_f32 v22, v22
v_mfma_f32_16x16x32_bf16 a[36:39], v[92:95], a[184:187], a[36:39]
buffer_load_dwordx4 v228, s[8:11], s32 offen offset:0  lds
v_mfma_f32_16x16x32_bf16 a[52:55], v[92:95], a[188:191], a[52:55]
v_exp_f32 v23, v23
v_mfma_f32_16x16x32_bf16 a[48:51], v[88:91], a[188:191], a[48:51]
ds_read_b64_tr_b16 a[188:189], v223 offset:0
v_cvt_pk_bf16_f32 v79, v22, v23
v_mfma_f32_16x16x32_bf16 a[32:35], v[88:91], a[184:187], a[32:35]
v_exp_f32 v24, v24
v_smfmac_f32_16x16x64_bf16 a[128:131], a[208:211], v[88:95], v245
ds_read_b64_tr_b16 a[190:191], v223 offset:4096
v_mfma_f32_16x16x32_bf16 v[44:47], a[160:163], v[152:155], v[136:139]
v_exp_f32 v25, v25
v_mfma_f32_16x16x32_bf16 v[44:47], a[164:167], v[156:159], v[44:47]
v_exp_f32 v26, v26
v_mfma_f32_16x16x32_bf16 v[44:47], a[168:171], v[160:163], v[44:47]
ds_read_b64_tr_b16 a[184:185], v222 offset:0
v_cvt_pk_bf16_f32 v80, v24, v25
v_mfma_f32_16x16x32_bf16 v[44:47], a[172:175], v[164:167], v[44:47]
v_exp_f32 v27, v27
v_mfma_f32_16x16x32_bf16 v[52:55], a[172:175], v[180:183], v[140:143]
ds_read_b64_tr_b16 a[186:187], v222 offset:4096
v_cvt_pk_bf16_f32 v81, v26, v27
v_mfma_f32_16x16x32_bf16 v[52:55], a[168:171], v[176:179], v[52:55]
v_exp_f32 v28, v28
v_mfma_f32_16x16x32_bf16 v[52:55], a[164:167], v[172:175], v[52:55]
buffer_load_dwordx4 v229, s[8:11], s32 offen offset:1024  lds
v_mfma_f32_16x16x32_bf16 v[52:55], a[160:163], v[168:171], v[52:55]
v_exp_f32 v29, v29
v_mfma_f32_16x16x32_bf16 v[60:63], a[160:163], v[184:187], v[144:147]
v_cvt_pk_bf16_f32 v82, v28, v29
v_add_u32 v237, s31, v244
v_mfma_f32_16x16x32_bf16 v[60:63], a[164:167], v[188:191], v[60:63]
v_exp_f32 v30, v30
v_mfma_f32_16x16x32_bf16 v[60:63], a[168:171], v[192:195], v[60:63]
buffer_load_dwordx4 v230, s[8:11], s32 offen offset:2048  lds
v_mfma_f32_16x16x32_bf16 v[60:63], a[172:175], v[196:199], v[60:63]
v_exp_f32 v31, v31
v_mfma_f32_16x16x32_bf16 v[68:71], a[172:175], v[212:215], v[148:151]
ds_read_b128 a[172:175], v219 offset:20480
v_cvt_pk_bf16_f32 v83, v30, v31
v_mfma_f32_16x16x32_bf16 v[68:71], a[168:171], v[208:211], v[68:71]
v_exp_f32 v32, v32
v_mfma_f32_16x16x32_bf16 v[68:71], a[164:167], v[204:207], v[68:71]
ds_read_b128 a[168:171], v218 offset:20480
ds_read_b128 a[164:167], v217 offset:20480
v_mfma_f32_16x16x32_bf16 v[68:71], a[160:163], v[200:203], v[68:71]
v_exp_f32 v33, v33
v_mfma_f32_16x16x32_bf16 a[64:67], v[88:91], a[192:195], a[64:67]
ds_read_b128 a[160:163], v216 offset:20480
v_cvt_pk_bf16_f32 v84, v32, v33
v_mfma_f32_16x16x32_bf16 a[80:83], v[88:91], a[196:199], a[80:83]
v_exp_f32 v34, v34
v_mfma_f32_16x16x32_bf16 a[84:87], v[92:95], a[196:199], a[84:87]
buffer_load_dwordx4 v231, s[8:11], s32 offen offset:3072  lds
v_mfma_f32_16x16x32_bf16 a[68:71], v[92:95], a[192:195], a[68:71]
v_exp_f32 v35, v35
v_mfma_f32_16x16x32_bf16 a[72:75], v[96:99], a[192:195], a[72:75]
v_cvt_pk_bf16_f32 v85, v34, v35
v_lshl_add_u32 v238, v4, 3, v3
v_mfma_f32_16x16x32_bf16 a[88:91], v[96:99], a[196:199], a[88:91]
v_exp_f32 v36, v36
v_mfma_f32_16x16x32_bf16 a[92:95], v[100:103], a[196:199], a[92:95]
ds_read_b64_tr_b16 a[196:197], v225 offset:0
ds_read_b64_tr_b16 a[198:199], v225 offset:4096
v_mfma_f32_16x16x32_bf16 a[76:79], v[100:103], a[192:195], a[76:79]
v_exp_f32 v37, v37
v_mfma_f32_16x16x32_bf16 a[108:111], v[100:103], a[200:203], a[108:111]
ds_read_b64_tr_b16 a[192:193], v224 offset:0
v_cvt_pk_bf16_f32 v86, v36, v37
v_mfma_f32_16x16x32_bf16 a[124:127], v[100:103], a[204:207], a[124:127]
v_exp_f32 v38, v38
v_mfma_f32_16x16x32_bf16 a[120:123], v[96:99], a[204:207], a[120:123]
ds_read_b64_tr_b16 a[194:195], v224 offset:4096
v_lshlrev_b32 v238, 4, v238
v_mfma_f32_16x16x32_bf16 a[104:107], v[96:99], a[200:203], a[104:107]
v_exp_f32 v39, v39
v_mfma_f32_16x16x32_bf16 a[100:103], v[92:95], a[200:203], a[100:103]
v_cvt_pk_bf16_f32 v87, v38, v39
v_mov_b32 v246, 0x7ffffff0
v_mfma_f32_16x16x32_bf16 a[116:119], v[92:95], a[204:207], a[116:119]
s_add_u32 m0, s86, 20480
s_add_u32 s50, s85, 12288
buffer_load_dwordx4 v244, s[72:75], s50 offen lds
v_mfma_f32_16x16x32_bf16 a[112:115], v[88:91], a[204:207], a[112:115]
ds_read_b64_tr_b16 a[204:205], v227 offset:0
ds_read_b64_tr_b16 a[206:207], v227 offset:4096
v_mfma_f32_16x16x32_bf16 a[96:99], v[88:91], a[200:203], a[96:99]
ds_read_b64_tr_b16 a[200:201], v226 offset:0
ds_read_b64_tr_b16 a[202:203], v226 offset:4096
v_smfmac_f32_16x16x64_bf16 a[132:135], a[208:211], v[96:103], v245
s_add_u32 m0, s86, 24576
s_add_u32 s50, s85, 16384
buffer_load_dwordx4 v244, s[72:75], s50 offen lds
s_add_u32 m0, s86, 28672
s_add_u32 s50, s85, 20480
buffer_load_dwordx4 v244, s[72:75], s50 offen lds
s_waitcnt lgkmcnt(8)
v_mfma_f32_16x16x32_bf16 v[8:11], a[144:147], v[152:155], v[136:139]
v_exp_f32 v40, v40
v_mfma_f32_16x16x32_bf16 v[8:11], a[148:151], v[156:159], v[8:11]
v_exp_f32 v41, v41
v_mfma_f32_16x16x32_bf16 v[8:11], a[152:155], v[160:163], v[8:11]
v_cvt_pk_bf16_f32 v88, v40, v41
v_cmp_lt_u32 vcc, 7, v3
v_mfma_f32_16x16x32_bf16 v[8:11], a[156:159], v[164:167], v[8:11]
v_exp_f32 v42, v42
v_mfma_f32_16x16x32_bf16 v[16:19], a[156:159], v[180:183], v[140:143]
s_add_u32 s39, s39, 16384
v_cndmask_b32 v238, v238, v246, vcc
v_mfma_f32_16x16x32_bf16 v[16:19], a[152:155], v[176:179], v[16:19]
v_exp_f32 v43, v43
v_mfma_f32_16x16x32_bf16 v[16:19], a[148:151], v[172:175], v[16:19]
s_mul_i32 s28, s40, 18432
v_cvt_pk_bf16_f32 v89, v42, v43
v_mfma_f32_16x16x32_bf16 v[16:19], a[144:147], v[168:171], v[16:19]
v_exp_f32 v44, v44
v_mfma_f32_16x16x32_bf16 v[24:27], a[144:147], v[184:187], v[144:147]
s_mul_i32 s29, s37, 4608
s_add_u32 s28, s28, s29
v_mfma_f32_16x16x32_bf16 v[24:27], a[148:151], v[188:191], v[24:27]
v_exp_f32 v45, v45
v_mfma_f32_16x16x32_bf16 v[24:27], a[152:155], v[192:195], v[24:27]
s_add_u32 m0, s30, 147456
v_cvt_pk_bf16_f32 v90, v44, v45
v_mfma_f32_16x16x32_bf16 v[24:27], a[156:159], v[196:199], v[24:27]
v_exp_f32 v46, v46
v_mfma_f32_16x16x32_bf16 v[32:35], a[156:159], v[212:215], v[148:151]
ds_read_b128 a[156:159], v219 offset:24576
s_add_u32 s28, s28, 0x2000000
v_mfma_f32_16x16x32_bf16 v[32:35], a[152:155], v[208:211], v[32:35]
v_exp_f32 v47, v47
v_mfma_f32_16x16x32_bf16 v[32:35], a[148:151], v[204:207], v[32:35]
ds_read_b128 a[152:155], v218 offset:24576
v_cvt_pk_bf16_f32 v91, v46, v47
v_mfma_f32_16x16x32_bf16 v[32:35], a[144:147], v[200:203], v[32:35]
v_exp_f32 v48, v48
v_mfma_f32_16x16x32_bf16 a[0:3], v[72:75], a[176:179], a[0:3]
ds_read_b128 a[148:151], v217 offset:24576
ds_read_b128 a[144:147], v216 offset:24576
v_mfma_f32_16x16x32_bf16 a[16:19], v[72:75], a[180:183], a[16:19]
v_exp_f32 v49, v49
v_mfma_f32_16x16x32_bf16 a[20:23], v[76:79], a[180:183], a[20:23]
v_cvt_pk_bf16_f32 v92, v48, v49
v_mfma_f32_16x16x32_bf16 a[4:7], v[76:79], a[176:179], a[4:7]
v_exp_f32 v50, v50
v_mfma_f32_16x16x32_bf16 a[8:11], v[80:83], a[176:179], a[8:11]
buffer_load_dwordx4 v232, s[12:15], s39 offen offset:0  lds
v_mfma_f32_16x16x32_bf16 a[24:27], v[80:83], a[180:183], a[24:27]
v_exp_f32 v51, v51
v_mfma_f32_16x16x32_bf16 a[28:31], v[84:87], a[180:183], a[28:31]
ds_read_b64_tr_b16 a[180:181], v221 offset:8192
v_cvt_pk_bf16_f32 v93, v50, v51
v_mfma_f32_16x16x32_bf16 a[12:15], v[84:87], a[176:179], a[12:15]
v_exp_f32 v52, v52
v_mfma_f32_16x16x32_bf16 a[44:47], v[84:87], a[184:187], a[44:47]
ds_read_b64_tr_b16 a[182:183], v221 offset:12288
ds_read_b64_tr_b16 a[176:177], v220 offset:8192
v_mfma_f32_16x16x32_bf16 a[60:63], v[84:87], a[188:191], a[60:63]
v_exp_f32 v53, v53
v_mfma_f32_16x16x32_bf16 a[56:59], v[80:83], a[188:191], a[56:59]
ds_read_b64_tr_b16 a[178:179], v220 offset:12288
v_cvt_pk_bf16_f32 v94, v52, v53
v_mfma_f32_16x16x32_bf16 a[40:43], v[80:83], a[184:187], a[40:43]
v_exp_f32 v54, v54
v_mfma_f32_16x16x32_bf16 a[36:39], v[76:79], a[184:187], a[36:39]
buffer_load_dwordx4 v233, s[12:15], s39 offen offset:1024  lds
v_mfma_f32_16x16x32_bf16 a[52:55], v[76:79], a[188:191], a[52:55]
v_exp_f32 v55, v55
v_mfma_f32_16x16x32_bf16 a[48:51], v[72:75], a[188:191], a[48:51]
ds_read_b64_tr_b16 a[188:189], v223 offset:8192
v_cvt_pk_bf16_f32 v95, v54, v55
STUB_8:
s_cbranch_execz STUB_11
v_mfma_f32_16x16x32_bf16 a[32:35], v[72:75], a[184:187], a[32:35]
v_exp_f32 v56, v56
v_smfmac_f32_16x16x64_bf16 a[128:131], a[208:211], v[72:79], v245
ds_read_b64_tr_b16 a[190:191], v223 offset:12288
v_mfma_f32_16x16x32_bf16 v[12:15], a[160:163], v[152:155], v[136:139]
v_exp_f32 v57, v57
v_mfma_f32_16x16x32_bf16 v[12:15], a[164:167], v[156:159], v[12:15]
v_exp_f32 v58, v58
v_mfma_f32_16x16x32_bf16 v[12:15], a[168:171], v[160:163], v[12:15]
ds_read_b64_tr_b16 a[184:185], v222 offset:8192
v_cvt_pk_bf16_f32 v96, v56, v57
v_mfma_f32_16x16x32_bf16 v[12:15], a[172:175], v[164:167], v[12:15]
v_exp_f32 v59, v59
v_mfma_f32_16x16x32_bf16 v[20:23], a[172:175], v[180:183], v[140:143]
ds_read_b64_tr_b16 a[186:187], v222 offset:12288
v_cvt_pk_bf16_f32 v97, v58, v59
v_mfma_f32_16x16x32_bf16 v[20:23], a[168:171], v[176:179], v[20:23]
v_exp_f32 v60, v60
v_mfma_f32_16x16x32_bf16 v[20:23], a[164:167], v[172:175], v[20:23]
buffer_load_dwordx4 v232, s[12:15], s39 offen offset:2048  lds
v_mfma_f32_16x16x32_bf16 v[20:23], a[160:163], v[168:171], v[20:23]
v_exp_f32 v61, v61
v_mfma_f32_16x16x32_bf16 v[28:31], a[160:163], v[184:187], v[144:147]
v_cvt_pk_bf16_f32 v98, v60, v61
v_mfma_f32_16x16x32_bf16 v[28:31], a[164:167], v[188:191], v[28:31]
v_exp_f32 v62, v62
v_mfma_f32_16x16x32_bf16 v[28:31], a[168:171], v[192:195], v[28:31]
buffer_load_dwordx4 v233, s[12:15], s39 offen offset:3072  lds
v_mfma_f32_16x16x32_bf16 v[28:31], a[172:175], v[196:199], v[28:31]
v_exp_f32 v63, v63
v_mfma_f32_16x16x32_bf16 v[36:39], a[172:175], v[212:215], v[148:151]
ds_read_b128 a[172:175], v219 offset:28672
v_cvt_pk_bf16_f32 v99, v62, v63
v_mfma_f32_16x16x32_bf16 v[36:39], a[168:171], v[208:211], v[36:39]
v_exp_f32 v64, v64
v_mfma_f32_16x16x32_bf16 v[36:39], a[164:167], v[204:207], v[36:39]
ds_read_b128 a[168:171], v218 offset:28672
ds_read_b128 a[164:167], v217 offset:28672
v_mfma_f32_16x16x32_bf16 v[36:39], a[160:163], v[200:203], v[36:39]
v_exp_f32 v65, v65
s_waitcnt lgkmcnt(8)
v_mfma_f32_16x16x32_bf16 a[64:67], v[72:75], a[192:195], a[64:67]
ds_read_b128 a[160:163], v216 offset:28672
v_cvt_pk_bf16_f32 v100, v64, v65
v_mfma_f32_16x16x32_bf16 a[80:83], v[72:75], a[196:199], a[80:83]
v_exp_f32 v66, v66
v_mfma_f32_16x16x32_bf16 a[84:87], v[76:79], a[196:199], a[84:87]
s_add_u32 m0, s86, 32768
s_add_u32 s50, s85, 24576
buffer_load_dwordx4 v244, s[72:75], s50 offen lds
v_mfma_f32_16x16x32_bf16 a[68:71], v[76:79], a[192:195], a[68:71]
v_exp_f32 v67, v67
v_mfma_f32_16x16x32_bf16 a[72:75], v[80:83], a[192:195], a[72:75]
s_cmp_lt_u32 s37, 2
s_cselect_b64 s[90:91], -1, 0
v_cvt_pk_bf16_f32 v101, v66, v67
v_mfma_f32_16x16x32_bf16 a[88:91], v[80:83], a[196:199], a[88:91]
v_exp_f32 v68, v68
v_mfma_f32_16x16x32_bf16 a[92:95], v[84:87], a[196:199], a[92:95]
ds_read_b64_tr_b16 a[196:197], v225 offset:8192
ds_read_b64_tr_b16 a[198:199], v225 offset:12288
v_mfma_f32_16x16x32_bf16 a[76:79], v[84:87], a[192:195], a[76:79]
v_exp_f32 v69, v69
v_mfma_f32_16x16x32_bf16 a[108:111], v[84:87], a[200:203], a[108:111]
ds_read_b64_tr_b16 a[192:193], v224 offset:8192
v_cvt_pk_bf16_f32 v102, v68, v69
v_mfma_f32_16x16x32_bf16 a[124:127], v[84:87], a[204:207], a[124:127]
v_exp_f32 v70, v70
v_mfma_f32_16x16x32_bf16 a[120:123], v[80:83], a[204:207], a[120:123]
ds_read_b64_tr_b16 a[194:195], v224 offset:12288
v_mfma_f32_16x16x32_bf16 a[104:107], v[80:83], a[200:203], a[104:107]
v_exp_f32 v71, v71
v_mfma_f32_16x16x32_bf16 a[100:103], v[76:79], a[200:203], a[100:103]
v_cvt_pk_bf16_f32 v103, v70, v71
v_mfma_f32_16x16x32_bf16 a[116:119], v[76:79], a[204:207], a[116:119]
s_add_u32 m0, s86, 36864
s_add_u32 s50, s85, 28672
buffer_load_dwordx4 v244, s[72:75], s50 offen lds
v_mfma_f32_16x16x32_bf16 a[112:115], v[72:75], a[204:207], a[112:115]
ds_read_b64_tr_b16 a[204:205], v227 offset:8192
ds_read_b64_tr_b16 a[206:207], v227 offset:12288
v_mfma_f32_16x16x32_bf16 a[96:99], v[72:75], a[200:203], a[96:99]
ds_read_b64_tr_b16 a[200:201], v226 offset:8192
ds_read_b64_tr_b16 a[202:203], v226 offset:12288
v_smfmac_f32_16x16x64_bf16 a[132:135], a[208:211], v[80:87], v245
s_add_u32 m0, s86, 40960
s_add_u32 s50, s85, 32768
buffer_load_dwordx4 v244, s[72:75], s50 offen lds
v_mfma_f32_16x16x32_bf16 v[40:43], a[144:147], v[152:155], v[136:139]
v_exp_f32 v8, v8
v_mfma_f32_16x16x32_bf16 v[40:43], a[148:151], v[156:159], v[40:43]
v_exp_f32 v9, v9
v_mfma_f32_16x16x32_bf16 v[40:43], a[152:155], v[160:163], v[40:43]
v_cvt_pk_bf16_f32 v72, v8, v9
v_mfma_f32_16x16x32_bf16 v[40:43], a[156:159], v[164:167], v[40:43]
v_exp_f32 v10, v10
v_mfma_f32_16x16x32_bf16 v[48:51], a[156:159], v[180:183], v[140:143]
v_mfma_f32_16x16x32_bf16 v[48:51], a[152:155], v[176:179], v[48:51]
v_exp_f32 v11, v11
v_mfma_f32_16x16x32_bf16 v[48:51], a[148:151], v[172:175], v[48:51]
v_cvt_pk_bf16_f32 v73, v10, v11
v_mfma_f32_16x16x32_bf16 v[48:51], a[144:147], v[168:171], v[48:51]
v_exp_f32 v12, v12
v_mfma_f32_16x16x32_bf16 v[56:59], a[144:147], v[184:187], v[144:147]
v_mfma_f32_16x16x32_bf16 v[56:59], a[148:151], v[188:191], v[56:59]
v_exp_f32 v13, v13
v_mfma_f32_16x16x32_bf16 v[56:59], a[152:155], v[192:195], v[56:59]
v_cvt_pk_bf16_f32 v74, v12, v13
v_mfma_f32_16x16x32_bf16 v[56:59], a[156:159], v[196:199], v[56:59]
v_exp_f32 v14, v14
v_mfma_f32_16x16x32_bf16 v[64:67], a[156:159], v[212:215], v[148:151]
s_waitcnt vmcnt(14) lgkmcnt(0)
s_barrier
v_mfma_f32_16x16x32_bf16 v[64:67], a[152:155], v[208:211], v[64:67]
ds_read_b128 v[124:127], v239 offset:45056
v_exp_f32 v15, v15
v_mfma_f32_16x16x32_bf16 v[64:67], a[148:151], v[204:207], v[64:67]
ds_read_b128 a[156:159], v219 offset:49152
ds_read_b128 v[128:131], v239 offset:45568
v_cvt_pk_bf16_f32 v75, v14, v15
v_mfma_f32_16x16x32_bf16 v[64:67], a[144:147], v[200:203], v[64:67]
ds_read_b128 v[248:251], v239 offset:46080
v_exp_f32 v16, v16
v_mfma_f32_16x16x32_bf16 a[0:3], v[88:91], a[176:179], a[0:3]
ds_read_b128 a[152:155], v218 offset:49152
ds_read_b128 a[148:151], v217 offset:49152
ds_read_b128 v[252:255], v239 offset:46592
v_mfma_f32_16x16x32_bf16 a[16:19], v[88:91], a[180:183], a[16:19]
ds_read_b64_tr_b16 v[116:117], v241 offset:0
v_exp_f32 v17, v17
v_mfma_f32_16x16x32_bf16 a[20:23], v[92:95], a[180:183], a[20:23]
ds_read_b128 a[144:147], v216 offset:49152
ds_read_b64_tr_b16 v[118:119], v241 offset:256
v_cvt_pk_bf16_f32 v76, v16, v17
v_mfma_f32_16x16x32_bf16 a[4:7], v[92:95], a[176:179], a[4:7]
ds_read_b64_tr_b16 v[120:121], v241 offset:2048
v_exp_f32 v18, v18
v_mfma_f32_16x16x32_bf16 a[8:11], v[96:99], a[176:179], a[8:11]
s_add_u32 s32, s32, 16384
ds_read_b64_tr_b16 v[122:123], v241 offset:2304
v_mfma_f32_16x16x32_bf16 a[24:27], v[96:99], a[180:183], a[24:27]
v_exp_f32 v19, v19
v_mfma_f32_16x16x32_bf16 a[28:31], v[100:103], a[180:183], a[28:31]
ds_read_b64_tr_b16 a[180:181], v221 offset:32768
v_cvt_pk_bf16_f32 v77, v18, v19
v_mfma_f32_16x16x32_bf16 a[12:15], v[100:103], a[176:179], a[12:15]
v_exp_f32 v20, v20
v_mfma_f32_16x16x32_bf16 a[44:47], v[100:103], a[184:187], a[44:47]
ds_read_b64_tr_b16 a[182:183], v221 offset:36864
ds_read_b64_tr_b16 a[176:177], v220 offset:32768
v_mfma_f32_16x16x32_bf16 a[60:63], v[100:103], a[188:191], a[60:63]
v_exp_f32 v21, v21
v_mfma_f32_16x16x32_bf16 a[56:59], v[96:99], a[188:191], a[56:59]
ds_read_b64_tr_b16 a[178:179], v220 offset:36864
v_cvt_pk_bf16_f32 v78, v20, v21
s_waitcnt lgkmcnt(8)
v_mfma_f32_16x16x32_bf16 v[132:135], a[212:215], v[124:127], 0
s_add_u32 m0, s30, 81920
ds_read_b128 v[124:127], v239 offset:47104
v_mfma_f32_16x16x32_bf16 a[40:43], v[96:99], a[184:187], a[40:43]
v_exp_f32 v22, v22
v_mfma_f32_16x16x32_bf16 a[36:39], v[92:95], a[184:187], a[36:39]
v_mfma_f32_16x16x32_bf16 v[132:135], a[216:219], v[128:131], v[132:135]
ds_read_b128 v[128:131], v239 offset:47616
v_mfma_f32_16x16x32_bf16 a[52:55], v[92:95], a[188:191], a[52:55]
v_exp_f32 v23, v23
v_mfma_f32_16x16x32_bf16 a[48:51], v[88:91], a[188:191], a[48:51]
ds_read_b64_tr_b16 a[188:189], v223 offset:32768
v_cvt_pk_bf16_f32 v79, v22, v23
v_mfma_f32_16x16x32_bf16 v[132:135], a[220:223], v[248:251], v[132:135]
ds_read_b64_tr_b16 a[190:191], v223 offset:36864
ds_read_b128 v[248:251], v239 offset:48128
v_mfma_f32_16x16x32_bf16 a[32:35], v[88:91], a[184:187], a[32:35]
v_exp_f32 v24, v24
v_smfmac_f32_16x16x64_bf16 a[128:131], a[208:211], v[88:95], v245
ds_read_b64_tr_b16 a[184:185], v222 offset:32768
v_mfma_f32_16x16x32_bf16 v[132:135], a[224:227], v[252:255], v[132:135]
ds_read_b64_tr_b16 a[186:187], v222 offset:36864
ds_read_b128 v[252:255], v239 offset:48640
v_mfma_f32_16x16x32_bf16 v[44:47], a[160:163], v[152:155], v[136:139]
v_exp_f32 v25, v25
v_mfma_f32_16x16x32_bf16 v[44:47], a[164:167], v[156:159], v[44:47]
v_exp_f32 v26, v26
s_waitcnt lgkmcnt(7)
v_mfma_f32_16x16x32_bf16 v[132:135], a[228:231], v[124:127], v[132:135]
ds_read_b128 v[124:127], v239 offset:49152
v_cvt_pk_bf16_f32 v80, v24, v25
v_mfma_f32_16x16x32_bf16 v[44:47], a[168:171], v[160:163], v[44:47]
buffer_load_dwordx4 v228, s[8:11], s32 offen offset:0  lds
v_mfma_f32_16x16x32_bf16 v[44:47], a[172:175], v[164:167], v[44:47]
v_exp_f32 v27, v27
s_waitcnt lgkmcnt(7)
v_mfma_f32_16x16x32_bf16 v[132:135], a[232:235], v[128:131], v[132:135]
ds_read_b128 v[128:131], v239 offset:49664
v_mfma_f32_16x16x32_bf16 v[52:55], a[172:175], v[180:183], v[140:143]
v_cvt_pk_bf16_f32 v81, v26, v27
v_mfma_f32_16x16x32_bf16 v[52:55], a[168:171], v[176:179], v[52:55]
v_exp_f32 v28, v28
s_waitcnt lgkmcnt(5)
v_mfma_f32_16x16x32_bf16 v[132:135], a[236:239], v[248:251], v[132:135]
buffer_load_dwordx4 v229, s[8:11], s32 offen offset:1024  lds
ds_read_b128 v[248:251], v239 offset:50176
v_mfma_f32_16x16x32_bf16 v[52:55], a[164:167], v[172:175], v[52:55]
v_mfma_f32_16x16x32_bf16 v[52:55], a[160:163], v[168:171], v[52:55]
v_exp_f32 v29, v29
s_waitcnt lgkmcnt(3)
v_mfma_f32_16x16x32_bf16 v[132:135], a[240:243], v[252:255], v[132:135]
ds_read_b128 v[252:255], v239 offset:50688
v_mfma_f32_16x16x32_bf16 v[60:63], a[160:163], v[184:187], v[144:147]
v_cvt_pk_bf16_f32 v82, v28, v29
v_mfma_f32_16x16x32_bf16 v[60:63], a[164:167], v[188:191], v[60:63]
v_exp_f32 v30, v30
s_waitcnt lgkmcnt(3)
v_mfma_f32_16x16x32_bf16 v[132:135], a[244:247], v[124:127], v[132:135]
ds_read_b128 v[124:127], v239 offset:51200
v_mfma_f32_16x16x32_bf16 v[60:63], a[168:171], v[192:195], v[60:63]
v_mfma_f32_16x16x32_bf16 v[60:63], a[172:175], v[196:199], v[60:63]
v_exp_f32 v31, v31
s_waitcnt lgkmcnt(3)
v_mfma_f32_16x16x32_bf16 v[132:135], a[248:251], v[128:131], v[132:135]
buffer_load_dwordx4 v230, s[8:11], s32 offen offset:2048  lds
ds_read_b128 v[128:131], v239 offset:51712
v_mfma_f32_16x16x32_bf16 v[68:71], a[172:175], v[212:215], v[148:151]
ds_read_b128 a[172:175], v219 offset:53248
v_cvt_pk_bf16_f32 v83, v30, v31
v_mfma_f32_16x16x32_bf16 v[68:71], a[168:171], v[208:211], v[68:71]
v_exp_f32 v32, v32
s_waitcnt lgkmcnt(4)
v_mfma_f32_16x16x32_bf16 v[132:135], a[252:255], v[248:251], v[132:135]
ds_read_b128 a[168:171], v218 offset:53248
ds_read_b128 v[248:251], v239 offset:52224
v_mfma_f32_16x16x32_bf16 v[68:71], a[164:167], v[204:207], v[68:71]
ds_read_b128 a[164:167], v217 offset:53248
v_mfma_f32_16x16x32_bf16 v[68:71], a[160:163], v[200:203], v[68:71]
v_exp_f32 v33, v33
s_waitcnt lgkmcnt(6)
v_mfma_f32_16x16x32_bf16 v[132:135], a[136:139], v[252:255], v[132:135]
ds_read_b128 a[160:163], v216 offset:53248
ds_read_b128 v[252:255], v239 offset:52736
v_mfma_f32_16x16x32_bf16 a[64:67], v[88:91], a[192:195], a[64:67]
v_cvt_pk_bf16_f32 v84, v32, v33
v_mfma_f32_16x16x32_bf16 a[80:83], v[88:91], a[196:199], a[80:83]
v_exp_f32 v34, v34
s_waitcnt lgkmcnt(7)
v_mfma_f32_16x16x32_bf16 v[132:135], a[140:143], v[124:127], v[132:135]
ds_read_b128 v[124:127], v239 offset:53248
v_mfma_f32_16x16x32_bf16 a[84:87], v[92:95], a[196:199], a[84:87]
buffer_load_dwordx4 v231, s[8:11], s32 offen offset:3072  lds
v_mfma_f32_16x16x32_bf16 a[68:71], v[92:95], a[192:195], a[68:71]
v_exp_f32 v35, v35
s_waitcnt lgkmcnt(7)
v_mfma_f32_16x16x32_bf16 v[132:135], v[104:107], v[128:131], v[132:135]
ds_read_b128 v[128:131], v239 offset:53760
v_mfma_f32_16x16x32_bf16 a[72:75], v[96:99], a[192:195], a[72:75]
v_cvt_pk_bf16_f32 v85, v34, v35
v_mfma_f32_16x16x32_bf16 a[88:91], v[96:99], a[196:199], a[88:91]
v_exp_f32 v36, v36
s_waitcnt lgkmcnt(5)
v_mfma_f32_16x16x32_bf16 v[132:135], v[108:111], v[248:251], v[132:135]
v_mfma_f32_16x16x32_bf16 a[92:95], v[100:103], a[196:199], a[92:95]
ds_read_b64_tr_b16 a[196:197], v225 offset:32768
ds_read_b64_tr_b16 a[198:199], v225 offset:36864
v_mfma_f32_16x16x32_bf16 a[76:79], v[100:103], a[192:195], a[76:79]
v_exp_f32 v37, v37
s_waitcnt lgkmcnt(4)
v_mfma_f32_16x16x32_bf16 v[132:135], v[112:115], v[252:255], v[132:135]
ds_read_b64_tr_b16 a[192:193], v224 offset:32768
ds_read_b64_tr_b16 a[194:195], v224 offset:36864
v_mfma_f32_16x16x32_bf16 a[108:111], v[100:103], a[200:203], a[108:111]
v_cvt_pk_bf16_f32 v86, v36, v37
v_mfma_f32_16x16x32_bf16 a[124:127], v[100:103], a[204:207], a[124:127]
v_exp_f32 v38, v38
s_waitcnt lgkmcnt(5)
v_mfma_f32_16x16x32_bf16 v[132:135], v[116:119], v[124:127], v[132:135]
v_mfma_f32_16x16x32_bf16 a[120:123], v[96:99], a[204:207], a[120:123]
v_mfma_f32_16x16x32_bf16 a[104:107], v[96:99], a[200:203], a[104:107]
v_exp_f32 v39, v39
s_waitcnt lgkmcnt(4)
v_mfma_f32_16x16x32_bf16 v[132:135], v[120:123], v[128:131], v[132:135]
v_mfma_f32_16x16x32_bf16 a[100:103], v[92:95], a[200:203], a[100:103]
v_cvt_pk_bf16_f32 v87, v38, v39
v_mfma_f32_16x16x32_bf16 a[116:119], v[92:95], a[204:207], a[116:119]
v_mfma_f32_16x16x32_bf16 a[112:115], v[88:91], a[204:207], a[112:115]
ds_read_b64_tr_b16 a[204:205], v227 offset:32768
ds_read_b64_tr_b16 a[206:207], v227 offset:36864
v_mfma_f32_16x16x32_bf16 a[96:99], v[88:91], a[200:203], a[96:99]
ds_read_b64_tr_b16 a[200:201], v226 offset:32768
ds_read_b64_tr_b16 a[202:203], v226 offset:36864
v_smfmac_f32_16x16x64_bf16 a[132:135], a[208:211], v[96:103], v245
v_mfma_f32_16x16x32_bf16 v[8:11], a[144:147], v[152:155], v[136:139]
v_exp_f32 v40, v40
v_mfma_f32_16x16x32_bf16 v[8:11], a[148:151], v[156:159], v[8:11]
v_exp_f32 v41, v41
v_mfma_f32_16x16x32_bf16 v[8:11], a[152:155], v[160:163], v[8:11]
v_cvt_pk_bf16_f32 v88, v40, v41
v_cvt_pk_bf16_f32 v104, v132, v133
v_cvt_pk_bf16_f32 v105, v134, v135
v_mfma_f32_16x16x32_bf16 v[8:11], a[156:159], v[164:167], v[8:11]
v_lshlrev_b32 v132, 16, v104
v_exp_f32 v42, v42
v_mfma_f32_16x16x32_bf16 v[16:19], a[156:159], v[180:183], v[140:143]
s_add_u32 s39, s39, 16384
v_and_b32 v133, 0xffff0000, v104
v_lshlrev_b32 v134, 16, v105
v_mfma_f32_16x16x32_bf16 v[16:19], a[152:155], v[176:179], v[16:19]
v_and_b32 v135, 0xffff0000, v105
v_exp_f32 v43, v43
v_mfma_f32_16x16x32_bf16 v[16:19], a[148:151], v[172:175], v[16:19]
v_cvt_pk_bf16_f32 v89, v42, v43
v_mul_f32 v104, 0xbfb8aa3b, v132
v_mul_f32 v105, 0xbfb8aa3b, v133
v_mfma_f32_16x16x32_bf16 v[16:19], a[144:147], v[168:171], v[16:19]
v_mul_f32 v106, 0xbfb8aa3b, v134
v_exp_f32 v44, v44
v_mfma_f32_16x16x32_bf16 v[24:27], a[144:147], v[184:187], v[144:147]
v_mul_f32 v107, 0xbfb8aa3b, v135
v_exp_f32 v104, v104
v_mfma_f32_16x16x32_bf16 v[24:27], a[148:151], v[188:191], v[24:27]
v_exp_f32 v45, v45
v_mfma_f32_16x16x32_bf16 v[24:27], a[152:155], v[192:195], v[24:27]
v_cvt_pk_bf16_f32 v90, v44, v45
v_exp_f32 v105, v105
v_mfma_f32_16x16x32_bf16 v[24:27], a[156:159], v[196:199], v[24:27]
v_exp_f32 v46, v46
v_mfma_f32_16x16x32_bf16 v[32:35], a[156:159], v[212:215], v[148:151]
ds_read_b128 a[156:159], v219 offset:57344
s_add_u32 m0, s30, 98304
v_mfma_f32_16x16x32_bf16 v[32:35], a[152:155], v[208:211], v[32:35]
v_exp_f32 v47, v47
v_mfma_f32_16x16x32_bf16 v[32:35], a[148:151], v[204:207], v[32:35]
ds_read_b128 a[152:155], v218 offset:57344
v_cvt_pk_bf16_f32 v91, v46, v47
v_mfma_f32_16x16x32_bf16 v[32:35], a[144:147], v[200:203], v[32:35]
v_exp_f32 v48, v48
v_mfma_f32_16x16x32_bf16 a[0:3], v[72:75], a[176:179], a[0:3]
ds_read_b128 a[148:151], v217 offset:57344
ds_read_b128 a[144:147], v216 offset:57344
v_mfma_f32_16x16x32_bf16 a[16:19], v[72:75], a[180:183], a[16:19]
v_exp_f32 v49, v49
v_mfma_f32_16x16x32_bf16 a[20:23], v[76:79], a[180:183], a[20:23]
v_cvt_pk_bf16_f32 v92, v48, v49
v_exp_f32 v106, v106
v_mfma_f32_16x16x32_bf16 a[4:7], v[76:79], a[176:179], a[4:7]
v_exp_f32 v50, v50
v_mfma_f32_16x16x32_bf16 a[8:11], v[80:83], a[176:179], a[8:11]
v_exp_f32 v107, v107
v_mfma_f32_16x16x32_bf16 a[24:27], v[80:83], a[180:183], a[24:27]
v_add_f32 v104, 1.0, v104
v_exp_f32 v51, v51
v_mfma_f32_16x16x32_bf16 a[28:31], v[84:87], a[180:183], a[28:31]
ds_read_b64_tr_b16 a[180:181], v221 offset:40960
v_cvt_pk_bf16_f32 v93, v50, v51
v_add_f32 v105, 1.0, v105
v_mfma_f32_16x16x32_bf16 a[12:15], v[84:87], a[176:179], a[12:15]
v_add_f32 v106, 1.0, v106
v_exp_f32 v52, v52
v_mfma_f32_16x16x32_bf16 a[44:47], v[84:87], a[184:187], a[44:47]
ds_read_b64_tr_b16 a[182:183], v221 offset:45056
ds_read_b64_tr_b16 a[176:177], v220 offset:40960
v_add_f32 v107, 1.0, v107
v_mfma_f32_16x16x32_bf16 a[60:63], v[84:87], a[188:191], a[60:63]
v_exp_f32 v53, v53
v_mfma_f32_16x16x32_bf16 a[56:59], v[80:83], a[188:191], a[56:59]
ds_read_b64_tr_b16 a[178:179], v220 offset:45056
v_cvt_pk_bf16_f32 v94, v52, v53
v_mfma_f32_16x16x32_bf16 a[40:43], v[80:83], a[184:187], a[40:43]
v_exp_f32 v54, v54
v_mfma_f32_16x16x32_bf16 a[36:39], v[76:79], a[184:187], a[36:39]
buffer_load_dwordx4 v232, s[12:15], s39 offen offset:0  lds
v_mfma_f32_16x16x32_bf16 a[52:55], v[76:79], a[188:191], a[52:55]
v_exp_f32 v55, v55
v_mfma_f32_16x16x32_bf16 a[48:51], v[72:75], a[188:191], a[48:51]
ds_read_b64_tr_b16 a[188:189], v223 offset:40960
v_cvt_pk_bf16_f32 v95, v54, v55
v_mfma_f32_16x16x32_bf16 a[32:35], v[72:75], a[184:187], a[32:35]
v_exp_f32 v56, v56
v_smfmac_f32_16x16x64_bf16 a[128:131], a[208:211], v[72:79], v245
ds_read_b64_tr_b16 a[190:191], v223 offset:45056
v_mfma_f32_16x16x32_bf16 v[12:15], a[160:163], v[152:155], v[136:139]
v_exp_f32 v57, v57
v_mfma_f32_16x16x32_bf16 v[12:15], a[164:167], v[156:159], v[12:15]
v_exp_f32 v58, v58
v_mfma_f32_16x16x32_bf16 v[12:15], a[168:171], v[160:163], v[12:15]
ds_read_b64_tr_b16 a[184:185], v222 offset:40960
v_cvt_pk_bf16_f32 v96, v56, v57
v_mfma_f32_16x16x32_bf16 v[12:15], a[172:175], v[164:167], v[12:15]
v_exp_f32 v59, v59
v_mfma_f32_16x16x32_bf16 v[20:23], a[172:175], v[180:183], v[140:143]
ds_read_b64_tr_b16 a[186:187], v222 offset:45056
v_cvt_pk_bf16_f32 v97, v58, v59
v_mfma_f32_16x16x32_bf16 v[20:23], a[168:171], v[176:179], v[20:23]
v_exp_f32 v60, v60
v_mfma_f32_16x16x32_bf16 v[20:23], a[164:167], v[172:175], v[20:23]
buffer_load_dwordx4 v233, s[12:15], s39 offen offset:1024  lds
v_mfma_f32_16x16x32_bf16 v[20:23], a[160:163], v[168:171], v[20:23]
v_exp_f32 v61, v61
v_mfma_f32_16x16x32_bf16 v[28:31], a[160:163], v[184:187], v[144:147]
v_cvt_pk_bf16_f32 v98, v60, v61
v_rcp_f32 v104, v104
v_mfma_f32_16x16x32_bf16 v[28:31], a[164:167], v[188:191], v[28:31]
v_exp_f32 v62, v62
v_mfma_f32_16x16x32_bf16 v[28:31], a[168:171], v[192:195], v[28:31]
buffer_load_dwordx4 v232, s[12:15], s39 offen offset:2048  lds
v_mfma_f32_16x16x32_bf16 v[28:31], a[172:175], v[196:199], v[28:31]
v_exp_f32 v63, v63
v_mfma_f32_16x16x32_bf16 v[36:39], a[172:175], v[212:215], v[148:151]
ds_read_b128 a[172:175], v219 offset:61440
v_cvt_pk_bf16_f32 v99, v62, v63
v_mfma_f32_16x16x32_bf16 v[36:39], a[168:171], v[208:211], v[36:39]
v_exp_f32 v64, v64
v_mfma_f32_16x16x32_bf16 v[36:39], a[164:167], v[204:207], v[36:39]
ds_read_b128 a[168:171], v218 offset:61440
ds_read_b128 a[164:167], v217 offset:61440
v_mfma_f32_16x16x32_bf16 v[36:39], a[160:163], v[200:203], v[36:39]
v_exp_f32 v65, v65
s_waitcnt lgkmcnt(8)
v_mfma_f32_16x16x32_bf16 a[64:67], v[72:75], a[192:195], a[64:67]
ds_read_b128 a[160:163], v216 offset:61440
v_cvt_pk_bf16_f32 v100, v64, v65
v_mfma_f32_16x16x32_bf16 a[80:83], v[72:75], a[196:199], a[80:83]
v_exp_f32 v66, v66
v_mfma_f32_16x16x32_bf16 a[84:87], v[76:79], a[196:199], a[84:87]
buffer_load_dwordx4 v233, s[12:15], s39 offen offset:3072  lds
v_mfma_f32_16x16x32_bf16 a[68:71], v[76:79], a[192:195], a[68:71]
v_exp_f32 v67, v67
v_mfma_f32_16x16x32_bf16 a[72:75], v[80:83], a[192:195], a[72:75]
v_cvt_pk_bf16_f32 v101, v66, v67
v_rcp_f32 v105, v105
v_mfma_f32_16x16x32_bf16 a[88:91], v[80:83], a[196:199], a[88:91]
v_exp_f32 v68, v68
v_mfma_f32_16x16x32_bf16 a[92:95], v[84:87], a[196:199], a[92:95]
ds_read_b64_tr_b16 a[196:197], v225 offset:40960
ds_read_b64_tr_b16 a[198:199], v225 offset:45056
v_mfma_f32_16x16x32_bf16 a[76:79], v[84:87], a[192:195], a[76:79]
v_exp_f32 v69, v69
v_mfma_f32_16x16x32_bf16 a[108:111], v[84:87], a[200:203], a[108:111]
ds_read_b64_tr_b16 a[192:193], v224 offset:40960
v_cvt_pk_bf16_f32 v102, v68, v69
v_mfma_f32_16x16x32_bf16 a[124:127], v[84:87], a[204:207], a[124:127]
v_exp_f32 v70, v70
v_mfma_f32_16x16x32_bf16 a[120:123], v[80:83], a[204:207], a[120:123]
ds_read_b64_tr_b16 a[194:195], v224 offset:45056
v_rcp_f32 v106, v106
v_mfma_f32_16x16x32_bf16 a[104:107], v[80:83], a[200:203], a[104:107]
v_exp_f32 v71, v71
v_mfma_f32_16x16x32_bf16 a[100:103], v[76:79], a[200:203], a[100:103]
v_cvt_pk_bf16_f32 v103, v70, v71
v_rcp_f32 v107, v107
v_mfma_f32_16x16x32_bf16 a[116:119], v[76:79], a[204:207], a[116:119]
v_mul_f32 v104, v132, v104
v_mul_f32 v105, v133, v105
v_mul_f32 v106, v134, v106
v_mfma_f32_16x16x32_bf16 a[112:115], v[72:75], a[204:207], a[112:115]
ds_read_b64_tr_b16 a[204:205], v227 offset:40960
ds_read_b64_tr_b16 a[206:207], v227 offset:45056
v_mul_f32 v107, v135, v107
v_mfma_f32_16x16x32_bf16 a[96:99], v[72:75], a[200:203], a[96:99]
ds_read_b64_tr_b16 a[200:201], v226 offset:40960
ds_read_b64_tr_b16 a[202:203], v226 offset:45056
v_cvt_pk_bf16_f32 v108, v104, v105
v_smfmac_f32_16x16x64_bf16 a[132:135], a[208:211], v[80:87], v245
v_cvt_pk_bf16_f32 v109, v106, v107
v_lshlrev_b32 v104, 16, v108
v_and_b32 v105, 0xffff0000, v108
v_lshlrev_b32 v106, 16, v109
v_and_b32 v107, 0xffff0000, v109
v_cndmask_b32 v132, v132, v104, s[90:91]
v_cndmask_b32 v133, v133, v105, s[90:91]
v_cndmask_b32 v134, v134, v106, s[90:91]
v_cndmask_b32 v135, v135, v107, s[90:91]
ds_write_b128 v237, v[132:135] offset:54272
v_mfma_f32_16x16x32_bf16 v[40:43], a[144:147], v[152:155], v[136:139]
v_exp_f32 v8, v8
v_mfma_f32_16x16x32_bf16 v[40:43], a[148:151], v[156:159], v[40:43]
v_exp_f32 v9, v9
v_mfma_f32_16x16x32_bf16 v[40:43], a[152:155], v[160:163], v[40:43]
v_cvt_pk_bf16_f32 v72, v8, v9
v_mfma_f32_16x16x32_bf16 v[40:43], a[156:159], v[164:167], v[40:43]
v_exp_f32 v10, v10
v_mfma_f32_16x16x32_bf16 v[48:51], a[156:159], v[180:183], v[140:143]
v_mfma_f32_16x16x32_bf16 v[48:51], a[152:155], v[176:179], v[48:51]
v_exp_f32 v11, v11
v_mfma_f32_16x16x32_bf16 v[48:51], a[148:151], v[172:175], v[48:51]
v_cvt_pk_bf16_f32 v73, v10, v11
v_mfma_f32_16x16x32_bf16 v[48:51], a[144:147], v[168:171], v[48:51]
v_exp_f32 v12, v12
v_mfma_f32_16x16x32_bf16 v[56:59], a[144:147], v[184:187], v[144:147]
v_mfma_f32_16x16x32_bf16 v[56:59], a[148:151], v[188:191], v[56:59]
v_exp_f32 v13, v13
v_mfma_f32_16x16x32_bf16 v[56:59], a[152:155], v[192:195], v[56:59]
v_cvt_pk_bf16_f32 v74, v12, v13
v_mfma_f32_16x16x32_bf16 v[56:59], a[156:159], v[196:199], v[56:59]
v_exp_f32 v14, v14
v_mfma_f32_16x16x32_bf16 v[64:67], a[156:159], v[212:215], v[148:151]
s_waitcnt vmcnt(8) lgkmcnt(0)
s_barrier
v_mfma_f32_16x16x32_bf16 v[64:67], a[152:155], v[208:211], v[64:67]
ds_read_b128 v[104:107], v244 offset:54272
v_exp_f32 v15, v15
v_mfma_f32_16x16x32_bf16 v[64:67], a[148:151], v[204:207], v[64:67]
ds_read_b128 a[156:159], v219 offset:0
ds_read_b128 v[108:111], v244 offset:55296
v_cvt_pk_bf16_f32 v75, v14, v15
v_mfma_f32_16x16x32_bf16 v[64:67], a[144:147], v[200:203], v[64:67]
ds_read_b128 v[112:115], v244 offset:56320
v_exp_f32 v16, v16
v_mfma_f32_16x16x32_bf16 a[0:3], v[88:91], a[176:179], a[0:3]
ds_read_b128 a[152:155], v218 offset:0
ds_read_b128 a[148:151], v217 offset:0
ds_read_b128 v[116:119], v244 offset:57344
v_mfma_f32_16x16x32_bf16 a[16:19], v[88:91], a[180:183], a[16:19]
ds_read_b64_tr_b16 a[212:213], v242 offset:0
v_exp_f32 v17, v17
v_mfma_f32_16x16x32_bf16 a[20:23], v[92:95], a[180:183], a[20:23]
ds_read_b128 a[144:147], v216 offset:0
ds_read_b64_tr_b16 a[214:215], v242 offset:18432
v_cvt_pk_bf16_f32 v76, v16, v17
v_mfma_f32_16x16x32_bf16 a[4:7], v[92:95], a[176:179], a[4:7]
ds_read_b64_tr_b16 a[216:217], v242 offset:32
v_exp_f32 v18, v18
v_mfma_f32_16x16x32_bf16 a[8:11], v[96:99], a[176:179], a[8:11]
s_add_u32 s32, s32, 16384
ds_read_b64_tr_b16 a[218:219], v242 offset:18464
ds_read_b64_tr_b16 a[220:221], v242 offset:64
v_mfma_f32_16x16x32_bf16 a[24:27], v[96:99], a[180:183], a[24:27]
ds_read_b64_tr_b16 a[222:223], v242 offset:18496
v_exp_f32 v19, v19
v_mfma_f32_16x16x32_bf16 a[28:31], v[100:103], a[180:183], a[28:31]
ds_read_b64_tr_b16 a[180:181], v221 offset:49152
ds_read_b64_tr_b16 a[224:225], v242 offset:96
v_cvt_pk_bf16_f32 v77, v18, v19
v_mfma_f32_16x16x32_bf16 a[12:15], v[100:103], a[176:179], a[12:15]
ds_read_b64_tr_b16 a[226:227], v242 offset:18528
v_exp_f32 v20, v20
v_mfma_f32_16x16x32_bf16 a[44:47], v[100:103], a[184:187], a[44:47]
ds_read_b64_tr_b16 a[182:183], v221 offset:53248
ds_read_b64_tr_b16 a[176:177], v220 offset:49152
ds_read_b64_tr_b16 a[228:229], v242 offset:128
v_mfma_f32_16x16x32_bf16 a[60:63], v[100:103], a[188:191], a[60:63]
ds_read_b64_tr_b16 a[230:231], v242 offset:18560
v_exp_f32 v21, v21
v_mfma_f32_16x16x32_bf16 a[56:59], v[96:99], a[188:191], a[56:59]
ds_read_b64_tr_b16 a[178:179], v220 offset:53248
ds_read_b64_tr_b16 a[232:233], v242 offset:160
v_cvt_pk_bf16_f32 v78, v20, v21
v_mfma_f32_16x16x32_bf16 a[40:43], v[96:99], a[184:187], a[40:43]
ds_read_b64_tr_b16 a[234:235], v242 offset:18592
v_exp_f32 v22, v22
v_mfma_f32_16x16x32_bf16 a[36:39], v[92:95], a[184:187], a[36:39]
s_add_u32 m0, s30, 114688
ds_read_b64_tr_b16 a[236:237], v242 offset:192
ds_read_b64_tr_b16 a[238:239], v242 offset:18624
v_mfma_f32_16x16x32_bf16 a[52:55], v[92:95], a[188:191], a[52:55]
ds_read_b64_tr_b16 a[240:241], v242 offset:224
v_exp_f32 v23, v23
v_mfma_f32_16x16x32_bf16 a[48:51], v[88:91], a[188:191], a[48:51]
ds_read_b64_tr_b16 a[188:189], v223 offset:49152
ds_read_b64_tr_b16 a[242:243], v242 offset:18656
v_cvt_pk_bf16_f32 v79, v22, v23
v_mfma_f32_16x16x32_bf16 a[32:35], v[88:91], a[184:187], a[32:35]
ds_read_b64_tr_b16 a[244:245], v242 offset:256
v_exp_f32 v24, v24
v_smfmac_f32_16x16x64_bf16 a[128:131], a[208:211], v[88:95], v245
ds_read_b64_tr_b16 a[190:191], v223 offset:53248
ds_read_b64_tr_b16 a[246:247], v242 offset:18688
v_mfma_f32_16x16x32_bf16 v[44:47], a[160:163], v[152:155], v[136:139]
s_waitcnt lgkmcnt(8)
v_mul_f32 v104, v104, v112
v_exp_f32 v25, v25
v_mfma_f32_16x16x32_bf16 v[44:47], a[164:167], v[156:159], v[44:47]
v_mul_f32 v105, v105, v113
v_exp_f32 v26, v26
v_mfma_f32_16x16x32_bf16 v[44:47], a[168:171], v[160:163], v[44:47]
ds_read_b64_tr_b16 a[184:185], v222 offset:49152
v_cvt_pk_bf16_f32 v80, v24, v25
v_mul_f32 v106, v106, v114
v_mfma_f32_16x16x32_bf16 v[44:47], a[172:175], v[164:167], v[44:47]
v_mul_f32 v107, v107, v115
v_exp_f32 v27, v27
v_mfma_f32_16x16x32_bf16 v[52:55], a[172:175], v[180:183], v[140:143]
ds_read_b64_tr_b16 a[186:187], v222 offset:53248
v_cvt_pk_bf16_f32 v81, v26, v27
v_mul_f32 v108, v108, v116
v_mfma_f32_16x16x32_bf16 v[52:55], a[168:171], v[176:179], v[52:55]
v_mul_f32 v109, v109, v117
v_exp_f32 v28, v28
v_mfma_f32_16x16x32_bf16 v[52:55], a[164:167], v[172:175], v[52:55]
STUB_9:
s_cbranch_execz STUB_12
buffer_load_dwordx4 v228, s[8:11], s32 offen offset:0  lds
v_mul_f32 v110, v110, v118
v_mfma_f32_16x16x32_bf16 v[52:55], a[160:163], v[168:171], v[52:55]
v_mul_f32 v111, v111, v119
v_exp_f32 v29, v29
v_mfma_f32_16x16x32_bf16 v[60:63], a[160:163], v[184:187], v[144:147]
v_cvt_pk_bf16_f32 v82, v28, v29
v_cvt_pk_bf16_f32 v120, v104, v105
v_cvt_pk_bf16_f32 v121, v106, v107
v_mfma_f32_16x16x32_bf16 v[60:63], a[164:167], v[188:191], v[60:63]
v_cvt_pk_bf16_f32 v122, v108, v109
v_exp_f32 v30, v30
v_mfma_f32_16x16x32_bf16 v[60:63], a[168:171], v[192:195], v[60:63]
buffer_load_dwordx4 v229, s[8:11], s32 offen offset:1024  lds
v_cvt_pk_bf16_f32 v123, v110, v111
v_mfma_f32_16x16x32_bf16 v[60:63], a[172:175], v[196:199], v[60:63]
v_exp_f32 v31, v31
v_mfma_f32_16x16x32_bf16 v[68:71], a[172:175], v[212:215], v[148:151]
ds_read_b128 a[172:175], v219 offset:4096
v_cvt_pk_bf16_f32 v83, v30, v31
v_mfma_f32_16x16x32_bf16 a[248:251], a[212:215], v[120:123], 0
buffer_load_dwordx4 v230, s[8:11], s32 offen offset:2048  lds
v_mfma_f32_16x16x32_bf16 v[68:71], a[168:171], v[208:211], v[68:71]
v_exp_f32 v32, v32
v_mfma_f32_16x16x32_bf16 a[212:215], a[216:219], v[120:123], 0
ds_read_b128 a[168:171], v218 offset:4096
v_mfma_f32_16x16x32_bf16 v[68:71], a[164:167], v[204:207], v[68:71]
ds_read_b128 a[164:167], v217 offset:4096
v_mfma_f32_16x16x32_bf16 a[216:219], a[220:223], v[120:123], 0
v_mfma_f32_16x16x32_bf16 v[68:71], a[160:163], v[200:203], v[68:71]
v_exp_f32 v33, v33
v_mfma_f32_16x16x32_bf16 a[220:223], a[224:227], v[120:123], 0
ds_read_b128 a[160:163], v216 offset:4096
v_mfma_f32_16x16x32_bf16 a[64:67], v[88:91], a[192:195], a[64:67]
v_cvt_pk_bf16_f32 v84, v32, v33
v_mfma_f32_16x16x32_bf16 a[224:227], a[228:231], v[120:123], 0
v_mfma_f32_16x16x32_bf16 a[80:83], v[88:91], a[196:199], a[80:83]
v_exp_f32 v34, v34
v_mfma_f32_16x16x32_bf16 a[228:231], a[232:235], v[120:123], 0
v_mfma_f32_16x16x32_bf16 a[84:87], v[92:95], a[196:199], a[84:87]
buffer_load_dwordx4 v231, s[8:11], s32 offen offset:3072  lds
s_waitcnt lgkmcnt(8)
v_mfma_f32_16x16x32_bf16 a[232:235], a[236:239], v[120:123], 0
v_mfma_f32_16x16x32_bf16 a[68:71], v[92:95], a[192:195], a[68:71]
v_exp_f32 v35, v35
v_mfma_f32_16x16x32_bf16 a[236:239], a[240:243], v[120:123], 0
v_mfma_f32_16x16x32_bf16 a[72:75], v[96:99], a[192:195], a[72:75]
v_cvt_pk_bf16_f32 v85, v34, v35
s_waitcnt lgkmcnt(6)
v_mfma_f32_16x16x32_bf16 a[240:243], a[244:247], v[120:123], 0
v_mfma_f32_16x16x32_bf16 a[88:91], v[96:99], a[196:199], a[88:91]
v_exp_f32 v36, v36
v_mfma_f32_16x16x32_bf16 a[92:95], v[100:103], a[196:199], a[92:95]
ds_read_b64_tr_b16 a[196:197], v225 offset:49152
ds_read_b64_tr_b16 a[198:199], v225 offset:53248
v_mfma_f32_16x16x32_bf16 a[76:79], v[100:103], a[192:195], a[76:79]
v_exp_f32 v37, v37
v_mfma_f32_16x16x32_bf16 a[108:111], v[100:103], a[200:203], a[108:111]
ds_read_b64_tr_b16 a[192:193], v224 offset:49152
v_cvt_pk_bf16_f32 v86, v36, v37
v_mfma_f32_16x16x32_bf16 a[124:127], v[100:103], a[204:207], a[124:127]
v_exp_f32 v38, v38
v_mfma_f32_16x16x32_bf16 a[120:123], v[96:99], a[204:207], a[120:123]
ds_read_b64_tr_b16 a[194:195], v224 offset:53248
v_mfma_f32_16x16x32_bf16 a[104:107], v[96:99], a[200:203], a[104:107]
v_exp_f32 v39, v39
v_mfma_f32_16x16x32_bf16 a[100:103], v[92:95], a[200:203], a[100:103]
buffer_store_dwordx4 a[248:251], v238, s[20:23], s28 offen offset:0 sc0 sc1
v_cvt_pk_bf16_f32 v87, v38, v39
v_mfma_f32_16x16x32_bf16 a[116:119], v[92:95], a[204:207], a[116:119]
v_mfma_f32_16x16x32_bf16 a[112:115], v[88:91], a[204:207], a[112:115]
ds_read_b64_tr_b16 a[204:205], v227 offset:49152
ds_read_b64_tr_b16 a[206:207], v227 offset:53248
v_mfma_f32_16x16x32_bf16 a[96:99], v[88:91], a[200:203], a[96:99]
ds_read_b64_tr_b16 a[200:201], v226 offset:49152
ds_read_b64_tr_b16 a[202:203], v226 offset:53248
v_smfmac_f32_16x16x64_bf16 a[132:135], a[208:211], v[96:103], v245
buffer_store_dwordx4 a[212:215], v238, s[20:23], s28 offen offset:512 sc0 sc1
v_mfma_f32_16x16x32_bf16 v[8:11], a[144:147], v[152:155], v[136:139]
v_exp_f32 v40, v40
v_mfma_f32_16x16x32_bf16 v[8:11], a[148:151], v[156:159], v[8:11]
v_exp_f32 v41, v41
v_mfma_f32_16x16x32_bf16 v[8:11], a[152:155], v[160:163], v[8:11]
buffer_store_dwordx4 a[216:219], v238, s[20:23], s28 offen offset:1024 sc0 sc1
v_cvt_pk_bf16_f32 v88, v40, v41
v_mfma_f32_16x16x32_bf16 v[8:11], a[156:159], v[164:167], v[8:11]
v_exp_f32 v42, v42
v_mfma_f32_16x16x32_bf16 v[16:19], a[156:159], v[180:183], v[140:143]
s_add_u32 s39, s39, 16384
buffer_store_dwordx4 a[220:223], v238, s[20:23], s28 offen offset:1536 sc0 sc1
v_mfma_f32_16x16x32_bf16 v[16:19], a[152:155], v[176:179], v[16:19]
v_exp_f32 v43, v43
v_mfma_f32_16x16x32_bf16 v[16:19], a[148:151], v[172:175], v[16:19]
v_cvt_pk_bf16_f32 v89, v42, v43
v_mfma_f32_16x16x32_bf16 v[16:19], a[144:147], v[168:171], v[16:19]
v_exp_f32 v44, v44
v_mfma_f32_16x16x32_bf16 v[24:27], a[144:147], v[184:187], v[144:147]
buffer_store_dwordx4 a[224:227], v238, s[20:23], s28 offen offset:2048 sc0 sc1
v_mfma_f32_16x16x32_bf16 v[24:27], a[148:151], v[188:191], v[24:27]
v_exp_f32 v45, v45
v_mfma_f32_16x16x32_bf16 v[24:27], a[152:155], v[192:195], v[24:27]
v_cvt_pk_bf16_f32 v90, v44, v45
v_mfma_f32_16x16x32_bf16 v[24:27], a[156:159], v[196:199], v[24:27]
v_exp_f32 v46, v46
v_mfma_f32_16x16x32_bf16 v[32:35], a[156:159], v[212:215], v[148:151]
ds_read_b128 a[156:159], v219 offset:8192
s_add_u32 m0, s30, 131072
v_mfma_f32_16x16x32_bf16 v[32:35], a[152:155], v[208:211], v[32:35]
v_exp_f32 v47, v47
v_mfma_f32_16x16x32_bf16 v[32:35], a[148:151], v[204:207], v[32:35]
ds_read_b128 a[152:155], v218 offset:8192
v_cvt_pk_bf16_f32 v91, v46, v47
v_mfma_f32_16x16x32_bf16 v[32:35], a[144:147], v[200:203], v[32:35]
v_exp_f32 v48, v48
v_mfma_f32_16x16x32_bf16 a[0:3], v[72:75], a[176:179], a[0:3]
ds_read_b128 a[148:151], v217 offset:8192
ds_read_b128 a[144:147], v216 offset:8192
v_mfma_f32_16x16x32_bf16 a[16:19], v[72:75], a[180:183], a[16:19]
v_exp_f32 v49, v49
v_mfma_f32_16x16x32_bf16 a[20:23], v[76:79], a[180:183], a[20:23]
v_cvt_pk_bf16_f32 v92, v48, v49
v_mfma_f32_16x16x32_bf16 a[4:7], v[76:79], a[176:179], a[4:7]
v_exp_f32 v50, v50
v_mfma_f32_16x16x32_bf16 a[8:11], v[80:83], a[176:179], a[8:11]
buffer_store_dwordx4 a[228:231], v238, s[20:23], s28 offen offset:2560 sc0 sc1
v_mfma_f32_16x16x32_bf16 a[24:27], v[80:83], a[180:183], a[24:27]
v_exp_f32 v51, v51
v_mfma_f32_16x16x32_bf16 a[28:31], v[84:87], a[180:183], a[28:31]
ds_read_b64_tr_b16 a[180:181], v221 offset:57344
v_cvt_pk_bf16_f32 v93, v50, v51
v_mfma_f32_16x16x32_bf16 a[12:15], v[84:87], a[176:179], a[12:15]
v_exp_f32 v52, v52
s_waitcnt lgkmcnt(8)
v_mfma_f32_16x16x32_bf16 a[44:47], v[84:87], a[184:187], a[44:47]
ds_read_b64_tr_b16 a[182:183], v221 offset:61440
ds_read_b64_tr_b16 a[176:177], v220 offset:57344
v_mfma_f32_16x16x32_bf16 a[60:63], v[84:87], a[188:191], a[60:63]
v_exp_f32 v53, v53
v_mfma_f32_16x16x32_bf16 a[56:59], v[80:83], a[188:191], a[56:59]
ds_read_b64_tr_b16 a[178:179], v220 offset:61440
v_cvt_pk_bf16_f32 v94, v52, v53
v_mfma_f32_16x16x32_bf16 a[40:43], v[80:83], a[184:187], a[40:43]
v_exp_f32 v54, v54
v_mfma_f32_16x16x32_bf16 a[36:39], v[76:79], a[184:187], a[36:39]
buffer_load_dwordx4 v232, s[12:15], s39 offen offset:0  lds
v_mfma_f32_16x16x32_bf16 a[52:55], v[76:79], a[188:191], a[52:55]
v_exp_f32 v55, v55
v_mfma_f32_16x16x32_bf16 a[48:51], v[72:75], a[188:191], a[48:51]
ds_read_b64_tr_b16 a[188:189], v223 offset:57344
v_cvt_pk_bf16_f32 v95, v54, v55
v_mfma_f32_16x16x32_bf16 a[32:35], v[72:75], a[184:187], a[32:35]
v_exp_f32 v56, v56
v_smfmac_f32_16x16x64_bf16 a[128:131], a[208:211], v[72:79], v245
ds_read_b64_tr_b16 a[190:191], v223 offset:61440
v_mfma_f32_16x16x32_bf16 v[12:15], a[160:163], v[152:155], v[136:139]
v_exp_f32 v57, v57
v_mfma_f32_16x16x32_bf16 v[12:15], a[164:167], v[156:159], v[12:15]
v_exp_f32 v58, v58
v_mfma_f32_16x16x32_bf16 v[12:15], a[168:171], v[160:163], v[12:15]
ds_read_b64_tr_b16 a[184:185], v222 offset:57344
v_cvt_pk_bf16_f32 v96, v56, v57
v_mfma_f32_16x16x32_bf16 v[12:15], a[172:175], v[164:167], v[12:15]
v_exp_f32 v59, v59
v_mfma_f32_16x16x32_bf16 v[20:23], a[172:175], v[180:183], v[140:143]
ds_read_b64_tr_b16 a[186:187], v222 offset:61440
v_cvt_pk_bf16_f32 v97, v58, v59
v_mfma_f32_16x16x32_bf16 v[20:23], a[168:171], v[176:179], v[20:23]
v_exp_f32 v60, v60
v_mfma_f32_16x16x32_bf16 v[20:23], a[164:167], v[172:175], v[20:23]
buffer_load_dwordx4 v233, s[12:15], s39 offen offset:1024  lds
v_mfma_f32_16x16x32_bf16 v[20:23], a[160:163], v[168:171], v[20:23]
v_exp_f32 v61, v61
v_mfma_f32_16x16x32_bf16 v[28:31], a[160:163], v[184:187], v[144:147]
buffer_store_dwordx4 a[232:235], v238, s[20:23], s28 offen offset:3072 sc0 sc1
v_cvt_pk_bf16_f32 v98, v60, v61
v_mfma_f32_16x16x32_bf16 v[28:31], a[164:167], v[188:191], v[28:31]
v_exp_f32 v62, v62
v_mfma_f32_16x16x32_bf16 v[28:31], a[168:171], v[192:195], v[28:31]
buffer_load_dwordx4 v232, s[12:15], s39 offen offset:2048  lds
v_mfma_f32_16x16x32_bf16 v[28:31], a[172:175], v[196:199], v[28:31]
v_exp_f32 v63, v63
v_mfma_f32_16x16x32_bf16 v[36:39], a[172:175], v[212:215], v[148:151]
ds_read_b128 a[172:175], v219 offset:12288
v_cvt_pk_bf16_f32 v99, v62, v63
v_mfma_f32_16x16x32_bf16 v[36:39], a[168:171], v[208:211], v[36:39]
v_exp_f32 v64, v64
v_mfma_f32_16x16x32_bf16 v[36:39], a[164:167], v[204:207], v[36:39]
ds_read_b128 a[168:171], v218 offset:12288
ds_read_b128 a[164:167], v217 offset:12288
v_mfma_f32_16x16x32_bf16 v[36:39], a[160:163], v[200:203], v[36:39]
v_exp_f32 v65, v65
v_mfma_f32_16x16x32_bf16 a[64:67], v[72:75], a[192:195], a[64:67]
ds_read_b128 a[160:163], v216 offset:12288
v_cvt_pk_bf16_f32 v100, v64, v65
v_mfma_f32_16x16x32_bf16 a[80:83], v[72:75], a[196:199], a[80:83]
v_exp_f32 v66, v66
v_mfma_f32_16x16x32_bf16 a[84:87], v[76:79], a[196:199], a[84:87]
buffer_load_dwordx4 v233, s[12:15], s39 offen offset:3072  lds
v_mfma_f32_16x16x32_bf16 a[68:71], v[76:79], a[192:195], a[68:71]
v_exp_f32 v67, v67
v_mfma_f32_16x16x32_bf16 a[72:75], v[80:83], a[192:195], a[72:75]
buffer_store_dwordx4 a[236:239], v238, s[20:23], s28 offen offset:3584 sc0 sc1
v_cvt_pk_bf16_f32 v101, v66, v67
v_mfma_f32_16x16x32_bf16 a[88:91], v[80:83], a[196:199], a[88:91]
v_exp_f32 v68, v68
v_mfma_f32_16x16x32_bf16 a[92:95], v[84:87], a[196:199], a[92:95]
ds_read_b64_tr_b16 a[196:197], v225 offset:57344
ds_read_b64_tr_b16 a[198:199], v225 offset:61440
v_mfma_f32_16x16x32_bf16 a[76:79], v[84:87], a[192:195], a[76:79]
v_exp_f32 v69, v69
s_waitcnt lgkmcnt(8)
v_mfma_f32_16x16x32_bf16 a[108:111], v[84:87], a[200:203], a[108:111]
ds_read_b64_tr_b16 a[192:193], v224 offset:57344
v_cvt_pk_bf16_f32 v102, v68, v69
v_mfma_f32_16x16x32_bf16 a[124:127], v[84:87], a[204:207], a[124:127]
v_exp_f32 v70, v70
v_mfma_f32_16x16x32_bf16 a[120:123], v[80:83], a[204:207], a[120:123]
ds_read_b64_tr_b16 a[194:195], v224 offset:61440
v_mfma_f32_16x16x32_bf16 a[104:107], v[80:83], a[200:203], a[104:107]
v_exp_f32 v71, v71
v_mfma_f32_16x16x32_bf16 a[100:103], v[76:79], a[200:203], a[100:103]
v_cvt_pk_bf16_f32 v103, v70, v71
v_mfma_f32_16x16x32_bf16 a[116:119], v[76:79], a[204:207], a[116:119]
s_add_u32 s28, s28, 4096
buffer_store_dwordx4 a[240:243], v238, s[20:23], s28 offen offset:0 sc0 sc1
v_mfma_f32_16x16x32_bf16 a[112:115], v[72:75], a[204:207], a[112:115]
ds_read_b64_tr_b16 a[204:205], v227 offset:57344
ds_read_b64_tr_b16 a[206:207], v227 offset:61440
v_mfma_f32_16x16x32_bf16 a[96:99], v[72:75], a[200:203], a[96:99]
ds_read_b64_tr_b16 a[200:201], v226 offset:57344
ds_read_b64_tr_b16 a[202:203], v226 offset:61440
v_smfmac_f32_16x16x64_bf16 a[132:135], a[208:211], v[80:87], v245
s_mov_b32 s33, 6
K_LOOPIN:
s_waitcnt lgkmcnt(0)
v_lshlrev_b32 v241, 4, v1
s_mov_b32 s46, s44
.p2align 6
K_LOOP:
s_cmp_eq_u32 s33, s3
s_cbranch_scc1 K_EVT
K_EVT_RET:
v_mfma_f32_16x16x32_bf16 v[40:43], a[144:147], v[152:155], v[136:139]
v_exp_f32 v8, v8
v_mfma_f32_16x16x32_bf16 v[40:43], a[148:151], v[156:159], v[40:43]
v_exp_f32 v9, v9
v_mfma_f32_16x16x32_bf16 v[40:43], a[152:155], v[160:163], v[40:43]
v_cvt_pk_bf16_f32 v72, v8, v9
v_mfma_f32_16x16x32_bf16 v[40:43], a[156:159], v[164:167], v[40:43]
v_exp_f32 v10, v10
v_mfma_f32_16x16x32_bf16 v[48:51], a[156:159], v[180:183], v[140:143]
v_mfma_f32_16x16x32_bf16 v[48:51], a[152:155], v[176:179], v[48:51]
v_exp_f32 v11, v11
v_mfma_f32_16x16x32_bf16 v[48:51], a[148:151], v[172:175], v[48:51]
v_cvt_pk_bf16_f32 v73, v10, v11
v_mfma_f32_16x16x32_bf16 v[48:51], a[144:147], v[168:171], v[48:51]
v_exp_f32 v12, v12
v_mfma_f32_16x16x32_bf16 v[56:59], a[144:147], v[184:187], v[144:147]
v_mfma_f32_16x16x32_bf16 v[56:59], a[148:151], v[188:191], v[56:59]
v_exp_f32 v13, v13
v_mfma_f32_16x16x32_bf16 v[56:59], a[152:155], v[192:195], v[56:59]
v_cvt_pk_bf16_f32 v74, v12, v13
v_mfma_f32_16x16x32_bf16 v[56:59], a[156:159], v[196:199], v[56:59]
v_exp_f32 v14, v14
v_mfma_f32_16x16x32_bf16 v[64:67], a[156:159], v[212:215], v[148:151]
s_waitcnt vmcnt(10) lgkmcnt(0)
s_barrier
v_mfma_f32_16x16x32_bf16 v[64:67], a[152:155], v[208:211], v[64:67]
v_exp_f32 v15, v15
v_mfma_f32_16x16x32_bf16 v[64:67], a[148:151], v[204:207], v[64:67]
ds_read_b128 a[156:159], v219 offset:16384
v_cvt_pk_bf16_f32 v75, v14, v15
v_mfma_f32_16x16x32_bf16 v[64:67], a[144:147], v[200:203], v[64:67]
v_exp_f32 v16, v16
v_mfma_f32_16x16x32_bf16 a[0:3], v[88:91], a[176:179], a[0:3]
ds_read_b128 a[152:155], v218 offset:16384
ds_read_b128 a[148:151], v217 offset:16384
v_mfma_f32_16x16x32_bf16 a[16:19], v[88:91], a[180:183], a[16:19]
v_exp_f32 v17, v17
v_mfma_f32_16x16x32_bf16 a[20:23], v[92:95], a[180:183], a[20:23]
ds_read_b128 a[144:147], v216 offset:16384
v_cvt_pk_bf16_f32 v76, v16, v17
v_mfma_f32_16x16x32_bf16 a[4:7], v[92:95], a[176:179], a[4:7]
v_exp_f32 v18, v18
v_mfma_f32_16x16x32_bf16 a[8:11], v[96:99], a[176:179], a[8:11]
s_add_u32 s32, s32, 16384
s_add_u32 m0, s30, 65536
v_mfma_f32_16x16x32_bf16 a[24:27], v[96:99], a[180:183], a[24:27]
v_exp_f32 v19, v19
v_mfma_f32_16x16x32_bf16 a[28:31], v[100:103], a[180:183], a[28:31]
ds_read_b64_tr_b16 a[180:181], v221 offset:0
v_cvt_pk_bf16_f32 v77, v18, v19
v_mfma_f32_16x16x32_bf16 a[12:15], v[100:103], a[176:179], a[12:15]
v_exp_f32 v20, v20
v_mfma_f32_16x16x32_bf16 a[44:47], v[100:103], a[184:187], a[44:47]
ds_read_b64_tr_b16 a[182:183], v221 offset:4096
ds_read_b64_tr_b16 a[176:177], v220 offset:0
v_mfma_f32_16x16x32_bf16 a[60:63], v[100:103], a[188:191], a[60:63]
v_exp_f32 v21, v21
v_mfma_f32_16x16x32_bf16 a[56:59], v[96:99], a[188:191], a[56:59]
ds_read_b64_tr_b16 a[178:179], v220 offset:4096
v_cvt_pk_bf16_f32 v78, v20, v21
v_mfma_f32_16x16x32_bf16 a[40:43], v[96:99], a[184:187], a[40:43]
v_exp_f32 v22, v22
v_mfma_f32_16x16x32_bf16 a[36:39], v[92:95], a[184:187], a[36:39]
buffer_load_dwordx4 v228, s[8:11], s32 offen offset:0  lds
v_mfma_f32_16x16x32_bf16 a[52:55], v[92:95], a[188:191], a[52:55]
v_exp_f32 v23, v23
v_mfma_f32_16x16x32_bf16 a[48:51], v[88:91], a[188:191], a[48:51]
ds_read_b64_tr_b16 a[188:189], v223 offset:0
v_cvt_pk_bf16_f32 v79, v22, v23
v_mfma_f32_16x16x32_bf16 a[32:35], v[88:91], a[184:187], a[32:35]
v_exp_f32 v24, v24
v_smfmac_f32_16x16x64_bf16 a[128:131], a[208:211], v[88:95], v245
ds_read_b64_tr_b16 a[190:191], v223 offset:4096
v_mfma_f32_16x16x32_bf16 v[44:47], a[160:163], v[152:155], v[136:139]
v_exp_f32 v25, v25
v_mfma_f32_16x16x32_bf16 v[44:47], a[164:167], v[156:159], v[44:47]
v_exp_f32 v26, v26
v_mfma_f32_16x16x32_bf16 v[44:47], a[168:171], v[160:163], v[44:47]
ds_read_b64_tr_b16 a[184:185], v222 offset:0
v_cvt_pk_bf16_f32 v80, v24, v25
v_mfma_f32_16x16x32_bf16 v[44:47], a[172:175], v[164:167], v[44:47]
v_exp_f32 v27, v27
v_mfma_f32_16x16x32_bf16 v[52:55], a[172:175], v[180:183], v[140:143]
ds_read_b64_tr_b16 a[186:187], v222 offset:4096
v_cvt_pk_bf16_f32 v81, v26, v27
v_mfma_f32_16x16x32_bf16 v[52:55], a[168:171], v[176:179], v[52:55]
v_exp_f32 v28, v28
v_mfma_f32_16x16x32_bf16 v[52:55], a[164:167], v[172:175], v[52:55]
buffer_load_dwordx4 v229, s[8:11], s32 offen offset:1024  lds
v_mfma_f32_16x16x32_bf16 v[52:55], a[160:163], v[168:171], v[52:55]
v_exp_f32 v29, v29
v_mfma_f32_16x16x32_bf16 v[60:63], a[160:163], v[184:187], v[144:147]
v_cvt_pk_bf16_f32 v82, v28, v29
v_mfma_f32_16x16x32_bf16 v[60:63], a[164:167], v[188:191], v[60:63]
v_exp_f32 v30, v30
v_mfma_f32_16x16x32_bf16 v[60:63], a[168:171], v[192:195], v[60:63]
buffer_load_dwordx4 v230, s[8:11], s32 offen offset:2048  lds
v_mfma_f32_16x16x32_bf16 v[60:63], a[172:175], v[196:199], v[60:63]
v_exp_f32 v31, v31
v_mfma_f32_16x16x32_bf16 v[68:71], a[172:175], v[212:215], v[148:151]
ds_read_b128 a[172:175], v219 offset:20480
v_cvt_pk_bf16_f32 v83, v30, v31
v_mfma_f32_16x16x32_bf16 v[68:71], a[168:171], v[208:211], v[68:71]
v_exp_f32 v32, v32
v_mfma_f32_16x16x32_bf16 v[68:71], a[164:167], v[204:207], v[68:71]
ds_read_b128 a[168:171], v218 offset:20480
ds_read_b128 a[164:167], v217 offset:20480
v_mfma_f32_16x16x32_bf16 v[68:71], a[160:163], v[200:203], v[68:71]
v_exp_f32 v33, v33
v_mfma_f32_16x16x32_bf16 a[64:67], v[88:91], a[192:195], a[64:67]
ds_read_b128 a[160:163], v216 offset:20480
v_cvt_pk_bf16_f32 v84, v32, v33
v_mfma_f32_16x16x32_bf16 a[80:83], v[88:91], a[196:199], a[80:83]
v_exp_f32 v34, v34
v_mfma_f32_16x16x32_bf16 a[84:87], v[92:95], a[196:199], a[84:87]
buffer_load_dwordx4 v231, s[8:11], s32 offen offset:3072  lds
v_mfma_f32_16x16x32_bf16 a[68:71], v[92:95], a[192:195], a[68:71]
v_exp_f32 v35, v35
v_mfma_f32_16x16x32_bf16 a[72:75], v[96:99], a[192:195], a[72:75]
v_cvt_pk_bf16_f32 v85, v34, v35
v_mfma_f32_16x16x32_bf16 a[88:91], v[96:99], a[196:199], a[88:91]
v_exp_f32 v36, v36
v_mfma_f32_16x16x32_bf16 a[92:95], v[100:103], a[196:199], a[92:95]
ds_read_b64_tr_b16 a[196:197], v225 offset:0
ds_read_b64_tr_b16 a[198:199], v225 offset:4096
v_mfma_f32_16x16x32_bf16 a[76:79], v[100:103], a[192:195], a[76:79]
v_exp_f32 v37, v37
v_mfma_f32_16x16x32_bf16 a[108:111], v[100:103], a[200:203], a[108:111]
ds_read_b64_tr_b16 a[192:193], v224 offset:0
v_cvt_pk_bf16_f32 v86, v36, v37
v_mfma_f32_16x16x32_bf16 a[124:127], v[100:103], a[204:207], a[124:127]
v_exp_f32 v38, v38
v_mfma_f32_16x16x32_bf16 a[120:123], v[96:99], a[204:207], a[120:123]
ds_read_b64_tr_b16 a[194:195], v224 offset:4096
v_mfma_f32_16x16x32_bf16 a[104:107], v[96:99], a[200:203], a[104:107]
v_exp_f32 v39, v39
v_mfma_f32_16x16x32_bf16 a[100:103], v[92:95], a[200:203], a[100:103]
v_cvt_pk_bf16_f32 v87, v38, v39
v_mfma_f32_16x16x32_bf16 a[116:119], v[92:95], a[204:207], a[116:119]
s_mov_b32 m0, s87
s_lshl2_add_u32 s50, s87, s89
buffer_load_dwordx4 v243, s[56:59], s50 offen  lds
v_mfma_f32_16x16x32_bf16 a[112:115], v[88:91], a[204:207], a[112:115]
ds_read_b64_tr_b16 a[204:205], v227 offset:0
ds_read_b64_tr_b16 a[206:207], v227 offset:4096
v_mfma_f32_16x16x32_bf16 a[96:99], v[88:91], a[200:203], a[96:99]
ds_read_b64_tr_b16 a[200:201], v226 offset:0
ds_read_b64_tr_b16 a[202:203], v226 offset:4096
v_smfmac_f32_16x16x64_bf16 a[132:135], a[208:211], v[96:103], v245
s_add_u32 s87, s87, 3456
s_min_u32 s87, s87, 63936
s_waitcnt lgkmcnt(8)
v_mfma_f32_16x16x32_bf16 v[8:11], a[144:147], v[152:155], v[136:139]
v_exp_f32 v40, v40
v_mfma_f32_16x16x32_bf16 v[8:11], a[148:151], v[156:159], v[8:11]
v_exp_f32 v41, v41
v_mfma_f32_16x16x32_bf16 v[8:11], a[152:155], v[160:163], v[8:11]
v_cvt_pk_bf16_f32 v88, v40, v41
v_mfma_f32_16x16x32_bf16 v[8:11], a[156:159], v[164:167], v[8:11]
v_exp_f32 v42, v42
v_mfma_f32_16x16x32_bf16 v[16:19], a[156:159], v[180:183], v[140:143]
s_add_u32 s39, s39, 16384
v_mfma_f32_16x16x32_bf16 v[16:19], a[152:155], v[176:179], v[16:19]
v_exp_f32 v43, v43
v_mfma_f32_16x16x32_bf16 v[16:19], a[148:151], v[172:175], v[16:19]
v_cvt_pk_bf16_f32 v89, v42, v43
v_mfma_f32_16x16x32_bf16 v[16:19], a[144:147], v[168:171], v[16:19]
v_exp_f32 v44, v44
v_mfma_f32_16x16x32_bf16 v[24:27], a[144:147], v[184:187], v[144:147]
v_mfma_f32_16x16x32_bf16 v[24:27], a[148:151], v[188:191], v[24:27]
v_exp_f32 v45, v45
v_mfma_f32_16x16x32_bf16 v[24:27], a[152:155], v[192:195], v[24:27]
s_add_u32 m0, s30, 147456
v_cvt_pk_bf16_f32 v90, v44, v45
v_mfma_f32_16x16x32_bf16 v[24:27], a[156:159], v[196:199], v[24:27]
v_exp_f32 v46, v46
v_mfma_f32_16x16x32_bf16 v[32:35], a[156:159], v[212:215], v[148:151]
ds_read_b128 a[156:159], v219 offset:24576
v_mfma_f32_16x16x32_bf16 v[32:35], a[152:155], v[208:211], v[32:35]
v_exp_f32 v47, v47
v_mfma_f32_16x16x32_bf16 v[32:35], a[148:151], v[204:207], v[32:35]
ds_read_b128 a[152:155], v218 offset:24576
v_cvt_pk_bf16_f32 v91, v46, v47
v_mfma_f32_16x16x32_bf16 v[32:35], a[144:147], v[200:203], v[32:35]
v_exp_f32 v48, v48
v_mfma_f32_16x16x32_bf16 a[0:3], v[72:75], a[176:179], a[0:3]
ds_read_b128 a[148:151], v217 offset:24576
ds_read_b128 a[144:147], v216 offset:24576
v_mfma_f32_16x16x32_bf16 a[16:19], v[72:75], a[180:183], a[16:19]
v_exp_f32 v49, v49
v_mfma_f32_16x16x32_bf16 a[20:23], v[76:79], a[180:183], a[20:23]
v_cvt_pk_bf16_f32 v92, v48, v49
v_mfma_f32_16x16x32_bf16 a[4:7], v[76:79], a[176:179], a[4:7]
v_exp_f32 v50, v50
v_mfma_f32_16x16x32_bf16 a[8:11], v[80:83], a[176:179], a[8:11]
buffer_load_dwordx4 v232, s[12:15], s39 offen offset:0  lds
v_mfma_f32_16x16x32_bf16 a[24:27], v[80:83], a[180:183], a[24:27]
v_exp_f32 v51, v51
v_mfma_f32_16x16x32_bf16 a[28:31], v[84:87], a[180:183], a[28:31]
ds_read_b64_tr_b16 a[180:181], v221 offset:8192
v_cvt_pk_bf16_f32 v93, v50, v51
v_mfma_f32_16x16x32_bf16 a[12:15], v[84:87], a[176:179], a[12:15]
v_exp_f32 v52, v52
v_mfma_f32_16x16x32_bf16 a[44:47], v[84:87], a[184:187], a[44:47]
ds_read_b64_tr_b16 a[182:183], v221 offset:12288
ds_read_b64_tr_b16 a[176:177], v220 offset:8192
v_mfma_f32_16x16x32_bf16 a[60:63], v[84:87], a[188:191], a[60:63]
v_exp_f32 v53, v53
v_mfma_f32_16x16x32_bf16 a[56:59], v[80:83], a[188:191], a[56:59]
ds_read_b64_tr_b16 a[178:179], v220 offset:12288
v_cvt_pk_bf16_f32 v94, v52, v53
v_mfma_f32_16x16x32_bf16 a[40:43], v[80:83], a[184:187], a[40:43]
v_exp_f32 v54, v54
v_mfma_f32_16x16x32_bf16 a[36:39], v[76:79], a[184:187], a[36:39]
buffer_load_dwordx4 v233, s[12:15], s39 offen offset:1024  lds
v_mfma_f32_16x16x32_bf16 a[52:55], v[76:79], a[188:191], a[52:55]
v_exp_f32 v55, v55
v_mfma_f32_16x16x32_bf16 a[48:51], v[72:75], a[188:191], a[48:51]
ds_read_b64_tr_b16 a[188:189], v223 offset:8192
v_cvt_pk_bf16_f32 v95, v54, v55
v_mfma_f32_16x16x32_bf16 a[32:35], v[72:75], a[184:187], a[32:35]
v_exp_f32 v56, v56
v_smfmac_f32_16x16x64_bf16 a[128:131], a[208:211], v[72:79], v245
ds_read_b64_tr_b16 a[190:191], v223 offset:12288
v_mfma_f32_16x16x32_bf16 v[12:15], a[160:163], v[152:155], v[136:139]
v_exp_f32 v57, v57
v_mfma_f32_16x16x32_bf16 v[12:15], a[164:167], v[156:159], v[12:15]
v_exp_f32 v58, v58
v_mfma_f32_16x16x32_bf16 v[12:15], a[168:171], v[160:163], v[12:15]
ds_read_b64_tr_b16 a[184:185], v222 offset:8192
v_cvt_pk_bf16_f32 v96, v56, v57
v_mfma_f32_16x16x32_bf16 v[12:15], a[172:175], v[164:167], v[12:15]
v_exp_f32 v59, v59
v_mfma_f32_16x16x32_bf16 v[20:23], a[172:175], v[180:183], v[140:143]
ds_read_b64_tr_b16 a[186:187], v222 offset:12288
v_cvt_pk_bf16_f32 v97, v58, v59
v_mfma_f32_16x16x32_bf16 v[20:23], a[168:171], v[176:179], v[20:23]
v_exp_f32 v60, v60
v_mfma_f32_16x16x32_bf16 v[20:23], a[164:167], v[172:175], v[20:23]
buffer_load_dwordx4 v232, s[12:15], s39 offen offset:2048  lds
v_mfma_f32_16x16x32_bf16 v[20:23], a[160:163], v[168:171], v[20:23]
v_exp_f32 v61, v61
v_mfma_f32_16x16x32_bf16 v[28:31], a[160:163], v[184:187], v[144:147]
v_cvt_pk_bf16_f32 v98, v60, v61
v_mfma_f32_16x16x32_bf16 v[28:31], a[164:167], v[188:191], v[28:31]
v_exp_f32 v62, v62
v_mfma_f32_16x16x32_bf16 v[28:31], a[168:171], v[192:195], v[28:31]
buffer_load_dwordx4 v233, s[12:15], s39 offen offset:3072  lds
v_mfma_f32_16x16x32_bf16 v[28:31], a[172:175], v[196:199], v[28:31]
v_exp_f32 v63, v63
v_mfma_f32_16x16x32_bf16 v[36:39], a[172:175], v[212:215], v[148:151]
ds_read_b128 a[172:175], v219 offset:28672
v_cvt_pk_bf16_f32 v99, v62, v63
v_mfma_f32_16x16x32_bf16 v[36:39], a[168:171], v[208:211], v[36:39]
v_exp_f32 v64, v64
v_mfma_f32_16x16x32_bf16 v[36:39], a[164:167], v[204:207], v[36:39]
ds_read_b128 a[168:171], v218 offset:28672
ds_read_b128 a[164:167], v217 offset:28672
v_mfma_f32_16x16x32_bf16 v[36:39], a[160:163], v[200:203], v[36:39]
v_exp_f32 v65, v65
s_waitcnt lgkmcnt(8)
v_mfma_f32_16x16x32_bf16 a[64:67], v[72:75], a[192:195], a[64:67]
ds_read_b128 a[160:163], v216 offset:28672
v_cvt_pk_bf16_f32 v100, v64, v65
v_mfma_f32_16x16x32_bf16 a[80:83], v[72:75], a[196:199], a[80:83]
v_exp_f32 v66, v66
v_mfma_f32_16x16x32_bf16 a[84:87], v[76:79], a[196:199], a[84:87]
buffer_load_dword v242, v241, s[20:23], s46 offen sc1
v_mfma_f32_16x16x32_bf16 a[68:71], v[76:79], a[192:195], a[68:71]
v_exp_f32 v67, v67
v_mfma_f32_16x16x32_bf16 a[72:75], v[80:83], a[192:195], a[72:75]
v_cvt_pk_bf16_f32 v101, v66, v67
v_add_u32 v241, 1024, v241
v_mfma_f32_16x16x32_bf16 a[88:91], v[80:83], a[196:199], a[88:91]
v_exp_f32 v68, v68
v_mfma_f32_16x16x32_bf16 a[92:95], v[84:87], a[196:199], a[92:95]
ds_read_b64_tr_b16 a[196:197], v225 offset:8192
ds_read_b64_tr_b16 a[198:199], v225 offset:12288
v_mfma_f32_16x16x32_bf16 a[76:79], v[84:87], a[192:195], a[76:79]
v_exp_f32 v69, v69
v_mfma_f32_16x16x32_bf16 a[108:111], v[84:87], a[200:203], a[108:111]
ds_read_b64_tr_b16 a[192:193], v224 offset:8192
v_cvt_pk_bf16_f32 v102, v68, v69
v_mfma_f32_16x16x32_bf16 a[124:127], v[84:87], a[204:207], a[124:127]
v_exp_f32 v70, v70
v_mfma_f32_16x16x32_bf16 a[120:123], v[80:83], a[204:207], a[120:123]
ds_read_b64_tr_b16 a[194:195], v224 offset:12288
v_and_b32 v241, 0x3fff, v241
v_mfma_f32_16x16x32_bf16 a[104:107], v[80:83], a[200:203], a[104:107]
v_exp_f32 v71, v71
v_mfma_f32_16x16x32_bf16 a[100:103], v[76:79], a[200:203], a[100:103]
v_cvt_pk_bf16_f32 v103, v70, v71
v_mfma_f32_16x16x32_bf16 a[116:119], v[76:79], a[204:207], a[116:119]
v_mfma_f32_16x16x32_bf16 a[112:115], v[72:75], a[204:207], a[112:115]
ds_read_b64_tr_b16 a[204:205], v227 offset:8192
ds_read_b64_tr_b16 a[206:207], v227 offset:12288
v_mfma_f32_16x16x32_bf16 a[96:99], v[72:75], a[200:203], a[96:99]
ds_read_b64_tr_b16 a[200:201], v226 offset:8192
ds_read_b64_tr_b16 a[202:203], v226 offset:12288
v_smfmac_f32_16x16x64_bf16 a[132:135], a[208:211], v[80:87], v245
v_mfma_f32_16x16x32_bf16 v[40:43], a[144:147], v[152:155], v[136:139]
v_exp_f32 v8, v8
v_mfma_f32_16x16x32_bf16 v[40:43], a[148:151], v[156:159], v[40:43]
v_exp_f32 v9, v9
v_mfma_f32_16x16x32_bf16 v[40:43], a[152:155], v[160:163], v[40:43]
v_cvt_pk_bf16_f32 v72, v8, v9
v_mfma_f32_16x16x32_bf16 v[40:43], a[156:159], v[164:167], v[40:43]
v_exp_f32 v10, v10
v_mfma_f32_16x16x32_bf16 v[48:51], a[156:159], v[180:183], v[140:143]
v_mfma_f32_16x16x32_bf16 v[48:51], a[152:155], v[176:179], v[48:51]
v_exp_f32 v11, v11
v_mfma_f32_16x16x32_bf16 v[48:51], a[148:151], v[172:175], v[48:51]
v_cvt_pk_bf16_f32 v73, v10, v11
v_mfma_f32_16x16x32_bf16 v[48:51], a[144:147], v[168:171], v[48:51]
v_exp_f32 v12, v12
v_mfma_f32_16x16x32_bf16 v[56:59], a[144:147], v[184:187], v[144:147]
v_mfma_f32_16x16x32_bf16 v[56:59], a[148:151], v[188:191], v[56:59]
v_exp_f32 v13, v13
v_mfma_f32_16x16x32_bf16 v[56:59], a[152:155], v[192:195], v[56:59]
v_cvt_pk_bf16_f32 v74, v12, v13
v_mfma_f32_16x16x32_bf16 v[56:59], a[156:159], v[196:199], v[56:59]
v_exp_f32 v14, v14
v_mfma_f32_16x16x32_bf16 v[64:67], a[156:159], v[212:215], v[148:151]
s_waitcnt vmcnt(10) lgkmcnt(0)
s_barrier
v_mfma_f32_16x16x32_bf16 v[64:67], a[152:155], v[208:211], v[64:67]
v_exp_f32 v15, v15
v_mfma_f32_16x16x32_bf16 v[64:67], a[148:151], v[204:207], v[64:67]
ds_read_b128 a[156:159], v219 offset:49152
v_cvt_pk_bf16_f32 v75, v14, v15
v_mfma_f32_16x16x32_bf16 v[64:67], a[144:147], v[200:203], v[64:67]
v_exp_f32 v16, v16
v_mfma_f32_16x16x32_bf16 a[0:3], v[88:91], a[176:179], a[0:3]
ds_read_b128 a[152:155], v218 offset:49152
ds_read_b128 a[148:151], v217 offset:49152
v_mfma_f32_16x16x32_bf16 a[16:19], v[88:91], a[180:183], a[16:19]
STUB_10:
s_cbranch_execz HOP_RET1
v_exp_f32 v17, v17
v_mfma_f32_16x16x32_bf16 a[20:23], v[92:95], a[180:183], a[20:23]
ds_read_b128 a[144:147], v216 offset:49152
v_cvt_pk_bf16_f32 v76, v16, v17
v_mfma_f32_16x16x32_bf16 a[4:7], v[92:95], a[176:179], a[4:7]
v_exp_f32 v18, v18
v_mfma_f32_16x16x32_bf16 a[8:11], v[96:99], a[176:179], a[8:11]
s_add_u32 s32, s32, 16384
s_add_u32 m0, s30, 81920
v_mfma_f32_16x16x32_bf16 a[24:27], v[96:99], a[180:183], a[24:27]
v_exp_f32 v19, v19
v_mfma_f32_16x16x32_bf16 a[28:31], v[100:103], a[180:183], a[28:31]
ds_read_b64_tr_b16 a[180:181], v221 offset:32768
v_cvt_pk_bf16_f32 v77, v18, v19
v_mfma_f32_16x16x32_bf16 a[12:15], v[100:103], a[176:179], a[12:15]
v_exp_f32 v20, v20
v_mfma_f32_16x16x32_bf16 a[44:47], v[100:103], a[184:187], a[44:47]
ds_read_b64_tr_b16 a[182:183], v221 offset:36864
ds_read_b64_tr_b16 a[176:177], v220 offset:32768
v_mfma_f32_16x16x32_bf16 a[60:63], v[100:103], a[188:191], a[60:63]
v_exp_f32 v21, v21
v_mfma_f32_16x16x32_bf16 a[56:59], v[96:99], a[188:191], a[56:59]
ds_read_b64_tr_b16 a[178:179], v220 offset:36864
v_cvt_pk_bf16_f32 v78, v20, v21
v_mfma_f32_16x16x32_bf16 a[40:43], v[96:99], a[184:187], a[40:43]
v_exp_f32 v22, v22
v_mfma_f32_16x16x32_bf16 a[36:39], v[92:95], a[184:187], a[36:39]
buffer_load_dwordx4 v228, s[8:11], s32 offen offset:0  lds
v_mfma_f32_16x16x32_bf16 a[52:55], v[92:95], a[188:191], a[52:55]
v_exp_f32 v23, v23
v_mfma_f32_16x16x32_bf16 a[48:51], v[88:91], a[188:191], a[48:51]
ds_read_b64_tr_b16 a[188:189], v223 offset:32768
v_cvt_pk_bf16_f32 v79, v22, v23
v_mfma_f32_16x16x32_bf16 a[32:35], v[88:91], a[184:187], a[32:35]
v_exp_f32 v24, v24
v_smfmac_f32_16x16x64_bf16 a[128:131], a[208:211], v[88:95], v245
ds_read_b64_tr_b16 a[190:191], v223 offset:36864
v_mfma_f32_16x16x32_bf16 v[44:47], a[160:163], v[152:155], v[136:139]
v_exp_f32 v25, v25
v_mfma_f32_16x16x32_bf16 v[44:47], a[164:167], v[156:159], v[44:47]
v_exp_f32 v26, v26
v_mfma_f32_16x16x32_bf16 v[44:47], a[168:171], v[160:163], v[44:47]
ds_read_b64_tr_b16 a[184:185], v222 offset:32768
v_cvt_pk_bf16_f32 v80, v24, v25
v_mfma_f32_16x16x32_bf16 v[44:47], a[172:175], v[164:167], v[44:47]
v_exp_f32 v27, v27
v_mfma_f32_16x16x32_bf16 v[52:55], a[172:175], v[180:183], v[140:143]
ds_read_b64_tr_b16 a[186:187], v222 offset:36864
v_cvt_pk_bf16_f32 v81, v26, v27
v_mfma_f32_16x16x32_bf16 v[52:55], a[168:171], v[176:179], v[52:55]
v_exp_f32 v28, v28
v_mfma_f32_16x16x32_bf16 v[52:55], a[164:167], v[172:175], v[52:55]
buffer_load_dwordx4 v229, s[8:11], s32 offen offset:1024  lds
v_mfma_f32_16x16x32_bf16 v[52:55], a[160:163], v[168:171], v[52:55]
v_exp_f32 v29, v29
v_mfma_f32_16x16x32_bf16 v[60:63], a[160:163], v[184:187], v[144:147]
v_cvt_pk_bf16_f32 v82, v28, v29
v_mfma_f32_16x16x32_bf16 v[60:63], a[164:167], v[188:191], v[60:63]
v_exp_f32 v30, v30
v_mfma_f32_16x16x32_bf16 v[60:63], a[168:171], v[192:195], v[60:63]
buffer_load_dwordx4 v230, s[8:11], s32 offen offset:2048  lds
v_mfma_f32_16x16x32_bf16 v[60:63], a[172:175], v[196:199], v[60:63]
v_exp_f32 v31, v31
v_mfma_f32_16x16x32_bf16 v[68:71], a[172:175], v[212:215], v[148:151]
ds_read_b128 a[172:175], v219 offset:53248
v_cvt_pk_bf16_f32 v83, v30, v31
v_mfma_f32_16x16x32_bf16 v[68:71], a[168:171], v[208:211], v[68:71]
v_exp_f32 v32, v32
v_mfma_f32_16x16x32_bf16 v[68:71], a[164:167], v[204:207], v[68:71]
ds_read_b128 a[168:171], v218 offset:53248
ds_read_b128 a[164:167], v217 offset:53248
v_mfma_f32_16x16x32_bf16 v[68:71], a[160:163], v[200:203], v[68:71]
v_exp_f32 v33, v33
v_mfma_f32_16x16x32_bf16 a[64:67], v[88:91], a[192:195], a[64:67]
ds_read_b128 a[160:163], v216 offset:53248
v_cvt_pk_bf16_f32 v84, v32, v33
v_mfma_f32_16x16x32_bf16 a[80:83], v[88:91], a[196:199], a[80:83]
v_exp_f32 v34, v34
v_mfma_f32_16x16x32_bf16 a[84:87], v[92:95], a[196:199], a[84:87]
buffer_load_dwordx4 v231, s[8:11], s32 offen offset:3072  lds
v_mfma_f32_16x16x32_bf16 a[68:71], v[92:95], a[192:195], a[68:71]
v_exp_f32 v35, v35
v_mfma_f32_16x16x32_bf16 a[72:75], v[96:99], a[192:195], a[72:75]
v_cvt_pk_bf16_f32 v85, v34, v35
v_mfma_f32_16x16x32_bf16 a[88:91], v[96:99], a[196:199], a[88:91]
v_exp_f32 v36, v36
v_mfma_f32_16x16x32_bf16 a[92:95], v[100:103], a[196:199], a[92:95]
ds_read_b64_tr_b16 a[196:197], v225 offset:32768
ds_read_b64_tr_b16 a[198:199], v225 offset:36864
v_mfma_f32_16x16x32_bf16 a[76:79], v[100:103], a[192:195], a[76:79]
v_exp_f32 v37, v37
v_mfma_f32_16x16x32_bf16 a[108:111], v[100:103], a[200:203], a[108:111]
ds_read_b64_tr_b16 a[192:193], v224 offset:32768
v_cvt_pk_bf16_f32 v86, v36, v37
v_mfma_f32_16x16x32_bf16 a[124:127], v[100:103], a[204:207], a[124:127]
v_exp_f32 v38, v38
v_mfma_f32_16x16x32_bf16 a[120:123], v[96:99], a[204:207], a[120:123]
ds_read_b64_tr_b16 a[194:195], v224 offset:36864
v_mfma_f32_16x16x32_bf16 a[104:107], v[96:99], a[200:203], a[104:107]
v_exp_f32 v39, v39
v_mfma_f32_16x16x32_bf16 a[100:103], v[92:95], a[200:203], a[100:103]
v_cvt_pk_bf16_f32 v87, v38, v39
v_mfma_f32_16x16x32_bf16 a[116:119], v[92:95], a[204:207], a[116:119]
s_mov_b32 m0, s87
s_lshl2_add_u32 s50, s87, s89
buffer_load_dwordx4 v243, s[56:59], s50 offen  lds
v_mfma_f32_16x16x32_bf16 a[112:115], v[88:91], a[204:207], a[112:115]
ds_read_b64_tr_b16 a[204:205], v227 offset:32768
ds_read_b64_tr_b16 a[206:207], v227 offset:36864
v_mfma_f32_16x16x32_bf16 a[96:99], v[88:91], a[200:203], a[96:99]
ds_read_b64_tr_b16 a[200:201], v226 offset:32768
ds_read_b64_tr_b16 a[202:203], v226 offset:36864
v_smfmac_f32_16x16x64_bf16 a[132:135], a[208:211], v[96:103], v245
s_add_u32 s87, s87, 3456
s_min_u32 s87, s87, 63936
s_waitcnt lgkmcnt(8)
v_mfma_f32_16x16x32_bf16 v[8:11], a[144:147], v[152:155], v[136:139]
v_exp_f32 v40, v40
v_mfma_f32_16x16x32_bf16 v[8:11], a[148:151], v[156:159], v[8:11]
v_exp_f32 v41, v41
v_mfma_f32_16x16x32_bf16 v[8:11], a[152:155], v[160:163], v[8:11]
v_cvt_pk_bf16_f32 v88, v40, v41
v_mfma_f32_16x16x32_bf16 v[8:11], a[156:159], v[164:167], v[8:11]
v_exp_f32 v42, v42
v_mfma_f32_16x16x32_bf16 v[16:19], a[156:159], v[180:183], v[140:143]
s_add_u32 s39, s39, 16384
v_mfma_f32_16x16x32_bf16 v[16:19], a[152:155], v[176:179], v[16:19]
v_exp_f32 v43, v43
v_mfma_f32_16x16x32_bf16 v[16:19], a[148:151], v[172:175], v[16:19]
v_cvt_pk_bf16_f32 v89, v42, v43
v_mfma_f32_16x16x32_bf16 v[16:19], a[144:147], v[168:171], v[16:19]
v_exp_f32 v44, v44
v_mfma_f32_16x16x32_bf16 v[24:27], a[144:147], v[184:187], v[144:147]
v_mfma_f32_16x16x32_bf16 v[24:27], a[148:151], v[188:191], v[24:27]
v_exp_f32 v45, v45
v_mfma_f32_16x16x32_bf16 v[24:27], a[152:155], v[192:195], v[24:27]
s_add_u32 m0, s30, 98304
v_cvt_pk_bf16_f32 v90, v44, v45
v_mfma_f32_16x16x32_bf16 v[24:27], a[156:159], v[196:199], v[24:27]
v_exp_f32 v46, v46
v_mfma_f32_16x16x32_bf16 v[32:35], a[156:159], v[212:215], v[148:151]
ds_read_b128 a[156:159], v219 offset:57344
v_mfma_f32_16x16x32_bf16 v[32:35], a[152:155], v[208:211], v[32:35]
v_exp_f32 v47, v47
v_mfma_f32_16x16x32_bf16 v[32:35], a[148:151], v[204:207], v[32:35]
ds_read_b128 a[152:155], v218 offset:57344
v_cvt_pk_bf16_f32 v91, v46, v47
v_mfma_f32_16x16x32_bf16 v[32:35], a[144:147], v[200:203], v[32:35]
v_exp_f32 v48, v48
v_mfma_f32_16x16x32_bf16 a[0:3], v[72:75], a[176:179], a[0:3]
ds_read_b128 a[148:151], v217 offset:57344
ds_read_b128 a[144:147], v216 offset:57344
v_mfma_f32_16x16x32_bf16 a[16:19], v[72:75], a[180:183], a[16:19]
v_exp_f32 v49, v49
v_mfma_f32_16x16x32_bf16 a[20:23], v[76:79], a[180:183], a[20:23]
v_cvt_pk_bf16_f32 v92, v48, v49
v_mfma_f32_16x16x32_bf16 a[4:7], v[76:79], a[176:179], a[4:7]
v_exp_f32 v50, v50
v_mfma_f32_16x16x32_bf16 a[8:11], v[80:83], a[176:179], a[8:11]
buffer_load_dwordx4 v232, s[12:15], s39 offen offset:0  lds
v_mfma_f32_16x16x32_bf16 a[24:27], v[80:83], a[180:183], a[24:27]
v_exp_f32 v51, v51
v_mfma_f32_16x16x32_bf16 a[28:31], v[84:87], a[180:183], a[28:31]
ds_read_b64_tr_b16 a[180:181], v221 offset:40960
v_cvt_pk_bf16_f32 v93, v50, v51
v_mfma_f32_16x16x32_bf16 a[12:15], v[84:87], a[176:179], a[12:15]
v_exp_f32 v52, v52
v_mfma_f32_16x16x32_bf16 a[44:47], v[84:87], a[184:187], a[44:47]
ds_read_b64_tr_b16 a[182:183], v221 offset:45056
ds_read_b64_tr_b16 a[176:177], v220 offset:40960
v_mfma_f32_16x16x32_bf16 a[60:63], v[84:87], a[188:191], a[60:63]
v_exp_f32 v53, v53
v_mfma_f32_16x16x32_bf16 a[56:59], v[80:83], a[188:191], a[56:59]
ds_read_b64_tr_b16 a[178:179], v220 offset:45056
v_cvt_pk_bf16_f32 v94, v52, v53
v_mfma_f32_16x16x32_bf16 a[40:43], v[80:83], a[184:187], a[40:43]
v_exp_f32 v54, v54
v_mfma_f32_16x16x32_bf16 a[36:39], v[76:79], a[184:187], a[36:39]
buffer_load_dwordx4 v233, s[12:15], s39 offen offset:1024  lds
v_mfma_f32_16x16x32_bf16 a[52:55], v[76:79], a[188:191], a[52:55]
v_exp_f32 v55, v55
v_mfma_f32_16x16x32_bf16 a[48:51], v[72:75], a[188:191], a[48:51]
ds_read_b64_tr_b16 a[188:189], v223 offset:40960
v_cvt_pk_bf16_f32 v95, v54, v55
v_mfma_f32_16x16x32_bf16 a[32:35], v[72:75], a[184:187], a[32:35]
v_exp_f32 v56, v56
v_smfmac_f32_16x16x64_bf16 a[128:131], a[208:211], v[72:79], v245
ds_read_b64_tr_b16 a[190:191], v223 offset:45056
v_mfma_f32_16x16x32_bf16 v[12:15], a[160:163], v[152:155], v[136:139]
v_exp_f32 v57, v57
v_mfma_f32_16x16x32_bf16 v[12:15], a[164:167], v[156:159], v[12:15]
v_exp_f32 v58, v58
v_mfma_f32_16x16x32_bf16 v[12:15], a[168:171], v[160:163], v[12:15]
ds_read_b64_tr_b16 a[184:185], v222 offset:40960
v_cvt_pk_bf16_f32 v96, v56, v57
v_mfma_f32_16x16x32_bf16 v[12:15], a[172:175], v[164:167], v[12:15]
v_exp_f32 v59, v59
v_mfma_f32_16x16x32_bf16 v[20:23], a[172:175], v[180:183], v[140:143]
ds_read_b64_tr_b16 a[186:187], v222 offset:45056
v_cvt_pk_bf16_f32 v97, v58, v59
v_mfma_f32_16x16x32_bf16 v[20:23], a[168:171], v[176:179], v[20:23]
v_exp_f32 v60, v60
v_mfma_f32_16x16x32_bf16 v[20:23], a[164:167], v[172:175], v[20:23]
buffer_load_dwordx4 v232, s[12:15], s39 offen offset:2048  lds
v_mfma_f32_16x16x32_bf16 v[20:23], a[160:163], v[168:171], v[20:23]
v_exp_f32 v61, v61
v_mfma_f32_16x16x32_bf16 v[28:31], a[160:163], v[184:187], v[144:147]
v_cvt_pk_bf16_f32 v98, v60, v61
v_mfma_f32_16x16x32_bf16 v[28:31], a[164:167], v[188:191], v[28:31]
v_exp_f32 v62, v62
v_mfma_f32_16x16x32_bf16 v[28:31], a[168:171], v[192:195], v[28:31]
buffer_load_dwordx4 v233, s[12:15], s39 offen offset:3072  lds
v_mfma_f32_16x16x32_bf16 v[28:31], a[172:175], v[196:199], v[28:31]
v_exp_f32 v63, v63
v_mfma_f32_16x16x32_bf16 v[36:39], a[172:175], v[212:215], v[148:151]
ds_read_b128 a[172:175], v219 offset:61440
v_cvt_pk_bf16_f32 v99, v62, v63
v_mfma_f32_16x16x32_bf16 v[36:39], a[168:171], v[208:211], v[36:39]
v_exp_f32 v64, v64
v_mfma_f32_16x16x32_bf16 v[36:39], a[164:167], v[204:207], v[36:39]
ds_read_b128 a[168:171], v218 offset:61440
ds_read_b128 a[164:167], v217 offset:61440
v_mfma_f32_16x16x32_bf16 v[36:39], a[160:163], v[200:203], v[36:39]
v_exp_f32 v65, v65
s_waitcnt lgkmcnt(8)
v_mfma_f32_16x16x32_bf16 a[64:67], v[72:75], a[192:195], a[64:67]
ds_read_b128 a[160:163], v216 offset:61440
v_cvt_pk_bf16_f32 v100, v64, v65
v_mfma_f32_16x16x32_bf16 a[80:83], v[72:75], a[196:199], a[80:83]
v_exp_f32 v66, v66
v_mfma_f32_16x16x32_bf16 a[84:87], v[76:79], a[196:199], a[84:87]
buffer_load_dword v242, v241, s[20:23], s46 offen sc1
v_mfma_f32_16x16x32_bf16 a[68:71], v[76:79], a[192:195], a[68:71]
v_exp_f32 v67, v67
v_mfma_f32_16x16x32_bf16 a[72:75], v[80:83], a[192:195], a[72:75]
v_cvt_pk_bf16_f32 v101, v66, v67
v_add_u32 v241, 1024, v241
v_mfma_f32_16x16x32_bf16 a[88:91], v[80:83], a[196:199], a[88:91]
v_exp_f32 v68, v68
v_mfma_f32_16x16x32_bf16 a[92:95], v[84:87], a[196:199], a[92:95]
ds_read_b64_tr_b16 a[196:197], v225 offset:40960
ds_read_b64_tr_b16 a[198:199], v225 offset:45056
v_mfma_f32_16x16x32_bf16 a[76:79], v[84:87], a[192:195], a[76:79]
v_exp_f32 v69, v69
v_mfma_f32_16x16x32_bf16 a[108:111], v[84:87], a[200:203], a[108:111]
ds_read_b64_tr_b16 a[192:193], v224 offset:40960
v_cvt_pk_bf16_f32 v102, v68, v69
v_mfma_f32_16x16x32_bf16 a[124:127], v[84:87], a[204:207], a[124:127]
v_exp_f32 v70, v70
v_mfma_f32_16x16x32_bf16 a[120:123], v[80:83], a[204:207], a[120:123]
ds_read_b64_tr_b16 a[194:195], v224 offset:45056
v_and_b32 v241, 0x3fff, v241
v_mfma_f32_16x16x32_bf16 a[104:107], v[80:83], a[200:203], a[104:107]
v_exp_f32 v71, v71
v_mfma_f32_16x16x32_bf16 a[100:103], v[76:79], a[200:203], a[100:103]
v_cvt_pk_bf16_f32 v103, v70, v71
v_mfma_f32_16x16x32_bf16 a[116:119], v[76:79], a[204:207], a[116:119]
v_mfma_f32_16x16x32_bf16 a[112:115], v[72:75], a[204:207], a[112:115]
ds_read_b64_tr_b16 a[204:205], v227 offset:40960
ds_read_b64_tr_b16 a[206:207], v227 offset:45056
v_mfma_f32_16x16x32_bf16 a[96:99], v[72:75], a[200:203], a[96:99]
ds_read_b64_tr_b16 a[200:201], v226 offset:40960
ds_read_b64_tr_b16 a[202:203], v226 offset:45056
v_smfmac_f32_16x16x64_bf16 a[132:135], a[208:211], v[80:87], v245
v_mfma_f32_16x16x32_bf16 v[40:43], a[144:147], v[152:155], v[136:139]
v_exp_f32 v8, v8
v_mfma_f32_16x16x32_bf16 v[40:43], a[148:151], v[156:159], v[40:43]
v_exp_f32 v9, v9
v_mfma_f32_16x16x32_bf16 v[40:43], a[152:155], v[160:163], v[40:43]
v_cvt_pk_bf16_f32 v72, v8, v9
v_mfma_f32_16x16x32_bf16 v[40:43], a[156:159], v[164:167], v[40:43]
v_exp_f32 v10, v10
v_mfma_f32_16x16x32_bf16 v[48:51], a[156:159], v[180:183], v[140:143]
v_mfma_f32_16x16x32_bf16 v[48:51], a[152:155], v[176:179], v[48:51]
v_exp_f32 v11, v11
v_mfma_f32_16x16x32_bf16 v[48:51], a[148:151], v[172:175], v[48:51]
v_cvt_pk_bf16_f32 v73, v10, v11
v_mfma_f32_16x16x32_bf16 v[48:51], a[144:147], v[168:171], v[48:51]
v_exp_f32 v12, v12
v_mfma_f32_16x16x32_bf16 v[56:59], a[144:147], v[184:187], v[144:147]
v_mfma_f32_16x16x32_bf16 v[56:59], a[148:151], v[188:191], v[56:59]
v_exp_f32 v13, v13
v_mfma_f32_16x16x32_bf16 v[56:59], a[152:155], v[192:195], v[56:59]
v_cvt_pk_bf16_f32 v74, v12, v13
v_mfma_f32_16x16x32_bf16 v[56:59], a[156:159], v[196:199], v[56:59]
v_exp_f32 v14, v14
v_mfma_f32_16x16x32_bf16 v[64:67], a[156:159], v[212:215], v[148:151]
s_waitcnt vmcnt(10) lgkmcnt(0)
s_barrier
v_mfma_f32_16x16x32_bf16 v[64:67], a[152:155], v[208:211], v[64:67]
v_exp_f32 v15, v15
v_mfma_f32_16x16x32_bf16 v[64:67], a[148:151], v[204:207], v[64:67]
ds_read_b128 a[156:159], v219 offset:0
v_cvt_pk_bf16_f32 v75, v14, v15
v_mfma_f32_16x16x32_bf16 v[64:67], a[144:147], v[200:203], v[64:67]
v_exp_f32 v16, v16
v_mfma_f32_16x16x32_bf16 a[0:3], v[88:91], a[176:179], a[0:3]
ds_read_b128 a[152:155], v218 offset:0
ds_read_b128 a[148:151], v217 offset:0
v_mfma_f32_16x16x32_bf16 a[16:19], v[88:91], a[180:183], a[16:19]
v_exp_f32 v17, v17
v_mfma_f32_16x16x32_bf16 a[20:23], v[92:95], a[180:183], a[20:23]
ds_read_b128 a[144:147], v216 offset:0
v_cvt_pk_bf16_f32 v76, v16, v17
v_mfma_f32_16x16x32_bf16 a[4:7], v[92:95], a[176:179], a[4:7]
v_exp_f32 v18, v18
v_mfma_f32_16x16x32_bf16 a[8:11], v[96:99], a[176:179], a[8:11]
s_add_u32 s32, s32, 16384
s_add_u32 m0, s30, 114688
v_mfma_f32_16x16x32_bf16 a[24:27], v[96:99], a[180:183], a[24:27]
v_exp_f32 v19, v19
v_mfma_f32_16x16x32_bf16 a[28:31], v[100:103], a[180:183], a[28:31]
ds_read_b64_tr_b16 a[180:181], v221 offset:49152
v_cvt_pk_bf16_f32 v77, v18, v19
v_mfma_f32_16x16x32_bf16 a[12:15], v[100:103], a[176:179], a[12:15]
v_exp_f32 v20, v20
v_mfma_f32_16x16x32_bf16 a[44:47], v[100:103], a[184:187], a[44:47]
ds_read_b64_tr_b16 a[182:183], v221 offset:53248
ds_read_b64_tr_b16 a[176:177], v220 offset:49152
v_mfma_f32_16x16x32_bf16 a[60:63], v[100:103], a[188:191], a[60:63]
v_exp_f32 v21, v21
v_mfma_f32_16x16x32_bf16 a[56:59], v[96:99], a[188:191], a[56:59]
ds_read_b64_tr_b16 a[178:179], v220 offset:53248
v_cvt_pk_bf16_f32 v78, v20, v21
v_mfma_f32_16x16x32_bf16 a[40:43], v[96:99], a[184:187], a[40:43]
v_exp_f32 v22, v22
v_mfma_f32_16x16x32_bf16 a[36:39], v[92:95], a[184:187], a[36:39]
buffer_load_dwordx4 v228, s[8:11], s32 offen offset:0  lds
v_mfma_f32_16x16x32_bf16 a[52:55], v[92:95], a[188:191], a[52:55]
v_exp_f32 v23, v23
v_mfma_f32_16x16x32_bf16 a[48:51], v[88:91], a[188:191], a[48:51]
ds_read_b64_tr_b16 a[188:189], v223 offset:49152
v_cvt_pk_bf16_f32 v79, v22, v23
v_mfma_f32_16x16x32_bf16 a[32:35], v[88:91], a[184:187], a[32:35]
v_exp_f32 v24, v24
v_smfmac_f32_16x16x64_bf16 a[128:131], a[208:211], v[88:95], v245
ds_read_b64_tr_b16 a[190:191], v223 offset:53248
v_mfma_f32_16x16x32_bf16 v[44:47], a[160:163], v[152:155], v[136:139]
v_exp_f32 v25, v25
v_mfma_f32_16x16x32_bf16 v[44:47], a[164:167], v[156:159], v[44:47]
v_exp_f32 v26, v26
v_mfma_f32_16x16x32_bf16 v[44:47], a[168:171], v[160:163], v[44:47]
ds_read_b64_tr_b16 a[184:185], v222 offset:49152
v_cvt_pk_bf16_f32 v80, v24, v25
v_mfma_f32_16x16x32_bf16 v[44:47], a[172:175], v[164:167], v[44:47]
v_exp_f32 v27, v27
v_mfma_f32_16x16x32_bf16 v[52:55], a[172:175], v[180:183], v[140:143]
ds_read_b64_tr_b16 a[186:187], v222 offset:53248
v_cvt_pk_bf16_f32 v81, v26, v27
v_mfma_f32_16x16x32_bf16 v[52:55], a[168:171], v[176:179], v[52:55]
v_exp_f32 v28, v28
v_mfma_f32_16x16x32_bf16 v[52:55], a[164:167], v[172:175], v[52:55]
buffer_load_dwordx4 v229, s[8:11], s32 offen offset:1024  lds
v_mfma_f32_16x16x32_bf16 v[52:55], a[160:163], v[168:171], v[52:55]
v_exp_f32 v29, v29
v_mfma_f32_16x16x32_bf16 v[60:63], a[160:163], v[184:187], v[144:147]
v_cvt_pk_bf16_f32 v82, v28, v29
v_mfma_f32_16x16x32_bf16 v[60:63], a[164:167], v[188:191], v[60:63]
v_exp_f32 v30, v30
v_mfma_f32_16x16x32_bf16 v[60:63], a[168:171], v[192:195], v[60:63]
buffer_load_dwordx4 v230, s[8:11], s32 offen offset:2048  lds
v_mfma_f32_16x16x32_bf16 v[60:63], a[172:175], v[196:199], v[60:63]
v_exp_f32 v31, v31
v_mfma_f32_16x16x32_bf16 v[68:71], a[172:175], v[212:215], v[148:151]
ds_read_b128 a[172:175], v219 offset:4096
v_cvt_pk_bf16_f32 v83, v30, v31
v_mfma_f32_16x16x32_bf16 v[68:71], a[168:171], v[208:211], v[68:71]
v_exp_f32 v32, v32
v_mfma_f32_16x16x32_bf16 v[68:71], a[164:167], v[204:207], v[68:71]
ds_read_b128 a[168:171], v218 offset:4096
ds_read_b128 a[164:167], v217 offset:4096
v_mfma_f32_16x16x32_bf16 v[68:71], a[160:163], v[200:203], v[68:71]
v_exp_f32 v33, v33
v_mfma_f32_16x16x32_bf16 a[64:67], v[88:91], a[192:195], a[64:67]
ds_read_b128 a[160:163], v216 offset:4096
v_cvt_pk_bf16_f32 v84, v32, v33
v_mfma_f32_16x16x32_bf16 a[80:83], v[88:91], a[196:199], a[80:83]
v_exp_f32 v34, v34
v_mfma_f32_16x16x32_bf16 a[84:87], v[92:95], a[196:199], a[84:87]
buffer_load_dwordx4 v231, s[8:11], s32 offen offset:3072  lds
v_mfma_f32_16x16x32_bf16 a[68:71], v[92:95], a[192:195], a[68:71]
v_exp_f32 v35, v35
v_mfma_f32_16x16x32_bf16 a[72:75], v[96:99], a[192:195], a[72:75]
v_cvt_pk_bf16_f32 v85, v34, v35
v_mfma_f32_16x16x32_bf16 a[88:91], v[96:99], a[196:199], a[88:91]
v_exp_f32 v36, v36
v_mfma_f32_16x16x32_bf16 a[92:95], v[100:103], a[196:199], a[92:95]
ds_read_b64_tr_b16 a[196:197], v225 offset:49152
ds_read_b64_tr_b16 a[198:199], v225 offset:53248
v_mfma_f32_16x16x32_bf16 a[76:79], v[100:103], a[192:195], a[76:79]
v_exp_f32 v37, v37
v_mfma_f32_16x16x32_bf16 a[108:111], v[100:103], a[200:203], a[108:111]
ds_read_b64_tr_b16 a[192:193], v224 offset:49152
v_cvt_pk_bf16_f32 v86, v36, v37
v_mfma_f32_16x16x32_bf16 a[124:127], v[100:103], a[204:207], a[124:127]
v_exp_f32 v38, v38
v_mfma_f32_16x16x32_bf16 a[120:123], v[96:99], a[204:207], a[120:123]
ds_read_b64_tr_b16 a[194:195], v224 offset:53248
v_mfma_f32_16x16x32_bf16 a[104:107], v[96:99], a[200:203], a[104:107]
v_exp_f32 v39, v39
v_mfma_f32_16x16x32_bf16 a[100:103], v[92:95], a[200:203], a[100:103]
v_cvt_pk_bf16_f32 v87, v38, v39
v_mfma_f32_16x16x32_bf16 a[116:119], v[92:95], a[204:207], a[116:119]
s_mov_b32 m0, s87
s_lshl2_add_u32 s50, s87, s89
buffer_load_dwordx4 v243, s[56:59], s50 offen  lds
v_mfma_f32_16x16x32_bf16 a[112:115], v[88:91], a[204:207], a[112:115]
ds_read_b64_tr_b16 a[204:205], v227 offset:49152
ds_read_b64_tr_b16 a[206:207], v227 offset:53248
v_mfma_f32_16x16x32_bf16 a[96:99], v[88:91], a[200:203], a[96:99]
ds_read_b64_tr_b16 a[200:201], v226 offset:49152
ds_read_b64_tr_b16 a[202:203], v226 offset:53248
v_smfmac_f32_16x16x64_bf16 a[132:135], a[208:211], v[96:103], v245
s_add_u32 s87, s87, 3456
s_min_u32 s87, s87, 63936
s_waitcnt lgkmcnt(8)
v_mfma_f32_16x16x32_bf16 v[8:11], a[144:147], v[152:155], v[136:139]
v_exp_f32 v40, v40
v_mfma_f32_16x16x32_bf16 v[8:11], a[148:151], v[156:159], v[8:11]
v_exp_f32 v41, v41
v_mfma_f32_16x16x32_bf16 v[8:11], a[152:155], v[160:163], v[8:11]
v_cvt_pk_bf16_f32 v88, v40, v41
v_mfma_f32_16x16x32_bf16 v[8:11], a[156:159], v[164:167], v[8:11]
v_exp_f32 v42, v42
v_mfma_f32_16x16x32_bf16 v[16:19], a[156:159], v[180:183], v[140:143]
s_add_u32 s39, s39, 16384
v_mfma_f32_16x16x32_bf16 v[16:19], a[152:155], v[176:179], v[16:19]
v_exp_f32 v43, v43
v_mfma_f32_16x16x32_bf16 v[16:19], a[148:151], v[172:175], v[16:19]
v_cvt_pk_bf16_f32 v89, v42, v43
v_mfma_f32_16x16x32_bf16 v[16:19], a[144:147], v[168:171], v[16:19]
v_exp_f32 v44, v44
v_mfma_f32_16x16x32_bf16 v[24:27], a[144:147], v[184:187], v[144:147]
v_mfma_f32_16x16x32_bf16 v[24:27], a[148:151], v[188:191], v[24:27]
v_exp_f32 v45, v45
v_mfma_f32_16x16x32_bf16 v[24:27], a[152:155], v[192:195], v[24:27]
s_add_u32 m0, s30, 131072
v_cvt_pk_bf16_f32 v90, v44, v45
v_mfma_f32_16x16x32_bf16 v[24:27], a[156:159], v[196:199], v[24:27]
v_exp_f32 v46, v46
v_mfma_f32_16x16x32_bf16 v[32:35], a[156:159], v[212:215], v[148:151]
ds_read_b128 a[156:159], v219 offset:8192
v_mfma_f32_16x16x32_bf16 v[32:35], a[152:155], v[208:211], v[32:35]
v_exp_f32 v47, v47
v_mfma_f32_16x16x32_bf16 v[32:35], a[148:151], v[204:207], v[32:35]
ds_read_b128 a[152:155], v218 offset:8192
v_cvt_pk_bf16_f32 v91, v46, v47
v_mfma_f32_16x16x32_bf16 v[32:35], a[144:147], v[200:203], v[32:35]
v_exp_f32 v48, v48
v_mfma_f32_16x16x32_bf16 a[0:3], v[72:75], a[176:179], a[0:3]
ds_read_b128 a[148:151], v217 offset:8192
ds_read_b128 a[144:147], v216 offset:8192
v_mfma_f32_16x16x32_bf16 a[16:19], v[72:75], a[180:183], a[16:19]
v_exp_f32 v49, v49
v_mfma_f32_16x16x32_bf16 a[20:23], v[76:79], a[180:183], a[20:23]
v_cvt_pk_bf16_f32 v92, v48, v49
v_mfma_f32_16x16x32_bf16 a[4:7], v[76:79], a[176:179], a[4:7]
v_exp_f32 v50, v50
v_mfma_f32_16x16x32_bf16 a[8:11], v[80:83], a[176:179], a[8:11]
buffer_load_dwordx4 v232, s[12:15], s39 offen offset:0  lds
v_mfma_f32_16x16x32_bf16 a[24:27], v[80:83], a[180:183], a[24:27]
v_exp_f32 v51, v51
v_mfma_f32_16x16x32_bf16 a[28:31], v[84:87], a[180:183], a[28:31]
ds_read_b64_tr_b16 a[180:181], v221 offset:57344
v_cvt_pk_bf16_f32 v93, v50, v51
v_mfma_f32_16x16x32_bf16 a[12:15], v[84:87], a[176:179], a[12:15]
v_exp_f32 v52, v52
v_mfma_f32_16x16x32_bf16 a[44:47], v[84:87], a[184:187], a[44:47]
ds_read_b64_tr_b16 a[182:183], v221 offset:61440
ds_read_b64_tr_b16 a[176:177], v220 offset:57344
v_mfma_f32_16x16x32_bf16 a[60:63], v[84:87], a[188:191], a[60:63]
v_exp_f32 v53, v53
v_mfma_f32_16x16x32_bf16 a[56:59], v[80:83], a[188:191], a[56:59]
ds_read_b64_tr_b16 a[178:179], v220 offset:61440
v_cvt_pk_bf16_f32 v94, v52, v53
v_mfma_f32_16x16x32_bf16 a[40:43], v[80:83], a[184:187], a[40:43]
v_exp_f32 v54, v54
v_mfma_f32_16x16x32_bf16 a[36:39], v[76:79], a[184:187], a[36:39]
buffer_load_dwordx4 v233, s[12:15], s39 offen offset:1024  lds
v_mfma_f32_16x16x32_bf16 a[52:55], v[76:79], a[188:191], a[52:55]
v_exp_f32 v55, v55
v_mfma_f32_16x16x32_bf16 a[48:51], v[72:75], a[188:191], a[48:51]
ds_read_b64_tr_b16 a[188:189], v223 offset:57344
v_cvt_pk_bf16_f32 v95, v54, v55
v_mfma_f32_16x16x32_bf16 a[32:35], v[72:75], a[184:187], a[32:35]
v_exp_f32 v56, v56
v_smfmac_f32_16x16x64_bf16 a[128:131], a[208:211], v[72:79], v245
ds_read_b64_tr_b16 a[190:191], v223 offset:61440
v_mfma_f32_16x16x32_bf16 v[12:15], a[160:163], v[152:155], v[136:139]
v_exp_f32 v57, v57
v_mfma_f32_16x16x32_bf16 v[12:15], a[164:167], v[156:159], v[12:15]
v_exp_f32 v58, v58
v_mfma_f32_16x16x32_bf16 v[12:15], a[168:171], v[160:163], v[12:15]
ds_read_b64_tr_b16 a[184:185], v222 offset:57344
v_cvt_pk_bf16_f32 v96, v56, v57
v_mfma_f32_16x16x32_bf16 v[12:15], a[172:175], v[164:167], v[12:15]
v_exp_f32 v59, v59
v_mfma_f32_16x16x32_bf16 v[20:23], a[172:175], v[180:183], v[140:143]
ds_read_b64_tr_b16 a[186:187], v222 offset:61440
v_cvt_pk_bf16_f32 v97, v58, v59
v_mfma_f32_16x16x32_bf16 v[20:23], a[168:171], v[176:179], v[20:23]
v_exp_f32 v60, v60
v_mfma_f32_16x16x32_bf16 v[20:23], a[164:167], v[172:175], v[20:23]
buffer_load_dwordx4 v232, s[12:15], s39 offen offset:2048  lds
v_mfma_f32_16x16x32_bf16 v[20:23], a[160:163], v[168:171], v[20:23]
v_exp_f32 v61, v61
v_mfma_f32_16x16x32_bf16 v[28:31], a[160:163], v[184:187], v[144:147]
v_cvt_pk_bf16_f32 v98, v60, v61
v_mfma_f32_16x16x32_bf16 v[28:31], a[164:167], v[188:191], v[28:31]
v_exp_f32 v62, v62
v_mfma_f32_16x16x32_bf16 v[28:31], a[168:171], v[192:195], v[28:31]
buffer_load_dwordx4 v233, s[12:15], s39 offen offset:3072  lds
v_mfma_f32_16x16x32_bf16 v[28:31], a[172:175], v[196:199], v[28:31]
v_exp_f32 v63, v63
v_mfma_f32_16x16x32_bf16 v[36:39], a[172:175], v[212:215], v[148:151]
ds_read_b128 a[172:175], v219 offset:12288
v_cvt_pk_bf16_f32 v99, v62, v63
v_mfma_f32_16x16x32_bf16 v[36:39], a[168:171], v[208:211], v[36:39]
v_exp_f32 v64, v64
v_mfma_f32_16x16x32_bf16 v[36:39], a[164:167], v[204:207], v[36:39]
ds_read_b128 a[168:171], v218 offset:12288
ds_read_b128 a[164:167], v217 offset:12288
v_mfma_f32_16x16x32_bf16 v[36:39], a[160:163], v[200:203], v[36:39]
v_exp_f32 v65, v65
s_waitcnt lgkmcnt(8)
v_mfma_f32_16x16x32_bf16 a[64:67], v[72:75], a[192:195], a[64:67]
ds_read_b128 a[160:163], v216 offset:12288
v_cvt_pk_bf16_f32 v100, v64, v65
v_mfma_f32_16x16x32_bf16 a[80:83], v[72:75], a[196:199], a[80:83]
v_exp_f32 v66, v66
v_mfma_f32_16x16x32_bf16 a[84:87], v[76:79], a[196:199], a[84:87]
buffer_load_dword v242, v241, s[20:23], s46 offen sc1
v_mfma_f32_16x16x32_bf16 a[68:71], v[76:79], a[192:195], a[68:71]
v_exp_f32 v67, v67
v_mfma_f32_16x16x32_bf16 a[72:75], v[80:83], a[192:195], a[72:75]
v_cvt_pk_bf16_f32 v101, v66, v67
v_add_u32 v241, 1024, v241
v_mfma_f32_16x16x32_bf16 a[88:91], v[80:83], a[196:199], a[88:91]
v_exp_f32 v68, v68
v_mfma_f32_16x16x32_bf16 a[92:95], v[84:87], a[196:199], a[92:95]
ds_read_b64_tr_b16 a[196:197], v225 offset:57344
ds_read_b64_tr_b16 a[198:199], v225 offset:61440
v_mfma_f32_16x16x32_bf16 a[76:79], v[84:87], a[192:195], a[76:79]
v_exp_f32 v69, v69
v_mfma_f32_16x16x32_bf16 a[108:111], v[84:87], a[200:203], a[108:111]
ds_read_b64_tr_b16 a[192:193], v224 offset:57344
v_cvt_pk_bf16_f32 v102, v68, v69
v_mfma_f32_16x16x32_bf16 a[124:127], v[84:87], a[204:207], a[124:127]
v_exp_f32 v70, v70
v_mfma_f32_16x16x32_bf16 a[120:123], v[80:83], a[204:207], a[120:123]
ds_read_b64_tr_b16 a[194:195], v224 offset:61440
v_and_b32 v241, 0x3fff, v241
v_mfma_f32_16x16x32_bf16 a[104:107], v[80:83], a[200:203], a[104:107]
v_exp_f32 v71, v71
v_mfma_f32_16x16x32_bf16 a[100:103], v[76:79], a[200:203], a[100:103]
v_cvt_pk_bf16_f32 v103, v70, v71
v_mfma_f32_16x16x32_bf16 a[116:119], v[76:79], a[204:207], a[116:119]
v_mfma_f32_16x16x32_bf16 a[112:115], v[72:75], a[204:207], a[112:115]
ds_read_b64_tr_b16 a[204:205], v227 offset:57344
ds_read_b64_tr_b16 a[206:207], v227 offset:61440
v_mfma_f32_16x16x32_bf16 a[96:99], v[72:75], a[200:203], a[96:99]
ds_read_b64_tr_b16 a[200:201], v226 offset:57344
ds_read_b64_tr_b16 a[202:203], v226 offset:61440
v_smfmac_f32_16x16x64_bf16 a[132:135], a[208:211], v[80:87], v245
s_sub_u32 s33, s33, 1
s_cmp_lg_u32 s33, 0
s_cbranch_scc1 K_LOOP
K_LAST:
v_mfma_f32_16x16x32_bf16 v[40:43], a[144:147], v[152:155], v[136:139]
v_and_b32 v246, 15, v1
v_exp_f32 v8, v8
v_mfma_f32_16x16x32_bf16 v[40:43], a[148:151], v[156:159], v[40:43]
v_lshrrev_b32 v247, 3, v246
v_exp_f32 v9, v9
v_mfma_f32_16x16x32_bf16 v[40:43], a[152:155], v[160:163], v[40:43]
v_cvt_pk_bf16_f32 v72, v8, v9
v_and_b32 v246, 7, v246
v_lshlrev_b32 v246, 6, v246
v_mfma_f32_16x16x32_bf16 v[40:43], a[156:159], v[164:167], v[40:43]
v_lshl_add_u32 v246, v247, 13, v246
v_exp_f32 v10, v10
v_mfma_f32_16x16x32_bf16 v[48:51], a[156:159], v[180:183], v[140:143]
STUB_11:
s_cbranch_execz HOP_RET1
s_lshl_b32 s28, s36, 9
s_add_u32 s28, s28, 0x248000
v_mfma_f32_16x16x32_bf16 v[48:51], a[152:155], v[176:179], v[48:51]
v_exp_f32 v11, v11
v_mfma_f32_16x16x32_bf16 v[48:51], a[148:151], v[172:175], v[48:51]
v_cvt_pk_bf16_f32 v73, v10, v11
v_mfma_f32_16x16x32_bf16 v[48:51], a[144:147], v[168:171], v[48:51]
v_exp_f32 v12, v12
v_mfma_f32_16x16x32_bf16 v[56:59], a[144:147], v[184:187], v[144:147]
v_mfma_f32_16x16x32_bf16 v[56:59], a[148:151], v[188:191], v[56:59]
v_exp_f32 v13, v13
v_mfma_f32_16x16x32_bf16 v[56:59], a[152:155], v[192:195], v[56:59]
v_cvt_pk_bf16_f32 v74, v12, v13
v_mfma_f32_16x16x32_bf16 v[56:59], a[156:159], v[196:199], v[56:59]
v_exp_f32 v14, v14
v_mfma_f32_16x16x32_bf16 v[64:67], a[156:159], v[212:215], v[148:151]
s_waitcnt vmcnt(10) lgkmcnt(0)
s_barrier
v_mfma_f32_16x16x32_bf16 v[64:67], a[152:155], v[208:211], v[64:67]
v_exp_f32 v15, v15
v_mfma_f32_16x16x32_bf16 v[64:67], a[148:151], v[204:207], v[64:67]
ds_read_b128 a[156:159], v219 offset:16384
v_cvt_pk_bf16_f32 v75, v14, v15
v_mfma_f32_16x16x32_bf16 v[64:67], a[144:147], v[200:203], v[64:67]
v_exp_f32 v16, v16
v_mfma_f32_16x16x32_bf16 a[0:3], v[88:91], a[176:179], a[0:3]
ds_read_b128 a[152:155], v218 offset:16384
ds_read_b128 a[148:151], v217 offset:16384
v_mfma_f32_16x16x32_bf16 a[16:19], v[88:91], a[180:183], a[16:19]
v_exp_f32 v17, v17
v_mfma_f32_16x16x32_bf16 a[20:23], v[92:95], a[180:183], a[20:23]
ds_read_b128 a[144:147], v216 offset:16384
v_cvt_pk_bf16_f32 v76, v16, v17
v_mfma_f32_16x16x32_bf16 a[4:7], v[92:95], a[176:179], a[4:7]
v_exp_f32 v18, v18
v_mfma_f32_16x16x32_bf16 a[8:11], v[96:99], a[176:179], a[8:11]
s_add_u32 m0, s88, 62208
s_lshl2_add_u32 s50, m0, s89
buffer_load_dwordx4 v243, s[56:59], s50 offen  lds
v_mfma_f32_16x16x32_bf16 a[24:27], v[96:99], a[180:183], a[24:27]
v_exp_f32 v19, v19
v_mfma_f32_16x16x32_bf16 a[28:31], v[100:103], a[180:183], a[28:31]
ds_read_b64_tr_b16 a[180:181], v221 offset:0
v_cvt_pk_bf16_f32 v77, v18, v19
v_mfma_f32_16x16x32_bf16 a[12:15], v[100:103], a[176:179], a[12:15]
v_exp_f32 v20, v20
v_mfma_f32_16x16x32_bf16 a[44:47], v[100:103], a[184:187], a[44:47]
ds_read_b64_tr_b16 a[182:183], v221 offset:4096
ds_read_b64_tr_b16 a[176:177], v220 offset:0
v_mfma_f32_16x16x32_bf16 a[60:63], v[100:103], a[188:191], a[60:63]
v_exp_f32 v21, v21
v_mfma_f32_16x16x32_bf16 a[56:59], v[96:99], a[188:191], a[56:59]
ds_read_b64_tr_b16 a[178:179], v220 offset:4096
v_cvt_pk_bf16_f32 v78, v20, v21
v_mfma_f32_16x16x32_bf16 a[40:43], v[96:99], a[184:187], a[40:43]
v_exp_f32 v22, v22
v_mfma_f32_16x16x32_bf16 a[36:39], v[92:95], a[184:187], a[36:39]
buffer_load_dword v242, v246, s[20:23], s28 offen sc1
v_mfma_f32_16x16x32_bf16 a[52:55], v[92:95], a[188:191], a[52:55]
v_bfe_u32 v246, v1, 2, 2
v_exp_f32 v23, v23
v_mfma_f32_16x16x32_bf16 a[48:51], v[88:91], a[188:191], a[48:51]
ds_read_b64_tr_b16 a[188:189], v223 offset:0
v_cvt_pk_bf16_f32 v79, v22, v23
v_lshl_add_u32 v246, v4, 2, v246
v_mfma_f32_16x16x32_bf16 a[32:35], v[88:91], a[184:187], a[32:35]
v_mul_u32_u24 v246, 288, v246
v_exp_f32 v24, v24
v_smfmac_f32_16x16x64_bf16 a[128:131], a[208:211], v[88:95], v245
ds_read_b64_tr_b16 a[190:191], v223 offset:4096
v_and_b32 v247, 3, v1
v_mfma_f32_16x16x32_bf16 v[44:47], a[160:163], v[152:155], v[136:139]
v_lshl_add_u32 v236, v247, 3, v246
v_exp_f32 v25, v25
v_mfma_f32_16x16x32_bf16 v[44:47], a[164:167], v[156:159], v[44:47]
v_add_u32 v236, 256, v236
v_exp_f32 v26, v26
v_mfma_f32_16x16x32_bf16 v[44:47], a[168:171], v[160:163], v[44:47]
ds_read_b64_tr_b16 a[184:185], v222 offset:0
v_cvt_pk_bf16_f32 v80, v24, v25
v_lshl_add_u32 v246, v247, 4, v246
v_mfma_f32_16x16x32_bf16 v[44:47], a[172:175], v[164:167], v[44:47]
v_exp_f32 v27, v27
v_mfma_f32_16x16x32_bf16 v[52:55], a[172:175], v[180:183], v[140:143]
ds_read_b64_tr_b16 a[186:187], v222 offset:4096
v_cvt_pk_bf16_f32 v81, v26, v27
v_mfma_f32_16x16x32_bf16 v[52:55], a[168:171], v[176:179], v[52:55]
v_exp_f32 v28, v28
v_mfma_f32_16x16x32_bf16 v[52:55], a[164:167], v[172:175], v[52:55]
s_add_u32 m0, s88, 65664
s_lshl2_add_u32 s50, m0, s89
buffer_load_dwordx4 v243, s[56:59], s50 offen  lds
v_mfma_f32_16x16x32_bf16 v[52:55], a[160:163], v[168:171], v[52:55]
v_exp_f32 v29, v29
v_mfma_f32_16x16x32_bf16 v[60:63], a[160:163], v[184:187], v[144:147]
s_lshr_b32 s28, s35, 4
s_lshl_b32 s28, s28, 6
v_cvt_pk_bf16_f32 v82, v28, v29
v_mfma_f32_16x16x32_bf16 v[60:63], a[164:167], v[188:191], v[60:63]
v_add_u32 v234, s28, v246
v_exp_f32 v30, v30
v_mfma_f32_16x16x32_bf16 v[60:63], a[168:171], v[192:195], v[60:63]
s_xor_b32 s28, s28, 64
v_mfma_f32_16x16x32_bf16 v[60:63], a[172:175], v[196:199], v[60:63]
v_add_u32 v235, s28, v246
v_exp_f32 v31, v31
v_mfma_f32_16x16x32_bf16 v[68:71], a[172:175], v[212:215], v[148:151]
ds_read_b128 a[172:175], v219 offset:20480
v_cvt_pk_bf16_f32 v83, v30, v31
v_mfma_f32_16x16x32_bf16 v[68:71], a[168:171], v[208:211], v[68:71]
v_exp_f32 v32, v32
v_mfma_f32_16x16x32_bf16 v[68:71], a[164:167], v[204:207], v[68:71]
ds_read_b128 a[168:171], v218 offset:20480
ds_read_b128 a[164:167], v217 offset:20480
v_mfma_f32_16x16x32_bf16 v[68:71], a[160:163], v[200:203], v[68:71]
v_exp_f32 v33, v33
v_mfma_f32_16x16x32_bf16 a[64:67], v[88:91], a[192:195], a[64:67]
ds_read_b128 a[160:163], v216 offset:20480
v_cvt_pk_bf16_f32 v84, v32, v33
v_mfma_f32_16x16x32_bf16 a[80:83], v[88:91], a[196:199], a[80:83]
v_exp_f32 v34, v34
v_mfma_f32_16x16x32_bf16 a[84:87], v[92:95], a[196:199], a[84:87]
s_add_u32 m0, s88, 69120
s_lshl2_add_u32 s50, m0, s89
buffer_load_dwordx4 v243, s[56:59], s50 offen  lds
v_mfma_f32_16x16x32_bf16 a[68:71], v[92:95], a[192:195], a[68:71]
v_exp_f32 v35, v35
v_mfma_f32_16x16x32_bf16 a[72:75], v[96:99], a[192:195], a[72:75]
s_add_u32 s28, s35, 0
s_and_b32 s28, s28, 3
v_cvt_pk_bf16_f32 v85, v34, v35
v_mfma_f32_16x16x32_bf16 a[88:91], v[96:99], a[196:199], a[88:91]
s_mul_i32 s28, s28, 36864
v_exp_f32 v36, v36
v_mfma_f32_16x16x32_bf16 a[92:95], v[100:103], a[196:199], a[92:95]
ds_read_b64_tr_b16 a[196:197], v225 offset:0
ds_read_b64_tr_b16 a[198:199], v225 offset:4096
v_add_u32 v237, s28, v234
v_mfma_f32_16x16x32_bf16 a[76:79], v[100:103], a[192:195], a[76:79]
v_add_u32 v238, s28, v235
v_exp_f32 v37, v37
v_mfma_f32_16x16x32_bf16 a[108:111], v[100:103], a[200:203], a[108:111]
ds_read_b64_tr_b16 a[192:193], v224 offset:0
v_cvt_pk_bf16_f32 v86, v36, v37
v_add_u32 v239, s28, v236
v_mfma_f32_16x16x32_bf16 a[124:127], v[100:103], a[204:207], a[124:127]
v_mov_b32 v254, 0x7ffffff0
v_exp_f32 v38, v38
v_mfma_f32_16x16x32_bf16 a[120:123], v[96:99], a[204:207], a[120:123]
ds_read_b64_tr_b16 a[194:195], v224 offset:4096
s_lshl2_add_u32 s92, s36, s37
s_bfe_u32 s93, s35, 0x20002
v_mfma_f32_16x16x32_bf16 a[104:107], v[96:99], a[200:203], a[104:107]
s_lshl2_add_u32 s92, s92, s93
v_exp_f32 v39, v39
v_mfma_f32_16x16x32_bf16 a[100:103], v[92:95], a[200:203], a[100:103]
s_lshl_b32 s93, s92, 4
v_cvt_pk_bf16_f32 v87, v38, v39
v_mfma_f32_16x16x32_bf16 a[116:119], v[92:95], a[204:207], a[116:119]
v_add_u32 v132, s93, v3
v_writelane_b32 v254, 0, 0
v_mfma_f32_16x16x32_bf16 a[112:115], v[88:91], a[204:207], a[112:115]
ds_read_b64_tr_b16 a[204:205], v227 offset:0
ds_read_b64_tr_b16 a[206:207], v227 offset:4096
s_and_b32 s93, s35, 3
v_mfma_f32_16x16x32_bf16 a[96:99], v[88:91], a[200:203], a[96:99]
ds_read_b64_tr_b16 a[200:201], v226 offset:0
ds_read_b64_tr_b16 a[202:203], v226 offset:4096
s_mul_i32 s93, s93, 144
v_smfmac_f32_16x16x64_bf16 a[132:135], a[208:211], v[96:103], v245
v_lshlrev_b32 v251, 2, v4
v_add_u32 v251, s93, v251
s_waitcnt lgkmcnt(8)
v_mfma_f32_16x16x32_bf16 v[8:11], a[144:147], v[152:155], v[136:139]
v_add_u32 v251, 128, v251
v_exp_f32 v40, v40
v_mfma_f32_16x16x32_bf16 v[8:11], a[148:151], v[156:159], v[8:11]
v_lshlrev_b32 v250, 3, v4
v_exp_f32 v41, v41
v_mfma_f32_16x16x32_bf16 v[8:11], a[152:155], v[160:163], v[8:11]
s_lshr_b32 s90, s35, 4
s_lshl_b32 s90, s90, 5
v_cvt_pk_bf16_f32 v88, v40, v41
v_mfma_f32_16x16x32_bf16 v[8:11], a[156:159], v[164:167], v[8:11]
s_add_u32 s93, s93, s90
v_exp_f32 v42, v42
v_mfma_f32_16x16x32_bf16 v[16:19], a[156:159], v[180:183], v[140:143]
s_add_u32 s39, s39, 16384
v_add_u32 v250, s93, v250
v_lshlrev_b32 v250, 1, v250
v_mfma_f32_16x16x32_bf16 v[16:19], a[152:155], v[176:179], v[16:19]
v_lshlrev_b32 v251, 1, v251
v_exp_f32 v43, v43
v_mfma_f32_16x16x32_bf16 v[16:19], a[148:151], v[172:175], v[16:19]
v_cvt_pk_bf16_f32 v89, v42, v43
v_mul_u32_u24 v133, 0x480, v132
v_add_u32 v248, v133, v250
v_mfma_f32_16x16x32_bf16 v[16:19], a[144:147], v[168:171], v[16:19]
v_add_u32 v249, v133, v251
v_exp_f32 v44, v44
v_mfma_f32_16x16x32_bf16 v[24:27], a[144:147], v[184:187], v[144:147]
v_mov_b32 v135, 0x7fffbff0
v_mfma_f32_16x16x32_bf16 v[24:27], a[148:151], v[188:191], v[24:27]
v_exp_f32 v45, v45
v_mfma_f32_16x16x32_bf16 v[24:27], a[152:155], v[192:195], v[24:27]
s_add_u32 m0, s30, 147456
v_cvt_pk_bf16_f32 v90, v44, v45
v_mfma_f32_16x16x32_bf16 v[24:27], a[156:159], v[196:199], v[24:27]
v_exp_f32 v46, v46
v_mfma_f32_16x16x32_bf16 v[32:35], a[156:159], v[212:215], v[148:151]
ds_read_b128 a[156:159], v219 offset:24576
v_mfma_f32_16x16x32_bf16 v[32:35], a[152:155], v[208:211], v[32:35]
v_exp_f32 v47, v47
v_mfma_f32_16x16x32_bf16 v[32:35], a[148:151], v[204:207], v[32:35]
ds_read_b128 a[152:155], v218 offset:24576
v_cvt_pk_bf16_f32 v91, v46, v47
v_mfma_f32_16x16x32_bf16 v[32:35], a[144:147], v[200:203], v[32:35]
v_exp_f32 v48, v48
v_mfma_f32_16x16x32_bf16 a[0:3], v[72:75], a[176:179], a[0:3]
ds_read_b128 a[148:151], v217 offset:24576
ds_read_b128 a[144:147], v216 offset:24576
v_mfma_f32_16x16x32_bf16 a[16:19], v[72:75], a[180:183], a[16:19]
v_exp_f32 v49, v49
v_mfma_f32_16x16x32_bf16 a[20:23], v[76:79], a[180:183], a[20:23]
v_cvt_pk_bf16_f32 v92, v48, v49
v_mfma_f32_16x16x32_bf16 a[4:7], v[76:79], a[176:179], a[4:7]
v_exp_f32 v50, v50
v_mfma_f32_16x16x32_bf16 a[8:11], v[80:83], a[176:179], a[8:11]
buffer_load_dwordx4 v232, s[12:15], s39 offen offset:0  lds
v_mfma_f32_16x16x32_bf16 a[24:27], v[80:83], a[180:183], a[24:27]
v_exp_f32 v51, v51
v_mfma_f32_16x16x32_bf16 a[28:31], v[84:87], a[180:183], a[28:31]
ds_read_b64_tr_b16 a[180:181], v221 offset:8192
v_cvt_pk_bf16_f32 v93, v50, v51
v_mfma_f32_16x16x32_bf16 a[12:15], v[84:87], a[176:179], a[12:15]
v_exp_f32 v52, v52
v_mfma_f32_16x16x32_bf16 a[44:47], v[84:87], a[184:187], a[44:47]
ds_read_b64_tr_b16 a[182:183], v221 offset:12288
ds_read_b64_tr_b16 a[176:177], v220 offset:8192
v_mfma_f32_16x16x32_bf16 a[60:63], v[84:87], a[188:191], a[60:63]
v_exp_f32 v53, v53
v_mfma_f32_16x16x32_bf16 a[56:59], v[80:83], a[188:191], a[56:59]
ds_read_b64_tr_b16 a[178:179], v220 offset:12288
v_cvt_pk_bf16_f32 v94, v52, v53
v_mfma_f32_16x16x32_bf16 a[40:43], v[80:83], a[184:187], a[40:43]
v_exp_f32 v54, v54
v_mfma_f32_16x16x32_bf16 a[36:39], v[76:79], a[184:187], a[36:39]
buffer_load_dwordx4 v233, s[12:15], s39 offen offset:1024  lds
v_mfma_f32_16x16x32_bf16 a[52:55], v[76:79], a[188:191], a[52:55]
v_exp_f32 v55, v55
v_mfma_f32_16x16x32_bf16 a[48:51], v[72:75], a[188:191], a[48:51]
ds_read_b64_tr_b16 a[188:189], v223 offset:8192
v_cvt_pk_bf16_f32 v95, v54, v55
v_mfma_f32_16x16x32_bf16 a[32:35], v[72:75], a[184:187], a[32:35]
v_exp_f32 v56, v56
v_smfmac_f32_16x16x64_bf16 a[128:131], a[208:211], v[72:79], v245
ds_read_b64_tr_b16 a[190:191], v223 offset:12288
v_mfma_f32_16x16x32_bf16 v[12:15], a[160:163], v[152:155], v[136:139]
v_exp_f32 v57, v57
v_mfma_f32_16x16x32_bf16 v[12:15], a[164:167], v[156:159], v[12:15]
v_exp_f32 v58, v58
v_mfma_f32_16x16x32_bf16 v[12:15], a[168:171], v[160:163], v[12:15]
ds_read_b64_tr_b16 a[184:185], v222 offset:8192
v_cvt_pk_bf16_f32 v96, v56, v57
v_mfma_f32_16x16x32_bf16 v[12:15], a[172:175], v[164:167], v[12:15]
v_exp_f32 v59, v59
v_mfma_f32_16x16x32_bf16 v[20:23], a[172:175], v[180:183], v[140:143]
ds_read_b64_tr_b16 a[186:187], v222 offset:12288
v_cvt_pk_bf16_f32 v97, v58, v59
v_mfma_f32_16x16x32_bf16 v[20:23], a[168:171], v[176:179], v[20:23]
v_exp_f32 v60, v60
v_mfma_f32_16x16x32_bf16 v[20:23], a[164:167], v[172:175], v[20:23]
buffer_load_dwordx4 v232, s[12:15], s39 offen offset:2048  lds
v_mfma_f32_16x16x32_bf16 v[20:23], a[160:163], v[168:171], v[20:23]
v_exp_f32 v61, v61
v_mfma_f32_16x16x32_bf16 v[28:31], a[160:163], v[184:187], v[144:147]
v_cvt_pk_bf16_f32 v98, v60, v61
v_mfma_f32_16x16x32_bf16 v[28:31], a[164:167], v[188:191], v[28:31]
v_exp_f32 v62, v62
v_mfma_f32_16x16x32_bf16 v[28:31], a[168:171], v[192:195], v[28:31]
buffer_load_dwordx4 v233, s[12:15], s39 offen offset:3072  lds
v_mfma_f32_16x16x32_bf16 v[28:31], a[172:175], v[196:199], v[28:31]
v_exp_f32 v63, v63
v_mfma_f32_16x16x32_bf16 v[36:39], a[172:175], v[212:215], v[148:151]
ds_read_b128 a[172:175], v219 offset:28672
v_cvt_pk_bf16_f32 v99, v62, v63
v_mfma_f32_16x16x32_bf16 v[36:39], a[168:171], v[208:211], v[36:39]
v_exp_f32 v64, v64
v_mfma_f32_16x16x32_bf16 v[36:39], a[164:167], v[204:207], v[36:39]
ds_read_b128 a[168:171], v218 offset:28672
ds_read_b128 a[164:167], v217 offset:28672
v_mfma_f32_16x16x32_bf16 v[36:39], a[160:163], v[200:203], v[36:39]
v_exp_f32 v65, v65
s_waitcnt lgkmcnt(8)
v_mfma_f32_16x16x32_bf16 a[64:67], v[72:75], a[192:195], a[64:67]
ds_read_b128 a[160:163], v216 offset:28672
v_cvt_pk_bf16_f32 v100, v64, v65
v_mfma_f32_16x16x32_bf16 a[80:83], v[72:75], a[196:199], a[80:83]
v_exp_f32 v66, v66
v_mfma_f32_16x16x32_bf16 a[84:87], v[76:79], a[196:199], a[84:87]
s_add_u32 m0, s88, 72576
s_lshl2_add_u32 s50, m0, s89
buffer_load_dwordx4 v243, s[56:59], s50 offen  lds
v_mfma_f32_16x16x32_bf16 a[68:71], v[76:79], a[192:195], a[68:71]
v_exp_f32 v67, v67
v_mfma_f32_16x16x32_bf16 a[72:75], v[80:83], a[192:195], a[72:75]
v_cvt_pk_bf16_f32 v101, v66, v67
v_mfma_f32_16x16x32_bf16 a[88:91], v[80:83], a[196:199], a[88:91]
v_exp_f32 v68, v68
v_mfma_f32_16x16x32_bf16 a[92:95], v[84:87], a[196:199], a[92:95]
ds_read_b64_tr_b16 a[196:197], v225 offset:8192
ds_read_b64_tr_b16 a[198:199], v225 offset:12288
v_mfma_f32_16x16x32_bf16 a[76:79], v[84:87], a[192:195], a[76:79]
v_exp_f32 v69, v69
v_mfma_f32_16x16x32_bf16 a[108:111], v[84:87], a[200:203], a[108:111]
ds_read_b64_tr_b16 a[192:193], v224 offset:8192
v_cvt_pk_bf16_f32 v102, v68, v69
v_mfma_f32_16x16x32_bf16 a[124:127], v[84:87], a[204:207], a[124:127]
v_exp_f32 v70, v70
v_mfma_f32_16x16x32_bf16 a[120:123], v[80:83], a[204:207], a[120:123]
ds_read_b64_tr_b16 a[194:195], v224 offset:12288
v_mfma_f32_16x16x32_bf16 a[104:107], v[80:83], a[200:203], a[104:107]
v_exp_f32 v71, v71
v_mfma_f32_16x16x32_bf16 a[100:103], v[76:79], a[200:203], a[100:103]
v_cvt_pk_bf16_f32 v103, v70, v71
v_mfma_f32_16x16x32_bf16 a[116:119], v[76:79], a[204:207], a[116:119]
s_add_u32 m0, s88, 76032
s_lshl2_add_u32 s50, m0, s89
buffer_load_dwordx4 v243, s[56:59], s50 offen  lds
v_mfma_f32_16x16x32_bf16 a[112:115], v[72:75], a[204:207], a[112:115]
ds_read_b64_tr_b16 a[204:205], v227 offset:8192
ds_read_b64_tr_b16 a[206:207], v227 offset:12288
v_mfma_f32_16x16x32_bf16 a[96:99], v[72:75], a[200:203], a[96:99]
ds_read_b64_tr_b16 a[200:201], v226 offset:8192
ds_read_b64_tr_b16 a[202:203], v226 offset:12288
v_smfmac_f32_16x16x64_bf16 a[132:135], a[208:211], v[80:87], v245
s_mov_b32 s93, 0x243080
buffer_load_dword v246, v254, s[20:23], s93 offen sc0 sc1
v_mfma_f32_16x16x32_bf16 v[40:43], a[144:147], v[152:155], v[136:139]
s_mov_b32 s92, 0x1c00000
v_exp_f32 v8, v8
v_mfma_f32_16x16x32_bf16 v[40:43], a[148:151], v[156:159], v[40:43]
v_exp_f32 v9, v9
v_mfma_f32_16x16x32_bf16 v[40:43], a[152:155], v[160:163], v[40:43]
v_cvt_pk_bf16_f32 v72, v8, v9
v_mfma_f32_16x16x32_bf16 v[40:43], a[156:159], v[164:167], v[40:43]
v_exp_f32 v10, v10
v_mfma_f32_16x16x32_bf16 v[48:51], a[156:159], v[180:183], v[140:143]
v_mfma_f32_16x16x32_bf16 v[48:51], a[152:155], v[176:179], v[48:51]
v_exp_f32 v11, v11
v_mfma_f32_16x16x32_bf16 v[48:51], a[148:151], v[172:175], v[48:51]
v_cvt_pk_bf16_f32 v73, v10, v11
v_mfma_f32_16x16x32_bf16 v[48:51], a[144:147], v[168:171], v[48:51]
v_exp_f32 v12, v12
v_mfma_f32_16x16x32_bf16 v[56:59], a[144:147], v[184:187], v[144:147]
v_mfma_f32_16x16x32_bf16 v[56:59], a[148:151], v[188:191], v[56:59]
v_exp_f32 v13, v13
v_mfma_f32_16x16x32_bf16 v[56:59], a[152:155], v[192:195], v[56:59]
v_cvt_pk_bf16_f32 v74, v12, v13
v_mfma_f32_16x16x32_bf16 v[56:59], a[156:159], v[196:199], v[56:59]
v_exp_f32 v14, v14
v_mfma_f32_16x16x32_bf16 v[64:67], a[156:159], v[212:215], v[148:151]
s_waitcnt vmcnt(11) lgkmcnt(0)
s_barrier
v_mfma_f32_16x16x32_bf16 v[64:67], a[152:155], v[208:211], v[64:67]
v_exp_f32 v15, v15
v_mfma_f32_16x16x32_bf16 v[64:67], a[148:151], v[204:207], v[64:67]
ds_read_b128 a[156:159], v219 offset:49152
v_cvt_pk_bf16_f32 v75, v14, v15
v_mfma_f32_16x16x32_bf16 v[64:67], a[144:147], v[200:203], v[64:67]
v_exp_f32 v16, v16
v_mfma_f32_16x16x32_bf16 a[0:3], v[88:91], a[176:179], a[0:3]
ds_read_b128 a[152:155], v218 offset:49152
ds_read_b128 a[148:151], v217 offset:49152
v_mfma_f32_16x16x32_bf16 a[16:19], v[88:91], a[180:183], a[16:19]
v_exp_f32 v17, v17
v_mfma_f32_16x16x32_bf16 a[20:23], v[92:95], a[180:183], a[20:23]
ds_read_b128 a[144:147], v216 offset:49152
v_cvt_pk_bf16_f32 v76, v16, v17
v_mfma_f32_16x16x32_bf16 a[4:7], v[92:95], a[176:179], a[4:7]
v_exp_f32 v18, v18
v_mfma_f32_16x16x32_bf16 a[8:11], v[96:99], a[176:179], a[8:11]
s_add_u32 m0, s88, 79488
s_lshl2_add_u32 s50, m0, s89
buffer_load_dwordx4 v243, s[56:59], s50 offen  lds
v_mfma_f32_16x16x32_bf16 a[24:27], v[96:99], a[180:183], a[24:27]
v_exp_f32 v19, v19
v_mfma_f32_16x16x32_bf16 a[28:31], v[100:103], a[180:183], a[28:31]
ds_read_b64_tr_b16 a[180:181], v221 offset:32768
v_cvt_pk_bf16_f32 v77, v18, v19
v_mfma_f32_16x16x32_bf16 a[12:15], v[100:103], a[176:179], a[12:15]
v_exp_f32 v20, v20
v_mfma_f32_16x16x32_bf16 a[44:47], v[100:103], a[184:187], a[44:47]
ds_read_b64_tr_b16 a[182:183], v221 offset:36864
ds_read_b64_tr_b16 a[176:177], v220 offset:32768
v_mfma_f32_16x16x32_bf16 a[60:63], v[100:103], a[188:191], a[60:63]
v_exp_f32 v21, v21
v_mfma_f32_16x16x32_bf16 a[56:59], v[96:99], a[188:191], a[56:59]
ds_read_b64_tr_b16 a[178:179], v220 offset:36864
v_cvt_pk_bf16_f32 v78, v20, v21
v_mfma_f32_16x16x32_bf16 a[40:43], v[96:99], a[184:187], a[40:43]
v_exp_f32 v22, v22
v_mfma_f32_16x16x32_bf16 a[36:39], v[92:95], a[184:187], a[36:39]
s_add_u32 m0, s88, 82944
s_lshl2_add_u32 s50, m0, s89
buffer_load_dwordx4 v243, s[56:59], s50 offen  lds
v_mfma_f32_16x16x32_bf16 a[52:55], v[92:95], a[188:191], a[52:55]
v_exp_f32 v23, v23
v_mfma_f32_16x16x32_bf16 a[48:51], v[88:91], a[188:191], a[48:51]
ds_read_b64_tr_b16 a[188:189], v223 offset:32768
v_cvt_pk_bf16_f32 v79, v22, v23
v_mfma_f32_16x16x32_bf16 a[32:35], v[88:91], a[184:187], a[32:35]
v_exp_f32 v24, v24
v_smfmac_f32_16x16x64_bf16 a[128:131], a[208:211], v[88:95], v245
ds_read_b64_tr_b16 a[190:191], v223 offset:36864
v_mfma_f32_16x16x32_bf16 v[44:47], a[160:163], v[152:155], v[136:139]
v_exp_f32 v25, v25
v_mfma_f32_16x16x32_bf16 v[44:47], a[164:167], v[156:159], v[44:47]
v_exp_f32 v26, v26
v_mfma_f32_16x16x32_bf16 v[44:47], a[168:171], v[160:163], v[44:47]
ds_read_b64_tr_b16 a[184:185], v222 offset:32768
v_cvt_pk_bf16_f32 v80, v24, v25
v_mfma_f32_16x16x32_bf16 v[44:47], a[172:175], v[164:167], v[44:47]
v_exp_f32 v27, v27
v_mfma_f32_16x16x32_bf16 v[52:55], a[172:175], v[180:183], v[140:143]
ds_read_b64_tr_b16 a[186:187], v222 offset:36864
v_cvt_pk_bf16_f32 v81, v26, v27
v_mfma_f32_16x16x32_bf16 v[52:55], a[168:171], v[176:179], v[52:55]
v_exp_f32 v28, v28
v_mfma_f32_16x16x32_bf16 v[52:55], a[164:167], v[172:175], v[52:55]
s_add_u32 m0, s88, 86400
s_lshl2_add_u32 s50, m0, s89
buffer_load_dwordx4 v243, s[56:59], s50 offen  lds
v_mfma_f32_16x16x32_bf16 v[52:55], a[160:163], v[168:171], v[52:55]
v_exp_f32 v29, v29
v_mfma_f32_16x16x32_bf16 v[60:63], a[160:163], v[184:187], v[144:147]
buffer_load_dwordx4 a[222:225], v248, s[20:23], s92 offen offset:0 sc0 sc1
v_cvt_pk_bf16_f32 v82, v28, v29
v_mfma_f32_16x16x32_bf16 v[60:63], a[164:167], v[188:191], v[60:63]
v_exp_f32 v30, v30
v_mfma_f32_16x16x32_bf16 v[60:63], a[168:171], v[192:195], v[60:63]
s_add_u32 m0, s88, 89856
s_lshl2_add_u32 s50, m0, s89
buffer_load_dwordx4 v243, s[56:59], s50 offen  lds
v_mfma_f32_16x16x32_bf16 v[60:63], a[172:175], v[196:199], v[60:63]
v_exp_f32 v31, v31
v_mfma_f32_16x16x32_bf16 v[68:71], a[172:175], v[212:215], v[148:151]
ds_read_b128 a[172:175], v219 offset:53248
v_cvt_pk_bf16_f32 v83, v30, v31
v_mfma_f32_16x16x32_bf16 v[68:71], a[168:171], v[208:211], v[68:71]
v_exp_f32 v32, v32
v_mfma_f32_16x16x32_bf16 v[68:71], a[164:167], v[204:207], v[68:71]
ds_read_b128 a[168:171], v218 offset:53248
ds_read_b128 a[164:167], v217 offset:53248
v_mfma_f32_16x16x32_bf16 v[68:71], a[160:163], v[200:203], v[68:71]
v_exp_f32 v33, v33
v_mfma_f32_16x16x32_bf16 a[64:67], v[88:91], a[192:195], a[64:67]
ds_read_b128 a[160:163], v216 offset:53248
v_cvt_pk_bf16_f32 v84, v32, v33
v_mfma_f32_16x16x32_bf16 a[80:83], v[88:91], a[196:199], a[80:83]
v_exp_f32 v34, v34
v_mfma_f32_16x16x32_bf16 a[84:87], v[92:95], a[196:199], a[84:87]
s_add_u32 m0, s88, 93312
s_lshl2_add_u32 s50, m0, s89
buffer_load_dwordx4 v243, s[56:59], s50 offen  lds
v_mfma_f32_16x16x32_bf16 a[68:71], v[92:95], a[192:195], a[68:71]
v_exp_f32 v35, v35
v_mfma_f32_16x16x32_bf16 a[72:75], v[96:99], a[192:195], a[72:75]
buffer_load_dwordx4 a[226:229], v248, s[20:23], s92 offen offset:128 sc0 sc1
v_cvt_pk_bf16_f32 v85, v34, v35
v_mfma_f32_16x16x32_bf16 a[88:91], v[96:99], a[196:199], a[88:91]
v_exp_f32 v36, v36
v_mfma_f32_16x16x32_bf16 a[92:95], v[100:103], a[196:199], a[92:95]
ds_read_b64_tr_b16 a[196:197], v225 offset:32768
ds_read_b64_tr_b16 a[198:199], v225 offset:36864
v_mfma_f32_16x16x32_bf16 a[76:79], v[100:103], a[192:195], a[76:79]
v_exp_f32 v37, v37
v_mfma_f32_16x16x32_bf16 a[108:111], v[100:103], a[200:203], a[108:111]
ds_read_b64_tr_b16 a[192:193], v224 offset:32768
v_cvt_pk_bf16_f32 v86, v36, v37
v_mfma_f32_16x16x32_bf16 a[124:127], v[100:103], a[204:207], a[124:127]
v_exp_f32 v38, v38
v_mfma_f32_16x16x32_bf16 a[120:123], v[96:99], a[204:207], a[120:123]
ds_read_b64_tr_b16 a[194:195], v224 offset:36864
v_mfma_f32_16x16x32_bf16 a[104:107], v[96:99], a[200:203], a[104:107]
v_exp_f32 v39, v39
v_mfma_f32_16x16x32_bf16 a[100:103], v[92:95], a[200:203], a[100:103]
v_cvt_pk_bf16_f32 v87, v38, v39
v_mfma_f32_16x16x32_bf16 a[116:119], v[92:95], a[204:207], a[116:119]
v_mfma_f32_16x16x32_bf16 a[112:115], v[88:91], a[204:207], a[112:115]
ds_read_b64_tr_b16 a[204:205], v227 offset:32768
ds_read_b64_tr_b16 a[206:207], v227 offset:36864
v_mfma_f32_16x16x32_bf16 a[96:99], v[88:91], a[200:203], a[96:99]
ds_read_b64_tr_b16 a[200:201], v226 offset:32768
ds_read_b64_tr_b16 a[202:203], v226 offset:36864
v_smfmac_f32_16x16x64_bf16 a[132:135], a[208:211], v[96:103], v245
buffer_load_dwordx2 a[230:231], v249, s[20:23], s92 offen sc0 sc1
s_waitcnt lgkmcnt(8)
v_mfma_f32_16x16x32_bf16 v[8:11], a[144:147], v[152:155], v[136:139]
v_exp_f32 v40, v40
v_mfma_f32_16x16x32_bf16 v[8:11], a[148:151], v[156:159], v[8:11]
v_exp_f32 v41, v41
v_mfma_f32_16x16x32_bf16 v[8:11], a[152:155], v[160:163], v[8:11]
v_cvt_pk_bf16_f32 v88, v40, v41
v_mfma_f32_16x16x32_bf16 v[8:11], a[156:159], v[164:167], v[8:11]
v_exp_f32 v42, v42
v_mfma_f32_16x16x32_bf16 v[16:19], a[156:159], v[180:183], v[140:143]
s_add_u32 m0, s88, 96768
s_lshl2_add_u32 s50, m0, s89
buffer_load_dwordx4 v243, s[56:59], s50 offen  lds
v_mfma_f32_16x16x32_bf16 v[16:19], a[152:155], v[176:179], v[16:19]
v_exp_f32 v43, v43
v_mfma_f32_16x16x32_bf16 v[16:19], a[148:151], v[172:175], v[16:19]
v_cvt_pk_bf16_f32 v89, v42, v43
v_mfma_f32_16x16x32_bf16 v[16:19], a[144:147], v[168:171], v[16:19]
v_exp_f32 v44, v44
v_mfma_f32_16x16x32_bf16 v[24:27], a[144:147], v[184:187], v[144:147]
v_mfma_f32_16x16x32_bf16 v[24:27], a[148:151], v[188:191], v[24:27]
v_exp_f32 v45, v45
v_mfma_f32_16x16x32_bf16 v[24:27], a[152:155], v[192:195], v[24:27]
buffer_load_dwordx4 a[212:215], v248, s[52:55], 0 offen offset:0
v_cvt_pk_bf16_f32 v90, v44, v45
v_mfma_f32_16x16x32_bf16 v[24:27], a[156:159], v[196:199], v[24:27]
v_exp_f32 v46, v46
v_mfma_f32_16x16x32_bf16 v[32:35], a[156:159], v[212:215], v[148:151]
ds_read_b128 a[156:159], v219 offset:57344
v_mfma_f32_16x16x32_bf16 v[32:35], a[152:155], v[208:211], v[32:35]
v_exp_f32 v47, v47
v_mfma_f32_16x16x32_bf16 v[32:35], a[148:151], v[204:207], v[32:35]
ds_read_b128 a[152:155], v218 offset:57344
v_cvt_pk_bf16_f32 v91, v46, v47
v_mfma_f32_16x16x32_bf16 v[32:35], a[144:147], v[200:203], v[32:35]
v_exp_f32 v48, v48
v_mfma_f32_16x16x32_bf16 a[0:3], v[72:75], a[176:179], a[0:3]
ds_read_b128 a[148:151], v217 offset:57344
ds_read_b128 a[144:147], v216 offset:57344
v_mfma_f32_16x16x32_bf16 a[16:19], v[72:75], a[180:183], a[16:19]
v_exp_f32 v49, v49
v_mfma_f32_16x16x32_bf16 a[20:23], v[76:79], a[180:183], a[20:23]
v_cvt_pk_bf16_f32 v92, v48, v49
v_mfma_f32_16x16x32_bf16 a[4:7], v[76:79], a[176:179], a[4:7]
v_exp_f32 v50, v50
v_mfma_f32_16x16x32_bf16 a[8:11], v[80:83], a[176:179], a[8:11]
s_add_u32 m0, s88, 100224
s_lshl2_add_u32 s50, m0, s89
buffer_load_dwordx4 v243, s[56:59], s50 offen  lds
v_mfma_f32_16x16x32_bf16 a[24:27], v[80:83], a[180:183], a[24:27]
v_exp_f32 v51, v51
v_mfma_f32_16x16x32_bf16 a[28:31], v[84:87], a[180:183], a[28:31]
ds_read_b64_tr_b16 a[180:181], v221 offset:40960
v_cvt_pk_bf16_f32 v93, v50, v51
v_mfma_f32_16x16x32_bf16 a[12:15], v[84:87], a[176:179], a[12:15]
v_exp_f32 v52, v52
v_mfma_f32_16x16x32_bf16 a[44:47], v[84:87], a[184:187], a[44:47]
ds_read_b64_tr_b16 a[182:183], v221 offset:45056
ds_read_b64_tr_b16 a[176:177], v220 offset:40960
v_mfma_f32_16x16x32_bf16 a[60:63], v[84:87], a[188:191], a[60:63]
v_exp_f32 v53, v53
v_mfma_f32_16x16x32_bf16 a[56:59], v[80:83], a[188:191], a[56:59]
ds_read_b64_tr_b16 a[178:179], v220 offset:45056
v_cvt_pk_bf16_f32 v94, v52, v53
v_mfma_f32_16x16x32_bf16 a[40:43], v[80:83], a[184:187], a[40:43]
v_exp_f32 v54, v54
v_mfma_f32_16x16x32_bf16 a[36:39], v[76:79], a[184:187], a[36:39]
s_add_u32 m0, s88, 103680
s_lshl2_add_u32 s50, m0, s89
buffer_load_dwordx4 v243, s[56:59], s50 offen  lds
v_mfma_f32_16x16x32_bf16 a[52:55], v[76:79], a[188:191], a[52:55]
v_exp_f32 v55, v55
v_mfma_f32_16x16x32_bf16 a[48:51], v[72:75], a[188:191], a[48:51]
ds_read_b64_tr_b16 a[188:189], v223 offset:40960
v_cvt_pk_bf16_f32 v95, v54, v55
v_mfma_f32_16x16x32_bf16 a[32:35], v[72:75], a[184:187], a[32:35]
v_exp_f32 v56, v56
v_smfmac_f32_16x16x64_bf16 a[128:131], a[208:211], v[72:79], v245
ds_read_b64_tr_b16 a[190:191], v223 offset:45056
v_mfma_f32_16x16x32_bf16 v[12:15], a[160:163], v[152:155], v[136:139]
v_exp_f32 v57, v57
v_mfma_f32_16x16x32_bf16 v[12:15], a[164:167], v[156:159], v[12:15]
v_exp_f32 v58, v58
v_mfma_f32_16x16x32_bf16 v[12:15], a[168:171], v[160:163], v[12:15]
ds_read_b64_tr_b16 a[184:185], v222 offset:40960
v_cvt_pk_bf16_f32 v96, v56, v57
v_mfma_f32_16x16x32_bf16 v[12:15], a[172:175], v[164:167], v[12:15]
v_exp_f32 v59, v59
v_mfma_f32_16x16x32_bf16 v[20:23], a[172:175], v[180:183], v[140:143]
ds_read_b64_tr_b16 a[186:187], v222 offset:45056
v_cvt_pk_bf16_f32 v97, v58, v59
v_mfma_f32_16x16x32_bf16 v[20:23], a[168:171], v[176:179], v[20:23]
v_exp_f32 v60, v60
v_mfma_f32_16x16x32_bf16 v[20:23], a[164:167], v[172:175], v[20:23]
s_add_u32 m0, s88, 107136
STUB_12:
s_cbranch_execz HOP_RET1
s_lshl2_add_u32 s50, m0, s89
buffer_load_dwordx4 v243, s[56:59], s50 offen  lds
v_mfma_f32_16x16x32_bf16 v[20:23], a[160:163], v[168:171], v[20:23]
v_exp_f32 v61, v61
v_mfma_f32_16x16x32_bf16 v[28:31], a[160:163], v[184:187], v[144:147]
buffer_load_dwordx4 a[216:219], v248, s[52:55], 0 offen offset:128
v_cvt_pk_bf16_f32 v98, v60, v61
v_mfma_f32_16x16x32_bf16 v[28:31], a[164:167], v[188:191], v[28:31]
v_exp_f32 v62, v62
v_mfma_f32_16x16x32_bf16 v[28:31], a[168:171], v[192:195], v[28:31]
v_mfma_f32_16x16x32_bf16 v[28:31], a[172:175], v[196:199], v[28:31]
v_exp_f32 v63, v63
v_mfma_f32_16x16x32_bf16 v[36:39], a[172:175], v[212:215], v[148:151]
ds_read_b128 a[172:175], v219 offset:61440
v_cvt_pk_bf16_f32 v99, v62, v63
v_mfma_f32_16x16x32_bf16 v[36:39], a[168:171], v[208:211], v[36:39]
v_exp_f32 v64, v64
v_mfma_f32_16x16x32_bf16 v[36:39], a[164:167], v[204:207], v[36:39]
ds_read_b128 a[168:171], v218 offset:61440
ds_read_b128 a[164:167], v217 offset:61440
v_mfma_f32_16x16x32_bf16 v[36:39], a[160:163], v[200:203], v[36:39]
v_exp_f32 v65, v65
s_waitcnt lgkmcnt(8)
v_mfma_f32_16x16x32_bf16 a[64:67], v[72:75], a[192:195], a[64:67]
ds_read_b128 a[160:163], v216 offset:61440
v_cvt_pk_bf16_f32 v100, v64, v65
v_mfma_f32_16x16x32_bf16 a[80:83], v[72:75], a[196:199], a[80:83]
v_exp_f32 v66, v66
v_mfma_f32_16x16x32_bf16 a[84:87], v[76:79], a[196:199], a[84:87]
s_add_u32 m0, s88, 110592
s_lshl2_add_u32 s50, m0, s89
buffer_load_dwordx4 v243, s[56:59], s50 offen  lds
v_mfma_f32_16x16x32_bf16 a[68:71], v[76:79], a[192:195], a[68:71]
v_exp_f32 v67, v67
v_mfma_f32_16x16x32_bf16 a[72:75], v[80:83], a[192:195], a[72:75]
buffer_load_dwordx2 a[220:221], v249, s[52:55], 0 offen
v_cvt_pk_bf16_f32 v101, v66, v67
v_mfma_f32_16x16x32_bf16 a[88:91], v[80:83], a[196:199], a[88:91]
v_sub_u32 v133, 0xffff, v132
v_exp_f32 v68, v68
v_mfma_f32_16x16x32_bf16 a[92:95], v[84:87], a[196:199], a[92:95]
ds_read_b64_tr_b16 a[196:197], v225 offset:40960
ds_read_b64_tr_b16 a[198:199], v225 offset:45056
s_and_b32 s93, s76, 0xffff
v_mfma_f32_16x16x32_bf16 a[76:79], v[84:87], a[192:195], a[76:79]
v_cmp_eq_u32 s[90:91], s93, v133
v_exp_f32 v69, v69
v_mfma_f32_16x16x32_bf16 a[108:111], v[84:87], a[200:203], a[108:111]
ds_read_b64_tr_b16 a[192:193], v224 offset:40960
v_cvt_pk_bf16_f32 v102, v68, v69
v_mov_b32 v134, 0
v_mfma_f32_16x16x32_bf16 a[124:127], v[84:87], a[204:207], a[124:127]
v_cndmask_b32 v135, v135, v134, s[90:91]
v_exp_f32 v70, v70
v_mfma_f32_16x16x32_bf16 a[120:123], v[80:83], a[204:207], a[120:123]
ds_read_b64_tr_b16 a[194:195], v224 offset:45056
s_and_b32 s93, s77, 0xffff
v_mfma_f32_16x16x32_bf16 a[104:107], v[80:83], a[200:203], a[104:107]
v_cmp_eq_u32 s[90:91], s93, v133
v_exp_f32 v71, v71
v_mfma_f32_16x16x32_bf16 a[100:103], v[76:79], a[200:203], a[100:103]
v_cvt_pk_bf16_f32 v103, v70, v71
v_mov_b32 v134, 1152
v_mfma_f32_16x16x32_bf16 a[116:119], v[76:79], a[204:207], a[116:119]
v_cndmask_b32 v135, v135, v134, s[90:91]
v_mfma_f32_16x16x32_bf16 a[112:115], v[72:75], a[204:207], a[112:115]
ds_read_b64_tr_b16 a[204:205], v227 offset:40960
ds_read_b64_tr_b16 a[206:207], v227 offset:45056
s_and_b32 s93, s78, 0xffff
v_mfma_f32_16x16x32_bf16 a[96:99], v[72:75], a[200:203], a[96:99]
ds_read_b64_tr_b16 a[200:201], v226 offset:40960
ds_read_b64_tr_b16 a[202:203], v226 offset:45056
v_cmp_eq_u32 s[90:91], s93, v133
v_smfmac_f32_16x16x64_bf16 a[132:135], a[208:211], v[80:87], v245
v_mov_b32 v134, 2304
v_mfma_f32_16x16x32_bf16 v[40:43], a[144:147], v[152:155], v[136:139]
v_cndmask_b32 v135, v135, v134, s[90:91]
v_exp_f32 v8, v8
v_mfma_f32_16x16x32_bf16 v[40:43], a[148:151], v[156:159], v[40:43]
s_and_b32 s93, s79, 0xffff
v_exp_f32 v9, v9
v_mfma_f32_16x16x32_bf16 v[40:43], a[152:155], v[160:163], v[40:43]
v_cvt_pk_bf16_f32 v72, v8, v9
v_cmp_eq_u32 s[90:91], s93, v133
v_mov_b32 v134, 3456
v_mfma_f32_16x16x32_bf16 v[40:43], a[156:159], v[164:167], v[40:43]
v_cndmask_b32 v135, v135, v134, s[90:91]
v_exp_f32 v10, v10
v_mfma_f32_16x16x32_bf16 v[48:51], a[156:159], v[180:183], v[140:143]
s_and_b32 s93, s80, 0xffff
v_mfma_f32_16x16x32_bf16 v[48:51], a[152:155], v[176:179], v[48:51]
v_cmp_eq_u32 s[90:91], s93, v133
v_exp_f32 v11, v11
v_mfma_f32_16x16x32_bf16 v[48:51], a[148:151], v[172:175], v[48:51]
v_cvt_pk_bf16_f32 v73, v10, v11
v_mov_b32 v134, 4608
v_mfma_f32_16x16x32_bf16 v[48:51], a[144:147], v[168:171], v[48:51]
v_cndmask_b32 v135, v135, v134, s[90:91]
v_exp_f32 v12, v12
v_mfma_f32_16x16x32_bf16 v[56:59], a[144:147], v[184:187], v[144:147]
s_and_b32 s93, s81, 0xffff
v_mfma_f32_16x16x32_bf16 v[56:59], a[148:151], v[188:191], v[56:59]
v_cmp_eq_u32 s[90:91], s93, v133
v_exp_f32 v13, v13
v_mfma_f32_16x16x32_bf16 v[56:59], a[152:155], v[192:195], v[56:59]
v_cvt_pk_bf16_f32 v74, v12, v13
v_mov_b32 v134, 5760
v_mfma_f32_16x16x32_bf16 v[56:59], a[156:159], v[196:199], v[56:59]
v_cndmask_b32 v135, v135, v134, s[90:91]
v_exp_f32 v14, v14
v_mfma_f32_16x16x32_bf16 v[64:67], a[156:159], v[212:215], v[148:151]
s_waitcnt vmcnt(16) lgkmcnt(0)
s_barrier
s_and_b32 s93, s82, 0xffff
v_mfma_f32_16x16x32_bf16 v[64:67], a[152:155], v[208:211], v[64:67]
v_cmp_eq_u32 s[90:91], s93, v133
v_exp_f32 v15, v15
v_mfma_f32_16x16x32_bf16 v[64:67], a[148:151], v[204:207], v[64:67]
v_cvt_pk_bf16_f32 v75, v14, v15
v_mov_b32 v134, 6912
v_mfma_f32_16x16x32_bf16 v[64:67], a[144:147], v[200:203], v[64:67]
v_cndmask_b32 v135, v135, v134, s[90:91]
v_exp_f32 v16, v16
v_mfma_f32_16x16x32_bf16 a[0:3], v[88:91], a[176:179], a[0:3]
s_add_u32 m0, s88, 114048
s_lshl2_add_u32 s50, m0, s89
buffer_load_dwordx4 v243, s[56:59], s50 offen  lds
v_mfma_f32_16x16x32_bf16 a[16:19], v[88:91], a[180:183], a[16:19]
s_and_b32 s93, s83, 0xffff
v_exp_f32 v17, v17
v_mfma_f32_16x16x32_bf16 a[20:23], v[92:95], a[180:183], a[20:23]
v_cvt_pk_bf16_f32 v76, v16, v17
v_cmp_eq_u32 s[90:91], s93, v133
v_mov_b32 v134, 8064
v_mfma_f32_16x16x32_bf16 a[4:7], v[92:95], a[176:179], a[4:7]
v_cndmask_b32 v135, v135, v134, s[90:91]
v_exp_f32 v18, v18
v_mfma_f32_16x16x32_bf16 a[8:11], v[96:99], a[176:179], a[8:11]
v_add_u32 v250, v250, v135
v_add_u32 v251, v251, v135
v_mfma_f32_16x16x32_bf16 a[24:27], v[96:99], a[180:183], a[24:27]
v_exp_f32 v19, v19
v_mfma_f32_16x16x32_bf16 a[28:31], v[100:103], a[180:183], a[28:31]
ds_read_b64_tr_b16 a[180:181], v221 offset:49152
v_cvt_pk_bf16_f32 v77, v18, v19
v_lshrrev_b32 v134, 14, v135
v_mfma_f32_16x16x32_bf16 a[12:15], v[100:103], a[176:179], a[12:15]
v_exp_f32 v20, v20
v_mfma_f32_16x16x32_bf16 a[44:47], v[100:103], a[184:187], a[44:47]
ds_read_b64_tr_b16 a[182:183], v221 offset:53248
ds_read_b64_tr_b16 a[176:177], v220 offset:49152
v_mfma_f32_16x16x32_bf16 a[60:63], v[100:103], a[188:191], a[60:63]
v_exp_f32 v21, v21
v_mfma_f32_16x16x32_bf16 a[56:59], v[96:99], a[188:191], a[56:59]
ds_read_b64_tr_b16 a[178:179], v220 offset:53248
v_cvt_pk_bf16_f32 v78, v20, v21
v_mfma_f32_16x16x32_bf16 a[40:43], v[96:99], a[184:187], a[40:43]
v_cmp_eq_u32 s[90:91], 0, v134
v_exp_f32 v22, v22
v_mfma_f32_16x16x32_bf16 a[36:39], v[92:95], a[184:187], a[36:39]
s_add_u32 m0, s88, 117504
s_lshl2_add_u32 s50, m0, s89
buffer_load_dwordx4 v243, s[56:59], s50 offen  lds
v_mfma_f32_16x16x32_bf16 a[52:55], v[92:95], a[188:191], a[52:55]
v_exp_f32 v23, v23
v_mfma_f32_16x16x32_bf16 a[48:51], v[88:91], a[188:191], a[48:51]
ds_read_b64_tr_b16 a[188:189], v223 offset:49152
v_cvt_pk_bf16_f32 v79, v22, v23
v_mfma_f32_16x16x32_bf16 a[32:35], v[88:91], a[184:187], a[32:35]
v_exp_f32 v24, v24
v_smfmac_f32_16x16x64_bf16 a[128:131], a[208:211], v[88:95], v245
ds_read_b64_tr_b16 a[190:191], v223 offset:53248
v_mfma_f32_16x16x32_bf16 v[44:47], a[160:163], v[152:155], v[136:139]
v_exp_f32 v25, v25
v_mfma_f32_16x16x32_bf16 v[44:47], a[164:167], v[156:159], v[44:47]
v_exp_f32 v26, v26
v_mfma_f32_16x16x32_bf16 v[44:47], a[168:171], v[160:163], v[44:47]
ds_read_b64_tr_b16 a[184:185], v222 offset:49152
v_cvt_pk_bf16_f32 v80, v24, v25
v_mfma_f32_16x16x32_bf16 v[44:47], a[172:175], v[164:167], v[44:47]
v_exp_f32 v27, v27
v_mfma_f32_16x16x32_bf16 v[52:55], a[172:175], v[180:183], v[140:143]
ds_read_b64_tr_b16 a[186:187], v222 offset:53248
v_cvt_pk_bf16_f32 v81, v26, v27
v_mfma_f32_16x16x32_bf16 v[52:55], a[168:171], v[176:179], v[52:55]
v_exp_f32 v28, v28
v_mfma_f32_16x16x32_bf16 v[52:55], a[164:167], v[172:175], v[52:55]
s_add_u32 m0, s88, 120960
s_lshl2_add_u32 s50, m0, s89
buffer_load_dwordx4 v243, s[56:59], s50 offen  lds
v_mfma_f32_16x16x32_bf16 v[52:55], a[160:163], v[168:171], v[52:55]
v_exp_f32 v29, v29
v_mfma_f32_16x16x32_bf16 v[60:63], a[160:163], v[184:187], v[144:147]
v_cvt_pk_bf16_f32 v82, v28, v29
s_waitcnt vmcnt(19)
v_readfirstlane_b32 s93, v246
v_mfma_f32_16x16x32_bf16 v[60:63], a[164:167], v[188:191], v[60:63]
v_exp_f32 v30, v30
v_mfma_f32_16x16x32_bf16 v[60:63], a[168:171], v[192:195], v[60:63]
s_add_u32 m0, s88, 124416
s_lshl2_add_u32 s50, m0, s89
buffer_load_dwordx4 v243, s[56:59], s50 offen  lds
v_mfma_f32_16x16x32_bf16 v[60:63], a[172:175], v[196:199], v[60:63]
v_exp_f32 v31, v31
v_mfma_f32_16x16x32_bf16 v[68:71], a[172:175], v[212:215], v[148:151]
s_cmp_eq_u64 s[90:91], 0
s_cselect_b32 s93, 144, s93
v_cvt_pk_bf16_f32 v83, v30, v31
v_mfma_f32_16x16x32_bf16 v[68:71], a[168:171], v[208:211], v[68:71]
v_exp_f32 v32, v32
v_mfma_f32_16x16x32_bf16 v[68:71], a[164:167], v[204:207], v[68:71]
s_add_u32 m0, s88, 127872
s_lshl2_add_u32 s50, m0, s89
buffer_load_dwordx4 v243, s[56:59], s50 offen  lds
v_mfma_f32_16x16x32_bf16 v[68:71], a[160:163], v[200:203], v[68:71]
v_exp_f32 v33, v33
v_mfma_f32_16x16x32_bf16 a[64:67], v[88:91], a[192:195], a[64:67]
v_cvt_pk_bf16_f32 v84, v32, v33
v_mfma_f32_16x16x32_bf16 a[80:83], v[88:91], a[196:199], a[80:83]
v_exp_f32 v34, v34
v_mfma_f32_16x16x32_bf16 a[84:87], v[92:95], a[196:199], a[84:87]
s_add_u32 m0, s88, 131328
s_lshl2_add_u32 s50, m0, s89
buffer_load_dwordx4 v243, s[56:59], s50 offen  lds
v_mfma_f32_16x16x32_bf16 a[68:71], v[92:95], a[192:195], a[68:71]
v_exp_f32 v35, v35
v_mfma_f32_16x16x32_bf16 a[72:75], v[96:99], a[192:195], a[72:75]
s_cmp_lt_u32 s93, 144
s_cbranch_scc1 SP_Y
SP_Y_RET:
v_cvt_pk_bf16_f32 v85, v34, v35
v_mfma_f32_16x16x32_bf16 a[88:91], v[96:99], a[196:199], a[88:91]
v_exp_f32 v36, v36
v_mfma_f32_16x16x32_bf16 a[92:95], v[100:103], a[196:199], a[92:95]
ds_read_b64_tr_b16 a[196:197], v225 offset:49152
ds_read_b64_tr_b16 a[198:199], v225 offset:53248
v_mfma_f32_16x16x32_bf16 a[76:79], v[100:103], a[192:195], a[76:79]
v_exp_f32 v37, v37
v_mfma_f32_16x16x32_bf16 a[108:111], v[100:103], a[200:203], a[108:111]
ds_read_b64_tr_b16 a[192:193], v224 offset:49152
v_cvt_pk_bf16_f32 v86, v36, v37
v_mfma_f32_16x16x32_bf16 a[124:127], v[100:103], a[204:207], a[124:127]
v_exp_f32 v38, v38
v_mfma_f32_16x16x32_bf16 a[120:123], v[96:99], a[204:207], a[120:123]
ds_read_b64_tr_b16 a[194:195], v224 offset:53248
s_mov_b32 s93, 0x244000
v_mfma_f32_16x16x32_bf16 a[104:107], v[96:99], a[200:203], a[104:107]
v_exp_f32 v39, v39
v_mfma_f32_16x16x32_bf16 a[100:103], v[92:95], a[200:203], a[100:103]
v_cvt_pk_bf16_f32 v87, v38, v39
v_mfma_f32_16x16x32_bf16 a[116:119], v[92:95], a[204:207], a[116:119]
s_add_u32 m0, s88, 134784
s_lshl2_add_u32 s50, m0, s89
buffer_load_dwordx4 v243, s[56:59], s50 offen  lds
v_mfma_f32_16x16x32_bf16 a[112:115], v[88:91], a[204:207], a[112:115]
ds_read_b64_tr_b16 a[204:205], v227 offset:49152
ds_read_b64_tr_b16 a[206:207], v227 offset:53248
v_mfma_f32_16x16x32_bf16 a[96:99], v[88:91], a[200:203], a[96:99]
ds_read_b64_tr_b16 a[200:201], v226 offset:49152
ds_read_b64_tr_b16 a[202:203], v226 offset:53248
v_smfmac_f32_16x16x64_bf16 a[132:135], a[208:211], v[96:103], v245
buffer_load_dwordx4 a[232:235], v250, s[20:23], s93 offen offset:0 sc0 sc1
s_waitcnt lgkmcnt(8)
v_mfma_f32_16x16x32_bf16 a[0:3], v[72:75], a[176:179], a[0:3]
v_exp_f32 v40, v40
v_exp_f32 v41, v41
v_mfma_f32_16x16x32_bf16 a[4:7], v[76:79], a[176:179], a[4:7]
v_cvt_pk_bf16_f32 v88, v40, v41
v_exp_f32 v42, v42
v_mfma_f32_16x16x32_bf16 a[8:11], v[80:83], a[176:179], a[8:11]
buffer_load_dwordx4 a[236:239], v250, s[20:23], s93 offen offset:128 sc0 sc1
v_exp_f32 v43, v43
v_mfma_f32_16x16x32_bf16 a[12:15], v[84:87], a[176:179], a[12:15]
ds_read_b64_tr_b16 a[176:177], v220 offset:57344
v_cvt_pk_bf16_f32 v89, v42, v43
v_exp_f32 v44, v44
v_mfma_f32_16x16x32_bf16 a[28:31], v[84:87], a[180:183], a[28:31]
ds_read_b64_tr_b16 a[178:179], v220 offset:61440
v_exp_f32 v45, v45
v_mfma_f32_16x16x32_bf16 a[24:27], v[80:83], a[180:183], a[24:27]
v_cvt_pk_bf16_f32 v90, v44, v45
v_exp_f32 v46, v46
v_mfma_f32_16x16x32_bf16 a[20:23], v[76:79], a[180:183], a[20:23]
buffer_load_dwordx2 a[240:241], v251, s[20:23], s93 offen sc0 sc1
v_exp_f32 v47, v47
v_mfma_f32_16x16x32_bf16 a[16:19], v[72:75], a[180:183], a[16:19]
ds_read_b64_tr_b16 a[180:181], v221 offset:57344
v_cvt_pk_bf16_f32 v91, v46, v47
v_exp_f32 v48, v48
v_mfma_f32_16x16x32_bf16 a[32:35], v[72:75], a[184:187], a[32:35]
ds_read_b64_tr_b16 a[182:183], v221 offset:61440
v_exp_f32 v49, v49
v_mfma_f32_16x16x32_bf16 a[36:39], v[76:79], a[184:187], a[36:39]
v_cvt_pk_bf16_f32 v92, v48, v49
v_exp_f32 v50, v50
v_mfma_f32_16x16x32_bf16 a[40:43], v[80:83], a[184:187], a[40:43]
v_exp_f32 v51, v51
v_mfma_f32_16x16x32_bf16 a[44:47], v[84:87], a[184:187], a[44:47]
ds_read_b64_tr_b16 a[184:185], v222 offset:57344
v_cvt_pk_bf16_f32 v93, v50, v51
v_exp_f32 v52, v52
v_mfma_f32_16x16x32_bf16 a[60:63], v[84:87], a[188:191], a[60:63]
ds_read_b64_tr_b16 a[186:187], v222 offset:61440
v_exp_f32 v53, v53
v_mfma_f32_16x16x32_bf16 a[56:59], v[80:83], a[188:191], a[56:59]
v_cvt_pk_bf16_f32 v94, v52, v53
v_exp_f32 v54, v54
v_mfma_f32_16x16x32_bf16 a[52:55], v[76:79], a[188:191], a[52:55]
v_exp_f32 v55, v55
v_mfma_f32_16x16x32_bf16 a[48:51], v[72:75], a[188:191], a[48:51]
v_exp_f32 v56, v56
v_exp_f32 v57, v57
v_smfmac_f32_16x16x64_bf16 a[128:131], a[208:211], v[72:79], v245
v_cvt_pk_bf16_f32 v95, v54, v55
v_cvt_pk_bf16_f32 v96, v56, v57
v_exp_f32 v58, v58
s_waitcnt lgkmcnt(8)
v_mfma_f32_16x16x32_bf16 a[64:67], v[72:75], a[192:195], a[64:67]
ds_read_b64_tr_b16 a[188:189], v223 offset:57344
ds_read_b64_tr_b16 a[190:191], v223 offset:61440
v_exp_f32 v59, v59
v_mfma_f32_16x16x32_bf16 a[68:71], v[76:79], a[192:195], a[68:71]
v_cvt_pk_bf16_f32 v97, v58, v59
v_exp_f32 v60, v60
v_mfma_f32_16x16x32_bf16 a[72:75], v[80:83], a[192:195], a[72:75]
v_exp_f32 v61, v61
v_mfma_f32_16x16x32_bf16 a[76:79], v[84:87], a[192:195], a[76:79]
ds_read_b64_tr_b16 a[192:193], v224 offset:57344
v_cvt_pk_bf16_f32 v98, v60, v61
v_exp_f32 v62, v62
v_mfma_f32_16x16x32_bf16 a[92:95], v[84:87], a[196:199], a[92:95]
ds_read_b64_tr_b16 a[194:195], v224 offset:61440
v_exp_f32 v63, v63
v_mfma_f32_16x16x32_bf16 a[88:91], v[80:83], a[196:199], a[88:91]
v_cvt_pk_bf16_f32 v99, v62, v63
v_exp_f32 v64, v64
v_mfma_f32_16x16x32_bf16 a[84:87], v[76:79], a[196:199], a[84:87]
v_exp_f32 v65, v65
v_mfma_f32_16x16x32_bf16 a[80:83], v[72:75], a[196:199], a[80:83]
ds_read_b64_tr_b16 a[196:197], v225 offset:57344
v_cvt_pk_bf16_f32 v100, v64, v65
v_exp_f32 v66, v66
s_waitcnt lgkmcnt(8)
v_mfma_f32_16x16x32_bf16 a[96:99], v[72:75], a[200:203], a[96:99]
ds_read_b64_tr_b16 a[198:199], v225 offset:61440
v_exp_f32 v67, v67
v_mfma_f32_16x16x32_bf16 a[100:103], v[76:79], a[200:203], a[100:103]
v_cvt_pk_bf16_f32 v101, v66, v67
v_exp_f32 v68, v68
v_mfma_f32_16x16x32_bf16 a[104:107], v[80:83], a[200:203], a[104:107]
v_exp_f32 v69, v69
v_mfma_f32_16x16x32_bf16 a[108:111], v[84:87], a[200:203], a[108:111]
ds_read_b64_tr_b16 a[200:201], v226 offset:57344
v_cvt_pk_bf16_f32 v102, v68, v69
v_exp_f32 v70, v70
v_mfma_f32_16x16x32_bf16 a[124:127], v[84:87], a[204:207], a[124:127]
ds_read_b64_tr_b16 a[202:203], v226 offset:61440
v_exp_f32 v71, v71
v_mfma_f32_16x16x32_bf16 a[120:123], v[80:83], a[204:207], a[120:123]
v_cvt_pk_bf16_f32 v103, v70, v71
v_mfma_f32_16x16x32_bf16 a[116:119], v[76:79], a[204:207], a[116:119]
s_add_u32 m0, s88, 138240
s_lshl2_add_u32 s50, m0, s89
buffer_load_dwordx4 v243, s[56:59], s50 offen  lds
v_mfma_f32_16x16x32_bf16 a[112:115], v[72:75], a[204:207], a[112:115]
ds_read_b64_tr_b16 a[204:205], v227 offset:57344
ds_read_b64_tr_b16 a[206:207], v227 offset:61440
v_smfmac_f32_16x16x64_bf16 a[132:135], a[208:211], v[80:87], v245
s_add_u32 m0, s88, 141696
s_lshl2_add_u32 s50, m0, s89
buffer_load_dwordx4 v243, s[56:59], s50 offen  lds
s_add_u32 m0, s88, 145152
s_min_u32 m0, m0, 146880
s_lshl2_add_u32 s50, m0, s89
s_cmp_ge_u32 s37, 2
s_cselect_b32 exec_hi, 15, -1
buffer_load_dwordx4 v243, s[56:59], s50 offen  lds
s_mov_b32 exec_hi, -1
K_TAIL:
s_cmp_eq_u32 s48, 0
s_cbranch_scc1 K_MIXED
s_waitcnt lgkmcnt(0)
s_barrier
s_add_u32 s28, s30, 147456
v_smfmac_f32_16x16x64_bf16 a[128:131], a[208:211], v[88:95], v245
v_lshrrev_b32 v132, 1, v1
v_and_b32 v132, 8, v132
v_smfmac_f32_16x16x64_bf16 a[132:135], a[208:211], v[96:103], v245
v_xor_b32 v132, v132, v1
v_lshlrev_b32 v132, 4, v132
v_mfma_f32_16x16x32_bf16 a[0:3], v[88:91], a[176:179], a[0:3]
v_add_u32 v132, s28, v132
v_lshlrev_b32 v133, 3, v1
v_mfma_f32_16x16x32_bf16 a[16:19], v[88:91], a[180:183], a[16:19]
v_and_b32 v133, 8, v133
v_lshrrev_b32 v134, 2, v1
v_mfma_f32_16x16x32_bf16 a[32:35], v[88:91], a[184:187], a[32:35]
v_xor_b32 v133, v133, v134
v_and_b32 v134, 3, v1
v_mfma_f32_16x16x32_bf16 a[48:51], v[88:91], a[188:191], a[48:51]
v_lshl_add_u32 v133, v134, 4, v133
v_lshlrev_b32 v133, 4, v133
v_mfma_f32_16x16x32_bf16 a[64:67], v[88:91], a[192:195], a[64:67]
v_add_u32 v133, s28, v133
v_lshlrev_b32 v134, 2, v1
v_mfma_f32_16x16x32_bf16 a[80:83], v[88:91], a[196:199], a[80:83]
v_add_u32 v134, s28, v134
v_lshlrev_b32 v135, 4, v4
v_mfma_f32_16x16x32_bf16 a[96:99], v[88:91], a[200:203], a[96:99]
v_add_u32 v135, s28, v135
v_mfma_f32_16x16x32_bf16 a[112:115], v[88:91], a[204:207], a[112:115]
v_mfma_f32_16x16x32_bf16 a[4:7], v[92:95], a[176:179], a[4:7]
v_accvgpr_read_b32 v120, a128
v_accvgpr_read_b32 v124, a129
v_accvgpr_read_b32 v121, a130
v_mfma_f32_16x16x32_bf16 a[20:23], v[92:95], a[180:183], a[20:23]
v_accvgpr_read_b32 v125, a131
v_accvgpr_read_b32 v122, a132
v_accvgpr_read_b32 v126, a133
v_mfma_f32_16x16x32_bf16 a[36:39], v[92:95], a[184:187], a[36:39]
v_accvgpr_read_b32 v123, a134
v_accvgpr_read_b32 v127, a135
v_add_f32 v120, v120, v124
v_mfma_f32_16x16x32_bf16 a[52:55], v[92:95], a[188:191], a[52:55]
v_add_f32 v121, v121, v125
v_add_f32 v122, v122, v126
v_add_f32 v123, v123, v127
v_mfma_f32_16x16x32_bf16 a[68:71], v[92:95], a[192:195], a[68:71]
v_rcp_f32 v124, v120
v_rcp_f32 v125, v121
v_rcp_f32 v126, v122
v_mfma_f32_16x16x32_bf16 a[84:87], v[92:95], a[196:199], a[84:87]
v_rcp_f32 v127, v123
ds_write_b32 v134, v124 offset:0
ds_write_b32 v134, v125 offset:256
v_mfma_f32_16x16x32_bf16 a[100:103], v[92:95], a[200:203], a[100:103]
ds_write_b32 v134, v126 offset:512
ds_write_b32 v134, v127 offset:768
ds_read_b128 v[72:75], v135 offset:0
v_mfma_f32_16x16x32_bf16 a[116:119], v[92:95], a[204:207], a[116:119]
ds_read_b128 v[76:79], v135 offset:256
ds_read_b128 v[80:83], v135 offset:512
ds_read_b128 v[84:87], v135 offset:768
s_add_u32 s92, s44, 4096
s_add_u32 s93, s44, 8192
s_add_u32 s51, s44, 12288
v_mfma_f32_16x16x32_bf16 a[8:11], v[96:99], a[176:179], a[8:11]
v_accvgpr_read_b32 v104, a0
v_accvgpr_read_b32 v105, a1
v_accvgpr_read_b32 v106, a2
v_accvgpr_read_b32 v107, a3
v_mfma_f32_16x16x32_bf16 a[24:27], v[96:99], a[180:183], a[24:27]
v_accvgpr_read_b32 v108, a16
v_accvgpr_read_b32 v109, a17
v_accvgpr_read_b32 v110, a18
v_accvgpr_read_b32 v111, a19
s_waitcnt lgkmcnt(0)
v_pk_mul_f32 v[104:105], v[104:105], v[72:73]
v_pk_mul_f32 v[106:107], v[106:107], v[74:75]
v_pk_mul_f32 v[108:109], v[108:109], v[72:73]
v_pk_mul_f32 v[110:111], v[110:111], v[74:75]
v_cvt_pk_bf16_f32 v104, v104, v105
v_cvt_pk_bf16_f32 v105, v106, v107
v_cvt_pk_bf16_f32 v106, v108, v109
v_cvt_pk_bf16_f32 v107, v110, v111
v_mfma_f32_16x16x32_bf16 a[40:43], v[96:99], a[184:187], a[40:43]
v_accvgpr_read_b32 v112, a32
v_accvgpr_read_b32 v113, a33
v_accvgpr_read_b32 v114, a34
v_accvgpr_read_b32 v115, a35
ds_write_b128 v132, v[104:107] offset:0
v_mfma_f32_16x16x32_bf16 a[56:59], v[96:99], a[188:191], a[56:59]
v_accvgpr_read_b32 v116, a48
v_accvgpr_read_b32 v117, a49
v_accvgpr_read_b32 v118, a50
v_accvgpr_read_b32 v119, a51
ds_read_b64_tr_b16 v[8:9], v133 offset:0
ds_read_b64_tr_b16 v[10:11], v133 offset:8
v_pk_mul_f32 v[112:113], v[112:113], v[72:73]
v_pk_mul_f32 v[114:115], v[114:115], v[74:75]
v_pk_mul_f32 v[116:117], v[116:117], v[72:73]
v_pk_mul_f32 v[118:119], v[118:119], v[74:75]
v_cvt_pk_bf16_f32 v112, v112, v113
v_cvt_pk_bf16_f32 v113, v114, v115
v_cvt_pk_bf16_f32 v114, v116, v117
v_cvt_pk_bf16_f32 v115, v118, v119
v_mfma_f32_16x16x32_bf16 a[72:75], v[96:99], a[192:195], a[72:75]
v_accvgpr_read_b32 v104, a64
v_accvgpr_read_b32 v105, a65
v_accvgpr_read_b32 v106, a66
v_accvgpr_read_b32 v107, a67
ds_write_b128 v132, v[112:115] offset:1024
v_mfma_f32_16x16x32_bf16 a[88:91], v[96:99], a[196:199], a[88:91]
v_accvgpr_read_b32 v108, a80
v_accvgpr_read_b32 v109, a81
v_accvgpr_read_b32 v110, a82
v_accvgpr_read_b32 v111, a83
ds_read_b64_tr_b16 v[12:13], v133 offset:1024
ds_read_b64_tr_b16 v[14:15], v133 offset:1032
v_pk_mul_f32 v[104:105], v[104:105], v[72:73]
v_pk_mul_f32 v[106:107], v[106:107], v[74:75]
v_pk_mul_f32 v[108:109], v[108:109], v[72:73]
v_pk_mul_f32 v[110:111], v[110:111], v[74:75]
s_waitcnt lgkmcnt(3)
buffer_store_dwordx4 v[8:11], v244, s[20:23], s44 offen offset:0
v_cvt_pk_bf16_f32 v104, v104, v105
v_cvt_pk_bf16_f32 v105, v106, v107
v_cvt_pk_bf16_f32 v106, v108, v109
v_cvt_pk_bf16_f32 v107, v110, v111
v_mfma_f32_16x16x32_bf16 a[104:107], v[96:99], a[200:203], a[104:107]
v_accvgpr_read_b32 v112, a96
v_accvgpr_read_b32 v113, a97
v_accvgpr_read_b32 v114, a98
v_accvgpr_read_b32 v115, a99
ds_write_b128 v132, v[104:107] offset:2048
v_mfma_f32_16x16x32_bf16 a[120:123], v[96:99], a[204:207], a[120:123]
v_accvgpr_read_b32 v116, a112
v_accvgpr_read_b32 v117, a113
v_accvgpr_read_b32 v118, a114
v_accvgpr_read_b32 v119, a115
ds_read_b64_tr_b16 v[16:17], v133 offset:2048
ds_read_b64_tr_b16 v[18:19], v133 offset:2056
v_pk_mul_f32 v[112:113], v[112:113], v[72:73]
v_pk_mul_f32 v[114:115], v[114:115], v[74:75]
v_pk_mul_f32 v[116:117], v[116:117], v[72:73]
v_pk_mul_f32 v[118:119], v[118:119], v[74:75]
s_waitcnt lgkmcnt(3)
buffer_store_dwordx4 v[12:15], v244, s[20:23], s44 offen offset:1024
v_cvt_pk_bf16_f32 v112, v112, v113
v_cvt_pk_bf16_f32 v113, v114, v115
v_cvt_pk_bf16_f32 v114, v116, v117
v_cvt_pk_bf16_f32 v115, v118, v119
v_mfma_f32_16x16x32_bf16 a[12:15], v[100:103], a[176:179], a[12:15]
v_accvgpr_read_b32 v104, a4
v_accvgpr_read_b32 v105, a5
v_accvgpr_read_b32 v106, a6
v_accvgpr_read_b32 v107, a7
ds_write_b128 v132, v[112:115] offset:3072
v_mfma_f32_16x16x32_bf16 a[28:31], v[100:103], a[180:183], a[28:31]
v_accvgpr_read_b32 v108, a20
v_accvgpr_read_b32 v109, a21
v_accvgpr_read_b32 v110, a22
v_accvgpr_read_b32 v111, a23
ds_read_b64_tr_b16 v[20:21], v133 offset:3072
ds_read_b64_tr_b16 v[22:23], v133 offset:3080
v_pk_mul_f32 v[104:105], v[104:105], v[76:77]
v_pk_mul_f32 v[106:107], v[106:107], v[78:79]
v_pk_mul_f32 v[108:109], v[108:109], v[76:77]
v_pk_mul_f32 v[110:111], v[110:111], v[78:79]
s_waitcnt lgkmcnt(3)
buffer_store_dwordx4 v[16:19], v244, s[20:23], s44 offen offset:2048
v_cvt_pk_bf16_f32 v104, v104, v105
v_cvt_pk_bf16_f32 v105, v106, v107
v_cvt_pk_bf16_f32 v106, v108, v109
v_cvt_pk_bf16_f32 v107, v110, v111
v_mfma_f32_16x16x32_bf16 a[44:47], v[100:103], a[184:187], a[44:47]
v_accvgpr_read_b32 v112, a36
v_accvgpr_read_b32 v113, a37
v_accvgpr_read_b32 v114, a38
v_accvgpr_read_b32 v115, a39
ds_write_b128 v132, v[104:107] offset:0
v_mfma_f32_16x16x32_bf16 a[60:63], v[100:103], a[188:191], a[60:63]
v_accvgpr_read_b32 v116, a52
v_accvgpr_read_b32 v117, a53
v_accvgpr_read_b32 v118, a54
v_accvgpr_read_b32 v119, a55
ds_read_b64_tr_b16 v[24:25], v133 offset:0
ds_read_b64_tr_b16 v[26:27], v133 offset:8
v_pk_mul_f32 v[112:113], v[112:113], v[76:77]
v_pk_mul_f32 v[114:115], v[114:115], v[78:79]
v_pk_mul_f32 v[116:117], v[116:117], v[76:77]
v_pk_mul_f32 v[118:119], v[118:119], v[78:79]
s_waitcnt lgkmcnt(3)
buffer_store_dwordx4 v[20:23], v244, s[20:23], s44 offen offset:3072
v_cvt_pk_bf16_f32 v112, v112, v113
v_cvt_pk_bf16_f32 v113, v114, v115
v_cvt_pk_bf16_f32 v114, v116, v117
v_cvt_pk_bf16_f32 v115, v118, v119
v_mfma_f32_16x16x32_bf16 a[76:79], v[100:103], a[192:195], a[76:79]
v_accvgpr_read_b32 v104, a68
v_accvgpr_read_b32 v105, a69
v_accvgpr_read_b32 v106, a70
STUB_13:
STUB_B1:
s_cbranch_execz STUB_16
v_accvgpr_read_b32 v107, a71
ds_write_b128 v132, v[112:115] offset:1024
v_mfma_f32_16x16x32_bf16 a[92:95], v[100:103], a[196:199], a[92:95]
v_accvgpr_read_b32 v108, a84
v_accvgpr_read_b32 v109, a85
v_accvgpr_read_b32 v110, a86
v_accvgpr_read_b32 v111, a87
ds_read_b64_tr_b16 v[28:29], v133 offset:1024
ds_read_b64_tr_b16 v[30:31], v133 offset:1032
v_pk_mul_f32 v[104:105], v[104:105], v[76:77]
v_pk_mul_f32 v[106:107], v[106:107], v[78:79]
v_pk_mul_f32 v[108:109], v[108:109], v[76:77]
v_pk_mul_f32 v[110:111], v[110:111], v[78:79]
s_waitcnt lgkmcnt(3)
buffer_store_dwordx4 v[24:27], v244, s[20:23], s92 offen offset:0
v_cvt_pk_bf16_f32 v104, v104, v105
v_cvt_pk_bf16_f32 v105, v106, v107
v_cvt_pk_bf16_f32 v106, v108, v109
v_cvt_pk_bf16_f32 v107, v110, v111
v_mfma_f32_16x16x32_bf16 a[108:111], v[100:103], a[200:203], a[108:111]
v_accvgpr_read_b32 v112, a100
v_accvgpr_read_b32 v113, a101
v_accvgpr_read_b32 v114, a102
v_accvgpr_read_b32 v115, a103
ds_write_b128 v132, v[104:107] offset:2048
v_mfma_f32_16x16x32_bf16 a[124:127], v[100:103], a[204:207], a[124:127]
v_accvgpr_read_b32 v116, a116
v_accvgpr_read_b32 v117, a117
v_accvgpr_read_b32 v118, a118
v_accvgpr_read_b32 v119, a119
ds_read_b64_tr_b16 v[32:33], v133 offset:2048
ds_read_b64_tr_b16 v[34:35], v133 offset:2056
v_pk_mul_f32 v[112:113], v[112:113], v[76:77]
v_pk_mul_f32 v[114:115], v[114:115], v[78:79]
v_pk_mul_f32 v[116:117], v[116:117], v[76:77]
v_pk_mul_f32 v[118:119], v[118:119], v[78:79]
s_waitcnt lgkmcnt(3)
buffer_store_dwordx4 v[28:31], v244, s[20:23], s92 offen offset:1024
v_cvt_pk_bf16_f32 v112, v112, v113
v_cvt_pk_bf16_f32 v113, v114, v115
v_cvt_pk_bf16_f32 v114, v116, v117
v_cvt_pk_bf16_f32 v115, v118, v119
v_accvgpr_read_b32 v104, a8
v_accvgpr_read_b32 v105, a9
v_accvgpr_read_b32 v106, a10
v_accvgpr_read_b32 v107, a11
ds_write_b128 v132, v[112:115] offset:3072
v_accvgpr_read_b32 v108, a24
v_accvgpr_read_b32 v109, a25
v_accvgpr_read_b32 v110, a26
v_accvgpr_read_b32 v111, a27
ds_read_b64_tr_b16 v[36:37], v133 offset:3072
ds_read_b64_tr_b16 v[38:39], v133 offset:3080
v_pk_mul_f32 v[104:105], v[104:105], v[80:81]
v_pk_mul_f32 v[106:107], v[106:107], v[82:83]
v_pk_mul_f32 v[108:109], v[108:109], v[80:81]
v_pk_mul_f32 v[110:111], v[110:111], v[82:83]
s_waitcnt lgkmcnt(3)
buffer_store_dwordx4 v[32:35], v244, s[20:23], s92 offen offset:2048
v_cvt_pk_bf16_f32 v104, v104, v105
v_cvt_pk_bf16_f32 v105, v106, v107
v_cvt_pk_bf16_f32 v106, v108, v109
v_cvt_pk_bf16_f32 v107, v110, v111
v_accvgpr_read_b32 v112, a40
v_accvgpr_read_b32 v113, a41
v_accvgpr_read_b32 v114, a42
v_accvgpr_read_b32 v115, a43
ds_write_b128 v132, v[104:107] offset:0
v_accvgpr_read_b32 v116, a56
v_accvgpr_read_b32 v117, a57
v_accvgpr_read_b32 v118, a58
v_accvgpr_read_b32 v119, a59
ds_read_b64_tr_b16 v[40:41], v133 offset:0
ds_read_b64_tr_b16 v[42:43], v133 offset:8
v_pk_mul_f32 v[112:113], v[112:113], v[80:81]
v_pk_mul_f32 v[114:115], v[114:115], v[82:83]
v_pk_mul_f32 v[116:117], v[116:117], v[80:81]
v_pk_mul_f32 v[118:119], v[118:119], v[82:83]
s_waitcnt lgkmcnt(3)
buffer_store_dwordx4 v[36:39], v244, s[20:23], s92 offen offset:3072
v_cvt_pk_bf16_f32 v112, v112, v113
v_cvt_pk_bf16_f32 v113, v114, v115
v_cvt_pk_bf16_f32 v114, v116, v117
v_cvt_pk_bf16_f32 v115, v118, v119
v_accvgpr_read_b32 v104, a72
v_accvgpr_read_b32 v105, a73
v_accvgpr_read_b32 v106, a74
v_accvgpr_read_b32 v107, a75
ds_write_b128 v132, v[112:115] offset:1024
v_accvgpr_read_b32 v108, a88
v_accvgpr_read_b32 v109, a89
v_accvgpr_read_b32 v110, a90
v_accvgpr_read_b32 v111, a91
ds_read_b64_tr_b16 v[44:45], v133 offset:1024
ds_read_b64_tr_b16 v[46:47], v133 offset:1032
v_pk_mul_f32 v[104:105], v[104:105], v[80:81]
v_pk_mul_f32 v[106:107], v[106:107], v[82:83]
v_pk_mul_f32 v[108:109], v[108:109], v[80:81]
v_pk_mul_f32 v[110:111], v[110:111], v[82:83]
s_waitcnt lgkmcnt(3)
buffer_store_dwordx4 v[40:43], v244, s[20:23], s93 offen offset:0
v_cvt_pk_bf16_f32 v104, v104, v105
v_cvt_pk_bf16_f32 v105, v106, v107
v_cvt_pk_bf16_f32 v106, v108, v109
v_cvt_pk_bf16_f32 v107, v110, v111
v_accvgpr_read_b32 v112, a104
v_accvgpr_read_b32 v113, a105
v_accvgpr_read_b32 v114, a106
v_accvgpr_read_b32 v115, a107
ds_write_b128 v132, v[104:107] offset:2048
v_accvgpr_read_b32 v116, a120
v_accvgpr_read_b32 v117, a121
v_accvgpr_read_b32 v118, a122
v_accvgpr_read_b32 v119, a123
ds_read_b64_tr_b16 v[48:49], v133 offset:2048
ds_read_b64_tr_b16 v[50:51], v133 offset:2056
v_pk_mul_f32 v[112:113], v[112:113], v[80:81]
v_pk_mul_f32 v[114:115], v[114:115], v[82:83]
v_pk_mul_f32 v[116:117], v[116:117], v[80:81]
v_pk_mul_f32 v[118:119], v[118:119], v[82:83]
s_waitcnt lgkmcnt(3)
buffer_store_dwordx4 v[44:47], v244, s[20:23], s93 offen offset:1024
v_cvt_pk_bf16_f32 v112, v112, v113
v_cvt_pk_bf16_f32 v113, v114, v115
v_cvt_pk_bf16_f32 v114, v116, v117
v_cvt_pk_bf16_f32 v115, v118, v119
v_accvgpr_read_b32 v104, a12
v_accvgpr_read_b32 v105, a13
v_accvgpr_read_b32 v106, a14
v_accvgpr_read_b32 v107, a15
ds_write_b128 v132, v[112:115] offset:3072
v_accvgpr_read_b32 v108, a28
v_accvgpr_read_b32 v109, a29
v_accvgpr_read_b32 v110, a30
v_accvgpr_read_b32 v111, a31
ds_read_b64_tr_b16 v[52:53], v133 offset:3072
ds_read_b64_tr_b16 v[54:55], v133 offset:3080
v_pk_mul_f32 v[104:105], v[104:105], v[84:85]
v_pk_mul_f32 v[106:107], v[106:107], v[86:87]
v_pk_mul_f32 v[108:109], v[108:109], v[84:85]
v_pk_mul_f32 v[110:111], v[110:111], v[86:87]
s_waitcnt lgkmcnt(3)
buffer_store_dwordx4 v[48:51], v244, s[20:23], s93 offen offset:2048
v_cvt_pk_bf16_f32 v104, v104, v105
v_cvt_pk_bf16_f32 v105, v106, v107
v_cvt_pk_bf16_f32 v106, v108, v109
v_cvt_pk_bf16_f32 v107, v110, v111
v_accvgpr_read_b32 v112, a44
v_accvgpr_read_b32 v113, a45
v_accvgpr_read_b32 v114, a46
v_accvgpr_read_b32 v115, a47
ds_write_b128 v132, v[104:107] offset:0
v_accvgpr_read_b32 v116, a60
v_accvgpr_read_b32 v117, a61
v_accvgpr_read_b32 v118, a62
v_accvgpr_read_b32 v119, a63
ds_read_b64_tr_b16 v[56:57], v133 offset:0
ds_read_b64_tr_b16 v[58:59], v133 offset:8
v_pk_mul_f32 v[112:113], v[112:113], v[84:85]
v_pk_mul_f32 v[114:115], v[114:115], v[86:87]
v_pk_mul_f32 v[116:117], v[116:117], v[84:85]
v_pk_mul_f32 v[118:119], v[118:119], v[86:87]
s_waitcnt lgkmcnt(3)
buffer_store_dwordx4 v[52:55], v244, s[20:23], s93 offen offset:3072
v_cvt_pk_bf16_f32 v112, v112, v113
v_cvt_pk_bf16_f32 v113, v114, v115
v_cvt_pk_bf16_f32 v114, v116, v117
v_cvt_pk_bf16_f32 v115, v118, v119
v_accvgpr_read_b32 v104, a76
v_accvgpr_read_b32 v105, a77
v_accvgpr_read_b32 v106, a78
v_accvgpr_read_b32 v107, a79
ds_write_b128 v132, v[112:115] offset:1024
v_accvgpr_read_b32 v108, a92
v_accvgpr_read_b32 v109, a93
v_accvgpr_read_b32 v110, a94
v_accvgpr_read_b32 v111, a95
ds_read_b64_tr_b16 v[60:61], v133 offset:1024
ds_read_b64_tr_b16 v[62:63], v133 offset:1032
v_pk_mul_f32 v[104:105], v[104:105], v[84:85]
v_pk_mul_f32 v[106:107], v[106:107], v[86:87]
v_pk_mul_f32 v[108:109], v[108:109], v[84:85]
v_pk_mul_f32 v[110:111], v[110:111], v[86:87]
s_waitcnt lgkmcnt(3)
buffer_store_dwordx4 v[56:59], v244, s[20:23], s51 offen offset:0
v_cvt_pk_bf16_f32 v104, v104, v105
v_cvt_pk_bf16_f32 v105, v106, v107
v_cvt_pk_bf16_f32 v106, v108, v109
v_cvt_pk_bf16_f32 v107, v110, v111
v_accvgpr_read_b32 v112, a108
v_accvgpr_read_b32 v113, a109
v_accvgpr_read_b32 v114, a110
v_accvgpr_read_b32 v115, a111
ds_write_b128 v132, v[104:107] offset:2048
v_accvgpr_read_b32 v116, a124
v_accvgpr_read_b32 v117, a125
v_accvgpr_read_b32 v118, a126
v_accvgpr_read_b32 v119, a127
ds_read_b64_tr_b16 v[64:65], v133 offset:2048
ds_read_b64_tr_b16 v[66:67], v133 offset:2056
v_pk_mul_f32 v[112:113], v[112:113], v[84:85]
v_pk_mul_f32 v[114:115], v[114:115], v[86:87]
v_pk_mul_f32 v[116:117], v[116:117], v[84:85]
v_pk_mul_f32 v[118:119], v[118:119], v[86:87]
s_waitcnt lgkmcnt(3)
buffer_store_dwordx4 v[60:63], v244, s[20:23], s51 offen offset:1024
v_cvt_pk_bf16_f32 v112, v112, v113
v_cvt_pk_bf16_f32 v113, v114, v115
v_cvt_pk_bf16_f32 v114, v116, v117
v_cvt_pk_bf16_f32 v115, v118, v119
ds_write_b128 v132, v[112:115] offset:3072
ds_read_b64_tr_b16 v[68:69], v133 offset:3072
ds_read_b64_tr_b16 v[70:71], v133 offset:3080
s_waitcnt lgkmcnt(3)
buffer_store_dwordx4 v[64:67], v244, s[20:23], s51 offen offset:2048
v_max3_f32 v104, v120, v121, v122
v_max_f32 v104, v104, v123
v_add_f32 v105, v120, v121
v_add_f32 v105, v105, v122
v_add_f32 v105, v105, v123
v_cmp_nge_f32 vcc, s42, v104
v_cmp_u_f32 s[28:29], v105, v105
s_or_b64 vcc, vcc, s[28:29]
s_cmp_lg_u64 vcc, 0
s_cselect_b32 s28, 1, 0
v_mov_b32 v104, s28
v_mov_b32 v106, 147456
s_waitcnt lgkmcnt(0)
buffer_store_dwordx4 v[68:71], v244, s[20:23], s51 offen offset:3072
ds_write_b32 v134, v104
s_waitcnt vmcnt(16) lgkmcnt(0)
s_barrier
ds_read2st64_b32 v[110:111], v106 offset0:32 offset1:48
ds_read2st64_b32 v[108:109], v106 offset0:0 offset1:16
ds_read_b64_tr_b16 a[64:65], v237 offset:0
ds_read_b64_tr_b16 a[66:67], v237 offset:4608
ds_read_b64_tr_b16 a[68:69], v237 offset:9216
ds_read_b64_tr_b16 a[70:71], v237 offset:13824
ds_read_b64_tr_b16 a[72:73], v237 offset:8
ds_read_b64_tr_b16 a[74:75], v237 offset:4616
ds_read_b64_tr_b16 a[76:77], v237 offset:9224
ds_read_b64_tr_b16 a[78:79], v237 offset:13832
ds_read_b64_tr_b16 a[80:81], v238 offset:0
ds_read_b64_tr_b16 a[82:83], v238 offset:4608
ds_read_b64_tr_b16 a[84:85], v238 offset:9216
ds_read_b64_tr_b16 a[86:87], v238 offset:13824
s_waitcnt lgkmcnt(12)
v_or_b32 v108, v108, v109
v_or3_b32 v108, v108, v110, v111
s_nop 0
v_readfirstlane_b32 s28, v108
s_cmp_gt_u32 s28, s43
s_cbranch_scc1 K_FALLBACK
s_waitcnt lgkmcnt(8)
v_mfma_f32_16x16x32_bf16 v[96:99], a[64:67], v[56:59], 0
ds_read_b64_tr_b16 a[88:89], v238 offset:8
ds_read_b64_tr_b16 a[90:91], v238 offset:4616
v_mfma_f32_16x16x32_bf16 v[96:99], a[68:71], v[60:63], v[96:99]
s_lshr_b32 s32, s35, 2
s_and_b32 s33, s35, 3
v_mfma_f32_16x16x32_bf16 v[88:91], a[68:71], v[44:47], 0
s_lshl_b32 s94, s36, 9
s_lshl_b32 s28, s32, 6
v_mfma_f32_16x16x32_bf16 v[88:91], a[64:67], v[40:43], v[88:91]
s_lshr_b32 s34, s32, 2
v_mfma_f32_16x16x32_bf16 v[80:83], a[64:67], v[24:27], 0
ds_read_b64_tr_b16 a[92:93], v238 offset:9224
ds_read_b64_tr_b16 a[94:95], v238 offset:13832
v_mfma_f32_16x16x32_bf16 v[80:83], a[68:71], v[28:31], v[80:83]
s_add_u32 s94, s94, s28
s_lshl_b32 s28, s37, 4
v_mfma_f32_16x16x32_bf16 v[72:75], a[68:71], v[12:15], 0
s_add_u32 s94, s94, s28
s_add_u32 s94, s94, 0x248000
v_mfma_f32_16x16x32_bf16 v[72:75], a[64:67], v[8:11], v[72:75]
v_mov_b32 v231, 1
v_and_b32 v229, 7, v1
s_waitcnt lgkmcnt(8)
v_mfma_f32_16x16x32_bf16 v[76:79], a[72:75], v[8:11], 0
ds_read_b64_tr_b16 a[64:65], v237 offset:128
ds_read_b64_tr_b16 a[66:67], v237 offset:4736
v_mfma_f32_16x16x32_bf16 v[76:79], a[76:79], v[12:15], v[76:79]
v_lshlrev_b32 v229, 2, v229
v_lshlrev_b32 v226, 3, v1
v_mfma_f32_16x16x32_bf16 v[84:87], a[76:79], v[28:31], 0
s_lshl2_add_u32 s29, s33, s94
v_mfma_f32_16x16x32_bf16 v[84:87], a[72:75], v[24:27], v[84:87]
v_mfma_f32_16x16x32_bf16 v[92:95], a[72:75], v[40:43], 0
ds_read_b64_tr_b16 a[68:69], v237 offset:9344
ds_read_b64_tr_b16 a[70:71], v237 offset:13952
v_mfma_f32_16x16x32_bf16 v[92:95], a[76:79], v[44:47], v[92:95]
v_mfma_f32_16x16x32_bf16 v[100:103], a[76:79], v[60:63], 0
v_mfma_f32_16x16x32_bf16 v[100:103], a[72:75], v[56:59], v[100:103]
s_waitcnt lgkmcnt(8)
v_mfma_f32_16x16x32_bf16 v[128:131], a[80:83], v[56:59], 0
ds_read_b64_tr_b16 a[72:73], v237 offset:136
ds_read_b64_tr_b16 a[74:75], v237 offset:4744
v_mfma_f32_16x16x32_bf16 v[128:131], a[84:87], v[60:63], v[128:131]
v_mfma_f32_16x16x32_bf16 v[120:123], a[84:87], v[44:47], 0
v_mfma_f32_16x16x32_bf16 v[120:123], a[80:83], v[40:43], v[120:123]
v_mfma_f32_16x16x32_bf16 v[112:115], a[80:83], v[24:27], 0
ds_read_b64_tr_b16 a[76:77], v237 offset:9352
ds_read_b64_tr_b16 a[78:79], v237 offset:13960
v_mfma_f32_16x16x32_bf16 v[112:115], a[84:87], v[28:31], v[112:115]
s_waitcnt vmcnt(0)
buffer_store_dword v231, v254, s[20:23], s29 offen
v_mfma_f32_16x16x32_bf16 v[104:107], a[84:87], v[12:15], 0
s_add_u32 s28, s35, 1
s_and_b32 s28, s28, 3
v_mfma_f32_16x16x32_bf16 v[104:107], a[80:83], v[8:11], v[104:107]
s_mul_i32 s28, s28, 36864
s_waitcnt lgkmcnt(8)
v_mfma_f32_16x16x32_bf16 v[108:111], a[88:91], v[8:11], 0
ds_read_b64_tr_b16 a[80:81], v238 offset:128
ds_read_b64_tr_b16 a[82:83], v238 offset:4736
v_mfma_f32_16x16x32_bf16 v[108:111], a[92:95], v[12:15], v[108:111]
v_add_u32 v216, s28, v234
v_add_u32 v217, s28, v235
v_mfma_f32_16x16x32_bf16 v[116:119], a[92:95], v[28:31], 0
v_add_u32 v218, s28, v236
v_mfma_f32_16x16x32_bf16 v[116:119], a[88:91], v[24:27], v[116:119]
v_mfma_f32_16x16x32_bf16 v[124:127], a[88:91], v[40:43], 0
ds_read_b64_tr_b16 a[84:85], v238 offset:9344
ds_read_b64_tr_b16 a[86:87], v238 offset:13952
v_mfma_f32_16x16x32_bf16 v[124:127], a[92:95], v[44:47], v[124:127]
v_mfma_f32_16x16x32_bf16 v[132:135], a[92:95], v[60:63], 0
v_mfma_f32_16x16x32_bf16 v[132:135], a[88:91], v[56:59], v[132:135]
s_waitcnt lgkmcnt(8)
v_mfma_f32_16x16x32_bf16 v[160:163], a[64:67], v[56:59], 0
ds_read_b64_tr_b16 a[88:89], v238 offset:136
ds_read_b64_tr_b16 a[90:91], v238 offset:4744
v_mfma_f32_16x16x32_bf16 v[160:163], a[68:71], v[60:63], v[160:163]
v_mfma_f32_16x16x32_bf16 v[152:155], a[68:71], v[44:47], 0
v_mfma_f32_16x16x32_bf16 v[152:155], a[64:67], v[40:43], v[152:155]
v_mfma_f32_16x16x32_bf16 v[144:147], a[64:67], v[24:27], 0
ds_read_b64_tr_b16 a[92:93], v238 offset:9352
ds_read_b64_tr_b16 a[94:95], v238 offset:13960
v_mfma_f32_16x16x32_bf16 v[144:147], a[68:71], v[28:31], v[144:147]
v_mfma_f32_16x16x32_bf16 v[136:139], a[68:71], v[12:15], 0
v_mfma_f32_16x16x32_bf16 v[136:139], a[64:67], v[8:11], v[136:139]
s_waitcnt lgkmcnt(8)
v_mfma_f32_16x16x32_bf16 v[140:143], a[72:75], v[8:11], 0
ds_read_b64_tr_b16 a[64:65], v239 offset:0
ds_read_b64_tr_b16 a[66:67], v239 offset:4608
v_mfma_f32_16x16x32_bf16 v[140:143], a[76:79], v[12:15], v[140:143]
buffer_load_dword v230, v229, s[20:23], s94 offen sc0 sc1
v_mfma_f32_16x16x32_bf16 v[148:151], a[76:79], v[28:31], 0
s_add_u32 s39, s35, 1
s_and_b32 s39, s39, 3
v_mfma_f32_16x16x32_bf16 v[148:151], a[72:75], v[24:27], v[148:151]
s_add_u32 s28, s33, 1
s_and_b32 s28, s28, 3
v_mfma_f32_16x16x32_bf16 v[156:159], a[72:75], v[40:43], 0
ds_read_b64_tr_b16 a[68:69], v239 offset:9216
ds_read_b64_tr_b16 a[70:71], v239 offset:13824
v_mfma_f32_16x16x32_bf16 v[156:159], a[76:79], v[44:47], v[156:159]
s_sub_u32 s28, s28, s33
s_lshl_b32 s28, s28, 16
v_mfma_f32_16x16x32_bf16 v[164:167], a[76:79], v[60:63], 0
s_add_u32 s64, s28, s44
s_add_u32 s65, s64, 4096
v_mfma_f32_16x16x32_bf16 v[164:167], a[72:75], v[56:59], v[164:167]
s_add_u32 s66, s64, 8192
s_add_u32 s67, s64, 12288
s_waitcnt lgkmcnt(8)
v_mfma_f32_16x16x32_bf16 v[192:195], a[80:83], v[56:59], 0
ds_read_b64_tr_b16 a[72:73], v237 offset:18432
ds_read_b64_tr_b16 a[74:75], v237 offset:23040
v_mfma_f32_16x16x32_bf16 v[192:195], a[84:87], v[60:63], v[192:195]
s_add_u32 s28, s35, 2
s_and_b32 s28, s28, 3
v_mfma_f32_16x16x32_bf16 v[184:187], a[84:87], v[44:47], 0
s_mul_i32 s28, s28, 36864
v_mfma_f32_16x16x32_bf16 v[184:187], a[80:83], v[40:43], v[184:187]
v_add_u32 v219, s28, v234
v_add_u32 v220, s28, v235
v_mfma_f32_16x16x32_bf16 v[176:179], a[80:83], v[24:27], 0
ds_read_b64_tr_b16 a[76:77], v237 offset:27648
ds_read_b64_tr_b16 a[78:79], v237 offset:32256
v_mfma_f32_16x16x32_bf16 v[176:179], a[84:87], v[28:31], v[176:179]
v_add_u32 v221, s28, v236
v_mfma_f32_16x16x32_bf16 v[168:171], a[84:87], v[12:15], 0
s_add_u32 s28, s35, 3
s_and_b32 s28, s28, 3
v_mfma_f32_16x16x32_bf16 v[168:171], a[80:83], v[8:11], v[168:171]
s_mul_i32 s28, s28, 36864
s_waitcnt lgkmcnt(8)
v_mfma_f32_16x16x32_bf16 v[172:175], a[88:91], v[8:11], 0
ds_read_b64_tr_b16 a[80:81], v237 offset:18440
ds_read_b64_tr_b16 a[82:83], v237 offset:23048
v_mfma_f32_16x16x32_bf16 v[172:175], a[92:95], v[12:15], v[172:175]
v_add_u32 v222, s28, v234
v_add_u32 v223, s28, v235
v_mfma_f32_16x16x32_bf16 v[180:183], a[92:95], v[28:31], 0
v_add_u32 v224, s28, v236
v_mfma_f32_16x16x32_bf16 v[180:183], a[88:91], v[24:27], v[180:183]
v_mfma_f32_16x16x32_bf16 v[188:191], a[88:91], v[40:43], 0
ds_read_b64_tr_b16 a[84:85], v237 offset:27656
ds_read_b64_tr_b16 a[86:87], v237 offset:32264
v_mfma_f32_16x16x32_bf16 v[188:191], a[92:95], v[44:47], v[188:191]
v_mfma_f32_16x16x32_bf16 v[196:199], a[92:95], v[60:63], 0
s_waitcnt vmcnt(0)
v_cmp_gt_u32 vcc, 1, v230
v_mfma_f32_16x16x32_bf16 v[196:199], a[88:91], v[56:59], v[196:199]
s_waitcnt lgkmcnt(8)
v_mfma_f32_16x16x32_bf16 v[212:215], a[64:67], v[56:59], 0
ds_read_b64_tr_b16 a[88:89], v238 offset:18432
ds_read_b64_tr_b16 a[90:91], v238 offset:23040
v_mfma_f32_16x16x32_bf16 v[212:215], a[68:71], v[60:63], v[212:215]
s_bitcmp1_b32 vcc_lo, s39
s_cbranch_scc1 SP_O1A
SP_O1A_RET:
v_mfma_f32_16x16x32_bf16 v[208:211], a[68:71], v[44:47], 0
buffer_load_dwordx4 a[128:131], v244, s[20:23], s64 offen offset:0 sc0 sc1
v_mfma_f32_16x16x32_bf16 v[208:211], a[64:67], v[40:43], v[208:211]
v_mfma_f32_16x16x32_bf16 v[204:207], a[64:67], v[24:27], 0
ds_read_b64_tr_b16 a[92:93], v238 offset:27648
ds_read_b64_tr_b16 a[94:95], v238 offset:32256
v_mfma_f32_16x16x32_bf16 v[204:207], a[68:71], v[28:31], v[204:207]
v_mfma_f32_16x16x32_bf16 v[200:203], a[68:71], v[12:15], 0
buffer_load_dwordx4 a[144:147], v244, s[20:23], s65 offen offset:0 sc0 sc1
v_mfma_f32_16x16x32_bf16 v[200:203], a[64:67], v[8:11], v[200:203]
s_waitcnt lgkmcnt(8)
v_mfma_f32_16x16x32_bf16 v[72:75], a[72:75], v[16:19], v[72:75]
ds_read_b64_tr_b16 a[64:65], v238 offset:18440
ds_read_b64_tr_b16 a[66:67], v238 offset:23048
v_mfma_f32_16x16x32_bf16 v[72:75], a[76:79], v[20:23], v[72:75]
v_mfma_f32_16x16x32_bf16 v[80:83], a[76:79], v[36:39], v[80:83]
buffer_load_dwordx4 a[160:163], v244, s[20:23], s66 offen offset:0 sc0 sc1
v_mfma_f32_16x16x32_bf16 v[80:83], a[72:75], v[32:35], v[80:83]
v_mfma_f32_16x16x32_bf16 v[88:91], a[72:75], v[48:51], v[88:91]
ds_read_b64_tr_b16 a[68:69], v238 offset:27656
ds_read_b64_tr_b16 a[70:71], v238 offset:32264
v_mfma_f32_16x16x32_bf16 v[88:91], a[76:79], v[52:55], v[88:91]
v_mfma_f32_16x16x32_bf16 v[96:99], a[76:79], v[68:71], v[96:99]
buffer_load_dwordx4 a[176:179], v244, s[20:23], s67 offen offset:0 sc0 sc1
v_mfma_f32_16x16x32_bf16 v[96:99], a[72:75], v[64:67], v[96:99]
s_waitcnt lgkmcnt(8)
v_mfma_f32_16x16x32_bf16 v[100:103], a[80:83], v[64:67], v[100:103]
ds_read_b64_tr_b16 a[72:73], v237 offset:18560
ds_read_b64_tr_b16 a[74:75], v237 offset:23168
v_mfma_f32_16x16x32_bf16 v[100:103], a[84:87], v[68:71], v[100:103]
v_mfma_f32_16x16x32_bf16 v[92:95], a[84:87], v[52:55], v[92:95]
buffer_load_dwordx4 a[132:135], v244, s[20:23], s64 offen offset:1024 sc0 sc1
v_mfma_f32_16x16x32_bf16 v[92:95], a[80:83], v[48:51], v[92:95]
v_mfma_f32_16x16x32_bf16 v[84:87], a[80:83], v[32:35], v[84:87]
ds_read_b64_tr_b16 a[76:77], v237 offset:27776
ds_read_b64_tr_b16 a[78:79], v237 offset:32384
v_mfma_f32_16x16x32_bf16 v[84:87], a[84:87], v[36:39], v[84:87]
v_mfma_f32_16x16x32_bf16 v[76:79], a[84:87], v[20:23], v[76:79]
buffer_load_dwordx4 a[148:151], v244, s[20:23], s65 offen offset:1024 sc0 sc1
v_mfma_f32_16x16x32_bf16 v[76:79], a[80:83], v[16:19], v[76:79]
s_waitcnt lgkmcnt(8)
v_mfma_f32_16x16x32_bf16 v[104:107], a[88:91], v[16:19], v[104:107]
ds_read_b64_tr_b16 a[80:81], v237 offset:18568
ds_read_b64_tr_b16 a[82:83], v237 offset:23176
v_mfma_f32_16x16x32_bf16 v[104:107], a[92:95], v[20:23], v[104:107]
v_mfma_f32_16x16x32_bf16 v[112:115], a[92:95], v[36:39], v[112:115]
buffer_load_dwordx4 a[164:167], v244, s[20:23], s66 offen offset:1024 sc0 sc1
v_mfma_f32_16x16x32_bf16 v[112:115], a[88:91], v[32:35], v[112:115]
v_mfma_f32_16x16x32_bf16 v[120:123], a[88:91], v[48:51], v[120:123]
ds_read_b64_tr_b16 a[84:85], v237 offset:27784
ds_read_b64_tr_b16 a[86:87], v237 offset:32392
v_mfma_f32_16x16x32_bf16 v[120:123], a[92:95], v[52:55], v[120:123]
v_mfma_f32_16x16x32_bf16 v[128:131], a[92:95], v[68:71], v[128:131]
buffer_load_dwordx4 a[180:183], v244, s[20:23], s67 offen offset:1024 sc0 sc1
v_mfma_f32_16x16x32_bf16 v[128:131], a[88:91], v[64:67], v[128:131]
s_waitcnt lgkmcnt(8)
v_mfma_f32_16x16x32_bf16 v[132:135], a[64:67], v[64:67], v[132:135]
ds_read_b64_tr_b16 a[88:89], v238 offset:18560
ds_read_b64_tr_b16 a[90:91], v238 offset:23168
v_mfma_f32_16x16x32_bf16 v[132:135], a[68:71], v[68:71], v[132:135]
v_mfma_f32_16x16x32_bf16 v[124:127], a[68:71], v[52:55], v[124:127]
buffer_load_dwordx4 a[136:139], v244, s[20:23], s64 offen offset:2048 sc0 sc1
v_mfma_f32_16x16x32_bf16 v[124:127], a[64:67], v[48:51], v[124:127]
buffer_load_dword v230, v229, s[20:23], s94 offen sc0 sc1
v_mfma_f32_16x16x32_bf16 v[116:119], a[64:67], v[32:35], v[116:119]
ds_read_b64_tr_b16 a[92:93], v238 offset:27776
ds_read_b64_tr_b16 a[94:95], v238 offset:32384
v_mfma_f32_16x16x32_bf16 v[116:119], a[68:71], v[36:39], v[116:119]
v_mfma_f32_16x16x32_bf16 v[108:111], a[68:71], v[20:23], v[108:111]
v_mfma_f32_16x16x32_bf16 v[108:111], a[64:67], v[16:19], v[108:111]
buffer_load_dwordx4 a[152:155], v244, s[20:23], s65 offen offset:2048 sc0 sc1
s_waitcnt lgkmcnt(8)
v_mfma_f32_16x16x32_bf16 v[136:139], a[72:75], v[16:19], v[136:139]
ds_read_b64_tr_b16 a[64:65], v238 offset:18568
ds_read_b64_tr_b16 a[66:67], v238 offset:23176
v_mfma_f32_16x16x32_bf16 v[136:139], a[76:79], v[20:23], v[136:139]
v_mfma_f32_16x16x32_bf16 v[144:147], a[76:79], v[36:39], v[144:147]
v_mfma_f32_16x16x32_bf16 v[144:147], a[72:75], v[32:35], v[144:147]
buffer_load_dwordx4 a[168:171], v244, s[20:23], s66 offen offset:2048 sc0 sc1
v_mfma_f32_16x16x32_bf16 v[152:155], a[72:75], v[48:51], v[152:155]
ds_read_b64_tr_b16 a[68:69], v238 offset:27784
ds_read_b64_tr_b16 a[70:71], v238 offset:32392
v_mfma_f32_16x16x32_bf16 v[152:155], a[76:79], v[52:55], v[152:155]
v_mfma_f32_16x16x32_bf16 v[160:163], a[76:79], v[68:71], v[160:163]
v_mfma_f32_16x16x32_bf16 v[160:163], a[72:75], v[64:67], v[160:163]
buffer_load_dwordx4 a[184:187], v244, s[20:23], s67 offen offset:2048 sc0 sc1
s_waitcnt lgkmcnt(8)
v_mfma_f32_16x16x32_bf16 v[164:167], a[80:83], v[64:67], v[164:167]
ds_read_b64_tr_b16 a[72:73], v239 offset:18432
ds_read_b64_tr_b16 a[74:75], v239 offset:23040
v_mfma_f32_16x16x32_bf16 v[164:167], a[84:87], v[68:71], v[164:167]
v_mfma_f32_16x16x32_bf16 v[156:159], a[84:87], v[52:55], v[156:159]
v_mfma_f32_16x16x32_bf16 v[156:159], a[80:83], v[48:51], v[156:159]
buffer_load_dwordx4 a[140:143], v244, s[20:23], s64 offen offset:3072 sc0 sc1
v_mfma_f32_16x16x32_bf16 v[148:151], a[80:83], v[32:35], v[148:151]
ds_read_b64_tr_b16 a[76:77], v239 offset:27648
ds_read_b64_tr_b16 a[78:79], v239 offset:32256
v_mfma_f32_16x16x32_bf16 v[148:151], a[84:87], v[36:39], v[148:151]
v_mfma_f32_16x16x32_bf16 v[140:143], a[84:87], v[20:23], v[140:143]
v_mfma_f32_16x16x32_bf16 v[140:143], a[80:83], v[16:19], v[140:143]
buffer_load_dwordx4 a[156:159], v244, s[20:23], s65 offen offset:3072 sc0 sc1
s_waitcnt lgkmcnt(8)
v_mfma_f32_16x16x32_bf16 v[168:171], a[88:91], v[16:19], v[168:171]
ds_read_b64_tr_b16 a[80:81], v216 offset:0
ds_read_b64_tr_b16 a[82:83], v216 offset:4608
v_mfma_f32_16x16x32_bf16 v[168:171], a[92:95], v[20:23], v[168:171]
v_mfma_f32_16x16x32_bf16 v[176:179], a[92:95], v[36:39], v[176:179]
v_mfma_f32_16x16x32_bf16 v[176:179], a[88:91], v[32:35], v[176:179]
buffer_load_dwordx4 a[172:175], v244, s[20:23], s66 offen offset:3072 sc0 sc1
v_mfma_f32_16x16x32_bf16 v[184:187], a[88:91], v[48:51], v[184:187]
ds_read_b64_tr_b16 a[84:85], v216 offset:9216
ds_read_b64_tr_b16 a[86:87], v216 offset:13824
v_mfma_f32_16x16x32_bf16 v[184:187], a[92:95], v[52:55], v[184:187]
v_mfma_f32_16x16x32_bf16 v[192:195], a[92:95], v[68:71], v[192:195]
v_mfma_f32_16x16x32_bf16 v[192:195], a[88:91], v[64:67], v[192:195]
buffer_load_dwordx4 a[188:191], v244, s[20:23], s67 offen offset:3072 sc0 sc1
s_waitcnt lgkmcnt(8)
v_mfma_f32_16x16x32_bf16 v[196:199], a[64:67], v[64:67], v[196:199]
ds_read_b64_tr_b16 a[88:89], v216 offset:8
ds_read_b64_tr_b16 a[90:91], v216 offset:4616
v_mfma_f32_16x16x32_bf16 v[196:199], a[68:71], v[68:71], v[196:199]
s_add_u32 s28, s33, 2
s_and_b32 s28, s28, 3
v_mfma_f32_16x16x32_bf16 v[188:191], a[68:71], v[52:55], v[188:191]
s_sub_u32 s28, s28, s33
s_lshl_b32 s28, s28, 16
v_mfma_f32_16x16x32_bf16 v[188:191], a[64:67], v[48:51], v[188:191]
s_add_u32 s64, s28, s44
s_add_u32 s65, s64, 4096
v_mfma_f32_16x16x32_bf16 v[180:183], a[64:67], v[32:35], v[180:183]
ds_read_b64_tr_b16 a[92:93], v216 offset:9224
ds_read_b64_tr_b16 a[94:95], v216 offset:13832
v_mfma_f32_16x16x32_bf16 v[180:183], a[68:71], v[36:39], v[180:183]
s_add_u32 s66, s64, 8192
s_add_u32 s67, s64, 12288
v_mfma_f32_16x16x32_bf16 v[172:175], a[68:71], v[20:23], v[172:175]
s_waitcnt vmcnt(7)
v_cmp_gt_u32 vcc, 1, v230
v_mfma_f32_16x16x32_bf16 v[172:175], a[64:67], v[16:19], v[172:175]
s_waitcnt lgkmcnt(8)
v_mfma_f32_16x16x32_bf16 v[200:203], a[72:75], v[16:19], v[200:203]
ds_read_b64_tr_b16 a[64:65], v217 offset:0
ds_read_b64_tr_b16 a[66:67], v217 offset:4608
v_mfma_f32_16x16x32_bf16 v[200:203], a[76:79], v[20:23], v[200:203]
s_and_b32 s29, vcc_lo, 15
s_cbranch_scc1 SP_O2A
SP_O2A_RET:
v_mfma_f32_16x16x32_bf16 v[204:207], a[76:79], v[36:39], v[204:207]
buffer_load_dwordx4 a[192:195], v244, s[20:23], s64 offen offset:0 sc0 sc1
v_mfma_f32_16x16x32_bf16 v[204:207], a[72:75], v[32:35], v[204:207]
STUB_14:
STUB_B2:
s_cbranch_execz STUB_17
v_mfma_f32_16x16x32_bf16 v[208:211], a[72:75], v[48:51], v[208:211]
ds_read_b64_tr_b16 a[68:69], v217 offset:9216
ds_read_b64_tr_b16 a[70:71], v217 offset:13824
v_mfma_f32_16x16x32_bf16 v[208:211], a[76:79], v[52:55], v[208:211]
v_mfma_f32_16x16x32_bf16 v[212:215], a[76:79], v[68:71], v[212:215]
buffer_load_dwordx4 a[208:211], v244, s[20:23], s65 offen offset:0 sc0 sc1
v_mfma_f32_16x16x32_bf16 v[212:215], a[72:75], v[64:67], v[212:215]
s_waitcnt vmcnt(15)
s_waitcnt lgkmcnt(8)
v_mfma_f32_16x16x32_bf16 v[96:99], a[80:83], a[176:179], v[96:99]
ds_read_b64_tr_b16 a[72:73], v217 offset:8
ds_read_b64_tr_b16 a[74:75], v217 offset:4616
s_waitcnt vmcnt(11)
v_mfma_f32_16x16x32_bf16 v[96:99], a[84:87], a[180:183], v[96:99]
v_mfma_f32_16x16x32_bf16 v[88:91], a[84:87], a[164:167], v[88:91]
buffer_load_dwordx4 a[96:99], v244, s[20:23], s66 offen offset:0 sc0 sc1
v_mfma_f32_16x16x32_bf16 v[88:91], a[80:83], a[160:163], v[88:91]
v_accvgpr_read_b32 v39, a222
v_accvgpr_read_b32 v59, a232
v_mfma_f32_16x16x32_bf16 v[80:83], a[80:83], a[144:147], v[80:83]
ds_read_b64_tr_b16 a[76:77], v217 offset:9224
ds_read_b64_tr_b16 a[78:79], v217 offset:13832
v_mfma_f32_16x16x32_bf16 v[80:83], a[84:87], a[148:151], v[80:83]
v_lshlrev_b32 v38, 16, v39
v_and_b32 v39, 0xffff0000, v39
v_mfma_f32_16x16x32_bf16 v[72:75], a[84:87], a[132:135], v[72:75]
buffer_load_dwordx4 a[112:115], v244, s[20:23], s67 offen offset:0 sc0 sc1
v_mfma_f32_16x16x32_bf16 v[72:75], a[80:83], a[128:131], v[72:75]
v_lshlrev_b32 v58, 16, v59
v_and_b32 v59, 0xffff0000, v59
s_waitcnt lgkmcnt(8)
v_mfma_f32_16x16x32_bf16 v[76:79], a[88:91], a[128:131], v[76:79]
ds_read_b64_tr_b16 a[80:81], v216 offset:128
ds_read_b64_tr_b16 a[82:83], v216 offset:4736
v_mfma_f32_16x16x32_bf16 v[76:79], a[92:95], a[132:135], v[76:79]
v_add_f32 v38, v38, v58
v_add_f32 v39, v39, v59
v_mfma_f32_16x16x32_bf16 v[84:87], a[92:95], a[148:151], v[84:87]
buffer_load_dwordx4 a[196:199], v244, s[20:23], s64 offen offset:1024 sc0 sc1
v_mfma_f32_16x16x32_bf16 v[84:87], a[88:91], a[144:147], v[84:87]
v_cvt_pk_bf16_f32 v58, v38, v39
v_lshlrev_b32 v38, 16, v58
v_mfma_f32_16x16x32_bf16 v[92:95], a[88:91], a[160:163], v[92:95]
ds_read_b64_tr_b16 a[84:85], v216 offset:9344
ds_read_b64_tr_b16 a[86:87], v216 offset:13952
v_mfma_f32_16x16x32_bf16 v[92:95], a[92:95], a[164:167], v[92:95]
v_and_b32 v39, 0xffff0000, v58
v_mul_f32 v58, 0xbfb8aa3b, v38
v_mfma_f32_16x16x32_bf16 v[100:103], a[92:95], a[180:183], v[100:103]
buffer_load_dwordx4 a[244:247], v244, s[20:23], s65 offen offset:1024 sc0 sc1
v_mfma_f32_16x16x32_bf16 v[100:103], a[88:91], a[176:179], v[100:103]
v_mul_f32 v59, 0xbfb8aa3b, v39
s_waitcnt lgkmcnt(8)
v_mfma_f32_16x16x32_bf16 v[128:131], a[64:67], a[176:179], v[128:131]
ds_read_b64_tr_b16 a[88:89], v216 offset:136
ds_read_b64_tr_b16 a[90:91], v216 offset:4744
v_mfma_f32_16x16x32_bf16 v[128:131], a[68:71], a[180:183], v[128:131]
v_exp_f32 v58, v58
v_mfma_f32_16x16x32_bf16 v[120:123], a[68:71], a[164:167], v[120:123]
buffer_load_dwordx4 a[100:103], v244, s[20:23], s66 offen offset:1024 sc0 sc1
v_mfma_f32_16x16x32_bf16 v[120:123], a[64:67], a[160:163], v[120:123]
v_exp_f32 v59, v59
v_mfma_f32_16x16x32_bf16 v[112:115], a[64:67], a[144:147], v[112:115]
ds_read_b64_tr_b16 a[92:93], v216 offset:9352
ds_read_b64_tr_b16 a[94:95], v216 offset:13960
v_mfma_f32_16x16x32_bf16 v[112:115], a[68:71], a[148:151], v[112:115]
v_add_f32 v58, 1.0, v58
v_add_f32 v59, 1.0, v59
v_mfma_f32_16x16x32_bf16 v[104:107], a[68:71], a[132:135], v[104:107]
buffer_load_dwordx4 a[116:119], v244, s[20:23], s67 offen offset:1024 sc0 sc1
v_mfma_f32_16x16x32_bf16 v[104:107], a[64:67], a[128:131], v[104:107]
v_rcp_f32 v58, v58
s_waitcnt lgkmcnt(8)
v_mfma_f32_16x16x32_bf16 v[108:111], a[72:75], a[128:131], v[108:111]
ds_read_b64_tr_b16 a[64:65], v217 offset:128
ds_read_b64_tr_b16 a[66:67], v217 offset:4736
v_mfma_f32_16x16x32_bf16 v[108:111], a[76:79], a[132:135], v[108:111]
v_rcp_f32 v59, v59
v_mfma_f32_16x16x32_bf16 v[116:119], a[76:79], a[148:151], v[116:119]
buffer_load_dwordx4 a[200:203], v244, s[20:23], s64 offen offset:2048 sc0 sc1
v_mfma_f32_16x16x32_bf16 v[116:119], a[72:75], a[144:147], v[116:119]
v_mul_f32 v38, v38, v58
v_mul_f32 v39, v39, v59
v_mfma_f32_16x16x32_bf16 v[124:127], a[72:75], a[160:163], v[124:127]
ds_read_b64_tr_b16 a[68:69], v217 offset:9344
ds_read_b64_tr_b16 a[70:71], v217 offset:13952
v_mfma_f32_16x16x32_bf16 v[124:127], a[76:79], a[164:167], v[124:127]
v_cvt_pk_bf16_f32 v58, v38, v39
v_lshlrev_b32 v38, 16, v58
v_mfma_f32_16x16x32_bf16 v[132:135], a[76:79], a[180:183], v[132:135]
buffer_load_dwordx4 a[248:251], v244, s[20:23], s65 offen offset:2048 sc0 sc1
v_mfma_f32_16x16x32_bf16 v[132:135], a[72:75], a[176:179], v[132:135]
v_and_b32 v39, 0xffff0000, v58
v_accvgpr_read_b32 v41, a223
s_waitcnt lgkmcnt(8)
v_mfma_f32_16x16x32_bf16 v[160:163], a[80:83], a[176:179], v[160:163]
ds_read_b64_tr_b16 a[72:73], v217 offset:136
ds_read_b64_tr_b16 a[74:75], v217 offset:4744
v_mfma_f32_16x16x32_bf16 v[160:163], a[84:87], a[180:183], v[160:163]
v_accvgpr_read_b32 v59, a233
v_lshlrev_b32 v40, 16, v41
v_mfma_f32_16x16x32_bf16 v[152:155], a[84:87], a[164:167], v[152:155]
buffer_load_dwordx4 a[104:107], v244, s[20:23], s66 offen offset:2048 sc0 sc1
v_mfma_f32_16x16x32_bf16 v[152:155], a[80:83], a[160:163], v[152:155]
v_and_b32 v41, 0xffff0000, v41
v_lshlrev_b32 v58, 16, v59
v_mfma_f32_16x16x32_bf16 v[144:147], a[80:83], a[144:147], v[144:147]
ds_read_b64_tr_b16 a[76:77], v217 offset:9352
ds_read_b64_tr_b16 a[78:79], v217 offset:13960
v_mfma_f32_16x16x32_bf16 v[144:147], a[84:87], a[148:151], v[144:147]
v_and_b32 v59, 0xffff0000, v59
v_add_f32 v40, v40, v58
v_mfma_f32_16x16x32_bf16 v[136:139], a[84:87], a[132:135], v[136:139]
buffer_load_dwordx4 a[120:123], v244, s[20:23], s67 offen offset:2048 sc0 sc1
v_mfma_f32_16x16x32_bf16 v[136:139], a[80:83], a[128:131], v[136:139]
v_add_f32 v41, v41, v59
v_cvt_pk_bf16_f32 v58, v40, v41
s_waitcnt lgkmcnt(8)
v_mfma_f32_16x16x32_bf16 v[140:143], a[88:91], a[128:131], v[140:143]
ds_read_b64_tr_b16 a[80:81], v218 offset:0
ds_read_b64_tr_b16 a[82:83], v218 offset:4608
v_mfma_f32_16x16x32_bf16 v[140:143], a[92:95], a[132:135], v[140:143]
v_lshlrev_b32 v40, 16, v58
v_and_b32 v41, 0xffff0000, v58
v_mfma_f32_16x16x32_bf16 v[148:151], a[92:95], a[148:151], v[148:151]
buffer_load_dwordx4 a[204:207], v244, s[20:23], s64 offen offset:3072 sc0 sc1
v_mfma_f32_16x16x32_bf16 v[148:151], a[88:91], a[144:147], v[148:151]
v_mul_f32 v58, 0xbfb8aa3b, v40
v_mul_f32 v59, 0xbfb8aa3b, v41
v_mfma_f32_16x16x32_bf16 v[156:159], a[88:91], a[160:163], v[156:159]
ds_read_b64_tr_b16 a[84:85], v218 offset:9216
ds_read_b64_tr_b16 a[86:87], v218 offset:13824
v_mfma_f32_16x16x32_bf16 v[156:159], a[92:95], a[164:167], v[156:159]
v_exp_f32 v58, v58
v_mfma_f32_16x16x32_bf16 v[164:167], a[92:95], a[180:183], v[164:167]
buffer_load_dwordx4 a[252:255], v244, s[20:23], s65 offen offset:3072 sc0 sc1
v_mfma_f32_16x16x32_bf16 v[164:167], a[88:91], a[176:179], v[164:167]
v_exp_f32 v59, v59
s_waitcnt lgkmcnt(8)
v_mfma_f32_16x16x32_bf16 v[192:195], a[64:67], a[176:179], v[192:195]
ds_read_b64_tr_b16 a[88:89], v216 offset:18432
ds_read_b64_tr_b16 a[90:91], v216 offset:23040
v_mfma_f32_16x16x32_bf16 v[192:195], a[68:71], a[180:183], v[192:195]
v_add_f32 v58, 1.0, v58
v_add_f32 v59, 1.0, v59
v_mfma_f32_16x16x32_bf16 v[184:187], a[68:71], a[164:167], v[184:187]
buffer_load_dwordx4 a[108:111], v244, s[20:23], s66 offen offset:3072 sc0 sc1
v_mfma_f32_16x16x32_bf16 v[184:187], a[64:67], a[160:163], v[184:187]
v_rcp_f32 v58, v58
v_mfma_f32_16x16x32_bf16 v[176:179], a[64:67], a[144:147], v[176:179]
ds_read_b64_tr_b16 a[92:93], v216 offset:27648
ds_read_b64_tr_b16 a[94:95], v216 offset:32256
v_mfma_f32_16x16x32_bf16 v[176:179], a[68:71], a[148:151], v[176:179]
v_rcp_f32 v59, v59
v_mfma_f32_16x16x32_bf16 v[168:171], a[68:71], a[132:135], v[168:171]
buffer_load_dwordx4 a[124:127], v244, s[20:23], s67 offen offset:3072 sc0 sc1
v_mfma_f32_16x16x32_bf16 v[168:171], a[64:67], a[128:131], v[168:171]
s_add_u32 s28, s33, 3
s_and_b32 s28, s28, 3
s_waitcnt lgkmcnt(8)
v_mfma_f32_16x16x32_bf16 v[172:175], a[72:75], a[128:131], v[172:175]
ds_read_b64_tr_b16 a[64:65], v216 offset:18440
ds_read_b64_tr_b16 a[66:67], v216 offset:23048
v_mfma_f32_16x16x32_bf16 v[172:175], a[76:79], a[132:135], v[172:175]
s_sub_u32 s28, s28, s33
s_lshl_b32 s28, s28, 16
v_mfma_f32_16x16x32_bf16 v[180:183], a[76:79], a[148:151], v[180:183]
s_add_u32 s64, s28, s44
s_add_u32 s65, s64, 4096
v_mfma_f32_16x16x32_bf16 v[180:183], a[72:75], a[144:147], v[180:183]
s_add_u32 s66, s64, 8192
s_add_u32 s67, s64, 12288
v_mfma_f32_16x16x32_bf16 v[188:191], a[72:75], a[160:163], v[188:191]
ds_read_b64_tr_b16 a[68:69], v216 offset:27656
ds_read_b64_tr_b16 a[70:71], v216 offset:32264
v_mfma_f32_16x16x32_bf16 v[188:191], a[76:79], a[164:167], v[188:191]
buffer_load_dwordx4 a[0:3], v244, s[20:23], s64 offen offset:0 sc0 sc1
v_mfma_f32_16x16x32_bf16 v[196:199], a[76:79], a[180:183], v[196:199]
v_mul_f32 v40, v40, v58
v_mul_f32 v41, v41, v59
v_mfma_f32_16x16x32_bf16 v[196:199], a[72:75], a[176:179], v[196:199]
v_cvt_pk_bf16_f32 v58, v40, v41
v_lshlrev_b32 v40, 16, v58
s_waitcnt lgkmcnt(8)
v_mfma_f32_16x16x32_bf16 v[212:215], a[80:83], a[176:179], v[212:215]
ds_read_b64_tr_b16 a[72:73], v217 offset:18432
ds_read_b64_tr_b16 a[74:75], v217 offset:23040
v_mfma_f32_16x16x32_bf16 v[212:215], a[84:87], a[180:183], v[212:215]
buffer_load_dwordx4 a[16:19], v244, s[20:23], s65 offen offset:0 sc0 sc1
v_mfma_f32_16x16x32_bf16 v[208:211], a[84:87], a[164:167], v[208:211]
v_and_b32 v41, 0xffff0000, v58
v_accvgpr_read_b32 v43, a224
v_mfma_f32_16x16x32_bf16 v[208:211], a[80:83], a[160:163], v[208:211]
v_accvgpr_read_b32 v59, a234
v_lshlrev_b32 v42, 16, v43
v_mfma_f32_16x16x32_bf16 v[204:207], a[80:83], a[144:147], v[204:207]
ds_read_b64_tr_b16 a[76:77], v217 offset:27648
ds_read_b64_tr_b16 a[78:79], v217 offset:32256
v_mfma_f32_16x16x32_bf16 v[204:207], a[84:87], a[148:151], v[204:207]
buffer_load_dwordx4 a[32:35], v244, s[20:23], s66 offen offset:0 sc0 sc1
v_mfma_f32_16x16x32_bf16 v[200:203], a[84:87], a[132:135], v[200:203]
v_and_b32 v43, 0xffff0000, v43
v_lshlrev_b32 v58, 16, v59
v_mfma_f32_16x16x32_bf16 v[200:203], a[80:83], a[128:131], v[200:203]
v_and_b32 v59, 0xffff0000, v59
v_add_f32 v42, v42, v58
s_waitcnt vmcnt(23)
s_waitcnt lgkmcnt(8)
v_mfma_f32_16x16x32_bf16 v[72:75], a[88:91], a[136:139], v[72:75]
ds_read_b64_tr_b16 a[80:81], v217 offset:18440
ds_read_b64_tr_b16 a[82:83], v217 offset:23048
s_waitcnt vmcnt(19)
v_mfma_f32_16x16x32_bf16 v[72:75], a[92:95], a[140:143], v[72:75]
buffer_load_dwordx4 a[48:51], v244, s[20:23], s67 offen offset:0 sc0 sc1
v_mfma_f32_16x16x32_bf16 v[80:83], a[92:95], a[156:159], v[80:83]
v_add_f32 v43, v43, v59
v_cvt_pk_bf16_f32 v58, v42, v43
v_mfma_f32_16x16x32_bf16 v[80:83], a[88:91], a[152:155], v[80:83]
v_lshlrev_b32 v42, 16, v58
v_and_b32 v43, 0xffff0000, v58
v_mfma_f32_16x16x32_bf16 v[88:91], a[88:91], a[168:171], v[88:91]
ds_read_b64_tr_b16 a[84:85], v217 offset:27656
ds_read_b64_tr_b16 a[86:87], v217 offset:32264
v_mfma_f32_16x16x32_bf16 v[88:91], a[92:95], a[172:175], v[88:91]
buffer_load_dwordx4 a[4:7], v244, s[20:23], s64 offen offset:1024 sc0 sc1
v_mfma_f32_16x16x32_bf16 v[96:99], a[92:95], a[188:191], v[96:99]
v_mul_f32 v58, 0xbfb8aa3b, v42
v_mul_f32 v59, 0xbfb8aa3b, v43
v_mfma_f32_16x16x32_bf16 v[96:99], a[88:91], a[184:187], v[96:99]
v_exp_f32 v58, v58
s_waitcnt lgkmcnt(8)
v_mfma_f32_16x16x32_bf16 v[100:103], a[64:67], a[184:187], v[100:103]
ds_read_b64_tr_b16 a[88:89], v216 offset:18560
ds_read_b64_tr_b16 a[90:91], v216 offset:23168
v_mfma_f32_16x16x32_bf16 v[100:103], a[68:71], a[188:191], v[100:103]
buffer_load_dwordx4 a[20:23], v244, s[20:23], s65 offen offset:1024 sc0 sc1
v_mfma_f32_16x16x32_bf16 v[92:95], a[68:71], a[172:175], v[92:95]
v_exp_f32 v59, v59
v_mfma_f32_16x16x32_bf16 v[92:95], a[64:67], a[168:171], v[92:95]
v_add_f32 v58, 1.0, v58
v_add_f32 v59, 1.0, v59
v_mfma_f32_16x16x32_bf16 v[84:87], a[64:67], a[152:155], v[84:87]
ds_read_b64_tr_b16 a[92:93], v216 offset:27776
ds_read_b64_tr_b16 a[94:95], v216 offset:32384
v_mfma_f32_16x16x32_bf16 v[84:87], a[68:71], a[156:159], v[84:87]
buffer_load_dwordx4 a[36:39], v244, s[20:23], s66 offen offset:1024 sc0 sc1
v_mfma_f32_16x16x32_bf16 v[76:79], a[68:71], a[140:143], v[76:79]
v_rcp_f32 v58, v58
v_mfma_f32_16x16x32_bf16 v[76:79], a[64:67], a[136:139], v[76:79]
v_rcp_f32 v59, v59
s_waitcnt lgkmcnt(8)
v_mfma_f32_16x16x32_bf16 v[104:107], a[72:75], a[136:139], v[104:107]
ds_read_b64_tr_b16 a[64:65], v216 offset:18568
ds_read_b64_tr_b16 a[66:67], v216 offset:23176
v_mfma_f32_16x16x32_bf16 v[104:107], a[76:79], a[140:143], v[104:107]
buffer_load_dwordx4 a[52:55], v244, s[20:23], s67 offen offset:1024 sc0 sc1
v_mfma_f32_16x16x32_bf16 v[112:115], a[76:79], a[156:159], v[112:115]
v_mul_f32 v42, v42, v58
v_mul_f32 v43, v43, v59
v_mfma_f32_16x16x32_bf16 v[112:115], a[72:75], a[152:155], v[112:115]
v_cvt_pk_bf16_f32 v58, v42, v43
v_lshlrev_b32 v42, 16, v58
v_mfma_f32_16x16x32_bf16 v[120:123], a[72:75], a[168:171], v[120:123]
ds_read_b64_tr_b16 a[68:69], v216 offset:27784
ds_read_b64_tr_b16 a[70:71], v216 offset:32392
v_mfma_f32_16x16x32_bf16 v[120:123], a[76:79], a[172:175], v[120:123]
buffer_load_dwordx4 a[8:11], v244, s[20:23], s64 offen offset:2048 sc0 sc1
v_mfma_f32_16x16x32_bf16 v[128:131], a[76:79], a[188:191], v[128:131]
v_and_b32 v43, 0xffff0000, v58
v_accvgpr_read_b32 v45, a225
v_mfma_f32_16x16x32_bf16 v[128:131], a[72:75], a[184:187], v[128:131]
v_accvgpr_read_b32 v59, a235
v_lshlrev_b32 v44, 16, v45
s_waitcnt lgkmcnt(8)
v_mfma_f32_16x16x32_bf16 v[132:135], a[80:83], a[184:187], v[132:135]
ds_read_b64_tr_b16 a[72:73], v217 offset:18560
ds_read_b64_tr_b16 a[74:75], v217 offset:23168
v_mfma_f32_16x16x32_bf16 v[132:135], a[84:87], a[188:191], v[132:135]
buffer_load_dwordx4 a[24:27], v244, s[20:23], s65 offen offset:2048 sc0 sc1
v_mfma_f32_16x16x32_bf16 v[124:127], a[84:87], a[172:175], v[124:127]
v_and_b32 v45, 0xffff0000, v45
v_lshlrev_b32 v58, 16, v59
v_mfma_f32_16x16x32_bf16 v[124:127], a[80:83], a[168:171], v[124:127]
v_and_b32 v59, 0xffff0000, v59
v_add_f32 v44, v44, v58
v_mfma_f32_16x16x32_bf16 v[116:119], a[80:83], a[152:155], v[116:119]
ds_read_b64_tr_b16 a[76:77], v217 offset:27776
ds_read_b64_tr_b16 a[78:79], v217 offset:32384
v_mfma_f32_16x16x32_bf16 v[116:119], a[84:87], a[156:159], v[116:119]
buffer_load_dwordx4 a[40:43], v244, s[20:23], s66 offen offset:2048 sc0 sc1
v_mfma_f32_16x16x32_bf16 v[108:111], a[84:87], a[140:143], v[108:111]
v_add_f32 v45, v45, v59
v_cvt_pk_bf16_f32 v58, v44, v45
v_mfma_f32_16x16x32_bf16 v[108:111], a[80:83], a[136:139], v[108:111]
v_lshlrev_b32 v44, 16, v58
v_and_b32 v45, 0xffff0000, v58
s_waitcnt lgkmcnt(8)
v_mfma_f32_16x16x32_bf16 v[136:139], a[88:91], a[136:139], v[136:139]
ds_read_b64_tr_b16 a[80:81], v217 offset:18568
ds_read_b64_tr_b16 a[82:83], v217 offset:23176
v_mfma_f32_16x16x32_bf16 v[136:139], a[92:95], a[140:143], v[136:139]
buffer_load_dwordx4 a[56:59], v244, s[20:23], s67 offen offset:2048 sc0 sc1
v_mfma_f32_16x16x32_bf16 v[144:147], a[92:95], a[156:159], v[144:147]
v_mul_f32 v58, 0xbfb8aa3b, v44
v_mul_f32 v59, 0xbfb8aa3b, v45
v_mfma_f32_16x16x32_bf16 v[144:147], a[88:91], a[152:155], v[144:147]
v_exp_f32 v58, v58
v_mfma_f32_16x16x32_bf16 v[152:155], a[88:91], a[168:171], v[152:155]
ds_read_b64_tr_b16 a[84:85], v217 offset:27784
ds_read_b64_tr_b16 a[86:87], v217 offset:32392
v_mfma_f32_16x16x32_bf16 v[152:155], a[92:95], a[172:175], v[152:155]
buffer_load_dwordx4 a[12:15], v244, s[20:23], s64 offen offset:3072 sc0 sc1
v_mfma_f32_16x16x32_bf16 v[160:163], a[92:95], a[188:191], v[160:163]
v_exp_f32 v59, v59
v_mfma_f32_16x16x32_bf16 v[160:163], a[88:91], a[184:187], v[160:163]
v_add_f32 v58, 1.0, v58
v_add_f32 v59, 1.0, v59
s_waitcnt lgkmcnt(8)
v_mfma_f32_16x16x32_bf16 v[164:167], a[64:67], a[184:187], v[164:167]
ds_read_b64_tr_b16 a[88:89], v218 offset:18432
ds_read_b64_tr_b16 a[90:91], v218 offset:23040
v_mfma_f32_16x16x32_bf16 v[164:167], a[68:71], a[188:191], v[164:167]
buffer_load_dwordx4 a[28:31], v244, s[20:23], s65 offen offset:3072 sc0 sc1
v_mfma_f32_16x16x32_bf16 v[156:159], a[68:71], a[172:175], v[156:159]
v_rcp_f32 v58, v58
v_mfma_f32_16x16x32_bf16 v[156:159], a[64:67], a[168:171], v[156:159]
v_rcp_f32 v59, v59
v_mfma_f32_16x16x32_bf16 v[148:151], a[64:67], a[152:155], v[148:151]
ds_read_b64_tr_b16 a[92:93], v218 offset:27648
ds_read_b64_tr_b16 a[94:95], v218 offset:32256
v_mfma_f32_16x16x32_bf16 v[148:151], a[68:71], a[156:159], v[148:151]
buffer_load_dwordx4 a[44:47], v244, s[20:23], s66 offen offset:3072 sc0 sc1
v_mfma_f32_16x16x32_bf16 v[140:143], a[68:71], a[140:143], v[140:143]
v_mul_f32 v44, v44, v58
v_mul_f32 v45, v45, v59
v_mfma_f32_16x16x32_bf16 v[140:143], a[64:67], a[136:139], v[140:143]
v_cvt_pk_bf16_f32 v58, v44, v45
v_lshlrev_b32 v44, 16, v58
s_waitcnt lgkmcnt(8)
v_mfma_f32_16x16x32_bf16 v[168:171], a[72:75], a[136:139], v[168:171]
ds_read_b64_tr_b16 a[64:65], v221 offset:0
ds_read_b64_tr_b16 a[66:67], v221 offset:4608
v_mfma_f32_16x16x32_bf16 v[168:171], a[76:79], a[140:143], v[168:171]
buffer_load_dwordx4 a[60:63], v244, s[20:23], s67 offen offset:3072 sc0 sc1
v_mfma_f32_16x16x32_bf16 v[176:179], a[76:79], a[156:159], v[176:179]
s_lshl2_add_u32 s28, s36, s33
s_lshl2_add_u32 s28, s28, s37
v_mfma_f32_16x16x32_bf16 v[176:179], a[72:75], a[152:155], v[176:179]
s_lshl_b32 s95, s28, 5
s_add_u32 s95, s95, 0x24a000
v_mfma_f32_16x16x32_bf16 v[184:187], a[72:75], a[168:171], v[184:187]
ds_read_b64_tr_b16 a[68:69], v221 offset:9216
ds_read_b64_tr_b16 a[70:71], v221 offset:13824
v_mfma_f32_16x16x32_bf16 v[184:187], a[76:79], a[172:175], v[184:187]
s_lshl_b32 s28, s32, 18
s_sub_u32 s49, s44, s28
v_mfma_f32_16x16x32_bf16 v[192:195], a[76:79], a[188:191], v[192:195]
v_add_u32 v243, 0x2000, v244
v_mov_b32 v246, 2
v_mfma_f32_16x16x32_bf16 v[192:195], a[72:75], a[184:187], v[192:195]
s_lshl2_add_u32 s29, s33, s94
v_and_b32 v45, 0xffff0000, v58
s_waitcnt lgkmcnt(8)
v_mfma_f32_16x16x32_bf16 v[196:199], a[80:83], a[184:187], v[196:199]
ds_read_b64_tr_b16 a[72:73], v221 offset:18432
ds_read_b64_tr_b16 a[74:75], v221 offset:23040
v_mfma_f32_16x16x32_bf16 v[196:199], a[84:87], a[188:191], v[196:199]
v_accvgpr_read_b32 v47, a226
v_accvgpr_read_b32 v59, a236
v_mfma_f32_16x16x32_bf16 v[188:191], a[84:87], a[172:175], v[188:191]
v_lshlrev_b32 v46, 16, v47
v_and_b32 v47, 0xffff0000, v47
v_mfma_f32_16x16x32_bf16 v[188:191], a[80:83], a[168:171], v[188:191]
v_lshlrev_b32 v58, 16, v59
v_and_b32 v59, 0xffff0000, v59
v_mfma_f32_16x16x32_bf16 v[180:183], a[80:83], a[152:155], v[180:183]
ds_read_b64_tr_b16 a[76:77], v221 offset:27648
ds_read_b64_tr_b16 a[78:79], v221 offset:32256
v_mfma_f32_16x16x32_bf16 v[180:183], a[84:87], a[156:159], v[180:183]
v_add_f32 v46, v46, v58
v_add_f32 v47, v47, v59
v_mfma_f32_16x16x32_bf16 v[172:175], a[84:87], a[140:143], v[172:175]
v_cvt_pk_bf16_f32 v58, v46, v47
v_lshlrev_b32 v46, 16, v58
v_mfma_f32_16x16x32_bf16 v[172:175], a[80:83], a[136:139], v[172:175]
v_and_b32 v47, 0xffff0000, v58
v_mul_f32 v58, 0xbfb8aa3b, v46
s_waitcnt lgkmcnt(8)
v_mfma_f32_16x16x32_bf16 v[200:203], a[88:91], a[136:139], v[200:203]
ds_read_b64_tr_b16 a[80:81], v224 offset:0
ds_read_b64_tr_b16 a[82:83], v224 offset:4608
v_mfma_f32_16x16x32_bf16 v[200:203], a[92:95], a[140:143], v[200:203]
v_mul_f32 v59, 0xbfb8aa3b, v47
v_mfma_f32_16x16x32_bf16 v[204:207], a[92:95], a[156:159], v[204:207]
v_exp_f32 v58, v58
v_mfma_f32_16x16x32_bf16 v[204:207], a[88:91], a[152:155], v[204:207]
v_exp_f32 v59, v59
v_mfma_f32_16x16x32_bf16 v[208:211], a[88:91], a[168:171], v[208:211]
ds_read_b64_tr_b16 a[84:85], v224 offset:9216
ds_read_b64_tr_b16 a[86:87], v224 offset:13824
v_mfma_f32_16x16x32_bf16 v[208:211], a[92:95], a[172:175], v[208:211]
v_add_f32 v58, 1.0, v58
v_add_f32 v59, 1.0, v59
v_mfma_f32_16x16x32_bf16 v[212:215], a[92:95], a[188:191], v[212:215]
v_rcp_f32 v58, v58
v_mfma_f32_16x16x32_bf16 v[212:215], a[88:91], a[184:187], v[212:215]
v_rcp_f32 v59, v59
s_waitcnt vmcnt(28)
s_waitcnt lgkmcnt(8)
v_mfma_f32_16x16x32_bf16 v[212:215], a[64:67], a[112:115], v[212:215]
ds_read_b64_tr_b16 a[88:89], v224 offset:18432
ds_read_b64_tr_b16 a[90:91], v224 offset:23040
s_waitcnt vmcnt(24)
v_mfma_f32_16x16x32_bf16 v[212:215], a[68:71], a[116:119], v[212:215]
v_mul_f32 v46, v46, v58
v_mul_f32 v47, v47, v59
v_mfma_f32_16x16x32_bf16 v[208:211], a[68:71], a[100:103], v[208:211]
v_cvt_pk_bf16_f32 v58, v46, v47
v_lshlrev_b32 v46, 16, v58
v_mfma_f32_16x16x32_bf16 v[208:211], a[64:67], a[96:99], v[208:211]
v_and_b32 v47, 0xffff0000, v58
v_accvgpr_read_b32 v49, a227
v_mfma_f32_16x16x32_bf16 v[204:207], a[64:67], a[208:211], v[204:207]
ds_read_b64_tr_b16 a[92:93], v224 offset:27648
ds_read_b64_tr_b16 a[94:95], v224 offset:32256
v_mfma_f32_16x16x32_bf16 v[204:207], a[68:71], a[244:247], v[204:207]
v_accvgpr_read_b32 v59, a237
v_lshlrev_b32 v48, 16, v49
v_mfma_f32_16x16x32_bf16 v[200:203], a[68:71], a[196:199], v[200:203]
v_and_b32 v49, 0xffff0000, v49
v_lshlrev_b32 v58, 16, v59
v_mfma_f32_16x16x32_bf16 v[200:203], a[64:67], a[192:195], v[200:203]
s_waitcnt vmcnt(0)
buffer_store_dword v246, v254, s[20:23], s29 offen
s_waitcnt vmcnt(21)
s_waitcnt lgkmcnt(8)
v_mfma_f32_16x16x32_bf16 v[200:203], a[72:75], a[200:203], v[200:203]
ds_read_b64_tr_b16 a[64:65], v219 offset:0
ds_read_b64_tr_b16 a[66:67], v219 offset:4608
s_waitcnt vmcnt(17)
v_mfma_f32_16x16x32_bf16 v[200:203], a[76:79], a[204:207], v[200:203]
s_add_u32 s28, s32, 0
s_and_b32 s28, s28, 7
v_mfma_f32_16x16x32_bf16 v[204:207], a[76:79], a[252:255], v[204:207]
s_xor_b32 s29, s28, s32
s_lshl_b32 s28, s28, 18
v_mfma_f32_16x16x32_bf16 v[204:207], a[72:75], a[248:251], v[204:207]
s_add_u32 s28, s28, s49
s_and_b32 s29, s29, 4
v_mfma_f32_16x16x32_bf16 v[208:211], a[72:75], a[104:107], v[208:211]
ds_read_b64_tr_b16 a[68:69], v219 offset:9216
ds_read_b64_tr_b16 a[70:71], v219 offset:13824
v_mfma_f32_16x16x32_bf16 v[208:211], a[76:79], a[108:111], v[208:211]
s_add_u32 s72, s28, 0
s_lshl_b32 s29, s29, 10
v_mfma_f32_16x16x32_bf16 v[212:215], a[76:79], a[124:127], v[212:215]
s_add_u32 s28, s32, 1
s_and_b32 s28, s28, 7
v_mfma_f32_16x16x32_bf16 v[212:215], a[72:75], a[120:123], v[212:215]
s_xor_b32 s29, s28, s32
s_lshl_b32 s28, s28, 18
s_waitcnt vmcnt(13)
s_waitcnt lgkmcnt(8)
v_mfma_f32_16x16x32_bf16 v[212:215], a[80:83], a[48:51], v[212:215]
ds_read_b64_tr_b16 a[72:73], v219 offset:18432
ds_read_b64_tr_b16 a[74:75], v219 offset:23040
s_waitcnt vmcnt(9)
v_mfma_f32_16x16x32_bf16 v[212:215], a[84:87], a[52:55], v[212:215]
s_add_u32 s28, s28, s49
s_and_b32 s29, s29, 4
v_mfma_f32_16x16x32_bf16 v[208:211], a[84:87], a[36:39], v[208:211]
s_add_u32 s73, s28, 8192
s_lshl_b32 s29, s29, 10
v_mfma_f32_16x16x32_bf16 v[208:211], a[80:83], a[32:35], v[208:211]
s_add_u32 s65, s28, s29
v_and_b32 v59, 0xffff0000, v59
v_mfma_f32_16x16x32_bf16 v[204:207], a[80:83], a[16:19], v[204:207]
ds_read_b64_tr_b16 a[76:77], v219 offset:27648
ds_read_b64_tr_b16 a[78:79], v219 offset:32256
v_mfma_f32_16x16x32_bf16 v[204:207], a[84:87], a[20:23], v[204:207]
s_add_u32 s28, s32, 2
s_and_b32 s28, s28, 7
v_mfma_f32_16x16x32_bf16 v[200:203], a[84:87], a[4:7], v[200:203]
s_xor_b32 s29, s28, s32
s_lshl_b32 s28, s28, 18
v_mfma_f32_16x16x32_bf16 v[200:203], a[80:83], a[0:3], v[200:203]
s_add_u32 s28, s28, s49
s_and_b32 s29, s29, 4
s_waitcnt vmcnt(5)
s_waitcnt lgkmcnt(8)
v_mfma_f32_16x16x32_bf16 v[200:203], a[88:91], a[8:11], v[200:203]
ds_read_b64_tr_b16 a[80:81], v222 offset:0
ds_read_b64_tr_b16 a[82:83], v222 offset:4608
s_waitcnt vmcnt(1)
v_mfma_f32_16x16x32_bf16 v[200:203], a[92:95], a[12:15], v[200:203]
s_add_u32 s74, s28, 8192
s_lshl_b32 s29, s29, 10
v_mfma_f32_16x16x32_bf16 v[204:207], a[92:95], a[28:31], v[204:207]
s_add_u32 s66, s28, s29
v_add_f32 v48, v48, v58
v_mfma_f32_16x16x32_bf16 v[204:207], a[88:91], a[24:27], v[204:207]
s_add_u32 s28, s32, 3
s_and_b32 s28, s28, 7
v_mfma_f32_16x16x32_bf16 v[208:211], a[88:91], a[40:43], v[208:211]
ds_read_b64_tr_b16 a[84:85], v222 offset:9216
ds_read_b64_tr_b16 a[86:87], v222 offset:13824
v_mfma_f32_16x16x32_bf16 v[208:211], a[92:95], a[44:47], v[208:211]
s_xor_b32 s29, s28, s32
s_lshl_b32 s28, s28, 18
v_mfma_f32_16x16x32_bf16 v[212:215], a[92:95], a[60:63], v[212:215]
s_add_u32 s28, s28, s49
s_and_b32 s29, s29, 4
v_mfma_f32_16x16x32_bf16 v[212:215], a[88:91], a[56:59], v[212:215]
s_add_u32 s75, s28, 0
s_lshl_b32 s29, s29, 10
s_waitcnt lgkmcnt(8)
v_mfma_f32_16x16x32_bf16 v[96:99], a[64:67], a[112:115], v[96:99]
ds_read_b64_tr_b16 a[88:89], v222 offset:18432
ds_read_b64_tr_b16 a[90:91], v222 offset:23040
v_mfma_f32_16x16x32_bf16 v[96:99], a[68:71], a[116:119], v[96:99]
s_add_u32 s67, s28, s29
v_add_f32 v49, v49, v59
v_mfma_f32_16x16x32_bf16 v[88:91], a[68:71], a[100:103], v[88:91]
buffer_load_dword v230, v229, s[20:23], s94 offen sc0 sc1
v_mfma_f32_16x16x32_bf16 v[88:91], a[64:67], a[96:99], v[88:91]
s_add_u32 s28, s32, 4
s_and_b32 s28, s28, 7
v_mfma_f32_16x16x32_bf16 v[80:83], a[64:67], a[208:211], v[80:83]
ds_read_b64_tr_b16 a[92:93], v222 offset:27648
ds_read_b64_tr_b16 a[94:95], v222 offset:32256
v_mfma_f32_16x16x32_bf16 v[80:83], a[68:71], a[244:247], v[80:83]
s_xor_b32 s29, s28, s32
s_lshl_b32 s28, s28, 18
v_mfma_f32_16x16x32_bf16 v[72:75], a[68:71], a[196:199], v[72:75]
s_add_u32 s28, s28, s49
s_and_b32 s29, s29, 4
v_mfma_f32_16x16x32_bf16 v[72:75], a[64:67], a[192:195], v[72:75]
s_add_u32 s84, s28, 0
s_lshl_b32 s29, s29, 10
s_waitcnt lgkmcnt(8)
v_mfma_f32_16x16x32_bf16 v[72:75], a[72:75], a[200:203], v[72:75]
ds_read_b64_tr_b16 a[64:65], v219 offset:8
ds_read_b64_tr_b16 a[66:67], v219 offset:4616
v_mfma_f32_16x16x32_bf16 v[72:75], a[76:79], a[204:207], v[72:75]
s_add_u32 s68, s28, s29
v_cvt_pk_bf16_f32 v58, v48, v49
v_mfma_f32_16x16x32_bf16 v[80:83], a[76:79], a[252:255], v[80:83]
s_add_u32 s28, s32, 5
s_and_b32 s28, s28, 7
v_mfma_f32_16x16x32_bf16 v[80:83], a[72:75], a[248:251], v[80:83]
s_xor_b32 s29, s28, s32
s_lshl_b32 s28, s28, 18
v_mfma_f32_16x16x32_bf16 v[88:91], a[72:75], a[104:107], v[88:91]
ds_read_b64_tr_b16 a[68:69], v219 offset:9224
ds_read_b64_tr_b16 a[70:71], v219 offset:13832
v_mfma_f32_16x16x32_bf16 v[88:91], a[76:79], a[108:111], v[88:91]
s_add_u32 s28, s28, s49
s_and_b32 s29, s29, 4
v_mfma_f32_16x16x32_bf16 v[96:99], a[76:79], a[124:127], v[96:99]
s_add_u32 s85, s28, 8192
s_lshl_b32 s29, s29, 10
v_mfma_f32_16x16x32_bf16 v[96:99], a[72:75], a[120:123], v[96:99]
s_add_u32 s69, s28, s29
v_lshlrev_b32 v48, 16, v58
s_waitcnt lgkmcnt(8)
v_mfma_f32_16x16x32_bf16 v[96:99], a[80:83], a[48:51], v[96:99]
ds_read_b64_tr_b16 a[72:73], v219 offset:18440
ds_read_b64_tr_b16 a[74:75], v219 offset:23048
v_mfma_f32_16x16x32_bf16 v[96:99], a[84:87], a[52:55], v[96:99]
s_add_u32 s28, s32, 6
s_and_b32 s28, s28, 7
v_mfma_f32_16x16x32_bf16 v[88:91], a[84:87], a[36:39], v[88:91]
s_xor_b32 s29, s28, s32
s_lshl_b32 s28, s28, 18
v_mfma_f32_16x16x32_bf16 v[88:91], a[80:83], a[32:35], v[88:91]
s_add_u32 s28, s28, s49
s_and_b32 s29, s29, 4
v_mfma_f32_16x16x32_bf16 v[80:83], a[80:83], a[16:19], v[80:83]
ds_read_b64_tr_b16 a[76:77], v219 offset:27656
ds_read_b64_tr_b16 a[78:79], v219 offset:32264
v_mfma_f32_16x16x32_bf16 v[80:83], a[84:87], a[20:23], v[80:83]
s_add_u32 s86, s28, 8192
s_lshl_b32 s29, s29, 10
v_mfma_f32_16x16x32_bf16 v[72:75], a[84:87], a[4:7], v[72:75]
s_add_u32 s70, s28, s29
v_and_b32 v49, 0xffff0000, v58
v_mfma_f32_16x16x32_bf16 v[72:75], a[80:83], a[0:3], v[72:75]
s_add_u32 s28, s32, 7
s_and_b32 s28, s28, 7
s_waitcnt lgkmcnt(8)
v_mfma_f32_16x16x32_bf16 v[72:75], a[88:91], a[8:11], v[72:75]
ds_read_b64_tr_b16 a[80:81], v222 offset:8
ds_read_b64_tr_b16 a[82:83], v222 offset:4616
v_mfma_f32_16x16x32_bf16 v[72:75], a[92:95], a[12:15], v[72:75]
s_xor_b32 s29, s28, s32
s_lshl_b32 s28, s28, 18
v_mfma_f32_16x16x32_bf16 v[80:83], a[92:95], a[28:31], v[80:83]
s_add_u32 s28, s28, s49
s_and_b32 s29, s29, 4
v_mfma_f32_16x16x32_bf16 v[80:83], a[88:91], a[24:27], v[80:83]
s_add_u32 s87, s28, 0
s_lshl_b32 s29, s29, 10
v_mfma_f32_16x16x32_bf16 v[88:91], a[88:91], a[40:43], v[88:91]
ds_read_b64_tr_b16 a[84:85], v222 offset:9224
ds_read_b64_tr_b16 a[86:87], v222 offset:13832
v_mfma_f32_16x16x32_bf16 v[88:91], a[92:95], a[44:47], v[88:91]
s_add_u32 s71, s28, s29
v_mul_f32 v58, 0xbfb8aa3b, v48
STUB_15:
STUB_B3:
s_cbranch_execz STUB_18
v_mfma_f32_16x16x32_bf16 v[96:99], a[92:95], a[60:63], v[96:99]
s_waitcnt vmcnt(0)
v_cmp_gt_u32 vcc, 2, v230
v_mfma_f32_16x16x32_bf16 v[96:99], a[88:91], a[56:59], v[96:99]
v_mul_f32 v59, 0xbfb8aa3b, v49
s_waitcnt lgkmcnt(8)
v_mfma_f32_16x16x32_bf16 v[100:103], a[64:67], a[112:115], v[100:103]
ds_read_b64_tr_b16 a[88:89], v222 offset:18440
ds_read_b64_tr_b16 a[90:91], v222 offset:23048
v_mfma_f32_16x16x32_bf16 v[100:103], a[68:71], a[116:119], v[100:103]
s_and_b32 s29, vcc_lo, 15
s_cbranch_scc1 SP_O3A
SP_O3A_RET:
v_mfma_f32_16x16x32_bf16 v[92:95], a[68:71], a[100:103], v[92:95]
s_add_u32 s39, s44, 8192
v_mfma_f32_16x16x32_bf16 v[92:95], a[64:67], a[96:99], v[92:95]
v_cvt_pk_bf16_f32 v200, v200, v201
v_cvt_pk_bf16_f32 v201, v202, v203
v_mfma_f32_16x16x32_bf16 v[84:87], a[64:67], a[208:211], v[84:87]
ds_read_b64_tr_b16 a[92:93], v222 offset:27656
ds_read_b64_tr_b16 a[94:95], v222 offset:32264
v_mfma_f32_16x16x32_bf16 v[84:87], a[68:71], a[244:247], v[84:87]
buffer_store_dwordx2 v[200:201], v226, s[20:23], s44 offen offset:0
v_mfma_f32_16x16x32_bf16 v[76:79], a[68:71], a[196:199], v[76:79]
v_cvt_pk_bf16_f32 v204, v204, v205
v_cvt_pk_bf16_f32 v205, v206, v207
v_mfma_f32_16x16x32_bf16 v[76:79], a[64:67], a[192:195], v[76:79]
buffer_store_dwordx2 v[204:205], v226, s[20:23], s44 offen offset:512
s_waitcnt lgkmcnt(8)
v_mfma_f32_16x16x32_bf16 v[76:79], a[72:75], a[200:203], v[76:79]
ds_read_b64_tr_b16 a[64:65], v220 offset:0
ds_read_b64_tr_b16 a[66:67], v220 offset:4608
v_mfma_f32_16x16x32_bf16 v[76:79], a[76:79], a[204:207], v[76:79]
v_cvt_pk_bf16_f32 v208, v208, v209
v_cvt_pk_bf16_f32 v209, v210, v211
v_mfma_f32_16x16x32_bf16 v[84:87], a[76:79], a[252:255], v[84:87]
buffer_store_dwordx2 v[208:209], v226, s[20:23], s39 offen offset:0
v_mfma_f32_16x16x32_bf16 v[84:87], a[72:75], a[248:251], v[84:87]
v_cvt_pk_bf16_f32 v212, v212, v213
v_cvt_pk_bf16_f32 v213, v214, v215
v_mfma_f32_16x16x32_bf16 v[92:95], a[72:75], a[104:107], v[92:95]
ds_read_b64_tr_b16 a[68:69], v220 offset:9216
ds_read_b64_tr_b16 a[70:71], v220 offset:13824
v_mfma_f32_16x16x32_bf16 v[92:95], a[76:79], a[108:111], v[92:95]
buffer_store_dwordx2 v[212:213], v226, s[20:23], s39 offen offset:512
v_mfma_f32_16x16x32_bf16 v[100:103], a[76:79], a[124:127], v[100:103]
v_exp_f32 v58, v58
v_mfma_f32_16x16x32_bf16 v[100:103], a[72:75], a[120:123], v[100:103]
v_exp_f32 v59, v59
s_waitcnt lgkmcnt(8)
v_mfma_f32_16x16x32_bf16 v[100:103], a[80:83], a[48:51], v[100:103]
ds_read_b64_tr_b16 a[72:73], v220 offset:18432
ds_read_b64_tr_b16 a[74:75], v220 offset:23040
v_mfma_f32_16x16x32_bf16 v[100:103], a[84:87], a[52:55], v[100:103]
v_add_f32 v58, 1.0, v58
v_add_f32 v59, 1.0, v59
v_mfma_f32_16x16x32_bf16 v[92:95], a[84:87], a[36:39], v[92:95]
v_rcp_f32 v58, v58
v_mfma_f32_16x16x32_bf16 v[92:95], a[80:83], a[32:35], v[92:95]
v_rcp_f32 v59, v59
v_mfma_f32_16x16x32_bf16 v[84:87], a[80:83], a[16:19], v[84:87]
ds_read_b64_tr_b16 a[76:77], v220 offset:27648
ds_read_b64_tr_b16 a[78:79], v220 offset:32256
v_mfma_f32_16x16x32_bf16 v[84:87], a[84:87], a[20:23], v[84:87]
v_mul_f32 v48, v48, v58
v_mul_f32 v49, v49, v59
v_mfma_f32_16x16x32_bf16 v[76:79], a[84:87], a[4:7], v[76:79]
v_cvt_pk_bf16_f32 v58, v48, v49
v_lshlrev_b32 v48, 16, v58
v_mfma_f32_16x16x32_bf16 v[76:79], a[80:83], a[0:3], v[76:79]
v_and_b32 v49, 0xffff0000, v58
v_accvgpr_read_b32 v51, a228
s_waitcnt lgkmcnt(8)
v_mfma_f32_16x16x32_bf16 v[76:79], a[88:91], a[8:11], v[76:79]
ds_read_b64_tr_b16 a[80:81], v223 offset:0
ds_read_b64_tr_b16 a[82:83], v223 offset:4608
v_mfma_f32_16x16x32_bf16 v[76:79], a[92:95], a[12:15], v[76:79]
v_accvgpr_read_b32 v59, a238
v_lshlrev_b32 v50, 16, v51
v_mfma_f32_16x16x32_bf16 v[84:87], a[92:95], a[28:31], v[84:87]
v_and_b32 v51, 0xffff0000, v51
v_lshlrev_b32 v58, 16, v59
v_mfma_f32_16x16x32_bf16 v[84:87], a[88:91], a[24:27], v[84:87]
v_and_b32 v59, 0xffff0000, v59
v_add_f32 v50, v50, v58
v_mfma_f32_16x16x32_bf16 v[92:95], a[88:91], a[40:43], v[92:95]
ds_read_b64_tr_b16 a[84:85], v223 offset:9216
ds_read_b64_tr_b16 a[86:87], v223 offset:13824
v_mfma_f32_16x16x32_bf16 v[92:95], a[92:95], a[44:47], v[92:95]
v_add_f32 v51, v51, v59
v_cvt_pk_bf16_f32 v58, v50, v51
v_mfma_f32_16x16x32_bf16 v[100:103], a[92:95], a[60:63], v[100:103]
v_lshlrev_b32 v50, 16, v58
v_and_b32 v51, 0xffff0000, v58
v_mfma_f32_16x16x32_bf16 v[100:103], a[88:91], a[56:59], v[100:103]
v_mul_f32 v58, 0xbfb8aa3b, v50
v_mul_f32 v59, 0xbfb8aa3b, v51
s_waitcnt lgkmcnt(8)
v_mfma_f32_16x16x32_bf16 v[128:131], a[64:67], a[112:115], v[128:131]
ds_read_b64_tr_b16 a[88:89], v223 offset:18432
ds_read_b64_tr_b16 a[90:91], v223 offset:23040
v_mfma_f32_16x16x32_bf16 v[128:131], a[68:71], a[116:119], v[128:131]
v_exp_f32 v58, v58
v_mfma_f32_16x16x32_bf16 v[120:123], a[68:71], a[100:103], v[120:123]
v_exp_f32 v59, v59
v_mfma_f32_16x16x32_bf16 v[120:123], a[64:67], a[96:99], v[120:123]
v_add_f32 v58, 1.0, v58
v_add_f32 v59, 1.0, v59
v_mfma_f32_16x16x32_bf16 v[112:115], a[64:67], a[208:211], v[112:115]
ds_read_b64_tr_b16 a[92:93], v223 offset:27648
ds_read_b64_tr_b16 a[94:95], v223 offset:32256
v_mfma_f32_16x16x32_bf16 v[112:115], a[68:71], a[244:247], v[112:115]
v_rcp_f32 v58, v58
v_mfma_f32_16x16x32_bf16 v[104:107], a[68:71], a[196:199], v[104:107]
v_rcp_f32 v59, v59
v_mfma_f32_16x16x32_bf16 v[104:107], a[64:67], a[192:195], v[104:107]
v_mul_f32 v50, v50, v58
v_mul_f32 v51, v51, v59
s_waitcnt lgkmcnt(8)
v_mfma_f32_16x16x32_bf16 v[104:107], a[72:75], a[200:203], v[104:107]
ds_read_b64_tr_b16 a[64:65], v220 offset:8
ds_read_b64_tr_b16 a[66:67], v220 offset:4616
v_mfma_f32_16x16x32_bf16 v[104:107], a[76:79], a[204:207], v[104:107]
s_add_u32 s39, s44, 0
v_cvt_pk_bf16_f32 v58, v50, v51
v_mfma_f32_16x16x32_bf16 v[112:115], a[76:79], a[252:255], v[112:115]
v_cvt_pk_bf16_f32 v80, v80, v81
v_cvt_pk_bf16_f32 v81, v82, v83
v_mfma_f32_16x16x32_bf16 v[112:115], a[72:75], a[248:251], v[112:115]
v_cvt_pk_bf16_f32 v82, v84, v85
v_cvt_pk_bf16_f32 v83, v86, v87
v_mfma_f32_16x16x32_bf16 v[120:123], a[72:75], a[104:107], v[120:123]
ds_read_b64_tr_b16 a[68:69], v220 offset:9224
ds_read_b64_tr_b16 a[70:71], v220 offset:13832
v_mfma_f32_16x16x32_bf16 v[120:123], a[76:79], a[108:111], v[120:123]
buffer_store_dwordx4 v[80:83], v244, s[20:23], s39 offen offset:1024
v_mfma_f32_16x16x32_bf16 v[128:131], a[76:79], a[124:127], v[128:131]
v_cvt_pk_bf16_f32 v88, v88, v89
v_cvt_pk_bf16_f32 v89, v90, v91
v_mfma_f32_16x16x32_bf16 v[128:131], a[72:75], a[120:123], v[128:131]
v_cvt_pk_bf16_f32 v90, v92, v93
v_cvt_pk_bf16_f32 v91, v94, v95
s_waitcnt lgkmcnt(8)
v_mfma_f32_16x16x32_bf16 v[128:131], a[80:83], a[48:51], v[128:131]
ds_read_b64_tr_b16 a[72:73], v220 offset:18440
ds_read_b64_tr_b16 a[74:75], v220 offset:23048
v_mfma_f32_16x16x32_bf16 v[128:131], a[84:87], a[52:55], v[128:131]
buffer_store_dwordx4 v[88:91], v244, s[20:23], s39 offen offset:2048
v_mfma_f32_16x16x32_bf16 v[120:123], a[84:87], a[36:39], v[120:123]
v_cvt_pk_bf16_f32 v96, v96, v97
v_cvt_pk_bf16_f32 v97, v98, v99
v_mfma_f32_16x16x32_bf16 v[120:123], a[80:83], a[32:35], v[120:123]
v_cvt_pk_bf16_f32 v98, v100, v101
v_cvt_pk_bf16_f32 v99, v102, v103
v_mfma_f32_16x16x32_bf16 v[112:115], a[80:83], a[16:19], v[112:115]
ds_read_b64_tr_b16 a[76:77], v220 offset:27656
ds_read_b64_tr_b16 a[78:79], v220 offset:32264
v_mfma_f32_16x16x32_bf16 v[112:115], a[84:87], a[20:23], v[112:115]
buffer_store_dwordx4 v[96:99], v244, s[20:23], s39 offen offset:3072
v_mfma_f32_16x16x32_bf16 v[104:107], a[84:87], a[4:7], v[104:107]
v_lshlrev_b32 v50, 16, v58
v_and_b32 v51, 0xffff0000, v58
v_mfma_f32_16x16x32_bf16 v[104:107], a[80:83], a[0:3], v[104:107]
v_accvgpr_read_b32 v53, a229
v_accvgpr_read_b32 v59, a239
s_waitcnt lgkmcnt(8)
v_mfma_f32_16x16x32_bf16 v[104:107], a[88:91], a[8:11], v[104:107]
ds_read_b64_tr_b16 a[80:81], v223 offset:8
ds_read_b64_tr_b16 a[82:83], v223 offset:4616
v_mfma_f32_16x16x32_bf16 v[104:107], a[92:95], a[12:15], v[104:107]
v_lshlrev_b32 v52, 16, v53
v_and_b32 v53, 0xffff0000, v53
v_mfma_f32_16x16x32_bf16 v[112:115], a[92:95], a[28:31], v[112:115]
v_lshlrev_b32 v58, 16, v59
v_and_b32 v59, 0xffff0000, v59
v_mfma_f32_16x16x32_bf16 v[112:115], a[88:91], a[24:27], v[112:115]
v_add_f32 v52, v52, v58
v_add_f32 v53, v53, v59
v_mfma_f32_16x16x32_bf16 v[120:123], a[88:91], a[40:43], v[120:123]
ds_read_b64_tr_b16 a[84:85], v223 offset:9224
ds_read_b64_tr_b16 a[86:87], v223 offset:13832
v_mfma_f32_16x16x32_bf16 v[120:123], a[92:95], a[44:47], v[120:123]
v_cvt_pk_bf16_f32 v58, v52, v53
v_lshlrev_b32 v52, 16, v58
v_mfma_f32_16x16x32_bf16 v[128:131], a[92:95], a[60:63], v[128:131]
v_and_b32 v53, 0xffff0000, v58
v_mul_f32 v58, 0xbfb8aa3b, v52
v_mfma_f32_16x16x32_bf16 v[128:131], a[88:91], a[56:59], v[128:131]
v_mul_f32 v59, 0xbfb8aa3b, v53
s_waitcnt lgkmcnt(8)
v_mfma_f32_16x16x32_bf16 v[132:135], a[64:67], a[112:115], v[132:135]
ds_read_b64_tr_b16 a[88:89], v223 offset:18440
ds_read_b64_tr_b16 a[90:91], v223 offset:23048
v_mfma_f32_16x16x32_bf16 v[132:135], a[68:71], a[116:119], v[132:135]
v_exp_f32 v58, v58
v_mfma_f32_16x16x32_bf16 v[124:127], a[68:71], a[100:103], v[124:127]
v_exp_f32 v59, v59
v_mfma_f32_16x16x32_bf16 v[124:127], a[64:67], a[96:99], v[124:127]
v_add_f32 v58, 1.0, v58
v_add_f32 v59, 1.0, v59
v_mfma_f32_16x16x32_bf16 v[116:119], a[64:67], a[208:211], v[116:119]
ds_read_b64_tr_b16 a[92:93], v223 offset:27656
ds_read_b64_tr_b16 a[94:95], v223 offset:32264
v_mfma_f32_16x16x32_bf16 v[116:119], a[68:71], a[244:247], v[116:119]
v_rcp_f32 v58, v58
v_mfma_f32_16x16x32_bf16 v[108:111], a[68:71], a[196:199], v[108:111]
v_rcp_f32 v59, v59
v_mfma_f32_16x16x32_bf16 v[108:111], a[64:67], a[192:195], v[108:111]
v_mul_f32 v52, v52, v58
v_mul_f32 v53, v53, v59
s_waitcnt lgkmcnt(8)
v_mfma_f32_16x16x32_bf16 v[108:111], a[72:75], a[200:203], v[108:111]
ds_read_b64_tr_b16 a[64:65], v219 offset:128
ds_read_b64_tr_b16 a[66:67], v219 offset:4736
v_mfma_f32_16x16x32_bf16 v[108:111], a[76:79], a[204:207], v[108:111]
v_cvt_pk_bf16_f32 v58, v52, v53
v_lshlrev_b32 v52, 16, v58
v_mfma_f32_16x16x32_bf16 v[116:119], a[76:79], a[252:255], v[116:119]
v_and_b32 v53, 0xffff0000, v58
v_accvgpr_read_b32 v55, a230
v_mfma_f32_16x16x32_bf16 v[116:119], a[72:75], a[248:251], v[116:119]
v_accvgpr_read_b32 v59, a240
v_lshlrev_b32 v54, 16, v55
v_mfma_f32_16x16x32_bf16 v[124:127], a[72:75], a[104:107], v[124:127]
ds_read_b64_tr_b16 a[68:69], v219 offset:9344
ds_read_b64_tr_b16 a[70:71], v219 offset:13952
v_mfma_f32_16x16x32_bf16 v[124:127], a[76:79], a[108:111], v[124:127]
v_and_b32 v55, 0xffff0000, v55
v_lshlrev_b32 v58, 16, v59
v_mfma_f32_16x16x32_bf16 v[132:135], a[76:79], a[124:127], v[132:135]
v_and_b32 v59, 0xffff0000, v59
v_add_f32 v54, v54, v58
v_mfma_f32_16x16x32_bf16 v[132:135], a[72:75], a[120:123], v[132:135]
v_add_f32 v55, v55, v59
v_cvt_pk_bf16_f32 v58, v54, v55
s_waitcnt lgkmcnt(8)
v_mfma_f32_16x16x32_bf16 v[132:135], a[80:83], a[48:51], v[132:135]
ds_read_b64_tr_b16 a[72:73], v219 offset:18560
ds_read_b64_tr_b16 a[74:75], v219 offset:23168
v_mfma_f32_16x16x32_bf16 v[132:135], a[84:87], a[52:55], v[132:135]
v_lshlrev_b32 v54, 16, v58
v_and_b32 v55, 0xffff0000, v58
v_mfma_f32_16x16x32_bf16 v[124:127], a[84:87], a[36:39], v[124:127]
v_mul_f32 v58, 0xbfb8aa3b, v54
v_mul_f32 v59, 0xbfb8aa3b, v55
v_mfma_f32_16x16x32_bf16 v[124:127], a[80:83], a[32:35], v[124:127]
v_exp_f32 v58, v58
v_mfma_f32_16x16x32_bf16 v[116:119], a[80:83], a[16:19], v[116:119]
ds_read_b64_tr_b16 a[76:77], v219 offset:27776
ds_read_b64_tr_b16 a[78:79], v219 offset:32384
v_mfma_f32_16x16x32_bf16 v[116:119], a[84:87], a[20:23], v[116:119]
v_exp_f32 v59, v59
v_mfma_f32_16x16x32_bf16 v[108:111], a[84:87], a[4:7], v[108:111]
v_add_f32 v58, 1.0, v58
v_add_f32 v59, 1.0, v59
v_mfma_f32_16x16x32_bf16 v[108:111], a[80:83], a[0:3], v[108:111]
v_rcp_f32 v58, v58
s_waitcnt lgkmcnt(8)
v_mfma_f32_16x16x32_bf16 v[108:111], a[88:91], a[8:11], v[108:111]
ds_read_b64_tr_b16 a[80:81], v222 offset:128
ds_read_b64_tr_b16 a[82:83], v222 offset:4736
v_mfma_f32_16x16x32_bf16 v[108:111], a[92:95], a[12:15], v[108:111]
v_rcp_f32 v59, v59
v_mfma_f32_16x16x32_bf16 v[116:119], a[92:95], a[28:31], v[116:119]
v_mul_f32 v54, v54, v58
v_mul_f32 v55, v55, v59
v_mfma_f32_16x16x32_bf16 v[116:119], a[88:91], a[24:27], v[116:119]
v_cvt_pk_bf16_f32 v58, v54, v55
v_lshlrev_b32 v54, 16, v58
v_mfma_f32_16x16x32_bf16 v[124:127], a[88:91], a[40:43], v[124:127]
ds_read_b64_tr_b16 a[84:85], v222 offset:9344
ds_read_b64_tr_b16 a[86:87], v222 offset:13952
v_mfma_f32_16x16x32_bf16 v[124:127], a[92:95], a[44:47], v[124:127]
v_and_b32 v55, 0xffff0000, v58
v_accvgpr_read_b32 v57, a231
v_mfma_f32_16x16x32_bf16 v[132:135], a[92:95], a[60:63], v[132:135]
v_accvgpr_read_b32 v59, a241
v_lshlrev_b32 v56, 16, v57
v_mfma_f32_16x16x32_bf16 v[132:135], a[88:91], a[56:59], v[132:135]
v_and_b32 v57, 0xffff0000, v57
v_lshlrev_b32 v58, 16, v59
s_waitcnt lgkmcnt(8)
v_mfma_f32_16x16x32_bf16 v[160:163], a[64:67], a[112:115], v[160:163]
ds_read_b64_tr_b16 a[88:89], v222 offset:18560
ds_read_b64_tr_b16 a[90:91], v222 offset:23168
v_mfma_f32_16x16x32_bf16 v[160:163], a[68:71], a[116:119], v[160:163]
v_and_b32 v59, 0xffff0000, v59
v_add_f32 v56, v56, v58
v_mfma_f32_16x16x32_bf16 v[152:155], a[68:71], a[100:103], v[152:155]
v_add_f32 v57, v57, v59
v_cvt_pk_bf16_f32 v58, v56, v57
v_mfma_f32_16x16x32_bf16 v[152:155], a[64:67], a[96:99], v[152:155]
v_lshlrev_b32 v56, 16, v58
v_and_b32 v57, 0xffff0000, v58
v_mfma_f32_16x16x32_bf16 v[144:147], a[64:67], a[208:211], v[144:147]
ds_read_b64_tr_b16 a[92:93], v222 offset:27776
ds_read_b64_tr_b16 a[94:95], v222 offset:32384
v_mfma_f32_16x16x32_bf16 v[144:147], a[68:71], a[244:247], v[144:147]
v_mul_f32 v58, 0xbfb8aa3b, v56
v_mul_f32 v59, 0xbfb8aa3b, v57
v_mfma_f32_16x16x32_bf16 v[136:139], a[68:71], a[196:199], v[136:139]
v_exp_f32 v58, v58
v_mfma_f32_16x16x32_bf16 v[136:139], a[64:67], a[192:195], v[136:139]
v_exp_f32 v59, v59
s_waitcnt lgkmcnt(8)
v_mfma_f32_16x16x32_bf16 v[136:139], a[72:75], a[200:203], v[136:139]
ds_read_b64_tr_b16 a[64:65], v219 offset:136
ds_read_b64_tr_b16 a[66:67], v219 offset:4744
v_mfma_f32_16x16x32_bf16 v[136:139], a[76:79], a[204:207], v[136:139]
s_add_u32 s39, s44, 4096
v_add_f32 v58, 1.0, v58
v_mfma_f32_16x16x32_bf16 v[144:147], a[76:79], a[252:255], v[144:147]
v_cvt_pk_bf16_f32 v104, v104, v105
v_cvt_pk_bf16_f32 v105, v106, v107
v_mfma_f32_16x16x32_bf16 v[144:147], a[72:75], a[248:251], v[144:147]
v_cvt_pk_bf16_f32 v106, v108, v109
v_cvt_pk_bf16_f32 v107, v110, v111
v_mfma_f32_16x16x32_bf16 v[152:155], a[72:75], a[104:107], v[152:155]
ds_read_b64_tr_b16 a[68:69], v219 offset:9352
ds_read_b64_tr_b16 a[70:71], v219 offset:13960
v_mfma_f32_16x16x32_bf16 v[152:155], a[76:79], a[108:111], v[152:155]
buffer_store_dwordx4 v[104:107], v244, s[20:23], s39 offen offset:0
v_mfma_f32_16x16x32_bf16 v[160:163], a[76:79], a[124:127], v[160:163]
v_cvt_pk_bf16_f32 v112, v112, v113
v_cvt_pk_bf16_f32 v113, v114, v115
v_mfma_f32_16x16x32_bf16 v[160:163], a[72:75], a[120:123], v[160:163]
v_cvt_pk_bf16_f32 v114, v116, v117
v_cvt_pk_bf16_f32 v115, v118, v119
s_waitcnt lgkmcnt(8)
v_mfma_f32_16x16x32_bf16 v[160:163], a[80:83], a[48:51], v[160:163]
ds_read_b64_tr_b16 a[72:73], v219 offset:18568
ds_read_b64_tr_b16 a[74:75], v219 offset:23176
v_mfma_f32_16x16x32_bf16 v[160:163], a[84:87], a[52:55], v[160:163]
buffer_store_dwordx4 v[112:115], v244, s[20:23], s39 offen offset:1024
v_mfma_f32_16x16x32_bf16 v[152:155], a[84:87], a[36:39], v[152:155]
v_cvt_pk_bf16_f32 v120, v120, v121
v_cvt_pk_bf16_f32 v121, v122, v123
v_mfma_f32_16x16x32_bf16 v[152:155], a[80:83], a[32:35], v[152:155]
v_cvt_pk_bf16_f32 v122, v124, v125
v_cvt_pk_bf16_f32 v123, v126, v127
v_mfma_f32_16x16x32_bf16 v[144:147], a[80:83], a[16:19], v[144:147]
ds_read_b64_tr_b16 a[76:77], v219 offset:27784
ds_read_b64_tr_b16 a[78:79], v219 offset:32392
v_mfma_f32_16x16x32_bf16 v[144:147], a[84:87], a[20:23], v[144:147]
buffer_store_dwordx4 v[120:123], v244, s[20:23], s39 offen offset:2048
v_mfma_f32_16x16x32_bf16 v[136:139], a[84:87], a[4:7], v[136:139]
v_cvt_pk_bf16_f32 v128, v128, v129
v_cvt_pk_bf16_f32 v129, v130, v131
v_mfma_f32_16x16x32_bf16 v[136:139], a[80:83], a[0:3], v[136:139]
v_cvt_pk_bf16_f32 v130, v132, v133
v_cvt_pk_bf16_f32 v131, v134, v135
s_waitcnt lgkmcnt(8)
v_mfma_f32_16x16x32_bf16 v[136:139], a[88:91], a[8:11], v[136:139]
ds_read_b64_tr_b16 a[80:81], v222 offset:136
ds_read_b64_tr_b16 a[82:83], v222 offset:4744
v_mfma_f32_16x16x32_bf16 v[136:139], a[92:95], a[12:15], v[136:139]
buffer_store_dwordx4 v[128:131], v244, s[20:23], s39 offen offset:3072
v_mfma_f32_16x16x32_bf16 v[144:147], a[92:95], a[28:31], v[144:147]
s_lshl2_add_u32 s28, s32, s95
v_add_f32 v59, 1.0, v59
v_mfma_f32_16x16x32_bf16 v[144:147], a[88:91], a[24:27], v[144:147]
v_rcp_f32 v58, v58
v_mfma_f32_16x16x32_bf16 v[152:155], a[88:91], a[40:43], v[152:155]
ds_read_b64_tr_b16 a[84:85], v222 offset:9352
ds_read_b64_tr_b16 a[86:87], v222 offset:13960
v_mfma_f32_16x16x32_bf16 v[152:155], a[92:95], a[44:47], v[152:155]
v_rcp_f32 v59, v59
v_mfma_f32_16x16x32_bf16 v[160:163], a[92:95], a[60:63], v[160:163]
v_mul_f32 v56, v56, v58
v_mul_f32 v57, v57, v59
v_mfma_f32_16x16x32_bf16 v[160:163], a[88:91], a[56:59], v[160:163]
v_cvt_pk_bf16_f32 v58, v56, v57
v_lshlrev_b32 v56, 16, v58
s_waitcnt lgkmcnt(8)
v_mfma_f32_16x16x32_bf16 v[164:167], a[64:67], a[112:115], v[164:167]
ds_read_b64_tr_b16 a[88:89], v222 offset:18568
ds_read_b64_tr_b16 a[90:91], v222 offset:23176
v_mfma_f32_16x16x32_bf16 v[164:167], a[68:71], a[116:119], v[164:167]
v_and_b32 v57, 0xffff0000, v58
v_accvgpr_read_b32 v19, a212
v_mfma_f32_16x16x32_bf16 v[156:159], a[68:71], a[100:103], v[156:159]
v_lshlrev_b32 v18, 16, v19
v_and_b32 v19, 0xffff0000, v19
v_mfma_f32_16x16x32_bf16 v[156:159], a[64:67], a[96:99], v[156:159]
v_accvgpr_read_b32 v21, a213
v_lshlrev_b32 v20, 16, v21
v_mfma_f32_16x16x32_bf16 v[148:151], a[64:67], a[208:211], v[148:151]
ds_read_b64_tr_b16 a[92:93], v222 offset:27784
ds_read_b64_tr_b16 a[94:95], v222 offset:32392
v_mfma_f32_16x16x32_bf16 v[148:151], a[68:71], a[244:247], v[148:151]
v_and_b32 v21, 0xffff0000, v21
v_accvgpr_read_b32 v23, a214
v_mfma_f32_16x16x32_bf16 v[140:143], a[68:71], a[196:199], v[140:143]
v_lshlrev_b32 v22, 16, v23
v_and_b32 v23, 0xffff0000, v23
v_mfma_f32_16x16x32_bf16 v[140:143], a[64:67], a[192:195], v[140:143]
v_accvgpr_read_b32 v25, a215
v_lshlrev_b32 v24, 16, v25
s_waitcnt lgkmcnt(8)
v_mfma_f32_16x16x32_bf16 v[140:143], a[72:75], a[200:203], v[140:143]
ds_read_b64_tr_b16 a[64:65], v220 offset:128
ds_read_b64_tr_b16 a[66:67], v220 offset:4736
v_mfma_f32_16x16x32_bf16 v[140:143], a[76:79], a[204:207], v[140:143]
v_and_b32 v25, 0xffff0000, v25
v_accvgpr_read_b32 v27, a216
v_mfma_f32_16x16x32_bf16 v[148:151], a[76:79], a[252:255], v[148:151]
v_lshlrev_b32 v26, 16, v27
v_and_b32 v27, 0xffff0000, v27
v_mfma_f32_16x16x32_bf16 v[148:151], a[72:75], a[248:251], v[148:151]
v_accvgpr_read_b32 v29, a217
v_lshlrev_b32 v28, 16, v29
v_mfma_f32_16x16x32_bf16 v[156:159], a[72:75], a[104:107], v[156:159]
ds_read_b64_tr_b16 a[68:69], v220 offset:9344
ds_read_b64_tr_b16 a[70:71], v220 offset:13952
v_mfma_f32_16x16x32_bf16 v[156:159], a[76:79], a[108:111], v[156:159]
v_and_b32 v29, 0xffff0000, v29
v_accvgpr_read_b32 v31, a218
v_mfma_f32_16x16x32_bf16 v[164:167], a[76:79], a[124:127], v[164:167]
v_lshlrev_b32 v30, 16, v31
v_and_b32 v31, 0xffff0000, v31
v_mfma_f32_16x16x32_bf16 v[164:167], a[72:75], a[120:123], v[164:167]
v_accvgpr_read_b32 v33, a219
v_lshlrev_b32 v32, 16, v33
s_waitcnt lgkmcnt(8)
v_mfma_f32_16x16x32_bf16 v[164:167], a[80:83], a[48:51], v[164:167]
ds_read_b64_tr_b16 a[72:73], v220 offset:18560
ds_read_b64_tr_b16 a[74:75], v220 offset:23168
v_mfma_f32_16x16x32_bf16 v[164:167], a[84:87], a[52:55], v[164:167]
v_and_b32 v33, 0xffff0000, v33
v_accvgpr_read_b32 v35, a220
v_mfma_f32_16x16x32_bf16 v[156:159], a[84:87], a[36:39], v[156:159]
s_waitcnt vmcnt(0)
buffer_store_dword v231, v254, s[20:23], s28 offen
v_mfma_f32_16x16x32_bf16 v[156:159], a[80:83], a[32:35], v[156:159]
v_lshlrev_b32 v34, 16, v35
v_and_b32 v35, 0xffff0000, v35
v_mfma_f32_16x16x32_bf16 v[148:151], a[80:83], a[16:19], v[148:151]
ds_read_b64_tr_b16 a[76:77], v220 offset:27776
ds_read_b64_tr_b16 a[78:79], v220 offset:32384
v_mfma_f32_16x16x32_bf16 v[148:151], a[84:87], a[20:23], v[148:151]
v_accvgpr_read_b32 v37, a221
v_lshlrev_b32 v36, 16, v37
v_mfma_f32_16x16x32_bf16 v[140:143], a[84:87], a[4:7], v[140:143]
v_and_b32 v37, 0xffff0000, v37
v_mfma_f32_16x16x32_bf16 v[140:143], a[80:83], a[0:3], v[140:143]
s_mov_b32 s90, 0x3f80
s_mov_b32 s91, 0x3f800000
s_waitcnt lgkmcnt(8)
v_mfma_f32_16x16x32_bf16 v[140:143], a[88:91], a[8:11], v[140:143]
ds_read_b64_tr_b16 a[80:81], v223 offset:128
ds_read_b64_tr_b16 a[82:83], v223 offset:4736
v_mfma_f32_16x16x32_bf16 v[140:143], a[92:95], a[12:15], v[140:143]
v_mov_b32 v66, 0
v_mov_b32 v67, 0
v_mfma_f32_16x16x32_bf16 v[148:151], a[92:95], a[28:31], v[148:151]
v_mov_b32 v68, 0
v_mov_b32 v69, 0
v_mfma_f32_16x16x32_bf16 v[148:151], a[88:91], a[24:27], v[148:151]
v_mfma_f32_16x16x32_bf16 v[156:159], a[88:91], a[40:43], v[156:159]
ds_read_b64_tr_b16 a[84:85], v223 offset:9344
ds_read_b64_tr_b16 a[86:87], v223 offset:13952
v_mfma_f32_16x16x32_bf16 v[156:159], a[92:95], a[44:47], v[156:159]
v_mfma_f32_16x16x32_bf16 v[164:167], a[92:95], a[60:63], v[164:167]
v_mfma_f32_16x16x32_bf16 v[164:167], a[88:91], a[56:59], v[164:167]
s_waitcnt lgkmcnt(8)
v_mfma_f32_16x16x32_bf16 v[192:195], a[64:67], a[112:115], v[192:195]
ds_read_b64_tr_b16 a[88:89], v223 offset:18560
ds_read_b64_tr_b16 a[90:91], v223 offset:23168
v_mfma_f32_16x16x32_bf16 v[192:195], a[68:71], a[116:119], v[192:195]
v_mfma_f32_16x16x32_bf16 v[184:187], a[68:71], a[100:103], v[184:187]
v_mfma_f32_16x16x32_bf16 v[184:187], a[64:67], a[96:99], v[184:187]
v_mfma_f32_16x16x32_bf16 v[176:179], a[64:67], a[208:211], v[176:179]
ds_read_b64_tr_b16 a[92:93], v223 offset:27776
ds_read_b64_tr_b16 a[94:95], v223 offset:32384
v_mfma_f32_16x16x32_bf16 v[176:179], a[68:71], a[244:247], v[176:179]
v_mfma_f32_16x16x32_bf16 v[168:171], a[68:71], a[196:199], v[168:171]
v_mfma_f32_16x16x32_bf16 v[168:171], a[64:67], a[192:195], v[168:171]
s_waitcnt lgkmcnt(8)
v_mfma_f32_16x16x32_bf16 v[168:171], a[72:75], a[200:203], v[168:171]
ds_read_b64_tr_b16 a[64:65], v220 offset:136
ds_read_b64_tr_b16 a[66:67], v220 offset:4744
v_mfma_f32_16x16x32_bf16 v[168:171], a[76:79], a[204:207], v[168:171]
s_add_u32 s39, s44, 8192
v_mfma_f32_16x16x32_bf16 v[176:179], a[76:79], a[252:255], v[176:179]
v_cvt_pk_bf16_f32 v144, v144, v145
v_cvt_pk_bf16_f32 v145, v146, v147
v_mfma_f32_16x16x32_bf16 v[176:179], a[72:75], a[248:251], v[176:179]
v_cvt_pk_bf16_f32 v146, v148, v149
v_cvt_pk_bf16_f32 v147, v150, v151
v_mfma_f32_16x16x32_bf16 v[184:187], a[72:75], a[104:107], v[184:187]
ds_read_b64_tr_b16 a[68:69], v220 offset:9352
ds_read_b64_tr_b16 a[70:71], v220 offset:13960
v_mfma_f32_16x16x32_bf16 v[184:187], a[76:79], a[108:111], v[184:187]
buffer_store_dwordx4 v[144:147], v244, s[20:23], s39 offen offset:1024
v_mfma_f32_16x16x32_bf16 v[192:195], a[76:79], a[124:127], v[192:195]
v_cvt_pk_bf16_f32 v152, v152, v153
v_cvt_pk_bf16_f32 v153, v154, v155
v_mfma_f32_16x16x32_bf16 v[192:195], a[72:75], a[120:123], v[192:195]
v_cvt_pk_bf16_f32 v154, v156, v157
v_cvt_pk_bf16_f32 v155, v158, v159
s_waitcnt lgkmcnt(8)
v_mfma_f32_16x16x32_bf16 v[192:195], a[80:83], a[48:51], v[192:195]
ds_read_b64_tr_b16 a[72:73], v220 offset:18568
ds_read_b64_tr_b16 a[74:75], v220 offset:23176
v_mfma_f32_16x16x32_bf16 v[192:195], a[84:87], a[52:55], v[192:195]
buffer_store_dwordx4 v[152:155], v244, s[20:23], s39 offen offset:2048
v_mfma_f32_16x16x32_bf16 v[184:187], a[84:87], a[36:39], v[184:187]
v_cvt_pk_bf16_f32 v160, v160, v161
v_cvt_pk_bf16_f32 v161, v162, v163
v_mfma_f32_16x16x32_bf16 v[184:187], a[80:83], a[32:35], v[184:187]
v_cvt_pk_bf16_f32 v162, v164, v165
v_cvt_pk_bf16_f32 v163, v166, v167
v_mfma_f32_16x16x32_bf16 v[176:179], a[80:83], a[16:19], v[176:179]
ds_read_b64_tr_b16 a[76:77], v220 offset:27784
ds_read_b64_tr_b16 a[78:79], v220 offset:32392
v_mfma_f32_16x16x32_bf16 v[176:179], a[84:87], a[20:23], v[176:179]
buffer_store_dwordx4 v[160:163], v244, s[20:23], s39 offen offset:3072
v_mfma_f32_16x16x32_bf16 v[168:171], a[84:87], a[4:7], v[168:171]
buffer_load_dword v230, v229, s[20:23], s95 offen sc0 sc1
v_mfma_f32_16x16x32_bf16 v[168:171], a[80:83], a[0:3], v[168:171]
s_waitcnt lgkmcnt(8)
v_mfma_f32_16x16x32_bf16 v[168:171], a[88:91], a[8:11], v[168:171]
ds_read_b64_tr_b16 a[80:81], v223 offset:136
ds_read_b64_tr_b16 a[82:83], v223 offset:4744
v_mfma_f32_16x16x32_bf16 v[168:171], a[92:95], a[12:15], v[168:171]
v_mfma_f32_16x16x32_bf16 v[176:179], a[92:95], a[28:31], v[176:179]
v_mfma_f32_16x16x32_bf16 v[176:179], a[88:91], a[24:27], v[176:179]
v_mfma_f32_16x16x32_bf16 v[184:187], a[88:91], a[40:43], v[184:187]
ds_read_b64_tr_b16 a[84:85], v223 offset:9352
ds_read_b64_tr_b16 a[86:87], v223 offset:13960
v_mfma_f32_16x16x32_bf16 v[184:187], a[92:95], a[44:47], v[184:187]
v_mfma_f32_16x16x32_bf16 v[192:195], a[92:95], a[60:63], v[192:195]
v_mfma_f32_16x16x32_bf16 v[192:195], a[88:91], a[56:59], v[192:195]
s_waitcnt lgkmcnt(8)
v_mfma_f32_16x16x32_bf16 v[196:199], a[64:67], a[112:115], v[196:199]
ds_read_b64_tr_b16 a[88:89], v223 offset:18568
ds_read_b64_tr_b16 a[90:91], v223 offset:23176
v_mfma_f32_16x16x32_bf16 v[196:199], a[68:71], a[116:119], v[196:199]
v_mfma_f32_16x16x32_bf16 v[188:191], a[68:71], a[100:103], v[188:191]
v_mfma_f32_16x16x32_bf16 v[188:191], a[64:67], a[96:99], v[188:191]
v_mfma_f32_16x16x32_bf16 v[180:183], a[64:67], a[208:211], v[180:183]
ds_read_b64_tr_b16 a[92:93], v223 offset:27784
ds_read_b64_tr_b16 a[94:95], v223 offset:32392
v_mfma_f32_16x16x32_bf16 v[180:183], a[68:71], a[244:247], v[180:183]
v_mfma_f32_16x16x32_bf16 v[172:175], a[68:71], a[196:199], v[172:175]
v_mfma_f32_16x16x32_bf16 v[172:175], a[64:67], a[192:195], v[172:175]
s_waitcnt lgkmcnt(8)
v_mfma_f32_16x16x32_bf16 v[172:175], a[72:75], a[200:203], v[172:175]
v_mfma_f32_16x16x32_bf16 v[172:175], a[76:79], a[204:207], v[172:175]
v_mfma_f32_16x16x32_bf16 v[180:183], a[76:79], a[252:255], v[180:183]
v_mfma_f32_16x16x32_bf16 v[180:183], a[72:75], a[248:251], v[180:183]
v_mfma_f32_16x16x32_bf16 v[188:191], a[72:75], a[104:107], v[188:191]
v_mfma_f32_16x16x32_bf16 v[188:191], a[76:79], a[108:111], v[188:191]
v_mfma_f32_16x16x32_bf16 v[196:199], a[76:79], a[124:127], v[196:199]
s_waitcnt vmcnt(0)
v_cmp_gt_u32 vcc, 1, v230
v_mfma_f32_16x16x32_bf16 v[196:199], a[72:75], a[120:123], v[196:199]
s_waitcnt lgkmcnt(6)
v_mfma_f32_16x16x32_bf16 v[196:199], a[80:83], a[48:51], v[196:199]
s_and_b32 s29, vcc_lo, 0xff
s_cbranch_scc1 SP_P1A
SP_P1A_RET:
s_waitcnt lgkmcnt(4)
v_mfma_f32_16x16x32_bf16 v[196:199], a[84:87], a[52:55], v[196:199]
buffer_load_dwordx4 v[104:107], v244, s[20:23], s65 offen offset:3072 sc0 sc1
v_mfma_f32_16x16x32_bf16 v[188:191], a[84:87], a[36:39], v[188:191]
buffer_load_dwordx4 v[108:111], v244, s[20:23], s66 offen offset:2048 sc0 sc1
v_mfma_f32_16x16x32_bf16 v[188:191], a[80:83], a[32:35], v[188:191]
buffer_load_dwordx4 v[112:115], v244, s[20:23], s67 offen offset:1024 sc0 sc1
v_mfma_f32_16x16x32_bf16 v[180:183], a[80:83], a[16:19], v[180:183]
buffer_load_dwordx4 v[116:119], v244, s[20:23], s68 offen offset:0 sc0 sc1
v_mfma_f32_16x16x32_bf16 v[180:183], a[84:87], a[20:23], v[180:183]
STUB_16:
s_cbranch_execz HOP_RET2
buffer_load_dwordx4 v[120:123], v244, s[20:23], s69 offen offset:3072 sc0 sc1
v_mfma_f32_16x16x32_bf16 v[172:175], a[84:87], a[4:7], v[172:175]
buffer_load_dwordx4 v[124:127], v244, s[20:23], s70 offen offset:2048 sc0 sc1
v_mfma_f32_16x16x32_bf16 v[172:175], a[80:83], a[0:3], v[172:175]
buffer_load_dwordx4 v[128:131], v244, s[20:23], s71 offen offset:1024 sc0 sc1
s_waitcnt lgkmcnt(2)
v_mfma_f32_16x16x32_bf16 v[172:175], a[88:91], a[8:11], v[172:175]
s_waitcnt lgkmcnt(0)
v_mfma_f32_16x16x32_bf16 v[172:175], a[92:95], a[12:15], v[172:175]
v_mfma_f32_16x16x32_bf16 v[180:183], a[92:95], a[28:31], v[180:183]
v_mfma_f32_16x16x32_bf16 v[180:183], a[88:91], a[24:27], v[180:183]
v_mfma_f32_16x16x32_bf16 v[188:191], a[88:91], a[40:43], v[188:191]
v_mfma_f32_16x16x32_bf16 v[188:191], a[92:95], a[44:47], v[188:191]
v_mfma_f32_16x16x32_bf16 v[196:199], a[92:95], a[60:63], v[196:199]
v_mfma_f32_16x16x32_bf16 v[196:199], a[88:91], a[56:59], v[196:199]
s_add_u32 s39, s44, 12288
s_nop 7
v_cvt_pk_bf16_f32 v168, v168, v169
v_cvt_pk_bf16_f32 v169, v170, v171
v_cvt_pk_bf16_f32 v170, v172, v173
v_cvt_pk_bf16_f32 v171, v174, v175
buffer_store_dwordx4 v[168:171], v244, s[20:23], s39 offen offset:0
v_cvt_pk_bf16_f32 v176, v176, v177
v_cvt_pk_bf16_f32 v177, v178, v179
v_cvt_pk_bf16_f32 v178, v180, v181
v_cvt_pk_bf16_f32 v179, v182, v183
buffer_store_dwordx4 v[176:179], v244, s[20:23], s39 offen offset:1024
v_cvt_pk_bf16_f32 v184, v184, v185
v_cvt_pk_bf16_f32 v185, v186, v187
v_cvt_pk_bf16_f32 v186, v188, v189
v_cvt_pk_bf16_f32 v187, v190, v191
buffer_store_dwordx4 v[184:187], v244, s[20:23], s39 offen offset:2048
v_cvt_pk_bf16_f32 v192, v192, v193
v_cvt_pk_bf16_f32 v193, v194, v195
v_cvt_pk_bf16_f32 v194, v196, v197
v_cvt_pk_bf16_f32 v195, v198, v199
buffer_store_dwordx4 v[192:195], v244, s[20:23], s39 offen offset:3072
buffer_load_dwordx2 v[200:201], v226, s[20:23], s72 offen offset:0 sc0 sc1
buffer_load_dwordx2 v[202:203], v226, s[20:23], s73 offen offset:512 sc0 sc1
buffer_load_dwordx2 v[204:205], v226, s[20:23], s74 offen offset:0 sc0 sc1
buffer_load_dwordx2 v[206:207], v226, s[20:23], s75 offen offset:512 sc0 sc1
buffer_load_dwordx2 v[208:209], v226, s[20:23], s84 offen offset:0 sc0 sc1
buffer_load_dwordx2 v[210:211], v226, s[20:23], s85 offen offset:512 sc0 sc1
buffer_load_dwordx2 v[212:213], v226, s[20:23], s86 offen offset:0 sc0 sc1
buffer_load_dwordx2 v[214:215], v226, s[20:23], s87 offen offset:512 sc0 sc1
s_waitcnt vmcnt(8)
buffer_store_dword v246, v254, s[20:23], s28 offen
buffer_load_dword v230, v229, s[20:23], s95 offen sc0 sc1
s_waitcnt vmcnt(20)
v_dot2c_f32_bf16 v72, s90, v104
v_dot2c_f32_bf16 v73, s91, v104
v_dot2c_f32_bf16 v74, s90, v105
v_dot2c_f32_bf16 v75, s91, v105
v_dot2c_f32_bf16 v76, s90, v106
v_dot2c_f32_bf16 v77, s91, v106
v_dot2c_f32_bf16 v78, s90, v107
v_dot2c_f32_bf16 v79, s91, v107
s_waitcnt vmcnt(19)
v_dot2c_f32_bf16 v72, s90, v108
v_dot2c_f32_bf16 v73, s91, v108
v_dot2c_f32_bf16 v74, s90, v109
v_dot2c_f32_bf16 v75, s91, v109
v_dot2c_f32_bf16 v76, s90, v110
v_dot2c_f32_bf16 v77, s91, v110
v_dot2c_f32_bf16 v78, s90, v111
v_dot2c_f32_bf16 v79, s91, v111
s_waitcnt vmcnt(18)
v_dot2c_f32_bf16 v72, s90, v112
v_dot2c_f32_bf16 v73, s91, v112
v_dot2c_f32_bf16 v74, s90, v113
v_dot2c_f32_bf16 v75, s91, v113
v_dot2c_f32_bf16 v76, s90, v114
v_dot2c_f32_bf16 v77, s91, v114
v_dot2c_f32_bf16 v78, s90, v115
v_dot2c_f32_bf16 v79, s91, v115
s_waitcnt vmcnt(17)
v_dot2c_f32_bf16 v72, s90, v116
v_dot2c_f32_bf16 v73, s91, v116
v_dot2c_f32_bf16 v74, s90, v117
v_dot2c_f32_bf16 v75, s91, v117
v_dot2c_f32_bf16 v76, s90, v118
v_dot2c_f32_bf16 v77, s91, v118
v_dot2c_f32_bf16 v78, s90, v119
v_dot2c_f32_bf16 v79, s91, v119
s_waitcnt vmcnt(16)
v_dot2c_f32_bf16 v72, s90, v120
v_dot2c_f32_bf16 v73, s91, v120
v_dot2c_f32_bf16 v74, s90, v121
v_dot2c_f32_bf16 v75, s91, v121
v_dot2c_f32_bf16 v76, s90, v122
v_dot2c_f32_bf16 v77, s91, v122
v_dot2c_f32_bf16 v78, s90, v123
v_dot2c_f32_bf16 v79, s91, v123
s_waitcnt vmcnt(15)
v_dot2c_f32_bf16 v72, s90, v124
v_dot2c_f32_bf16 v73, s91, v124
v_dot2c_f32_bf16 v74, s90, v125
v_dot2c_f32_bf16 v75, s91, v125
v_dot2c_f32_bf16 v76, s90, v126
v_dot2c_f32_bf16 v77, s91, v126
v_dot2c_f32_bf16 v78, s90, v127
v_dot2c_f32_bf16 v79, s91, v127
s_waitcnt vmcnt(14)
v_dot2c_f32_bf16 v72, s90, v128
v_dot2c_f32_bf16 v73, s91, v128
v_dot2c_f32_bf16 v74, s90, v129
v_dot2c_f32_bf16 v75, s91, v129
v_dot2c_f32_bf16 v76, s90, v130
v_dot2c_f32_bf16 v77, s91, v130
v_dot2c_f32_bf16 v78, s90, v131
v_dot2c_f32_bf16 v79, s91, v131
s_nop 2
v_cvt_pk_bf16_f32 v58, v72, v73
v_cvt_pk_bf16_f32 v59, v74, v75
v_cvt_pk_bf16_f32 v60, v76, v77
v_cvt_pk_bf16_f32 v61, v78, v79
v_lshlrev_b32 v72, 16, v58
v_and_b32 v73, 0xffff0000, v58
v_lshlrev_b32 v74, 16, v59
v_and_b32 v75, 0xffff0000, v59
v_lshlrev_b32 v76, 16, v60
v_and_b32 v77, 0xffff0000, v60
v_lshlrev_b32 v78, 16, v61
v_and_b32 v79, 0xffff0000, v61
v_pk_mul_f32 v[72:73], v[72:73], v[38:39]
v_pk_mul_f32 v[74:75], v[74:75], v[40:41]
v_pk_mul_f32 v[76:77], v[76:77], v[42:43]
v_pk_mul_f32 v[78:79], v[78:79], v[44:45]
v_cvt_pk_bf16_f32 v58, v72, v73
v_cvt_pk_bf16_f32 v59, v74, v75
v_cvt_pk_bf16_f32 v60, v76, v77
v_cvt_pk_bf16_f32 v61, v78, v79
v_lshlrev_b32 v72, 16, v58
v_and_b32 v73, 0xffff0000, v58
v_lshlrev_b32 v74, 16, v59
v_and_b32 v75, 0xffff0000, v59
v_lshlrev_b32 v76, 16, v60
v_and_b32 v77, 0xffff0000, v60
v_lshlrev_b32 v78, 16, v61
v_and_b32 v79, 0xffff0000, v61
v_pk_add_f32 v[72:73], v[72:73], v[18:19]
v_pk_add_f32 v[74:75], v[74:75], v[20:21]
v_pk_add_f32 v[76:77], v[76:77], v[22:23]
v_pk_add_f32 v[78:79], v[78:79], v[24:25]
v_cvt_pk_bf16_f32 v72, v72, v73
v_cvt_pk_bf16_f32 v73, v74, v75
v_cvt_pk_bf16_f32 v74, v76, v77
v_cvt_pk_bf16_f32 v75, v78, v79
buffer_store_dwordx4 v[72:75], v248, s[60:63], 0 offen
s_waitcnt vmcnt(1)
v_cmp_gt_u32 vcc, 2, v230
s_nop 0
s_and_b32 s29, vcc_lo, 0xff
s_cbranch_scc0 SP_P2A_RET
SP_P2A:
s_sleep 0
s_add_u32 s100, s100, 1
s_bitcmp1_b32 s100, 19
s_cbranch_scc1 K_END
buffer_load_dword v230, v229, s[20:23], s95 offen sc0 sc1
s_waitcnt vmcnt(0)
v_cmp_gt_u32 vcc, 2, v230
s_nop 0
s_and_b32 s29, vcc_lo, 0xff
s_cbranch_scc1 SP_P2A
SP_P2A_RET:
buffer_load_dwordx4 v[80:83], v243, s[20:23], s65 offen offset:3072 sc0 sc1
buffer_load_dwordx4 v[84:87], v243, s[20:23], s66 offen offset:2048 sc0 sc1
buffer_load_dwordx4 v[88:91], v243, s[20:23], s67 offen offset:1024 sc0 sc1
buffer_load_dwordx4 v[92:95], v243, s[20:23], s68 offen offset:0 sc0 sc1
buffer_load_dwordx4 v[96:99], v243, s[20:23], s69 offen offset:3072 sc0 sc1
buffer_load_dwordx4 v[100:103], v243, s[20:23], s70 offen offset:2048 sc0 sc1
buffer_load_dwordx4 v[132:135], v243, s[20:23], s71 offen offset:1024 sc0 sc1
s_waitcnt vmcnt(17)
v_dot2c_f32_bf16 v66, s90, v200
v_dot2c_f32_bf16 v67, s91, v200
v_dot2c_f32_bf16 v68, s90, v201
v_dot2c_f32_bf16 v69, s91, v201
s_waitcnt vmcnt(16)
v_dot2c_f32_bf16 v66, s90, v202
v_dot2c_f32_bf16 v67, s91, v202
v_dot2c_f32_bf16 v68, s90, v203
v_dot2c_f32_bf16 v69, s91, v203
s_waitcnt vmcnt(15)
v_dot2c_f32_bf16 v66, s90, v204
v_dot2c_f32_bf16 v67, s91, v204
v_dot2c_f32_bf16 v68, s90, v205
v_dot2c_f32_bf16 v69, s91, v205
s_waitcnt vmcnt(14)
v_dot2c_f32_bf16 v66, s90, v206
v_dot2c_f32_bf16 v67, s91, v206
v_dot2c_f32_bf16 v68, s90, v207
v_dot2c_f32_bf16 v69, s91, v207
s_waitcnt vmcnt(13)
v_dot2c_f32_bf16 v66, s90, v208
v_dot2c_f32_bf16 v67, s91, v208
v_dot2c_f32_bf16 v68, s90, v209
v_dot2c_f32_bf16 v69, s91, v209
s_waitcnt vmcnt(12)
v_dot2c_f32_bf16 v66, s90, v210
v_dot2c_f32_bf16 v67, s91, v210
v_dot2c_f32_bf16 v68, s90, v211
v_dot2c_f32_bf16 v69, s91, v211
s_waitcnt vmcnt(11)
v_dot2c_f32_bf16 v66, s90, v212
v_dot2c_f32_bf16 v67, s91, v212
v_dot2c_f32_bf16 v68, s90, v213
v_dot2c_f32_bf16 v69, s91, v213
s_waitcnt vmcnt(10)
v_dot2c_f32_bf16 v66, s90, v214
v_dot2c_f32_bf16 v67, s91, v214
v_dot2c_f32_bf16 v68, s90, v215
v_dot2c_f32_bf16 v69, s91, v215
s_nop 2
s_cmp_eq_u32 s34, 0
s_cselect_b32 s29, 0, 0x7fbffff0
v_cvt_pk_bf16_f32 v58, v66, v67
v_cvt_pk_bf16_f32 v59, v68, v69
v_lshlrev_b32 v66, 16, v58
v_and_b32 v67, 0xffff0000, v58
v_lshlrev_b32 v68, 16, v59
v_and_b32 v69, 0xffff0000, v59
v_pk_mul_f32 v[66:67], v[66:67], v[54:55]
v_pk_mul_f32 v[68:69], v[68:69], v[56:57]
v_cvt_pk_bf16_f32 v58, v66, v67
v_cvt_pk_bf16_f32 v59, v68, v69
v_lshlrev_b32 v66, 16, v58
v_and_b32 v67, 0xffff0000, v58
v_lshlrev_b32 v68, 16, v59
v_and_b32 v69, 0xffff0000, v59
v_pk_add_f32 v[66:67], v[66:67], v[34:35]
v_pk_add_f32 v[68:69], v[68:69], v[36:37]
v_cvt_pk_bf16_f32 v66, v66, v67
v_cvt_pk_bf16_f32 v67, v68, v69
buffer_store_dwordx2 v[66:67], v249, s[60:63], s29 offen
s_waitcnt vmcnt(7)
v_dot2c_f32_bf16 v136, s90, v80
v_dot2c_f32_bf16 v137, s91, v80
v_dot2c_f32_bf16 v138, s90, v81
v_dot2c_f32_bf16 v139, s91, v81
v_dot2c_f32_bf16 v140, s90, v82
v_dot2c_f32_bf16 v141, s91, v82
v_dot2c_f32_bf16 v142, s90, v83
v_dot2c_f32_bf16 v143, s91, v83
s_waitcnt vmcnt(6)
v_dot2c_f32_bf16 v136, s90, v84
v_dot2c_f32_bf16 v137, s91, v84
v_dot2c_f32_bf16 v138, s90, v85
v_dot2c_f32_bf16 v139, s91, v85
v_dot2c_f32_bf16 v140, s90, v86
v_dot2c_f32_bf16 v141, s91, v86
v_dot2c_f32_bf16 v142, s90, v87
v_dot2c_f32_bf16 v143, s91, v87
s_waitcnt vmcnt(5)
v_dot2c_f32_bf16 v136, s90, v88
v_dot2c_f32_bf16 v137, s91, v88
v_dot2c_f32_bf16 v138, s90, v89
v_dot2c_f32_bf16 v139, s91, v89
v_dot2c_f32_bf16 v140, s90, v90
v_dot2c_f32_bf16 v141, s91, v90
v_dot2c_f32_bf16 v142, s90, v91
v_dot2c_f32_bf16 v143, s91, v91
s_waitcnt vmcnt(4)
v_dot2c_f32_bf16 v136, s90, v92
v_dot2c_f32_bf16 v137, s91, v92
v_dot2c_f32_bf16 v138, s90, v93
v_dot2c_f32_bf16 v139, s91, v93
v_dot2c_f32_bf16 v140, s90, v94
v_dot2c_f32_bf16 v141, s91, v94
v_dot2c_f32_bf16 v142, s90, v95
v_dot2c_f32_bf16 v143, s91, v95
s_waitcnt vmcnt(3)
v_dot2c_f32_bf16 v136, s90, v96
v_dot2c_f32_bf16 v137, s91, v96
v_dot2c_f32_bf16 v138, s90, v97
v_dot2c_f32_bf16 v139, s91, v97
v_dot2c_f32_bf16 v140, s90, v98
v_dot2c_f32_bf16 v141, s91, v98
v_dot2c_f32_bf16 v142, s90, v99
v_dot2c_f32_bf16 v143, s91, v99
s_waitcnt vmcnt(2)
v_dot2c_f32_bf16 v136, s90, v100
v_dot2c_f32_bf16 v137, s91, v100
v_dot2c_f32_bf16 v138, s90, v101
v_dot2c_f32_bf16 v139, s91, v101
v_dot2c_f32_bf16 v140, s90, v102
v_dot2c_f32_bf16 v141, s91, v102
v_dot2c_f32_bf16 v142, s90, v103
v_dot2c_f32_bf16 v143, s91, v103
s_waitcnt vmcnt(1)
v_dot2c_f32_bf16 v136, s90, v132
v_dot2c_f32_bf16 v137, s91, v132
v_dot2c_f32_bf16 v138, s90, v133
v_dot2c_f32_bf16 v139, s91, v133
v_dot2c_f32_bf16 v140, s90, v134
v_dot2c_f32_bf16 v141, s91, v134
v_dot2c_f32_bf16 v142, s90, v135
v_dot2c_f32_bf16 v143, s91, v135
s_nop 2
v_cvt_pk_bf16_f32 v58, v136, v137
v_cvt_pk_bf16_f32 v59, v138, v139
v_cvt_pk_bf16_f32 v60, v140, v141
v_cvt_pk_bf16_f32 v61, v142, v143
v_lshlrev_b32 v136, 16, v58
v_and_b32 v137, 0xffff0000, v58
v_lshlrev_b32 v138, 16, v59
v_and_b32 v139, 0xffff0000, v59
v_lshlrev_b32 v140, 16, v60
v_and_b32 v141, 0xffff0000, v60
v_lshlrev_b32 v142, 16, v61
v_and_b32 v143, 0xffff0000, v61
v_pk_mul_f32 v[136:137], v[136:137], v[46:47]
v_pk_mul_f32 v[138:139], v[138:139], v[48:49]
v_pk_mul_f32 v[140:141], v[140:141], v[50:51]
v_pk_mul_f32 v[142:143], v[142:143], v[52:53]
v_cvt_pk_bf16_f32 v58, v136, v137
v_cvt_pk_bf16_f32 v59, v138, v139
v_cvt_pk_bf16_f32 v60, v140, v141
v_cvt_pk_bf16_f32 v61, v142, v143
v_lshlrev_b32 v136, 16, v58
v_and_b32 v137, 0xffff0000, v58
v_lshlrev_b32 v138, 16, v59
v_and_b32 v139, 0xffff0000, v59
v_lshlrev_b32 v140, 16, v60
v_and_b32 v141, 0xffff0000, v60
v_lshlrev_b32 v142, 16, v61
v_and_b32 v143, 0xffff0000, v61
v_pk_add_f32 v[136:137], v[136:137], v[26:27]
v_pk_add_f32 v[138:139], v[138:139], v[28:29]
v_pk_add_f32 v[140:141], v[140:141], v[30:31]
v_pk_add_f32 v[142:143], v[142:143], v[32:33]
v_cvt_pk_bf16_f32 v136, v136, v137
v_cvt_pk_bf16_f32 v137, v138, v139
v_cvt_pk_bf16_f32 v138, v140, v141
v_cvt_pk_bf16_f32 v139, v142, v143
buffer_store_dwordx4 v[136:139], v248, s[60:63], 0 offen offset:128
K_END:
s_endpgm
K_EVT:
STUB_17:
s_cbranch_execz HOP_RET2
s_sub_u32 s3, s33, 1
s_cmp_eq_u32 s33, 5
s_cbranch_scc0 EV_Y
s_sub_u32 s28, s40, 0
s_cmp_lt_u32 s28, 72
s_cselect_b32 s3, 4, 0
s_cmp_eq_u32 s37, 0
s_cbranch_scc0 K_EVT_RET
s_mov_b32 s28, 0x243000
EV_INC:
v_mov_b32 v246, 0
v_mov_b32 v247, 1
s_mov_b64 exec, 1
buffer_atomic_add v247, v246, s[20:23], s28 offen sc1
s_mov_b64 exec, -1
s_branch K_EVT_RET
EV_Y:
s_cmp_eq_u32 s33, 4
s_cbranch_scc0 EV_Y4
v_mov_b32 v246, 0
s_mov_b32 s28, 0x243000
buffer_load_dword v247, v246, s[20:23], s28 offen sc0 sc1
s_branch K_EVT_RET
EV_Y4:
s_cmp_eq_u32 s33, 1
s_cbranch_scc0 EV_Y5
s_mov_b32 s28, 0x243080
s_bitcmp0_b32 s37, 0
s_cbranch_scc1 EV_INC
s_branch K_EVT_RET
EV_Y5:
s_sub_u32 s29, s40, 0
s_lshr_b32 s28, s37, 1
s_lshl1_add_u32 s29, s29, s28
s_cmp_eq_u32 s33, 3
s_cbranch_scc0 EV_Y3
v_readfirstlane_b32 s28, v247
s_cmp_ge_u32 s28, 144
s_cbranch_scc0 EV_Y4SP
EV_Y4OK:
v_lshrrev_b32 v246, 3, v1
v_mul_u32_u24 v246, 18432, v246
v_and_b32 v247, 7, v1
v_lshl_add_u32 v246, v247, 4, v246
s_lshl_b32 s28, s29, 7
s_and_b32 s29, s37, 1
s_mul_i32 s29, s29, 1327104
s_add_u32 s28, s28, s29
s_add_u32 s28, s28, 0x2000000
buffer_load_dwordx4 v[104:107], v246, s[20:23], s28 offen sc0 sc1
s_add_u32 s28, s28, 147456
buffer_load_dwordx4 v[108:111], v246, s[20:23], s28 offen sc0 sc1
s_add_u32 s28, s28, 147456
buffer_load_dwordx4 v[112:115], v246, s[20:23], s28 offen sc0 sc1
s_add_u32 s28, s28, 147456
buffer_load_dwordx4 v[116:119], v246, s[20:23], s28 offen sc0 sc1
s_add_u32 s28, s28, 147456
buffer_load_dwordx4 v[120:123], v246, s[20:23], s28 offen sc0 sc1
s_add_u32 s28, s28, 147456
buffer_load_dwordx4 v[124:127], v246, s[20:23], s28 offen sc0 sc1
s_add_u32 s28, s28, 147456
buffer_load_dwordx4 v[128:131], v246, s[20:23], s28 offen sc0 sc1
s_add_u32 s28, s28, 147456
buffer_load_dwordx4 v[132:135], v246, s[20:23], s28 offen sc0 sc1
s_add_u32 s28, s28, 147456
buffer_load_dwordx4 v[248:251], v246, s[20:23], s28 offen sc0 sc1
s_branch K_EVT_RET
EV_Y3:
STUB_18:
s_cbranch_execz HOP_RET2
v_pk_add_f32 v[104:105], v[104:105], v[108:109]
v_pk_add_f32 v[106:107], v[106:107], v[110:111]
v_pk_add_f32 v[112:113], v[112:113], v[116:117]
v_pk_add_f32 v[114:115], v[114:115], v[118:119]
v_pk_add_f32 v[120:121], v[120:121], v[124:125]
v_pk_add_f32 v[122:123], v[122:123], v[126:127]
v_pk_add_f32 v[128:129], v[128:129], v[132:133]
v_pk_add_f32 v[130:131], v[130:131], v[134:135]
v_pk_add_f32 v[104:105], v[104:105], v[112:113]
v_pk_add_f32 v[106:107], v[106:107], v[114:115]
v_pk_add_f32 v[120:121], v[120:121], v[128:129]
v_pk_add_f32 v[122:123], v[122:123], v[130:131]
v_pk_add_f32 v[104:105], v[104:105], v[248:249]
v_pk_add_f32 v[106:107], v[106:107], v[250:251]
v_pk_add_f32 v[104:105], v[104:105], v[120:121]
v_pk_add_f32 v[106:107], v[106:107], v[122:123]
v_and_b32 v246, 7, v1
s_lshr_b32 s28, s37, 1
s_lshl_b32 s28, s28, 7
v_add_f32_dpp v108, v104, v104 row_ror:8 row_mask:0xf bank_mask:0xf
v_add_f32_dpp v109, v105, v105 row_ror:8 row_mask:0xf bank_mask:0xf
v_add_f32_dpp v110, v106, v106 row_ror:8 row_mask:0xf bank_mask:0xf
v_add_f32_dpp v111, v107, v107 row_ror:8 row_mask:0xf bank_mask:0xf
v_mov_b32 v104, v108
v_mov_b32 v105, v109
v_mov_b32 v106, v110
v_mov_b32 v107, v111
v_permlane16_swap_b32 v104, v108
v_permlane16_swap_b32 v105, v109
v_permlane16_swap_b32 v106, v110
v_permlane16_swap_b32 v107, v111
v_add_f32 v108, v104, v108
v_add_f32 v109, v105, v109
v_add_f32 v110, v106, v110
v_add_f32 v111, v107, v111
v_mov_b32 v104, v108
v_mov_b32 v105, v109
v_mov_b32 v106, v110
v_mov_b32 v107, v111
v_permlane32_swap_b32 v104, v108
v_permlane32_swap_b32 v105, v109
v_permlane32_swap_b32 v106, v110
v_permlane32_swap_b32 v107, v111
v_add_f32 v108, v104, v108
v_add_f32 v109, v105, v109
v_add_f32 v110, v106, v110
v_add_f32 v111, v107, v111
v_lshlrev_b32 v247, 4, v246
v_add_u32 v247, s28, v247
s_bitcmp1_b32 s37, 0
s_cbranch_scc0 EV_YE
ds_write_b128 v247, v[108:111] offset:65024
s_waitcnt lgkmcnt(0)
s_barrier
s_branch K_EVT_RET
EV_YE:
s_barrier
ds_read_b128 v[104:107], v247 offset:65024
v_mul_u32_u24 v246, 0x480, v246
s_lshl_b32 s28, s29, 3
s_add_u32 s28, s28, 0x244000
s_waitcnt lgkmcnt(0)
v_pk_add_f32 v[104:105], v[104:105], v[108:109]
v_pk_add_f32 v[106:107], v[106:107], v[110:111]
v_cvt_pk_bf16_f32 v108, v104, v105
v_cvt_pk_bf16_f32 v109, v106, v107
v_lshlrev_b32 v104, 16, v108
v_and_b32 v105, 0xffff0000, v108
v_lshlrev_b32 v106, 16, v109
v_and_b32 v107, 0xffff0000, v109
v_mul_f32 v104, v104, v236
v_mul_f32 v105, v105, v236
v_mul_f32 v106, v106, v236
v_mul_f32 v107, v107, v236
v_cvt_pk_bf16_f32 v108, v104, v105
v_cvt_pk_bf16_f32 v109, v106, v107
s_mov_b64 exec, 0xff
buffer_store_dwordx2 v[108:109], v246, s[20:23], s28 offen sc0 sc1
s_mov_b64 exec, -1
s_branch K_EVT_RET
SP_X0:
s_sleep 2
s_add_u32 s100, s100, 1
s_bitcmp1_b32 s100, 19
s_cbranch_scc1 K_END
buffer_load_dword v193, v192, s[24:27], 0 offen sc0 sc1
s_waitcnt vmcnt(0)
v_readfirstlane_b32 s92, v193
s_and_b32 s93, s92, 0xf0
s_cbranch_scc0 SP_X0
s_branch SP_X0_RET
SP_CAND:
s_sleep 2
s_add_u32 s100, s100, 1
s_bitcmp1_b32 s100, 19
s_cbranch_scc1 K_END
s_mov_b32 s29, 0x242000
buffer_load_dwordx2 v[248:249], v250, s[20:23], s29 offen sc0 sc1
s_waitcnt vmcnt(0)
v_cmp_ne_u32 vcc, s47, v249
s_cbranch_vccnz SP_CAND
s_branch SP_CAND_RET
SP_FL:
s_sleep 2
s_add_u32 s100, s100, 1
s_bitcmp1_b32 s100, 19
s_cbranch_scc1 K_END
buffer_load_dword v253, v246, s[24:27], 0 offen sc0 sc1
s_waitcnt vmcnt(0)
v_and_b32 v253, 0x20202020, v253
v_cmp_ne_u32 vcc, 0x20202020, v253
s_cbranch_vccnz SP_FL
s_branch SP_FL_RET
SP_Y:
s_sleep 4
s_add_u32 s100, s100, 1
s_bitcmp1_b32 s100, 19
s_cbranch_scc1 K_END
s_mov_b32 s93, 0x243080
buffer_load_dword v246, v254, s[20:23], s93 offen sc0 sc1
s_waitcnt vmcnt(0)
v_readfirstlane_b32 s93, v246
s_cmp_lt_u32 s93, 144
s_cbranch_scc1 SP_Y
s_branch SP_Y_RET
SP_O1A:
s_sleep 1
s_add_u32 s100, s100, 1
s_bitcmp1_b32 s100, 19
s_cbranch_scc1 K_END
buffer_load_dword v230, v229, s[20:23], s94 offen sc0 sc1
s_waitcnt vmcnt(0)
v_cmp_gt_u32 vcc, 1, v230
s_bitcmp1_b32 vcc_lo, s39
s_cbranch_scc1 SP_O1A
s_branch SP_O1A_RET
SP_O2A:
s_sleep 1
s_add_u32 s100, s100, 1
s_bitcmp1_b32 s100, 19
s_cbranch_scc1 K_END
buffer_load_dword v230, v229, s[20:23], s94 offen sc0 sc1
s_waitcnt vmcnt(0)
v_cmp_gt_u32 vcc, 1, v230
s_and_b32 s29, vcc_lo, 15
s_cbranch_scc1 SP_O2A
s_branch SP_O2A_RET
SP_O3A:
s_sleep 1
s_add_u32 s100, s100, 1
s_bitcmp1_b32 s100, 19
s_cbranch_scc1 K_END
buffer_load_dword v230, v229, s[20:23], s94 offen sc0 sc1
s_waitcnt vmcnt(0)
v_cmp_gt_u32 vcc, 2, v230
s_and_b32 s29, vcc_lo, 15
s_cbranch_scc1 SP_O3A
s_branch SP_O3A_RET
SP_P1A:
s_sleep 1
s_add_u32 s100, s100, 1
s_bitcmp1_b32 s100, 19
s_cbranch_scc1 K_END
buffer_load_dword v230, v229, s[20:23], s95 offen sc0 sc1
s_waitcnt vmcnt(0)
v_cmp_gt_u32 vcc, 1, v230
s_and_b32 s29, vcc_lo, 0xff
s_cbranch_scc1 SP_P1A
s_branch SP_P1A_RET
EV_Y4SP:
s_sleep 8
s_add_u32 s100, s100, 1
s_bitcmp1_b32 s100, 19
s_cbranch_scc1 K_END
v_mov_b32 v246, 0
s_mov_b32 s28, 0x243000
buffer_load_dword v247, v246, s[20:23], s28 offen sc0 sc1
s_waitcnt vmcnt(0)
v_readfirstlane_b32 s28, v247
s_cmp_ge_u32 s28, 144
s_cbranch_scc0 EV_Y4SP
s_branch EV_Y4OK
K_HOT_END:
K_MIXED:
s_waitcnt lgkmcnt(0)
s_barrier
s_add_u32 s28, s30, 147456
v_smfmac_f32_16x16x64_bf16 a[128:131], a[208:211], v[88:95], v245
v_lshrrev_b32 v132, 1, v1
v_and_b32 v132, 8, v132
v_smfmac_f32_16x16x64_bf16 a[132:135], a[208:211], v[96:103], v245
v_xor_b32 v132, v132, v1
v_lshlrev_b32 v132, 4, v132
v_mfma_f32_16x16x32_bf16 a[0:3], v[88:91], a[176:179], a[0:3]
v_add_u32 v132, s28, v132
v_lshlrev_b32 v133, 3, v1
v_mfma_f32_16x16x32_bf16 a[16:19], v[88:91], a[180:183], a[16:19]
v_and_b32 v133, 8, v133
v_lshrrev_b32 v134, 2, v1
v_mfma_f32_16x16x32_bf16 a[32:35], v[88:91], a[184:187], a[32:35]
v_xor_b32 v133, v133, v134
v_and_b32 v134, 3, v1
v_mfma_f32_16x16x32_bf16 a[48:51], v[88:91], a[188:191], a[48:51]
v_lshl_add_u32 v133, v134, 4, v133
v_lshlrev_b32 v133, 4, v133
v_mfma_f32_16x16x32_bf16 a[64:67], v[88:91], a[192:195], a[64:67]
v_add_u32 v133, s28, v133
v_lshlrev_b32 v134, 2, v1
v_mfma_f32_16x16x32_bf16 a[80:83], v[88:91], a[196:199], a[80:83]
v_add_u32 v134, s28, v134
v_lshlrev_b32 v135, 4, v4
v_mfma_f32_16x16x32_bf16 a[96:99], v[88:91], a[200:203], a[96:99]
v_add_u32 v135, s28, v135
v_mfma_f32_16x16x32_bf16 a[112:115], v[88:91], a[204:207], a[112:115]
v_mfma_f32_16x16x32_bf16 a[4:7], v[92:95], a[176:179], a[4:7]
v_accvgpr_read_b32 v120, a128
v_accvgpr_read_b32 v124, a129
v_accvgpr_read_b32 v121, a130
v_mfma_f32_16x16x32_bf16 a[20:23], v[92:95], a[180:183], a[20:23]
v_accvgpr_read_b32 v125, a131
v_accvgpr_read_b32 v122, a132
v_accvgpr_read_b32 v126, a133
v_mfma_f32_16x16x32_bf16 a[36:39], v[92:95], a[184:187], a[36:39]
v_accvgpr_read_b32 v123, a134
v_accvgpr_read_b32 v127, a135
v_add_f32 v120, v120, v124
v_mfma_f32_16x16x32_bf16 a[52:55], v[92:95], a[188:191], a[52:55]
v_add_f32 v121, v121, v125
v_add_f32 v122, v122, v126
v_add_f32 v123, v123, v127
v_mfma_f32_16x16x32_bf16 a[68:71], v[92:95], a[192:195], a[68:71]
v_rcp_f32 v124, v120
v_rcp_f32 v125, v121
v_rcp_f32 v126, v122
v_mfma_f32_16x16x32_bf16 a[84:87], v[92:95], a[196:199], a[84:87]
v_rcp_f32 v127, v123
ds_write_b32 v134, v124 offset:0
ds_write_b32 v134, v125 offset:256
v_mfma_f32_16x16x32_bf16 a[100:103], v[92:95], a[200:203], a[100:103]
ds_write_b32 v134, v126 offset:512
ds_write_b32 v134, v127 offset:768
ds_read_b128 v[72:75], v135 offset:0
v_mfma_f32_16x16x32_bf16 a[116:119], v[92:95], a[204:207], a[116:119]
ds_read_b128 v[76:79], v135 offset:256
ds_read_b128 v[80:83], v135 offset:512
ds_read_b128 v[84:87], v135 offset:768
s_add_u32 s92, s44, 4096
s_add_u32 s93, s44, 8192
s_add_u32 s51, s44, 12288
v_mfma_f32_16x16x32_bf16 a[8:11], v[96:99], a[176:179], a[8:11]
v_accvgpr_read_b32 v104, a0
v_accvgpr_read_b32 v105, a1
v_accvgpr_read_b32 v106, a2
v_accvgpr_read_b32 v107, a3
v_mfma_f32_16x16x32_bf16 a[24:27], v[96:99], a[180:183], a[24:27]
v_accvgpr_read_b32 v108, a16
v_accvgpr_read_b32 v109, a17
v_accvgpr_read_b32 v110, a18
v_accvgpr_read_b32 v111, a19
s_waitcnt lgkmcnt(0)
v_pk_mul_f32 v[104:105], v[104:105], v[72:73]
v_pk_mul_f32 v[106:107], v[106:107], v[74:75]
v_pk_mul_f32 v[108:109], v[108:109], v[72:73]
v_pk_mul_f32 v[110:111], v[110:111], v[74:75]
v_cvt_pk_bf16_f32 v104, v104, v105
v_cvt_pk_bf16_f32 v105, v106, v107
v_cvt_pk_bf16_f32 v106, v108, v109
v_cvt_pk_bf16_f32 v107, v110, v111
v_mfma_f32_16x16x32_bf16 a[40:43], v[96:99], a[184:187], a[40:43]
v_accvgpr_read_b32 v112, a32
v_accvgpr_read_b32 v113, a33
v_accvgpr_read_b32 v114, a34
v_accvgpr_read_b32 v115, a35
ds_write_b128 v132, v[104:107] offset:0
v_mfma_f32_16x16x32_bf16 a[56:59], v[96:99], a[188:191], a[56:59]
v_accvgpr_read_b32 v116, a48
v_accvgpr_read_b32 v117, a49
v_accvgpr_read_b32 v118, a50
v_accvgpr_read_b32 v119, a51
ds_read_b64_tr_b16 v[8:9], v133 offset:0
ds_read_b64_tr_b16 v[10:11], v133 offset:8
v_pk_mul_f32 v[112:113], v[112:113], v[72:73]
v_pk_mul_f32 v[114:115], v[114:115], v[74:75]
v_pk_mul_f32 v[116:117], v[116:117], v[72:73]
v_pk_mul_f32 v[118:119], v[118:119], v[74:75]
v_cvt_pk_bf16_f32 v112, v112, v113
v_cvt_pk_bf16_f32 v113, v114, v115
v_cvt_pk_bf16_f32 v114, v116, v117
v_cvt_pk_bf16_f32 v115, v118, v119
v_mfma_f32_16x16x32_bf16 a[72:75], v[96:99], a[192:195], a[72:75]
v_accvgpr_read_b32 v104, a64
v_accvgpr_read_b32 v105, a65
v_accvgpr_read_b32 v106, a66
v_accvgpr_read_b32 v107, a67
ds_write_b128 v132, v[112:115] offset:1024
v_mfma_f32_16x16x32_bf16 a[88:91], v[96:99], a[196:199], a[88:91]
v_accvgpr_read_b32 v108, a80
v_accvgpr_read_b32 v109, a81
v_accvgpr_read_b32 v110, a82
v_accvgpr_read_b32 v111, a83
ds_read_b64_tr_b16 v[12:13], v133 offset:1024
ds_read_b64_tr_b16 v[14:15], v133 offset:1032
v_pk_mul_f32 v[104:105], v[104:105], v[72:73]
v_pk_mul_f32 v[106:107], v[106:107], v[74:75]
v_pk_mul_f32 v[108:109], v[108:109], v[72:73]
v_pk_mul_f32 v[110:111], v[110:111], v[74:75]
s_waitcnt lgkmcnt(3)
buffer_store_dwordx4 v[8:11], v244, s[20:23], s44 offen offset:0 sc0 sc1
v_cvt_pk_bf16_f32 v104, v104, v105
v_cvt_pk_bf16_f32 v105, v106, v107
v_cvt_pk_bf16_f32 v106, v108, v109
v_cvt_pk_bf16_f32 v107, v110, v111
v_mfma_f32_16x16x32_bf16 a[104:107], v[96:99], a[200:203], a[104:107]
v_accvgpr_read_b32 v112, a96
v_accvgpr_read_b32 v113, a97
v_accvgpr_read_b32 v114, a98
v_accvgpr_read_b32 v115, a99
ds_write_b128 v132, v[104:107] offset:2048
v_mfma_f32_16x16x32_bf16 a[120:123], v[96:99], a[204:207], a[120:123]
v_accvgpr_read_b32 v116, a112
v_accvgpr_read_b32 v117, a113
v_accvgpr_read_b32 v118, a114
v_accvgpr_read_b32 v119, a115
ds_read_b64_tr_b16 v[16:17], v133 offset:2048
ds_read_b64_tr_b16 v[18:19], v133 offset:2056
v_pk_mul_f32 v[112:113], v[112:113], v[72:73]
v_pk_mul_f32 v[114:115], v[114:115], v[74:75]
v_pk_mul_f32 v[116:117], v[116:117], v[72:73]
v_pk_mul_f32 v[118:119], v[118:119], v[74:75]
s_waitcnt lgkmcnt(3)
buffer_store_dwordx4 v[12:15], v244, s[20:23], s44 offen offset:1024 sc0 sc1
v_cvt_pk_bf16_f32 v112, v112, v113
v_cvt_pk_bf16_f32 v113, v114, v115
v_cvt_pk_bf16_f32 v114, v116, v117
v_cvt_pk_bf16_f32 v115, v118, v119
v_mfma_f32_16x16x32_bf16 a[12:15], v[100:103], a[176:179], a[12:15]
v_accvgpr_read_b32 v104, a4
v_accvgpr_read_b32 v105, a5
v_accvgpr_read_b32 v106, a6
v_accvgpr_read_b32 v107, a7
ds_write_b128 v132, v[112:115] offset:3072
v_mfma_f32_16x16x32_bf16 a[28:31], v[100:103], a[180:183], a[28:31]
v_accvgpr_read_b32 v108, a20
v_accvgpr_read_b32 v109, a21
v_accvgpr_read_b32 v110, a22
v_accvgpr_read_b32 v111, a23
ds_read_b64_tr_b16 v[20:21], v133 offset:3072
ds_read_b64_tr_b16 v[22:23], v133 offset:3080
v_pk_mul_f32 v[104:105], v[104:105], v[76:77]
v_pk_mul_f32 v[106:107], v[106:107], v[78:79]
v_pk_mul_f32 v[108:109], v[108:109], v[76:77]
v_pk_mul_f32 v[110:111], v[110:111], v[78:79]
s_waitcnt lgkmcnt(3)
buffer_store_dwordx4 v[16:19], v244, s[20:23], s44 offen offset:2048 sc0 sc1
v_cvt_pk_bf16_f32 v104, v104, v105
v_cvt_pk_bf16_f32 v105, v106, v107
v_cvt_pk_bf16_f32 v106, v108, v109
v_cvt_pk_bf16_f32 v107, v110, v111
v_mfma_f32_16x16x32_bf16 a[44:47], v[100:103], a[184:187], a[44:47]
v_accvgpr_read_b32 v112, a36
v_accvgpr_read_b32 v113, a37
v_accvgpr_read_b32 v114, a38
v_accvgpr_read_b32 v115, a39
ds_write_b128 v132, v[104:107] offset:0
v_mfma_f32_16x16x32_bf16 a[60:63], v[100:103], a[188:191], a[60:63]
v_accvgpr_read_b32 v116, a52
v_accvgpr_read_b32 v117, a53
v_accvgpr_read_b32 v118, a54
v_accvgpr_read_b32 v119, a55
ds_read_b64_tr_b16 v[24:25], v133 offset:0
ds_read_b64_tr_b16 v[26:27], v133 offset:8
v_pk_mul_f32 v[112:113], v[112:113], v[76:77]
v_pk_mul_f32 v[114:115], v[114:115], v[78:79]
v_pk_mul_f32 v[116:117], v[116:117], v[76:77]
v_pk_mul_f32 v[118:119], v[118:119], v[78:79]
s_waitcnt lgkmcnt(3)
buffer_store_dwordx4 v[20:23], v244, s[20:23], s44 offen offset:3072 sc0 sc1
v_cvt_pk_bf16_f32 v112, v112, v113
v_cvt_pk_bf16_f32 v113, v114, v115
v_cvt_pk_bf16_f32 v114, v116, v117
v_cvt_pk_bf16_f32 v115, v118, v119
v_mfma_f32_16x16x32_bf16 a[76:79], v[100:103], a[192:195], a[76:79]
v_accvgpr_read_b32 v104, a68
v_accvgpr_read_b32 v105, a69
v_accvgpr_read_b32 v106, a70
v_accvgpr_read_b32 v107, a71
ds_write_b128 v132, v[112:115] offset:1024
v_mfma_f32_16x16x32_bf16 a[92:95], v[100:103], a[196:199], a[92:95]
v_accvgpr_read_b32 v108, a84
v_accvgpr_read_b32 v109, a85
v_accvgpr_read_b32 v110, a86
v_accvgpr_read_b32 v111, a87
ds_read_b64_tr_b16 v[28:29], v133 offset:1024
ds_read_b64_tr_b16 v[30:31], v133 offset:1032
v_pk_mul_f32 v[104:105], v[104:105], v[76:77]
v_pk_mul_f32 v[106:107], v[106:107], v[78:79]
v_pk_mul_f32 v[108:109], v[108:109], v[76:77]
v_pk_mul_f32 v[110:111], v[110:111], v[78:79]
s_waitcnt lgkmcnt(3)
buffer_store_dwordx4 v[24:27], v244, s[20:23], s92 offen offset:0 sc0 sc1
v_cvt_pk_bf16_f32 v104, v104, v105
v_cvt_pk_bf16_f32 v105, v106, v107
v_cvt_pk_bf16_f32 v106, v108, v109
v_cvt_pk_bf16_f32 v107, v110, v111
v_mfma_f32_16x16x32_bf16 a[108:111], v[100:103], a[200:203], a[108:111]
v_accvgpr_read_b32 v112, a100
v_accvgpr_read_b32 v113, a101
v_accvgpr_read_b32 v114, a102
v_accvgpr_read_b32 v115, a103
ds_write_b128 v132, v[104:107] offset:2048
v_mfma_f32_16x16x32_bf16 a[124:127], v[100:103], a[204:207], a[124:127]
v_accvgpr_read_b32 v116, a116
v_accvgpr_read_b32 v117, a117
v_accvgpr_read_b32 v118, a118
v_accvgpr_read_b32 v119, a119
ds_read_b64_tr_b16 v[32:33], v133 offset:2048
ds_read_b64_tr_b16 v[34:35], v133 offset:2056
v_pk_mul_f32 v[112:113], v[112:113], v[76:77]
v_pk_mul_f32 v[114:115], v[114:115], v[78:79]
v_pk_mul_f32 v[116:117], v[116:117], v[76:77]
v_pk_mul_f32 v[118:119], v[118:119], v[78:79]
s_waitcnt lgkmcnt(3)
buffer_store_dwordx4 v[28:31], v244, s[20:23], s92 offen offset:1024 sc0 sc1
v_cvt_pk_bf16_f32 v112, v112, v113
v_cvt_pk_bf16_f32 v113, v114, v115
v_cvt_pk_bf16_f32 v114, v116, v117
v_cvt_pk_bf16_f32 v115, v118, v119
v_accvgpr_read_b32 v104, a8
v_accvgpr_read_b32 v105, a9
v_accvgpr_read_b32 v106, a10
v_accvgpr_read_b32 v107, a11
ds_write_b128 v132, v[112:115] offset:3072
v_accvgpr_read_b32 v108, a24
v_accvgpr_read_b32 v109, a25
v_accvgpr_read_b32 v110, a26
v_accvgpr_read_b32 v111, a27
ds_read_b64_tr_b16 v[36:37], v133 offset:3072
ds_read_b64_tr_b16 v[38:39], v133 offset:3080
v_pk_mul_f32 v[104:105], v[104:105], v[80:81]
v_pk_mul_f32 v[106:107], v[106:107], v[82:83]
v_pk_mul_f32 v[108:109], v[108:109], v[80:81]
v_pk_mul_f32 v[110:111], v[110:111], v[82:83]
s_waitcnt lgkmcnt(3)
buffer_store_dwordx4 v[32:35], v244, s[20:23], s92 offen offset:2048 sc0 sc1
v_cvt_pk_bf16_f32 v104, v104, v105
v_cvt_pk_bf16_f32 v105, v106, v107
v_cvt_pk_bf16_f32 v106, v108, v109
v_cvt_pk_bf16_f32 v107, v110, v111
v_accvgpr_read_b32 v112, a40
v_accvgpr_read_b32 v113, a41
v_accvgpr_read_b32 v114, a42
v_accvgpr_read_b32 v115, a43
ds_write_b128 v132, v[104:107] offset:0
v_accvgpr_read_b32 v116, a56
v_accvgpr_read_b32 v117, a57
v_accvgpr_read_b32 v118, a58
v_accvgpr_read_b32 v119, a59
ds_read_b64_tr_b16 v[40:41], v133 offset:0
ds_read_b64_tr_b16 v[42:43], v133 offset:8
v_pk_mul_f32 v[112:113], v[112:113], v[80:81]
v_pk_mul_f32 v[114:115], v[114:115], v[82:83]
v_pk_mul_f32 v[116:117], v[116:117], v[80:81]
v_pk_mul_f32 v[118:119], v[118:119], v[82:83]
s_waitcnt lgkmcnt(3)
buffer_store_dwordx4 v[36:39], v244, s[20:23], s92 offen offset:3072 sc0 sc1
v_cvt_pk_bf16_f32 v112, v112, v113
v_cvt_pk_bf16_f32 v113, v114, v115
v_cvt_pk_bf16_f32 v114, v116, v117
v_cvt_pk_bf16_f32 v115, v118, v119
v_accvgpr_read_b32 v104, a72
v_accvgpr_read_b32 v105, a73
v_accvgpr_read_b32 v106, a74
v_accvgpr_read_b32 v107, a75
ds_write_b128 v132, v[112:115] offset:1024
v_accvgpr_read_b32 v108, a88
v_accvgpr_read_b32 v109, a89
v_accvgpr_read_b32 v110, a90
v_accvgpr_read_b32 v111, a91
ds_read_b64_tr_b16 v[44:45], v133 offset:1024
ds_read_b64_tr_b16 v[46:47], v133 offset:1032
v_pk_mul_f32 v[104:105], v[104:105], v[80:81]
v_pk_mul_f32 v[106:107], v[106:107], v[82:83]
v_pk_mul_f32 v[108:109], v[108:109], v[80:81]
v_pk_mul_f32 v[110:111], v[110:111], v[82:83]
s_waitcnt lgkmcnt(3)
buffer_store_dwordx4 v[40:43], v244, s[20:23], s93 offen offset:0 sc0 sc1
v_cvt_pk_bf16_f32 v104, v104, v105
v_cvt_pk_bf16_f32 v105, v106, v107
v_cvt_pk_bf16_f32 v106, v108, v109
v_cvt_pk_bf16_f32 v107, v110, v111
v_accvgpr_read_b32 v112, a104
v_accvgpr_read_b32 v113, a105
v_accvgpr_read_b32 v114, a106
v_accvgpr_read_b32 v115, a107
ds_write_b128 v132, v[104:107] offset:2048
v_accvgpr_read_b32 v116, a120
v_accvgpr_read_b32 v117, a121
v_accvgpr_read_b32 v118, a122
v_accvgpr_read_b32 v119, a123
ds_read_b64_tr_b16 v[48:49], v133 offset:2048
ds_read_b64_tr_b16 v[50:51], v133 offset:2056
v_pk_mul_f32 v[112:113], v[112:113], v[80:81]
v_pk_mul_f32 v[114:115], v[114:115], v[82:83]
v_pk_mul_f32 v[116:117], v[116:117], v[80:81]
v_pk_mul_f32 v[118:119], v[118:119], v[82:83]
s_waitcnt lgkmcnt(3)
buffer_store_dwordx4 v[44:47], v244, s[20:23], s93 offen offset:1024 sc0 sc1
v_cvt_pk_bf16_f32 v112, v112, v113
v_cvt_pk_bf16_f32 v113, v114, v115
v_cvt_pk_bf16_f32 v114, v116, v117
v_cvt_pk_bf16_f32 v115, v118, v119
v_accvgpr_read_b32 v104, a12
v_accvgpr_read_b32 v105, a13
v_accvgpr_read_b32 v106, a14
v_accvgpr_read_b32 v107, a15
ds_write_b128 v132, v[112:115] offset:3072
v_accvgpr_read_b32 v108, a28
v_accvgpr_read_b32 v109, a29
v_accvgpr_read_b32 v110, a30
v_accvgpr_read_b32 v111, a31
ds_read_b64_tr_b16 v[52:53], v133 offset:3072
ds_read_b64_tr_b16 v[54:55], v133 offset:3080
v_pk_mul_f32 v[104:105], v[104:105], v[84:85]
v_pk_mul_f32 v[106:107], v[106:107], v[86:87]
v_pk_mul_f32 v[108:109], v[108:109], v[84:85]
v_pk_mul_f32 v[110:111], v[110:111], v[86:87]
s_waitcnt lgkmcnt(3)
buffer_store_dwordx4 v[48:51], v244, s[20:23], s93 offen offset:2048 sc0 sc1
v_cvt_pk_bf16_f32 v104, v104, v105
v_cvt_pk_bf16_f32 v105, v106, v107
v_cvt_pk_bf16_f32 v106, v108, v109
v_cvt_pk_bf16_f32 v107, v110, v111
v_accvgpr_read_b32 v112, a44
v_accvgpr_read_b32 v113, a45
v_accvgpr_read_b32 v114, a46
v_accvgpr_read_b32 v115, a47
ds_write_b128 v132, v[104:107] offset:0
v_accvgpr_read_b32 v116, a60
v_accvgpr_read_b32 v117, a61
v_accvgpr_read_b32 v118, a62
v_accvgpr_read_b32 v119, a63
ds_read_b64_tr_b16 v[56:57], v133 offset:0
ds_read_b64_tr_b16 v[58:59], v133 offset:8
v_pk_mul_f32 v[112:113], v[112:113], v[84:85]
v_pk_mul_f32 v[114:115], v[114:115], v[86:87]
v_pk_mul_f32 v[116:117], v[116:117], v[84:85]
v_pk_mul_f32 v[118:119], v[118:119], v[86:87]
s_waitcnt lgkmcnt(3)
buffer_store_dwordx4 v[52:55], v244, s[20:23], s93 offen offset:3072 sc0 sc1
v_cvt_pk_bf16_f32 v112, v112, v113
v_cvt_pk_bf16_f32 v113, v114, v115
v_cvt_pk_bf16_f32 v114, v116, v117
v_cvt_pk_bf16_f32 v115, v118, v119
v_accvgpr_read_b32 v104, a76
v_accvgpr_read_b32 v105, a77
v_accvgpr_read_b32 v106, a78
v_accvgpr_read_b32 v107, a79
ds_write_b128 v132, v[112:115] offset:1024
v_accvgpr_read_b32 v108, a92
v_accvgpr_read_b32 v109, a93
v_accvgpr_read_b32 v110, a94
v_accvgpr_read_b32 v111, a95
ds_read_b64_tr_b16 v[60:61], v133 offset:1024
ds_read_b64_tr_b16 v[62:63], v133 offset:1032
v_pk_mul_f32 v[104:105], v[104:105], v[84:85]
v_pk_mul_f32 v[106:107], v[106:107], v[86:87]
v_pk_mul_f32 v[108:109], v[108:109], v[84:85]
v_pk_mul_f32 v[110:111], v[110:111], v[86:87]
s_waitcnt lgkmcnt(3)
buffer_store_dwordx4 v[56:59], v244, s[20:23], s51 offen offset:0 sc0 sc1
v_cvt_pk_bf16_f32 v104, v104, v105
v_cvt_pk_bf16_f32 v105, v106, v107
v_cvt_pk_bf16_f32 v106, v108, v109
v_cvt_pk_bf16_f32 v107, v110, v111
v_accvgpr_read_b32 v112, a108
v_accvgpr_read_b32 v113, a109
v_accvgpr_read_b32 v114, a110
v_accvgpr_read_b32 v115, a111
ds_write_b128 v132, v[104:107] offset:2048
v_accvgpr_read_b32 v116, a124
v_accvgpr_read_b32 v117, a125
v_accvgpr_read_b32 v118, a126
v_accvgpr_read_b32 v119, a127
ds_read_b64_tr_b16 v[64:65], v133 offset:2048
ds_read_b64_tr_b16 v[66:67], v133 offset:2056
v_pk_mul_f32 v[112:113], v[112:113], v[84:85]
v_pk_mul_f32 v[114:115], v[114:115], v[86:87]
v_pk_mul_f32 v[116:117], v[116:117], v[84:85]
v_pk_mul_f32 v[118:119], v[118:119], v[86:87]
s_waitcnt lgkmcnt(3)
buffer_store_dwordx4 v[60:63], v244, s[20:23], s51 offen offset:1024 sc0 sc1
v_cvt_pk_bf16_f32 v112, v112, v113
v_cvt_pk_bf16_f32 v113, v114, v115
v_cvt_pk_bf16_f32 v114, v116, v117
v_cvt_pk_bf16_f32 v115, v118, v119
ds_write_b128 v132, v[112:115] offset:3072
ds_read_b64_tr_b16 v[68:69], v133 offset:3072
ds_read_b64_tr_b16 v[70:71], v133 offset:3080
s_waitcnt lgkmcnt(3)
buffer_store_dwordx4 v[64:67], v244, s[20:23], s51 offen offset:2048 sc0 sc1
v_max3_f32 v104, v120, v121, v122
v_max_f32 v104, v104, v123
v_add_f32 v105, v120, v121
v_add_f32 v105, v105, v122
v_add_f32 v105, v105, v123
v_cmp_nge_f32 vcc, s42, v104
v_cmp_u_f32 s[28:29], v105, v105
s_or_b64 vcc, vcc, s[28:29]
s_cmp_lg_u64 vcc, 0
s_cselect_b32 s28, 1, 0
v_mov_b32 v104, s28
v_mov_b32 v106, 147456
s_waitcnt lgkmcnt(0)
buffer_store_dwordx4 v[68:71], v244, s[20:23], s51 offen offset:3072 sc0 sc1
ds_write_b32 v134, v104
s_waitcnt vmcnt(16) lgkmcnt(0)
s_barrier
ds_read2st64_b32 v[110:111], v106 offset0:32 offset1:48
ds_read2st64_b32 v[108:109], v106 offset0:0 offset1:16
ds_read_b64_tr_b16 a[64:65], v237 offset:0
ds_read_b64_tr_b16 a[66:67], v237 offset:4608
ds_read_b64_tr_b16 a[68:69], v237 offset:9216
ds_read_b64_tr_b16 a[70:71], v237 offset:13824
ds_read_b64_tr_b16 a[72:73], v237 offset:8
ds_read_b64_tr_b16 a[74:75], v237 offset:4616
ds_read_b64_tr_b16 a[76:77], v237 offset:9224
ds_read_b64_tr_b16 a[78:79], v237 offset:13832
ds_read_b64_tr_b16 a[80:81], v238 offset:0
ds_read_b64_tr_b16 a[82:83], v238 offset:4608
ds_read_b64_tr_b16 a[84:85], v238 offset:9216
ds_read_b64_tr_b16 a[86:87], v238 offset:13824
s_waitcnt lgkmcnt(12)
v_or_b32 v108, v108, v109
v_or3_b32 v108, v108, v110, v111
s_nop 0
v_readfirstlane_b32 s28, v108
s_cmp_gt_u32 s28, s43
s_cbranch_scc1 K_FALLBACK
s_waitcnt lgkmcnt(8)
v_mfma_f32_16x16x32_bf16 v[96:99], a[64:67], v[56:59], 0
ds_read_b64_tr_b16 a[88:89], v238 offset:8
ds_read_b64_tr_b16 a[90:91], v238 offset:4616
v_mfma_f32_16x16x32_bf16 v[96:99], a[68:71], v[60:63], v[96:99]
s_lshr_b32 s32, s35, 2
s_and_b32 s33, s35, 3
v_mfma_f32_16x16x32_bf16 v[88:91], a[68:71], v[44:47], 0
s_lshl_b32 s94, s36, 9
s_lshl_b32 s28, s32, 6
v_mfma_f32_16x16x32_bf16 v[88:91], a[64:67], v[40:43], v[88:91]
s_lshr_b32 s34, s32, 2
v_mfma_f32_16x16x32_bf16 v[80:83], a[64:67], v[24:27], 0
ds_read_b64_tr_b16 a[92:93], v238 offset:9224
ds_read_b64_tr_b16 a[94:95], v238 offset:13832
v_mfma_f32_16x16x32_bf16 v[80:83], a[68:71], v[28:31], v[80:83]
s_add_u32 s94, s94, s28
s_lshl_b32 s28, s37, 4
v_mfma_f32_16x16x32_bf16 v[72:75], a[68:71], v[12:15], 0
s_add_u32 s94, s94, s28
s_add_u32 s94, s94, 0x248000
v_mfma_f32_16x16x32_bf16 v[72:75], a[64:67], v[8:11], v[72:75]
v_mov_b32 v231, 1
v_and_b32 v229, 7, v1
s_waitcnt lgkmcnt(8)
v_mfma_f32_16x16x32_bf16 v[76:79], a[72:75], v[8:11], 0
ds_read_b64_tr_b16 a[64:65], v237 offset:128
ds_read_b64_tr_b16 a[66:67], v237 offset:4736
v_mfma_f32_16x16x32_bf16 v[76:79], a[76:79], v[12:15], v[76:79]
v_lshlrev_b32 v229, 2, v229
v_lshlrev_b32 v226, 3, v1
v_mfma_f32_16x16x32_bf16 v[84:87], a[76:79], v[28:31], 0
s_lshl2_add_u32 s29, s33, s94
v_mfma_f32_16x16x32_bf16 v[84:87], a[72:75], v[24:27], v[84:87]
v_mfma_f32_16x16x32_bf16 v[92:95], a[72:75], v[40:43], 0
ds_read_b64_tr_b16 a[68:69], v237 offset:9344
ds_read_b64_tr_b16 a[70:71], v237 offset:13952
v_mfma_f32_16x16x32_bf16 v[92:95], a[76:79], v[44:47], v[92:95]
v_mfma_f32_16x16x32_bf16 v[100:103], a[76:79], v[60:63], 0
v_mfma_f32_16x16x32_bf16 v[100:103], a[72:75], v[56:59], v[100:103]
s_waitcnt lgkmcnt(8)
v_mfma_f32_16x16x32_bf16 v[128:131], a[80:83], v[56:59], 0
ds_read_b64_tr_b16 a[72:73], v237 offset:136
ds_read_b64_tr_b16 a[74:75], v237 offset:4744
v_mfma_f32_16x16x32_bf16 v[128:131], a[84:87], v[60:63], v[128:131]
v_mfma_f32_16x16x32_bf16 v[120:123], a[84:87], v[44:47], 0
v_mfma_f32_16x16x32_bf16 v[120:123], a[80:83], v[40:43], v[120:123]
v_mfma_f32_16x16x32_bf16 v[112:115], a[80:83], v[24:27], 0
ds_read_b64_tr_b16 a[76:77], v237 offset:9352
ds_read_b64_tr_b16 a[78:79], v237 offset:13960
v_mfma_f32_16x16x32_bf16 v[112:115], a[84:87], v[28:31], v[112:115]
s_waitcnt vmcnt(0)
buffer_store_dword v231, v254, s[20:23], s29 offen sc0 sc1
v_mfma_f32_16x16x32_bf16 v[104:107], a[84:87], v[12:15], 0
s_add_u32 s28, s35, 1
s_and_b32 s28, s28, 3
v_mfma_f32_16x16x32_bf16 v[104:107], a[80:83], v[8:11], v[104:107]
s_mul_i32 s28, s28, 36864
s_waitcnt lgkmcnt(8)
v_mfma_f32_16x16x32_bf16 v[108:111], a[88:91], v[8:11], 0
ds_read_b64_tr_b16 a[80:81], v238 offset:128
ds_read_b64_tr_b16 a[82:83], v238 offset:4736
v_mfma_f32_16x16x32_bf16 v[108:111], a[92:95], v[12:15], v[108:111]
v_add_u32 v216, s28, v234
v_add_u32 v217, s28, v235
v_mfma_f32_16x16x32_bf16 v[116:119], a[92:95], v[28:31], 0
v_add_u32 v218, s28, v236
v_mfma_f32_16x16x32_bf16 v[116:119], a[88:91], v[24:27], v[116:119]
v_mfma_f32_16x16x32_bf16 v[124:127], a[88:91], v[40:43], 0
ds_read_b64_tr_b16 a[84:85], v238 offset:9344
ds_read_b64_tr_b16 a[86:87], v238 offset:13952
v_mfma_f32_16x16x32_bf16 v[124:127], a[92:95], v[44:47], v[124:127]
v_mfma_f32_16x16x32_bf16 v[132:135], a[92:95], v[60:63], 0
v_mfma_f32_16x16x32_bf16 v[132:135], a[88:91], v[56:59], v[132:135]
s_waitcnt lgkmcnt(8)
v_mfma_f32_16x16x32_bf16 v[160:163], a[64:67], v[56:59], 0
ds_read_b64_tr_b16 a[88:89], v238 offset:136
ds_read_b64_tr_b16 a[90:91], v238 offset:4744
v_mfma_f32_16x16x32_bf16 v[160:163], a[68:71], v[60:63], v[160:163]
v_mfma_f32_16x16x32_bf16 v[152:155], a[68:71], v[44:47], 0
v_mfma_f32_16x16x32_bf16 v[152:155], a[64:67], v[40:43], v[152:155]
v_mfma_f32_16x16x32_bf16 v[144:147], a[64:67], v[24:27], 0
ds_read_b64_tr_b16 a[92:93], v238 offset:9352
ds_read_b64_tr_b16 a[94:95], v238 offset:13960
v_mfma_f32_16x16x32_bf16 v[144:147], a[68:71], v[28:31], v[144:147]
v_mfma_f32_16x16x32_bf16 v[136:139], a[68:71], v[12:15], 0
v_mfma_f32_16x16x32_bf16 v[136:139], a[64:67], v[8:11], v[136:139]
s_waitcnt lgkmcnt(8)
v_mfma_f32_16x16x32_bf16 v[140:143], a[72:75], v[8:11], 0
ds_read_b64_tr_b16 a[64:65], v239 offset:0
ds_read_b64_tr_b16 a[66:67], v239 offset:4608
v_mfma_f32_16x16x32_bf16 v[140:143], a[76:79], v[12:15], v[140:143]
buffer_load_dword v230, v229, s[20:23], s94 offen sc0 sc1
v_mfma_f32_16x16x32_bf16 v[148:151], a[76:79], v[28:31], 0
s_add_u32 s39, s35, 1
s_and_b32 s39, s39, 3
v_mfma_f32_16x16x32_bf16 v[148:151], a[72:75], v[24:27], v[148:151]
s_add_u32 s28, s33, 1
s_and_b32 s28, s28, 3
v_mfma_f32_16x16x32_bf16 v[156:159], a[72:75], v[40:43], 0
ds_read_b64_tr_b16 a[68:69], v239 offset:9216
ds_read_b64_tr_b16 a[70:71], v239 offset:13824
v_mfma_f32_16x16x32_bf16 v[156:159], a[76:79], v[44:47], v[156:159]
s_sub_u32 s28, s28, s33
s_lshl_b32 s28, s28, 16
v_mfma_f32_16x16x32_bf16 v[164:167], a[76:79], v[60:63], 0
s_add_u32 s64, s28, s44
s_add_u32 s65, s64, 4096
v_mfma_f32_16x16x32_bf16 v[164:167], a[72:75], v[56:59], v[164:167]
s_add_u32 s66, s64, 8192
s_add_u32 s67, s64, 12288
s_waitcnt lgkmcnt(8)
v_mfma_f32_16x16x32_bf16 v[192:195], a[80:83], v[56:59], 0
ds_read_b64_tr_b16 a[72:73], v237 offset:18432
ds_read_b64_tr_b16 a[74:75], v237 offset:23040
v_mfma_f32_16x16x32_bf16 v[192:195], a[84:87], v[60:63], v[192:195]
s_add_u32 s28, s35, 2
s_and_b32 s28, s28, 3
v_mfma_f32_16x16x32_bf16 v[184:187], a[84:87], v[44:47], 0
s_mul_i32 s28, s28, 36864
v_mfma_f32_16x16x32_bf16 v[184:187], a[80:83], v[40:43], v[184:187]
v_add_u32 v219, s28, v234
v_add_u32 v220, s28, v235
v_mfma_f32_16x16x32_bf16 v[176:179], a[80:83], v[24:27], 0
ds_read_b64_tr_b16 a[76:77], v237 offset:27648
ds_read_b64_tr_b16 a[78:79], v237 offset:32256
v_mfma_f32_16x16x32_bf16 v[176:179], a[84:87], v[28:31], v[176:179]
v_add_u32 v221, s28, v236
v_mfma_f32_16x16x32_bf16 v[168:171], a[84:87], v[12:15], 0
s_add_u32 s28, s35, 3
s_and_b32 s28, s28, 3
v_mfma_f32_16x16x32_bf16 v[168:171], a[80:83], v[8:11], v[168:171]
s_mul_i32 s28, s28, 36864
s_waitcnt lgkmcnt(8)
v_mfma_f32_16x16x32_bf16 v[172:175], a[88:91], v[8:11], 0
ds_read_b64_tr_b16 a[80:81], v237 offset:18440
ds_read_b64_tr_b16 a[82:83], v237 offset:23048
v_mfma_f32_16x16x32_bf16 v[172:175], a[92:95], v[12:15], v[172:175]
v_add_u32 v222, s28, v234
v_add_u32 v223, s28, v235
v_mfma_f32_16x16x32_bf16 v[180:183], a[92:95], v[28:31], 0
v_add_u32 v224, s28, v236
v_mfma_f32_16x16x32_bf16 v[180:183], a[88:91], v[24:27], v[180:183]
v_mfma_f32_16x16x32_bf16 v[188:191], a[88:91], v[40:43], 0
ds_read_b64_tr_b16 a[84:85], v237 offset:27656
ds_read_b64_tr_b16 a[86:87], v237 offset:32264
v_mfma_f32_16x16x32_bf16 v[188:191], a[92:95], v[44:47], v[188:191]
v_mfma_f32_16x16x32_bf16 v[196:199], a[92:95], v[60:63], 0
s_waitcnt vmcnt(0)
v_cmp_gt_u32 vcc, 1, v230
v_mfma_f32_16x16x32_bf16 v[196:199], a[88:91], v[56:59], v[196:199]
s_waitcnt lgkmcnt(8)
v_mfma_f32_16x16x32_bf16 v[212:215], a[64:67], v[56:59], 0
ds_read_b64_tr_b16 a[88:89], v238 offset:18432
ds_read_b64_tr_b16 a[90:91], v238 offset:23040
v_mfma_f32_16x16x32_bf16 v[212:215], a[68:71], v[60:63], v[212:215]
s_bitcmp1_b32 vcc_lo, s39
s_cbranch_scc1 SP_O1B
SP_O1B_RET:
v_mfma_f32_16x16x32_bf16 v[208:211], a[68:71], v[44:47], 0
buffer_load_dwordx4 a[128:131], v244, s[20:23], s64 offen offset:0 sc0 sc1
v_mfma_f32_16x16x32_bf16 v[208:211], a[64:67], v[40:43], v[208:211]
v_mfma_f32_16x16x32_bf16 v[204:207], a[64:67], v[24:27], 0
ds_read_b64_tr_b16 a[92:93], v238 offset:27648
ds_read_b64_tr_b16 a[94:95], v238 offset:32256
v_mfma_f32_16x16x32_bf16 v[204:207], a[68:71], v[28:31], v[204:207]
v_mfma_f32_16x16x32_bf16 v[200:203], a[68:71], v[12:15], 0
buffer_load_dwordx4 a[144:147], v244, s[20:23], s65 offen offset:0 sc0 sc1
v_mfma_f32_16x16x32_bf16 v[200:203], a[64:67], v[8:11], v[200:203]
s_waitcnt lgkmcnt(8)
v_mfma_f32_16x16x32_bf16 v[72:75], a[72:75], v[16:19], v[72:75]
ds_read_b64_tr_b16 a[64:65], v238 offset:18440
ds_read_b64_tr_b16 a[66:67], v238 offset:23048
v_mfma_f32_16x16x32_bf16 v[72:75], a[76:79], v[20:23], v[72:75]
v_mfma_f32_16x16x32_bf16 v[80:83], a[76:79], v[36:39], v[80:83]
buffer_load_dwordx4 a[160:163], v244, s[20:23], s66 offen offset:0 sc0 sc1
v_mfma_f32_16x16x32_bf16 v[80:83], a[72:75], v[32:35], v[80:83]
v_mfma_f32_16x16x32_bf16 v[88:91], a[72:75], v[48:51], v[88:91]
ds_read_b64_tr_b16 a[68:69], v238 offset:27656
ds_read_b64_tr_b16 a[70:71], v238 offset:32264
v_mfma_f32_16x16x32_bf16 v[88:91], a[76:79], v[52:55], v[88:91]
v_mfma_f32_16x16x32_bf16 v[96:99], a[76:79], v[68:71], v[96:99]
buffer_load_dwordx4 a[176:179], v244, s[20:23], s67 offen offset:0 sc0 sc1
v_mfma_f32_16x16x32_bf16 v[96:99], a[72:75], v[64:67], v[96:99]
s_waitcnt lgkmcnt(8)
v_mfma_f32_16x16x32_bf16 v[100:103], a[80:83], v[64:67], v[100:103]
ds_read_b64_tr_b16 a[72:73], v237 offset:18560
ds_read_b64_tr_b16 a[74:75], v237 offset:23168
v_mfma_f32_16x16x32_bf16 v[100:103], a[84:87], v[68:71], v[100:103]
v_mfma_f32_16x16x32_bf16 v[92:95], a[84:87], v[52:55], v[92:95]
buffer_load_dwordx4 a[132:135], v244, s[20:23], s64 offen offset:1024 sc0 sc1
v_mfma_f32_16x16x32_bf16 v[92:95], a[80:83], v[48:51], v[92:95]
v_mfma_f32_16x16x32_bf16 v[84:87], a[80:83], v[32:35], v[84:87]
ds_read_b64_tr_b16 a[76:77], v237 offset:27776
ds_read_b64_tr_b16 a[78:79], v237 offset:32384
v_mfma_f32_16x16x32_bf16 v[84:87], a[84:87], v[36:39], v[84:87]
v_mfma_f32_16x16x32_bf16 v[76:79], a[84:87], v[20:23], v[76:79]
buffer_load_dwordx4 a[148:151], v244, s[20:23], s65 offen offset:1024 sc0 sc1
v_mfma_f32_16x16x32_bf16 v[76:79], a[80:83], v[16:19], v[76:79]
s_waitcnt lgkmcnt(8)
v_mfma_f32_16x16x32_bf16 v[104:107], a[88:91], v[16:19], v[104:107]
ds_read_b64_tr_b16 a[80:81], v237 offset:18568
ds_read_b64_tr_b16 a[82:83], v237 offset:23176
v_mfma_f32_16x16x32_bf16 v[104:107], a[92:95], v[20:23], v[104:107]
v_mfma_f32_16x16x32_bf16 v[112:115], a[92:95], v[36:39], v[112:115]
buffer_load_dwordx4 a[164:167], v244, s[20:23], s66 offen offset:1024 sc0 sc1
v_mfma_f32_16x16x32_bf16 v[112:115], a[88:91], v[32:35], v[112:115]
v_mfma_f32_16x16x32_bf16 v[120:123], a[88:91], v[48:51], v[120:123]
ds_read_b64_tr_b16 a[84:85], v237 offset:27784
ds_read_b64_tr_b16 a[86:87], v237 offset:32392
v_mfma_f32_16x16x32_bf16 v[120:123], a[92:95], v[52:55], v[120:123]
v_mfma_f32_16x16x32_bf16 v[128:131], a[92:95], v[68:71], v[128:131]
buffer_load_dwordx4 a[180:183], v244, s[20:23], s67 offen offset:1024 sc0 sc1
v_mfma_f32_16x16x32_bf16 v[128:131], a[88:91], v[64:67], v[128:131]
s_waitcnt lgkmcnt(8)
v_mfma_f32_16x16x32_bf16 v[132:135], a[64:67], v[64:67], v[132:135]
ds_read_b64_tr_b16 a[88:89], v238 offset:18560
ds_read_b64_tr_b16 a[90:91], v238 offset:23168
v_mfma_f32_16x16x32_bf16 v[132:135], a[68:71], v[68:71], v[132:135]
v_mfma_f32_16x16x32_bf16 v[124:127], a[68:71], v[52:55], v[124:127]
buffer_load_dwordx4 a[136:139], v244, s[20:23], s64 offen offset:2048 sc0 sc1
v_mfma_f32_16x16x32_bf16 v[124:127], a[64:67], v[48:51], v[124:127]
buffer_load_dword v230, v229, s[20:23], s94 offen sc0 sc1
v_mfma_f32_16x16x32_bf16 v[116:119], a[64:67], v[32:35], v[116:119]
ds_read_b64_tr_b16 a[92:93], v238 offset:27776
ds_read_b64_tr_b16 a[94:95], v238 offset:32384
v_mfma_f32_16x16x32_bf16 v[116:119], a[68:71], v[36:39], v[116:119]
v_mfma_f32_16x16x32_bf16 v[108:111], a[68:71], v[20:23], v[108:111]
v_mfma_f32_16x16x32_bf16 v[108:111], a[64:67], v[16:19], v[108:111]
buffer_load_dwordx4 a[152:155], v244, s[20:23], s65 offen offset:2048 sc0 sc1
s_waitcnt lgkmcnt(8)
v_mfma_f32_16x16x32_bf16 v[136:139], a[72:75], v[16:19], v[136:139]
ds_read_b64_tr_b16 a[64:65], v238 offset:18568
ds_read_b64_tr_b16 a[66:67], v238 offset:23176
v_mfma_f32_16x16x32_bf16 v[136:139], a[76:79], v[20:23], v[136:139]
v_mfma_f32_16x16x32_bf16 v[144:147], a[76:79], v[36:39], v[144:147]
v_mfma_f32_16x16x32_bf16 v[144:147], a[72:75], v[32:35], v[144:147]
buffer_load_dwordx4 a[168:171], v244, s[20:23], s66 offen offset:2048 sc0 sc1
v_mfma_f32_16x16x32_bf16 v[152:155], a[72:75], v[48:51], v[152:155]
ds_read_b64_tr_b16 a[68:69], v238 offset:27784
ds_read_b64_tr_b16 a[70:71], v238 offset:32392
v_mfma_f32_16x16x32_bf16 v[152:155], a[76:79], v[52:55], v[152:155]
v_mfma_f32_16x16x32_bf16 v[160:163], a[76:79], v[68:71], v[160:163]
v_mfma_f32_16x16x32_bf16 v[160:163], a[72:75], v[64:67], v[160:163]
buffer_load_dwordx4 a[184:187], v244, s[20:23], s67 offen offset:2048 sc0 sc1
s_waitcnt lgkmcnt(8)
v_mfma_f32_16x16x32_bf16 v[164:167], a[80:83], v[64:67], v[164:167]
ds_read_b64_tr_b16 a[72:73], v239 offset:18432
ds_read_b64_tr_b16 a[74:75], v239 offset:23040
v_mfma_f32_16x16x32_bf16 v[164:167], a[84:87], v[68:71], v[164:167]
v_mfma_f32_16x16x32_bf16 v[156:159], a[84:87], v[52:55], v[156:159]
v_mfma_f32_16x16x32_bf16 v[156:159], a[80:83], v[48:51], v[156:159]
buffer_load_dwordx4 a[140:143], v244, s[20:23], s64 offen offset:3072 sc0 sc1
v_mfma_f32_16x16x32_bf16 v[148:151], a[80:83], v[32:35], v[148:151]
ds_read_b64_tr_b16 a[76:77], v239 offset:27648
ds_read_b64_tr_b16 a[78:79], v239 offset:32256
v_mfma_f32_16x16x32_bf16 v[148:151], a[84:87], v[36:39], v[148:151]
v_mfma_f32_16x16x32_bf16 v[140:143], a[84:87], v[20:23], v[140:143]
v_mfma_f32_16x16x32_bf16 v[140:143], a[80:83], v[16:19], v[140:143]
buffer_load_dwordx4 a[156:159], v244, s[20:23], s65 offen offset:3072 sc0 sc1
s_waitcnt lgkmcnt(8)
v_mfma_f32_16x16x32_bf16 v[168:171], a[88:91], v[16:19], v[168:171]
ds_read_b64_tr_b16 a[80:81], v216 offset:0
ds_read_b64_tr_b16 a[82:83], v216 offset:4608
v_mfma_f32_16x16x32_bf16 v[168:171], a[92:95], v[20:23], v[168:171]
v_mfma_f32_16x16x32_bf16 v[176:179], a[92:95], v[36:39], v[176:179]
v_mfma_f32_16x16x32_bf16 v[176:179], a[88:91], v[32:35], v[176:179]
buffer_load_dwordx4 a[172:175], v244, s[20:23], s66 offen offset:3072 sc0 sc1
v_mfma_f32_16x16x32_bf16 v[184:187], a[88:91], v[48:51], v[184:187]
ds_read_b64_tr_b16 a[84:85], v216 offset:9216
ds_read_b64_tr_b16 a[86:87], v216 offset:13824
v_mfma_f32_16x16x32_bf16 v[184:187], a[92:95], v[52:55], v[184:187]
v_mfma_f32_16x16x32_bf16 v[192:195], a[92:95], v[68:71], v[192:195]
v_mfma_f32_16x16x32_bf16 v[192:195], a[88:91], v[64:67], v[192:195]
buffer_load_dwordx4 a[188:191], v244, s[20:23], s67 offen offset:3072 sc0 sc1
s_waitcnt lgkmcnt(8)
v_mfma_f32_16x16x32_bf16 v[196:199], a[64:67], v[64:67], v[196:199]
ds_read_b64_tr_b16 a[88:89], v216 offset:8
ds_read_b64_tr_b16 a[90:91], v216 offset:4616
v_mfma_f32_16x16x32_bf16 v[196:199], a[68:71], v[68:71], v[196:199]
s_add_u32 s28, s33, 2
s_and_b32 s28, s28, 3
v_mfma_f32_16x16x32_bf16 v[188:191], a[68:71], v[52:55], v[188:191]
s_sub_u32 s28, s28, s33
s_lshl_b32 s28, s28, 16
v_mfma_f32_16x16x32_bf16 v[188:191], a[64:67], v[48:51], v[188:191]
s_add_u32 s64, s28, s44
s_add_u32 s65, s64, 4096
v_mfma_f32_16x16x32_bf16 v[180:183], a[64:67], v[32:35], v[180:183]
ds_read_b64_tr_b16 a[92:93], v216 offset:9224
ds_read_b64_tr_b16 a[94:95], v216 offset:13832
v_mfma_f32_16x16x32_bf16 v[180:183], a[68:71], v[36:39], v[180:183]
s_add_u32 s66, s64, 8192
s_add_u32 s67, s64, 12288
v_mfma_f32_16x16x32_bf16 v[172:175], a[68:71], v[20:23], v[172:175]
s_waitcnt vmcnt(7)
v_cmp_gt_u32 vcc, 1, v230
v_mfma_f32_16x16x32_bf16 v[172:175], a[64:67], v[16:19], v[172:175]
s_waitcnt lgkmcnt(8)
v_mfma_f32_16x16x32_bf16 v[200:203], a[72:75], v[16:19], v[200:203]
ds_read_b64_tr_b16 a[64:65], v217 offset:0
ds_read_b64_tr_b16 a[66:67], v217 offset:4608
v_mfma_f32_16x16x32_bf16 v[200:203], a[76:79], v[20:23], v[200:203]
s_and_b32 s29, vcc_lo, 15
s_cbranch_scc1 SP_O2B
SP_O2B_RET:
v_mfma_f32_16x16x32_bf16 v[204:207], a[76:79], v[36:39], v[204:207]
buffer_load_dwordx4 a[192:195], v244, s[20:23], s64 offen offset:0 sc0 sc1
v_mfma_f32_16x16x32_bf16 v[204:207], a[72:75], v[32:35], v[204:207]
v_mfma_f32_16x16x32_bf16 v[208:211], a[72:75], v[48:51], v[208:211]
ds_read_b64_tr_b16 a[68:69], v217 offset:9216
ds_read_b64_tr_b16 a[70:71], v217 offset:13824
v_mfma_f32_16x16x32_bf16 v[208:211], a[76:79], v[52:55], v[208:211]
v_mfma_f32_16x16x32_bf16 v[212:215], a[76:79], v[68:71], v[212:215]
buffer_load_dwordx4 a[208:211], v244, s[20:23], s65 offen offset:0 sc0 sc1
v_mfma_f32_16x16x32_bf16 v[212:215], a[72:75], v[64:67], v[212:215]
s_waitcnt vmcnt(15)
s_waitcnt lgkmcnt(8)
v_mfma_f32_16x16x32_bf16 v[96:99], a[80:83], a[176:179], v[96:99]
ds_read_b64_tr_b16 a[72:73], v217 offset:8
ds_read_b64_tr_b16 a[74:75], v217 offset:4616
s_waitcnt vmcnt(11)
v_mfma_f32_16x16x32_bf16 v[96:99], a[84:87], a[180:183], v[96:99]
v_mfma_f32_16x16x32_bf16 v[88:91], a[84:87], a[164:167], v[88:91]
buffer_load_dwordx4 a[96:99], v244, s[20:23], s66 offen offset:0 sc0 sc1
v_mfma_f32_16x16x32_bf16 v[88:91], a[80:83], a[160:163], v[88:91]
v_accvgpr_read_b32 v39, a222
v_accvgpr_read_b32 v59, a232
v_mfma_f32_16x16x32_bf16 v[80:83], a[80:83], a[144:147], v[80:83]
ds_read_b64_tr_b16 a[76:77], v217 offset:9224
ds_read_b64_tr_b16 a[78:79], v217 offset:13832
v_mfma_f32_16x16x32_bf16 v[80:83], a[84:87], a[148:151], v[80:83]
v_lshlrev_b32 v38, 16, v39
v_and_b32 v39, 0xffff0000, v39
v_mfma_f32_16x16x32_bf16 v[72:75], a[84:87], a[132:135], v[72:75]
buffer_load_dwordx4 a[112:115], v244, s[20:23], s67 offen offset:0 sc0 sc1
v_mfma_f32_16x16x32_bf16 v[72:75], a[80:83], a[128:131], v[72:75]
v_lshlrev_b32 v58, 16, v59
v_and_b32 v59, 0xffff0000, v59
s_waitcnt lgkmcnt(8)
v_mfma_f32_16x16x32_bf16 v[76:79], a[88:91], a[128:131], v[76:79]
ds_read_b64_tr_b16 a[80:81], v216 offset:128
ds_read_b64_tr_b16 a[82:83], v216 offset:4736
v_mfma_f32_16x16x32_bf16 v[76:79], a[92:95], a[132:135], v[76:79]
v_add_f32 v38, v38, v58
v_add_f32 v39, v39, v59
v_mfma_f32_16x16x32_bf16 v[84:87], a[92:95], a[148:151], v[84:87]
buffer_load_dwordx4 a[196:199], v244, s[20:23], s64 offen offset:1024 sc0 sc1
v_mfma_f32_16x16x32_bf16 v[84:87], a[88:91], a[144:147], v[84:87]
v_cvt_pk_bf16_f32 v58, v38, v39
v_lshlrev_b32 v38, 16, v58
v_mfma_f32_16x16x32_bf16 v[92:95], a[88:91], a[160:163], v[92:95]
ds_read_b64_tr_b16 a[84:85], v216 offset:9344
ds_read_b64_tr_b16 a[86:87], v216 offset:13952
v_mfma_f32_16x16x32_bf16 v[92:95], a[92:95], a[164:167], v[92:95]
v_and_b32 v39, 0xffff0000, v58
v_mul_f32 v58, 0xbfb8aa3b, v38
v_mfma_f32_16x16x32_bf16 v[100:103], a[92:95], a[180:183], v[100:103]
buffer_load_dwordx4 a[244:247], v244, s[20:23], s65 offen offset:1024 sc0 sc1
v_mfma_f32_16x16x32_bf16 v[100:103], a[88:91], a[176:179], v[100:103]
v_mul_f32 v59, 0xbfb8aa3b, v39
s_waitcnt lgkmcnt(8)
v_mfma_f32_16x16x32_bf16 v[128:131], a[64:67], a[176:179], v[128:131]
ds_read_b64_tr_b16 a[88:89], v216 offset:136
ds_read_b64_tr_b16 a[90:91], v216 offset:4744
v_mfma_f32_16x16x32_bf16 v[128:131], a[68:71], a[180:183], v[128:131]
v_exp_f32 v58, v58
v_mfma_f32_16x16x32_bf16 v[120:123], a[68:71], a[164:167], v[120:123]
buffer_load_dwordx4 a[100:103], v244, s[20:23], s66 offen offset:1024 sc0 sc1
v_mfma_f32_16x16x32_bf16 v[120:123], a[64:67], a[160:163], v[120:123]
v_exp_f32 v59, v59
v_mfma_f32_16x16x32_bf16 v[112:115], a[64:67], a[144:147], v[112:115]
ds_read_b64_tr_b16 a[92:93], v216 offset:9352
ds_read_b64_tr_b16 a[94:95], v216 offset:13960
v_mfma_f32_16x16x32_bf16 v[112:115], a[68:71], a[148:151], v[112:115]
v_add_f32 v58, 1.0, v58
v_add_f32 v59, 1.0, v59
v_mfma_f32_16x16x32_bf16 v[104:107], a[68:71], a[132:135], v[104:107]
buffer_load_dwordx4 a[116:119], v244, s[20:23], s67 offen offset:1024 sc0 sc1
v_mfma_f32_16x16x32_bf16 v[104:107], a[64:67], a[128:131], v[104:107]
v_rcp_f32 v58, v58
s_waitcnt lgkmcnt(8)
v_mfma_f32_16x16x32_bf16 v[108:111], a[72:75], a[128:131], v[108:111]
ds_read_b64_tr_b16 a[64:65], v217 offset:128
ds_read_b64_tr_b16 a[66:67], v217 offset:4736
v_mfma_f32_16x16x32_bf16 v[108:111], a[76:79], a[132:135], v[108:111]
v_rcp_f32 v59, v59
v_mfma_f32_16x16x32_bf16 v[116:119], a[76:79], a[148:151], v[116:119]
buffer_load_dwordx4 a[200:203], v244, s[20:23], s64 offen offset:2048 sc0 sc1
v_mfma_f32_16x16x32_bf16 v[116:119], a[72:75], a[144:147], v[116:119]
v_mul_f32 v38, v38, v58
v_mul_f32 v39, v39, v59
v_mfma_f32_16x16x32_bf16 v[124:127], a[72:75], a[160:163], v[124:127]
ds_read_b64_tr_b16 a[68:69], v217 offset:9344
ds_read_b64_tr_b16 a[70:71], v217 offset:13952
v_mfma_f32_16x16x32_bf16 v[124:127], a[76:79], a[164:167], v[124:127]
v_cvt_pk_bf16_f32 v58, v38, v39
v_lshlrev_b32 v38, 16, v58
v_mfma_f32_16x16x32_bf16 v[132:135], a[76:79], a[180:183], v[132:135]
buffer_load_dwordx4 a[248:251], v244, s[20:23], s65 offen offset:2048 sc0 sc1
v_mfma_f32_16x16x32_bf16 v[132:135], a[72:75], a[176:179], v[132:135]
v_and_b32 v39, 0xffff0000, v58
v_accvgpr_read_b32 v41, a223
s_waitcnt lgkmcnt(8)
v_mfma_f32_16x16x32_bf16 v[160:163], a[80:83], a[176:179], v[160:163]
ds_read_b64_tr_b16 a[72:73], v217 offset:136
ds_read_b64_tr_b16 a[74:75], v217 offset:4744
v_mfma_f32_16x16x32_bf16 v[160:163], a[84:87], a[180:183], v[160:163]
v_accvgpr_read_b32 v59, a233
v_lshlrev_b32 v40, 16, v41
v_mfma_f32_16x16x32_bf16 v[152:155], a[84:87], a[164:167], v[152:155]
buffer_load_dwordx4 a[104:107], v244, s[20:23], s66 offen offset:2048 sc0 sc1
v_mfma_f32_16x16x32_bf16 v[152:155], a[80:83], a[160:163], v[152:155]
v_and_b32 v41, 0xffff0000, v41
v_lshlrev_b32 v58, 16, v59
v_mfma_f32_16x16x32_bf16 v[144:147], a[80:83], a[144:147], v[144:147]
ds_read_b64_tr_b16 a[76:77], v217 offset:9352
ds_read_b64_tr_b16 a[78:79], v217 offset:13960
v_mfma_f32_16x16x32_bf16 v[144:147], a[84:87], a[148:151], v[144:147]
v_and_b32 v59, 0xffff0000, v59
v_add_f32 v40, v40, v58
v_mfma_f32_16x16x32_bf16 v[136:139], a[84:87], a[132:135], v[136:139]
buffer_load_dwordx4 a[120:123], v244, s[20:23], s67 offen offset:2048 sc0 sc1
v_mfma_f32_16x16x32_bf16 v[136:139], a[80:83], a[128:131], v[136:139]
v_add_f32 v41, v41, v59
v_cvt_pk_bf16_f32 v58, v40, v41
s_waitcnt lgkmcnt(8)
v_mfma_f32_16x16x32_bf16 v[140:143], a[88:91], a[128:131], v[140:143]
ds_read_b64_tr_b16 a[80:81], v218 offset:0
ds_read_b64_tr_b16 a[82:83], v218 offset:4608
v_mfma_f32_16x16x32_bf16 v[140:143], a[92:95], a[132:135], v[140:143]
v_lshlrev_b32 v40, 16, v58
v_and_b32 v41, 0xffff0000, v58
v_mfma_f32_16x16x32_bf16 v[148:151], a[92:95], a[148:151], v[148:151]
buffer_load_dwordx4 a[204:207], v244, s[20:23], s64 offen offset:3072 sc0 sc1
v_mfma_f32_16x16x32_bf16 v[148:151], a[88:91], a[144:147], v[148:151]
v_mul_f32 v58, 0xbfb8aa3b, v40
v_mul_f32 v59, 0xbfb8aa3b, v41
v_mfma_f32_16x16x32_bf16 v[156:159], a[88:91], a[160:163], v[156:159]
ds_read_b64_tr_b16 a[84:85], v218 offset:9216
ds_read_b64_tr_b16 a[86:87], v218 offset:13824
v_mfma_f32_16x16x32_bf16 v[156:159], a[92:95], a[164:167], v[156:159]
v_exp_f32 v58, v58
v_mfma_f32_16x16x32_bf16 v[164:167], a[92:95], a[180:183], v[164:167]
buffer_load_dwordx4 a[252:255], v244, s[20:23], s65 offen offset:3072 sc0 sc1
v_mfma_f32_16x16x32_bf16 v[164:167], a[88:91], a[176:179], v[164:167]
v_exp_f32 v59, v59
s_waitcnt lgkmcnt(8)
v_mfma_f32_16x16x32_bf16 v[192:195], a[64:67], a[176:179], v[192:195]
ds_read_b64_tr_b16 a[88:89], v216 offset:18432
ds_read_b64_tr_b16 a[90:91], v216 offset:23040
v_mfma_f32_16x16x32_bf16 v[192:195], a[68:71], a[180:183], v[192:195]
v_add_f32 v58, 1.0, v58
v_add_f32 v59, 1.0, v59
v_mfma_f32_16x16x32_bf16 v[184:187], a[68:71], a[164:167], v[184:187]
buffer_load_dwordx4 a[108:111], v244, s[20:23], s66 offen offset:3072 sc0 sc1
v_mfma_f32_16x16x32_bf16 v[184:187], a[64:67], a[160:163], v[184:187]
v_rcp_f32 v58, v58
v_mfma_f32_16x16x32_bf16 v[176:179], a[64:67], a[144:147], v[176:179]
ds_read_b64_tr_b16 a[92:93], v216 offset:27648
ds_read_b64_tr_b16 a[94:95], v216 offset:32256
v_mfma_f32_16x16x32_bf16 v[176:179], a[68:71], a[148:151], v[176:179]
v_rcp_f32 v59, v59
v_mfma_f32_16x16x32_bf16 v[168:171], a[68:71], a[132:135], v[168:171]
buffer_load_dwordx4 a[124:127], v244, s[20:23], s67 offen offset:3072 sc0 sc1
v_mfma_f32_16x16x32_bf16 v[168:171], a[64:67], a[128:131], v[168:171]
s_add_u32 s28, s33, 3
s_and_b32 s28, s28, 3
s_waitcnt lgkmcnt(8)
v_mfma_f32_16x16x32_bf16 v[172:175], a[72:75], a[128:131], v[172:175]
ds_read_b64_tr_b16 a[64:65], v216 offset:18440
ds_read_b64_tr_b16 a[66:67], v216 offset:23048
v_mfma_f32_16x16x32_bf16 v[172:175], a[76:79], a[132:135], v[172:175]
s_sub_u32 s28, s28, s33
s_lshl_b32 s28, s28, 16
v_mfma_f32_16x16x32_bf16 v[180:183], a[76:79], a[148:151], v[180:183]
s_add_u32 s64, s28, s44
s_add_u32 s65, s64, 4096
v_mfma_f32_16x16x32_bf16 v[180:183], a[72:75], a[144:147], v[180:183]
s_add_u32 s66, s64, 8192
s_add_u32 s67, s64, 12288
v_mfma_f32_16x16x32_bf16 v[188:191], a[72:75], a[160:163], v[188:191]
ds_read_b64_tr_b16 a[68:69], v216 offset:27656
ds_read_b64_tr_b16 a[70:71], v216 offset:32264
v_mfma_f32_16x16x32_bf16 v[188:191], a[76:79], a[164:167], v[188:191]
buffer_load_dwordx4 a[0:3], v244, s[20:23], s64 offen offset:0 sc0 sc1
v_mfma_f32_16x16x32_bf16 v[196:199], a[76:79], a[180:183], v[196:199]
v_mul_f32 v40, v40, v58
v_mul_f32 v41, v41, v59
v_mfma_f32_16x16x32_bf16 v[196:199], a[72:75], a[176:179], v[196:199]
v_cvt_pk_bf16_f32 v58, v40, v41
v_lshlrev_b32 v40, 16, v58
s_waitcnt lgkmcnt(8)
v_mfma_f32_16x16x32_bf16 v[212:215], a[80:83], a[176:179], v[212:215]
ds_read_b64_tr_b16 a[72:73], v217 offset:18432
ds_read_b64_tr_b16 a[74:75], v217 offset:23040
v_mfma_f32_16x16x32_bf16 v[212:215], a[84:87], a[180:183], v[212:215]
buffer_load_dwordx4 a[16:19], v244, s[20:23], s65 offen offset:0 sc0 sc1
v_mfma_f32_16x16x32_bf16 v[208:211], a[84:87], a[164:167], v[208:211]
v_and_b32 v41, 0xffff0000, v58
v_accvgpr_read_b32 v43, a224
v_mfma_f32_16x16x32_bf16 v[208:211], a[80:83], a[160:163], v[208:211]
v_accvgpr_read_b32 v59, a234
v_lshlrev_b32 v42, 16, v43
v_mfma_f32_16x16x32_bf16 v[204:207], a[80:83], a[144:147], v[204:207]
ds_read_b64_tr_b16 a[76:77], v217 offset:27648
ds_read_b64_tr_b16 a[78:79], v217 offset:32256
v_mfma_f32_16x16x32_bf16 v[204:207], a[84:87], a[148:151], v[204:207]
buffer_load_dwordx4 a[32:35], v244, s[20:23], s66 offen offset:0 sc0 sc1
v_mfma_f32_16x16x32_bf16 v[200:203], a[84:87], a[132:135], v[200:203]
v_and_b32 v43, 0xffff0000, v43
v_lshlrev_b32 v58, 16, v59
v_mfma_f32_16x16x32_bf16 v[200:203], a[80:83], a[128:131], v[200:203]
v_and_b32 v59, 0xffff0000, v59
v_add_f32 v42, v42, v58
s_waitcnt vmcnt(23)
s_waitcnt lgkmcnt(8)
v_mfma_f32_16x16x32_bf16 v[72:75], a[88:91], a[136:139], v[72:75]
ds_read_b64_tr_b16 a[80:81], v217 offset:18440
ds_read_b64_tr_b16 a[82:83], v217 offset:23048
s_waitcnt vmcnt(19)
v_mfma_f32_16x16x32_bf16 v[72:75], a[92:95], a[140:143], v[72:75]
buffer_load_dwordx4 a[48:51], v244, s[20:23], s67 offen offset:0 sc0 sc1
v_mfma_f32_16x16x32_bf16 v[80:83], a[92:95], a[156:159], v[80:83]
v_add_f32 v43, v43, v59
v_cvt_pk_bf16_f32 v58, v42, v43
v_mfma_f32_16x16x32_bf16 v[80:83], a[88:91], a[152:155], v[80:83]
v_lshlrev_b32 v42, 16, v58
v_and_b32 v43, 0xffff0000, v58
v_mfma_f32_16x16x32_bf16 v[88:91], a[88:91], a[168:171], v[88:91]
ds_read_b64_tr_b16 a[84:85], v217 offset:27656
ds_read_b64_tr_b16 a[86:87], v217 offset:32264
v_mfma_f32_16x16x32_bf16 v[88:91], a[92:95], a[172:175], v[88:91]
buffer_load_dwordx4 a[4:7], v244, s[20:23], s64 offen offset:1024 sc0 sc1
v_mfma_f32_16x16x32_bf16 v[96:99], a[92:95], a[188:191], v[96:99]
v_mul_f32 v58, 0xbfb8aa3b, v42
v_mul_f32 v59, 0xbfb8aa3b, v43
v_mfma_f32_16x16x32_bf16 v[96:99], a[88:91], a[184:187], v[96:99]
v_exp_f32 v58, v58
s_waitcnt lgkmcnt(8)
v_mfma_f32_16x16x32_bf16 v[100:103], a[64:67], a[184:187], v[100:103]
ds_read_b64_tr_b16 a[88:89], v216 offset:18560
ds_read_b64_tr_b16 a[90:91], v216 offset:23168
v_mfma_f32_16x16x32_bf16 v[100:103], a[68:71], a[188:191], v[100:103]
buffer_load_dwordx4 a[20:23], v244, s[20:23], s65 offen offset:1024 sc0 sc1
v_mfma_f32_16x16x32_bf16 v[92:95], a[68:71], a[172:175], v[92:95]
v_exp_f32 v59, v59
v_mfma_f32_16x16x32_bf16 v[92:95], a[64:67], a[168:171], v[92:95]
v_add_f32 v58, 1.0, v58
v_add_f32 v59, 1.0, v59
v_mfma_f32_16x16x32_bf16 v[84:87], a[64:67], a[152:155], v[84:87]
ds_read_b64_tr_b16 a[92:93], v216 offset:27776
ds_read_b64_tr_b16 a[94:95], v216 offset:32384
v_mfma_f32_16x16x32_bf16 v[84:87], a[68:71], a[156:159], v[84:87]
buffer_load_dwordx4 a[36:39], v244, s[20:23], s66 offen offset:1024 sc0 sc1
v_mfma_f32_16x16x32_bf16 v[76:79], a[68:71], a[140:143], v[76:79]
v_rcp_f32 v58, v58
v_mfma_f32_16x16x32_bf16 v[76:79], a[64:67], a[136:139], v[76:79]
v_rcp_f32 v59, v59
s_waitcnt lgkmcnt(8)
v_mfma_f32_16x16x32_bf16 v[104:107], a[72:75], a[136:139], v[104:107]
ds_read_b64_tr_b16 a[64:65], v216 offset:18568
ds_read_b64_tr_b16 a[66:67], v216 offset:23176
v_mfma_f32_16x16x32_bf16 v[104:107], a[76:79], a[140:143], v[104:107]
buffer_load_dwordx4 a[52:55], v244, s[20:23], s67 offen offset:1024 sc0 sc1
v_mfma_f32_16x16x32_bf16 v[112:115], a[76:79], a[156:159], v[112:115]
v_mul_f32 v42, v42, v58
v_mul_f32 v43, v43, v59
v_mfma_f32_16x16x32_bf16 v[112:115], a[72:75], a[152:155], v[112:115]
v_cvt_pk_bf16_f32 v58, v42, v43
v_lshlrev_b32 v42, 16, v58
v_mfma_f32_16x16x32_bf16 v[120:123], a[72:75], a[168:171], v[120:123]
ds_read_b64_tr_b16 a[68:69], v216 offset:27784
ds_read_b64_tr_b16 a[70:71], v216 offset:32392
v_mfma_f32_16x16x32_bf16 v[120:123], a[76:79], a[172:175], v[120:123]
buffer_load_dwordx4 a[8:11], v244, s[20:23], s64 offen offset:2048 sc0 sc1
v_mfma_f32_16x16x32_bf16 v[128:131], a[76:79], a[188:191], v[128:131]
v_and_b32 v43, 0xffff0000, v58
v_accvgpr_read_b32 v45, a225
v_mfma_f32_16x16x32_bf16 v[128:131], a[72:75], a[184:187], v[128:131]
v_accvgpr_read_b32 v59, a235
v_lshlrev_b32 v44, 16, v45
s_waitcnt lgkmcnt(8)
v_mfma_f32_16x16x32_bf16 v[132:135], a[80:83], a[184:187], v[132:135]
ds_read_b64_tr_b16 a[72:73], v217 offset:18560
ds_read_b64_tr_b16 a[74:75], v217 offset:23168
v_mfma_f32_16x16x32_bf16 v[132:135], a[84:87], a[188:191], v[132:135]
buffer_load_dwordx4 a[24:27], v244, s[20:23], s65 offen offset:2048 sc0 sc1
v_mfma_f32_16x16x32_bf16 v[124:127], a[84:87], a[172:175], v[124:127]
v_and_b32 v45, 0xffff0000, v45
v_lshlrev_b32 v58, 16, v59
v_mfma_f32_16x16x32_bf16 v[124:127], a[80:83], a[168:171], v[124:127]
v_and_b32 v59, 0xffff0000, v59
v_add_f32 v44, v44, v58
v_mfma_f32_16x16x32_bf16 v[116:119], a[80:83], a[152:155], v[116:119]
ds_read_b64_tr_b16 a[76:77], v217 offset:27776
ds_read_b64_tr_b16 a[78:79], v217 offset:32384
v_mfma_f32_16x16x32_bf16 v[116:119], a[84:87], a[156:159], v[116:119]
buffer_load_dwordx4 a[40:43], v244, s[20:23], s66 offen offset:2048 sc0 sc1
v_mfma_f32_16x16x32_bf16 v[108:111], a[84:87], a[140:143], v[108:111]
v_add_f32 v45, v45, v59
v_cvt_pk_bf16_f32 v58, v44, v45
v_mfma_f32_16x16x32_bf16 v[108:111], a[80:83], a[136:139], v[108:111]
v_lshlrev_b32 v44, 16, v58
v_and_b32 v45, 0xffff0000, v58
s_waitcnt lgkmcnt(8)
v_mfma_f32_16x16x32_bf16 v[136:139], a[88:91], a[136:139], v[136:139]
ds_read_b64_tr_b16 a[80:81], v217 offset:18568
ds_read_b64_tr_b16 a[82:83], v217 offset:23176
v_mfma_f32_16x16x32_bf16 v[136:139], a[92:95], a[140:143], v[136:139]
buffer_load_dwordx4 a[56:59], v244, s[20:23], s67 offen offset:2048 sc0 sc1
v_mfma_f32_16x16x32_bf16 v[144:147], a[92:95], a[156:159], v[144:147]
v_mul_f32 v58, 0xbfb8aa3b, v44
v_mul_f32 v59, 0xbfb8aa3b, v45
v_mfma_f32_16x16x32_bf16 v[144:147], a[88:91], a[152:155], v[144:147]
v_exp_f32 v58, v58
v_mfma_f32_16x16x32_bf16 v[152:155], a[88:91], a[168:171], v[152:155]
ds_read_b64_tr_b16 a[84:85], v217 offset:27784
ds_read_b64_tr_b16 a[86:87], v217 offset:32392
v_mfma_f32_16x16x32_bf16 v[152:155], a[92:95], a[172:175], v[152:155]
buffer_load_dwordx4 a[12:15], v244, s[20:23], s64 offen offset:3072 sc0 sc1
v_mfma_f32_16x16x32_bf16 v[160:163], a[92:95], a[188:191], v[160:163]
v_exp_f32 v59, v59
v_mfma_f32_16x16x32_bf16 v[160:163], a[88:91], a[184:187], v[160:163]
v_add_f32 v58, 1.0, v58
v_add_f32 v59, 1.0, v59
s_waitcnt lgkmcnt(8)
v_mfma_f32_16x16x32_bf16 v[164:167], a[64:67], a[184:187], v[164:167]
ds_read_b64_tr_b16 a[88:89], v218 offset:18432
ds_read_b64_tr_b16 a[90:91], v218 offset:23040
v_mfma_f32_16x16x32_bf16 v[164:167], a[68:71], a[188:191], v[164:167]
buffer_load_dwordx4 a[28:31], v244, s[20:23], s65 offen offset:3072 sc0 sc1
v_mfma_f32_16x16x32_bf16 v[156:159], a[68:71], a[172:175], v[156:159]
v_rcp_f32 v58, v58
v_mfma_f32_16x16x32_bf16 v[156:159], a[64:67], a[168:171], v[156:159]
v_rcp_f32 v59, v59
v_mfma_f32_16x16x32_bf16 v[148:151], a[64:67], a[152:155], v[148:151]
ds_read_b64_tr_b16 a[92:93], v218 offset:27648
ds_read_b64_tr_b16 a[94:95], v218 offset:32256
v_mfma_f32_16x16x32_bf16 v[148:151], a[68:71], a[156:159], v[148:151]
buffer_load_dwordx4 a[44:47], v244, s[20:23], s66 offen offset:3072 sc0 sc1
v_mfma_f32_16x16x32_bf16 v[140:143], a[68:71], a[140:143], v[140:143]
v_mul_f32 v44, v44, v58
v_mul_f32 v45, v45, v59
v_mfma_f32_16x16x32_bf16 v[140:143], a[64:67], a[136:139], v[140:143]
v_cvt_pk_bf16_f32 v58, v44, v45
v_lshlrev_b32 v44, 16, v58
s_waitcnt lgkmcnt(8)
v_mfma_f32_16x16x32_bf16 v[168:171], a[72:75], a[136:139], v[168:171]
ds_read_b64_tr_b16 a[64:65], v221 offset:0
ds_read_b64_tr_b16 a[66:67], v221 offset:4608
v_mfma_f32_16x16x32_bf16 v[168:171], a[76:79], a[140:143], v[168:171]
buffer_load_dwordx4 a[60:63], v244, s[20:23], s67 offen offset:3072 sc0 sc1
v_mfma_f32_16x16x32_bf16 v[176:179], a[76:79], a[156:159], v[176:179]
s_lshl2_add_u32 s28, s36, s33
s_lshl2_add_u32 s28, s28, s37
v_mfma_f32_16x16x32_bf16 v[176:179], a[72:75], a[152:155], v[176:179]
s_lshl_b32 s95, s28, 5
s_add_u32 s95, s95, 0x24a000
v_mfma_f32_16x16x32_bf16 v[184:187], a[72:75], a[168:171], v[184:187]
ds_read_b64_tr_b16 a[68:69], v221 offset:9216
ds_read_b64_tr_b16 a[70:71], v221 offset:13824
v_mfma_f32_16x16x32_bf16 v[184:187], a[76:79], a[172:175], v[184:187]
s_lshl_b32 s28, s32, 18
s_sub_u32 s49, s44, s28
v_mfma_f32_16x16x32_bf16 v[192:195], a[76:79], a[188:191], v[192:195]
v_add_u32 v243, 0x2000, v244
v_mov_b32 v246, 2
v_mfma_f32_16x16x32_bf16 v[192:195], a[72:75], a[184:187], v[192:195]
s_lshl2_add_u32 s29, s33, s94
v_and_b32 v45, 0xffff0000, v58
s_waitcnt lgkmcnt(8)
v_mfma_f32_16x16x32_bf16 v[196:199], a[80:83], a[184:187], v[196:199]
ds_read_b64_tr_b16 a[72:73], v221 offset:18432
ds_read_b64_tr_b16 a[74:75], v221 offset:23040
v_mfma_f32_16x16x32_bf16 v[196:199], a[84:87], a[188:191], v[196:199]
v_accvgpr_read_b32 v47, a226
v_accvgpr_read_b32 v59, a236
v_mfma_f32_16x16x32_bf16 v[188:191], a[84:87], a[172:175], v[188:191]
v_lshlrev_b32 v46, 16, v47
v_and_b32 v47, 0xffff0000, v47
v_mfma_f32_16x16x32_bf16 v[188:191], a[80:83], a[168:171], v[188:191]
v_lshlrev_b32 v58, 16, v59
v_and_b32 v59, 0xffff0000, v59
v_mfma_f32_16x16x32_bf16 v[180:183], a[80:83], a[152:155], v[180:183]
ds_read_b64_tr_b16 a[76:77], v221 offset:27648
ds_read_b64_tr_b16 a[78:79], v221 offset:32256
v_mfma_f32_16x16x32_bf16 v[180:183], a[84:87], a[156:159], v[180:183]
v_add_f32 v46, v46, v58
v_add_f32 v47, v47, v59
v_mfma_f32_16x16x32_bf16 v[172:175], a[84:87], a[140:143], v[172:175]
v_cvt_pk_bf16_f32 v58, v46, v47
v_lshlrev_b32 v46, 16, v58
v_mfma_f32_16x16x32_bf16 v[172:175], a[80:83], a[136:139], v[172:175]
v_and_b32 v47, 0xffff0000, v58
v_mul_f32 v58, 0xbfb8aa3b, v46
s_waitcnt lgkmcnt(8)
v_mfma_f32_16x16x32_bf16 v[200:203], a[88:91], a[136:139], v[200:203]
ds_read_b64_tr_b16 a[80:81], v224 offset:0
ds_read_b64_tr_b16 a[82:83], v224 offset:4608
v_mfma_f32_16x16x32_bf16 v[200:203], a[92:95], a[140:143], v[200:203]
v_mul_f32 v59, 0xbfb8aa3b, v47
v_mfma_f32_16x16x32_bf16 v[204:207], a[92:95], a[156:159], v[204:207]
v_exp_f32 v58, v58
v_mfma_f32_16x16x32_bf16 v[204:207], a[88:91], a[152:155], v[204:207]
v_exp_f32 v59, v59
v_mfma_f32_16x16x32_bf16 v[208:211], a[88:91], a[168:171], v[208:211]
ds_read_b64_tr_b16 a[84:85], v224 offset:9216
ds_read_b64_tr_b16 a[86:87], v224 offset:13824
v_mfma_f32_16x16x32_bf16 v[208:211], a[92:95], a[172:175], v[208:211]
v_add_f32 v58, 1.0, v58
v_add_f32 v59, 1.0, v59
v_mfma_f32_16x16x32_bf16 v[212:215], a[92:95], a[188:191], v[212:215]
v_rcp_f32 v58, v58
v_mfma_f32_16x16x32_bf16 v[212:215], a[88:91], a[184:187], v[212:215]
v_rcp_f32 v59, v59
s_waitcnt vmcnt(28)
s_waitcnt lgkmcnt(8)
v_mfma_f32_16x16x32_bf16 v[212:215], a[64:67], a[112:115], v[212:215]
ds_read_b64_tr_b16 a[88:89], v224 offset:18432
ds_read_b64_tr_b16 a[90:91], v224 offset:23040
s_waitcnt vmcnt(24)
v_mfma_f32_16x16x32_bf16 v[212:215], a[68:71], a[116:119], v[212:215]
v_mul_f32 v46, v46, v58
v_mul_f32 v47, v47, v59
v_mfma_f32_16x16x32_bf16 v[208:211], a[68:71], a[100:103], v[208:211]
v_cvt_pk_bf16_f32 v58, v46, v47
v_lshlrev_b32 v46, 16, v58
v_mfma_f32_16x16x32_bf16 v[208:211], a[64:67], a[96:99], v[208:211]
v_and_b32 v47, 0xffff0000, v58
v_accvgpr_read_b32 v49, a227
v_mfma_f32_16x16x32_bf16 v[204:207], a[64:67], a[208:211], v[204:207]
ds_read_b64_tr_b16 a[92:93], v224 offset:27648
ds_read_b64_tr_b16 a[94:95], v224 offset:32256
v_mfma_f32_16x16x32_bf16 v[204:207], a[68:71], a[244:247], v[204:207]
v_accvgpr_read_b32 v59, a237
v_lshlrev_b32 v48, 16, v49
v_mfma_f32_16x16x32_bf16 v[200:203], a[68:71], a[196:199], v[200:203]
v_and_b32 v49, 0xffff0000, v49
v_lshlrev_b32 v58, 16, v59
v_mfma_f32_16x16x32_bf16 v[200:203], a[64:67], a[192:195], v[200:203]
s_waitcnt vmcnt(0)
buffer_store_dword v246, v254, s[20:23], s29 offen sc0 sc1
s_waitcnt vmcnt(21)
s_waitcnt lgkmcnt(8)
v_mfma_f32_16x16x32_bf16 v[200:203], a[72:75], a[200:203], v[200:203]
ds_read_b64_tr_b16 a[64:65], v219 offset:0
ds_read_b64_tr_b16 a[66:67], v219 offset:4608
s_waitcnt vmcnt(17)
v_mfma_f32_16x16x32_bf16 v[200:203], a[76:79], a[204:207], v[200:203]
s_add_u32 s28, s32, 0
s_and_b32 s28, s28, 7
v_mfma_f32_16x16x32_bf16 v[204:207], a[76:79], a[252:255], v[204:207]
s_xor_b32 s29, s28, s32
s_lshl_b32 s28, s28, 18
v_mfma_f32_16x16x32_bf16 v[204:207], a[72:75], a[248:251], v[204:207]
s_add_u32 s28, s28, s49
s_and_b32 s29, s29, 4
v_mfma_f32_16x16x32_bf16 v[208:211], a[72:75], a[104:107], v[208:211]
ds_read_b64_tr_b16 a[68:69], v219 offset:9216
ds_read_b64_tr_b16 a[70:71], v219 offset:13824
v_mfma_f32_16x16x32_bf16 v[208:211], a[76:79], a[108:111], v[208:211]
s_add_u32 s72, s28, 0
s_lshl_b32 s29, s29, 10
v_mfma_f32_16x16x32_bf16 v[212:215], a[76:79], a[124:127], v[212:215]
s_add_u32 s28, s32, 1
s_and_b32 s28, s28, 7
v_mfma_f32_16x16x32_bf16 v[212:215], a[72:75], a[120:123], v[212:215]
s_xor_b32 s29, s28, s32
s_lshl_b32 s28, s28, 18
s_waitcnt vmcnt(13)
s_waitcnt lgkmcnt(8)
v_mfma_f32_16x16x32_bf16 v[212:215], a[80:83], a[48:51], v[212:215]
ds_read_b64_tr_b16 a[72:73], v219 offset:18432
ds_read_b64_tr_b16 a[74:75], v219 offset:23040
s_waitcnt vmcnt(9)
v_mfma_f32_16x16x32_bf16 v[212:215], a[84:87], a[52:55], v[212:215]
s_add_u32 s28, s28, s49
s_and_b32 s29, s29, 4
v_mfma_f32_16x16x32_bf16 v[208:211], a[84:87], a[36:39], v[208:211]
s_add_u32 s73, s28, 8192
s_lshl_b32 s29, s29, 10
v_mfma_f32_16x16x32_bf16 v[208:211], a[80:83], a[32:35], v[208:211]
s_add_u32 s65, s28, s29
v_and_b32 v59, 0xffff0000, v59
v_mfma_f32_16x16x32_bf16 v[204:207], a[80:83], a[16:19], v[204:207]
ds_read_b64_tr_b16 a[76:77], v219 offset:27648
ds_read_b64_tr_b16 a[78:79], v219 offset:32256
v_mfma_f32_16x16x32_bf16 v[204:207], a[84:87], a[20:23], v[204:207]
s_add_u32 s28, s32, 2
s_and_b32 s28, s28, 7
v_mfma_f32_16x16x32_bf16 v[200:203], a[84:87], a[4:7], v[200:203]
s_xor_b32 s29, s28, s32
s_lshl_b32 s28, s28, 18
v_mfma_f32_16x16x32_bf16 v[200:203], a[80:83], a[0:3], v[200:203]
s_add_u32 s28, s28, s49
s_and_b32 s29, s29, 4
s_waitcnt vmcnt(5)
s_waitcnt lgkmcnt(8)
v_mfma_f32_16x16x32_bf16 v[200:203], a[88:91], a[8:11], v[200:203]
ds_read_b64_tr_b16 a[80:81], v222 offset:0
ds_read_b64_tr_b16 a[82:83], v222 offset:4608
s_waitcnt vmcnt(1)
v_mfma_f32_16x16x32_bf16 v[200:203], a[92:95], a[12:15], v[200:203]
s_add_u32 s74, s28, 8192
s_lshl_b32 s29, s29, 10
v_mfma_f32_16x16x32_bf16 v[204:207], a[92:95], a[28:31], v[204:207]
s_add_u32 s66, s28, s29
v_add_f32 v48, v48, v58
v_mfma_f32_16x16x32_bf16 v[204:207], a[88:91], a[24:27], v[204:207]
s_add_u32 s28, s32, 3
s_and_b32 s28, s28, 7
v_mfma_f32_16x16x32_bf16 v[208:211], a[88:91], a[40:43], v[208:211]
ds_read_b64_tr_b16 a[84:85], v222 offset:9216
ds_read_b64_tr_b16 a[86:87], v222 offset:13824
v_mfma_f32_16x16x32_bf16 v[208:211], a[92:95], a[44:47], v[208:211]
s_xor_b32 s29, s28, s32
s_lshl_b32 s28, s28, 18
v_mfma_f32_16x16x32_bf16 v[212:215], a[92:95], a[60:63], v[212:215]
s_add_u32 s28, s28, s49
s_and_b32 s29, s29, 4
v_mfma_f32_16x16x32_bf16 v[212:215], a[88:91], a[56:59], v[212:215]
s_add_u32 s75, s28, 0
s_lshl_b32 s29, s29, 10
s_waitcnt lgkmcnt(8)
v_mfma_f32_16x16x32_bf16 v[96:99], a[64:67], a[112:115], v[96:99]
ds_read_b64_tr_b16 a[88:89], v222 offset:18432
ds_read_b64_tr_b16 a[90:91], v222 offset:23040
v_mfma_f32_16x16x32_bf16 v[96:99], a[68:71], a[116:119], v[96:99]
s_add_u32 s67, s28, s29
v_add_f32 v49, v49, v59
v_mfma_f32_16x16x32_bf16 v[88:91], a[68:71], a[100:103], v[88:91]
buffer_load_dword v230, v229, s[20:23], s94 offen sc0 sc1
v_mfma_f32_16x16x32_bf16 v[88:91], a[64:67], a[96:99], v[88:91]
s_add_u32 s28, s32, 4
s_and_b32 s28, s28, 7
v_mfma_f32_16x16x32_bf16 v[80:83], a[64:67], a[208:211], v[80:83]
ds_read_b64_tr_b16 a[92:93], v222 offset:27648
ds_read_b64_tr_b16 a[94:95], v222 offset:32256
v_mfma_f32_16x16x32_bf16 v[80:83], a[68:71], a[244:247], v[80:83]
s_xor_b32 s29, s28, s32
s_lshl_b32 s28, s28, 18
v_mfma_f32_16x16x32_bf16 v[72:75], a[68:71], a[196:199], v[72:75]
s_add_u32 s28, s28, s49
s_and_b32 s29, s29, 4
v_mfma_f32_16x16x32_bf16 v[72:75], a[64:67], a[192:195], v[72:75]
s_add_u32 s84, s28, 0
s_lshl_b32 s29, s29, 10
s_waitcnt lgkmcnt(8)
v_mfma_f32_16x16x32_bf16 v[72:75], a[72:75], a[200:203], v[72:75]
ds_read_b64_tr_b16 a[64:65], v219 offset:8
ds_read_b64_tr_b16 a[66:67], v219 offset:4616
v_mfma_f32_16x16x32_bf16 v[72:75], a[76:79], a[204:207], v[72:75]
s_add_u32 s68, s28, s29
v_cvt_pk_bf16_f32 v58, v48, v49
v_mfma_f32_16x16x32_bf16 v[80:83], a[76:79], a[252:255], v[80:83]
s_add_u32 s28, s32, 5
s_and_b32 s28, s28, 7
v_mfma_f32_16x16x32_bf16 v[80:83], a[72:75], a[248:251], v[80:83]
s_xor_b32 s29, s28, s32
s_lshl_b32 s28, s28, 18
v_mfma_f32_16x16x32_bf16 v[88:91], a[72:75], a[104:107], v[88:91]
ds_read_b64_tr_b16 a[68:69], v219 offset:9224
ds_read_b64_tr_b16 a[70:71], v219 offset:13832
v_mfma_f32_16x16x32_bf16 v[88:91], a[76:79], a[108:111], v[88:91]
s_add_u32 s28, s28, s49
s_and_b32 s29, s29, 4
v_mfma_f32_16x16x32_bf16 v[96:99], a[76:79], a[124:127], v[96:99]
s_add_u32 s85, s28, 8192
s_lshl_b32 s29, s29, 10
v_mfma_f32_16x16x32_bf16 v[96:99], a[72:75], a[120:123], v[96:99]
s_add_u32 s69, s28, s29
v_lshlrev_b32 v48, 16, v58
s_waitcnt lgkmcnt(8)
v_mfma_f32_16x16x32_bf16 v[96:99], a[80:83], a[48:51], v[96:99]
ds_read_b64_tr_b16 a[72:73], v219 offset:18440
ds_read_b64_tr_b16 a[74:75], v219 offset:23048
v_mfma_f32_16x16x32_bf16 v[96:99], a[84:87], a[52:55], v[96:99]
s_add_u32 s28, s32, 6
s_and_b32 s28, s28, 7
v_mfma_f32_16x16x32_bf16 v[88:91], a[84:87], a[36:39], v[88:91]
s_xor_b32 s29, s28, s32
s_lshl_b32 s28, s28, 18
v_mfma_f32_16x16x32_bf16 v[88:91], a[80:83], a[32:35], v[88:91]
s_add_u32 s28, s28, s49
s_and_b32 s29, s29, 4
v_mfma_f32_16x16x32_bf16 v[80:83], a[80:83], a[16:19], v[80:83]
ds_read_b64_tr_b16 a[76:77], v219 offset:27656
ds_read_b64_tr_b16 a[78:79], v219 offset:32264
v_mfma_f32_16x16x32_bf16 v[80:83], a[84:87], a[20:23], v[80:83]
s_add_u32 s86, s28, 8192
s_lshl_b32 s29, s29, 10
v_mfma_f32_16x16x32_bf16 v[72:75], a[84:87], a[4:7], v[72:75]
s_add_u32 s70, s28, s29
v_and_b32 v49, 0xffff0000, v58
v_mfma_f32_16x16x32_bf16 v[72:75], a[80:83], a[0:3], v[72:75]
s_add_u32 s28, s32, 7
s_and_b32 s28, s28, 7
s_waitcnt lgkmcnt(8)
v_mfma_f32_16x16x32_bf16 v[72:75], a[88:91], a[8:11], v[72:75]
ds_read_b64_tr_b16 a[80:81], v222 offset:8
ds_read_b64_tr_b16 a[82:83], v222 offset:4616
v_mfma_f32_16x16x32_bf16 v[72:75], a[92:95], a[12:15], v[72:75]
s_xor_b32 s29, s28, s32
s_lshl_b32 s28, s28, 18
v_mfma_f32_16x16x32_bf16 v[80:83], a[92:95], a[28:31], v[80:83]
s_add_u32 s28, s28, s49
s_and_b32 s29, s29, 4
v_mfma_f32_16x16x32_bf16 v[80:83], a[88:91], a[24:27], v[80:83]
s_add_u32 s87, s28, 0
s_lshl_b32 s29, s29, 10
v_mfma_f32_16x16x32_bf16 v[88:91], a[88:91], a[40:43], v[88:91]
ds_read_b64_tr_b16 a[84:85], v222 offset:9224
ds_read_b64_tr_b16 a[86:87], v222 offset:13832
v_mfma_f32_16x16x32_bf16 v[88:91], a[92:95], a[44:47], v[88:91]
s_add_u32 s71, s28, s29
v_mul_f32 v58, 0xbfb8aa3b, v48
v_mfma_f32_16x16x32_bf16 v[96:99], a[92:95], a[60:63], v[96:99]
s_waitcnt vmcnt(0)
v_cmp_gt_u32 vcc, 2, v230
v_mfma_f32_16x16x32_bf16 v[96:99], a[88:91], a[56:59], v[96:99]
v_mul_f32 v59, 0xbfb8aa3b, v49
s_waitcnt lgkmcnt(8)
v_mfma_f32_16x16x32_bf16 v[100:103], a[64:67], a[112:115], v[100:103]
ds_read_b64_tr_b16 a[88:89], v222 offset:18440
ds_read_b64_tr_b16 a[90:91], v222 offset:23048
v_mfma_f32_16x16x32_bf16 v[100:103], a[68:71], a[116:119], v[100:103]
s_and_b32 s29, vcc_lo, 15
s_cbranch_scc1 SP_O3B
SP_O3B_RET:
v_mfma_f32_16x16x32_bf16 v[92:95], a[68:71], a[100:103], v[92:95]
s_add_u32 s39, s44, 8192
v_mfma_f32_16x16x32_bf16 v[92:95], a[64:67], a[96:99], v[92:95]
v_cvt_pk_bf16_f32 v200, v200, v201
v_cvt_pk_bf16_f32 v201, v202, v203
v_mfma_f32_16x16x32_bf16 v[84:87], a[64:67], a[208:211], v[84:87]
ds_read_b64_tr_b16 a[92:93], v222 offset:27656
ds_read_b64_tr_b16 a[94:95], v222 offset:32264
v_mfma_f32_16x16x32_bf16 v[84:87], a[68:71], a[244:247], v[84:87]
buffer_store_dwordx2 v[200:201], v226, s[20:23], s44 offen offset:0 sc0 sc1
v_mfma_f32_16x16x32_bf16 v[76:79], a[68:71], a[196:199], v[76:79]
v_cvt_pk_bf16_f32 v204, v204, v205
v_cvt_pk_bf16_f32 v205, v206, v207
v_mfma_f32_16x16x32_bf16 v[76:79], a[64:67], a[192:195], v[76:79]
buffer_store_dwordx2 v[204:205], v226, s[20:23], s44 offen offset:512 sc0 sc1
s_waitcnt lgkmcnt(8)
v_mfma_f32_16x16x32_bf16 v[76:79], a[72:75], a[200:203], v[76:79]
ds_read_b64_tr_b16 a[64:65], v220 offset:0
ds_read_b64_tr_b16 a[66:67], v220 offset:4608
v_mfma_f32_16x16x32_bf16 v[76:79], a[76:79], a[204:207], v[76:79]
v_cvt_pk_bf16_f32 v208, v208, v209
v_cvt_pk_bf16_f32 v209, v210, v211
v_mfma_f32_16x16x32_bf16 v[84:87], a[76:79], a[252:255], v[84:87]
buffer_store_dwordx2 v[208:209], v226, s[20:23], s39 offen offset:0 sc0 sc1
v_mfma_f32_16x16x32_bf16 v[84:87], a[72:75], a[248:251], v[84:87]
v_cvt_pk_bf16_f32 v212, v212, v213
v_cvt_pk_bf16_f32 v213, v214, v215
v_mfma_f32_16x16x32_bf16 v[92:95], a[72:75], a[104:107], v[92:95]
ds_read_b64_tr_b16 a[68:69], v220 offset:9216
ds_read_b64_tr_b16 a[70:71], v220 offset:13824
v_mfma_f32_16x16x32_bf16 v[92:95], a[76:79], a[108:111], v[92:95]
buffer_store_dwordx2 v[212:213], v226, s[20:23], s39 offen offset:512 sc0 sc1
v_mfma_f32_16x16x32_bf16 v[100:103], a[76:79], a[124:127], v[100:103]
v_exp_f32 v58, v58
v_mfma_f32_16x16x32_bf16 v[100:103], a[72:75], a[120:123], v[100:103]
v_exp_f32 v59, v59
s_waitcnt lgkmcnt(8)
v_mfma_f32_16x16x32_bf16 v[100:103], a[80:83], a[48:51], v[100:103]
ds_read_b64_tr_b16 a[72:73], v220 offset:18432
ds_read_b64_tr_b16 a[74:75], v220 offset:23040
v_mfma_f32_16x16x32_bf16 v[100:103], a[84:87], a[52:55], v[100:103]
v_add_f32 v58, 1.0, v58
v_add_f32 v59, 1.0, v59
v_mfma_f32_16x16x32_bf16 v[92:95], a[84:87], a[36:39], v[92:95]
v_rcp_f32 v58, v58
v_mfma_f32_16x16x32_bf16 v[92:95], a[80:83], a[32:35], v[92:95]
v_rcp_f32 v59, v59
v_mfma_f32_16x16x32_bf16 v[84:87], a[80:83], a[16:19], v[84:87]
ds_read_b64_tr_b16 a[76:77], v220 offset:27648
ds_read_b64_tr_b16 a[78:79], v220 offset:32256
v_mfma_f32_16x16x32_bf16 v[84:87], a[84:87], a[20:23], v[84:87]
v_mul_f32 v48, v48, v58
v_mul_f32 v49, v49, v59
v_mfma_f32_16x16x32_bf16 v[76:79], a[84:87], a[4:7], v[76:79]
v_cvt_pk_bf16_f32 v58, v48, v49
v_lshlrev_b32 v48, 16, v58
v_mfma_f32_16x16x32_bf16 v[76:79], a[80:83], a[0:3], v[76:79]
v_and_b32 v49, 0xffff0000, v58
v_accvgpr_read_b32 v51, a228
s_waitcnt lgkmcnt(8)
v_mfma_f32_16x16x32_bf16 v[76:79], a[88:91], a[8:11], v[76:79]
ds_read_b64_tr_b16 a[80:81], v223 offset:0
ds_read_b64_tr_b16 a[82:83], v223 offset:4608
v_mfma_f32_16x16x32_bf16 v[76:79], a[92:95], a[12:15], v[76:79]
v_accvgpr_read_b32 v59, a238
v_lshlrev_b32 v50, 16, v51
v_mfma_f32_16x16x32_bf16 v[84:87], a[92:95], a[28:31], v[84:87]
v_and_b32 v51, 0xffff0000, v51
v_lshlrev_b32 v58, 16, v59
v_mfma_f32_16x16x32_bf16 v[84:87], a[88:91], a[24:27], v[84:87]
v_and_b32 v59, 0xffff0000, v59
v_add_f32 v50, v50, v58
v_mfma_f32_16x16x32_bf16 v[92:95], a[88:91], a[40:43], v[92:95]
ds_read_b64_tr_b16 a[84:85], v223 offset:9216
ds_read_b64_tr_b16 a[86:87], v223 offset:13824
v_mfma_f32_16x16x32_bf16 v[92:95], a[92:95], a[44:47], v[92:95]
v_add_f32 v51, v51, v59
v_cvt_pk_bf16_f32 v58, v50, v51
v_mfma_f32_16x16x32_bf16 v[100:103], a[92:95], a[60:63], v[100:103]
v_lshlrev_b32 v50, 16, v58
v_and_b32 v51, 0xffff0000, v58
v_mfma_f32_16x16x32_bf16 v[100:103], a[88:91], a[56:59], v[100:103]
v_mul_f32 v58, 0xbfb8aa3b, v50
v_mul_f32 v59, 0xbfb8aa3b, v51
s_waitcnt lgkmcnt(8)
v_mfma_f32_16x16x32_bf16 v[128:131], a[64:67], a[112:115], v[128:131]
ds_read_b64_tr_b16 a[88:89], v223 offset:18432
ds_read_b64_tr_b16 a[90:91], v223 offset:23040
v_mfma_f32_16x16x32_bf16 v[128:131], a[68:71], a[116:119], v[128:131]
v_exp_f32 v58, v58
v_mfma_f32_16x16x32_bf16 v[120:123], a[68:71], a[100:103], v[120:123]
v_exp_f32 v59, v59
v_mfma_f32_16x16x32_bf16 v[120:123], a[64:67], a[96:99], v[120:123]
v_add_f32 v58, 1.0, v58
v_add_f32 v59, 1.0, v59
v_mfma_f32_16x16x32_bf16 v[112:115], a[64:67], a[208:211], v[112:115]
ds_read_b64_tr_b16 a[92:93], v223 offset:27648
ds_read_b64_tr_b16 a[94:95], v223 offset:32256
v_mfma_f32_16x16x32_bf16 v[112:115], a[68:71], a[244:247], v[112:115]
v_rcp_f32 v58, v58
v_mfma_f32_16x16x32_bf16 v[104:107], a[68:71], a[196:199], v[104:107]
v_rcp_f32 v59, v59
v_mfma_f32_16x16x32_bf16 v[104:107], a[64:67], a[192:195], v[104:107]
v_mul_f32 v50, v50, v58
v_mul_f32 v51, v51, v59
s_waitcnt lgkmcnt(8)
v_mfma_f32_16x16x32_bf16 v[104:107], a[72:75], a[200:203], v[104:107]
ds_read_b64_tr_b16 a[64:65], v220 offset:8
ds_read_b64_tr_b16 a[66:67], v220 offset:4616
v_mfma_f32_16x16x32_bf16 v[104:107], a[76:79], a[204:207], v[104:107]
s_add_u32 s39, s44, 0
v_cvt_pk_bf16_f32 v58, v50, v51
v_mfma_f32_16x16x32_bf16 v[112:115], a[76:79], a[252:255], v[112:115]
v_cvt_pk_bf16_f32 v80, v80, v81
v_cvt_pk_bf16_f32 v81, v82, v83
v_mfma_f32_16x16x32_bf16 v[112:115], a[72:75], a[248:251], v[112:115]
v_cvt_pk_bf16_f32 v82, v84, v85
v_cvt_pk_bf16_f32 v83, v86, v87
v_mfma_f32_16x16x32_bf16 v[120:123], a[72:75], a[104:107], v[120:123]
ds_read_b64_tr_b16 a[68:69], v220 offset:9224
ds_read_b64_tr_b16 a[70:71], v220 offset:13832
v_mfma_f32_16x16x32_bf16 v[120:123], a[76:79], a[108:111], v[120:123]
buffer_store_dwordx4 v[80:83], v244, s[20:23], s39 offen offset:1024 sc0 sc1
v_mfma_f32_16x16x32_bf16 v[128:131], a[76:79], a[124:127], v[128:131]
v_cvt_pk_bf16_f32 v88, v88, v89
v_cvt_pk_bf16_f32 v89, v90, v91
v_mfma_f32_16x16x32_bf16 v[128:131], a[72:75], a[120:123], v[128:131]
v_cvt_pk_bf16_f32 v90, v92, v93
v_cvt_pk_bf16_f32 v91, v94, v95
s_waitcnt lgkmcnt(8)
v_mfma_f32_16x16x32_bf16 v[128:131], a[80:83], a[48:51], v[128:131]
ds_read_b64_tr_b16 a[72:73], v220 offset:18440
ds_read_b64_tr_b16 a[74:75], v220 offset:23048
v_mfma_f32_16x16x32_bf16 v[128:131], a[84:87], a[52:55], v[128:131]
buffer_store_dwordx4 v[88:91], v244, s[20:23], s39 offen offset:2048 sc0 sc1
v_mfma_f32_16x16x32_bf16 v[120:123], a[84:87], a[36:39], v[120:123]
v_cvt_pk_bf16_f32 v96, v96, v97
v_cvt_pk_bf16_f32 v97, v98, v99
v_mfma_f32_16x16x32_bf16 v[120:123], a[80:83], a[32:35], v[120:123]
v_cvt_pk_bf16_f32 v98, v100, v101
v_cvt_pk_bf16_f32 v99, v102, v103
v_mfma_f32_16x16x32_bf16 v[112:115], a[80:83], a[16:19], v[112:115]
ds_read_b64_tr_b16 a[76:77], v220 offset:27656
ds_read_b64_tr_b16 a[78:79], v220 offset:32264
v_mfma_f32_16x16x32_bf16 v[112:115], a[84:87], a[20:23], v[112:115]
buffer_store_dwordx4 v[96:99], v244, s[20:23], s39 offen offset:3072 sc0 sc1
v_mfma_f32_16x16x32_bf16 v[104:107], a[84:87], a[4:7], v[104:107]
v_lshlrev_b32 v50, 16, v58
v_and_b32 v51, 0xffff0000, v58
v_mfma_f32_16x16x32_bf16 v[104:107], a[80:83], a[0:3], v[104:107]
v_accvgpr_read_b32 v53, a229
v_accvgpr_read_b32 v59, a239
s_waitcnt lgkmcnt(8)
v_mfma_f32_16x16x32_bf16 v[104:107], a[88:91], a[8:11], v[104:107]
ds_read_b64_tr_b16 a[80:81], v223 offset:8
ds_read_b64_tr_b16 a[82:83], v223 offset:4616
v_mfma_f32_16x16x32_bf16 v[104:107], a[92:95], a[12:15], v[104:107]
v_lshlrev_b32 v52, 16, v53
v_and_b32 v53, 0xffff0000, v53
v_mfma_f32_16x16x32_bf16 v[112:115], a[92:95], a[28:31], v[112:115]
v_lshlrev_b32 v58, 16, v59
v_and_b32 v59, 0xffff0000, v59
v_mfma_f32_16x16x32_bf16 v[112:115], a[88:91], a[24:27], v[112:115]
v_add_f32 v52, v52, v58
v_add_f32 v53, v53, v59
v_mfma_f32_16x16x32_bf16 v[120:123], a[88:91], a[40:43], v[120:123]
ds_read_b64_tr_b16 a[84:85], v223 offset:9224
ds_read_b64_tr_b16 a[86:87], v223 offset:13832
v_mfma_f32_16x16x32_bf16 v[120:123], a[92:95], a[44:47], v[120:123]
v_cvt_pk_bf16_f32 v58, v52, v53
v_lshlrev_b32 v52, 16, v58
v_mfma_f32_16x16x32_bf16 v[128:131], a[92:95], a[60:63], v[128:131]
v_and_b32 v53, 0xffff0000, v58
v_mul_f32 v58, 0xbfb8aa3b, v52
v_mfma_f32_16x16x32_bf16 v[128:131], a[88:91], a[56:59], v[128:131]
v_mul_f32 v59, 0xbfb8aa3b, v53
s_waitcnt lgkmcnt(8)
v_mfma_f32_16x16x32_bf16 v[132:135], a[64:67], a[112:115], v[132:135]
ds_read_b64_tr_b16 a[88:89], v223 offset:18440
ds_read_b64_tr_b16 a[90:91], v223 offset:23048
v_mfma_f32_16x16x32_bf16 v[132:135], a[68:71], a[116:119], v[132:135]
v_exp_f32 v58, v58
v_mfma_f32_16x16x32_bf16 v[124:127], a[68:71], a[100:103], v[124:127]
v_exp_f32 v59, v59
v_mfma_f32_16x16x32_bf16 v[124:127], a[64:67], a[96:99], v[124:127]
v_add_f32 v58, 1.0, v58
v_add_f32 v59, 1.0, v59
v_mfma_f32_16x16x32_bf16 v[116:119], a[64:67], a[208:211], v[116:119]
ds_read_b64_tr_b16 a[92:93], v223 offset:27656
ds_read_b64_tr_b16 a[94:95], v223 offset:32264
v_mfma_f32_16x16x32_bf16 v[116:119], a[68:71], a[244:247], v[116:119]
v_rcp_f32 v58, v58
v_mfma_f32_16x16x32_bf16 v[108:111], a[68:71], a[196:199], v[108:111]
v_rcp_f32 v59, v59
v_mfma_f32_16x16x32_bf16 v[108:111], a[64:67], a[192:195], v[108:111]
v_mul_f32 v52, v52, v58
v_mul_f32 v53, v53, v59
s_waitcnt lgkmcnt(8)
v_mfma_f32_16x16x32_bf16 v[108:111], a[72:75], a[200:203], v[108:111]
ds_read_b64_tr_b16 a[64:65], v219 offset:128
ds_read_b64_tr_b16 a[66:67], v219 offset:4736
v_mfma_f32_16x16x32_bf16 v[108:111], a[76:79], a[204:207], v[108:111]
v_cvt_pk_bf16_f32 v58, v52, v53
v_lshlrev_b32 v52, 16, v58
v_mfma_f32_16x16x32_bf16 v[116:119], a[76:79], a[252:255], v[116:119]
v_and_b32 v53, 0xffff0000, v58
v_accvgpr_read_b32 v55, a230
v_mfma_f32_16x16x32_bf16 v[116:119], a[72:75], a[248:251], v[116:119]
v_accvgpr_read_b32 v59, a240
v_lshlrev_b32 v54, 16, v55
v_mfma_f32_16x16x32_bf16 v[124:127], a[72:75], a[104:107], v[124:127]
ds_read_b64_tr_b16 a[68:69], v219 offset:9344
ds_read_b64_tr_b16 a[70:71], v219 offset:13952
v_mfma_f32_16x16x32_bf16 v[124:127], a[76:79], a[108:111], v[124:127]
v_and_b32 v55, 0xffff0000, v55
v_lshlrev_b32 v58, 16, v59
v_mfma_f32_16x16x32_bf16 v[132:135], a[76:79], a[124:127], v[132:135]
v_and_b32 v59, 0xffff0000, v59
v_add_f32 v54, v54, v58
v_mfma_f32_16x16x32_bf16 v[132:135], a[72:75], a[120:123], v[132:135]
v_add_f32 v55, v55, v59
v_cvt_pk_bf16_f32 v58, v54, v55
s_waitcnt lgkmcnt(8)
v_mfma_f32_16x16x32_bf16 v[132:135], a[80:83], a[48:51], v[132:135]
ds_read_b64_tr_b16 a[72:73], v219 offset:18560
ds_read_b64_tr_b16 a[74:75], v219 offset:23168
v_mfma_f32_16x16x32_bf16 v[132:135], a[84:87], a[52:55], v[132:135]
v_lshlrev_b32 v54, 16, v58
v_and_b32 v55, 0xffff0000, v58
v_mfma_f32_16x16x32_bf16 v[124:127], a[84:87], a[36:39], v[124:127]
v_mul_f32 v58, 0xbfb8aa3b, v54
v_mul_f32 v59, 0xbfb8aa3b, v55
v_mfma_f32_16x16x32_bf16 v[124:127], a[80:83], a[32:35], v[124:127]
v_exp_f32 v58, v58
v_mfma_f32_16x16x32_bf16 v[116:119], a[80:83], a[16:19], v[116:119]
ds_read_b64_tr_b16 a[76:77], v219 offset:27776
ds_read_b64_tr_b16 a[78:79], v219 offset:32384
v_mfma_f32_16x16x32_bf16 v[116:119], a[84:87], a[20:23], v[116:119]
v_exp_f32 v59, v59
v_mfma_f32_16x16x32_bf16 v[108:111], a[84:87], a[4:7], v[108:111]
v_add_f32 v58, 1.0, v58
v_add_f32 v59, 1.0, v59
v_mfma_f32_16x16x32_bf16 v[108:111], a[80:83], a[0:3], v[108:111]
v_rcp_f32 v58, v58
s_waitcnt lgkmcnt(8)
v_mfma_f32_16x16x32_bf16 v[108:111], a[88:91], a[8:11], v[108:111]
ds_read_b64_tr_b16 a[80:81], v222 offset:128
ds_read_b64_tr_b16 a[82:83], v222 offset:4736
v_mfma_f32_16x16x32_bf16 v[108:111], a[92:95], a[12:15], v[108:111]
v_rcp_f32 v59, v59
v_mfma_f32_16x16x32_bf16 v[116:119], a[92:95], a[28:31], v[116:119]
v_mul_f32 v54, v54, v58
v_mul_f32 v55, v55, v59
v_mfma_f32_16x16x32_bf16 v[116:119], a[88:91], a[24:27], v[116:119]
v_cvt_pk_bf16_f32 v58, v54, v55
v_lshlrev_b32 v54, 16, v58
v_mfma_f32_16x16x32_bf16 v[124:127], a[88:91], a[40:43], v[124:127]
ds_read_b64_tr_b16 a[84:85], v222 offset:9344
ds_read_b64_tr_b16 a[86:87], v222 offset:13952
v_mfma_f32_16x16x32_bf16 v[124:127], a[92:95], a[44:47], v[124:127]
v_and_b32 v55, 0xffff0000, v58
v_accvgpr_read_b32 v57, a231
v_mfma_f32_16x16x32_bf16 v[132:135], a[92:95], a[60:63], v[132:135]
v_accvgpr_read_b32 v59, a241
v_lshlrev_b32 v56, 16, v57
v_mfma_f32_16x16x32_bf16 v[132:135], a[88:91], a[56:59], v[132:135]
v_and_b32 v57, 0xffff0000, v57
v_lshlrev_b32 v58, 16, v59
s_waitcnt lgkmcnt(8)
v_mfma_f32_16x16x32_bf16 v[160:163], a[64:67], a[112:115], v[160:163]
ds_read_b64_tr_b16 a[88:89], v222 offset:18560
ds_read_b64_tr_b16 a[90:91], v222 offset:23168
v_mfma_f32_16x16x32_bf16 v[160:163], a[68:71], a[116:119], v[160:163]
v_and_b32 v59, 0xffff0000, v59
v_add_f32 v56, v56, v58
v_mfma_f32_16x16x32_bf16 v[152:155], a[68:71], a[100:103], v[152:155]
v_add_f32 v57, v57, v59
v_cvt_pk_bf16_f32 v58, v56, v57
v_mfma_f32_16x16x32_bf16 v[152:155], a[64:67], a[96:99], v[152:155]
v_lshlrev_b32 v56, 16, v58
v_and_b32 v57, 0xffff0000, v58
v_mfma_f32_16x16x32_bf16 v[144:147], a[64:67], a[208:211], v[144:147]
ds_read_b64_tr_b16 a[92:93], v222 offset:27776
ds_read_b64_tr_b16 a[94:95], v222 offset:32384
v_mfma_f32_16x16x32_bf16 v[144:147], a[68:71], a[244:247], v[144:147]
v_mul_f32 v58, 0xbfb8aa3b, v56
v_mul_f32 v59, 0xbfb8aa3b, v57
v_mfma_f32_16x16x32_bf16 v[136:139], a[68:71], a[196:199], v[136:139]
v_exp_f32 v58, v58
v_mfma_f32_16x16x32_bf16 v[136:139], a[64:67], a[192:195], v[136:139]
v_exp_f32 v59, v59
s_waitcnt lgkmcnt(8)
v_mfma_f32_16x16x32_bf16 v[136:139], a[72:75], a[200:203], v[136:139]
ds_read_b64_tr_b16 a[64:65], v219 offset:136
ds_read_b64_tr_b16 a[66:67], v219 offset:4744
v_mfma_f32_16x16x32_bf16 v[136:139], a[76:79], a[204:207], v[136:139]
s_add_u32 s39, s44, 4096
v_add_f32 v58, 1.0, v58
v_mfma_f32_16x16x32_bf16 v[144:147], a[76:79], a[252:255], v[144:147]
v_cvt_pk_bf16_f32 v104, v104, v105
v_cvt_pk_bf16_f32 v105, v106, v107
v_mfma_f32_16x16x32_bf16 v[144:147], a[72:75], a[248:251], v[144:147]
v_cvt_pk_bf16_f32 v106, v108, v109
v_cvt_pk_bf16_f32 v107, v110, v111
v_mfma_f32_16x16x32_bf16 v[152:155], a[72:75], a[104:107], v[152:155]
ds_read_b64_tr_b16 a[68:69], v219 offset:9352
ds_read_b64_tr_b16 a[70:71], v219 offset:13960
v_mfma_f32_16x16x32_bf16 v[152:155], a[76:79], a[108:111], v[152:155]
buffer_store_dwordx4 v[104:107], v244, s[20:23], s39 offen offset:0 sc0 sc1
v_mfma_f32_16x16x32_bf16 v[160:163], a[76:79], a[124:127], v[160:163]
v_cvt_pk_bf16_f32 v112, v112, v113
v_cvt_pk_bf16_f32 v113, v114, v115
v_mfma_f32_16x16x32_bf16 v[160:163], a[72:75], a[120:123], v[160:163]
v_cvt_pk_bf16_f32 v114, v116, v117
v_cvt_pk_bf16_f32 v115, v118, v119
s_waitcnt lgkmcnt(8)
v_mfma_f32_16x16x32_bf16 v[160:163], a[80:83], a[48:51], v[160:163]
ds_read_b64_tr_b16 a[72:73], v219 offset:18568
ds_read_b64_tr_b16 a[74:75], v219 offset:23176
v_mfma_f32_16x16x32_bf16 v[160:163], a[84:87], a[52:55], v[160:163]
buffer_store_dwordx4 v[112:115], v244, s[20:23], s39 offen offset:1024 sc0 sc1
v_mfma_f32_16x16x32_bf16 v[152:155], a[84:87], a[36:39], v[152:155]
v_cvt_pk_bf16_f32 v120, v120, v121
v_cvt_pk_bf16_f32 v121, v122, v123
v_mfma_f32_16x16x32_bf16 v[152:155], a[80:83], a[32:35], v[152:155]
v_cvt_pk_bf16_f32 v122, v124, v125
v_cvt_pk_bf16_f32 v123, v126, v127
v_mfma_f32_16x16x32_bf16 v[144:147], a[80:83], a[16:19], v[144:147]
ds_read_b64_tr_b16 a[76:77], v219 offset:27784
ds_read_b64_tr_b16 a[78:79], v219 offset:32392
v_mfma_f32_16x16x32_bf16 v[144:147], a[84:87], a[20:23], v[144:147]
buffer_store_dwordx4 v[120:123], v244, s[20:23], s39 offen offset:2048 sc0 sc1
v_mfma_f32_16x16x32_bf16 v[136:139], a[84:87], a[4:7], v[136:139]
v_cvt_pk_bf16_f32 v128, v128, v129
v_cvt_pk_bf16_f32 v129, v130, v131
v_mfma_f32_16x16x32_bf16 v[136:139], a[80:83], a[0:3], v[136:139]
v_cvt_pk_bf16_f32 v130, v132, v133
v_cvt_pk_bf16_f32 v131, v134, v135
s_waitcnt lgkmcnt(8)
v_mfma_f32_16x16x32_bf16 v[136:139], a[88:91], a[8:11], v[136:139]
ds_read_b64_tr_b16 a[80:81], v222 offset:136
ds_read_b64_tr_b16 a[82:83], v222 offset:4744
v_mfma_f32_16x16x32_bf16 v[136:139], a[92:95], a[12:15], v[136:139]
buffer_store_dwordx4 v[128:131], v244, s[20:23], s39 offen offset:3072 sc0 sc1
v_mfma_f32_16x16x32_bf16 v[144:147], a[92:95], a[28:31], v[144:147]
s_lshl2_add_u32 s28, s32, s95
v_add_f32 v59, 1.0, v59
v_mfma_f32_16x16x32_bf16 v[144:147], a[88:91], a[24:27], v[144:147]
v_rcp_f32 v58, v58
v_mfma_f32_16x16x32_bf16 v[152:155], a[88:91], a[40:43], v[152:155]
ds_read_b64_tr_b16 a[84:85], v222 offset:9352
ds_read_b64_tr_b16 a[86:87], v222 offset:13960
v_mfma_f32_16x16x32_bf16 v[152:155], a[92:95], a[44:47], v[152:155]
v_rcp_f32 v59, v59
v_mfma_f32_16x16x32_bf16 v[160:163], a[92:95], a[60:63], v[160:163]
v_mul_f32 v56, v56, v58
v_mul_f32 v57, v57, v59
v_mfma_f32_16x16x32_bf16 v[160:163], a[88:91], a[56:59], v[160:163]
v_cvt_pk_bf16_f32 v58, v56, v57
v_lshlrev_b32 v56, 16, v58
s_waitcnt lgkmcnt(8)
v_mfma_f32_16x16x32_bf16 v[164:167], a[64:67], a[112:115], v[164:167]
ds_read_b64_tr_b16 a[88:89], v222 offset:18568
ds_read_b64_tr_b16 a[90:91], v222 offset:23176
v_mfma_f32_16x16x32_bf16 v[164:167], a[68:71], a[116:119], v[164:167]
v_and_b32 v57, 0xffff0000, v58
v_accvgpr_read_b32 v19, a212
v_mfma_f32_16x16x32_bf16 v[156:159], a[68:71], a[100:103], v[156:159]
v_lshlrev_b32 v18, 16, v19
v_and_b32 v19, 0xffff0000, v19
v_mfma_f32_16x16x32_bf16 v[156:159], a[64:67], a[96:99], v[156:159]
v_accvgpr_read_b32 v21, a213
v_lshlrev_b32 v20, 16, v21
v_mfma_f32_16x16x32_bf16 v[148:151], a[64:67], a[208:211], v[148:151]
ds_read_b64_tr_b16 a[92:93], v222 offset:27784
ds_read_b64_tr_b16 a[94:95], v222 offset:32392
v_mfma_f32_16x16x32_bf16 v[148:151], a[68:71], a[244:247], v[148:151]
v_and_b32 v21, 0xffff0000, v21
v_accvgpr_read_b32 v23, a214
v_mfma_f32_16x16x32_bf16 v[140:143], a[68:71], a[196:199], v[140:143]
v_lshlrev_b32 v22, 16, v23
v_and_b32 v23, 0xffff0000, v23
v_mfma_f32_16x16x32_bf16 v[140:143], a[64:67], a[192:195], v[140:143]
v_accvgpr_read_b32 v25, a215
v_lshlrev_b32 v24, 16, v25
s_waitcnt lgkmcnt(8)
v_mfma_f32_16x16x32_bf16 v[140:143], a[72:75], a[200:203], v[140:143]
ds_read_b64_tr_b16 a[64:65], v220 offset:128
ds_read_b64_tr_b16 a[66:67], v220 offset:4736
v_mfma_f32_16x16x32_bf16 v[140:143], a[76:79], a[204:207], v[140:143]
v_and_b32 v25, 0xffff0000, v25
v_accvgpr_read_b32 v27, a216
v_mfma_f32_16x16x32_bf16 v[148:151], a[76:79], a[252:255], v[148:151]
v_lshlrev_b32 v26, 16, v27
v_and_b32 v27, 0xffff0000, v27
v_mfma_f32_16x16x32_bf16 v[148:151], a[72:75], a[248:251], v[148:151]
v_accvgpr_read_b32 v29, a217
v_lshlrev_b32 v28, 16, v29
v_mfma_f32_16x16x32_bf16 v[156:159], a[72:75], a[104:107], v[156:159]
ds_read_b64_tr_b16 a[68:69], v220 offset:9344
ds_read_b64_tr_b16 a[70:71], v220 offset:13952
v_mfma_f32_16x16x32_bf16 v[156:159], a[76:79], a[108:111], v[156:159]
v_and_b32 v29, 0xffff0000, v29
v_accvgpr_read_b32 v31, a218
v_mfma_f32_16x16x32_bf16 v[164:167], a[76:79], a[124:127], v[164:167]
v_lshlrev_b32 v30, 16, v31
v_and_b32 v31, 0xffff0000, v31
v_mfma_f32_16x16x32_bf16 v[164:167], a[72:75], a[120:123], v[164:167]
v_accvgpr_read_b32 v33, a219
v_lshlrev_b32 v32, 16, v33
s_waitcnt lgkmcnt(8)
v_mfma_f32_16x16x32_bf16 v[164:167], a[80:83], a[48:51], v[164:167]
ds_read_b64_tr_b16 a[72:73], v220 offset:18560
ds_read_b64_tr_b16 a[74:75], v220 offset:23168
v_mfma_f32_16x16x32_bf16 v[164:167], a[84:87], a[52:55], v[164:167]
v_and_b32 v33, 0xffff0000, v33
v_accvgpr_read_b32 v35, a220
v_mfma_f32_16x16x32_bf16 v[156:159], a[84:87], a[36:39], v[156:159]
s_waitcnt vmcnt(0)
buffer_store_dword v231, v254, s[20:23], s28 offen sc0 sc1
v_mfma_f32_16x16x32_bf16 v[156:159], a[80:83], a[32:35], v[156:159]
v_lshlrev_b32 v34, 16, v35
v_and_b32 v35, 0xffff0000, v35
v_mfma_f32_16x16x32_bf16 v[148:151], a[80:83], a[16:19], v[148:151]
ds_read_b64_tr_b16 a[76:77], v220 offset:27776
ds_read_b64_tr_b16 a[78:79], v220 offset:32384
v_mfma_f32_16x16x32_bf16 v[148:151], a[84:87], a[20:23], v[148:151]
v_accvgpr_read_b32 v37, a221
v_lshlrev_b32 v36, 16, v37
v_mfma_f32_16x16x32_bf16 v[140:143], a[84:87], a[4:7], v[140:143]
v_and_b32 v37, 0xffff0000, v37
v_mfma_f32_16x16x32_bf16 v[140:143], a[80:83], a[0:3], v[140:143]
s_mov_b32 s90, 0x3f80
s_mov_b32 s91, 0x3f800000
s_waitcnt lgkmcnt(8)
v_mfma_f32_16x16x32_bf16 v[140:143], a[88:91], a[8:11], v[140:143]
ds_read_b64_tr_b16 a[80:81], v223 offset:128
ds_read_b64_tr_b16 a[82:83], v223 offset:4736
v_mfma_f32_16x16x32_bf16 v[140:143], a[92:95], a[12:15], v[140:143]
v_mov_b32 v66, 0
v_mov_b32 v67, 0
v_mfma_f32_16x16x32_bf16 v[148:151], a[92:95], a[28:31], v[148:151]
v_mov_b32 v68, 0
v_mov_b32 v69, 0
v_mfma_f32_16x16x32_bf16 v[148:151], a[88:91], a[24:27], v[148:151]
v_mfma_f32_16x16x32_bf16 v[156:159], a[88:91], a[40:43], v[156:159]
ds_read_b64_tr_b16 a[84:85], v223 offset:9344
ds_read_b64_tr_b16 a[86:87], v223 offset:13952
v_mfma_f32_16x16x32_bf16 v[156:159], a[92:95], a[44:47], v[156:159]
v_mfma_f32_16x16x32_bf16 v[164:167], a[92:95], a[60:63], v[164:167]
v_mfma_f32_16x16x32_bf16 v[164:167], a[88:91], a[56:59], v[164:167]
s_waitcnt lgkmcnt(8)
v_mfma_f32_16x16x32_bf16 v[192:195], a[64:67], a[112:115], v[192:195]
ds_read_b64_tr_b16 a[88:89], v223 offset:18560
ds_read_b64_tr_b16 a[90:91], v223 offset:23168
v_mfma_f32_16x16x32_bf16 v[192:195], a[68:71], a[116:119], v[192:195]
v_mfma_f32_16x16x32_bf16 v[184:187], a[68:71], a[100:103], v[184:187]
v_mfma_f32_16x16x32_bf16 v[184:187], a[64:67], a[96:99], v[184:187]
v_mfma_f32_16x16x32_bf16 v[176:179], a[64:67], a[208:211], v[176:179]
ds_read_b64_tr_b16 a[92:93], v223 offset:27776
ds_read_b64_tr_b16 a[94:95], v223 offset:32384
v_mfma_f32_16x16x32_bf16 v[176:179], a[68:71], a[244:247], v[176:179]
v_mfma_f32_16x16x32_bf16 v[168:171], a[68:71], a[196:199], v[168:171]
v_mfma_f32_16x16x32_bf16 v[168:171], a[64:67], a[192:195], v[168:171]
s_waitcnt lgkmcnt(8)
v_mfma_f32_16x16x32_bf16 v[168:171], a[72:75], a[200:203], v[168:171]
ds_read_b64_tr_b16 a[64:65], v220 offset:136
ds_read_b64_tr_b16 a[66:67], v220 offset:4744
v_mfma_f32_16x16x32_bf16 v[168:171], a[76:79], a[204:207], v[168:171]
s_add_u32 s39, s44, 8192
v_mfma_f32_16x16x32_bf16 v[176:179], a[76:79], a[252:255], v[176:179]
v_cvt_pk_bf16_f32 v144, v144, v145
v_cvt_pk_bf16_f32 v145, v146, v147
v_mfma_f32_16x16x32_bf16 v[176:179], a[72:75], a[248:251], v[176:179]
v_cvt_pk_bf16_f32 v146, v148, v149
v_cvt_pk_bf16_f32 v147, v150, v151
v_mfma_f32_16x16x32_bf16 v[184:187], a[72:75], a[104:107], v[184:187]
ds_read_b64_tr_b16 a[68:69], v220 offset:9352
ds_read_b64_tr_b16 a[70:71], v220 offset:13960
v_mfma_f32_16x16x32_bf16 v[184:187], a[76:79], a[108:111], v[184:187]
buffer_store_dwordx4 v[144:147], v244, s[20:23], s39 offen offset:1024 sc0 sc1
v_mfma_f32_16x16x32_bf16 v[192:195], a[76:79], a[124:127], v[192:195]
v_cvt_pk_bf16_f32 v152, v152, v153
v_cvt_pk_bf16_f32 v153, v154, v155
v_mfma_f32_16x16x32_bf16 v[192:195], a[72:75], a[120:123], v[192:195]
v_cvt_pk_bf16_f32 v154, v156, v157
v_cvt_pk_bf16_f32 v155, v158, v159
s_waitcnt lgkmcnt(8)
v_mfma_f32_16x16x32_bf16 v[192:195], a[80:83], a[48:51], v[192:195]
ds_read_b64_tr_b16 a[72:73], v220 offset:18568
ds_read_b64_tr_b16 a[74:75], v220 offset:23176
v_mfma_f32_16x16x32_bf16 v[192:195], a[84:87], a[52:55], v[192:195]
buffer_store_dwordx4 v[152:155], v244, s[20:23], s39 offen offset:2048 sc0 sc1
v_mfma_f32_16x16x32_bf16 v[184:187], a[84:87], a[36:39], v[184:187]
v_cvt_pk_bf16_f32 v160, v160, v161
v_cvt_pk_bf16_f32 v161, v162, v163
v_mfma_f32_16x16x32_bf16 v[184:187], a[80:83], a[32:35], v[184:187]
v_cvt_pk_bf16_f32 v162, v164, v165
v_cvt_pk_bf16_f32 v163, v166, v167
v_mfma_f32_16x16x32_bf16 v[176:179], a[80:83], a[16:19], v[176:179]
ds_read_b64_tr_b16 a[76:77], v220 offset:27784
ds_read_b64_tr_b16 a[78:79], v220 offset:32392
v_mfma_f32_16x16x32_bf16 v[176:179], a[84:87], a[20:23], v[176:179]
buffer_store_dwordx4 v[160:163], v244, s[20:23], s39 offen offset:3072 sc0 sc1
v_mfma_f32_16x16x32_bf16 v[168:171], a[84:87], a[4:7], v[168:171]
buffer_load_dword v230, v229, s[20:23], s95 offen sc0 sc1
v_mfma_f32_16x16x32_bf16 v[168:171], a[80:83], a[0:3], v[168:171]
s_waitcnt lgkmcnt(8)
v_mfma_f32_16x16x32_bf16 v[168:171], a[88:91], a[8:11], v[168:171]
ds_read_b64_tr_b16 a[80:81], v223 offset:136
ds_read_b64_tr_b16 a[82:83], v223 offset:4744
v_mfma_f32_16x16x32_bf16 v[168:171], a[92:95], a[12:15], v[168:171]
v_mfma_f32_16x16x32_bf16 v[176:179], a[92:95], a[28:31], v[176:179]
v_mfma_f32_16x16x32_bf16 v[176:179], a[88:91], a[24:27], v[176:179]
v_mfma_f32_16x16x32_bf16 v[184:187], a[88:91], a[40:43], v[184:187]
ds_read_b64_tr_b16 a[84:85], v223 offset:9352
ds_read_b64_tr_b16 a[86:87], v223 offset:13960
v_mfma_f32_16x16x32_bf16 v[184:187], a[92:95], a[44:47], v[184:187]
v_mfma_f32_16x16x32_bf16 v[192:195], a[92:95], a[60:63], v[192:195]
v_mfma_f32_16x16x32_bf16 v[192:195], a[88:91], a[56:59], v[192:195]
s_waitcnt lgkmcnt(8)
v_mfma_f32_16x16x32_bf16 v[196:199], a[64:67], a[112:115], v[196:199]
ds_read_b64_tr_b16 a[88:89], v223 offset:18568
ds_read_b64_tr_b16 a[90:91], v223 offset:23176
v_mfma_f32_16x16x32_bf16 v[196:199], a[68:71], a[116:119], v[196:199]
v_mfma_f32_16x16x32_bf16 v[188:191], a[68:71], a[100:103], v[188:191]
v_mfma_f32_16x16x32_bf16 v[188:191], a[64:67], a[96:99], v[188:191]
v_mfma_f32_16x16x32_bf16 v[180:183], a[64:67], a[208:211], v[180:183]
ds_read_b64_tr_b16 a[92:93], v223 offset:27784
ds_read_b64_tr_b16 a[94:95], v223 offset:32392
v_mfma_f32_16x16x32_bf16 v[180:183], a[68:71], a[244:247], v[180:183]
v_mfma_f32_16x16x32_bf16 v[172:175], a[68:71], a[196:199], v[172:175]
v_mfma_f32_16x16x32_bf16 v[172:175], a[64:67], a[192:195], v[172:175]
s_waitcnt lgkmcnt(8)
v_mfma_f32_16x16x32_bf16 v[172:175], a[72:75], a[200:203], v[172:175]
v_mfma_f32_16x16x32_bf16 v[172:175], a[76:79], a[204:207], v[172:175]
v_mfma_f32_16x16x32_bf16 v[180:183], a[76:79], a[252:255], v[180:183]
v_mfma_f32_16x16x32_bf16 v[180:183], a[72:75], a[248:251], v[180:183]
v_mfma_f32_16x16x32_bf16 v[188:191], a[72:75], a[104:107], v[188:191]
v_mfma_f32_16x16x32_bf16 v[188:191], a[76:79], a[108:111], v[188:191]
v_mfma_f32_16x16x32_bf16 v[196:199], a[76:79], a[124:127], v[196:199]
s_waitcnt vmcnt(0)
v_cmp_gt_u32 vcc, 1, v230
v_mfma_f32_16x16x32_bf16 v[196:199], a[72:75], a[120:123], v[196:199]
s_waitcnt lgkmcnt(6)
v_mfma_f32_16x16x32_bf16 v[196:199], a[80:83], a[48:51], v[196:199]
s_and_b32 s29, vcc_lo, 0xff
s_cbranch_scc1 SP_P1B
SP_P1B_RET:
s_waitcnt lgkmcnt(4)
v_mfma_f32_16x16x32_bf16 v[196:199], a[84:87], a[52:55], v[196:199]
buffer_load_dwordx4 v[104:107], v244, s[20:23], s65 offen offset:3072 sc0 sc1
v_mfma_f32_16x16x32_bf16 v[188:191], a[84:87], a[36:39], v[188:191]
buffer_load_dwordx4 v[108:111], v244, s[20:23], s66 offen offset:2048 sc0 sc1
v_mfma_f32_16x16x32_bf16 v[188:191], a[80:83], a[32:35], v[188:191]
buffer_load_dwordx4 v[112:115], v244, s[20:23], s67 offen offset:1024 sc0 sc1
v_mfma_f32_16x16x32_bf16 v[180:183], a[80:83], a[16:19], v[180:183]
buffer_load_dwordx4 v[116:119], v244, s[20:23], s68 offen offset:0 sc0 sc1
v_mfma_f32_16x16x32_bf16 v[180:183], a[84:87], a[20:23], v[180:183]
buffer_load_dwordx4 v[120:123], v244, s[20:23], s69 offen offset:3072 sc0 sc1
v_mfma_f32_16x16x32_bf16 v[172:175], a[84:87], a[4:7], v[172:175]
buffer_load_dwordx4 v[124:127], v244, s[20:23], s70 offen offset:2048 sc0 sc1
v_mfma_f32_16x16x32_bf16 v[172:175], a[80:83], a[0:3], v[172:175]
buffer_load_dwordx4 v[128:131], v244, s[20:23], s71 offen offset:1024 sc0 sc1
s_waitcnt lgkmcnt(2)
v_mfma_f32_16x16x32_bf16 v[172:175], a[88:91], a[8:11], v[172:175]
s_waitcnt lgkmcnt(0)
v_mfma_f32_16x16x32_bf16 v[172:175], a[92:95], a[12:15], v[172:175]
v_mfma_f32_16x16x32_bf16 v[180:183], a[92:95], a[28:31], v[180:183]
v_mfma_f32_16x16x32_bf16 v[180:183], a[88:91], a[24:27], v[180:183]
v_mfma_f32_16x16x32_bf16 v[188:191], a[88:91], a[40:43], v[188:191]
v_mfma_f32_16x16x32_bf16 v[188:191], a[92:95], a[44:47], v[188:191]
v_mfma_f32_16x16x32_bf16 v[196:199], a[92:95], a[60:63], v[196:199]
v_mfma_f32_16x16x32_bf16 v[196:199], a[88:91], a[56:59], v[196:199]
s_add_u32 s39, s44, 12288
s_nop 7
v_cvt_pk_bf16_f32 v168, v168, v169
v_cvt_pk_bf16_f32 v169, v170, v171
v_cvt_pk_bf16_f32 v170, v172, v173
v_cvt_pk_bf16_f32 v171, v174, v175
buffer_store_dwordx4 v[168:171], v244, s[20:23], s39 offen offset:0 sc0 sc1
v_cvt_pk_bf16_f32 v176, v176, v177
v_cvt_pk_bf16_f32 v177, v178, v179
v_cvt_pk_bf16_f32 v178, v180, v181
v_cvt_pk_bf16_f32 v179, v182, v183
buffer_store_dwordx4 v[176:179], v244, s[20:23], s39 offen offset:1024 sc0 sc1
v_cvt_pk_bf16_f32 v184, v184, v185
v_cvt_pk_bf16_f32 v185, v186, v187
v_cvt_pk_bf16_f32 v186, v188, v189
v_cvt_pk_bf16_f32 v187, v190, v191
buffer_store_dwordx4 v[184:187], v244, s[20:23], s39 offen offset:2048 sc0 sc1
v_cvt_pk_bf16_f32 v192, v192, v193
v_cvt_pk_bf16_f32 v193, v194, v195
v_cvt_pk_bf16_f32 v194, v196, v197
v_cvt_pk_bf16_f32 v195, v198, v199
buffer_store_dwordx4 v[192:195], v244, s[20:23], s39 offen offset:3072 sc0 sc1
buffer_load_dwordx2 v[200:201], v226, s[20:23], s72 offen offset:0 sc0 sc1
buffer_load_dwordx2 v[202:203], v226, s[20:23], s73 offen offset:512 sc0 sc1
buffer_load_dwordx2 v[204:205], v226, s[20:23], s74 offen offset:0 sc0 sc1
buffer_load_dwordx2 v[206:207], v226, s[20:23], s75 offen offset:512 sc0 sc1
buffer_load_dwordx2 v[208:209], v226, s[20:23], s84 offen offset:0 sc0 sc1
buffer_load_dwordx2 v[210:211], v226, s[20:23], s85 offen offset:512 sc0 sc1
buffer_load_dwordx2 v[212:213], v226, s[20:23], s86 offen offset:0 sc0 sc1
buffer_load_dwordx2 v[214:215], v226, s[20:23], s87 offen offset:512 sc0 sc1
s_waitcnt vmcnt(8)
buffer_store_dword v246, v254, s[20:23], s28 offen sc0 sc1
buffer_load_dword v230, v229, s[20:23], s95 offen sc0 sc1
s_waitcnt vmcnt(20)
v_dot2c_f32_bf16 v72, s90, v104
v_dot2c_f32_bf16 v73, s91, v104
v_dot2c_f32_bf16 v74, s90, v105
v_dot2c_f32_bf16 v75, s91, v105
v_dot2c_f32_bf16 v76, s90, v106
v_dot2c_f32_bf16 v77, s91, v106
v_dot2c_f32_bf16 v78, s90, v107
v_dot2c_f32_bf16 v79, s91, v107
s_waitcnt vmcnt(19)
v_dot2c_f32_bf16 v72, s90, v108
v_dot2c_f32_bf16 v73, s91, v108
v_dot2c_f32_bf16 v74, s90, v109
v_dot2c_f32_bf16 v75, s91, v109
v_dot2c_f32_bf16 v76, s90, v110
v_dot2c_f32_bf16 v77, s91, v110
v_dot2c_f32_bf16 v78, s90, v111
v_dot2c_f32_bf16 v79, s91, v111
s_waitcnt vmcnt(18)
v_dot2c_f32_bf16 v72, s90, v112
v_dot2c_f32_bf16 v73, s91, v112
v_dot2c_f32_bf16 v74, s90, v113
v_dot2c_f32_bf16 v75, s91, v113
v_dot2c_f32_bf16 v76, s90, v114
v_dot2c_f32_bf16 v77, s91, v114
v_dot2c_f32_bf16 v78, s90, v115
v_dot2c_f32_bf16 v79, s91, v115
s_waitcnt vmcnt(17)
v_dot2c_f32_bf16 v72, s90, v116
v_dot2c_f32_bf16 v73, s91, v116
v_dot2c_f32_bf16 v74, s90, v117
v_dot2c_f32_bf16 v75, s91, v117
v_dot2c_f32_bf16 v76, s90, v118
v_dot2c_f32_bf16 v77, s91, v118
v_dot2c_f32_bf16 v78, s90, v119
v_dot2c_f32_bf16 v79, s91, v119
s_waitcnt vmcnt(16)
v_dot2c_f32_bf16 v72, s90, v120
v_dot2c_f32_bf16 v73, s91, v120
v_dot2c_f32_bf16 v74, s90, v121
v_dot2c_f32_bf16 v75, s91, v121
v_dot2c_f32_bf16 v76, s90, v122
v_dot2c_f32_bf16 v77, s91, v122
v_dot2c_f32_bf16 v78, s90, v123
v_dot2c_f32_bf16 v79, s91, v123
s_waitcnt vmcnt(15)
v_dot2c_f32_bf16 v72, s90, v124
v_dot2c_f32_bf16 v73, s91, v124
v_dot2c_f32_bf16 v74, s90, v125
v_dot2c_f32_bf16 v75, s91, v125
v_dot2c_f32_bf16 v76, s90, v126
v_dot2c_f32_bf16 v77, s91, v126
v_dot2c_f32_bf16 v78, s90, v127
v_dot2c_f32_bf16 v79, s91, v127
s_waitcnt vmcnt(14)
v_dot2c_f32_bf16 v72, s90, v128
v_dot2c_f32_bf16 v73, s91, v128
v_dot2c_f32_bf16 v74, s90, v129
v_dot2c_f32_bf16 v75, s91, v129
v_dot2c_f32_bf16 v76, s90, v130
v_dot2c_f32_bf16 v77, s91, v130
v_dot2c_f32_bf16 v78, s90, v131
v_dot2c_f32_bf16 v79, s91, v131
s_nop 2
v_cvt_pk_bf16_f32 v58, v72, v73
v_cvt_pk_bf16_f32 v59, v74, v75
v_cvt_pk_bf16_f32 v60, v76, v77
v_cvt_pk_bf16_f32 v61, v78, v79
v_lshlrev_b32 v72, 16, v58
v_and_b32 v73, 0xffff0000, v58
v_lshlrev_b32 v74, 16, v59
v_and_b32 v75, 0xffff0000, v59
v_lshlrev_b32 v76, 16, v60
v_and_b32 v77, 0xffff0000, v60
v_lshlrev_b32 v78, 16, v61
v_and_b32 v79, 0xffff0000, v61
v_pk_mul_f32 v[72:73], v[72:73], v[38:39]
v_pk_mul_f32 v[74:75], v[74:75], v[40:41]
v_pk_mul_f32 v[76:77], v[76:77], v[42:43]
v_pk_mul_f32 v[78:79], v[78:79], v[44:45]
v_cvt_pk_bf16_f32 v58, v72, v73
v_cvt_pk_bf16_f32 v59, v74, v75
v_cvt_pk_bf16_f32 v60, v76, v77
v_cvt_pk_bf16_f32 v61, v78, v79
v_lshlrev_b32 v72, 16, v58
v_and_b32 v73, 0xffff0000, v58
v_lshlrev_b32 v74, 16, v59
v_and_b32 v75, 0xffff0000, v59
v_lshlrev_b32 v76, 16, v60
v_and_b32 v77, 0xffff0000, v60
v_lshlrev_b32 v78, 16, v61
v_and_b32 v79, 0xffff0000, v61
v_pk_add_f32 v[72:73], v[72:73], v[18:19]
v_pk_add_f32 v[74:75], v[74:75], v[20:21]
v_pk_add_f32 v[76:77], v[76:77], v[22:23]
v_pk_add_f32 v[78:79], v[78:79], v[24:25]
v_cvt_pk_bf16_f32 v72, v72, v73
v_cvt_pk_bf16_f32 v73, v74, v75
v_cvt_pk_bf16_f32 v74, v76, v77
v_cvt_pk_bf16_f32 v75, v78, v79
buffer_store_dwordx4 v[72:75], v248, s[60:63], 0 offen
s_waitcnt vmcnt(1)
v_cmp_gt_u32 vcc, 2, v230
s_nop 0
s_and_b32 s29, vcc_lo, 0xff
s_cbranch_scc0 SP_P2B_RET
SP_P2B:
s_sleep 0
s_add_u32 s100, s100, 1
s_bitcmp1_b32 s100, 19
s_cbranch_scc1 K_END
buffer_load_dword v230, v229, s[20:23], s95 offen sc0 sc1
s_waitcnt vmcnt(0)
v_cmp_gt_u32 vcc, 2, v230
s_nop 0
s_and_b32 s29, vcc_lo, 0xff
s_cbranch_scc1 SP_P2B
SP_P2B_RET:
buffer_load_dwordx4 v[80:83], v243, s[20:23], s65 offen offset:3072 sc0 sc1
buffer_load_dwordx4 v[84:87], v243, s[20:23], s66 offen offset:2048 sc0 sc1
buffer_load_dwordx4 v[88:91], v243, s[20:23], s67 offen offset:1024 sc0 sc1
buffer_load_dwordx4 v[92:95], v243, s[20:23], s68 offen offset:0 sc0 sc1
buffer_load_dwordx4 v[96:99], v243, s[20:23], s69 offen offset:3072 sc0 sc1
buffer_load_dwordx4 v[100:103], v243, s[20:23], s70 offen offset:2048 sc0 sc1
buffer_load_dwordx4 v[132:135], v243, s[20:23], s71 offen offset:1024 sc0 sc1
s_waitcnt vmcnt(17)
v_dot2c_f32_bf16 v66, s90, v200
v_dot2c_f32_bf16 v67, s91, v200
v_dot2c_f32_bf16 v68, s90, v201
v_dot2c_f32_bf16 v69, s91, v201
s_waitcnt vmcnt(16)
v_dot2c_f32_bf16 v66, s90, v202
v_dot2c_f32_bf16 v67, s91, v202
v_dot2c_f32_bf16 v68, s90, v203
v_dot2c_f32_bf16 v69, s91, v203
s_waitcnt vmcnt(15)
v_dot2c_f32_bf16 v66, s90, v204
v_dot2c_f32_bf16 v67, s91, v204
v_dot2c_f32_bf16 v68, s90, v205
v_dot2c_f32_bf16 v69, s91, v205
s_waitcnt vmcnt(14)
v_dot2c_f32_bf16 v66, s90, v206
v_dot2c_f32_bf16 v67, s91, v206
v_dot2c_f32_bf16 v68, s90, v207
v_dot2c_f32_bf16 v69, s91, v207
s_waitcnt vmcnt(13)
v_dot2c_f32_bf16 v66, s90, v208
v_dot2c_f32_bf16 v67, s91, v208
v_dot2c_f32_bf16 v68, s90, v209
v_dot2c_f32_bf16 v69, s91, v209
s_waitcnt vmcnt(12)
v_dot2c_f32_bf16 v66, s90, v210
v_dot2c_f32_bf16 v67, s91, v210
v_dot2c_f32_bf16 v68, s90, v211
v_dot2c_f32_bf16 v69, s91, v211
s_waitcnt vmcnt(11)
v_dot2c_f32_bf16 v66, s90, v212
v_dot2c_f32_bf16 v67, s91, v212
v_dot2c_f32_bf16 v68, s90, v213
v_dot2c_f32_bf16 v69, s91, v213
s_waitcnt vmcnt(10)
v_dot2c_f32_bf16 v66, s90, v214
v_dot2c_f32_bf16 v67, s91, v214
v_dot2c_f32_bf16 v68, s90, v215
v_dot2c_f32_bf16 v69, s91, v215
s_nop 2
s_cmp_eq_u32 s34, 0
s_cselect_b32 s29, 0, 0x7fbffff0
v_cvt_pk_bf16_f32 v58, v66, v67
v_cvt_pk_bf16_f32 v59, v68, v69
v_lshlrev_b32 v66, 16, v58
v_and_b32 v67, 0xffff0000, v58
v_lshlrev_b32 v68, 16, v59
v_and_b32 v69, 0xffff0000, v59
v_pk_mul_f32 v[66:67], v[66:67], v[54:55]
v_pk_mul_f32 v[68:69], v[68:69], v[56:57]
v_cvt_pk_bf16_f32 v58, v66, v67
v_cvt_pk_bf16_f32 v59, v68, v69
v_lshlrev_b32 v66, 16, v58
v_and_b32 v67, 0xffff0000, v58
v_lshlrev_b32 v68, 16, v59
v_and_b32 v69, 0xffff0000, v59
v_pk_add_f32 v[66:67], v[66:67], v[34:35]
v_pk_add_f32 v[68:69], v[68:69], v[36:37]
v_cvt_pk_bf16_f32 v66, v66, v67
v_cvt_pk_bf16_f32 v67, v68, v69
buffer_store_dwordx2 v[66:67], v249, s[60:63], s29 offen
s_waitcnt vmcnt(7)
v_dot2c_f32_bf16 v136, s90, v80
v_dot2c_f32_bf16 v137, s91, v80
v_dot2c_f32_bf16 v138, s90, v81
v_dot2c_f32_bf16 v139, s91, v81
v_dot2c_f32_bf16 v140, s90, v82
v_dot2c_f32_bf16 v141, s91, v82
v_dot2c_f32_bf16 v142, s90, v83
v_dot2c_f32_bf16 v143, s91, v83
s_waitcnt vmcnt(6)
v_dot2c_f32_bf16 v136, s90, v84
v_dot2c_f32_bf16 v137, s91, v84
v_dot2c_f32_bf16 v138, s90, v85
v_dot2c_f32_bf16 v139, s91, v85
v_dot2c_f32_bf16 v140, s90, v86
v_dot2c_f32_bf16 v141, s91, v86
v_dot2c_f32_bf16 v142, s90, v87
v_dot2c_f32_bf16 v143, s91, v87
s_waitcnt vmcnt(5)
v_dot2c_f32_bf16 v136, s90, v88
v_dot2c_f32_bf16 v137, s91, v88
v_dot2c_f32_bf16 v138, s90, v89
v_dot2c_f32_bf16 v139, s91, v89
v_dot2c_f32_bf16 v140, s90, v90
v_dot2c_f32_bf16 v141, s91, v90
v_dot2c_f32_bf16 v142, s90, v91
v_dot2c_f32_bf16 v143, s91, v91
s_waitcnt vmcnt(4)
v_dot2c_f32_bf16 v136, s90, v92
v_dot2c_f32_bf16 v137, s91, v92
v_dot2c_f32_bf16 v138, s90, v93
v_dot2c_f32_bf16 v139, s91, v93
v_dot2c_f32_bf16 v140, s90, v94
v_dot2c_f32_bf16 v141, s91, v94
v_dot2c_f32_bf16 v142, s90, v95
v_dot2c_f32_bf16 v143, s91, v95
s_waitcnt vmcnt(3)
v_dot2c_f32_bf16 v136, s90, v96
v_dot2c_f32_bf16 v137, s91, v96
v_dot2c_f32_bf16 v138, s90, v97
v_dot2c_f32_bf16 v139, s91, v97
v_dot2c_f32_bf16 v140, s90, v98
v_dot2c_f32_bf16 v141, s91, v98
v_dot2c_f32_bf16 v142, s90, v99
v_dot2c_f32_bf16 v143, s91, v99
s_waitcnt vmcnt(2)
v_dot2c_f32_bf16 v136, s90, v100
v_dot2c_f32_bf16 v137, s91, v100
v_dot2c_f32_bf16 v138, s90, v101
v_dot2c_f32_bf16 v139, s91, v101
v_dot2c_f32_bf16 v140, s90, v102
v_dot2c_f32_bf16 v141, s91, v102
v_dot2c_f32_bf16 v142, s90, v103
v_dot2c_f32_bf16 v143, s91, v103
s_waitcnt vmcnt(1)
v_dot2c_f32_bf16 v136, s90, v132
v_dot2c_f32_bf16 v137, s91, v132
v_dot2c_f32_bf16 v138, s90, v133
v_dot2c_f32_bf16 v139, s91, v133
v_dot2c_f32_bf16 v140, s90, v134
v_dot2c_f32_bf16 v141, s91, v134
v_dot2c_f32_bf16 v142, s90, v135
v_dot2c_f32_bf16 v143, s91, v135
s_nop 2
v_cvt_pk_bf16_f32 v58, v136, v137
v_cvt_pk_bf16_f32 v59, v138, v139
v_cvt_pk_bf16_f32 v60, v140, v141
v_cvt_pk_bf16_f32 v61, v142, v143
v_lshlrev_b32 v136, 16, v58
v_and_b32 v137, 0xffff0000, v58
v_lshlrev_b32 v138, 16, v59
v_and_b32 v139, 0xffff0000, v59
v_lshlrev_b32 v140, 16, v60
v_and_b32 v141, 0xffff0000, v60
v_lshlrev_b32 v142, 16, v61
v_and_b32 v143, 0xffff0000, v61
v_pk_mul_f32 v[136:137], v[136:137], v[46:47]
v_pk_mul_f32 v[138:139], v[138:139], v[48:49]
v_pk_mul_f32 v[140:141], v[140:141], v[50:51]
v_pk_mul_f32 v[142:143], v[142:143], v[52:53]
v_cvt_pk_bf16_f32 v58, v136, v137
v_cvt_pk_bf16_f32 v59, v138, v139
v_cvt_pk_bf16_f32 v60, v140, v141
v_cvt_pk_bf16_f32 v61, v142, v143
v_lshlrev_b32 v136, 16, v58
v_and_b32 v137, 0xffff0000, v58
v_lshlrev_b32 v138, 16, v59
v_and_b32 v139, 0xffff0000, v59
v_lshlrev_b32 v140, 16, v60
v_and_b32 v141, 0xffff0000, v60
v_lshlrev_b32 v142, 16, v61
v_and_b32 v143, 0xffff0000, v61
v_pk_add_f32 v[136:137], v[136:137], v[26:27]
v_pk_add_f32 v[138:139], v[138:139], v[28:29]
v_pk_add_f32 v[140:141], v[140:141], v[30:31]
v_pk_add_f32 v[142:143], v[142:143], v[32:33]
v_cvt_pk_bf16_f32 v136, v136, v137
v_cvt_pk_bf16_f32 v137, v138, v139
v_cvt_pk_bf16_f32 v138, v140, v141
v_cvt_pk_bf16_f32 v139, v142, v143
buffer_store_dwordx4 v[136:139], v248, s[60:63], 0 offen offset:128
s_endpgm
SP_O1B:
s_sleep 1
s_add_u32 s100, s100, 1
s_bitcmp1_b32 s100, 19
s_cbranch_scc1 K_END
buffer_load_dword v230, v229, s[20:23], s94 offen sc0 sc1
s_waitcnt vmcnt(0)
v_cmp_gt_u32 vcc, 1, v230
s_bitcmp1_b32 vcc_lo, s39
s_cbranch_scc1 SP_O1B
s_branch SP_O1B_RET
SP_O2B:
s_sleep 1
s_add_u32 s100, s100, 1
s_bitcmp1_b32 s100, 19
s_cbranch_scc1 K_END
buffer_load_dword v230, v229, s[20:23], s94 offen sc0 sc1
s_waitcnt vmcnt(0)
v_cmp_gt_u32 vcc, 1, v230
s_and_b32 s29, vcc_lo, 15
s_cbranch_scc1 SP_O2B
s_branch SP_O2B_RET
SP_O3B:
s_sleep 1
s_add_u32 s100, s100, 1
s_bitcmp1_b32 s100, 19
s_cbranch_scc1 K_END
buffer_load_dword v230, v229, s[20:23], s94 offen sc0 sc1
s_waitcnt vmcnt(0)
v_cmp_gt_u32 vcc, 2, v230
s_and_b32 s29, vcc_lo, 15
s_cbranch_scc1 SP_O3B
s_branch SP_O3B_RET
SP_P1B:
s_sleep 1
s_add_u32 s100, s100, 1
s_bitcmp1_b32 s100, 19
s_cbranch_scc1 K_END
buffer_load_dword v230, v229, s[20:23], s95 offen sc0 sc1
s_waitcnt vmcnt(0)
v_cmp_gt_u32 vcc, 1, v230
s_and_b32 s29, vcc_lo, 0xff
s_cbranch_scc1 SP_P1B
s_branch SP_P1B_RET
F_NOTYET:
s_bitcmp1_b32 s51, 30
s_cbranch_scc1 F_BSENT
s_bitset1_b32 s51, 30
s_mov_b32 s46, 0x60
s_mov_b32 s50, s28
s_add_u32 s28, s45, 0x0
buffer_store_dwordx4 v[72:75], v169, s[20:23], s28 offen offset:0 sc0 sc1
buffer_store_dwordx4 v[76:79], v169, s[20:23], s28 offen offset:2048 sc0 sc1
s_add_u32 s28, s28, 4096
buffer_store_dwordx4 v[80:83], v169, s[20:23], s28 offen offset:0 sc0 sc1
buffer_store_dwordx4 v[84:87], v169, s[20:23], s28 offen offset:2048 sc0 sc1
s_add_u32 s28, s28, 4096
buffer_store_dwordx4 v[88:91], v169, s[20:23], s28 offen offset:0 sc0 sc1
buffer_store_dwordx4 v[92:95], v169, s[20:23], s28 offen offset:2048 sc0 sc1
s_add_u32 s28, s28, 4096
buffer_store_dwordx4 v[96:99], v169, s[20:23], s28 offen offset:0 sc0 sc1
buffer_store_dwordx4 v[100:103], v169, s[20:23], s28 offen offset:2048 sc0 sc1
s_add_u32 s28, s28, 4096
buffer_store_dwordx4 v[104:107], v169, s[20:23], s28 offen offset:0 sc0 sc1
s_lshl_b32 s28, s3, 2
s_add_u32 s28, s28, 0x240000
buffer_store_dword v65, v64, s[20:23], s28 offen sc0 sc1
s_mov_b32 s28, s50
s_or_b32 s29, s38, 0x40
v_mov_b32 v62, s29
v_mov_b32 v63, s35
s_lshl_b32 s29, s36, 5
s_waitcnt vmcnt(0)
s_mov_b64 exec, 1
buffer_store_byte v62, v63, s[24:27], s29 offen sc0 sc1
s_mov_b64 exec, -1
F_BSENT:
s_lshl_b32 s29, s36, 5
buffer_load_dword v62, v64, s[24:27], s29 offen sc0 sc1
s_waitcnt vmcnt(0)
v_and_b32 v63, 0x40404040, v62
v_cmp_ne_u32 vcc, 0x40404040, v63
s_cbranch_vccnz F_NOB
s_mul_i32 s29, s38, 0x01010101
v_and_b32 v62, 0x0f0f0f0f, v62
v_cmp_ne_u32 vcc, s29, v62
v_mov_b32 v60, 0
s_cbranch_vccnz F_GO
v_mov_b32 v60, 1
s_branch F_GO
F_NOB:
s_sleep 1
s_add_u32 s100, s100, 1
s_bitcmp1_b32 s100, 19
s_cbranch_scc1 K_END
s_branch F_POLL
Q_REDO:
s_mov_b32 s4, 0
s_mov_b32 s51, 0
s_waitcnt vmcnt(0) lgkmcnt(0)
s_branch Q_START
K_FALLBACK:
s_mov_b32 s43, 1
s_mov_b32 s3, 0
s_mov_b32 s86, 0x30000
s_mov_b32 s66, 0
s_mov_b32 s70, 0
s_mov_b32 s74, 0
s_waitcnt vmcnt(0) lgkmcnt(0)
s_barrier
v_mov_b32 v254, 0x7ffffff0
v_mov_b32 v136, 0xff800000
v_mov_b32 v140, 0xff800000
v_mov_b32 v144, 0xff800000
v_mov_b32 v148, 0xff800000
s_mov_b32 s32, 0
s_mov_b32 s33, 32
K_FBLOOP:
s_add_u32 m0, s30, 81920
s_nop 0
buffer_load_dwordx4 v228, s[8:11], s32 offen offset:0  lds
buffer_load_dwordx4 v229, s[8:11], s32 offen offset:1024  lds
buffer_load_dwordx4 v230, s[8:11], s32 offen offset:2048  lds
buffer_load_dwordx4 v231, s[8:11], s32 offen offset:3072  lds
s_waitcnt vmcnt(0)
s_barrier
ds_read_b128 a[144:147], v216 offset:16384
ds_read_b128 a[148:151], v217 offset:16384
ds_read_b128 a[152:155], v218 offset:16384
ds_read_b128 a[156:159], v219 offset:16384
ds_read_b128 a[160:163], v216 offset:20480
ds_read_b128 a[164:167], v217 offset:20480
ds_read_b128 a[168:171], v218 offset:20480
ds_read_b128 a[172:175], v219 offset:20480
s_waitcnt lgkmcnt(0)
v_mfma_f32_16x16x32_bf16 v[8:11], a[144:147], v[152:155], 0
v_mfma_f32_16x16x32_bf16 v[16:19], a[144:147], v[168:171], 0
v_mfma_f32_16x16x32_bf16 v[24:27], a[144:147], v[184:187], 0
v_mfma_f32_16x16x32_bf16 v[32:35], a[144:147], v[200:203], 0
v_mfma_f32_16x16x32_bf16 v[8:11], a[148:151], v[156:159], v[8:11]
v_mfma_f32_16x16x32_bf16 v[16:19], a[148:151], v[172:175], v[16:19]
v_mfma_f32_16x16x32_bf16 v[24:27], a[148:151], v[188:191], v[24:27]
v_mfma_f32_16x16x32_bf16 v[32:35], a[148:151], v[204:207], v[32:35]
v_mfma_f32_16x16x32_bf16 v[8:11], a[152:155], v[160:163], v[8:11]
v_mfma_f32_16x16x32_bf16 v[16:19], a[152:155], v[176:179], v[16:19]
v_mfma_f32_16x16x32_bf16 v[24:27], a[152:155], v[192:195], v[24:27]
v_mfma_f32_16x16x32_bf16 v[32:35], a[152:155], v[208:211], v[32:35]
v_mfma_f32_16x16x32_bf16 v[8:11], a[156:159], v[164:167], v[8:11]
v_mfma_f32_16x16x32_bf16 v[16:19], a[156:159], v[180:183], v[16:19]
v_mfma_f32_16x16x32_bf16 v[24:27], a[156:159], v[196:199], v[24:27]
v_mfma_f32_16x16x32_bf16 v[32:35], a[156:159], v[212:215], v[32:35]
v_mfma_f32_16x16x32_bf16 v[12:15], a[160:163], v[152:155], 0
v_mfma_f32_16x16x32_bf16 v[20:23], a[160:163], v[168:171], 0
v_mfma_f32_16x16x32_bf16 v[28:31], a[160:163], v[184:187], 0
v_mfma_f32_16x16x32_bf16 v[36:39], a[160:163], v[200:203], 0
v_mfma_f32_16x16x32_bf16 v[12:15], a[164:167], v[156:159], v[12:15]
v_mfma_f32_16x16x32_bf16 v[20:23], a[164:167], v[172:175], v[20:23]
v_mfma_f32_16x16x32_bf16 v[28:31], a[164:167], v[188:191], v[28:31]
v_mfma_f32_16x16x32_bf16 v[36:39], a[164:167], v[204:207], v[36:39]
v_mfma_f32_16x16x32_bf16 v[12:15], a[168:171], v[160:163], v[12:15]
v_mfma_f32_16x16x32_bf16 v[20:23], a[168:171], v[176:179], v[20:23]
v_mfma_f32_16x16x32_bf16 v[28:31], a[168:171], v[192:195], v[28:31]
v_mfma_f32_16x16x32_bf16 v[36:39], a[168:171], v[208:211], v[36:39]
v_mfma_f32_16x16x32_bf16 v[12:15], a[172:175], v[164:167], v[12:15]
v_mfma_f32_16x16x32_bf16 v[20:23], a[172:175], v[180:183], v[20:23]
v_mfma_f32_16x16x32_bf16 v[28:31], a[172:175], v[196:199], v[28:31]
v_mfma_f32_16x16x32_bf16 v[36:39], a[172:175], v[212:215], v[36:39]
s_nop 7
s_nop 3
v_max3_f32 v136, v136, v8, v9
v_max3_f32 v136, v136, v10, v11
v_max3_f32 v136, v136, v12, v13
v_max3_f32 v136, v136, v14, v15
v_max3_f32 v140, v140, v16, v17
v_max3_f32 v140, v140, v18, v19
v_max3_f32 v140, v140, v20, v21
v_max3_f32 v140, v140, v22, v23
v_max3_f32 v144, v144, v24, v25
v_max3_f32 v144, v144, v26, v27
v_max3_f32 v144, v144, v28, v29
v_max3_f32 v144, v144, v30, v31
v_max3_f32 v148, v148, v32, v33
v_max3_f32 v148, v148, v34, v35
v_max3_f32 v148, v148, v36, v37
v_max3_f32 v148, v148, v38, v39
ds_read_b128 a[144:147], v216 offset:24576
ds_read_b128 a[148:151], v217 offset:24576
ds_read_b128 a[152:155], v218 offset:24576
ds_read_b128 a[156:159], v219 offset:24576
ds_read_b128 a[160:163], v216 offset:28672
ds_read_b128 a[164:167], v217 offset:28672
ds_read_b128 a[168:171], v218 offset:28672
ds_read_b128 a[172:175], v219 offset:28672
s_waitcnt lgkmcnt(0)
v_mfma_f32_16x16x32_bf16 v[8:11], a[144:147], v[152:155], 0
v_mfma_f32_16x16x32_bf16 v[16:19], a[144:147], v[168:171], 0
v_mfma_f32_16x16x32_bf16 v[24:27], a[144:147], v[184:187], 0
v_mfma_f32_16x16x32_bf16 v[32:35], a[144:147], v[200:203], 0
v_mfma_f32_16x16x32_bf16 v[8:11], a[148:151], v[156:159], v[8:11]
v_mfma_f32_16x16x32_bf16 v[16:19], a[148:151], v[172:175], v[16:19]
v_mfma_f32_16x16x32_bf16 v[24:27], a[148:151], v[188:191], v[24:27]
v_mfma_f32_16x16x32_bf16 v[32:35], a[148:151], v[204:207], v[32:35]
v_mfma_f32_16x16x32_bf16 v[8:11], a[152:155], v[160:163], v[8:11]
v_mfma_f32_16x16x32_bf16 v[16:19], a[152:155], v[176:179], v[16:19]
v_mfma_f32_16x16x32_bf16 v[24:27], a[152:155], v[192:195], v[24:27]
v_mfma_f32_16x16x32_bf16 v[32:35], a[152:155], v[208:211], v[32:35]
v_mfma_f32_16x16x32_bf16 v[8:11], a[156:159], v[164:167], v[8:11]
v_mfma_f32_16x16x32_bf16 v[16:19], a[156:159], v[180:183], v[16:19]
v_mfma_f32_16x16x32_bf16 v[24:27], a[156:159], v[196:199], v[24:27]
v_mfma_f32_16x16x32_bf16 v[32:35], a[156:159], v[212:215], v[32:35]
v_mfma_f32_16x16x32_bf16 v[12:15], a[160:163], v[152:155], 0
v_mfma_f32_16x16x32_bf16 v[20:23], a[160:163], v[168:171], 0
v_mfma_f32_16x16x32_bf16 v[28:31], a[160:163], v[184:187], 0
v_mfma_f32_16x16x32_bf16 v[36:39], a[160:163], v[200:203], 0
v_mfma_f32_16x16x32_bf16 v[12:15], a[164:167], v[156:159], v[12:15]
v_mfma_f32_16x16x32_bf16 v[20:23], a[164:167], v[172:175], v[20:23]
v_mfma_f32_16x16x32_bf16 v[28:31], a[164:167], v[188:191], v[28:31]
v_mfma_f32_16x16x32_bf16 v[36:39], a[164:167], v[204:207], v[36:39]
v_mfma_f32_16x16x32_bf16 v[12:15], a[168:171], v[160:163], v[12:15]
v_mfma_f32_16x16x32_bf16 v[20:23], a[168:171], v[176:179], v[20:23]
v_mfma_f32_16x16x32_bf16 v[28:31], a[168:171], v[192:195], v[28:31]
v_mfma_f32_16x16x32_bf16 v[36:39], a[168:171], v[208:211], v[36:39]
v_mfma_f32_16x16x32_bf16 v[12:15], a[172:175], v[164:167], v[12:15]
v_mfma_f32_16x16x32_bf16 v[20:23], a[172:175], v[180:183], v[20:23]
v_mfma_f32_16x16x32_bf16 v[28:31], a[172:175], v[196:199], v[28:31]
v_mfma_f32_16x16x32_bf16 v[36:39], a[172:175], v[212:215], v[36:39]
s_nop 7
s_nop 3
v_max3_f32 v136, v136, v8, v9
v_max3_f32 v136, v136, v10, v11
v_max3_f32 v136, v136, v12, v13
v_max3_f32 v136, v136, v14, v15
v_max3_f32 v140, v140, v16, v17
v_max3_f32 v140, v140, v18, v19
v_max3_f32 v140, v140, v20, v21
v_max3_f32 v140, v140, v22, v23
v_max3_f32 v144, v144, v24, v25
v_max3_f32 v144, v144, v26, v27
v_max3_f32 v144, v144, v28, v29
v_max3_f32 v144, v144, v30, v31
v_max3_f32 v148, v148, v32, v33
v_max3_f32 v148, v148, v34, v35
v_max3_f32 v148, v148, v36, v37
v_max3_f32 v148, v148, v38, v39
s_barrier
s_add_u32 s32, s32, 16384
s_sub_u32 s33, s33, 1
s_cmp_lg_u32 s33, 0
s_cbranch_scc1 K_FBLOOP
v_mov_b32 v246, v136
s_nop 1
v_permlane16_swap_b32 v136, v246
v_max_f32 v136, v136, v246
v_mov_b32 v246, v136
s_nop 1
v_permlane32_swap_b32 v136, v246
v_max_f32 v136, v136, v246
v_sub_f32 v136, 0, v136
v_mov_b32 v137, v136
v_mov_b32 v138, v136
v_mov_b32 v139, v136
v_mov_b32 v246, v140
s_nop 1
v_permlane16_swap_b32 v140, v246
v_max_f32 v140, v140, v246
v_mov_b32 v246, v140
s_nop 1
v_permlane32_swap_b32 v140, v246
v_max_f32 v140, v140, v246
v_sub_f32 v140, 0, v140
v_mov_b32 v141, v140
v_mov_b32 v142, v140
v_mov_b32 v143, v140
v_mov_b32 v246, v144
s_nop 1
v_permlane16_swap_b32 v144, v246
v_max_f32 v144, v144, v246
v_mov_b32 v246, v144
s_nop 1
v_permlane32_swap_b32 v144, v246
v_max_f32 v144, v144, v246
v_sub_f32 v144, 0, v144
v_mov_b32 v145, v144
v_mov_b32 v146, v144
v_mov_b32 v147, v144
v_mov_b32 v246, v148
s_nop 1
v_permlane16_swap_b32 v148, v246
v_max_f32 v148, v148, v246
v_mov_b32 v246, v148
s_nop 1
v_permlane32_swap_b32 v148, v246
v_max_f32 v148, v148, v246
v_sub_f32 v148, 0, v148
v_mov_b32 v149, v148
v_mov_b32 v150, v148
v_mov_b32 v151, v148
s_add_u32 s32, s7, 0
s_add_u32 m0, s30, 81920
s_nop 0
buffer_load_dwordx4 v228, s[8:11], s32 offen offset:0  lds
buffer_load_dwordx4 v229, s[8:11], s32 offen offset:1024  lds
buffer_load_dwordx4 v230, s[8:11], s32 offen offset:2048  lds
buffer_load_dwordx4 v231, s[8:11], s32 offen offset:3072  lds
s_add_u32 s32, s7, 16384
s_add_u32 m0, s30, 114688
s_nop 0
buffer_load_dwordx4 v228, s[8:11], s32 offen offset:0  lds
buffer_load_dwordx4 v229, s[8:11], s32 offen offset:1024  lds
buffer_load_dwordx4 v230, s[8:11], s32 offen offset:2048  lds
buffer_load_dwordx4 v231, s[8:11], s32 offen offset:3072  lds
s_add_u32 s39, s7, 0
s_add_u32 m0, s30, 131072
s_nop 0
buffer_load_dwordx4 v232, s[12:15], s39 offen offset:0  lds
buffer_load_dwordx4 v233, s[12:15], s39 offen offset:1024  lds
buffer_load_dwordx4 v232, s[12:15], s39 offen offset:2048  lds
buffer_load_dwordx4 v233, s[12:15], s39 offen offset:3072  lds
s_add_u32 s32, s7, 32768
s_add_u32 m0, s30, 65536
s_nop 0
buffer_load_dwordx4 v228, s[8:11], s32 offen offset:0  lds
buffer_load_dwordx4 v229, s[8:11], s32 offen offset:1024  lds
buffer_load_dwordx4 v230, s[8:11], s32 offen offset:2048  lds
buffer_load_dwordx4 v231, s[8:11], s32 offen offset:3072  lds
s_add_u32 s39, s7, 16384
s_add_u32 m0, s30, 147456
s_nop 0
buffer_load_dwordx4 v232, s[12:15], s39 offen offset:0  lds
buffer_load_dwordx4 v233, s[12:15], s39 offen offset:1024  lds
buffer_load_dwordx4 v232, s[12:15], s39 offen offset:2048  lds
buffer_load_dwordx4 v233, s[12:15], s39 offen offset:3072  lds
s_waitcnt vmcnt(0)
s_barrier
ds_read_b128 a[144:147], v216 offset:16384
ds_read_b128 a[148:151], v217 offset:16384
ds_read_b128 a[152:155], v218 offset:16384
ds_read_b128 a[156:159], v219 offset:16384
ds_read_b128 a[160:163], v216 offset:20480
ds_read_b128 a[164:167], v217 offset:20480
ds_read_b128 a[168:171], v218 offset:20480
ds_read_b128 a[172:175], v219 offset:20480
s_add_u32 s32, s7, 32768
s_add_u32 s39, s7, 16384
s_mul_i32 s88, s37, 864
s_mov_b32 s87, s88
v_accvgpr_write_b32 a128, 0
v_accvgpr_write_b32 a129, 0
v_accvgpr_write_b32 a130, 0
v_accvgpr_write_b32 a131, 0
v_accvgpr_write_b32 a132, 0
v_accvgpr_write_b32 a133, 0
v_accvgpr_write_b32 a134, 0
v_accvgpr_write_b32 a135, 0
v_lshrrev_b32 v240, 2, v1
v_mul_u32_u24 v240, 0x2400, v240
v_and_b32 v246, 3, v1
v_lshl_add_u32 v240, v246, 4, v240
v_mul_u32_u24 v243, 3641, v1
v_lshrrev_b32 v243, 16, v243
v_mul_u32_u24 v243, 864, v243
v_add_u32 v243, v243, v244
s_waitcnt lgkmcnt(0)
v_mfma_f32_16x16x32_bf16 v[8:11], a[144:147], v[152:155], v[136:139]
v_mfma_f32_16x16x32_bf16 v[16:19], a[144:147], v[168:171], v[140:143]
v_mfma_f32_16x16x32_bf16 v[24:27], a[144:147], v[184:187], v[144:147]
v_mfma_f32_16x16x32_bf16 v[32:35], a[144:147], v[200:203], v[148:151]
ds_read_b128 a[144:147], v216 offset:24576
v_mfma_f32_16x16x32_bf16 v[8:11], a[148:151], v[156:159], v[8:11]
v_mfma_f32_16x16x32_bf16 v[16:19], a[148:151], v[172:175], v[16:19]
v_mfma_f32_16x16x32_bf16 v[24:27], a[148:151], v[188:191], v[24:27]
v_mfma_f32_16x16x32_bf16 v[32:35], a[148:151], v[204:207], v[32:35]
ds_read_b128 a[148:151], v217 offset:24576
v_mfma_f32_16x16x32_bf16 v[8:11], a[152:155], v[160:163], v[8:11]
v_mfma_f32_16x16x32_bf16 v[16:19], a[152:155], v[176:179], v[16:19]
v_mfma_f32_16x16x32_bf16 v[24:27], a[152:155], v[192:195], v[24:27]
v_mfma_f32_16x16x32_bf16 v[32:35], a[152:155], v[208:211], v[32:35]
ds_read_b128 a[152:155], v218 offset:24576
v_mfma_f32_16x16x32_bf16 v[8:11], a[156:159], v[164:167], v[8:11]
v_mfma_f32_16x16x32_bf16 v[16:19], a[156:159], v[180:183], v[16:19]
v_mfma_f32_16x16x32_bf16 v[24:27], a[156:159], v[196:199], v[24:27]
v_mfma_f32_16x16x32_bf16 v[32:35], a[156:159], v[212:215], v[32:35]
ds_read_b128 a[156:159], v219 offset:24576
v_mfma_f32_16x16x32_bf16 v[12:15], a[160:163], v[152:155], v[136:139]
v_mfma_f32_16x16x32_bf16 v[20:23], a[160:163], v[168:171], v[140:143]
v_mfma_f32_16x16x32_bf16 v[28:31], a[160:163], v[184:187], v[144:147]
v_mfma_f32_16x16x32_bf16 v[36:39], a[160:163], v[200:203], v[148:151]
ds_read_b128 a[160:163], v216 offset:28672
v_mfma_f32_16x16x32_bf16 v[12:15], a[164:167], v[156:159], v[12:15]
v_mfma_f32_16x16x32_bf16 v[20:23], a[164:167], v[172:175], v[20:23]
v_mfma_f32_16x16x32_bf16 v[28:31], a[164:167], v[188:191], v[28:31]
v_mfma_f32_16x16x32_bf16 v[36:39], a[164:167], v[204:207], v[36:39]
ds_read_b128 a[164:167], v217 offset:28672
v_mfma_f32_16x16x32_bf16 v[12:15], a[168:171], v[160:163], v[12:15]
v_mfma_f32_16x16x32_bf16 v[20:23], a[168:171], v[176:179], v[20:23]
v_mfma_f32_16x16x32_bf16 v[28:31], a[168:171], v[192:195], v[28:31]
v_mfma_f32_16x16x32_bf16 v[36:39], a[168:171], v[208:211], v[36:39]
ds_read_b128 a[168:171], v218 offset:28672
v_mfma_f32_16x16x32_bf16 v[12:15], a[172:175], v[164:167], v[12:15]
v_mfma_f32_16x16x32_bf16 v[20:23], a[172:175], v[180:183], v[20:23]
v_mfma_f32_16x16x32_bf16 v[28:31], a[172:175], v[196:199], v[28:31]
v_mfma_f32_16x16x32_bf16 v[36:39], a[172:175], v[212:215], v[36:39]
ds_read_b128 a[172:175], v219 offset:28672
s_nop 7
s_branch K_BODY0
K_CODE_END:
.section .rodata,"a"
.p2align 6
.amdhsa_kernel recurrent_scan__gqa_block_cached__moe_arch_mod__prompt_kernel
  .amdhsa_next_free_vgpr 512
  .amdhsa_next_free_sgpr 102
  .amdhsa_accum_offset 256
  .amdhsa_group_segment_fixed_size 0
  .amdhsa_kernarg_size 104
  .amdhsa_user_sgpr_count 2
  .amdhsa_user_sgpr_kernarg_segment_ptr 1
  .amdhsa_system_sgpr_workgroup_id_x 1
  .amdhsa_float_denorm_mode_32 3
.end_amdhsa_kernel
```

```asm
; @launch grid=(256,1,1) block=(256,1,1) lds=163840
.amdgcn_target "amdgcn-amd-amdhsa--gfx950"
.text
.globl recurrent_scan__gqa_block_cached__moe_arch_mod__prompt_kernel
.p2align 8
.type recurrent_scan__gqa_block_cached__moe_arch_mod__prompt_kernel,@function
recurrent_scan__gqa_block_cached__moe_arch_mod__prompt_kernel:
s_cmp_ge_u32 s2, 256
s_cbranch_scc1 K_END
s_mov_b32 s100, 0
s_load_dwordx16 s[64:79], s[0:1], 0
s_load_dwordx8 s[80:87], s[0:1], 64
s_load_dwordx2 s[88:89], s[0:1], 96
s_lshr_b32 s35, s2, 3
s_and_b32 s36, s2, 7
s_mul_i32 s5, s36, 9
s_lshr_b32 s5, s5, 2
s_lshl_b32 s3, s36, 8
s_lshl_b32 s28, s35, 3
s_add_u32 s3, s3, s28
v_lshrrev_b32 v5, 5, v0
v_add_u32 v5, s3, v5
v_and_b32 v6, 31, v0
v_mul_u32_u24 v7, 0x480, v5
v_lshl_add_u32 v7, v6, 2, v7
v_and_b32 v1, 63, v0
v_lshrrev_b32 v2, 6, v0
v_lshlrev_b32 v8, 2, v6
v_readfirstlane_b32 s37, v2
v_and_b32 v3, 15, v1
v_lshrrev_b32 v4, 4, v1
s_getpc_b64 s[96:97]
PC_a:
s_sub_u32 s96, s96, PC_a-recurrent_scan__gqa_block_cached__moe_arch_mod__prompt_kernel
s_subb_u32 s97, s97, 0
s_lshl_b32 s50, s35, 2
s_add_u32 s50, s50, s37
s_min_u32 s50, s50, ((K_HOT_END-recurrent_scan__gqa_block_cached__moe_arch_mod__prompt_kernel)>>10)-1
s_lshl_b32 s50, s50, 10
v_lshlrev_b32 v11, 4, v1
v_add_u32 v11, s50, v11
global_load_dwordx4 v[172:175], v11, s[96:97]
s_waitcnt lgkmcnt(0)
s_mov_b32 s52, s64
s_and_b32 s53, s65, 0xffff
s_mov_b32 s54, 0x240000
s_mov_b32 s55, 0x00020000
buffer_load_dword v18, v7, s[52:55], 0 offen offset:0
buffer_load_dword v19, v7, s[52:55], 0 offen offset:128
buffer_load_dword v20, v7, s[52:55], 0 offen offset:256
buffer_load_dword v21, v7, s[52:55], 0 offen offset:384
buffer_load_dword v22, v7, s[52:55], 0 offen offset:512
buffer_load_dword v23, v7, s[52:55], 0 offen offset:640
buffer_load_dword v24, v7, s[52:55], 0 offen offset:768
buffer_load_dword v25, v7, s[52:55], 0 offen offset:896
buffer_load_dword v26, v7, s[52:55], 0 offen offset:1024
s_mov_b32 s28, 0x24c000
s_load_dwordx2 s[6:7], s[88:89], s28
s_mov_b32 s92, s76
s_and_b32 s93, s77, 0xffff
s_mov_b32 s94, 0x480
s_mov_b32 s95, 0x00020000
buffer_load_dword v28, v8, s[92:95], 0 offen offset:0
buffer_load_dword v29, v8, s[92:95], 0 offen offset:128
buffer_load_dword v30, v8, s[92:95], 0 offen offset:256
buffer_load_dword v31, v8, s[92:95], 0 offen offset:384
buffer_load_dword v32, v8, s[92:95], 0 offen offset:512
buffer_load_dword v33, v8, s[92:95], 0 offen offset:640
buffer_load_dword v34, v8, s[92:95], 0 offen offset:768
buffer_load_dword v35, v8, s[92:95], 0 offen offset:896
buffer_load_dword v36, v8, s[92:95], 0 offen offset:1024
s_mov_b32 s20, s88
s_and_b32 s21, s89, 0xffff
s_mov_b32 s22, 0x8000000
s_mov_b32 s23, 0x00020000
s_lshr_b32 s45, s3, 4
s_mul_i32 s45, s45, 18432
s_and_b32 s29, s3, 15
s_lshl_b32 s29, s29, 4
s_add_u32 s45, s45, s29
v_lshrrev_b32 v9, 1, v0
v_lshlrev_b32 v9, 8, v9
v_and_b32 v10, 1, v0
v_lshl_add_u32 v9, v10, 6, v9
s_add_u32 s29, s45, 0x1800000
v_add_u32 v9, s29, v9
s_lshl_b32 s28, s36, 8
s_add_u32 s28, s28, 0x24ac00
v_lshlrev_b32 v10, 6, v0
v_add_u32 v10, s28, v10
v_cmp_lt_u32 vcc, 143, v0
s_lshl_b32 s29, s3, 2
s_add_u32 s29, s29, 0x1a40000
v_cndmask_b32 v9, v9, v10, vcc
v_mov_b32 v10, s29
v_cmp_lt_u32 vcc, 147, v0
s_nop 1
v_cndmask_b32 v9, v9, v10, vcc
buffer_load_dword v176, v9, s[20:23], 0 offen sc1
s_mov_b32 s16, s70
s_and_b32 s17, s71, 0xffff
s_mov_b32 s18, 0x480000
s_mov_b32 s19, 0x00020000
v_add_u32 v9, 0, v4
v_lshlrev_b32 v10, 1, v9
v_xor_b32 v10, v10, v3
v_lshlrev_b32 v10, 4, v10
v_lshl_add_u32 v238, v9, 13, v10
v_add_u32 v9, 4, v4
v_lshlrev_b32 v10, 1, v9
v_xor_b32 v10, v10, v3
v_lshlrev_b32 v10, 4, v10
v_lshl_add_u32 v239, v9, 13, v10
v_subrev_u32 v239, 1024, v239
s_cmp_eq_u32 s37, 0
s_cbranch_scc1 F_NOWQ
s_sub_u32 s28, s37, 1
s_lshl_b32 s49, s28, 11
s_lshl_b32 s28, s28, 16
s_lshl_b32 s34, s35, 8
s_add_u32 s34, s34, s28
s_lshl_b32 s28, s5, 18
s_add_u32 s34, s34, s28
s_add_u32 m0, s49, 65536
s_nop 0
buffer_load_dwordx4 v238, s[16:19], s34 offen offset:0 lds
buffer_load_dwordx4 v239, s[16:19], s34 offen offset:1024 lds
s_add_u32 s34, s34, 196608
s_sub_u32 s51, s34, 4718592
s_cselect_b32 s34, s34, s51
s_add_u32 m0, s49, 71680
s_nop 0
buffer_load_dwordx4 v238, s[16:19], s34 offen offset:0 lds
buffer_load_dwordx4 v239, s[16:19], s34 offen offset:1024 lds
s_add_u32 s34, s34, 196608
s_sub_u32 s51, s34, 4718592
s_cselect_b32 s34, s34, s51
s_add_u32 m0, s49, 77824
s_nop 0
buffer_load_dwordx4 v238, s[16:19], s34 offen offset:0 lds
buffer_load_dwordx4 v239, s[16:19], s34 offen offset:1024 lds
s_add_u32 s34, s34, 196608
s_sub_u32 s51, s34, 4718592
s_cselect_b32 s34, s34, s51
s_add_u32 m0, s49, 83968
s_nop 0
buffer_load_dwordx4 v238, s[16:19], s34 offen offset:0 lds
buffer_load_dwordx4 v239, s[16:19], s34 offen offset:1024 lds
s_add_u32 s34, s34, 196608
s_sub_u32 s51, s34, 4718592
s_cselect_b32 s34, s34, s51
s_add_u32 m0, s49, 90112
s_nop 0
buffer_load_dwordx4 v238, s[16:19], s34 offen offset:0 lds
buffer_load_dwordx4 v239, s[16:19], s34 offen offset:1024 lds
s_add_u32 s34, s34, 196608
s_sub_u32 s51, s34, 4718592
s_cselect_b32 s34, s34, s51
F_NOWQ:
s_getreg_b32 s38, hwreg(HW_REG_XCC_ID, 0, 4)
s_mov_b32 s24, s86
s_and_b32 s25, s87, 0xffff
s_mov_b32 s26, 0x100
s_mov_b32 s27, 0x00020000
s_add_u32 s28, s2, s37
s_cbranch_scc1 F_NOX
s_cmp_eq_u32 s28, 0
s_cbranch_scc0 F_NOX
s_or_b32 s28, s38, 0x80
v_mov_b32 v9, s28
v_mov_b32 v10, 0
s_mov_b64 exec, 1
buffer_store_byte v9, v10, s[24:27], 0 offen sc0 sc1
s_mov_b64 exec, -1
s_waitcnt vmcnt(2)
F_NOX:
v_and_b32 v66, 7, v1
v_mul_u32_u24 v67, 1168, v66
v_lshrrev_b32 v68, 5, v1
v_lshl_add_u32 v67, v68, 6, v67
v_bfe_u32 v69, v1, 3, 2
v_lshl_add_u32 v67, v69, 3, v67
v_add_u32 v168, 0x24000, v67
v_lshlrev_b32 v70, 10, v68
v_lshl_add_u32 v71, v69, 4, v66
v_lshl_add_u32 v169, v71, 4, v70
v_lshlrev_b32 v244, 4, v1
v_bfe_u32 v9, v1, 2, 2
v_and_b32 v10, 3, v1
v_lshl_add_u32 v11, v4, 2, v9
v_and_b32 v12, 7, v11
v_lshrrev_b32 v14, 1, v10
v_xor_b32 v14, v14, v12
v_and_b32 v15, 1, v10
v_lshlrev_b32 v15, 4, v15
v_lshl_add_u32 v15, v11, 8, v15
v_add_u32 v15, 0x10000, v15
v_xor_b32 v16, 0, v14
v_lshl_add_u32 v234, v16, 5, v15
v_xor_b32 v16, 2, v14
v_lshl_add_u32 v235, v16, 5, v15
v_xor_b32 v16, 4, v14
v_lshl_add_u32 v236, v16, 5, v15
v_xor_b32 v16, 6, v14
v_lshl_add_u32 v237, v16, 5, v15
s_lshl2_add_u32 s50, s36, s37
s_lshr_b32 s29, s35, 2
s_add_u32 s28, s29, 0
s_and_b32 s28, s28, 3
s_lshl2_add_u32 s28, s50, s28
s_mul_i32 s28, s28, 18432
v_add_u32 v240, s28, v244
s_add_u32 s28, s29, 1
s_and_b32 s28, s28, 3
s_lshl2_add_u32 s28, s50, s28
s_mul_i32 s28, s28, 18432
v_add_u32 v241, s28, v244
s_add_u32 s28, s29, 2
s_and_b32 s28, s28, 3
s_lshl2_add_u32 s28, s50, s28
s_mul_i32 s28, s28, 18432
v_add_u32 v242, s28, v244
s_add_u32 s28, s29, 3
s_and_b32 s28, s28, 3
s_lshl2_add_u32 s28, s50, s28
s_mul_i32 s28, s28, 18432
v_add_u32 v243, s28, v244
s_mov_b32 s40, 0x3e0293ee
s_mov_b32 s41, 0x3e0293ee
s_mov_b32 s76, 0x3ae38e39
s_mov_b32 s77, 0x3727c5ac
s_mov_b32 s75, 0xffff0000
s_cmp_eq_u32 s37, 0
s_cbranch_scc0 F_W1
s_waitcnt vmcnt(10)
s_branch F_W2
F_W1:
s_waitcnt vmcnt(20)
F_W2:
v_lshlrev_b32 v40, 16, v18
v_and_b32 v41, s75, v18
v_lshlrev_b32 v42, 16, v19
v_and_b32 v43, s75, v19
v_lshlrev_b32 v44, 16, v20
v_and_b32 v45, s75, v20
v_lshlrev_b32 v46, 16, v21
v_and_b32 v47, s75, v21
v_lshlrev_b32 v48, 16, v22
v_and_b32 v49, s75, v22
v_lshlrev_b32 v50, 16, v23
v_and_b32 v51, s75, v23
v_lshlrev_b32 v52, 16, v24
v_and_b32 v53, s75, v24
v_lshlrev_b32 v54, 16, v25
v_and_b32 v55, s75, v25
v_lshlrev_b32 v56, 16, v26
v_and_b32 v57, s75, v26
v_pk_add_f32 v[60:61], v[40:41], v[42:43]
v_pk_add_f32 v[62:63], v[44:45], v[46:47]
v_pk_add_f32 v[60:61], v[60:61], v[48:49]
v_pk_add_f32 v[62:63], v[62:63], v[50:51]
v_pk_add_f32 v[60:61], v[60:61], v[52:53]
v_pk_add_f32 v[62:63], v[62:63], v[54:55]
v_pk_add_f32 v[60:61], v[60:61], v[56:57]
v_pk_add_f32 v[60:61], v[60:61], v[62:63]
v_add_f32 v60, v60, v61
s_nop 1
v_add_f32_dpp v61, v60, v60 row_ror:8 row_mask:0xf bank_mask:0xf
s_nop 1
v_add_f32_dpp v60, v61, v61 row_ror:4 row_mask:0xf bank_mask:0xf
s_nop 1
v_add_f32_dpp v61, v60, v60 row_ror:2 row_mask:0xf bank_mask:0xf
s_nop 1
v_add_f32_dpp v60, v61, v61 row_ror:1 row_mask:0xf bank_mask:0xf
v_mov_b32 v61, v60
s_nop 1
v_permlane16_swap_b32 v60, v61
v_add_f32 v60, v60, v61
v_mul_f32 v60, s76, v60
v_mov_b32 v61, v60
v_pk_add_f32 v[66:67], v[40:41], v[60:61] neg_lo:[0,1] neg_hi:[0,1]
v_pk_mul_f32 v[62:63], v[66:67], v[66:67]
v_pk_add_f32 v[68:69], v[42:43], v[60:61] neg_lo:[0,1] neg_hi:[0,1]
v_pk_fma_f32 v[62:63], v[68:69], v[68:69], v[62:63]
v_pk_add_f32 v[66:67], v[44:45], v[60:61] neg_lo:[0,1] neg_hi:[0,1]
v_pk_fma_f32 v[62:63], v[66:67], v[66:67], v[62:63]
v_pk_add_f32 v[68:69], v[46:47], v[60:61] neg_lo:[0,1] neg_hi:[0,1]
v_pk_fma_f32 v[62:63], v[68:69], v[68:69], v[62:63]
v_pk_add_f32 v[66:67], v[48:49], v[60:61] neg_lo:[0,1] neg_hi:[0,1]
v_pk_fma_f32 v[62:63], v[66:67], v[66:67], v[62:63]
v_pk_add_f32 v[68:69], v[50:51], v[60:61] neg_lo:[0,1] neg_hi:[0,1]
v_pk_fma_f32 v[62:63], v[68:69], v[68:69], v[62:63]
v_pk_add_f32 v[66:67], v[52:53], v[60:61] neg_lo:[0,1] neg_hi:[0,1]
v_pk_fma_f32 v[62:63], v[66:67], v[66:67], v[62:63]
v_pk_add_f32 v[68:69], v[54:55], v[60:61] neg_lo:[0,1] neg_hi:[0,1]
v_pk_fma_f32 v[62:63], v[68:69], v[68:69], v[62:63]
v_pk_add_f32 v[66:67], v[56:57], v[60:61] neg_lo:[0,1] neg_hi:[0,1]
v_pk_fma_f32 v[62:63], v[66:67], v[66:67], v[62:63]
v_add_f32 v61, v62, v63
s_nop 1
v_add_f32_dpp v62, v61, v61 row_ror:8 row_mask:0xf bank_mask:0xf
s_nop 1
v_add_f32_dpp v61, v62, v62 row_ror:4 row_mask:0xf bank_mask:0xf
s_nop 1
v_add_f32_dpp v62, v61, v61 row_ror:2 row_mask:0xf bank_mask:0xf
s_nop 1
v_add_f32_dpp v61, v62, v62 row_ror:1 row_mask:0xf bank_mask:0xf
v_mov_b32 v62, v61
s_nop 1
v_permlane16_swap_b32 v61, v62
v_add_f32 v61, v61, v62
v_mul_f32 v61, s76, v61
v_cvt_pk_bf16_f32 v60, v60, v60
v_lshlrev_b32 v60, 16, v60
v_cvt_pk_bf16_f32 v61, v61, v61
v_lshlrev_b32 v61, 16, v61
v_add_f32 v61, s77, v61
v_cvt_pk_bf16_f32 v61, v61, v61
v_lshlrev_b32 v61, 16, v61
v_sqrt_f32 v61, v61
s_nop 0
v_cvt_pk_bf16_f32 v61, v61, v61
v_lshlrev_b32 v61, 16, v61
v_rcp_f32 v62, v61
v_mov_b32 v63, 0
v_lshrrev_b32 v69, 5, v0
v_mul_u32_u24 v65, 1168, v69
v_lshl_add_u32 v65, v6, 2, v65
v_add_u32 v209, 0x24000, v65
s_cmp_eq_u32 s37, 0
s_cbranch_scc0 F_W3
s_waitcnt vmcnt(1)
F_W3:
s_waitcnt vmcnt(11)
v_mov_b32 v70, v60
v_mov_b32 v71, v60
v_mov_b32 v72, v61
v_mov_b32 v73, v61
v_mov_b32 v74, v62
v_mov_b32 v75, v62
v_pk_add_f32 v[40:41], v[40:41], v[70:71] neg_lo:[0,1] neg_hi:[0,1]
v_cvt_pk_bf16_f32 v68, v40, v41
v_lshlrev_b32 v40, 16, v68
v_and_b32 v41, s75, v68
v_pk_mul_f32 v[66:67], v[40:41], v[74:75]
v_pk_fma_f32 v[40:41], v[66:67], v[72:73], v[40:41] neg_lo:[1,0,0] neg_hi:[1,0,0]
v_pk_fma_f32 v[66:67], v[40:41], v[74:75], v[66:67]
v_cvt_pk_bf16_f32 v200, v66, v67
v_pk_mul_f32 v[66:67], v[66:67], s[40:41]
v_dot2_f32_bf16 v63, v200, v28, v63
v_cvt_pk_bf16_f32 v18, v66, v67
ds_write_b32 v209, v18 offset:0
v_pk_add_f32 v[42:43], v[42:43], v[70:71] neg_lo:[0,1] neg_hi:[0,1]
v_cvt_pk_bf16_f32 v68, v42, v43
v_lshlrev_b32 v42, 16, v68
v_and_b32 v43, s75, v68
v_pk_mul_f32 v[66:67], v[42:43], v[74:75]
v_pk_fma_f32 v[42:43], v[66:67], v[72:73], v[42:43] neg_lo:[1,0,0] neg_hi:[1,0,0]
v_pk_fma_f32 v[66:67], v[42:43], v[74:75], v[66:67]
v_cvt_pk_bf16_f32 v201, v66, v67
v_pk_mul_f32 v[66:67], v[66:67], s[40:41]
v_dot2_f32_bf16 v63, v201, v29, v63
v_cvt_pk_bf16_f32 v19, v66, v67
ds_write_b32 v209, v19 offset:128
v_pk_add_f32 v[44:45], v[44:45], v[70:71] neg_lo:[0,1] neg_hi:[0,1]
v_cvt_pk_bf16_f32 v68, v44, v45
v_lshlrev_b32 v44, 16, v68
v_and_b32 v45, s75, v68
v_pk_mul_f32 v[66:67], v[44:45], v[74:75]
v_pk_fma_f32 v[44:45], v[66:67], v[72:73], v[44:45] neg_lo:[1,0,0] neg_hi:[1,0,0]
v_pk_fma_f32 v[66:67], v[44:45], v[74:75], v[66:67]
v_cvt_pk_bf16_f32 v202, v66, v67
v_pk_mul_f32 v[66:67], v[66:67], s[40:41]
v_dot2_f32_bf16 v63, v202, v30, v63
v_cvt_pk_bf16_f32 v20, v66, v67
ds_write_b32 v209, v20 offset:256
v_pk_add_f32 v[46:47], v[46:47], v[70:71] neg_lo:[0,1] neg_hi:[0,1]
v_cvt_pk_bf16_f32 v68, v46, v47
v_lshlrev_b32 v46, 16, v68
v_and_b32 v47, s75, v68
v_pk_mul_f32 v[66:67], v[46:47], v[74:75]
v_pk_fma_f32 v[46:47], v[66:67], v[72:73], v[46:47] neg_lo:[1,0,0] neg_hi:[1,0,0]
v_pk_fma_f32 v[66:67], v[46:47], v[74:75], v[66:67]
v_cvt_pk_bf16_f32 v203, v66, v67
v_pk_mul_f32 v[66:67], v[66:67], s[40:41]
v_dot2_f32_bf16 v63, v203, v31, v63
v_cvt_pk_bf16_f32 v21, v66, v67
ds_write_b32 v209, v21 offset:384
v_pk_add_f32 v[48:49], v[48:49], v[70:71] neg_lo:[0,1] neg_hi:[0,1]
v_cvt_pk_bf16_f32 v68, v48, v49
v_lshlrev_b32 v48, 16, v68
v_and_b32 v49, s75, v68
v_pk_mul_f32 v[66:67], v[48:49], v[74:75]
v_pk_fma_f32 v[48:49], v[66:67], v[72:73], v[48:49] neg_lo:[1,0,0] neg_hi:[1,0,0]
v_pk_fma_f32 v[66:67], v[48:49], v[74:75], v[66:67]
v_cvt_pk_bf16_f32 v204, v66, v67
v_pk_mul_f32 v[66:67], v[66:67], s[40:41]
v_dot2_f32_bf16 v63, v204, v32, v63
v_cvt_pk_bf16_f32 v22, v66, v67
ds_write_b32 v209, v22 offset:512
v_pk_add_f32 v[50:51], v[50:51], v[70:71] neg_lo:[0,1] neg_hi:[0,1]
v_cvt_pk_bf16_f32 v68, v50, v51
v_lshlrev_b32 v50, 16, v68
v_and_b32 v51, s75, v68
v_pk_mul_f32 v[66:67], v[50:51], v[74:75]
v_pk_fma_f32 v[50:51], v[66:67], v[72:73], v[50:51] neg_lo:[1,0,0] neg_hi:[1,0,0]
v_pk_fma_f32 v[66:67], v[50:51], v[74:75], v[66:67]
v_cvt_pk_bf16_f32 v205, v66, v67
v_pk_mul_f32 v[66:67], v[66:67], s[40:41]
v_dot2_f32_bf16 v63, v205, v33, v63
v_cvt_pk_bf16_f32 v23, v66, v67
ds_write_b32 v209, v23 offset:640
v_pk_add_f32 v[52:53], v[52:53], v[70:71] neg_lo:[0,1] neg_hi:[0,1]
v_cvt_pk_bf16_f32 v68, v52, v53
v_lshlrev_b32 v52, 16, v68
v_and_b32 v53, s75, v68
v_pk_mul_f32 v[66:67], v[52:53], v[74:75]
v_pk_fma_f32 v[52:53], v[66:67], v[72:73], v[52:53] neg_lo:[1,0,0] neg_hi:[1,0,0]
v_pk_fma_f32 v[66:67], v[52:53], v[74:75], v[66:67]
v_cvt_pk_bf16_f32 v206, v66, v67
v_pk_mul_f32 v[66:67], v[66:67], s[40:41]
v_dot2_f32_bf16 v63, v206, v34, v63
v_cvt_pk_bf16_f32 v24, v66, v67
ds_write_b32 v209, v24 offset:768
v_pk_add_f32 v[54:55], v[54:55], v[70:71] neg_lo:[0,1] neg_hi:[0,1]
v_cvt_pk_bf16_f32 v68, v54, v55
v_lshlrev_b32 v54, 16, v68
v_and_b32 v55, s75, v68
v_pk_mul_f32 v[66:67], v[54:55], v[74:75]
v_pk_fma_f32 v[54:55], v[66:67], v[72:73], v[54:55] neg_lo:[1,0,0] neg_hi:[1,0,0]
v_pk_fma_f32 v[66:67], v[54:55], v[74:75], v[66:67]
v_cvt_pk_bf16_f32 v207, v66, v67
v_pk_mul_f32 v[66:67], v[66:67], s[40:41]
v_dot2_f32_bf16 v63, v207, v35, v63
v_cvt_pk_bf16_f32 v25, v66, v67
ds_write_b32 v209, v25 offset:896
v_pk_add_f32 v[56:57], v[56:57], v[70:71] neg_lo:[0,1] neg_hi:[0,1]
v_cvt_pk_bf16_f32 v68, v56, v57
v_lshlrev_b32 v56, 16, v68
v_and_b32 v57, s75, v68
v_pk_mul_f32 v[66:67], v[56:57], v[74:75]
v_pk_fma_f32 v[56:57], v[66:67], v[72:73], v[56:57] neg_lo:[1,0,0] neg_hi:[1,0,0]
v_pk_fma_f32 v[66:67], v[56:57], v[74:75], v[66:67]
v_cvt_pk_bf16_f32 v208, v66, v67
v_pk_mul_f32 v[66:67], v[66:67], s[40:41]
v_dot2_f32_bf16 v63, v208, v36, v63
v_cvt_pk_bf16_f32 v26, v66, v67
ds_write_b32 v209, v26 offset:1024
s_nop 2
s_nop 1
v_add_f32_dpp v62, v63, v63 row_ror:8 row_mask:0xf bank_mask:0xf
s_nop 1
v_add_f32_dpp v63, v62, v62 row_ror:4 row_mask:0xf bank_mask:0xf
s_nop 1
v_add_f32_dpp v62, v63, v63 row_ror:2 row_mask:0xf bank_mask:0xf
s_nop 1
v_add_f32_dpp v63, v62, v62 row_ror:1 row_mask:0xf bank_mask:0xf
v_mov_b32 v62, v63
s_nop 1
v_permlane16_swap_b32 v63, v62
v_add_f32 v63, v63, v62
v_cvt_pk_bf16_f32 v63, v63, v63
v_lshlrev_b32 v63, 16, v63
v_ashrrev_i32 v66, 31, v63
v_or_b32 v66, 0x80000000, v66
v_xor_b32 v63, v63, v66
v_and_b32 v63, s75, v63
v_sub_u32 v66, 0xffff, v5
v_or_b32 v63, v63, v66
v_lshlrev_b32 v66, 2, v69
v_add_u32 v66, 0x26480, v66
ds_write_b32 v66, v63
v_and_b32 v64, 7, v1
v_lshlrev_b32 v64, 2, v64
s_waitcnt lgkmcnt(0)
s_barrier
s_mul_i32 s101, s6, 0x9e3779b1
s_add_u32 s101, s101, 0x7f4a7c15
s_mul_i32 s47, s7, 0x85ebca6b
s_add_u32 s47, s47, 0x165667b1
s_cmp_eq_u32 s37, 0
s_cbranch_scc0 F_OTHER
ds_read2_b64 v[72:75], v168 offset0:0 offset1:4
ds_read2_b64 v[76:79], v168 offset0:16 offset1:20
ds_read2_b64 v[80:83], v168 offset0:32 offset1:36
ds_read2_b64 v[84:87], v168 offset0:48 offset1:52
ds_read2_b64 v[88:91], v168 offset0:64 offset1:68
ds_read2_b64 v[92:95], v168 offset0:80 offset1:84
ds_read2_b64 v[96:99], v168 offset0:96 offset1:100
ds_read2_b64 v[100:103], v168 offset0:112 offset1:116
ds_read2_b64 v[104:107], v168 offset0:128 offset1:132
v_add_u32 v65, 0x26480, v64
ds_read_b32 v65, v65
s_add_u32 s28, s45, 0x1800000
s_waitcnt lgkmcnt(9)
buffer_store_dwordx4 v[72:75], v169, s[20:23], s28 offen offset:0
s_waitcnt lgkmcnt(8)
buffer_store_dwordx4 v[76:79], v169, s[20:23], s28 offen offset:2048
s_add_u32 s28, s28, 4096
s_waitcnt lgkmcnt(7)
buffer_store_dwordx4 v[80:83], v169, s[20:23], s28 offen offset:0
s_waitcnt lgkmcnt(6)
buffer_store_dwordx4 v[84:87], v169, s[20:23], s28 offen offset:2048
s_add_u32 s28, s28, 4096
s_waitcnt lgkmcnt(5)
buffer_store_dwordx4 v[88:91], v169, s[20:23], s28 offen offset:0
s_waitcnt lgkmcnt(4)
buffer_store_dwordx4 v[92:95], v169, s[20:23], s28 offen offset:2048
s_add_u32 s28, s28, 4096
s_waitcnt lgkmcnt(3)
buffer_store_dwordx4 v[96:99], v169, s[20:23], s28 offen offset:0
s_waitcnt lgkmcnt(2)
buffer_store_dwordx4 v[100:103], v169, s[20:23], s28 offen offset:2048
s_add_u32 s28, s28, 4096
s_waitcnt lgkmcnt(1)
buffer_store_dwordx4 v[104:107], v169, s[20:23], s28 offen offset:0
s_lshl_b32 s28, s3, 2
s_add_u32 s28, s28, 0x1a40000
s_waitcnt lgkmcnt(0)
buffer_store_dword v65, v64, s[20:23], s28 offen
s_and_b32 s29, s101, -16
s_or_b32 s29, s29, s38
v_mov_b32 v58, s29
v_mov_b32 v59, s47
s_lshl_b32 s29, s35, 3
v_mov_b32 v61, s29
s_lshl_b32 s28, s36, 8
s_add_u32 s28, s28, 0x24d000
s_waitcnt vmcnt(0)
s_mov_b64 exec, 1
buffer_store_dwordx2 v[58:59], v61, s[20:23], s28 offen
s_mov_b64 exec, -1
s_branch F_JOIN
F_END0:
.p2align 12
K_P1:
F_OTHER:
STUB_0:
s_mov_b64 exec, 0
s_cmp_eq_u32 s37, 1
s_cbranch_scc1 STUB_A1
s_cmp_eq_u32 s37, 2
s_cbranch_scc1 STUB_A2
s_cmp_eq_u32 s37, 3
s_cbranch_scc1 STUB_A3
s_mov_b64 exec, -1
HOP_R1:
s_add_u32 m0, s49, 96256
s_nop 0
buffer_load_dwordx4 v238, s[16:19], s34 offen offset:0 lds
buffer_load_dwordx4 v239, s[16:19], s34 offen offset:1024 lds
s_add_u32 s34, s34, 196608
s_sub_u32 s51, s34, 4718592
s_cselect_b32 s34, s34, s51
s_add_u32 m0, s49, 102400
s_nop 0
buffer_load_dwordx4 v238, s[16:19], s34 offen offset:0 lds
buffer_load_dwordx4 v239, s[16:19], s34 offen offset:1024 lds
s_add_u32 s34, s34, 196608
s_sub_u32 s51, s34, 4718592
s_cselect_b32 s34, s34, s51
s_add_u32 m0, s49, 108544
s_nop 0
buffer_load_dwordx4 v238, s[16:19], s34 offen offset:0 lds
buffer_load_dwordx4 v239, s[16:19], s34 offen offset:1024 lds
s_add_u32 s34, s34, 196608
s_sub_u32 s51, s34, 4718592
s_cselect_b32 s34, s34, s51
s_mov_b64 exec, 0
s_cmp_eq_u32 s37, 1
s_cbranch_scc1 STUB_B1
s_cmp_eq_u32 s37, 2
s_cbranch_scc1 STUB_B2
s_cmp_eq_u32 s37, 3
s_cbranch_scc1 STUB_B3
s_mov_b64 exec, -1
HOP_R2:
F_JOIN:
s_lshl_b32 s49, s37, 11
s_lshl_b32 s28, s37, 16
s_lshl_b32 s34, s35, 8
s_add_u32 s34, s34, s28
s_lshl_b32 s28, s5, 18
s_add_u32 s34, s34, s28
s_add_u32 s34, s34, 1572864
s_sub_u32 s51, s34, 4718592
s_cselect_b32 s34, s34, s51
s_lshl_b32 s30, s37, 12
s_lshl_b32 s31, s37, 10
s_lshl_b32 s92, s36, 5
s_add_u32 s92, s92, s35
s_lshl2_add_u32 s92, s92, s37
s_lshl_b32 s44, s92, 14
s_add_u32 s44, s44, 0x400000
s_mov_b32 s42, 0x5f800000
s_mov_b32 s43, 0
s_lshr_b32 s92, s35, 1
s_lshl_b32 s92, s92, 19
s_add_u32 s66, s66, s92
s_addc_u32 s67, s67, 0
s_add_u32 s68, s68, s92
s_addc_u32 s69, s69, 0
s_mov_b32 s8, s66
s_and_b32 s9, s67, 0xffff
s_mov_b32 s10, 0x80000
s_mov_b32 s11, 0x00020000
s_mov_b32 s12, s68
s_and_b32 s13, s69, 0xffff
s_mov_b32 s14, 0x80000
s_mov_b32 s15, 0x00020000
s_mov_b32 s56, s72
s_and_b32 s57, s73, 0xffff
s_mov_b32 s58, 0x480000
s_mov_b32 s59, 0x00020000
s_mov_b32 s60, s84
s_and_b32 s61, s85, 0xffff
s_mov_b32 s62, 0x240000
s_mov_b32 s63, 0x00020000
s_mov_b32 s64, s78
s_and_b32 s65, s79, 0xffff
s_mov_b32 s66, 0x510000
s_mov_b32 s67, 0x00020000
s_mov_b32 s68, s80
s_and_b32 s69, s81, 0xffff
s_mov_b32 s70, 0x510000
s_mov_b32 s71, 0x00020000
s_mov_b32 s72, s82
s_and_b32 s73, s83, 0xffff
s_mov_b32 s74, 0x510000
s_mov_b32 s75, 0x00020000
s_lshr_b32 s92, s35, 2
s_mul_i32 s89, s92, 589824
s_and_b32 s92, s35, 3
s_mul_i32 s92, s92, 288
s_add_u32 s89, s89, s92
s_cmp_eq_u32 s37, 0
s_cbranch_scc1 F_W0P
s_waitcnt vmcnt(0)
s_branch F_BAR2
HOP_RET1:
s_mov_b64 exec, -1
s_branch HOP_R1
HOP_RET2:
s_mov_b64 exec, -1
s_branch HOP_R2
F_W0P:
s_mov_b32 s46, 0x20
s_lshl_b32 s28, s36, 8
s_add_u32 s28, s28, 0x24d000
v_and_b32 v61, 31, v1
v_lshlrev_b32 v61, 3, v61
s_mov_b32 s51, 0
v_mov_b32 v60, 3
F_POLL:
buffer_load_dwordx2 v[62:63], v61, s[20:23], s28 offen sc0 sc1
s_waitcnt vmcnt(0)
v_cmp_ne_u64 vcc, v[62:63], v[58:59]
s_cbranch_vccz F_GO
s_add_u32 s51, s51, 1
s_and_b32 s29, s51, 31
s_cbranch_scc1 F_POLL
s_branch F_NOTYET
F_GO:
v_mov_b32 v61, 156864
ds_write_b32 v61, v60
s_waitcnt lgkmcnt(0)
F_BAR2:
s_barrier
s_lshl_b32 s7, s36, 31
s_mov_b32 s7, 0
v_mov_b32 v246, 156864
ds_read_b32 v246, v246
s_mov_b32 s4, 0x1800000
s_mov_b32 s51, 3
Q_START:
s_lshl_b32 s28, s5, 10
s_add_u32 s28, s28, s4
s_add_u32 s6, s4, 18432
buffer_load_dwordx4 a[0:3], v240, s[20:23], s28 offen sc0 sc1
buffer_load_dwordx4 a[4:7], v241, s[20:23], s28 offen sc0 sc1
buffer_load_dwordx4 a[8:11], v242, s[20:23], s28 offen sc0 sc1
buffer_load_dwordx4 a[12:15], v243, s[20:23], s28 offen sc0 sc1
s_waitcnt lgkmcnt(0)
v_readfirstlane_b32 s48, v246
ds_read_b64_tr_b16 a[144:145], v234 offset:0
ds_read_b64_tr_b16 a[146:147], v234 offset:4096
ds_read_b64_tr_b16 a[148:149], v234 offset:8
ds_read_b64_tr_b16 a[150:151], v234 offset:4104
ds_read_b64_tr_b16 a[152:153], v235 offset:0
ds_read_b64_tr_b16 a[154:155], v235 offset:4096
ds_read_b64_tr_b16 a[156:157], v235 offset:8
ds_read_b64_tr_b16 a[158:159], v235 offset:4104
ds_read_b64_tr_b16 a[160:161], v236 offset:0
ds_read_b64_tr_b16 a[162:163], v236 offset:4096
ds_read_b64_tr_b16 a[164:165], v236 offset:8
ds_read_b64_tr_b16 a[166:167], v236 offset:4104
ds_read_b64_tr_b16 a[168:169], v237 offset:0
ds_read_b64_tr_b16 a[170:171], v237 offset:4096
ds_read_b64_tr_b16 a[172:173], v237 offset:8
ds_read_b64_tr_b16 a[174:175], v237 offset:4104
s_cmp_lt_u32 s48, s51
s_cbranch_scc1 Q_REDO
s_add_u32 s28, s28, 1024
s_cmp_lt_u32 s28, s6
s_cselect_b32 s28, s28, s4
buffer_load_dwordx4 a[16:19], v240, s[20:23], s28 offen sc0 sc1
buffer_load_dwordx4 a[20:23], v241, s[20:23], s28 offen sc0 sc1
buffer_load_dwordx4 a[24:27], v242, s[20:23], s28 offen sc0 sc1
buffer_load_dwordx4 a[28:31], v243, s[20:23], s28 offen sc0 sc1
s_lshl_b32 s29, s36, 10
s_add_u32 s29, s29, s4
s_add_u32 s29, s29, 0x240000
buffer_load_dwordx4 v[136:139], v244, s[20:23], s29 offen sc0 sc1
s_add_u32 s28, s28, 1024
s_cmp_lt_u32 s28, s6
s_cselect_b32 s28, s28, s4
buffer_load_dwordx4 a[32:35], v240, s[20:23], s28 offen sc0 sc1
buffer_load_dwordx4 a[36:39], v241, s[20:23], s28 offen sc0 sc1
buffer_load_dwordx4 a[40:43], v242, s[20:23], s28 offen sc0 sc1
buffer_load_dwordx4 a[44:47], v243, s[20:23], s28 offen sc0 sc1
s_waitcnt vmcnt(9)
s_waitcnt lgkmcnt(8)
v_mfma_f32_16x16x32_bf16 v[8:11], a[144:147], a[0:3], 0
ds_read_b64_tr_b16 a[176:177], v234 offset:8192
v_mov_b32 v143, 0
v_mfma_f32_16x16x32_bf16 v[40:43], a[144:147], a[4:7], 0
ds_read_b64_tr_b16 a[178:179], v234 offset:12288
ds_write_b32 v209, v200 offset:0
v_mfma_f32_16x16x32_bf16 v[72:75], a[144:147], a[8:11], 0
s_add_u32 s28, s28, 1024
s_cmp_lt_u32 s28, s6
s_cselect_b32 s28, s28, s4
v_mfma_f32_16x16x32_bf16 v[104:107], a[144:147], a[12:15], 0
ds_read_b64_tr_b16 a[180:181], v234 offset:8200
ds_write_b32 v209, v201 offset:128
v_mfma_f32_16x16x32_bf16 v[108:111], a[148:151], a[12:15], 0
ds_read_b64_tr_b16 a[182:183], v234 offset:12296
ds_write_b32 v209, v202 offset:256
v_mfma_f32_16x16x32_bf16 v[76:79], a[148:151], a[8:11], 0
buffer_load_dwordx4 a[48:51], v240, s[20:23], s28 offen sc0 sc1
v_mfma_f32_16x16x32_bf16 v[44:47], a[148:151], a[4:7], 0
ds_read_b64_tr_b16 a[184:185], v235 offset:8192
ds_write_b32 v209, v203 offset:384
v_mfma_f32_16x16x32_bf16 v[12:15], a[148:151], a[0:3], 0
ds_read_b64_tr_b16 a[186:187], v235 offset:12288
ds_write_b32 v209, v204 offset:512
v_mfma_f32_16x16x32_bf16 v[16:19], a[152:155], a[0:3], 0
buffer_load_dwordx4 a[52:55], v241, s[20:23], s28 offen sc0 sc1
v_mfma_f32_16x16x32_bf16 v[48:51], a[152:155], a[4:7], 0
ds_read_b64_tr_b16 a[188:189], v235 offset:8200
ds_write_b32 v209, v205 offset:640
v_mfma_f32_16x16x32_bf16 v[80:83], a[152:155], a[8:11], 0
ds_read_b64_tr_b16 a[190:191], v235 offset:12296
ds_write_b32 v209, v206 offset:768
v_mfma_f32_16x16x32_bf16 v[112:115], a[152:155], a[12:15], 0
buffer_load_dwordx4 a[56:59], v242, s[20:23], s28 offen sc0 sc1
v_mfma_f32_16x16x32_bf16 v[116:119], a[156:159], a[12:15], 0
ds_read_b64_tr_b16 a[192:193], v236 offset:8192
ds_write_b32 v209, v207 offset:896
v_mfma_f32_16x16x32_bf16 v[84:87], a[156:159], a[8:11], 0
buffer_load_dwordx4 a[60:63], v243, s[20:23], s28 offen sc0 sc1
v_mfma_f32_16x16x32_bf16 v[52:55], a[156:159], a[4:7], 0
ds_read_b64_tr_b16 a[194:195], v236 offset:12288
ds_write_b32 v209, v208 offset:1024
v_mfma_f32_16x16x32_bf16 v[20:23], a[156:159], a[0:3], 0
ds_read_b64_tr_b16 a[196:197], v236 offset:8200
v_add_u32 v184, 0, v4
s_waitcnt lgkmcnt(8)
v_mfma_f32_16x16x32_bf16 v[24:27], a[160:163], a[0:3], 0
s_add_u32 s28, s28, 1024
s_cmp_lt_u32 s28, s6
s_cselect_b32 s28, s28, s4
v_mfma_f32_16x16x32_bf16 v[56:59], a[160:163], a[4:7], 0
ds_read_b64_tr_b16 a[198:199], v236 offset:12296
v_xor_b32 v184, v184, v3
v_mfma_f32_16x16x32_bf16 v[88:91], a[160:163], a[8:11], 0
ds_read_b64_tr_b16 a[200:201], v237 offset:8192
v_lshlrev_b32 v184, 4, v184
v_mfma_f32_16x16x32_bf16 v[120:123], a[160:163], a[12:15], 0
buffer_load_dwordx4 a[64:67], v240, s[20:23], s28 offen sc0 sc1
v_mfma_f32_16x16x32_bf16 v[124:127], a[164:167], a[12:15], 0
ds_read_b64_tr_b16 a[202:203], v237 offset:12288
v_lshl_add_u32 v184, v3, 8, v184
v_mfma_f32_16x16x32_bf16 v[92:95], a[164:167], a[8:11], 0
ds_read_b64_tr_b16 a[204:205], v237 offset:8200
v_add_u32 v216, 0x10000, v184
v_mfma_f32_16x16x32_bf16 v[60:63], a[164:167], a[4:7], 0
buffer_load_dwordx4 a[68:71], v241, s[20:23], s28 offen sc0 sc1
v_mfma_f32_16x16x32_bf16 v[28:31], a[164:167], a[0:3], 0
ds_read_b64_tr_b16 a[206:207], v237 offset:12296
v_add_u32 v184, 4, v4
v_mfma_f32_16x16x32_bf16 v[32:35], a[168:171], a[0:3], 0
buffer_load_dwordx4 a[72:75], v242, s[20:23], s28 offen sc0 sc1
v_mfma_f32_16x16x32_bf16 v[64:67], a[168:171], a[4:7], 0
buffer_load_dwordx4 a[76:79], v243, s[20:23], s28 offen sc0 sc1
v_mfma_f32_16x16x32_bf16 v[96:99], a[168:171], a[8:11], 0
s_add_u32 m0, s49, 114688
v_xor_b32 v184, v184, v3
v_mfma_f32_16x16x32_bf16 v[128:131], a[168:171], a[12:15], 0
buffer_load_dwordx4 v238, s[16:19], s34 offen offset:0 lds
v_mfma_f32_16x16x32_bf16 v[132:135], a[172:175], a[12:15], 0
buffer_load_dwordx4 v239, s[16:19], s34 offen offset:1024 lds
v_mfma_f32_16x16x32_bf16 v[100:103], a[172:175], a[8:11], 0
s_add_u32 s34, s34, 262144
s_sub_u32 s51, s34, 4718592
s_cselect_b32 s34, s34, s51
v_mfma_f32_16x16x32_bf16 v[68:71], a[172:175], a[4:7], 0
s_mov_b32 s90, 0x01010101
s_mov_b32 s91, 0x01010101
v_mfma_f32_16x16x32_bf16 v[36:39], a[172:175], a[0:3], 0
v_lshlrev_b32 v184, 4, v184
v_lshl_add_u32 v184, v3, 8, v184
s_waitcnt vmcnt(15)
v_mfma_f32_16x16x32_bf16 v[8:11], a[176:179], a[16:19], v[8:11]
ds_read_b64_tr_b16 a[144:145], v234 offset:16384
v_add_u32 v217, 0x10000, v184
v_mfma_f32_16x16x32_bf16 v[40:43], a[176:179], a[20:23], v[40:43]
ds_read_b64_tr_b16 a[146:147], v234 offset:20480
v_add_u32 v184, 8, v4
v_mfma_f32_16x16x32_bf16 v[72:75], a[176:179], a[24:27], v[72:75]
s_add_u32 s28, s28, 1024
s_cmp_lt_u32 s28, s6
s_cselect_b32 s28, s28, s4
v_mfma_f32_16x16x32_bf16 v[104:107], a[176:179], a[28:31], v[104:107]
ds_read_b64_tr_b16 a[148:149], v234 offset:16392
v_xor_b32 v184, v184, v3
v_mfma_f32_16x16x32_bf16 v[108:111], a[180:183], a[28:31], v[108:111]
ds_read_b64_tr_b16 a[150:151], v234 offset:20488
v_lshlrev_b32 v184, 4, v184
v_mfma_f32_16x16x32_bf16 v[76:79], a[180:183], a[24:27], v[76:79]
buffer_load_dwordx4 a[80:83], v240, s[20:23], s28 offen sc0 sc1
v_mfma_f32_16x16x32_bf16 v[44:47], a[180:183], a[20:23], v[44:47]
ds_read_b64_tr_b16 a[152:153], v235 offset:16384
v_lshl_add_u32 v184, v3, 8, v184
v_mfma_f32_16x16x32_bf16 v[12:15], a[180:183], a[16:19], v[12:15]
ds_read_b64_tr_b16 a[154:155], v235 offset:20480
v_add_u32 v218, 0x10000, v184
v_mfma_f32_16x16x32_bf16 v[16:19], a[184:187], a[16:19], v[16:19]
buffer_load_dwordx4 a[84:87], v241, s[20:23], s28 offen sc0 sc1
v_mfma_f32_16x16x32_bf16 v[48:51], a[184:187], a[20:23], v[48:51]
ds_read_b64_tr_b16 a[156:157], v235 offset:16392
v_add_u32 v184, 12, v4
v_mfma_f32_16x16x32_bf16 v[80:83], a[184:187], a[24:27], v[80:83]
ds_read_b64_tr_b16 a[158:159], v235 offset:20488
v_xor_b32 v184, v184, v3
v_mfma_f32_16x16x32_bf16 v[112:115], a[184:187], a[28:31], v[112:115]
buffer_load_dwordx4 a[88:91], v242, s[20:23], s28 offen sc0 sc1
s_waitcnt lgkmcnt(8)
v_mfma_f32_16x16x32_bf16 v[116:119], a[188:191], a[28:31], v[116:119]
ds_read_b64_tr_b16 a[160:161], v236 offset:16384
v_lshlrev_b32 v184, 4, v184
v_mfma_f32_16x16x32_bf16 v[84:87], a[188:191], a[24:27], v[84:87]
buffer_load_dwordx4 a[92:95], v243, s[20:23], s28 offen sc0 sc1
v_mfma_f32_16x16x32_bf16 v[52:55], a[188:191], a[20:23], v[52:55]
ds_read_b64_tr_b16 a[162:163], v236 offset:20480
v_lshl_add_u32 v184, v3, 8, v184
v_mfma_f32_16x16x32_bf16 v[20:23], a[188:191], a[16:19], v[20:23]
ds_read_b64_tr_b16 a[164:165], v236 offset:16392
v_add_u32 v219, 0x10000, v184
v_mfma_f32_16x16x32_bf16 v[24:27], a[192:195], a[16:19], v[24:27]
s_add_u32 m0, s49, 122880
v_bfe_u32 v184, v1, 2, 2
v_mfma_f32_16x16x32_bf16 v[56:59], a[192:195], a[20:23], v[56:59]
ds_read_b64_tr_b16 a[166:167], v236 offset:20488
v_and_b32 v185, 3, v1
v_mfma_f32_16x16x32_bf16 v[88:91], a[192:195], a[24:27], v[88:91]
ds_read_b64_tr_b16 a[168:169], v237 offset:16384
v_lshl_add_u32 v186, v4, 2, v184
v_mfma_f32_16x16x32_bf16 v[120:123], a[192:195], a[28:31], v[120:123]
s_waitcnt vmcnt(18)
v_max3_u32 v140, v136, v137, v138
v_mfma_f32_16x16x32_bf16 v[124:127], a[196:199], a[28:31], v[124:127]
ds_read_b64_tr_b16 a[170:171], v237 offset:20480
v_max_u32 v140, v140, v139
v_mfma_f32_16x16x32_bf16 v[92:95], a[196:199], a[24:27], v[92:95]
ds_read_b64_tr_b16 a[172:173], v237 offset:16392
v_and_b32 v187, 7, v186
v_mfma_f32_16x16x32_bf16 v[60:63], a[196:199], a[20:23], v[60:63]
buffer_load_dwordx4 v238, s[16:19], s34 offen offset:0 lds
v_mfma_f32_16x16x32_bf16 v[28:31], a[196:199], a[16:19], v[28:31]
ds_read_b64_tr_b16 a[174:175], v237 offset:20488
v_max_u32_dpp v141, v140, v140 row_ror:8 row_mask:0xf bank_mask:0xf
v_mfma_f32_16x16x32_bf16 v[32:35], a[200:203], a[16:19], v[32:35]
buffer_load_dwordx4 v239, s[16:19], s34 offen offset:1024 lds
v_mfma_f32_16x16x32_bf16 v[64:67], a[200:203], a[20:23], v[64:67]
v_max_u32_dpp v140, v141, v141 row_ror:4 row_mask:0xf bank_mask:0xf
v_lshlrev_b32 v188, 8, v186
v_mfma_f32_16x16x32_bf16 v[96:99], a[200:203], a[24:27], v[96:99]
s_add_u32 s34, s34, 262144
s_sub_u32 s51, s34, 4718592
s_cselect_b32 s34, s34, s51
v_mfma_f32_16x16x32_bf16 v[128:131], a[200:203], a[28:31], v[128:131]
v_max_u32_dpp v141, v140, v140 row_ror:2 row_mask:0xf bank_mask:0xf
v_lshl_add_u32 v188, v185, 3, v188
v_mfma_f32_16x16x32_bf16 v[132:135], a[204:207], a[28:31], v[132:135]
v_add_u32 v188, 0x18000, v188
v_xor_b32 v189, 0, v187
v_mfma_f32_16x16x32_bf16 v[100:103], a[204:207], a[24:27], v[100:103]
v_max_u32_dpp v140, v141, v141 row_ror:1 row_mask:0xf bank_mask:0xf
v_mov_b32 v141, v140
v_mfma_f32_16x16x32_bf16 v[68:71], a[204:207], a[20:23], v[68:71]
v_lshl_add_u32 v220, v189, 5, v188
v_xor_b32 v189, 1, v187
v_mfma_f32_16x16x32_bf16 v[36:39], a[204:207], a[16:19], v[36:39]
v_permlane16_swap_b32 v140, v141
v_max_u32 v140, v140, v141
s_waitcnt vmcnt(16)
s_waitcnt lgkmcnt(8)
v_mfma_f32_16x16x32_bf16 v[8:11], a[144:147], a[32:35], v[8:11]
ds_read_b64_tr_b16 a[176:177], v234 offset:24576
v_mov_b32 v141, v140
v_mfma_f32_16x16x32_bf16 v[40:43], a[144:147], a[36:39], v[40:43]
ds_read_b64_tr_b16 a[178:179], v234 offset:28672
v_lshl_add_u32 v221, v189, 5, v188
v_mfma_f32_16x16x32_bf16 v[72:75], a[144:147], a[40:43], v[72:75]
s_add_u32 s28, s28, 1024
s_cmp_lt_u32 s28, s6
s_cselect_b32 s28, s28, s4
v_mfma_f32_16x16x32_bf16 v[104:107], a[144:147], a[44:47], v[104:107]
ds_read_b64_tr_b16 a[180:181], v234 offset:24584
v_permlane32_swap_b32 v140, v141
v_mfma_f32_16x16x32_bf16 v[108:111], a[148:151], a[44:47], v[108:111]
ds_read_b64_tr_b16 a[182:183], v234 offset:28680
v_max_u32 v140, v140, v141
v_mfma_f32_16x16x32_bf16 v[76:79], a[148:151], a[40:43], v[76:79]
buffer_load_dwordx4 a[96:99], v240, s[20:23], s28 offen sc0 sc1
v_mfma_f32_16x16x32_bf16 v[44:47], a[148:151], a[36:39], v[44:47]
ds_read_b64_tr_b16 a[184:185], v235 offset:24576
v_add_u32 v143, v143, v140
v_mfma_f32_16x16x32_bf16 v[12:15], a[148:151], a[32:35], v[12:15]
ds_read_b64_tr_b16 a[186:187], v235 offset:28672
v_sub_u32 v136, v136, v140
v_mfma_f32_16x16x32_bf16 v[16:19], a[152:155], a[32:35], v[16:19]
buffer_load_dwordx4 a[100:103], v241, s[20:23], s28 offen sc0 sc1
v_mfma_f32_16x16x32_bf16 v[48:51], a[152:155], a[36:39], v[48:51]
ds_read_b64_tr_b16 a[188:189], v235 offset:24584
v_sub_u32 v137, v137, v140
v_mfma_f32_16x16x32_bf16 v[80:83], a[152:155], a[40:43], v[80:83]
ds_read_b64_tr_b16 a[190:191], v235 offset:28680
v_sub_u32 v138, v138, v140
v_mfma_f32_16x16x32_bf16 v[112:115], a[152:155], a[44:47], v[112:115]
buffer_load_dwordx4 a[104:107], v242, s[20:23], s28 offen sc0 sc1
v_mfma_f32_16x16x32_bf16 v[116:119], a[156:159], a[44:47], v[116:119]
ds_read_b64_tr_b16 a[192:193], v236 offset:24576
v_sub_u32 v139, v139, v140
v_mfma_f32_16x16x32_bf16 v[84:87], a[156:159], a[40:43], v[84:87]
buffer_load_dwordx4 a[108:111], v243, s[20:23], s28 offen sc0 sc1
v_mfma_f32_16x16x32_bf16 v[52:55], a[156:159], a[36:39], v[52:55]
ds_read_b64_tr_b16 a[194:195], v236 offset:28672
v_cndmask_b32 v142, v142, v143, s[90:91]
v_mfma_f32_16x16x32_bf16 v[20:23], a[156:159], a[32:35], v[20:23]
ds_read_b64_tr_b16 a[196:197], v236 offset:24584
s_lshl_b64 s[90:91], s[90:91], 1
s_waitcnt lgkmcnt(8)
v_mfma_f32_16x16x32_bf16 v[24:27], a[160:163], a[32:35], v[24:27]
s_add_u32 m0, s49, 131072
v_max3_u32 v140, v136, v137, v138
v_mfma_f32_16x16x32_bf16 v[56:59], a[160:163], a[36:39], v[56:59]
ds_read_b64_tr_b16 a[198:199], v236 offset:28680
v_max_u32 v140, v140, v139
v_mfma_f32_16x16x32_bf16 v[88:91], a[160:163], a[40:43], v[88:91]
ds_read_b64_tr_b16 a[200:201], v237 offset:24576
v_xor_b32 v189, 2, v187
v_mfma_f32_16x16x32_bf16 v[120:123], a[160:163], a[44:47], v[120:123]
v_max_u32_dpp v141, v140, v140 row_ror:8 row_mask:0xf bank_mask:0xf
v_lshl_add_u32 v222, v189, 5, v188
v_mfma_f32_16x16x32_bf16 v[124:127], a[164:167], a[44:47], v[124:127]
ds_read_b64_tr_b16 a[202:203], v237 offset:28672
v_xor_b32 v189, 3, v187
v_mfma_f32_16x16x32_bf16 v[92:95], a[164:167], a[40:43], v[92:95]
ds_read_b64_tr_b16 a[204:205], v237 offset:24584
v_max_u32_dpp v140, v141, v141 row_ror:4 row_mask:0xf bank_mask:0xf
v_mfma_f32_16x16x32_bf16 v[60:63], a[164:167], a[36:39], v[60:63]
buffer_load_dwordx4 v238, s[16:19], s34 offen offset:0 lds
v_mfma_f32_16x16x32_bf16 v[28:31], a[164:167], a[32:35], v[28:31]
ds_read_b64_tr_b16 a[206:207], v237 offset:28680
v_max_u32_dpp v141, v140, v140 row_ror:2 row_mask:0xf bank_mask:0xf
v_mfma_f32_16x16x32_bf16 v[32:35], a[168:171], a[32:35], v[32:35]
buffer_load_dwordx4 v239, s[16:19], s34 offen offset:1024 lds
v_mfma_f32_16x16x32_bf16 v[64:67], a[168:171], a[36:39], v[64:67]
v_max_u32_dpp v140, v141, v141 row_ror:1 row_mask:0xf bank_mask:0xf
v_mov_b32 v141, v140
v_mfma_f32_16x16x32_bf16 v[96:99], a[168:171], a[40:43], v[96:99]
s_add_u32 s34, s34, 262144
s_sub_u32 s51, s34, 4718592
s_cselect_b32 s34, s34, s51
v_mfma_f32_16x16x32_bf16 v[128:131], a[168:171], a[44:47], v[128:131]
v_permlane16_swap_b32 v140, v141
v_max_u32 v140, v140, v141
v_mfma_f32_16x16x32_bf16 v[132:135], a[172:175], a[44:47], v[132:135]
v_mov_b32 v141, v140
v_lshl_add_u32 v223, v189, 5, v188
v_mfma_f32_16x16x32_bf16 v[100:103], a[172:175], a[40:43], v[100:103]
v_xor_b32 v189, 4, v187
v_lshl_add_u32 v224, v189, 5, v188
v_mfma_f32_16x16x32_bf16 v[68:71], a[172:175], a[36:39], v[68:71]
v_permlane32_swap_b32 v140, v141
v_max_u32 v140, v140, v141
v_mfma_f32_16x16x32_bf16 v[36:39], a[172:175], a[32:35], v[36:39]
v_add_u32 v143, v143, v140
v_sub_u32 v136, v136, v140
s_waitcnt vmcnt(18)
v_mfma_f32_16x16x32_bf16 v[8:11], a[176:179], a[48:51], v[8:11]
ds_read_b64_tr_b16 a[144:145], v234 offset:32768
v_sub_u32 v137, v137, v140
v_mfma_f32_16x16x32_bf16 v[40:43], a[176:179], a[52:55], v[40:43]
ds_read_b64_tr_b16 a[146:147], v234 offset:36864
v_sub_u32 v138, v138, v140
v_mfma_f32_16x16x32_bf16 v[72:75], a[176:179], a[56:59], v[72:75]
s_add_u32 s28, s28, 1024
s_cmp_lt_u32 s28, s6
s_cselect_b32 s28, s28, s4
v_mfma_f32_16x16x32_bf16 v[104:107], a[176:179], a[60:63], v[104:107]
ds_read_b64_tr_b16 a[148:149], v234 offset:32776
v_sub_u32 v139, v139, v140
s_waitcnt lgkmcnt(8)
v_mfma_f32_16x16x32_bf16 v[108:111], a[180:183], a[60:63], v[108:111]
ds_read_b64_tr_b16 a[150:151], v234 offset:36872
v_cndmask_b32 v142, v142, v143, s[90:91]
v_mfma_f32_16x16x32_bf16 v[76:79], a[180:183], a[56:59], v[76:79]
buffer_load_dwordx4 a[112:115], v240, s[20:23], s28 offen sc0 sc1
v_mfma_f32_16x16x32_bf16 v[44:47], a[180:183], a[52:55], v[44:47]
ds_read_b64_tr_b16 a[152:153], v235 offset:32768
s_lshl_b64 s[90:91], s[90:91], 1
v_mfma_f32_16x16x32_bf16 v[12:15], a[180:183], a[48:51], v[12:15]
ds_read_b64_tr_b16 a[154:155], v235 offset:36864
v_max3_u32 v140, v136, v137, v138
v_mfma_f32_16x16x32_bf16 v[16:19], a[184:187], a[48:51], v[16:19]
buffer_load_dwordx4 a[116:119], v241, s[20:23], s28 offen sc0 sc1
v_mfma_f32_16x16x32_bf16 v[48:51], a[184:187], a[52:55], v[48:51]
ds_read_b64_tr_b16 a[156:157], v235 offset:32776
v_max_u32 v140, v140, v139
v_mfma_f32_16x16x32_bf16 v[80:83], a[184:187], a[56:59], v[80:83]
ds_read_b64_tr_b16 a[158:159], v235 offset:36872
v_xor_b32 v189, 5, v187
v_mfma_f32_16x16x32_bf16 v[112:115], a[184:187], a[60:63], v[112:115]
buffer_load_dwordx4 a[120:123], v242, s[20:23], s28 offen sc0 sc1
v_mfma_f32_16x16x32_bf16 v[116:119], a[188:191], a[60:63], v[116:119]
ds_read_b64_tr_b16 a[160:161], v236 offset:32768
v_max_u32_dpp v141, v140, v140 row_ror:8 row_mask:0xf bank_mask:0xf
v_mfma_f32_16x16x32_bf16 v[84:87], a[188:191], a[56:59], v[84:87]
buffer_load_dwordx4 a[124:127], v243, s[20:23], s28 offen sc0 sc1
v_mfma_f32_16x16x32_bf16 v[52:55], a[188:191], a[52:55], v[52:55]
ds_read_b64_tr_b16 a[162:163], v236 offset:36864
v_max_u32_dpp v140, v141, v141 row_ror:4 row_mask:0xf bank_mask:0xf
v_mfma_f32_16x16x32_bf16 v[20:23], a[188:191], a[48:51], v[20:23]
ds_read_b64_tr_b16 a[164:165], v236 offset:32776
v_lshl_add_u32 v225, v189, 5, v188
v_mfma_f32_16x16x32_bf16 v[24:27], a[192:195], a[48:51], v[24:27]
s_add_u32 m0, s49, 139264
v_max_u32_dpp v141, v140, v140 row_ror:2 row_mask:0xf bank_mask:0xf
v_mfma_f32_16x16x32_bf16 v[56:59], a[192:195], a[52:55], v[56:59]
ds_read_b64_tr_b16 a[166:167], v236 offset:36872
v_xor_b32 v189, 6, v187
v_mfma_f32_16x16x32_bf16 v[88:91], a[192:195], a[56:59], v[88:91]
ds_read_b64_tr_b16 a[168:169], v237 offset:32768
v_max_u32_dpp v140, v141, v141 row_ror:1 row_mask:0xf bank_mask:0xf
v_mfma_f32_16x16x32_bf16 v[120:123], a[192:195], a[60:63], v[120:123]
v_mov_b32 v141, v140
v_lshl_add_u32 v226, v189, 5, v188
s_waitcnt lgkmcnt(8)
v_mfma_f32_16x16x32_bf16 v[124:127], a[196:199], a[60:63], v[124:127]
ds_read_b64_tr_b16 a[170:171], v237 offset:36864
v_xor_b32 v189, 7, v187
v_mfma_f32_16x16x32_bf16 v[92:95], a[196:199], a[56:59], v[92:95]
ds_read_b64_tr_b16 a[172:173], v237 offset:32776
v_permlane16_swap_b32 v140, v141
v_mfma_f32_16x16x32_bf16 v[60:63], a[196:199], a[52:55], v[60:63]
buffer_load_dwordx4 v238, s[16:19], s34 offen offset:0 lds
v_mfma_f32_16x16x32_bf16 v[28:31], a[196:199], a[48:51], v[28:31]
ds_read_b64_tr_b16 a[174:175], v237 offset:36872
v_max_u32 v140, v140, v141
v_mfma_f32_16x16x32_bf16 v[32:35], a[200:203], a[48:51], v[32:35]
buffer_load_dwordx4 v239, s[16:19], s34 offen offset:1024 lds
v_mfma_f32_16x16x32_bf16 v[64:67], a[200:203], a[52:55], v[64:67]
v_mov_b32 v141, v140
v_lshl_add_u32 v227, v189, 5, v188
v_mfma_f32_16x16x32_bf16 v[96:99], a[200:203], a[56:59], v[96:99]
s_add_u32 s34, s34, 262144
s_sub_u32 s51, s34, 4718592
s_cselect_b32 s34, s34, s51
v_mfma_f32_16x16x32_bf16 v[128:131], a[200:203], a[60:63], v[128:131]
v_permlane32_swap_b32 v140, v141
v_max_u32 v140, v140, v141
v_mfma_f32_16x16x32_bf16 v[132:135], a[204:207], a[60:63], v[132:135]
v_add_u32 v143, v143, v140
v_sub_u32 v136, v136, v140
v_mfma_f32_16x16x32_bf16 v[100:103], a[204:207], a[56:59], v[100:103]
v_sub_u32 v137, v137, v140
v_sub_u32 v138, v138, v140
v_mfma_f32_16x16x32_bf16 v[68:71], a[204:207], a[52:55], v[68:71]
v_sub_u32 v139, v139, v140
v_cndmask_b32 v142, v142, v143, s[90:91]
v_mfma_f32_16x16x32_bf16 v[36:39], a[204:207], a[48:51], v[36:39]
s_lshl_b64 s[90:91], s[90:91], 1
v_add_u32 v184, 0, v4
s_waitcnt vmcnt(20)
v_mfma_f32_16x16x32_bf16 v[8:11], a[144:147], a[64:67], v[8:11]
ds_read_b64_tr_b16 a[176:177], v234 offset:40960
v_max3_u32 v140, v136, v137, v138
v_mfma_f32_16x16x32_bf16 v[40:43], a[144:147], a[68:71], v[40:43]
ds_read_b64_tr_b16 a[178:179], v234 offset:45056
v_max_u32 v140, v140, v139
v_mfma_f32_16x16x32_bf16 v[72:75], a[144:147], a[72:75], v[72:75]
s_add_u32 s28, s28, 1024
s_cmp_lt_u32 s28, s6
s_cselect_b32 s28, s28, s4
v_mfma_f32_16x16x32_bf16 v[104:107], a[144:147], a[76:79], v[104:107]
ds_read_b64_tr_b16 a[180:181], v234 offset:40968
v_max_u32_dpp v141, v140, v140 row_ror:8 row_mask:0xf bank_mask:0xf
v_mfma_f32_16x16x32_bf16 v[108:111], a[148:151], a[76:79], v[108:111]
ds_read_b64_tr_b16 a[182:183], v234 offset:45064
v_xor_b32 v184, v184, v3
v_mfma_f32_16x16x32_bf16 v[76:79], a[148:151], a[72:75], v[76:79]
buffer_load_dwordx4 a[0:3], v240, s[20:23], s28 offen sc0 sc1
v_mfma_f32_16x16x32_bf16 v[44:47], a[148:151], a[68:71], v[44:47]
ds_read_b64_tr_b16 a[184:185], v235 offset:40960
v_max_u32_dpp v140, v141, v141 row_ror:4 row_mask:0xf bank_mask:0xf
v_mfma_f32_16x16x32_bf16 v[12:15], a[148:151], a[64:67], v[12:15]
ds_read_b64_tr_b16 a[186:187], v235 offset:45056
v_lshlrev_b32 v184, 4, v184
s_waitcnt lgkmcnt(8)
v_mfma_f32_16x16x32_bf16 v[16:19], a[152:155], a[64:67], v[16:19]
buffer_load_dwordx4 a[4:7], v241, s[20:23], s28 offen sc0 sc1
v_mfma_f32_16x16x32_bf16 v[48:51], a[152:155], a[68:71], v[48:51]
ds_read_b64_tr_b16 a[188:189], v235 offset:40968
v_max_u32_dpp v141, v140, v140 row_ror:2 row_mask:0xf bank_mask:0xf
v_mfma_f32_16x16x32_bf16 v[80:83], a[152:155], a[72:75], v[80:83]
ds_read_b64_tr_b16 a[190:191], v235 offset:45064
v_lshl_add_u32 v184, v4, 8, v184
v_mfma_f32_16x16x32_bf16 v[112:115], a[152:155], a[76:79], v[112:115]
buffer_load_dwordx4 a[8:11], v242, s[20:23], s28 offen sc0 sc1
v_mfma_f32_16x16x32_bf16 v[116:119], a[156:159], a[76:79], v[116:119]
ds_read_b64_tr_b16 a[192:193], v236 offset:40960
v_max_u32_dpp v140, v141, v141 row_ror:1 row_mask:0xf bank_mask:0xf
v_mfma_f32_16x16x32_bf16 v[84:87], a[156:159], a[72:75], v[84:87]
buffer_load_dwordx4 a[12:15], v243, s[20:23], s28 offen sc0 sc1
v_mfma_f32_16x16x32_bf16 v[52:55], a[156:159], a[68:71], v[52:55]
ds_read_b64_tr_b16 a[194:195], v236 offset:45056
v_mov_b32 v141, v140
v_mfma_f32_16x16x32_bf16 v[20:23], a[156:159], a[64:67], v[20:23]
ds_read_b64_tr_b16 a[196:197], v236 offset:40968
v_add_u32 v228, s30, v184
v_mfma_f32_16x16x32_bf16 v[24:27], a[160:163], a[64:67], v[24:27]
s_add_u32 m0, s49, 0
v_permlane16_swap_b32 v140, v141
v_mfma_f32_16x16x32_bf16 v[56:59], a[160:163], a[68:71], v[56:59]
ds_read_b64_tr_b16 a[198:199], v236 offset:45064
v_max_u32 v140, v140, v141
v_mfma_f32_16x16x32_bf16 v[88:91], a[160:163], a[72:75], v[88:91]
ds_read_b64_tr_b16 a[200:201], v237 offset:40960
v_mov_b32 v141, v140
v_mfma_f32_16x16x32_bf16 v[120:123], a[160:163], a[76:79], v[120:123]
v_add_u32 v184, 4, v4
v_xor_b32 v184, v184, v3
v_mfma_f32_16x16x32_bf16 v[124:127], a[164:167], a[76:79], v[124:127]
ds_read_b64_tr_b16 a[202:203], v237 offset:45056
v_permlane32_swap_b32 v140, v141
STUB_1:
STUB_A1:
s_cbranch_execz STUB_4
v_mfma_f32_16x16x32_bf16 v[92:95], a[164:167], a[72:75], v[92:95]
ds_read_b64_tr_b16 a[204:205], v237 offset:40968
v_max_u32 v140, v140, v141
v_mfma_f32_16x16x32_bf16 v[60:63], a[164:167], a[68:71], v[60:63]
buffer_load_dwordx4 v238, s[16:19], s34 offen offset:0 lds
v_mfma_f32_16x16x32_bf16 v[28:31], a[164:167], a[64:67], v[28:31]
ds_read_b64_tr_b16 a[206:207], v237 offset:45064
v_add_u32 v143, v143, v140
v_mfma_f32_16x16x32_bf16 v[32:35], a[168:171], a[64:67], v[32:35]
buffer_load_dwordx4 v239, s[16:19], s34 offen offset:1024 lds
v_mfma_f32_16x16x32_bf16 v[64:67], a[168:171], a[68:71], v[64:67]
v_sub_u32 v136, v136, v140
v_sub_u32 v137, v137, v140
v_mfma_f32_16x16x32_bf16 v[96:99], a[168:171], a[72:75], v[96:99]
s_add_u32 s34, s34, 262144
s_sub_u32 s51, s34, 4718592
s_cselect_b32 s34, s34, s51
v_mfma_f32_16x16x32_bf16 v[128:131], a[168:171], a[76:79], v[128:131]
v_sub_u32 v138, v138, v140
v_sub_u32 v139, v139, v140
s_waitcnt lgkmcnt(8)
v_mfma_f32_16x16x32_bf16 v[132:135], a[172:175], a[76:79], v[132:135]
v_cndmask_b32 v142, v142, v143, s[90:91]
v_lshlrev_b32 v184, 4, v184
v_mfma_f32_16x16x32_bf16 v[100:103], a[172:175], a[72:75], v[100:103]
s_lshl_b64 s[90:91], s[90:91], 1
v_lshl_add_u32 v184, v4, 8, v184
v_mfma_f32_16x16x32_bf16 v[68:71], a[172:175], a[68:71], v[68:71]
v_max3_u32 v140, v136, v137, v138
v_max_u32 v140, v140, v139
v_mfma_f32_16x16x32_bf16 v[36:39], a[172:175], a[64:67], v[36:39]
v_add_u32 v229, s30, v184
v_add_u32 v184, 8, v4
s_waitcnt vmcnt(20)
v_mfma_f32_16x16x32_bf16 v[8:11], a[176:179], a[80:83], v[8:11]
v_max_u32_dpp v141, v140, v140 row_ror:8 row_mask:0xf bank_mask:0xf
v_xor_b32 v184, v184, v3
v_mfma_f32_16x16x32_bf16 v[40:43], a[176:179], a[84:87], v[40:43]
s_waitcnt vmcnt(12) lgkmcnt(0)
s_barrier
v_mfma_f32_16x16x32_bf16 v[72:75], a[176:179], a[88:91], v[72:75]
ds_read_b64_tr_b16 a[144:145], v234 offset:49152
v_max_u32_dpp v140, v141, v141 row_ror:4 row_mask:0xf bank_mask:0xf
v_mfma_f32_16x16x32_bf16 v[104:107], a[176:179], a[92:95], v[104:107]
ds_read_b64_tr_b16 a[146:147], v234 offset:53248
v_lshlrev_b32 v184, 4, v184
v_mfma_f32_16x16x32_bf16 v[108:111], a[180:183], a[92:95], v[108:111]
ds_read_b64_tr_b16 a[148:149], v234 offset:49160
v_max_u32_dpp v141, v140, v140 row_ror:2 row_mask:0xf bank_mask:0xf
v_mfma_f32_16x16x32_bf16 v[76:79], a[180:183], a[88:91], v[76:79]
s_add_u32 s28, s28, 1024
s_cmp_lt_u32 s28, s6
s_cselect_b32 s28, s28, s4
v_mfma_f32_16x16x32_bf16 v[44:47], a[180:183], a[84:87], v[44:47]
ds_read_b64_tr_b16 a[150:151], v234 offset:53256
v_max_u32_dpp v140, v141, v141 row_ror:1 row_mask:0xf bank_mask:0xf
v_mfma_f32_16x16x32_bf16 v[12:15], a[180:183], a[80:83], v[12:15]
ds_read_b64_tr_b16 a[152:153], v235 offset:49152
v_mov_b32 v141, v140
v_mfma_f32_16x16x32_bf16 v[16:19], a[184:187], a[80:83], v[16:19]
buffer_load_dwordx4 a[16:19], v240, s[20:23], s28 offen sc0 sc1
v_mfma_f32_16x16x32_bf16 v[48:51], a[184:187], a[84:87], v[48:51]
ds_read_b64_tr_b16 a[154:155], v235 offset:53248
v_permlane16_swap_b32 v140, v141
v_mfma_f32_16x16x32_bf16 v[80:83], a[184:187], a[88:91], v[80:83]
ds_read_b64_tr_b16 a[156:157], v235 offset:49160
v_max_u32 v140, v140, v141
v_mfma_f32_16x16x32_bf16 v[112:115], a[184:187], a[92:95], v[112:115]
buffer_load_dwordx4 a[20:23], v241, s[20:23], s28 offen sc0 sc1
v_mfma_f32_16x16x32_bf16 v[116:119], a[188:191], a[92:95], v[116:119]
ds_read_b64_tr_b16 a[158:159], v235 offset:53256
v_mov_b32 v141, v140
v_mfma_f32_16x16x32_bf16 v[84:87], a[188:191], a[88:91], v[84:87]
ds_read_b64_tr_b16 a[160:161], v236 offset:49152
v_lshl_add_u32 v184, v4, 8, v184
v_mfma_f32_16x16x32_bf16 v[52:55], a[188:191], a[84:87], v[52:55]
ds_read_b64_tr_b16 a[162:163], v236 offset:53248
v_permlane32_swap_b32 v140, v141
v_mfma_f32_16x16x32_bf16 v[20:23], a[188:191], a[80:83], v[20:23]
buffer_load_dwordx4 a[24:27], v242, s[20:23], s28 offen sc0 sc1
v_mfma_f32_16x16x32_bf16 v[24:27], a[192:195], a[80:83], v[24:27]
ds_read_b64_tr_b16 a[164:165], v236 offset:49160
v_max_u32 v140, v140, v141
v_mfma_f32_16x16x32_bf16 v[56:59], a[192:195], a[84:87], v[56:59]
ds_read_b64_tr_b16 a[166:167], v236 offset:53256
v_add_u32 v143, v143, v140
v_mfma_f32_16x16x32_bf16 v[88:91], a[192:195], a[88:91], v[88:91]
buffer_load_dwordx4 a[28:31], v243, s[20:23], s28 offen sc0 sc1
v_mfma_f32_16x16x32_bf16 v[120:123], a[192:195], a[92:95], v[120:123]
ds_read_b64_tr_b16 a[168:169], v237 offset:49152
s_add_u32 m0, s49, 8192
v_mfma_f32_16x16x32_bf16 v[124:127], a[196:199], a[92:95], v[124:127]
ds_read_b64_tr_b16 a[170:171], v237 offset:53248
v_sub_u32 v136, v136, v140
v_mfma_f32_16x16x32_bf16 v[92:95], a[196:199], a[88:91], v[92:95]
buffer_load_dwordx4 v238, s[16:19], s34 offen offset:0 lds
v_mfma_f32_16x16x32_bf16 v[60:63], a[196:199], a[84:87], v[60:63]
ds_read_b64_tr_b16 a[172:173], v237 offset:49160
v_sub_u32 v137, v137, v140
v_mfma_f32_16x16x32_bf16 v[28:31], a[196:199], a[80:83], v[28:31]
ds_read_b64_tr_b16 a[174:175], v237 offset:53256
v_sub_u32 v138, v138, v140
v_mfma_f32_16x16x32_bf16 v[32:35], a[200:203], a[80:83], v[32:35]
buffer_load_dwordx4 v239, s[16:19], s34 offen offset:1024 lds
v_mfma_f32_16x16x32_bf16 v[64:67], a[200:203], a[84:87], v[64:67]
v_sub_u32 v139, v139, v140
v_cndmask_b32 v142, v142, v143, s[90:91]
v_mfma_f32_16x16x32_bf16 v[96:99], a[200:203], a[88:91], v[96:99]
s_add_u32 s34, s34, 262144
s_sub_u32 s51, s34, 4718592
s_cselect_b32 s34, s34, s51
v_mfma_f32_16x16x32_bf16 v[128:131], a[200:203], a[92:95], v[128:131]
s_lshl_b64 s[90:91], s[90:91], 1
v_add_u32 v230, s30, v184
v_mfma_f32_16x16x32_bf16 v[132:135], a[204:207], a[92:95], v[132:135]
v_max3_u32 v140, v136, v137, v138
v_max_u32 v140, v140, v139
v_mfma_f32_16x16x32_bf16 v[100:103], a[204:207], a[88:91], v[100:103]
v_add_u32 v184, 12, v4
v_xor_b32 v184, v184, v3
v_mfma_f32_16x16x32_bf16 v[68:71], a[204:207], a[84:87], v[68:71]
v_max_u32_dpp v141, v140, v140 row_ror:8 row_mask:0xf bank_mask:0xf
v_mov_b32 v192, 0
v_mfma_f32_16x16x32_bf16 v[36:39], a[204:207], a[80:83], v[36:39]
buffer_load_dword v193, v192, s[24:27], 0 offen sc0 sc1
s_waitcnt vmcnt(21)
s_waitcnt lgkmcnt(8)
v_mfma_f32_16x16x32_bf16 v[8:11], a[144:147], a[96:99], v[8:11]
ds_read_b64_tr_b16 a[176:177], v234 offset:57344
v_max_u32_dpp v140, v141, v141 row_ror:4 row_mask:0xf bank_mask:0xf
v_mfma_f32_16x16x32_bf16 v[40:43], a[144:147], a[100:103], v[40:43]
ds_read_b64_tr_b16 a[178:179], v234 offset:61440
v_lshlrev_b32 v184, 4, v184
v_mfma_f32_16x16x32_bf16 v[72:75], a[144:147], a[104:107], v[72:75]
s_add_u32 s28, s28, 1024
s_cmp_lt_u32 s28, s6
s_cselect_b32 s28, s28, s4
v_mfma_f32_16x16x32_bf16 v[104:107], a[144:147], a[108:111], v[104:107]
ds_read_b64_tr_b16 a[180:181], v234 offset:57352
v_max_u32_dpp v141, v140, v140 row_ror:2 row_mask:0xf bank_mask:0xf
v_mfma_f32_16x16x32_bf16 v[108:111], a[148:151], a[108:111], v[108:111]
ds_read_b64_tr_b16 a[182:183], v234 offset:61448
v_lshl_add_u32 v184, v4, 8, v184
v_mfma_f32_16x16x32_bf16 v[76:79], a[148:151], a[104:107], v[76:79]
buffer_load_dwordx4 a[32:35], v240, s[20:23], s28 offen sc0 sc1
v_mfma_f32_16x16x32_bf16 v[44:47], a[148:151], a[100:103], v[44:47]
ds_read_b64_tr_b16 a[184:185], v235 offset:57344
v_max_u32_dpp v140, v141, v141 row_ror:1 row_mask:0xf bank_mask:0xf
v_mfma_f32_16x16x32_bf16 v[12:15], a[148:151], a[96:99], v[12:15]
ds_read_b64_tr_b16 a[186:187], v235 offset:61440
v_mov_b32 v141, v140
v_mfma_f32_16x16x32_bf16 v[16:19], a[152:155], a[96:99], v[16:19]
buffer_load_dwordx4 a[36:39], v241, s[20:23], s28 offen sc0 sc1
v_mfma_f32_16x16x32_bf16 v[48:51], a[152:155], a[100:103], v[48:51]
ds_read_b64_tr_b16 a[188:189], v235 offset:57352
v_permlane16_swap_b32 v140, v141
v_mfma_f32_16x16x32_bf16 v[80:83], a[152:155], a[104:107], v[80:83]
ds_read_b64_tr_b16 a[190:191], v235 offset:61448
v_max_u32 v140, v140, v141
v_mfma_f32_16x16x32_bf16 v[112:115], a[152:155], a[108:111], v[112:115]
buffer_load_dwordx4 a[40:43], v242, s[20:23], s28 offen sc0 sc1
v_mfma_f32_16x16x32_bf16 v[116:119], a[156:159], a[108:111], v[116:119]
ds_read_b64_tr_b16 a[192:193], v236 offset:57344
v_mov_b32 v141, v140
v_mfma_f32_16x16x32_bf16 v[84:87], a[156:159], a[104:107], v[84:87]
buffer_load_dwordx4 a[44:47], v243, s[20:23], s28 offen sc0 sc1
v_mfma_f32_16x16x32_bf16 v[52:55], a[156:159], a[100:103], v[52:55]
ds_read_b64_tr_b16 a[194:195], v236 offset:61440
v_permlane32_swap_b32 v140, v141
v_mfma_f32_16x16x32_bf16 v[20:23], a[156:159], a[96:99], v[20:23]
ds_read_b64_tr_b16 a[196:197], v236 offset:57352
v_max_u32 v140, v140, v141
s_waitcnt lgkmcnt(8)
v_mfma_f32_16x16x32_bf16 v[24:27], a[160:163], a[96:99], v[24:27]
s_add_u32 m0, s49, 16384
v_add_u32 v143, v143, v140
v_mfma_f32_16x16x32_bf16 v[56:59], a[160:163], a[100:103], v[56:59]
ds_read_b64_tr_b16 a[198:199], v236 offset:61448
v_sub_u32 v136, v136, v140
v_mfma_f32_16x16x32_bf16 v[88:91], a[160:163], a[104:107], v[88:91]
ds_read_b64_tr_b16 a[200:201], v237 offset:57344
v_sub_u32 v137, v137, v140
v_mfma_f32_16x16x32_bf16 v[120:123], a[160:163], a[108:111], v[120:123]
v_sub_u32 v138, v138, v140
v_sub_u32 v139, v139, v140
v_mfma_f32_16x16x32_bf16 v[124:127], a[164:167], a[108:111], v[124:127]
ds_read_b64_tr_b16 a[202:203], v237 offset:61440
v_cndmask_b32 v142, v142, v143, s[90:91]
v_mfma_f32_16x16x32_bf16 v[92:95], a[164:167], a[104:107], v[92:95]
ds_read_b64_tr_b16 a[204:205], v237 offset:57352
s_lshl_b64 s[90:91], s[90:91], 1
v_mfma_f32_16x16x32_bf16 v[60:63], a[164:167], a[100:103], v[60:63]
buffer_load_dwordx4 v238, s[16:19], s34 offen offset:0 lds
v_mfma_f32_16x16x32_bf16 v[28:31], a[164:167], a[96:99], v[28:31]
ds_read_b64_tr_b16 a[206:207], v237 offset:61448
v_max3_u32 v140, v136, v137, v138
v_mfma_f32_16x16x32_bf16 v[32:35], a[168:171], a[96:99], v[32:35]
buffer_load_dwordx4 v239, s[16:19], s34 offen offset:1024 lds
v_mfma_f32_16x16x32_bf16 v[64:67], a[168:171], a[100:103], v[64:67]
v_max_u32 v140, v140, v139
v_add_u32 v231, s30, v184
v_mfma_f32_16x16x32_bf16 v[96:99], a[168:171], a[104:107], v[96:99]
s_add_u32 s34, s34, 262144
s_sub_u32 s51, s34, 4718592
s_cselect_b32 s34, s34, s51
v_mfma_f32_16x16x32_bf16 v[128:131], a[168:171], a[108:111], v[128:131]
v_max_u32_dpp v141, v140, v140 row_ror:8 row_mask:0xf bank_mask:0xf
v_add_u32 v184, 0, v4
v_mfma_f32_16x16x32_bf16 v[132:135], a[172:175], a[108:111], v[132:135]
v_lshlrev_b32 v184, 1, v184
v_xor_b32 v184, v184, v3
v_mfma_f32_16x16x32_bf16 v[100:103], a[172:175], a[104:107], v[100:103]
v_max_u32_dpp v140, v141, v141 row_ror:4 row_mask:0xf bank_mask:0xf
v_lshlrev_b32 v184, 4, v184
v_mfma_f32_16x16x32_bf16 v[68:71], a[172:175], a[100:103], v[68:71]
v_lshl_add_u32 v184, v4, 8, v184
v_add_u32 v232, s30, v184
v_mfma_f32_16x16x32_bf16 v[36:39], a[172:175], a[96:99], v[36:39]
v_max_u32_dpp v141, v140, v140 row_ror:2 row_mask:0xf bank_mask:0xf
v_add_u32 v184, 4, v4
s_waitcnt vmcnt(21)
v_mfma_f32_16x16x32_bf16 v[8:11], a[176:179], a[112:115], v[8:11]
v_add_u32 v234, 0x10000, v234
v_add_u32 v235, 0x10000, v235
v_mfma_f32_16x16x32_bf16 v[40:43], a[176:179], a[116:119], v[40:43]
v_add_u32 v236, 0x10000, v236
v_add_u32 v237, 0x10000, v237
v_mfma_f32_16x16x32_bf16 v[72:75], a[176:179], a[120:123], v[72:75]
v_max_u32_dpp v140, v141, v141 row_ror:1 row_mask:0xf bank_mask:0xf
v_mov_b32 v141, v140
v_mfma_f32_16x16x32_bf16 v[104:107], a[176:179], a[124:127], v[104:107]
ds_read_b64_tr_b16 a[144:145], v234 offset:0
v_lshlrev_b32 v184, 1, v184
s_waitcnt lgkmcnt(8)
v_mfma_f32_16x16x32_bf16 v[108:111], a[180:183], a[124:127], v[108:111]
ds_read_b64_tr_b16 a[146:147], v234 offset:4096
v_permlane16_swap_b32 v140, v141
v_mfma_f32_16x16x32_bf16 v[76:79], a[180:183], a[120:123], v[76:79]
ds_read_b64_tr_b16 a[148:149], v234 offset:8
v_max_u32 v140, v140, v141
v_mfma_f32_16x16x32_bf16 v[44:47], a[180:183], a[116:119], v[44:47]
s_add_u32 s28, s28, 1024
s_cmp_lt_u32 s28, s6
s_cselect_b32 s28, s28, s4
v_mfma_f32_16x16x32_bf16 v[12:15], a[180:183], a[112:115], v[12:15]
ds_read_b64_tr_b16 a[150:151], v234 offset:4104
v_mov_b32 v141, v140
v_mfma_f32_16x16x32_bf16 v[16:19], a[184:187], a[112:115], v[16:19]
ds_read_b64_tr_b16 a[152:153], v235 offset:0
v_xor_b32 v184, v184, v3
v_mfma_f32_16x16x32_bf16 v[48:51], a[184:187], a[116:119], v[48:51]
ds_read_b64_tr_b16 a[154:155], v235 offset:4096
v_permlane32_swap_b32 v140, v141
v_mfma_f32_16x16x32_bf16 v[80:83], a[184:187], a[120:123], v[80:83]
buffer_load_dwordx4 a[48:51], v240, s[20:23], s28 offen sc0 sc1
v_mfma_f32_16x16x32_bf16 v[112:115], a[184:187], a[124:127], v[112:115]
ds_read_b64_tr_b16 a[156:157], v235 offset:8
v_max_u32 v140, v140, v141
v_mfma_f32_16x16x32_bf16 v[116:119], a[188:191], a[124:127], v[116:119]
ds_read_b64_tr_b16 a[158:159], v235 offset:4104
v_add_u32 v143, v143, v140
v_mfma_f32_16x16x32_bf16 v[84:87], a[188:191], a[120:123], v[84:87]
buffer_load_dwordx4 a[52:55], v241, s[20:23], s28 offen sc0 sc1
v_mfma_f32_16x16x32_bf16 v[52:55], a[188:191], a[116:119], v[52:55]
ds_read_b64_tr_b16 a[160:161], v236 offset:0
v_sub_u32 v136, v136, v140
v_mfma_f32_16x16x32_bf16 v[20:23], a[188:191], a[112:115], v[20:23]
ds_read_b64_tr_b16 a[162:163], v236 offset:4096
v_sub_u32 v137, v137, v140
s_waitcnt lgkmcnt(8)
v_mfma_f32_16x16x32_bf16 v[24:27], a[192:195], a[112:115], v[24:27]
ds_read_b64_tr_b16 a[164:165], v236 offset:8
v_sub_u32 v138, v138, v140
v_mfma_f32_16x16x32_bf16 v[56:59], a[192:195], a[116:119], v[56:59]
buffer_load_dwordx4 a[56:59], v242, s[20:23], s28 offen sc0 sc1
v_mfma_f32_16x16x32_bf16 v[88:91], a[192:195], a[120:123], v[88:91]
ds_read_b64_tr_b16 a[166:167], v236 offset:4104
v_sub_u32 v139, v139, v140
v_mfma_f32_16x16x32_bf16 v[120:123], a[192:195], a[124:127], v[120:123]
ds_read_b64_tr_b16 a[168:169], v237 offset:0
v_cndmask_b32 v142, v142, v143, s[90:91]
v_mfma_f32_16x16x32_bf16 v[124:127], a[196:199], a[124:127], v[124:127]
ds_read_b64_tr_b16 a[170:171], v237 offset:4096
s_lshl_b64 s[90:91], s[90:91], 1
v_mfma_f32_16x16x32_bf16 v[92:95], a[196:199], a[120:123], v[92:95]
buffer_load_dwordx4 a[60:63], v243, s[20:23], s28 offen sc0 sc1
v_mfma_f32_16x16x32_bf16 v[60:63], a[196:199], a[116:119], v[60:63]
ds_read_b64_tr_b16 a[172:173], v237 offset:8
s_add_u32 m0, s49, 24576
v_mfma_f32_16x16x32_bf16 v[28:31], a[196:199], a[112:115], v[28:31]
ds_read_b64_tr_b16 a[174:175], v237 offset:4104
v_max3_u32 v140, v136, v137, v138
v_mfma_f32_16x16x32_bf16 v[32:35], a[200:203], a[112:115], v[32:35]
buffer_load_dwordx4 v238, s[16:19], s34 offen offset:0 lds
v_mfma_f32_16x16x32_bf16 v[64:67], a[200:203], a[116:119], v[64:67]
buffer_load_dwordx4 v239, s[16:19], s34 offen offset:1024 lds
v_mfma_f32_16x16x32_bf16 v[96:99], a[200:203], a[120:123], v[96:99]
v_max_u32 v140, v140, v139
v_lshlrev_b32 v184, 4, v184
v_mfma_f32_16x16x32_bf16 v[128:131], a[200:203], a[124:127], v[128:131]
s_add_u32 s34, s34, 262144
s_sub_u32 s51, s34, 4718592
s_cselect_b32 s34, s34, s51
v_mfma_f32_16x16x32_bf16 v[132:135], a[204:207], a[124:127], v[132:135]
v_max_u32_dpp v141, v140, v140 row_ror:8 row_mask:0xf bank_mask:0xf
v_lshl_add_u32 v184, v4, 8, v184
v_mfma_f32_16x16x32_bf16 v[100:103], a[204:207], a[120:123], v[100:103]
v_add_u32 v233, s30, v184
v_bfe_u32 v184, v1, 1, 1
v_mfma_f32_16x16x32_bf16 v[68:71], a[204:207], a[116:119], v[68:71]
v_max_u32_dpp v140, v141, v141 row_ror:4 row_mask:0xf bank_mask:0xf
v_lshrrev_b32 v185, 5, v1
v_mfma_f32_16x16x32_bf16 v[36:39], a[204:207], a[112:115], v[36:39]
v_cmp_eq_u32 vcc, v184, v185
v_mov_b32 v186, 0x3f803f80
s_waitcnt vmcnt(21)
v_mfma_f32_16x16x32_bf16 v[8:11], a[144:147], a[0:3], v[8:11]
v_max_u32_dpp v141, v140, v140 row_ror:2 row_mask:0xf bank_mask:0xf
v_mfma_f32_16x16x32_bf16 v[40:43], a[144:147], a[4:7], v[40:43]
s_waitcnt vmcnt(13) lgkmcnt(0)
s_barrier
v_mfma_f32_16x16x32_bf16 v[72:75], a[144:147], a[8:11], v[72:75]
ds_read_b64_tr_b16 a[176:177], v234 offset:8192
v_max_u32_dpp v140, v141, v141 row_ror:1 row_mask:0xf bank_mask:0xf
v_mfma_f32_16x16x32_bf16 v[104:107], a[144:147], a[12:15], v[104:107]
ds_read_b64_tr_b16 a[178:179], v234 offset:12288
v_mov_b32 v141, v140
v_mfma_f32_16x16x32_bf16 v[108:111], a[148:151], a[12:15], v[108:111]
ds_read_b64_tr_b16 a[180:181], v234 offset:8200
v_cndmask_b32 v186, 0, v186, vcc
v_mfma_f32_16x16x32_bf16 v[76:79], a[148:151], a[8:11], v[76:79]
s_add_u32 s28, s28, 1024
s_cmp_lt_u32 s28, s6
s_cselect_b32 s28, s28, s4
v_mfma_f32_16x16x32_bf16 v[44:47], a[148:151], a[4:7], v[44:47]
ds_read_b64_tr_b16 a[182:183], v234 offset:12296
v_permlane16_swap_b32 v140, v141
v_mfma_f32_16x16x32_bf16 v[12:15], a[148:151], a[0:3], v[12:15]
ds_read_b64_tr_b16 a[184:185], v235 offset:8192
v_max_u32 v140, v140, v141
v_mfma_f32_16x16x32_bf16 v[16:19], a[152:155], a[0:3], v[16:19]
buffer_load_dwordx4 a[64:67], v240, s[20:23], s28 offen sc0 sc1
v_mfma_f32_16x16x32_bf16 v[48:51], a[152:155], a[4:7], v[48:51]
ds_read_b64_tr_b16 a[186:187], v235 offset:12288
v_mov_b32 v141, v140
v_mfma_f32_16x16x32_bf16 v[80:83], a[152:155], a[8:11], v[80:83]
ds_read_b64_tr_b16 a[188:189], v235 offset:8200
v_and_b32 v184, 1, v1
v_mfma_f32_16x16x32_bf16 v[112:115], a[152:155], a[12:15], v[112:115]
buffer_load_dwordx4 a[68:71], v241, s[20:23], s28 offen sc0 sc1
v_mfma_f32_16x16x32_bf16 v[116:119], a[156:159], a[12:15], v[116:119]
ds_read_b64_tr_b16 a[190:191], v235 offset:12296
v_permlane32_swap_b32 v140, v141
v_mfma_f32_16x16x32_bf16 v[84:87], a[156:159], a[8:11], v[84:87]
ds_read_b64_tr_b16 a[192:193], v236 offset:8192
v_max_u32 v140, v140, v141
v_mfma_f32_16x16x32_bf16 v[52:55], a[156:159], a[4:7], v[52:55]
ds_read_b64_tr_b16 a[194:195], v236 offset:12288
v_add_u32 v143, v143, v140
v_mfma_f32_16x16x32_bf16 v[20:23], a[156:159], a[0:3], v[20:23]
buffer_load_dwordx4 a[72:75], v242, s[20:23], s28 offen sc0 sc1
v_mfma_f32_16x16x32_bf16 v[24:27], a[160:163], a[0:3], v[24:27]
ds_read_b64_tr_b16 a[196:197], v236 offset:8200
v_cndmask_b32 v142, v142, v143, s[90:91]
v_mfma_f32_16x16x32_bf16 v[56:59], a[160:163], a[4:7], v[56:59]
ds_read_b64_tr_b16 a[198:199], v236 offset:12296
v_cmp_eq_u32 vcc, 1, v184
v_mfma_f32_16x16x32_bf16 v[88:91], a[160:163], a[8:11], v[88:91]
buffer_load_dwordx4 a[76:79], v243, s[20:23], s28 offen sc0 sc1
v_mfma_f32_16x16x32_bf16 v[120:123], a[160:163], a[12:15], v[120:123]
ds_read_b64_tr_b16 a[200:201], v237 offset:8192
s_add_u32 m0, s49, 32768
v_mfma_f32_16x16x32_bf16 v[124:127], a[164:167], a[12:15], v[124:127]
ds_read_b64_tr_b16 a[202:203], v237 offset:12288
v_mov_b32 v184, 0x44444444
v_mfma_f32_16x16x32_bf16 v[92:95], a[164:167], a[8:11], v[92:95]
buffer_load_dwordx4 v238, s[16:19], s34 offen offset:0 lds
v_mfma_f32_16x16x32_bf16 v[60:63], a[164:167], a[4:7], v[60:63]
ds_read_b64_tr_b16 a[204:205], v237 offset:8200
v_mov_b32 v185, 0xeeeeeeee
v_mfma_f32_16x16x32_bf16 v[28:31], a[164:167], a[0:3], v[28:31]
ds_read_b64_tr_b16 a[206:207], v237 offset:12296
v_mfma_f32_16x16x32_bf16 v[32:35], a[168:171], a[0:3], v[32:35]
buffer_load_dwordx4 v239, s[16:19], s34 offen offset:1024 lds
v_mfma_f32_16x16x32_bf16 v[64:67], a[168:171], a[4:7], v[64:67]
v_cndmask_b32 v245, v184, v185, vcc
v_accvgpr_write_b32 a208, v186
v_mfma_f32_16x16x32_bf16 v[96:99], a[168:171], a[8:11], v[96:99]
s_add_u32 s34, s34, 262144
s_sub_u32 s51, s34, 4718592
s_cselect_b32 s34, s34, s51
v_mfma_f32_16x16x32_bf16 v[128:131], a[168:171], a[12:15], v[128:131]
v_accvgpr_write_b32 a209, v186
v_accvgpr_write_b32 a210, v186
v_mfma_f32_16x16x32_bf16 v[132:135], a[172:175], a[12:15], v[132:135]
v_accvgpr_write_b32 a211, v186
v_mfma_f32_16x16x32_bf16 v[100:103], a[172:175], a[8:11], v[100:103]
s_lshl_b32 s92, s36, 9
s_lshr_b32 s93, s35, 2
v_mfma_f32_16x16x32_bf16 v[68:71], a[172:175], a[4:7], v[68:71]
s_and_b32 s94, s35, 3
s_lshl_b32 s95, s93, 6
v_mfma_f32_16x16x32_bf16 v[36:39], a[172:175], a[0:3], v[36:39]
s_add_u32 s95, s95, s92
s_lshl2_add_u32 s95, s94, s95
s_waitcnt vmcnt(21)
s_waitcnt lgkmcnt(8)
v_mfma_f32_16x16x32_bf16 v[8:11], a[176:179], a[16:19], v[8:11]
v_add_u32 v234, 0xfffe0000, v234
v_add_u32 v235, 0xfffe0000, v235
v_mfma_f32_16x16x32_bf16 v[40:43], a[176:179], a[20:23], v[40:43]
v_add_u32 v236, 0xfffe0000, v236
v_add_u32 v237, 0xfffe0000, v237
v_mfma_f32_16x16x32_bf16 v[72:75], a[176:179], a[24:27], v[72:75]
s_add_u32 s95, s95, 0x248000
v_mfma_f32_16x16x32_bf16 v[104:107], a[176:179], a[28:31], v[104:107]
ds_read_b64_tr_b16 a[144:145], v234 offset:0
v_lshlrev_b32 v170, 4, v1
v_mfma_f32_16x16x32_bf16 v[108:111], a[180:183], a[28:31], v[108:111]
ds_read_b64_tr_b16 a[146:147], v234 offset:4096
v_add_u32 v170, s95, v170
v_mfma_f32_16x16x32_bf16 v[76:79], a[180:183], a[24:27], v[76:79]
ds_read_b64_tr_b16 a[148:149], v234 offset:8
s_lshl_b32 s95, s94, 7
v_mfma_f32_16x16x32_bf16 v[44:47], a[180:183], a[20:23], v[44:47]
s_add_u32 s28, s28, 1024
s_cmp_lt_u32 s28, s6
s_cselect_b32 s28, s28, s4
v_mfma_f32_16x16x32_bf16 v[12:15], a[180:183], a[16:19], v[12:15]
ds_read_b64_tr_b16 a[150:151], v234 offset:4104
s_add_u32 s95, s95, s92
v_mfma_f32_16x16x32_bf16 v[16:19], a[184:187], a[16:19], v[16:19]
ds_read_b64_tr_b16 a[152:153], v235 offset:0
s_lshl2_add_u32 s95, s93, s95
v_mfma_f32_16x16x32_bf16 v[48:51], a[184:187], a[20:23], v[48:51]
ds_read_b64_tr_b16 a[154:155], v235 offset:4096
s_add_u32 s95, s95, 0x249f80
v_mfma_f32_16x16x32_bf16 v[80:83], a[184:187], a[24:27], v[80:83]
buffer_load_dwordx4 a[80:83], v240, s[20:23], s28 offen sc0 sc1
v_mfma_f32_16x16x32_bf16 v[112:115], a[184:187], a[28:31], v[112:115]
ds_read_b64_tr_b16 a[156:157], v235 offset:8
v_lshlrev_b32 v184, 5, v1
v_mfma_f32_16x16x32_bf16 v[116:119], a[188:191], a[28:31], v[116:119]
ds_read_b64_tr_b16 a[158:159], v235 offset:4104
v_add_u32 v184, s95, v184
v_mfma_f32_16x16x32_bf16 v[84:87], a[188:191], a[24:27], v[84:87]
buffer_load_dwordx4 a[84:87], v241, s[20:23], s28 offen sc0 sc1
v_mfma_f32_16x16x32_bf16 v[52:55], a[188:191], a[20:23], v[52:55]
ds_read_b64_tr_b16 a[160:161], v236 offset:0
v_cmp_lt_u32 vcc, 3, v1
v_mfma_f32_16x16x32_bf16 v[20:23], a[188:191], a[16:19], v[20:23]
ds_read_b64_tr_b16 a[162:163], v236 offset:4096
s_waitcnt lgkmcnt(8)
v_mfma_f32_16x16x32_bf16 v[24:27], a[192:195], a[16:19], v[24:27]
ds_read_b64_tr_b16 a[164:165], v236 offset:8
v_cndmask_b32 v170, v170, v184, vcc
v_mfma_f32_16x16x32_bf16 v[56:59], a[192:195], a[20:23], v[56:59]
buffer_load_dwordx4 a[88:91], v242, s[20:23], s28 offen sc0 sc1
v_mfma_f32_16x16x32_bf16 v[88:91], a[192:195], a[24:27], v[88:91]
ds_read_b64_tr_b16 a[166:167], v236 offset:4104
s_mov_b32 s95, 0x7fffbff0
v_mfma_f32_16x16x32_bf16 v[120:123], a[192:195], a[28:31], v[120:123]
ds_read_b64_tr_b16 a[168:169], v237 offset:0
v_mfma_f32_16x16x32_bf16 v[124:127], a[196:199], a[28:31], v[124:127]
ds_read_b64_tr_b16 a[170:171], v237 offset:4096
v_mfma_f32_16x16x32_bf16 v[92:95], a[196:199], a[24:27], v[92:95]
buffer_load_dwordx4 a[92:95], v243, s[20:23], s28 offen sc0 sc1
v_mfma_f32_16x16x32_bf16 v[60:63], a[196:199], a[20:23], v[60:63]
ds_read_b64_tr_b16 a[172:173], v237 offset:8
s_add_u32 m0, s49, 40960
v_mfma_f32_16x16x32_bf16 v[28:31], a[196:199], a[16:19], v[28:31]
ds_read_b64_tr_b16 a[174:175], v237 offset:4104
v_mfma_f32_16x16x32_bf16 v[32:35], a[200:203], a[16:19], v[32:35]
buffer_load_dwordx4 v238, s[16:19], s34 offen offset:0 lds
v_mfma_f32_16x16x32_bf16 v[64:67], a[200:203], a[20:23], v[64:67]
buffer_load_dwordx4 v239, s[16:19], s34 offen offset:1024 lds
v_mfma_f32_16x16x32_bf16 v[96:99], a[200:203], a[24:27], v[96:99]
s_cmp_eq_u32 s2, 0
s_cselect_b32 s95, 0x242c00, s95
v_mfma_f32_16x16x32_bf16 v[128:131], a[200:203], a[28:31], v[128:131]
s_add_u32 s34, s34, 262144
s_sub_u32 s51, s34, 4718592
s_cselect_b32 s34, s34, s51
v_mfma_f32_16x16x32_bf16 v[132:135], a[204:207], a[28:31], v[132:135]
v_lshlrev_b32 v184, 7, v1
v_add_u32 v184, s95, v184
v_mfma_f32_16x16x32_bf16 v[100:103], a[204:207], a[24:27], v[100:103]
v_cmp_lt_u32 vcc, 7, v1
v_mfma_f32_16x16x32_bf16 v[68:71], a[204:207], a[20:23], v[68:71]
v_mfma_f32_16x16x32_bf16 v[36:39], a[204:207], a[16:19], v[36:39]
v_cndmask_b32 v170, v170, v184, vcc
v_mov_b32 v184, 0x7ffffff0
s_waitcnt vmcnt(20)
v_mfma_f32_16x16x32_bf16 v[8:11], a[144:147], a[32:35], v[8:11]
ds_read_b64_tr_b16 a[176:177], v234 offset:8192
v_mov_b32 v171, 0
v_mfma_f32_16x16x32_bf16 v[40:43], a[144:147], a[36:39], v[40:43]
ds_read_b64_tr_b16 a[178:179], v234 offset:12288
v_cmp_lt_u32 vcc, 9, v0
v_mfma_f32_16x16x32_bf16 v[72:75], a[144:147], a[40:43], v[72:75]
s_add_u32 s28, s28, 1024
s_cmp_lt_u32 s28, s6
s_cselect_b32 s28, s28, s4
v_mfma_f32_16x16x32_bf16 v[104:107], a[144:147], a[44:47], v[104:107]
ds_read_b64_tr_b16 a[180:181], v234 offset:8200
v_cndmask_b32 v170, v170, v184, vcc
s_waitcnt lgkmcnt(8)
v_mfma_f32_16x16x32_bf16 v[108:111], a[148:151], a[44:47], v[108:111]
ds_read_b64_tr_b16 a[182:183], v234 offset:12296
v_mov_b32 v254, 0x7ffffff0
v_mfma_f32_16x16x32_bf16 v[76:79], a[148:151], a[40:43], v[76:79]
buffer_load_dwordx4 a[96:99], v240, s[20:23], s28 offen sc0 sc1
v_mfma_f32_16x16x32_bf16 v[44:47], a[148:151], a[36:39], v[44:47]
ds_read_b64_tr_b16 a[184:185], v235 offset:8192
s_lshl_b32 s92, s36, 5
v_mfma_f32_16x16x32_bf16 v[12:15], a[148:151], a[32:35], v[12:15]
ds_read_b64_tr_b16 a[186:187], v235 offset:12288
s_add_u32 s92, s92, s35
v_mfma_f32_16x16x32_bf16 v[16:19], a[152:155], a[32:35], v[16:19]
buffer_load_dwordx4 a[100:103], v241, s[20:23], s28 offen sc0 sc1
v_mfma_f32_16x16x32_bf16 v[48:51], a[152:155], a[36:39], v[48:51]
ds_read_b64_tr_b16 a[188:189], v235 offset:8200
v_mfma_f32_16x16x32_bf16 v[80:83], a[152:155], a[40:43], v[80:83]
ds_read_b64_tr_b16 a[190:191], v235 offset:12296
v_mfma_f32_16x16x32_bf16 v[112:115], a[152:155], a[44:47], v[112:115]
buffer_load_dwordx4 a[104:107], v242, s[20:23], s28 offen sc0 sc1
v_mfma_f32_16x16x32_bf16 v[116:119], a[156:159], a[44:47], v[116:119]
ds_read_b64_tr_b16 a[192:193], v236 offset:8192
v_mfma_f32_16x16x32_bf16 v[84:87], a[156:159], a[40:43], v[84:87]
buffer_load_dwordx4 a[108:111], v243, s[20:23], s28 offen sc0 sc1
v_mfma_f32_16x16x32_bf16 v[52:55], a[156:159], a[36:39], v[52:55]
ds_read_b64_tr_b16 a[194:195], v236 offset:12288
v_mfma_f32_16x16x32_bf16 v[20:23], a[156:159], a[32:35], v[20:23]
ds_read_b64_tr_b16 a[196:197], v236 offset:8200
v_mfma_f32_16x16x32_bf16 v[24:27], a[160:163], a[32:35], v[24:27]
s_add_u32 m0, s49, 49152
v_mfma_f32_16x16x32_bf16 v[56:59], a[160:163], a[36:39], v[56:59]
ds_read_b64_tr_b16 a[198:199], v236 offset:12296
v_mfma_f32_16x16x32_bf16 v[88:91], a[160:163], a[40:43], v[88:91]
ds_read_b64_tr_b16 a[200:201], v237 offset:8192
v_mfma_f32_16x16x32_bf16 v[120:123], a[160:163], a[44:47], v[120:123]
s_cmp_eq_u32 s37, 0
s_cselect_b32 s92, s92, 0x7ffffff0
s_waitcnt lgkmcnt(8)
v_mfma_f32_16x16x32_bf16 v[124:127], a[164:167], a[44:47], v[124:127]
ds_read_b64_tr_b16 a[202:203], v237 offset:12288
v_mfma_f32_16x16x32_bf16 v[92:95], a[164:167], a[40:43], v[92:95]
ds_read_b64_tr_b16 a[204:205], v237 offset:8200
v_writelane_b32 v254, s92, 0
v_mfma_f32_16x16x32_bf16 v[60:63], a[164:167], a[36:39], v[60:63]
buffer_load_dwordx4 v238, s[16:19], s34 offen offset:0 lds
v_mfma_f32_16x16x32_bf16 v[28:31], a[164:167], a[32:35], v[28:31]
ds_read_b64_tr_b16 a[206:207], v237 offset:12296
s_or_b32 s92, s38, s46
v_mfma_f32_16x16x32_bf16 v[32:35], a[168:171], a[32:35], v[32:35]
buffer_load_dwordx4 v239, s[16:19], s34 offen offset:1024 lds
v_mfma_f32_16x16x32_bf16 v[64:67], a[168:171], a[36:39], v[64:67]
v_mov_b32 v255, s92
v_add_u32 v184, 0, v0
v_mfma_f32_16x16x32_bf16 v[96:99], a[168:171], a[40:43], v[96:99]
s_add_u32 s34, s34, 262144
s_sub_u32 s51, s34, 4718592
s_cselect_b32 s34, s34, s51
v_mfma_f32_16x16x32_bf16 v[128:131], a[168:171], a[44:47], v[128:131]
v_mul_u32_u24 v185, 911, v184
v_lshrrev_b32 v185, 16, v185
v_mfma_f32_16x16x32_bf16 v[132:135], a[172:175], a[44:47], v[132:135]
v_add_u32 v184, v184, v185
v_lshlrev_b32 v184, 4, v184
v_mfma_f32_16x16x32_bf16 v[100:103], a[172:175], a[40:43], v[100:103]
v_add_u32 v178, 0x24000, v184
v_add_u32 v184, 256, v0
v_mfma_f32_16x16x32_bf16 v[68:71], a[172:175], a[36:39], v[68:71]
v_mul_u32_u24 v185, 911, v184
v_lshrrev_b32 v185, 16, v185
v_mfma_f32_16x16x32_bf16 v[36:39], a[172:175], a[32:35], v[36:39]
v_add_u32 v184, v184, v185
v_lshlrev_b32 v184, 4, v184
s_waitcnt vmcnt(20)
v_mfma_f32_16x16x32_bf16 v[8:11], a[176:179], a[48:51], v[8:11]
v_add_u32 v179, 0x24000, v184
v_add_u32 v184, 512, v0
v_mfma_f32_16x16x32_bf16 v[40:43], a[176:179], a[52:55], v[40:43]
s_waitcnt vmcnt(12) lgkmcnt(0)
s_barrier
v_mfma_f32_16x16x32_bf16 v[72:75], a[176:179], a[56:59], v[72:75]
ds_read_b64_tr_b16 a[144:145], v234 offset:16384
v_mul_u32_u24 v185, 911, v184
v_mfma_f32_16x16x32_bf16 v[104:107], a[176:179], a[60:63], v[104:107]
ds_read_b64_tr_b16 a[146:147], v234 offset:20480
STUB_2:
STUB_A2:
s_cbranch_execz STUB_5
v_lshrrev_b32 v185, 16, v185
v_mfma_f32_16x16x32_bf16 v[108:111], a[180:183], a[60:63], v[108:111]
ds_read_b64_tr_b16 a[148:149], v234 offset:16392
v_add_u32 v184, v184, v185
v_mfma_f32_16x16x32_bf16 v[76:79], a[180:183], a[56:59], v[76:79]
s_add_u32 s28, s28, 1024
s_cmp_lt_u32 s28, s6
s_cselect_b32 s28, s28, s4
v_mfma_f32_16x16x32_bf16 v[44:47], a[180:183], a[52:55], v[44:47]
ds_read_b64_tr_b16 a[150:151], v234 offset:20488
v_lshlrev_b32 v184, 4, v184
v_mfma_f32_16x16x32_bf16 v[12:15], a[180:183], a[48:51], v[12:15]
ds_read_b64_tr_b16 a[152:153], v235 offset:16384
v_add_u32 v180, 0x24000, v184
v_mfma_f32_16x16x32_bf16 v[16:19], a[184:187], a[48:51], v[16:19]
buffer_load_dwordx4 a[112:115], v240, s[20:23], s28 offen sc0 sc1
v_mfma_f32_16x16x32_bf16 v[48:51], a[184:187], a[52:55], v[48:51]
ds_read_b64_tr_b16 a[154:155], v235 offset:20480
v_mfma_f32_16x16x32_bf16 v[80:83], a[184:187], a[56:59], v[80:83]
ds_read_b64_tr_b16 a[156:157], v235 offset:16392
v_mfma_f32_16x16x32_bf16 v[112:115], a[184:187], a[60:63], v[112:115]
buffer_load_dwordx4 a[116:119], v241, s[20:23], s28 offen sc0 sc1
v_mfma_f32_16x16x32_bf16 v[116:119], a[188:191], a[60:63], v[116:119]
ds_read_b64_tr_b16 a[158:159], v235 offset:20488
v_mfma_f32_16x16x32_bf16 v[84:87], a[188:191], a[56:59], v[84:87]
ds_read_b64_tr_b16 a[160:161], v236 offset:16384
v_mfma_f32_16x16x32_bf16 v[52:55], a[188:191], a[52:55], v[52:55]
ds_read_b64_tr_b16 a[162:163], v236 offset:20480
v_mfma_f32_16x16x32_bf16 v[20:23], a[188:191], a[48:51], v[20:23]
buffer_load_dwordx4 a[120:123], v242, s[20:23], s28 offen sc0 sc1
v_mfma_f32_16x16x32_bf16 v[24:27], a[192:195], a[48:51], v[24:27]
ds_read_b64_tr_b16 a[164:165], v236 offset:16392
v_mfma_f32_16x16x32_bf16 v[56:59], a[192:195], a[52:55], v[56:59]
ds_read_b64_tr_b16 a[166:167], v236 offset:20488
v_mfma_f32_16x16x32_bf16 v[88:91], a[192:195], a[56:59], v[88:91]
buffer_load_dwordx4 a[124:127], v243, s[20:23], s28 offen sc0 sc1
v_mfma_f32_16x16x32_bf16 v[120:123], a[192:195], a[60:63], v[120:123]
ds_read_b64_tr_b16 a[168:169], v237 offset:16384
s_add_u32 m0, s49, 57344
v_mfma_f32_16x16x32_bf16 v[124:127], a[196:199], a[60:63], v[124:127]
ds_read_b64_tr_b16 a[170:171], v237 offset:20480
v_mfma_f32_16x16x32_bf16 v[92:95], a[196:199], a[56:59], v[92:95]
buffer_load_dwordx4 v238, s[16:19], s34 offen offset:0 lds
v_mfma_f32_16x16x32_bf16 v[60:63], a[196:199], a[52:55], v[60:63]
ds_read_b64_tr_b16 a[172:173], v237 offset:16392
v_mfma_f32_16x16x32_bf16 v[28:31], a[196:199], a[48:51], v[28:31]
ds_read_b64_tr_b16 a[174:175], v237 offset:20488
v_mfma_f32_16x16x32_bf16 v[32:35], a[200:203], a[48:51], v[32:35]
buffer_load_dwordx4 v239, s[16:19], s34 offen offset:1024 lds
v_mfma_f32_16x16x32_bf16 v[64:67], a[200:203], a[52:55], v[64:67]
s_waitcnt vmcnt(36)
v_readfirstlane_b32 s92, v193
v_mfma_f32_16x16x32_bf16 v[96:99], a[200:203], a[56:59], v[96:99]
s_add_u32 s34, s34, 262144
s_sub_u32 s51, s34, 4718592
s_cselect_b32 s34, s34, s51
v_mfma_f32_16x16x32_bf16 v[128:131], a[200:203], a[60:63], v[128:131]
s_and_b32 s93, s92, 0xf0
s_cbranch_scc0 SP_X0
SP_X0_RET:
v_mfma_f32_16x16x32_bf16 v[132:135], a[204:207], a[60:63], v[132:135]
s_add_u32 s92, s92, s36
s_and_b32 s92, s92, 7
v_mfma_f32_16x16x32_bf16 v[100:103], a[204:207], a[56:59], v[100:103]
s_lshl_b32 s92, s92, 2
s_lshr_b32 s92, 0x63724150, s92
v_mfma_f32_16x16x32_bf16 v[68:71], a[204:207], a[52:55], v[68:71]
s_and_b32 s92, s92, 7
s_lshl_b32 s93, s92, 5
v_mfma_f32_16x16x32_bf16 v[36:39], a[204:207], a[48:51], v[36:39]
s_add_u32 s40, s93, s35
s_lshr_b32 s93, s35, 1
s_waitcnt vmcnt(20)
s_waitcnt lgkmcnt(8)
v_mfma_f32_16x16x32_bf16 v[8:11], a[144:147], a[64:67], v[8:11]
ds_read_b64_tr_b16 a[176:177], v234 offset:24576
s_lshl2_add_u32 s93, s93, s92
v_mfma_f32_16x16x32_bf16 v[40:43], a[144:147], a[68:71], v[40:43]
ds_read_b64_tr_b16 a[178:179], v234 offset:28672
s_and_b32 s94, s35, 1
v_mfma_f32_16x16x32_bf16 v[72:75], a[144:147], a[72:75], v[72:75]
s_add_u32 s28, s28, 1024
s_cmp_lt_u32 s28, s6
s_cselect_b32 s28, s28, s4
v_mfma_f32_16x16x32_bf16 v[104:107], a[144:147], a[76:79], v[104:107]
ds_read_b64_tr_b16 a[180:181], v234 offset:24584
s_lshl1_add_u32 s93, s93, s94
v_mfma_f32_16x16x32_bf16 v[108:111], a[148:151], a[76:79], v[108:111]
ds_read_b64_tr_b16 a[182:183], v234 offset:28680
v_mfma_f32_16x16x32_bf16 v[76:79], a[148:151], a[72:75], v[76:79]
buffer_load_dwordx4 a[0:3], v240, s[20:23], s28 offen sc0 sc1
v_mfma_f32_16x16x32_bf16 v[44:47], a[148:151], a[68:71], v[44:47]
ds_read_b64_tr_b16 a[184:185], v235 offset:24576
v_mfma_f32_16x16x32_bf16 v[12:15], a[148:151], a[64:67], v[12:15]
ds_read_b64_tr_b16 a[186:187], v235 offset:28672
v_mfma_f32_16x16x32_bf16 v[16:19], a[152:155], a[64:67], v[16:19]
buffer_load_dwordx4 a[4:7], v241, s[20:23], s28 offen sc0 sc1
v_mfma_f32_16x16x32_bf16 v[48:51], a[152:155], a[68:71], v[48:51]
ds_read_b64_tr_b16 a[188:189], v235 offset:24584
v_mfma_f32_16x16x32_bf16 v[80:83], a[152:155], a[72:75], v[80:83]
ds_read_b64_tr_b16 a[190:191], v235 offset:28680
v_mfma_f32_16x16x32_bf16 v[112:115], a[152:155], a[76:79], v[112:115]
buffer_load_dwordx4 a[8:11], v242, s[20:23], s28 offen sc0 sc1
v_mfma_f32_16x16x32_bf16 v[116:119], a[156:159], a[76:79], v[116:119]
ds_read_b64_tr_b16 a[192:193], v236 offset:24576
v_mfma_f32_16x16x32_bf16 v[84:87], a[156:159], a[72:75], v[84:87]
buffer_load_dwordx4 a[12:15], v243, s[20:23], s28 offen sc0 sc1
v_mfma_f32_16x16x32_bf16 v[52:55], a[156:159], a[68:71], v[52:55]
ds_read_b64_tr_b16 a[194:195], v236 offset:28672
s_add_u32 s32, s7, 0
v_mfma_f32_16x16x32_bf16 v[20:23], a[156:159], a[64:67], v[20:23]
ds_read_b64_tr_b16 a[196:197], v236 offset:24584
s_waitcnt lgkmcnt(8)
v_mfma_f32_16x16x32_bf16 v[24:27], a[160:163], a[64:67], v[24:27]
s_add_u32 m0, s30, 81920
v_mfma_f32_16x16x32_bf16 v[56:59], a[160:163], a[68:71], v[56:59]
ds_read_b64_tr_b16 a[198:199], v236 offset:28680
v_mfma_f32_16x16x32_bf16 v[88:91], a[160:163], a[72:75], v[88:91]
ds_read_b64_tr_b16 a[200:201], v237 offset:24576
v_mfma_f32_16x16x32_bf16 v[120:123], a[160:163], a[76:79], v[120:123]
buffer_load_dwordx4 v228, s[8:11], s32 offen offset:0  lds
v_mfma_f32_16x16x32_bf16 v[124:127], a[164:167], a[76:79], v[124:127]
ds_read_b64_tr_b16 a[202:203], v237 offset:28672
v_mfma_f32_16x16x32_bf16 v[92:95], a[164:167], a[72:75], v[92:95]
ds_read_b64_tr_b16 a[204:205], v237 offset:24584
v_mfma_f32_16x16x32_bf16 v[60:63], a[164:167], a[68:71], v[60:63]
buffer_load_dwordx4 v229, s[8:11], s32 offen offset:1024  lds
v_mfma_f32_16x16x32_bf16 v[28:31], a[164:167], a[64:67], v[28:31]
ds_read_b64_tr_b16 a[206:207], v237 offset:28680
v_mfma_f32_16x16x32_bf16 v[32:35], a[168:171], a[64:67], v[32:35]
buffer_load_dwordx4 v230, s[8:11], s32 offen offset:2048  lds
v_mfma_f32_16x16x32_bf16 v[64:67], a[168:171], a[68:71], v[64:67]
s_cmp_lt_u32 s92, 4
s_cselect_b32 s40, s93, s40
v_mfma_f32_16x16x32_bf16 v[96:99], a[168:171], a[72:75], v[96:99]
s_mov_b32 s92, s40
s_lshl_b32 s84, s92, 6
v_mfma_f32_16x16x32_bf16 v[128:131], a[168:171], a[76:79], v[128:131]
buffer_load_dwordx4 v231, s[8:11], s32 offen offset:3072  lds
v_mfma_f32_16x16x32_bf16 v[132:135], a[172:175], a[76:79], v[132:135]
s_mul_i32 s93, s37, 147456
s_add_u32 s84, s84, s93
v_mfma_f32_16x16x32_bf16 v[100:103], a[172:175], a[72:75], v[100:103]
s_mul_i32 s85, s92, 36864
s_add_u32 s85, s85, s31
v_mfma_f32_16x16x32_bf16 v[68:71], a[172:175], a[68:71], v[68:71]
s_cmp_lt_u32 s40, 144
s_cselect_b32 s86, s31, 0x30000
s_cselect_b32 s84, s84, 0x40000000
s_cselect_b32 s85, s85, 0x40000000
v_mfma_f32_16x16x32_bf16 v[36:39], a[172:175], a[64:67], v[36:39]
s_waitcnt vmcnt(22)
v_mfma_f32_16x16x32_bf16 v[8:11], a[176:179], a[80:83], v[8:11]
ds_read_b64_tr_b16 a[144:145], v234 offset:32768
v_mfma_f32_16x16x32_bf16 v[40:43], a[176:179], a[84:87], v[40:43]
ds_read_b64_tr_b16 a[146:147], v234 offset:36864
v_mfma_f32_16x16x32_bf16 v[72:75], a[176:179], a[88:91], v[72:75]
s_add_u32 s28, s28, 1024
s_cmp_lt_u32 s28, s6
s_cselect_b32 s28, s28, s4
v_mfma_f32_16x16x32_bf16 v[104:107], a[176:179], a[92:95], v[104:107]
ds_read_b64_tr_b16 a[148:149], v234 offset:32776
s_waitcnt lgkmcnt(8)
v_mfma_f32_16x16x32_bf16 v[108:111], a[180:183], a[92:95], v[108:111]
ds_read_b64_tr_b16 a[150:151], v234 offset:36872
v_mfma_f32_16x16x32_bf16 v[76:79], a[180:183], a[88:91], v[76:79]
v_mfma_f32_16x16x32_bf16 v[44:47], a[180:183], a[84:87], v[44:47]
ds_read_b64_tr_b16 a[152:153], v235 offset:32768
v_mfma_f32_16x16x32_bf16 v[12:15], a[180:183], a[80:83], v[12:15]
ds_read_b64_tr_b16 a[154:155], v235 offset:36864
v_mfma_f32_16x16x32_bf16 v[16:19], a[184:187], a[80:83], v[16:19]
buffer_load_dwordx4 a[16:19], v240, s[20:23], s28 offen sc0 sc1
v_mfma_f32_16x16x32_bf16 v[48:51], a[184:187], a[84:87], v[48:51]
ds_read_b64_tr_b16 a[156:157], v235 offset:32776
v_mfma_f32_16x16x32_bf16 v[80:83], a[184:187], a[88:91], v[80:83]
ds_read_b64_tr_b16 a[158:159], v235 offset:36872
v_mfma_f32_16x16x32_bf16 v[112:115], a[184:187], a[92:95], v[112:115]
v_mfma_f32_16x16x32_bf16 v[116:119], a[188:191], a[92:95], v[116:119]
ds_read_b64_tr_b16 a[160:161], v236 offset:32768
v_mfma_f32_16x16x32_bf16 v[84:87], a[188:191], a[88:91], v[84:87]
buffer_load_dwordx4 a[20:23], v241, s[20:23], s28 offen sc0 sc1
v_mfma_f32_16x16x32_bf16 v[52:55], a[188:191], a[84:87], v[52:55]
ds_read_b64_tr_b16 a[162:163], v236 offset:36864
v_mfma_f32_16x16x32_bf16 v[20:23], a[188:191], a[80:83], v[20:23]
ds_read_b64_tr_b16 a[164:165], v236 offset:32776
v_mfma_f32_16x16x32_bf16 v[24:27], a[192:195], a[80:83], v[24:27]
v_mfma_f32_16x16x32_bf16 v[56:59], a[192:195], a[84:87], v[56:59]
ds_read_b64_tr_b16 a[166:167], v236 offset:36872
v_mfma_f32_16x16x32_bf16 v[88:91], a[192:195], a[88:91], v[88:91]
ds_read_b64_tr_b16 a[168:169], v237 offset:32768
v_mfma_f32_16x16x32_bf16 v[120:123], a[192:195], a[92:95], v[120:123]
buffer_load_dwordx4 a[24:27], v242, s[20:23], s28 offen sc0 sc1
s_waitcnt lgkmcnt(8)
v_mfma_f32_16x16x32_bf16 v[124:127], a[196:199], a[92:95], v[124:127]
ds_read_b64_tr_b16 a[170:171], v237 offset:36864
v_mfma_f32_16x16x32_bf16 v[92:95], a[196:199], a[88:91], v[92:95]
ds_read_b64_tr_b16 a[172:173], v237 offset:32776
v_mfma_f32_16x16x32_bf16 v[60:63], a[196:199], a[84:87], v[60:63]
v_lshlrev_b32 v136, 3, v1
v_mov_b32 v137, 0x7ffffff0
v_mfma_f32_16x16x32_bf16 v[28:31], a[196:199], a[80:83], v[28:31]
ds_read_b64_tr_b16 a[174:175], v237 offset:36872
v_mfma_f32_16x16x32_bf16 v[32:35], a[200:203], a[80:83], v[32:35]
buffer_load_dwordx4 a[28:31], v243, s[20:23], s28 offen sc0 sc1
v_mfma_f32_16x16x32_bf16 v[64:67], a[200:203], a[84:87], v[64:67]
v_cmp_lt_u32 vcc, 7, v1
v_mov_b32 v143, s47
v_mfma_f32_16x16x32_bf16 v[96:99], a[200:203], a[88:91], v[96:99]
v_mfma_f32_16x16x32_bf16 v[128:131], a[200:203], a[92:95], v[128:131]
v_cndmask_b32 v136, v136, v137, vcc
v_mfma_f32_16x16x32_bf16 v[132:135], a[204:207], a[92:95], v[132:135]
s_lshl_b32 s29, s36, 6
s_add_u32 s29, s29, 0x242000
v_mfma_f32_16x16x32_bf16 v[100:103], a[204:207], a[88:91], v[100:103]
s_add_u32 s50, s35, s37
s_cmp_eq_u32 s50, 0
s_cselect_b32 s29, s29, 0x7ffffff0
v_mfma_f32_16x16x32_bf16 v[68:71], a[204:207], a[84:87], v[68:71]
v_mfma_f32_16x16x32_bf16 v[36:39], a[204:207], a[80:83], v[36:39]
s_waitcnt vmcnt(20)
v_mfma_f32_16x16x32_bf16 v[8:11], a[144:147], a[96:99], v[8:11]
v_mfma_f32_16x16x32_bf16 v[40:43], a[144:147], a[100:103], v[40:43]
s_waitcnt vmcnt(12) lgkmcnt(0)
s_barrier
v_mfma_f32_16x16x32_bf16 v[72:75], a[144:147], a[104:107], v[72:75]
ds_read_b64_tr_b16 a[176:177], v234 offset:40960
s_add_u32 s32, s7, 16384
v_mfma_f32_16x16x32_bf16 v[104:107], a[144:147], a[108:111], v[104:107]
ds_read_b64_tr_b16 a[178:179], v234 offset:45056
v_mfma_f32_16x16x32_bf16 v[108:111], a[148:151], a[108:111], v[108:111]
ds_read_b64_tr_b16 a[180:181], v234 offset:40968
v_mfma_f32_16x16x32_bf16 v[76:79], a[148:151], a[104:107], v[76:79]
buffer_store_dwordx2 v[142:143], v136, s[20:23], s29 offen sc0 sc1
v_mfma_f32_16x16x32_bf16 v[44:47], a[148:151], a[100:103], v[44:47]
ds_read_b64_tr_b16 a[182:183], v234 offset:45064
s_add_u32 m0, s30, 114688
v_mfma_f32_16x16x32_bf16 v[12:15], a[148:151], a[96:99], v[12:15]
ds_read_b64_tr_b16 a[184:185], v235 offset:40960
v_mfma_f32_16x16x32_bf16 v[16:19], a[152:155], a[96:99], v[16:19]
buffer_store_dword v171, v170, s[20:23], 0 offen sc0 sc1
v_mfma_f32_16x16x32_bf16 v[48:51], a[152:155], a[100:103], v[48:51]
ds_read_b64_tr_b16 a[186:187], v235 offset:45056
ds_read_b128 v[152:155], v178
v_mfma_f32_16x16x32_bf16 v[80:83], a[152:155], a[104:107], v[80:83]
ds_read_b64_tr_b16 a[188:189], v235 offset:40968
ds_read_b128 v[156:159], v179
v_mfma_f32_16x16x32_bf16 v[112:115], a[152:155], a[108:111], v[112:115]
buffer_load_dwordx4 v228, s[8:11], s32 offen offset:0  lds
v_mfma_f32_16x16x32_bf16 v[116:119], a[156:159], a[108:111], v[116:119]
ds_read_b64_tr_b16 a[190:191], v235 offset:45064
ds_read_b128 v[160:163], v180
v_mfma_f32_16x16x32_bf16 v[84:87], a[156:159], a[104:107], v[84:87]
ds_read_b64_tr_b16 a[192:193], v236 offset:40960
v_mfma_f32_16x16x32_bf16 v[52:55], a[156:159], a[100:103], v[52:55]
ds_read_b64_tr_b16 a[194:195], v236 offset:45056
v_mfma_f32_16x16x32_bf16 v[20:23], a[156:159], a[96:99], v[20:23]
s_mul_i32 s45, s3, 1152
s_add_u32 s45, s45, s31
v_mfma_f32_16x16x32_bf16 v[24:27], a[160:163], a[96:99], v[24:27]
ds_read_b64_tr_b16 a[196:197], v236 offset:40968
s_add_u32 s45, s45, 0x1c00000
v_mfma_f32_16x16x32_bf16 v[56:59], a[160:163], a[100:103], v[56:59]
ds_read_b64_tr_b16 a[198:199], v236 offset:45064
v_mfma_f32_16x16x32_bf16 v[88:91], a[160:163], a[104:107], v[88:91]
buffer_load_dwordx4 v229, s[8:11], s32 offen offset:1024  lds
v_mfma_f32_16x16x32_bf16 v[120:123], a[160:163], a[108:111], v[120:123]
ds_read_b64_tr_b16 a[200:201], v237 offset:40960
v_mfma_f32_16x16x32_bf16 v[124:127], a[164:167], a[108:111], v[124:127]
ds_read_b64_tr_b16 a[202:203], v237 offset:45056
v_mfma_f32_16x16x32_bf16 v[92:95], a[164:167], a[104:107], v[92:95]
buffer_load_dwordx4 v230, s[8:11], s32 offen offset:2048  lds
v_mfma_f32_16x16x32_bf16 v[60:63], a[164:167], a[100:103], v[60:63]
ds_read_b64_tr_b16 a[204:205], v237 offset:40968
v_mfma_f32_16x16x32_bf16 v[28:31], a[164:167], a[96:99], v[28:31]
ds_read_b64_tr_b16 a[206:207], v237 offset:45064
v_mfma_f32_16x16x32_bf16 v[32:35], a[168:171], a[96:99], v[32:35]
s_waitcnt lgkmcnt(8)
buffer_store_dwordx4 v[152:155], v244, s[20:23], s45 offen sc0 sc1
v_mfma_f32_16x16x32_bf16 v[64:67], a[168:171], a[100:103], v[64:67]
buffer_load_dwordx4 v231, s[8:11], s32 offen offset:3072  lds
v_mfma_f32_16x16x32_bf16 v[96:99], a[168:171], a[104:107], v[96:99]
v_mfma_f32_16x16x32_bf16 v[128:131], a[168:171], a[108:111], v[128:131]
v_mfma_f32_16x16x32_bf16 v[132:135], a[172:175], a[108:111], v[132:135]
v_mfma_f32_16x16x32_bf16 v[100:103], a[172:175], a[104:107], v[100:103]
v_mfma_f32_16x16x32_bf16 v[68:71], a[172:175], a[100:103], v[68:71]
s_add_u32 s45, s45, 4096
buffer_store_dwordx4 v[156:159], v244, s[20:23], s45 offen sc0 sc1
v_mfma_f32_16x16x32_bf16 v[36:39], a[172:175], a[96:99], v[36:39]
s_waitcnt vmcnt(22)
v_mfma_f32_16x16x32_bf16 v[8:11], a[176:179], a[112:115], v[8:11]
ds_read_b64_tr_b16 a[144:145], v234 offset:49152
v_mfma_f32_16x16x32_bf16 v[40:43], a[176:179], a[116:119], v[40:43]
ds_read_b64_tr_b16 a[146:147], v234 offset:53248
v_mfma_f32_16x16x32_bf16 v[72:75], a[176:179], a[120:123], v[72:75]
v_mfma_f32_16x16x32_bf16 v[104:107], a[176:179], a[124:127], v[104:107]
ds_read_b64_tr_b16 a[148:149], v234 offset:49160
v_mfma_f32_16x16x32_bf16 v[108:111], a[180:183], a[124:127], v[108:111]
ds_read_b64_tr_b16 a[150:151], v234 offset:53256
v_mfma_f32_16x16x32_bf16 v[76:79], a[180:183], a[120:123], v[76:79]
s_add_u32 s45, s45, 4096
s_cmp_eq_u32 s37, 0
s_cselect_b32 s45, s45, 0x7ffffff0
buffer_store_dwordx4 v[160:163], v244, s[20:23], s45 offen sc0 sc1
v_mfma_f32_16x16x32_bf16 v[44:47], a[180:183], a[116:119], v[44:47]
ds_read_b64_tr_b16 a[152:153], v235 offset:49152
s_mul_i32 s88, s37, 864
v_mfma_f32_16x16x32_bf16 v[12:15], a[180:183], a[112:115], v[12:15]
ds_read_b64_tr_b16 a[154:155], v235 offset:53248
s_mov_b32 s87, s88
v_mfma_f32_16x16x32_bf16 v[16:19], a[184:187], a[112:115], v[16:19]
v_accvgpr_write_b32 a128, 0
v_accvgpr_write_b32 a129, 0
v_mfma_f32_16x16x32_bf16 v[48:51], a[184:187], a[116:119], v[48:51]
ds_read_b64_tr_b16 a[156:157], v235 offset:49160
v_accvgpr_write_b32 a130, 0
v_mfma_f32_16x16x32_bf16 v[80:83], a[184:187], a[120:123], v[80:83]
ds_read_b64_tr_b16 a[158:159], v235 offset:53256
v_accvgpr_write_b32 a131, 0
v_mfma_f32_16x16x32_bf16 v[112:115], a[184:187], a[124:127], v[112:115]
v_accvgpr_write_b32 a132, 0
v_accvgpr_write_b32 a133, 0
v_mfma_f32_16x16x32_bf16 v[116:119], a[188:191], a[124:127], v[116:119]
ds_read_b64_tr_b16 a[160:161], v236 offset:49152
v_accvgpr_write_b32 a134, 0
v_mfma_f32_16x16x32_bf16 v[84:87], a[188:191], a[120:123], v[84:87]
v_accvgpr_write_b32 a135, 0
v_lshrrev_b32 v240, 2, v1
v_mfma_f32_16x16x32_bf16 v[52:55], a[188:191], a[116:119], v[52:55]
ds_read_b64_tr_b16 a[162:163], v236 offset:53248
v_mul_u32_u24 v240, 0x2400, v240
v_mfma_f32_16x16x32_bf16 v[20:23], a[188:191], a[112:115], v[20:23]
ds_read_b64_tr_b16 a[164:165], v236 offset:49160
v_and_b32 v246, 3, v1
s_waitcnt lgkmcnt(8)
v_mfma_f32_16x16x32_bf16 v[24:27], a[192:195], a[112:115], v[24:27]
v_lshl_add_u32 v240, v246, 4, v240
v_mul_u32_u24 v243, 3641, v1
v_mfma_f32_16x16x32_bf16 v[56:59], a[192:195], a[116:119], v[56:59]
ds_read_b64_tr_b16 a[166:167], v236 offset:53256
v_lshrrev_b32 v243, 16, v243
v_mfma_f32_16x16x32_bf16 v[88:91], a[192:195], a[120:123], v[88:91]
ds_read_b64_tr_b16 a[168:169], v237 offset:49152
v_mul_u32_u24 v243, 864, v243
v_mfma_f32_16x16x32_bf16 v[120:123], a[192:195], a[124:127], v[120:123]
v_add_u32 v243, v243, v244
v_mfma_f32_16x16x32_bf16 v[124:127], a[196:199], a[124:127], v[124:127]
ds_read_b64_tr_b16 a[170:171], v237 offset:53248
s_sub_u32 s92, s40, 0
v_mfma_f32_16x16x32_bf16 v[92:95], a[196:199], a[120:123], v[92:95]
ds_read_b64_tr_b16 a[172:173], v237 offset:49160
v_mfma_f32_16x16x32_bf16 v[60:63], a[196:199], a[116:119], v[60:63]
s_cmp_lt_u32 s92, 72
s_cselect_b32 s3, 4, 0
v_mfma_f32_16x16x32_bf16 v[28:31], a[196:199], a[112:115], v[28:31]
ds_read_b64_tr_b16 a[174:175], v237 offset:53256
v_mfma_f32_16x16x32_bf16 v[32:35], a[200:203], a[112:115], v[32:35]
s_cmp_lt_u32 s40, 144
s_cselect_b32 s3, 5, s3
v_mfma_f32_16x16x32_bf16 v[64:67], a[200:203], a[116:119], v[64:67]
v_mfma_f32_16x16x32_bf16 v[96:99], a[200:203], a[120:123], v[96:99]
v_mfma_f32_16x16x32_bf16 v[128:131], a[200:203], a[124:127], v[128:131]
v_mfma_f32_16x16x32_bf16 v[132:135], a[204:207], a[124:127], v[132:135]
v_mfma_f32_16x16x32_bf16 v[100:103], a[204:207], a[120:123], v[100:103]
v_mfma_f32_16x16x32_bf16 v[68:71], a[204:207], a[116:119], v[68:71]
v_mfma_f32_16x16x32_bf16 v[36:39], a[204:207], a[112:115], v[36:39]
s_waitcnt vmcnt(17)
v_mfma_f32_16x16x32_bf16 v[8:11], a[144:147], a[0:3], v[8:11]
ds_read_b64_tr_b16 a[176:177], v234 offset:57344
s_add_u32 s39, s7, 0
v_mfma_f32_16x16x32_bf16 v[40:43], a[144:147], a[4:7], v[40:43]
ds_read_b64_tr_b16 a[178:179], v234 offset:61440
v_mfma_f32_16x16x32_bf16 v[72:75], a[144:147], a[8:11], v[72:75]
v_mfma_f32_16x16x32_bf16 v[104:107], a[144:147], a[12:15], v[104:107]
ds_read_b64_tr_b16 a[180:181], v234 offset:57352
s_waitcnt lgkmcnt(8)
v_mfma_f32_16x16x32_bf16 v[108:111], a[148:151], a[12:15], v[108:111]
ds_read_b64_tr_b16 a[182:183], v234 offset:61448
v_mfma_f32_16x16x32_bf16 v[76:79], a[148:151], a[8:11], v[76:79]
s_add_u32 m0, s30, 131072
v_mfma_f32_16x16x32_bf16 v[44:47], a[148:151], a[4:7], v[44:47]
ds_read_b64_tr_b16 a[184:185], v235 offset:57344
v_mfma_f32_16x16x32_bf16 v[12:15], a[148:151], a[0:3], v[12:15]
ds_read_b64_tr_b16 a[186:187], v235 offset:61440
v_mfma_f32_16x16x32_bf16 v[16:19], a[152:155], a[0:3], v[16:19]
v_mfma_f32_16x16x32_bf16 v[48:51], a[152:155], a[4:7], v[48:51]
ds_read_b64_tr_b16 a[188:189], v235 offset:57352
v_mfma_f32_16x16x32_bf16 v[80:83], a[152:155], a[8:11], v[80:83]
ds_read_b64_tr_b16 a[190:191], v235 offset:61448
v_mfma_f32_16x16x32_bf16 v[112:115], a[152:155], a[12:15], v[112:115]
buffer_load_dwordx4 v232, s[12:15], s39 offen offset:0  lds
v_mfma_f32_16x16x32_bf16 v[116:119], a[156:159], a[12:15], v[116:119]
ds_read_b64_tr_b16 a[192:193], v236 offset:57344
v_mfma_f32_16x16x32_bf16 v[84:87], a[156:159], a[8:11], v[84:87]
v_mfma_f32_16x16x32_bf16 v[52:55], a[156:159], a[4:7], v[52:55]
ds_read_b64_tr_b16 a[194:195], v236 offset:61440
v_mfma_f32_16x16x32_bf16 v[20:23], a[156:159], a[0:3], v[20:23]
ds_read_b64_tr_b16 a[196:197], v236 offset:57352
v_mfma_f32_16x16x32_bf16 v[24:27], a[160:163], a[0:3], v[24:27]
buffer_load_dwordx4 v233, s[12:15], s39 offen offset:1024  lds
v_mfma_f32_16x16x32_bf16 v[56:59], a[160:163], a[4:7], v[56:59]
ds_read_b64_tr_b16 a[198:199], v236 offset:61448
v_mfma_f32_16x16x32_bf16 v[88:91], a[160:163], a[8:11], v[88:91]
ds_read_b64_tr_b16 a[200:201], v237 offset:57344
v_mfma_f32_16x16x32_bf16 v[120:123], a[160:163], a[12:15], v[120:123]
s_waitcnt lgkmcnt(8)
v_mfma_f32_16x16x32_bf16 v[124:127], a[164:167], a[12:15], v[124:127]
ds_read_b64_tr_b16 a[202:203], v237 offset:61440
v_mfma_f32_16x16x32_bf16 v[92:95], a[164:167], a[8:11], v[92:95]
ds_read_b64_tr_b16 a[204:205], v237 offset:57352
v_mfma_f32_16x16x32_bf16 v[60:63], a[164:167], a[4:7], v[60:63]
buffer_load_dwordx4 v232, s[12:15], s39 offen offset:2048  lds
v_mfma_f32_16x16x32_bf16 v[28:31], a[164:167], a[0:3], v[28:31]
ds_read_b64_tr_b16 a[206:207], v237 offset:61448
v_mfma_f32_16x16x32_bf16 v[32:35], a[168:171], a[0:3], v[32:35]
v_mfma_f32_16x16x32_bf16 v[64:67], a[168:171], a[4:7], v[64:67]
buffer_load_dwordx4 v233, s[12:15], s39 offen offset:3072  lds
v_mfma_f32_16x16x32_bf16 v[96:99], a[168:171], a[8:11], v[96:99]
v_mfma_f32_16x16x32_bf16 v[128:131], a[168:171], a[12:15], v[128:131]
v_mfma_f32_16x16x32_bf16 v[132:135], a[172:175], a[12:15], v[132:135]
v_mfma_f32_16x16x32_bf16 v[100:103], a[172:175], a[8:11], v[100:103]
v_mfma_f32_16x16x32_bf16 v[68:71], a[172:175], a[4:7], v[68:71]
v_mfma_f32_16x16x32_bf16 v[36:39], a[172:175], a[0:3], v[36:39]
s_waitcnt vmcnt(13)
v_mfma_f32_16x16x32_bf16 v[8:11], a[176:179], a[16:19], v[8:11]
v_mfma_f32_16x16x32_bf16 v[12:15], a[180:183], a[16:19], v[12:15]
s_waitcnt vmcnt(17) lgkmcnt(0)
s_barrier
v_mfma_f32_16x16x32_bf16 v[16:19], a[184:187], a[16:19], v[16:19]
ds_read_b128 a[144:147], v216 offset:16384
ds_read_b128 a[148:151], v217 offset:16384
v_mfma_f32_16x16x32_bf16 v[20:23], a[188:191], a[16:19], v[20:23]
ds_read_b128 a[152:155], v218 offset:16384
ds_read_b128 a[156:159], v219 offset:16384
v_mfma_f32_16x16x32_bf16 v[24:27], a[192:195], a[16:19], v[24:27]
ds_read_b128 a[160:163], v216 offset:20480
ds_read_b128 a[164:167], v217 offset:20480
v_mfma_f32_16x16x32_bf16 v[28:31], a[196:199], a[16:19], v[28:31]
ds_read_b128 a[168:171], v218 offset:20480
ds_read_b128 a[172:175], v219 offset:20480
v_mfma_f32_16x16x32_bf16 v[32:35], a[200:203], a[16:19], v[32:35]
s_add_u32 s32, s7, 32768
v_mfma_f32_16x16x32_bf16 v[36:39], a[204:207], a[16:19], v[36:39]
s_add_u32 m0, s30, 65536
v_mfma_f32_16x16x32_bf16 v[40:43], a[176:179], a[20:23], v[40:43]
v_cvt_pk_bf16_f32 v152, v8, v9
v_cvt_pk_bf16_f32 v153, v10, v11
v_mfma_f32_16x16x32_bf16 v[44:47], a[180:183], a[20:23], v[44:47]
v_cvt_pk_bf16_f32 v154, v12, v13
v_cvt_pk_bf16_f32 v155, v14, v15
v_mfma_f32_16x16x32_bf16 v[48:51], a[184:187], a[20:23], v[48:51]
v_cvt_pk_bf16_f32 v156, v16, v17
v_cvt_pk_bf16_f32 v157, v18, v19
v_mfma_f32_16x16x32_bf16 v[52:55], a[188:191], a[20:23], v[52:55]
v_cvt_pk_bf16_f32 v158, v20, v21
v_cvt_pk_bf16_f32 v159, v22, v23
v_mfma_f32_16x16x32_bf16 v[56:59], a[192:195], a[20:23], v[56:59]
v_cvt_pk_bf16_f32 v160, v24, v25
v_cvt_pk_bf16_f32 v161, v26, v27
v_mfma_f32_16x16x32_bf16 v[60:63], a[196:199], a[20:23], v[60:63]
v_cvt_pk_bf16_f32 v162, v28, v29
v_cvt_pk_bf16_f32 v163, v30, v31
v_mfma_f32_16x16x32_bf16 v[64:67], a[200:203], a[20:23], v[64:67]
v_cvt_pk_bf16_f32 v164, v32, v33
v_cvt_pk_bf16_f32 v165, v34, v35
v_mfma_f32_16x16x32_bf16 v[68:71], a[204:207], a[20:23], v[68:71]
v_cvt_pk_bf16_f32 v166, v36, v37
v_cvt_pk_bf16_f32 v167, v38, v39
v_mfma_f32_16x16x32_bf16 v[72:75], a[176:179], a[24:27], v[72:75]
v_cvt_pk_bf16_f32 v168, v40, v41
v_cvt_pk_bf16_f32 v169, v42, v43
v_mfma_f32_16x16x32_bf16 v[76:79], a[180:183], a[24:27], v[76:79]
v_cvt_pk_bf16_f32 v170, v44, v45
v_cvt_pk_bf16_f32 v171, v46, v47
v_mfma_f32_16x16x32_bf16 v[80:83], a[184:187], a[24:27], v[80:83]
v_cvt_pk_bf16_f32 v172, v48, v49
v_cvt_pk_bf16_f32 v173, v50, v51
v_mfma_f32_16x16x32_bf16 v[84:87], a[188:191], a[24:27], v[84:87]
v_cvt_pk_bf16_f32 v174, v52, v53
v_cvt_pk_bf16_f32 v175, v54, v55
v_mfma_f32_16x16x32_bf16 v[88:91], a[192:195], a[24:27], v[88:91]
v_cvt_pk_bf16_f32 v176, v56, v57
v_cvt_pk_bf16_f32 v177, v58, v59
v_mfma_f32_16x16x32_bf16 v[92:95], a[196:199], a[24:27], v[92:95]
v_cvt_pk_bf16_f32 v178, v60, v61
v_cvt_pk_bf16_f32 v179, v62, v63
v_mfma_f32_16x16x32_bf16 v[96:99], a[200:203], a[24:27], v[96:99]
v_cvt_pk_bf16_f32 v180, v64, v65
v_cvt_pk_bf16_f32 v181, v66, v67
v_mfma_f32_16x16x32_bf16 v[100:103], a[204:207], a[24:27], v[100:103]
v_cvt_pk_bf16_f32 v182, v68, v69
v_cvt_pk_bf16_f32 v183, v70, v71
v_mfma_f32_16x16x32_bf16 v[104:107], a[176:179], a[28:31], v[104:107]
v_cvt_pk_bf16_f32 v184, v72, v73
v_cvt_pk_bf16_f32 v185, v74, v75
v_mfma_f32_16x16x32_bf16 v[108:111], a[180:183], a[28:31], v[108:111]
v_cvt_pk_bf16_f32 v186, v76, v77
v_cvt_pk_bf16_f32 v187, v78, v79
v_mfma_f32_16x16x32_bf16 v[112:115], a[184:187], a[28:31], v[112:115]
v_cvt_pk_bf16_f32 v188, v80, v81
v_cvt_pk_bf16_f32 v189, v82, v83
v_mfma_f32_16x16x32_bf16 v[116:119], a[188:191], a[28:31], v[116:119]
v_cvt_pk_bf16_f32 v190, v84, v85
v_cvt_pk_bf16_f32 v191, v86, v87
v_mfma_f32_16x16x32_bf16 v[120:123], a[192:195], a[28:31], v[120:123]
v_cvt_pk_bf16_f32 v192, v88, v89
v_cvt_pk_bf16_f32 v193, v90, v91
v_mfma_f32_16x16x32_bf16 v[124:127], a[196:199], a[28:31], v[124:127]
v_cvt_pk_bf16_f32 v194, v92, v93
v_cvt_pk_bf16_f32 v195, v94, v95
v_mfma_f32_16x16x32_bf16 v[128:131], a[200:203], a[28:31], v[128:131]
v_cvt_pk_bf16_f32 v196, v96, v97
v_cvt_pk_bf16_f32 v197, v98, v99
v_mfma_f32_16x16x32_bf16 v[132:135], a[204:207], a[28:31], v[132:135]
v_cvt_pk_bf16_f32 v198, v100, v101
v_cvt_pk_bf16_f32 v199, v102, v103
s_waitcnt lgkmcnt(7)
v_mfma_f32_16x16x32_bf16 v[8:11], a[144:147], v[152:155], 0
v_cvt_pk_bf16_f32 v200, v104, v105
v_cvt_pk_bf16_f32 v201, v106, v107
s_waitcnt lgkmcnt(6)
v_mfma_f32_16x16x32_bf16 v[8:11], a[148:151], v[156:159], v[8:11]
v_cvt_pk_bf16_f32 v202, v108, v109
v_cvt_pk_bf16_f32 v203, v110, v111
s_waitcnt lgkmcnt(5)
v_mfma_f32_16x16x32_bf16 v[8:11], a[152:155], v[160:163], v[8:11]
v_cvt_pk_bf16_f32 v204, v112, v113
v_cvt_pk_bf16_f32 v205, v114, v115
s_waitcnt lgkmcnt(4)
v_mfma_f32_16x16x32_bf16 v[8:11], a[156:159], v[164:167], v[8:11]
v_cvt_pk_bf16_f32 v206, v116, v117
v_cvt_pk_bf16_f32 v207, v118, v119
s_waitcnt lgkmcnt(3)
v_mfma_f32_16x16x32_bf16 v[12:15], a[160:163], v[152:155], 0
v_cvt_pk_bf16_f32 v208, v120, v121
v_cvt_pk_bf16_f32 v209, v122, v123
s_waitcnt lgkmcnt(2)
v_mfma_f32_16x16x32_bf16 v[12:15], a[164:167], v[156:159], v[12:15]
v_cvt_pk_bf16_f32 v210, v124, v125
v_cvt_pk_bf16_f32 v211, v126, v127
s_waitcnt lgkmcnt(1)
v_mfma_f32_16x16x32_bf16 v[12:15], a[168:171], v[160:163], v[12:15]
v_cvt_pk_bf16_f32 v212, v128, v129
v_cvt_pk_bf16_f32 v213, v130, v131
s_waitcnt lgkmcnt(0)
v_mfma_f32_16x16x32_bf16 v[12:15], a[172:175], v[164:167], v[12:15]
v_cvt_pk_bf16_f32 v214, v132, v133
v_cvt_pk_bf16_f32 v215, v134, v135
v_mfma_f32_16x16x32_bf16 v[16:19], a[144:147], v[168:171], 0
buffer_load_dwordx4 v228, s[8:11], s32 offen offset:0  lds
v_mfma_f32_16x16x32_bf16 v[16:19], a[148:151], v[172:175], v[16:19]
buffer_load_dwordx4 v229, s[8:11], s32 offen offset:1024  lds
STUB_3:
STUB_A3:
s_cbranch_execz STUB_6
v_mfma_f32_16x16x32_bf16 v[16:19], a[152:155], v[176:179], v[16:19]
buffer_load_dwordx4 v230, s[8:11], s32 offen offset:2048  lds
v_mfma_f32_16x16x32_bf16 v[16:19], a[156:159], v[180:183], v[16:19]
buffer_load_dwordx4 v231, s[8:11], s32 offen offset:3072  lds
v_max3_f32 v248, v8, v9, v10
v_mfma_f32_16x16x32_bf16 v[20:23], a[160:163], v[168:171], 0
s_add_u32 s39, s7, 16384
s_add_u32 m0, s30, 147456
v_mfma_f32_16x16x32_bf16 v[20:23], a[164:167], v[172:175], v[20:23]
buffer_load_dwordx4 v232, s[12:15], s39 offen offset:0  lds
v_mfma_f32_16x16x32_bf16 v[20:23], a[168:171], v[176:179], v[20:23]
buffer_load_dwordx4 v233, s[12:15], s39 offen offset:1024  lds
v_mfma_f32_16x16x32_bf16 v[20:23], a[172:175], v[180:183], v[20:23]
v_max3_f32 v248, v248, v11, v12
v_max3_f32 v248, v248, v13, v14
v_mfma_f32_16x16x32_bf16 v[24:27], a[144:147], v[184:187], 0
v_max_f32 v248, v248, v15
v_mov_b32 v249, v248
v_mfma_f32_16x16x32_bf16 v[24:27], a[148:151], v[188:191], v[24:27]
s_nop 0
v_permlane16_swap_b32 v248, v249
v_mfma_f32_16x16x32_bf16 v[24:27], a[152:155], v[192:195], v[24:27]
v_max_f32 v248, v248, v249
v_mov_b32 v249, v248
v_mfma_f32_16x16x32_bf16 v[24:27], a[156:159], v[196:199], v[24:27]
s_nop 0
v_permlane32_swap_b32 v248, v249
v_mfma_f32_16x16x32_bf16 v[28:31], a[160:163], v[184:187], 0
v_max_f32 v248, v248, v249
v_sub_f32 v136, 0, v248
v_sub_f32 v137, 0, v248
v_mfma_f32_16x16x32_bf16 v[28:31], a[164:167], v[188:191], v[28:31]
v_sub_f32 v138, 0, v248
v_sub_f32 v139, 0, v248
v_sub_f32 v8, v8, v248
v_mfma_f32_16x16x32_bf16 v[28:31], a[168:171], v[192:195], v[28:31]
v_sub_f32 v9, v9, v248
v_sub_f32 v10, v10, v248
v_sub_f32 v11, v11, v248
v_mfma_f32_16x16x32_bf16 v[28:31], a[172:175], v[196:199], v[28:31]
v_sub_f32 v12, v12, v248
v_sub_f32 v13, v13, v248
v_sub_f32 v14, v14, v248
v_mfma_f32_16x16x32_bf16 v[32:35], a[144:147], v[200:203], 0
v_sub_f32 v15, v15, v248
v_max3_f32 v250, v16, v17, v18
v_max3_f32 v250, v250, v19, v20
v_mfma_f32_16x16x32_bf16 v[32:35], a[148:151], v[204:207], v[32:35]
v_max3_f32 v250, v250, v21, v22
v_max_f32 v250, v250, v23
v_mov_b32 v251, v250
v_mfma_f32_16x16x32_bf16 v[32:35], a[152:155], v[208:211], v[32:35]
s_nop 0
v_permlane16_swap_b32 v250, v251
v_max_f32 v250, v250, v251
v_mfma_f32_16x16x32_bf16 v[32:35], a[156:159], v[212:215], v[32:35]
v_mov_b32 v251, v250
s_nop 1
v_permlane32_swap_b32 v250, v251
v_mfma_f32_16x16x32_bf16 v[36:39], a[160:163], v[200:203], 0
v_max_f32 v250, v250, v251
v_sub_f32 v140, 0, v250
v_sub_f32 v141, 0, v250
v_mfma_f32_16x16x32_bf16 v[36:39], a[164:167], v[204:207], v[36:39]
v_sub_f32 v142, 0, v250
v_sub_f32 v143, 0, v250
v_sub_f32 v16, v16, v250
v_mfma_f32_16x16x32_bf16 v[36:39], a[168:171], v[208:211], v[36:39]
v_sub_f32 v17, v17, v250
v_sub_f32 v18, v18, v250
v_sub_f32 v19, v19, v250
v_mfma_f32_16x16x32_bf16 v[36:39], a[172:175], v[212:215], v[36:39]
v_sub_f32 v20, v20, v250
v_sub_f32 v21, v21, v250
v_sub_f32 v22, v22, v250
ds_read_b128 a[144:147], v216 offset:24576
ds_read_b128 a[148:151], v217 offset:24576
ds_read_b128 a[152:155], v218 offset:24576
ds_read_b128 a[156:159], v219 offset:24576
ds_read_b128 a[160:163], v216 offset:28672
ds_read_b128 a[164:167], v217 offset:28672
ds_read_b128 a[168:171], v218 offset:28672
ds_read_b128 a[172:175], v219 offset:28672
buffer_load_dwordx4 v232, s[12:15], s39 offen offset:2048  lds
buffer_load_dwordx4 v233, s[12:15], s39 offen offset:3072  lds
s_add_u32 s32, s7, 32768
s_add_u32 s39, s7, 16384
v_sub_f32 v23, v23, v250
v_max3_f32 v248, v24, v25, v26
v_max3_f32 v248, v248, v27, v28
v_max3_f32 v248, v248, v29, v30
v_max_f32 v248, v248, v31
s_nop 3
v_max3_f32 v250, v32, v33, v34
v_max3_f32 v250, v250, v35, v36
v_max3_f32 v250, v250, v37, v38
v_max_f32 v250, v250, v39
v_mov_b32 v249, v248
v_mov_b32 v251, v250
s_nop 0
v_permlane16_swap_b32 v248, v249
v_permlane16_swap_b32 v250, v251
v_max_f32 v248, v248, v249
v_max_f32 v250, v250, v251
v_mov_b32 v249, v248
v_mov_b32 v251, v250
s_nop 0
v_permlane32_swap_b32 v248, v249
v_permlane32_swap_b32 v250, v251
v_max_f32 v248, v248, v249
v_max_f32 v250, v250, v251
v_sub_f32 v144, 0, v248
v_sub_f32 v148, 0, v250
v_sub_f32 v145, 0, v248
v_sub_f32 v149, 0, v250
v_sub_f32 v146, 0, v248
v_sub_f32 v150, 0, v250
v_sub_f32 v147, 0, v248
v_sub_f32 v151, 0, v250
v_sub_f32 v24, v24, v248
v_sub_f32 v32, v32, v250
v_sub_f32 v25, v25, v248
v_sub_f32 v33, v33, v250
v_sub_f32 v26, v26, v248
v_sub_f32 v34, v34, v250
v_sub_f32 v27, v27, v248
v_sub_f32 v35, v35, v250
v_sub_f32 v28, v28, v248
v_sub_f32 v36, v36, v250
v_sub_f32 v29, v29, v248
v_sub_f32 v37, v37, v250
v_sub_f32 v30, v30, v248
v_sub_f32 v38, v38, v250
v_sub_f32 v31, v31, v248
v_sub_f32 v39, v39, v250
K_BODY0:
s_waitcnt lgkmcnt(0)
v_mfma_f32_16x16x32_bf16 v[40:43], a[144:147], v[152:155], v[136:139]
v_exp_f32 v8, v8
v_exp_f32 v9, v9
v_mfma_f32_16x16x32_bf16 v[40:43], a[148:151], v[156:159], v[40:43]
v_cvt_pk_bf16_f32 v72, v8, v9
v_exp_f32 v10, v10
v_mfma_f32_16x16x32_bf16 v[40:43], a[152:155], v[160:163], v[40:43]
v_exp_f32 v11, v11
v_mfma_f32_16x16x32_bf16 v[40:43], a[156:159], v[164:167], v[40:43]
v_cvt_pk_bf16_f32 v73, v10, v11
v_exp_f32 v12, v12
v_mfma_f32_16x16x32_bf16 v[48:51], a[156:159], v[180:183], v[140:143]
v_exp_f32 v13, v13
v_mfma_f32_16x16x32_bf16 v[48:51], a[152:155], v[176:179], v[48:51]
v_cvt_pk_bf16_f32 v74, v12, v13
v_exp_f32 v14, v14
v_mfma_f32_16x16x32_bf16 v[48:51], a[148:151], v[172:175], v[48:51]
v_exp_f32 v15, v15
v_mfma_f32_16x16x32_bf16 v[48:51], a[144:147], v[168:171], v[48:51]
v_exp_f32 v16, v16
v_exp_f32 v17, v17
v_mfma_f32_16x16x32_bf16 v[56:59], a[144:147], v[184:187], v[144:147]
v_cvt_pk_bf16_f32 v75, v14, v15
v_cvt_pk_bf16_f32 v76, v16, v17
v_exp_f32 v18, v18
v_mfma_f32_16x16x32_bf16 v[56:59], a[148:151], v[188:191], v[56:59]
v_exp_f32 v19, v19
v_mfma_f32_16x16x32_bf16 v[56:59], a[152:155], v[192:195], v[56:59]
v_cvt_pk_bf16_f32 v77, v18, v19
v_exp_f32 v20, v20
v_mfma_f32_16x16x32_bf16 v[56:59], a[156:159], v[196:199], v[56:59]
v_exp_f32 v21, v21
v_mfma_f32_16x16x32_bf16 v[64:67], a[156:159], v[212:215], v[148:151]
s_waitcnt vmcnt(8) lgkmcnt(0)
s_barrier
v_exp_f32 v22, v22
v_mfma_f32_16x16x32_bf16 v[64:67], a[152:155], v[208:211], v[64:67]
ds_read_b64_tr_b16 a[176:177], v220 offset:32768
v_cvt_pk_bf16_f32 v78, v20, v21
v_exp_f32 v23, v23
v_mfma_f32_16x16x32_bf16 v[64:67], a[148:151], v[204:207], v[64:67]
v_exp_f32 v24, v24
v_exp_f32 v25, v25
v_mfma_f32_16x16x32_bf16 v[64:67], a[144:147], v[200:203], v[64:67]
v_cvt_pk_bf16_f32 v79, v22, v23
v_cvt_pk_bf16_f32 v80, v24, v25
v_exp_f32 v26, v26
v_mfma_f32_16x16x32_bf16 v[44:47], a[160:163], v[152:155], v[136:139]
ds_read_b64_tr_b16 a[178:179], v220 offset:36864
ds_read_b64_tr_b16 a[180:181], v221 offset:32768
v_exp_f32 v27, v27
v_mfma_f32_16x16x32_bf16 v[44:47], a[164:167], v[156:159], v[44:47]
ds_read_b64_tr_b16 a[182:183], v221 offset:36864
v_cvt_pk_bf16_f32 v81, v26, v27
v_exp_f32 v28, v28
v_mfma_f32_16x16x32_bf16 v[44:47], a[168:171], v[160:163], v[44:47]
ds_read_b64_tr_b16 a[184:185], v222 offset:32768
ds_read_b64_tr_b16 a[186:187], v222 offset:36864
v_exp_f32 v29, v29
v_mfma_f32_16x16x32_bf16 v[44:47], a[172:175], v[164:167], v[44:47]
ds_read_b64_tr_b16 a[188:189], v223 offset:32768
v_cvt_pk_bf16_f32 v82, v28, v29
v_exp_f32 v30, v30
v_mfma_f32_16x16x32_bf16 v[52:55], a[172:175], v[180:183], v[140:143]
ds_read_b64_tr_b16 a[190:191], v223 offset:36864
ds_read_b128 a[156:159], v219 offset:49152
v_exp_f32 v31, v31
v_mfma_f32_16x16x32_bf16 v[52:55], a[168:171], v[176:179], v[52:55]
v_exp_f32 v32, v32
v_exp_f32 v33, v33
v_mfma_f32_16x16x32_bf16 v[52:55], a[164:167], v[172:175], v[52:55]
v_cvt_pk_bf16_f32 v83, v30, v31
v_cvt_pk_bf16_f32 v84, v32, v33
v_exp_f32 v34, v34
v_mfma_f32_16x16x32_bf16 v[52:55], a[160:163], v[168:171], v[52:55]
ds_read_b64_tr_b16 a[192:193], v224 offset:32768
ds_read_b64_tr_b16 a[194:195], v224 offset:36864
v_exp_f32 v35, v35
v_mfma_f32_16x16x32_bf16 v[60:63], a[160:163], v[184:187], v[144:147]
ds_read_b128 a[152:155], v218 offset:49152
v_cvt_pk_bf16_f32 v85, v34, v35
v_exp_f32 v36, v36
v_mfma_f32_16x16x32_bf16 v[60:63], a[164:167], v[188:191], v[60:63]
ds_read_b128 a[148:151], v217 offset:49152
ds_read_b128 a[144:147], v216 offset:49152
v_exp_f32 v37, v37
v_mfma_f32_16x16x32_bf16 v[60:63], a[168:171], v[192:195], v[60:63]
ds_read_b64_tr_b16 a[196:197], v225 offset:32768
v_cvt_pk_bf16_f32 v86, v36, v37
v_exp_f32 v38, v38
v_mfma_f32_16x16x32_bf16 v[60:63], a[172:175], v[196:199], v[60:63]
ds_read_b64_tr_b16 a[198:199], v225 offset:36864
ds_read_b64_tr_b16 a[200:201], v226 offset:32768
v_exp_f32 v39, v39
v_mfma_f32_16x16x32_bf16 v[68:71], a[172:175], v[212:215], v[148:151]
ds_read_b64_tr_b16 a[202:203], v226 offset:36864
ds_read_b64_tr_b16 a[204:205], v227 offset:32768
ds_read_b64_tr_b16 a[206:207], v227 offset:36864
v_cvt_pk_bf16_f32 v87, v38, v39
v_mfma_f32_16x16x32_bf16 v[68:71], a[168:171], v[208:211], v[68:71]
ds_read_b128 a[172:175], v219 offset:53248
ds_read_b128 a[168:171], v218 offset:53248
s_add_u32 s32, s32, 16384
s_add_u32 m0, s30, 81920
v_mfma_f32_16x16x32_bf16 v[68:71], a[164:167], v[204:207], v[68:71]
ds_read_b128 a[164:167], v217 offset:53248
buffer_load_dwordx4 v228, s[8:11], s32 offen offset:0  lds
v_mfma_f32_16x16x32_bf16 v[68:71], a[160:163], v[200:203], v[68:71]
ds_read_b128 a[160:163], v216 offset:53248
buffer_load_dwordx4 v229, s[8:11], s32 offen offset:1024  lds
buffer_load_dwordx4 v230, s[8:11], s32 offen offset:2048  lds
buffer_load_dwordx4 v231, s[8:11], s32 offen offset:3072  lds
buffer_store_byte v255, v254, s[24:27], 0 offen sc0 sc1
s_waitcnt lgkmcnt(8)
v_mfma_f32_16x16x32_bf16 v[8:11], a[144:147], v[152:155], v[136:139]
v_exp_f32 v40, v40
v_mfma_f32_16x16x32_bf16 v[8:11], a[148:151], v[156:159], v[8:11]
v_exp_f32 v41, v41
v_mfma_f32_16x16x32_bf16 v[8:11], a[152:155], v[160:163], v[8:11]
v_cvt_pk_bf16_f32 v88, v40, v41
v_mfma_f32_16x16x32_bf16 v[8:11], a[156:159], v[164:167], v[8:11]
v_exp_f32 v42, v42
v_mfma_f32_16x16x32_bf16 v[16:19], a[156:159], v[180:183], v[140:143]
s_add_u32 s39, s39, 16384
v_mfma_f32_16x16x32_bf16 v[16:19], a[152:155], v[176:179], v[16:19]
v_exp_f32 v43, v43
v_mfma_f32_16x16x32_bf16 v[16:19], a[148:151], v[172:175], v[16:19]
v_cvt_pk_bf16_f32 v89, v42, v43
v_mfma_f32_16x16x32_bf16 v[16:19], a[144:147], v[168:171], v[16:19]
v_exp_f32 v44, v44
v_mfma_f32_16x16x32_bf16 v[24:27], a[144:147], v[184:187], v[144:147]
v_mfma_f32_16x16x32_bf16 v[24:27], a[148:151], v[188:191], v[24:27]
v_exp_f32 v45, v45
v_mfma_f32_16x16x32_bf16 v[24:27], a[152:155], v[192:195], v[24:27]
v_cvt_pk_bf16_f32 v90, v44, v45
v_mfma_f32_16x16x32_bf16 v[24:27], a[156:159], v[196:199], v[24:27]
v_exp_f32 v46, v46
v_mfma_f32_16x16x32_bf16 v[32:35], a[156:159], v[212:215], v[148:151]
ds_read_b128 a[156:159], v219 offset:57344
s_add_u32 m0, s30, 98304
v_mfma_f32_16x16x32_bf16 v[32:35], a[152:155], v[208:211], v[32:35]
v_exp_f32 v47, v47
v_mfma_f32_16x16x32_bf16 v[32:35], a[148:151], v[204:207], v[32:35]
ds_read_b128 a[152:155], v218 offset:57344
v_cvt_pk_bf16_f32 v91, v46, v47
v_mfma_f32_16x16x32_bf16 v[32:35], a[144:147], v[200:203], v[32:35]
v_exp_f32 v48, v48
v_mfma_f32_16x16x32_bf16 a[0:3], v[72:75], a[176:179], 0
ds_read_b128 a[148:151], v217 offset:57344
ds_read_b128 a[144:147], v216 offset:57344
v_mfma_f32_16x16x32_bf16 a[16:19], v[72:75], a[180:183], 0
v_exp_f32 v49, v49
v_mfma_f32_16x16x32_bf16 a[20:23], v[76:79], a[180:183], 0
v_cvt_pk_bf16_f32 v92, v48, v49
v_mfma_f32_16x16x32_bf16 a[4:7], v[76:79], a[176:179], 0
v_exp_f32 v50, v50
v_mfma_f32_16x16x32_bf16 a[8:11], v[80:83], a[176:179], 0
v_mfma_f32_16x16x32_bf16 a[24:27], v[80:83], a[180:183], 0
v_exp_f32 v51, v51
v_mfma_f32_16x16x32_bf16 a[28:31], v[84:87], a[180:183], 0
ds_read_b64_tr_b16 a[180:181], v221 offset:40960
v_cvt_pk_bf16_f32 v93, v50, v51
v_mfma_f32_16x16x32_bf16 a[12:15], v[84:87], a[176:179], 0
v_exp_f32 v52, v52
v_mfma_f32_16x16x32_bf16 a[44:47], v[84:87], a[184:187], 0
ds_read_b64_tr_b16 a[182:183], v221 offset:45056
ds_read_b64_tr_b16 a[176:177], v220 offset:40960
v_mfma_f32_16x16x32_bf16 a[60:63], v[84:87], a[188:191], 0
v_exp_f32 v53, v53
v_mfma_f32_16x16x32_bf16 a[56:59], v[80:83], a[188:191], 0
ds_read_b64_tr_b16 a[178:179], v220 offset:45056
v_cvt_pk_bf16_f32 v94, v52, v53
v_mfma_f32_16x16x32_bf16 a[40:43], v[80:83], a[184:187], 0
v_exp_f32 v54, v54
v_mfma_f32_16x16x32_bf16 a[36:39], v[76:79], a[184:187], 0
buffer_load_dwordx4 v232, s[12:15], s39 offen offset:0  lds
v_mfma_f32_16x16x32_bf16 a[52:55], v[76:79], a[188:191], 0
v_exp_f32 v55, v55
v_mfma_f32_16x16x32_bf16 a[48:51], v[72:75], a[188:191], 0
ds_read_b64_tr_b16 a[188:189], v223 offset:40960
v_cvt_pk_bf16_f32 v95, v54, v55
v_mfma_f32_16x16x32_bf16 a[32:35], v[72:75], a[184:187], 0
v_exp_f32 v56, v56
v_smfmac_f32_16x16x64_bf16 a[128:131], a[208:211], v[72:79], v245
ds_read_b64_tr_b16 a[190:191], v223 offset:45056
s_waitcnt lgkmcnt(8)
v_mfma_f32_16x16x32_bf16 v[12:15], a[160:163], v[152:155], v[136:139]
v_exp_f32 v57, v57
v_mfma_f32_16x16x32_bf16 v[12:15], a[164:167], v[156:159], v[12:15]
v_exp_f32 v58, v58
v_mfma_f32_16x16x32_bf16 v[12:15], a[168:171], v[160:163], v[12:15]
ds_read_b64_tr_b16 a[184:185], v222 offset:40960
v_cvt_pk_bf16_f32 v96, v56, v57
v_mfma_f32_16x16x32_bf16 v[12:15], a[172:175], v[164:167], v[12:15]
v_exp_f32 v59, v59
v_mfma_f32_16x16x32_bf16 v[20:23], a[172:175], v[180:183], v[140:143]
ds_read_b64_tr_b16 a[186:187], v222 offset:45056
v_cvt_pk_bf16_f32 v97, v58, v59
v_mfma_f32_16x16x32_bf16 v[20:23], a[168:171], v[176:179], v[20:23]
v_exp_f32 v60, v60
v_mfma_f32_16x16x32_bf16 v[20:23], a[164:167], v[172:175], v[20:23]
buffer_load_dwordx4 v233, s[12:15], s39 offen offset:1024  lds
v_mfma_f32_16x16x32_bf16 v[20:23], a[160:163], v[168:171], v[20:23]
v_exp_f32 v61, v61
v_mfma_f32_16x16x32_bf16 v[28:31], a[160:163], v[184:187], v[144:147]
v_cvt_pk_bf16_f32 v98, v60, v61
v_mfma_f32_16x16x32_bf16 v[28:31], a[164:167], v[188:191], v[28:31]
v_exp_f32 v62, v62
v_mfma_f32_16x16x32_bf16 v[28:31], a[168:171], v[192:195], v[28:31]
buffer_load_dwordx4 v232, s[12:15], s39 offen offset:2048  lds
v_mfma_f32_16x16x32_bf16 v[28:31], a[172:175], v[196:199], v[28:31]
v_exp_f32 v63, v63
v_mfma_f32_16x16x32_bf16 v[36:39], a[172:175], v[212:215], v[148:151]
ds_read_b128 a[172:175], v219 offset:61440
v_cvt_pk_bf16_f32 v99, v62, v63
v_mfma_f32_16x16x32_bf16 v[36:39], a[168:171], v[208:211], v[36:39]
v_exp_f32 v64, v64
v_mfma_f32_16x16x32_bf16 v[36:39], a[164:167], v[204:207], v[36:39]
ds_read_b128 a[168:171], v218 offset:61440
ds_read_b128 a[164:167], v217 offset:61440
v_mfma_f32_16x16x32_bf16 v[36:39], a[160:163], v[200:203], v[36:39]
v_exp_f32 v65, v65
v_mfma_f32_16x16x32_bf16 a[64:67], v[72:75], a[192:195], 0
ds_read_b128 a[160:163], v216 offset:61440
v_cvt_pk_bf16_f32 v100, v64, v65
v_mfma_f32_16x16x32_bf16 a[80:83], v[72:75], a[196:199], 0
v_exp_f32 v66, v66
v_mfma_f32_16x16x32_bf16 a[84:87], v[76:79], a[196:199], 0
buffer_load_dwordx4 v233, s[12:15], s39 offen offset:3072  lds
v_mfma_f32_16x16x32_bf16 a[68:71], v[76:79], a[192:195], 0
v_exp_f32 v67, v67
v_mfma_f32_16x16x32_bf16 a[72:75], v[80:83], a[192:195], 0
v_cvt_pk_bf16_f32 v101, v66, v67
v_mfma_f32_16x16x32_bf16 a[88:91], v[80:83], a[196:199], 0
v_exp_f32 v68, v68
v_mfma_f32_16x16x32_bf16 a[92:95], v[84:87], a[196:199], 0
ds_read_b64_tr_b16 a[196:197], v225 offset:40960
ds_read_b64_tr_b16 a[198:199], v225 offset:45056
v_mfma_f32_16x16x32_bf16 a[76:79], v[84:87], a[192:195], 0
v_exp_f32 v69, v69
v_mfma_f32_16x16x32_bf16 a[108:111], v[84:87], a[200:203], 0
ds_read_b64_tr_b16 a[192:193], v224 offset:40960
v_cvt_pk_bf16_f32 v102, v68, v69
v_mfma_f32_16x16x32_bf16 a[124:127], v[84:87], a[204:207], 0
v_exp_f32 v70, v70
v_mfma_f32_16x16x32_bf16 a[120:123], v[80:83], a[204:207], 0
ds_read_b64_tr_b16 a[194:195], v224 offset:45056
v_mfma_f32_16x16x32_bf16 a[104:107], v[80:83], a[200:203], 0
v_exp_f32 v71, v71
v_mfma_f32_16x16x32_bf16 a[100:103], v[76:79], a[200:203], 0
v_cvt_pk_bf16_f32 v103, v70, v71
v_mfma_f32_16x16x32_bf16 a[116:119], v[76:79], a[204:207], 0
v_mfma_f32_16x16x32_bf16 a[112:115], v[72:75], a[204:207], 0
ds_read_b64_tr_b16 a[204:205], v227 offset:40960
ds_read_b64_tr_b16 a[206:207], v227 offset:45056
v_mfma_f32_16x16x32_bf16 a[96:99], v[72:75], a[200:203], 0
ds_read_b64_tr_b16 a[200:201], v226 offset:40960
ds_read_b64_tr_b16 a[202:203], v226 offset:45056
v_smfmac_f32_16x16x64_bf16 a[132:135], a[208:211], v[80:87], v245
s_waitcnt lgkmcnt(8)
v_mfma_f32_16x16x32_bf16 v[40:43], a[144:147], v[152:155], v[136:139]
v_exp_f32 v8, v8
v_mfma_f32_16x16x32_bf16 v[40:43], a[148:151], v[156:159], v[40:43]
v_exp_f32 v9, v9
v_mfma_f32_16x16x32_bf16 v[40:43], a[152:155], v[160:163], v[40:43]
v_cvt_pk_bf16_f32 v72, v8, v9
v_lshlrev_b32 v250, 3, v1
v_mfma_f32_16x16x32_bf16 v[40:43], a[156:159], v[164:167], v[40:43]
v_exp_f32 v10, v10
v_mfma_f32_16x16x32_bf16 v[48:51], a[156:159], v[180:183], v[140:143]
v_mfma_f32_16x16x32_bf16 v[48:51], a[152:155], v[176:179], v[48:51]
v_exp_f32 v11, v11
v_mfma_f32_16x16x32_bf16 v[48:51], a[148:151], v[172:175], v[48:51]
v_cvt_pk_bf16_f32 v73, v10, v11
v_mfma_f32_16x16x32_bf16 v[48:51], a[144:147], v[168:171], v[48:51]
v_exp_f32 v12, v12
v_mfma_f32_16x16x32_bf16 v[56:59], a[144:147], v[184:187], v[144:147]
v_mfma_f32_16x16x32_bf16 v[56:59], a[148:151], v[188:191], v[56:59]
v_exp_f32 v13, v13
v_mfma_f32_16x16x32_bf16 v[56:59], a[152:155], v[192:195], v[56:59]
v_cvt_pk_bf16_f32 v74, v12, v13
v_mfma_f32_16x16x32_bf16 v[56:59], a[156:159], v[196:199], v[56:59]
v_exp_f32 v14, v14
v_mfma_f32_16x16x32_bf16 v[64:67], a[156:159], v[212:215], v[148:151]
s_waitcnt vmcnt(9) lgkmcnt(0)
s_barrier
v_mfma_f32_16x16x32_bf16 v[64:67], a[152:155], v[208:211], v[64:67]
v_exp_f32 v15, v15
v_mfma_f32_16x16x32_bf16 v[64:67], a[148:151], v[204:207], v[64:67]
ds_read_b128 a[156:159], v219 offset:0
v_cvt_pk_bf16_f32 v75, v14, v15
v_mfma_f32_16x16x32_bf16 v[64:67], a[144:147], v[200:203], v[64:67]
v_exp_f32 v16, v16
v_mfma_f32_16x16x32_bf16 a[0:3], v[88:91], a[176:179], a[0:3]
ds_read_b128 a[152:155], v218 offset:0
ds_read_b128 a[148:151], v217 offset:0
v_mfma_f32_16x16x32_bf16 a[16:19], v[88:91], a[180:183], a[16:19]
v_exp_f32 v17, v17
v_mfma_f32_16x16x32_bf16 a[20:23], v[92:95], a[180:183], a[20:23]
ds_read_b128 a[144:147], v216 offset:0
v_cvt_pk_bf16_f32 v76, v16, v17
v_mfma_f32_16x16x32_bf16 a[4:7], v[92:95], a[176:179], a[4:7]
v_exp_f32 v18, v18
v_mfma_f32_16x16x32_bf16 a[8:11], v[96:99], a[176:179], a[8:11]
s_add_u32 s32, s32, 16384
s_add_u32 m0, s30, 114688
v_mfma_f32_16x16x32_bf16 a[24:27], v[96:99], a[180:183], a[24:27]
v_exp_f32 v19, v19
v_mfma_f32_16x16x32_bf16 a[28:31], v[100:103], a[180:183], a[28:31]
ds_read_b64_tr_b16 a[180:181], v221 offset:49152
v_cvt_pk_bf16_f32 v77, v18, v19
v_mfma_f32_16x16x32_bf16 a[12:15], v[100:103], a[176:179], a[12:15]
v_exp_f32 v20, v20
v_mfma_f32_16x16x32_bf16 a[44:47], v[100:103], a[184:187], a[44:47]
ds_read_b64_tr_b16 a[182:183], v221 offset:53248
ds_read_b64_tr_b16 a[176:177], v220 offset:49152
v_mfma_f32_16x16x32_bf16 a[60:63], v[100:103], a[188:191], a[60:63]
v_exp_f32 v21, v21
v_mfma_f32_16x16x32_bf16 a[56:59], v[96:99], a[188:191], a[56:59]
ds_read_b64_tr_b16 a[178:179], v220 offset:53248
v_cvt_pk_bf16_f32 v78, v20, v21
v_mfma_f32_16x16x32_bf16 a[40:43], v[96:99], a[184:187], a[40:43]
v_exp_f32 v22, v22
v_mfma_f32_16x16x32_bf16 a[36:39], v[92:95], a[184:187], a[36:39]
buffer_load_dwordx4 v228, s[8:11], s32 offen offset:0  lds
v_mfma_f32_16x16x32_bf16 a[52:55], v[92:95], a[188:191], a[52:55]
v_exp_f32 v23, v23
v_mfma_f32_16x16x32_bf16 a[48:51], v[88:91], a[188:191], a[48:51]
ds_read_b64_tr_b16 a[188:189], v223 offset:49152
v_cvt_pk_bf16_f32 v79, v22, v23
v_mfma_f32_16x16x32_bf16 a[32:35], v[88:91], a[184:187], a[32:35]
v_exp_f32 v24, v24
v_smfmac_f32_16x16x64_bf16 a[128:131], a[208:211], v[88:95], v245
ds_read_b64_tr_b16 a[190:191], v223 offset:53248
v_mfma_f32_16x16x32_bf16 v[44:47], a[160:163], v[152:155], v[136:139]
v_exp_f32 v25, v25
v_mfma_f32_16x16x32_bf16 v[44:47], a[164:167], v[156:159], v[44:47]
v_exp_f32 v26, v26
v_mfma_f32_16x16x32_bf16 v[44:47], a[168:171], v[160:163], v[44:47]
ds_read_b64_tr_b16 a[184:185], v222 offset:49152
v_cvt_pk_bf16_f32 v80, v24, v25
v_mfma_f32_16x16x32_bf16 v[44:47], a[172:175], v[164:167], v[44:47]
v_exp_f32 v27, v27
v_mfma_f32_16x16x32_bf16 v[52:55], a[172:175], v[180:183], v[140:143]
ds_read_b64_tr_b16 a[186:187], v222 offset:53248
v_cvt_pk_bf16_f32 v81, v26, v27
v_mfma_f32_16x16x32_bf16 v[52:55], a[168:171], v[176:179], v[52:55]
v_exp_f32 v28, v28
v_mfma_f32_16x16x32_bf16 v[52:55], a[164:167], v[172:175], v[52:55]
buffer_load_dwordx4 v229, s[8:11], s32 offen offset:1024  lds
v_mfma_f32_16x16x32_bf16 v[52:55], a[160:163], v[168:171], v[52:55]
v_exp_f32 v29, v29
v_mfma_f32_16x16x32_bf16 v[60:63], a[160:163], v[184:187], v[144:147]
v_cvt_pk_bf16_f32 v82, v28, v29
v_mfma_f32_16x16x32_bf16 v[60:63], a[164:167], v[188:191], v[60:63]
v_exp_f32 v30, v30
v_mfma_f32_16x16x32_bf16 v[60:63], a[168:171], v[192:195], v[60:63]
buffer_load_dwordx4 v230, s[8:11], s32 offen offset:2048  lds
v_mfma_f32_16x16x32_bf16 v[60:63], a[172:175], v[196:199], v[60:63]
v_exp_f32 v31, v31
v_mfma_f32_16x16x32_bf16 v[68:71], a[172:175], v[212:215], v[148:151]
ds_read_b128 a[172:175], v219 offset:4096
v_cvt_pk_bf16_f32 v83, v30, v31
v_mfma_f32_16x16x32_bf16 v[68:71], a[168:171], v[208:211], v[68:71]
v_exp_f32 v32, v32
v_mfma_f32_16x16x32_bf16 v[68:71], a[164:167], v[204:207], v[68:71]
ds_read_b128 a[168:171], v218 offset:4096
ds_read_b128 a[164:167], v217 offset:4096
v_mfma_f32_16x16x32_bf16 v[68:71], a[160:163], v[200:203], v[68:71]
v_exp_f32 v33, v33
v_mfma_f32_16x16x32_bf16 a[64:67], v[88:91], a[192:195], a[64:67]
ds_read_b128 a[160:163], v216 offset:4096
v_cvt_pk_bf16_f32 v84, v32, v33
v_mfma_f32_16x16x32_bf16 a[80:83], v[88:91], a[196:199], a[80:83]
v_exp_f32 v34, v34
v_mfma_f32_16x16x32_bf16 a[84:87], v[92:95], a[196:199], a[84:87]
buffer_load_dwordx4 v231, s[8:11], s32 offen offset:3072  lds
v_mfma_f32_16x16x32_bf16 a[68:71], v[92:95], a[192:195], a[68:71]
v_exp_f32 v35, v35
v_mfma_f32_16x16x32_bf16 a[72:75], v[96:99], a[192:195], a[72:75]
v_cvt_pk_bf16_f32 v85, v34, v35
v_mfma_f32_16x16x32_bf16 a[88:91], v[96:99], a[196:199], a[88:91]
v_exp_f32 v36, v36
v_mfma_f32_16x16x32_bf16 a[92:95], v[100:103], a[196:199], a[92:95]
ds_read_b64_tr_b16 a[196:197], v225 offset:49152
ds_read_b64_tr_b16 a[198:199], v225 offset:53248
v_mfma_f32_16x16x32_bf16 a[76:79], v[100:103], a[192:195], a[76:79]
v_exp_f32 v37, v37
v_mfma_f32_16x16x32_bf16 a[108:111], v[100:103], a[200:203], a[108:111]
ds_read_b64_tr_b16 a[192:193], v224 offset:49152
v_cvt_pk_bf16_f32 v86, v36, v37
v_mfma_f32_16x16x32_bf16 a[124:127], v[100:103], a[204:207], a[124:127]
v_exp_f32 v38, v38
v_mfma_f32_16x16x32_bf16 a[120:123], v[96:99], a[204:207], a[120:123]
ds_read_b64_tr_b16 a[194:195], v224 offset:53248
v_mfma_f32_16x16x32_bf16 a[104:107], v[96:99], a[200:203], a[104:107]
v_exp_f32 v39, v39
v_mfma_f32_16x16x32_bf16 a[100:103], v[92:95], a[200:203], a[100:103]
v_cvt_pk_bf16_f32 v87, v38, v39
v_mfma_f32_16x16x32_bf16 a[116:119], v[92:95], a[204:207], a[116:119]
s_add_u32 m0, s86, 0
s_add_u32 s50, s84, 0
buffer_load_dwordx4 v240, s[64:67], s50 offen lds
v_mfma_f32_16x16x32_bf16 a[112:115], v[88:91], a[204:207], a[112:115]
ds_read_b64_tr_b16 a[204:205], v227 offset:49152
ds_read_b64_tr_b16 a[206:207], v227 offset:53248
v_mfma_f32_16x16x32_bf16 a[96:99], v[88:91], a[200:203], a[96:99]
ds_read_b64_tr_b16 a[200:201], v226 offset:49152
ds_read_b64_tr_b16 a[202:203], v226 offset:53248
v_smfmac_f32_16x16x64_bf16 a[132:135], a[208:211], v[96:103], v245
s_add_u32 m0, s86, 4096
s_add_u32 s50, s84, 589824
buffer_load_dwordx4 v240, s[64:67], s50 offen lds
s_waitcnt lgkmcnt(8)
v_mfma_f32_16x16x32_bf16 v[8:11], a[144:147], v[152:155], v[136:139]
v_exp_f32 v40, v40
v_mfma_f32_16x16x32_bf16 v[8:11], a[148:151], v[156:159], v[8:11]
v_exp_f32 v41, v41
v_mfma_f32_16x16x32_bf16 v[8:11], a[152:155], v[160:163], v[8:11]
v_cvt_pk_bf16_f32 v88, v40, v41
v_mfma_f32_16x16x32_bf16 v[8:11], a[156:159], v[164:167], v[8:11]
v_exp_f32 v42, v42
v_mfma_f32_16x16x32_bf16 v[16:19], a[156:159], v[180:183], v[140:143]
s_add_u32 s39, s39, 16384
v_mfma_f32_16x16x32_bf16 v[16:19], a[152:155], v[176:179], v[16:19]
v_exp_f32 v43, v43
v_mfma_f32_16x16x32_bf16 v[16:19], a[148:151], v[172:175], v[16:19]
v_cvt_pk_bf16_f32 v89, v42, v43
v_mfma_f32_16x16x32_bf16 v[16:19], a[144:147], v[168:171], v[16:19]
v_exp_f32 v44, v44
v_mfma_f32_16x16x32_bf16 v[24:27], a[144:147], v[184:187], v[144:147]
s_mov_b32 s29, 0x242000
buffer_load_dwordx2 v[248:249], v250, s[20:23], s29 offen sc0 sc1
v_mfma_f32_16x16x32_bf16 v[24:27], a[148:151], v[188:191], v[24:27]
v_exp_f32 v45, v45
v_mfma_f32_16x16x32_bf16 v[24:27], a[152:155], v[192:195], v[24:27]
s_add_u32 m0, s30, 131072
v_cvt_pk_bf16_f32 v90, v44, v45
v_mfma_f32_16x16x32_bf16 v[24:27], a[156:159], v[196:199], v[24:27]
v_exp_f32 v46, v46
v_mfma_f32_16x16x32_bf16 v[32:35], a[156:159], v[212:215], v[148:151]
ds_read_b128 a[156:159], v219 offset:8192
v_mfma_f32_16x16x32_bf16 v[32:35], a[152:155], v[208:211], v[32:35]
v_exp_f32 v47, v47
v_mfma_f32_16x16x32_bf16 v[32:35], a[148:151], v[204:207], v[32:35]
ds_read_b128 a[152:155], v218 offset:8192
v_cvt_pk_bf16_f32 v91, v46, v47
v_mfma_f32_16x16x32_bf16 v[32:35], a[144:147], v[200:203], v[32:35]
v_exp_f32 v48, v48
v_mfma_f32_16x16x32_bf16 a[0:3], v[72:75], a[176:179], a[0:3]
ds_read_b128 a[148:151], v217 offset:8192
ds_read_b128 a[144:147], v216 offset:8192
v_mfma_f32_16x16x32_bf16 a[16:19], v[72:75], a[180:183], a[16:19]
v_exp_f32 v49, v49
v_mfma_f32_16x16x32_bf16 a[20:23], v[76:79], a[180:183], a[20:23]
v_cvt_pk_bf16_f32 v92, v48, v49
v_mfma_f32_16x16x32_bf16 a[4:7], v[76:79], a[176:179], a[4:7]
v_exp_f32 v50, v50
v_mfma_f32_16x16x32_bf16 a[8:11], v[80:83], a[176:179], a[8:11]
buffer_load_dwordx4 v232, s[12:15], s39 offen offset:0  lds
v_mfma_f32_16x16x32_bf16 a[24:27], v[80:83], a[180:183], a[24:27]
v_exp_f32 v51, v51
v_mfma_f32_16x16x32_bf16 a[28:31], v[84:87], a[180:183], a[28:31]
ds_read_b64_tr_b16 a[180:181], v221 offset:57344
v_cvt_pk_bf16_f32 v93, v50, v51
v_mfma_f32_16x16x32_bf16 a[12:15], v[84:87], a[176:179], a[12:15]
v_exp_f32 v52, v52
v_mfma_f32_16x16x32_bf16 a[44:47], v[84:87], a[184:187], a[44:47]
ds_read_b64_tr_b16 a[182:183], v221 offset:61440
ds_read_b64_tr_b16 a[176:177], v220 offset:57344
v_mfma_f32_16x16x32_bf16 a[60:63], v[84:87], a[188:191], a[60:63]
v_exp_f32 v53, v53
v_mfma_f32_16x16x32_bf16 a[56:59], v[80:83], a[188:191], a[56:59]
ds_read_b64_tr_b16 a[178:179], v220 offset:61440
v_cvt_pk_bf16_f32 v94, v52, v53
v_mfma_f32_16x16x32_bf16 a[40:43], v[80:83], a[184:187], a[40:43]
v_exp_f32 v54, v54
v_mfma_f32_16x16x32_bf16 a[36:39], v[76:79], a[184:187], a[36:39]
STUB_4:
s_cbranch_execz STUB_7
buffer_load_dwordx4 v233, s[12:15], s39 offen offset:1024  lds
v_mfma_f32_16x16x32_bf16 a[52:55], v[76:79], a[188:191], a[52:55]
v_exp_f32 v55, v55
v_mfma_f32_16x16x32_bf16 a[48:51], v[72:75], a[188:191], a[48:51]
ds_read_b64_tr_b16 a[188:189], v223 offset:57344
v_cvt_pk_bf16_f32 v95, v54, v55
v_mfma_f32_16x16x32_bf16 a[32:35], v[72:75], a[184:187], a[32:35]
v_exp_f32 v56, v56
v_smfmac_f32_16x16x64_bf16 a[128:131], a[208:211], v[72:79], v245
ds_read_b64_tr_b16 a[190:191], v223 offset:61440
v_mfma_f32_16x16x32_bf16 v[12:15], a[160:163], v[152:155], v[136:139]
v_exp_f32 v57, v57
v_mfma_f32_16x16x32_bf16 v[12:15], a[164:167], v[156:159], v[12:15]
v_exp_f32 v58, v58
v_mfma_f32_16x16x32_bf16 v[12:15], a[168:171], v[160:163], v[12:15]
ds_read_b64_tr_b16 a[184:185], v222 offset:57344
v_cvt_pk_bf16_f32 v96, v56, v57
v_mfma_f32_16x16x32_bf16 v[12:15], a[172:175], v[164:167], v[12:15]
v_exp_f32 v59, v59
v_mfma_f32_16x16x32_bf16 v[20:23], a[172:175], v[180:183], v[140:143]
ds_read_b64_tr_b16 a[186:187], v222 offset:61440
v_cvt_pk_bf16_f32 v97, v58, v59
v_mfma_f32_16x16x32_bf16 v[20:23], a[168:171], v[176:179], v[20:23]
v_exp_f32 v60, v60
v_mfma_f32_16x16x32_bf16 v[20:23], a[164:167], v[172:175], v[20:23]
buffer_load_dwordx4 v232, s[12:15], s39 offen offset:2048  lds
v_mfma_f32_16x16x32_bf16 v[20:23], a[160:163], v[168:171], v[20:23]
v_exp_f32 v61, v61
v_mfma_f32_16x16x32_bf16 v[28:31], a[160:163], v[184:187], v[144:147]
v_cvt_pk_bf16_f32 v98, v60, v61
v_mfma_f32_16x16x32_bf16 v[28:31], a[164:167], v[188:191], v[28:31]
v_exp_f32 v62, v62
v_mfma_f32_16x16x32_bf16 v[28:31], a[168:171], v[192:195], v[28:31]
buffer_load_dwordx4 v233, s[12:15], s39 offen offset:3072  lds
v_mfma_f32_16x16x32_bf16 v[28:31], a[172:175], v[196:199], v[28:31]
v_exp_f32 v63, v63
v_mfma_f32_16x16x32_bf16 v[36:39], a[172:175], v[212:215], v[148:151]
ds_read_b128 a[172:175], v219 offset:12288
v_cvt_pk_bf16_f32 v99, v62, v63
v_mfma_f32_16x16x32_bf16 v[36:39], a[168:171], v[208:211], v[36:39]
v_exp_f32 v64, v64
v_mfma_f32_16x16x32_bf16 v[36:39], a[164:167], v[204:207], v[36:39]
ds_read_b128 a[168:171], v218 offset:12288
ds_read_b128 a[164:167], v217 offset:12288
v_mfma_f32_16x16x32_bf16 v[36:39], a[160:163], v[200:203], v[36:39]
v_exp_f32 v65, v65
s_waitcnt lgkmcnt(8)
v_mfma_f32_16x16x32_bf16 a[64:67], v[72:75], a[192:195], a[64:67]
ds_read_b128 a[160:163], v216 offset:12288
v_cvt_pk_bf16_f32 v100, v64, v65
v_mfma_f32_16x16x32_bf16 a[80:83], v[72:75], a[196:199], a[80:83]
v_exp_f32 v66, v66
v_mfma_f32_16x16x32_bf16 a[84:87], v[76:79], a[196:199], a[84:87]
s_add_u32 m0, s86, 8192
s_add_u32 s50, s84, 1179648
buffer_load_dwordx4 v240, s[64:67], s50 offen lds
v_mfma_f32_16x16x32_bf16 a[68:71], v[76:79], a[192:195], a[68:71]
v_exp_f32 v67, v67
v_mfma_f32_16x16x32_bf16 a[72:75], v[80:83], a[192:195], a[72:75]
v_cvt_pk_bf16_f32 v101, v66, v67
v_mfma_f32_16x16x32_bf16 a[88:91], v[80:83], a[196:199], a[88:91]
v_exp_f32 v68, v68
v_mfma_f32_16x16x32_bf16 a[92:95], v[84:87], a[196:199], a[92:95]
ds_read_b64_tr_b16 a[196:197], v225 offset:57344
ds_read_b64_tr_b16 a[198:199], v225 offset:61440
v_mfma_f32_16x16x32_bf16 a[76:79], v[84:87], a[192:195], a[76:79]
v_exp_f32 v69, v69
v_mfma_f32_16x16x32_bf16 a[108:111], v[84:87], a[200:203], a[108:111]
ds_read_b64_tr_b16 a[192:193], v224 offset:57344
v_cvt_pk_bf16_f32 v102, v68, v69
v_mfma_f32_16x16x32_bf16 a[124:127], v[84:87], a[204:207], a[124:127]
v_exp_f32 v70, v70
v_mfma_f32_16x16x32_bf16 a[120:123], v[80:83], a[204:207], a[120:123]
ds_read_b64_tr_b16 a[194:195], v224 offset:61440
v_mfma_f32_16x16x32_bf16 a[104:107], v[80:83], a[200:203], a[104:107]
v_exp_f32 v71, v71
v_mfma_f32_16x16x32_bf16 a[100:103], v[76:79], a[200:203], a[100:103]
v_cvt_pk_bf16_f32 v103, v70, v71
v_mfma_f32_16x16x32_bf16 a[116:119], v[76:79], a[204:207], a[116:119]
s_add_u32 m0, s86, 12288
s_add_u32 s50, s84, 1769472
buffer_load_dwordx4 v240, s[64:67], s50 offen lds
v_mfma_f32_16x16x32_bf16 a[112:115], v[72:75], a[204:207], a[112:115]
ds_read_b64_tr_b16 a[204:205], v227 offset:57344
ds_read_b64_tr_b16 a[206:207], v227 offset:61440
v_mfma_f32_16x16x32_bf16 a[96:99], v[72:75], a[200:203], a[96:99]
ds_read_b64_tr_b16 a[200:201], v226 offset:57344
ds_read_b64_tr_b16 a[202:203], v226 offset:61440
v_smfmac_f32_16x16x64_bf16 a[132:135], a[208:211], v[80:87], v245
s_mov_b32 s33, 9
s_cmp_lt_u32 s86, 0x10000
s_cbranch_scc0 K_LOOPIN
v_mfma_f32_16x16x32_bf16 v[40:43], a[144:147], v[152:155], v[136:139]
v_exp_f32 v8, v8
v_mfma_f32_16x16x32_bf16 v[40:43], a[148:151], v[156:159], v[40:43]
v_exp_f32 v9, v9
v_mfma_f32_16x16x32_bf16 v[40:43], a[152:155], v[160:163], v[40:43]
v_cvt_pk_bf16_f32 v72, v8, v9
v_bfe_u32 v246, v1, 2, 2
v_mfma_f32_16x16x32_bf16 v[40:43], a[156:159], v[164:167], v[40:43]
v_exp_f32 v10, v10
v_mfma_f32_16x16x32_bf16 v[48:51], a[156:159], v[180:183], v[140:143]
v_lshl_add_u32 v241, v4, 3, v246
v_lshl_add_u32 v246, v4, 2, v246
v_mfma_f32_16x16x32_bf16 v[48:51], a[152:155], v[176:179], v[48:51]
v_exp_f32 v11, v11
v_mfma_f32_16x16x32_bf16 v[48:51], a[148:151], v[172:175], v[48:51]
v_cvt_pk_bf16_f32 v73, v10, v11
v_and_b32 v247, 3, v1
v_mfma_f32_16x16x32_bf16 v[48:51], a[144:147], v[168:171], v[48:51]
v_exp_f32 v12, v12
v_mfma_f32_16x16x32_bf16 v[56:59], a[144:147], v[184:187], v[144:147]
v_lshlrev_b32 v247, 3, v247
v_lshl_add_u32 v241, v241, 6, v247
v_mfma_f32_16x16x32_bf16 v[56:59], a[148:151], v[188:191], v[56:59]
v_exp_f32 v13, v13
v_mfma_f32_16x16x32_bf16 v[56:59], a[152:155], v[192:195], v[56:59]
s_and_b32 s28, s37, 1
v_cvt_pk_bf16_f32 v74, v12, v13
v_mfma_f32_16x16x32_bf16 v[56:59], a[156:159], v[196:199], v[56:59]
v_exp_f32 v14, v14
v_mfma_f32_16x16x32_bf16 v[64:67], a[156:159], v[212:215], v[148:151]
s_waitcnt vmcnt(13) lgkmcnt(0)
s_barrier
v_mfma_f32_16x16x32_bf16 v[64:67], a[152:155], v[208:211], v[64:67]
v_exp_f32 v15, v15
v_mfma_f32_16x16x32_bf16 v[64:67], a[148:151], v[204:207], v[64:67]
ds_read_b128 a[156:159], v219 offset:16384
v_cvt_pk_bf16_f32 v75, v14, v15
v_mfma_f32_16x16x32_bf16 v[64:67], a[144:147], v[200:203], v[64:67]
v_exp_f32 v16, v16
v_mfma_f32_16x16x32_bf16 a[0:3], v[88:91], a[176:179], a[0:3]
ds_read_b128 a[152:155], v218 offset:16384
ds_read_b128 a[148:151], v217 offset:16384
v_mfma_f32_16x16x32_bf16 a[16:19], v[88:91], a[180:183], a[16:19]
v_exp_f32 v17, v17
v_mfma_f32_16x16x32_bf16 a[20:23], v[92:95], a[180:183], a[20:23]
ds_read_b128 a[144:147], v216 offset:16384
v_cvt_pk_bf16_f32 v76, v16, v17
v_mfma_f32_16x16x32_bf16 a[4:7], v[92:95], a[176:179], a[4:7]
v_exp_f32 v18, v18
v_mfma_f32_16x16x32_bf16 a[8:11], v[96:99], a[176:179], a[8:11]
s_add_u32 s32, s32, 16384
s_add_u32 m0, s30, 65536
v_mfma_f32_16x16x32_bf16 a[24:27], v[96:99], a[180:183], a[24:27]
v_exp_f32 v19, v19
v_mfma_f32_16x16x32_bf16 a[28:31], v[100:103], a[180:183], a[28:31]
ds_read_b64_tr_b16 a[180:181], v221 offset:0
v_cvt_pk_bf16_f32 v77, v18, v19
v_mfma_f32_16x16x32_bf16 a[12:15], v[100:103], a[176:179], a[12:15]
v_exp_f32 v20, v20
v_mfma_f32_16x16x32_bf16 a[44:47], v[100:103], a[184:187], a[44:47]
ds_read_b64_tr_b16 a[182:183], v221 offset:4096
ds_read_b64_tr_b16 a[176:177], v220 offset:0
v_mfma_f32_16x16x32_bf16 a[60:63], v[100:103], a[188:191], a[60:63]
v_exp_f32 v21, v21
v_mfma_f32_16x16x32_bf16 a[56:59], v[96:99], a[188:191], a[56:59]
ds_read_b64_tr_b16 a[178:179], v220 offset:4096
v_cvt_pk_bf16_f32 v78, v20, v21
v_mfma_f32_16x16x32_bf16 a[40:43], v[96:99], a[184:187], a[40:43]
v_exp_f32 v22, v22
v_mfma_f32_16x16x32_bf16 a[36:39], v[92:95], a[184:187], a[36:39]
buffer_load_dwordx4 v228, s[8:11], s32 offen offset:0  lds
v_mfma_f32_16x16x32_bf16 a[52:55], v[92:95], a[188:191], a[52:55]
v_exp_f32 v23, v23
v_mfma_f32_16x16x32_bf16 a[48:51], v[88:91], a[188:191], a[48:51]
ds_read_b64_tr_b16 a[188:189], v223 offset:0
v_cvt_pk_bf16_f32 v79, v22, v23
v_mfma_f32_16x16x32_bf16 a[32:35], v[88:91], a[184:187], a[32:35]
v_exp_f32 v24, v24
v_smfmac_f32_16x16x64_bf16 a[128:131], a[208:211], v[88:95], v245
ds_read_b64_tr_b16 a[190:191], v223 offset:4096
v_mfma_f32_16x16x32_bf16 v[44:47], a[160:163], v[152:155], v[136:139]
v_exp_f32 v25, v25
v_mfma_f32_16x16x32_bf16 v[44:47], a[164:167], v[156:159], v[44:47]
v_exp_f32 v26, v26
v_mfma_f32_16x16x32_bf16 v[44:47], a[168:171], v[160:163], v[44:47]
ds_read_b64_tr_b16 a[184:185], v222 offset:0
v_cvt_pk_bf16_f32 v80, v24, v25
v_mfma_f32_16x16x32_bf16 v[44:47], a[172:175], v[164:167], v[44:47]
v_exp_f32 v27, v27
v_mfma_f32_16x16x32_bf16 v[52:55], a[172:175], v[180:183], v[140:143]
ds_read_b64_tr_b16 a[186:187], v222 offset:4096
v_cvt_pk_bf16_f32 v81, v26, v27
v_mfma_f32_16x16x32_bf16 v[52:55], a[168:171], v[176:179], v[52:55]
v_exp_f32 v28, v28
v_mfma_f32_16x16x32_bf16 v[52:55], a[164:167], v[172:175], v[52:55]
buffer_load_dwordx4 v229, s[8:11], s32 offen offset:1024  lds
v_mfma_f32_16x16x32_bf16 v[52:55], a[160:163], v[168:171], v[52:55]
v_exp_f32 v29, v29
v_mfma_f32_16x16x32_bf16 v[60:63], a[160:163], v[184:187], v[144:147]
s_lshl_b32 s28, s28, 5
v_cvt_pk_bf16_f32 v82, v28, v29
v_mfma_f32_16x16x32_bf16 v[60:63], a[164:167], v[188:191], v[60:63]
v_exp_f32 v30, v30
v_mfma_f32_16x16x32_bf16 v[60:63], a[168:171], v[192:195], v[60:63]
buffer_load_dwordx4 v230, s[8:11], s32 offen offset:2048  lds
v_mfma_f32_16x16x32_bf16 v[60:63], a[172:175], v[196:199], v[60:63]
v_exp_f32 v31, v31
v_mfma_f32_16x16x32_bf16 v[68:71], a[172:175], v[212:215], v[148:151]
ds_read_b128 a[172:175], v219 offset:20480
v_cvt_pk_bf16_f32 v83, v30, v31
v_mfma_f32_16x16x32_bf16 v[68:71], a[168:171], v[208:211], v[68:71]
v_exp_f32 v32, v32
v_mfma_f32_16x16x32_bf16 v[68:71], a[164:167], v[204:207], v[68:71]
ds_read_b128 a[168:171], v218 offset:20480
ds_read_b128 a[164:167], v217 offset:20480
v_mfma_f32_16x16x32_bf16 v[68:71], a[160:163], v[200:203], v[68:71]
v_exp_f32 v33, v33
v_mfma_f32_16x16x32_bf16 a[64:67], v[88:91], a[192:195], a[64:67]
ds_read_b128 a[160:163], v216 offset:20480
v_cvt_pk_bf16_f32 v84, v32, v33
v_mfma_f32_16x16x32_bf16 a[80:83], v[88:91], a[196:199], a[80:83]
v_exp_f32 v34, v34
v_mfma_f32_16x16x32_bf16 a[84:87], v[92:95], a[196:199], a[84:87]
buffer_load_dwordx4 v231, s[8:11], s32 offen offset:3072  lds
v_mfma_f32_16x16x32_bf16 a[68:71], v[92:95], a[192:195], a[68:71]
v_exp_f32 v35, v35
v_mfma_f32_16x16x32_bf16 a[72:75], v[96:99], a[192:195], a[72:75]
s_lshr_b32 s29, s37, 1
v_cvt_pk_bf16_f32 v85, v34, v35
v_mfma_f32_16x16x32_bf16 a[88:91], v[96:99], a[196:199], a[88:91]
v_exp_f32 v36, v36
v_mfma_f32_16x16x32_bf16 a[92:95], v[100:103], a[196:199], a[92:95]
ds_read_b64_tr_b16 a[196:197], v225 offset:0
ds_read_b64_tr_b16 a[198:199], v225 offset:4096
v_mfma_f32_16x16x32_bf16 a[76:79], v[100:103], a[192:195], a[76:79]
v_exp_f32 v37, v37
v_mfma_f32_16x16x32_bf16 a[108:111], v[100:103], a[200:203], a[108:111]
ds_read_b64_tr_b16 a[192:193], v224 offset:0
v_cvt_pk_bf16_f32 v86, v36, v37
v_mfma_f32_16x16x32_bf16 a[124:127], v[100:103], a[204:207], a[124:127]
v_exp_f32 v38, v38
v_mfma_f32_16x16x32_bf16 a[120:123], v[96:99], a[204:207], a[120:123]
ds_read_b64_tr_b16 a[194:195], v224 offset:4096
s_lshl_b32 s29, s29, 15
v_mfma_f32_16x16x32_bf16 a[104:107], v[96:99], a[200:203], a[104:107]
v_exp_f32 v39, v39
v_mfma_f32_16x16x32_bf16 a[100:103], v[92:95], a[200:203], a[100:103]
s_add_u32 s28, s28, s29
v_cvt_pk_bf16_f32 v87, v38, v39
v_mfma_f32_16x16x32_bf16 a[116:119], v[92:95], a[204:207], a[116:119]
s_add_u32 m0, s86, 16384
s_add_u32 s50, s84, 2359296
buffer_load_dwordx4 v240, s[64:67], s50 offen lds
v_mfma_f32_16x16x32_bf16 a[112:115], v[88:91], a[204:207], a[112:115]
ds_read_b64_tr_b16 a[204:205], v227 offset:0
ds_read_b64_tr_b16 a[206:207], v227 offset:4096
v_mfma_f32_16x16x32_bf16 a[96:99], v[88:91], a[200:203], a[96:99]
ds_read_b64_tr_b16 a[200:201], v226 offset:0
ds_read_b64_tr_b16 a[202:203], v226 offset:4096
v_smfmac_f32_16x16x64_bf16 a[132:135], a[208:211], v[96:103], v245
s_add_u32 m0, s86, 20480
s_add_u32 s50, s84, 2949120
buffer_load_dwordx4 v240, s[64:67], s50 offen lds
s_waitcnt lgkmcnt(8)
v_mfma_f32_16x16x32_bf16 v[8:11], a[144:147], v[152:155], v[136:139]
v_exp_f32 v40, v40
v_mfma_f32_16x16x32_bf16 v[8:11], a[148:151], v[156:159], v[8:11]
v_exp_f32 v41, v41
v_mfma_f32_16x16x32_bf16 v[8:11], a[152:155], v[160:163], v[8:11]
v_cvt_pk_bf16_f32 v88, v40, v41
v_add_u32 v241, s28, v241
v_mfma_f32_16x16x32_bf16 v[8:11], a[156:159], v[164:167], v[8:11]
v_exp_f32 v42, v42
v_mfma_f32_16x16x32_bf16 v[16:19], a[156:159], v[180:183], v[140:143]
s_add_u32 s39, s39, 16384
v_mul_u32_u24 v242, 0x480, v246
v_mfma_f32_16x16x32_bf16 v[16:19], a[152:155], v[176:179], v[16:19]
v_exp_f32 v43, v43
v_mfma_f32_16x16x32_bf16 v[16:19], a[148:151], v[172:175], v[16:19]
v_cvt_pk_bf16_f32 v89, v42, v43
v_add_u32 v242, v242, v247
v_mfma_f32_16x16x32_bf16 v[16:19], a[144:147], v[168:171], v[16:19]
v_exp_f32 v44, v44
v_mfma_f32_16x16x32_bf16 v[24:27], a[144:147], v[184:187], v[144:147]
s_mul_i32 s28, s37, 288
s_add_u32 s28, s28, 8192
v_mfma_f32_16x16x32_bf16 v[24:27], a[148:151], v[188:191], v[24:27]
v_exp_f32 v45, v45
v_mfma_f32_16x16x32_bf16 v[24:27], a[152:155], v[192:195], v[24:27]
s_add_u32 m0, s30, 147456
v_cvt_pk_bf16_f32 v90, v44, v45
v_mfma_f32_16x16x32_bf16 v[24:27], a[156:159], v[196:199], v[24:27]
v_exp_f32 v46, v46
v_mfma_f32_16x16x32_bf16 v[32:35], a[156:159], v[212:215], v[148:151]
ds_read_b128 a[156:159], v219 offset:24576
v_add_u32 v242, s28, v242
v_mfma_f32_16x16x32_bf16 v[32:35], a[152:155], v[208:211], v[32:35]
v_exp_f32 v47, v47
v_mfma_f32_16x16x32_bf16 v[32:35], a[148:151], v[204:207], v[32:35]
ds_read_b128 a[152:155], v218 offset:24576
v_cvt_pk_bf16_f32 v91, v46, v47
v_mfma_f32_16x16x32_bf16 v[32:35], a[144:147], v[200:203], v[32:35]
v_exp_f32 v48, v48
v_mfma_f32_16x16x32_bf16 a[0:3], v[72:75], a[176:179], a[0:3]
ds_read_b128 a[148:151], v217 offset:24576
ds_read_b128 a[144:147], v216 offset:24576
v_mfma_f32_16x16x32_bf16 a[16:19], v[72:75], a[180:183], a[16:19]
v_exp_f32 v49, v49
v_mfma_f32_16x16x32_bf16 a[20:23], v[76:79], a[180:183], a[20:23]
v_cvt_pk_bf16_f32 v92, v48, v49
v_mfma_f32_16x16x32_bf16 a[4:7], v[76:79], a[176:179], a[4:7]
v_exp_f32 v50, v50
v_mfma_f32_16x16x32_bf16 a[8:11], v[80:83], a[176:179], a[8:11]
buffer_load_dwordx4 v232, s[12:15], s39 offen offset:0  lds
v_mfma_f32_16x16x32_bf16 a[24:27], v[80:83], a[180:183], a[24:27]
v_exp_f32 v51, v51
v_mfma_f32_16x16x32_bf16 a[28:31], v[84:87], a[180:183], a[28:31]
ds_read_b64_tr_b16 a[180:181], v221 offset:8192
v_cvt_pk_bf16_f32 v93, v50, v51
v_mfma_f32_16x16x32_bf16 a[12:15], v[84:87], a[176:179], a[12:15]
v_exp_f32 v52, v52
v_mfma_f32_16x16x32_bf16 a[44:47], v[84:87], a[184:187], a[44:47]
ds_read_b64_tr_b16 a[182:183], v221 offset:12288
ds_read_b64_tr_b16 a[176:177], v220 offset:8192
v_mfma_f32_16x16x32_bf16 a[60:63], v[84:87], a[188:191], a[60:63]
v_exp_f32 v53, v53
v_mfma_f32_16x16x32_bf16 a[56:59], v[80:83], a[188:191], a[56:59]
ds_read_b64_tr_b16 a[178:179], v220 offset:12288
v_cvt_pk_bf16_f32 v94, v52, v53
v_mfma_f32_16x16x32_bf16 a[40:43], v[80:83], a[184:187], a[40:43]
v_exp_f32 v54, v54
v_mfma_f32_16x16x32_bf16 a[36:39], v[76:79], a[184:187], a[36:39]
buffer_load_dwordx4 v233, s[12:15], s39 offen offset:1024  lds
v_mfma_f32_16x16x32_bf16 a[52:55], v[76:79], a[188:191], a[52:55]
v_exp_f32 v55, v55
v_mfma_f32_16x16x32_bf16 a[48:51], v[72:75], a[188:191], a[48:51]
ds_read_b64_tr_b16 a[188:189], v223 offset:8192
v_cvt_pk_bf16_f32 v95, v54, v55
v_mfma_f32_16x16x32_bf16 a[32:35], v[72:75], a[184:187], a[32:35]
v_exp_f32 v56, v56
v_smfmac_f32_16x16x64_bf16 a[128:131], a[208:211], v[72:79], v245
ds_read_b64_tr_b16 a[190:191], v223 offset:12288
v_mfma_f32_16x16x32_bf16 v[12:15], a[160:163], v[152:155], v[136:139]
v_exp_f32 v57, v57
v_mfma_f32_16x16x32_bf16 v[12:15], a[164:167], v[156:159], v[12:15]
v_exp_f32 v58, v58
v_mfma_f32_16x16x32_bf16 v[12:15], a[168:171], v[160:163], v[12:15]
ds_read_b64_tr_b16 a[184:185], v222 offset:8192
v_cvt_pk_bf16_f32 v96, v56, v57
v_mfma_f32_16x16x32_bf16 v[12:15], a[172:175], v[164:167], v[12:15]
v_exp_f32 v59, v59
v_mfma_f32_16x16x32_bf16 v[20:23], a[172:175], v[180:183], v[140:143]
ds_read_b64_tr_b16 a[186:187], v222 offset:12288
v_cvt_pk_bf16_f32 v97, v58, v59
v_mfma_f32_16x16x32_bf16 v[20:23], a[168:171], v[176:179], v[20:23]
v_exp_f32 v60, v60
v_mfma_f32_16x16x32_bf16 v[20:23], a[164:167], v[172:175], v[20:23]
buffer_load_dwordx4 v232, s[12:15], s39 offen offset:2048  lds
v_mfma_f32_16x16x32_bf16 v[20:23], a[160:163], v[168:171], v[20:23]
v_exp_f32 v61, v61
v_mfma_f32_16x16x32_bf16 v[28:31], a[160:163], v[184:187], v[144:147]
v_cvt_pk_bf16_f32 v98, v60, v61
v_mfma_f32_16x16x32_bf16 v[28:31], a[164:167], v[188:191], v[28:31]
v_exp_f32 v62, v62
v_mfma_f32_16x16x32_bf16 v[28:31], a[168:171], v[192:195], v[28:31]
buffer_load_dwordx4 v233, s[12:15], s39 offen offset:3072  lds
v_mfma_f32_16x16x32_bf16 v[28:31], a[172:175], v[196:199], v[28:31]
v_exp_f32 v63, v63
v_mfma_f32_16x16x32_bf16 v[36:39], a[172:175], v[212:215], v[148:151]
ds_read_b128 a[172:175], v219 offset:28672
v_cvt_pk_bf16_f32 v99, v62, v63
v_mfma_f32_16x16x32_bf16 v[36:39], a[168:171], v[208:211], v[36:39]
v_exp_f32 v64, v64
v_mfma_f32_16x16x32_bf16 v[36:39], a[164:167], v[204:207], v[36:39]
ds_read_b128 a[168:171], v218 offset:28672
ds_read_b128 a[164:167], v217 offset:28672
v_mfma_f32_16x16x32_bf16 v[36:39], a[160:163], v[200:203], v[36:39]
v_exp_f32 v65, v65
s_waitcnt lgkmcnt(8)
v_mfma_f32_16x16x32_bf16 a[64:67], v[72:75], a[192:195], a[64:67]
ds_read_b128 a[160:163], v216 offset:28672
v_cvt_pk_bf16_f32 v100, v64, v65
v_mfma_f32_16x16x32_bf16 a[80:83], v[72:75], a[196:199], a[80:83]
v_exp_f32 v66, v66
v_mfma_f32_16x16x32_bf16 a[84:87], v[76:79], a[196:199], a[84:87]
s_add_u32 m0, s86, 24576
s_add_u32 s50, s84, 3538944
buffer_load_dwordx4 v240, s[64:67], s50 offen lds
v_mfma_f32_16x16x32_bf16 a[68:71], v[76:79], a[192:195], a[68:71]
v_exp_f32 v67, v67
v_mfma_f32_16x16x32_bf16 a[72:75], v[80:83], a[192:195], a[72:75]
v_cvt_pk_bf16_f32 v101, v66, v67
v_mfma_f32_16x16x32_bf16 a[88:91], v[80:83], a[196:199], a[88:91]
v_exp_f32 v68, v68
v_mfma_f32_16x16x32_bf16 a[92:95], v[84:87], a[196:199], a[92:95]
ds_read_b64_tr_b16 a[196:197], v225 offset:8192
ds_read_b64_tr_b16 a[198:199], v225 offset:12288
v_mfma_f32_16x16x32_bf16 a[76:79], v[84:87], a[192:195], a[76:79]
v_exp_f32 v69, v69
v_mfma_f32_16x16x32_bf16 a[108:111], v[84:87], a[200:203], a[108:111]
ds_read_b64_tr_b16 a[192:193], v224 offset:8192
v_cvt_pk_bf16_f32 v102, v68, v69
v_mfma_f32_16x16x32_bf16 a[124:127], v[84:87], a[204:207], a[124:127]
v_exp_f32 v70, v70
v_mfma_f32_16x16x32_bf16 a[120:123], v[80:83], a[204:207], a[120:123]
ds_read_b64_tr_b16 a[194:195], v224 offset:12288
v_mfma_f32_16x16x32_bf16 a[104:107], v[80:83], a[200:203], a[104:107]
v_exp_f32 v71, v71
v_mfma_f32_16x16x32_bf16 a[100:103], v[76:79], a[200:203], a[100:103]
v_cvt_pk_bf16_f32 v103, v70, v71
v_mfma_f32_16x16x32_bf16 a[116:119], v[76:79], a[204:207], a[116:119]
s_add_u32 m0, s86, 28672
s_add_u32 s50, s84, 4128768
buffer_load_dwordx4 v240, s[64:67], s50 offen lds
v_mfma_f32_16x16x32_bf16 a[112:115], v[72:75], a[204:207], a[112:115]
ds_read_b64_tr_b16 a[204:205], v227 offset:8192
ds_read_b64_tr_b16 a[206:207], v227 offset:12288
v_mfma_f32_16x16x32_bf16 a[96:99], v[72:75], a[200:203], a[96:99]
ds_read_b64_tr_b16 a[200:201], v226 offset:8192
ds_read_b64_tr_b16 a[202:203], v226 offset:12288
v_smfmac_f32_16x16x64_bf16 a[132:135], a[208:211], v[80:87], v245
v_mfma_f32_16x16x32_bf16 v[40:43], a[144:147], v[152:155], v[136:139]
v_exp_f32 v8, v8
v_mfma_f32_16x16x32_bf16 v[40:43], a[148:151], v[156:159], v[40:43]
v_exp_f32 v9, v9
v_mfma_f32_16x16x32_bf16 v[40:43], a[152:155], v[160:163], v[40:43]
v_cvt_pk_bf16_f32 v72, v8, v9
v_mfma_f32_16x16x32_bf16 v[40:43], a[156:159], v[164:167], v[40:43]
v_exp_f32 v10, v10
v_mfma_f32_16x16x32_bf16 v[48:51], a[156:159], v[180:183], v[140:143]
v_mfma_f32_16x16x32_bf16 v[48:51], a[152:155], v[176:179], v[48:51]
v_exp_f32 v11, v11
v_mfma_f32_16x16x32_bf16 v[48:51], a[148:151], v[172:175], v[48:51]
v_cvt_pk_bf16_f32 v73, v10, v11
v_mfma_f32_16x16x32_bf16 v[48:51], a[144:147], v[168:171], v[48:51]
v_exp_f32 v12, v12
v_mfma_f32_16x16x32_bf16 v[56:59], a[144:147], v[184:187], v[144:147]
v_mfma_f32_16x16x32_bf16 v[56:59], a[148:151], v[188:191], v[56:59]
v_exp_f32 v13, v13
v_mfma_f32_16x16x32_bf16 v[56:59], a[152:155], v[192:195], v[56:59]
v_cvt_pk_bf16_f32 v74, v12, v13
v_mfma_f32_16x16x32_bf16 v[56:59], a[156:159], v[196:199], v[56:59]
v_exp_f32 v14, v14
v_mfma_f32_16x16x32_bf16 v[64:67], a[156:159], v[212:215], v[148:151]
s_waitcnt vmcnt(12) lgkmcnt(0)
s_barrier
v_mfma_f32_16x16x32_bf16 v[64:67], a[152:155], v[208:211], v[64:67]
v_exp_f32 v15, v15
v_mfma_f32_16x16x32_bf16 v[64:67], a[148:151], v[204:207], v[64:67]
ds_read_b128 a[156:159], v219 offset:49152
v_cvt_pk_bf16_f32 v75, v14, v15
v_mfma_f32_16x16x32_bf16 v[64:67], a[144:147], v[200:203], v[64:67]
v_exp_f32 v16, v16
v_mfma_f32_16x16x32_bf16 a[0:3], v[88:91], a[176:179], a[0:3]
ds_read_b128 a[152:155], v218 offset:49152
ds_read_b128 a[148:151], v217 offset:49152
v_mfma_f32_16x16x32_bf16 a[16:19], v[88:91], a[180:183], a[16:19]
v_exp_f32 v17, v17
v_mfma_f32_16x16x32_bf16 a[20:23], v[92:95], a[180:183], a[20:23]
ds_read_b128 a[144:147], v216 offset:49152
v_cvt_pk_bf16_f32 v76, v16, v17
v_mfma_f32_16x16x32_bf16 a[4:7], v[92:95], a[176:179], a[4:7]
v_exp_f32 v18, v18
v_mfma_f32_16x16x32_bf16 a[8:11], v[96:99], a[176:179], a[8:11]
s_add_u32 s32, s32, 16384
s_add_u32 m0, s30, 81920
v_mfma_f32_16x16x32_bf16 a[24:27], v[96:99], a[180:183], a[24:27]
v_exp_f32 v19, v19
v_mfma_f32_16x16x32_bf16 a[28:31], v[100:103], a[180:183], a[28:31]
ds_read_b64_tr_b16 a[180:181], v221 offset:32768
v_cvt_pk_bf16_f32 v77, v18, v19
v_mfma_f32_16x16x32_bf16 a[12:15], v[100:103], a[176:179], a[12:15]
v_exp_f32 v20, v20
v_mfma_f32_16x16x32_bf16 a[44:47], v[100:103], a[184:187], a[44:47]
ds_read_b64_tr_b16 a[182:183], v221 offset:36864
ds_read_b64_tr_b16 a[176:177], v220 offset:32768
v_mfma_f32_16x16x32_bf16 a[60:63], v[100:103], a[188:191], a[60:63]
v_exp_f32 v21, v21
v_mfma_f32_16x16x32_bf16 a[56:59], v[96:99], a[188:191], a[56:59]
ds_read_b64_tr_b16 a[178:179], v220 offset:36864
v_cvt_pk_bf16_f32 v78, v20, v21
v_mfma_f32_16x16x32_bf16 a[40:43], v[96:99], a[184:187], a[40:43]
v_exp_f32 v22, v22
v_mfma_f32_16x16x32_bf16 a[36:39], v[92:95], a[184:187], a[36:39]
buffer_load_dwordx4 v228, s[8:11], s32 offen offset:0  lds
v_mfma_f32_16x16x32_bf16 a[52:55], v[92:95], a[188:191], a[52:55]
v_exp_f32 v23, v23
v_mfma_f32_16x16x32_bf16 a[48:51], v[88:91], a[188:191], a[48:51]
ds_read_b64_tr_b16 a[188:189], v223 offset:32768
v_cvt_pk_bf16_f32 v79, v22, v23
v_mfma_f32_16x16x32_bf16 a[32:35], v[88:91], a[184:187], a[32:35]
v_exp_f32 v24, v24
v_smfmac_f32_16x16x64_bf16 a[128:131], a[208:211], v[88:95], v245
ds_read_b64_tr_b16 a[190:191], v223 offset:36864
v_mfma_f32_16x16x32_bf16 v[44:47], a[160:163], v[152:155], v[136:139]
v_exp_f32 v25, v25
v_mfma_f32_16x16x32_bf16 v[44:47], a[164:167], v[156:159], v[44:47]
v_exp_f32 v26, v26
v_mfma_f32_16x16x32_bf16 v[44:47], a[168:171], v[160:163], v[44:47]
ds_read_b64_tr_b16 a[184:185], v222 offset:32768
v_cvt_pk_bf16_f32 v80, v24, v25
v_mfma_f32_16x16x32_bf16 v[44:47], a[172:175], v[164:167], v[44:47]
v_exp_f32 v27, v27
v_mfma_f32_16x16x32_bf16 v[52:55], a[172:175], v[180:183], v[140:143]
ds_read_b64_tr_b16 a[186:187], v222 offset:36864
v_cvt_pk_bf16_f32 v81, v26, v27
v_mfma_f32_16x16x32_bf16 v[52:55], a[168:171], v[176:179], v[52:55]
v_exp_f32 v28, v28
v_mfma_f32_16x16x32_bf16 v[52:55], a[164:167], v[172:175], v[52:55]
buffer_load_dwordx4 v229, s[8:11], s32 offen offset:1024  lds
v_mfma_f32_16x16x32_bf16 v[52:55], a[160:163], v[168:171], v[52:55]
v_exp_f32 v29, v29
v_mfma_f32_16x16x32_bf16 v[60:63], a[160:163], v[184:187], v[144:147]
v_cmp_ne_u32 vcc, s47, v249
s_cbranch_vccnz SP_CAND
SP_CAND_RET:
v_cvt_pk_bf16_f32 v82, v28, v29
v_mfma_f32_16x16x32_bf16 v[60:63], a[164:167], v[188:191], v[60:63]
v_exp_f32 v30, v30
v_mfma_f32_16x16x32_bf16 v[60:63], a[168:171], v[192:195], v[60:63]
buffer_load_dwordx4 v230, s[8:11], s32 offen offset:2048  lds
v_mfma_f32_16x16x32_bf16 v[60:63], a[172:175], v[196:199], v[60:63]
v_exp_f32 v31, v31
v_mfma_f32_16x16x32_bf16 v[68:71], a[172:175], v[212:215], v[148:151]
ds_read_b128 a[172:175], v219 offset:53248
v_cvt_pk_bf16_f32 v83, v30, v31
v_mfma_f32_16x16x32_bf16 v[68:71], a[168:171], v[208:211], v[68:71]
v_exp_f32 v32, v32
v_mfma_f32_16x16x32_bf16 v[68:71], a[164:167], v[204:207], v[68:71]
ds_read_b128 a[168:171], v218 offset:53248
ds_read_b128 a[164:167], v217 offset:53248
v_mfma_f32_16x16x32_bf16 v[68:71], a[160:163], v[200:203], v[68:71]
v_mov_b32 v251, 0
v_exp_f32 v33, v33
v_mfma_f32_16x16x32_bf16 a[64:67], v[88:91], a[192:195], a[64:67]
ds_read_b128 a[160:163], v216 offset:53248
v_cvt_pk_bf16_f32 v84, v32, v33
v_mfma_f32_16x16x32_bf16 a[80:83], v[88:91], a[196:199], a[80:83]
v_exp_f32 v34, v34
v_mfma_f32_16x16x32_bf16 a[84:87], v[92:95], a[196:199], a[84:87]
buffer_load_dwordx4 v231, s[8:11], s32 offen offset:3072  lds
v_mfma_f32_16x16x32_bf16 a[68:71], v[92:95], a[192:195], a[68:71]
v_exp_f32 v35, v35
v_mfma_f32_16x16x32_bf16 a[72:75], v[96:99], a[192:195], a[72:75]
s_mov_b32 s90, 0x01010101
s_mov_b32 s91, 0x01010101
v_cvt_pk_bf16_f32 v85, v34, v35
v_mfma_f32_16x16x32_bf16 a[88:91], v[96:99], a[196:199], a[88:91]
v_exp_f32 v36, v36
v_mfma_f32_16x16x32_bf16 a[92:95], v[100:103], a[196:199], a[92:95]
ds_read_b64_tr_b16 a[196:197], v225 offset:32768
ds_read_b64_tr_b16 a[198:199], v225 offset:36864
v_mfma_f32_16x16x32_bf16 a[76:79], v[100:103], a[192:195], a[76:79]
v_exp_f32 v37, v37
v_mfma_f32_16x16x32_bf16 a[108:111], v[100:103], a[200:203], a[108:111]
ds_read_b64_tr_b16 a[192:193], v224 offset:32768
v_cvt_pk_bf16_f32 v86, v36, v37
v_mfma_f32_16x16x32_bf16 a[124:127], v[100:103], a[204:207], a[124:127]
v_exp_f32 v38, v38
v_mfma_f32_16x16x32_bf16 a[120:123], v[96:99], a[204:207], a[120:123]
ds_read_b64_tr_b16 a[194:195], v224 offset:36864
v_max_u32_dpp v250, v248, v248 row_ror:8 row_mask:0xf bank_mask:0xf
v_mfma_f32_16x16x32_bf16 a[104:107], v[96:99], a[200:203], a[104:107]
v_exp_f32 v39, v39
v_mfma_f32_16x16x32_bf16 a[100:103], v[92:95], a[200:203], a[100:103]
v_cvt_pk_bf16_f32 v87, v38, v39
v_max_u32_dpp v249, v250, v250 row_ror:4 row_mask:0xf bank_mask:0xf
v_mfma_f32_16x16x32_bf16 a[116:119], v[92:95], a[204:207], a[116:119]
s_add_u32 m0, s86, 32768
s_add_u32 s50, s84, 0
buffer_load_dwordx4 v240, s[68:71], s50 offen lds
v_mfma_f32_16x16x32_bf16 a[112:115], v[88:91], a[204:207], a[112:115]
ds_read_b64_tr_b16 a[204:205], v227 offset:32768
ds_read_b64_tr_b16 a[206:207], v227 offset:36864
v_mfma_f32_16x16x32_bf16 a[96:99], v[88:91], a[200:203], a[96:99]
ds_read_b64_tr_b16 a[200:201], v226 offset:32768
ds_read_b64_tr_b16 a[202:203], v226 offset:36864
v_smfmac_f32_16x16x64_bf16 a[132:135], a[208:211], v[96:103], v245
s_add_u32 m0, s86, 36864
s_add_u32 s50, s84, 589824
buffer_load_dwordx4 v240, s[68:71], s50 offen lds
s_waitcnt lgkmcnt(8)
v_mfma_f32_16x16x32_bf16 v[8:11], a[144:147], v[152:155], v[136:139]
v_exp_f32 v40, v40
v_mfma_f32_16x16x32_bf16 v[8:11], a[148:151], v[156:159], v[8:11]
v_exp_f32 v41, v41
v_mfma_f32_16x16x32_bf16 v[8:11], a[152:155], v[160:163], v[8:11]
v_cvt_pk_bf16_f32 v88, v40, v41
v_max_u32_dpp v250, v249, v249 row_ror:2 row_mask:0xf bank_mask:0xf
v_mfma_f32_16x16x32_bf16 v[8:11], a[156:159], v[164:167], v[8:11]
STUB_5:
s_cbranch_execz STUB_8
v_exp_f32 v42, v42
v_mfma_f32_16x16x32_bf16 v[16:19], a[156:159], v[180:183], v[140:143]
s_add_u32 s39, s39, 16384
v_max_u32_dpp v249, v250, v250 row_ror:1 row_mask:0xf bank_mask:0xf
v_mfma_f32_16x16x32_bf16 v[16:19], a[152:155], v[176:179], v[16:19]
v_exp_f32 v43, v43
v_mfma_f32_16x16x32_bf16 v[16:19], a[148:151], v[172:175], v[16:19]
v_cvt_pk_bf16_f32 v89, v42, v43
v_mov_b32 v250, v249
v_mfma_f32_16x16x32_bf16 v[16:19], a[144:147], v[168:171], v[16:19]
v_exp_f32 v44, v44
v_mfma_f32_16x16x32_bf16 v[24:27], a[144:147], v[184:187], v[144:147]
v_permlane16_swap_b32 v249, v250
v_max_u32 v249, v249, v250
v_mfma_f32_16x16x32_bf16 v[24:27], a[148:151], v[188:191], v[24:27]
v_exp_f32 v45, v45
v_mfma_f32_16x16x32_bf16 v[24:27], a[152:155], v[192:195], v[24:27]
s_add_u32 m0, s30, 98304
v_cvt_pk_bf16_f32 v90, v44, v45
v_mfma_f32_16x16x32_bf16 v[24:27], a[156:159], v[196:199], v[24:27]
v_exp_f32 v46, v46
v_mfma_f32_16x16x32_bf16 v[32:35], a[156:159], v[212:215], v[148:151]
ds_read_b128 a[156:159], v219 offset:57344
v_mov_b32 v250, v249
v_mfma_f32_16x16x32_bf16 v[32:35], a[152:155], v[208:211], v[32:35]
v_exp_f32 v47, v47
v_mfma_f32_16x16x32_bf16 v[32:35], a[148:151], v[204:207], v[32:35]
ds_read_b128 a[152:155], v218 offset:57344
v_cvt_pk_bf16_f32 v91, v46, v47
v_mfma_f32_16x16x32_bf16 v[32:35], a[144:147], v[200:203], v[32:35]
v_exp_f32 v48, v48
v_mfma_f32_16x16x32_bf16 a[0:3], v[72:75], a[176:179], a[0:3]
ds_read_b128 a[148:151], v217 offset:57344
ds_read_b128 a[144:147], v216 offset:57344
v_mfma_f32_16x16x32_bf16 a[16:19], v[72:75], a[180:183], a[16:19]
v_exp_f32 v49, v49
v_mfma_f32_16x16x32_bf16 a[20:23], v[76:79], a[180:183], a[20:23]
v_cvt_pk_bf16_f32 v92, v48, v49
v_permlane32_swap_b32 v249, v250
v_mfma_f32_16x16x32_bf16 a[4:7], v[76:79], a[176:179], a[4:7]
v_exp_f32 v50, v50
v_mfma_f32_16x16x32_bf16 a[8:11], v[80:83], a[176:179], a[8:11]
buffer_load_dwordx4 v232, s[12:15], s39 offen offset:0  lds
v_mfma_f32_16x16x32_bf16 a[24:27], v[80:83], a[180:183], a[24:27]
v_exp_f32 v51, v51
v_mfma_f32_16x16x32_bf16 a[28:31], v[84:87], a[180:183], a[28:31]
ds_read_b64_tr_b16 a[180:181], v221 offset:40960
v_cvt_pk_bf16_f32 v93, v50, v51
v_mfma_f32_16x16x32_bf16 a[12:15], v[84:87], a[176:179], a[12:15]
v_exp_f32 v52, v52
v_mfma_f32_16x16x32_bf16 a[44:47], v[84:87], a[184:187], a[44:47]
ds_read_b64_tr_b16 a[182:183], v221 offset:45056
ds_read_b64_tr_b16 a[176:177], v220 offset:40960
v_mfma_f32_16x16x32_bf16 a[60:63], v[84:87], a[188:191], a[60:63]
v_exp_f32 v53, v53
v_mfma_f32_16x16x32_bf16 a[56:59], v[80:83], a[188:191], a[56:59]
ds_read_b64_tr_b16 a[178:179], v220 offset:45056
v_cvt_pk_bf16_f32 v94, v52, v53
v_mfma_f32_16x16x32_bf16 a[40:43], v[80:83], a[184:187], a[40:43]
v_exp_f32 v54, v54
v_mfma_f32_16x16x32_bf16 a[36:39], v[76:79], a[184:187], a[36:39]
buffer_load_dwordx4 v233, s[12:15], s39 offen offset:1024  lds
v_mfma_f32_16x16x32_bf16 a[52:55], v[76:79], a[188:191], a[52:55]
v_exp_f32 v55, v55
v_mfma_f32_16x16x32_bf16 a[48:51], v[72:75], a[188:191], a[48:51]
ds_read_b64_tr_b16 a[188:189], v223 offset:40960
v_cvt_pk_bf16_f32 v95, v54, v55
v_mfma_f32_16x16x32_bf16 a[32:35], v[72:75], a[184:187], a[32:35]
v_exp_f32 v56, v56
v_smfmac_f32_16x16x64_bf16 a[128:131], a[208:211], v[72:79], v245
ds_read_b64_tr_b16 a[190:191], v223 offset:45056
v_mfma_f32_16x16x32_bf16 v[12:15], a[160:163], v[152:155], v[136:139]
v_exp_f32 v57, v57
v_mfma_f32_16x16x32_bf16 v[12:15], a[164:167], v[156:159], v[12:15]
v_exp_f32 v58, v58
v_mfma_f32_16x16x32_bf16 v[12:15], a[168:171], v[160:163], v[12:15]
ds_read_b64_tr_b16 a[184:185], v222 offset:40960
v_cvt_pk_bf16_f32 v96, v56, v57
v_mfma_f32_16x16x32_bf16 v[12:15], a[172:175], v[164:167], v[12:15]
v_max_u32 v249, v249, v250
v_exp_f32 v59, v59
v_mfma_f32_16x16x32_bf16 v[20:23], a[172:175], v[180:183], v[140:143]
ds_read_b64_tr_b16 a[186:187], v222 offset:45056
v_cvt_pk_bf16_f32 v97, v58, v59
v_mfma_f32_16x16x32_bf16 v[20:23], a[168:171], v[176:179], v[20:23]
v_exp_f32 v60, v60
v_mfma_f32_16x16x32_bf16 v[20:23], a[164:167], v[172:175], v[20:23]
buffer_load_dwordx4 v232, s[12:15], s39 offen offset:2048  lds
v_mfma_f32_16x16x32_bf16 v[20:23], a[160:163], v[168:171], v[20:23]
v_exp_f32 v61, v61
v_mfma_f32_16x16x32_bf16 v[28:31], a[160:163], v[184:187], v[144:147]
v_cvt_pk_bf16_f32 v98, v60, v61
v_add_u32 v251, v251, v249
v_mfma_f32_16x16x32_bf16 v[28:31], a[164:167], v[188:191], v[28:31]
v_exp_f32 v62, v62
v_mfma_f32_16x16x32_bf16 v[28:31], a[168:171], v[192:195], v[28:31]
buffer_load_dwordx4 v233, s[12:15], s39 offen offset:3072  lds
v_mfma_f32_16x16x32_bf16 v[28:31], a[172:175], v[196:199], v[28:31]
v_exp_f32 v63, v63
v_mfma_f32_16x16x32_bf16 v[36:39], a[172:175], v[212:215], v[148:151]
ds_read_b128 a[172:175], v219 offset:61440
v_cvt_pk_bf16_f32 v99, v62, v63
v_sub_u32 v248, v248, v249
v_mfma_f32_16x16x32_bf16 v[36:39], a[168:171], v[208:211], v[36:39]
v_exp_f32 v64, v64
v_mfma_f32_16x16x32_bf16 v[36:39], a[164:167], v[204:207], v[36:39]
ds_read_b128 a[168:171], v218 offset:61440
ds_read_b128 a[164:167], v217 offset:61440
v_mfma_f32_16x16x32_bf16 v[36:39], a[160:163], v[200:203], v[36:39]
v_exp_f32 v65, v65
s_waitcnt lgkmcnt(8)
v_mfma_f32_16x16x32_bf16 a[64:67], v[72:75], a[192:195], a[64:67]
ds_read_b128 a[160:163], v216 offset:61440
v_cvt_pk_bf16_f32 v100, v64, v65
v_mfma_f32_16x16x32_bf16 a[80:83], v[72:75], a[196:199], a[80:83]
v_cndmask_b32 v252, v252, v251, s[90:91]
v_exp_f32 v66, v66
v_mfma_f32_16x16x32_bf16 a[84:87], v[76:79], a[196:199], a[84:87]
s_add_u32 m0, s86, 40960
s_add_u32 s50, s84, 1179648
buffer_load_dwordx4 v240, s[68:71], s50 offen lds
v_mfma_f32_16x16x32_bf16 a[68:71], v[76:79], a[192:195], a[68:71]
v_exp_f32 v67, v67
v_mfma_f32_16x16x32_bf16 a[72:75], v[80:83], a[192:195], a[72:75]
s_lshl_b64 s[90:91], s[90:91], 1
v_cvt_pk_bf16_f32 v101, v66, v67
v_mfma_f32_16x16x32_bf16 a[88:91], v[80:83], a[196:199], a[88:91]
v_exp_f32 v68, v68
v_mfma_f32_16x16x32_bf16 a[92:95], v[84:87], a[196:199], a[92:95]
ds_read_b64_tr_b16 a[196:197], v225 offset:40960
ds_read_b64_tr_b16 a[198:199], v225 offset:45056
v_mfma_f32_16x16x32_bf16 a[76:79], v[84:87], a[192:195], a[76:79]
v_exp_f32 v69, v69
v_mfma_f32_16x16x32_bf16 a[108:111], v[84:87], a[200:203], a[108:111]
ds_read_b64_tr_b16 a[192:193], v224 offset:40960
v_cvt_pk_bf16_f32 v102, v68, v69
v_mfma_f32_16x16x32_bf16 a[124:127], v[84:87], a[204:207], a[124:127]
v_exp_f32 v70, v70
v_mfma_f32_16x16x32_bf16 a[120:123], v[80:83], a[204:207], a[120:123]
ds_read_b64_tr_b16 a[194:195], v224 offset:45056
v_max_u32_dpp v250, v248, v248 row_ror:8 row_mask:0xf bank_mask:0xf
v_mfma_f32_16x16x32_bf16 a[104:107], v[80:83], a[200:203], a[104:107]
v_exp_f32 v71, v71
v_mfma_f32_16x16x32_bf16 a[100:103], v[76:79], a[200:203], a[100:103]
v_cvt_pk_bf16_f32 v103, v70, v71
v_max_u32_dpp v249, v250, v250 row_ror:4 row_mask:0xf bank_mask:0xf
v_mfma_f32_16x16x32_bf16 a[116:119], v[76:79], a[204:207], a[116:119]
s_add_u32 m0, s86, 45056
s_add_u32 s50, s84, 1769472
buffer_load_dwordx4 v240, s[68:71], s50 offen lds
v_mfma_f32_16x16x32_bf16 a[112:115], v[72:75], a[204:207], a[112:115]
ds_read_b64_tr_b16 a[204:205], v227 offset:40960
ds_read_b64_tr_b16 a[206:207], v227 offset:45056
v_mfma_f32_16x16x32_bf16 a[96:99], v[72:75], a[200:203], a[96:99]
ds_read_b64_tr_b16 a[200:201], v226 offset:40960
ds_read_b64_tr_b16 a[202:203], v226 offset:45056
v_smfmac_f32_16x16x64_bf16 a[132:135], a[208:211], v[80:87], v245
v_max_u32_dpp v250, v249, v249 row_ror:2 row_mask:0xf bank_mask:0xf
v_mfma_f32_16x16x32_bf16 v[40:43], a[144:147], v[152:155], v[136:139]
v_exp_f32 v8, v8
v_mfma_f32_16x16x32_bf16 v[40:43], a[148:151], v[156:159], v[40:43]
v_exp_f32 v9, v9
v_mfma_f32_16x16x32_bf16 v[40:43], a[152:155], v[160:163], v[40:43]
v_cvt_pk_bf16_f32 v72, v8, v9
v_lshlrev_b32 v246, 2, v1
v_mfma_f32_16x16x32_bf16 v[40:43], a[156:159], v[164:167], v[40:43]
v_exp_f32 v10, v10
v_mfma_f32_16x16x32_bf16 v[48:51], a[156:159], v[180:183], v[140:143]
v_max_u32_dpp v249, v250, v250 row_ror:1 row_mask:0xf bank_mask:0xf
v_mov_b32 v250, v249
v_mfma_f32_16x16x32_bf16 v[48:51], a[152:155], v[176:179], v[48:51]
v_exp_f32 v11, v11
v_mfma_f32_16x16x32_bf16 v[48:51], a[148:151], v[172:175], v[48:51]
v_cvt_pk_bf16_f32 v73, v10, v11
v_permlane16_swap_b32 v249, v250
v_mfma_f32_16x16x32_bf16 v[48:51], a[144:147], v[168:171], v[48:51]
v_exp_f32 v12, v12
v_mfma_f32_16x16x32_bf16 v[56:59], a[144:147], v[184:187], v[144:147]
v_max_u32 v249, v249, v250
v_mov_b32 v250, v249
v_mfma_f32_16x16x32_bf16 v[56:59], a[148:151], v[188:191], v[56:59]
v_exp_f32 v13, v13
v_mfma_f32_16x16x32_bf16 v[56:59], a[152:155], v[192:195], v[56:59]
v_cvt_pk_bf16_f32 v74, v12, v13
v_permlane32_swap_b32 v249, v250
v_mfma_f32_16x16x32_bf16 v[56:59], a[156:159], v[196:199], v[56:59]
v_exp_f32 v14, v14
v_mfma_f32_16x16x32_bf16 v[64:67], a[156:159], v[212:215], v[148:151]
s_waitcnt vmcnt(12) lgkmcnt(0)
s_barrier
v_mfma_f32_16x16x32_bf16 v[64:67], a[152:155], v[208:211], v[64:67]
v_exp_f32 v15, v15
v_mfma_f32_16x16x32_bf16 v[64:67], a[148:151], v[204:207], v[64:67]
ds_read_b128 a[156:159], v219 offset:0
v_cvt_pk_bf16_f32 v75, v14, v15
v_mfma_f32_16x16x32_bf16 v[64:67], a[144:147], v[200:203], v[64:67]
v_exp_f32 v16, v16
v_mfma_f32_16x16x32_bf16 a[0:3], v[88:91], a[176:179], a[0:3]
ds_read_b128 a[152:155], v218 offset:0
ds_read_b128 a[148:151], v217 offset:0
v_mfma_f32_16x16x32_bf16 a[16:19], v[88:91], a[180:183], a[16:19]
v_exp_f32 v17, v17
v_mfma_f32_16x16x32_bf16 a[20:23], v[92:95], a[180:183], a[20:23]
ds_read_b128 a[144:147], v216 offset:0
v_cvt_pk_bf16_f32 v76, v16, v17
v_mfma_f32_16x16x32_bf16 a[4:7], v[92:95], a[176:179], a[4:7]
v_exp_f32 v18, v18
v_mfma_f32_16x16x32_bf16 a[8:11], v[96:99], a[176:179], a[8:11]
s_add_u32 s32, s32, 16384
s_add_u32 m0, s30, 114688
v_mfma_f32_16x16x32_bf16 a[24:27], v[96:99], a[180:183], a[24:27]
v_exp_f32 v19, v19
v_mfma_f32_16x16x32_bf16 a[28:31], v[100:103], a[180:183], a[28:31]
ds_read_b64_tr_b16 a[180:181], v221 offset:49152
v_cvt_pk_bf16_f32 v77, v18, v19
v_mfma_f32_16x16x32_bf16 a[12:15], v[100:103], a[176:179], a[12:15]
v_exp_f32 v20, v20
v_mfma_f32_16x16x32_bf16 a[44:47], v[100:103], a[184:187], a[44:47]
ds_read_b64_tr_b16 a[182:183], v221 offset:53248
ds_read_b64_tr_b16 a[176:177], v220 offset:49152
v_mfma_f32_16x16x32_bf16 a[60:63], v[100:103], a[188:191], a[60:63]
v_exp_f32 v21, v21
v_mfma_f32_16x16x32_bf16 a[56:59], v[96:99], a[188:191], a[56:59]
ds_read_b64_tr_b16 a[178:179], v220 offset:53248
v_cvt_pk_bf16_f32 v78, v20, v21
v_mfma_f32_16x16x32_bf16 a[40:43], v[96:99], a[184:187], a[40:43]
v_exp_f32 v22, v22
v_mfma_f32_16x16x32_bf16 a[36:39], v[92:95], a[184:187], a[36:39]
buffer_load_dwordx4 v228, s[8:11], s32 offen offset:0  lds
v_mfma_f32_16x16x32_bf16 a[52:55], v[92:95], a[188:191], a[52:55]
v_exp_f32 v23, v23
v_mfma_f32_16x16x32_bf16 a[48:51], v[88:91], a[188:191], a[48:51]
ds_read_b64_tr_b16 a[188:189], v223 offset:49152
v_cvt_pk_bf16_f32 v79, v22, v23
v_mfma_f32_16x16x32_bf16 a[32:35], v[88:91], a[184:187], a[32:35]
v_exp_f32 v24, v24
v_smfmac_f32_16x16x64_bf16 a[128:131], a[208:211], v[88:95], v245
ds_read_b64_tr_b16 a[190:191], v223 offset:53248
v_mfma_f32_16x16x32_bf16 v[44:47], a[160:163], v[152:155], v[136:139]
v_exp_f32 v25, v25
v_mfma_f32_16x16x32_bf16 v[44:47], a[164:167], v[156:159], v[44:47]
v_max_u32 v249, v249, v250
v_exp_f32 v26, v26
v_mfma_f32_16x16x32_bf16 v[44:47], a[168:171], v[160:163], v[44:47]
ds_read_b64_tr_b16 a[184:185], v222 offset:49152
v_cvt_pk_bf16_f32 v80, v24, v25
v_mfma_f32_16x16x32_bf16 v[44:47], a[172:175], v[164:167], v[44:47]
v_exp_f32 v27, v27
v_mfma_f32_16x16x32_bf16 v[52:55], a[172:175], v[180:183], v[140:143]
ds_read_b64_tr_b16 a[186:187], v222 offset:53248
v_cvt_pk_bf16_f32 v81, v26, v27
v_mfma_f32_16x16x32_bf16 v[52:55], a[168:171], v[176:179], v[52:55]
v_add_u32 v251, v251, v249
v_exp_f32 v28, v28
v_mfma_f32_16x16x32_bf16 v[52:55], a[164:167], v[172:175], v[52:55]
buffer_load_dwordx4 v229, s[8:11], s32 offen offset:1024  lds
v_mfma_f32_16x16x32_bf16 v[52:55], a[160:163], v[168:171], v[52:55]
v_exp_f32 v29, v29
v_mfma_f32_16x16x32_bf16 v[60:63], a[160:163], v[184:187], v[144:147]
v_cvt_pk_bf16_f32 v82, v28, v29
v_sub_u32 v248, v248, v249
v_mfma_f32_16x16x32_bf16 v[60:63], a[164:167], v[188:191], v[60:63]
v_exp_f32 v30, v30
v_mfma_f32_16x16x32_bf16 v[60:63], a[168:171], v[192:195], v[60:63]
buffer_load_dwordx4 v230, s[8:11], s32 offen offset:2048  lds
v_mfma_f32_16x16x32_bf16 v[60:63], a[172:175], v[196:199], v[60:63]
v_exp_f32 v31, v31
v_mfma_f32_16x16x32_bf16 v[68:71], a[172:175], v[212:215], v[148:151]
ds_read_b128 a[172:175], v219 offset:4096
v_cvt_pk_bf16_f32 v83, v30, v31
v_mfma_f32_16x16x32_bf16 v[68:71], a[168:171], v[208:211], v[68:71]
v_exp_f32 v32, v32
v_mfma_f32_16x16x32_bf16 v[68:71], a[164:167], v[204:207], v[68:71]
ds_read_b128 a[168:171], v218 offset:4096
ds_read_b128 a[164:167], v217 offset:4096
v_cndmask_b32 v252, v252, v251, s[90:91]
v_mfma_f32_16x16x32_bf16 v[68:71], a[160:163], v[200:203], v[68:71]
v_exp_f32 v33, v33
v_mfma_f32_16x16x32_bf16 a[64:67], v[88:91], a[192:195], a[64:67]
ds_read_b128 a[160:163], v216 offset:4096
v_cvt_pk_bf16_f32 v84, v32, v33
v_mfma_f32_16x16x32_bf16 a[80:83], v[88:91], a[196:199], a[80:83]
v_exp_f32 v34, v34
v_mfma_f32_16x16x32_bf16 a[84:87], v[92:95], a[196:199], a[84:87]
buffer_load_dwordx4 v231, s[8:11], s32 offen offset:3072  lds
v_mfma_f32_16x16x32_bf16 a[68:71], v[92:95], a[192:195], a[68:71]
s_lshl_b64 s[90:91], s[90:91], 1
v_exp_f32 v35, v35
v_mfma_f32_16x16x32_bf16 a[72:75], v[96:99], a[192:195], a[72:75]
v_cvt_pk_bf16_f32 v85, v34, v35
v_mfma_f32_16x16x32_bf16 a[88:91], v[96:99], a[196:199], a[88:91]
v_exp_f32 v36, v36
v_mfma_f32_16x16x32_bf16 a[92:95], v[100:103], a[196:199], a[92:95]
ds_read_b64_tr_b16 a[196:197], v225 offset:49152
ds_read_b64_tr_b16 a[198:199], v225 offset:53248
v_mfma_f32_16x16x32_bf16 a[76:79], v[100:103], a[192:195], a[76:79]
v_exp_f32 v37, v37
v_mfma_f32_16x16x32_bf16 a[108:111], v[100:103], a[200:203], a[108:111]
ds_read_b64_tr_b16 a[192:193], v224 offset:49152
v_cvt_pk_bf16_f32 v86, v36, v37
v_max_u32_dpp v250, v248, v248 row_ror:8 row_mask:0xf bank_mask:0xf
v_mfma_f32_16x16x32_bf16 a[124:127], v[100:103], a[204:207], a[124:127]
v_exp_f32 v38, v38
v_mfma_f32_16x16x32_bf16 a[120:123], v[96:99], a[204:207], a[120:123]
ds_read_b64_tr_b16 a[194:195], v224 offset:53248
v_max_u32_dpp v249, v250, v250 row_ror:4 row_mask:0xf bank_mask:0xf
v_mfma_f32_16x16x32_bf16 a[104:107], v[96:99], a[200:203], a[104:107]
v_exp_f32 v39, v39
v_mfma_f32_16x16x32_bf16 a[100:103], v[92:95], a[200:203], a[100:103]
v_cvt_pk_bf16_f32 v87, v38, v39
v_max_u32_dpp v250, v249, v249 row_ror:2 row_mask:0xf bank_mask:0xf
v_mfma_f32_16x16x32_bf16 a[116:119], v[92:95], a[204:207], a[116:119]
s_add_u32 m0, s86, 49152
s_add_u32 s50, s84, 2359296
buffer_load_dwordx4 v240, s[68:71], s50 offen lds
v_mfma_f32_16x16x32_bf16 a[112:115], v[88:91], a[204:207], a[112:115]
ds_read_b64_tr_b16 a[204:205], v227 offset:49152
ds_read_b64_tr_b16 a[206:207], v227 offset:53248
v_mfma_f32_16x16x32_bf16 a[96:99], v[88:91], a[200:203], a[96:99]
ds_read_b64_tr_b16 a[200:201], v226 offset:49152
ds_read_b64_tr_b16 a[202:203], v226 offset:53248
v_smfmac_f32_16x16x64_bf16 a[132:135], a[208:211], v[96:103], v245
s_add_u32 m0, s86, 53248
s_add_u32 s50, s84, 2949120
buffer_load_dwordx4 v240, s[68:71], s50 offen lds
s_waitcnt lgkmcnt(8)
v_mfma_f32_16x16x32_bf16 v[8:11], a[144:147], v[152:155], v[136:139]
v_exp_f32 v40, v40
v_mfma_f32_16x16x32_bf16 v[8:11], a[148:151], v[156:159], v[8:11]
v_exp_f32 v41, v41
v_mfma_f32_16x16x32_bf16 v[8:11], a[152:155], v[160:163], v[8:11]
v_cvt_pk_bf16_f32 v88, v40, v41
v_max_u32_dpp v249, v250, v250 row_ror:1 row_mask:0xf bank_mask:0xf
v_mfma_f32_16x16x32_bf16 v[8:11], a[156:159], v[164:167], v[8:11]
v_exp_f32 v42, v42
v_mfma_f32_16x16x32_bf16 v[16:19], a[156:159], v[180:183], v[140:143]
s_add_u32 s39, s39, 16384
v_mov_b32 v250, v249
v_mfma_f32_16x16x32_bf16 v[16:19], a[152:155], v[176:179], v[16:19]
v_exp_f32 v43, v43
v_mfma_f32_16x16x32_bf16 v[16:19], a[148:151], v[172:175], v[16:19]
v_cvt_pk_bf16_f32 v89, v42, v43
v_permlane16_swap_b32 v249, v250
v_mfma_f32_16x16x32_bf16 v[16:19], a[144:147], v[168:171], v[16:19]
v_exp_f32 v44, v44
v_mfma_f32_16x16x32_bf16 v[24:27], a[144:147], v[184:187], v[144:147]
buffer_load_dword v253, v246, s[24:27], 0 offen sc0 sc1
v_mfma_f32_16x16x32_bf16 v[24:27], a[148:151], v[188:191], v[24:27]
v_exp_f32 v45, v45
v_mfma_f32_16x16x32_bf16 v[24:27], a[152:155], v[192:195], v[24:27]
s_add_u32 m0, s30, 131072
v_cvt_pk_bf16_f32 v90, v44, v45
v_mfma_f32_16x16x32_bf16 v[24:27], a[156:159], v[196:199], v[24:27]
v_exp_f32 v46, v46
v_mfma_f32_16x16x32_bf16 v[32:35], a[156:159], v[212:215], v[148:151]
ds_read_b128 a[156:159], v219 offset:8192
v_max_u32 v249, v249, v250
v_mfma_f32_16x16x32_bf16 v[32:35], a[152:155], v[208:211], v[32:35]
v_exp_f32 v47, v47
v_mfma_f32_16x16x32_bf16 v[32:35], a[148:151], v[204:207], v[32:35]
ds_read_b128 a[152:155], v218 offset:8192
v_cvt_pk_bf16_f32 v91, v46, v47
v_mfma_f32_16x16x32_bf16 v[32:35], a[144:147], v[200:203], v[32:35]
v_exp_f32 v48, v48
v_mfma_f32_16x16x32_bf16 a[0:3], v[72:75], a[176:179], a[0:3]
ds_read_b128 a[148:151], v217 offset:8192
ds_read_b128 a[144:147], v216 offset:8192
v_mfma_f32_16x16x32_bf16 a[16:19], v[72:75], a[180:183], a[16:19]
v_exp_f32 v49, v49
v_mfma_f32_16x16x32_bf16 a[20:23], v[76:79], a[180:183], a[20:23]
v_cvt_pk_bf16_f32 v92, v48, v49
v_mov_b32 v250, v249
v_mfma_f32_16x16x32_bf16 a[4:7], v[76:79], a[176:179], a[4:7]
v_exp_f32 v50, v50
v_mfma_f32_16x16x32_bf16 a[8:11], v[80:83], a[176:179], a[8:11]
buffer_load_dwordx4 v232, s[12:15], s39 offen offset:0  lds
v_mfma_f32_16x16x32_bf16 a[24:27], v[80:83], a[180:183], a[24:27]
v_exp_f32 v51, v51
v_mfma_f32_16x16x32_bf16 a[28:31], v[84:87], a[180:183], a[28:31]
ds_read_b64_tr_b16 a[180:181], v221 offset:57344
v_cvt_pk_bf16_f32 v93, v50, v51
v_mfma_f32_16x16x32_bf16 a[12:15], v[84:87], a[176:179], a[12:15]
v_exp_f32 v52, v52
v_mfma_f32_16x16x32_bf16 a[44:47], v[84:87], a[184:187], a[44:47]
ds_read_b64_tr_b16 a[182:183], v221 offset:61440
ds_read_b64_tr_b16 a[176:177], v220 offset:57344
v_mfma_f32_16x16x32_bf16 a[60:63], v[84:87], a[188:191], a[60:63]
v_exp_f32 v53, v53
v_mfma_f32_16x16x32_bf16 a[56:59], v[80:83], a[188:191], a[56:59]
ds_read_b64_tr_b16 a[178:179], v220 offset:61440
v_cvt_pk_bf16_f32 v94, v52, v53
v_mfma_f32_16x16x32_bf16 a[40:43], v[80:83], a[184:187], a[40:43]
v_permlane32_swap_b32 v249, v250
v_exp_f32 v54, v54
v_mfma_f32_16x16x32_bf16 a[36:39], v[76:79], a[184:187], a[36:39]
buffer_load_dwordx4 v233, s[12:15], s39 offen offset:1024  lds
v_mfma_f32_16x16x32_bf16 a[52:55], v[76:79], a[188:191], a[52:55]
v_exp_f32 v55, v55
v_mfma_f32_16x16x32_bf16 a[48:51], v[72:75], a[188:191], a[48:51]
ds_read_b64_tr_b16 a[188:189], v223 offset:57344
v_cvt_pk_bf16_f32 v95, v54, v55
v_mfma_f32_16x16x32_bf16 a[32:35], v[72:75], a[184:187], a[32:35]
v_max_u32 v249, v249, v250
v_exp_f32 v56, v56
v_smfmac_f32_16x16x64_bf16 a[128:131], a[208:211], v[72:79], v245
ds_read_b64_tr_b16 a[190:191], v223 offset:61440
v_mfma_f32_16x16x32_bf16 v[12:15], a[160:163], v[152:155], v[136:139]
v_exp_f32 v57, v57
v_mfma_f32_16x16x32_bf16 v[12:15], a[164:167], v[156:159], v[12:15]
v_exp_f32 v58, v58
v_mfma_f32_16x16x32_bf16 v[12:15], a[168:171], v[160:163], v[12:15]
ds_read_b64_tr_b16 a[184:185], v222 offset:57344
v_cvt_pk_bf16_f32 v96, v56, v57
v_mfma_f32_16x16x32_bf16 v[12:15], a[172:175], v[164:167], v[12:15]
v_add_u32 v251, v251, v249
v_exp_f32 v59, v59
v_mfma_f32_16x16x32_bf16 v[20:23], a[172:175], v[180:183], v[140:143]
ds_read_b64_tr_b16 a[186:187], v222 offset:61440
v_cvt_pk_bf16_f32 v97, v58, v59
v_mfma_f32_16x16x32_bf16 v[20:23], a[168:171], v[176:179], v[20:23]
v_exp_f32 v60, v60
v_mfma_f32_16x16x32_bf16 v[20:23], a[164:167], v[172:175], v[20:23]
buffer_load_dwordx4 v232, s[12:15], s39 offen offset:2048  lds
v_mfma_f32_16x16x32_bf16 v[20:23], a[160:163], v[168:171], v[20:23]
v_exp_f32 v61, v61
v_mfma_f32_16x16x32_bf16 v[28:31], a[160:163], v[184:187], v[144:147]
v_cvt_pk_bf16_f32 v98, v60, v61
v_sub_u32 v248, v248, v249
v_mfma_f32_16x16x32_bf16 v[28:31], a[164:167], v[188:191], v[28:31]
v_exp_f32 v62, v62
v_mfma_f32_16x16x32_bf16 v[28:31], a[168:171], v[192:195], v[28:31]
buffer_load_dwordx4 v233, s[12:15], s39 offen offset:3072  lds
v_mfma_f32_16x16x32_bf16 v[28:31], a[172:175], v[196:199], v[28:31]
v_exp_f32 v63, v63
v_mfma_f32_16x16x32_bf16 v[36:39], a[172:175], v[212:215], v[148:151]
ds_read_b128 a[172:175], v219 offset:12288
v_cvt_pk_bf16_f32 v99, v62, v63
v_cndmask_b32 v252, v252, v251, s[90:91]
v_mfma_f32_16x16x32_bf16 v[36:39], a[168:171], v[208:211], v[36:39]
v_exp_f32 v64, v64
v_mfma_f32_16x16x32_bf16 v[36:39], a[164:167], v[204:207], v[36:39]
ds_read_b128 a[168:171], v218 offset:12288
ds_read_b128 a[164:167], v217 offset:12288
v_mfma_f32_16x16x32_bf16 v[36:39], a[160:163], v[200:203], v[36:39]
v_exp_f32 v65, v65
s_waitcnt lgkmcnt(8)
v_mfma_f32_16x16x32_bf16 a[64:67], v[72:75], a[192:195], a[64:67]
ds_read_b128 a[160:163], v216 offset:12288
v_cvt_pk_bf16_f32 v100, v64, v65
v_mfma_f32_16x16x32_bf16 a[80:83], v[72:75], a[196:199], a[80:83]
s_lshl_b64 s[90:91], s[90:91], 1
v_exp_f32 v66, v66
v_mfma_f32_16x16x32_bf16 a[84:87], v[76:79], a[196:199], a[84:87]
s_add_u32 m0, s86, 57344
s_add_u32 s50, s84, 3538944
buffer_load_dwordx4 v240, s[68:71], s50 offen lds
v_mfma_f32_16x16x32_bf16 a[68:71], v[76:79], a[192:195], a[68:71]
v_exp_f32 v67, v67
v_mfma_f32_16x16x32_bf16 a[72:75], v[80:83], a[192:195], a[72:75]
v_cvt_pk_bf16_f32 v101, v66, v67
v_max_u32_dpp v250, v248, v248 row_ror:8 row_mask:0xf bank_mask:0xf
v_mfma_f32_16x16x32_bf16 a[88:91], v[80:83], a[196:199], a[88:91]
v_exp_f32 v68, v68
v_mfma_f32_16x16x32_bf16 a[92:95], v[84:87], a[196:199], a[92:95]
ds_read_b64_tr_b16 a[196:197], v225 offset:57344
ds_read_b64_tr_b16 a[198:199], v225 offset:61440
v_mfma_f32_16x16x32_bf16 a[76:79], v[84:87], a[192:195], a[76:79]
v_exp_f32 v69, v69
v_mfma_f32_16x16x32_bf16 a[108:111], v[84:87], a[200:203], a[108:111]
ds_read_b64_tr_b16 a[192:193], v224 offset:57344
v_cvt_pk_bf16_f32 v102, v68, v69
v_mfma_f32_16x16x32_bf16 a[124:127], v[84:87], a[204:207], a[124:127]
v_exp_f32 v70, v70
v_mfma_f32_16x16x32_bf16 a[120:123], v[80:83], a[204:207], a[120:123]
ds_read_b64_tr_b16 a[194:195], v224 offset:61440
v_max_u32_dpp v249, v250, v250 row_ror:4 row_mask:0xf bank_mask:0xf
v_mfma_f32_16x16x32_bf16 a[104:107], v[80:83], a[200:203], a[104:107]
v_exp_f32 v71, v71
v_mfma_f32_16x16x32_bf16 a[100:103], v[76:79], a[200:203], a[100:103]
v_cvt_pk_bf16_f32 v103, v70, v71
v_max_u32_dpp v250, v249, v249 row_ror:2 row_mask:0xf bank_mask:0xf
v_mfma_f32_16x16x32_bf16 a[116:119], v[76:79], a[204:207], a[116:119]
s_add_u32 m0, s86, 61440
s_add_u32 s50, s84, 4128768
buffer_load_dwordx4 v240, s[68:71], s50 offen lds
v_mfma_f32_16x16x32_bf16 a[112:115], v[72:75], a[204:207], a[112:115]
ds_read_b64_tr_b16 a[204:205], v227 offset:57344
ds_read_b64_tr_b16 a[206:207], v227 offset:61440
v_mfma_f32_16x16x32_bf16 a[96:99], v[72:75], a[200:203], a[96:99]
ds_read_b64_tr_b16 a[200:201], v226 offset:57344
ds_read_b64_tr_b16 a[202:203], v226 offset:61440
v_smfmac_f32_16x16x64_bf16 a[132:135], a[208:211], v[80:87], v245
v_max_u32_dpp v249, v250, v250 row_ror:1 row_mask:0xf bank_mask:0xf
v_mfma_f32_16x16x32_bf16 v[40:43], a[144:147], v[152:155], v[136:139]
v_exp_f32 v8, v8
v_mfma_f32_16x16x32_bf16 v[40:43], a[148:151], v[156:159], v[40:43]
v_exp_f32 v9, v9
v_mfma_f32_16x16x32_bf16 v[40:43], a[152:155], v[160:163], v[40:43]
v_cvt_pk_bf16_f32 v72, v8, v9
v_mov_b32 v250, v249
v_mfma_f32_16x16x32_bf16 v[40:43], a[156:159], v[164:167], v[40:43]
v_exp_f32 v10, v10
v_mfma_f32_16x16x32_bf16 v[48:51], a[156:159], v[180:183], v[140:143]
v_permlane16_swap_b32 v249, v250
v_max_u32 v249, v249, v250
v_mfma_f32_16x16x32_bf16 v[48:51], a[152:155], v[176:179], v[48:51]
v_exp_f32 v11, v11
v_mfma_f32_16x16x32_bf16 v[48:51], a[148:151], v[172:175], v[48:51]
v_cvt_pk_bf16_f32 v73, v10, v11
v_mov_b32 v250, v249
v_mfma_f32_16x16x32_bf16 v[48:51], a[144:147], v[168:171], v[48:51]
v_exp_f32 v12, v12
v_mfma_f32_16x16x32_bf16 v[56:59], a[144:147], v[184:187], v[144:147]
v_permlane32_swap_b32 v249, v250
v_max_u32 v249, v249, v250
v_mfma_f32_16x16x32_bf16 v[56:59], a[148:151], v[188:191], v[56:59]
v_exp_f32 v13, v13
v_mfma_f32_16x16x32_bf16 v[56:59], a[152:155], v[192:195], v[56:59]
v_cvt_pk_bf16_f32 v74, v12, v13
v_add_u32 v251, v251, v249
v_mfma_f32_16x16x32_bf16 v[56:59], a[156:159], v[196:199], v[56:59]
v_exp_f32 v14, v14
v_mfma_f32_16x16x32_bf16 v[64:67], a[156:159], v[212:215], v[148:151]
s_waitcnt vmcnt(13) lgkmcnt(0)
s_barrier
v_mfma_f32_16x16x32_bf16 v[64:67], a[152:155], v[208:211], v[64:67]
v_exp_f32 v15, v15
v_mfma_f32_16x16x32_bf16 v[64:67], a[148:151], v[204:207], v[64:67]
ds_read_b128 a[156:159], v219 offset:16384
v_cvt_pk_bf16_f32 v75, v14, v15
v_mfma_f32_16x16x32_bf16 v[64:67], a[144:147], v[200:203], v[64:67]
v_exp_f32 v16, v16
v_mfma_f32_16x16x32_bf16 a[0:3], v[88:91], a[176:179], a[0:3]
ds_read_b128 a[152:155], v218 offset:16384
ds_read_b128 a[148:151], v217 offset:16384
v_mfma_f32_16x16x32_bf16 a[16:19], v[88:91], a[180:183], a[16:19]
v_exp_f32 v17, v17
v_mfma_f32_16x16x32_bf16 a[20:23], v[92:95], a[180:183], a[20:23]
ds_read_b128 a[144:147], v216 offset:16384
v_cvt_pk_bf16_f32 v76, v16, v17
v_mfma_f32_16x16x32_bf16 a[4:7], v[92:95], a[176:179], a[4:7]
v_exp_f32 v18, v18
v_mfma_f32_16x16x32_bf16 a[8:11], v[96:99], a[176:179], a[8:11]
s_add_u32 s32, s32, 16384
v_sub_u32 v248, v248, v249
v_mfma_f32_16x16x32_bf16 a[24:27], v[96:99], a[180:183], a[24:27]
v_exp_f32 v19, v19
v_mfma_f32_16x16x32_bf16 a[28:31], v[100:103], a[180:183], a[28:31]
ds_read_b64_tr_b16 a[180:181], v221 offset:0
v_cvt_pk_bf16_f32 v77, v18, v19
v_mfma_f32_16x16x32_bf16 a[12:15], v[100:103], a[176:179], a[12:15]
v_exp_f32 v20, v20
v_mfma_f32_16x16x32_bf16 a[44:47], v[100:103], a[184:187], a[44:47]
ds_read_b64_tr_b16 a[182:183], v221 offset:4096
ds_read_b64_tr_b16 a[176:177], v220 offset:0
v_mfma_f32_16x16x32_bf16 a[60:63], v[100:103], a[188:191], a[60:63]
v_exp_f32 v21, v21
v_mfma_f32_16x16x32_bf16 a[56:59], v[96:99], a[188:191], a[56:59]
ds_read_b64_tr_b16 a[178:179], v220 offset:4096
v_cvt_pk_bf16_f32 v78, v20, v21
v_mfma_f32_16x16x32_bf16 a[40:43], v[96:99], a[184:187], a[40:43]
v_exp_f32 v22, v22
v_mfma_f32_16x16x32_bf16 a[36:39], v[92:95], a[184:187], a[36:39]
s_add_u32 m0, s30, 65536
v_cndmask_b32 v252, v252, v251, s[90:91]
v_mfma_f32_16x16x32_bf16 a[52:55], v[92:95], a[188:191], a[52:55]
v_exp_f32 v23, v23
v_mfma_f32_16x16x32_bf16 a[48:51], v[88:91], a[188:191], a[48:51]
ds_read_b64_tr_b16 a[188:189], v223 offset:0
v_cvt_pk_bf16_f32 v79, v22, v23
v_mfma_f32_16x16x32_bf16 a[32:35], v[88:91], a[184:187], a[32:35]
v_exp_f32 v24, v24
v_smfmac_f32_16x16x64_bf16 a[128:131], a[208:211], v[88:95], v245
ds_read_b64_tr_b16 a[190:191], v223 offset:4096
v_mfma_f32_16x16x32_bf16 v[44:47], a[160:163], v[152:155], v[136:139]
v_exp_f32 v25, v25
v_mfma_f32_16x16x32_bf16 v[44:47], a[164:167], v[156:159], v[44:47]
v_exp_f32 v26, v26
v_mfma_f32_16x16x32_bf16 v[44:47], a[168:171], v[160:163], v[44:47]
ds_read_b64_tr_b16 a[184:185], v222 offset:0
v_cvt_pk_bf16_f32 v80, v24, v25
v_mfma_f32_16x16x32_bf16 v[44:47], a[172:175], v[164:167], v[44:47]
v_exp_f32 v27, v27
v_mfma_f32_16x16x32_bf16 v[52:55], a[172:175], v[180:183], v[140:143]
ds_read_b64_tr_b16 a[186:187], v222 offset:4096
v_cvt_pk_bf16_f32 v81, v26, v27
v_mfma_f32_16x16x32_bf16 v[52:55], a[168:171], v[176:179], v[52:55]
v_exp_f32 v28, v28
v_mfma_f32_16x16x32_bf16 v[52:55], a[164:167], v[172:175], v[52:55]
buffer_load_dwordx4 v228, s[8:11], s32 offen offset:0  lds
v_mfma_f32_16x16x32_bf16 v[52:55], a[160:163], v[168:171], v[52:55]
STUB_6:
s_cbranch_execz STUB_9
v_exp_f32 v29, v29
v_mfma_f32_16x16x32_bf16 v[60:63], a[160:163], v[184:187], v[144:147]
s_lshl_b64 s[90:91], s[90:91], 1
v_cvt_pk_bf16_f32 v82, v28, v29
v_mfma_f32_16x16x32_bf16 v[60:63], a[164:167], v[188:191], v[60:63]
v_exp_f32 v30, v30
v_mfma_f32_16x16x32_bf16 v[60:63], a[168:171], v[192:195], v[60:63]
buffer_load_dwordx4 v229, s[8:11], s32 offen offset:1024  lds
v_mfma_f32_16x16x32_bf16 v[60:63], a[172:175], v[196:199], v[60:63]
v_exp_f32 v31, v31
v_mfma_f32_16x16x32_bf16 v[68:71], a[172:175], v[212:215], v[148:151]
ds_read_b128 a[172:175], v219 offset:20480
v_cvt_pk_bf16_f32 v83, v30, v31
v_mfma_f32_16x16x32_bf16 v[68:71], a[168:171], v[208:211], v[68:71]
v_exp_f32 v32, v32
v_mfma_f32_16x16x32_bf16 v[68:71], a[164:167], v[204:207], v[68:71]
ds_read_b128 a[168:171], v218 offset:20480
ds_read_b128 a[164:167], v217 offset:20480
v_mfma_f32_16x16x32_bf16 v[68:71], a[160:163], v[200:203], v[68:71]
v_exp_f32 v33, v33
v_mfma_f32_16x16x32_bf16 a[64:67], v[88:91], a[192:195], a[64:67]
ds_read_b128 a[160:163], v216 offset:20480
v_cvt_pk_bf16_f32 v84, v32, v33
v_mfma_f32_16x16x32_bf16 a[80:83], v[88:91], a[196:199], a[80:83]
v_exp_f32 v34, v34
v_mfma_f32_16x16x32_bf16 a[84:87], v[92:95], a[196:199], a[84:87]
buffer_load_dwordx4 v230, s[8:11], s32 offen offset:2048  lds
v_mfma_f32_16x16x32_bf16 a[68:71], v[92:95], a[192:195], a[68:71]
v_max_u32_dpp v250, v248, v248 row_ror:8 row_mask:0xf bank_mask:0xf
v_exp_f32 v35, v35
v_mfma_f32_16x16x32_bf16 a[72:75], v[96:99], a[192:195], a[72:75]
v_cvt_pk_bf16_f32 v85, v34, v35
v_mfma_f32_16x16x32_bf16 a[88:91], v[96:99], a[196:199], a[88:91]
v_exp_f32 v36, v36
v_mfma_f32_16x16x32_bf16 a[92:95], v[100:103], a[196:199], a[92:95]
ds_read_b64_tr_b16 a[196:197], v225 offset:0
ds_read_b64_tr_b16 a[198:199], v225 offset:4096
v_mfma_f32_16x16x32_bf16 a[76:79], v[100:103], a[192:195], a[76:79]
v_max_u32_dpp v249, v250, v250 row_ror:4 row_mask:0xf bank_mask:0xf
v_exp_f32 v37, v37
v_mfma_f32_16x16x32_bf16 a[108:111], v[100:103], a[200:203], a[108:111]
ds_read_b64_tr_b16 a[192:193], v224 offset:0
v_cvt_pk_bf16_f32 v86, v36, v37
v_mfma_f32_16x16x32_bf16 a[124:127], v[100:103], a[204:207], a[124:127]
v_exp_f32 v38, v38
v_mfma_f32_16x16x32_bf16 a[120:123], v[96:99], a[204:207], a[120:123]
ds_read_b64_tr_b16 a[194:195], v224 offset:4096
v_max_u32_dpp v250, v249, v249 row_ror:2 row_mask:0xf bank_mask:0xf
v_mfma_f32_16x16x32_bf16 a[104:107], v[96:99], a[200:203], a[104:107]
v_exp_f32 v39, v39
v_mfma_f32_16x16x32_bf16 a[100:103], v[92:95], a[200:203], a[100:103]
v_cvt_pk_bf16_f32 v87, v38, v39
v_max_u32_dpp v249, v250, v250 row_ror:1 row_mask:0xf bank_mask:0xf
v_mfma_f32_16x16x32_bf16 a[116:119], v[92:95], a[204:207], a[116:119]
buffer_load_dwordx4 v231, s[8:11], s32 offen offset:3072  lds
v_mfma_f32_16x16x32_bf16 a[112:115], v[88:91], a[204:207], a[112:115]
ds_read_b64_tr_b16 a[204:205], v227 offset:0
ds_read_b64_tr_b16 a[206:207], v227 offset:4096
v_mfma_f32_16x16x32_bf16 a[96:99], v[88:91], a[200:203], a[96:99]
ds_read_b64_tr_b16 a[200:201], v226 offset:0
ds_read_b64_tr_b16 a[202:203], v226 offset:4096
v_smfmac_f32_16x16x64_bf16 a[132:135], a[208:211], v[96:103], v245
v_mov_b32 v250, v249
s_waitcnt lgkmcnt(8)
v_mfma_f32_16x16x32_bf16 v[8:11], a[144:147], v[152:155], v[136:139]
v_exp_f32 v40, v40
v_mfma_f32_16x16x32_bf16 v[8:11], a[148:151], v[156:159], v[8:11]
v_exp_f32 v41, v41
v_mfma_f32_16x16x32_bf16 v[8:11], a[152:155], v[160:163], v[8:11]
v_cvt_pk_bf16_f32 v88, v40, v41
v_permlane16_swap_b32 v249, v250
v_mfma_f32_16x16x32_bf16 v[8:11], a[156:159], v[164:167], v[8:11]
v_exp_f32 v42, v42
v_mfma_f32_16x16x32_bf16 v[16:19], a[156:159], v[180:183], v[140:143]
s_add_u32 s39, s39, 16384
v_max_u32 v249, v249, v250
v_mfma_f32_16x16x32_bf16 v[16:19], a[152:155], v[176:179], v[16:19]
v_exp_f32 v43, v43
v_mfma_f32_16x16x32_bf16 v[16:19], a[148:151], v[172:175], v[16:19]
v_cvt_pk_bf16_f32 v89, v42, v43
v_mov_b32 v250, v249
v_mfma_f32_16x16x32_bf16 v[16:19], a[144:147], v[168:171], v[16:19]
v_exp_f32 v44, v44
v_mfma_f32_16x16x32_bf16 v[24:27], a[144:147], v[184:187], v[144:147]
v_permlane32_swap_b32 v249, v250
v_max_u32 v249, v249, v250
v_mfma_f32_16x16x32_bf16 v[24:27], a[148:151], v[188:191], v[24:27]
v_exp_f32 v45, v45
v_mfma_f32_16x16x32_bf16 v[24:27], a[152:155], v[192:195], v[24:27]
v_cvt_pk_bf16_f32 v90, v44, v45
v_add_u32 v251, v251, v249
v_mfma_f32_16x16x32_bf16 v[24:27], a[156:159], v[196:199], v[24:27]
v_exp_f32 v46, v46
v_mfma_f32_16x16x32_bf16 v[32:35], a[156:159], v[212:215], v[148:151]
ds_read_b128 a[156:159], v219 offset:24576
s_add_u32 m0, s30, 147456
v_mfma_f32_16x16x32_bf16 v[32:35], a[152:155], v[208:211], v[32:35]
v_exp_f32 v47, v47
v_mfma_f32_16x16x32_bf16 v[32:35], a[148:151], v[204:207], v[32:35]
ds_read_b128 a[152:155], v218 offset:24576
v_cvt_pk_bf16_f32 v91, v46, v47
v_mfma_f32_16x16x32_bf16 v[32:35], a[144:147], v[200:203], v[32:35]
v_exp_f32 v48, v48
v_mfma_f32_16x16x32_bf16 a[0:3], v[72:75], a[176:179], a[0:3]
ds_read_b128 a[148:151], v217 offset:24576
ds_read_b128 a[144:147], v216 offset:24576
v_mfma_f32_16x16x32_bf16 a[16:19], v[72:75], a[180:183], a[16:19]
v_exp_f32 v49, v49
v_mfma_f32_16x16x32_bf16 a[20:23], v[76:79], a[180:183], a[20:23]
v_cvt_pk_bf16_f32 v92, v48, v49
v_sub_u32 v248, v248, v249
v_mfma_f32_16x16x32_bf16 a[4:7], v[76:79], a[176:179], a[4:7]
v_exp_f32 v50, v50
v_mfma_f32_16x16x32_bf16 a[8:11], v[80:83], a[176:179], a[8:11]
v_cndmask_b32 v252, v252, v251, s[90:91]
v_mfma_f32_16x16x32_bf16 a[24:27], v[80:83], a[180:183], a[24:27]
v_exp_f32 v51, v51
v_mfma_f32_16x16x32_bf16 a[28:31], v[84:87], a[180:183], a[28:31]
ds_read_b64_tr_b16 a[180:181], v221 offset:8192
v_cvt_pk_bf16_f32 v93, v50, v51
v_mfma_f32_16x16x32_bf16 a[12:15], v[84:87], a[176:179], a[12:15]
v_exp_f32 v52, v52
v_mfma_f32_16x16x32_bf16 a[44:47], v[84:87], a[184:187], a[44:47]
ds_read_b64_tr_b16 a[182:183], v221 offset:12288
ds_read_b64_tr_b16 a[176:177], v220 offset:8192
v_mfma_f32_16x16x32_bf16 a[60:63], v[84:87], a[188:191], a[60:63]
v_exp_f32 v53, v53
v_mfma_f32_16x16x32_bf16 a[56:59], v[80:83], a[188:191], a[56:59]
ds_read_b64_tr_b16 a[178:179], v220 offset:12288
v_cvt_pk_bf16_f32 v94, v52, v53
v_mfma_f32_16x16x32_bf16 a[40:43], v[80:83], a[184:187], a[40:43]
v_exp_f32 v54, v54
v_mfma_f32_16x16x32_bf16 a[36:39], v[76:79], a[184:187], a[36:39]
buffer_load_dwordx4 v232, s[12:15], s39 offen offset:0  lds
v_mfma_f32_16x16x32_bf16 a[52:55], v[76:79], a[188:191], a[52:55]
v_exp_f32 v55, v55
v_mfma_f32_16x16x32_bf16 a[48:51], v[72:75], a[188:191], a[48:51]
ds_read_b64_tr_b16 a[188:189], v223 offset:8192
v_cvt_pk_bf16_f32 v95, v54, v55
v_mfma_f32_16x16x32_bf16 a[32:35], v[72:75], a[184:187], a[32:35]
v_exp_f32 v56, v56
v_smfmac_f32_16x16x64_bf16 a[128:131], a[208:211], v[72:79], v245
ds_read_b64_tr_b16 a[190:191], v223 offset:12288
v_mfma_f32_16x16x32_bf16 v[12:15], a[160:163], v[152:155], v[136:139]
v_exp_f32 v57, v57
v_mfma_f32_16x16x32_bf16 v[12:15], a[164:167], v[156:159], v[12:15]
v_exp_f32 v58, v58
v_mfma_f32_16x16x32_bf16 v[12:15], a[168:171], v[160:163], v[12:15]
ds_read_b64_tr_b16 a[184:185], v222 offset:8192
v_cvt_pk_bf16_f32 v96, v56, v57
v_mfma_f32_16x16x32_bf16 v[12:15], a[172:175], v[164:167], v[12:15]
v_exp_f32 v59, v59
v_mfma_f32_16x16x32_bf16 v[20:23], a[172:175], v[180:183], v[140:143]
ds_read_b64_tr_b16 a[186:187], v222 offset:12288
v_cvt_pk_bf16_f32 v97, v58, v59
v_mfma_f32_16x16x32_bf16 v[20:23], a[168:171], v[176:179], v[20:23]
v_exp_f32 v60, v60
v_mfma_f32_16x16x32_bf16 v[20:23], a[164:167], v[172:175], v[20:23]
buffer_load_dwordx4 v233, s[12:15], s39 offen offset:1024  lds
v_mfma_f32_16x16x32_bf16 v[20:23], a[160:163], v[168:171], v[20:23]
v_exp_f32 v61, v61
v_mfma_f32_16x16x32_bf16 v[28:31], a[160:163], v[184:187], v[144:147]
s_lshl_b64 s[90:91], s[90:91], 1
v_cvt_pk_bf16_f32 v98, v60, v61
v_mfma_f32_16x16x32_bf16 v[28:31], a[164:167], v[188:191], v[28:31]
v_exp_f32 v62, v62
v_mfma_f32_16x16x32_bf16 v[28:31], a[168:171], v[192:195], v[28:31]
buffer_load_dwordx4 v232, s[12:15], s39 offen offset:2048  lds
v_mfma_f32_16x16x32_bf16 v[28:31], a[172:175], v[196:199], v[28:31]
v_exp_f32 v63, v63
v_mfma_f32_16x16x32_bf16 v[36:39], a[172:175], v[212:215], v[148:151]
ds_read_b128 a[172:175], v219 offset:28672
v_cvt_pk_bf16_f32 v99, v62, v63
v_mfma_f32_16x16x32_bf16 v[36:39], a[168:171], v[208:211], v[36:39]
v_exp_f32 v64, v64
v_mfma_f32_16x16x32_bf16 v[36:39], a[164:167], v[204:207], v[36:39]
ds_read_b128 a[168:171], v218 offset:28672
ds_read_b128 a[164:167], v217 offset:28672
v_mfma_f32_16x16x32_bf16 v[36:39], a[160:163], v[200:203], v[36:39]
v_exp_f32 v65, v65
s_waitcnt lgkmcnt(8)
v_mfma_f32_16x16x32_bf16 a[64:67], v[72:75], a[192:195], a[64:67]
ds_read_b128 a[160:163], v216 offset:28672
v_cvt_pk_bf16_f32 v100, v64, v65
v_max_u32_dpp v250, v248, v248 row_ror:8 row_mask:0xf bank_mask:0xf
v_mfma_f32_16x16x32_bf16 a[80:83], v[72:75], a[196:199], a[80:83]
v_exp_f32 v66, v66
v_mfma_f32_16x16x32_bf16 a[84:87], v[76:79], a[196:199], a[84:87]
buffer_load_dwordx4 v233, s[12:15], s39 offen offset:3072  lds
v_mfma_f32_16x16x32_bf16 a[68:71], v[76:79], a[192:195], a[68:71]
v_exp_f32 v67, v67
v_mfma_f32_16x16x32_bf16 a[72:75], v[80:83], a[192:195], a[72:75]
v_cvt_pk_bf16_f32 v101, v66, v67
v_max_u32_dpp v249, v250, v250 row_ror:4 row_mask:0xf bank_mask:0xf
v_mfma_f32_16x16x32_bf16 a[88:91], v[80:83], a[196:199], a[88:91]
v_exp_f32 v68, v68
v_mfma_f32_16x16x32_bf16 a[92:95], v[84:87], a[196:199], a[92:95]
ds_read_b64_tr_b16 a[196:197], v225 offset:8192
ds_read_b64_tr_b16 a[198:199], v225 offset:12288
v_mfma_f32_16x16x32_bf16 a[76:79], v[84:87], a[192:195], a[76:79]
v_exp_f32 v69, v69
v_mfma_f32_16x16x32_bf16 a[108:111], v[84:87], a[200:203], a[108:111]
ds_read_b64_tr_b16 a[192:193], v224 offset:8192
v_cvt_pk_bf16_f32 v102, v68, v69
v_mfma_f32_16x16x32_bf16 a[124:127], v[84:87], a[204:207], a[124:127]
v_exp_f32 v70, v70
v_mfma_f32_16x16x32_bf16 a[120:123], v[80:83], a[204:207], a[120:123]
ds_read_b64_tr_b16 a[194:195], v224 offset:12288
v_max_u32_dpp v250, v249, v249 row_ror:2 row_mask:0xf bank_mask:0xf
v_mfma_f32_16x16x32_bf16 a[104:107], v[80:83], a[200:203], a[104:107]
v_exp_f32 v71, v71
v_mfma_f32_16x16x32_bf16 a[100:103], v[76:79], a[200:203], a[100:103]
v_cvt_pk_bf16_f32 v103, v70, v71
v_max_u32_dpp v249, v250, v250 row_ror:1 row_mask:0xf bank_mask:0xf
v_mfma_f32_16x16x32_bf16 a[116:119], v[76:79], a[204:207], a[116:119]
v_mov_b32 v250, v249
v_mfma_f32_16x16x32_bf16 a[112:115], v[72:75], a[204:207], a[112:115]
ds_read_b64_tr_b16 a[204:205], v227 offset:8192
ds_read_b64_tr_b16 a[206:207], v227 offset:12288
v_mfma_f32_16x16x32_bf16 a[96:99], v[72:75], a[200:203], a[96:99]
ds_read_b64_tr_b16 a[200:201], v226 offset:8192
ds_read_b64_tr_b16 a[202:203], v226 offset:12288
v_smfmac_f32_16x16x64_bf16 a[132:135], a[208:211], v[80:87], v245
v_permlane16_swap_b32 v249, v250
v_mfma_f32_16x16x32_bf16 v[40:43], a[144:147], v[152:155], v[136:139]
v_exp_f32 v8, v8
v_mfma_f32_16x16x32_bf16 v[40:43], a[148:151], v[156:159], v[40:43]
v_exp_f32 v9, v9
v_mfma_f32_16x16x32_bf16 v[40:43], a[152:155], v[160:163], v[40:43]
v_cvt_pk_bf16_f32 v72, v8, v9
v_max_u32 v249, v249, v250
v_mfma_f32_16x16x32_bf16 v[40:43], a[156:159], v[164:167], v[40:43]
v_exp_f32 v10, v10
v_mfma_f32_16x16x32_bf16 v[48:51], a[156:159], v[180:183], v[140:143]
v_mov_b32 v250, v249
v_mfma_f32_16x16x32_bf16 v[48:51], a[152:155], v[176:179], v[48:51]
v_exp_f32 v11, v11
v_mfma_f32_16x16x32_bf16 v[48:51], a[148:151], v[172:175], v[48:51]
v_cvt_pk_bf16_f32 v73, v10, v11
v_permlane32_swap_b32 v249, v250
v_mfma_f32_16x16x32_bf16 v[48:51], a[144:147], v[168:171], v[48:51]
v_exp_f32 v12, v12
v_mfma_f32_16x16x32_bf16 v[56:59], a[144:147], v[184:187], v[144:147]
v_max_u32 v249, v249, v250
v_add_u32 v251, v251, v249
v_mfma_f32_16x16x32_bf16 v[56:59], a[148:151], v[188:191], v[56:59]
v_exp_f32 v13, v13
v_mfma_f32_16x16x32_bf16 v[56:59], a[152:155], v[192:195], v[56:59]
v_cvt_pk_bf16_f32 v74, v12, v13
v_sub_u32 v248, v248, v249
v_mfma_f32_16x16x32_bf16 v[56:59], a[156:159], v[196:199], v[56:59]
v_exp_f32 v14, v14
v_mfma_f32_16x16x32_bf16 v[64:67], a[156:159], v[212:215], v[148:151]
s_waitcnt vmcnt(8) lgkmcnt(0)
s_barrier
v_mfma_f32_16x16x32_bf16 v[64:67], a[152:155], v[208:211], v[64:67]
ds_read_b64_tr_b16 a[212:213], v241 offset:0
v_exp_f32 v15, v15
v_mfma_f32_16x16x32_bf16 v[64:67], a[148:151], v[204:207], v[64:67]
ds_read_b128 a[156:159], v219 offset:49152
ds_read_b64_tr_b16 a[214:215], v241 offset:256
v_cvt_pk_bf16_f32 v75, v14, v15
v_mfma_f32_16x16x32_bf16 v[64:67], a[144:147], v[200:203], v[64:67]
ds_read_b64_tr_b16 a[216:217], v241 offset:2048
v_exp_f32 v16, v16
v_mfma_f32_16x16x32_bf16 a[0:3], v[88:91], a[176:179], a[0:3]
ds_read_b128 a[152:155], v218 offset:49152
ds_read_b128 a[148:151], v217 offset:49152
ds_read_b64_tr_b16 a[218:219], v241 offset:2304
v_mfma_f32_16x16x32_bf16 a[16:19], v[88:91], a[180:183], a[16:19]
ds_read_b64_tr_b16 a[220:221], v241 offset:4096
v_exp_f32 v17, v17
v_mfma_f32_16x16x32_bf16 a[20:23], v[92:95], a[180:183], a[20:23]
ds_read_b128 a[144:147], v216 offset:49152
ds_read_b64_tr_b16 a[222:223], v241 offset:4352
v_cvt_pk_bf16_f32 v76, v16, v17
v_mfma_f32_16x16x32_bf16 a[4:7], v[92:95], a[176:179], a[4:7]
ds_read_b64_tr_b16 a[224:225], v241 offset:6144
v_exp_f32 v18, v18
v_mfma_f32_16x16x32_bf16 a[8:11], v[96:99], a[176:179], a[8:11]
s_add_u32 s32, s32, 16384
ds_read_b64_tr_b16 a[226:227], v241 offset:6400
ds_read_b64_tr_b16 a[228:229], v241 offset:8192
v_mfma_f32_16x16x32_bf16 a[24:27], v[96:99], a[180:183], a[24:27]
ds_read_b64_tr_b16 a[230:231], v241 offset:8448
v_exp_f32 v19, v19
v_mfma_f32_16x16x32_bf16 a[28:31], v[100:103], a[180:183], a[28:31]
ds_read_b64_tr_b16 a[180:181], v221 offset:32768
ds_read_b64_tr_b16 a[232:233], v241 offset:10240
v_cvt_pk_bf16_f32 v77, v18, v19
v_mfma_f32_16x16x32_bf16 a[12:15], v[100:103], a[176:179], a[12:15]
ds_read_b64_tr_b16 a[234:235], v241 offset:10496
v_exp_f32 v20, v20
v_mfma_f32_16x16x32_bf16 a[44:47], v[100:103], a[184:187], a[44:47]
ds_read_b64_tr_b16 a[182:183], v221 offset:36864
ds_read_b64_tr_b16 a[176:177], v220 offset:32768
ds_read_b64_tr_b16 a[236:237], v241 offset:12288
v_mfma_f32_16x16x32_bf16 a[60:63], v[100:103], a[188:191], a[60:63]
ds_read_b64_tr_b16 a[238:239], v241 offset:12544
v_exp_f32 v21, v21
v_mfma_f32_16x16x32_bf16 a[56:59], v[96:99], a[188:191], a[56:59]
ds_read_b64_tr_b16 a[178:179], v220 offset:36864
ds_read_b64_tr_b16 a[240:241], v241 offset:14336
v_cvt_pk_bf16_f32 v78, v20, v21
v_mfma_f32_16x16x32_bf16 a[40:43], v[96:99], a[184:187], a[40:43]
ds_read_b64_tr_b16 a[242:243], v241 offset:14592
v_exp_f32 v22, v22
v_mfma_f32_16x16x32_bf16 a[36:39], v[92:95], a[184:187], a[36:39]
s_add_u32 m0, s30, 81920
ds_read_b64_tr_b16 a[244:245], v241 offset:16384
ds_read_b64_tr_b16 a[246:247], v241 offset:16640
v_mfma_f32_16x16x32_bf16 a[52:55], v[92:95], a[188:191], a[52:55]
ds_read_b64_tr_b16 a[248:249], v241 offset:18432
v_exp_f32 v23, v23
v_mfma_f32_16x16x32_bf16 a[48:51], v[88:91], a[188:191], a[48:51]
ds_read_b64_tr_b16 a[188:189], v223 offset:32768
ds_read_b64_tr_b16 a[250:251], v241 offset:18688
v_cvt_pk_bf16_f32 v79, v22, v23
v_mfma_f32_16x16x32_bf16 a[32:35], v[88:91], a[184:187], a[32:35]
ds_read_b64_tr_b16 a[252:253], v241 offset:20480
v_exp_f32 v24, v24
v_smfmac_f32_16x16x64_bf16 a[128:131], a[208:211], v[88:95], v245
ds_read_b64_tr_b16 a[190:191], v223 offset:36864
ds_read_b64_tr_b16 a[254:255], v241 offset:20736
v_mfma_f32_16x16x32_bf16 v[44:47], a[160:163], v[152:155], v[136:139]
ds_read_b64_tr_b16 a[136:137], v241 offset:22528
v_exp_f32 v25, v25
v_mfma_f32_16x16x32_bf16 v[44:47], a[164:167], v[156:159], v[44:47]
v_exp_f32 v26, v26
v_mfma_f32_16x16x32_bf16 v[44:47], a[168:171], v[160:163], v[44:47]
ds_read_b64_tr_b16 a[184:185], v222 offset:32768
v_cvt_pk_bf16_f32 v80, v24, v25
v_mfma_f32_16x16x32_bf16 v[44:47], a[172:175], v[164:167], v[44:47]
ds_read_b64_tr_b16 a[138:139], v241 offset:22784
v_exp_f32 v27, v27
v_mfma_f32_16x16x32_bf16 v[52:55], a[172:175], v[180:183], v[140:143]
ds_read_b64_tr_b16 a[186:187], v222 offset:36864
v_cvt_pk_bf16_f32 v81, v26, v27
v_mfma_f32_16x16x32_bf16 v[52:55], a[168:171], v[176:179], v[52:55]
v_cndmask_b32 v252, v252, v251, s[90:91]
v_exp_f32 v28, v28
v_mfma_f32_16x16x32_bf16 v[52:55], a[164:167], v[172:175], v[52:55]
buffer_load_dwordx4 v228, s[8:11], s32 offen offset:0  lds
v_mfma_f32_16x16x32_bf16 v[52:55], a[160:163], v[168:171], v[52:55]
ds_read_b64_tr_b16 a[140:141], v241 offset:24576
v_exp_f32 v29, v29
v_mfma_f32_16x16x32_bf16 v[60:63], a[160:163], v[184:187], v[144:147]
ds_read_b64_tr_b16 a[142:143], v241 offset:24832
v_cvt_pk_bf16_f32 v82, v28, v29
v_mfma_f32_16x16x32_bf16 v[60:63], a[164:167], v[188:191], v[60:63]
v_exp_f32 v30, v30
v_mfma_f32_16x16x32_bf16 v[60:63], a[168:171], v[192:195], v[60:63]
buffer_load_dwordx4 v229, s[8:11], s32 offen offset:1024  lds
s_lshl_b64 s[90:91], s[90:91], 1
v_mfma_f32_16x16x32_bf16 v[60:63], a[172:175], v[196:199], v[60:63]
v_exp_f32 v31, v31
v_mfma_f32_16x16x32_bf16 v[68:71], a[172:175], v[212:215], v[148:151]
ds_read_b128 a[172:175], v219 offset:53248
v_cvt_pk_bf16_f32 v83, v30, v31
v_mfma_f32_16x16x32_bf16 v[68:71], a[168:171], v[208:211], v[68:71]
v_exp_f32 v32, v32
v_mfma_f32_16x16x32_bf16 v[68:71], a[164:167], v[204:207], v[68:71]
ds_read_b128 a[168:171], v218 offset:53248
ds_read_b128 a[164:167], v217 offset:53248
v_max_u32_dpp v250, v248, v248 row_ror:8 row_mask:0xf bank_mask:0xf
v_mfma_f32_16x16x32_bf16 v[68:71], a[160:163], v[200:203], v[68:71]
v_exp_f32 v33, v33
v_mfma_f32_16x16x32_bf16 a[64:67], v[88:91], a[192:195], a[64:67]
ds_read_b128 a[160:163], v216 offset:53248
ds_read_b64_tr_b16 v[104:105], v241 offset:26624
v_cvt_pk_bf16_f32 v84, v32, v33
v_mfma_f32_16x16x32_bf16 a[80:83], v[88:91], a[196:199], a[80:83]
v_exp_f32 v34, v34
v_mfma_f32_16x16x32_bf16 a[84:87], v[92:95], a[196:199], a[84:87]
buffer_load_dwordx4 v230, s[8:11], s32 offen offset:2048  lds
v_mfma_f32_16x16x32_bf16 a[68:71], v[92:95], a[192:195], a[68:71]
v_max_u32_dpp v249, v250, v250 row_ror:4 row_mask:0xf bank_mask:0xf
v_exp_f32 v35, v35
v_mfma_f32_16x16x32_bf16 a[72:75], v[96:99], a[192:195], a[72:75]
ds_read_b64_tr_b16 v[106:107], v241 offset:26880
v_cvt_pk_bf16_f32 v85, v34, v35
v_mfma_f32_16x16x32_bf16 a[88:91], v[96:99], a[196:199], a[88:91]
v_exp_f32 v36, v36
v_mfma_f32_16x16x32_bf16 a[92:95], v[100:103], a[196:199], a[92:95]
ds_read_b64_tr_b16 a[196:197], v225 offset:32768
ds_read_b64_tr_b16 a[198:199], v225 offset:36864
v_mfma_f32_16x16x32_bf16 a[76:79], v[100:103], a[192:195], a[76:79]
v_max_u32_dpp v250, v249, v249 row_ror:2 row_mask:0xf bank_mask:0xf
v_exp_f32 v37, v37
v_mfma_f32_16x16x32_bf16 a[108:111], v[100:103], a[200:203], a[108:111]
ds_read_b64_tr_b16 a[192:193], v224 offset:32768
v_cvt_pk_bf16_f32 v86, v36, v37
v_mfma_f32_16x16x32_bf16 a[124:127], v[100:103], a[204:207], a[124:127]
ds_read_b64_tr_b16 v[108:109], v241 offset:28672
v_exp_f32 v38, v38
v_mfma_f32_16x16x32_bf16 a[120:123], v[96:99], a[204:207], a[120:123]
ds_read_b64_tr_b16 a[194:195], v224 offset:36864
ds_read_b64_tr_b16 v[110:111], v241 offset:28928
v_mfma_f32_16x16x32_bf16 a[104:107], v[96:99], a[200:203], a[104:107]
v_exp_f32 v39, v39
v_mfma_f32_16x16x32_bf16 a[100:103], v[92:95], a[200:203], a[100:103]
ds_read_b64_tr_b16 v[112:113], v241 offset:30720
v_cvt_pk_bf16_f32 v87, v38, v39
v_max_u32_dpp v249, v250, v250 row_ror:1 row_mask:0xf bank_mask:0xf
v_mfma_f32_16x16x32_bf16 a[116:119], v[92:95], a[204:207], a[116:119]
buffer_load_dwordx4 v231, s[8:11], s32 offen offset:3072  lds
v_mfma_f32_16x16x32_bf16 a[112:115], v[88:91], a[204:207], a[112:115]
ds_read_b64_tr_b16 a[204:205], v227 offset:32768
ds_read_b64_tr_b16 a[206:207], v227 offset:36864
v_mfma_f32_16x16x32_bf16 a[96:99], v[88:91], a[200:203], a[96:99]
ds_read_b64_tr_b16 a[200:201], v226 offset:32768
ds_read_b64_tr_b16 a[202:203], v226 offset:36864
v_smfmac_f32_16x16x64_bf16 a[132:135], a[208:211], v[96:103], v245
ds_read_b64_tr_b16 v[114:115], v241 offset:30976
v_mov_b32 v250, v249
s_waitcnt lgkmcnt(8)
v_mfma_f32_16x16x32_bf16 v[8:11], a[144:147], v[152:155], v[136:139]
v_exp_f32 v40, v40
v_mfma_f32_16x16x32_bf16 v[8:11], a[148:151], v[156:159], v[8:11]
v_exp_f32 v41, v41
v_mfma_f32_16x16x32_bf16 v[8:11], a[152:155], v[160:163], v[8:11]
v_and_b32 v253, 0x20202020, v253
v_cvt_pk_bf16_f32 v88, v40, v41
v_mfma_f32_16x16x32_bf16 v[8:11], a[156:159], v[164:167], v[8:11]
v_exp_f32 v42, v42
v_mfma_f32_16x16x32_bf16 v[16:19], a[156:159], v[180:183], v[140:143]
s_add_u32 s39, s39, 16384
v_permlane16_swap_b32 v249, v250
v_mfma_f32_16x16x32_bf16 v[16:19], a[152:155], v[176:179], v[16:19]
v_exp_f32 v43, v43
v_mfma_f32_16x16x32_bf16 v[16:19], a[148:151], v[172:175], v[16:19]
v_cvt_pk_bf16_f32 v89, v42, v43
v_max_u32 v249, v249, v250
v_mfma_f32_16x16x32_bf16 v[16:19], a[144:147], v[168:171], v[16:19]
v_exp_f32 v44, v44
v_mfma_f32_16x16x32_bf16 v[24:27], a[144:147], v[184:187], v[144:147]
v_cmp_ne_u32 vcc, 0x20202020, v253
s_cbranch_vccnz SP_FL
SP_FL_RET:
v_mfma_f32_16x16x32_bf16 v[24:27], a[148:151], v[188:191], v[24:27]
v_exp_f32 v45, v45
v_mfma_f32_16x16x32_bf16 v[24:27], a[152:155], v[192:195], v[24:27]
v_cvt_pk_bf16_f32 v90, v44, v45
v_mov_b32 v246, s101
v_mfma_f32_16x16x32_bf16 v[24:27], a[156:159], v[196:199], v[24:27]
v_exp_f32 v46, v46
v_mfma_f32_16x16x32_bf16 v[32:35], a[156:159], v[212:215], v[148:151]
ds_read_b128 a[156:159], v219 offset:57344
s_add_u32 m0, s30, 98304
v_mfma_f32_16x16x32_bf16 v[32:35], a[152:155], v[208:211], v[32:35]
v_mov_b32 v250, v249
v_exp_f32 v47, v47
v_mfma_f32_16x16x32_bf16 v[32:35], a[148:151], v[204:207], v[32:35]
ds_read_b128 a[152:155], v218 offset:57344
v_cvt_pk_bf16_f32 v91, v46, v47
v_mfma_f32_16x16x32_bf16 v[32:35], a[144:147], v[200:203], v[32:35]
v_exp_f32 v48, v48
v_mfma_f32_16x16x32_bf16 a[0:3], v[72:75], a[176:179], a[0:3]
ds_read_b128 a[148:151], v217 offset:57344
ds_read_b128 a[144:147], v216 offset:57344
v_mfma_f32_16x16x32_bf16 a[16:19], v[72:75], a[180:183], a[16:19]
v_permlane32_swap_b32 v249, v250
v_exp_f32 v49, v49
v_mfma_f32_16x16x32_bf16 a[20:23], v[76:79], a[180:183], a[20:23]
v_cvt_pk_bf16_f32 v92, v48, v49
v_mov_b32 v247, s47
v_mfma_f32_16x16x32_bf16 a[4:7], v[76:79], a[176:179], a[4:7]
v_exp_f32 v50, v50
v_mfma_f32_16x16x32_bf16 a[8:11], v[80:83], a[176:179], a[8:11]
v_mov_b32 v253, 0
v_max_u32 v249, v249, v250
v_mfma_f32_16x16x32_bf16 a[24:27], v[80:83], a[180:183], a[24:27]
v_exp_f32 v51, v51
v_mfma_f32_16x16x32_bf16 a[28:31], v[84:87], a[180:183], a[28:31]
ds_read_b64_tr_b16 a[180:181], v221 offset:40960
v_cvt_pk_bf16_f32 v93, v50, v51
v_mfma_f32_16x16x32_bf16 a[12:15], v[84:87], a[176:179], a[12:15]
v_exp_f32 v52, v52
v_mfma_f32_16x16x32_bf16 a[44:47], v[84:87], a[184:187], a[44:47]
ds_read_b64_tr_b16 a[182:183], v221 offset:45056
ds_read_b64_tr_b16 a[176:177], v220 offset:40960
v_mfma_f32_16x16x32_bf16 a[60:63], v[84:87], a[188:191], a[60:63]
v_exp_f32 v53, v53
v_mfma_f32_16x16x32_bf16 a[56:59], v[80:83], a[188:191], a[56:59]
ds_read_b64_tr_b16 a[178:179], v220 offset:45056
v_cvt_pk_bf16_f32 v94, v52, v53
v_mfma_f32_16x16x32_bf16 a[40:43], v[80:83], a[184:187], a[40:43]
v_add_u32 v251, v251, v249
v_exp_f32 v54, v54
v_mfma_f32_16x16x32_bf16 a[36:39], v[76:79], a[184:187], a[36:39]
buffer_load_dwordx4 v232, s[12:15], s39 offen offset:0  lds
v_mfma_f32_16x16x32_bf16 a[52:55], v[76:79], a[188:191], a[52:55]
v_exp_f32 v55, v55
v_mfma_f32_16x16x32_bf16 a[48:51], v[72:75], a[188:191], a[48:51]
ds_read_b64_tr_b16 a[188:189], v223 offset:40960
v_cvt_pk_bf16_f32 v95, v54, v55
v_mfma_f32_16x16x32_bf16 a[32:35], v[72:75], a[184:187], a[32:35]
v_sub_u32 v248, v248, v249
v_exp_f32 v56, v56
v_smfmac_f32_16x16x64_bf16 a[128:131], a[208:211], v[72:79], v245
ds_read_b64_tr_b16 a[190:191], v223 offset:45056
v_mfma_f32_16x16x32_bf16 v[12:15], a[160:163], v[152:155], v[136:139]
v_exp_f32 v57, v57
v_mfma_f32_16x16x32_bf16 v[12:15], a[164:167], v[156:159], v[12:15]
v_exp_f32 v58, v58
v_mfma_f32_16x16x32_bf16 v[12:15], a[168:171], v[160:163], v[12:15]
ds_read_b64_tr_b16 a[184:185], v222 offset:40960
v_cvt_pk_bf16_f32 v96, v56, v57
v_mfma_f32_16x16x32_bf16 v[12:15], a[172:175], v[164:167], v[12:15]
v_cndmask_b32 v252, v252, v251, s[90:91]
v_exp_f32 v59, v59
v_mfma_f32_16x16x32_bf16 v[20:23], a[172:175], v[180:183], v[140:143]
ds_read_b64_tr_b16 a[186:187], v222 offset:45056
v_cvt_pk_bf16_f32 v97, v58, v59
v_mfma_f32_16x16x32_bf16 v[20:23], a[168:171], v[176:179], v[20:23]
s_add_u32 s29, s40, s37
v_exp_f32 v60, v60
v_mfma_f32_16x16x32_bf16 v[20:23], a[164:167], v[172:175], v[20:23]
buffer_load_dwordx4 v233, s[12:15], s39 offen offset:1024  lds
v_mfma_f32_16x16x32_bf16 v[20:23], a[160:163], v[168:171], v[20:23]
s_lshl_b64 s[90:91], s[90:91], 1
v_exp_f32 v61, v61
v_mfma_f32_16x16x32_bf16 v[28:31], a[160:163], v[184:187], v[144:147]
v_cvt_pk_bf16_f32 v98, v60, v61
v_mfma_f32_16x16x32_bf16 v[28:31], a[164:167], v[188:191], v[28:31]
v_exp_f32 v62, v62
v_mfma_f32_16x16x32_bf16 v[28:31], a[168:171], v[192:195], v[28:31]
buffer_load_dwordx4 v232, s[12:15], s39 offen offset:2048  lds
v_mfma_f32_16x16x32_bf16 v[28:31], a[172:175], v[196:199], v[28:31]
v_exp_f32 v63, v63
v_mfma_f32_16x16x32_bf16 v[36:39], a[172:175], v[212:215], v[148:151]
ds_read_b128 a[172:175], v219 offset:61440
v_cvt_pk_bf16_f32 v99, v62, v63
v_max_u32_dpp v250, v248, v248 row_ror:8 row_mask:0xf bank_mask:0xf
v_mfma_f32_16x16x32_bf16 v[36:39], a[168:171], v[208:211], v[36:39]
v_exp_f32 v64, v64
v_mfma_f32_16x16x32_bf16 v[36:39], a[164:167], v[204:207], v[36:39]
ds_read_b128 a[168:171], v218 offset:61440
ds_read_b128 a[164:167], v217 offset:61440
v_mfma_f32_16x16x32_bf16 v[36:39], a[160:163], v[200:203], v[36:39]
v_exp_f32 v65, v65
s_waitcnt lgkmcnt(8)
v_mfma_f32_16x16x32_bf16 a[64:67], v[72:75], a[192:195], a[64:67]
ds_read_b128 a[160:163], v216 offset:61440
v_cvt_pk_bf16_f32 v100, v64, v65
v_max_u32_dpp v249, v250, v250 row_ror:4 row_mask:0xf bank_mask:0xf
v_mfma_f32_16x16x32_bf16 a[80:83], v[72:75], a[196:199], a[80:83]
v_exp_f32 v66, v66
v_mfma_f32_16x16x32_bf16 a[84:87], v[76:79], a[196:199], a[84:87]
buffer_load_dwordx4 v233, s[12:15], s39 offen offset:3072  lds
v_mfma_f32_16x16x32_bf16 a[68:71], v[76:79], a[192:195], a[68:71]
v_exp_f32 v67, v67
v_mfma_f32_16x16x32_bf16 a[72:75], v[80:83], a[192:195], a[72:75]
s_cmp_eq_u32 s29, 0
s_cselect_b32 s29, 0x24c000, -16
v_cvt_pk_bf16_f32 v101, v66, v67
v_mfma_f32_16x16x32_bf16 a[88:91], v[80:83], a[196:199], a[88:91]
v_max_u32_dpp v250, v249, v249 row_ror:2 row_mask:0xf bank_mask:0xf
v_exp_f32 v68, v68
v_mfma_f32_16x16x32_bf16 a[92:95], v[84:87], a[196:199], a[92:95]
ds_read_b64_tr_b16 a[196:197], v225 offset:40960
ds_read_b64_tr_b16 a[198:199], v225 offset:45056
v_mfma_f32_16x16x32_bf16 a[76:79], v[84:87], a[192:195], a[76:79]
v_exp_f32 v69, v69
v_mfma_f32_16x16x32_bf16 a[108:111], v[84:87], a[200:203], a[108:111]
ds_read_b64_tr_b16 a[192:193], v224 offset:40960
v_cvt_pk_bf16_f32 v102, v68, v69
v_mfma_f32_16x16x32_bf16 a[124:127], v[84:87], a[204:207], a[124:127]
v_max_u32_dpp v249, v250, v250 row_ror:1 row_mask:0xf bank_mask:0xf
v_exp_f32 v70, v70
v_mfma_f32_16x16x32_bf16 a[120:123], v[80:83], a[204:207], a[120:123]
ds_read_b64_tr_b16 a[194:195], v224 offset:45056
buffer_store_dwordx2 v[246:247], v253, s[20:23], s29 offen
v_mfma_f32_16x16x32_bf16 a[104:107], v[80:83], a[200:203], a[104:107]
v_exp_f32 v71, v71
v_mfma_f32_16x16x32_bf16 a[100:103], v[76:79], a[200:203], a[100:103]
v_cvt_pk_bf16_f32 v103, v70, v71
v_mov_b32 v250, v249
v_mfma_f32_16x16x32_bf16 a[116:119], v[76:79], a[204:207], a[116:119]
v_mfma_f32_16x16x32_bf16 a[112:115], v[72:75], a[204:207], a[112:115]
ds_read_b64_tr_b16 a[204:205], v227 offset:40960
ds_read_b64_tr_b16 a[206:207], v227 offset:45056
v_mfma_f32_16x16x32_bf16 a[96:99], v[72:75], a[200:203], a[96:99]
ds_read_b64_tr_b16 a[200:201], v226 offset:40960
ds_read_b64_tr_b16 a[202:203], v226 offset:45056
v_smfmac_f32_16x16x64_bf16 a[132:135], a[208:211], v[80:87], v245
STUB_7:
s_cbranch_execz STUB_10
v_permlane16_swap_b32 v249, v250
v_mfma_f32_16x16x32_bf16 v[40:43], a[144:147], v[152:155], v[136:139]
v_exp_f32 v8, v8
v_mfma_f32_16x16x32_bf16 v[40:43], a[148:151], v[156:159], v[40:43]
v_exp_f32 v9, v9
v_mfma_f32_16x16x32_bf16 v[40:43], a[152:155], v[160:163], v[40:43]
v_cvt_pk_bf16_f32 v72, v8, v9
v_max_u32 v249, v249, v250
v_mfma_f32_16x16x32_bf16 v[40:43], a[156:159], v[164:167], v[40:43]
v_exp_f32 v10, v10
v_mfma_f32_16x16x32_bf16 v[48:51], a[156:159], v[180:183], v[140:143]
v_mov_b32 v250, v249
v_mfma_f32_16x16x32_bf16 v[48:51], a[152:155], v[176:179], v[48:51]
v_exp_f32 v11, v11
v_mfma_f32_16x16x32_bf16 v[48:51], a[148:151], v[172:175], v[48:51]
v_cvt_pk_bf16_f32 v73, v10, v11
v_permlane32_swap_b32 v249, v250
v_mfma_f32_16x16x32_bf16 v[48:51], a[144:147], v[168:171], v[48:51]
v_exp_f32 v12, v12
v_mfma_f32_16x16x32_bf16 v[56:59], a[144:147], v[184:187], v[144:147]
v_max_u32 v249, v249, v250
v_add_u32 v251, v251, v249
v_mfma_f32_16x16x32_bf16 v[56:59], a[148:151], v[188:191], v[56:59]
v_exp_f32 v13, v13
v_mfma_f32_16x16x32_bf16 v[56:59], a[152:155], v[192:195], v[56:59]
v_cvt_pk_bf16_f32 v74, v12, v13
v_cndmask_b32 v252, v252, v251, s[90:91]
v_mfma_f32_16x16x32_bf16 v[56:59], a[156:159], v[196:199], v[56:59]
v_exp_f32 v14, v14
v_mfma_f32_16x16x32_bf16 v[64:67], a[156:159], v[212:215], v[148:151]
s_waitcnt vmcnt(9) lgkmcnt(0)
s_barrier
v_mfma_f32_16x16x32_bf16 v[64:67], a[152:155], v[208:211], v[64:67]
v_exp_f32 v15, v15
v_mfma_f32_16x16x32_bf16 v[64:67], a[148:151], v[204:207], v[64:67]
ds_read_b128 a[156:159], v219 offset:0
v_cvt_pk_bf16_f32 v75, v14, v15
v_mfma_f32_16x16x32_bf16 v[64:67], a[144:147], v[200:203], v[64:67]
v_exp_f32 v16, v16
v_mfma_f32_16x16x32_bf16 a[0:3], v[88:91], a[176:179], a[0:3]
ds_read_b128 a[152:155], v218 offset:0
ds_read_b128 a[148:151], v217 offset:0
v_mfma_f32_16x16x32_bf16 a[16:19], v[88:91], a[180:183], a[16:19]
v_exp_f32 v17, v17
v_mfma_f32_16x16x32_bf16 a[20:23], v[92:95], a[180:183], a[20:23]
ds_read_b128 a[144:147], v216 offset:0
v_cvt_pk_bf16_f32 v76, v16, v17
v_mfma_f32_16x16x32_bf16 a[4:7], v[92:95], a[176:179], a[4:7]
v_exp_f32 v18, v18
v_mfma_f32_16x16x32_bf16 a[8:11], v[96:99], a[176:179], a[8:11]
s_add_u32 s32, s32, 16384
s_add_u32 m0, s30, 114688
v_mfma_f32_16x16x32_bf16 a[24:27], v[96:99], a[180:183], a[24:27]
v_exp_f32 v19, v19
v_mfma_f32_16x16x32_bf16 a[28:31], v[100:103], a[180:183], a[28:31]
ds_read_b64_tr_b16 a[180:181], v221 offset:49152
v_cvt_pk_bf16_f32 v77, v18, v19
v_mfma_f32_16x16x32_bf16 a[12:15], v[100:103], a[176:179], a[12:15]
v_exp_f32 v20, v20
v_mfma_f32_16x16x32_bf16 a[44:47], v[100:103], a[184:187], a[44:47]
ds_read_b64_tr_b16 a[182:183], v221 offset:53248
ds_read_b64_tr_b16 a[176:177], v220 offset:49152
v_mfma_f32_16x16x32_bf16 a[60:63], v[100:103], a[188:191], a[60:63]
v_exp_f32 v21, v21
v_mfma_f32_16x16x32_bf16 a[56:59], v[96:99], a[188:191], a[56:59]
ds_read_b64_tr_b16 a[178:179], v220 offset:53248
v_cvt_pk_bf16_f32 v78, v20, v21
v_mfma_f32_16x16x32_bf16 a[40:43], v[96:99], a[184:187], a[40:43]
v_exp_f32 v22, v22
v_mfma_f32_16x16x32_bf16 a[36:39], v[92:95], a[184:187], a[36:39]
buffer_load_dwordx4 v228, s[8:11], s32 offen offset:0  lds
v_mfma_f32_16x16x32_bf16 a[52:55], v[92:95], a[188:191], a[52:55]
v_exp_f32 v23, v23
v_mfma_f32_16x16x32_bf16 a[48:51], v[88:91], a[188:191], a[48:51]
ds_read_b64_tr_b16 a[188:189], v223 offset:49152
v_cvt_pk_bf16_f32 v79, v22, v23
v_mfma_f32_16x16x32_bf16 a[32:35], v[88:91], a[184:187], a[32:35]
v_exp_f32 v24, v24
v_smfmac_f32_16x16x64_bf16 a[128:131], a[208:211], v[88:95], v245
ds_read_b64_tr_b16 a[190:191], v223 offset:53248
v_mfma_f32_16x16x32_bf16 v[44:47], a[160:163], v[152:155], v[136:139]
v_mov_b32 v236, v252
v_exp_f32 v25, v25
v_mfma_f32_16x16x32_bf16 v[44:47], a[164:167], v[156:159], v[44:47]
v_exp_f32 v26, v26
v_mfma_f32_16x16x32_bf16 v[44:47], a[168:171], v[160:163], v[44:47]
ds_read_b64_tr_b16 a[184:185], v222 offset:49152
v_cvt_pk_bf16_f32 v80, v24, v25
v_mfma_f32_16x16x32_bf16 v[44:47], a[172:175], v[164:167], v[44:47]
v_exp_f32 v27, v27
v_mfma_f32_16x16x32_bf16 v[52:55], a[172:175], v[180:183], v[140:143]
ds_read_b64_tr_b16 a[186:187], v222 offset:53248
v_cvt_pk_bf16_f32 v81, v26, v27
v_mfma_f32_16x16x32_bf16 v[52:55], a[168:171], v[176:179], v[52:55]
v_and_b32 v252, 0xffff, v252
v_exp_f32 v28, v28
v_mfma_f32_16x16x32_bf16 v[52:55], a[164:167], v[172:175], v[52:55]
buffer_load_dwordx4 v229, s[8:11], s32 offen offset:1024  lds
v_mfma_f32_16x16x32_bf16 v[52:55], a[160:163], v[168:171], v[52:55]
v_exp_f32 v29, v29
v_mfma_f32_16x16x32_bf16 v[60:63], a[160:163], v[184:187], v[144:147]
v_cvt_pk_bf16_f32 v82, v28, v29
v_sub_u32 v252, 0xffff, v252
v_mfma_f32_16x16x32_bf16 v[60:63], a[164:167], v[188:191], v[60:63]
v_exp_f32 v30, v30
v_mfma_f32_16x16x32_bf16 v[60:63], a[168:171], v[192:195], v[60:63]
buffer_load_dwordx4 v230, s[8:11], s32 offen offset:2048  lds
v_mfma_f32_16x16x32_bf16 v[60:63], a[172:175], v[196:199], v[60:63]
v_exp_f32 v31, v31
v_mfma_f32_16x16x32_bf16 v[68:71], a[172:175], v[212:215], v[148:151]
ds_read_b128 a[172:175], v219 offset:4096
v_cvt_pk_bf16_f32 v83, v30, v31
v_mfma_f32_16x16x32_bf16 v[68:71], a[168:171], v[208:211], v[68:71]
v_exp_f32 v32, v32
v_mfma_f32_16x16x32_bf16 v[68:71], a[164:167], v[204:207], v[68:71]
ds_read_b128 a[168:171], v218 offset:4096
ds_read_b128 a[164:167], v217 offset:4096
v_mul_u32_u24 v252, 0x480, v252
v_mfma_f32_16x16x32_bf16 v[68:71], a[160:163], v[200:203], v[68:71]
v_exp_f32 v33, v33
v_mfma_f32_16x16x32_bf16 a[64:67], v[88:91], a[192:195], a[64:67]
ds_read_b128 a[160:163], v216 offset:4096
v_cvt_pk_bf16_f32 v84, v32, v33
v_mfma_f32_16x16x32_bf16 a[80:83], v[88:91], a[196:199], a[80:83]
v_exp_f32 v34, v34
v_mfma_f32_16x16x32_bf16 a[84:87], v[92:95], a[196:199], a[84:87]
buffer_load_dwordx4 v231, s[8:11], s32 offen offset:3072  lds
v_lshrrev_b32 v249, 3, v0
v_mfma_f32_16x16x32_bf16 a[68:71], v[92:95], a[192:195], a[68:71]
v_exp_f32 v35, v35
v_mfma_f32_16x16x32_bf16 a[72:75], v[96:99], a[192:195], a[72:75]
v_cvt_pk_bf16_f32 v85, v34, v35
v_lshl_add_u32 v252, v249, 4, v252
v_mfma_f32_16x16x32_bf16 a[88:91], v[96:99], a[196:199], a[88:91]
v_exp_f32 v36, v36
v_mfma_f32_16x16x32_bf16 a[92:95], v[100:103], a[196:199], a[92:95]
ds_read_b64_tr_b16 a[196:197], v225 offset:49152
ds_read_b64_tr_b16 a[198:199], v225 offset:53248
v_mfma_f32_16x16x32_bf16 a[76:79], v[100:103], a[192:195], a[76:79]
v_exp_f32 v37, v37
v_mfma_f32_16x16x32_bf16 a[108:111], v[100:103], a[200:203], a[108:111]
ds_read_b64_tr_b16 a[192:193], v224 offset:49152
v_cvt_pk_bf16_f32 v86, v36, v37
v_mfma_f32_16x16x32_bf16 a[124:127], v[100:103], a[204:207], a[124:127]
v_exp_f32 v38, v38
v_mfma_f32_16x16x32_bf16 a[120:123], v[96:99], a[204:207], a[120:123]
ds_read_b64_tr_b16 a[194:195], v224 offset:53248
v_mfma_f32_16x16x32_bf16 a[104:107], v[96:99], a[200:203], a[104:107]
v_exp_f32 v39, v39
v_mfma_f32_16x16x32_bf16 a[100:103], v[92:95], a[200:203], a[100:103]
v_cvt_pk_bf16_f32 v87, v38, v39
v_mfma_f32_16x16x32_bf16 a[116:119], v[92:95], a[204:207], a[116:119]
s_add_u32 m0, s86, 0
s_add_u32 s50, s84, 4718592
buffer_load_dwordx4 v240, s[64:67], s50 offen lds
v_mfma_f32_16x16x32_bf16 a[112:115], v[88:91], a[204:207], a[112:115]
ds_read_b64_tr_b16 a[204:205], v227 offset:49152
ds_read_b64_tr_b16 a[206:207], v227 offset:53248
v_mfma_f32_16x16x32_bf16 a[96:99], v[88:91], a[200:203], a[96:99]
ds_read_b64_tr_b16 a[200:201], v226 offset:49152
ds_read_b64_tr_b16 a[202:203], v226 offset:53248
v_smfmac_f32_16x16x64_bf16 a[132:135], a[208:211], v[96:103], v245
s_add_u32 m0, s86, 4096
s_add_u32 s50, s84, 4718592
buffer_load_dwordx4 v240, s[68:71], s50 offen lds
s_add_u32 m0, s86, 8192
s_add_u32 s50, s85, 0
buffer_load_dwordx4 v244, s[72:75], s50 offen lds
s_add_u32 m0, s86, 12288
s_add_u32 s50, s85, 4096
buffer_load_dwordx4 v244, s[72:75], s50 offen lds
s_waitcnt lgkmcnt(8)
v_mfma_f32_16x16x32_bf16 v[8:11], a[144:147], v[152:155], v[136:139]
v_exp_f32 v40, v40
v_mfma_f32_16x16x32_bf16 v[8:11], a[148:151], v[156:159], v[8:11]
v_exp_f32 v41, v41
v_mfma_f32_16x16x32_bf16 v[8:11], a[152:155], v[160:163], v[8:11]
v_cvt_pk_bf16_f32 v88, v40, v41
v_mfma_f32_16x16x32_bf16 v[8:11], a[156:159], v[164:167], v[8:11]
v_exp_f32 v42, v42
v_mfma_f32_16x16x32_bf16 v[16:19], a[156:159], v[180:183], v[140:143]
s_add_u32 s39, s39, 16384
v_mfma_f32_16x16x32_bf16 v[16:19], a[152:155], v[176:179], v[16:19]
v_exp_f32 v43, v43
v_mfma_f32_16x16x32_bf16 v[16:19], a[148:151], v[172:175], v[16:19]
v_cvt_pk_bf16_f32 v89, v42, v43
v_mfma_f32_16x16x32_bf16 v[16:19], a[144:147], v[168:171], v[16:19]
v_exp_f32 v44, v44
v_mfma_f32_16x16x32_bf16 v[24:27], a[144:147], v[184:187], v[144:147]
s_add_u32 m0, s30, 131072
v_mfma_f32_16x16x32_bf16 v[24:27], a[148:151], v[188:191], v[24:27]
v_exp_f32 v45, v45
v_mfma_f32_16x16x32_bf16 v[24:27], a[152:155], v[192:195], v[24:27]
v_cvt_pk_bf16_f32 v90, v44, v45
v_mfma_f32_16x16x32_bf16 v[24:27], a[156:159], v[196:199], v[24:27]
v_exp_f32 v46, v46
v_mfma_f32_16x16x32_bf16 v[32:35], a[156:159], v[212:215], v[148:151]
ds_read_b128 a[156:159], v219 offset:8192
v_mfma_f32_16x16x32_bf16 v[32:35], a[152:155], v[208:211], v[32:35]
v_exp_f32 v47, v47
v_mfma_f32_16x16x32_bf16 v[32:35], a[148:151], v[204:207], v[32:35]
ds_read_b128 a[152:155], v218 offset:8192
v_cvt_pk_bf16_f32 v91, v46, v47
v_mfma_f32_16x16x32_bf16 v[32:35], a[144:147], v[200:203], v[32:35]
v_exp_f32 v48, v48
v_mfma_f32_16x16x32_bf16 a[0:3], v[72:75], a[176:179], a[0:3]
ds_read_b128 a[148:151], v217 offset:8192
ds_read_b128 a[144:147], v216 offset:8192
v_mfma_f32_16x16x32_bf16 a[16:19], v[72:75], a[180:183], a[16:19]
v_exp_f32 v49, v49
v_mfma_f32_16x16x32_bf16 a[20:23], v[76:79], a[180:183], a[20:23]
v_cvt_pk_bf16_f32 v92, v48, v49
v_mfma_f32_16x16x32_bf16 a[4:7], v[76:79], a[176:179], a[4:7]
v_exp_f32 v50, v50
v_mfma_f32_16x16x32_bf16 a[8:11], v[80:83], a[176:179], a[8:11]
buffer_load_dwordx4 v232, s[12:15], s39 offen offset:0  lds
v_mfma_f32_16x16x32_bf16 a[24:27], v[80:83], a[180:183], a[24:27]
v_exp_f32 v51, v51
v_mfma_f32_16x16x32_bf16 a[28:31], v[84:87], a[180:183], a[28:31]
ds_read_b64_tr_b16 a[180:181], v221 offset:57344
v_cvt_pk_bf16_f32 v93, v50, v51
v_mfma_f32_16x16x32_bf16 a[12:15], v[84:87], a[176:179], a[12:15]
v_exp_f32 v52, v52
v_mfma_f32_16x16x32_bf16 a[44:47], v[84:87], a[184:187], a[44:47]
ds_read_b64_tr_b16 a[182:183], v221 offset:61440
ds_read_b64_tr_b16 a[176:177], v220 offset:57344
v_mfma_f32_16x16x32_bf16 a[60:63], v[84:87], a[188:191], a[60:63]
v_exp_f32 v53, v53
v_mfma_f32_16x16x32_bf16 a[56:59], v[80:83], a[188:191], a[56:59]
ds_read_b64_tr_b16 a[178:179], v220 offset:61440
v_cvt_pk_bf16_f32 v94, v52, v53
v_mfma_f32_16x16x32_bf16 a[40:43], v[80:83], a[184:187], a[40:43]
v_exp_f32 v54, v54
v_mfma_f32_16x16x32_bf16 a[36:39], v[76:79], a[184:187], a[36:39]
buffer_load_dwordx4 v233, s[12:15], s39 offen offset:1024  lds
v_mfma_f32_16x16x32_bf16 a[52:55], v[76:79], a[188:191], a[52:55]
v_exp_f32 v55, v55
v_mfma_f32_16x16x32_bf16 a[48:51], v[72:75], a[188:191], a[48:51]
ds_read_b64_tr_b16 a[188:189], v223 offset:57344
v_cvt_pk_bf16_f32 v95, v54, v55
v_mfma_f32_16x16x32_bf16 a[32:35], v[72:75], a[184:187], a[32:35]
v_exp_f32 v56, v56
v_smfmac_f32_16x16x64_bf16 a[128:131], a[208:211], v[72:79], v245
ds_read_b64_tr_b16 a[190:191], v223 offset:61440
v_mfma_f32_16x16x32_bf16 v[12:15], a[160:163], v[152:155], v[136:139]
v_exp_f32 v57, v57
v_mfma_f32_16x16x32_bf16 v[12:15], a[164:167], v[156:159], v[12:15]
v_exp_f32 v58, v58
v_mfma_f32_16x16x32_bf16 v[12:15], a[168:171], v[160:163], v[12:15]
ds_read_b64_tr_b16 a[184:185], v222 offset:57344
v_cvt_pk_bf16_f32 v96, v56, v57
v_mfma_f32_16x16x32_bf16 v[12:15], a[172:175], v[164:167], v[12:15]
v_exp_f32 v59, v59
v_mfma_f32_16x16x32_bf16 v[20:23], a[172:175], v[180:183], v[140:143]
ds_read_b64_tr_b16 a[186:187], v222 offset:61440
v_cvt_pk_bf16_f32 v97, v58, v59
v_mfma_f32_16x16x32_bf16 v[20:23], a[168:171], v[176:179], v[20:23]
v_exp_f32 v60, v60
v_mfma_f32_16x16x32_bf16 v[20:23], a[164:167], v[172:175], v[20:23]
buffer_load_dwordx4 v232, s[12:15], s39 offen offset:2048  lds
v_mfma_f32_16x16x32_bf16 v[20:23], a[160:163], v[168:171], v[20:23]
v_exp_f32 v61, v61
v_mfma_f32_16x16x32_bf16 v[28:31], a[160:163], v[184:187], v[144:147]
v_cvt_pk_bf16_f32 v98, v60, v61
v_mfma_f32_16x16x32_bf16 v[28:31], a[164:167], v[188:191], v[28:31]
v_exp_f32 v62, v62
v_mfma_f32_16x16x32_bf16 v[28:31], a[168:171], v[192:195], v[28:31]
buffer_load_dwordx4 v233, s[12:15], s39 offen offset:3072  lds
v_mfma_f32_16x16x32_bf16 v[28:31], a[172:175], v[196:199], v[28:31]
v_exp_f32 v63, v63
v_mfma_f32_16x16x32_bf16 v[36:39], a[172:175], v[212:215], v[148:151]
ds_read_b128 a[172:175], v219 offset:12288
v_cvt_pk_bf16_f32 v99, v62, v63
v_mfma_f32_16x16x32_bf16 v[36:39], a[168:171], v[208:211], v[36:39]
v_exp_f32 v64, v64
v_mfma_f32_16x16x32_bf16 v[36:39], a[164:167], v[204:207], v[36:39]
ds_read_b128 a[168:171], v218 offset:12288
ds_read_b128 a[164:167], v217 offset:12288
v_mfma_f32_16x16x32_bf16 v[36:39], a[160:163], v[200:203], v[36:39]
v_exp_f32 v65, v65
s_waitcnt lgkmcnt(8)
v_mfma_f32_16x16x32_bf16 a[64:67], v[72:75], a[192:195], a[64:67]
ds_read_b128 a[160:163], v216 offset:12288
v_cvt_pk_bf16_f32 v100, v64, v65
v_mfma_f32_16x16x32_bf16 a[80:83], v[72:75], a[196:199], a[80:83]
v_exp_f32 v66, v66
v_mfma_f32_16x16x32_bf16 a[84:87], v[76:79], a[196:199], a[84:87]
s_add_u32 m0, s86, 45056
s_mov_b32 s50, 29360128
buffer_load_dwordx4 v252, s[20:23], s50 offen sc0 sc1 lds
v_mfma_f32_16x16x32_bf16 a[68:71], v[76:79], a[192:195], a[68:71]
v_exp_f32 v67, v67
v_mfma_f32_16x16x32_bf16 a[72:75], v[80:83], a[192:195], a[72:75]
v_cvt_pk_bf16_f32 v101, v66, v67
v_mfma_f32_16x16x32_bf16 a[88:91], v[80:83], a[196:199], a[88:91]
v_exp_f32 v68, v68
v_mfma_f32_16x16x32_bf16 a[92:95], v[84:87], a[196:199], a[92:95]
ds_read_b64_tr_b16 a[196:197], v225 offset:57344
ds_read_b64_tr_b16 a[198:199], v225 offset:61440
v_mfma_f32_16x16x32_bf16 a[76:79], v[84:87], a[192:195], a[76:79]
v_exp_f32 v69, v69
v_mfma_f32_16x16x32_bf16 a[108:111], v[84:87], a[200:203], a[108:111]
ds_read_b64_tr_b16 a[192:193], v224 offset:57344
v_cvt_pk_bf16_f32 v102, v68, v69
v_mfma_f32_16x16x32_bf16 a[124:127], v[84:87], a[204:207], a[124:127]
v_exp_f32 v70, v70
v_mfma_f32_16x16x32_bf16 a[120:123], v[80:83], a[204:207], a[120:123]
ds_read_b64_tr_b16 a[194:195], v224 offset:61440
v_mfma_f32_16x16x32_bf16 a[104:107], v[80:83], a[200:203], a[104:107]
v_exp_f32 v71, v71
v_mfma_f32_16x16x32_bf16 a[100:103], v[76:79], a[200:203], a[100:103]
v_cvt_pk_bf16_f32 v103, v70, v71
v_mfma_f32_16x16x32_bf16 a[116:119], v[76:79], a[204:207], a[116:119]
s_add_u32 m0, s86, 49152
s_mov_b32 s50, 29360640
buffer_load_dwordx4 v252, s[20:23], s50 offen sc0 sc1 lds
v_mfma_f32_16x16x32_bf16 a[112:115], v[72:75], a[204:207], a[112:115]
ds_read_b64_tr_b16 a[204:205], v227 offset:57344
ds_read_b64_tr_b16 a[206:207], v227 offset:61440
v_mfma_f32_16x16x32_bf16 a[96:99], v[72:75], a[200:203], a[96:99]
ds_read_b64_tr_b16 a[200:201], v226 offset:57344
ds_read_b64_tr_b16 a[202:203], v226 offset:61440
v_smfmac_f32_16x16x64_bf16 a[132:135], a[208:211], v[80:87], v245
s_add_u32 m0, s86, 53248
s_mov_b32 s50, 29361152
buffer_load_dwordx4 v252, s[20:23], s50 offen sc0 sc1 lds
s_add_u32 m0, s86, 16384
s_add_u32 s50, s85, 8192
buffer_load_dwordx4 v244, s[72:75], s50 offen lds
v_mfma_f32_16x16x32_bf16 v[40:43], a[144:147], v[152:155], v[136:139]
v_mov_b32 v248, v236
v_exp_f32 v8, v8
v_mfma_f32_16x16x32_bf16 v[40:43], a[148:151], v[156:159], v[40:43]
v_mov_b32 v249, s47
v_exp_f32 v9, v9
v_mfma_f32_16x16x32_bf16 v[40:43], a[152:155], v[160:163], v[40:43]
v_cvt_pk_bf16_f32 v72, v8, v9
v_and_b32 v250, 7, v1
v_lshlrev_b32 v250, 3, v250
v_mfma_f32_16x16x32_bf16 v[40:43], a[156:159], v[164:167], v[40:43]
s_add_u32 s29, s40, s37
v_exp_f32 v10, v10
v_mfma_f32_16x16x32_bf16 v[48:51], a[156:159], v[180:183], v[140:143]
s_cmp_eq_u32 s29, 0
s_mov_b32 s29, 0x7ffffff0
s_cselect_b32 s29, 0x242800, s29
v_mfma_f32_16x16x32_bf16 v[48:51], a[152:155], v[176:179], v[48:51]
v_exp_f32 v11, v11
v_mfma_f32_16x16x32_bf16 v[48:51], a[148:151], v[172:175], v[48:51]
v_cvt_pk_bf16_f32 v73, v10, v11
v_mfma_f32_16x16x32_bf16 v[48:51], a[144:147], v[168:171], v[48:51]
v_exp_f32 v12, v12
v_mfma_f32_16x16x32_bf16 v[56:59], a[144:147], v[184:187], v[144:147]
v_mfma_f32_16x16x32_bf16 v[56:59], a[148:151], v[188:191], v[56:59]
v_exp_f32 v13, v13
v_mfma_f32_16x16x32_bf16 v[56:59], a[152:155], v[192:195], v[56:59]
v_cvt_pk_bf16_f32 v74, v12, v13
v_mfma_f32_16x16x32_bf16 v[56:59], a[156:159], v[196:199], v[56:59]
v_exp_f32 v14, v14
v_mfma_f32_16x16x32_bf16 v[64:67], a[156:159], v[212:215], v[148:151]
s_waitcnt vmcnt(16) lgkmcnt(0)
s_barrier
v_mfma_f32_16x16x32_bf16 v[64:67], a[152:155], v[208:211], v[64:67]
v_exp_f32 v15, v15
v_mfma_f32_16x16x32_bf16 v[64:67], a[148:151], v[204:207], v[64:67]
ds_read_b128 a[156:159], v219 offset:16384
v_cvt_pk_bf16_f32 v75, v14, v15
v_mfma_f32_16x16x32_bf16 v[64:67], a[144:147], v[200:203], v[64:67]
v_exp_f32 v16, v16
v_mfma_f32_16x16x32_bf16 a[0:3], v[88:91], a[176:179], a[0:3]
ds_read_b128 a[152:155], v218 offset:16384
ds_read_b128 a[148:151], v217 offset:16384
v_mfma_f32_16x16x32_bf16 a[16:19], v[88:91], a[180:183], a[16:19]
v_exp_f32 v17, v17
v_mfma_f32_16x16x32_bf16 a[20:23], v[92:95], a[180:183], a[20:23]
ds_read_b128 a[144:147], v216 offset:16384
v_cvt_pk_bf16_f32 v76, v16, v17
v_mfma_f32_16x16x32_bf16 a[4:7], v[92:95], a[176:179], a[4:7]
v_exp_f32 v18, v18
v_mfma_f32_16x16x32_bf16 a[8:11], v[96:99], a[176:179], a[8:11]
s_add_u32 s32, s32, 16384
s_add_u32 m0, s30, 65536
v_mfma_f32_16x16x32_bf16 a[24:27], v[96:99], a[180:183], a[24:27]
v_exp_f32 v19, v19
v_mfma_f32_16x16x32_bf16 a[28:31], v[100:103], a[180:183], a[28:31]
ds_read_b64_tr_b16 a[180:181], v221 offset:0
v_cvt_pk_bf16_f32 v77, v18, v19
v_mfma_f32_16x16x32_bf16 a[12:15], v[100:103], a[176:179], a[12:15]
v_exp_f32 v20, v20
v_mfma_f32_16x16x32_bf16 a[44:47], v[100:103], a[184:187], a[44:47]
ds_read_b64_tr_b16 a[182:183], v221 offset:4096
ds_read_b64_tr_b16 a[176:177], v220 offset:0
v_mfma_f32_16x16x32_bf16 a[60:63], v[100:103], a[188:191], a[60:63]
v_exp_f32 v21, v21
v_mfma_f32_16x16x32_bf16 a[56:59], v[96:99], a[188:191], a[56:59]
ds_read_b64_tr_b16 a[178:179], v220 offset:4096
v_cvt_pk_bf16_f32 v78, v20, v21
v_mfma_f32_16x16x32_bf16 a[40:43], v[96:99], a[184:187], a[40:43]
v_exp_f32 v22, v22
v_mfma_f32_16x16x32_bf16 a[36:39], v[92:95], a[184:187], a[36:39]
buffer_load_dwordx4 v228, s[8:11], s32 offen offset:0  lds
v_mfma_f32_16x16x32_bf16 a[52:55], v[92:95], a[188:191], a[52:55]
v_exp_f32 v23, v23
v_mfma_f32_16x16x32_bf16 a[48:51], v[88:91], a[188:191], a[48:51]
ds_read_b64_tr_b16 a[188:189], v223 offset:0
v_cvt_pk_bf16_f32 v79, v22, v23
v_mfma_f32_16x16x32_bf16 a[32:35], v[88:91], a[184:187], a[32:35]
v_exp_f32 v24, v24
v_smfmac_f32_16x16x64_bf16 a[128:131], a[208:211], v[88:95], v245
ds_read_b64_tr_b16 a[190:191], v223 offset:4096
v_mfma_f32_16x16x32_bf16 v[44:47], a[160:163], v[152:155], v[136:139]
v_exp_f32 v25, v25
v_mfma_f32_16x16x32_bf16 v[44:47], a[164:167], v[156:159], v[44:47]
v_exp_f32 v26, v26
v_mfma_f32_16x16x32_bf16 v[44:47], a[168:171], v[160:163], v[44:47]
ds_read_b64_tr_b16 a[184:185], v222 offset:0
v_cvt_pk_bf16_f32 v80, v24, v25
v_mfma_f32_16x16x32_bf16 v[44:47], a[172:175], v[164:167], v[44:47]
v_exp_f32 v27, v27
v_mfma_f32_16x16x32_bf16 v[52:55], a[172:175], v[180:183], v[140:143]
ds_read_b64_tr_b16 a[186:187], v222 offset:4096
v_cvt_pk_bf16_f32 v81, v26, v27
v_mfma_f32_16x16x32_bf16 v[52:55], a[168:171], v[176:179], v[52:55]
v_exp_f32 v28, v28
v_mfma_f32_16x16x32_bf16 v[52:55], a[164:167], v[172:175], v[52:55]
buffer_load_dwordx4 v229, s[8:11], s32 offen offset:1024  lds
v_mfma_f32_16x16x32_bf16 v[52:55], a[160:163], v[168:171], v[52:55]
v_exp_f32 v29, v29
v_mfma_f32_16x16x32_bf16 v[60:63], a[160:163], v[184:187], v[144:147]
buffer_store_dwordx2 v[248:249], v250, s[20:23], s29 offen sc0 sc1
v_cvt_pk_bf16_f32 v82, v28, v29
v_mfma_f32_16x16x32_bf16 v[60:63], a[164:167], v[188:191], v[60:63]
v_ashrrev_i32 v246, 31, v236
v_exp_f32 v30, v30
v_mfma_f32_16x16x32_bf16 v[60:63], a[168:171], v[192:195], v[60:63]
buffer_load_dwordx4 v230, s[8:11], s32 offen offset:2048  lds
v_not_b32 v246, v246
v_mfma_f32_16x16x32_bf16 v[60:63], a[172:175], v[196:199], v[60:63]
v_or_b32 v246, 0x80000000, v246
v_exp_f32 v31, v31
v_mfma_f32_16x16x32_bf16 v[68:71], a[172:175], v[212:215], v[148:151]
ds_read_b128 a[172:175], v219 offset:20480
v_cvt_pk_bf16_f32 v83, v30, v31
v_xor_b32 v236, v236, v246
v_mfma_f32_16x16x32_bf16 v[68:71], a[168:171], v[208:211], v[68:71]
v_and_b32 v236, 0xffff0000, v236
v_exp_f32 v32, v32
v_mfma_f32_16x16x32_bf16 v[68:71], a[164:167], v[204:207], v[68:71]
ds_read_b128 a[168:171], v218 offset:20480
ds_read_b128 a[164:167], v217 offset:20480
v_mul_f32 v236, 0xbfb8aa3b, v236
v_mfma_f32_16x16x32_bf16 v[68:71], a[160:163], v[200:203], v[68:71]
v_exp_f32 v33, v33
v_mfma_f32_16x16x32_bf16 a[64:67], v[88:91], a[192:195], a[64:67]
ds_read_b128 a[160:163], v216 offset:20480
v_cvt_pk_bf16_f32 v84, v32, v33
v_mfma_f32_16x16x32_bf16 a[80:83], v[88:91], a[196:199], a[80:83]
v_exp_f32 v34, v34
v_mfma_f32_16x16x32_bf16 a[84:87], v[92:95], a[196:199], a[84:87]
buffer_load_dwordx4 v231, s[8:11], s32 offen offset:3072  lds
v_mfma_f32_16x16x32_bf16 a[68:71], v[92:95], a[192:195], a[68:71]
v_exp_f32 v35, v35
v_mfma_f32_16x16x32_bf16 a[72:75], v[96:99], a[192:195], a[72:75]
v_cvt_pk_bf16_f32 v85, v34, v35
v_exp_f32 v236, v236
v_mfma_f32_16x16x32_bf16 a[88:91], v[96:99], a[196:199], a[88:91]
v_add_f32 v236, 1.0, v236
v_exp_f32 v36, v36
v_mfma_f32_16x16x32_bf16 a[92:95], v[100:103], a[196:199], a[92:95]
ds_read_b64_tr_b16 a[196:197], v225 offset:0
ds_read_b64_tr_b16 a[198:199], v225 offset:4096
v_mfma_f32_16x16x32_bf16 a[76:79], v[100:103], a[192:195], a[76:79]
v_exp_f32 v37, v37
v_mfma_f32_16x16x32_bf16 a[108:111], v[100:103], a[200:203], a[108:111]
ds_read_b64_tr_b16 a[192:193], v224 offset:0
v_cvt_pk_bf16_f32 v86, v36, v37
v_mfma_f32_16x16x32_bf16 a[124:127], v[100:103], a[204:207], a[124:127]
v_exp_f32 v38, v38
v_mfma_f32_16x16x32_bf16 a[120:123], v[96:99], a[204:207], a[120:123]
ds_read_b64_tr_b16 a[194:195], v224 offset:4096
v_rcp_f32 v236, v236
v_mfma_f32_16x16x32_bf16 a[104:107], v[96:99], a[200:203], a[104:107]
v_cvt_pk_bf16_f32 v236, v236, v236
v_exp_f32 v39, v39
v_mfma_f32_16x16x32_bf16 a[100:103], v[92:95], a[200:203], a[100:103]
v_cvt_pk_bf16_f32 v87, v38, v39
v_lshlrev_b32 v236, 16, v236
v_mfma_f32_16x16x32_bf16 a[116:119], v[92:95], a[204:207], a[116:119]
s_add_u32 m0, s86, 20480
s_add_u32 s50, s85, 12288
buffer_load_dwordx4 v244, s[72:75], s50 offen lds
v_mfma_f32_16x16x32_bf16 a[112:115], v[88:91], a[204:207], a[112:115]
ds_read_b64_tr_b16 a[204:205], v227 offset:0
ds_read_b64_tr_b16 a[206:207], v227 offset:4096
s_lshr_b32 s28, s37, 1
v_mfma_f32_16x16x32_bf16 a[96:99], v[88:91], a[200:203], a[96:99]
ds_read_b64_tr_b16 a[200:201], v226 offset:0
ds_read_b64_tr_b16 a[202:203], v226 offset:4096
s_mul_i32 s28, s28, 28672
v_smfmac_f32_16x16x64_bf16 a[132:135], a[208:211], v[96:103], v245
s_add_u32 m0, s86, 24576
s_add_u32 s50, s85, 16384
buffer_load_dwordx4 v244, s[72:75], s50 offen lds
s_add_u32 m0, s86, 28672
s_add_u32 s50, s85, 20480
buffer_load_dwordx4 v244, s[72:75], s50 offen lds
s_waitcnt lgkmcnt(8)
v_mfma_f32_16x16x32_bf16 v[8:11], a[144:147], v[152:155], v[136:139]
v_subrev_u32 v241, s28, v241
v_exp_f32 v40, v40
v_mfma_f32_16x16x32_bf16 v[8:11], a[148:151], v[156:159], v[8:11]
v_and_b32 v239, 7, v1
v_exp_f32 v41, v41
v_mfma_f32_16x16x32_bf16 v[8:11], a[152:155], v[160:163], v[8:11]
v_cvt_pk_bf16_f32 v88, v40, v41
v_lshl_add_u32 v239, v4, 3, v239
v_lshlrev_b32 v239, 4, v239
v_mfma_f32_16x16x32_bf16 v[8:11], a[156:159], v[164:167], v[8:11]
v_exp_f32 v42, v42
v_mfma_f32_16x16x32_bf16 v[16:19], a[156:159], v[180:183], v[140:143]
s_add_u32 s39, s39, 16384
v_add_u32 v237, s31, v244
v_mfma_f32_16x16x32_bf16 v[16:19], a[152:155], v[176:179], v[16:19]
v_exp_f32 v43, v43
v_mfma_f32_16x16x32_bf16 v[16:19], a[148:151], v[172:175], v[16:19]
v_cvt_pk_bf16_f32 v89, v42, v43
v_lshl_add_u32 v238, v4, 3, v3
v_mfma_f32_16x16x32_bf16 v[16:19], a[144:147], v[168:171], v[16:19]
v_exp_f32 v44, v44
v_mfma_f32_16x16x32_bf16 v[24:27], a[144:147], v[184:187], v[144:147]
v_lshlrev_b32 v238, 4, v238
v_mov_b32 v246, 0x7ffffff0
v_mfma_f32_16x16x32_bf16 v[24:27], a[148:151], v[188:191], v[24:27]
v_exp_f32 v45, v45
v_mfma_f32_16x16x32_bf16 v[24:27], a[152:155], v[192:195], v[24:27]
s_add_u32 m0, s30, 147456
v_cvt_pk_bf16_f32 v90, v44, v45
v_mfma_f32_16x16x32_bf16 v[24:27], a[156:159], v[196:199], v[24:27]
v_exp_f32 v46, v46
v_mfma_f32_16x16x32_bf16 v[32:35], a[156:159], v[212:215], v[148:151]
ds_read_b128 a[156:159], v219 offset:24576
v_cmp_lt_u32 vcc, 7, v3
v_mfma_f32_16x16x32_bf16 v[32:35], a[152:155], v[208:211], v[32:35]
v_exp_f32 v47, v47
v_mfma_f32_16x16x32_bf16 v[32:35], a[148:151], v[204:207], v[32:35]
ds_read_b128 a[152:155], v218 offset:24576
v_cvt_pk_bf16_f32 v91, v46, v47
v_mfma_f32_16x16x32_bf16 v[32:35], a[144:147], v[200:203], v[32:35]
v_exp_f32 v48, v48
v_mfma_f32_16x16x32_bf16 a[0:3], v[72:75], a[176:179], a[0:3]
ds_read_b128 a[148:151], v217 offset:24576
ds_read_b128 a[144:147], v216 offset:24576
v_mfma_f32_16x16x32_bf16 a[16:19], v[72:75], a[180:183], a[16:19]
v_exp_f32 v49, v49
v_mfma_f32_16x16x32_bf16 a[20:23], v[76:79], a[180:183], a[20:23]
v_cvt_pk_bf16_f32 v92, v48, v49
v_cndmask_b32 v238, v238, v246, vcc
v_mfma_f32_16x16x32_bf16 a[4:7], v[76:79], a[176:179], a[4:7]
v_exp_f32 v50, v50
v_mfma_f32_16x16x32_bf16 a[8:11], v[80:83], a[176:179], a[8:11]
buffer_load_dwordx4 v232, s[12:15], s39 offen offset:0  lds
v_mfma_f32_16x16x32_bf16 a[24:27], v[80:83], a[180:183], a[24:27]
v_exp_f32 v51, v51
v_mfma_f32_16x16x32_bf16 a[28:31], v[84:87], a[180:183], a[28:31]
ds_read_b64_tr_b16 a[180:181], v221 offset:8192
v_cvt_pk_bf16_f32 v93, v50, v51
v_mfma_f32_16x16x32_bf16 a[12:15], v[84:87], a[176:179], a[12:15]
v_exp_f32 v52, v52
v_mfma_f32_16x16x32_bf16 a[44:47], v[84:87], a[184:187], a[44:47]
ds_read_b64_tr_b16 a[182:183], v221 offset:12288
ds_read_b64_tr_b16 a[176:177], v220 offset:8192
v_mfma_f32_16x16x32_bf16 a[60:63], v[84:87], a[188:191], a[60:63]
v_exp_f32 v53, v53
v_mfma_f32_16x16x32_bf16 a[56:59], v[80:83], a[188:191], a[56:59]
ds_read_b64_tr_b16 a[178:179], v220 offset:12288
v_cvt_pk_bf16_f32 v94, v52, v53
v_mfma_f32_16x16x32_bf16 a[40:43], v[80:83], a[184:187], a[40:43]
v_exp_f32 v54, v54
v_mfma_f32_16x16x32_bf16 a[36:39], v[76:79], a[184:187], a[36:39]
buffer_load_dwordx4 v233, s[12:15], s39 offen offset:1024  lds
v_mfma_f32_16x16x32_bf16 a[52:55], v[76:79], a[188:191], a[52:55]
v_exp_f32 v55, v55
v_mfma_f32_16x16x32_bf16 a[48:51], v[72:75], a[188:191], a[48:51]
ds_read_b64_tr_b16 a[188:189], v223 offset:8192
v_cvt_pk_bf16_f32 v95, v54, v55
v_mfma_f32_16x16x32_bf16 a[32:35], v[72:75], a[184:187], a[32:35]
v_exp_f32 v56, v56
STUB_8:
s_cbranch_execz STUB_11
v_smfmac_f32_16x16x64_bf16 a[128:131], a[208:211], v[72:79], v245
ds_read_b64_tr_b16 a[190:191], v223 offset:12288
v_mfma_f32_16x16x32_bf16 v[12:15], a[160:163], v[152:155], v[136:139]
s_mul_i32 s28, s40, 18432
v_exp_f32 v57, v57
v_mfma_f32_16x16x32_bf16 v[12:15], a[164:167], v[156:159], v[12:15]
v_exp_f32 v58, v58
v_mfma_f32_16x16x32_bf16 v[12:15], a[168:171], v[160:163], v[12:15]
ds_read_b64_tr_b16 a[184:185], v222 offset:8192
v_cvt_pk_bf16_f32 v96, v56, v57
v_mfma_f32_16x16x32_bf16 v[12:15], a[172:175], v[164:167], v[12:15]
v_exp_f32 v59, v59
v_mfma_f32_16x16x32_bf16 v[20:23], a[172:175], v[180:183], v[140:143]
ds_read_b64_tr_b16 a[186:187], v222 offset:12288
v_cvt_pk_bf16_f32 v97, v58, v59
v_mfma_f32_16x16x32_bf16 v[20:23], a[168:171], v[176:179], v[20:23]
s_mul_i32 s29, s37, 4608
v_exp_f32 v60, v60
v_mfma_f32_16x16x32_bf16 v[20:23], a[164:167], v[172:175], v[20:23]
buffer_load_dwordx4 v232, s[12:15], s39 offen offset:2048  lds
v_mfma_f32_16x16x32_bf16 v[20:23], a[160:163], v[168:171], v[20:23]
v_exp_f32 v61, v61
v_mfma_f32_16x16x32_bf16 v[28:31], a[160:163], v[184:187], v[144:147]
s_add_u32 s28, s28, s29
v_cvt_pk_bf16_f32 v98, v60, v61
v_mfma_f32_16x16x32_bf16 v[28:31], a[164:167], v[188:191], v[28:31]
v_exp_f32 v62, v62
v_mfma_f32_16x16x32_bf16 v[28:31], a[168:171], v[192:195], v[28:31]
buffer_load_dwordx4 v233, s[12:15], s39 offen offset:3072  lds
v_mfma_f32_16x16x32_bf16 v[28:31], a[172:175], v[196:199], v[28:31]
v_exp_f32 v63, v63
v_mfma_f32_16x16x32_bf16 v[36:39], a[172:175], v[212:215], v[148:151]
ds_read_b128 a[172:175], v219 offset:28672
v_cvt_pk_bf16_f32 v99, v62, v63
v_mfma_f32_16x16x32_bf16 v[36:39], a[168:171], v[208:211], v[36:39]
v_exp_f32 v64, v64
v_mfma_f32_16x16x32_bf16 v[36:39], a[164:167], v[204:207], v[36:39]
ds_read_b128 a[168:171], v218 offset:28672
ds_read_b128 a[164:167], v217 offset:28672
s_add_u32 s28, s28, 0x2000000
v_mfma_f32_16x16x32_bf16 v[36:39], a[160:163], v[200:203], v[36:39]
v_exp_f32 v65, v65
s_waitcnt lgkmcnt(8)
v_mfma_f32_16x16x32_bf16 a[64:67], v[72:75], a[192:195], a[64:67]
ds_read_b128 a[160:163], v216 offset:28672
v_cvt_pk_bf16_f32 v100, v64, v65
v_mfma_f32_16x16x32_bf16 a[80:83], v[72:75], a[196:199], a[80:83]
v_exp_f32 v66, v66
v_mfma_f32_16x16x32_bf16 a[84:87], v[76:79], a[196:199], a[84:87]
s_add_u32 m0, s86, 32768
s_add_u32 s50, s85, 24576
buffer_load_dwordx4 v244, s[72:75], s50 offen lds
v_mfma_f32_16x16x32_bf16 a[68:71], v[76:79], a[192:195], a[68:71]
v_exp_f32 v67, v67
v_mfma_f32_16x16x32_bf16 a[72:75], v[80:83], a[192:195], a[72:75]
s_cmp_lt_u32 s37, 2
s_cselect_b64 s[90:91], -1, 0
v_cvt_pk_bf16_f32 v101, v66, v67
v_mfma_f32_16x16x32_bf16 a[88:91], v[80:83], a[196:199], a[88:91]
v_exp_f32 v68, v68
v_mfma_f32_16x16x32_bf16 a[92:95], v[84:87], a[196:199], a[92:95]
ds_read_b64_tr_b16 a[196:197], v225 offset:8192
ds_read_b64_tr_b16 a[198:199], v225 offset:12288
v_mfma_f32_16x16x32_bf16 a[76:79], v[84:87], a[192:195], a[76:79]
v_exp_f32 v69, v69
v_mfma_f32_16x16x32_bf16 a[108:111], v[84:87], a[200:203], a[108:111]
ds_read_b64_tr_b16 a[192:193], v224 offset:8192
v_cvt_pk_bf16_f32 v102, v68, v69
v_mfma_f32_16x16x32_bf16 a[124:127], v[84:87], a[204:207], a[124:127]
v_exp_f32 v70, v70
v_mfma_f32_16x16x32_bf16 a[120:123], v[80:83], a[204:207], a[120:123]
ds_read_b64_tr_b16 a[194:195], v224 offset:12288
v_mfma_f32_16x16x32_bf16 a[104:107], v[80:83], a[200:203], a[104:107]
v_exp_f32 v71, v71
v_mfma_f32_16x16x32_bf16 a[100:103], v[76:79], a[200:203], a[100:103]
v_cvt_pk_bf16_f32 v103, v70, v71
v_mfma_f32_16x16x32_bf16 a[116:119], v[76:79], a[204:207], a[116:119]
s_add_u32 m0, s86, 36864
s_add_u32 s50, s85, 28672
buffer_load_dwordx4 v244, s[72:75], s50 offen lds
v_mfma_f32_16x16x32_bf16 a[112:115], v[72:75], a[204:207], a[112:115]
ds_read_b64_tr_b16 a[204:205], v227 offset:8192
ds_read_b64_tr_b16 a[206:207], v227 offset:12288
v_mfma_f32_16x16x32_bf16 a[96:99], v[72:75], a[200:203], a[96:99]
ds_read_b64_tr_b16 a[200:201], v226 offset:8192
ds_read_b64_tr_b16 a[202:203], v226 offset:12288
v_smfmac_f32_16x16x64_bf16 a[132:135], a[208:211], v[80:87], v245
s_add_u32 m0, s86, 40960
s_add_u32 s50, s85, 32768
buffer_load_dwordx4 v244, s[72:75], s50 offen lds
v_mfma_f32_16x16x32_bf16 v[40:43], a[144:147], v[152:155], v[136:139]
v_exp_f32 v8, v8
v_mfma_f32_16x16x32_bf16 v[40:43], a[148:151], v[156:159], v[40:43]
v_exp_f32 v9, v9
v_mfma_f32_16x16x32_bf16 v[40:43], a[152:155], v[160:163], v[40:43]
v_cvt_pk_bf16_f32 v72, v8, v9
v_mfma_f32_16x16x32_bf16 v[40:43], a[156:159], v[164:167], v[40:43]
v_exp_f32 v10, v10
v_mfma_f32_16x16x32_bf16 v[48:51], a[156:159], v[180:183], v[140:143]
v_mfma_f32_16x16x32_bf16 v[48:51], a[152:155], v[176:179], v[48:51]
v_exp_f32 v11, v11
v_mfma_f32_16x16x32_bf16 v[48:51], a[148:151], v[172:175], v[48:51]
v_cvt_pk_bf16_f32 v73, v10, v11
v_mfma_f32_16x16x32_bf16 v[48:51], a[144:147], v[168:171], v[48:51]
v_exp_f32 v12, v12
v_mfma_f32_16x16x32_bf16 v[56:59], a[144:147], v[184:187], v[144:147]
v_mfma_f32_16x16x32_bf16 v[56:59], a[148:151], v[188:191], v[56:59]
v_exp_f32 v13, v13
v_mfma_f32_16x16x32_bf16 v[56:59], a[152:155], v[192:195], v[56:59]
v_cvt_pk_bf16_f32 v74, v12, v13
v_mfma_f32_16x16x32_bf16 v[56:59], a[156:159], v[196:199], v[56:59]
v_exp_f32 v14, v14
v_mfma_f32_16x16x32_bf16 v[64:67], a[156:159], v[212:215], v[148:151]
s_waitcnt vmcnt(15) lgkmcnt(0)
s_barrier
v_mfma_f32_16x16x32_bf16 v[64:67], a[152:155], v[208:211], v[64:67]
ds_read_b128 v[124:127], v239 offset:45056
v_exp_f32 v15, v15
v_mfma_f32_16x16x32_bf16 v[64:67], a[148:151], v[204:207], v[64:67]
ds_read_b128 a[156:159], v219 offset:49152
ds_read_b128 v[128:131], v239 offset:45568
v_cvt_pk_bf16_f32 v75, v14, v15
v_mfma_f32_16x16x32_bf16 v[64:67], a[144:147], v[200:203], v[64:67]
ds_read_b128 v[248:251], v239 offset:46080
v_exp_f32 v16, v16
v_mfma_f32_16x16x32_bf16 a[0:3], v[88:91], a[176:179], a[0:3]
ds_read_b128 a[152:155], v218 offset:49152
ds_read_b128 a[148:151], v217 offset:49152
ds_read_b128 v[252:255], v239 offset:46592
v_mfma_f32_16x16x32_bf16 a[16:19], v[88:91], a[180:183], a[16:19]
ds_read_b64_tr_b16 v[116:117], v241 offset:0
v_exp_f32 v17, v17
v_mfma_f32_16x16x32_bf16 a[20:23], v[92:95], a[180:183], a[20:23]
ds_read_b128 a[144:147], v216 offset:49152
ds_read_b64_tr_b16 v[118:119], v241 offset:256
v_cvt_pk_bf16_f32 v76, v16, v17
v_mfma_f32_16x16x32_bf16 a[4:7], v[92:95], a[176:179], a[4:7]
ds_read_b64_tr_b16 v[120:121], v241 offset:2048
v_exp_f32 v18, v18
v_mfma_f32_16x16x32_bf16 a[8:11], v[96:99], a[176:179], a[8:11]
s_add_u32 s32, s32, 16384
ds_read_b64_tr_b16 v[122:123], v241 offset:2304
v_mfma_f32_16x16x32_bf16 a[24:27], v[96:99], a[180:183], a[24:27]
v_exp_f32 v19, v19
v_mfma_f32_16x16x32_bf16 a[28:31], v[100:103], a[180:183], a[28:31]
ds_read_b64_tr_b16 a[180:181], v221 offset:32768
v_cvt_pk_bf16_f32 v77, v18, v19
v_mfma_f32_16x16x32_bf16 a[12:15], v[100:103], a[176:179], a[12:15]
v_exp_f32 v20, v20
v_mfma_f32_16x16x32_bf16 a[44:47], v[100:103], a[184:187], a[44:47]
ds_read_b64_tr_b16 a[182:183], v221 offset:36864
ds_read_b64_tr_b16 a[176:177], v220 offset:32768
v_mfma_f32_16x16x32_bf16 a[60:63], v[100:103], a[188:191], a[60:63]
v_exp_f32 v21, v21
v_mfma_f32_16x16x32_bf16 a[56:59], v[96:99], a[188:191], a[56:59]
ds_read_b64_tr_b16 a[178:179], v220 offset:36864
v_cvt_pk_bf16_f32 v78, v20, v21
s_waitcnt lgkmcnt(8)
v_mfma_f32_16x16x32_bf16 v[132:135], a[212:215], v[124:127], 0
s_add_u32 m0, s30, 81920
ds_read_b128 v[124:127], v239 offset:47104
v_mfma_f32_16x16x32_bf16 a[40:43], v[96:99], a[184:187], a[40:43]
v_exp_f32 v22, v22
v_mfma_f32_16x16x32_bf16 a[36:39], v[92:95], a[184:187], a[36:39]
v_mfma_f32_16x16x32_bf16 v[132:135], a[216:219], v[128:131], v[132:135]
ds_read_b128 v[128:131], v239 offset:47616
v_mfma_f32_16x16x32_bf16 a[52:55], v[92:95], a[188:191], a[52:55]
v_exp_f32 v23, v23
v_mfma_f32_16x16x32_bf16 a[48:51], v[88:91], a[188:191], a[48:51]
ds_read_b64_tr_b16 a[188:189], v223 offset:32768
v_cvt_pk_bf16_f32 v79, v22, v23
v_mfma_f32_16x16x32_bf16 v[132:135], a[220:223], v[248:251], v[132:135]
ds_read_b64_tr_b16 a[190:191], v223 offset:36864
ds_read_b128 v[248:251], v239 offset:48128
v_mfma_f32_16x16x32_bf16 a[32:35], v[88:91], a[184:187], a[32:35]
v_exp_f32 v24, v24
v_smfmac_f32_16x16x64_bf16 a[128:131], a[208:211], v[88:95], v245
ds_read_b64_tr_b16 a[184:185], v222 offset:32768
v_mfma_f32_16x16x32_bf16 v[132:135], a[224:227], v[252:255], v[132:135]
ds_read_b64_tr_b16 a[186:187], v222 offset:36864
ds_read_b128 v[252:255], v239 offset:48640
v_mfma_f32_16x16x32_bf16 v[44:47], a[160:163], v[152:155], v[136:139]
v_exp_f32 v25, v25
v_mfma_f32_16x16x32_bf16 v[44:47], a[164:167], v[156:159], v[44:47]
v_exp_f32 v26, v26
s_waitcnt lgkmcnt(7)
v_mfma_f32_16x16x32_bf16 v[132:135], a[228:231], v[124:127], v[132:135]
ds_read_b128 v[124:127], v239 offset:49152
v_cvt_pk_bf16_f32 v80, v24, v25
v_mfma_f32_16x16x32_bf16 v[44:47], a[168:171], v[160:163], v[44:47]
buffer_load_dwordx4 v228, s[8:11], s32 offen offset:0  lds
v_mfma_f32_16x16x32_bf16 v[44:47], a[172:175], v[164:167], v[44:47]
v_exp_f32 v27, v27
s_waitcnt lgkmcnt(7)
v_mfma_f32_16x16x32_bf16 v[132:135], a[232:235], v[128:131], v[132:135]
ds_read_b128 v[128:131], v239 offset:49664
v_mfma_f32_16x16x32_bf16 v[52:55], a[172:175], v[180:183], v[140:143]
v_cvt_pk_bf16_f32 v81, v26, v27
v_mfma_f32_16x16x32_bf16 v[52:55], a[168:171], v[176:179], v[52:55]
v_exp_f32 v28, v28
s_waitcnt lgkmcnt(5)
v_mfma_f32_16x16x32_bf16 v[132:135], a[236:239], v[248:251], v[132:135]
buffer_load_dwordx4 v229, s[8:11], s32 offen offset:1024  lds
ds_read_b128 v[248:251], v239 offset:50176
v_mfma_f32_16x16x32_bf16 v[52:55], a[164:167], v[172:175], v[52:55]
v_mfma_f32_16x16x32_bf16 v[52:55], a[160:163], v[168:171], v[52:55]
v_exp_f32 v29, v29
s_waitcnt lgkmcnt(3)
v_mfma_f32_16x16x32_bf16 v[132:135], a[240:243], v[252:255], v[132:135]
ds_read_b128 v[252:255], v239 offset:50688
v_mfma_f32_16x16x32_bf16 v[60:63], a[160:163], v[184:187], v[144:147]
v_cvt_pk_bf16_f32 v82, v28, v29
v_mfma_f32_16x16x32_bf16 v[60:63], a[164:167], v[188:191], v[60:63]
v_exp_f32 v30, v30
s_waitcnt lgkmcnt(3)
v_mfma_f32_16x16x32_bf16 v[132:135], a[244:247], v[124:127], v[132:135]
ds_read_b128 v[124:127], v239 offset:51200
v_mfma_f32_16x16x32_bf16 v[60:63], a[168:171], v[192:195], v[60:63]
v_mfma_f32_16x16x32_bf16 v[60:63], a[172:175], v[196:199], v[60:63]
v_exp_f32 v31, v31
s_waitcnt lgkmcnt(3)
v_mfma_f32_16x16x32_bf16 v[132:135], a[248:251], v[128:131], v[132:135]
buffer_load_dwordx4 v230, s[8:11], s32 offen offset:2048  lds
ds_read_b128 v[128:131], v239 offset:51712
v_mfma_f32_16x16x32_bf16 v[68:71], a[172:175], v[212:215], v[148:151]
ds_read_b128 a[172:175], v219 offset:53248
v_cvt_pk_bf16_f32 v83, v30, v31
v_mfma_f32_16x16x32_bf16 v[68:71], a[168:171], v[208:211], v[68:71]
v_exp_f32 v32, v32
s_waitcnt lgkmcnt(4)
v_mfma_f32_16x16x32_bf16 v[132:135], a[252:255], v[248:251], v[132:135]
ds_read_b128 a[168:171], v218 offset:53248
ds_read_b128 v[248:251], v239 offset:52224
v_mfma_f32_16x16x32_bf16 v[68:71], a[164:167], v[204:207], v[68:71]
ds_read_b128 a[164:167], v217 offset:53248
v_mfma_f32_16x16x32_bf16 v[68:71], a[160:163], v[200:203], v[68:71]
v_exp_f32 v33, v33
s_waitcnt lgkmcnt(6)
v_mfma_f32_16x16x32_bf16 v[132:135], a[136:139], v[252:255], v[132:135]
ds_read_b128 a[160:163], v216 offset:53248
ds_read_b128 v[252:255], v239 offset:52736
v_mfma_f32_16x16x32_bf16 a[64:67], v[88:91], a[192:195], a[64:67]
v_cvt_pk_bf16_f32 v84, v32, v33
v_mfma_f32_16x16x32_bf16 a[80:83], v[88:91], a[196:199], a[80:83]
v_exp_f32 v34, v34
s_waitcnt lgkmcnt(7)
v_mfma_f32_16x16x32_bf16 v[132:135], a[140:143], v[124:127], v[132:135]
ds_read_b128 v[124:127], v239 offset:53248
v_mfma_f32_16x16x32_bf16 a[84:87], v[92:95], a[196:199], a[84:87]
buffer_load_dwordx4 v231, s[8:11], s32 offen offset:3072  lds
v_mfma_f32_16x16x32_bf16 a[68:71], v[92:95], a[192:195], a[68:71]
v_exp_f32 v35, v35
s_waitcnt lgkmcnt(7)
v_mfma_f32_16x16x32_bf16 v[132:135], v[104:107], v[128:131], v[132:135]
ds_read_b128 v[128:131], v239 offset:53760
v_mfma_f32_16x16x32_bf16 a[72:75], v[96:99], a[192:195], a[72:75]
v_cvt_pk_bf16_f32 v85, v34, v35
v_mfma_f32_16x16x32_bf16 a[88:91], v[96:99], a[196:199], a[88:91]
v_exp_f32 v36, v36
s_waitcnt lgkmcnt(5)
v_mfma_f32_16x16x32_bf16 v[132:135], v[108:111], v[248:251], v[132:135]
v_mfma_f32_16x16x32_bf16 a[92:95], v[100:103], a[196:199], a[92:95]
ds_read_b64_tr_b16 a[196:197], v225 offset:32768
ds_read_b64_tr_b16 a[198:199], v225 offset:36864
v_mfma_f32_16x16x32_bf16 a[76:79], v[100:103], a[192:195], a[76:79]
v_exp_f32 v37, v37
s_waitcnt lgkmcnt(4)
v_mfma_f32_16x16x32_bf16 v[132:135], v[112:115], v[252:255], v[132:135]
ds_read_b64_tr_b16 a[192:193], v224 offset:32768
ds_read_b64_tr_b16 a[194:195], v224 offset:36864
v_mfma_f32_16x16x32_bf16 a[108:111], v[100:103], a[200:203], a[108:111]
v_cvt_pk_bf16_f32 v86, v36, v37
v_mfma_f32_16x16x32_bf16 a[124:127], v[100:103], a[204:207], a[124:127]
v_exp_f32 v38, v38
s_waitcnt lgkmcnt(5)
v_mfma_f32_16x16x32_bf16 v[132:135], v[116:119], v[124:127], v[132:135]
v_mfma_f32_16x16x32_bf16 a[120:123], v[96:99], a[204:207], a[120:123]
v_mfma_f32_16x16x32_bf16 a[104:107], v[96:99], a[200:203], a[104:107]
v_exp_f32 v39, v39
s_waitcnt lgkmcnt(4)
v_mfma_f32_16x16x32_bf16 v[132:135], v[120:123], v[128:131], v[132:135]
v_mfma_f32_16x16x32_bf16 a[100:103], v[92:95], a[200:203], a[100:103]
v_cvt_pk_bf16_f32 v87, v38, v39
v_mfma_f32_16x16x32_bf16 a[116:119], v[92:95], a[204:207], a[116:119]
v_mfma_f32_16x16x32_bf16 a[112:115], v[88:91], a[204:207], a[112:115]
ds_read_b64_tr_b16 a[204:205], v227 offset:32768
ds_read_b64_tr_b16 a[206:207], v227 offset:36864
v_mfma_f32_16x16x32_bf16 a[96:99], v[88:91], a[200:203], a[96:99]
ds_read_b64_tr_b16 a[200:201], v226 offset:32768
ds_read_b64_tr_b16 a[202:203], v226 offset:36864
v_smfmac_f32_16x16x64_bf16 a[132:135], a[208:211], v[96:103], v245
v_mfma_f32_16x16x32_bf16 v[8:11], a[144:147], v[152:155], v[136:139]
v_exp_f32 v40, v40
v_mfma_f32_16x16x32_bf16 v[8:11], a[148:151], v[156:159], v[8:11]
v_exp_f32 v41, v41
v_mfma_f32_16x16x32_bf16 v[8:11], a[152:155], v[160:163], v[8:11]
v_cvt_pk_bf16_f32 v88, v40, v41
v_cvt_pk_bf16_f32 v104, v132, v133
v_cvt_pk_bf16_f32 v105, v134, v135
v_mfma_f32_16x16x32_bf16 v[8:11], a[156:159], v[164:167], v[8:11]
v_lshlrev_b32 v132, 16, v104
v_exp_f32 v42, v42
v_mfma_f32_16x16x32_bf16 v[16:19], a[156:159], v[180:183], v[140:143]
s_add_u32 s39, s39, 16384
v_and_b32 v133, 0xffff0000, v104
v_lshlrev_b32 v134, 16, v105
v_mfma_f32_16x16x32_bf16 v[16:19], a[152:155], v[176:179], v[16:19]
v_and_b32 v135, 0xffff0000, v105
v_exp_f32 v43, v43
v_mfma_f32_16x16x32_bf16 v[16:19], a[148:151], v[172:175], v[16:19]
v_cvt_pk_bf16_f32 v89, v42, v43
v_mul_f32 v104, 0xbfb8aa3b, v132
v_mul_f32 v105, 0xbfb8aa3b, v133
v_mfma_f32_16x16x32_bf16 v[16:19], a[144:147], v[168:171], v[16:19]
v_mul_f32 v106, 0xbfb8aa3b, v134
v_exp_f32 v44, v44
v_mfma_f32_16x16x32_bf16 v[24:27], a[144:147], v[184:187], v[144:147]
v_mul_f32 v107, 0xbfb8aa3b, v135
v_exp_f32 v104, v104
v_mfma_f32_16x16x32_bf16 v[24:27], a[148:151], v[188:191], v[24:27]
v_exp_f32 v45, v45
v_mfma_f32_16x16x32_bf16 v[24:27], a[152:155], v[192:195], v[24:27]
v_cvt_pk_bf16_f32 v90, v44, v45
v_exp_f32 v105, v105
v_mfma_f32_16x16x32_bf16 v[24:27], a[156:159], v[196:199], v[24:27]
v_exp_f32 v46, v46
v_mfma_f32_16x16x32_bf16 v[32:35], a[156:159], v[212:215], v[148:151]
ds_read_b128 a[156:159], v219 offset:57344
s_add_u32 m0, s30, 98304
v_mfma_f32_16x16x32_bf16 v[32:35], a[152:155], v[208:211], v[32:35]
v_exp_f32 v47, v47
v_mfma_f32_16x16x32_bf16 v[32:35], a[148:151], v[204:207], v[32:35]
ds_read_b128 a[152:155], v218 offset:57344
v_cvt_pk_bf16_f32 v91, v46, v47
v_mfma_f32_16x16x32_bf16 v[32:35], a[144:147], v[200:203], v[32:35]
v_exp_f32 v48, v48
v_mfma_f32_16x16x32_bf16 a[0:3], v[72:75], a[176:179], a[0:3]
ds_read_b128 a[148:151], v217 offset:57344
ds_read_b128 a[144:147], v216 offset:57344
v_mfma_f32_16x16x32_bf16 a[16:19], v[72:75], a[180:183], a[16:19]
v_exp_f32 v49, v49
v_mfma_f32_16x16x32_bf16 a[20:23], v[76:79], a[180:183], a[20:23]
v_cvt_pk_bf16_f32 v92, v48, v49
v_exp_f32 v106, v106
v_mfma_f32_16x16x32_bf16 a[4:7], v[76:79], a[176:179], a[4:7]
v_exp_f32 v50, v50
v_mfma_f32_16x16x32_bf16 a[8:11], v[80:83], a[176:179], a[8:11]
v_exp_f32 v107, v107
v_mfma_f32_16x16x32_bf16 a[24:27], v[80:83], a[180:183], a[24:27]
v_add_f32 v104, 1.0, v104
v_exp_f32 v51, v51
v_mfma_f32_16x16x32_bf16 a[28:31], v[84:87], a[180:183], a[28:31]
ds_read_b64_tr_b16 a[180:181], v221 offset:40960
v_cvt_pk_bf16_f32 v93, v50, v51
v_add_f32 v105, 1.0, v105
v_mfma_f32_16x16x32_bf16 a[12:15], v[84:87], a[176:179], a[12:15]
v_add_f32 v106, 1.0, v106
v_exp_f32 v52, v52
v_mfma_f32_16x16x32_bf16 a[44:47], v[84:87], a[184:187], a[44:47]
ds_read_b64_tr_b16 a[182:183], v221 offset:45056
ds_read_b64_tr_b16 a[176:177], v220 offset:40960
v_add_f32 v107, 1.0, v107
v_mfma_f32_16x16x32_bf16 a[60:63], v[84:87], a[188:191], a[60:63]
v_exp_f32 v53, v53
v_mfma_f32_16x16x32_bf16 a[56:59], v[80:83], a[188:191], a[56:59]
ds_read_b64_tr_b16 a[178:179], v220 offset:45056
v_cvt_pk_bf16_f32 v94, v52, v53
v_mfma_f32_16x16x32_bf16 a[40:43], v[80:83], a[184:187], a[40:43]
v_exp_f32 v54, v54
v_mfma_f32_16x16x32_bf16 a[36:39], v[76:79], a[184:187], a[36:39]
buffer_load_dwordx4 v232, s[12:15], s39 offen offset:0  lds
v_mfma_f32_16x16x32_bf16 a[52:55], v[76:79], a[188:191], a[52:55]
v_exp_f32 v55, v55
v_mfma_f32_16x16x32_bf16 a[48:51], v[72:75], a[188:191], a[48:51]
ds_read_b64_tr_b16 a[188:189], v223 offset:40960
v_cvt_pk_bf16_f32 v95, v54, v55
v_mfma_f32_16x16x32_bf16 a[32:35], v[72:75], a[184:187], a[32:35]
v_exp_f32 v56, v56
v_smfmac_f32_16x16x64_bf16 a[128:131], a[208:211], v[72:79], v245
ds_read_b64_tr_b16 a[190:191], v223 offset:45056
v_mfma_f32_16x16x32_bf16 v[12:15], a[160:163], v[152:155], v[136:139]
v_exp_f32 v57, v57
v_mfma_f32_16x16x32_bf16 v[12:15], a[164:167], v[156:159], v[12:15]
v_exp_f32 v58, v58
v_mfma_f32_16x16x32_bf16 v[12:15], a[168:171], v[160:163], v[12:15]
ds_read_b64_tr_b16 a[184:185], v222 offset:40960
v_cvt_pk_bf16_f32 v96, v56, v57
v_mfma_f32_16x16x32_bf16 v[12:15], a[172:175], v[164:167], v[12:15]
v_exp_f32 v59, v59
v_mfma_f32_16x16x32_bf16 v[20:23], a[172:175], v[180:183], v[140:143]
ds_read_b64_tr_b16 a[186:187], v222 offset:45056
v_cvt_pk_bf16_f32 v97, v58, v59
v_mfma_f32_16x16x32_bf16 v[20:23], a[168:171], v[176:179], v[20:23]
v_exp_f32 v60, v60
v_mfma_f32_16x16x32_bf16 v[20:23], a[164:167], v[172:175], v[20:23]
buffer_load_dwordx4 v233, s[12:15], s39 offen offset:1024  lds
v_mfma_f32_16x16x32_bf16 v[20:23], a[160:163], v[168:171], v[20:23]
v_exp_f32 v61, v61
v_mfma_f32_16x16x32_bf16 v[28:31], a[160:163], v[184:187], v[144:147]
v_cvt_pk_bf16_f32 v98, v60, v61
v_rcp_f32 v104, v104
v_mfma_f32_16x16x32_bf16 v[28:31], a[164:167], v[188:191], v[28:31]
v_exp_f32 v62, v62
v_mfma_f32_16x16x32_bf16 v[28:31], a[168:171], v[192:195], v[28:31]
buffer_load_dwordx4 v232, s[12:15], s39 offen offset:2048  lds
v_mfma_f32_16x16x32_bf16 v[28:31], a[172:175], v[196:199], v[28:31]
v_exp_f32 v63, v63
v_mfma_f32_16x16x32_bf16 v[36:39], a[172:175], v[212:215], v[148:151]
ds_read_b128 a[172:175], v219 offset:61440
v_cvt_pk_bf16_f32 v99, v62, v63
v_mfma_f32_16x16x32_bf16 v[36:39], a[168:171], v[208:211], v[36:39]
v_exp_f32 v64, v64
v_mfma_f32_16x16x32_bf16 v[36:39], a[164:167], v[204:207], v[36:39]
ds_read_b128 a[168:171], v218 offset:61440
ds_read_b128 a[164:167], v217 offset:61440
v_mfma_f32_16x16x32_bf16 v[36:39], a[160:163], v[200:203], v[36:39]
v_exp_f32 v65, v65
s_waitcnt lgkmcnt(8)
v_mfma_f32_16x16x32_bf16 a[64:67], v[72:75], a[192:195], a[64:67]
ds_read_b128 a[160:163], v216 offset:61440
v_cvt_pk_bf16_f32 v100, v64, v65
v_mfma_f32_16x16x32_bf16 a[80:83], v[72:75], a[196:199], a[80:83]
v_exp_f32 v66, v66
v_mfma_f32_16x16x32_bf16 a[84:87], v[76:79], a[196:199], a[84:87]
buffer_load_dwordx4 v233, s[12:15], s39 offen offset:3072  lds
v_mfma_f32_16x16x32_bf16 a[68:71], v[76:79], a[192:195], a[68:71]
v_exp_f32 v67, v67
v_mfma_f32_16x16x32_bf16 a[72:75], v[80:83], a[192:195], a[72:75]
v_cvt_pk_bf16_f32 v101, v66, v67
v_rcp_f32 v105, v105
v_mfma_f32_16x16x32_bf16 a[88:91], v[80:83], a[196:199], a[88:91]
v_exp_f32 v68, v68
v_mfma_f32_16x16x32_bf16 a[92:95], v[84:87], a[196:199], a[92:95]
ds_read_b64_tr_b16 a[196:197], v225 offset:40960
ds_read_b64_tr_b16 a[198:199], v225 offset:45056
v_mfma_f32_16x16x32_bf16 a[76:79], v[84:87], a[192:195], a[76:79]
v_exp_f32 v69, v69
v_mfma_f32_16x16x32_bf16 a[108:111], v[84:87], a[200:203], a[108:111]
ds_read_b64_tr_b16 a[192:193], v224 offset:40960
v_cvt_pk_bf16_f32 v102, v68, v69
v_mfma_f32_16x16x32_bf16 a[124:127], v[84:87], a[204:207], a[124:127]
v_exp_f32 v70, v70
v_mfma_f32_16x16x32_bf16 a[120:123], v[80:83], a[204:207], a[120:123]
ds_read_b64_tr_b16 a[194:195], v224 offset:45056
v_rcp_f32 v106, v106
v_mfma_f32_16x16x32_bf16 a[104:107], v[80:83], a[200:203], a[104:107]
v_exp_f32 v71, v71
v_mfma_f32_16x16x32_bf16 a[100:103], v[76:79], a[200:203], a[100:103]
v_cvt_pk_bf16_f32 v103, v70, v71
v_rcp_f32 v107, v107
v_mfma_f32_16x16x32_bf16 a[116:119], v[76:79], a[204:207], a[116:119]
v_mul_f32 v104, v132, v104
v_mul_f32 v105, v133, v105
v_mul_f32 v106, v134, v106
v_mfma_f32_16x16x32_bf16 a[112:115], v[72:75], a[204:207], a[112:115]
ds_read_b64_tr_b16 a[204:205], v227 offset:40960
ds_read_b64_tr_b16 a[206:207], v227 offset:45056
v_mul_f32 v107, v135, v107
v_mfma_f32_16x16x32_bf16 a[96:99], v[72:75], a[200:203], a[96:99]
ds_read_b64_tr_b16 a[200:201], v226 offset:40960
ds_read_b64_tr_b16 a[202:203], v226 offset:45056
v_cvt_pk_bf16_f32 v108, v104, v105
v_smfmac_f32_16x16x64_bf16 a[132:135], a[208:211], v[80:87], v245
v_cvt_pk_bf16_f32 v109, v106, v107
v_lshlrev_b32 v104, 16, v108
v_and_b32 v105, 0xffff0000, v108
v_lshlrev_b32 v106, 16, v109
v_and_b32 v107, 0xffff0000, v109
v_cndmask_b32 v132, v132, v104, s[90:91]
v_cndmask_b32 v133, v133, v105, s[90:91]
v_cndmask_b32 v134, v134, v106, s[90:91]
v_cndmask_b32 v135, v135, v107, s[90:91]
ds_write_b128 v237, v[132:135] offset:54272
v_mfma_f32_16x16x32_bf16 v[40:43], a[144:147], v[152:155], v[136:139]
v_exp_f32 v8, v8
v_mfma_f32_16x16x32_bf16 v[40:43], a[148:151], v[156:159], v[40:43]
v_exp_f32 v9, v9
v_mfma_f32_16x16x32_bf16 v[40:43], a[152:155], v[160:163], v[40:43]
v_cvt_pk_bf16_f32 v72, v8, v9
v_mfma_f32_16x16x32_bf16 v[40:43], a[156:159], v[164:167], v[40:43]
v_exp_f32 v10, v10
v_mfma_f32_16x16x32_bf16 v[48:51], a[156:159], v[180:183], v[140:143]
v_mfma_f32_16x16x32_bf16 v[48:51], a[152:155], v[176:179], v[48:51]
v_exp_f32 v11, v11
v_mfma_f32_16x16x32_bf16 v[48:51], a[148:151], v[172:175], v[48:51]
v_cvt_pk_bf16_f32 v73, v10, v11
v_mfma_f32_16x16x32_bf16 v[48:51], a[144:147], v[168:171], v[48:51]
v_exp_f32 v12, v12
v_mfma_f32_16x16x32_bf16 v[56:59], a[144:147], v[184:187], v[144:147]
v_mfma_f32_16x16x32_bf16 v[56:59], a[148:151], v[188:191], v[56:59]
v_exp_f32 v13, v13
v_mfma_f32_16x16x32_bf16 v[56:59], a[152:155], v[192:195], v[56:59]
v_cvt_pk_bf16_f32 v74, v12, v13
v_mfma_f32_16x16x32_bf16 v[56:59], a[156:159], v[196:199], v[56:59]
v_exp_f32 v14, v14
v_mfma_f32_16x16x32_bf16 v[64:67], a[156:159], v[212:215], v[148:151]
s_waitcnt vmcnt(8) lgkmcnt(0)
s_barrier
v_mfma_f32_16x16x32_bf16 v[64:67], a[152:155], v[208:211], v[64:67]
ds_read_b128 v[104:107], v244 offset:54272
v_exp_f32 v15, v15
v_mfma_f32_16x16x32_bf16 v[64:67], a[148:151], v[204:207], v[64:67]
ds_read_b128 a[156:159], v219 offset:0
ds_read_b128 v[108:111], v244 offset:55296
v_cvt_pk_bf16_f32 v75, v14, v15
v_mfma_f32_16x16x32_bf16 v[64:67], a[144:147], v[200:203], v[64:67]
ds_read_b128 v[112:115], v244 offset:56320
v_exp_f32 v16, v16
v_mfma_f32_16x16x32_bf16 a[0:3], v[88:91], a[176:179], a[0:3]
ds_read_b128 a[152:155], v218 offset:0
ds_read_b128 a[148:151], v217 offset:0
ds_read_b128 v[116:119], v244 offset:57344
v_mfma_f32_16x16x32_bf16 a[16:19], v[88:91], a[180:183], a[16:19]
ds_read_b64_tr_b16 a[212:213], v242 offset:0
v_exp_f32 v17, v17
v_mfma_f32_16x16x32_bf16 a[20:23], v[92:95], a[180:183], a[20:23]
ds_read_b128 a[144:147], v216 offset:0
ds_read_b64_tr_b16 a[214:215], v242 offset:18432
v_cvt_pk_bf16_f32 v76, v16, v17
v_mfma_f32_16x16x32_bf16 a[4:7], v[92:95], a[176:179], a[4:7]
ds_read_b64_tr_b16 a[216:217], v242 offset:32
v_exp_f32 v18, v18
v_mfma_f32_16x16x32_bf16 a[8:11], v[96:99], a[176:179], a[8:11]
s_add_u32 s32, s32, 16384
ds_read_b64_tr_b16 a[218:219], v242 offset:18464
ds_read_b64_tr_b16 a[220:221], v242 offset:64
v_mfma_f32_16x16x32_bf16 a[24:27], v[96:99], a[180:183], a[24:27]
ds_read_b64_tr_b16 a[222:223], v242 offset:18496
v_exp_f32 v19, v19
v_mfma_f32_16x16x32_bf16 a[28:31], v[100:103], a[180:183], a[28:31]
ds_read_b64_tr_b16 a[180:181], v221 offset:49152
ds_read_b64_tr_b16 a[224:225], v242 offset:96
v_cvt_pk_bf16_f32 v77, v18, v19
v_mfma_f32_16x16x32_bf16 a[12:15], v[100:103], a[176:179], a[12:15]
ds_read_b64_tr_b16 a[226:227], v242 offset:18528
v_exp_f32 v20, v20
v_mfma_f32_16x16x32_bf16 a[44:47], v[100:103], a[184:187], a[44:47]
ds_read_b64_tr_b16 a[182:183], v221 offset:53248
ds_read_b64_tr_b16 a[176:177], v220 offset:49152
ds_read_b64_tr_b16 a[228:229], v242 offset:128
v_mfma_f32_16x16x32_bf16 a[60:63], v[100:103], a[188:191], a[60:63]
ds_read_b64_tr_b16 a[230:231], v242 offset:18560
v_exp_f32 v21, v21
v_mfma_f32_16x16x32_bf16 a[56:59], v[96:99], a[188:191], a[56:59]
ds_read_b64_tr_b16 a[178:179], v220 offset:53248
ds_read_b64_tr_b16 a[232:233], v242 offset:160
v_cvt_pk_bf16_f32 v78, v20, v21
v_mfma_f32_16x16x32_bf16 a[40:43], v[96:99], a[184:187], a[40:43]
ds_read_b64_tr_b16 a[234:235], v242 offset:18592
v_exp_f32 v22, v22
v_mfma_f32_16x16x32_bf16 a[36:39], v[92:95], a[184:187], a[36:39]
s_add_u32 m0, s30, 114688
ds_read_b64_tr_b16 a[236:237], v242 offset:192
ds_read_b64_tr_b16 a[238:239], v242 offset:18624
v_mfma_f32_16x16x32_bf16 a[52:55], v[92:95], a[188:191], a[52:55]
ds_read_b64_tr_b16 a[240:241], v242 offset:224
v_exp_f32 v23, v23
v_mfma_f32_16x16x32_bf16 a[48:51], v[88:91], a[188:191], a[48:51]
ds_read_b64_tr_b16 a[188:189], v223 offset:49152
ds_read_b64_tr_b16 a[242:243], v242 offset:18656
v_cvt_pk_bf16_f32 v79, v22, v23
v_mfma_f32_16x16x32_bf16 a[32:35], v[88:91], a[184:187], a[32:35]
ds_read_b64_tr_b16 a[244:245], v242 offset:256
v_exp_f32 v24, v24
v_smfmac_f32_16x16x64_bf16 a[128:131], a[208:211], v[88:95], v245
ds_read_b64_tr_b16 a[190:191], v223 offset:53248
ds_read_b64_tr_b16 a[246:247], v242 offset:18688
v_mfma_f32_16x16x32_bf16 v[44:47], a[160:163], v[152:155], v[136:139]
s_waitcnt lgkmcnt(8)
v_mul_f32 v104, v104, v112
v_exp_f32 v25, v25
v_mfma_f32_16x16x32_bf16 v[44:47], a[164:167], v[156:159], v[44:47]
v_mul_f32 v105, v105, v113
v_exp_f32 v26, v26
v_mfma_f32_16x16x32_bf16 v[44:47], a[168:171], v[160:163], v[44:47]
ds_read_b64_tr_b16 a[184:185], v222 offset:49152
v_cvt_pk_bf16_f32 v80, v24, v25
v_mul_f32 v106, v106, v114
v_mfma_f32_16x16x32_bf16 v[44:47], a[172:175], v[164:167], v[44:47]
v_mul_f32 v107, v107, v115
v_exp_f32 v27, v27
v_mfma_f32_16x16x32_bf16 v[52:55], a[172:175], v[180:183], v[140:143]
ds_read_b64_tr_b16 a[186:187], v222 offset:53248
v_cvt_pk_bf16_f32 v81, v26, v27
v_mul_f32 v108, v108, v116
v_mfma_f32_16x16x32_bf16 v[52:55], a[168:171], v[176:179], v[52:55]
STUB_9:
s_cbranch_execz STUB_12
v_mul_f32 v109, v109, v117
v_exp_f32 v28, v28
v_mfma_f32_16x16x32_bf16 v[52:55], a[164:167], v[172:175], v[52:55]
buffer_load_dwordx4 v228, s[8:11], s32 offen offset:0  lds
v_mul_f32 v110, v110, v118
v_mfma_f32_16x16x32_bf16 v[52:55], a[160:163], v[168:171], v[52:55]
v_mul_f32 v111, v111, v119
v_exp_f32 v29, v29
v_mfma_f32_16x16x32_bf16 v[60:63], a[160:163], v[184:187], v[144:147]
v_cvt_pk_bf16_f32 v82, v28, v29
v_cvt_pk_bf16_f32 v120, v104, v105
v_cvt_pk_bf16_f32 v121, v106, v107
v_mfma_f32_16x16x32_bf16 v[60:63], a[164:167], v[188:191], v[60:63]
v_cvt_pk_bf16_f32 v122, v108, v109
v_exp_f32 v30, v30
v_mfma_f32_16x16x32_bf16 v[60:63], a[168:171], v[192:195], v[60:63]
buffer_load_dwordx4 v229, s[8:11], s32 offen offset:1024  lds
v_cvt_pk_bf16_f32 v123, v110, v111
v_mfma_f32_16x16x32_bf16 v[60:63], a[172:175], v[196:199], v[60:63]
v_exp_f32 v31, v31
v_mfma_f32_16x16x32_bf16 v[68:71], a[172:175], v[212:215], v[148:151]
ds_read_b128 a[172:175], v219 offset:4096
v_cvt_pk_bf16_f32 v83, v30, v31
v_mfma_f32_16x16x32_bf16 a[248:251], a[212:215], v[120:123], 0
buffer_load_dwordx4 v230, s[8:11], s32 offen offset:2048  lds
v_mfma_f32_16x16x32_bf16 v[68:71], a[168:171], v[208:211], v[68:71]
v_exp_f32 v32, v32
v_mfma_f32_16x16x32_bf16 a[212:215], a[216:219], v[120:123], 0
ds_read_b128 a[168:171], v218 offset:4096
v_mfma_f32_16x16x32_bf16 v[68:71], a[164:167], v[204:207], v[68:71]
ds_read_b128 a[164:167], v217 offset:4096
v_mfma_f32_16x16x32_bf16 a[216:219], a[220:223], v[120:123], 0
v_mfma_f32_16x16x32_bf16 v[68:71], a[160:163], v[200:203], v[68:71]
v_exp_f32 v33, v33
v_mfma_f32_16x16x32_bf16 a[220:223], a[224:227], v[120:123], 0
ds_read_b128 a[160:163], v216 offset:4096
v_mfma_f32_16x16x32_bf16 a[64:67], v[88:91], a[192:195], a[64:67]
v_cvt_pk_bf16_f32 v84, v32, v33
v_mfma_f32_16x16x32_bf16 a[224:227], a[228:231], v[120:123], 0
v_mfma_f32_16x16x32_bf16 a[80:83], v[88:91], a[196:199], a[80:83]
v_exp_f32 v34, v34
v_mfma_f32_16x16x32_bf16 a[228:231], a[232:235], v[120:123], 0
v_mfma_f32_16x16x32_bf16 a[84:87], v[92:95], a[196:199], a[84:87]
buffer_load_dwordx4 v231, s[8:11], s32 offen offset:3072  lds
s_waitcnt lgkmcnt(8)
v_mfma_f32_16x16x32_bf16 a[232:235], a[236:239], v[120:123], 0
v_mfma_f32_16x16x32_bf16 a[68:71], v[92:95], a[192:195], a[68:71]
v_exp_f32 v35, v35
v_mfma_f32_16x16x32_bf16 a[236:239], a[240:243], v[120:123], 0
v_mfma_f32_16x16x32_bf16 a[72:75], v[96:99], a[192:195], a[72:75]
v_cvt_pk_bf16_f32 v85, v34, v35
s_waitcnt lgkmcnt(6)
v_mfma_f32_16x16x32_bf16 a[240:243], a[244:247], v[120:123], 0
v_mfma_f32_16x16x32_bf16 a[88:91], v[96:99], a[196:199], a[88:91]
v_exp_f32 v36, v36
v_mfma_f32_16x16x32_bf16 a[92:95], v[100:103], a[196:199], a[92:95]
ds_read_b64_tr_b16 a[196:197], v225 offset:49152
ds_read_b64_tr_b16 a[198:199], v225 offset:53248
v_mfma_f32_16x16x32_bf16 a[76:79], v[100:103], a[192:195], a[76:79]
v_exp_f32 v37, v37
v_mfma_f32_16x16x32_bf16 a[108:111], v[100:103], a[200:203], a[108:111]
ds_read_b64_tr_b16 a[192:193], v224 offset:49152
v_cvt_pk_bf16_f32 v86, v36, v37
v_mfma_f32_16x16x32_bf16 a[124:127], v[100:103], a[204:207], a[124:127]
v_exp_f32 v38, v38
v_mfma_f32_16x16x32_bf16 a[120:123], v[96:99], a[204:207], a[120:123]
ds_read_b64_tr_b16 a[194:195], v224 offset:53248
v_mfma_f32_16x16x32_bf16 a[104:107], v[96:99], a[200:203], a[104:107]
v_exp_f32 v39, v39
v_mfma_f32_16x16x32_bf16 a[100:103], v[92:95], a[200:203], a[100:103]
buffer_store_dwordx4 a[248:251], v238, s[20:23], s28 offen offset:0 sc0 sc1
v_cvt_pk_bf16_f32 v87, v38, v39
v_mfma_f32_16x16x32_bf16 a[116:119], v[92:95], a[204:207], a[116:119]
v_mfma_f32_16x16x32_bf16 a[112:115], v[88:91], a[204:207], a[112:115]
ds_read_b64_tr_b16 a[204:205], v227 offset:49152
ds_read_b64_tr_b16 a[206:207], v227 offset:53248
v_mfma_f32_16x16x32_bf16 a[96:99], v[88:91], a[200:203], a[96:99]
ds_read_b64_tr_b16 a[200:201], v226 offset:49152
ds_read_b64_tr_b16 a[202:203], v226 offset:53248
v_smfmac_f32_16x16x64_bf16 a[132:135], a[208:211], v[96:103], v245
buffer_store_dwordx4 a[212:215], v238, s[20:23], s28 offen offset:512 sc0 sc1
v_mfma_f32_16x16x32_bf16 v[8:11], a[144:147], v[152:155], v[136:139]
v_exp_f32 v40, v40
v_mfma_f32_16x16x32_bf16 v[8:11], a[148:151], v[156:159], v[8:11]
v_exp_f32 v41, v41
v_mfma_f32_16x16x32_bf16 v[8:11], a[152:155], v[160:163], v[8:11]
buffer_store_dwordx4 a[216:219], v238, s[20:23], s28 offen offset:1024 sc0 sc1
v_cvt_pk_bf16_f32 v88, v40, v41
v_mfma_f32_16x16x32_bf16 v[8:11], a[156:159], v[164:167], v[8:11]
v_exp_f32 v42, v42
v_mfma_f32_16x16x32_bf16 v[16:19], a[156:159], v[180:183], v[140:143]
s_add_u32 s39, s39, 16384
buffer_store_dwordx4 a[220:223], v238, s[20:23], s28 offen offset:1536 sc0 sc1
v_mfma_f32_16x16x32_bf16 v[16:19], a[152:155], v[176:179], v[16:19]
v_exp_f32 v43, v43
v_mfma_f32_16x16x32_bf16 v[16:19], a[148:151], v[172:175], v[16:19]
v_cvt_pk_bf16_f32 v89, v42, v43
v_mfma_f32_16x16x32_bf16 v[16:19], a[144:147], v[168:171], v[16:19]
v_exp_f32 v44, v44
v_mfma_f32_16x16x32_bf16 v[24:27], a[144:147], v[184:187], v[144:147]
buffer_store_dwordx4 a[224:227], v238, s[20:23], s28 offen offset:2048 sc0 sc1
v_mfma_f32_16x16x32_bf16 v[24:27], a[148:151], v[188:191], v[24:27]
v_exp_f32 v45, v45
v_mfma_f32_16x16x32_bf16 v[24:27], a[152:155], v[192:195], v[24:27]
v_cvt_pk_bf16_f32 v90, v44, v45
v_mfma_f32_16x16x32_bf16 v[24:27], a[156:159], v[196:199], v[24:27]
v_exp_f32 v46, v46
v_mfma_f32_16x16x32_bf16 v[32:35], a[156:159], v[212:215], v[148:151]
ds_read_b128 a[156:159], v219 offset:8192
s_add_u32 m0, s30, 131072
v_mfma_f32_16x16x32_bf16 v[32:35], a[152:155], v[208:211], v[32:35]
v_exp_f32 v47, v47
v_mfma_f32_16x16x32_bf16 v[32:35], a[148:151], v[204:207], v[32:35]
ds_read_b128 a[152:155], v218 offset:8192
v_cvt_pk_bf16_f32 v91, v46, v47
v_mfma_f32_16x16x32_bf16 v[32:35], a[144:147], v[200:203], v[32:35]
v_exp_f32 v48, v48
v_mfma_f32_16x16x32_bf16 a[0:3], v[72:75], a[176:179], a[0:3]
ds_read_b128 a[148:151], v217 offset:8192
ds_read_b128 a[144:147], v216 offset:8192
v_mfma_f32_16x16x32_bf16 a[16:19], v[72:75], a[180:183], a[16:19]
v_exp_f32 v49, v49
v_mfma_f32_16x16x32_bf16 a[20:23], v[76:79], a[180:183], a[20:23]
v_cvt_pk_bf16_f32 v92, v48, v49
v_mfma_f32_16x16x32_bf16 a[4:7], v[76:79], a[176:179], a[4:7]
v_exp_f32 v50, v50
v_mfma_f32_16x16x32_bf16 a[8:11], v[80:83], a[176:179], a[8:11]
buffer_store_dwordx4 a[228:231], v238, s[20:23], s28 offen offset:2560 sc0 sc1
v_mfma_f32_16x16x32_bf16 a[24:27], v[80:83], a[180:183], a[24:27]
v_exp_f32 v51, v51
v_mfma_f32_16x16x32_bf16 a[28:31], v[84:87], a[180:183], a[28:31]
ds_read_b64_tr_b16 a[180:181], v221 offset:57344
v_cvt_pk_bf16_f32 v93, v50, v51
v_mfma_f32_16x16x32_bf16 a[12:15], v[84:87], a[176:179], a[12:15]
v_exp_f32 v52, v52
s_waitcnt lgkmcnt(8)
v_mfma_f32_16x16x32_bf16 a[44:47], v[84:87], a[184:187], a[44:47]
ds_read_b64_tr_b16 a[182:183], v221 offset:61440
ds_read_b64_tr_b16 a[176:177], v220 offset:57344
v_mfma_f32_16x16x32_bf16 a[60:63], v[84:87], a[188:191], a[60:63]
v_exp_f32 v53, v53
v_mfma_f32_16x16x32_bf16 a[56:59], v[80:83], a[188:191], a[56:59]
ds_read_b64_tr_b16 a[178:179], v220 offset:61440
v_cvt_pk_bf16_f32 v94, v52, v53
v_mfma_f32_16x16x32_bf16 a[40:43], v[80:83], a[184:187], a[40:43]
v_exp_f32 v54, v54
v_mfma_f32_16x16x32_bf16 a[36:39], v[76:79], a[184:187], a[36:39]
buffer_load_dwordx4 v232, s[12:15], s39 offen offset:0  lds
v_mfma_f32_16x16x32_bf16 a[52:55], v[76:79], a[188:191], a[52:55]
v_exp_f32 v55, v55
v_mfma_f32_16x16x32_bf16 a[48:51], v[72:75], a[188:191], a[48:51]
ds_read_b64_tr_b16 a[188:189], v223 offset:57344
v_cvt_pk_bf16_f32 v95, v54, v55
v_mfma_f32_16x16x32_bf16 a[32:35], v[72:75], a[184:187], a[32:35]
v_exp_f32 v56, v56
v_smfmac_f32_16x16x64_bf16 a[128:131], a[208:211], v[72:79], v245
ds_read_b64_tr_b16 a[190:191], v223 offset:61440
v_mfma_f32_16x16x32_bf16 v[12:15], a[160:163], v[152:155], v[136:139]
v_exp_f32 v57, v57
v_mfma_f32_16x16x32_bf16 v[12:15], a[164:167], v[156:159], v[12:15]
v_exp_f32 v58, v58
v_mfma_f32_16x16x32_bf16 v[12:15], a[168:171], v[160:163], v[12:15]
ds_read_b64_tr_b16 a[184:185], v222 offset:57344
v_cvt_pk_bf16_f32 v96, v56, v57
v_mfma_f32_16x16x32_bf16 v[12:15], a[172:175], v[164:167], v[12:15]
v_exp_f32 v59, v59
v_mfma_f32_16x16x32_bf16 v[20:23], a[172:175], v[180:183], v[140:143]
ds_read_b64_tr_b16 a[186:187], v222 offset:61440
v_cvt_pk_bf16_f32 v97, v58, v59
v_mfma_f32_16x16x32_bf16 v[20:23], a[168:171], v[176:179], v[20:23]
v_exp_f32 v60, v60
v_mfma_f32_16x16x32_bf16 v[20:23], a[164:167], v[172:175], v[20:23]
buffer_load_dwordx4 v233, s[12:15], s39 offen offset:1024  lds
v_mfma_f32_16x16x32_bf16 v[20:23], a[160:163], v[168:171], v[20:23]
v_exp_f32 v61, v61
v_mfma_f32_16x16x32_bf16 v[28:31], a[160:163], v[184:187], v[144:147]
buffer_store_dwordx4 a[232:235], v238, s[20:23], s28 offen offset:3072 sc0 sc1
v_cvt_pk_bf16_f32 v98, v60, v61
v_mfma_f32_16x16x32_bf16 v[28:31], a[164:167], v[188:191], v[28:31]
v_exp_f32 v62, v62
v_mfma_f32_16x16x32_bf16 v[28:31], a[168:171], v[192:195], v[28:31]
buffer_load_dwordx4 v232, s[12:15], s39 offen offset:2048  lds
v_mfma_f32_16x16x32_bf16 v[28:31], a[172:175], v[196:199], v[28:31]
v_exp_f32 v63, v63
v_mfma_f32_16x16x32_bf16 v[36:39], a[172:175], v[212:215], v[148:151]
ds_read_b128 a[172:175], v219 offset:12288
v_cvt_pk_bf16_f32 v99, v62, v63
v_mfma_f32_16x16x32_bf16 v[36:39], a[168:171], v[208:211], v[36:39]
v_exp_f32 v64, v64
v_mfma_f32_16x16x32_bf16 v[36:39], a[164:167], v[204:207], v[36:39]
ds_read_b128 a[168:171], v218 offset:12288
ds_read_b128 a[164:167], v217 offset:12288
v_mfma_f32_16x16x32_bf16 v[36:39], a[160:163], v[200:203], v[36:39]
v_exp_f32 v65, v65
v_mfma_f32_16x16x32_bf16 a[64:67], v[72:75], a[192:195], a[64:67]
ds_read_b128 a[160:163], v216 offset:12288
v_cvt_pk_bf16_f32 v100, v64, v65
v_mfma_f32_16x16x32_bf16 a[80:83], v[72:75], a[196:199], a[80:83]
v_exp_f32 v66, v66
v_mfma_f32_16x16x32_bf16 a[84:87], v[76:79], a[196:199], a[84:87]
buffer_load_dwordx4 v233, s[12:15], s39 offen offset:3072  lds
v_mfma_f32_16x16x32_bf16 a[68:71], v[76:79], a[192:195], a[68:71]
v_exp_f32 v67, v67
v_mfma_f32_16x16x32_bf16 a[72:75], v[80:83], a[192:195], a[72:75]
buffer_store_dwordx4 a[236:239], v238, s[20:23], s28 offen offset:3584 sc0 sc1
v_cvt_pk_bf16_f32 v101, v66, v67
v_mfma_f32_16x16x32_bf16 a[88:91], v[80:83], a[196:199], a[88:91]
v_exp_f32 v68, v68
v_mfma_f32_16x16x32_bf16 a[92:95], v[84:87], a[196:199], a[92:95]
ds_read_b64_tr_b16 a[196:197], v225 offset:57344
ds_read_b64_tr_b16 a[198:199], v225 offset:61440
v_mfma_f32_16x16x32_bf16 a[76:79], v[84:87], a[192:195], a[76:79]
v_exp_f32 v69, v69
s_waitcnt lgkmcnt(8)
v_mfma_f32_16x16x32_bf16 a[108:111], v[84:87], a[200:203], a[108:111]
ds_read_b64_tr_b16 a[192:193], v224 offset:57344
v_cvt_pk_bf16_f32 v102, v68, v69
v_mfma_f32_16x16x32_bf16 a[124:127], v[84:87], a[204:207], a[124:127]
v_exp_f32 v70, v70
v_mfma_f32_16x16x32_bf16 a[120:123], v[80:83], a[204:207], a[120:123]
ds_read_b64_tr_b16 a[194:195], v224 offset:61440
v_mfma_f32_16x16x32_bf16 a[104:107], v[80:83], a[200:203], a[104:107]
v_exp_f32 v71, v71
v_mfma_f32_16x16x32_bf16 a[100:103], v[76:79], a[200:203], a[100:103]
v_cvt_pk_bf16_f32 v103, v70, v71
v_mfma_f32_16x16x32_bf16 a[116:119], v[76:79], a[204:207], a[116:119]
s_add_u32 s28, s28, 4096
buffer_store_dwordx4 a[240:243], v238, s[20:23], s28 offen offset:0 sc0 sc1
v_mfma_f32_16x16x32_bf16 a[112:115], v[72:75], a[204:207], a[112:115]
ds_read_b64_tr_b16 a[204:205], v227 offset:57344
ds_read_b64_tr_b16 a[206:207], v227 offset:61440
v_mfma_f32_16x16x32_bf16 a[96:99], v[72:75], a[200:203], a[96:99]
ds_read_b64_tr_b16 a[200:201], v226 offset:57344
ds_read_b64_tr_b16 a[202:203], v226 offset:61440
v_smfmac_f32_16x16x64_bf16 a[132:135], a[208:211], v[80:87], v245
s_mov_b32 s33, 6
K_LOOPIN:
s_waitcnt lgkmcnt(0)
v_lshlrev_b32 v241, 4, v1
s_mov_b32 s46, s44
.p2align 6
K_LOOP:
s_cmp_eq_u32 s33, s3
s_cbranch_scc1 K_EVT
K_EVT_RET:
v_mfma_f32_16x16x32_bf16 v[40:43], a[144:147], v[152:155], v[136:139]
v_exp_f32 v8, v8
v_mfma_f32_16x16x32_bf16 v[40:43], a[148:151], v[156:159], v[40:43]
v_exp_f32 v9, v9
v_mfma_f32_16x16x32_bf16 v[40:43], a[152:155], v[160:163], v[40:43]
v_cvt_pk_bf16_f32 v72, v8, v9
v_mfma_f32_16x16x32_bf16 v[40:43], a[156:159], v[164:167], v[40:43]
v_exp_f32 v10, v10
v_mfma_f32_16x16x32_bf16 v[48:51], a[156:159], v[180:183], v[140:143]
v_mfma_f32_16x16x32_bf16 v[48:51], a[152:155], v[176:179], v[48:51]
v_exp_f32 v11, v11
v_mfma_f32_16x16x32_bf16 v[48:51], a[148:151], v[172:175], v[48:51]
v_cvt_pk_bf16_f32 v73, v10, v11
v_mfma_f32_16x16x32_bf16 v[48:51], a[144:147], v[168:171], v[48:51]
v_exp_f32 v12, v12
v_mfma_f32_16x16x32_bf16 v[56:59], a[144:147], v[184:187], v[144:147]
v_mfma_f32_16x16x32_bf16 v[56:59], a[148:151], v[188:191], v[56:59]
v_exp_f32 v13, v13
v_mfma_f32_16x16x32_bf16 v[56:59], a[152:155], v[192:195], v[56:59]
v_cvt_pk_bf16_f32 v74, v12, v13
v_mfma_f32_16x16x32_bf16 v[56:59], a[156:159], v[196:199], v[56:59]
v_exp_f32 v14, v14
v_mfma_f32_16x16x32_bf16 v[64:67], a[156:159], v[212:215], v[148:151]
s_waitcnt vmcnt(10) lgkmcnt(0)
s_barrier
v_mfma_f32_16x16x32_bf16 v[64:67], a[152:155], v[208:211], v[64:67]
v_exp_f32 v15, v15
v_mfma_f32_16x16x32_bf16 v[64:67], a[148:151], v[204:207], v[64:67]
ds_read_b128 a[156:159], v219 offset:16384
v_cvt_pk_bf16_f32 v75, v14, v15
v_mfma_f32_16x16x32_bf16 v[64:67], a[144:147], v[200:203], v[64:67]
v_exp_f32 v16, v16
v_mfma_f32_16x16x32_bf16 a[0:3], v[88:91], a[176:179], a[0:3]
ds_read_b128 a[152:155], v218 offset:16384
ds_read_b128 a[148:151], v217 offset:16384
v_mfma_f32_16x16x32_bf16 a[16:19], v[88:91], a[180:183], a[16:19]
v_exp_f32 v17, v17
v_mfma_f32_16x16x32_bf16 a[20:23], v[92:95], a[180:183], a[20:23]
ds_read_b128 a[144:147], v216 offset:16384
v_cvt_pk_bf16_f32 v76, v16, v17
v_mfma_f32_16x16x32_bf16 a[4:7], v[92:95], a[176:179], a[4:7]
v_exp_f32 v18, v18
v_mfma_f32_16x16x32_bf16 a[8:11], v[96:99], a[176:179], a[8:11]
s_add_u32 s32, s32, 16384
s_add_u32 m0, s30, 65536
v_mfma_f32_16x16x32_bf16 a[24:27], v[96:99], a[180:183], a[24:27]
v_exp_f32 v19, v19
v_mfma_f32_16x16x32_bf16 a[28:31], v[100:103], a[180:183], a[28:31]
ds_read_b64_tr_b16 a[180:181], v221 offset:0
v_cvt_pk_bf16_f32 v77, v18, v19
v_mfma_f32_16x16x32_bf16 a[12:15], v[100:103], a[176:179], a[12:15]
v_exp_f32 v20, v20
v_mfma_f32_16x16x32_bf16 a[44:47], v[100:103], a[184:187], a[44:47]
ds_read_b64_tr_b16 a[182:183], v221 offset:4096
ds_read_b64_tr_b16 a[176:177], v220 offset:0
v_mfma_f32_16x16x32_bf16 a[60:63], v[100:103], a[188:191], a[60:63]
v_exp_f32 v21, v21
v_mfma_f32_16x16x32_bf16 a[56:59], v[96:99], a[188:191], a[56:59]
ds_read_b64_tr_b16 a[178:179], v220 offset:4096
v_cvt_pk_bf16_f32 v78, v20, v21
v_mfma_f32_16x16x32_bf16 a[40:43], v[96:99], a[184:187], a[40:43]
v_exp_f32 v22, v22
v_mfma_f32_16x16x32_bf16 a[36:39], v[92:95], a[184:187], a[36:39]
buffer_load_dwordx4 v228, s[8:11], s32 offen offset:0  lds
v_mfma_f32_16x16x32_bf16 a[52:55], v[92:95], a[188:191], a[52:55]
v_exp_f32 v23, v23
v_mfma_f32_16x16x32_bf16 a[48:51], v[88:91], a[188:191], a[48:51]
ds_read_b64_tr_b16 a[188:189], v223 offset:0
v_cvt_pk_bf16_f32 v79, v22, v23
v_mfma_f32_16x16x32_bf16 a[32:35], v[88:91], a[184:187], a[32:35]
v_exp_f32 v24, v24
v_smfmac_f32_16x16x64_bf16 a[128:131], a[208:211], v[88:95], v245
ds_read_b64_tr_b16 a[190:191], v223 offset:4096
v_mfma_f32_16x16x32_bf16 v[44:47], a[160:163], v[152:155], v[136:139]
v_exp_f32 v25, v25
v_mfma_f32_16x16x32_bf16 v[44:47], a[164:167], v[156:159], v[44:47]
v_exp_f32 v26, v26
v_mfma_f32_16x16x32_bf16 v[44:47], a[168:171], v[160:163], v[44:47]
ds_read_b64_tr_b16 a[184:185], v222 offset:0
v_cvt_pk_bf16_f32 v80, v24, v25
v_mfma_f32_16x16x32_bf16 v[44:47], a[172:175], v[164:167], v[44:47]
v_exp_f32 v27, v27
v_mfma_f32_16x16x32_bf16 v[52:55], a[172:175], v[180:183], v[140:143]
ds_read_b64_tr_b16 a[186:187], v222 offset:4096
v_cvt_pk_bf16_f32 v81, v26, v27
v_mfma_f32_16x16x32_bf16 v[52:55], a[168:171], v[176:179], v[52:55]
v_exp_f32 v28, v28
v_mfma_f32_16x16x32_bf16 v[52:55], a[164:167], v[172:175], v[52:55]
buffer_load_dwordx4 v229, s[8:11], s32 offen offset:1024  lds
v_mfma_f32_16x16x32_bf16 v[52:55], a[160:163], v[168:171], v[52:55]
v_exp_f32 v29, v29
v_mfma_f32_16x16x32_bf16 v[60:63], a[160:163], v[184:187], v[144:147]
v_cvt_pk_bf16_f32 v82, v28, v29
v_mfma_f32_16x16x32_bf16 v[60:63], a[164:167], v[188:191], v[60:63]
v_exp_f32 v30, v30
v_mfma_f32_16x16x32_bf16 v[60:63], a[168:171], v[192:195], v[60:63]
buffer_load_dwordx4 v230, s[8:11], s32 offen offset:2048  lds
v_mfma_f32_16x16x32_bf16 v[60:63], a[172:175], v[196:199], v[60:63]
v_exp_f32 v31, v31
v_mfma_f32_16x16x32_bf16 v[68:71], a[172:175], v[212:215], v[148:151]
ds_read_b128 a[172:175], v219 offset:20480
v_cvt_pk_bf16_f32 v83, v30, v31
v_mfma_f32_16x16x32_bf16 v[68:71], a[168:171], v[208:211], v[68:71]
v_exp_f32 v32, v32
v_mfma_f32_16x16x32_bf16 v[68:71], a[164:167], v[204:207], v[68:71]
ds_read_b128 a[168:171], v218 offset:20480
ds_read_b128 a[164:167], v217 offset:20480
v_mfma_f32_16x16x32_bf16 v[68:71], a[160:163], v[200:203], v[68:71]
v_exp_f32 v33, v33
v_mfma_f32_16x16x32_bf16 a[64:67], v[88:91], a[192:195], a[64:67]
ds_read_b128 a[160:163], v216 offset:20480
v_cvt_pk_bf16_f32 v84, v32, v33
v_mfma_f32_16x16x32_bf16 a[80:83], v[88:91], a[196:199], a[80:83]
v_exp_f32 v34, v34
v_mfma_f32_16x16x32_bf16 a[84:87], v[92:95], a[196:199], a[84:87]
buffer_load_dwordx4 v231, s[8:11], s32 offen offset:3072  lds
v_mfma_f32_16x16x32_bf16 a[68:71], v[92:95], a[192:195], a[68:71]
v_exp_f32 v35, v35
v_mfma_f32_16x16x32_bf16 a[72:75], v[96:99], a[192:195], a[72:75]
v_cvt_pk_bf16_f32 v85, v34, v35
v_mfma_f32_16x16x32_bf16 a[88:91], v[96:99], a[196:199], a[88:91]
v_exp_f32 v36, v36
v_mfma_f32_16x16x32_bf16 a[92:95], v[100:103], a[196:199], a[92:95]
ds_read_b64_tr_b16 a[196:197], v225 offset:0
ds_read_b64_tr_b16 a[198:199], v225 offset:4096
v_mfma_f32_16x16x32_bf16 a[76:79], v[100:103], a[192:195], a[76:79]
v_exp_f32 v37, v37
v_mfma_f32_16x16x32_bf16 a[108:111], v[100:103], a[200:203], a[108:111]
ds_read_b64_tr_b16 a[192:193], v224 offset:0
v_cvt_pk_bf16_f32 v86, v36, v37
v_mfma_f32_16x16x32_bf16 a[124:127], v[100:103], a[204:207], a[124:127]
v_exp_f32 v38, v38
v_mfma_f32_16x16x32_bf16 a[120:123], v[96:99], a[204:207], a[120:123]
ds_read_b64_tr_b16 a[194:195], v224 offset:4096
v_mfma_f32_16x16x32_bf16 a[104:107], v[96:99], a[200:203], a[104:107]
v_exp_f32 v39, v39
v_mfma_f32_16x16x32_bf16 a[100:103], v[92:95], a[200:203], a[100:103]
v_cvt_pk_bf16_f32 v87, v38, v39
v_mfma_f32_16x16x32_bf16 a[116:119], v[92:95], a[204:207], a[116:119]
s_mov_b32 m0, s87
s_lshl2_add_u32 s50, s87, s89
buffer_load_dwordx4 v243, s[56:59], s50 offen  lds
v_mfma_f32_16x16x32_bf16 a[112:115], v[88:91], a[204:207], a[112:115]
ds_read_b64_tr_b16 a[204:205], v227 offset:0
ds_read_b64_tr_b16 a[206:207], v227 offset:4096
v_mfma_f32_16x16x32_bf16 a[96:99], v[88:91], a[200:203], a[96:99]
ds_read_b64_tr_b16 a[200:201], v226 offset:0
ds_read_b64_tr_b16 a[202:203], v226 offset:4096
v_smfmac_f32_16x16x64_bf16 a[132:135], a[208:211], v[96:103], v245
s_add_u32 s87, s87, 3456
s_min_u32 s87, s87, 63936
s_waitcnt lgkmcnt(8)
v_mfma_f32_16x16x32_bf16 v[8:11], a[144:147], v[152:155], v[136:139]
v_exp_f32 v40, v40
v_mfma_f32_16x16x32_bf16 v[8:11], a[148:151], v[156:159], v[8:11]
v_exp_f32 v41, v41
v_mfma_f32_16x16x32_bf16 v[8:11], a[152:155], v[160:163], v[8:11]
v_cvt_pk_bf16_f32 v88, v40, v41
v_mfma_f32_16x16x32_bf16 v[8:11], a[156:159], v[164:167], v[8:11]
v_exp_f32 v42, v42
v_mfma_f32_16x16x32_bf16 v[16:19], a[156:159], v[180:183], v[140:143]
s_add_u32 s39, s39, 16384
v_mfma_f32_16x16x32_bf16 v[16:19], a[152:155], v[176:179], v[16:19]
v_exp_f32 v43, v43
v_mfma_f32_16x16x32_bf16 v[16:19], a[148:151], v[172:175], v[16:19]
v_cvt_pk_bf16_f32 v89, v42, v43
v_mfma_f32_16x16x32_bf16 v[16:19], a[144:147], v[168:171], v[16:19]
v_exp_f32 v44, v44
v_mfma_f32_16x16x32_bf16 v[24:27], a[144:147], v[184:187], v[144:147]
v_mfma_f32_16x16x32_bf16 v[24:27], a[148:151], v[188:191], v[24:27]
v_exp_f32 v45, v45
v_mfma_f32_16x16x32_bf16 v[24:27], a[152:155], v[192:195], v[24:27]
s_add_u32 m0, s30, 147456
v_cvt_pk_bf16_f32 v90, v44, v45
v_mfma_f32_16x16x32_bf16 v[24:27], a[156:159], v[196:199], v[24:27]
v_exp_f32 v46, v46
v_mfma_f32_16x16x32_bf16 v[32:35], a[156:159], v[212:215], v[148:151]
ds_read_b128 a[156:159], v219 offset:24576
v_mfma_f32_16x16x32_bf16 v[32:35], a[152:155], v[208:211], v[32:35]
v_exp_f32 v47, v47
v_mfma_f32_16x16x32_bf16 v[32:35], a[148:151], v[204:207], v[32:35]
ds_read_b128 a[152:155], v218 offset:24576
v_cvt_pk_bf16_f32 v91, v46, v47
v_mfma_f32_16x16x32_bf16 v[32:35], a[144:147], v[200:203], v[32:35]
v_exp_f32 v48, v48
v_mfma_f32_16x16x32_bf16 a[0:3], v[72:75], a[176:179], a[0:3]
ds_read_b128 a[148:151], v217 offset:24576
ds_read_b128 a[144:147], v216 offset:24576
v_mfma_f32_16x16x32_bf16 a[16:19], v[72:75], a[180:183], a[16:19]
v_exp_f32 v49, v49
v_mfma_f32_16x16x32_bf16 a[20:23], v[76:79], a[180:183], a[20:23]
v_cvt_pk_bf16_f32 v92, v48, v49
v_mfma_f32_16x16x32_bf16 a[4:7], v[76:79], a[176:179], a[4:7]
v_exp_f32 v50, v50
v_mfma_f32_16x16x32_bf16 a[8:11], v[80:83], a[176:179], a[8:11]
buffer_load_dwordx4 v232, s[12:15], s39 offen offset:0  lds
v_mfma_f32_16x16x32_bf16 a[24:27], v[80:83], a[180:183], a[24:27]
v_exp_f32 v51, v51
v_mfma_f32_16x16x32_bf16 a[28:31], v[84:87], a[180:183], a[28:31]
ds_read_b64_tr_b16 a[180:181], v221 offset:8192
v_cvt_pk_bf16_f32 v93, v50, v51
v_mfma_f32_16x16x32_bf16 a[12:15], v[84:87], a[176:179], a[12:15]
v_exp_f32 v52, v52
v_mfma_f32_16x16x32_bf16 a[44:47], v[84:87], a[184:187], a[44:47]
ds_read_b64_tr_b16 a[182:183], v221 offset:12288
ds_read_b64_tr_b16 a[176:177], v220 offset:8192
v_mfma_f32_16x16x32_bf16 a[60:63], v[84:87], a[188:191], a[60:63]
v_exp_f32 v53, v53
v_mfma_f32_16x16x32_bf16 a[56:59], v[80:83], a[188:191], a[56:59]
ds_read_b64_tr_b16 a[178:179], v220 offset:12288
v_cvt_pk_bf16_f32 v94, v52, v53
v_mfma_f32_16x16x32_bf16 a[40:43], v[80:83], a[184:187], a[40:43]
v_exp_f32 v54, v54
v_mfma_f32_16x16x32_bf16 a[36:39], v[76:79], a[184:187], a[36:39]
buffer_load_dwordx4 v233, s[12:15], s39 offen offset:1024  lds
v_mfma_f32_16x16x32_bf16 a[52:55], v[76:79], a[188:191], a[52:55]
v_exp_f32 v55, v55
v_mfma_f32_16x16x32_bf16 a[48:51], v[72:75], a[188:191], a[48:51]
ds_read_b64_tr_b16 a[188:189], v223 offset:8192
v_cvt_pk_bf16_f32 v95, v54, v55
v_mfma_f32_16x16x32_bf16 a[32:35], v[72:75], a[184:187], a[32:35]
v_exp_f32 v56, v56
v_smfmac_f32_16x16x64_bf16 a[128:131], a[208:211], v[72:79], v245
ds_read_b64_tr_b16 a[190:191], v223 offset:12288
v_mfma_f32_16x16x32_bf16 v[12:15], a[160:163], v[152:155], v[136:139]
v_exp_f32 v57, v57
v_mfma_f32_16x16x32_bf16 v[12:15], a[164:167], v[156:159], v[12:15]
v_exp_f32 v58, v58
v_mfma_f32_16x16x32_bf16 v[12:15], a[168:171], v[160:163], v[12:15]
ds_read_b64_tr_b16 a[184:185], v222 offset:8192
v_cvt_pk_bf16_f32 v96, v56, v57
v_mfma_f32_16x16x32_bf16 v[12:15], a[172:175], v[164:167], v[12:15]
v_exp_f32 v59, v59
v_mfma_f32_16x16x32_bf16 v[20:23], a[172:175], v[180:183], v[140:143]
ds_read_b64_tr_b16 a[186:187], v222 offset:12288
v_cvt_pk_bf16_f32 v97, v58, v59
v_mfma_f32_16x16x32_bf16 v[20:23], a[168:171], v[176:179], v[20:23]
v_exp_f32 v60, v60
v_mfma_f32_16x16x32_bf16 v[20:23], a[164:167], v[172:175], v[20:23]
buffer_load_dwordx4 v232, s[12:15], s39 offen offset:2048  lds
v_mfma_f32_16x16x32_bf16 v[20:23], a[160:163], v[168:171], v[20:23]
v_exp_f32 v61, v61
v_mfma_f32_16x16x32_bf16 v[28:31], a[160:163], v[184:187], v[144:147]
v_cvt_pk_bf16_f32 v98, v60, v61
v_mfma_f32_16x16x32_bf16 v[28:31], a[164:167], v[188:191], v[28:31]
v_exp_f32 v62, v62
v_mfma_f32_16x16x32_bf16 v[28:31], a[168:171], v[192:195], v[28:31]
buffer_load_dwordx4 v233, s[12:15], s39 offen offset:3072  lds
v_mfma_f32_16x16x32_bf16 v[28:31], a[172:175], v[196:199], v[28:31]
v_exp_f32 v63, v63
v_mfma_f32_16x16x32_bf16 v[36:39], a[172:175], v[212:215], v[148:151]
ds_read_b128 a[172:175], v219 offset:28672
v_cvt_pk_bf16_f32 v99, v62, v63
v_mfma_f32_16x16x32_bf16 v[36:39], a[168:171], v[208:211], v[36:39]
v_exp_f32 v64, v64
v_mfma_f32_16x16x32_bf16 v[36:39], a[164:167], v[204:207], v[36:39]
ds_read_b128 a[168:171], v218 offset:28672
ds_read_b128 a[164:167], v217 offset:28672
v_mfma_f32_16x16x32_bf16 v[36:39], a[160:163], v[200:203], v[36:39]
v_exp_f32 v65, v65
s_waitcnt lgkmcnt(8)
v_mfma_f32_16x16x32_bf16 a[64:67], v[72:75], a[192:195], a[64:67]
ds_read_b128 a[160:163], v216 offset:28672
v_cvt_pk_bf16_f32 v100, v64, v65
v_mfma_f32_16x16x32_bf16 a[80:83], v[72:75], a[196:199], a[80:83]
v_exp_f32 v66, v66
v_mfma_f32_16x16x32_bf16 a[84:87], v[76:79], a[196:199], a[84:87]
buffer_load_dword v242, v241, s[20:23], s46 offen sc1
v_mfma_f32_16x16x32_bf16 a[68:71], v[76:79], a[192:195], a[68:71]
v_exp_f32 v67, v67
v_mfma_f32_16x16x32_bf16 a[72:75], v[80:83], a[192:195], a[72:75]
v_cvt_pk_bf16_f32 v101, v66, v67
v_add_u32 v241, 1024, v241
v_mfma_f32_16x16x32_bf16 a[88:91], v[80:83], a[196:199], a[88:91]
v_exp_f32 v68, v68
v_mfma_f32_16x16x32_bf16 a[92:95], v[84:87], a[196:199], a[92:95]
ds_read_b64_tr_b16 a[196:197], v225 offset:8192
ds_read_b64_tr_b16 a[198:199], v225 offset:12288
v_mfma_f32_16x16x32_bf16 a[76:79], v[84:87], a[192:195], a[76:79]
v_exp_f32 v69, v69
v_mfma_f32_16x16x32_bf16 a[108:111], v[84:87], a[200:203], a[108:111]
ds_read_b64_tr_b16 a[192:193], v224 offset:8192
v_cvt_pk_bf16_f32 v102, v68, v69
v_mfma_f32_16x16x32_bf16 a[124:127], v[84:87], a[204:207], a[124:127]
v_exp_f32 v70, v70
v_mfma_f32_16x16x32_bf16 a[120:123], v[80:83], a[204:207], a[120:123]
ds_read_b64_tr_b16 a[194:195], v224 offset:12288
v_and_b32 v241, 0x3fff, v241
v_mfma_f32_16x16x32_bf16 a[104:107], v[80:83], a[200:203], a[104:107]
v_exp_f32 v71, v71
v_mfma_f32_16x16x32_bf16 a[100:103], v[76:79], a[200:203], a[100:103]
v_cvt_pk_bf16_f32 v103, v70, v71
v_mfma_f32_16x16x32_bf16 a[116:119], v[76:79], a[204:207], a[116:119]
v_mfma_f32_16x16x32_bf16 a[112:115], v[72:75], a[204:207], a[112:115]
ds_read_b64_tr_b16 a[204:205], v227 offset:8192
ds_read_b64_tr_b16 a[206:207], v227 offset:12288
v_mfma_f32_16x16x32_bf16 a[96:99], v[72:75], a[200:203], a[96:99]
ds_read_b64_tr_b16 a[200:201], v226 offset:8192
ds_read_b64_tr_b16 a[202:203], v226 offset:12288
v_smfmac_f32_16x16x64_bf16 a[132:135], a[208:211], v[80:87], v245
v_mfma_f32_16x16x32_bf16 v[40:43], a[144:147], v[152:155], v[136:139]
v_exp_f32 v8, v8
v_mfma_f32_16x16x32_bf16 v[40:43], a[148:151], v[156:159], v[40:43]
v_exp_f32 v9, v9
v_mfma_f32_16x16x32_bf16 v[40:43], a[152:155], v[160:163], v[40:43]
v_cvt_pk_bf16_f32 v72, v8, v9
v_mfma_f32_16x16x32_bf16 v[40:43], a[156:159], v[164:167], v[40:43]
v_exp_f32 v10, v10
v_mfma_f32_16x16x32_bf16 v[48:51], a[156:159], v[180:183], v[140:143]
v_mfma_f32_16x16x32_bf16 v[48:51], a[152:155], v[176:179], v[48:51]
v_exp_f32 v11, v11
v_mfma_f32_16x16x32_bf16 v[48:51], a[148:151], v[172:175], v[48:51]
v_cvt_pk_bf16_f32 v73, v10, v11
v_mfma_f32_16x16x32_bf16 v[48:51], a[144:147], v[168:171], v[48:51]
v_exp_f32 v12, v12
v_mfma_f32_16x16x32_bf16 v[56:59], a[144:147], v[184:187], v[144:147]
v_mfma_f32_16x16x32_bf16 v[56:59], a[148:151], v[188:191], v[56:59]
v_exp_f32 v13, v13
v_mfma_f32_16x16x32_bf16 v[56:59], a[152:155], v[192:195], v[56:59]
v_cvt_pk_bf16_f32 v74, v12, v13
v_mfma_f32_16x16x32_bf16 v[56:59], a[156:159], v[196:199], v[56:59]
v_exp_f32 v14, v14
v_mfma_f32_16x16x32_bf16 v[64:67], a[156:159], v[212:215], v[148:151]
s_waitcnt vmcnt(10) lgkmcnt(0)
s_barrier
v_mfma_f32_16x16x32_bf16 v[64:67], a[152:155], v[208:211], v[64:67]
v_exp_f32 v15, v15
v_mfma_f32_16x16x32_bf16 v[64:67], a[148:151], v[204:207], v[64:67]
ds_read_b128 a[156:159], v219 offset:49152
v_cvt_pk_bf16_f32 v75, v14, v15
v_mfma_f32_16x16x32_bf16 v[64:67], a[144:147], v[200:203], v[64:67]
v_exp_f32 v16, v16
v_mfma_f32_16x16x32_bf16 a[0:3], v[88:91], a[176:179], a[0:3]
ds_read_b128 a[152:155], v218 offset:49152
ds_read_b128 a[148:151], v217 offset:49152
v_mfma_f32_16x16x32_bf16 a[16:19], v[88:91], a[180:183], a[16:19]
STUB_10:
s_cbranch_execz HOP_RET1
v_exp_f32 v17, v17
v_mfma_f32_16x16x32_bf16 a[20:23], v[92:95], a[180:183], a[20:23]
ds_read_b128 a[144:147], v216 offset:49152
v_cvt_pk_bf16_f32 v76, v16, v17
v_mfma_f32_16x16x32_bf16 a[4:7], v[92:95], a[176:179], a[4:7]
v_exp_f32 v18, v18
v_mfma_f32_16x16x32_bf16 a[8:11], v[96:99], a[176:179], a[8:11]
s_add_u32 s32, s32, 16384
s_add_u32 m0, s30, 81920
v_mfma_f32_16x16x32_bf16 a[24:27], v[96:99], a[180:183], a[24:27]
v_exp_f32 v19, v19
v_mfma_f32_16x16x32_bf16 a[28:31], v[100:103], a[180:183], a[28:31]
ds_read_b64_tr_b16 a[180:181], v221 offset:32768
v_cvt_pk_bf16_f32 v77, v18, v19
v_mfma_f32_16x16x32_bf16 a[12:15], v[100:103], a[176:179], a[12:15]
v_exp_f32 v20, v20
v_mfma_f32_16x16x32_bf16 a[44:47], v[100:103], a[184:187], a[44:47]
ds_read_b64_tr_b16 a[182:183], v221 offset:36864
ds_read_b64_tr_b16 a[176:177], v220 offset:32768
v_mfma_f32_16x16x32_bf16 a[60:63], v[100:103], a[188:191], a[60:63]
v_exp_f32 v21, v21
v_mfma_f32_16x16x32_bf16 a[56:59], v[96:99], a[188:191], a[56:59]
ds_read_b64_tr_b16 a[178:179], v220 offset:36864
v_cvt_pk_bf16_f32 v78, v20, v21
v_mfma_f32_16x16x32_bf16 a[40:43], v[96:99], a[184:187], a[40:43]
v_exp_f32 v22, v22
v_mfma_f32_16x16x32_bf16 a[36:39], v[92:95], a[184:187], a[36:39]
buffer_load_dwordx4 v228, s[8:11], s32 offen offset:0  lds
v_mfma_f32_16x16x32_bf16 a[52:55], v[92:95], a[188:191], a[52:55]
v_exp_f32 v23, v23
v_mfma_f32_16x16x32_bf16 a[48:51], v[88:91], a[188:191], a[48:51]
ds_read_b64_tr_b16 a[188:189], v223 offset:32768
v_cvt_pk_bf16_f32 v79, v22, v23
v_mfma_f32_16x16x32_bf16 a[32:35], v[88:91], a[184:187], a[32:35]
v_exp_f32 v24, v24
v_smfmac_f32_16x16x64_bf16 a[128:131], a[208:211], v[88:95], v245
ds_read_b64_tr_b16 a[190:191], v223 offset:36864
v_mfma_f32_16x16x32_bf16 v[44:47], a[160:163], v[152:155], v[136:139]
v_exp_f32 v25, v25
v_mfma_f32_16x16x32_bf16 v[44:47], a[164:167], v[156:159], v[44:47]
v_exp_f32 v26, v26
v_mfma_f32_16x16x32_bf16 v[44:47], a[168:171], v[160:163], v[44:47]
ds_read_b64_tr_b16 a[184:185], v222 offset:32768
v_cvt_pk_bf16_f32 v80, v24, v25
v_mfma_f32_16x16x32_bf16 v[44:47], a[172:175], v[164:167], v[44:47]
v_exp_f32 v27, v27
v_mfma_f32_16x16x32_bf16 v[52:55], a[172:175], v[180:183], v[140:143]
ds_read_b64_tr_b16 a[186:187], v222 offset:36864
v_cvt_pk_bf16_f32 v81, v26, v27
v_mfma_f32_16x16x32_bf16 v[52:55], a[168:171], v[176:179], v[52:55]
v_exp_f32 v28, v28
v_mfma_f32_16x16x32_bf16 v[52:55], a[164:167], v[172:175], v[52:55]
buffer_load_dwordx4 v229, s[8:11], s32 offen offset:1024  lds
v_mfma_f32_16x16x32_bf16 v[52:55], a[160:163], v[168:171], v[52:55]
v_exp_f32 v29, v29
v_mfma_f32_16x16x32_bf16 v[60:63], a[160:163], v[184:187], v[144:147]
v_cvt_pk_bf16_f32 v82, v28, v29
v_mfma_f32_16x16x32_bf16 v[60:63], a[164:167], v[188:191], v[60:63]
v_exp_f32 v30, v30
v_mfma_f32_16x16x32_bf16 v[60:63], a[168:171], v[192:195], v[60:63]
buffer_load_dwordx4 v230, s[8:11], s32 offen offset:2048  lds
v_mfma_f32_16x16x32_bf16 v[60:63], a[172:175], v[196:199], v[60:63]
v_exp_f32 v31, v31
v_mfma_f32_16x16x32_bf16 v[68:71], a[172:175], v[212:215], v[148:151]
ds_read_b128 a[172:175], v219 offset:53248
v_cvt_pk_bf16_f32 v83, v30, v31
v_mfma_f32_16x16x32_bf16 v[68:71], a[168:171], v[208:211], v[68:71]
v_exp_f32 v32, v32
v_mfma_f32_16x16x32_bf16 v[68:71], a[164:167], v[204:207], v[68:71]
ds_read_b128 a[168:171], v218 offset:53248
ds_read_b128 a[164:167], v217 offset:53248
v_mfma_f32_16x16x32_bf16 v[68:71], a[160:163], v[200:203], v[68:71]
v_exp_f32 v33, v33
v_mfma_f32_16x16x32_bf16 a[64:67], v[88:91], a[192:195], a[64:67]
ds_read_b128 a[160:163], v216 offset:53248
v_cvt_pk_bf16_f32 v84, v32, v33
v_mfma_f32_16x16x32_bf16 a[80:83], v[88:91], a[196:199], a[80:83]
v_exp_f32 v34, v34
v_mfma_f32_16x16x32_bf16 a[84:87], v[92:95], a[196:199], a[84:87]
buffer_load_dwordx4 v231, s[8:11], s32 offen offset:3072  lds
v_mfma_f32_16x16x32_bf16 a[68:71], v[92:95], a[192:195], a[68:71]
v_exp_f32 v35, v35
v_mfma_f32_16x16x32_bf16 a[72:75], v[96:99], a[192:195], a[72:75]
v_cvt_pk_bf16_f32 v85, v34, v35
v_mfma_f32_16x16x32_bf16 a[88:91], v[96:99], a[196:199], a[88:91]
v_exp_f32 v36, v36
v_mfma_f32_16x16x32_bf16 a[92:95], v[100:103], a[196:199], a[92:95]
ds_read_b64_tr_b16 a[196:197], v225 offset:32768
ds_read_b64_tr_b16 a[198:199], v225 offset:36864
v_mfma_f32_16x16x32_bf16 a[76:79], v[100:103], a[192:195], a[76:79]
v_exp_f32 v37, v37
v_mfma_f32_16x16x32_bf16 a[108:111], v[100:103], a[200:203], a[108:111]
ds_read_b64_tr_b16 a[192:193], v224 offset:32768
v_cvt_pk_bf16_f32 v86, v36, v37
v_mfma_f32_16x16x32_bf16 a[124:127], v[100:103], a[204:207], a[124:127]
v_exp_f32 v38, v38
v_mfma_f32_16x16x32_bf16 a[120:123], v[96:99], a[204:207], a[120:123]
ds_read_b64_tr_b16 a[194:195], v224 offset:36864
v_mfma_f32_16x16x32_bf16 a[104:107], v[96:99], a[200:203], a[104:107]
v_exp_f32 v39, v39
v_mfma_f32_16x16x32_bf16 a[100:103], v[92:95], a[200:203], a[100:103]
v_cvt_pk_bf16_f32 v87, v38, v39
v_mfma_f32_16x16x32_bf16 a[116:119], v[92:95], a[204:207], a[116:119]
s_mov_b32 m0, s87
s_lshl2_add_u32 s50, s87, s89
buffer_load_dwordx4 v243, s[56:59], s50 offen  lds
v_mfma_f32_16x16x32_bf16 a[112:115], v[88:91], a[204:207], a[112:115]
ds_read_b64_tr_b16 a[204:205], v227 offset:32768
ds_read_b64_tr_b16 a[206:207], v227 offset:36864
v_mfma_f32_16x16x32_bf16 a[96:99], v[88:91], a[200:203], a[96:99]
ds_read_b64_tr_b16 a[200:201], v226 offset:32768
ds_read_b64_tr_b16 a[202:203], v226 offset:36864
v_smfmac_f32_16x16x64_bf16 a[132:135], a[208:211], v[96:103], v245
s_add_u32 s87, s87, 3456
s_min_u32 s87, s87, 63936
s_waitcnt lgkmcnt(8)
v_mfma_f32_16x16x32_bf16 v[8:11], a[144:147], v[152:155], v[136:139]
v_exp_f32 v40, v40
v_mfma_f32_16x16x32_bf16 v[8:11], a[148:151], v[156:159], v[8:11]
v_exp_f32 v41, v41
v_mfma_f32_16x16x32_bf16 v[8:11], a[152:155], v[160:163], v[8:11]
v_cvt_pk_bf16_f32 v88, v40, v41
v_mfma_f32_16x16x32_bf16 v[8:11], a[156:159], v[164:167], v[8:11]
v_exp_f32 v42, v42
v_mfma_f32_16x16x32_bf16 v[16:19], a[156:159], v[180:183], v[140:143]
s_add_u32 s39, s39, 16384
v_mfma_f32_16x16x32_bf16 v[16:19], a[152:155], v[176:179], v[16:19]
v_exp_f32 v43, v43
v_mfma_f32_16x16x32_bf16 v[16:19], a[148:151], v[172:175], v[16:19]
v_cvt_pk_bf16_f32 v89, v42, v43
v_mfma_f32_16x16x32_bf16 v[16:19], a[144:147], v[168:171], v[16:19]
v_exp_f32 v44, v44
v_mfma_f32_16x16x32_bf16 v[24:27], a[144:147], v[184:187], v[144:147]
v_mfma_f32_16x16x32_bf16 v[24:27], a[148:151], v[188:191], v[24:27]
v_exp_f32 v45, v45
v_mfma_f32_16x16x32_bf16 v[24:27], a[152:155], v[192:195], v[24:27]
s_add_u32 m0, s30, 98304
v_cvt_pk_bf16_f32 v90, v44, v45
v_mfma_f32_16x16x32_bf16 v[24:27], a[156:159], v[196:199], v[24:27]
v_exp_f32 v46, v46
v_mfma_f32_16x16x32_bf16 v[32:35], a[156:159], v[212:215], v[148:151]
ds_read_b128 a[156:159], v219 offset:57344
v_mfma_f32_16x16x32_bf16 v[32:35], a[152:155], v[208:211], v[32:35]
v_exp_f32 v47, v47
v_mfma_f32_16x16x32_bf16 v[32:35], a[148:151], v[204:207], v[32:35]
ds_read_b128 a[152:155], v218 offset:57344
v_cvt_pk_bf16_f32 v91, v46, v47
v_mfma_f32_16x16x32_bf16 v[32:35], a[144:147], v[200:203], v[32:35]
v_exp_f32 v48, v48
v_mfma_f32_16x16x32_bf16 a[0:3], v[72:75], a[176:179], a[0:3]
ds_read_b128 a[148:151], v217 offset:57344
ds_read_b128 a[144:147], v216 offset:57344
v_mfma_f32_16x16x32_bf16 a[16:19], v[72:75], a[180:183], a[16:19]
v_exp_f32 v49, v49
v_mfma_f32_16x16x32_bf16 a[20:23], v[76:79], a[180:183], a[20:23]
v_cvt_pk_bf16_f32 v92, v48, v49
v_mfma_f32_16x16x32_bf16 a[4:7], v[76:79], a[176:179], a[4:7]
v_exp_f32 v50, v50
v_mfma_f32_16x16x32_bf16 a[8:11], v[80:83], a[176:179], a[8:11]
buffer_load_dwordx4 v232, s[12:15], s39 offen offset:0  lds
v_mfma_f32_16x16x32_bf16 a[24:27], v[80:83], a[180:183], a[24:27]
v_exp_f32 v51, v51
v_mfma_f32_16x16x32_bf16 a[28:31], v[84:87], a[180:183], a[28:31]
ds_read_b64_tr_b16 a[180:181], v221 offset:40960
v_cvt_pk_bf16_f32 v93, v50, v51
v_mfma_f32_16x16x32_bf16 a[12:15], v[84:87], a[176:179], a[12:15]
v_exp_f32 v52, v52
v_mfma_f32_16x16x32_bf16 a[44:47], v[84:87], a[184:187], a[44:47]
ds_read_b64_tr_b16 a[182:183], v221 offset:45056
ds_read_b64_tr_b16 a[176:177], v220 offset:40960
v_mfma_f32_16x16x32_bf16 a[60:63], v[84:87], a[188:191], a[60:63]
v_exp_f32 v53, v53
v_mfma_f32_16x16x32_bf16 a[56:59], v[80:83], a[188:191], a[56:59]
ds_read_b64_tr_b16 a[178:179], v220 offset:45056
v_cvt_pk_bf16_f32 v94, v52, v53
v_mfma_f32_16x16x32_bf16 a[40:43], v[80:83], a[184:187], a[40:43]
v_exp_f32 v54, v54
v_mfma_f32_16x16x32_bf16 a[36:39], v[76:79], a[184:187], a[36:39]
buffer_load_dwordx4 v233, s[12:15], s39 offen offset:1024  lds
v_mfma_f32_16x16x32_bf16 a[52:55], v[76:79], a[188:191], a[52:55]
v_exp_f32 v55, v55
v_mfma_f32_16x16x32_bf16 a[48:51], v[72:75], a[188:191], a[48:51]
ds_read_b64_tr_b16 a[188:189], v223 offset:40960
v_cvt_pk_bf16_f32 v95, v54, v55
v_mfma_f32_16x16x32_bf16 a[32:35], v[72:75], a[184:187], a[32:35]
v_exp_f32 v56, v56
v_smfmac_f32_16x16x64_bf16 a[128:131], a[208:211], v[72:79], v245
ds_read_b64_tr_b16 a[190:191], v223 offset:45056
v_mfma_f32_16x16x32_bf16 v[12:15], a[160:163], v[152:155], v[136:139]
v_exp_f32 v57, v57
v_mfma_f32_16x16x32_bf16 v[12:15], a[164:167], v[156:159], v[12:15]
v_exp_f32 v58, v58
v_mfma_f32_16x16x32_bf16 v[12:15], a[168:171], v[160:163], v[12:15]
ds_read_b64_tr_b16 a[184:185], v222 offset:40960
v_cvt_pk_bf16_f32 v96, v56, v57
v_mfma_f32_16x16x32_bf16 v[12:15], a[172:175], v[164:167], v[12:15]
v_exp_f32 v59, v59
v_mfma_f32_16x16x32_bf16 v[20:23], a[172:175], v[180:183], v[140:143]
ds_read_b64_tr_b16 a[186:187], v222 offset:45056
v_cvt_pk_bf16_f32 v97, v58, v59
v_mfma_f32_16x16x32_bf16 v[20:23], a[168:171], v[176:179], v[20:23]
v_exp_f32 v60, v60
v_mfma_f32_16x16x32_bf16 v[20:23], a[164:167], v[172:175], v[20:23]
buffer_load_dwordx4 v232, s[12:15], s39 offen offset:2048  lds
v_mfma_f32_16x16x32_bf16 v[20:23], a[160:163], v[168:171], v[20:23]
v_exp_f32 v61, v61
v_mfma_f32_16x16x32_bf16 v[28:31], a[160:163], v[184:187], v[144:147]
v_cvt_pk_bf16_f32 v98, v60, v61
v_mfma_f32_16x16x32_bf16 v[28:31], a[164:167], v[188:191], v[28:31]
v_exp_f32 v62, v62
v_mfma_f32_16x16x32_bf16 v[28:31], a[168:171], v[192:195], v[28:31]
buffer_load_dwordx4 v233, s[12:15], s39 offen offset:3072  lds
v_mfma_f32_16x16x32_bf16 v[28:31], a[172:175], v[196:199], v[28:31]
v_exp_f32 v63, v63
v_mfma_f32_16x16x32_bf16 v[36:39], a[172:175], v[212:215], v[148:151]
ds_read_b128 a[172:175], v219 offset:61440
v_cvt_pk_bf16_f32 v99, v62, v63
v_mfma_f32_16x16x32_bf16 v[36:39], a[168:171], v[208:211], v[36:39]
v_exp_f32 v64, v64
v_mfma_f32_16x16x32_bf16 v[36:39], a[164:167], v[204:207], v[36:39]
ds_read_b128 a[168:171], v218 offset:61440
ds_read_b128 a[164:167], v217 offset:61440
v_mfma_f32_16x16x32_bf16 v[36:39], a[160:163], v[200:203], v[36:39]
v_exp_f32 v65, v65
s_waitcnt lgkmcnt(8)
v_mfma_f32_16x16x32_bf16 a[64:67], v[72:75], a[192:195], a[64:67]
ds_read_b128 a[160:163], v216 offset:61440
v_cvt_pk_bf16_f32 v100, v64, v65
v_mfma_f32_16x16x32_bf16 a[80:83], v[72:75], a[196:199], a[80:83]
v_exp_f32 v66, v66
v_mfma_f32_16x16x32_bf16 a[84:87], v[76:79], a[196:199], a[84:87]
buffer_load_dword v242, v241, s[20:23], s46 offen sc1
v_mfma_f32_16x16x32_bf16 a[68:71], v[76:79], a[192:195], a[68:71]
v_exp_f32 v67, v67
v_mfma_f32_16x16x32_bf16 a[72:75], v[80:83], a[192:195], a[72:75]
v_cvt_pk_bf16_f32 v101, v66, v67
v_add_u32 v241, 1024, v241
v_mfma_f32_16x16x32_bf16 a[88:91], v[80:83], a[196:199], a[88:91]
v_exp_f32 v68, v68
v_mfma_f32_16x16x32_bf16 a[92:95], v[84:87], a[196:199], a[92:95]
ds_read_b64_tr_b16 a[196:197], v225 offset:40960
ds_read_b64_tr_b16 a[198:199], v225 offset:45056
v_mfma_f32_16x16x32_bf16 a[76:79], v[84:87], a[192:195], a[76:79]
v_exp_f32 v69, v69
v_mfma_f32_16x16x32_bf16 a[108:111], v[84:87], a[200:203], a[108:111]
ds_read_b64_tr_b16 a[192:193], v224 offset:40960
v_cvt_pk_bf16_f32 v102, v68, v69
v_mfma_f32_16x16x32_bf16 a[124:127], v[84:87], a[204:207], a[124:127]
v_exp_f32 v70, v70
v_mfma_f32_16x16x32_bf16 a[120:123], v[80:83], a[204:207], a[120:123]
ds_read_b64_tr_b16 a[194:195], v224 offset:45056
v_and_b32 v241, 0x3fff, v241
v_mfma_f32_16x16x32_bf16 a[104:107], v[80:83], a[200:203], a[104:107]
v_exp_f32 v71, v71
v_mfma_f32_16x16x32_bf16 a[100:103], v[76:79], a[200:203], a[100:103]
v_cvt_pk_bf16_f32 v103, v70, v71
v_mfma_f32_16x16x32_bf16 a[116:119], v[76:79], a[204:207], a[116:119]
v_mfma_f32_16x16x32_bf16 a[112:115], v[72:75], a[204:207], a[112:115]
ds_read_b64_tr_b16 a[204:205], v227 offset:40960
ds_read_b64_tr_b16 a[206:207], v227 offset:45056
v_mfma_f32_16x16x32_bf16 a[96:99], v[72:75], a[200:203], a[96:99]
ds_read_b64_tr_b16 a[200:201], v226 offset:40960
ds_read_b64_tr_b16 a[202:203], v226 offset:45056
v_smfmac_f32_16x16x64_bf16 a[132:135], a[208:211], v[80:87], v245
v_mfma_f32_16x16x32_bf16 v[40:43], a[144:147], v[152:155], v[136:139]
v_exp_f32 v8, v8
v_mfma_f32_16x16x32_bf16 v[40:43], a[148:151], v[156:159], v[40:43]
v_exp_f32 v9, v9
v_mfma_f32_16x16x32_bf16 v[40:43], a[152:155], v[160:163], v[40:43]
v_cvt_pk_bf16_f32 v72, v8, v9
v_mfma_f32_16x16x32_bf16 v[40:43], a[156:159], v[164:167], v[40:43]
v_exp_f32 v10, v10
v_mfma_f32_16x16x32_bf16 v[48:51], a[156:159], v[180:183], v[140:143]
v_mfma_f32_16x16x32_bf16 v[48:51], a[152:155], v[176:179], v[48:51]
v_exp_f32 v11, v11
v_mfma_f32_16x16x32_bf16 v[48:51], a[148:151], v[172:175], v[48:51]
v_cvt_pk_bf16_f32 v73, v10, v11
v_mfma_f32_16x16x32_bf16 v[48:51], a[144:147], v[168:171], v[48:51]
v_exp_f32 v12, v12
v_mfma_f32_16x16x32_bf16 v[56:59], a[144:147], v[184:187], v[144:147]
v_mfma_f32_16x16x32_bf16 v[56:59], a[148:151], v[188:191], v[56:59]
v_exp_f32 v13, v13
v_mfma_f32_16x16x32_bf16 v[56:59], a[152:155], v[192:195], v[56:59]
v_cvt_pk_bf16_f32 v74, v12, v13
v_mfma_f32_16x16x32_bf16 v[56:59], a[156:159], v[196:199], v[56:59]
v_exp_f32 v14, v14
v_mfma_f32_16x16x32_bf16 v[64:67], a[156:159], v[212:215], v[148:151]
s_waitcnt vmcnt(10) lgkmcnt(0)
s_barrier
v_mfma_f32_16x16x32_bf16 v[64:67], a[152:155], v[208:211], v[64:67]
v_exp_f32 v15, v15
v_mfma_f32_16x16x32_bf16 v[64:67], a[148:151], v[204:207], v[64:67]
ds_read_b128 a[156:159], v219 offset:0
v_cvt_pk_bf16_f32 v75, v14, v15
v_mfma_f32_16x16x32_bf16 v[64:67], a[144:147], v[200:203], v[64:67]
v_exp_f32 v16, v16
v_mfma_f32_16x16x32_bf16 a[0:3], v[88:91], a[176:179], a[0:3]
ds_read_b128 a[152:155], v218 offset:0
ds_read_b128 a[148:151], v217 offset:0
v_mfma_f32_16x16x32_bf16 a[16:19], v[88:91], a[180:183], a[16:19]
v_exp_f32 v17, v17
v_mfma_f32_16x16x32_bf16 a[20:23], v[92:95], a[180:183], a[20:23]
ds_read_b128 a[144:147], v216 offset:0
v_cvt_pk_bf16_f32 v76, v16, v17
v_mfma_f32_16x16x32_bf16 a[4:7], v[92:95], a[176:179], a[4:7]
v_exp_f32 v18, v18
v_mfma_f32_16x16x32_bf16 a[8:11], v[96:99], a[176:179], a[8:11]
s_add_u32 s32, s32, 16384
s_add_u32 m0, s30, 114688
v_mfma_f32_16x16x32_bf16 a[24:27], v[96:99], a[180:183], a[24:27]
v_exp_f32 v19, v19
v_mfma_f32_16x16x32_bf16 a[28:31], v[100:103], a[180:183], a[28:31]
ds_read_b64_tr_b16 a[180:181], v221 offset:49152
v_cvt_pk_bf16_f32 v77, v18, v19
v_mfma_f32_16x16x32_bf16 a[12:15], v[100:103], a[176:179], a[12:15]
v_exp_f32 v20, v20
v_mfma_f32_16x16x32_bf16 a[44:47], v[100:103], a[184:187], a[44:47]
ds_read_b64_tr_b16 a[182:183], v221 offset:53248
ds_read_b64_tr_b16 a[176:177], v220 offset:49152
v_mfma_f32_16x16x32_bf16 a[60:63], v[100:103], a[188:191], a[60:63]
v_exp_f32 v21, v21
v_mfma_f32_16x16x32_bf16 a[56:59], v[96:99], a[188:191], a[56:59]
ds_read_b64_tr_b16 a[178:179], v220 offset:53248
v_cvt_pk_bf16_f32 v78, v20, v21
v_mfma_f32_16x16x32_bf16 a[40:43], v[96:99], a[184:187], a[40:43]
v_exp_f32 v22, v22
v_mfma_f32_16x16x32_bf16 a[36:39], v[92:95], a[184:187], a[36:39]
buffer_load_dwordx4 v228, s[8:11], s32 offen offset:0  lds
v_mfma_f32_16x16x32_bf16 a[52:55], v[92:95], a[188:191], a[52:55]
v_exp_f32 v23, v23
v_mfma_f32_16x16x32_bf16 a[48:51], v[88:91], a[188:191], a[48:51]
ds_read_b64_tr_b16 a[188:189], v223 offset:49152
v_cvt_pk_bf16_f32 v79, v22, v23
v_mfma_f32_16x16x32_bf16 a[32:35], v[88:91], a[184:187], a[32:35]
v_exp_f32 v24, v24
v_smfmac_f32_16x16x64_bf16 a[128:131], a[208:211], v[88:95], v245
ds_read_b64_tr_b16 a[190:191], v223 offset:53248
v_mfma_f32_16x16x32_bf16 v[44:47], a[160:163], v[152:155], v[136:139]
v_exp_f32 v25, v25
v_mfma_f32_16x16x32_bf16 v[44:47], a[164:167], v[156:159], v[44:47]
v_exp_f32 v26, v26
v_mfma_f32_16x16x32_bf16 v[44:47], a[168:171], v[160:163], v[44:47]
ds_read_b64_tr_b16 a[184:185], v222 offset:49152
v_cvt_pk_bf16_f32 v80, v24, v25
v_mfma_f32_16x16x32_bf16 v[44:47], a[172:175], v[164:167], v[44:47]
v_exp_f32 v27, v27
v_mfma_f32_16x16x32_bf16 v[52:55], a[172:175], v[180:183], v[140:143]
ds_read_b64_tr_b16 a[186:187], v222 offset:53248
v_cvt_pk_bf16_f32 v81, v26, v27
v_mfma_f32_16x16x32_bf16 v[52:55], a[168:171], v[176:179], v[52:55]
v_exp_f32 v28, v28
v_mfma_f32_16x16x32_bf16 v[52:55], a[164:167], v[172:175], v[52:55]
buffer_load_dwordx4 v229, s[8:11], s32 offen offset:1024  lds
v_mfma_f32_16x16x32_bf16 v[52:55], a[160:163], v[168:171], v[52:55]
v_exp_f32 v29, v29
v_mfma_f32_16x16x32_bf16 v[60:63], a[160:163], v[184:187], v[144:147]
v_cvt_pk_bf16_f32 v82, v28, v29
v_mfma_f32_16x16x32_bf16 v[60:63], a[164:167], v[188:191], v[60:63]
v_exp_f32 v30, v30
v_mfma_f32_16x16x32_bf16 v[60:63], a[168:171], v[192:195], v[60:63]
buffer_load_dwordx4 v230, s[8:11], s32 offen offset:2048  lds
v_mfma_f32_16x16x32_bf16 v[60:63], a[172:175], v[196:199], v[60:63]
v_exp_f32 v31, v31
v_mfma_f32_16x16x32_bf16 v[68:71], a[172:175], v[212:215], v[148:151]
ds_read_b128 a[172:175], v219 offset:4096
v_cvt_pk_bf16_f32 v83, v30, v31
v_mfma_f32_16x16x32_bf16 v[68:71], a[168:171], v[208:211], v[68:71]
v_exp_f32 v32, v32
v_mfma_f32_16x16x32_bf16 v[68:71], a[164:167], v[204:207], v[68:71]
ds_read_b128 a[168:171], v218 offset:4096
ds_read_b128 a[164:167], v217 offset:4096
v_mfma_f32_16x16x32_bf16 v[68:71], a[160:163], v[200:203], v[68:71]
v_exp_f32 v33, v33
v_mfma_f32_16x16x32_bf16 a[64:67], v[88:91], a[192:195], a[64:67]
ds_read_b128 a[160:163], v216 offset:4096
v_cvt_pk_bf16_f32 v84, v32, v33
v_mfma_f32_16x16x32_bf16 a[80:83], v[88:91], a[196:199], a[80:83]
v_exp_f32 v34, v34
v_mfma_f32_16x16x32_bf16 a[84:87], v[92:95], a[196:199], a[84:87]
buffer_load_dwordx4 v231, s[8:11], s32 offen offset:3072  lds
v_mfma_f32_16x16x32_bf16 a[68:71], v[92:95], a[192:195], a[68:71]
v_exp_f32 v35, v35
v_mfma_f32_16x16x32_bf16 a[72:75], v[96:99], a[192:195], a[72:75]
v_cvt_pk_bf16_f32 v85, v34, v35
v_mfma_f32_16x16x32_bf16 a[88:91], v[96:99], a[196:199], a[88:91]
v_exp_f32 v36, v36
v_mfma_f32_16x16x32_bf16 a[92:95], v[100:103], a[196:199], a[92:95]
ds_read_b64_tr_b16 a[196:197], v225 offset:49152
ds_read_b64_tr_b16 a[198:199], v225 offset:53248
v_mfma_f32_16x16x32_bf16 a[76:79], v[100:103], a[192:195], a[76:79]
v_exp_f32 v37, v37
v_mfma_f32_16x16x32_bf16 a[108:111], v[100:103], a[200:203], a[108:111]
ds_read_b64_tr_b16 a[192:193], v224 offset:49152
v_cvt_pk_bf16_f32 v86, v36, v37
v_mfma_f32_16x16x32_bf16 a[124:127], v[100:103], a[204:207], a[124:127]
v_exp_f32 v38, v38
v_mfma_f32_16x16x32_bf16 a[120:123], v[96:99], a[204:207], a[120:123]
ds_read_b64_tr_b16 a[194:195], v224 offset:53248
v_mfma_f32_16x16x32_bf16 a[104:107], v[96:99], a[200:203], a[104:107]
v_exp_f32 v39, v39
v_mfma_f32_16x16x32_bf16 a[100:103], v[92:95], a[200:203], a[100:103]
v_cvt_pk_bf16_f32 v87, v38, v39
v_mfma_f32_16x16x32_bf16 a[116:119], v[92:95], a[204:207], a[116:119]
s_mov_b32 m0, s87
s_lshl2_add_u32 s50, s87, s89
buffer_load_dwordx4 v243, s[56:59], s50 offen  lds
v_mfma_f32_16x16x32_bf16 a[112:115], v[88:91], a[204:207], a[112:115]
ds_read_b64_tr_b16 a[204:205], v227 offset:49152
ds_read_b64_tr_b16 a[206:207], v227 offset:53248
v_mfma_f32_16x16x32_bf16 a[96:99], v[88:91], a[200:203], a[96:99]
ds_read_b64_tr_b16 a[200:201], v226 offset:49152
ds_read_b64_tr_b16 a[202:203], v226 offset:53248
v_smfmac_f32_16x16x64_bf16 a[132:135], a[208:211], v[96:103], v245
s_add_u32 s87, s87, 3456
s_min_u32 s87, s87, 63936
s_waitcnt lgkmcnt(8)
v_mfma_f32_16x16x32_bf16 v[8:11], a[144:147], v[152:155], v[136:139]
v_exp_f32 v40, v40
v_mfma_f32_16x16x32_bf16 v[8:11], a[148:151], v[156:159], v[8:11]
v_exp_f32 v41, v41
v_mfma_f32_16x16x32_bf16 v[8:11], a[152:155], v[160:163], v[8:11]
v_cvt_pk_bf16_f32 v88, v40, v41
v_mfma_f32_16x16x32_bf16 v[8:11], a[156:159], v[164:167], v[8:11]
v_exp_f32 v42, v42
v_mfma_f32_16x16x32_bf16 v[16:19], a[156:159], v[180:183], v[140:143]
s_add_u32 s39, s39, 16384
v_mfma_f32_16x16x32_bf16 v[16:19], a[152:155], v[176:179], v[16:19]
v_exp_f32 v43, v43
v_mfma_f32_16x16x32_bf16 v[16:19], a[148:151], v[172:175], v[16:19]
v_cvt_pk_bf16_f32 v89, v42, v43
v_mfma_f32_16x16x32_bf16 v[16:19], a[144:147], v[168:171], v[16:19]
v_exp_f32 v44, v44
v_mfma_f32_16x16x32_bf16 v[24:27], a[144:147], v[184:187], v[144:147]
v_mfma_f32_16x16x32_bf16 v[24:27], a[148:151], v[188:191], v[24:27]
v_exp_f32 v45, v45
v_mfma_f32_16x16x32_bf16 v[24:27], a[152:155], v[192:195], v[24:27]
s_add_u32 m0, s30, 131072
v_cvt_pk_bf16_f32 v90, v44, v45
v_mfma_f32_16x16x32_bf16 v[24:27], a[156:159], v[196:199], v[24:27]
v_exp_f32 v46, v46
v_mfma_f32_16x16x32_bf16 v[32:35], a[156:159], v[212:215], v[148:151]
ds_read_b128 a[156:159], v219 offset:8192
v_mfma_f32_16x16x32_bf16 v[32:35], a[152:155], v[208:211], v[32:35]
v_exp_f32 v47, v47
v_mfma_f32_16x16x32_bf16 v[32:35], a[148:151], v[204:207], v[32:35]
ds_read_b128 a[152:155], v218 offset:8192
v_cvt_pk_bf16_f32 v91, v46, v47
v_mfma_f32_16x16x32_bf16 v[32:35], a[144:147], v[200:203], v[32:35]
v_exp_f32 v48, v48
v_mfma_f32_16x16x32_bf16 a[0:3], v[72:75], a[176:179], a[0:3]
ds_read_b128 a[148:151], v217 offset:8192
ds_read_b128 a[144:147], v216 offset:8192
v_mfma_f32_16x16x32_bf16 a[16:19], v[72:75], a[180:183], a[16:19]
v_exp_f32 v49, v49
v_mfma_f32_16x16x32_bf16 a[20:23], v[76:79], a[180:183], a[20:23]
v_cvt_pk_bf16_f32 v92, v48, v49
v_mfma_f32_16x16x32_bf16 a[4:7], v[76:79], a[176:179], a[4:7]
v_exp_f32 v50, v50
v_mfma_f32_16x16x32_bf16 a[8:11], v[80:83], a[176:179], a[8:11]
buffer_load_dwordx4 v232, s[12:15], s39 offen offset:0  lds
v_mfma_f32_16x16x32_bf16 a[24:27], v[80:83], a[180:183], a[24:27]
v_exp_f32 v51, v51
v_mfma_f32_16x16x32_bf16 a[28:31], v[84:87], a[180:183], a[28:31]
ds_read_b64_tr_b16 a[180:181], v221 offset:57344
v_cvt_pk_bf16_f32 v93, v50, v51
v_mfma_f32_16x16x32_bf16 a[12:15], v[84:87], a[176:179], a[12:15]
v_exp_f32 v52, v52
v_mfma_f32_16x16x32_bf16 a[44:47], v[84:87], a[184:187], a[44:47]
ds_read_b64_tr_b16 a[182:183], v221 offset:61440
ds_read_b64_tr_b16 a[176:177], v220 offset:57344
v_mfma_f32_16x16x32_bf16 a[60:63], v[84:87], a[188:191], a[60:63]
v_exp_f32 v53, v53
v_mfma_f32_16x16x32_bf16 a[56:59], v[80:83], a[188:191], a[56:59]
ds_read_b64_tr_b16 a[178:179], v220 offset:61440
v_cvt_pk_bf16_f32 v94, v52, v53
v_mfma_f32_16x16x32_bf16 a[40:43], v[80:83], a[184:187], a[40:43]
v_exp_f32 v54, v54
v_mfma_f32_16x16x32_bf16 a[36:39], v[76:79], a[184:187], a[36:39]
buffer_load_dwordx4 v233, s[12:15], s39 offen offset:1024  lds
v_mfma_f32_16x16x32_bf16 a[52:55], v[76:79], a[188:191], a[52:55]
v_exp_f32 v55, v55
v_mfma_f32_16x16x32_bf16 a[48:51], v[72:75], a[188:191], a[48:51]
ds_read_b64_tr_b16 a[188:189], v223 offset:57344
v_cvt_pk_bf16_f32 v95, v54, v55
v_mfma_f32_16x16x32_bf16 a[32:35], v[72:75], a[184:187], a[32:35]
v_exp_f32 v56, v56
v_smfmac_f32_16x16x64_bf16 a[128:131], a[208:211], v[72:79], v245
ds_read_b64_tr_b16 a[190:191], v223 offset:61440
v_mfma_f32_16x16x32_bf16 v[12:15], a[160:163], v[152:155], v[136:139]
v_exp_f32 v57, v57
v_mfma_f32_16x16x32_bf16 v[12:15], a[164:167], v[156:159], v[12:15]
v_exp_f32 v58, v58
v_mfma_f32_16x16x32_bf16 v[12:15], a[168:171], v[160:163], v[12:15]
ds_read_b64_tr_b16 a[184:185], v222 offset:57344
v_cvt_pk_bf16_f32 v96, v56, v57
v_mfma_f32_16x16x32_bf16 v[12:15], a[172:175], v[164:167], v[12:15]
v_exp_f32 v59, v59
v_mfma_f32_16x16x32_bf16 v[20:23], a[172:175], v[180:183], v[140:143]
ds_read_b64_tr_b16 a[186:187], v222 offset:61440
v_cvt_pk_bf16_f32 v97, v58, v59
v_mfma_f32_16x16x32_bf16 v[20:23], a[168:171], v[176:179], v[20:23]
v_exp_f32 v60, v60
v_mfma_f32_16x16x32_bf16 v[20:23], a[164:167], v[172:175], v[20:23]
buffer_load_dwordx4 v232, s[12:15], s39 offen offset:2048  lds
v_mfma_f32_16x16x32_bf16 v[20:23], a[160:163], v[168:171], v[20:23]
v_exp_f32 v61, v61
v_mfma_f32_16x16x32_bf16 v[28:31], a[160:163], v[184:187], v[144:147]
v_cvt_pk_bf16_f32 v98, v60, v61
v_mfma_f32_16x16x32_bf16 v[28:31], a[164:167], v[188:191], v[28:31]
v_exp_f32 v62, v62
v_mfma_f32_16x16x32_bf16 v[28:31], a[168:171], v[192:195], v[28:31]
buffer_load_dwordx4 v233, s[12:15], s39 offen offset:3072  lds
v_mfma_f32_16x16x32_bf16 v[28:31], a[172:175], v[196:199], v[28:31]
v_exp_f32 v63, v63
v_mfma_f32_16x16x32_bf16 v[36:39], a[172:175], v[212:215], v[148:151]
ds_read_b128 a[172:175], v219 offset:12288
v_cvt_pk_bf16_f32 v99, v62, v63
v_mfma_f32_16x16x32_bf16 v[36:39], a[168:171], v[208:211], v[36:39]
v_exp_f32 v64, v64
v_mfma_f32_16x16x32_bf16 v[36:39], a[164:167], v[204:207], v[36:39]
ds_read_b128 a[168:171], v218 offset:12288
ds_read_b128 a[164:167], v217 offset:12288
v_mfma_f32_16x16x32_bf16 v[36:39], a[160:163], v[200:203], v[36:39]
v_exp_f32 v65, v65
s_waitcnt lgkmcnt(8)
v_mfma_f32_16x16x32_bf16 a[64:67], v[72:75], a[192:195], a[64:67]
ds_read_b128 a[160:163], v216 offset:12288
v_cvt_pk_bf16_f32 v100, v64, v65
v_mfma_f32_16x16x32_bf16 a[80:83], v[72:75], a[196:199], a[80:83]
v_exp_f32 v66, v66
v_mfma_f32_16x16x32_bf16 a[84:87], v[76:79], a[196:199], a[84:87]
buffer_load_dword v242, v241, s[20:23], s46 offen sc1
v_mfma_f32_16x16x32_bf16 a[68:71], v[76:79], a[192:195], a[68:71]
v_exp_f32 v67, v67
v_mfma_f32_16x16x32_bf16 a[72:75], v[80:83], a[192:195], a[72:75]
v_cvt_pk_bf16_f32 v101, v66, v67
v_add_u32 v241, 1024, v241
v_mfma_f32_16x16x32_bf16 a[88:91], v[80:83], a[196:199], a[88:91]
v_exp_f32 v68, v68
v_mfma_f32_16x16x32_bf16 a[92:95], v[84:87], a[196:199], a[92:95]
ds_read_b64_tr_b16 a[196:197], v225 offset:57344
ds_read_b64_tr_b16 a[198:199], v225 offset:61440
v_mfma_f32_16x16x32_bf16 a[76:79], v[84:87], a[192:195], a[76:79]
v_exp_f32 v69, v69
v_mfma_f32_16x16x32_bf16 a[108:111], v[84:87], a[200:203], a[108:111]
ds_read_b64_tr_b16 a[192:193], v224 offset:57344
v_cvt_pk_bf16_f32 v102, v68, v69
v_mfma_f32_16x16x32_bf16 a[124:127], v[84:87], a[204:207], a[124:127]
v_exp_f32 v70, v70
v_mfma_f32_16x16x32_bf16 a[120:123], v[80:83], a[204:207], a[120:123]
ds_read_b64_tr_b16 a[194:195], v224 offset:61440
v_and_b32 v241, 0x3fff, v241
v_mfma_f32_16x16x32_bf16 a[104:107], v[80:83], a[200:203], a[104:107]
v_exp_f32 v71, v71
v_mfma_f32_16x16x32_bf16 a[100:103], v[76:79], a[200:203], a[100:103]
v_cvt_pk_bf16_f32 v103, v70, v71
v_mfma_f32_16x16x32_bf16 a[116:119], v[76:79], a[204:207], a[116:119]
v_mfma_f32_16x16x32_bf16 a[112:115], v[72:75], a[204:207], a[112:115]
ds_read_b64_tr_b16 a[204:205], v227 offset:57344
ds_read_b64_tr_b16 a[206:207], v227 offset:61440
v_mfma_f32_16x16x32_bf16 a[96:99], v[72:75], a[200:203], a[96:99]
ds_read_b64_tr_b16 a[200:201], v226 offset:57344
ds_read_b64_tr_b16 a[202:203], v226 offset:61440
v_smfmac_f32_16x16x64_bf16 a[132:135], a[208:211], v[80:87], v245
s_sub_u32 s33, s33, 1
s_cmp_lg_u32 s33, 0
s_cbranch_scc1 K_LOOP
K_LAST:
v_mfma_f32_16x16x32_bf16 v[40:43], a[144:147], v[152:155], v[136:139]
v_and_b32 v106, 7, v1
v_exp_f32 v8, v8
v_mfma_f32_16x16x32_bf16 v[40:43], a[148:151], v[156:159], v[40:43]
v_lshlrev_b32 v106, 3, v106
v_exp_f32 v9, v9
v_mfma_f32_16x16x32_bf16 v[40:43], a[152:155], v[160:163], v[40:43]
v_cvt_pk_bf16_f32 v72, v8, v9
v_mfma_f32_16x16x32_bf16 v[40:43], a[156:159], v[164:167], v[40:43]
v_exp_f32 v10, v10
v_mfma_f32_16x16x32_bf16 v[48:51], a[156:159], v[180:183], v[140:143]
v_mfma_f32_16x16x32_bf16 v[48:51], a[152:155], v[176:179], v[48:51]
v_exp_f32 v11, v11
STUB_11:
s_cbranch_execz HOP_RET1
v_mfma_f32_16x16x32_bf16 v[48:51], a[148:151], v[172:175], v[48:51]
v_cvt_pk_bf16_f32 v73, v10, v11
v_mfma_f32_16x16x32_bf16 v[48:51], a[144:147], v[168:171], v[48:51]
v_exp_f32 v12, v12
v_mfma_f32_16x16x32_bf16 v[56:59], a[144:147], v[184:187], v[144:147]
v_mfma_f32_16x16x32_bf16 v[56:59], a[148:151], v[188:191], v[56:59]
v_exp_f32 v13, v13
v_mfma_f32_16x16x32_bf16 v[56:59], a[152:155], v[192:195], v[56:59]
v_cvt_pk_bf16_f32 v74, v12, v13
v_mfma_f32_16x16x32_bf16 v[56:59], a[156:159], v[196:199], v[56:59]
v_exp_f32 v14, v14
v_mfma_f32_16x16x32_bf16 v[64:67], a[156:159], v[212:215], v[148:151]
s_waitcnt vmcnt(10) lgkmcnt(0)
s_barrier
v_mfma_f32_16x16x32_bf16 v[64:67], a[152:155], v[208:211], v[64:67]
v_exp_f32 v15, v15
v_mfma_f32_16x16x32_bf16 v[64:67], a[148:151], v[204:207], v[64:67]
ds_read_b128 a[156:159], v219 offset:16384
v_cvt_pk_bf16_f32 v75, v14, v15
v_mfma_f32_16x16x32_bf16 v[64:67], a[144:147], v[200:203], v[64:67]
v_exp_f32 v16, v16
v_mfma_f32_16x16x32_bf16 a[0:3], v[88:91], a[176:179], a[0:3]
ds_read_b128 a[152:155], v218 offset:16384
ds_read_b128 a[148:151], v217 offset:16384
v_mfma_f32_16x16x32_bf16 a[16:19], v[88:91], a[180:183], a[16:19]
v_exp_f32 v17, v17
v_mfma_f32_16x16x32_bf16 a[20:23], v[92:95], a[180:183], a[20:23]
ds_read_b128 a[144:147], v216 offset:16384
v_cvt_pk_bf16_f32 v76, v16, v17
v_mfma_f32_16x16x32_bf16 a[4:7], v[92:95], a[176:179], a[4:7]
v_exp_f32 v18, v18
v_mfma_f32_16x16x32_bf16 a[8:11], v[96:99], a[176:179], a[8:11]
s_add_u32 m0, s88, 62208
s_lshl2_add_u32 s50, m0, s89
buffer_load_dwordx4 v243, s[56:59], s50 offen  lds
v_mfma_f32_16x16x32_bf16 a[24:27], v[96:99], a[180:183], a[24:27]
v_exp_f32 v19, v19
v_mfma_f32_16x16x32_bf16 a[28:31], v[100:103], a[180:183], a[28:31]
ds_read_b64_tr_b16 a[180:181], v221 offset:0
v_cvt_pk_bf16_f32 v77, v18, v19
v_mfma_f32_16x16x32_bf16 a[12:15], v[100:103], a[176:179], a[12:15]
v_exp_f32 v20, v20
v_mfma_f32_16x16x32_bf16 a[44:47], v[100:103], a[184:187], a[44:47]
ds_read_b64_tr_b16 a[182:183], v221 offset:4096
ds_read_b64_tr_b16 a[176:177], v220 offset:0
v_mfma_f32_16x16x32_bf16 a[60:63], v[100:103], a[188:191], a[60:63]
v_exp_f32 v21, v21
v_mfma_f32_16x16x32_bf16 a[56:59], v[96:99], a[188:191], a[56:59]
ds_read_b64_tr_b16 a[178:179], v220 offset:4096
v_cvt_pk_bf16_f32 v78, v20, v21
v_mfma_f32_16x16x32_bf16 a[40:43], v[96:99], a[184:187], a[40:43]
v_exp_f32 v22, v22
v_mfma_f32_16x16x32_bf16 a[36:39], v[92:95], a[184:187], a[36:39]
s_mov_b32 s93, 0x242800
buffer_load_dwordx2 v[104:105], v106, s[20:23], s93 offen sc0 sc1
v_mfma_f32_16x16x32_bf16 a[52:55], v[92:95], a[188:191], a[52:55]
v_and_b32 v246, 15, v1
v_exp_f32 v23, v23
v_mfma_f32_16x16x32_bf16 a[48:51], v[88:91], a[188:191], a[48:51]
ds_read_b64_tr_b16 a[188:189], v223 offset:0
v_cvt_pk_bf16_f32 v79, v22, v23
v_lshrrev_b32 v247, 3, v246
v_mfma_f32_16x16x32_bf16 a[32:35], v[88:91], a[184:187], a[32:35]
v_and_b32 v246, 7, v246
v_exp_f32 v24, v24
v_smfmac_f32_16x16x64_bf16 a[128:131], a[208:211], v[88:95], v245
ds_read_b64_tr_b16 a[190:191], v223 offset:4096
v_lshlrev_b32 v246, 6, v246
v_mfma_f32_16x16x32_bf16 v[44:47], a[160:163], v[152:155], v[136:139]
v_lshl_add_u32 v246, v247, 13, v246
v_exp_f32 v25, v25
v_mfma_f32_16x16x32_bf16 v[44:47], a[164:167], v[156:159], v[44:47]
v_exp_f32 v26, v26
v_mfma_f32_16x16x32_bf16 v[44:47], a[168:171], v[160:163], v[44:47]
ds_read_b64_tr_b16 a[184:185], v222 offset:0
v_cvt_pk_bf16_f32 v80, v24, v25
v_mfma_f32_16x16x32_bf16 v[44:47], a[172:175], v[164:167], v[44:47]
v_exp_f32 v27, v27
v_mfma_f32_16x16x32_bf16 v[52:55], a[172:175], v[180:183], v[140:143]
ds_read_b64_tr_b16 a[186:187], v222 offset:4096
v_cvt_pk_bf16_f32 v81, v26, v27
v_mfma_f32_16x16x32_bf16 v[52:55], a[168:171], v[176:179], v[52:55]
v_exp_f32 v28, v28
v_mfma_f32_16x16x32_bf16 v[52:55], a[164:167], v[172:175], v[52:55]
s_add_u32 m0, s88, 65664
s_lshl2_add_u32 s50, m0, s89
buffer_load_dwordx4 v243, s[56:59], s50 offen  lds
v_mfma_f32_16x16x32_bf16 v[52:55], a[160:163], v[168:171], v[52:55]
v_exp_f32 v29, v29
v_mfma_f32_16x16x32_bf16 v[60:63], a[160:163], v[184:187], v[144:147]
s_lshl_b32 s28, s36, 9
s_add_u32 s28, s28, 0x248000
v_cvt_pk_bf16_f32 v82, v28, v29
v_mfma_f32_16x16x32_bf16 v[60:63], a[164:167], v[188:191], v[60:63]
v_exp_f32 v30, v30
v_mfma_f32_16x16x32_bf16 v[60:63], a[168:171], v[192:195], v[60:63]
buffer_load_dword v242, v246, s[20:23], s28 offen sc1
v_mfma_f32_16x16x32_bf16 v[60:63], a[172:175], v[196:199], v[60:63]
v_bfe_u32 v246, v1, 2, 2
v_exp_f32 v31, v31
v_mfma_f32_16x16x32_bf16 v[68:71], a[172:175], v[212:215], v[148:151]
ds_read_b128 a[172:175], v219 offset:20480
v_cvt_pk_bf16_f32 v83, v30, v31
v_lshl_add_u32 v246, v4, 2, v246
v_mfma_f32_16x16x32_bf16 v[68:71], a[168:171], v[208:211], v[68:71]
v_mul_u32_u24 v246, 288, v246
v_exp_f32 v32, v32
v_mfma_f32_16x16x32_bf16 v[68:71], a[164:167], v[204:207], v[68:71]
ds_read_b128 a[168:171], v218 offset:20480
ds_read_b128 a[164:167], v217 offset:20480
v_and_b32 v247, 3, v1
v_mfma_f32_16x16x32_bf16 v[68:71], a[160:163], v[200:203], v[68:71]
v_lshl_add_u32 v236, v247, 3, v246
v_exp_f32 v33, v33
v_mfma_f32_16x16x32_bf16 a[64:67], v[88:91], a[192:195], a[64:67]
ds_read_b128 a[160:163], v216 offset:20480
v_cvt_pk_bf16_f32 v84, v32, v33
v_add_u32 v236, 256, v236
v_mfma_f32_16x16x32_bf16 a[80:83], v[88:91], a[196:199], a[80:83]
v_lshl_add_u32 v246, v247, 4, v246
v_exp_f32 v34, v34
v_mfma_f32_16x16x32_bf16 a[84:87], v[92:95], a[196:199], a[84:87]
s_add_u32 m0, s88, 69120
s_lshl2_add_u32 s50, m0, s89
buffer_load_dwordx4 v243, s[56:59], s50 offen  lds
v_mfma_f32_16x16x32_bf16 a[68:71], v[92:95], a[192:195], a[68:71]
v_exp_f32 v35, v35
v_mfma_f32_16x16x32_bf16 a[72:75], v[96:99], a[192:195], a[72:75]
s_lshr_b32 s28, s35, 4
s_lshl_b32 s28, s28, 6
v_cvt_pk_bf16_f32 v85, v34, v35
v_mfma_f32_16x16x32_bf16 a[88:91], v[96:99], a[196:199], a[88:91]
v_add_u32 v234, s28, v246
v_exp_f32 v36, v36
v_mfma_f32_16x16x32_bf16 a[92:95], v[100:103], a[196:199], a[92:95]
ds_read_b64_tr_b16 a[196:197], v225 offset:0
ds_read_b64_tr_b16 a[198:199], v225 offset:4096
s_xor_b32 s28, s28, 64
v_mfma_f32_16x16x32_bf16 a[76:79], v[100:103], a[192:195], a[76:79]
v_add_u32 v235, s28, v246
v_exp_f32 v37, v37
v_mfma_f32_16x16x32_bf16 a[108:111], v[100:103], a[200:203], a[108:111]
ds_read_b64_tr_b16 a[192:193], v224 offset:0
v_cvt_pk_bf16_f32 v86, v36, v37
v_mfma_f32_16x16x32_bf16 a[124:127], v[100:103], a[204:207], a[124:127]
v_exp_f32 v38, v38
v_mfma_f32_16x16x32_bf16 a[120:123], v[96:99], a[204:207], a[120:123]
ds_read_b64_tr_b16 a[194:195], v224 offset:4096
s_add_u32 s28, s35, 0
s_and_b32 s28, s28, 3
v_mfma_f32_16x16x32_bf16 a[104:107], v[96:99], a[200:203], a[104:107]
s_mul_i32 s28, s28, 36864
v_exp_f32 v39, v39
v_mfma_f32_16x16x32_bf16 a[100:103], v[92:95], a[200:203], a[100:103]
v_cvt_pk_bf16_f32 v87, v38, v39
v_add_u32 v237, s28, v234
v_add_u32 v238, s28, v235
v_mfma_f32_16x16x32_bf16 a[116:119], v[92:95], a[204:207], a[116:119]
v_add_u32 v239, s28, v236
v_mfma_f32_16x16x32_bf16 a[112:115], v[88:91], a[204:207], a[112:115]
ds_read_b64_tr_b16 a[204:205], v227 offset:0
ds_read_b64_tr_b16 a[206:207], v227 offset:4096
v_mov_b32 v254, 0x7ffffff0
v_mfma_f32_16x16x32_bf16 a[96:99], v[88:91], a[200:203], a[96:99]
ds_read_b64_tr_b16 a[200:201], v226 offset:0
ds_read_b64_tr_b16 a[202:203], v226 offset:4096
s_lshl2_add_u32 s92, s36, s37
v_smfmac_f32_16x16x64_bf16 a[132:135], a[208:211], v[96:103], v245
s_bfe_u32 s93, s35, 0x20002
s_waitcnt lgkmcnt(8)
v_mfma_f32_16x16x32_bf16 v[8:11], a[144:147], v[152:155], v[136:139]
s_lshl2_add_u32 s92, s92, s93
v_exp_f32 v40, v40
v_mfma_f32_16x16x32_bf16 v[8:11], a[148:151], v[156:159], v[8:11]
s_lshl_b32 s93, s92, 4
v_exp_f32 v41, v41
v_mfma_f32_16x16x32_bf16 v[8:11], a[152:155], v[160:163], v[8:11]
v_cvt_pk_bf16_f32 v88, v40, v41
v_add_u32 v132, s93, v3
v_writelane_b32 v254, 0, 0
v_mfma_f32_16x16x32_bf16 v[8:11], a[156:159], v[164:167], v[8:11]
s_and_b32 s93, s35, 3
v_exp_f32 v42, v42
v_mfma_f32_16x16x32_bf16 v[16:19], a[156:159], v[180:183], v[140:143]
s_add_u32 s39, s39, 16384
s_mul_i32 s93, s93, 144
v_mfma_f32_16x16x32_bf16 v[16:19], a[152:155], v[176:179], v[16:19]
v_lshlrev_b32 v251, 2, v4
v_exp_f32 v43, v43
v_mfma_f32_16x16x32_bf16 v[16:19], a[148:151], v[172:175], v[16:19]
v_cvt_pk_bf16_f32 v89, v42, v43
v_add_u32 v251, s93, v251
v_add_u32 v251, 128, v251
v_mfma_f32_16x16x32_bf16 v[16:19], a[144:147], v[168:171], v[16:19]
v_lshlrev_b32 v250, 3, v4
v_exp_f32 v44, v44
v_mfma_f32_16x16x32_bf16 v[24:27], a[144:147], v[184:187], v[144:147]
s_lshr_b32 s90, s35, 4
s_lshl_b32 s90, s90, 5
s_add_u32 s93, s93, s90
v_mfma_f32_16x16x32_bf16 v[24:27], a[148:151], v[188:191], v[24:27]
v_add_u32 v250, s93, v250
v_exp_f32 v45, v45
v_mfma_f32_16x16x32_bf16 v[24:27], a[152:155], v[192:195], v[24:27]
s_add_u32 m0, s30, 147456
v_cvt_pk_bf16_f32 v90, v44, v45
v_lshlrev_b32 v250, 1, v250
v_mfma_f32_16x16x32_bf16 v[24:27], a[156:159], v[196:199], v[24:27]
v_lshlrev_b32 v251, 1, v251
v_exp_f32 v46, v46
v_mfma_f32_16x16x32_bf16 v[32:35], a[156:159], v[212:215], v[148:151]
ds_read_b128 a[156:159], v219 offset:24576
v_mul_u32_u24 v133, 0x480, v132
v_add_u32 v248, v133, v250
v_mfma_f32_16x16x32_bf16 v[32:35], a[152:155], v[208:211], v[32:35]
v_add_u32 v249, v133, v251
v_exp_f32 v47, v47
v_mfma_f32_16x16x32_bf16 v[32:35], a[148:151], v[204:207], v[32:35]
ds_read_b128 a[152:155], v218 offset:24576
v_cvt_pk_bf16_f32 v91, v46, v47
v_mov_b32 v135, 0x7fffbff0
v_mfma_f32_16x16x32_bf16 v[32:35], a[144:147], v[200:203], v[32:35]
v_exp_f32 v48, v48
v_mfma_f32_16x16x32_bf16 a[0:3], v[72:75], a[176:179], a[0:3]
ds_read_b128 a[148:151], v217 offset:24576
ds_read_b128 a[144:147], v216 offset:24576
v_mfma_f32_16x16x32_bf16 a[16:19], v[72:75], a[180:183], a[16:19]
v_exp_f32 v49, v49
v_mfma_f32_16x16x32_bf16 a[20:23], v[76:79], a[180:183], a[20:23]
v_cvt_pk_bf16_f32 v92, v48, v49
v_mfma_f32_16x16x32_bf16 a[4:7], v[76:79], a[176:179], a[4:7]
v_exp_f32 v50, v50
v_mfma_f32_16x16x32_bf16 a[8:11], v[80:83], a[176:179], a[8:11]
buffer_load_dwordx4 v232, s[12:15], s39 offen offset:0  lds
v_mfma_f32_16x16x32_bf16 a[24:27], v[80:83], a[180:183], a[24:27]
v_exp_f32 v51, v51
v_mfma_f32_16x16x32_bf16 a[28:31], v[84:87], a[180:183], a[28:31]
ds_read_b64_tr_b16 a[180:181], v221 offset:8192
v_cvt_pk_bf16_f32 v93, v50, v51
v_mfma_f32_16x16x32_bf16 a[12:15], v[84:87], a[176:179], a[12:15]
v_exp_f32 v52, v52
v_mfma_f32_16x16x32_bf16 a[44:47], v[84:87], a[184:187], a[44:47]
ds_read_b64_tr_b16 a[182:183], v221 offset:12288
ds_read_b64_tr_b16 a[176:177], v220 offset:8192
v_mfma_f32_16x16x32_bf16 a[60:63], v[84:87], a[188:191], a[60:63]
v_exp_f32 v53, v53
v_mfma_f32_16x16x32_bf16 a[56:59], v[80:83], a[188:191], a[56:59]
ds_read_b64_tr_b16 a[178:179], v220 offset:12288
v_cvt_pk_bf16_f32 v94, v52, v53
v_mfma_f32_16x16x32_bf16 a[40:43], v[80:83], a[184:187], a[40:43]
v_exp_f32 v54, v54
v_mfma_f32_16x16x32_bf16 a[36:39], v[76:79], a[184:187], a[36:39]
buffer_load_dwordx4 v233, s[12:15], s39 offen offset:1024  lds
v_mfma_f32_16x16x32_bf16 a[52:55], v[76:79], a[188:191], a[52:55]
v_exp_f32 v55, v55
v_mfma_f32_16x16x32_bf16 a[48:51], v[72:75], a[188:191], a[48:51]
ds_read_b64_tr_b16 a[188:189], v223 offset:8192
v_cvt_pk_bf16_f32 v95, v54, v55
v_mfma_f32_16x16x32_bf16 a[32:35], v[72:75], a[184:187], a[32:35]
v_exp_f32 v56, v56
v_smfmac_f32_16x16x64_bf16 a[128:131], a[208:211], v[72:79], v245
ds_read_b64_tr_b16 a[190:191], v223 offset:12288
v_mfma_f32_16x16x32_bf16 v[12:15], a[160:163], v[152:155], v[136:139]
v_exp_f32 v57, v57
v_mfma_f32_16x16x32_bf16 v[12:15], a[164:167], v[156:159], v[12:15]
v_exp_f32 v58, v58
v_mfma_f32_16x16x32_bf16 v[12:15], a[168:171], v[160:163], v[12:15]
ds_read_b64_tr_b16 a[184:185], v222 offset:8192
v_cvt_pk_bf16_f32 v96, v56, v57
v_mfma_f32_16x16x32_bf16 v[12:15], a[172:175], v[164:167], v[12:15]
v_exp_f32 v59, v59
v_mfma_f32_16x16x32_bf16 v[20:23], a[172:175], v[180:183], v[140:143]
ds_read_b64_tr_b16 a[186:187], v222 offset:12288
v_cvt_pk_bf16_f32 v97, v58, v59
v_mfma_f32_16x16x32_bf16 v[20:23], a[168:171], v[176:179], v[20:23]
v_exp_f32 v60, v60
v_mfma_f32_16x16x32_bf16 v[20:23], a[164:167], v[172:175], v[20:23]
buffer_load_dwordx4 v232, s[12:15], s39 offen offset:2048  lds
v_mfma_f32_16x16x32_bf16 v[20:23], a[160:163], v[168:171], v[20:23]
v_exp_f32 v61, v61
v_mfma_f32_16x16x32_bf16 v[28:31], a[160:163], v[184:187], v[144:147]
buffer_load_dwordx4 a[212:215], v248, s[52:55], 0 offen offset:0
v_cvt_pk_bf16_f32 v98, v60, v61
v_mfma_f32_16x16x32_bf16 v[28:31], a[164:167], v[188:191], v[28:31]
v_exp_f32 v62, v62
v_mfma_f32_16x16x32_bf16 v[28:31], a[168:171], v[192:195], v[28:31]
buffer_load_dwordx4 v233, s[12:15], s39 offen offset:3072  lds
v_mfma_f32_16x16x32_bf16 v[28:31], a[172:175], v[196:199], v[28:31]
v_exp_f32 v63, v63
v_mfma_f32_16x16x32_bf16 v[36:39], a[172:175], v[212:215], v[148:151]
ds_read_b128 a[172:175], v219 offset:28672
v_cvt_pk_bf16_f32 v99, v62, v63
v_mfma_f32_16x16x32_bf16 v[36:39], a[168:171], v[208:211], v[36:39]
v_exp_f32 v64, v64
v_mfma_f32_16x16x32_bf16 v[36:39], a[164:167], v[204:207], v[36:39]
ds_read_b128 a[168:171], v218 offset:28672
ds_read_b128 a[164:167], v217 offset:28672
v_mfma_f32_16x16x32_bf16 v[36:39], a[160:163], v[200:203], v[36:39]
v_exp_f32 v65, v65
s_waitcnt lgkmcnt(8)
v_mfma_f32_16x16x32_bf16 a[64:67], v[72:75], a[192:195], a[64:67]
ds_read_b128 a[160:163], v216 offset:28672
v_cvt_pk_bf16_f32 v100, v64, v65
v_mfma_f32_16x16x32_bf16 a[80:83], v[72:75], a[196:199], a[80:83]
v_exp_f32 v66, v66
v_mfma_f32_16x16x32_bf16 a[84:87], v[76:79], a[196:199], a[84:87]
s_add_u32 m0, s88, 72576
s_lshl2_add_u32 s50, m0, s89
buffer_load_dwordx4 v243, s[56:59], s50 offen  lds
v_mfma_f32_16x16x32_bf16 a[68:71], v[76:79], a[192:195], a[68:71]
v_exp_f32 v67, v67
v_mfma_f32_16x16x32_bf16 a[72:75], v[80:83], a[192:195], a[72:75]
buffer_load_dwordx4 a[216:219], v248, s[52:55], 0 offen offset:128
v_cvt_pk_bf16_f32 v101, v66, v67
v_mfma_f32_16x16x32_bf16 a[88:91], v[80:83], a[196:199], a[88:91]
v_exp_f32 v68, v68
v_mfma_f32_16x16x32_bf16 a[92:95], v[84:87], a[196:199], a[92:95]
ds_read_b64_tr_b16 a[196:197], v225 offset:8192
ds_read_b64_tr_b16 a[198:199], v225 offset:12288
v_mfma_f32_16x16x32_bf16 a[76:79], v[84:87], a[192:195], a[76:79]
v_exp_f32 v69, v69
v_mfma_f32_16x16x32_bf16 a[108:111], v[84:87], a[200:203], a[108:111]
ds_read_b64_tr_b16 a[192:193], v224 offset:8192
v_cvt_pk_bf16_f32 v102, v68, v69
v_mfma_f32_16x16x32_bf16 a[124:127], v[84:87], a[204:207], a[124:127]
v_exp_f32 v70, v70
v_mfma_f32_16x16x32_bf16 a[120:123], v[80:83], a[204:207], a[120:123]
ds_read_b64_tr_b16 a[194:195], v224 offset:12288
v_mfma_f32_16x16x32_bf16 a[104:107], v[80:83], a[200:203], a[104:107]
v_exp_f32 v71, v71
v_mfma_f32_16x16x32_bf16 a[100:103], v[76:79], a[200:203], a[100:103]
v_cvt_pk_bf16_f32 v103, v70, v71
v_mfma_f32_16x16x32_bf16 a[116:119], v[76:79], a[204:207], a[116:119]
s_add_u32 m0, s88, 76032
s_lshl2_add_u32 s50, m0, s89
buffer_load_dwordx4 v243, s[56:59], s50 offen  lds
v_mfma_f32_16x16x32_bf16 a[112:115], v[72:75], a[204:207], a[112:115]
ds_read_b64_tr_b16 a[204:205], v227 offset:8192
ds_read_b64_tr_b16 a[206:207], v227 offset:12288
v_mfma_f32_16x16x32_bf16 a[96:99], v[72:75], a[200:203], a[96:99]
ds_read_b64_tr_b16 a[200:201], v226 offset:8192
ds_read_b64_tr_b16 a[202:203], v226 offset:12288
v_smfmac_f32_16x16x64_bf16 a[132:135], a[208:211], v[80:87], v245
buffer_load_dwordx2 a[220:221], v249, s[52:55], 0 offen
v_mfma_f32_16x16x32_bf16 v[40:43], a[144:147], v[152:155], v[136:139]
v_exp_f32 v8, v8
v_mfma_f32_16x16x32_bf16 v[40:43], a[148:151], v[156:159], v[40:43]
v_exp_f32 v9, v9
v_mfma_f32_16x16x32_bf16 v[40:43], a[152:155], v[160:163], v[40:43]
v_cvt_pk_bf16_f32 v72, v8, v9
v_mfma_f32_16x16x32_bf16 v[40:43], a[156:159], v[164:167], v[40:43]
v_exp_f32 v10, v10
v_mfma_f32_16x16x32_bf16 v[48:51], a[156:159], v[180:183], v[140:143]
s_waitcnt vmcnt(12)
v_cmp_ne_u32 vcc, s47, v105
s_cbranch_vccnz SP_FK
SP_FK_RET:
v_mfma_f32_16x16x32_bf16 v[48:51], a[152:155], v[176:179], v[48:51]
v_exp_f32 v11, v11
v_mfma_f32_16x16x32_bf16 v[48:51], a[148:151], v[172:175], v[48:51]
v_cvt_pk_bf16_f32 v73, v10, v11
v_mfma_f32_16x16x32_bf16 v[48:51], a[144:147], v[168:171], v[48:51]
v_exp_f32 v12, v12
v_mfma_f32_16x16x32_bf16 v[56:59], a[144:147], v[184:187], v[144:147]
v_mfma_f32_16x16x32_bf16 v[56:59], a[148:151], v[188:191], v[56:59]
v_exp_f32 v13, v13
v_mfma_f32_16x16x32_bf16 v[56:59], a[152:155], v[192:195], v[56:59]
v_cvt_pk_bf16_f32 v74, v12, v13
v_mfma_f32_16x16x32_bf16 v[56:59], a[156:159], v[196:199], v[56:59]
v_exp_f32 v14, v14
v_mfma_f32_16x16x32_bf16 v[64:67], a[156:159], v[212:215], v[148:151]
s_waitcnt vmcnt(14) lgkmcnt(0)
s_barrier
v_mfma_f32_16x16x32_bf16 v[64:67], a[152:155], v[208:211], v[64:67]
v_exp_f32 v15, v15
v_mfma_f32_16x16x32_bf16 v[64:67], a[148:151], v[204:207], v[64:67]
ds_read_b128 a[156:159], v219 offset:49152
v_cvt_pk_bf16_f32 v75, v14, v15
v_mfma_f32_16x16x32_bf16 v[64:67], a[144:147], v[200:203], v[64:67]
v_exp_f32 v16, v16
v_mfma_f32_16x16x32_bf16 a[0:3], v[88:91], a[176:179], a[0:3]
ds_read_b128 a[152:155], v218 offset:49152
ds_read_b128 a[148:151], v217 offset:49152
v_mfma_f32_16x16x32_bf16 a[16:19], v[88:91], a[180:183], a[16:19]
v_exp_f32 v17, v17
v_mfma_f32_16x16x32_bf16 a[20:23], v[92:95], a[180:183], a[20:23]
ds_read_b128 a[144:147], v216 offset:49152
v_cvt_pk_bf16_f32 v76, v16, v17
v_mfma_f32_16x16x32_bf16 a[4:7], v[92:95], a[176:179], a[4:7]
v_exp_f32 v18, v18
v_mfma_f32_16x16x32_bf16 a[8:11], v[96:99], a[176:179], a[8:11]
s_add_u32 m0, s88, 79488
s_lshl2_add_u32 s50, m0, s89
buffer_load_dwordx4 v243, s[56:59], s50 offen  lds
v_mfma_f32_16x16x32_bf16 a[24:27], v[96:99], a[180:183], a[24:27]
v_exp_f32 v19, v19
v_mfma_f32_16x16x32_bf16 a[28:31], v[100:103], a[180:183], a[28:31]
ds_read_b64_tr_b16 a[180:181], v221 offset:32768
v_cvt_pk_bf16_f32 v77, v18, v19
v_mfma_f32_16x16x32_bf16 a[12:15], v[100:103], a[176:179], a[12:15]
v_exp_f32 v20, v20
v_mfma_f32_16x16x32_bf16 a[44:47], v[100:103], a[184:187], a[44:47]
ds_read_b64_tr_b16 a[182:183], v221 offset:36864
ds_read_b64_tr_b16 a[176:177], v220 offset:32768
v_mfma_f32_16x16x32_bf16 a[60:63], v[100:103], a[188:191], a[60:63]
v_exp_f32 v21, v21
v_mfma_f32_16x16x32_bf16 a[56:59], v[96:99], a[188:191], a[56:59]
ds_read_b64_tr_b16 a[178:179], v220 offset:36864
v_cvt_pk_bf16_f32 v78, v20, v21
v_mfma_f32_16x16x32_bf16 a[40:43], v[96:99], a[184:187], a[40:43]
v_exp_f32 v22, v22
v_mfma_f32_16x16x32_bf16 a[36:39], v[92:95], a[184:187], a[36:39]
s_add_u32 m0, s88, 82944
s_lshl2_add_u32 s50, m0, s89
buffer_load_dwordx4 v243, s[56:59], s50 offen  lds
v_mfma_f32_16x16x32_bf16 a[52:55], v[92:95], a[188:191], a[52:55]
v_exp_f32 v23, v23
v_mfma_f32_16x16x32_bf16 a[48:51], v[88:91], a[188:191], a[48:51]
ds_read_b64_tr_b16 a[188:189], v223 offset:32768
v_cvt_pk_bf16_f32 v79, v22, v23
v_mfma_f32_16x16x32_bf16 a[32:35], v[88:91], a[184:187], a[32:35]
v_exp_f32 v24, v24
v_smfmac_f32_16x16x64_bf16 a[128:131], a[208:211], v[88:95], v245
ds_read_b64_tr_b16 a[190:191], v223 offset:36864
v_mfma_f32_16x16x32_bf16 v[44:47], a[160:163], v[152:155], v[136:139]
v_exp_f32 v25, v25
v_mfma_f32_16x16x32_bf16 v[44:47], a[164:167], v[156:159], v[44:47]
v_exp_f32 v26, v26
v_mfma_f32_16x16x32_bf16 v[44:47], a[168:171], v[160:163], v[44:47]
ds_read_b64_tr_b16 a[184:185], v222 offset:32768
v_cvt_pk_bf16_f32 v80, v24, v25
v_mfma_f32_16x16x32_bf16 v[44:47], a[172:175], v[164:167], v[44:47]
v_exp_f32 v27, v27
v_mfma_f32_16x16x32_bf16 v[52:55], a[172:175], v[180:183], v[140:143]
ds_read_b64_tr_b16 a[186:187], v222 offset:36864
v_cvt_pk_bf16_f32 v81, v26, v27
v_mfma_f32_16x16x32_bf16 v[52:55], a[168:171], v[176:179], v[52:55]
v_exp_f32 v28, v28
v_mfma_f32_16x16x32_bf16 v[52:55], a[164:167], v[172:175], v[52:55]
s_add_u32 m0, s88, 86400
s_lshl2_add_u32 s50, m0, s89
buffer_load_dwordx4 v243, s[56:59], s50 offen  lds
v_mfma_f32_16x16x32_bf16 v[52:55], a[160:163], v[168:171], v[52:55]
v_exp_f32 v29, v29
v_mfma_f32_16x16x32_bf16 v[60:63], a[160:163], v[184:187], v[144:147]
v_cvt_pk_bf16_f32 v82, v28, v29
v_mfma_f32_16x16x32_bf16 v[60:63], a[164:167], v[188:191], v[60:63]
v_exp_f32 v30, v30
v_mfma_f32_16x16x32_bf16 v[60:63], a[168:171], v[192:195], v[60:63]
s_add_u32 m0, s88, 89856
s_lshl2_add_u32 s50, m0, s89
buffer_load_dwordx4 v243, s[56:59], s50 offen  lds
v_mfma_f32_16x16x32_bf16 v[60:63], a[172:175], v[196:199], v[60:63]
v_exp_f32 v31, v31
v_mfma_f32_16x16x32_bf16 v[68:71], a[172:175], v[212:215], v[148:151]
ds_read_b128 a[172:175], v219 offset:53248
v_cvt_pk_bf16_f32 v83, v30, v31
v_mfma_f32_16x16x32_bf16 v[68:71], a[168:171], v[208:211], v[68:71]
v_exp_f32 v32, v32
v_mfma_f32_16x16x32_bf16 v[68:71], a[164:167], v[204:207], v[68:71]
ds_read_b128 a[168:171], v218 offset:53248
ds_read_b128 a[164:167], v217 offset:53248
v_mfma_f32_16x16x32_bf16 v[68:71], a[160:163], v[200:203], v[68:71]
v_exp_f32 v33, v33
v_mfma_f32_16x16x32_bf16 a[64:67], v[88:91], a[192:195], a[64:67]
ds_read_b128 a[160:163], v216 offset:53248
v_cvt_pk_bf16_f32 v84, v32, v33
v_mfma_f32_16x16x32_bf16 a[80:83], v[88:91], a[196:199], a[80:83]
v_exp_f32 v34, v34
v_mfma_f32_16x16x32_bf16 a[84:87], v[92:95], a[196:199], a[84:87]
s_add_u32 m0, s88, 93312
s_lshl2_add_u32 s50, m0, s89
buffer_load_dwordx4 v243, s[56:59], s50 offen  lds
v_mfma_f32_16x16x32_bf16 a[68:71], v[92:95], a[192:195], a[68:71]
v_exp_f32 v35, v35
v_mfma_f32_16x16x32_bf16 a[72:75], v[96:99], a[192:195], a[72:75]
v_cvt_pk_bf16_f32 v85, v34, v35
v_mfma_f32_16x16x32_bf16 a[88:91], v[96:99], a[196:199], a[88:91]
v_exp_f32 v36, v36
v_mfma_f32_16x16x32_bf16 a[92:95], v[100:103], a[196:199], a[92:95]
ds_read_b64_tr_b16 a[196:197], v225 offset:32768
ds_read_b64_tr_b16 a[198:199], v225 offset:36864
v_mfma_f32_16x16x32_bf16 a[76:79], v[100:103], a[192:195], a[76:79]
v_exp_f32 v37, v37
v_mfma_f32_16x16x32_bf16 a[108:111], v[100:103], a[200:203], a[108:111]
ds_read_b64_tr_b16 a[192:193], v224 offset:32768
v_cvt_pk_bf16_f32 v86, v36, v37
v_mfma_f32_16x16x32_bf16 a[124:127], v[100:103], a[204:207], a[124:127]
v_exp_f32 v38, v38
v_mfma_f32_16x16x32_bf16 a[120:123], v[96:99], a[204:207], a[120:123]
ds_read_b64_tr_b16 a[194:195], v224 offset:36864
v_mfma_f32_16x16x32_bf16 a[104:107], v[96:99], a[200:203], a[104:107]
v_exp_f32 v39, v39
v_mfma_f32_16x16x32_bf16 a[100:103], v[92:95], a[200:203], a[100:103]
v_cvt_pk_bf16_f32 v87, v38, v39
v_mfma_f32_16x16x32_bf16 a[116:119], v[92:95], a[204:207], a[116:119]
s_mov_b32 s93, 0x243080
buffer_load_dword v246, v254, s[20:23], s93 offen sc0 sc1
v_mfma_f32_16x16x32_bf16 a[112:115], v[88:91], a[204:207], a[112:115]
ds_read_b64_tr_b16 a[204:205], v227 offset:32768
ds_read_b64_tr_b16 a[206:207], v227 offset:36864
s_mov_b32 s92, 0x1c00000
v_mfma_f32_16x16x32_bf16 a[96:99], v[88:91], a[200:203], a[96:99]
ds_read_b64_tr_b16 a[200:201], v226 offset:32768
ds_read_b64_tr_b16 a[202:203], v226 offset:36864
v_smfmac_f32_16x16x64_bf16 a[132:135], a[208:211], v[96:103], v245
s_waitcnt lgkmcnt(8)
v_mfma_f32_16x16x32_bf16 v[8:11], a[144:147], v[152:155], v[136:139]
v_exp_f32 v40, v40
v_mfma_f32_16x16x32_bf16 v[8:11], a[148:151], v[156:159], v[8:11]
v_exp_f32 v41, v41
v_mfma_f32_16x16x32_bf16 v[8:11], a[152:155], v[160:163], v[8:11]
v_cvt_pk_bf16_f32 v88, v40, v41
v_mfma_f32_16x16x32_bf16 v[8:11], a[156:159], v[164:167], v[8:11]
v_exp_f32 v42, v42
v_mfma_f32_16x16x32_bf16 v[16:19], a[156:159], v[180:183], v[140:143]
s_add_u32 m0, s88, 96768
s_lshl2_add_u32 s50, m0, s89
buffer_load_dwordx4 v243, s[56:59], s50 offen  lds
v_mfma_f32_16x16x32_bf16 v[16:19], a[152:155], v[176:179], v[16:19]
v_exp_f32 v43, v43
v_mfma_f32_16x16x32_bf16 v[16:19], a[148:151], v[172:175], v[16:19]
v_cvt_pk_bf16_f32 v89, v42, v43
v_mfma_f32_16x16x32_bf16 v[16:19], a[144:147], v[168:171], v[16:19]
v_exp_f32 v44, v44
v_mfma_f32_16x16x32_bf16 v[24:27], a[144:147], v[184:187], v[144:147]
buffer_load_dwordx4 a[222:225], v248, s[20:23], s92 offen offset:0 sc0 sc1
v_mfma_f32_16x16x32_bf16 v[24:27], a[148:151], v[188:191], v[24:27]
v_exp_f32 v45, v45
v_mfma_f32_16x16x32_bf16 v[24:27], a[152:155], v[192:195], v[24:27]
v_cvt_pk_bf16_f32 v90, v44, v45
v_mfma_f32_16x16x32_bf16 v[24:27], a[156:159], v[196:199], v[24:27]
v_exp_f32 v46, v46
v_mfma_f32_16x16x32_bf16 v[32:35], a[156:159], v[212:215], v[148:151]
ds_read_b128 a[156:159], v219 offset:57344
v_mfma_f32_16x16x32_bf16 v[32:35], a[152:155], v[208:211], v[32:35]
v_exp_f32 v47, v47
v_mfma_f32_16x16x32_bf16 v[32:35], a[148:151], v[204:207], v[32:35]
ds_read_b128 a[152:155], v218 offset:57344
v_cvt_pk_bf16_f32 v91, v46, v47
v_mfma_f32_16x16x32_bf16 v[32:35], a[144:147], v[200:203], v[32:35]
v_exp_f32 v48, v48
v_mfma_f32_16x16x32_bf16 a[0:3], v[72:75], a[176:179], a[0:3]
ds_read_b128 a[148:151], v217 offset:57344
ds_read_b128 a[144:147], v216 offset:57344
v_mfma_f32_16x16x32_bf16 a[16:19], v[72:75], a[180:183], a[16:19]
v_exp_f32 v49, v49
v_mfma_f32_16x16x32_bf16 a[20:23], v[76:79], a[180:183], a[20:23]
buffer_load_dwordx4 a[226:229], v248, s[20:23], s92 offen offset:128 sc0 sc1
v_cvt_pk_bf16_f32 v92, v48, v49
v_mfma_f32_16x16x32_bf16 a[4:7], v[76:79], a[176:179], a[4:7]
v_exp_f32 v50, v50
v_mfma_f32_16x16x32_bf16 a[8:11], v[80:83], a[176:179], a[8:11]
s_add_u32 m0, s88, 100224
s_lshl2_add_u32 s50, m0, s89
buffer_load_dwordx4 v243, s[56:59], s50 offen  lds
v_mfma_f32_16x16x32_bf16 a[24:27], v[80:83], a[180:183], a[24:27]
v_exp_f32 v51, v51
v_mfma_f32_16x16x32_bf16 a[28:31], v[84:87], a[180:183], a[28:31]
ds_read_b64_tr_b16 a[180:181], v221 offset:40960
v_cvt_pk_bf16_f32 v93, v50, v51
v_mfma_f32_16x16x32_bf16 a[12:15], v[84:87], a[176:179], a[12:15]
v_exp_f32 v52, v52
v_mfma_f32_16x16x32_bf16 a[44:47], v[84:87], a[184:187], a[44:47]
ds_read_b64_tr_b16 a[182:183], v221 offset:45056
ds_read_b64_tr_b16 a[176:177], v220 offset:40960
v_mfma_f32_16x16x32_bf16 a[60:63], v[84:87], a[188:191], a[60:63]
v_exp_f32 v53, v53
v_mfma_f32_16x16x32_bf16 a[56:59], v[80:83], a[188:191], a[56:59]
ds_read_b64_tr_b16 a[178:179], v220 offset:45056
v_cvt_pk_bf16_f32 v94, v52, v53
v_mfma_f32_16x16x32_bf16 a[40:43], v[80:83], a[184:187], a[40:43]
v_exp_f32 v54, v54
v_mfma_f32_16x16x32_bf16 a[36:39], v[76:79], a[184:187], a[36:39]
s_add_u32 m0, s88, 103680
s_lshl2_add_u32 s50, m0, s89
buffer_load_dwordx4 v243, s[56:59], s50 offen  lds
v_mfma_f32_16x16x32_bf16 a[52:55], v[76:79], a[188:191], a[52:55]
v_exp_f32 v55, v55
v_mfma_f32_16x16x32_bf16 a[48:51], v[72:75], a[188:191], a[48:51]
ds_read_b64_tr_b16 a[188:189], v223 offset:40960
v_cvt_pk_bf16_f32 v95, v54, v55
v_mfma_f32_16x16x32_bf16 a[32:35], v[72:75], a[184:187], a[32:35]
v_exp_f32 v56, v56
v_smfmac_f32_16x16x64_bf16 a[128:131], a[208:211], v[72:79], v245
ds_read_b64_tr_b16 a[190:191], v223 offset:45056
v_mfma_f32_16x16x32_bf16 v[12:15], a[160:163], v[152:155], v[136:139]
v_exp_f32 v57, v57
v_mfma_f32_16x16x32_bf16 v[12:15], a[164:167], v[156:159], v[12:15]
v_exp_f32 v58, v58
v_mfma_f32_16x16x32_bf16 v[12:15], a[168:171], v[160:163], v[12:15]
ds_read_b64_tr_b16 a[184:185], v222 offset:40960
v_cvt_pk_bf16_f32 v96, v56, v57
v_mfma_f32_16x16x32_bf16 v[12:15], a[172:175], v[164:167], v[12:15]
v_exp_f32 v59, v59
v_mfma_f32_16x16x32_bf16 v[20:23], a[172:175], v[180:183], v[140:143]
STUB_12:
s_cbranch_execz HOP_RET1
ds_read_b64_tr_b16 a[186:187], v222 offset:45056
v_cvt_pk_bf16_f32 v97, v58, v59
v_mfma_f32_16x16x32_bf16 v[20:23], a[168:171], v[176:179], v[20:23]
v_exp_f32 v60, v60
v_mfma_f32_16x16x32_bf16 v[20:23], a[164:167], v[172:175], v[20:23]
s_add_u32 m0, s88, 107136
s_lshl2_add_u32 s50, m0, s89
buffer_load_dwordx4 v243, s[56:59], s50 offen  lds
v_mfma_f32_16x16x32_bf16 v[20:23], a[160:163], v[168:171], v[20:23]
v_exp_f32 v61, v61
v_mfma_f32_16x16x32_bf16 v[28:31], a[160:163], v[184:187], v[144:147]
buffer_load_dwordx2 a[230:231], v249, s[20:23], s92 offen sc0 sc1
v_cvt_pk_bf16_f32 v98, v60, v61
v_mfma_f32_16x16x32_bf16 v[28:31], a[164:167], v[188:191], v[28:31]
v_sub_u32 v133, 0xffff, v132
v_exp_f32 v62, v62
v_mfma_f32_16x16x32_bf16 v[28:31], a[168:171], v[192:195], v[28:31]
v_and_b32 v104, 0xffff, v104
v_mfma_f32_16x16x32_bf16 v[28:31], a[172:175], v[196:199], v[28:31]
v_readlane_b32 s93, v104, 0
v_exp_f32 v63, v63
v_mfma_f32_16x16x32_bf16 v[36:39], a[172:175], v[212:215], v[148:151]
ds_read_b128 a[172:175], v219 offset:61440
v_cvt_pk_bf16_f32 v99, v62, v63
v_mfma_f32_16x16x32_bf16 v[36:39], a[168:171], v[208:211], v[36:39]
v_cmp_eq_u32 s[90:91], s93, v133
v_exp_f32 v64, v64
v_mfma_f32_16x16x32_bf16 v[36:39], a[164:167], v[204:207], v[36:39]
ds_read_b128 a[168:171], v218 offset:61440
ds_read_b128 a[164:167], v217 offset:61440
v_mov_b32 v134, 0
v_mfma_f32_16x16x32_bf16 v[36:39], a[160:163], v[200:203], v[36:39]
v_cndmask_b32 v135, v135, v134, s[90:91]
v_exp_f32 v65, v65
s_waitcnt lgkmcnt(8)
v_mfma_f32_16x16x32_bf16 a[64:67], v[72:75], a[192:195], a[64:67]
ds_read_b128 a[160:163], v216 offset:61440
v_cvt_pk_bf16_f32 v100, v64, v65
v_readlane_b32 s93, v104, 1
v_mfma_f32_16x16x32_bf16 a[80:83], v[72:75], a[196:199], a[80:83]
v_exp_f32 v66, v66
v_mfma_f32_16x16x32_bf16 a[84:87], v[76:79], a[196:199], a[84:87]
s_add_u32 m0, s88, 110592
s_lshl2_add_u32 s50, m0, s89
buffer_load_dwordx4 v243, s[56:59], s50 offen  lds
v_mfma_f32_16x16x32_bf16 a[68:71], v[76:79], a[192:195], a[68:71]
v_cmp_eq_u32 s[90:91], s93, v133
v_exp_f32 v67, v67
v_mfma_f32_16x16x32_bf16 a[72:75], v[80:83], a[192:195], a[72:75]
v_cvt_pk_bf16_f32 v101, v66, v67
v_mov_b32 v134, 1152
v_mfma_f32_16x16x32_bf16 a[88:91], v[80:83], a[196:199], a[88:91]
v_cndmask_b32 v135, v135, v134, s[90:91]
v_exp_f32 v68, v68
v_mfma_f32_16x16x32_bf16 a[92:95], v[84:87], a[196:199], a[92:95]
ds_read_b64_tr_b16 a[196:197], v225 offset:40960
ds_read_b64_tr_b16 a[198:199], v225 offset:45056
v_readlane_b32 s93, v104, 2
v_mfma_f32_16x16x32_bf16 a[76:79], v[84:87], a[192:195], a[76:79]
v_exp_f32 v69, v69
v_mfma_f32_16x16x32_bf16 a[108:111], v[84:87], a[200:203], a[108:111]
ds_read_b64_tr_b16 a[192:193], v224 offset:40960
v_cvt_pk_bf16_f32 v102, v68, v69
v_cmp_eq_u32 s[90:91], s93, v133
v_mfma_f32_16x16x32_bf16 a[124:127], v[84:87], a[204:207], a[124:127]
v_mov_b32 v134, 2304
v_exp_f32 v70, v70
v_mfma_f32_16x16x32_bf16 a[120:123], v[80:83], a[204:207], a[120:123]
ds_read_b64_tr_b16 a[194:195], v224 offset:45056
v_cndmask_b32 v135, v135, v134, s[90:91]
v_mfma_f32_16x16x32_bf16 a[104:107], v[80:83], a[200:203], a[104:107]
v_readlane_b32 s93, v104, 3
v_exp_f32 v71, v71
v_mfma_f32_16x16x32_bf16 a[100:103], v[76:79], a[200:203], a[100:103]
v_cvt_pk_bf16_f32 v103, v70, v71
v_mfma_f32_16x16x32_bf16 a[116:119], v[76:79], a[204:207], a[116:119]
v_cmp_eq_u32 s[90:91], s93, v133
v_mov_b32 v134, 3456
v_mfma_f32_16x16x32_bf16 a[112:115], v[72:75], a[204:207], a[112:115]
ds_read_b64_tr_b16 a[204:205], v227 offset:40960
ds_read_b64_tr_b16 a[206:207], v227 offset:45056
v_cndmask_b32 v135, v135, v134, s[90:91]
v_mfma_f32_16x16x32_bf16 a[96:99], v[72:75], a[200:203], a[96:99]
ds_read_b64_tr_b16 a[200:201], v226 offset:40960
ds_read_b64_tr_b16 a[202:203], v226 offset:45056
v_readlane_b32 s93, v104, 4
v_smfmac_f32_16x16x64_bf16 a[132:135], a[208:211], v[80:87], v245
v_mfma_f32_16x16x32_bf16 v[40:43], a[144:147], v[152:155], v[136:139]
v_cmp_eq_u32 s[90:91], s93, v133
v_exp_f32 v8, v8
v_mfma_f32_16x16x32_bf16 v[40:43], a[148:151], v[156:159], v[40:43]
v_mov_b32 v134, 4608
v_exp_f32 v9, v9
v_mfma_f32_16x16x32_bf16 v[40:43], a[152:155], v[160:163], v[40:43]
v_cvt_pk_bf16_f32 v72, v8, v9
v_cndmask_b32 v135, v135, v134, s[90:91]
v_mfma_f32_16x16x32_bf16 v[40:43], a[156:159], v[164:167], v[40:43]
v_readlane_b32 s93, v104, 5
v_exp_f32 v10, v10
v_mfma_f32_16x16x32_bf16 v[48:51], a[156:159], v[180:183], v[140:143]
v_mfma_f32_16x16x32_bf16 v[48:51], a[152:155], v[176:179], v[48:51]
v_cmp_eq_u32 s[90:91], s93, v133
v_exp_f32 v11, v11
v_mfma_f32_16x16x32_bf16 v[48:51], a[148:151], v[172:175], v[48:51]
v_cvt_pk_bf16_f32 v73, v10, v11
v_mov_b32 v134, 5760
v_mfma_f32_16x16x32_bf16 v[48:51], a[144:147], v[168:171], v[48:51]
v_cndmask_b32 v135, v135, v134, s[90:91]
v_exp_f32 v12, v12
v_mfma_f32_16x16x32_bf16 v[56:59], a[144:147], v[184:187], v[144:147]
v_readlane_b32 s93, v104, 6
v_mfma_f32_16x16x32_bf16 v[56:59], a[148:151], v[188:191], v[56:59]
v_exp_f32 v13, v13
v_mfma_f32_16x16x32_bf16 v[56:59], a[152:155], v[192:195], v[56:59]
v_cvt_pk_bf16_f32 v74, v12, v13
v_cmp_eq_u32 s[90:91], s93, v133
v_mov_b32 v134, 6912
v_mfma_f32_16x16x32_bf16 v[56:59], a[156:159], v[196:199], v[56:59]
v_cndmask_b32 v135, v135, v134, s[90:91]
v_exp_f32 v14, v14
v_mfma_f32_16x16x32_bf16 v[64:67], a[156:159], v[212:215], v[148:151]
s_waitcnt vmcnt(14) lgkmcnt(0)
s_barrier
v_readlane_b32 s93, v104, 7
v_mfma_f32_16x16x32_bf16 v[64:67], a[152:155], v[208:211], v[64:67]
v_exp_f32 v15, v15
v_mfma_f32_16x16x32_bf16 v[64:67], a[148:151], v[204:207], v[64:67]
v_cvt_pk_bf16_f32 v75, v14, v15
v_cmp_eq_u32 s[90:91], s93, v133
v_mov_b32 v134, 8064
v_mfma_f32_16x16x32_bf16 v[64:67], a[144:147], v[200:203], v[64:67]
v_cndmask_b32 v135, v135, v134, s[90:91]
v_exp_f32 v16, v16
v_mfma_f32_16x16x32_bf16 a[0:3], v[88:91], a[176:179], a[0:3]
s_add_u32 m0, s88, 114048
s_lshl2_add_u32 s50, m0, s89
buffer_load_dwordx4 v243, s[56:59], s50 offen  lds
v_mfma_f32_16x16x32_bf16 a[16:19], v[88:91], a[180:183], a[16:19]
v_add_u32 v250, v250, v135
v_exp_f32 v17, v17
v_mfma_f32_16x16x32_bf16 a[20:23], v[92:95], a[180:183], a[20:23]
v_cvt_pk_bf16_f32 v76, v16, v17
v_add_u32 v251, v251, v135
v_mfma_f32_16x16x32_bf16 a[4:7], v[92:95], a[176:179], a[4:7]
v_exp_f32 v18, v18
v_mfma_f32_16x16x32_bf16 a[8:11], v[96:99], a[176:179], a[8:11]
v_lshrrev_b32 v134, 14, v135
v_cmp_eq_u32 s[90:91], 0, v134
v_mfma_f32_16x16x32_bf16 a[24:27], v[96:99], a[180:183], a[24:27]
v_exp_f32 v19, v19
v_mfma_f32_16x16x32_bf16 a[28:31], v[100:103], a[180:183], a[28:31]
ds_read_b64_tr_b16 a[180:181], v221 offset:49152
v_cvt_pk_bf16_f32 v77, v18, v19
v_mfma_f32_16x16x32_bf16 a[12:15], v[100:103], a[176:179], a[12:15]
v_exp_f32 v20, v20
v_mfma_f32_16x16x32_bf16 a[44:47], v[100:103], a[184:187], a[44:47]
ds_read_b64_tr_b16 a[182:183], v221 offset:53248
ds_read_b64_tr_b16 a[176:177], v220 offset:49152
v_mfma_f32_16x16x32_bf16 a[60:63], v[100:103], a[188:191], a[60:63]
v_exp_f32 v21, v21
v_mfma_f32_16x16x32_bf16 a[56:59], v[96:99], a[188:191], a[56:59]
ds_read_b64_tr_b16 a[178:179], v220 offset:53248
v_cvt_pk_bf16_f32 v78, v20, v21
v_mfma_f32_16x16x32_bf16 a[40:43], v[96:99], a[184:187], a[40:43]
v_exp_f32 v22, v22
v_mfma_f32_16x16x32_bf16 a[36:39], v[92:95], a[184:187], a[36:39]
s_add_u32 m0, s88, 117504
s_lshl2_add_u32 s50, m0, s89
buffer_load_dwordx4 v243, s[56:59], s50 offen  lds
v_mfma_f32_16x16x32_bf16 a[52:55], v[92:95], a[188:191], a[52:55]
v_exp_f32 v23, v23
v_mfma_f32_16x16x32_bf16 a[48:51], v[88:91], a[188:191], a[48:51]
ds_read_b64_tr_b16 a[188:189], v223 offset:49152
v_cvt_pk_bf16_f32 v79, v22, v23
v_mfma_f32_16x16x32_bf16 a[32:35], v[88:91], a[184:187], a[32:35]
v_exp_f32 v24, v24
v_smfmac_f32_16x16x64_bf16 a[128:131], a[208:211], v[88:95], v245
ds_read_b64_tr_b16 a[190:191], v223 offset:53248
v_mfma_f32_16x16x32_bf16 v[44:47], a[160:163], v[152:155], v[136:139]
v_exp_f32 v25, v25
v_mfma_f32_16x16x32_bf16 v[44:47], a[164:167], v[156:159], v[44:47]
v_exp_f32 v26, v26
v_mfma_f32_16x16x32_bf16 v[44:47], a[168:171], v[160:163], v[44:47]
ds_read_b64_tr_b16 a[184:185], v222 offset:49152
v_cvt_pk_bf16_f32 v80, v24, v25
v_mfma_f32_16x16x32_bf16 v[44:47], a[172:175], v[164:167], v[44:47]
v_exp_f32 v27, v27
v_mfma_f32_16x16x32_bf16 v[52:55], a[172:175], v[180:183], v[140:143]
ds_read_b64_tr_b16 a[186:187], v222 offset:53248
v_cvt_pk_bf16_f32 v81, v26, v27
v_mfma_f32_16x16x32_bf16 v[52:55], a[168:171], v[176:179], v[52:55]
v_exp_f32 v28, v28
v_mfma_f32_16x16x32_bf16 v[52:55], a[164:167], v[172:175], v[52:55]
s_add_u32 m0, s88, 120960
s_lshl2_add_u32 s50, m0, s89
buffer_load_dwordx4 v243, s[56:59], s50 offen  lds
v_mfma_f32_16x16x32_bf16 v[52:55], a[160:163], v[168:171], v[52:55]
v_exp_f32 v29, v29
v_mfma_f32_16x16x32_bf16 v[60:63], a[160:163], v[184:187], v[144:147]
v_cvt_pk_bf16_f32 v82, v28, v29
s_waitcnt vmcnt(11)
v_readfirstlane_b32 s93, v246
v_mfma_f32_16x16x32_bf16 v[60:63], a[164:167], v[188:191], v[60:63]
v_exp_f32 v30, v30
v_mfma_f32_16x16x32_bf16 v[60:63], a[168:171], v[192:195], v[60:63]
s_add_u32 m0, s88, 124416
s_lshl2_add_u32 s50, m0, s89
buffer_load_dwordx4 v243, s[56:59], s50 offen  lds
v_mfma_f32_16x16x32_bf16 v[60:63], a[172:175], v[196:199], v[60:63]
v_exp_f32 v31, v31
v_mfma_f32_16x16x32_bf16 v[68:71], a[172:175], v[212:215], v[148:151]
s_cmp_eq_u64 s[90:91], 0
s_cselect_b32 s93, 144, s93
v_cvt_pk_bf16_f32 v83, v30, v31
v_mfma_f32_16x16x32_bf16 v[68:71], a[168:171], v[208:211], v[68:71]
v_exp_f32 v32, v32
v_mfma_f32_16x16x32_bf16 v[68:71], a[164:167], v[204:207], v[68:71]
s_add_u32 m0, s88, 127872
s_lshl2_add_u32 s50, m0, s89
buffer_load_dwordx4 v243, s[56:59], s50 offen  lds
v_mfma_f32_16x16x32_bf16 v[68:71], a[160:163], v[200:203], v[68:71]
v_exp_f32 v33, v33
v_mfma_f32_16x16x32_bf16 a[64:67], v[88:91], a[192:195], a[64:67]
v_cvt_pk_bf16_f32 v84, v32, v33
v_mfma_f32_16x16x32_bf16 a[80:83], v[88:91], a[196:199], a[80:83]
v_exp_f32 v34, v34
v_mfma_f32_16x16x32_bf16 a[84:87], v[92:95], a[196:199], a[84:87]
s_add_u32 m0, s88, 131328
s_lshl2_add_u32 s50, m0, s89
buffer_load_dwordx4 v243, s[56:59], s50 offen  lds
v_mfma_f32_16x16x32_bf16 a[68:71], v[92:95], a[192:195], a[68:71]
v_exp_f32 v35, v35
v_mfma_f32_16x16x32_bf16 a[72:75], v[96:99], a[192:195], a[72:75]
s_cmp_lt_u32 s93, 144
s_cbranch_scc1 SP_Y
SP_Y_RET:
v_cvt_pk_bf16_f32 v85, v34, v35
v_mfma_f32_16x16x32_bf16 a[88:91], v[96:99], a[196:199], a[88:91]
v_exp_f32 v36, v36
v_mfma_f32_16x16x32_bf16 a[92:95], v[100:103], a[196:199], a[92:95]
ds_read_b64_tr_b16 a[196:197], v225 offset:49152
ds_read_b64_tr_b16 a[198:199], v225 offset:53248
v_mfma_f32_16x16x32_bf16 a[76:79], v[100:103], a[192:195], a[76:79]
v_exp_f32 v37, v37
v_mfma_f32_16x16x32_bf16 a[108:111], v[100:103], a[200:203], a[108:111]
ds_read_b64_tr_b16 a[192:193], v224 offset:49152
v_cvt_pk_bf16_f32 v86, v36, v37
v_mfma_f32_16x16x32_bf16 a[124:127], v[100:103], a[204:207], a[124:127]
v_exp_f32 v38, v38
v_mfma_f32_16x16x32_bf16 a[120:123], v[96:99], a[204:207], a[120:123]
ds_read_b64_tr_b16 a[194:195], v224 offset:53248
s_mov_b32 s93, 0x244000
v_mfma_f32_16x16x32_bf16 a[104:107], v[96:99], a[200:203], a[104:107]
v_exp_f32 v39, v39
v_mfma_f32_16x16x32_bf16 a[100:103], v[92:95], a[200:203], a[100:103]
v_cvt_pk_bf16_f32 v87, v38, v39
v_mfma_f32_16x16x32_bf16 a[116:119], v[92:95], a[204:207], a[116:119]
s_add_u32 m0, s88, 134784
s_lshl2_add_u32 s50, m0, s89
buffer_load_dwordx4 v243, s[56:59], s50 offen  lds
v_mfma_f32_16x16x32_bf16 a[112:115], v[88:91], a[204:207], a[112:115]
ds_read_b64_tr_b16 a[204:205], v227 offset:49152
ds_read_b64_tr_b16 a[206:207], v227 offset:53248
v_mfma_f32_16x16x32_bf16 a[96:99], v[88:91], a[200:203], a[96:99]
ds_read_b64_tr_b16 a[200:201], v226 offset:49152
ds_read_b64_tr_b16 a[202:203], v226 offset:53248
v_smfmac_f32_16x16x64_bf16 a[132:135], a[208:211], v[96:103], v245
buffer_load_dwordx4 a[232:235], v250, s[20:23], s93 offen offset:0 sc0 sc1
s_waitcnt lgkmcnt(8)
v_mfma_f32_16x16x32_bf16 a[0:3], v[72:75], a[176:179], a[0:3]
v_exp_f32 v40, v40
v_exp_f32 v41, v41
v_mfma_f32_16x16x32_bf16 a[4:7], v[76:79], a[176:179], a[4:7]
v_cvt_pk_bf16_f32 v88, v40, v41
v_exp_f32 v42, v42
v_mfma_f32_16x16x32_bf16 a[8:11], v[80:83], a[176:179], a[8:11]
buffer_load_dwordx4 a[236:239], v250, s[20:23], s93 offen offset:128 sc0 sc1
v_exp_f32 v43, v43
v_mfma_f32_16x16x32_bf16 a[12:15], v[84:87], a[176:179], a[12:15]
ds_read_b64_tr_b16 a[176:177], v220 offset:57344
v_cvt_pk_bf16_f32 v89, v42, v43
v_exp_f32 v44, v44
v_mfma_f32_16x16x32_bf16 a[28:31], v[84:87], a[180:183], a[28:31]
ds_read_b64_tr_b16 a[178:179], v220 offset:61440
v_exp_f32 v45, v45
v_mfma_f32_16x16x32_bf16 a[24:27], v[80:83], a[180:183], a[24:27]
v_cvt_pk_bf16_f32 v90, v44, v45
v_exp_f32 v46, v46
v_mfma_f32_16x16x32_bf16 a[20:23], v[76:79], a[180:183], a[20:23]
buffer_load_dwordx2 a[240:241], v251, s[20:23], s93 offen sc0 sc1
v_exp_f32 v47, v47
v_mfma_f32_16x16x32_bf16 a[16:19], v[72:75], a[180:183], a[16:19]
ds_read_b64_tr_b16 a[180:181], v221 offset:57344
v_cvt_pk_bf16_f32 v91, v46, v47
v_exp_f32 v48, v48
v_mfma_f32_16x16x32_bf16 a[32:35], v[72:75], a[184:187], a[32:35]
ds_read_b64_tr_b16 a[182:183], v221 offset:61440
v_exp_f32 v49, v49
v_mfma_f32_16x16x32_bf16 a[36:39], v[76:79], a[184:187], a[36:39]
v_cvt_pk_bf16_f32 v92, v48, v49
v_exp_f32 v50, v50
v_mfma_f32_16x16x32_bf16 a[40:43], v[80:83], a[184:187], a[40:43]
v_exp_f32 v51, v51
v_mfma_f32_16x16x32_bf16 a[44:47], v[84:87], a[184:187], a[44:47]
ds_read_b64_tr_b16 a[184:185], v222 offset:57344
v_cvt_pk_bf16_f32 v93, v50, v51
v_exp_f32 v52, v52
v_mfma_f32_16x16x32_bf16 a[60:63], v[84:87], a[188:191], a[60:63]
ds_read_b64_tr_b16 a[186:187], v222 offset:61440
v_exp_f32 v53, v53
v_mfma_f32_16x16x32_bf16 a[56:59], v[80:83], a[188:191], a[56:59]
v_cvt_pk_bf16_f32 v94, v52, v53
v_exp_f32 v54, v54
v_mfma_f32_16x16x32_bf16 a[52:55], v[76:79], a[188:191], a[52:55]
v_exp_f32 v55, v55
v_mfma_f32_16x16x32_bf16 a[48:51], v[72:75], a[188:191], a[48:51]
v_exp_f32 v56, v56
v_exp_f32 v57, v57
v_smfmac_f32_16x16x64_bf16 a[128:131], a[208:211], v[72:79], v245
v_cvt_pk_bf16_f32 v95, v54, v55
v_cvt_pk_bf16_f32 v96, v56, v57
v_exp_f32 v58, v58
s_waitcnt lgkmcnt(8)
v_mfma_f32_16x16x32_bf16 a[64:67], v[72:75], a[192:195], a[64:67]
ds_read_b64_tr_b16 a[188:189], v223 offset:57344
ds_read_b64_tr_b16 a[190:191], v223 offset:61440
v_exp_f32 v59, v59
v_mfma_f32_16x16x32_bf16 a[68:71], v[76:79], a[192:195], a[68:71]
v_cvt_pk_bf16_f32 v97, v58, v59
v_exp_f32 v60, v60
v_mfma_f32_16x16x32_bf16 a[72:75], v[80:83], a[192:195], a[72:75]
v_exp_f32 v61, v61
v_mfma_f32_16x16x32_bf16 a[76:79], v[84:87], a[192:195], a[76:79]
ds_read_b64_tr_b16 a[192:193], v224 offset:57344
v_cvt_pk_bf16_f32 v98, v60, v61
v_exp_f32 v62, v62
v_mfma_f32_16x16x32_bf16 a[92:95], v[84:87], a[196:199], a[92:95]
ds_read_b64_tr_b16 a[194:195], v224 offset:61440
v_exp_f32 v63, v63
v_mfma_f32_16x16x32_bf16 a[88:91], v[80:83], a[196:199], a[88:91]
v_cvt_pk_bf16_f32 v99, v62, v63
v_exp_f32 v64, v64
v_mfma_f32_16x16x32_bf16 a[84:87], v[76:79], a[196:199], a[84:87]
v_exp_f32 v65, v65
v_mfma_f32_16x16x32_bf16 a[80:83], v[72:75], a[196:199], a[80:83]
ds_read_b64_tr_b16 a[196:197], v225 offset:57344
v_cvt_pk_bf16_f32 v100, v64, v65
v_exp_f32 v66, v66
s_waitcnt lgkmcnt(8)
v_mfma_f32_16x16x32_bf16 a[96:99], v[72:75], a[200:203], a[96:99]
ds_read_b64_tr_b16 a[198:199], v225 offset:61440
v_exp_f32 v67, v67
v_mfma_f32_16x16x32_bf16 a[100:103], v[76:79], a[200:203], a[100:103]
v_cvt_pk_bf16_f32 v101, v66, v67
v_exp_f32 v68, v68
v_mfma_f32_16x16x32_bf16 a[104:107], v[80:83], a[200:203], a[104:107]
v_exp_f32 v69, v69
v_mfma_f32_16x16x32_bf16 a[108:111], v[84:87], a[200:203], a[108:111]
ds_read_b64_tr_b16 a[200:201], v226 offset:57344
v_cvt_pk_bf16_f32 v102, v68, v69
v_exp_f32 v70, v70
v_mfma_f32_16x16x32_bf16 a[124:127], v[84:87], a[204:207], a[124:127]
ds_read_b64_tr_b16 a[202:203], v226 offset:61440
v_exp_f32 v71, v71
v_mfma_f32_16x16x32_bf16 a[120:123], v[80:83], a[204:207], a[120:123]
v_cvt_pk_bf16_f32 v103, v70, v71
v_mfma_f32_16x16x32_bf16 a[116:119], v[76:79], a[204:207], a[116:119]
s_add_u32 m0, s88, 138240
s_lshl2_add_u32 s50, m0, s89
buffer_load_dwordx4 v243, s[56:59], s50 offen  lds
v_mfma_f32_16x16x32_bf16 a[112:115], v[72:75], a[204:207], a[112:115]
ds_read_b64_tr_b16 a[204:205], v227 offset:57344
ds_read_b64_tr_b16 a[206:207], v227 offset:61440
v_smfmac_f32_16x16x64_bf16 a[132:135], a[208:211], v[80:87], v245
s_add_u32 m0, s88, 141696
s_lshl2_add_u32 s50, m0, s89
buffer_load_dwordx4 v243, s[56:59], s50 offen  lds
s_add_u32 m0, s88, 145152
s_min_u32 m0, m0, 146880
s_lshl2_add_u32 s50, m0, s89
s_cmp_ge_u32 s37, 2
s_cselect_b32 exec_hi, 15, -1
buffer_load_dwordx4 v243, s[56:59], s50 offen  lds
s_mov_b32 exec_hi, -1
K_TAIL:
s_cmp_eq_u32 s48, 0
s_cbranch_scc1 K_MIXED
s_waitcnt lgkmcnt(0)
s_barrier
s_add_u32 s28, s30, 147456
v_smfmac_f32_16x16x64_bf16 a[128:131], a[208:211], v[88:95], v245
v_lshrrev_b32 v132, 1, v1
v_and_b32 v132, 8, v132
v_smfmac_f32_16x16x64_bf16 a[132:135], a[208:211], v[96:103], v245
v_xor_b32 v132, v132, v1
v_lshlrev_b32 v132, 4, v132
v_mfma_f32_16x16x32_bf16 a[0:3], v[88:91], a[176:179], a[0:3]
v_add_u32 v132, s28, v132
v_lshlrev_b32 v133, 3, v1
v_mfma_f32_16x16x32_bf16 a[16:19], v[88:91], a[180:183], a[16:19]
v_and_b32 v133, 8, v133
v_lshrrev_b32 v134, 2, v1
v_mfma_f32_16x16x32_bf16 a[32:35], v[88:91], a[184:187], a[32:35]
v_xor_b32 v133, v133, v134
v_and_b32 v134, 3, v1
v_mfma_f32_16x16x32_bf16 a[48:51], v[88:91], a[188:191], a[48:51]
v_lshl_add_u32 v133, v134, 4, v133
v_lshlrev_b32 v133, 4, v133
v_mfma_f32_16x16x32_bf16 a[64:67], v[88:91], a[192:195], a[64:67]
v_add_u32 v133, s28, v133
v_lshlrev_b32 v134, 2, v1
v_mfma_f32_16x16x32_bf16 a[80:83], v[88:91], a[196:199], a[80:83]
v_add_u32 v134, s28, v134
v_lshlrev_b32 v135, 4, v4
v_mfma_f32_16x16x32_bf16 a[96:99], v[88:91], a[200:203], a[96:99]
v_add_u32 v135, s28, v135
v_mfma_f32_16x16x32_bf16 a[112:115], v[88:91], a[204:207], a[112:115]
v_mfma_f32_16x16x32_bf16 a[4:7], v[92:95], a[176:179], a[4:7]
v_accvgpr_read_b32 v120, a128
v_accvgpr_read_b32 v124, a129
v_accvgpr_read_b32 v121, a130
v_mfma_f32_16x16x32_bf16 a[20:23], v[92:95], a[180:183], a[20:23]
v_accvgpr_read_b32 v125, a131
v_accvgpr_read_b32 v122, a132
v_accvgpr_read_b32 v126, a133
v_mfma_f32_16x16x32_bf16 a[36:39], v[92:95], a[184:187], a[36:39]
v_accvgpr_read_b32 v123, a134
v_accvgpr_read_b32 v127, a135
v_add_f32 v120, v120, v124
v_mfma_f32_16x16x32_bf16 a[52:55], v[92:95], a[188:191], a[52:55]
v_add_f32 v121, v121, v125
v_add_f32 v122, v122, v126
v_add_f32 v123, v123, v127
v_mfma_f32_16x16x32_bf16 a[68:71], v[92:95], a[192:195], a[68:71]
v_rcp_f32 v124, v120
v_rcp_f32 v125, v121
v_rcp_f32 v126, v122
v_mfma_f32_16x16x32_bf16 a[84:87], v[92:95], a[196:199], a[84:87]
v_rcp_f32 v127, v123
ds_write_b32 v134, v124 offset:0
ds_write_b32 v134, v125 offset:256
v_mfma_f32_16x16x32_bf16 a[100:103], v[92:95], a[200:203], a[100:103]
ds_write_b32 v134, v126 offset:512
ds_write_b32 v134, v127 offset:768
ds_read_b128 v[72:75], v135 offset:0
v_mfma_f32_16x16x32_bf16 a[116:119], v[92:95], a[204:207], a[116:119]
ds_read_b128 v[76:79], v135 offset:256
ds_read_b128 v[80:83], v135 offset:512
ds_read_b128 v[84:87], v135 offset:768
s_add_u32 s92, s44, 4096
s_add_u32 s93, s44, 8192
s_add_u32 s51, s44, 12288
v_mfma_f32_16x16x32_bf16 a[8:11], v[96:99], a[176:179], a[8:11]
v_accvgpr_read_b32 v104, a0
v_accvgpr_read_b32 v105, a1
v_accvgpr_read_b32 v106, a2
v_accvgpr_read_b32 v107, a3
v_mfma_f32_16x16x32_bf16 a[24:27], v[96:99], a[180:183], a[24:27]
v_accvgpr_read_b32 v108, a16
v_accvgpr_read_b32 v109, a17
v_accvgpr_read_b32 v110, a18
v_accvgpr_read_b32 v111, a19
s_waitcnt lgkmcnt(0)
v_pk_mul_f32 v[104:105], v[104:105], v[72:73]
v_pk_mul_f32 v[106:107], v[106:107], v[74:75]
v_pk_mul_f32 v[108:109], v[108:109], v[72:73]
v_pk_mul_f32 v[110:111], v[110:111], v[74:75]
v_cvt_pk_bf16_f32 v104, v104, v105
v_cvt_pk_bf16_f32 v105, v106, v107
v_cvt_pk_bf16_f32 v106, v108, v109
v_cvt_pk_bf16_f32 v107, v110, v111
v_mfma_f32_16x16x32_bf16 a[40:43], v[96:99], a[184:187], a[40:43]
v_accvgpr_read_b32 v112, a32
v_accvgpr_read_b32 v113, a33
v_accvgpr_read_b32 v114, a34
v_accvgpr_read_b32 v115, a35
ds_write_b128 v132, v[104:107] offset:0
v_mfma_f32_16x16x32_bf16 a[56:59], v[96:99], a[188:191], a[56:59]
v_accvgpr_read_b32 v116, a48
v_accvgpr_read_b32 v117, a49
v_accvgpr_read_b32 v118, a50
v_accvgpr_read_b32 v119, a51
ds_read_b64_tr_b16 v[8:9], v133 offset:0
ds_read_b64_tr_b16 v[10:11], v133 offset:8
v_pk_mul_f32 v[112:113], v[112:113], v[72:73]
v_pk_mul_f32 v[114:115], v[114:115], v[74:75]
v_pk_mul_f32 v[116:117], v[116:117], v[72:73]
v_pk_mul_f32 v[118:119], v[118:119], v[74:75]
v_cvt_pk_bf16_f32 v112, v112, v113
v_cvt_pk_bf16_f32 v113, v114, v115
v_cvt_pk_bf16_f32 v114, v116, v117
v_cvt_pk_bf16_f32 v115, v118, v119
v_mfma_f32_16x16x32_bf16 a[72:75], v[96:99], a[192:195], a[72:75]
v_accvgpr_read_b32 v104, a64
v_accvgpr_read_b32 v105, a65
v_accvgpr_read_b32 v106, a66
v_accvgpr_read_b32 v107, a67
ds_write_b128 v132, v[112:115] offset:1024
v_mfma_f32_16x16x32_bf16 a[88:91], v[96:99], a[196:199], a[88:91]
v_accvgpr_read_b32 v108, a80
v_accvgpr_read_b32 v109, a81
v_accvgpr_read_b32 v110, a82
v_accvgpr_read_b32 v111, a83
ds_read_b64_tr_b16 v[12:13], v133 offset:1024
ds_read_b64_tr_b16 v[14:15], v133 offset:1032
v_pk_mul_f32 v[104:105], v[104:105], v[72:73]
v_pk_mul_f32 v[106:107], v[106:107], v[74:75]
v_pk_mul_f32 v[108:109], v[108:109], v[72:73]
v_pk_mul_f32 v[110:111], v[110:111], v[74:75]
s_waitcnt lgkmcnt(3)
buffer_store_dwordx4 v[8:11], v244, s[20:23], s44 offen offset:0
v_cvt_pk_bf16_f32 v104, v104, v105
v_cvt_pk_bf16_f32 v105, v106, v107
v_cvt_pk_bf16_f32 v106, v108, v109
v_cvt_pk_bf16_f32 v107, v110, v111
v_mfma_f32_16x16x32_bf16 a[104:107], v[96:99], a[200:203], a[104:107]
v_accvgpr_read_b32 v112, a96
v_accvgpr_read_b32 v113, a97
v_accvgpr_read_b32 v114, a98
v_accvgpr_read_b32 v115, a99
ds_write_b128 v132, v[104:107] offset:2048
v_mfma_f32_16x16x32_bf16 a[120:123], v[96:99], a[204:207], a[120:123]
v_accvgpr_read_b32 v116, a112
v_accvgpr_read_b32 v117, a113
v_accvgpr_read_b32 v118, a114
v_accvgpr_read_b32 v119, a115
ds_read_b64_tr_b16 v[16:17], v133 offset:2048
ds_read_b64_tr_b16 v[18:19], v133 offset:2056
v_pk_mul_f32 v[112:113], v[112:113], v[72:73]
v_pk_mul_f32 v[114:115], v[114:115], v[74:75]
v_pk_mul_f32 v[116:117], v[116:117], v[72:73]
v_pk_mul_f32 v[118:119], v[118:119], v[74:75]
s_waitcnt lgkmcnt(3)
buffer_store_dwordx4 v[12:15], v244, s[20:23], s44 offen offset:1024
v_cvt_pk_bf16_f32 v112, v112, v113
v_cvt_pk_bf16_f32 v113, v114, v115
v_cvt_pk_bf16_f32 v114, v116, v117
v_cvt_pk_bf16_f32 v115, v118, v119
v_mfma_f32_16x16x32_bf16 a[12:15], v[100:103], a[176:179], a[12:15]
v_accvgpr_read_b32 v104, a4
v_accvgpr_read_b32 v105, a5
v_accvgpr_read_b32 v106, a6
v_accvgpr_read_b32 v107, a7
ds_write_b128 v132, v[112:115] offset:3072
v_mfma_f32_16x16x32_bf16 a[28:31], v[100:103], a[180:183], a[28:31]
v_accvgpr_read_b32 v108, a20
v_accvgpr_read_b32 v109, a21
v_accvgpr_read_b32 v110, a22
v_accvgpr_read_b32 v111, a23
ds_read_b64_tr_b16 v[20:21], v133 offset:3072
ds_read_b64_tr_b16 v[22:23], v133 offset:3080
v_pk_mul_f32 v[104:105], v[104:105], v[76:77]
v_pk_mul_f32 v[106:107], v[106:107], v[78:79]
v_pk_mul_f32 v[108:109], v[108:109], v[76:77]
v_pk_mul_f32 v[110:111], v[110:111], v[78:79]
s_waitcnt lgkmcnt(3)
buffer_store_dwordx4 v[16:19], v244, s[20:23], s44 offen offset:2048
v_cvt_pk_bf16_f32 v104, v104, v105
v_cvt_pk_bf16_f32 v105, v106, v107
v_cvt_pk_bf16_f32 v106, v108, v109
v_cvt_pk_bf16_f32 v107, v110, v111
v_mfma_f32_16x16x32_bf16 a[44:47], v[100:103], a[184:187], a[44:47]
v_accvgpr_read_b32 v112, a36
v_accvgpr_read_b32 v113, a37
v_accvgpr_read_b32 v114, a38
v_accvgpr_read_b32 v115, a39
ds_write_b128 v132, v[104:107] offset:0
v_mfma_f32_16x16x32_bf16 a[60:63], v[100:103], a[188:191], a[60:63]
v_accvgpr_read_b32 v116, a52
v_accvgpr_read_b32 v117, a53
v_accvgpr_read_b32 v118, a54
v_accvgpr_read_b32 v119, a55
ds_read_b64_tr_b16 v[24:25], v133 offset:0
ds_read_b64_tr_b16 v[26:27], v133 offset:8
v_pk_mul_f32 v[112:113], v[112:113], v[76:77]
v_pk_mul_f32 v[114:115], v[114:115], v[78:79]
v_pk_mul_f32 v[116:117], v[116:117], v[76:77]
v_pk_mul_f32 v[118:119], v[118:119], v[78:79]
s_waitcnt lgkmcnt(3)
buffer_store_dwordx4 v[20:23], v244, s[20:23], s44 offen offset:3072
v_cvt_pk_bf16_f32 v112, v112, v113
v_cvt_pk_bf16_f32 v113, v114, v115
v_cvt_pk_bf16_f32 v114, v116, v117
STUB_13:
STUB_B1:
s_cbranch_execz STUB_16
v_cvt_pk_bf16_f32 v115, v118, v119
v_mfma_f32_16x16x32_bf16 a[76:79], v[100:103], a[192:195], a[76:79]
v_accvgpr_read_b32 v104, a68
v_accvgpr_read_b32 v105, a69
v_accvgpr_read_b32 v106, a70
v_accvgpr_read_b32 v107, a71
ds_write_b128 v132, v[112:115] offset:1024
v_mfma_f32_16x16x32_bf16 a[92:95], v[100:103], a[196:199], a[92:95]
v_accvgpr_read_b32 v108, a84
v_accvgpr_read_b32 v109, a85
v_accvgpr_read_b32 v110, a86
v_accvgpr_read_b32 v111, a87
ds_read_b64_tr_b16 v[28:29], v133 offset:1024
ds_read_b64_tr_b16 v[30:31], v133 offset:1032
v_pk_mul_f32 v[104:105], v[104:105], v[76:77]
v_pk_mul_f32 v[106:107], v[106:107], v[78:79]
v_pk_mul_f32 v[108:109], v[108:109], v[76:77]
v_pk_mul_f32 v[110:111], v[110:111], v[78:79]
s_waitcnt lgkmcnt(3)
buffer_store_dwordx4 v[24:27], v244, s[20:23], s92 offen offset:0
v_cvt_pk_bf16_f32 v104, v104, v105
v_cvt_pk_bf16_f32 v105, v106, v107
v_cvt_pk_bf16_f32 v106, v108, v109
v_cvt_pk_bf16_f32 v107, v110, v111
v_mfma_f32_16x16x32_bf16 a[108:111], v[100:103], a[200:203], a[108:111]
v_accvgpr_read_b32 v112, a100
v_accvgpr_read_b32 v113, a101
v_accvgpr_read_b32 v114, a102
v_accvgpr_read_b32 v115, a103
ds_write_b128 v132, v[104:107] offset:2048
v_mfma_f32_16x16x32_bf16 a[124:127], v[100:103], a[204:207], a[124:127]
v_accvgpr_read_b32 v116, a116
v_accvgpr_read_b32 v117, a117
v_accvgpr_read_b32 v118, a118
v_accvgpr_read_b32 v119, a119
ds_read_b64_tr_b16 v[32:33], v133 offset:2048
ds_read_b64_tr_b16 v[34:35], v133 offset:2056
v_pk_mul_f32 v[112:113], v[112:113], v[76:77]
v_pk_mul_f32 v[114:115], v[114:115], v[78:79]
v_pk_mul_f32 v[116:117], v[116:117], v[76:77]
v_pk_mul_f32 v[118:119], v[118:119], v[78:79]
s_waitcnt lgkmcnt(3)
buffer_store_dwordx4 v[28:31], v244, s[20:23], s92 offen offset:1024
v_cvt_pk_bf16_f32 v112, v112, v113
v_cvt_pk_bf16_f32 v113, v114, v115
v_cvt_pk_bf16_f32 v114, v116, v117
v_cvt_pk_bf16_f32 v115, v118, v119
v_accvgpr_read_b32 v104, a8
v_accvgpr_read_b32 v105, a9
v_accvgpr_read_b32 v106, a10
v_accvgpr_read_b32 v107, a11
ds_write_b128 v132, v[112:115] offset:3072
v_accvgpr_read_b32 v108, a24
v_accvgpr_read_b32 v109, a25
v_accvgpr_read_b32 v110, a26
v_accvgpr_read_b32 v111, a27
ds_read_b64_tr_b16 v[36:37], v133 offset:3072
ds_read_b64_tr_b16 v[38:39], v133 offset:3080
v_pk_mul_f32 v[104:105], v[104:105], v[80:81]
v_pk_mul_f32 v[106:107], v[106:107], v[82:83]
v_pk_mul_f32 v[108:109], v[108:109], v[80:81]
v_pk_mul_f32 v[110:111], v[110:111], v[82:83]
s_waitcnt lgkmcnt(3)
buffer_store_dwordx4 v[32:35], v244, s[20:23], s92 offen offset:2048
v_cvt_pk_bf16_f32 v104, v104, v105
v_cvt_pk_bf16_f32 v105, v106, v107
v_cvt_pk_bf16_f32 v106, v108, v109
v_cvt_pk_bf16_f32 v107, v110, v111
v_accvgpr_read_b32 v112, a40
v_accvgpr_read_b32 v113, a41
v_accvgpr_read_b32 v114, a42
v_accvgpr_read_b32 v115, a43
ds_write_b128 v132, v[104:107] offset:0
v_accvgpr_read_b32 v116, a56
v_accvgpr_read_b32 v117, a57
v_accvgpr_read_b32 v118, a58
v_accvgpr_read_b32 v119, a59
ds_read_b64_tr_b16 v[40:41], v133 offset:0
ds_read_b64_tr_b16 v[42:43], v133 offset:8
v_pk_mul_f32 v[112:113], v[112:113], v[80:81]
v_pk_mul_f32 v[114:115], v[114:115], v[82:83]
v_pk_mul_f32 v[116:117], v[116:117], v[80:81]
v_pk_mul_f32 v[118:119], v[118:119], v[82:83]
s_waitcnt lgkmcnt(3)
buffer_store_dwordx4 v[36:39], v244, s[20:23], s92 offen offset:3072
v_cvt_pk_bf16_f32 v112, v112, v113
v_cvt_pk_bf16_f32 v113, v114, v115
v_cvt_pk_bf16_f32 v114, v116, v117
v_cvt_pk_bf16_f32 v115, v118, v119
v_accvgpr_read_b32 v104, a72
v_accvgpr_read_b32 v105, a73
v_accvgpr_read_b32 v106, a74
v_accvgpr_read_b32 v107, a75
ds_write_b128 v132, v[112:115] offset:1024
v_accvgpr_read_b32 v108, a88
v_accvgpr_read_b32 v109, a89
v_accvgpr_read_b32 v110, a90
v_accvgpr_read_b32 v111, a91
ds_read_b64_tr_b16 v[44:45], v133 offset:1024
ds_read_b64_tr_b16 v[46:47], v133 offset:1032
v_pk_mul_f32 v[104:105], v[104:105], v[80:81]
v_pk_mul_f32 v[106:107], v[106:107], v[82:83]
v_pk_mul_f32 v[108:109], v[108:109], v[80:81]
v_pk_mul_f32 v[110:111], v[110:111], v[82:83]
s_waitcnt lgkmcnt(3)
buffer_store_dwordx4 v[40:43], v244, s[20:23], s93 offen offset:0
v_cvt_pk_bf16_f32 v104, v104, v105
v_cvt_pk_bf16_f32 v105, v106, v107
v_cvt_pk_bf16_f32 v106, v108, v109
v_cvt_pk_bf16_f32 v107, v110, v111
v_accvgpr_read_b32 v112, a104
v_accvgpr_read_b32 v113, a105
v_accvgpr_read_b32 v114, a106
v_accvgpr_read_b32 v115, a107
ds_write_b128 v132, v[104:107] offset:2048
v_accvgpr_read_b32 v116, a120
v_accvgpr_read_b32 v117, a121
v_accvgpr_read_b32 v118, a122
v_accvgpr_read_b32 v119, a123
ds_read_b64_tr_b16 v[48:49], v133 offset:2048
ds_read_b64_tr_b16 v[50:51], v133 offset:2056
v_pk_mul_f32 v[112:113], v[112:113], v[80:81]
v_pk_mul_f32 v[114:115], v[114:115], v[82:83]
v_pk_mul_f32 v[116:117], v[116:117], v[80:81]
v_pk_mul_f32 v[118:119], v[118:119], v[82:83]
s_waitcnt lgkmcnt(3)
buffer_store_dwordx4 v[44:47], v244, s[20:23], s93 offen offset:1024
v_cvt_pk_bf16_f32 v112, v112, v113
v_cvt_pk_bf16_f32 v113, v114, v115
v_cvt_pk_bf16_f32 v114, v116, v117
v_cvt_pk_bf16_f32 v115, v118, v119
v_accvgpr_read_b32 v104, a12
v_accvgpr_read_b32 v105, a13
v_accvgpr_read_b32 v106, a14
v_accvgpr_read_b32 v107, a15
ds_write_b128 v132, v[112:115] offset:3072
v_accvgpr_read_b32 v108, a28
v_accvgpr_read_b32 v109, a29
v_accvgpr_read_b32 v110, a30
v_accvgpr_read_b32 v111, a31
ds_read_b64_tr_b16 v[52:53], v133 offset:3072
ds_read_b64_tr_b16 v[54:55], v133 offset:3080
v_pk_mul_f32 v[104:105], v[104:105], v[84:85]
v_pk_mul_f32 v[106:107], v[106:107], v[86:87]
v_pk_mul_f32 v[108:109], v[108:109], v[84:85]
v_pk_mul_f32 v[110:111], v[110:111], v[86:87]
s_waitcnt lgkmcnt(3)
buffer_store_dwordx4 v[48:51], v244, s[20:23], s93 offen offset:2048
v_cvt_pk_bf16_f32 v104, v104, v105
v_cvt_pk_bf16_f32 v105, v106, v107
v_cvt_pk_bf16_f32 v106, v108, v109
v_cvt_pk_bf16_f32 v107, v110, v111
v_accvgpr_read_b32 v112, a44
v_accvgpr_read_b32 v113, a45
v_accvgpr_read_b32 v114, a46
v_accvgpr_read_b32 v115, a47
ds_write_b128 v132, v[104:107] offset:0
v_accvgpr_read_b32 v116, a60
v_accvgpr_read_b32 v117, a61
v_accvgpr_read_b32 v118, a62
v_accvgpr_read_b32 v119, a63
ds_read_b64_tr_b16 v[56:57], v133 offset:0
ds_read_b64_tr_b16 v[58:59], v133 offset:8
v_pk_mul_f32 v[112:113], v[112:113], v[84:85]
v_pk_mul_f32 v[114:115], v[114:115], v[86:87]
v_pk_mul_f32 v[116:117], v[116:117], v[84:85]
v_pk_mul_f32 v[118:119], v[118:119], v[86:87]
s_waitcnt lgkmcnt(3)
buffer_store_dwordx4 v[52:55], v244, s[20:23], s93 offen offset:3072
v_cvt_pk_bf16_f32 v112, v112, v113
v_cvt_pk_bf16_f32 v113, v114, v115
v_cvt_pk_bf16_f32 v114, v116, v117
v_cvt_pk_bf16_f32 v115, v118, v119
v_accvgpr_read_b32 v104, a76
v_accvgpr_read_b32 v105, a77
v_accvgpr_read_b32 v106, a78
v_accvgpr_read_b32 v107, a79
ds_write_b128 v132, v[112:115] offset:1024
v_accvgpr_read_b32 v108, a92
v_accvgpr_read_b32 v109, a93
v_accvgpr_read_b32 v110, a94
v_accvgpr_read_b32 v111, a95
ds_read_b64_tr_b16 v[60:61], v133 offset:1024
ds_read_b64_tr_b16 v[62:63], v133 offset:1032
v_pk_mul_f32 v[104:105], v[104:105], v[84:85]
v_pk_mul_f32 v[106:107], v[106:107], v[86:87]
v_pk_mul_f32 v[108:109], v[108:109], v[84:85]
v_pk_mul_f32 v[110:111], v[110:111], v[86:87]
s_waitcnt lgkmcnt(3)
buffer_store_dwordx4 v[56:59], v244, s[20:23], s51 offen offset:0
v_cvt_pk_bf16_f32 v104, v104, v105
v_cvt_pk_bf16_f32 v105, v106, v107
v_cvt_pk_bf16_f32 v106, v108, v109
v_cvt_pk_bf16_f32 v107, v110, v111
v_accvgpr_read_b32 v112, a108
v_accvgpr_read_b32 v113, a109
v_accvgpr_read_b32 v114, a110
v_accvgpr_read_b32 v115, a111
ds_write_b128 v132, v[104:107] offset:2048
v_accvgpr_read_b32 v116, a124
v_accvgpr_read_b32 v117, a125
v_accvgpr_read_b32 v118, a126
v_accvgpr_read_b32 v119, a127
ds_read_b64_tr_b16 v[64:65], v133 offset:2048
ds_read_b64_tr_b16 v[66:67], v133 offset:2056
v_pk_mul_f32 v[112:113], v[112:113], v[84:85]
v_pk_mul_f32 v[114:115], v[114:115], v[86:87]
v_pk_mul_f32 v[116:117], v[116:117], v[84:85]
v_pk_mul_f32 v[118:119], v[118:119], v[86:87]
s_waitcnt lgkmcnt(3)
buffer_store_dwordx4 v[60:63], v244, s[20:23], s51 offen offset:1024
v_cvt_pk_bf16_f32 v112, v112, v113
v_cvt_pk_bf16_f32 v113, v114, v115
v_cvt_pk_bf16_f32 v114, v116, v117
v_cvt_pk_bf16_f32 v115, v118, v119
ds_write_b128 v132, v[112:115] offset:3072
ds_read_b64_tr_b16 v[68:69], v133 offset:3072
ds_read_b64_tr_b16 v[70:71], v133 offset:3080
s_waitcnt lgkmcnt(3)
buffer_store_dwordx4 v[64:67], v244, s[20:23], s51 offen offset:2048
v_max3_f32 v104, v120, v121, v122
v_max_f32 v104, v104, v123
v_add_f32 v105, v120, v121
v_add_f32 v105, v105, v122
v_add_f32 v105, v105, v123
v_cmp_nge_f32 vcc, s42, v104
v_cmp_u_f32 s[28:29], v105, v105
s_or_b64 vcc, vcc, s[28:29]
s_cmp_lg_u64 vcc, 0
s_cselect_b32 s28, 1, 0
v_mov_b32 v104, s28
v_mov_b32 v106, 147456
s_waitcnt lgkmcnt(0)
buffer_store_dwordx4 v[68:71], v244, s[20:23], s51 offen offset:3072
ds_write_b32 v134, v104
s_waitcnt vmcnt(16) lgkmcnt(0)
s_barrier
ds_read2st64_b32 v[110:111], v106 offset0:32 offset1:48
ds_read2st64_b32 v[108:109], v106 offset0:0 offset1:16
ds_read_b64_tr_b16 a[64:65], v237 offset:0
ds_read_b64_tr_b16 a[66:67], v237 offset:4608
ds_read_b64_tr_b16 a[68:69], v237 offset:9216
ds_read_b64_tr_b16 a[70:71], v237 offset:13824
ds_read_b64_tr_b16 a[72:73], v237 offset:8
ds_read_b64_tr_b16 a[74:75], v237 offset:4616
ds_read_b64_tr_b16 a[76:77], v237 offset:9224
ds_read_b64_tr_b16 a[78:79], v237 offset:13832
ds_read_b64_tr_b16 a[80:81], v238 offset:0
ds_read_b64_tr_b16 a[82:83], v238 offset:4608
ds_read_b64_tr_b16 a[84:85], v238 offset:9216
ds_read_b64_tr_b16 a[86:87], v238 offset:13824
s_waitcnt lgkmcnt(12)
v_or_b32 v108, v108, v109
v_or3_b32 v108, v108, v110, v111
s_nop 0
v_readfirstlane_b32 s28, v108
s_cmp_gt_u32 s28, s43
s_cbranch_scc1 K_FALLBACK
s_waitcnt lgkmcnt(8)
v_mfma_f32_16x16x32_bf16 v[96:99], a[64:67], v[56:59], 0
ds_read_b64_tr_b16 a[88:89], v238 offset:8
ds_read_b64_tr_b16 a[90:91], v238 offset:4616
v_mfma_f32_16x16x32_bf16 v[96:99], a[68:71], v[60:63], v[96:99]
s_lshr_b32 s32, s35, 2
s_and_b32 s33, s35, 3
v_mfma_f32_16x16x32_bf16 v[88:91], a[68:71], v[44:47], 0
s_lshl_b32 s94, s36, 9
s_lshl_b32 s28, s32, 6
v_mfma_f32_16x16x32_bf16 v[88:91], a[64:67], v[40:43], v[88:91]
s_lshr_b32 s34, s32, 2
v_mfma_f32_16x16x32_bf16 v[80:83], a[64:67], v[24:27], 0
ds_read_b64_tr_b16 a[92:93], v238 offset:9224
ds_read_b64_tr_b16 a[94:95], v238 offset:13832
v_mfma_f32_16x16x32_bf16 v[80:83], a[68:71], v[28:31], v[80:83]
s_add_u32 s94, s94, s28
s_lshl_b32 s28, s37, 4
v_mfma_f32_16x16x32_bf16 v[72:75], a[68:71], v[12:15], 0
s_add_u32 s94, s94, s28
s_add_u32 s94, s94, 0x248000
v_mfma_f32_16x16x32_bf16 v[72:75], a[64:67], v[8:11], v[72:75]
v_mov_b32 v231, 1
v_and_b32 v229, 7, v1
s_waitcnt lgkmcnt(8)
v_mfma_f32_16x16x32_bf16 v[76:79], a[72:75], v[8:11], 0
ds_read_b64_tr_b16 a[64:65], v237 offset:128
ds_read_b64_tr_b16 a[66:67], v237 offset:4736
v_mfma_f32_16x16x32_bf16 v[76:79], a[76:79], v[12:15], v[76:79]
v_lshlrev_b32 v229, 2, v229
v_lshlrev_b32 v226, 3, v1
v_mfma_f32_16x16x32_bf16 v[84:87], a[76:79], v[28:31], 0
s_lshl2_add_u32 s29, s33, s94
v_mfma_f32_16x16x32_bf16 v[84:87], a[72:75], v[24:27], v[84:87]
v_mfma_f32_16x16x32_bf16 v[92:95], a[72:75], v[40:43], 0
ds_read_b64_tr_b16 a[68:69], v237 offset:9344
ds_read_b64_tr_b16 a[70:71], v237 offset:13952
v_mfma_f32_16x16x32_bf16 v[92:95], a[76:79], v[44:47], v[92:95]
v_mfma_f32_16x16x32_bf16 v[100:103], a[76:79], v[60:63], 0
v_mfma_f32_16x16x32_bf16 v[100:103], a[72:75], v[56:59], v[100:103]
s_waitcnt lgkmcnt(8)
v_mfma_f32_16x16x32_bf16 v[128:131], a[80:83], v[56:59], 0
ds_read_b64_tr_b16 a[72:73], v237 offset:136
ds_read_b64_tr_b16 a[74:75], v237 offset:4744
v_mfma_f32_16x16x32_bf16 v[128:131], a[84:87], v[60:63], v[128:131]
v_mfma_f32_16x16x32_bf16 v[120:123], a[84:87], v[44:47], 0
v_mfma_f32_16x16x32_bf16 v[120:123], a[80:83], v[40:43], v[120:123]
v_mfma_f32_16x16x32_bf16 v[112:115], a[80:83], v[24:27], 0
ds_read_b64_tr_b16 a[76:77], v237 offset:9352
ds_read_b64_tr_b16 a[78:79], v237 offset:13960
v_mfma_f32_16x16x32_bf16 v[112:115], a[84:87], v[28:31], v[112:115]
s_waitcnt vmcnt(0)
buffer_store_dword v231, v254, s[20:23], s29 offen
v_mfma_f32_16x16x32_bf16 v[104:107], a[84:87], v[12:15], 0
s_add_u32 s28, s35, 1
s_and_b32 s28, s28, 3
v_mfma_f32_16x16x32_bf16 v[104:107], a[80:83], v[8:11], v[104:107]
s_mul_i32 s28, s28, 36864
s_waitcnt lgkmcnt(8)
v_mfma_f32_16x16x32_bf16 v[108:111], a[88:91], v[8:11], 0
ds_read_b64_tr_b16 a[80:81], v238 offset:128
ds_read_b64_tr_b16 a[82:83], v238 offset:4736
v_mfma_f32_16x16x32_bf16 v[108:111], a[92:95], v[12:15], v[108:111]
v_add_u32 v216, s28, v234
v_add_u32 v217, s28, v235
v_mfma_f32_16x16x32_bf16 v[116:119], a[92:95], v[28:31], 0
v_add_u32 v218, s28, v236
v_mfma_f32_16x16x32_bf16 v[116:119], a[88:91], v[24:27], v[116:119]
v_mfma_f32_16x16x32_bf16 v[124:127], a[88:91], v[40:43], 0
ds_read_b64_tr_b16 a[84:85], v238 offset:9344
ds_read_b64_tr_b16 a[86:87], v238 offset:13952
v_mfma_f32_16x16x32_bf16 v[124:127], a[92:95], v[44:47], v[124:127]
v_mfma_f32_16x16x32_bf16 v[132:135], a[92:95], v[60:63], 0
v_mfma_f32_16x16x32_bf16 v[132:135], a[88:91], v[56:59], v[132:135]
s_waitcnt lgkmcnt(8)
v_mfma_f32_16x16x32_bf16 v[160:163], a[64:67], v[56:59], 0
ds_read_b64_tr_b16 a[88:89], v238 offset:136
ds_read_b64_tr_b16 a[90:91], v238 offset:4744
v_mfma_f32_16x16x32_bf16 v[160:163], a[68:71], v[60:63], v[160:163]
v_mfma_f32_16x16x32_bf16 v[152:155], a[68:71], v[44:47], 0
v_mfma_f32_16x16x32_bf16 v[152:155], a[64:67], v[40:43], v[152:155]
v_mfma_f32_16x16x32_bf16 v[144:147], a[64:67], v[24:27], 0
ds_read_b64_tr_b16 a[92:93], v238 offset:9352
ds_read_b64_tr_b16 a[94:95], v238 offset:13960
v_mfma_f32_16x16x32_bf16 v[144:147], a[68:71], v[28:31], v[144:147]
v_mfma_f32_16x16x32_bf16 v[136:139], a[68:71], v[12:15], 0
v_mfma_f32_16x16x32_bf16 v[136:139], a[64:67], v[8:11], v[136:139]
s_waitcnt lgkmcnt(8)
v_mfma_f32_16x16x32_bf16 v[140:143], a[72:75], v[8:11], 0
ds_read_b64_tr_b16 a[64:65], v239 offset:0
ds_read_b64_tr_b16 a[66:67], v239 offset:4608
v_mfma_f32_16x16x32_bf16 v[140:143], a[76:79], v[12:15], v[140:143]
buffer_load_dword v230, v229, s[20:23], s94 offen sc0 sc1
v_mfma_f32_16x16x32_bf16 v[148:151], a[76:79], v[28:31], 0
s_add_u32 s39, s35, 1
s_and_b32 s39, s39, 3
v_mfma_f32_16x16x32_bf16 v[148:151], a[72:75], v[24:27], v[148:151]
s_add_u32 s28, s33, 1
s_and_b32 s28, s28, 3
v_mfma_f32_16x16x32_bf16 v[156:159], a[72:75], v[40:43], 0
ds_read_b64_tr_b16 a[68:69], v239 offset:9216
ds_read_b64_tr_b16 a[70:71], v239 offset:13824
v_mfma_f32_16x16x32_bf16 v[156:159], a[76:79], v[44:47], v[156:159]
s_sub_u32 s28, s28, s33
s_lshl_b32 s28, s28, 16
v_mfma_f32_16x16x32_bf16 v[164:167], a[76:79], v[60:63], 0
s_add_u32 s64, s28, s44
s_add_u32 s65, s64, 4096
v_mfma_f32_16x16x32_bf16 v[164:167], a[72:75], v[56:59], v[164:167]
s_add_u32 s66, s64, 8192
s_add_u32 s67, s64, 12288
s_waitcnt lgkmcnt(8)
v_mfma_f32_16x16x32_bf16 v[192:195], a[80:83], v[56:59], 0
ds_read_b64_tr_b16 a[72:73], v237 offset:18432
ds_read_b64_tr_b16 a[74:75], v237 offset:23040
v_mfma_f32_16x16x32_bf16 v[192:195], a[84:87], v[60:63], v[192:195]
s_add_u32 s28, s35, 2
s_and_b32 s28, s28, 3
v_mfma_f32_16x16x32_bf16 v[184:187], a[84:87], v[44:47], 0
s_mul_i32 s28, s28, 36864
v_mfma_f32_16x16x32_bf16 v[184:187], a[80:83], v[40:43], v[184:187]
v_add_u32 v219, s28, v234
v_add_u32 v220, s28, v235
v_mfma_f32_16x16x32_bf16 v[176:179], a[80:83], v[24:27], 0
ds_read_b64_tr_b16 a[76:77], v237 offset:27648
ds_read_b64_tr_b16 a[78:79], v237 offset:32256
v_mfma_f32_16x16x32_bf16 v[176:179], a[84:87], v[28:31], v[176:179]
v_add_u32 v221, s28, v236
v_mfma_f32_16x16x32_bf16 v[168:171], a[84:87], v[12:15], 0
s_add_u32 s28, s35, 3
s_and_b32 s28, s28, 3
v_mfma_f32_16x16x32_bf16 v[168:171], a[80:83], v[8:11], v[168:171]
s_mul_i32 s28, s28, 36864
s_waitcnt lgkmcnt(8)
v_mfma_f32_16x16x32_bf16 v[172:175], a[88:91], v[8:11], 0
ds_read_b64_tr_b16 a[80:81], v237 offset:18440
ds_read_b64_tr_b16 a[82:83], v237 offset:23048
v_mfma_f32_16x16x32_bf16 v[172:175], a[92:95], v[12:15], v[172:175]
v_add_u32 v222, s28, v234
v_add_u32 v223, s28, v235
v_mfma_f32_16x16x32_bf16 v[180:183], a[92:95], v[28:31], 0
v_add_u32 v224, s28, v236
v_mfma_f32_16x16x32_bf16 v[180:183], a[88:91], v[24:27], v[180:183]
v_mfma_f32_16x16x32_bf16 v[188:191], a[88:91], v[40:43], 0
ds_read_b64_tr_b16 a[84:85], v237 offset:27656
ds_read_b64_tr_b16 a[86:87], v237 offset:32264
v_mfma_f32_16x16x32_bf16 v[188:191], a[92:95], v[44:47], v[188:191]
v_mfma_f32_16x16x32_bf16 v[196:199], a[92:95], v[60:63], 0
s_waitcnt vmcnt(0)
v_cmp_gt_u32 vcc, 1, v230
v_mfma_f32_16x16x32_bf16 v[196:199], a[88:91], v[56:59], v[196:199]
s_waitcnt lgkmcnt(8)
v_mfma_f32_16x16x32_bf16 v[212:215], a[64:67], v[56:59], 0
ds_read_b64_tr_b16 a[88:89], v238 offset:18432
ds_read_b64_tr_b16 a[90:91], v238 offset:23040
v_mfma_f32_16x16x32_bf16 v[212:215], a[68:71], v[60:63], v[212:215]
s_bitcmp1_b32 vcc_lo, s39
s_cbranch_scc1 SP_O1A
SP_O1A_RET:
v_mfma_f32_16x16x32_bf16 v[208:211], a[68:71], v[44:47], 0
buffer_load_dwordx4 a[128:131], v244, s[20:23], s64 offen offset:0 sc0 sc1
v_mfma_f32_16x16x32_bf16 v[208:211], a[64:67], v[40:43], v[208:211]
v_mfma_f32_16x16x32_bf16 v[204:207], a[64:67], v[24:27], 0
ds_read_b64_tr_b16 a[92:93], v238 offset:27648
ds_read_b64_tr_b16 a[94:95], v238 offset:32256
v_mfma_f32_16x16x32_bf16 v[204:207], a[68:71], v[28:31], v[204:207]
v_mfma_f32_16x16x32_bf16 v[200:203], a[68:71], v[12:15], 0
buffer_load_dwordx4 a[144:147], v244, s[20:23], s65 offen offset:0 sc0 sc1
v_mfma_f32_16x16x32_bf16 v[200:203], a[64:67], v[8:11], v[200:203]
s_waitcnt lgkmcnt(8)
v_mfma_f32_16x16x32_bf16 v[72:75], a[72:75], v[16:19], v[72:75]
ds_read_b64_tr_b16 a[64:65], v238 offset:18440
ds_read_b64_tr_b16 a[66:67], v238 offset:23048
v_mfma_f32_16x16x32_bf16 v[72:75], a[76:79], v[20:23], v[72:75]
v_mfma_f32_16x16x32_bf16 v[80:83], a[76:79], v[36:39], v[80:83]
buffer_load_dwordx4 a[160:163], v244, s[20:23], s66 offen offset:0 sc0 sc1
v_mfma_f32_16x16x32_bf16 v[80:83], a[72:75], v[32:35], v[80:83]
v_mfma_f32_16x16x32_bf16 v[88:91], a[72:75], v[48:51], v[88:91]
ds_read_b64_tr_b16 a[68:69], v238 offset:27656
ds_read_b64_tr_b16 a[70:71], v238 offset:32264
v_mfma_f32_16x16x32_bf16 v[88:91], a[76:79], v[52:55], v[88:91]
v_mfma_f32_16x16x32_bf16 v[96:99], a[76:79], v[68:71], v[96:99]
buffer_load_dwordx4 a[176:179], v244, s[20:23], s67 offen offset:0 sc0 sc1
v_mfma_f32_16x16x32_bf16 v[96:99], a[72:75], v[64:67], v[96:99]
s_waitcnt lgkmcnt(8)
v_mfma_f32_16x16x32_bf16 v[100:103], a[80:83], v[64:67], v[100:103]
ds_read_b64_tr_b16 a[72:73], v237 offset:18560
ds_read_b64_tr_b16 a[74:75], v237 offset:23168
v_mfma_f32_16x16x32_bf16 v[100:103], a[84:87], v[68:71], v[100:103]
v_mfma_f32_16x16x32_bf16 v[92:95], a[84:87], v[52:55], v[92:95]
buffer_load_dwordx4 a[132:135], v244, s[20:23], s64 offen offset:1024 sc0 sc1
v_mfma_f32_16x16x32_bf16 v[92:95], a[80:83], v[48:51], v[92:95]
v_mfma_f32_16x16x32_bf16 v[84:87], a[80:83], v[32:35], v[84:87]
ds_read_b64_tr_b16 a[76:77], v237 offset:27776
ds_read_b64_tr_b16 a[78:79], v237 offset:32384
v_mfma_f32_16x16x32_bf16 v[84:87], a[84:87], v[36:39], v[84:87]
v_mfma_f32_16x16x32_bf16 v[76:79], a[84:87], v[20:23], v[76:79]
buffer_load_dwordx4 a[148:151], v244, s[20:23], s65 offen offset:1024 sc0 sc1
v_mfma_f32_16x16x32_bf16 v[76:79], a[80:83], v[16:19], v[76:79]
s_waitcnt lgkmcnt(8)
v_mfma_f32_16x16x32_bf16 v[104:107], a[88:91], v[16:19], v[104:107]
ds_read_b64_tr_b16 a[80:81], v237 offset:18568
ds_read_b64_tr_b16 a[82:83], v237 offset:23176
v_mfma_f32_16x16x32_bf16 v[104:107], a[92:95], v[20:23], v[104:107]
v_mfma_f32_16x16x32_bf16 v[112:115], a[92:95], v[36:39], v[112:115]
buffer_load_dwordx4 a[164:167], v244, s[20:23], s66 offen offset:1024 sc0 sc1
v_mfma_f32_16x16x32_bf16 v[112:115], a[88:91], v[32:35], v[112:115]
v_mfma_f32_16x16x32_bf16 v[120:123], a[88:91], v[48:51], v[120:123]
ds_read_b64_tr_b16 a[84:85], v237 offset:27784
ds_read_b64_tr_b16 a[86:87], v237 offset:32392
v_mfma_f32_16x16x32_bf16 v[120:123], a[92:95], v[52:55], v[120:123]
v_mfma_f32_16x16x32_bf16 v[128:131], a[92:95], v[68:71], v[128:131]
buffer_load_dwordx4 a[180:183], v244, s[20:23], s67 offen offset:1024 sc0 sc1
v_mfma_f32_16x16x32_bf16 v[128:131], a[88:91], v[64:67], v[128:131]
s_waitcnt lgkmcnt(8)
v_mfma_f32_16x16x32_bf16 v[132:135], a[64:67], v[64:67], v[132:135]
ds_read_b64_tr_b16 a[88:89], v238 offset:18560
ds_read_b64_tr_b16 a[90:91], v238 offset:23168
v_mfma_f32_16x16x32_bf16 v[132:135], a[68:71], v[68:71], v[132:135]
v_mfma_f32_16x16x32_bf16 v[124:127], a[68:71], v[52:55], v[124:127]
buffer_load_dwordx4 a[136:139], v244, s[20:23], s64 offen offset:2048 sc0 sc1
v_mfma_f32_16x16x32_bf16 v[124:127], a[64:67], v[48:51], v[124:127]
buffer_load_dword v230, v229, s[20:23], s94 offen sc0 sc1
v_mfma_f32_16x16x32_bf16 v[116:119], a[64:67], v[32:35], v[116:119]
ds_read_b64_tr_b16 a[92:93], v238 offset:27776
ds_read_b64_tr_b16 a[94:95], v238 offset:32384
v_mfma_f32_16x16x32_bf16 v[116:119], a[68:71], v[36:39], v[116:119]
v_mfma_f32_16x16x32_bf16 v[108:111], a[68:71], v[20:23], v[108:111]
v_mfma_f32_16x16x32_bf16 v[108:111], a[64:67], v[16:19], v[108:111]
buffer_load_dwordx4 a[152:155], v244, s[20:23], s65 offen offset:2048 sc0 sc1
s_waitcnt lgkmcnt(8)
v_mfma_f32_16x16x32_bf16 v[136:139], a[72:75], v[16:19], v[136:139]
ds_read_b64_tr_b16 a[64:65], v238 offset:18568
ds_read_b64_tr_b16 a[66:67], v238 offset:23176
v_mfma_f32_16x16x32_bf16 v[136:139], a[76:79], v[20:23], v[136:139]
v_mfma_f32_16x16x32_bf16 v[144:147], a[76:79], v[36:39], v[144:147]
v_mfma_f32_16x16x32_bf16 v[144:147], a[72:75], v[32:35], v[144:147]
buffer_load_dwordx4 a[168:171], v244, s[20:23], s66 offen offset:2048 sc0 sc1
v_mfma_f32_16x16x32_bf16 v[152:155], a[72:75], v[48:51], v[152:155]
ds_read_b64_tr_b16 a[68:69], v238 offset:27784
ds_read_b64_tr_b16 a[70:71], v238 offset:32392
v_mfma_f32_16x16x32_bf16 v[152:155], a[76:79], v[52:55], v[152:155]
v_mfma_f32_16x16x32_bf16 v[160:163], a[76:79], v[68:71], v[160:163]
v_mfma_f32_16x16x32_bf16 v[160:163], a[72:75], v[64:67], v[160:163]
buffer_load_dwordx4 a[184:187], v244, s[20:23], s67 offen offset:2048 sc0 sc1
s_waitcnt lgkmcnt(8)
v_mfma_f32_16x16x32_bf16 v[164:167], a[80:83], v[64:67], v[164:167]
ds_read_b64_tr_b16 a[72:73], v239 offset:18432
ds_read_b64_tr_b16 a[74:75], v239 offset:23040
v_mfma_f32_16x16x32_bf16 v[164:167], a[84:87], v[68:71], v[164:167]
v_mfma_f32_16x16x32_bf16 v[156:159], a[84:87], v[52:55], v[156:159]
v_mfma_f32_16x16x32_bf16 v[156:159], a[80:83], v[48:51], v[156:159]
buffer_load_dwordx4 a[140:143], v244, s[20:23], s64 offen offset:3072 sc0 sc1
v_mfma_f32_16x16x32_bf16 v[148:151], a[80:83], v[32:35], v[148:151]
ds_read_b64_tr_b16 a[76:77], v239 offset:27648
ds_read_b64_tr_b16 a[78:79], v239 offset:32256
v_mfma_f32_16x16x32_bf16 v[148:151], a[84:87], v[36:39], v[148:151]
v_mfma_f32_16x16x32_bf16 v[140:143], a[84:87], v[20:23], v[140:143]
v_mfma_f32_16x16x32_bf16 v[140:143], a[80:83], v[16:19], v[140:143]
buffer_load_dwordx4 a[156:159], v244, s[20:23], s65 offen offset:3072 sc0 sc1
s_waitcnt lgkmcnt(8)
v_mfma_f32_16x16x32_bf16 v[168:171], a[88:91], v[16:19], v[168:171]
ds_read_b64_tr_b16 a[80:81], v216 offset:0
ds_read_b64_tr_b16 a[82:83], v216 offset:4608
v_mfma_f32_16x16x32_bf16 v[168:171], a[92:95], v[20:23], v[168:171]
v_mfma_f32_16x16x32_bf16 v[176:179], a[92:95], v[36:39], v[176:179]
v_mfma_f32_16x16x32_bf16 v[176:179], a[88:91], v[32:35], v[176:179]
buffer_load_dwordx4 a[172:175], v244, s[20:23], s66 offen offset:3072 sc0 sc1
v_mfma_f32_16x16x32_bf16 v[184:187], a[88:91], v[48:51], v[184:187]
ds_read_b64_tr_b16 a[84:85], v216 offset:9216
ds_read_b64_tr_b16 a[86:87], v216 offset:13824
v_mfma_f32_16x16x32_bf16 v[184:187], a[92:95], v[52:55], v[184:187]
v_mfma_f32_16x16x32_bf16 v[192:195], a[92:95], v[68:71], v[192:195]
v_mfma_f32_16x16x32_bf16 v[192:195], a[88:91], v[64:67], v[192:195]
buffer_load_dwordx4 a[188:191], v244, s[20:23], s67 offen offset:3072 sc0 sc1
s_waitcnt lgkmcnt(8)
v_mfma_f32_16x16x32_bf16 v[196:199], a[64:67], v[64:67], v[196:199]
ds_read_b64_tr_b16 a[88:89], v216 offset:8
ds_read_b64_tr_b16 a[90:91], v216 offset:4616
v_mfma_f32_16x16x32_bf16 v[196:199], a[68:71], v[68:71], v[196:199]
s_add_u32 s28, s33, 2
s_and_b32 s28, s28, 3
v_mfma_f32_16x16x32_bf16 v[188:191], a[68:71], v[52:55], v[188:191]
s_sub_u32 s28, s28, s33
s_lshl_b32 s28, s28, 16
v_mfma_f32_16x16x32_bf16 v[188:191], a[64:67], v[48:51], v[188:191]
s_add_u32 s64, s28, s44
s_add_u32 s65, s64, 4096
v_mfma_f32_16x16x32_bf16 v[180:183], a[64:67], v[32:35], v[180:183]
ds_read_b64_tr_b16 a[92:93], v216 offset:9224
ds_read_b64_tr_b16 a[94:95], v216 offset:13832
v_mfma_f32_16x16x32_bf16 v[180:183], a[68:71], v[36:39], v[180:183]
s_add_u32 s66, s64, 8192
s_add_u32 s67, s64, 12288
v_mfma_f32_16x16x32_bf16 v[172:175], a[68:71], v[20:23], v[172:175]
s_waitcnt vmcnt(7)
v_cmp_gt_u32 vcc, 1, v230
v_mfma_f32_16x16x32_bf16 v[172:175], a[64:67], v[16:19], v[172:175]
s_waitcnt lgkmcnt(8)
v_mfma_f32_16x16x32_bf16 v[200:203], a[72:75], v[16:19], v[200:203]
ds_read_b64_tr_b16 a[64:65], v217 offset:0
STUB_14:
STUB_B2:
s_cbranch_execz STUB_17
ds_read_b64_tr_b16 a[66:67], v217 offset:4608
v_mfma_f32_16x16x32_bf16 v[200:203], a[76:79], v[20:23], v[200:203]
s_and_b32 s29, vcc_lo, 15
s_cbranch_scc1 SP_O2A
SP_O2A_RET:
v_mfma_f32_16x16x32_bf16 v[204:207], a[76:79], v[36:39], v[204:207]
buffer_load_dwordx4 a[192:195], v244, s[20:23], s64 offen offset:0 sc0 sc1
v_mfma_f32_16x16x32_bf16 v[204:207], a[72:75], v[32:35], v[204:207]
v_mfma_f32_16x16x32_bf16 v[208:211], a[72:75], v[48:51], v[208:211]
ds_read_b64_tr_b16 a[68:69], v217 offset:9216
ds_read_b64_tr_b16 a[70:71], v217 offset:13824
v_mfma_f32_16x16x32_bf16 v[208:211], a[76:79], v[52:55], v[208:211]
v_mfma_f32_16x16x32_bf16 v[212:215], a[76:79], v[68:71], v[212:215]
buffer_load_dwordx4 a[208:211], v244, s[20:23], s65 offen offset:0 sc0 sc1
v_mfma_f32_16x16x32_bf16 v[212:215], a[72:75], v[64:67], v[212:215]
s_waitcnt vmcnt(15)
s_waitcnt lgkmcnt(8)
v_mfma_f32_16x16x32_bf16 v[96:99], a[80:83], a[176:179], v[96:99]
ds_read_b64_tr_b16 a[72:73], v217 offset:8
ds_read_b64_tr_b16 a[74:75], v217 offset:4616
s_waitcnt vmcnt(11)
v_mfma_f32_16x16x32_bf16 v[96:99], a[84:87], a[180:183], v[96:99]
v_mfma_f32_16x16x32_bf16 v[88:91], a[84:87], a[164:167], v[88:91]
buffer_load_dwordx4 a[96:99], v244, s[20:23], s66 offen offset:0 sc0 sc1
v_mfma_f32_16x16x32_bf16 v[88:91], a[80:83], a[160:163], v[88:91]
v_accvgpr_read_b32 v39, a222
v_accvgpr_read_b32 v59, a232
v_mfma_f32_16x16x32_bf16 v[80:83], a[80:83], a[144:147], v[80:83]
ds_read_b64_tr_b16 a[76:77], v217 offset:9224
ds_read_b64_tr_b16 a[78:79], v217 offset:13832
v_mfma_f32_16x16x32_bf16 v[80:83], a[84:87], a[148:151], v[80:83]
v_lshlrev_b32 v38, 16, v39
v_and_b32 v39, 0xffff0000, v39
v_mfma_f32_16x16x32_bf16 v[72:75], a[84:87], a[132:135], v[72:75]
buffer_load_dwordx4 a[112:115], v244, s[20:23], s67 offen offset:0 sc0 sc1
v_mfma_f32_16x16x32_bf16 v[72:75], a[80:83], a[128:131], v[72:75]
v_lshlrev_b32 v58, 16, v59
v_and_b32 v59, 0xffff0000, v59
s_waitcnt lgkmcnt(8)
v_mfma_f32_16x16x32_bf16 v[76:79], a[88:91], a[128:131], v[76:79]
ds_read_b64_tr_b16 a[80:81], v216 offset:128
ds_read_b64_tr_b16 a[82:83], v216 offset:4736
v_mfma_f32_16x16x32_bf16 v[76:79], a[92:95], a[132:135], v[76:79]
v_add_f32 v38, v38, v58
v_add_f32 v39, v39, v59
v_mfma_f32_16x16x32_bf16 v[84:87], a[92:95], a[148:151], v[84:87]
buffer_load_dwordx4 a[196:199], v244, s[20:23], s64 offen offset:1024 sc0 sc1
v_mfma_f32_16x16x32_bf16 v[84:87], a[88:91], a[144:147], v[84:87]
v_cvt_pk_bf16_f32 v58, v38, v39
v_lshlrev_b32 v38, 16, v58
v_mfma_f32_16x16x32_bf16 v[92:95], a[88:91], a[160:163], v[92:95]
ds_read_b64_tr_b16 a[84:85], v216 offset:9344
ds_read_b64_tr_b16 a[86:87], v216 offset:13952
v_mfma_f32_16x16x32_bf16 v[92:95], a[92:95], a[164:167], v[92:95]
v_and_b32 v39, 0xffff0000, v58
v_mul_f32 v58, 0xbfb8aa3b, v38
v_mfma_f32_16x16x32_bf16 v[100:103], a[92:95], a[180:183], v[100:103]
buffer_load_dwordx4 a[244:247], v244, s[20:23], s65 offen offset:1024 sc0 sc1
v_mfma_f32_16x16x32_bf16 v[100:103], a[88:91], a[176:179], v[100:103]
v_mul_f32 v59, 0xbfb8aa3b, v39
s_waitcnt lgkmcnt(8)
v_mfma_f32_16x16x32_bf16 v[128:131], a[64:67], a[176:179], v[128:131]
ds_read_b64_tr_b16 a[88:89], v216 offset:136
ds_read_b64_tr_b16 a[90:91], v216 offset:4744
v_mfma_f32_16x16x32_bf16 v[128:131], a[68:71], a[180:183], v[128:131]
v_exp_f32 v58, v58
v_mfma_f32_16x16x32_bf16 v[120:123], a[68:71], a[164:167], v[120:123]
buffer_load_dwordx4 a[100:103], v244, s[20:23], s66 offen offset:1024 sc0 sc1
v_mfma_f32_16x16x32_bf16 v[120:123], a[64:67], a[160:163], v[120:123]
v_exp_f32 v59, v59
v_mfma_f32_16x16x32_bf16 v[112:115], a[64:67], a[144:147], v[112:115]
ds_read_b64_tr_b16 a[92:93], v216 offset:9352
ds_read_b64_tr_b16 a[94:95], v216 offset:13960
v_mfma_f32_16x16x32_bf16 v[112:115], a[68:71], a[148:151], v[112:115]
v_add_f32 v58, 1.0, v58
v_add_f32 v59, 1.0, v59
v_mfma_f32_16x16x32_bf16 v[104:107], a[68:71], a[132:135], v[104:107]
buffer_load_dwordx4 a[116:119], v244, s[20:23], s67 offen offset:1024 sc0 sc1
v_mfma_f32_16x16x32_bf16 v[104:107], a[64:67], a[128:131], v[104:107]
v_rcp_f32 v58, v58
s_waitcnt lgkmcnt(8)
v_mfma_f32_16x16x32_bf16 v[108:111], a[72:75], a[128:131], v[108:111]
ds_read_b64_tr_b16 a[64:65], v217 offset:128
ds_read_b64_tr_b16 a[66:67], v217 offset:4736
v_mfma_f32_16x16x32_bf16 v[108:111], a[76:79], a[132:135], v[108:111]
v_rcp_f32 v59, v59
v_mfma_f32_16x16x32_bf16 v[116:119], a[76:79], a[148:151], v[116:119]
buffer_load_dwordx4 a[200:203], v244, s[20:23], s64 offen offset:2048 sc0 sc1
v_mfma_f32_16x16x32_bf16 v[116:119], a[72:75], a[144:147], v[116:119]
v_mul_f32 v38, v38, v58
v_mul_f32 v39, v39, v59
v_mfma_f32_16x16x32_bf16 v[124:127], a[72:75], a[160:163], v[124:127]
ds_read_b64_tr_b16 a[68:69], v217 offset:9344
ds_read_b64_tr_b16 a[70:71], v217 offset:13952
v_mfma_f32_16x16x32_bf16 v[124:127], a[76:79], a[164:167], v[124:127]
v_cvt_pk_bf16_f32 v58, v38, v39
v_lshlrev_b32 v38, 16, v58
v_mfma_f32_16x16x32_bf16 v[132:135], a[76:79], a[180:183], v[132:135]
buffer_load_dwordx4 a[248:251], v244, s[20:23], s65 offen offset:2048 sc0 sc1
v_mfma_f32_16x16x32_bf16 v[132:135], a[72:75], a[176:179], v[132:135]
v_and_b32 v39, 0xffff0000, v58
v_accvgpr_read_b32 v41, a223
s_waitcnt lgkmcnt(8)
v_mfma_f32_16x16x32_bf16 v[160:163], a[80:83], a[176:179], v[160:163]
ds_read_b64_tr_b16 a[72:73], v217 offset:136
ds_read_b64_tr_b16 a[74:75], v217 offset:4744
v_mfma_f32_16x16x32_bf16 v[160:163], a[84:87], a[180:183], v[160:163]
v_accvgpr_read_b32 v59, a233
v_lshlrev_b32 v40, 16, v41
v_mfma_f32_16x16x32_bf16 v[152:155], a[84:87], a[164:167], v[152:155]
buffer_load_dwordx4 a[104:107], v244, s[20:23], s66 offen offset:2048 sc0 sc1
v_mfma_f32_16x16x32_bf16 v[152:155], a[80:83], a[160:163], v[152:155]
v_and_b32 v41, 0xffff0000, v41
v_lshlrev_b32 v58, 16, v59
v_mfma_f32_16x16x32_bf16 v[144:147], a[80:83], a[144:147], v[144:147]
ds_read_b64_tr_b16 a[76:77], v217 offset:9352
ds_read_b64_tr_b16 a[78:79], v217 offset:13960
v_mfma_f32_16x16x32_bf16 v[144:147], a[84:87], a[148:151], v[144:147]
v_and_b32 v59, 0xffff0000, v59
v_add_f32 v40, v40, v58
v_mfma_f32_16x16x32_bf16 v[136:139], a[84:87], a[132:135], v[136:139]
buffer_load_dwordx4 a[120:123], v244, s[20:23], s67 offen offset:2048 sc0 sc1
v_mfma_f32_16x16x32_bf16 v[136:139], a[80:83], a[128:131], v[136:139]
v_add_f32 v41, v41, v59
v_cvt_pk_bf16_f32 v58, v40, v41
s_waitcnt lgkmcnt(8)
v_mfma_f32_16x16x32_bf16 v[140:143], a[88:91], a[128:131], v[140:143]
ds_read_b64_tr_b16 a[80:81], v218 offset:0
ds_read_b64_tr_b16 a[82:83], v218 offset:4608
v_mfma_f32_16x16x32_bf16 v[140:143], a[92:95], a[132:135], v[140:143]
v_lshlrev_b32 v40, 16, v58
v_and_b32 v41, 0xffff0000, v58
v_mfma_f32_16x16x32_bf16 v[148:151], a[92:95], a[148:151], v[148:151]
buffer_load_dwordx4 a[204:207], v244, s[20:23], s64 offen offset:3072 sc0 sc1
v_mfma_f32_16x16x32_bf16 v[148:151], a[88:91], a[144:147], v[148:151]
v_mul_f32 v58, 0xbfb8aa3b, v40
v_mul_f32 v59, 0xbfb8aa3b, v41
v_mfma_f32_16x16x32_bf16 v[156:159], a[88:91], a[160:163], v[156:159]
ds_read_b64_tr_b16 a[84:85], v218 offset:9216
ds_read_b64_tr_b16 a[86:87], v218 offset:13824
v_mfma_f32_16x16x32_bf16 v[156:159], a[92:95], a[164:167], v[156:159]
v_exp_f32 v58, v58
v_mfma_f32_16x16x32_bf16 v[164:167], a[92:95], a[180:183], v[164:167]
buffer_load_dwordx4 a[252:255], v244, s[20:23], s65 offen offset:3072 sc0 sc1
v_mfma_f32_16x16x32_bf16 v[164:167], a[88:91], a[176:179], v[164:167]
v_exp_f32 v59, v59
s_waitcnt lgkmcnt(8)
v_mfma_f32_16x16x32_bf16 v[192:195], a[64:67], a[176:179], v[192:195]
ds_read_b64_tr_b16 a[88:89], v216 offset:18432
ds_read_b64_tr_b16 a[90:91], v216 offset:23040
v_mfma_f32_16x16x32_bf16 v[192:195], a[68:71], a[180:183], v[192:195]
v_add_f32 v58, 1.0, v58
v_add_f32 v59, 1.0, v59
v_mfma_f32_16x16x32_bf16 v[184:187], a[68:71], a[164:167], v[184:187]
buffer_load_dwordx4 a[108:111], v244, s[20:23], s66 offen offset:3072 sc0 sc1
v_mfma_f32_16x16x32_bf16 v[184:187], a[64:67], a[160:163], v[184:187]
v_rcp_f32 v58, v58
v_mfma_f32_16x16x32_bf16 v[176:179], a[64:67], a[144:147], v[176:179]
ds_read_b64_tr_b16 a[92:93], v216 offset:27648
ds_read_b64_tr_b16 a[94:95], v216 offset:32256
v_mfma_f32_16x16x32_bf16 v[176:179], a[68:71], a[148:151], v[176:179]
v_rcp_f32 v59, v59
v_mfma_f32_16x16x32_bf16 v[168:171], a[68:71], a[132:135], v[168:171]
buffer_load_dwordx4 a[124:127], v244, s[20:23], s67 offen offset:3072 sc0 sc1
v_mfma_f32_16x16x32_bf16 v[168:171], a[64:67], a[128:131], v[168:171]
s_add_u32 s28, s33, 3
s_and_b32 s28, s28, 3
s_waitcnt lgkmcnt(8)
v_mfma_f32_16x16x32_bf16 v[172:175], a[72:75], a[128:131], v[172:175]
ds_read_b64_tr_b16 a[64:65], v216 offset:18440
ds_read_b64_tr_b16 a[66:67], v216 offset:23048
v_mfma_f32_16x16x32_bf16 v[172:175], a[76:79], a[132:135], v[172:175]
s_sub_u32 s28, s28, s33
s_lshl_b32 s28, s28, 16
v_mfma_f32_16x16x32_bf16 v[180:183], a[76:79], a[148:151], v[180:183]
s_add_u32 s64, s28, s44
s_add_u32 s65, s64, 4096
v_mfma_f32_16x16x32_bf16 v[180:183], a[72:75], a[144:147], v[180:183]
s_add_u32 s66, s64, 8192
s_add_u32 s67, s64, 12288
v_mfma_f32_16x16x32_bf16 v[188:191], a[72:75], a[160:163], v[188:191]
ds_read_b64_tr_b16 a[68:69], v216 offset:27656
ds_read_b64_tr_b16 a[70:71], v216 offset:32264
v_mfma_f32_16x16x32_bf16 v[188:191], a[76:79], a[164:167], v[188:191]
buffer_load_dwordx4 a[0:3], v244, s[20:23], s64 offen offset:0 sc0 sc1
v_mfma_f32_16x16x32_bf16 v[196:199], a[76:79], a[180:183], v[196:199]
v_mul_f32 v40, v40, v58
v_mul_f32 v41, v41, v59
v_mfma_f32_16x16x32_bf16 v[196:199], a[72:75], a[176:179], v[196:199]
v_cvt_pk_bf16_f32 v58, v40, v41
v_lshlrev_b32 v40, 16, v58
s_waitcnt lgkmcnt(8)
v_mfma_f32_16x16x32_bf16 v[212:215], a[80:83], a[176:179], v[212:215]
ds_read_b64_tr_b16 a[72:73], v217 offset:18432
ds_read_b64_tr_b16 a[74:75], v217 offset:23040
v_mfma_f32_16x16x32_bf16 v[212:215], a[84:87], a[180:183], v[212:215]
buffer_load_dwordx4 a[16:19], v244, s[20:23], s65 offen offset:0 sc0 sc1
v_mfma_f32_16x16x32_bf16 v[208:211], a[84:87], a[164:167], v[208:211]
v_and_b32 v41, 0xffff0000, v58
v_accvgpr_read_b32 v43, a224
v_mfma_f32_16x16x32_bf16 v[208:211], a[80:83], a[160:163], v[208:211]
v_accvgpr_read_b32 v59, a234
v_lshlrev_b32 v42, 16, v43
v_mfma_f32_16x16x32_bf16 v[204:207], a[80:83], a[144:147], v[204:207]
ds_read_b64_tr_b16 a[76:77], v217 offset:27648
ds_read_b64_tr_b16 a[78:79], v217 offset:32256
v_mfma_f32_16x16x32_bf16 v[204:207], a[84:87], a[148:151], v[204:207]
buffer_load_dwordx4 a[32:35], v244, s[20:23], s66 offen offset:0 sc0 sc1
v_mfma_f32_16x16x32_bf16 v[200:203], a[84:87], a[132:135], v[200:203]
v_and_b32 v43, 0xffff0000, v43
v_lshlrev_b32 v58, 16, v59
v_mfma_f32_16x16x32_bf16 v[200:203], a[80:83], a[128:131], v[200:203]
v_and_b32 v59, 0xffff0000, v59
v_add_f32 v42, v42, v58
s_waitcnt vmcnt(23)
s_waitcnt lgkmcnt(8)
v_mfma_f32_16x16x32_bf16 v[72:75], a[88:91], a[136:139], v[72:75]
ds_read_b64_tr_b16 a[80:81], v217 offset:18440
ds_read_b64_tr_b16 a[82:83], v217 offset:23048
s_waitcnt vmcnt(19)
v_mfma_f32_16x16x32_bf16 v[72:75], a[92:95], a[140:143], v[72:75]
buffer_load_dwordx4 a[48:51], v244, s[20:23], s67 offen offset:0 sc0 sc1
v_mfma_f32_16x16x32_bf16 v[80:83], a[92:95], a[156:159], v[80:83]
v_add_f32 v43, v43, v59
v_cvt_pk_bf16_f32 v58, v42, v43
v_mfma_f32_16x16x32_bf16 v[80:83], a[88:91], a[152:155], v[80:83]
v_lshlrev_b32 v42, 16, v58
v_and_b32 v43, 0xffff0000, v58
v_mfma_f32_16x16x32_bf16 v[88:91], a[88:91], a[168:171], v[88:91]
ds_read_b64_tr_b16 a[84:85], v217 offset:27656
ds_read_b64_tr_b16 a[86:87], v217 offset:32264
v_mfma_f32_16x16x32_bf16 v[88:91], a[92:95], a[172:175], v[88:91]
buffer_load_dwordx4 a[4:7], v244, s[20:23], s64 offen offset:1024 sc0 sc1
v_mfma_f32_16x16x32_bf16 v[96:99], a[92:95], a[188:191], v[96:99]
v_mul_f32 v58, 0xbfb8aa3b, v42
v_mul_f32 v59, 0xbfb8aa3b, v43
v_mfma_f32_16x16x32_bf16 v[96:99], a[88:91], a[184:187], v[96:99]
v_exp_f32 v58, v58
s_waitcnt lgkmcnt(8)
v_mfma_f32_16x16x32_bf16 v[100:103], a[64:67], a[184:187], v[100:103]
ds_read_b64_tr_b16 a[88:89], v216 offset:18560
ds_read_b64_tr_b16 a[90:91], v216 offset:23168
v_mfma_f32_16x16x32_bf16 v[100:103], a[68:71], a[188:191], v[100:103]
buffer_load_dwordx4 a[20:23], v244, s[20:23], s65 offen offset:1024 sc0 sc1
v_mfma_f32_16x16x32_bf16 v[92:95], a[68:71], a[172:175], v[92:95]
v_exp_f32 v59, v59
v_mfma_f32_16x16x32_bf16 v[92:95], a[64:67], a[168:171], v[92:95]
v_add_f32 v58, 1.0, v58
v_add_f32 v59, 1.0, v59
v_mfma_f32_16x16x32_bf16 v[84:87], a[64:67], a[152:155], v[84:87]
ds_read_b64_tr_b16 a[92:93], v216 offset:27776
ds_read_b64_tr_b16 a[94:95], v216 offset:32384
v_mfma_f32_16x16x32_bf16 v[84:87], a[68:71], a[156:159], v[84:87]
buffer_load_dwordx4 a[36:39], v244, s[20:23], s66 offen offset:1024 sc0 sc1
v_mfma_f32_16x16x32_bf16 v[76:79], a[68:71], a[140:143], v[76:79]
v_rcp_f32 v58, v58
v_mfma_f32_16x16x32_bf16 v[76:79], a[64:67], a[136:139], v[76:79]
v_rcp_f32 v59, v59
s_waitcnt lgkmcnt(8)
v_mfma_f32_16x16x32_bf16 v[104:107], a[72:75], a[136:139], v[104:107]
ds_read_b64_tr_b16 a[64:65], v216 offset:18568
ds_read_b64_tr_b16 a[66:67], v216 offset:23176
v_mfma_f32_16x16x32_bf16 v[104:107], a[76:79], a[140:143], v[104:107]
buffer_load_dwordx4 a[52:55], v244, s[20:23], s67 offen offset:1024 sc0 sc1
v_mfma_f32_16x16x32_bf16 v[112:115], a[76:79], a[156:159], v[112:115]
v_mul_f32 v42, v42, v58
v_mul_f32 v43, v43, v59
v_mfma_f32_16x16x32_bf16 v[112:115], a[72:75], a[152:155], v[112:115]
v_cvt_pk_bf16_f32 v58, v42, v43
v_lshlrev_b32 v42, 16, v58
v_mfma_f32_16x16x32_bf16 v[120:123], a[72:75], a[168:171], v[120:123]
ds_read_b64_tr_b16 a[68:69], v216 offset:27784
ds_read_b64_tr_b16 a[70:71], v216 offset:32392
v_mfma_f32_16x16x32_bf16 v[120:123], a[76:79], a[172:175], v[120:123]
buffer_load_dwordx4 a[8:11], v244, s[20:23], s64 offen offset:2048 sc0 sc1
v_mfma_f32_16x16x32_bf16 v[128:131], a[76:79], a[188:191], v[128:131]
v_and_b32 v43, 0xffff0000, v58
v_accvgpr_read_b32 v45, a225
v_mfma_f32_16x16x32_bf16 v[128:131], a[72:75], a[184:187], v[128:131]
v_accvgpr_read_b32 v59, a235
v_lshlrev_b32 v44, 16, v45
s_waitcnt lgkmcnt(8)
v_mfma_f32_16x16x32_bf16 v[132:135], a[80:83], a[184:187], v[132:135]
ds_read_b64_tr_b16 a[72:73], v217 offset:18560
ds_read_b64_tr_b16 a[74:75], v217 offset:23168
v_mfma_f32_16x16x32_bf16 v[132:135], a[84:87], a[188:191], v[132:135]
buffer_load_dwordx4 a[24:27], v244, s[20:23], s65 offen offset:2048 sc0 sc1
v_mfma_f32_16x16x32_bf16 v[124:127], a[84:87], a[172:175], v[124:127]
v_and_b32 v45, 0xffff0000, v45
v_lshlrev_b32 v58, 16, v59
v_mfma_f32_16x16x32_bf16 v[124:127], a[80:83], a[168:171], v[124:127]
v_and_b32 v59, 0xffff0000, v59
v_add_f32 v44, v44, v58
v_mfma_f32_16x16x32_bf16 v[116:119], a[80:83], a[152:155], v[116:119]
ds_read_b64_tr_b16 a[76:77], v217 offset:27776
ds_read_b64_tr_b16 a[78:79], v217 offset:32384
v_mfma_f32_16x16x32_bf16 v[116:119], a[84:87], a[156:159], v[116:119]
buffer_load_dwordx4 a[40:43], v244, s[20:23], s66 offen offset:2048 sc0 sc1
v_mfma_f32_16x16x32_bf16 v[108:111], a[84:87], a[140:143], v[108:111]
v_add_f32 v45, v45, v59
v_cvt_pk_bf16_f32 v58, v44, v45
v_mfma_f32_16x16x32_bf16 v[108:111], a[80:83], a[136:139], v[108:111]
v_lshlrev_b32 v44, 16, v58
v_and_b32 v45, 0xffff0000, v58
s_waitcnt lgkmcnt(8)
v_mfma_f32_16x16x32_bf16 v[136:139], a[88:91], a[136:139], v[136:139]
ds_read_b64_tr_b16 a[80:81], v217 offset:18568
ds_read_b64_tr_b16 a[82:83], v217 offset:23176
v_mfma_f32_16x16x32_bf16 v[136:139], a[92:95], a[140:143], v[136:139]
buffer_load_dwordx4 a[56:59], v244, s[20:23], s67 offen offset:2048 sc0 sc1
v_mfma_f32_16x16x32_bf16 v[144:147], a[92:95], a[156:159], v[144:147]
v_mul_f32 v58, 0xbfb8aa3b, v44
v_mul_f32 v59, 0xbfb8aa3b, v45
v_mfma_f32_16x16x32_bf16 v[144:147], a[88:91], a[152:155], v[144:147]
v_exp_f32 v58, v58
v_mfma_f32_16x16x32_bf16 v[152:155], a[88:91], a[168:171], v[152:155]
ds_read_b64_tr_b16 a[84:85], v217 offset:27784
ds_read_b64_tr_b16 a[86:87], v217 offset:32392
v_mfma_f32_16x16x32_bf16 v[152:155], a[92:95], a[172:175], v[152:155]
buffer_load_dwordx4 a[12:15], v244, s[20:23], s64 offen offset:3072 sc0 sc1
v_mfma_f32_16x16x32_bf16 v[160:163], a[92:95], a[188:191], v[160:163]
v_exp_f32 v59, v59
v_mfma_f32_16x16x32_bf16 v[160:163], a[88:91], a[184:187], v[160:163]
v_add_f32 v58, 1.0, v58
v_add_f32 v59, 1.0, v59
s_waitcnt lgkmcnt(8)
v_mfma_f32_16x16x32_bf16 v[164:167], a[64:67], a[184:187], v[164:167]
ds_read_b64_tr_b16 a[88:89], v218 offset:18432
ds_read_b64_tr_b16 a[90:91], v218 offset:23040
v_mfma_f32_16x16x32_bf16 v[164:167], a[68:71], a[188:191], v[164:167]
buffer_load_dwordx4 a[28:31], v244, s[20:23], s65 offen offset:3072 sc0 sc1
v_mfma_f32_16x16x32_bf16 v[156:159], a[68:71], a[172:175], v[156:159]
v_rcp_f32 v58, v58
v_mfma_f32_16x16x32_bf16 v[156:159], a[64:67], a[168:171], v[156:159]
v_rcp_f32 v59, v59
v_mfma_f32_16x16x32_bf16 v[148:151], a[64:67], a[152:155], v[148:151]
ds_read_b64_tr_b16 a[92:93], v218 offset:27648
ds_read_b64_tr_b16 a[94:95], v218 offset:32256
v_mfma_f32_16x16x32_bf16 v[148:151], a[68:71], a[156:159], v[148:151]
buffer_load_dwordx4 a[44:47], v244, s[20:23], s66 offen offset:3072 sc0 sc1
v_mfma_f32_16x16x32_bf16 v[140:143], a[68:71], a[140:143], v[140:143]
v_mul_f32 v44, v44, v58
v_mul_f32 v45, v45, v59
v_mfma_f32_16x16x32_bf16 v[140:143], a[64:67], a[136:139], v[140:143]
v_cvt_pk_bf16_f32 v58, v44, v45
v_lshlrev_b32 v44, 16, v58
s_waitcnt lgkmcnt(8)
v_mfma_f32_16x16x32_bf16 v[168:171], a[72:75], a[136:139], v[168:171]
ds_read_b64_tr_b16 a[64:65], v220 offset:0
ds_read_b64_tr_b16 a[66:67], v220 offset:4608
v_mfma_f32_16x16x32_bf16 v[168:171], a[76:79], a[140:143], v[168:171]
buffer_load_dwordx4 a[60:63], v244, s[20:23], s67 offen offset:3072 sc0 sc1
v_mfma_f32_16x16x32_bf16 v[176:179], a[76:79], a[156:159], v[176:179]
s_lshl2_add_u32 s28, s36, s33
s_lshl2_add_u32 s28, s28, s37
v_mfma_f32_16x16x32_bf16 v[176:179], a[72:75], a[152:155], v[176:179]
s_lshl_b32 s95, s28, 5
s_add_u32 s95, s95, 0x24a000
v_mfma_f32_16x16x32_bf16 v[184:187], a[72:75], a[168:171], v[184:187]
ds_read_b64_tr_b16 a[68:69], v220 offset:9216
ds_read_b64_tr_b16 a[70:71], v220 offset:13824
v_mfma_f32_16x16x32_bf16 v[184:187], a[76:79], a[172:175], v[184:187]
s_lshl_b32 s28, s32, 18
s_sub_u32 s49, s44, s28
v_mfma_f32_16x16x32_bf16 v[192:195], a[76:79], a[188:191], v[192:195]
v_add_u32 v243, 0x2000, v244
v_mov_b32 v246, 2
v_mfma_f32_16x16x32_bf16 v[192:195], a[72:75], a[184:187], v[192:195]
s_lshl2_add_u32 s29, s33, s94
v_and_b32 v45, 0xffff0000, v58
s_waitcnt lgkmcnt(8)
v_mfma_f32_16x16x32_bf16 v[196:199], a[80:83], a[184:187], v[196:199]
ds_read_b64_tr_b16 a[72:73], v220 offset:18432
ds_read_b64_tr_b16 a[74:75], v220 offset:23040
v_mfma_f32_16x16x32_bf16 v[196:199], a[84:87], a[188:191], v[196:199]
v_accvgpr_read_b32 v47, a226
v_accvgpr_read_b32 v59, a236
v_mfma_f32_16x16x32_bf16 v[188:191], a[84:87], a[172:175], v[188:191]
v_lshlrev_b32 v46, 16, v47
v_and_b32 v47, 0xffff0000, v47
v_mfma_f32_16x16x32_bf16 v[188:191], a[80:83], a[168:171], v[188:191]
v_lshlrev_b32 v58, 16, v59
v_and_b32 v59, 0xffff0000, v59
v_mfma_f32_16x16x32_bf16 v[180:183], a[80:83], a[152:155], v[180:183]
ds_read_b64_tr_b16 a[76:77], v220 offset:27648
ds_read_b64_tr_b16 a[78:79], v220 offset:32256
v_mfma_f32_16x16x32_bf16 v[180:183], a[84:87], a[156:159], v[180:183]
v_add_f32 v46, v46, v58
v_add_f32 v47, v47, v59
v_mfma_f32_16x16x32_bf16 v[172:175], a[84:87], a[140:143], v[172:175]
v_cvt_pk_bf16_f32 v58, v46, v47
v_lshlrev_b32 v46, 16, v58
v_mfma_f32_16x16x32_bf16 v[172:175], a[80:83], a[136:139], v[172:175]
v_and_b32 v47, 0xffff0000, v58
v_mul_f32 v58, 0xbfb8aa3b, v46
s_waitcnt lgkmcnt(8)
v_mfma_f32_16x16x32_bf16 v[200:203], a[88:91], a[136:139], v[200:203]
ds_read_b64_tr_b16 a[80:81], v223 offset:0
ds_read_b64_tr_b16 a[82:83], v223 offset:4608
v_mfma_f32_16x16x32_bf16 v[200:203], a[92:95], a[140:143], v[200:203]
v_mul_f32 v59, 0xbfb8aa3b, v47
v_mfma_f32_16x16x32_bf16 v[204:207], a[92:95], a[156:159], v[204:207]
v_exp_f32 v58, v58
v_mfma_f32_16x16x32_bf16 v[204:207], a[88:91], a[152:155], v[204:207]
v_exp_f32 v59, v59
v_mfma_f32_16x16x32_bf16 v[208:211], a[88:91], a[168:171], v[208:211]
ds_read_b64_tr_b16 a[84:85], v223 offset:9216
ds_read_b64_tr_b16 a[86:87], v223 offset:13824
v_mfma_f32_16x16x32_bf16 v[208:211], a[92:95], a[172:175], v[208:211]
v_add_f32 v58, 1.0, v58
v_add_f32 v59, 1.0, v59
v_mfma_f32_16x16x32_bf16 v[212:215], a[92:95], a[188:191], v[212:215]
v_rcp_f32 v58, v58
v_mfma_f32_16x16x32_bf16 v[212:215], a[88:91], a[184:187], v[212:215]
v_rcp_f32 v59, v59
s_waitcnt vmcnt(28)
s_waitcnt lgkmcnt(8)
v_mfma_f32_16x16x32_bf16 v[128:131], a[64:67], a[112:115], v[128:131]
ds_read_b64_tr_b16 a[88:89], v223 offset:18432
ds_read_b64_tr_b16 a[90:91], v223 offset:23040
s_waitcnt vmcnt(24)
v_mfma_f32_16x16x32_bf16 v[128:131], a[68:71], a[116:119], v[128:131]
v_mul_f32 v46, v46, v58
v_mul_f32 v47, v47, v59
v_mfma_f32_16x16x32_bf16 v[120:123], a[68:71], a[100:103], v[120:123]
v_cvt_pk_bf16_f32 v58, v46, v47
v_lshlrev_b32 v46, 16, v58
v_mfma_f32_16x16x32_bf16 v[120:123], a[64:67], a[96:99], v[120:123]
v_and_b32 v47, 0xffff0000, v58
v_accvgpr_read_b32 v49, a227
v_mfma_f32_16x16x32_bf16 v[112:115], a[64:67], a[208:211], v[112:115]
ds_read_b64_tr_b16 a[92:93], v223 offset:27648
ds_read_b64_tr_b16 a[94:95], v223 offset:32256
v_mfma_f32_16x16x32_bf16 v[112:115], a[68:71], a[244:247], v[112:115]
v_accvgpr_read_b32 v59, a237
v_lshlrev_b32 v48, 16, v49
v_mfma_f32_16x16x32_bf16 v[104:107], a[68:71], a[196:199], v[104:107]
v_and_b32 v49, 0xffff0000, v49
v_lshlrev_b32 v58, 16, v59
v_mfma_f32_16x16x32_bf16 v[104:107], a[64:67], a[192:195], v[104:107]
s_waitcnt vmcnt(0)
buffer_store_dword v246, v254, s[20:23], s29 offen
s_waitcnt vmcnt(21)
s_waitcnt lgkmcnt(8)
v_mfma_f32_16x16x32_bf16 v[104:107], a[72:75], a[200:203], v[104:107]
ds_read_b64_tr_b16 a[64:65], v220 offset:8
ds_read_b64_tr_b16 a[66:67], v220 offset:4616
s_waitcnt vmcnt(17)
v_mfma_f32_16x16x32_bf16 v[104:107], a[76:79], a[204:207], v[104:107]
s_xor_b32 s28, s32, 0
s_sub_u32 s29, s32, s28
v_mfma_f32_16x16x32_bf16 v[112:115], a[76:79], a[252:255], v[112:115]
s_lshl_b32 s28, s28, 18
s_and_b32 s29, s29, 3
v_mfma_f32_16x16x32_bf16 v[112:115], a[72:75], a[248:251], v[112:115]
s_add_u32 s28, s28, s49
s_lshl_b32 s50, s29, 10
v_mfma_f32_16x16x32_bf16 v[120:123], a[72:75], a[104:107], v[120:123]
ds_read_b64_tr_b16 a[68:69], v220 offset:9224
ds_read_b64_tr_b16 a[70:71], v220 offset:13832
v_mfma_f32_16x16x32_bf16 v[120:123], a[76:79], a[108:111], v[120:123]
s_mul_i32 s29, s29, 0x1200
s_and_b32 s29, s29, 0x2200
v_mfma_f32_16x16x32_bf16 v[128:131], a[76:79], a[124:127], v[128:131]
s_add_u32 s72, s28, s29
v_and_b32 v59, 0xffff0000, v59
v_mfma_f32_16x16x32_bf16 v[128:131], a[72:75], a[120:123], v[128:131]
s_xor_b32 s28, s32, 1
s_sub_u32 s29, s32, s28
s_waitcnt vmcnt(13)
s_waitcnt lgkmcnt(8)
v_mfma_f32_16x16x32_bf16 v[128:131], a[80:83], a[48:51], v[128:131]
ds_read_b64_tr_b16 a[72:73], v220 offset:18440
ds_read_b64_tr_b16 a[74:75], v220 offset:23048
s_waitcnt vmcnt(9)
v_mfma_f32_16x16x32_bf16 v[128:131], a[84:87], a[52:55], v[128:131]
s_lshl_b32 s28, s28, 18
s_and_b32 s29, s29, 3
v_mfma_f32_16x16x32_bf16 v[120:123], a[84:87], a[36:39], v[120:123]
s_add_u32 s28, s28, s49
s_lshl_b32 s50, s29, 10
v_mfma_f32_16x16x32_bf16 v[120:123], a[80:83], a[32:35], v[120:123]
s_add_u32 s65, s28, s50
v_add_f32 v48, v48, v58
v_mfma_f32_16x16x32_bf16 v[112:115], a[80:83], a[16:19], v[112:115]
ds_read_b64_tr_b16 a[76:77], v220 offset:27656
ds_read_b64_tr_b16 a[78:79], v220 offset:32264
v_mfma_f32_16x16x32_bf16 v[112:115], a[84:87], a[20:23], v[112:115]
s_mul_i32 s29, s29, 0x1200
s_and_b32 s29, s29, 0x2200
v_mfma_f32_16x16x32_bf16 v[104:107], a[84:87], a[4:7], v[104:107]
s_add_u32 s73, s28, s29
v_add_f32 v49, v49, v59
v_mfma_f32_16x16x32_bf16 v[104:107], a[80:83], a[0:3], v[104:107]
s_xor_b32 s28, s32, 2
s_sub_u32 s29, s32, s28
s_waitcnt vmcnt(5)
s_waitcnt lgkmcnt(8)
v_mfma_f32_16x16x32_bf16 v[104:107], a[88:91], a[8:11], v[104:107]
ds_read_b64_tr_b16 a[80:81], v223 offset:8
ds_read_b64_tr_b16 a[82:83], v223 offset:4616
s_waitcnt vmcnt(1)
v_mfma_f32_16x16x32_bf16 v[104:107], a[92:95], a[12:15], v[104:107]
s_lshl_b32 s28, s28, 18
s_and_b32 s29, s29, 3
v_mfma_f32_16x16x32_bf16 v[112:115], a[92:95], a[28:31], v[112:115]
s_add_u32 s28, s28, s49
s_lshl_b32 s50, s29, 10
v_mfma_f32_16x16x32_bf16 v[112:115], a[88:91], a[24:27], v[112:115]
s_add_u32 s66, s28, s50
v_cvt_pk_bf16_f32 v58, v48, v49
v_mfma_f32_16x16x32_bf16 v[120:123], a[88:91], a[40:43], v[120:123]
ds_read_b64_tr_b16 a[84:85], v223 offset:9224
ds_read_b64_tr_b16 a[86:87], v223 offset:13832
v_mfma_f32_16x16x32_bf16 v[120:123], a[92:95], a[44:47], v[120:123]
s_mul_i32 s29, s29, 0x1200
s_and_b32 s29, s29, 0x2200
v_mfma_f32_16x16x32_bf16 v[128:131], a[92:95], a[60:63], v[128:131]
s_add_u32 s74, s28, s29
v_lshlrev_b32 v48, 16, v58
v_mfma_f32_16x16x32_bf16 v[128:131], a[88:91], a[56:59], v[128:131]
s_xor_b32 s28, s32, 3
s_sub_u32 s29, s32, s28
s_waitcnt lgkmcnt(8)
v_mfma_f32_16x16x32_bf16 v[132:135], a[64:67], a[112:115], v[132:135]
ds_read_b64_tr_b16 a[88:89], v223 offset:18440
ds_read_b64_tr_b16 a[90:91], v223 offset:23048
v_mfma_f32_16x16x32_bf16 v[132:135], a[68:71], a[116:119], v[132:135]
s_lshl_b32 s28, s28, 18
s_and_b32 s29, s29, 3
v_mfma_f32_16x16x32_bf16 v[124:127], a[68:71], a[100:103], v[124:127]
s_add_u32 s28, s28, s49
s_lshl_b32 s50, s29, 10
v_mfma_f32_16x16x32_bf16 v[124:127], a[64:67], a[96:99], v[124:127]
s_add_u32 s67, s28, s50
v_and_b32 v49, 0xffff0000, v58
v_mfma_f32_16x16x32_bf16 v[116:119], a[64:67], a[208:211], v[116:119]
ds_read_b64_tr_b16 a[92:93], v223 offset:27656
ds_read_b64_tr_b16 a[94:95], v223 offset:32264
v_mfma_f32_16x16x32_bf16 v[116:119], a[68:71], a[244:247], v[116:119]
s_mul_i32 s29, s29, 0x1200
s_and_b32 s29, s29, 0x2200
v_mfma_f32_16x16x32_bf16 v[108:111], a[68:71], a[196:199], v[108:111]
s_add_u32 s75, s28, s29
v_mul_f32 v58, 0xbfb8aa3b, v48
v_mfma_f32_16x16x32_bf16 v[108:111], a[64:67], a[192:195], v[108:111]
buffer_load_dword v230, v229, s[20:23], s94 offen sc0 sc1
s_waitcnt lgkmcnt(8)
v_mfma_f32_16x16x32_bf16 v[108:111], a[72:75], a[200:203], v[108:111]
ds_read_b64_tr_b16 a[64:65], v220 offset:128
ds_read_b64_tr_b16 a[66:67], v220 offset:4736
v_mfma_f32_16x16x32_bf16 v[108:111], a[76:79], a[204:207], v[108:111]
s_xor_b32 s28, s32, 4
s_sub_u32 s29, s32, s28
v_mfma_f32_16x16x32_bf16 v[116:119], a[76:79], a[252:255], v[116:119]
s_lshl_b32 s28, s28, 18
s_and_b32 s29, s29, 3
v_mfma_f32_16x16x32_bf16 v[116:119], a[72:75], a[248:251], v[116:119]
s_add_u32 s28, s28, s49
s_lshl_b32 s50, s29, 10
v_mfma_f32_16x16x32_bf16 v[124:127], a[72:75], a[104:107], v[124:127]
ds_read_b64_tr_b16 a[68:69], v220 offset:9344
ds_read_b64_tr_b16 a[70:71], v220 offset:13952
v_mfma_f32_16x16x32_bf16 v[124:127], a[76:79], a[108:111], v[124:127]
s_add_u32 s68, s28, s50
s_add_u32 s68, s68, 4096
v_mfma_f32_16x16x32_bf16 v[132:135], a[76:79], a[124:127], v[132:135]
s_mul_i32 s29, s29, 0x1200
s_and_b32 s29, s29, 0x2200
v_mfma_f32_16x16x32_bf16 v[132:135], a[72:75], a[120:123], v[132:135]
s_add_u32 s84, s28, s29
v_mul_f32 v59, 0xbfb8aa3b, v49
s_waitcnt lgkmcnt(8)
v_mfma_f32_16x16x32_bf16 v[132:135], a[80:83], a[48:51], v[132:135]
ds_read_b64_tr_b16 a[72:73], v220 offset:18560
ds_read_b64_tr_b16 a[74:75], v220 offset:23168
v_mfma_f32_16x16x32_bf16 v[132:135], a[84:87], a[52:55], v[132:135]
s_xor_b32 s28, s32, 5
s_sub_u32 s29, s32, s28
v_mfma_f32_16x16x32_bf16 v[124:127], a[84:87], a[36:39], v[124:127]
s_lshl_b32 s28, s28, 18
s_and_b32 s29, s29, 3
v_mfma_f32_16x16x32_bf16 v[124:127], a[80:83], a[32:35], v[124:127]
s_add_u32 s28, s28, s49
s_lshl_b32 s50, s29, 10
v_mfma_f32_16x16x32_bf16 v[116:119], a[80:83], a[16:19], v[116:119]
ds_read_b64_tr_b16 a[76:77], v220 offset:27776
ds_read_b64_tr_b16 a[78:79], v220 offset:32384
v_mfma_f32_16x16x32_bf16 v[116:119], a[84:87], a[20:23], v[116:119]
s_add_u32 s69, s28, s50
s_add_u32 s69, s69, 4096
v_mfma_f32_16x16x32_bf16 v[108:111], a[84:87], a[4:7], v[108:111]
s_mul_i32 s29, s29, 0x1200
s_and_b32 s29, s29, 0x2200
v_mfma_f32_16x16x32_bf16 v[108:111], a[80:83], a[0:3], v[108:111]
s_add_u32 s85, s28, s29
s_waitcnt lgkmcnt(8)
v_mfma_f32_16x16x32_bf16 v[108:111], a[88:91], a[8:11], v[108:111]
ds_read_b64_tr_b16 a[80:81], v223 offset:128
ds_read_b64_tr_b16 a[82:83], v223 offset:4736
STUB_15:
STUB_B3:
s_cbranch_execz STUB_18
v_mfma_f32_16x16x32_bf16 v[108:111], a[92:95], a[12:15], v[108:111]
s_xor_b32 s28, s32, 6
s_sub_u32 s29, s32, s28
v_mfma_f32_16x16x32_bf16 v[116:119], a[92:95], a[28:31], v[116:119]
s_lshl_b32 s28, s28, 18
s_and_b32 s29, s29, 3
v_mfma_f32_16x16x32_bf16 v[116:119], a[88:91], a[24:27], v[116:119]
s_add_u32 s28, s28, s49
s_lshl_b32 s50, s29, 10
v_mfma_f32_16x16x32_bf16 v[124:127], a[88:91], a[40:43], v[124:127]
ds_read_b64_tr_b16 a[84:85], v223 offset:9344
ds_read_b64_tr_b16 a[86:87], v223 offset:13952
v_mfma_f32_16x16x32_bf16 v[124:127], a[92:95], a[44:47], v[124:127]
s_add_u32 s70, s28, s50
s_add_u32 s70, s70, 4096
v_mfma_f32_16x16x32_bf16 v[132:135], a[92:95], a[60:63], v[132:135]
s_mul_i32 s29, s29, 0x1200
s_and_b32 s29, s29, 0x2200
v_mfma_f32_16x16x32_bf16 v[132:135], a[88:91], a[56:59], v[132:135]
s_add_u32 s86, s28, s29
s_waitcnt lgkmcnt(8)
v_mfma_f32_16x16x32_bf16 v[192:195], a[64:67], a[112:115], v[192:195]
ds_read_b64_tr_b16 a[88:89], v223 offset:18560
ds_read_b64_tr_b16 a[90:91], v223 offset:23168
v_mfma_f32_16x16x32_bf16 v[192:195], a[68:71], a[116:119], v[192:195]
s_xor_b32 s28, s32, 7
s_sub_u32 s29, s32, s28
v_mfma_f32_16x16x32_bf16 v[184:187], a[68:71], a[100:103], v[184:187]
s_lshl_b32 s28, s28, 18
s_and_b32 s29, s29, 3
v_mfma_f32_16x16x32_bf16 v[184:187], a[64:67], a[96:99], v[184:187]
s_add_u32 s28, s28, s49
s_lshl_b32 s50, s29, 10
v_mfma_f32_16x16x32_bf16 v[176:179], a[64:67], a[208:211], v[176:179]
ds_read_b64_tr_b16 a[92:93], v223 offset:27776
ds_read_b64_tr_b16 a[94:95], v223 offset:32384
v_mfma_f32_16x16x32_bf16 v[176:179], a[68:71], a[244:247], v[176:179]
s_add_u32 s71, s28, s50
s_add_u32 s71, s71, 4096
v_mfma_f32_16x16x32_bf16 v[168:171], a[68:71], a[196:199], v[168:171]
s_mul_i32 s29, s29, 0x1200
s_and_b32 s29, s29, 0x2200
v_mfma_f32_16x16x32_bf16 v[168:171], a[64:67], a[192:195], v[168:171]
s_add_u32 s87, s28, s29
s_waitcnt lgkmcnt(8)
v_mfma_f32_16x16x32_bf16 v[168:171], a[72:75], a[200:203], v[168:171]
ds_read_b64_tr_b16 a[64:65], v220 offset:136
ds_read_b64_tr_b16 a[66:67], v220 offset:4744
v_mfma_f32_16x16x32_bf16 v[168:171], a[76:79], a[204:207], v[168:171]
s_waitcnt vmcnt(0)
v_cmp_gt_u32 vcc, 2, v230
v_mfma_f32_16x16x32_bf16 v[176:179], a[76:79], a[252:255], v[176:179]
v_exp_f32 v58, v58
v_mfma_f32_16x16x32_bf16 v[176:179], a[72:75], a[248:251], v[176:179]
s_and_b32 s29, vcc_lo, 15
s_cbranch_scc1 SP_O3A
SP_O3A_RET:
v_mfma_f32_16x16x32_bf16 v[184:187], a[72:75], a[104:107], v[184:187]
ds_read_b64_tr_b16 a[68:69], v220 offset:9352
ds_read_b64_tr_b16 a[70:71], v220 offset:13960
v_mfma_f32_16x16x32_bf16 v[184:187], a[76:79], a[108:111], v[184:187]
s_add_u32 s39, s44, 4096
v_mfma_f32_16x16x32_bf16 v[192:195], a[76:79], a[124:127], v[192:195]
v_cvt_pk_bf16_f32 v104, v104, v105
v_cvt_pk_bf16_f32 v105, v106, v107
v_mfma_f32_16x16x32_bf16 v[192:195], a[72:75], a[120:123], v[192:195]
v_cvt_pk_bf16_f32 v106, v108, v109
v_cvt_pk_bf16_f32 v107, v110, v111
s_waitcnt lgkmcnt(8)
v_mfma_f32_16x16x32_bf16 v[192:195], a[80:83], a[48:51], v[192:195]
ds_read_b64_tr_b16 a[72:73], v220 offset:18568
ds_read_b64_tr_b16 a[74:75], v220 offset:23176
v_mfma_f32_16x16x32_bf16 v[192:195], a[84:87], a[52:55], v[192:195]
buffer_store_dwordx4 v[104:107], v244, s[20:23], s39 offen offset:0
v_mfma_f32_16x16x32_bf16 v[184:187], a[84:87], a[36:39], v[184:187]
v_cvt_pk_bf16_f32 v112, v112, v113
v_cvt_pk_bf16_f32 v113, v114, v115
v_mfma_f32_16x16x32_bf16 v[184:187], a[80:83], a[32:35], v[184:187]
v_cvt_pk_bf16_f32 v114, v116, v117
v_cvt_pk_bf16_f32 v115, v118, v119
v_mfma_f32_16x16x32_bf16 v[176:179], a[80:83], a[16:19], v[176:179]
ds_read_b64_tr_b16 a[76:77], v220 offset:27784
ds_read_b64_tr_b16 a[78:79], v220 offset:32392
v_mfma_f32_16x16x32_bf16 v[176:179], a[84:87], a[20:23], v[176:179]
buffer_store_dwordx4 v[112:115], v244, s[20:23], s39 offen offset:1024
v_mfma_f32_16x16x32_bf16 v[168:171], a[84:87], a[4:7], v[168:171]
v_cvt_pk_bf16_f32 v120, v120, v121
v_cvt_pk_bf16_f32 v121, v122, v123
v_mfma_f32_16x16x32_bf16 v[168:171], a[80:83], a[0:3], v[168:171]
v_cvt_pk_bf16_f32 v122, v124, v125
v_cvt_pk_bf16_f32 v123, v126, v127
s_waitcnt lgkmcnt(8)
v_mfma_f32_16x16x32_bf16 v[168:171], a[88:91], a[8:11], v[168:171]
ds_read_b64_tr_b16 a[80:81], v223 offset:136
ds_read_b64_tr_b16 a[82:83], v223 offset:4744
v_mfma_f32_16x16x32_bf16 v[168:171], a[92:95], a[12:15], v[168:171]
buffer_store_dwordx4 v[120:123], v244, s[20:23], s39 offen offset:2048
v_mfma_f32_16x16x32_bf16 v[176:179], a[92:95], a[28:31], v[176:179]
v_cvt_pk_bf16_f32 v128, v128, v129
v_cvt_pk_bf16_f32 v129, v130, v131
v_mfma_f32_16x16x32_bf16 v[176:179], a[88:91], a[24:27], v[176:179]
v_cvt_pk_bf16_f32 v130, v132, v133
v_cvt_pk_bf16_f32 v131, v134, v135
v_mfma_f32_16x16x32_bf16 v[184:187], a[88:91], a[40:43], v[184:187]
ds_read_b64_tr_b16 a[84:85], v223 offset:9352
ds_read_b64_tr_b16 a[86:87], v223 offset:13960
v_mfma_f32_16x16x32_bf16 v[184:187], a[92:95], a[44:47], v[184:187]
buffer_store_dwordx4 v[128:131], v244, s[20:23], s39 offen offset:3072
v_mfma_f32_16x16x32_bf16 v[192:195], a[92:95], a[60:63], v[192:195]
v_exp_f32 v59, v59
v_mfma_f32_16x16x32_bf16 v[192:195], a[88:91], a[56:59], v[192:195]
v_add_f32 v58, 1.0, v58
v_add_f32 v59, 1.0, v59
s_waitcnt lgkmcnt(8)
v_mfma_f32_16x16x32_bf16 v[196:199], a[64:67], a[112:115], v[196:199]
ds_read_b64_tr_b16 a[88:89], v223 offset:18568
ds_read_b64_tr_b16 a[90:91], v223 offset:23176
v_mfma_f32_16x16x32_bf16 v[196:199], a[68:71], a[116:119], v[196:199]
v_rcp_f32 v58, v58
v_mfma_f32_16x16x32_bf16 v[188:191], a[68:71], a[100:103], v[188:191]
v_rcp_f32 v59, v59
v_mfma_f32_16x16x32_bf16 v[188:191], a[64:67], a[96:99], v[188:191]
v_mul_f32 v48, v48, v58
v_mul_f32 v49, v49, v59
v_mfma_f32_16x16x32_bf16 v[180:183], a[64:67], a[208:211], v[180:183]
ds_read_b64_tr_b16 a[92:93], v223 offset:27784
ds_read_b64_tr_b16 a[94:95], v223 offset:32392
v_mfma_f32_16x16x32_bf16 v[180:183], a[68:71], a[244:247], v[180:183]
v_cvt_pk_bf16_f32 v58, v48, v49
v_lshlrev_b32 v48, 16, v58
v_mfma_f32_16x16x32_bf16 v[172:175], a[68:71], a[196:199], v[172:175]
v_and_b32 v49, 0xffff0000, v58
v_accvgpr_read_b32 v51, a228
v_mfma_f32_16x16x32_bf16 v[172:175], a[64:67], a[192:195], v[172:175]
v_accvgpr_read_b32 v59, a238
v_lshlrev_b32 v50, 16, v51
s_waitcnt lgkmcnt(8)
v_mfma_f32_16x16x32_bf16 v[172:175], a[72:75], a[200:203], v[172:175]
ds_read_b64_tr_b16 a[64:65], v221 offset:0
ds_read_b64_tr_b16 a[66:67], v221 offset:4608
v_mfma_f32_16x16x32_bf16 v[172:175], a[76:79], a[204:207], v[172:175]
v_and_b32 v51, 0xffff0000, v51
v_lshlrev_b32 v58, 16, v59
v_mfma_f32_16x16x32_bf16 v[180:183], a[76:79], a[252:255], v[180:183]
v_and_b32 v59, 0xffff0000, v59
v_add_f32 v50, v50, v58
v_mfma_f32_16x16x32_bf16 v[180:183], a[72:75], a[248:251], v[180:183]
v_add_f32 v51, v51, v59
v_cvt_pk_bf16_f32 v58, v50, v51
v_mfma_f32_16x16x32_bf16 v[188:191], a[72:75], a[104:107], v[188:191]
ds_read_b64_tr_b16 a[68:69], v221 offset:9216
ds_read_b64_tr_b16 a[70:71], v221 offset:13824
v_mfma_f32_16x16x32_bf16 v[188:191], a[76:79], a[108:111], v[188:191]
v_lshlrev_b32 v50, 16, v58
v_and_b32 v51, 0xffff0000, v58
v_mfma_f32_16x16x32_bf16 v[196:199], a[76:79], a[124:127], v[196:199]
v_mul_f32 v58, 0xbfb8aa3b, v50
v_mul_f32 v59, 0xbfb8aa3b, v51
v_mfma_f32_16x16x32_bf16 v[196:199], a[72:75], a[120:123], v[196:199]
v_exp_f32 v58, v58
s_waitcnt lgkmcnt(8)
v_mfma_f32_16x16x32_bf16 v[196:199], a[80:83], a[48:51], v[196:199]
ds_read_b64_tr_b16 a[72:73], v221 offset:18432
ds_read_b64_tr_b16 a[74:75], v221 offset:23040
v_mfma_f32_16x16x32_bf16 v[196:199], a[84:87], a[52:55], v[196:199]
v_exp_f32 v59, v59
v_mfma_f32_16x16x32_bf16 v[188:191], a[84:87], a[36:39], v[188:191]
v_add_f32 v58, 1.0, v58
v_add_f32 v59, 1.0, v59
v_mfma_f32_16x16x32_bf16 v[188:191], a[80:83], a[32:35], v[188:191]
v_rcp_f32 v58, v58
v_mfma_f32_16x16x32_bf16 v[180:183], a[80:83], a[16:19], v[180:183]
ds_read_b64_tr_b16 a[76:77], v221 offset:27648
ds_read_b64_tr_b16 a[78:79], v221 offset:32256
v_mfma_f32_16x16x32_bf16 v[180:183], a[84:87], a[20:23], v[180:183]
v_rcp_f32 v59, v59
v_mfma_f32_16x16x32_bf16 v[172:175], a[84:87], a[4:7], v[172:175]
v_mul_f32 v50, v50, v58
v_mul_f32 v51, v51, v59
v_mfma_f32_16x16x32_bf16 v[172:175], a[80:83], a[0:3], v[172:175]
v_cvt_pk_bf16_f32 v58, v50, v51
v_lshlrev_b32 v50, 16, v58
s_waitcnt lgkmcnt(8)
v_mfma_f32_16x16x32_bf16 v[172:175], a[88:91], a[8:11], v[172:175]
ds_read_b64_tr_b16 a[80:81], v224 offset:0
ds_read_b64_tr_b16 a[82:83], v224 offset:4608
v_mfma_f32_16x16x32_bf16 v[172:175], a[92:95], a[12:15], v[172:175]
v_and_b32 v51, 0xffff0000, v58
v_accvgpr_read_b32 v53, a229
v_mfma_f32_16x16x32_bf16 v[180:183], a[92:95], a[28:31], v[180:183]
v_accvgpr_read_b32 v59, a239
v_lshlrev_b32 v52, 16, v53
v_mfma_f32_16x16x32_bf16 v[180:183], a[88:91], a[24:27], v[180:183]
v_and_b32 v53, 0xffff0000, v53
v_lshlrev_b32 v58, 16, v59
v_mfma_f32_16x16x32_bf16 v[188:191], a[88:91], a[40:43], v[188:191]
ds_read_b64_tr_b16 a[84:85], v224 offset:9216
ds_read_b64_tr_b16 a[86:87], v224 offset:13824
v_mfma_f32_16x16x32_bf16 v[188:191], a[92:95], a[44:47], v[188:191]
v_and_b32 v59, 0xffff0000, v59
v_add_f32 v52, v52, v58
v_mfma_f32_16x16x32_bf16 v[196:199], a[92:95], a[60:63], v[196:199]
v_add_f32 v53, v53, v59
v_cvt_pk_bf16_f32 v58, v52, v53
v_mfma_f32_16x16x32_bf16 v[196:199], a[88:91], a[56:59], v[196:199]
v_lshlrev_b32 v52, 16, v58
v_and_b32 v53, 0xffff0000, v58
s_waitcnt lgkmcnt(8)
v_mfma_f32_16x16x32_bf16 v[212:215], a[64:67], a[112:115], v[212:215]
ds_read_b64_tr_b16 a[88:89], v224 offset:18432
ds_read_b64_tr_b16 a[90:91], v224 offset:23040
v_mfma_f32_16x16x32_bf16 v[212:215], a[68:71], a[116:119], v[212:215]
v_mul_f32 v58, 0xbfb8aa3b, v52
v_mul_f32 v59, 0xbfb8aa3b, v53
v_mfma_f32_16x16x32_bf16 v[208:211], a[68:71], a[100:103], v[208:211]
v_exp_f32 v58, v58
v_mfma_f32_16x16x32_bf16 v[208:211], a[64:67], a[96:99], v[208:211]
v_exp_f32 v59, v59
v_mfma_f32_16x16x32_bf16 v[204:207], a[64:67], a[208:211], v[204:207]
ds_read_b64_tr_b16 a[92:93], v224 offset:27648
ds_read_b64_tr_b16 a[94:95], v224 offset:32256
v_mfma_f32_16x16x32_bf16 v[204:207], a[68:71], a[244:247], v[204:207]
v_add_f32 v58, 1.0, v58
v_add_f32 v59, 1.0, v59
v_mfma_f32_16x16x32_bf16 v[200:203], a[68:71], a[196:199], v[200:203]
v_rcp_f32 v58, v58
v_mfma_f32_16x16x32_bf16 v[200:203], a[64:67], a[192:195], v[200:203]
v_rcp_f32 v59, v59
s_waitcnt lgkmcnt(8)
v_mfma_f32_16x16x32_bf16 v[200:203], a[72:75], a[200:203], v[200:203]
ds_read_b64_tr_b16 a[64:65], v219 offset:0
ds_read_b64_tr_b16 a[66:67], v219 offset:4608
v_mfma_f32_16x16x32_bf16 v[200:203], a[76:79], a[204:207], v[200:203]
s_add_u32 s39, s44, 12288
v_mul_f32 v52, v52, v58
v_mfma_f32_16x16x32_bf16 v[204:207], a[76:79], a[252:255], v[204:207]
v_cvt_pk_bf16_f32 v168, v168, v169
v_cvt_pk_bf16_f32 v169, v170, v171
v_mfma_f32_16x16x32_bf16 v[204:207], a[72:75], a[248:251], v[204:207]
v_cvt_pk_bf16_f32 v170, v172, v173
v_cvt_pk_bf16_f32 v171, v174, v175
v_mfma_f32_16x16x32_bf16 v[208:211], a[72:75], a[104:107], v[208:211]
ds_read_b64_tr_b16 a[68:69], v219 offset:9216
ds_read_b64_tr_b16 a[70:71], v219 offset:13824
v_mfma_f32_16x16x32_bf16 v[208:211], a[76:79], a[108:111], v[208:211]
buffer_store_dwordx4 v[168:171], v244, s[20:23], s39 offen offset:0
v_mfma_f32_16x16x32_bf16 v[212:215], a[76:79], a[124:127], v[212:215]
v_cvt_pk_bf16_f32 v176, v176, v177
v_cvt_pk_bf16_f32 v177, v178, v179
v_mfma_f32_16x16x32_bf16 v[212:215], a[72:75], a[120:123], v[212:215]
v_cvt_pk_bf16_f32 v178, v180, v181
v_cvt_pk_bf16_f32 v179, v182, v183
s_waitcnt lgkmcnt(8)
v_mfma_f32_16x16x32_bf16 v[212:215], a[80:83], a[48:51], v[212:215]
ds_read_b64_tr_b16 a[72:73], v219 offset:18432
ds_read_b64_tr_b16 a[74:75], v219 offset:23040
v_mfma_f32_16x16x32_bf16 v[212:215], a[84:87], a[52:55], v[212:215]
buffer_store_dwordx4 v[176:179], v244, s[20:23], s39 offen offset:1024
v_mfma_f32_16x16x32_bf16 v[208:211], a[84:87], a[36:39], v[208:211]
v_cvt_pk_bf16_f32 v184, v184, v185
v_cvt_pk_bf16_f32 v185, v186, v187
v_mfma_f32_16x16x32_bf16 v[208:211], a[80:83], a[32:35], v[208:211]
v_cvt_pk_bf16_f32 v186, v188, v189
v_cvt_pk_bf16_f32 v187, v190, v191
v_mfma_f32_16x16x32_bf16 v[204:207], a[80:83], a[16:19], v[204:207]
ds_read_b64_tr_b16 a[76:77], v219 offset:27648
ds_read_b64_tr_b16 a[78:79], v219 offset:32256
v_mfma_f32_16x16x32_bf16 v[204:207], a[84:87], a[20:23], v[204:207]
buffer_store_dwordx4 v[184:187], v244, s[20:23], s39 offen offset:2048
v_mfma_f32_16x16x32_bf16 v[200:203], a[84:87], a[4:7], v[200:203]
v_cvt_pk_bf16_f32 v192, v192, v193
v_cvt_pk_bf16_f32 v193, v194, v195
v_mfma_f32_16x16x32_bf16 v[200:203], a[80:83], a[0:3], v[200:203]
v_cvt_pk_bf16_f32 v194, v196, v197
v_cvt_pk_bf16_f32 v195, v198, v199
s_waitcnt lgkmcnt(8)
v_mfma_f32_16x16x32_bf16 v[200:203], a[88:91], a[8:11], v[200:203]
ds_read_b64_tr_b16 a[80:81], v222 offset:0
ds_read_b64_tr_b16 a[82:83], v222 offset:4608
v_mfma_f32_16x16x32_bf16 v[200:203], a[92:95], a[12:15], v[200:203]
buffer_store_dwordx4 v[192:195], v244, s[20:23], s39 offen offset:3072
v_mfma_f32_16x16x32_bf16 v[204:207], a[92:95], a[28:31], v[204:207]
ds_read_b64_tr_b16 a[128:129], v219 offset:128
ds_read_b64_tr_b16 a[130:131], v219 offset:4736
v_mfma_f32_16x16x32_bf16 v[204:207], a[88:91], a[24:27], v[204:207]
v_mul_f32 v53, v53, v59
v_cvt_pk_bf16_f32 v58, v52, v53
v_mfma_f32_16x16x32_bf16 v[208:211], a[88:91], a[40:43], v[208:211]
ds_read_b64_tr_b16 a[84:85], v222 offset:9216
ds_read_b64_tr_b16 a[86:87], v222 offset:13824
v_mfma_f32_16x16x32_bf16 v[208:211], a[92:95], a[44:47], v[208:211]
v_lshlrev_b32 v52, 16, v58
v_and_b32 v53, 0xffff0000, v58
v_mfma_f32_16x16x32_bf16 v[212:215], a[92:95], a[60:63], v[212:215]
ds_read_b64_tr_b16 a[132:133], v219 offset:9344
ds_read_b64_tr_b16 a[134:135], v219 offset:13952
v_mfma_f32_16x16x32_bf16 v[212:215], a[88:91], a[56:59], v[212:215]
v_accvgpr_read_b32 v55, a230
v_accvgpr_read_b32 v59, a240
s_waitcnt lgkmcnt(8)
v_mfma_f32_16x16x32_bf16 v[96:99], a[64:67], a[112:115], v[96:99]
ds_read_b64_tr_b16 a[88:89], v222 offset:18432
ds_read_b64_tr_b16 a[90:91], v222 offset:23040
v_mfma_f32_16x16x32_bf16 v[96:99], a[68:71], a[116:119], v[96:99]
v_lshlrev_b32 v54, 16, v55
v_and_b32 v55, 0xffff0000, v55
v_mfma_f32_16x16x32_bf16 v[88:91], a[68:71], a[100:103], v[88:91]
ds_read_b64_tr_b16 a[136:137], v219 offset:18560
ds_read_b64_tr_b16 a[138:139], v219 offset:23168
v_mfma_f32_16x16x32_bf16 v[88:91], a[64:67], a[96:99], v[88:91]
v_lshlrev_b32 v58, 16, v59
v_and_b32 v59, 0xffff0000, v59
v_mfma_f32_16x16x32_bf16 v[80:83], a[64:67], a[208:211], v[80:83]
ds_read_b64_tr_b16 a[92:93], v222 offset:27648
ds_read_b64_tr_b16 a[94:95], v222 offset:32256
v_mfma_f32_16x16x32_bf16 v[80:83], a[68:71], a[244:247], v[80:83]
v_add_f32 v54, v54, v58
v_add_f32 v55, v55, v59
v_mfma_f32_16x16x32_bf16 v[72:75], a[68:71], a[196:199], v[72:75]
ds_read_b64_tr_b16 a[140:141], v219 offset:27776
ds_read_b64_tr_b16 a[142:143], v219 offset:32384
v_mfma_f32_16x16x32_bf16 v[72:75], a[64:67], a[192:195], v[72:75]
v_cvt_pk_bf16_f32 v58, v54, v55
v_lshlrev_b32 v54, 16, v58
v_mfma_f32_16x16x32_bf16 v[72:75], a[72:75], a[200:203], v[72:75]
ds_read_b64_tr_b16 a[64:65], v219 offset:8
ds_read_b64_tr_b16 a[66:67], v219 offset:4616
v_mfma_f32_16x16x32_bf16 v[72:75], a[76:79], a[204:207], v[72:75]
s_add_u32 s39, s44, 8192
v_and_b32 v55, 0xffff0000, v58
v_mfma_f32_16x16x32_bf16 v[80:83], a[76:79], a[252:255], v[80:83]
ds_read_b64_tr_b16 a[144:145], v222 offset:128
ds_read_b64_tr_b16 a[146:147], v222 offset:4736
v_mfma_f32_16x16x32_bf16 v[80:83], a[72:75], a[248:251], v[80:83]
v_cvt_pk_bf16_f32 v200, v200, v201
v_cvt_pk_bf16_f32 v201, v202, v203
v_mfma_f32_16x16x32_bf16 v[88:91], a[72:75], a[104:107], v[88:91]
ds_read_b64_tr_b16 a[68:69], v219 offset:9224
ds_read_b64_tr_b16 a[70:71], v219 offset:13832
v_mfma_f32_16x16x32_bf16 v[88:91], a[76:79], a[108:111], v[88:91]
buffer_store_dwordx2 v[200:201], v226, s[20:23], s44 offen offset:0
v_mfma_f32_16x16x32_bf16 v[96:99], a[76:79], a[124:127], v[96:99]
ds_read_b64_tr_b16 a[148:149], v222 offset:9344
ds_read_b64_tr_b16 a[150:151], v222 offset:13952
v_mfma_f32_16x16x32_bf16 v[96:99], a[72:75], a[120:123], v[96:99]
v_cvt_pk_bf16_f32 v204, v204, v205
v_cvt_pk_bf16_f32 v205, v206, v207
s_waitcnt lgkmcnt(8)
v_mfma_f32_16x16x32_bf16 v[96:99], a[80:83], a[48:51], v[96:99]
ds_read_b64_tr_b16 a[72:73], v219 offset:18440
ds_read_b64_tr_b16 a[74:75], v219 offset:23048
v_mfma_f32_16x16x32_bf16 v[96:99], a[84:87], a[52:55], v[96:99]
buffer_store_dwordx2 v[204:205], v226, s[20:23], s44 offen offset:512
v_mfma_f32_16x16x32_bf16 v[88:91], a[84:87], a[36:39], v[88:91]
ds_read_b64_tr_b16 a[152:153], v222 offset:18560
ds_read_b64_tr_b16 a[154:155], v222 offset:23168
v_mfma_f32_16x16x32_bf16 v[88:91], a[80:83], a[32:35], v[88:91]
v_cvt_pk_bf16_f32 v208, v208, v209
v_cvt_pk_bf16_f32 v209, v210, v211
v_mfma_f32_16x16x32_bf16 v[80:83], a[80:83], a[16:19], v[80:83]
ds_read_b64_tr_b16 a[76:77], v219 offset:27656
ds_read_b64_tr_b16 a[78:79], v219 offset:32264
v_mfma_f32_16x16x32_bf16 v[80:83], a[84:87], a[20:23], v[80:83]
buffer_store_dwordx2 v[208:209], v226, s[20:23], s39 offen offset:0
v_mfma_f32_16x16x32_bf16 v[72:75], a[84:87], a[4:7], v[72:75]
ds_read_b64_tr_b16 a[156:157], v222 offset:27776
ds_read_b64_tr_b16 a[158:159], v222 offset:32384
v_mfma_f32_16x16x32_bf16 v[72:75], a[80:83], a[0:3], v[72:75]
v_cvt_pk_bf16_f32 v212, v212, v213
v_cvt_pk_bf16_f32 v213, v214, v215
v_mfma_f32_16x16x32_bf16 v[72:75], a[88:91], a[8:11], v[72:75]
ds_read_b64_tr_b16 a[80:81], v222 offset:8
ds_read_b64_tr_b16 a[82:83], v222 offset:4616
v_mfma_f32_16x16x32_bf16 v[72:75], a[92:95], a[12:15], v[72:75]
buffer_store_dwordx2 v[212:213], v226, s[20:23], s39 offen offset:512
v_mfma_f32_16x16x32_bf16 v[80:83], a[92:95], a[28:31], v[80:83]
ds_read_b64_tr_b16 a[160:161], v219 offset:136
ds_read_b64_tr_b16 a[162:163], v219 offset:4744
v_mfma_f32_16x16x32_bf16 v[80:83], a[88:91], a[24:27], v[80:83]
s_lshl2_add_u32 s28, s32, s95
v_mul_f32 v58, 0xbfb8aa3b, v54
v_mfma_f32_16x16x32_bf16 v[88:91], a[88:91], a[40:43], v[88:91]
ds_read_b64_tr_b16 a[84:85], v222 offset:9224
ds_read_b64_tr_b16 a[86:87], v222 offset:13832
v_mfma_f32_16x16x32_bf16 v[88:91], a[92:95], a[44:47], v[88:91]
v_mul_f32 v59, 0xbfb8aa3b, v55
v_mfma_f32_16x16x32_bf16 v[96:99], a[92:95], a[60:63], v[96:99]
ds_read_b64_tr_b16 a[164:165], v219 offset:9352
ds_read_b64_tr_b16 a[166:167], v219 offset:13960
v_mfma_f32_16x16x32_bf16 v[96:99], a[88:91], a[56:59], v[96:99]
v_exp_f32 v58, v58
s_waitcnt lgkmcnt(8)
v_mfma_f32_16x16x32_bf16 v[100:103], a[64:67], a[112:115], v[100:103]
ds_read_b64_tr_b16 a[88:89], v222 offset:18440
ds_read_b64_tr_b16 a[90:91], v222 offset:23048
v_mfma_f32_16x16x32_bf16 v[100:103], a[68:71], a[116:119], v[100:103]
v_exp_f32 v59, v59
v_mfma_f32_16x16x32_bf16 v[92:95], a[68:71], a[100:103], v[92:95]
ds_read_b64_tr_b16 a[168:169], v219 offset:18568
ds_read_b64_tr_b16 a[170:171], v219 offset:23176
v_mfma_f32_16x16x32_bf16 v[92:95], a[64:67], a[96:99], v[92:95]
v_add_f32 v58, 1.0, v58
v_add_f32 v59, 1.0, v59
v_mfma_f32_16x16x32_bf16 v[84:87], a[64:67], a[208:211], v[84:87]
ds_read_b64_tr_b16 a[92:93], v222 offset:27656
ds_read_b64_tr_b16 a[94:95], v222 offset:32264
v_mfma_f32_16x16x32_bf16 v[84:87], a[68:71], a[244:247], v[84:87]
v_rcp_f32 v58, v58
v_mfma_f32_16x16x32_bf16 v[76:79], a[68:71], a[196:199], v[76:79]
ds_read_b64_tr_b16 a[172:173], v219 offset:27784
ds_read_b64_tr_b16 a[174:175], v219 offset:32392
v_mfma_f32_16x16x32_bf16 v[76:79], a[64:67], a[192:195], v[76:79]
v_rcp_f32 v59, v59
v_mfma_f32_16x16x32_bf16 v[76:79], a[72:75], a[200:203], v[76:79]
v_mul_f32 v54, v54, v58
v_mul_f32 v55, v55, v59
v_mfma_f32_16x16x32_bf16 v[76:79], a[76:79], a[204:207], v[76:79]
v_cvt_pk_bf16_f32 v58, v54, v55
v_lshlrev_b32 v54, 16, v58
v_mfma_f32_16x16x32_bf16 v[84:87], a[76:79], a[252:255], v[84:87]
ds_read_b64_tr_b16 a[176:177], v222 offset:136
ds_read_b64_tr_b16 a[178:179], v222 offset:4744
v_mfma_f32_16x16x32_bf16 v[84:87], a[72:75], a[248:251], v[84:87]
v_and_b32 v55, 0xffff0000, v58
v_accvgpr_read_b32 v57, a231
v_mfma_f32_16x16x32_bf16 v[92:95], a[72:75], a[104:107], v[92:95]
v_accvgpr_read_b32 v59, a241
v_lshlrev_b32 v56, 16, v57
v_mfma_f32_16x16x32_bf16 v[92:95], a[76:79], a[108:111], v[92:95]
s_waitcnt vmcnt(0)
buffer_store_dword v231, v254, s[20:23], s28 offen
v_mfma_f32_16x16x32_bf16 v[100:103], a[76:79], a[124:127], v[100:103]
ds_read_b64_tr_b16 a[180:181], v222 offset:9352
ds_read_b64_tr_b16 a[182:183], v222 offset:13960
v_mfma_f32_16x16x32_bf16 v[100:103], a[72:75], a[120:123], v[100:103]
v_and_b32 v57, 0xffff0000, v57
v_lshlrev_b32 v58, 16, v59
s_waitcnt lgkmcnt(8)
v_mfma_f32_16x16x32_bf16 v[100:103], a[80:83], a[48:51], v[100:103]
v_and_b32 v59, 0xffff0000, v59
v_add_f32 v56, v56, v58
v_mfma_f32_16x16x32_bf16 v[100:103], a[84:87], a[52:55], v[100:103]
v_add_f32 v57, v57, v59
v_cvt_pk_bf16_f32 v58, v56, v57
v_mfma_f32_16x16x32_bf16 v[92:95], a[84:87], a[36:39], v[92:95]
ds_read_b64_tr_b16 a[184:185], v222 offset:18568
ds_read_b64_tr_b16 a[186:187], v222 offset:23176
v_mfma_f32_16x16x32_bf16 v[92:95], a[80:83], a[32:35], v[92:95]
v_lshlrev_b32 v56, 16, v58
v_and_b32 v57, 0xffff0000, v58
v_mfma_f32_16x16x32_bf16 v[84:87], a[80:83], a[16:19], v[84:87]
v_mul_f32 v58, 0xbfb8aa3b, v56
v_mul_f32 v59, 0xbfb8aa3b, v57
v_mfma_f32_16x16x32_bf16 v[84:87], a[84:87], a[20:23], v[84:87]
v_exp_f32 v58, v58
v_mfma_f32_16x16x32_bf16 v[76:79], a[84:87], a[4:7], v[76:79]
ds_read_b64_tr_b16 a[188:189], v222 offset:27784
ds_read_b64_tr_b16 a[190:191], v222 offset:32392
v_mfma_f32_16x16x32_bf16 v[76:79], a[80:83], a[0:3], v[76:79]
s_waitcnt vmcnt(1)
buffer_load_dword v230, v229, s[20:23], s95 offen sc0 sc1
v_mfma_f32_16x16x32_bf16 v[76:79], a[88:91], a[8:11], v[76:79]
v_exp_f32 v59, v59
s_waitcnt lgkmcnt(8)
v_mfma_f32_16x16x32_bf16 v[76:79], a[92:95], a[12:15], v[76:79]
v_add_f32 v58, 1.0, v58
v_add_f32 v59, 1.0, v59
v_mfma_f32_16x16x32_bf16 v[84:87], a[92:95], a[28:31], v[84:87]
v_rcp_f32 v58, v58
v_mfma_f32_16x16x32_bf16 v[84:87], a[88:91], a[24:27], v[84:87]
v_rcp_f32 v59, v59
v_mfma_f32_16x16x32_bf16 v[92:95], a[88:91], a[40:43], v[92:95]
v_mul_f32 v56, v56, v58
v_mul_f32 v57, v57, v59
v_mfma_f32_16x16x32_bf16 v[92:95], a[92:95], a[44:47], v[92:95]
v_cvt_pk_bf16_f32 v58, v56, v57
v_lshlrev_b32 v56, 16, v58
v_mfma_f32_16x16x32_bf16 v[100:103], a[92:95], a[60:63], v[100:103]
v_and_b32 v57, 0xffff0000, v58
v_accvgpr_read_b32 v19, a212
v_mfma_f32_16x16x32_bf16 v[100:103], a[88:91], a[56:59], v[100:103]
v_lshlrev_b32 v18, 16, v19
v_and_b32 v19, 0xffff0000, v19
v_mfma_f32_16x16x32_bf16 v[144:147], a[128:131], a[208:211], v[144:147]
v_accvgpr_read_b32 v21, a213
v_lshlrev_b32 v20, 16, v21
v_mfma_f32_16x16x32_bf16 v[144:147], a[132:135], a[244:247], v[144:147]
v_and_b32 v21, 0xffff0000, v21
v_accvgpr_read_b32 v23, a214
v_mfma_f32_16x16x32_bf16 v[144:147], a[136:139], a[248:251], v[144:147]
v_lshlrev_b32 v22, 16, v23
v_and_b32 v23, 0xffff0000, v23
v_mfma_f32_16x16x32_bf16 v[144:147], a[140:143], a[252:255], v[144:147]
v_accvgpr_read_b32 v25, a215
v_lshlrev_b32 v24, 16, v25
v_mfma_f32_16x16x32_bf16 v[144:147], a[144:147], a[16:19], v[144:147]
v_and_b32 v25, 0xffff0000, v25
v_accvgpr_read_b32 v27, a216
v_mfma_f32_16x16x32_bf16 v[144:147], a[148:151], a[20:23], v[144:147]
v_lshlrev_b32 v26, 16, v27
v_and_b32 v27, 0xffff0000, v27
v_mfma_f32_16x16x32_bf16 v[144:147], a[152:155], a[24:27], v[144:147]
v_accvgpr_read_b32 v29, a217
v_lshlrev_b32 v28, 16, v29
v_mfma_f32_16x16x32_bf16 v[144:147], a[156:159], a[28:31], v[144:147]
v_and_b32 v29, 0xffff0000, v29
v_accvgpr_read_b32 v31, a218
s_waitcnt lgkmcnt(0)
v_mfma_f32_16x16x32_bf16 v[148:151], a[188:191], a[28:31], v[148:151]
s_add_u32 s39, s44, 0
v_lshlrev_b32 v30, 16, v31
v_mfma_f32_16x16x32_bf16 v[148:151], a[184:187], a[24:27], v[148:151]
v_cvt_pk_bf16_f32 v80, v80, v81
v_cvt_pk_bf16_f32 v81, v82, v83
v_mfma_f32_16x16x32_bf16 v[148:151], a[180:183], a[20:23], v[148:151]
v_cvt_pk_bf16_f32 v82, v84, v85
v_cvt_pk_bf16_f32 v83, v86, v87
v_mfma_f32_16x16x32_bf16 v[148:151], a[176:179], a[16:19], v[148:151]
buffer_store_dwordx4 v[80:83], v244, s[20:23], s39 offen offset:1024
v_mfma_f32_16x16x32_bf16 v[148:151], a[172:175], a[252:255], v[148:151]
v_cvt_pk_bf16_f32 v88, v88, v89
v_cvt_pk_bf16_f32 v89, v90, v91
v_mfma_f32_16x16x32_bf16 v[148:151], a[168:171], a[248:251], v[148:151]
v_cvt_pk_bf16_f32 v90, v92, v93
v_cvt_pk_bf16_f32 v91, v94, v95
v_mfma_f32_16x16x32_bf16 v[148:151], a[164:167], a[244:247], v[148:151]
buffer_store_dwordx4 v[88:91], v244, s[20:23], s39 offen offset:2048
v_mfma_f32_16x16x32_bf16 v[148:151], a[160:163], a[208:211], v[148:151]
v_cvt_pk_bf16_f32 v96, v96, v97
v_cvt_pk_bf16_f32 v97, v98, v99
v_mfma_f32_16x16x32_bf16 v[156:159], a[160:163], a[96:99], v[156:159]
v_cvt_pk_bf16_f32 v98, v100, v101
v_cvt_pk_bf16_f32 v99, v102, v103
v_mfma_f32_16x16x32_bf16 v[156:159], a[164:167], a[100:103], v[156:159]
buffer_store_dwordx4 v[96:99], v244, s[20:23], s39 offen offset:3072
v_mfma_f32_16x16x32_bf16 v[156:159], a[168:171], a[104:107], v[156:159]
s_add_u32 s39, s44, 8192
v_and_b32 v31, 0xffff0000, v31
v_mfma_f32_16x16x32_bf16 v[156:159], a[172:175], a[108:111], v[156:159]
s_waitcnt vmcnt(3)
v_cmp_gt_u32 vcc, 1, v230
v_mfma_f32_16x16x32_bf16 v[156:159], a[176:179], a[32:35], v[156:159]
v_accvgpr_read_b32 v33, a219
v_lshlrev_b32 v32, 16, v33
v_mfma_f32_16x16x32_bf16 v[156:159], a[180:183], a[36:39], v[156:159]
s_and_b32 s29, vcc_lo, 0xff
s_cbranch_scc1 SP_P1A
SP_P1A_RET:
v_mfma_f32_16x16x32_bf16 v[156:159], a[184:187], a[40:43], v[156:159]
v_and_b32 v33, 0xffff0000, v33
v_accvgpr_read_b32 v35, a220
v_mfma_f32_16x16x32_bf16 v[156:159], a[188:191], a[44:47], v[156:159]
v_cvt_pk_bf16_f32 v144, v144, v145
v_cvt_pk_bf16_f32 v145, v146, v147
v_mfma_f32_16x16x32_bf16 v[152:155], a[156:159], a[44:47], v[152:155]
v_cvt_pk_bf16_f32 v146, v148, v149
v_cvt_pk_bf16_f32 v147, v150, v151
v_mfma_f32_16x16x32_bf16 v[152:155], a[152:155], a[40:43], v[152:155]
buffer_store_dwordx4 v[144:147], v244, s[20:23], s39 offen offset:1024
v_mfma_f32_16x16x32_bf16 v[152:155], a[148:151], a[36:39], v[152:155]
buffer_load_dwordx4 v[104:107], v244, s[20:23], s68 offen sc0 sc1
v_mfma_f32_16x16x32_bf16 v[152:155], a[144:147], a[32:35], v[152:155]
v_lshlrev_b32 v34, 16, v35
v_and_b32 v35, 0xffff0000, v35
v_mfma_f32_16x16x32_bf16 v[152:155], a[140:143], a[108:111], v[152:155]
v_accvgpr_read_b32 v37, a221
v_lshlrev_b32 v36, 16, v37
v_mfma_f32_16x16x32_bf16 v[152:155], a[136:139], a[104:107], v[152:155]
buffer_load_dwordx4 v[108:111], v244, s[20:23], s69 offen sc0 sc1
v_mfma_f32_16x16x32_bf16 v[152:155], a[132:135], a[100:103], v[152:155]
v_and_b32 v37, 0xffff0000, v37
v_mfma_f32_16x16x32_bf16 v[152:155], a[128:131], a[96:99], v[152:155]
s_mov_b32 s90, 0x3f80
s_mov_b32 s91, 0x3f800000
STUB_16:
s_cbranch_execz HOP_RET2
v_mfma_f32_16x16x32_bf16 v[160:163], a[128:131], a[112:115], v[160:163]
buffer_load_dwordx4 v[112:115], v244, s[20:23], s70 offen sc0 sc1
v_mfma_f32_16x16x32_bf16 v[160:163], a[132:135], a[116:119], v[160:163]
v_mov_b32 v66, 0
v_mov_b32 v67, 0
v_mfma_f32_16x16x32_bf16 v[160:163], a[136:139], a[120:123], v[160:163]
v_mov_b32 v68, 0
v_mov_b32 v69, 0
v_mfma_f32_16x16x32_bf16 v[160:163], a[140:143], a[124:127], v[160:163]
buffer_load_dwordx4 v[116:119], v244, s[20:23], s71 offen sc0 sc1
v_mfma_f32_16x16x32_bf16 v[160:163], a[144:147], a[48:51], v[160:163]
v_mfma_f32_16x16x32_bf16 v[160:163], a[148:151], a[52:55], v[160:163]
v_mfma_f32_16x16x32_bf16 v[160:163], a[152:155], a[56:59], v[160:163]
buffer_load_dwordx2 v[200:201], v226, s[20:23], s72 offen sc0 sc1
v_mfma_f32_16x16x32_bf16 v[160:163], a[156:159], a[60:63], v[160:163]
v_cvt_pk_bf16_f32 v152, v152, v153
v_cvt_pk_bf16_f32 v153, v154, v155
v_mfma_f32_16x16x32_bf16 v[164:167], a[188:191], a[60:63], v[164:167]
v_cvt_pk_bf16_f32 v154, v156, v157
v_cvt_pk_bf16_f32 v155, v158, v159
v_mfma_f32_16x16x32_bf16 v[164:167], a[184:187], a[56:59], v[164:167]
buffer_store_dwordx4 v[152:155], v244, s[20:23], s39 offen offset:2048
v_mfma_f32_16x16x32_bf16 v[164:167], a[180:183], a[52:55], v[164:167]
buffer_load_dwordx2 v[202:203], v226, s[20:23], s73 offen sc0 sc1
v_mfma_f32_16x16x32_bf16 v[164:167], a[176:179], a[48:51], v[164:167]
v_mfma_f32_16x16x32_bf16 v[164:167], a[172:175], a[124:127], v[164:167]
v_mfma_f32_16x16x32_bf16 v[164:167], a[168:171], a[120:123], v[164:167]
buffer_load_dwordx2 v[204:205], v226, s[20:23], s74 offen sc0 sc1
v_mfma_f32_16x16x32_bf16 v[164:167], a[164:167], a[116:119], v[164:167]
v_mfma_f32_16x16x32_bf16 v[164:167], a[160:163], a[112:115], v[164:167]
v_mfma_f32_16x16x32_bf16 v[140:143], a[160:163], a[192:195], v[140:143]
buffer_load_dwordx2 v[206:207], v226, s[20:23], s75 offen sc0 sc1
v_mfma_f32_16x16x32_bf16 v[140:143], a[164:167], a[196:199], v[140:143]
v_mfma_f32_16x16x32_bf16 v[140:143], a[168:171], a[200:203], v[140:143]
v_mfma_f32_16x16x32_bf16 v[140:143], a[172:175], a[204:207], v[140:143]
buffer_load_dwordx2 v[208:209], v226, s[20:23], s84 offen sc0 sc1
v_mfma_f32_16x16x32_bf16 v[140:143], a[176:179], a[0:3], v[140:143]
v_mfma_f32_16x16x32_bf16 v[140:143], a[180:183], a[4:7], v[140:143]
v_mfma_f32_16x16x32_bf16 v[140:143], a[184:187], a[8:11], v[140:143]
buffer_load_dwordx2 v[210:211], v226, s[20:23], s85 offen sc0 sc1
v_mfma_f32_16x16x32_bf16 v[140:143], a[188:191], a[12:15], v[140:143]
v_cvt_pk_bf16_f32 v160, v160, v161
v_cvt_pk_bf16_f32 v161, v162, v163
v_mfma_f32_16x16x32_bf16 v[136:139], a[156:159], a[12:15], v[136:139]
v_cvt_pk_bf16_f32 v162, v164, v165
v_cvt_pk_bf16_f32 v163, v166, v167
v_mfma_f32_16x16x32_bf16 v[136:139], a[152:155], a[8:11], v[136:139]
buffer_store_dwordx4 v[160:163], v244, s[20:23], s39 offen offset:3072
v_mfma_f32_16x16x32_bf16 v[136:139], a[148:151], a[4:7], v[136:139]
buffer_load_dwordx2 v[212:213], v226, s[20:23], s86 offen sc0 sc1
v_mfma_f32_16x16x32_bf16 v[136:139], a[144:147], a[0:3], v[136:139]
v_mfma_f32_16x16x32_bf16 v[136:139], a[140:143], a[204:207], v[136:139]
v_mfma_f32_16x16x32_bf16 v[136:139], a[136:139], a[200:203], v[136:139]
buffer_load_dwordx2 v[214:215], v226, s[20:23], s87 offen sc0 sc1
v_mfma_f32_16x16x32_bf16 v[136:139], a[132:135], a[196:199], v[136:139]
v_mfma_f32_16x16x32_bf16 v[136:139], a[128:131], a[192:195], v[136:139]
buffer_load_dwordx4 v[120:123], v243, s[20:23], s68 offen sc0 sc1
buffer_load_dwordx4 v[124:127], v243, s[20:23], s69 offen sc0 sc1
buffer_load_dwordx4 v[128:131], v243, s[20:23], s70 offen sc0 sc1
buffer_load_dwordx4 v[132:135], v243, s[20:23], s71 offen sc0 sc1
s_lshl_b32 s50, s34, 2
s_lshl_b32 s50, 15, s50
s_waitcnt vmcnt(6)
buffer_store_dword v246, v254, s[20:23], s28 offen
s_waitcnt vmcnt(18)
v_dot2c_f32_bf16 v72, s90, v104
v_dot2c_f32_bf16 v73, s91, v104
v_dot2c_f32_bf16 v74, s90, v105
v_dot2c_f32_bf16 v75, s91, v105
v_dot2c_f32_bf16 v76, s90, v106
v_dot2c_f32_bf16 v77, s91, v106
v_dot2c_f32_bf16 v78, s90, v107
v_dot2c_f32_bf16 v79, s91, v107
s_waitcnt vmcnt(17)
v_dot2c_f32_bf16 v72, s90, v108
v_dot2c_f32_bf16 v73, s91, v108
v_dot2c_f32_bf16 v74, s90, v109
v_dot2c_f32_bf16 v75, s91, v109
v_dot2c_f32_bf16 v76, s90, v110
v_dot2c_f32_bf16 v77, s91, v110
v_dot2c_f32_bf16 v78, s90, v111
v_dot2c_f32_bf16 v79, s91, v111
s_waitcnt vmcnt(16)
v_dot2c_f32_bf16 v72, s90, v112
v_dot2c_f32_bf16 v73, s91, v112
v_dot2c_f32_bf16 v74, s90, v113
v_dot2c_f32_bf16 v75, s91, v113
v_dot2c_f32_bf16 v76, s90, v114
v_dot2c_f32_bf16 v77, s91, v114
v_dot2c_f32_bf16 v78, s90, v115
v_dot2c_f32_bf16 v79, s91, v115
s_waitcnt vmcnt(15)
v_dot2c_f32_bf16 v72, s90, v116
v_dot2c_f32_bf16 v73, s91, v116
v_dot2c_f32_bf16 v74, s90, v117
v_dot2c_f32_bf16 v75, s91, v117
v_dot2c_f32_bf16 v76, s90, v118
v_dot2c_f32_bf16 v77, s91, v118
v_dot2c_f32_bf16 v78, s90, v119
v_dot2c_f32_bf16 v79, s91, v119
buffer_load_dword v230, v229, s[20:23], s95 offen sc0 sc1
s_waitcnt vmcnt(5)
v_dot2c_f32_bf16 v136, s90, v120
v_dot2c_f32_bf16 v137, s91, v120
v_dot2c_f32_bf16 v138, s90, v121
v_dot2c_f32_bf16 v139, s91, v121
v_dot2c_f32_bf16 v140, s90, v122
v_dot2c_f32_bf16 v141, s91, v122
v_dot2c_f32_bf16 v142, s90, v123
v_dot2c_f32_bf16 v143, s91, v123
s_waitcnt vmcnt(4)
v_dot2c_f32_bf16 v136, s90, v124
v_dot2c_f32_bf16 v137, s91, v124
v_dot2c_f32_bf16 v138, s90, v125
v_dot2c_f32_bf16 v139, s91, v125
v_dot2c_f32_bf16 v140, s90, v126
v_dot2c_f32_bf16 v141, s91, v126
v_dot2c_f32_bf16 v142, s90, v127
v_dot2c_f32_bf16 v143, s91, v127
s_waitcnt vmcnt(3)
v_dot2c_f32_bf16 v136, s90, v128
v_dot2c_f32_bf16 v137, s91, v128
v_dot2c_f32_bf16 v138, s90, v129
v_dot2c_f32_bf16 v139, s91, v129
v_dot2c_f32_bf16 v140, s90, v130
v_dot2c_f32_bf16 v141, s91, v130
v_dot2c_f32_bf16 v142, s90, v131
v_dot2c_f32_bf16 v143, s91, v131
s_waitcnt vmcnt(2)
v_dot2c_f32_bf16 v136, s90, v132
v_dot2c_f32_bf16 v137, s91, v132
v_dot2c_f32_bf16 v138, s90, v133
v_dot2c_f32_bf16 v139, s91, v133
v_dot2c_f32_bf16 v140, s90, v134
v_dot2c_f32_bf16 v141, s91, v134
v_dot2c_f32_bf16 v142, s90, v135
v_dot2c_f32_bf16 v143, s91, v135
s_waitcnt vmcnt(0)
v_cmp_gt_u32 vcc, 2, v230
s_nop 0
s_and_b32 s29, vcc_lo, s50
s_cbranch_scc0 SP_P2A_RET
SP_P2A:
s_sleep 0
s_add_u32 s100, s100, 1
s_bitcmp1_b32 s100, 19
s_cbranch_scc1 K_END
buffer_load_dword v230, v229, s[20:23], s95 offen sc0 sc1
s_waitcnt vmcnt(0)
v_cmp_gt_u32 vcc, 2, v230
s_nop 0
s_and_b32 s29, vcc_lo, s50
s_cbranch_scc1 SP_P2A
SP_P2A_RET:
buffer_load_dwordx4 v[168:171], v244, s[20:23], s65 offen sc0 sc1
buffer_load_dwordx4 v[172:175], v244, s[20:23], s66 offen sc0 sc1
buffer_load_dwordx4 v[176:179], v244, s[20:23], s67 offen sc0 sc1
buffer_load_dwordx4 v[180:183], v243, s[20:23], s65 offen sc0 sc1
buffer_load_dwordx4 v[184:187], v243, s[20:23], s66 offen sc0 sc1
buffer_load_dwordx4 v[188:191], v243, s[20:23], s67 offen sc0 sc1
s_waitcnt vmcnt(21)
v_dot2c_f32_bf16 v66, s90, v200
v_dot2c_f32_bf16 v67, s91, v200
v_dot2c_f32_bf16 v68, s90, v201
v_dot2c_f32_bf16 v69, s91, v201
s_waitcnt vmcnt(19)
v_dot2c_f32_bf16 v66, s90, v202
v_dot2c_f32_bf16 v67, s91, v202
v_dot2c_f32_bf16 v68, s90, v203
v_dot2c_f32_bf16 v69, s91, v203
s_waitcnt vmcnt(18)
v_dot2c_f32_bf16 v66, s90, v204
v_dot2c_f32_bf16 v67, s91, v204
v_dot2c_f32_bf16 v68, s90, v205
v_dot2c_f32_bf16 v69, s91, v205
s_waitcnt vmcnt(17)
v_dot2c_f32_bf16 v66, s90, v206
v_dot2c_f32_bf16 v67, s91, v206
v_dot2c_f32_bf16 v68, s90, v207
v_dot2c_f32_bf16 v69, s91, v207
s_waitcnt vmcnt(16)
v_dot2c_f32_bf16 v66, s90, v208
v_dot2c_f32_bf16 v67, s91, v208
v_dot2c_f32_bf16 v68, s90, v209
v_dot2c_f32_bf16 v69, s91, v209
s_waitcnt vmcnt(15)
v_dot2c_f32_bf16 v66, s90, v210
v_dot2c_f32_bf16 v67, s91, v210
v_dot2c_f32_bf16 v68, s90, v211
v_dot2c_f32_bf16 v69, s91, v211
s_waitcnt vmcnt(13)
v_dot2c_f32_bf16 v66, s90, v212
v_dot2c_f32_bf16 v67, s91, v212
v_dot2c_f32_bf16 v68, s90, v213
v_dot2c_f32_bf16 v69, s91, v213
s_waitcnt vmcnt(12)
v_dot2c_f32_bf16 v66, s90, v214
v_dot2c_f32_bf16 v67, s91, v214
v_dot2c_f32_bf16 v68, s90, v215
v_dot2c_f32_bf16 v69, s91, v215
s_cmp_eq_u32 s34, 0
s_cselect_b32 s29, 0, 0x7fbffff0
s_nop 2
v_cvt_pk_bf16_f32 v58, v66, v67
v_cvt_pk_bf16_f32 v59, v68, v69
v_lshlrev_b32 v66, 16, v58
v_and_b32 v67, 0xffff0000, v58
v_lshlrev_b32 v68, 16, v59
v_and_b32 v69, 0xffff0000, v59
v_pk_mul_f32 v[66:67], v[66:67], v[54:55]
v_pk_mul_f32 v[68:69], v[68:69], v[56:57]
v_cvt_pk_bf16_f32 v58, v66, v67
v_cvt_pk_bf16_f32 v59, v68, v69
v_lshlrev_b32 v66, 16, v58
v_and_b32 v67, 0xffff0000, v58
v_lshlrev_b32 v68, 16, v59
v_and_b32 v69, 0xffff0000, v59
v_pk_add_f32 v[66:67], v[66:67], v[34:35]
v_pk_add_f32 v[68:69], v[68:69], v[36:37]
v_cvt_pk_bf16_f32 v66, v66, v67
v_cvt_pk_bf16_f32 v67, v68, v69
buffer_store_dwordx2 v[66:67], v249, s[60:63], s29 offen
s_waitcnt vmcnt(6)
v_dot2c_f32_bf16 v72, s90, v168
v_dot2c_f32_bf16 v73, s91, v168
v_dot2c_f32_bf16 v74, s90, v169
v_dot2c_f32_bf16 v75, s91, v169
v_dot2c_f32_bf16 v76, s90, v170
v_dot2c_f32_bf16 v77, s91, v170
v_dot2c_f32_bf16 v78, s90, v171
v_dot2c_f32_bf16 v79, s91, v171
s_waitcnt vmcnt(5)
v_dot2c_f32_bf16 v72, s90, v172
v_dot2c_f32_bf16 v73, s91, v172
v_dot2c_f32_bf16 v74, s90, v173
v_dot2c_f32_bf16 v75, s91, v173
v_dot2c_f32_bf16 v76, s90, v174
v_dot2c_f32_bf16 v77, s91, v174
v_dot2c_f32_bf16 v78, s90, v175
v_dot2c_f32_bf16 v79, s91, v175
s_waitcnt vmcnt(4)
v_dot2c_f32_bf16 v72, s90, v176
v_dot2c_f32_bf16 v73, s91, v176
v_dot2c_f32_bf16 v74, s90, v177
v_dot2c_f32_bf16 v75, s91, v177
v_dot2c_f32_bf16 v76, s90, v178
v_dot2c_f32_bf16 v77, s91, v178
v_dot2c_f32_bf16 v78, s90, v179
v_dot2c_f32_bf16 v79, s91, v179
s_nop 2
v_cvt_pk_bf16_f32 v58, v72, v73
v_cvt_pk_bf16_f32 v59, v74, v75
v_cvt_pk_bf16_f32 v60, v76, v77
v_cvt_pk_bf16_f32 v61, v78, v79
v_lshlrev_b32 v72, 16, v58
v_and_b32 v73, 0xffff0000, v58
v_lshlrev_b32 v74, 16, v59
v_and_b32 v75, 0xffff0000, v59
v_lshlrev_b32 v76, 16, v60
v_and_b32 v77, 0xffff0000, v60
v_lshlrev_b32 v78, 16, v61
v_and_b32 v79, 0xffff0000, v61
v_pk_mul_f32 v[72:73], v[72:73], v[38:39]
v_pk_mul_f32 v[74:75], v[74:75], v[40:41]
v_pk_mul_f32 v[76:77], v[76:77], v[42:43]
v_pk_mul_f32 v[78:79], v[78:79], v[44:45]
v_cvt_pk_bf16_f32 v58, v72, v73
v_cvt_pk_bf16_f32 v59, v74, v75
v_cvt_pk_bf16_f32 v60, v76, v77
v_cvt_pk_bf16_f32 v61, v78, v79
v_lshlrev_b32 v72, 16, v58
v_and_b32 v73, 0xffff0000, v58
v_lshlrev_b32 v74, 16, v59
v_and_b32 v75, 0xffff0000, v59
v_lshlrev_b32 v76, 16, v60
v_and_b32 v77, 0xffff0000, v60
v_lshlrev_b32 v78, 16, v61
v_and_b32 v79, 0xffff0000, v61
v_pk_add_f32 v[72:73], v[72:73], v[18:19]
v_pk_add_f32 v[74:75], v[74:75], v[20:21]
v_pk_add_f32 v[76:77], v[76:77], v[22:23]
v_pk_add_f32 v[78:79], v[78:79], v[24:25]
v_cvt_pk_bf16_f32 v72, v72, v73
v_cvt_pk_bf16_f32 v73, v74, v75
v_cvt_pk_bf16_f32 v74, v76, v77
v_cvt_pk_bf16_f32 v75, v78, v79
buffer_store_dwordx4 v[72:75], v248, s[60:63], 0 offen
s_waitcnt vmcnt(4)
v_dot2c_f32_bf16 v136, s90, v180
v_dot2c_f32_bf16 v137, s91, v180
v_dot2c_f32_bf16 v138, s90, v181
v_dot2c_f32_bf16 v139, s91, v181
v_dot2c_f32_bf16 v140, s90, v182
v_dot2c_f32_bf16 v141, s91, v182
v_dot2c_f32_bf16 v142, s90, v183
v_dot2c_f32_bf16 v143, s91, v183
s_waitcnt vmcnt(3)
v_dot2c_f32_bf16 v136, s90, v184
v_dot2c_f32_bf16 v137, s91, v184
v_dot2c_f32_bf16 v138, s90, v185
v_dot2c_f32_bf16 v139, s91, v185
v_dot2c_f32_bf16 v140, s90, v186
v_dot2c_f32_bf16 v141, s91, v186
v_dot2c_f32_bf16 v142, s90, v187
v_dot2c_f32_bf16 v143, s91, v187
s_waitcnt vmcnt(2)
v_dot2c_f32_bf16 v136, s90, v188
v_dot2c_f32_bf16 v137, s91, v188
v_dot2c_f32_bf16 v138, s90, v189
v_dot2c_f32_bf16 v139, s91, v189
v_dot2c_f32_bf16 v140, s90, v190
v_dot2c_f32_bf16 v141, s91, v190
v_dot2c_f32_bf16 v142, s90, v191
v_dot2c_f32_bf16 v143, s91, v191
s_nop 2
v_cvt_pk_bf16_f32 v58, v136, v137
v_cvt_pk_bf16_f32 v59, v138, v139
v_cvt_pk_bf16_f32 v60, v140, v141
v_cvt_pk_bf16_f32 v61, v142, v143
v_lshlrev_b32 v136, 16, v58
v_and_b32 v137, 0xffff0000, v58
v_lshlrev_b32 v138, 16, v59
v_and_b32 v139, 0xffff0000, v59
v_lshlrev_b32 v140, 16, v60
v_and_b32 v141, 0xffff0000, v60
v_lshlrev_b32 v142, 16, v61
v_and_b32 v143, 0xffff0000, v61
v_pk_mul_f32 v[136:137], v[136:137], v[46:47]
v_pk_mul_f32 v[138:139], v[138:139], v[48:49]
v_pk_mul_f32 v[140:141], v[140:141], v[50:51]
v_pk_mul_f32 v[142:143], v[142:143], v[52:53]
v_cvt_pk_bf16_f32 v58, v136, v137
v_cvt_pk_bf16_f32 v59, v138, v139
v_cvt_pk_bf16_f32 v60, v140, v141
v_cvt_pk_bf16_f32 v61, v142, v143
v_lshlrev_b32 v136, 16, v58
v_and_b32 v137, 0xffff0000, v58
v_lshlrev_b32 v138, 16, v59
v_and_b32 v139, 0xffff0000, v59
v_lshlrev_b32 v140, 16, v60
v_and_b32 v141, 0xffff0000, v60
v_lshlrev_b32 v142, 16, v61
v_and_b32 v143, 0xffff0000, v61
v_pk_add_f32 v[136:137], v[136:137], v[26:27]
v_pk_add_f32 v[138:139], v[138:139], v[28:29]
v_pk_add_f32 v[140:141], v[140:141], v[30:31]
v_pk_add_f32 v[142:143], v[142:143], v[32:33]
v_cvt_pk_bf16_f32 v136, v136, v137
v_cvt_pk_bf16_f32 v137, v138, v139
v_cvt_pk_bf16_f32 v138, v140, v141
v_cvt_pk_bf16_f32 v139, v142, v143
buffer_store_dwordx4 v[136:139], v248, s[60:63], 0 offen offset:128
K_END:
s_endpgm
K_EVT:
STUB_17:
s_cbranch_execz HOP_RET2
s_sub_u32 s3, s33, 1
s_cmp_eq_u32 s33, 5
s_cbranch_scc0 EV_Y
s_sub_u32 s28, s40, 0
s_cmp_lt_u32 s28, 72
s_cselect_b32 s3, 4, 0
s_cmp_eq_u32 s37, 0
s_cbranch_scc0 K_EVT_RET
s_mov_b32 s28, 0x243000
EV_INC:
v_mov_b32 v246, 0
v_mov_b32 v247, 1
s_mov_b64 exec, 1
buffer_atomic_add v247, v246, s[20:23], s28 offen sc1
s_mov_b64 exec, -1
s_branch K_EVT_RET
EV_Y:
s_cmp_eq_u32 s33, 4
s_cbranch_scc0 EV_Y4
v_mov_b32 v246, 0
s_mov_b32 s28, 0x243000
buffer_load_dword v247, v246, s[20:23], s28 offen sc0 sc1
s_branch K_EVT_RET
EV_Y4:
s_cmp_eq_u32 s33, 1
s_cbranch_scc0 EV_Y5
s_mov_b32 s28, 0x243080
s_bitcmp0_b32 s37, 0
s_cbranch_scc1 EV_INC
s_branch K_EVT_RET
EV_Y5:
s_sub_u32 s29, s40, 0
s_lshr_b32 s28, s37, 1
s_lshl1_add_u32 s29, s29, s28
s_cmp_eq_u32 s33, 3
s_cbranch_scc0 EV_Y3
v_readfirstlane_b32 s28, v247
s_cmp_ge_u32 s28, 144
s_cbranch_scc0 EV_Y4SP
EV_Y4OK:
v_lshrrev_b32 v246, 3, v1
v_mul_u32_u24 v246, 18432, v246
v_and_b32 v247, 7, v1
v_lshl_add_u32 v246, v247, 4, v246
s_lshl_b32 s28, s29, 7
s_and_b32 s29, s37, 1
s_mul_i32 s29, s29, 1327104
s_add_u32 s28, s28, s29
s_add_u32 s28, s28, 0x2000000
buffer_load_dwordx4 v[104:107], v246, s[20:23], s28 offen sc0 sc1
s_add_u32 s28, s28, 147456
buffer_load_dwordx4 v[108:111], v246, s[20:23], s28 offen sc0 sc1
s_add_u32 s28, s28, 147456
buffer_load_dwordx4 v[112:115], v246, s[20:23], s28 offen sc0 sc1
s_add_u32 s28, s28, 147456
buffer_load_dwordx4 v[116:119], v246, s[20:23], s28 offen sc0 sc1
s_add_u32 s28, s28, 147456
buffer_load_dwordx4 v[120:123], v246, s[20:23], s28 offen sc0 sc1
s_add_u32 s28, s28, 147456
buffer_load_dwordx4 v[124:127], v246, s[20:23], s28 offen sc0 sc1
s_add_u32 s28, s28, 147456
buffer_load_dwordx4 v[128:131], v246, s[20:23], s28 offen sc0 sc1
s_add_u32 s28, s28, 147456
buffer_load_dwordx4 v[132:135], v246, s[20:23], s28 offen sc0 sc1
s_add_u32 s28, s28, 147456
buffer_load_dwordx4 v[248:251], v246, s[20:23], s28 offen sc0 sc1
s_branch K_EVT_RET
EV_Y3:
STUB_18:
s_cbranch_execz HOP_RET2
v_pk_add_f32 v[104:105], v[104:105], v[108:109]
v_pk_add_f32 v[106:107], v[106:107], v[110:111]
v_pk_add_f32 v[112:113], v[112:113], v[116:117]
v_pk_add_f32 v[114:115], v[114:115], v[118:119]
v_pk_add_f32 v[120:121], v[120:121], v[124:125]
v_pk_add_f32 v[122:123], v[122:123], v[126:127]
v_pk_add_f32 v[128:129], v[128:129], v[132:133]
v_pk_add_f32 v[130:131], v[130:131], v[134:135]
v_pk_add_f32 v[104:105], v[104:105], v[112:113]
v_pk_add_f32 v[106:107], v[106:107], v[114:115]
v_pk_add_f32 v[120:121], v[120:121], v[128:129]
v_pk_add_f32 v[122:123], v[122:123], v[130:131]
v_pk_add_f32 v[104:105], v[104:105], v[248:249]
v_pk_add_f32 v[106:107], v[106:107], v[250:251]
v_pk_add_f32 v[104:105], v[104:105], v[120:121]
v_pk_add_f32 v[106:107], v[106:107], v[122:123]
v_and_b32 v246, 7, v1
s_lshr_b32 s28, s37, 1
s_lshl_b32 s28, s28, 7
v_add_f32_dpp v108, v104, v104 row_ror:8 row_mask:0xf bank_mask:0xf
v_add_f32_dpp v109, v105, v105 row_ror:8 row_mask:0xf bank_mask:0xf
v_add_f32_dpp v110, v106, v106 row_ror:8 row_mask:0xf bank_mask:0xf
v_add_f32_dpp v111, v107, v107 row_ror:8 row_mask:0xf bank_mask:0xf
v_mov_b32 v104, v108
v_mov_b32 v105, v109
v_mov_b32 v106, v110
v_mov_b32 v107, v111
v_permlane16_swap_b32 v104, v108
v_permlane16_swap_b32 v105, v109
v_permlane16_swap_b32 v106, v110
v_permlane16_swap_b32 v107, v111
v_add_f32 v108, v104, v108
v_add_f32 v109, v105, v109
v_add_f32 v110, v106, v110
v_add_f32 v111, v107, v111
v_mov_b32 v104, v108
v_mov_b32 v105, v109
v_mov_b32 v106, v110
v_mov_b32 v107, v111
v_permlane32_swap_b32 v104, v108
v_permlane32_swap_b32 v105, v109
v_permlane32_swap_b32 v106, v110
v_permlane32_swap_b32 v107, v111
v_add_f32 v108, v104, v108
v_add_f32 v109, v105, v109
v_add_f32 v110, v106, v110
v_add_f32 v111, v107, v111
v_lshlrev_b32 v247, 4, v246
v_add_u32 v247, s28, v247
s_bitcmp1_b32 s37, 0
s_cbranch_scc0 EV_YE
ds_write_b128 v247, v[108:111] offset:65024
s_waitcnt lgkmcnt(0)
s_barrier
s_branch K_EVT_RET
EV_YE:
s_barrier
ds_read_b128 v[104:107], v247 offset:65024
v_mul_u32_u24 v246, 0x480, v246
s_lshl_b32 s28, s29, 3
s_add_u32 s28, s28, 0x244000
s_waitcnt lgkmcnt(0)
v_pk_add_f32 v[104:105], v[104:105], v[108:109]
v_pk_add_f32 v[106:107], v[106:107], v[110:111]
v_cvt_pk_bf16_f32 v108, v104, v105
v_cvt_pk_bf16_f32 v109, v106, v107
v_lshlrev_b32 v104, 16, v108
v_and_b32 v105, 0xffff0000, v108
v_lshlrev_b32 v106, 16, v109
v_and_b32 v107, 0xffff0000, v109
v_mul_f32 v104, v104, v236
v_mul_f32 v105, v105, v236
v_mul_f32 v106, v106, v236
v_mul_f32 v107, v107, v236
v_cvt_pk_bf16_f32 v108, v104, v105
v_cvt_pk_bf16_f32 v109, v106, v107
s_mov_b64 exec, 0xff
buffer_store_dwordx2 v[108:109], v246, s[20:23], s28 offen sc0 sc1
s_mov_b64 exec, -1
s_branch K_EVT_RET
SP_X0:
s_sleep 2
s_add_u32 s100, s100, 1
s_bitcmp1_b32 s100, 19
s_cbranch_scc1 K_END
buffer_load_dword v193, v192, s[24:27], 0 offen sc0 sc1
s_waitcnt vmcnt(0)
v_readfirstlane_b32 s92, v193
s_and_b32 s93, s92, 0xf0
s_cbranch_scc0 SP_X0
s_branch SP_X0_RET
SP_CAND:
s_sleep 2
s_add_u32 s100, s100, 1
s_bitcmp1_b32 s100, 19
s_cbranch_scc1 K_END
s_mov_b32 s29, 0x242000
buffer_load_dwordx2 v[248:249], v250, s[20:23], s29 offen sc0 sc1
s_waitcnt vmcnt(0)
v_cmp_ne_u32 vcc, s47, v249
s_cbranch_vccnz SP_CAND
s_branch SP_CAND_RET
SP_FL:
s_sleep 2
s_add_u32 s100, s100, 1
s_bitcmp1_b32 s100, 19
s_cbranch_scc1 K_END
buffer_load_dword v253, v246, s[24:27], 0 offen sc0 sc1
s_waitcnt vmcnt(0)
v_and_b32 v253, 0x20202020, v253
v_cmp_ne_u32 vcc, 0x20202020, v253
s_cbranch_vccnz SP_FL
s_branch SP_FL_RET
SP_FK:
s_sleep 4
s_add_u32 s100, s100, 1
s_bitcmp1_b32 s100, 19
s_cbranch_scc1 K_END
s_mov_b32 s93, 0x242800
buffer_load_dwordx2 v[104:105], v106, s[20:23], s93 offen sc0 sc1
s_waitcnt vmcnt(0)
v_cmp_ne_u32 vcc, s47, v105
s_cbranch_vccnz SP_FK
s_branch SP_FK_RET
SP_Y:
s_sleep 4
s_add_u32 s100, s100, 1
s_bitcmp1_b32 s100, 19
s_cbranch_scc1 K_END
s_mov_b32 s93, 0x243080
buffer_load_dword v246, v254, s[20:23], s93 offen sc0 sc1
s_waitcnt vmcnt(0)
v_readfirstlane_b32 s93, v246
s_cmp_lt_u32 s93, 144
s_cbranch_scc1 SP_Y
s_branch SP_Y_RET
SP_O1A:
s_sleep 1
s_add_u32 s100, s100, 1
s_bitcmp1_b32 s100, 19
s_cbranch_scc1 K_END
buffer_load_dword v230, v229, s[20:23], s94 offen sc0 sc1
s_waitcnt vmcnt(0)
v_cmp_gt_u32 vcc, 1, v230
s_bitcmp1_b32 vcc_lo, s39
s_cbranch_scc1 SP_O1A
s_branch SP_O1A_RET
SP_O2A:
s_sleep 1
s_add_u32 s100, s100, 1
s_bitcmp1_b32 s100, 19
s_cbranch_scc1 K_END
buffer_load_dword v230, v229, s[20:23], s94 offen sc0 sc1
s_waitcnt vmcnt(0)
v_cmp_gt_u32 vcc, 1, v230
s_and_b32 s29, vcc_lo, 15
s_cbranch_scc1 SP_O2A
s_branch SP_O2A_RET
SP_O3A:
s_sleep 1
s_add_u32 s100, s100, 1
s_bitcmp1_b32 s100, 19
s_cbranch_scc1 K_END
buffer_load_dword v230, v229, s[20:23], s94 offen sc0 sc1
s_waitcnt vmcnt(0)
v_cmp_gt_u32 vcc, 2, v230
s_and_b32 s29, vcc_lo, 15
s_cbranch_scc1 SP_O3A
s_branch SP_O3A_RET
SP_P1A:
s_sleep 1
s_add_u32 s100, s100, 1
s_bitcmp1_b32 s100, 19
s_cbranch_scc1 K_END
buffer_load_dword v230, v229, s[20:23], s95 offen sc0 sc1
s_waitcnt vmcnt(0)
v_cmp_gt_u32 vcc, 1, v230
s_and_b32 s29, vcc_lo, 0xff
s_cbranch_scc1 SP_P1A
s_branch SP_P1A_RET
EV_Y4SP:
s_sleep 8
s_add_u32 s100, s100, 1
s_bitcmp1_b32 s100, 19
s_cbranch_scc1 K_END
v_mov_b32 v246, 0
s_mov_b32 s28, 0x243000
buffer_load_dword v247, v246, s[20:23], s28 offen sc0 sc1
s_waitcnt vmcnt(0)
v_readfirstlane_b32 s28, v247
s_cmp_ge_u32 s28, 144
s_cbranch_scc0 EV_Y4SP
s_branch EV_Y4OK
K_HOT_END:
K_MIXED:
s_waitcnt lgkmcnt(0)
s_barrier
s_add_u32 s28, s30, 147456
v_smfmac_f32_16x16x64_bf16 a[128:131], a[208:211], v[88:95], v245
v_lshrrev_b32 v132, 1, v1
v_and_b32 v132, 8, v132
v_smfmac_f32_16x16x64_bf16 a[132:135], a[208:211], v[96:103], v245
v_xor_b32 v132, v132, v1
v_lshlrev_b32 v132, 4, v132
v_mfma_f32_16x16x32_bf16 a[0:3], v[88:91], a[176:179], a[0:3]
v_add_u32 v132, s28, v132
v_lshlrev_b32 v133, 3, v1
v_mfma_f32_16x16x32_bf16 a[16:19], v[88:91], a[180:183], a[16:19]
v_and_b32 v133, 8, v133
v_lshrrev_b32 v134, 2, v1
v_mfma_f32_16x16x32_bf16 a[32:35], v[88:91], a[184:187], a[32:35]
v_xor_b32 v133, v133, v134
v_and_b32 v134, 3, v1
v_mfma_f32_16x16x32_bf16 a[48:51], v[88:91], a[188:191], a[48:51]
v_lshl_add_u32 v133, v134, 4, v133
v_lshlrev_b32 v133, 4, v133
v_mfma_f32_16x16x32_bf16 a[64:67], v[88:91], a[192:195], a[64:67]
v_add_u32 v133, s28, v133
v_lshlrev_b32 v134, 2, v1
v_mfma_f32_16x16x32_bf16 a[80:83], v[88:91], a[196:199], a[80:83]
v_add_u32 v134, s28, v134
v_lshlrev_b32 v135, 4, v4
v_mfma_f32_16x16x32_bf16 a[96:99], v[88:91], a[200:203], a[96:99]
v_add_u32 v135, s28, v135
v_mfma_f32_16x16x32_bf16 a[112:115], v[88:91], a[204:207], a[112:115]
v_mfma_f32_16x16x32_bf16 a[4:7], v[92:95], a[176:179], a[4:7]
v_accvgpr_read_b32 v120, a128
v_accvgpr_read_b32 v124, a129
v_accvgpr_read_b32 v121, a130
v_mfma_f32_16x16x32_bf16 a[20:23], v[92:95], a[180:183], a[20:23]
v_accvgpr_read_b32 v125, a131
v_accvgpr_read_b32 v122, a132
v_accvgpr_read_b32 v126, a133
v_mfma_f32_16x16x32_bf16 a[36:39], v[92:95], a[184:187], a[36:39]
v_accvgpr_read_b32 v123, a134
v_accvgpr_read_b32 v127, a135
v_add_f32 v120, v120, v124
v_mfma_f32_16x16x32_bf16 a[52:55], v[92:95], a[188:191], a[52:55]
v_add_f32 v121, v121, v125
v_add_f32 v122, v122, v126
v_add_f32 v123, v123, v127
v_mfma_f32_16x16x32_bf16 a[68:71], v[92:95], a[192:195], a[68:71]
v_rcp_f32 v124, v120
v_rcp_f32 v125, v121
v_rcp_f32 v126, v122
v_mfma_f32_16x16x32_bf16 a[84:87], v[92:95], a[196:199], a[84:87]
v_rcp_f32 v127, v123
ds_write_b32 v134, v124 offset:0
ds_write_b32 v134, v125 offset:256
v_mfma_f32_16x16x32_bf16 a[100:103], v[92:95], a[200:203], a[100:103]
ds_write_b32 v134, v126 offset:512
ds_write_b32 v134, v127 offset:768
ds_read_b128 v[72:75], v135 offset:0
v_mfma_f32_16x16x32_bf16 a[116:119], v[92:95], a[204:207], a[116:119]
ds_read_b128 v[76:79], v135 offset:256
ds_read_b128 v[80:83], v135 offset:512
ds_read_b128 v[84:87], v135 offset:768
s_add_u32 s92, s44, 4096
s_add_u32 s93, s44, 8192
s_add_u32 s51, s44, 12288
v_mfma_f32_16x16x32_bf16 a[8:11], v[96:99], a[176:179], a[8:11]
v_accvgpr_read_b32 v104, a0
v_accvgpr_read_b32 v105, a1
v_accvgpr_read_b32 v106, a2
v_accvgpr_read_b32 v107, a3
v_mfma_f32_16x16x32_bf16 a[24:27], v[96:99], a[180:183], a[24:27]
v_accvgpr_read_b32 v108, a16
v_accvgpr_read_b32 v109, a17
v_accvgpr_read_b32 v110, a18
v_accvgpr_read_b32 v111, a19
s_waitcnt lgkmcnt(0)
v_pk_mul_f32 v[104:105], v[104:105], v[72:73]
v_pk_mul_f32 v[106:107], v[106:107], v[74:75]
v_pk_mul_f32 v[108:109], v[108:109], v[72:73]
v_pk_mul_f32 v[110:111], v[110:111], v[74:75]
v_cvt_pk_bf16_f32 v104, v104, v105
v_cvt_pk_bf16_f32 v105, v106, v107
v_cvt_pk_bf16_f32 v106, v108, v109
v_cvt_pk_bf16_f32 v107, v110, v111
v_mfma_f32_16x16x32_bf16 a[40:43], v[96:99], a[184:187], a[40:43]
v_accvgpr_read_b32 v112, a32
v_accvgpr_read_b32 v113, a33
v_accvgpr_read_b32 v114, a34
v_accvgpr_read_b32 v115, a35
ds_write_b128 v132, v[104:107] offset:0
v_mfma_f32_16x16x32_bf16 a[56:59], v[96:99], a[188:191], a[56:59]
v_accvgpr_read_b32 v116, a48
v_accvgpr_read_b32 v117, a49
v_accvgpr_read_b32 v118, a50
v_accvgpr_read_b32 v119, a51
ds_read_b64_tr_b16 v[8:9], v133 offset:0
ds_read_b64_tr_b16 v[10:11], v133 offset:8
v_pk_mul_f32 v[112:113], v[112:113], v[72:73]
v_pk_mul_f32 v[114:115], v[114:115], v[74:75]
v_pk_mul_f32 v[116:117], v[116:117], v[72:73]
v_pk_mul_f32 v[118:119], v[118:119], v[74:75]
v_cvt_pk_bf16_f32 v112, v112, v113
v_cvt_pk_bf16_f32 v113, v114, v115
v_cvt_pk_bf16_f32 v114, v116, v117
v_cvt_pk_bf16_f32 v115, v118, v119
v_mfma_f32_16x16x32_bf16 a[72:75], v[96:99], a[192:195], a[72:75]
v_accvgpr_read_b32 v104, a64
v_accvgpr_read_b32 v105, a65
v_accvgpr_read_b32 v106, a66
v_accvgpr_read_b32 v107, a67
ds_write_b128 v132, v[112:115] offset:1024
v_mfma_f32_16x16x32_bf16 a[88:91], v[96:99], a[196:199], a[88:91]
v_accvgpr_read_b32 v108, a80
v_accvgpr_read_b32 v109, a81
v_accvgpr_read_b32 v110, a82
v_accvgpr_read_b32 v111, a83
ds_read_b64_tr_b16 v[12:13], v133 offset:1024
ds_read_b64_tr_b16 v[14:15], v133 offset:1032
v_pk_mul_f32 v[104:105], v[104:105], v[72:73]
v_pk_mul_f32 v[106:107], v[106:107], v[74:75]
v_pk_mul_f32 v[108:109], v[108:109], v[72:73]
v_pk_mul_f32 v[110:111], v[110:111], v[74:75]
s_waitcnt lgkmcnt(3)
buffer_store_dwordx4 v[8:11], v244, s[20:23], s44 offen offset:0 sc0 sc1
v_cvt_pk_bf16_f32 v104, v104, v105
v_cvt_pk_bf16_f32 v105, v106, v107
v_cvt_pk_bf16_f32 v106, v108, v109
v_cvt_pk_bf16_f32 v107, v110, v111
v_mfma_f32_16x16x32_bf16 a[104:107], v[96:99], a[200:203], a[104:107]
v_accvgpr_read_b32 v112, a96
v_accvgpr_read_b32 v113, a97
v_accvgpr_read_b32 v114, a98
v_accvgpr_read_b32 v115, a99
ds_write_b128 v132, v[104:107] offset:2048
v_mfma_f32_16x16x32_bf16 a[120:123], v[96:99], a[204:207], a[120:123]
v_accvgpr_read_b32 v116, a112
v_accvgpr_read_b32 v117, a113
v_accvgpr_read_b32 v118, a114
v_accvgpr_read_b32 v119, a115
ds_read_b64_tr_b16 v[16:17], v133 offset:2048
ds_read_b64_tr_b16 v[18:19], v133 offset:2056
v_pk_mul_f32 v[112:113], v[112:113], v[72:73]
v_pk_mul_f32 v[114:115], v[114:115], v[74:75]
v_pk_mul_f32 v[116:117], v[116:117], v[72:73]
v_pk_mul_f32 v[118:119], v[118:119], v[74:75]
s_waitcnt lgkmcnt(3)
buffer_store_dwordx4 v[12:15], v244, s[20:23], s44 offen offset:1024 sc0 sc1
v_cvt_pk_bf16_f32 v112, v112, v113
v_cvt_pk_bf16_f32 v113, v114, v115
v_cvt_pk_bf16_f32 v114, v116, v117
v_cvt_pk_bf16_f32 v115, v118, v119
v_mfma_f32_16x16x32_bf16 a[12:15], v[100:103], a[176:179], a[12:15]
v_accvgpr_read_b32 v104, a4
v_accvgpr_read_b32 v105, a5
v_accvgpr_read_b32 v106, a6
v_accvgpr_read_b32 v107, a7
ds_write_b128 v132, v[112:115] offset:3072
v_mfma_f32_16x16x32_bf16 a[28:31], v[100:103], a[180:183], a[28:31]
v_accvgpr_read_b32 v108, a20
v_accvgpr_read_b32 v109, a21
v_accvgpr_read_b32 v110, a22
v_accvgpr_read_b32 v111, a23
ds_read_b64_tr_b16 v[20:21], v133 offset:3072
ds_read_b64_tr_b16 v[22:23], v133 offset:3080
v_pk_mul_f32 v[104:105], v[104:105], v[76:77]
v_pk_mul_f32 v[106:107], v[106:107], v[78:79]
v_pk_mul_f32 v[108:109], v[108:109], v[76:77]
v_pk_mul_f32 v[110:111], v[110:111], v[78:79]
s_waitcnt lgkmcnt(3)
buffer_store_dwordx4 v[16:19], v244, s[20:23], s44 offen offset:2048 sc0 sc1
v_cvt_pk_bf16_f32 v104, v104, v105
v_cvt_pk_bf16_f32 v105, v106, v107
v_cvt_pk_bf16_f32 v106, v108, v109
v_cvt_pk_bf16_f32 v107, v110, v111
v_mfma_f32_16x16x32_bf16 a[44:47], v[100:103], a[184:187], a[44:47]
v_accvgpr_read_b32 v112, a36
v_accvgpr_read_b32 v113, a37
v_accvgpr_read_b32 v114, a38
v_accvgpr_read_b32 v115, a39
ds_write_b128 v132, v[104:107] offset:0
v_mfma_f32_16x16x32_bf16 a[60:63], v[100:103], a[188:191], a[60:63]
v_accvgpr_read_b32 v116, a52
v_accvgpr_read_b32 v117, a53
v_accvgpr_read_b32 v118, a54
v_accvgpr_read_b32 v119, a55
ds_read_b64_tr_b16 v[24:25], v133 offset:0
ds_read_b64_tr_b16 v[26:27], v133 offset:8
v_pk_mul_f32 v[112:113], v[112:113], v[76:77]
v_pk_mul_f32 v[114:115], v[114:115], v[78:79]
v_pk_mul_f32 v[116:117], v[116:117], v[76:77]
v_pk_mul_f32 v[118:119], v[118:119], v[78:79]
s_waitcnt lgkmcnt(3)
buffer_store_dwordx4 v[20:23], v244, s[20:23], s44 offen offset:3072 sc0 sc1
v_cvt_pk_bf16_f32 v112, v112, v113
v_cvt_pk_bf16_f32 v113, v114, v115
v_cvt_pk_bf16_f32 v114, v116, v117
v_cvt_pk_bf16_f32 v115, v118, v119
v_mfma_f32_16x16x32_bf16 a[76:79], v[100:103], a[192:195], a[76:79]
v_accvgpr_read_b32 v104, a68
v_accvgpr_read_b32 v105, a69
v_accvgpr_read_b32 v106, a70
v_accvgpr_read_b32 v107, a71
ds_write_b128 v132, v[112:115] offset:1024
v_mfma_f32_16x16x32_bf16 a[92:95], v[100:103], a[196:199], a[92:95]
v_accvgpr_read_b32 v108, a84
v_accvgpr_read_b32 v109, a85
v_accvgpr_read_b32 v110, a86
v_accvgpr_read_b32 v111, a87
ds_read_b64_tr_b16 v[28:29], v133 offset:1024
ds_read_b64_tr_b16 v[30:31], v133 offset:1032
v_pk_mul_f32 v[104:105], v[104:105], v[76:77]
v_pk_mul_f32 v[106:107], v[106:107], v[78:79]
v_pk_mul_f32 v[108:109], v[108:109], v[76:77]
v_pk_mul_f32 v[110:111], v[110:111], v[78:79]
s_waitcnt lgkmcnt(3)
buffer_store_dwordx4 v[24:27], v244, s[20:23], s92 offen offset:0 sc0 sc1
v_cvt_pk_bf16_f32 v104, v104, v105
v_cvt_pk_bf16_f32 v105, v106, v107
v_cvt_pk_bf16_f32 v106, v108, v109
v_cvt_pk_bf16_f32 v107, v110, v111
v_mfma_f32_16x16x32_bf16 a[108:111], v[100:103], a[200:203], a[108:111]
v_accvgpr_read_b32 v112, a100
v_accvgpr_read_b32 v113, a101
v_accvgpr_read_b32 v114, a102
v_accvgpr_read_b32 v115, a103
ds_write_b128 v132, v[104:107] offset:2048
v_mfma_f32_16x16x32_bf16 a[124:127], v[100:103], a[204:207], a[124:127]
v_accvgpr_read_b32 v116, a116
v_accvgpr_read_b32 v117, a117
v_accvgpr_read_b32 v118, a118
v_accvgpr_read_b32 v119, a119
ds_read_b64_tr_b16 v[32:33], v133 offset:2048
ds_read_b64_tr_b16 v[34:35], v133 offset:2056
v_pk_mul_f32 v[112:113], v[112:113], v[76:77]
v_pk_mul_f32 v[114:115], v[114:115], v[78:79]
v_pk_mul_f32 v[116:117], v[116:117], v[76:77]
v_pk_mul_f32 v[118:119], v[118:119], v[78:79]
s_waitcnt lgkmcnt(3)
buffer_store_dwordx4 v[28:31], v244, s[20:23], s92 offen offset:1024 sc0 sc1
v_cvt_pk_bf16_f32 v112, v112, v113
v_cvt_pk_bf16_f32 v113, v114, v115
v_cvt_pk_bf16_f32 v114, v116, v117
v_cvt_pk_bf16_f32 v115, v118, v119
v_accvgpr_read_b32 v104, a8
v_accvgpr_read_b32 v105, a9
v_accvgpr_read_b32 v106, a10
v_accvgpr_read_b32 v107, a11
ds_write_b128 v132, v[112:115] offset:3072
v_accvgpr_read_b32 v108, a24
v_accvgpr_read_b32 v109, a25
v_accvgpr_read_b32 v110, a26
v_accvgpr_read_b32 v111, a27
ds_read_b64_tr_b16 v[36:37], v133 offset:3072
ds_read_b64_tr_b16 v[38:39], v133 offset:3080
v_pk_mul_f32 v[104:105], v[104:105], v[80:81]
v_pk_mul_f32 v[106:107], v[106:107], v[82:83]
v_pk_mul_f32 v[108:109], v[108:109], v[80:81]
v_pk_mul_f32 v[110:111], v[110:111], v[82:83]
s_waitcnt lgkmcnt(3)
buffer_store_dwordx4 v[32:35], v244, s[20:23], s92 offen offset:2048 sc0 sc1
v_cvt_pk_bf16_f32 v104, v104, v105
v_cvt_pk_bf16_f32 v105, v106, v107
v_cvt_pk_bf16_f32 v106, v108, v109
v_cvt_pk_bf16_f32 v107, v110, v111
v_accvgpr_read_b32 v112, a40
v_accvgpr_read_b32 v113, a41
v_accvgpr_read_b32 v114, a42
v_accvgpr_read_b32 v115, a43
ds_write_b128 v132, v[104:107] offset:0
v_accvgpr_read_b32 v116, a56
v_accvgpr_read_b32 v117, a57
v_accvgpr_read_b32 v118, a58
v_accvgpr_read_b32 v119, a59
ds_read_b64_tr_b16 v[40:41], v133 offset:0
ds_read_b64_tr_b16 v[42:43], v133 offset:8
v_pk_mul_f32 v[112:113], v[112:113], v[80:81]
v_pk_mul_f32 v[114:115], v[114:115], v[82:83]
v_pk_mul_f32 v[116:117], v[116:117], v[80:81]
v_pk_mul_f32 v[118:119], v[118:119], v[82:83]
s_waitcnt lgkmcnt(3)
buffer_store_dwordx4 v[36:39], v244, s[20:23], s92 offen offset:3072 sc0 sc1
v_cvt_pk_bf16_f32 v112, v112, v113
v_cvt_pk_bf16_f32 v113, v114, v115
v_cvt_pk_bf16_f32 v114, v116, v117
v_cvt_pk_bf16_f32 v115, v118, v119
v_accvgpr_read_b32 v104, a72
v_accvgpr_read_b32 v105, a73
v_accvgpr_read_b32 v106, a74
v_accvgpr_read_b32 v107, a75
ds_write_b128 v132, v[112:115] offset:1024
v_accvgpr_read_b32 v108, a88
v_accvgpr_read_b32 v109, a89
v_accvgpr_read_b32 v110, a90
v_accvgpr_read_b32 v111, a91
ds_read_b64_tr_b16 v[44:45], v133 offset:1024
ds_read_b64_tr_b16 v[46:47], v133 offset:1032
v_pk_mul_f32 v[104:105], v[104:105], v[80:81]
v_pk_mul_f32 v[106:107], v[106:107], v[82:83]
v_pk_mul_f32 v[108:109], v[108:109], v[80:81]
v_pk_mul_f32 v[110:111], v[110:111], v[82:83]
s_waitcnt lgkmcnt(3)
buffer_store_dwordx4 v[40:43], v244, s[20:23], s93 offen offset:0 sc0 sc1
v_cvt_pk_bf16_f32 v104, v104, v105
v_cvt_pk_bf16_f32 v105, v106, v107
v_cvt_pk_bf16_f32 v106, v108, v109
v_cvt_pk_bf16_f32 v107, v110, v111
v_accvgpr_read_b32 v112, a104
v_accvgpr_read_b32 v113, a105
v_accvgpr_read_b32 v114, a106
v_accvgpr_read_b32 v115, a107
ds_write_b128 v132, v[104:107] offset:2048
v_accvgpr_read_b32 v116, a120
v_accvgpr_read_b32 v117, a121
v_accvgpr_read_b32 v118, a122
v_accvgpr_read_b32 v119, a123
ds_read_b64_tr_b16 v[48:49], v133 offset:2048
ds_read_b64_tr_b16 v[50:51], v133 offset:2056
v_pk_mul_f32 v[112:113], v[112:113], v[80:81]
v_pk_mul_f32 v[114:115], v[114:115], v[82:83]
v_pk_mul_f32 v[116:117], v[116:117], v[80:81]
v_pk_mul_f32 v[118:119], v[118:119], v[82:83]
s_waitcnt lgkmcnt(3)
buffer_store_dwordx4 v[44:47], v244, s[20:23], s93 offen offset:1024 sc0 sc1
v_cvt_pk_bf16_f32 v112, v112, v113
v_cvt_pk_bf16_f32 v113, v114, v115
v_cvt_pk_bf16_f32 v114, v116, v117
v_cvt_pk_bf16_f32 v115, v118, v119
v_accvgpr_read_b32 v104, a12
v_accvgpr_read_b32 v105, a13
v_accvgpr_read_b32 v106, a14
v_accvgpr_read_b32 v107, a15
ds_write_b128 v132, v[112:115] offset:3072
v_accvgpr_read_b32 v108, a28
v_accvgpr_read_b32 v109, a29
v_accvgpr_read_b32 v110, a30
v_accvgpr_read_b32 v111, a31
ds_read_b64_tr_b16 v[52:53], v133 offset:3072
ds_read_b64_tr_b16 v[54:55], v133 offset:3080
v_pk_mul_f32 v[104:105], v[104:105], v[84:85]
v_pk_mul_f32 v[106:107], v[106:107], v[86:87]
v_pk_mul_f32 v[108:109], v[108:109], v[84:85]
v_pk_mul_f32 v[110:111], v[110:111], v[86:87]
s_waitcnt lgkmcnt(3)
buffer_store_dwordx4 v[48:51], v244, s[20:23], s93 offen offset:2048 sc0 sc1
v_cvt_pk_bf16_f32 v104, v104, v105
v_cvt_pk_bf16_f32 v105, v106, v107
v_cvt_pk_bf16_f32 v106, v108, v109
v_cvt_pk_bf16_f32 v107, v110, v111
v_accvgpr_read_b32 v112, a44
v_accvgpr_read_b32 v113, a45
v_accvgpr_read_b32 v114, a46
v_accvgpr_read_b32 v115, a47
ds_write_b128 v132, v[104:107] offset:0
v_accvgpr_read_b32 v116, a60
v_accvgpr_read_b32 v117, a61
v_accvgpr_read_b32 v118, a62
v_accvgpr_read_b32 v119, a63
ds_read_b64_tr_b16 v[56:57], v133 offset:0
ds_read_b64_tr_b16 v[58:59], v133 offset:8
v_pk_mul_f32 v[112:113], v[112:113], v[84:85]
v_pk_mul_f32 v[114:115], v[114:115], v[86:87]
v_pk_mul_f32 v[116:117], v[116:117], v[84:85]
v_pk_mul_f32 v[118:119], v[118:119], v[86:87]
s_waitcnt lgkmcnt(3)
buffer_store_dwordx4 v[52:55], v244, s[20:23], s93 offen offset:3072 sc0 sc1
v_cvt_pk_bf16_f32 v112, v112, v113
v_cvt_pk_bf16_f32 v113, v114, v115
v_cvt_pk_bf16_f32 v114, v116, v117
v_cvt_pk_bf16_f32 v115, v118, v119
v_accvgpr_read_b32 v104, a76
v_accvgpr_read_b32 v105, a77
v_accvgpr_read_b32 v106, a78
v_accvgpr_read_b32 v107, a79
ds_write_b128 v132, v[112:115] offset:1024
v_accvgpr_read_b32 v108, a92
v_accvgpr_read_b32 v109, a93
v_accvgpr_read_b32 v110, a94
v_accvgpr_read_b32 v111, a95
ds_read_b64_tr_b16 v[60:61], v133 offset:1024
ds_read_b64_tr_b16 v[62:63], v133 offset:1032
v_pk_mul_f32 v[104:105], v[104:105], v[84:85]
v_pk_mul_f32 v[106:107], v[106:107], v[86:87]
v_pk_mul_f32 v[108:109], v[108:109], v[84:85]
v_pk_mul_f32 v[110:111], v[110:111], v[86:87]
s_waitcnt lgkmcnt(3)
buffer_store_dwordx4 v[56:59], v244, s[20:23], s51 offen offset:0 sc0 sc1
v_cvt_pk_bf16_f32 v104, v104, v105
v_cvt_pk_bf16_f32 v105, v106, v107
v_cvt_pk_bf16_f32 v106, v108, v109
v_cvt_pk_bf16_f32 v107, v110, v111
v_accvgpr_read_b32 v112, a108
v_accvgpr_read_b32 v113, a109
v_accvgpr_read_b32 v114, a110
v_accvgpr_read_b32 v115, a111
ds_write_b128 v132, v[104:107] offset:2048
v_accvgpr_read_b32 v116, a124
v_accvgpr_read_b32 v117, a125
v_accvgpr_read_b32 v118, a126
v_accvgpr_read_b32 v119, a127
ds_read_b64_tr_b16 v[64:65], v133 offset:2048
ds_read_b64_tr_b16 v[66:67], v133 offset:2056
v_pk_mul_f32 v[112:113], v[112:113], v[84:85]
v_pk_mul_f32 v[114:115], v[114:115], v[86:87]
v_pk_mul_f32 v[116:117], v[116:117], v[84:85]
v_pk_mul_f32 v[118:119], v[118:119], v[86:87]
s_waitcnt lgkmcnt(3)
buffer_store_dwordx4 v[60:63], v244, s[20:23], s51 offen offset:1024 sc0 sc1
v_cvt_pk_bf16_f32 v112, v112, v113
v_cvt_pk_bf16_f32 v113, v114, v115
v_cvt_pk_bf16_f32 v114, v116, v117
v_cvt_pk_bf16_f32 v115, v118, v119
ds_write_b128 v132, v[112:115] offset:3072
ds_read_b64_tr_b16 v[68:69], v133 offset:3072
ds_read_b64_tr_b16 v[70:71], v133 offset:3080
s_waitcnt lgkmcnt(3)
buffer_store_dwordx4 v[64:67], v244, s[20:23], s51 offen offset:2048 sc0 sc1
v_max3_f32 v104, v120, v121, v122
v_max_f32 v104, v104, v123
v_add_f32 v105, v120, v121
v_add_f32 v105, v105, v122
v_add_f32 v105, v105, v123
v_cmp_nge_f32 vcc, s42, v104
v_cmp_u_f32 s[28:29], v105, v105
s_or_b64 vcc, vcc, s[28:29]
s_cmp_lg_u64 vcc, 0
s_cselect_b32 s28, 1, 0
v_mov_b32 v104, s28
v_mov_b32 v106, 147456
s_waitcnt lgkmcnt(0)
buffer_store_dwordx4 v[68:71], v244, s[20:23], s51 offen offset:3072 sc0 sc1
ds_write_b32 v134, v104
s_waitcnt vmcnt(16) lgkmcnt(0)
s_barrier
ds_read2st64_b32 v[110:111], v106 offset0:32 offset1:48
ds_read2st64_b32 v[108:109], v106 offset0:0 offset1:16
ds_read_b64_tr_b16 a[64:65], v237 offset:0
ds_read_b64_tr_b16 a[66:67], v237 offset:4608
ds_read_b64_tr_b16 a[68:69], v237 offset:9216
ds_read_b64_tr_b16 a[70:71], v237 offset:13824
ds_read_b64_tr_b16 a[72:73], v237 offset:8
ds_read_b64_tr_b16 a[74:75], v237 offset:4616
ds_read_b64_tr_b16 a[76:77], v237 offset:9224
ds_read_b64_tr_b16 a[78:79], v237 offset:13832
ds_read_b64_tr_b16 a[80:81], v238 offset:0
ds_read_b64_tr_b16 a[82:83], v238 offset:4608
ds_read_b64_tr_b16 a[84:85], v238 offset:9216
ds_read_b64_tr_b16 a[86:87], v238 offset:13824
s_waitcnt lgkmcnt(12)
v_or_b32 v108, v108, v109
v_or3_b32 v108, v108, v110, v111
s_nop 0
v_readfirstlane_b32 s28, v108
s_cmp_gt_u32 s28, s43
s_cbranch_scc1 K_FALLBACK
s_waitcnt lgkmcnt(8)
v_mfma_f32_16x16x32_bf16 v[96:99], a[64:67], v[56:59], 0
ds_read_b64_tr_b16 a[88:89], v238 offset:8
ds_read_b64_tr_b16 a[90:91], v238 offset:4616
v_mfma_f32_16x16x32_bf16 v[96:99], a[68:71], v[60:63], v[96:99]
s_lshr_b32 s32, s35, 2
s_and_b32 s33, s35, 3
v_mfma_f32_16x16x32_bf16 v[88:91], a[68:71], v[44:47], 0
s_lshl_b32 s94, s36, 9
s_lshl_b32 s28, s32, 6
v_mfma_f32_16x16x32_bf16 v[88:91], a[64:67], v[40:43], v[88:91]
s_lshr_b32 s34, s32, 2
v_mfma_f32_16x16x32_bf16 v[80:83], a[64:67], v[24:27], 0
ds_read_b64_tr_b16 a[92:93], v238 offset:9224
ds_read_b64_tr_b16 a[94:95], v238 offset:13832
v_mfma_f32_16x16x32_bf16 v[80:83], a[68:71], v[28:31], v[80:83]
s_add_u32 s94, s94, s28
s_lshl_b32 s28, s37, 4
v_mfma_f32_16x16x32_bf16 v[72:75], a[68:71], v[12:15], 0
s_add_u32 s94, s94, s28
s_add_u32 s94, s94, 0x248000
v_mfma_f32_16x16x32_bf16 v[72:75], a[64:67], v[8:11], v[72:75]
v_mov_b32 v231, 1
v_and_b32 v229, 7, v1
s_waitcnt lgkmcnt(8)
v_mfma_f32_16x16x32_bf16 v[76:79], a[72:75], v[8:11], 0
ds_read_b64_tr_b16 a[64:65], v237 offset:128
ds_read_b64_tr_b16 a[66:67], v237 offset:4736
v_mfma_f32_16x16x32_bf16 v[76:79], a[76:79], v[12:15], v[76:79]
v_lshlrev_b32 v229, 2, v229
v_lshlrev_b32 v226, 3, v1
v_mfma_f32_16x16x32_bf16 v[84:87], a[76:79], v[28:31], 0
s_lshl2_add_u32 s29, s33, s94
v_mfma_f32_16x16x32_bf16 v[84:87], a[72:75], v[24:27], v[84:87]
v_mfma_f32_16x16x32_bf16 v[92:95], a[72:75], v[40:43], 0
ds_read_b64_tr_b16 a[68:69], v237 offset:9344
ds_read_b64_tr_b16 a[70:71], v237 offset:13952
v_mfma_f32_16x16x32_bf16 v[92:95], a[76:79], v[44:47], v[92:95]
v_mfma_f32_16x16x32_bf16 v[100:103], a[76:79], v[60:63], 0
v_mfma_f32_16x16x32_bf16 v[100:103], a[72:75], v[56:59], v[100:103]
s_waitcnt lgkmcnt(8)
v_mfma_f32_16x16x32_bf16 v[128:131], a[80:83], v[56:59], 0
ds_read_b64_tr_b16 a[72:73], v237 offset:136
ds_read_b64_tr_b16 a[74:75], v237 offset:4744
v_mfma_f32_16x16x32_bf16 v[128:131], a[84:87], v[60:63], v[128:131]
v_mfma_f32_16x16x32_bf16 v[120:123], a[84:87], v[44:47], 0
v_mfma_f32_16x16x32_bf16 v[120:123], a[80:83], v[40:43], v[120:123]
v_mfma_f32_16x16x32_bf16 v[112:115], a[80:83], v[24:27], 0
ds_read_b64_tr_b16 a[76:77], v237 offset:9352
ds_read_b64_tr_b16 a[78:79], v237 offset:13960
v_mfma_f32_16x16x32_bf16 v[112:115], a[84:87], v[28:31], v[112:115]
s_waitcnt vmcnt(0)
buffer_store_dword v231, v254, s[20:23], s29 offen sc0 sc1
v_mfma_f32_16x16x32_bf16 v[104:107], a[84:87], v[12:15], 0
s_add_u32 s28, s35, 1
s_and_b32 s28, s28, 3
v_mfma_f32_16x16x32_bf16 v[104:107], a[80:83], v[8:11], v[104:107]
s_mul_i32 s28, s28, 36864
s_waitcnt lgkmcnt(8)
v_mfma_f32_16x16x32_bf16 v[108:111], a[88:91], v[8:11], 0
ds_read_b64_tr_b16 a[80:81], v238 offset:128
ds_read_b64_tr_b16 a[82:83], v238 offset:4736
v_mfma_f32_16x16x32_bf16 v[108:111], a[92:95], v[12:15], v[108:111]
v_add_u32 v216, s28, v234
v_add_u32 v217, s28, v235
v_mfma_f32_16x16x32_bf16 v[116:119], a[92:95], v[28:31], 0
v_add_u32 v218, s28, v236
v_mfma_f32_16x16x32_bf16 v[116:119], a[88:91], v[24:27], v[116:119]
v_mfma_f32_16x16x32_bf16 v[124:127], a[88:91], v[40:43], 0
ds_read_b64_tr_b16 a[84:85], v238 offset:9344
ds_read_b64_tr_b16 a[86:87], v238 offset:13952
v_mfma_f32_16x16x32_bf16 v[124:127], a[92:95], v[44:47], v[124:127]
v_mfma_f32_16x16x32_bf16 v[132:135], a[92:95], v[60:63], 0
v_mfma_f32_16x16x32_bf16 v[132:135], a[88:91], v[56:59], v[132:135]
s_waitcnt lgkmcnt(8)
v_mfma_f32_16x16x32_bf16 v[160:163], a[64:67], v[56:59], 0
ds_read_b64_tr_b16 a[88:89], v238 offset:136
ds_read_b64_tr_b16 a[90:91], v238 offset:4744
v_mfma_f32_16x16x32_bf16 v[160:163], a[68:71], v[60:63], v[160:163]
v_mfma_f32_16x16x32_bf16 v[152:155], a[68:71], v[44:47], 0
v_mfma_f32_16x16x32_bf16 v[152:155], a[64:67], v[40:43], v[152:155]
v_mfma_f32_16x16x32_bf16 v[144:147], a[64:67], v[24:27], 0
ds_read_b64_tr_b16 a[92:93], v238 offset:9352
ds_read_b64_tr_b16 a[94:95], v238 offset:13960
v_mfma_f32_16x16x32_bf16 v[144:147], a[68:71], v[28:31], v[144:147]
v_mfma_f32_16x16x32_bf16 v[136:139], a[68:71], v[12:15], 0
v_mfma_f32_16x16x32_bf16 v[136:139], a[64:67], v[8:11], v[136:139]
s_waitcnt lgkmcnt(8)
v_mfma_f32_16x16x32_bf16 v[140:143], a[72:75], v[8:11], 0
ds_read_b64_tr_b16 a[64:65], v239 offset:0
ds_read_b64_tr_b16 a[66:67], v239 offset:4608
v_mfma_f32_16x16x32_bf16 v[140:143], a[76:79], v[12:15], v[140:143]
buffer_load_dword v230, v229, s[20:23], s94 offen sc0 sc1
v_mfma_f32_16x16x32_bf16 v[148:151], a[76:79], v[28:31], 0
s_add_u32 s39, s35, 1
s_and_b32 s39, s39, 3
v_mfma_f32_16x16x32_bf16 v[148:151], a[72:75], v[24:27], v[148:151]
s_add_u32 s28, s33, 1
s_and_b32 s28, s28, 3
v_mfma_f32_16x16x32_bf16 v[156:159], a[72:75], v[40:43], 0
ds_read_b64_tr_b16 a[68:69], v239 offset:9216
ds_read_b64_tr_b16 a[70:71], v239 offset:13824
v_mfma_f32_16x16x32_bf16 v[156:159], a[76:79], v[44:47], v[156:159]
s_sub_u32 s28, s28, s33
s_lshl_b32 s28, s28, 16
v_mfma_f32_16x16x32_bf16 v[164:167], a[76:79], v[60:63], 0
s_add_u32 s64, s28, s44
s_add_u32 s65, s64, 4096
v_mfma_f32_16x16x32_bf16 v[164:167], a[72:75], v[56:59], v[164:167]
s_add_u32 s66, s64, 8192
s_add_u32 s67, s64, 12288
s_waitcnt lgkmcnt(8)
v_mfma_f32_16x16x32_bf16 v[192:195], a[80:83], v[56:59], 0
ds_read_b64_tr_b16 a[72:73], v237 offset:18432
ds_read_b64_tr_b16 a[74:75], v237 offset:23040
v_mfma_f32_16x16x32_bf16 v[192:195], a[84:87], v[60:63], v[192:195]
s_add_u32 s28, s35, 2
s_and_b32 s28, s28, 3
v_mfma_f32_16x16x32_bf16 v[184:187], a[84:87], v[44:47], 0
s_mul_i32 s28, s28, 36864
v_mfma_f32_16x16x32_bf16 v[184:187], a[80:83], v[40:43], v[184:187]
v_add_u32 v219, s28, v234
v_add_u32 v220, s28, v235
v_mfma_f32_16x16x32_bf16 v[176:179], a[80:83], v[24:27], 0
ds_read_b64_tr_b16 a[76:77], v237 offset:27648
ds_read_b64_tr_b16 a[78:79], v237 offset:32256
v_mfma_f32_16x16x32_bf16 v[176:179], a[84:87], v[28:31], v[176:179]
v_add_u32 v221, s28, v236
v_mfma_f32_16x16x32_bf16 v[168:171], a[84:87], v[12:15], 0
s_add_u32 s28, s35, 3
s_and_b32 s28, s28, 3
v_mfma_f32_16x16x32_bf16 v[168:171], a[80:83], v[8:11], v[168:171]
s_mul_i32 s28, s28, 36864
s_waitcnt lgkmcnt(8)
v_mfma_f32_16x16x32_bf16 v[172:175], a[88:91], v[8:11], 0
ds_read_b64_tr_b16 a[80:81], v237 offset:18440
ds_read_b64_tr_b16 a[82:83], v237 offset:23048
v_mfma_f32_16x16x32_bf16 v[172:175], a[92:95], v[12:15], v[172:175]
v_add_u32 v222, s28, v234
v_add_u32 v223, s28, v235
v_mfma_f32_16x16x32_bf16 v[180:183], a[92:95], v[28:31], 0
v_add_u32 v224, s28, v236
v_mfma_f32_16x16x32_bf16 v[180:183], a[88:91], v[24:27], v[180:183]
v_mfma_f32_16x16x32_bf16 v[188:191], a[88:91], v[40:43], 0
ds_read_b64_tr_b16 a[84:85], v237 offset:27656
ds_read_b64_tr_b16 a[86:87], v237 offset:32264
v_mfma_f32_16x16x32_bf16 v[188:191], a[92:95], v[44:47], v[188:191]
v_mfma_f32_16x16x32_bf16 v[196:199], a[92:95], v[60:63], 0
s_waitcnt vmcnt(0)
v_cmp_gt_u32 vcc, 1, v230
v_mfma_f32_16x16x32_bf16 v[196:199], a[88:91], v[56:59], v[196:199]
s_waitcnt lgkmcnt(8)
v_mfma_f32_16x16x32_bf16 v[212:215], a[64:67], v[56:59], 0
ds_read_b64_tr_b16 a[88:89], v238 offset:18432
ds_read_b64_tr_b16 a[90:91], v238 offset:23040
v_mfma_f32_16x16x32_bf16 v[212:215], a[68:71], v[60:63], v[212:215]
s_bitcmp1_b32 vcc_lo, s39
s_cbranch_scc1 SP_O1B
SP_O1B_RET:
v_mfma_f32_16x16x32_bf16 v[208:211], a[68:71], v[44:47], 0
buffer_load_dwordx4 a[128:131], v244, s[20:23], s64 offen offset:0 sc0 sc1
v_mfma_f32_16x16x32_bf16 v[208:211], a[64:67], v[40:43], v[208:211]
v_mfma_f32_16x16x32_bf16 v[204:207], a[64:67], v[24:27], 0
ds_read_b64_tr_b16 a[92:93], v238 offset:27648
ds_read_b64_tr_b16 a[94:95], v238 offset:32256
v_mfma_f32_16x16x32_bf16 v[204:207], a[68:71], v[28:31], v[204:207]
v_mfma_f32_16x16x32_bf16 v[200:203], a[68:71], v[12:15], 0
buffer_load_dwordx4 a[144:147], v244, s[20:23], s65 offen offset:0 sc0 sc1
v_mfma_f32_16x16x32_bf16 v[200:203], a[64:67], v[8:11], v[200:203]
s_waitcnt lgkmcnt(8)
v_mfma_f32_16x16x32_bf16 v[72:75], a[72:75], v[16:19], v[72:75]
ds_read_b64_tr_b16 a[64:65], v238 offset:18440
ds_read_b64_tr_b16 a[66:67], v238 offset:23048
v_mfma_f32_16x16x32_bf16 v[72:75], a[76:79], v[20:23], v[72:75]
v_mfma_f32_16x16x32_bf16 v[80:83], a[76:79], v[36:39], v[80:83]
buffer_load_dwordx4 a[160:163], v244, s[20:23], s66 offen offset:0 sc0 sc1
v_mfma_f32_16x16x32_bf16 v[80:83], a[72:75], v[32:35], v[80:83]
v_mfma_f32_16x16x32_bf16 v[88:91], a[72:75], v[48:51], v[88:91]
ds_read_b64_tr_b16 a[68:69], v238 offset:27656
ds_read_b64_tr_b16 a[70:71], v238 offset:32264
v_mfma_f32_16x16x32_bf16 v[88:91], a[76:79], v[52:55], v[88:91]
v_mfma_f32_16x16x32_bf16 v[96:99], a[76:79], v[68:71], v[96:99]
buffer_load_dwordx4 a[176:179], v244, s[20:23], s67 offen offset:0 sc0 sc1
v_mfma_f32_16x16x32_bf16 v[96:99], a[72:75], v[64:67], v[96:99]
s_waitcnt lgkmcnt(8)
v_mfma_f32_16x16x32_bf16 v[100:103], a[80:83], v[64:67], v[100:103]
ds_read_b64_tr_b16 a[72:73], v237 offset:18560
ds_read_b64_tr_b16 a[74:75], v237 offset:23168
v_mfma_f32_16x16x32_bf16 v[100:103], a[84:87], v[68:71], v[100:103]
v_mfma_f32_16x16x32_bf16 v[92:95], a[84:87], v[52:55], v[92:95]
buffer_load_dwordx4 a[132:135], v244, s[20:23], s64 offen offset:1024 sc0 sc1
v_mfma_f32_16x16x32_bf16 v[92:95], a[80:83], v[48:51], v[92:95]
v_mfma_f32_16x16x32_bf16 v[84:87], a[80:83], v[32:35], v[84:87]
ds_read_b64_tr_b16 a[76:77], v237 offset:27776
ds_read_b64_tr_b16 a[78:79], v237 offset:32384
v_mfma_f32_16x16x32_bf16 v[84:87], a[84:87], v[36:39], v[84:87]
v_mfma_f32_16x16x32_bf16 v[76:79], a[84:87], v[20:23], v[76:79]
buffer_load_dwordx4 a[148:151], v244, s[20:23], s65 offen offset:1024 sc0 sc1
v_mfma_f32_16x16x32_bf16 v[76:79], a[80:83], v[16:19], v[76:79]
s_waitcnt lgkmcnt(8)
v_mfma_f32_16x16x32_bf16 v[104:107], a[88:91], v[16:19], v[104:107]
ds_read_b64_tr_b16 a[80:81], v237 offset:18568
ds_read_b64_tr_b16 a[82:83], v237 offset:23176
v_mfma_f32_16x16x32_bf16 v[104:107], a[92:95], v[20:23], v[104:107]
v_mfma_f32_16x16x32_bf16 v[112:115], a[92:95], v[36:39], v[112:115]
buffer_load_dwordx4 a[164:167], v244, s[20:23], s66 offen offset:1024 sc0 sc1
v_mfma_f32_16x16x32_bf16 v[112:115], a[88:91], v[32:35], v[112:115]
v_mfma_f32_16x16x32_bf16 v[120:123], a[88:91], v[48:51], v[120:123]
ds_read_b64_tr_b16 a[84:85], v237 offset:27784
ds_read_b64_tr_b16 a[86:87], v237 offset:32392
v_mfma_f32_16x16x32_bf16 v[120:123], a[92:95], v[52:55], v[120:123]
v_mfma_f32_16x16x32_bf16 v[128:131], a[92:95], v[68:71], v[128:131]
buffer_load_dwordx4 a[180:183], v244, s[20:23], s67 offen offset:1024 sc0 sc1
v_mfma_f32_16x16x32_bf16 v[128:131], a[88:91], v[64:67], v[128:131]
s_waitcnt lgkmcnt(8)
v_mfma_f32_16x16x32_bf16 v[132:135], a[64:67], v[64:67], v[132:135]
ds_read_b64_tr_b16 a[88:89], v238 offset:18560
ds_read_b64_tr_b16 a[90:91], v238 offset:23168
v_mfma_f32_16x16x32_bf16 v[132:135], a[68:71], v[68:71], v[132:135]
v_mfma_f32_16x16x32_bf16 v[124:127], a[68:71], v[52:55], v[124:127]
buffer_load_dwordx4 a[136:139], v244, s[20:23], s64 offen offset:2048 sc0 sc1
v_mfma_f32_16x16x32_bf16 v[124:127], a[64:67], v[48:51], v[124:127]
buffer_load_dword v230, v229, s[20:23], s94 offen sc0 sc1
v_mfma_f32_16x16x32_bf16 v[116:119], a[64:67], v[32:35], v[116:119]
ds_read_b64_tr_b16 a[92:93], v238 offset:27776
ds_read_b64_tr_b16 a[94:95], v238 offset:32384
v_mfma_f32_16x16x32_bf16 v[116:119], a[68:71], v[36:39], v[116:119]
v_mfma_f32_16x16x32_bf16 v[108:111], a[68:71], v[20:23], v[108:111]
v_mfma_f32_16x16x32_bf16 v[108:111], a[64:67], v[16:19], v[108:111]
buffer_load_dwordx4 a[152:155], v244, s[20:23], s65 offen offset:2048 sc0 sc1
s_waitcnt lgkmcnt(8)
v_mfma_f32_16x16x32_bf16 v[136:139], a[72:75], v[16:19], v[136:139]
ds_read_b64_tr_b16 a[64:65], v238 offset:18568
ds_read_b64_tr_b16 a[66:67], v238 offset:23176
v_mfma_f32_16x16x32_bf16 v[136:139], a[76:79], v[20:23], v[136:139]
v_mfma_f32_16x16x32_bf16 v[144:147], a[76:79], v[36:39], v[144:147]
v_mfma_f32_16x16x32_bf16 v[144:147], a[72:75], v[32:35], v[144:147]
buffer_load_dwordx4 a[168:171], v244, s[20:23], s66 offen offset:2048 sc0 sc1
v_mfma_f32_16x16x32_bf16 v[152:155], a[72:75], v[48:51], v[152:155]
ds_read_b64_tr_b16 a[68:69], v238 offset:27784
ds_read_b64_tr_b16 a[70:71], v238 offset:32392
v_mfma_f32_16x16x32_bf16 v[152:155], a[76:79], v[52:55], v[152:155]
v_mfma_f32_16x16x32_bf16 v[160:163], a[76:79], v[68:71], v[160:163]
v_mfma_f32_16x16x32_bf16 v[160:163], a[72:75], v[64:67], v[160:163]
buffer_load_dwordx4 a[184:187], v244, s[20:23], s67 offen offset:2048 sc0 sc1
s_waitcnt lgkmcnt(8)
v_mfma_f32_16x16x32_bf16 v[164:167], a[80:83], v[64:67], v[164:167]
ds_read_b64_tr_b16 a[72:73], v239 offset:18432
ds_read_b64_tr_b16 a[74:75], v239 offset:23040
v_mfma_f32_16x16x32_bf16 v[164:167], a[84:87], v[68:71], v[164:167]
v_mfma_f32_16x16x32_bf16 v[156:159], a[84:87], v[52:55], v[156:159]
v_mfma_f32_16x16x32_bf16 v[156:159], a[80:83], v[48:51], v[156:159]
buffer_load_dwordx4 a[140:143], v244, s[20:23], s64 offen offset:3072 sc0 sc1
v_mfma_f32_16x16x32_bf16 v[148:151], a[80:83], v[32:35], v[148:151]
ds_read_b64_tr_b16 a[76:77], v239 offset:27648
ds_read_b64_tr_b16 a[78:79], v239 offset:32256
v_mfma_f32_16x16x32_bf16 v[148:151], a[84:87], v[36:39], v[148:151]
v_mfma_f32_16x16x32_bf16 v[140:143], a[84:87], v[20:23], v[140:143]
v_mfma_f32_16x16x32_bf16 v[140:143], a[80:83], v[16:19], v[140:143]
buffer_load_dwordx4 a[156:159], v244, s[20:23], s65 offen offset:3072 sc0 sc1
s_waitcnt lgkmcnt(8)
v_mfma_f32_16x16x32_bf16 v[168:171], a[88:91], v[16:19], v[168:171]
ds_read_b64_tr_b16 a[80:81], v216 offset:0
ds_read_b64_tr_b16 a[82:83], v216 offset:4608
v_mfma_f32_16x16x32_bf16 v[168:171], a[92:95], v[20:23], v[168:171]
v_mfma_f32_16x16x32_bf16 v[176:179], a[92:95], v[36:39], v[176:179]
v_mfma_f32_16x16x32_bf16 v[176:179], a[88:91], v[32:35], v[176:179]
buffer_load_dwordx4 a[172:175], v244, s[20:23], s66 offen offset:3072 sc0 sc1
v_mfma_f32_16x16x32_bf16 v[184:187], a[88:91], v[48:51], v[184:187]
ds_read_b64_tr_b16 a[84:85], v216 offset:9216
ds_read_b64_tr_b16 a[86:87], v216 offset:13824
v_mfma_f32_16x16x32_bf16 v[184:187], a[92:95], v[52:55], v[184:187]
v_mfma_f32_16x16x32_bf16 v[192:195], a[92:95], v[68:71], v[192:195]
v_mfma_f32_16x16x32_bf16 v[192:195], a[88:91], v[64:67], v[192:195]
buffer_load_dwordx4 a[188:191], v244, s[20:23], s67 offen offset:3072 sc0 sc1
s_waitcnt lgkmcnt(8)
v_mfma_f32_16x16x32_bf16 v[196:199], a[64:67], v[64:67], v[196:199]
ds_read_b64_tr_b16 a[88:89], v216 offset:8
ds_read_b64_tr_b16 a[90:91], v216 offset:4616
v_mfma_f32_16x16x32_bf16 v[196:199], a[68:71], v[68:71], v[196:199]
s_add_u32 s28, s33, 2
s_and_b32 s28, s28, 3
v_mfma_f32_16x16x32_bf16 v[188:191], a[68:71], v[52:55], v[188:191]
s_sub_u32 s28, s28, s33
s_lshl_b32 s28, s28, 16
v_mfma_f32_16x16x32_bf16 v[188:191], a[64:67], v[48:51], v[188:191]
s_add_u32 s64, s28, s44
s_add_u32 s65, s64, 4096
v_mfma_f32_16x16x32_bf16 v[180:183], a[64:67], v[32:35], v[180:183]
ds_read_b64_tr_b16 a[92:93], v216 offset:9224
ds_read_b64_tr_b16 a[94:95], v216 offset:13832
v_mfma_f32_16x16x32_bf16 v[180:183], a[68:71], v[36:39], v[180:183]
s_add_u32 s66, s64, 8192
s_add_u32 s67, s64, 12288
v_mfma_f32_16x16x32_bf16 v[172:175], a[68:71], v[20:23], v[172:175]
s_waitcnt vmcnt(7)
v_cmp_gt_u32 vcc, 1, v230
v_mfma_f32_16x16x32_bf16 v[172:175], a[64:67], v[16:19], v[172:175]
s_waitcnt lgkmcnt(8)
v_mfma_f32_16x16x32_bf16 v[200:203], a[72:75], v[16:19], v[200:203]
ds_read_b64_tr_b16 a[64:65], v217 offset:0
ds_read_b64_tr_b16 a[66:67], v217 offset:4608
v_mfma_f32_16x16x32_bf16 v[200:203], a[76:79], v[20:23], v[200:203]
s_and_b32 s29, vcc_lo, 15
s_cbranch_scc1 SP_O2B
SP_O2B_RET:
v_mfma_f32_16x16x32_bf16 v[204:207], a[76:79], v[36:39], v[204:207]
buffer_load_dwordx4 a[192:195], v244, s[20:23], s64 offen offset:0 sc0 sc1
v_mfma_f32_16x16x32_bf16 v[204:207], a[72:75], v[32:35], v[204:207]
v_mfma_f32_16x16x32_bf16 v[208:211], a[72:75], v[48:51], v[208:211]
ds_read_b64_tr_b16 a[68:69], v217 offset:9216
ds_read_b64_tr_b16 a[70:71], v217 offset:13824
v_mfma_f32_16x16x32_bf16 v[208:211], a[76:79], v[52:55], v[208:211]
v_mfma_f32_16x16x32_bf16 v[212:215], a[76:79], v[68:71], v[212:215]
buffer_load_dwordx4 a[208:211], v244, s[20:23], s65 offen offset:0 sc0 sc1
v_mfma_f32_16x16x32_bf16 v[212:215], a[72:75], v[64:67], v[212:215]
s_waitcnt vmcnt(15)
s_waitcnt lgkmcnt(8)
v_mfma_f32_16x16x32_bf16 v[96:99], a[80:83], a[176:179], v[96:99]
ds_read_b64_tr_b16 a[72:73], v217 offset:8
ds_read_b64_tr_b16 a[74:75], v217 offset:4616
s_waitcnt vmcnt(11)
v_mfma_f32_16x16x32_bf16 v[96:99], a[84:87], a[180:183], v[96:99]
v_mfma_f32_16x16x32_bf16 v[88:91], a[84:87], a[164:167], v[88:91]
buffer_load_dwordx4 a[96:99], v244, s[20:23], s66 offen offset:0 sc0 sc1
v_mfma_f32_16x16x32_bf16 v[88:91], a[80:83], a[160:163], v[88:91]
v_accvgpr_read_b32 v39, a222
v_accvgpr_read_b32 v59, a232
v_mfma_f32_16x16x32_bf16 v[80:83], a[80:83], a[144:147], v[80:83]
ds_read_b64_tr_b16 a[76:77], v217 offset:9224
ds_read_b64_tr_b16 a[78:79], v217 offset:13832
v_mfma_f32_16x16x32_bf16 v[80:83], a[84:87], a[148:151], v[80:83]
v_lshlrev_b32 v38, 16, v39
v_and_b32 v39, 0xffff0000, v39
v_mfma_f32_16x16x32_bf16 v[72:75], a[84:87], a[132:135], v[72:75]
buffer_load_dwordx4 a[112:115], v244, s[20:23], s67 offen offset:0 sc0 sc1
v_mfma_f32_16x16x32_bf16 v[72:75], a[80:83], a[128:131], v[72:75]
v_lshlrev_b32 v58, 16, v59
v_and_b32 v59, 0xffff0000, v59
s_waitcnt lgkmcnt(8)
v_mfma_f32_16x16x32_bf16 v[76:79], a[88:91], a[128:131], v[76:79]
ds_read_b64_tr_b16 a[80:81], v216 offset:128
ds_read_b64_tr_b16 a[82:83], v216 offset:4736
v_mfma_f32_16x16x32_bf16 v[76:79], a[92:95], a[132:135], v[76:79]
v_add_f32 v38, v38, v58
v_add_f32 v39, v39, v59
v_mfma_f32_16x16x32_bf16 v[84:87], a[92:95], a[148:151], v[84:87]
buffer_load_dwordx4 a[196:199], v244, s[20:23], s64 offen offset:1024 sc0 sc1
v_mfma_f32_16x16x32_bf16 v[84:87], a[88:91], a[144:147], v[84:87]
v_cvt_pk_bf16_f32 v58, v38, v39
v_lshlrev_b32 v38, 16, v58
v_mfma_f32_16x16x32_bf16 v[92:95], a[88:91], a[160:163], v[92:95]
ds_read_b64_tr_b16 a[84:85], v216 offset:9344
ds_read_b64_tr_b16 a[86:87], v216 offset:13952
v_mfma_f32_16x16x32_bf16 v[92:95], a[92:95], a[164:167], v[92:95]
v_and_b32 v39, 0xffff0000, v58
v_mul_f32 v58, 0xbfb8aa3b, v38
v_mfma_f32_16x16x32_bf16 v[100:103], a[92:95], a[180:183], v[100:103]
buffer_load_dwordx4 a[244:247], v244, s[20:23], s65 offen offset:1024 sc0 sc1
v_mfma_f32_16x16x32_bf16 v[100:103], a[88:91], a[176:179], v[100:103]
v_mul_f32 v59, 0xbfb8aa3b, v39
s_waitcnt lgkmcnt(8)
v_mfma_f32_16x16x32_bf16 v[128:131], a[64:67], a[176:179], v[128:131]
ds_read_b64_tr_b16 a[88:89], v216 offset:136
ds_read_b64_tr_b16 a[90:91], v216 offset:4744
v_mfma_f32_16x16x32_bf16 v[128:131], a[68:71], a[180:183], v[128:131]
v_exp_f32 v58, v58
v_mfma_f32_16x16x32_bf16 v[120:123], a[68:71], a[164:167], v[120:123]
buffer_load_dwordx4 a[100:103], v244, s[20:23], s66 offen offset:1024 sc0 sc1
v_mfma_f32_16x16x32_bf16 v[120:123], a[64:67], a[160:163], v[120:123]
v_exp_f32 v59, v59
v_mfma_f32_16x16x32_bf16 v[112:115], a[64:67], a[144:147], v[112:115]
ds_read_b64_tr_b16 a[92:93], v216 offset:9352
ds_read_b64_tr_b16 a[94:95], v216 offset:13960
v_mfma_f32_16x16x32_bf16 v[112:115], a[68:71], a[148:151], v[112:115]
v_add_f32 v58, 1.0, v58
v_add_f32 v59, 1.0, v59
v_mfma_f32_16x16x32_bf16 v[104:107], a[68:71], a[132:135], v[104:107]
buffer_load_dwordx4 a[116:119], v244, s[20:23], s67 offen offset:1024 sc0 sc1
v_mfma_f32_16x16x32_bf16 v[104:107], a[64:67], a[128:131], v[104:107]
v_rcp_f32 v58, v58
s_waitcnt lgkmcnt(8)
v_mfma_f32_16x16x32_bf16 v[108:111], a[72:75], a[128:131], v[108:111]
ds_read_b64_tr_b16 a[64:65], v217 offset:128
ds_read_b64_tr_b16 a[66:67], v217 offset:4736
v_mfma_f32_16x16x32_bf16 v[108:111], a[76:79], a[132:135], v[108:111]
v_rcp_f32 v59, v59
v_mfma_f32_16x16x32_bf16 v[116:119], a[76:79], a[148:151], v[116:119]
buffer_load_dwordx4 a[200:203], v244, s[20:23], s64 offen offset:2048 sc0 sc1
v_mfma_f32_16x16x32_bf16 v[116:119], a[72:75], a[144:147], v[116:119]
v_mul_f32 v38, v38, v58
v_mul_f32 v39, v39, v59
v_mfma_f32_16x16x32_bf16 v[124:127], a[72:75], a[160:163], v[124:127]
ds_read_b64_tr_b16 a[68:69], v217 offset:9344
ds_read_b64_tr_b16 a[70:71], v217 offset:13952
v_mfma_f32_16x16x32_bf16 v[124:127], a[76:79], a[164:167], v[124:127]
v_cvt_pk_bf16_f32 v58, v38, v39
v_lshlrev_b32 v38, 16, v58
v_mfma_f32_16x16x32_bf16 v[132:135], a[76:79], a[180:183], v[132:135]
buffer_load_dwordx4 a[248:251], v244, s[20:23], s65 offen offset:2048 sc0 sc1
v_mfma_f32_16x16x32_bf16 v[132:135], a[72:75], a[176:179], v[132:135]
v_and_b32 v39, 0xffff0000, v58
v_accvgpr_read_b32 v41, a223
s_waitcnt lgkmcnt(8)
v_mfma_f32_16x16x32_bf16 v[160:163], a[80:83], a[176:179], v[160:163]
ds_read_b64_tr_b16 a[72:73], v217 offset:136
ds_read_b64_tr_b16 a[74:75], v217 offset:4744
v_mfma_f32_16x16x32_bf16 v[160:163], a[84:87], a[180:183], v[160:163]
v_accvgpr_read_b32 v59, a233
v_lshlrev_b32 v40, 16, v41
v_mfma_f32_16x16x32_bf16 v[152:155], a[84:87], a[164:167], v[152:155]
buffer_load_dwordx4 a[104:107], v244, s[20:23], s66 offen offset:2048 sc0 sc1
v_mfma_f32_16x16x32_bf16 v[152:155], a[80:83], a[160:163], v[152:155]
v_and_b32 v41, 0xffff0000, v41
v_lshlrev_b32 v58, 16, v59
v_mfma_f32_16x16x32_bf16 v[144:147], a[80:83], a[144:147], v[144:147]
ds_read_b64_tr_b16 a[76:77], v217 offset:9352
ds_read_b64_tr_b16 a[78:79], v217 offset:13960
v_mfma_f32_16x16x32_bf16 v[144:147], a[84:87], a[148:151], v[144:147]
v_and_b32 v59, 0xffff0000, v59
v_add_f32 v40, v40, v58
v_mfma_f32_16x16x32_bf16 v[136:139], a[84:87], a[132:135], v[136:139]
buffer_load_dwordx4 a[120:123], v244, s[20:23], s67 offen offset:2048 sc0 sc1
v_mfma_f32_16x16x32_bf16 v[136:139], a[80:83], a[128:131], v[136:139]
v_add_f32 v41, v41, v59
v_cvt_pk_bf16_f32 v58, v40, v41
s_waitcnt lgkmcnt(8)
v_mfma_f32_16x16x32_bf16 v[140:143], a[88:91], a[128:131], v[140:143]
ds_read_b64_tr_b16 a[80:81], v218 offset:0
ds_read_b64_tr_b16 a[82:83], v218 offset:4608
v_mfma_f32_16x16x32_bf16 v[140:143], a[92:95], a[132:135], v[140:143]
v_lshlrev_b32 v40, 16, v58
v_and_b32 v41, 0xffff0000, v58
v_mfma_f32_16x16x32_bf16 v[148:151], a[92:95], a[148:151], v[148:151]
buffer_load_dwordx4 a[204:207], v244, s[20:23], s64 offen offset:3072 sc0 sc1
v_mfma_f32_16x16x32_bf16 v[148:151], a[88:91], a[144:147], v[148:151]
v_mul_f32 v58, 0xbfb8aa3b, v40
v_mul_f32 v59, 0xbfb8aa3b, v41
v_mfma_f32_16x16x32_bf16 v[156:159], a[88:91], a[160:163], v[156:159]
ds_read_b64_tr_b16 a[84:85], v218 offset:9216
ds_read_b64_tr_b16 a[86:87], v218 offset:13824
v_mfma_f32_16x16x32_bf16 v[156:159], a[92:95], a[164:167], v[156:159]
v_exp_f32 v58, v58
v_mfma_f32_16x16x32_bf16 v[164:167], a[92:95], a[180:183], v[164:167]
buffer_load_dwordx4 a[252:255], v244, s[20:23], s65 offen offset:3072 sc0 sc1
v_mfma_f32_16x16x32_bf16 v[164:167], a[88:91], a[176:179], v[164:167]
v_exp_f32 v59, v59
s_waitcnt lgkmcnt(8)
v_mfma_f32_16x16x32_bf16 v[192:195], a[64:67], a[176:179], v[192:195]
ds_read_b64_tr_b16 a[88:89], v216 offset:18432
ds_read_b64_tr_b16 a[90:91], v216 offset:23040
v_mfma_f32_16x16x32_bf16 v[192:195], a[68:71], a[180:183], v[192:195]
v_add_f32 v58, 1.0, v58
v_add_f32 v59, 1.0, v59
v_mfma_f32_16x16x32_bf16 v[184:187], a[68:71], a[164:167], v[184:187]
buffer_load_dwordx4 a[108:111], v244, s[20:23], s66 offen offset:3072 sc0 sc1
v_mfma_f32_16x16x32_bf16 v[184:187], a[64:67], a[160:163], v[184:187]
v_rcp_f32 v58, v58
v_mfma_f32_16x16x32_bf16 v[176:179], a[64:67], a[144:147], v[176:179]
ds_read_b64_tr_b16 a[92:93], v216 offset:27648
ds_read_b64_tr_b16 a[94:95], v216 offset:32256
v_mfma_f32_16x16x32_bf16 v[176:179], a[68:71], a[148:151], v[176:179]
v_rcp_f32 v59, v59
v_mfma_f32_16x16x32_bf16 v[168:171], a[68:71], a[132:135], v[168:171]
buffer_load_dwordx4 a[124:127], v244, s[20:23], s67 offen offset:3072 sc0 sc1
v_mfma_f32_16x16x32_bf16 v[168:171], a[64:67], a[128:131], v[168:171]
s_add_u32 s28, s33, 3
s_and_b32 s28, s28, 3
s_waitcnt lgkmcnt(8)
v_mfma_f32_16x16x32_bf16 v[172:175], a[72:75], a[128:131], v[172:175]
ds_read_b64_tr_b16 a[64:65], v216 offset:18440
ds_read_b64_tr_b16 a[66:67], v216 offset:23048
v_mfma_f32_16x16x32_bf16 v[172:175], a[76:79], a[132:135], v[172:175]
s_sub_u32 s28, s28, s33
s_lshl_b32 s28, s28, 16
v_mfma_f32_16x16x32_bf16 v[180:183], a[76:79], a[148:151], v[180:183]
s_add_u32 s64, s28, s44
s_add_u32 s65, s64, 4096
v_mfma_f32_16x16x32_bf16 v[180:183], a[72:75], a[144:147], v[180:183]
s_add_u32 s66, s64, 8192
s_add_u32 s67, s64, 12288
v_mfma_f32_16x16x32_bf16 v[188:191], a[72:75], a[160:163], v[188:191]
ds_read_b64_tr_b16 a[68:69], v216 offset:27656
ds_read_b64_tr_b16 a[70:71], v216 offset:32264
v_mfma_f32_16x16x32_bf16 v[188:191], a[76:79], a[164:167], v[188:191]
buffer_load_dwordx4 a[0:3], v244, s[20:23], s64 offen offset:0 sc0 sc1
v_mfma_f32_16x16x32_bf16 v[196:199], a[76:79], a[180:183], v[196:199]
v_mul_f32 v40, v40, v58
v_mul_f32 v41, v41, v59
v_mfma_f32_16x16x32_bf16 v[196:199], a[72:75], a[176:179], v[196:199]
v_cvt_pk_bf16_f32 v58, v40, v41
v_lshlrev_b32 v40, 16, v58
s_waitcnt lgkmcnt(8)
v_mfma_f32_16x16x32_bf16 v[212:215], a[80:83], a[176:179], v[212:215]
ds_read_b64_tr_b16 a[72:73], v217 offset:18432
ds_read_b64_tr_b16 a[74:75], v217 offset:23040
v_mfma_f32_16x16x32_bf16 v[212:215], a[84:87], a[180:183], v[212:215]
buffer_load_dwordx4 a[16:19], v244, s[20:23], s65 offen offset:0 sc0 sc1
v_mfma_f32_16x16x32_bf16 v[208:211], a[84:87], a[164:167], v[208:211]
v_and_b32 v41, 0xffff0000, v58
v_accvgpr_read_b32 v43, a224
v_mfma_f32_16x16x32_bf16 v[208:211], a[80:83], a[160:163], v[208:211]
v_accvgpr_read_b32 v59, a234
v_lshlrev_b32 v42, 16, v43
v_mfma_f32_16x16x32_bf16 v[204:207], a[80:83], a[144:147], v[204:207]
ds_read_b64_tr_b16 a[76:77], v217 offset:27648
ds_read_b64_tr_b16 a[78:79], v217 offset:32256
v_mfma_f32_16x16x32_bf16 v[204:207], a[84:87], a[148:151], v[204:207]
buffer_load_dwordx4 a[32:35], v244, s[20:23], s66 offen offset:0 sc0 sc1
v_mfma_f32_16x16x32_bf16 v[200:203], a[84:87], a[132:135], v[200:203]
v_and_b32 v43, 0xffff0000, v43
v_lshlrev_b32 v58, 16, v59
v_mfma_f32_16x16x32_bf16 v[200:203], a[80:83], a[128:131], v[200:203]
v_and_b32 v59, 0xffff0000, v59
v_add_f32 v42, v42, v58
s_waitcnt vmcnt(23)
s_waitcnt lgkmcnt(8)
v_mfma_f32_16x16x32_bf16 v[72:75], a[88:91], a[136:139], v[72:75]
ds_read_b64_tr_b16 a[80:81], v217 offset:18440
ds_read_b64_tr_b16 a[82:83], v217 offset:23048
s_waitcnt vmcnt(19)
v_mfma_f32_16x16x32_bf16 v[72:75], a[92:95], a[140:143], v[72:75]
buffer_load_dwordx4 a[48:51], v244, s[20:23], s67 offen offset:0 sc0 sc1
v_mfma_f32_16x16x32_bf16 v[80:83], a[92:95], a[156:159], v[80:83]
v_add_f32 v43, v43, v59
v_cvt_pk_bf16_f32 v58, v42, v43
v_mfma_f32_16x16x32_bf16 v[80:83], a[88:91], a[152:155], v[80:83]
v_lshlrev_b32 v42, 16, v58
v_and_b32 v43, 0xffff0000, v58
v_mfma_f32_16x16x32_bf16 v[88:91], a[88:91], a[168:171], v[88:91]
ds_read_b64_tr_b16 a[84:85], v217 offset:27656
ds_read_b64_tr_b16 a[86:87], v217 offset:32264
v_mfma_f32_16x16x32_bf16 v[88:91], a[92:95], a[172:175], v[88:91]
buffer_load_dwordx4 a[4:7], v244, s[20:23], s64 offen offset:1024 sc0 sc1
v_mfma_f32_16x16x32_bf16 v[96:99], a[92:95], a[188:191], v[96:99]
v_mul_f32 v58, 0xbfb8aa3b, v42
v_mul_f32 v59, 0xbfb8aa3b, v43
v_mfma_f32_16x16x32_bf16 v[96:99], a[88:91], a[184:187], v[96:99]
v_exp_f32 v58, v58
s_waitcnt lgkmcnt(8)
v_mfma_f32_16x16x32_bf16 v[100:103], a[64:67], a[184:187], v[100:103]
ds_read_b64_tr_b16 a[88:89], v216 offset:18560
ds_read_b64_tr_b16 a[90:91], v216 offset:23168
v_mfma_f32_16x16x32_bf16 v[100:103], a[68:71], a[188:191], v[100:103]
buffer_load_dwordx4 a[20:23], v244, s[20:23], s65 offen offset:1024 sc0 sc1
v_mfma_f32_16x16x32_bf16 v[92:95], a[68:71], a[172:175], v[92:95]
v_exp_f32 v59, v59
v_mfma_f32_16x16x32_bf16 v[92:95], a[64:67], a[168:171], v[92:95]
v_add_f32 v58, 1.0, v58
v_add_f32 v59, 1.0, v59
v_mfma_f32_16x16x32_bf16 v[84:87], a[64:67], a[152:155], v[84:87]
ds_read_b64_tr_b16 a[92:93], v216 offset:27776
ds_read_b64_tr_b16 a[94:95], v216 offset:32384
v_mfma_f32_16x16x32_bf16 v[84:87], a[68:71], a[156:159], v[84:87]
buffer_load_dwordx4 a[36:39], v244, s[20:23], s66 offen offset:1024 sc0 sc1
v_mfma_f32_16x16x32_bf16 v[76:79], a[68:71], a[140:143], v[76:79]
v_rcp_f32 v58, v58
v_mfma_f32_16x16x32_bf16 v[76:79], a[64:67], a[136:139], v[76:79]
v_rcp_f32 v59, v59
s_waitcnt lgkmcnt(8)
v_mfma_f32_16x16x32_bf16 v[104:107], a[72:75], a[136:139], v[104:107]
ds_read_b64_tr_b16 a[64:65], v216 offset:18568
ds_read_b64_tr_b16 a[66:67], v216 offset:23176
v_mfma_f32_16x16x32_bf16 v[104:107], a[76:79], a[140:143], v[104:107]
buffer_load_dwordx4 a[52:55], v244, s[20:23], s67 offen offset:1024 sc0 sc1
v_mfma_f32_16x16x32_bf16 v[112:115], a[76:79], a[156:159], v[112:115]
v_mul_f32 v42, v42, v58
v_mul_f32 v43, v43, v59
v_mfma_f32_16x16x32_bf16 v[112:115], a[72:75], a[152:155], v[112:115]
v_cvt_pk_bf16_f32 v58, v42, v43
v_lshlrev_b32 v42, 16, v58
v_mfma_f32_16x16x32_bf16 v[120:123], a[72:75], a[168:171], v[120:123]
ds_read_b64_tr_b16 a[68:69], v216 offset:27784
ds_read_b64_tr_b16 a[70:71], v216 offset:32392
v_mfma_f32_16x16x32_bf16 v[120:123], a[76:79], a[172:175], v[120:123]
buffer_load_dwordx4 a[8:11], v244, s[20:23], s64 offen offset:2048 sc0 sc1
v_mfma_f32_16x16x32_bf16 v[128:131], a[76:79], a[188:191], v[128:131]
v_and_b32 v43, 0xffff0000, v58
v_accvgpr_read_b32 v45, a225
v_mfma_f32_16x16x32_bf16 v[128:131], a[72:75], a[184:187], v[128:131]
v_accvgpr_read_b32 v59, a235
v_lshlrev_b32 v44, 16, v45
s_waitcnt lgkmcnt(8)
v_mfma_f32_16x16x32_bf16 v[132:135], a[80:83], a[184:187], v[132:135]
ds_read_b64_tr_b16 a[72:73], v217 offset:18560
ds_read_b64_tr_b16 a[74:75], v217 offset:23168
v_mfma_f32_16x16x32_bf16 v[132:135], a[84:87], a[188:191], v[132:135]
buffer_load_dwordx4 a[24:27], v244, s[20:23], s65 offen offset:2048 sc0 sc1
v_mfma_f32_16x16x32_bf16 v[124:127], a[84:87], a[172:175], v[124:127]
v_and_b32 v45, 0xffff0000, v45
v_lshlrev_b32 v58, 16, v59
v_mfma_f32_16x16x32_bf16 v[124:127], a[80:83], a[168:171], v[124:127]
v_and_b32 v59, 0xffff0000, v59
v_add_f32 v44, v44, v58
v_mfma_f32_16x16x32_bf16 v[116:119], a[80:83], a[152:155], v[116:119]
ds_read_b64_tr_b16 a[76:77], v217 offset:27776
ds_read_b64_tr_b16 a[78:79], v217 offset:32384
v_mfma_f32_16x16x32_bf16 v[116:119], a[84:87], a[156:159], v[116:119]
buffer_load_dwordx4 a[40:43], v244, s[20:23], s66 offen offset:2048 sc0 sc1
v_mfma_f32_16x16x32_bf16 v[108:111], a[84:87], a[140:143], v[108:111]
v_add_f32 v45, v45, v59
v_cvt_pk_bf16_f32 v58, v44, v45
v_mfma_f32_16x16x32_bf16 v[108:111], a[80:83], a[136:139], v[108:111]
v_lshlrev_b32 v44, 16, v58
v_and_b32 v45, 0xffff0000, v58
s_waitcnt lgkmcnt(8)
v_mfma_f32_16x16x32_bf16 v[136:139], a[88:91], a[136:139], v[136:139]
ds_read_b64_tr_b16 a[80:81], v217 offset:18568
ds_read_b64_tr_b16 a[82:83], v217 offset:23176
v_mfma_f32_16x16x32_bf16 v[136:139], a[92:95], a[140:143], v[136:139]
buffer_load_dwordx4 a[56:59], v244, s[20:23], s67 offen offset:2048 sc0 sc1
v_mfma_f32_16x16x32_bf16 v[144:147], a[92:95], a[156:159], v[144:147]
v_mul_f32 v58, 0xbfb8aa3b, v44
v_mul_f32 v59, 0xbfb8aa3b, v45
v_mfma_f32_16x16x32_bf16 v[144:147], a[88:91], a[152:155], v[144:147]
v_exp_f32 v58, v58
v_mfma_f32_16x16x32_bf16 v[152:155], a[88:91], a[168:171], v[152:155]
ds_read_b64_tr_b16 a[84:85], v217 offset:27784
ds_read_b64_tr_b16 a[86:87], v217 offset:32392
v_mfma_f32_16x16x32_bf16 v[152:155], a[92:95], a[172:175], v[152:155]
buffer_load_dwordx4 a[12:15], v244, s[20:23], s64 offen offset:3072 sc0 sc1
v_mfma_f32_16x16x32_bf16 v[160:163], a[92:95], a[188:191], v[160:163]
v_exp_f32 v59, v59
v_mfma_f32_16x16x32_bf16 v[160:163], a[88:91], a[184:187], v[160:163]
v_add_f32 v58, 1.0, v58
v_add_f32 v59, 1.0, v59
s_waitcnt lgkmcnt(8)
v_mfma_f32_16x16x32_bf16 v[164:167], a[64:67], a[184:187], v[164:167]
ds_read_b64_tr_b16 a[88:89], v218 offset:18432
ds_read_b64_tr_b16 a[90:91], v218 offset:23040
v_mfma_f32_16x16x32_bf16 v[164:167], a[68:71], a[188:191], v[164:167]
buffer_load_dwordx4 a[28:31], v244, s[20:23], s65 offen offset:3072 sc0 sc1
v_mfma_f32_16x16x32_bf16 v[156:159], a[68:71], a[172:175], v[156:159]
v_rcp_f32 v58, v58
v_mfma_f32_16x16x32_bf16 v[156:159], a[64:67], a[168:171], v[156:159]
v_rcp_f32 v59, v59
v_mfma_f32_16x16x32_bf16 v[148:151], a[64:67], a[152:155], v[148:151]
ds_read_b64_tr_b16 a[92:93], v218 offset:27648
ds_read_b64_tr_b16 a[94:95], v218 offset:32256
v_mfma_f32_16x16x32_bf16 v[148:151], a[68:71], a[156:159], v[148:151]
buffer_load_dwordx4 a[44:47], v244, s[20:23], s66 offen offset:3072 sc0 sc1
v_mfma_f32_16x16x32_bf16 v[140:143], a[68:71], a[140:143], v[140:143]
v_mul_f32 v44, v44, v58
v_mul_f32 v45, v45, v59
v_mfma_f32_16x16x32_bf16 v[140:143], a[64:67], a[136:139], v[140:143]
v_cvt_pk_bf16_f32 v58, v44, v45
v_lshlrev_b32 v44, 16, v58
s_waitcnt lgkmcnt(8)
v_mfma_f32_16x16x32_bf16 v[168:171], a[72:75], a[136:139], v[168:171]
ds_read_b64_tr_b16 a[64:65], v220 offset:0
ds_read_b64_tr_b16 a[66:67], v220 offset:4608
v_mfma_f32_16x16x32_bf16 v[168:171], a[76:79], a[140:143], v[168:171]
buffer_load_dwordx4 a[60:63], v244, s[20:23], s67 offen offset:3072 sc0 sc1
v_mfma_f32_16x16x32_bf16 v[176:179], a[76:79], a[156:159], v[176:179]
s_lshl2_add_u32 s28, s36, s33
s_lshl2_add_u32 s28, s28, s37
v_mfma_f32_16x16x32_bf16 v[176:179], a[72:75], a[152:155], v[176:179]
s_lshl_b32 s95, s28, 5
s_add_u32 s95, s95, 0x24a000
v_mfma_f32_16x16x32_bf16 v[184:187], a[72:75], a[168:171], v[184:187]
ds_read_b64_tr_b16 a[68:69], v220 offset:9216
ds_read_b64_tr_b16 a[70:71], v220 offset:13824
v_mfma_f32_16x16x32_bf16 v[184:187], a[76:79], a[172:175], v[184:187]
s_lshl_b32 s28, s32, 18
s_sub_u32 s49, s44, s28
v_mfma_f32_16x16x32_bf16 v[192:195], a[76:79], a[188:191], v[192:195]
v_add_u32 v243, 0x2000, v244
v_mov_b32 v246, 2
v_mfma_f32_16x16x32_bf16 v[192:195], a[72:75], a[184:187], v[192:195]
s_lshl2_add_u32 s29, s33, s94
v_and_b32 v45, 0xffff0000, v58
s_waitcnt lgkmcnt(8)
v_mfma_f32_16x16x32_bf16 v[196:199], a[80:83], a[184:187], v[196:199]
ds_read_b64_tr_b16 a[72:73], v220 offset:18432
ds_read_b64_tr_b16 a[74:75], v220 offset:23040
v_mfma_f32_16x16x32_bf16 v[196:199], a[84:87], a[188:191], v[196:199]
v_accvgpr_read_b32 v47, a226
v_accvgpr_read_b32 v59, a236
v_mfma_f32_16x16x32_bf16 v[188:191], a[84:87], a[172:175], v[188:191]
v_lshlrev_b32 v46, 16, v47
v_and_b32 v47, 0xffff0000, v47
v_mfma_f32_16x16x32_bf16 v[188:191], a[80:83], a[168:171], v[188:191]
v_lshlrev_b32 v58, 16, v59
v_and_b32 v59, 0xffff0000, v59
v_mfma_f32_16x16x32_bf16 v[180:183], a[80:83], a[152:155], v[180:183]
ds_read_b64_tr_b16 a[76:77], v220 offset:27648
ds_read_b64_tr_b16 a[78:79], v220 offset:32256
v_mfma_f32_16x16x32_bf16 v[180:183], a[84:87], a[156:159], v[180:183]
v_add_f32 v46, v46, v58
v_add_f32 v47, v47, v59
v_mfma_f32_16x16x32_bf16 v[172:175], a[84:87], a[140:143], v[172:175]
v_cvt_pk_bf16_f32 v58, v46, v47
v_lshlrev_b32 v46, 16, v58
v_mfma_f32_16x16x32_bf16 v[172:175], a[80:83], a[136:139], v[172:175]
v_and_b32 v47, 0xffff0000, v58
v_mul_f32 v58, 0xbfb8aa3b, v46
s_waitcnt lgkmcnt(8)
v_mfma_f32_16x16x32_bf16 v[200:203], a[88:91], a[136:139], v[200:203]
ds_read_b64_tr_b16 a[80:81], v223 offset:0
ds_read_b64_tr_b16 a[82:83], v223 offset:4608
v_mfma_f32_16x16x32_bf16 v[200:203], a[92:95], a[140:143], v[200:203]
v_mul_f32 v59, 0xbfb8aa3b, v47
v_mfma_f32_16x16x32_bf16 v[204:207], a[92:95], a[156:159], v[204:207]
v_exp_f32 v58, v58
v_mfma_f32_16x16x32_bf16 v[204:207], a[88:91], a[152:155], v[204:207]
v_exp_f32 v59, v59
v_mfma_f32_16x16x32_bf16 v[208:211], a[88:91], a[168:171], v[208:211]
ds_read_b64_tr_b16 a[84:85], v223 offset:9216
ds_read_b64_tr_b16 a[86:87], v223 offset:13824
v_mfma_f32_16x16x32_bf16 v[208:211], a[92:95], a[172:175], v[208:211]
v_add_f32 v58, 1.0, v58
v_add_f32 v59, 1.0, v59
v_mfma_f32_16x16x32_bf16 v[212:215], a[92:95], a[188:191], v[212:215]
v_rcp_f32 v58, v58
v_mfma_f32_16x16x32_bf16 v[212:215], a[88:91], a[184:187], v[212:215]
v_rcp_f32 v59, v59
s_waitcnt vmcnt(28)
s_waitcnt lgkmcnt(8)
v_mfma_f32_16x16x32_bf16 v[128:131], a[64:67], a[112:115], v[128:131]
ds_read_b64_tr_b16 a[88:89], v223 offset:18432
ds_read_b64_tr_b16 a[90:91], v223 offset:23040
s_waitcnt vmcnt(24)
v_mfma_f32_16x16x32_bf16 v[128:131], a[68:71], a[116:119], v[128:131]
v_mul_f32 v46, v46, v58
v_mul_f32 v47, v47, v59
v_mfma_f32_16x16x32_bf16 v[120:123], a[68:71], a[100:103], v[120:123]
v_cvt_pk_bf16_f32 v58, v46, v47
v_lshlrev_b32 v46, 16, v58
v_mfma_f32_16x16x32_bf16 v[120:123], a[64:67], a[96:99], v[120:123]
v_and_b32 v47, 0xffff0000, v58
v_accvgpr_read_b32 v49, a227
v_mfma_f32_16x16x32_bf16 v[112:115], a[64:67], a[208:211], v[112:115]
ds_read_b64_tr_b16 a[92:93], v223 offset:27648
ds_read_b64_tr_b16 a[94:95], v223 offset:32256
v_mfma_f32_16x16x32_bf16 v[112:115], a[68:71], a[244:247], v[112:115]
v_accvgpr_read_b32 v59, a237
v_lshlrev_b32 v48, 16, v49
v_mfma_f32_16x16x32_bf16 v[104:107], a[68:71], a[196:199], v[104:107]
v_and_b32 v49, 0xffff0000, v49
v_lshlrev_b32 v58, 16, v59
v_mfma_f32_16x16x32_bf16 v[104:107], a[64:67], a[192:195], v[104:107]
s_waitcnt vmcnt(0)
buffer_store_dword v246, v254, s[20:23], s29 offen sc0 sc1
s_waitcnt vmcnt(21)
s_waitcnt lgkmcnt(8)
v_mfma_f32_16x16x32_bf16 v[104:107], a[72:75], a[200:203], v[104:107]
ds_read_b64_tr_b16 a[64:65], v220 offset:8
ds_read_b64_tr_b16 a[66:67], v220 offset:4616
s_waitcnt vmcnt(17)
v_mfma_f32_16x16x32_bf16 v[104:107], a[76:79], a[204:207], v[104:107]
s_xor_b32 s28, s32, 0
s_sub_u32 s29, s32, s28
v_mfma_f32_16x16x32_bf16 v[112:115], a[76:79], a[252:255], v[112:115]
s_lshl_b32 s28, s28, 18
s_and_b32 s29, s29, 3
v_mfma_f32_16x16x32_bf16 v[112:115], a[72:75], a[248:251], v[112:115]
s_add_u32 s28, s28, s49
s_lshl_b32 s50, s29, 10
v_mfma_f32_16x16x32_bf16 v[120:123], a[72:75], a[104:107], v[120:123]
ds_read_b64_tr_b16 a[68:69], v220 offset:9224
ds_read_b64_tr_b16 a[70:71], v220 offset:13832
v_mfma_f32_16x16x32_bf16 v[120:123], a[76:79], a[108:111], v[120:123]
s_mul_i32 s29, s29, 0x1200
s_and_b32 s29, s29, 0x2200
v_mfma_f32_16x16x32_bf16 v[128:131], a[76:79], a[124:127], v[128:131]
s_add_u32 s72, s28, s29
v_and_b32 v59, 0xffff0000, v59
v_mfma_f32_16x16x32_bf16 v[128:131], a[72:75], a[120:123], v[128:131]
s_xor_b32 s28, s32, 1
s_sub_u32 s29, s32, s28
s_waitcnt vmcnt(13)
s_waitcnt lgkmcnt(8)
v_mfma_f32_16x16x32_bf16 v[128:131], a[80:83], a[48:51], v[128:131]
ds_read_b64_tr_b16 a[72:73], v220 offset:18440
ds_read_b64_tr_b16 a[74:75], v220 offset:23048
s_waitcnt vmcnt(9)
v_mfma_f32_16x16x32_bf16 v[128:131], a[84:87], a[52:55], v[128:131]
s_lshl_b32 s28, s28, 18
s_and_b32 s29, s29, 3
v_mfma_f32_16x16x32_bf16 v[120:123], a[84:87], a[36:39], v[120:123]
s_add_u32 s28, s28, s49
s_lshl_b32 s50, s29, 10
v_mfma_f32_16x16x32_bf16 v[120:123], a[80:83], a[32:35], v[120:123]
s_add_u32 s65, s28, s50
v_add_f32 v48, v48, v58
v_mfma_f32_16x16x32_bf16 v[112:115], a[80:83], a[16:19], v[112:115]
ds_read_b64_tr_b16 a[76:77], v220 offset:27656
ds_read_b64_tr_b16 a[78:79], v220 offset:32264
v_mfma_f32_16x16x32_bf16 v[112:115], a[84:87], a[20:23], v[112:115]
s_mul_i32 s29, s29, 0x1200
s_and_b32 s29, s29, 0x2200
v_mfma_f32_16x16x32_bf16 v[104:107], a[84:87], a[4:7], v[104:107]
s_add_u32 s73, s28, s29
v_add_f32 v49, v49, v59
v_mfma_f32_16x16x32_bf16 v[104:107], a[80:83], a[0:3], v[104:107]
s_xor_b32 s28, s32, 2
s_sub_u32 s29, s32, s28
s_waitcnt vmcnt(5)
s_waitcnt lgkmcnt(8)
v_mfma_f32_16x16x32_bf16 v[104:107], a[88:91], a[8:11], v[104:107]
ds_read_b64_tr_b16 a[80:81], v223 offset:8
ds_read_b64_tr_b16 a[82:83], v223 offset:4616
s_waitcnt vmcnt(1)
v_mfma_f32_16x16x32_bf16 v[104:107], a[92:95], a[12:15], v[104:107]
s_lshl_b32 s28, s28, 18
s_and_b32 s29, s29, 3
v_mfma_f32_16x16x32_bf16 v[112:115], a[92:95], a[28:31], v[112:115]
s_add_u32 s28, s28, s49
s_lshl_b32 s50, s29, 10
v_mfma_f32_16x16x32_bf16 v[112:115], a[88:91], a[24:27], v[112:115]
s_add_u32 s66, s28, s50
v_cvt_pk_bf16_f32 v58, v48, v49
v_mfma_f32_16x16x32_bf16 v[120:123], a[88:91], a[40:43], v[120:123]
ds_read_b64_tr_b16 a[84:85], v223 offset:9224
ds_read_b64_tr_b16 a[86:87], v223 offset:13832
v_mfma_f32_16x16x32_bf16 v[120:123], a[92:95], a[44:47], v[120:123]
s_mul_i32 s29, s29, 0x1200
s_and_b32 s29, s29, 0x2200
v_mfma_f32_16x16x32_bf16 v[128:131], a[92:95], a[60:63], v[128:131]
s_add_u32 s74, s28, s29
v_lshlrev_b32 v48, 16, v58
v_mfma_f32_16x16x32_bf16 v[128:131], a[88:91], a[56:59], v[128:131]
s_xor_b32 s28, s32, 3
s_sub_u32 s29, s32, s28
s_waitcnt lgkmcnt(8)
v_mfma_f32_16x16x32_bf16 v[132:135], a[64:67], a[112:115], v[132:135]
ds_read_b64_tr_b16 a[88:89], v223 offset:18440
ds_read_b64_tr_b16 a[90:91], v223 offset:23048
v_mfma_f32_16x16x32_bf16 v[132:135], a[68:71], a[116:119], v[132:135]
s_lshl_b32 s28, s28, 18
s_and_b32 s29, s29, 3
v_mfma_f32_16x16x32_bf16 v[124:127], a[68:71], a[100:103], v[124:127]
s_add_u32 s28, s28, s49
s_lshl_b32 s50, s29, 10
v_mfma_f32_16x16x32_bf16 v[124:127], a[64:67], a[96:99], v[124:127]
s_add_u32 s67, s28, s50
v_and_b32 v49, 0xffff0000, v58
v_mfma_f32_16x16x32_bf16 v[116:119], a[64:67], a[208:211], v[116:119]
ds_read_b64_tr_b16 a[92:93], v223 offset:27656
ds_read_b64_tr_b16 a[94:95], v223 offset:32264
v_mfma_f32_16x16x32_bf16 v[116:119], a[68:71], a[244:247], v[116:119]
s_mul_i32 s29, s29, 0x1200
s_and_b32 s29, s29, 0x2200
v_mfma_f32_16x16x32_bf16 v[108:111], a[68:71], a[196:199], v[108:111]
s_add_u32 s75, s28, s29
v_mul_f32 v58, 0xbfb8aa3b, v48
v_mfma_f32_16x16x32_bf16 v[108:111], a[64:67], a[192:195], v[108:111]
buffer_load_dword v230, v229, s[20:23], s94 offen sc0 sc1
s_waitcnt lgkmcnt(8)
v_mfma_f32_16x16x32_bf16 v[108:111], a[72:75], a[200:203], v[108:111]
ds_read_b64_tr_b16 a[64:65], v220 offset:128
ds_read_b64_tr_b16 a[66:67], v220 offset:4736
v_mfma_f32_16x16x32_bf16 v[108:111], a[76:79], a[204:207], v[108:111]
s_xor_b32 s28, s32, 4
s_sub_u32 s29, s32, s28
v_mfma_f32_16x16x32_bf16 v[116:119], a[76:79], a[252:255], v[116:119]
s_lshl_b32 s28, s28, 18
s_and_b32 s29, s29, 3
v_mfma_f32_16x16x32_bf16 v[116:119], a[72:75], a[248:251], v[116:119]
s_add_u32 s28, s28, s49
s_lshl_b32 s50, s29, 10
v_mfma_f32_16x16x32_bf16 v[124:127], a[72:75], a[104:107], v[124:127]
ds_read_b64_tr_b16 a[68:69], v220 offset:9344
ds_read_b64_tr_b16 a[70:71], v220 offset:13952
v_mfma_f32_16x16x32_bf16 v[124:127], a[76:79], a[108:111], v[124:127]
s_add_u32 s68, s28, s50
s_add_u32 s68, s68, 4096
v_mfma_f32_16x16x32_bf16 v[132:135], a[76:79], a[124:127], v[132:135]
s_mul_i32 s29, s29, 0x1200
s_and_b32 s29, s29, 0x2200
v_mfma_f32_16x16x32_bf16 v[132:135], a[72:75], a[120:123], v[132:135]
s_add_u32 s84, s28, s29
v_mul_f32 v59, 0xbfb8aa3b, v49
s_waitcnt lgkmcnt(8)
v_mfma_f32_16x16x32_bf16 v[132:135], a[80:83], a[48:51], v[132:135]
ds_read_b64_tr_b16 a[72:73], v220 offset:18560
ds_read_b64_tr_b16 a[74:75], v220 offset:23168
v_mfma_f32_16x16x32_bf16 v[132:135], a[84:87], a[52:55], v[132:135]
s_xor_b32 s28, s32, 5
s_sub_u32 s29, s32, s28
v_mfma_f32_16x16x32_bf16 v[124:127], a[84:87], a[36:39], v[124:127]
s_lshl_b32 s28, s28, 18
s_and_b32 s29, s29, 3
v_mfma_f32_16x16x32_bf16 v[124:127], a[80:83], a[32:35], v[124:127]
s_add_u32 s28, s28, s49
s_lshl_b32 s50, s29, 10
v_mfma_f32_16x16x32_bf16 v[116:119], a[80:83], a[16:19], v[116:119]
ds_read_b64_tr_b16 a[76:77], v220 offset:27776
ds_read_b64_tr_b16 a[78:79], v220 offset:32384
v_mfma_f32_16x16x32_bf16 v[116:119], a[84:87], a[20:23], v[116:119]
s_add_u32 s69, s28, s50
s_add_u32 s69, s69, 4096
v_mfma_f32_16x16x32_bf16 v[108:111], a[84:87], a[4:7], v[108:111]
s_mul_i32 s29, s29, 0x1200
s_and_b32 s29, s29, 0x2200
v_mfma_f32_16x16x32_bf16 v[108:111], a[80:83], a[0:3], v[108:111]
s_add_u32 s85, s28, s29
s_waitcnt lgkmcnt(8)
v_mfma_f32_16x16x32_bf16 v[108:111], a[88:91], a[8:11], v[108:111]
ds_read_b64_tr_b16 a[80:81], v223 offset:128
ds_read_b64_tr_b16 a[82:83], v223 offset:4736
v_mfma_f32_16x16x32_bf16 v[108:111], a[92:95], a[12:15], v[108:111]
s_xor_b32 s28, s32, 6
s_sub_u32 s29, s32, s28
v_mfma_f32_16x16x32_bf16 v[116:119], a[92:95], a[28:31], v[116:119]
s_lshl_b32 s28, s28, 18
s_and_b32 s29, s29, 3
v_mfma_f32_16x16x32_bf16 v[116:119], a[88:91], a[24:27], v[116:119]
s_add_u32 s28, s28, s49
s_lshl_b32 s50, s29, 10
v_mfma_f32_16x16x32_bf16 v[124:127], a[88:91], a[40:43], v[124:127]
ds_read_b64_tr_b16 a[84:85], v223 offset:9344
ds_read_b64_tr_b16 a[86:87], v223 offset:13952
v_mfma_f32_16x16x32_bf16 v[124:127], a[92:95], a[44:47], v[124:127]
s_add_u32 s70, s28, s50
s_add_u32 s70, s70, 4096
v_mfma_f32_16x16x32_bf16 v[132:135], a[92:95], a[60:63], v[132:135]
s_mul_i32 s29, s29, 0x1200
s_and_b32 s29, s29, 0x2200
v_mfma_f32_16x16x32_bf16 v[132:135], a[88:91], a[56:59], v[132:135]
s_add_u32 s86, s28, s29
s_waitcnt lgkmcnt(8)
v_mfma_f32_16x16x32_bf16 v[192:195], a[64:67], a[112:115], v[192:195]
ds_read_b64_tr_b16 a[88:89], v223 offset:18560
ds_read_b64_tr_b16 a[90:91], v223 offset:23168
v_mfma_f32_16x16x32_bf16 v[192:195], a[68:71], a[116:119], v[192:195]
s_xor_b32 s28, s32, 7
s_sub_u32 s29, s32, s28
v_mfma_f32_16x16x32_bf16 v[184:187], a[68:71], a[100:103], v[184:187]
s_lshl_b32 s28, s28, 18
s_and_b32 s29, s29, 3
v_mfma_f32_16x16x32_bf16 v[184:187], a[64:67], a[96:99], v[184:187]
s_add_u32 s28, s28, s49
s_lshl_b32 s50, s29, 10
v_mfma_f32_16x16x32_bf16 v[176:179], a[64:67], a[208:211], v[176:179]
ds_read_b64_tr_b16 a[92:93], v223 offset:27776
ds_read_b64_tr_b16 a[94:95], v223 offset:32384
v_mfma_f32_16x16x32_bf16 v[176:179], a[68:71], a[244:247], v[176:179]
s_add_u32 s71, s28, s50
s_add_u32 s71, s71, 4096
v_mfma_f32_16x16x32_bf16 v[168:171], a[68:71], a[196:199], v[168:171]
s_mul_i32 s29, s29, 0x1200
s_and_b32 s29, s29, 0x2200
v_mfma_f32_16x16x32_bf16 v[168:171], a[64:67], a[192:195], v[168:171]
s_add_u32 s87, s28, s29
s_waitcnt lgkmcnt(8)
v_mfma_f32_16x16x32_bf16 v[168:171], a[72:75], a[200:203], v[168:171]
ds_read_b64_tr_b16 a[64:65], v220 offset:136
ds_read_b64_tr_b16 a[66:67], v220 offset:4744
v_mfma_f32_16x16x32_bf16 v[168:171], a[76:79], a[204:207], v[168:171]
s_waitcnt vmcnt(0)
v_cmp_gt_u32 vcc, 2, v230
v_mfma_f32_16x16x32_bf16 v[176:179], a[76:79], a[252:255], v[176:179]
v_exp_f32 v58, v58
v_mfma_f32_16x16x32_bf16 v[176:179], a[72:75], a[248:251], v[176:179]
s_and_b32 s29, vcc_lo, 15
s_cbranch_scc1 SP_O3B
SP_O3B_RET:
v_mfma_f32_16x16x32_bf16 v[184:187], a[72:75], a[104:107], v[184:187]
ds_read_b64_tr_b16 a[68:69], v220 offset:9352
ds_read_b64_tr_b16 a[70:71], v220 offset:13960
v_mfma_f32_16x16x32_bf16 v[184:187], a[76:79], a[108:111], v[184:187]
s_add_u32 s39, s44, 4096
v_mfma_f32_16x16x32_bf16 v[192:195], a[76:79], a[124:127], v[192:195]
v_cvt_pk_bf16_f32 v104, v104, v105
v_cvt_pk_bf16_f32 v105, v106, v107
v_mfma_f32_16x16x32_bf16 v[192:195], a[72:75], a[120:123], v[192:195]
v_cvt_pk_bf16_f32 v106, v108, v109
v_cvt_pk_bf16_f32 v107, v110, v111
s_waitcnt lgkmcnt(8)
v_mfma_f32_16x16x32_bf16 v[192:195], a[80:83], a[48:51], v[192:195]
ds_read_b64_tr_b16 a[72:73], v220 offset:18568
ds_read_b64_tr_b16 a[74:75], v220 offset:23176
v_mfma_f32_16x16x32_bf16 v[192:195], a[84:87], a[52:55], v[192:195]
buffer_store_dwordx4 v[104:107], v244, s[20:23], s39 offen offset:0 sc0 sc1
v_mfma_f32_16x16x32_bf16 v[184:187], a[84:87], a[36:39], v[184:187]
v_cvt_pk_bf16_f32 v112, v112, v113
v_cvt_pk_bf16_f32 v113, v114, v115
v_mfma_f32_16x16x32_bf16 v[184:187], a[80:83], a[32:35], v[184:187]
v_cvt_pk_bf16_f32 v114, v116, v117
v_cvt_pk_bf16_f32 v115, v118, v119
v_mfma_f32_16x16x32_bf16 v[176:179], a[80:83], a[16:19], v[176:179]
ds_read_b64_tr_b16 a[76:77], v220 offset:27784
ds_read_b64_tr_b16 a[78:79], v220 offset:32392
v_mfma_f32_16x16x32_bf16 v[176:179], a[84:87], a[20:23], v[176:179]
buffer_store_dwordx4 v[112:115], v244, s[20:23], s39 offen offset:1024 sc0 sc1
v_mfma_f32_16x16x32_bf16 v[168:171], a[84:87], a[4:7], v[168:171]
v_cvt_pk_bf16_f32 v120, v120, v121
v_cvt_pk_bf16_f32 v121, v122, v123
v_mfma_f32_16x16x32_bf16 v[168:171], a[80:83], a[0:3], v[168:171]
v_cvt_pk_bf16_f32 v122, v124, v125
v_cvt_pk_bf16_f32 v123, v126, v127
s_waitcnt lgkmcnt(8)
v_mfma_f32_16x16x32_bf16 v[168:171], a[88:91], a[8:11], v[168:171]
ds_read_b64_tr_b16 a[80:81], v223 offset:136
ds_read_b64_tr_b16 a[82:83], v223 offset:4744
v_mfma_f32_16x16x32_bf16 v[168:171], a[92:95], a[12:15], v[168:171]
buffer_store_dwordx4 v[120:123], v244, s[20:23], s39 offen offset:2048 sc0 sc1
v_mfma_f32_16x16x32_bf16 v[176:179], a[92:95], a[28:31], v[176:179]
v_cvt_pk_bf16_f32 v128, v128, v129
v_cvt_pk_bf16_f32 v129, v130, v131
v_mfma_f32_16x16x32_bf16 v[176:179], a[88:91], a[24:27], v[176:179]
v_cvt_pk_bf16_f32 v130, v132, v133
v_cvt_pk_bf16_f32 v131, v134, v135
v_mfma_f32_16x16x32_bf16 v[184:187], a[88:91], a[40:43], v[184:187]
ds_read_b64_tr_b16 a[84:85], v223 offset:9352
ds_read_b64_tr_b16 a[86:87], v223 offset:13960
v_mfma_f32_16x16x32_bf16 v[184:187], a[92:95], a[44:47], v[184:187]
buffer_store_dwordx4 v[128:131], v244, s[20:23], s39 offen offset:3072 sc0 sc1
v_mfma_f32_16x16x32_bf16 v[192:195], a[92:95], a[60:63], v[192:195]
v_exp_f32 v59, v59
v_mfma_f32_16x16x32_bf16 v[192:195], a[88:91], a[56:59], v[192:195]
v_add_f32 v58, 1.0, v58
v_add_f32 v59, 1.0, v59
s_waitcnt lgkmcnt(8)
v_mfma_f32_16x16x32_bf16 v[196:199], a[64:67], a[112:115], v[196:199]
ds_read_b64_tr_b16 a[88:89], v223 offset:18568
ds_read_b64_tr_b16 a[90:91], v223 offset:23176
v_mfma_f32_16x16x32_bf16 v[196:199], a[68:71], a[116:119], v[196:199]
v_rcp_f32 v58, v58
v_mfma_f32_16x16x32_bf16 v[188:191], a[68:71], a[100:103], v[188:191]
v_rcp_f32 v59, v59
v_mfma_f32_16x16x32_bf16 v[188:191], a[64:67], a[96:99], v[188:191]
v_mul_f32 v48, v48, v58
v_mul_f32 v49, v49, v59
v_mfma_f32_16x16x32_bf16 v[180:183], a[64:67], a[208:211], v[180:183]
ds_read_b64_tr_b16 a[92:93], v223 offset:27784
ds_read_b64_tr_b16 a[94:95], v223 offset:32392
v_mfma_f32_16x16x32_bf16 v[180:183], a[68:71], a[244:247], v[180:183]
v_cvt_pk_bf16_f32 v58, v48, v49
v_lshlrev_b32 v48, 16, v58
v_mfma_f32_16x16x32_bf16 v[172:175], a[68:71], a[196:199], v[172:175]
v_and_b32 v49, 0xffff0000, v58
v_accvgpr_read_b32 v51, a228
v_mfma_f32_16x16x32_bf16 v[172:175], a[64:67], a[192:195], v[172:175]
v_accvgpr_read_b32 v59, a238
v_lshlrev_b32 v50, 16, v51
s_waitcnt lgkmcnt(8)
v_mfma_f32_16x16x32_bf16 v[172:175], a[72:75], a[200:203], v[172:175]
ds_read_b64_tr_b16 a[64:65], v221 offset:0
ds_read_b64_tr_b16 a[66:67], v221 offset:4608
v_mfma_f32_16x16x32_bf16 v[172:175], a[76:79], a[204:207], v[172:175]
v_and_b32 v51, 0xffff0000, v51
v_lshlrev_b32 v58, 16, v59
v_mfma_f32_16x16x32_bf16 v[180:183], a[76:79], a[252:255], v[180:183]
v_and_b32 v59, 0xffff0000, v59
v_add_f32 v50, v50, v58
v_mfma_f32_16x16x32_bf16 v[180:183], a[72:75], a[248:251], v[180:183]
v_add_f32 v51, v51, v59
v_cvt_pk_bf16_f32 v58, v50, v51
v_mfma_f32_16x16x32_bf16 v[188:191], a[72:75], a[104:107], v[188:191]
ds_read_b64_tr_b16 a[68:69], v221 offset:9216
ds_read_b64_tr_b16 a[70:71], v221 offset:13824
v_mfma_f32_16x16x32_bf16 v[188:191], a[76:79], a[108:111], v[188:191]
v_lshlrev_b32 v50, 16, v58
v_and_b32 v51, 0xffff0000, v58
v_mfma_f32_16x16x32_bf16 v[196:199], a[76:79], a[124:127], v[196:199]
v_mul_f32 v58, 0xbfb8aa3b, v50
v_mul_f32 v59, 0xbfb8aa3b, v51
v_mfma_f32_16x16x32_bf16 v[196:199], a[72:75], a[120:123], v[196:199]
v_exp_f32 v58, v58
s_waitcnt lgkmcnt(8)
v_mfma_f32_16x16x32_bf16 v[196:199], a[80:83], a[48:51], v[196:199]
ds_read_b64_tr_b16 a[72:73], v221 offset:18432
ds_read_b64_tr_b16 a[74:75], v221 offset:23040
v_mfma_f32_16x16x32_bf16 v[196:199], a[84:87], a[52:55], v[196:199]
v_exp_f32 v59, v59
v_mfma_f32_16x16x32_bf16 v[188:191], a[84:87], a[36:39], v[188:191]
v_add_f32 v58, 1.0, v58
v_add_f32 v59, 1.0, v59
v_mfma_f32_16x16x32_bf16 v[188:191], a[80:83], a[32:35], v[188:191]
v_rcp_f32 v58, v58
v_mfma_f32_16x16x32_bf16 v[180:183], a[80:83], a[16:19], v[180:183]
ds_read_b64_tr_b16 a[76:77], v221 offset:27648
ds_read_b64_tr_b16 a[78:79], v221 offset:32256
v_mfma_f32_16x16x32_bf16 v[180:183], a[84:87], a[20:23], v[180:183]
v_rcp_f32 v59, v59
v_mfma_f32_16x16x32_bf16 v[172:175], a[84:87], a[4:7], v[172:175]
v_mul_f32 v50, v50, v58
v_mul_f32 v51, v51, v59
v_mfma_f32_16x16x32_bf16 v[172:175], a[80:83], a[0:3], v[172:175]
v_cvt_pk_bf16_f32 v58, v50, v51
v_lshlrev_b32 v50, 16, v58
s_waitcnt lgkmcnt(8)
v_mfma_f32_16x16x32_bf16 v[172:175], a[88:91], a[8:11], v[172:175]
ds_read_b64_tr_b16 a[80:81], v224 offset:0
ds_read_b64_tr_b16 a[82:83], v224 offset:4608
v_mfma_f32_16x16x32_bf16 v[172:175], a[92:95], a[12:15], v[172:175]
v_and_b32 v51, 0xffff0000, v58
v_accvgpr_read_b32 v53, a229
v_mfma_f32_16x16x32_bf16 v[180:183], a[92:95], a[28:31], v[180:183]
v_accvgpr_read_b32 v59, a239
v_lshlrev_b32 v52, 16, v53
v_mfma_f32_16x16x32_bf16 v[180:183], a[88:91], a[24:27], v[180:183]
v_and_b32 v53, 0xffff0000, v53
v_lshlrev_b32 v58, 16, v59
v_mfma_f32_16x16x32_bf16 v[188:191], a[88:91], a[40:43], v[188:191]
ds_read_b64_tr_b16 a[84:85], v224 offset:9216
ds_read_b64_tr_b16 a[86:87], v224 offset:13824
v_mfma_f32_16x16x32_bf16 v[188:191], a[92:95], a[44:47], v[188:191]
v_and_b32 v59, 0xffff0000, v59
v_add_f32 v52, v52, v58
v_mfma_f32_16x16x32_bf16 v[196:199], a[92:95], a[60:63], v[196:199]
v_add_f32 v53, v53, v59
v_cvt_pk_bf16_f32 v58, v52, v53
v_mfma_f32_16x16x32_bf16 v[196:199], a[88:91], a[56:59], v[196:199]
v_lshlrev_b32 v52, 16, v58
v_and_b32 v53, 0xffff0000, v58
s_waitcnt lgkmcnt(8)
v_mfma_f32_16x16x32_bf16 v[212:215], a[64:67], a[112:115], v[212:215]
ds_read_b64_tr_b16 a[88:89], v224 offset:18432
ds_read_b64_tr_b16 a[90:91], v224 offset:23040
v_mfma_f32_16x16x32_bf16 v[212:215], a[68:71], a[116:119], v[212:215]
v_mul_f32 v58, 0xbfb8aa3b, v52
v_mul_f32 v59, 0xbfb8aa3b, v53
v_mfma_f32_16x16x32_bf16 v[208:211], a[68:71], a[100:103], v[208:211]
v_exp_f32 v58, v58
v_mfma_f32_16x16x32_bf16 v[208:211], a[64:67], a[96:99], v[208:211]
v_exp_f32 v59, v59
v_mfma_f32_16x16x32_bf16 v[204:207], a[64:67], a[208:211], v[204:207]
ds_read_b64_tr_b16 a[92:93], v224 offset:27648
ds_read_b64_tr_b16 a[94:95], v224 offset:32256
v_mfma_f32_16x16x32_bf16 v[204:207], a[68:71], a[244:247], v[204:207]
v_add_f32 v58, 1.0, v58
v_add_f32 v59, 1.0, v59
v_mfma_f32_16x16x32_bf16 v[200:203], a[68:71], a[196:199], v[200:203]
v_rcp_f32 v58, v58
v_mfma_f32_16x16x32_bf16 v[200:203], a[64:67], a[192:195], v[200:203]
v_rcp_f32 v59, v59
s_waitcnt lgkmcnt(8)
v_mfma_f32_16x16x32_bf16 v[200:203], a[72:75], a[200:203], v[200:203]
ds_read_b64_tr_b16 a[64:65], v219 offset:0
ds_read_b64_tr_b16 a[66:67], v219 offset:4608
v_mfma_f32_16x16x32_bf16 v[200:203], a[76:79], a[204:207], v[200:203]
s_add_u32 s39, s44, 12288
v_mul_f32 v52, v52, v58
v_mfma_f32_16x16x32_bf16 v[204:207], a[76:79], a[252:255], v[204:207]
v_cvt_pk_bf16_f32 v168, v168, v169
v_cvt_pk_bf16_f32 v169, v170, v171
v_mfma_f32_16x16x32_bf16 v[204:207], a[72:75], a[248:251], v[204:207]
v_cvt_pk_bf16_f32 v170, v172, v173
v_cvt_pk_bf16_f32 v171, v174, v175
v_mfma_f32_16x16x32_bf16 v[208:211], a[72:75], a[104:107], v[208:211]
ds_read_b64_tr_b16 a[68:69], v219 offset:9216
ds_read_b64_tr_b16 a[70:71], v219 offset:13824
v_mfma_f32_16x16x32_bf16 v[208:211], a[76:79], a[108:111], v[208:211]
buffer_store_dwordx4 v[168:171], v244, s[20:23], s39 offen offset:0 sc0 sc1
v_mfma_f32_16x16x32_bf16 v[212:215], a[76:79], a[124:127], v[212:215]
v_cvt_pk_bf16_f32 v176, v176, v177
v_cvt_pk_bf16_f32 v177, v178, v179
v_mfma_f32_16x16x32_bf16 v[212:215], a[72:75], a[120:123], v[212:215]
v_cvt_pk_bf16_f32 v178, v180, v181
v_cvt_pk_bf16_f32 v179, v182, v183
s_waitcnt lgkmcnt(8)
v_mfma_f32_16x16x32_bf16 v[212:215], a[80:83], a[48:51], v[212:215]
ds_read_b64_tr_b16 a[72:73], v219 offset:18432
ds_read_b64_tr_b16 a[74:75], v219 offset:23040
v_mfma_f32_16x16x32_bf16 v[212:215], a[84:87], a[52:55], v[212:215]
buffer_store_dwordx4 v[176:179], v244, s[20:23], s39 offen offset:1024 sc0 sc1
v_mfma_f32_16x16x32_bf16 v[208:211], a[84:87], a[36:39], v[208:211]
v_cvt_pk_bf16_f32 v184, v184, v185
v_cvt_pk_bf16_f32 v185, v186, v187
v_mfma_f32_16x16x32_bf16 v[208:211], a[80:83], a[32:35], v[208:211]
v_cvt_pk_bf16_f32 v186, v188, v189
v_cvt_pk_bf16_f32 v187, v190, v191
v_mfma_f32_16x16x32_bf16 v[204:207], a[80:83], a[16:19], v[204:207]
ds_read_b64_tr_b16 a[76:77], v219 offset:27648
ds_read_b64_tr_b16 a[78:79], v219 offset:32256
v_mfma_f32_16x16x32_bf16 v[204:207], a[84:87], a[20:23], v[204:207]
buffer_store_dwordx4 v[184:187], v244, s[20:23], s39 offen offset:2048 sc0 sc1
v_mfma_f32_16x16x32_bf16 v[200:203], a[84:87], a[4:7], v[200:203]
v_cvt_pk_bf16_f32 v192, v192, v193
v_cvt_pk_bf16_f32 v193, v194, v195
v_mfma_f32_16x16x32_bf16 v[200:203], a[80:83], a[0:3], v[200:203]
v_cvt_pk_bf16_f32 v194, v196, v197
v_cvt_pk_bf16_f32 v195, v198, v199
s_waitcnt lgkmcnt(8)
v_mfma_f32_16x16x32_bf16 v[200:203], a[88:91], a[8:11], v[200:203]
ds_read_b64_tr_b16 a[80:81], v222 offset:0
ds_read_b64_tr_b16 a[82:83], v222 offset:4608
v_mfma_f32_16x16x32_bf16 v[200:203], a[92:95], a[12:15], v[200:203]
buffer_store_dwordx4 v[192:195], v244, s[20:23], s39 offen offset:3072 sc0 sc1
v_mfma_f32_16x16x32_bf16 v[204:207], a[92:95], a[28:31], v[204:207]
ds_read_b64_tr_b16 a[128:129], v219 offset:128
ds_read_b64_tr_b16 a[130:131], v219 offset:4736
v_mfma_f32_16x16x32_bf16 v[204:207], a[88:91], a[24:27], v[204:207]
v_mul_f32 v53, v53, v59
v_cvt_pk_bf16_f32 v58, v52, v53
v_mfma_f32_16x16x32_bf16 v[208:211], a[88:91], a[40:43], v[208:211]
ds_read_b64_tr_b16 a[84:85], v222 offset:9216
ds_read_b64_tr_b16 a[86:87], v222 offset:13824
v_mfma_f32_16x16x32_bf16 v[208:211], a[92:95], a[44:47], v[208:211]
v_lshlrev_b32 v52, 16, v58
v_and_b32 v53, 0xffff0000, v58
v_mfma_f32_16x16x32_bf16 v[212:215], a[92:95], a[60:63], v[212:215]
ds_read_b64_tr_b16 a[132:133], v219 offset:9344
ds_read_b64_tr_b16 a[134:135], v219 offset:13952
v_mfma_f32_16x16x32_bf16 v[212:215], a[88:91], a[56:59], v[212:215]
v_accvgpr_read_b32 v55, a230
v_accvgpr_read_b32 v59, a240
s_waitcnt lgkmcnt(8)
v_mfma_f32_16x16x32_bf16 v[96:99], a[64:67], a[112:115], v[96:99]
ds_read_b64_tr_b16 a[88:89], v222 offset:18432
ds_read_b64_tr_b16 a[90:91], v222 offset:23040
v_mfma_f32_16x16x32_bf16 v[96:99], a[68:71], a[116:119], v[96:99]
v_lshlrev_b32 v54, 16, v55
v_and_b32 v55, 0xffff0000, v55
v_mfma_f32_16x16x32_bf16 v[88:91], a[68:71], a[100:103], v[88:91]
ds_read_b64_tr_b16 a[136:137], v219 offset:18560
ds_read_b64_tr_b16 a[138:139], v219 offset:23168
v_mfma_f32_16x16x32_bf16 v[88:91], a[64:67], a[96:99], v[88:91]
v_lshlrev_b32 v58, 16, v59
v_and_b32 v59, 0xffff0000, v59
v_mfma_f32_16x16x32_bf16 v[80:83], a[64:67], a[208:211], v[80:83]
ds_read_b64_tr_b16 a[92:93], v222 offset:27648
ds_read_b64_tr_b16 a[94:95], v222 offset:32256
v_mfma_f32_16x16x32_bf16 v[80:83], a[68:71], a[244:247], v[80:83]
v_add_f32 v54, v54, v58
v_add_f32 v55, v55, v59
v_mfma_f32_16x16x32_bf16 v[72:75], a[68:71], a[196:199], v[72:75]
ds_read_b64_tr_b16 a[140:141], v219 offset:27776
ds_read_b64_tr_b16 a[142:143], v219 offset:32384
v_mfma_f32_16x16x32_bf16 v[72:75], a[64:67], a[192:195], v[72:75]
v_cvt_pk_bf16_f32 v58, v54, v55
v_lshlrev_b32 v54, 16, v58
v_mfma_f32_16x16x32_bf16 v[72:75], a[72:75], a[200:203], v[72:75]
ds_read_b64_tr_b16 a[64:65], v219 offset:8
ds_read_b64_tr_b16 a[66:67], v219 offset:4616
v_mfma_f32_16x16x32_bf16 v[72:75], a[76:79], a[204:207], v[72:75]
s_add_u32 s39, s44, 8192
v_and_b32 v55, 0xffff0000, v58
v_mfma_f32_16x16x32_bf16 v[80:83], a[76:79], a[252:255], v[80:83]
ds_read_b64_tr_b16 a[144:145], v222 offset:128
ds_read_b64_tr_b16 a[146:147], v222 offset:4736
v_mfma_f32_16x16x32_bf16 v[80:83], a[72:75], a[248:251], v[80:83]
v_cvt_pk_bf16_f32 v200, v200, v201
v_cvt_pk_bf16_f32 v201, v202, v203
v_mfma_f32_16x16x32_bf16 v[88:91], a[72:75], a[104:107], v[88:91]
ds_read_b64_tr_b16 a[68:69], v219 offset:9224
ds_read_b64_tr_b16 a[70:71], v219 offset:13832
v_mfma_f32_16x16x32_bf16 v[88:91], a[76:79], a[108:111], v[88:91]
buffer_store_dwordx2 v[200:201], v226, s[20:23], s44 offen offset:0 sc0 sc1
v_mfma_f32_16x16x32_bf16 v[96:99], a[76:79], a[124:127], v[96:99]
ds_read_b64_tr_b16 a[148:149], v222 offset:9344
ds_read_b64_tr_b16 a[150:151], v222 offset:13952
v_mfma_f32_16x16x32_bf16 v[96:99], a[72:75], a[120:123], v[96:99]
v_cvt_pk_bf16_f32 v204, v204, v205
v_cvt_pk_bf16_f32 v205, v206, v207
s_waitcnt lgkmcnt(8)
v_mfma_f32_16x16x32_bf16 v[96:99], a[80:83], a[48:51], v[96:99]
ds_read_b64_tr_b16 a[72:73], v219 offset:18440
ds_read_b64_tr_b16 a[74:75], v219 offset:23048
v_mfma_f32_16x16x32_bf16 v[96:99], a[84:87], a[52:55], v[96:99]
buffer_store_dwordx2 v[204:205], v226, s[20:23], s44 offen offset:512 sc0 sc1
v_mfma_f32_16x16x32_bf16 v[88:91], a[84:87], a[36:39], v[88:91]
ds_read_b64_tr_b16 a[152:153], v222 offset:18560
ds_read_b64_tr_b16 a[154:155], v222 offset:23168
v_mfma_f32_16x16x32_bf16 v[88:91], a[80:83], a[32:35], v[88:91]
v_cvt_pk_bf16_f32 v208, v208, v209
v_cvt_pk_bf16_f32 v209, v210, v211
v_mfma_f32_16x16x32_bf16 v[80:83], a[80:83], a[16:19], v[80:83]
ds_read_b64_tr_b16 a[76:77], v219 offset:27656
ds_read_b64_tr_b16 a[78:79], v219 offset:32264
v_mfma_f32_16x16x32_bf16 v[80:83], a[84:87], a[20:23], v[80:83]
buffer_store_dwordx2 v[208:209], v226, s[20:23], s39 offen offset:0 sc0 sc1
v_mfma_f32_16x16x32_bf16 v[72:75], a[84:87], a[4:7], v[72:75]
ds_read_b64_tr_b16 a[156:157], v222 offset:27776
ds_read_b64_tr_b16 a[158:159], v222 offset:32384
v_mfma_f32_16x16x32_bf16 v[72:75], a[80:83], a[0:3], v[72:75]
v_cvt_pk_bf16_f32 v212, v212, v213
v_cvt_pk_bf16_f32 v213, v214, v215
v_mfma_f32_16x16x32_bf16 v[72:75], a[88:91], a[8:11], v[72:75]
ds_read_b64_tr_b16 a[80:81], v222 offset:8
ds_read_b64_tr_b16 a[82:83], v222 offset:4616
v_mfma_f32_16x16x32_bf16 v[72:75], a[92:95], a[12:15], v[72:75]
buffer_store_dwordx2 v[212:213], v226, s[20:23], s39 offen offset:512 sc0 sc1
v_mfma_f32_16x16x32_bf16 v[80:83], a[92:95], a[28:31], v[80:83]
ds_read_b64_tr_b16 a[160:161], v219 offset:136
ds_read_b64_tr_b16 a[162:163], v219 offset:4744
v_mfma_f32_16x16x32_bf16 v[80:83], a[88:91], a[24:27], v[80:83]
s_lshl2_add_u32 s28, s32, s95
v_mul_f32 v58, 0xbfb8aa3b, v54
v_mfma_f32_16x16x32_bf16 v[88:91], a[88:91], a[40:43], v[88:91]
ds_read_b64_tr_b16 a[84:85], v222 offset:9224
ds_read_b64_tr_b16 a[86:87], v222 offset:13832
v_mfma_f32_16x16x32_bf16 v[88:91], a[92:95], a[44:47], v[88:91]
v_mul_f32 v59, 0xbfb8aa3b, v55
v_mfma_f32_16x16x32_bf16 v[96:99], a[92:95], a[60:63], v[96:99]
ds_read_b64_tr_b16 a[164:165], v219 offset:9352
ds_read_b64_tr_b16 a[166:167], v219 offset:13960
v_mfma_f32_16x16x32_bf16 v[96:99], a[88:91], a[56:59], v[96:99]
v_exp_f32 v58, v58
s_waitcnt lgkmcnt(8)
v_mfma_f32_16x16x32_bf16 v[100:103], a[64:67], a[112:115], v[100:103]
ds_read_b64_tr_b16 a[88:89], v222 offset:18440
ds_read_b64_tr_b16 a[90:91], v222 offset:23048
v_mfma_f32_16x16x32_bf16 v[100:103], a[68:71], a[116:119], v[100:103]
v_exp_f32 v59, v59
v_mfma_f32_16x16x32_bf16 v[92:95], a[68:71], a[100:103], v[92:95]
ds_read_b64_tr_b16 a[168:169], v219 offset:18568
ds_read_b64_tr_b16 a[170:171], v219 offset:23176
v_mfma_f32_16x16x32_bf16 v[92:95], a[64:67], a[96:99], v[92:95]
v_add_f32 v58, 1.0, v58
v_add_f32 v59, 1.0, v59
v_mfma_f32_16x16x32_bf16 v[84:87], a[64:67], a[208:211], v[84:87]
ds_read_b64_tr_b16 a[92:93], v222 offset:27656
ds_read_b64_tr_b16 a[94:95], v222 offset:32264
v_mfma_f32_16x16x32_bf16 v[84:87], a[68:71], a[244:247], v[84:87]
v_rcp_f32 v58, v58
v_mfma_f32_16x16x32_bf16 v[76:79], a[68:71], a[196:199], v[76:79]
ds_read_b64_tr_b16 a[172:173], v219 offset:27784
ds_read_b64_tr_b16 a[174:175], v219 offset:32392
v_mfma_f32_16x16x32_bf16 v[76:79], a[64:67], a[192:195], v[76:79]
v_rcp_f32 v59, v59
v_mfma_f32_16x16x32_bf16 v[76:79], a[72:75], a[200:203], v[76:79]
v_mul_f32 v54, v54, v58
v_mul_f32 v55, v55, v59
v_mfma_f32_16x16x32_bf16 v[76:79], a[76:79], a[204:207], v[76:79]
v_cvt_pk_bf16_f32 v58, v54, v55
v_lshlrev_b32 v54, 16, v58
v_mfma_f32_16x16x32_bf16 v[84:87], a[76:79], a[252:255], v[84:87]
ds_read_b64_tr_b16 a[176:177], v222 offset:136
ds_read_b64_tr_b16 a[178:179], v222 offset:4744
v_mfma_f32_16x16x32_bf16 v[84:87], a[72:75], a[248:251], v[84:87]
v_and_b32 v55, 0xffff0000, v58
v_accvgpr_read_b32 v57, a231
v_mfma_f32_16x16x32_bf16 v[92:95], a[72:75], a[104:107], v[92:95]
v_accvgpr_read_b32 v59, a241
v_lshlrev_b32 v56, 16, v57
v_mfma_f32_16x16x32_bf16 v[92:95], a[76:79], a[108:111], v[92:95]
s_waitcnt vmcnt(0)
buffer_store_dword v231, v254, s[20:23], s28 offen sc0 sc1
v_mfma_f32_16x16x32_bf16 v[100:103], a[76:79], a[124:127], v[100:103]
ds_read_b64_tr_b16 a[180:181], v222 offset:9352
ds_read_b64_tr_b16 a[182:183], v222 offset:13960
v_mfma_f32_16x16x32_bf16 v[100:103], a[72:75], a[120:123], v[100:103]
v_and_b32 v57, 0xffff0000, v57
v_lshlrev_b32 v58, 16, v59
s_waitcnt lgkmcnt(8)
v_mfma_f32_16x16x32_bf16 v[100:103], a[80:83], a[48:51], v[100:103]
v_and_b32 v59, 0xffff0000, v59
v_add_f32 v56, v56, v58
v_mfma_f32_16x16x32_bf16 v[100:103], a[84:87], a[52:55], v[100:103]
v_add_f32 v57, v57, v59
v_cvt_pk_bf16_f32 v58, v56, v57
v_mfma_f32_16x16x32_bf16 v[92:95], a[84:87], a[36:39], v[92:95]
ds_read_b64_tr_b16 a[184:185], v222 offset:18568
ds_read_b64_tr_b16 a[186:187], v222 offset:23176
v_mfma_f32_16x16x32_bf16 v[92:95], a[80:83], a[32:35], v[92:95]
v_lshlrev_b32 v56, 16, v58
v_and_b32 v57, 0xffff0000, v58
v_mfma_f32_16x16x32_bf16 v[84:87], a[80:83], a[16:19], v[84:87]
v_mul_f32 v58, 0xbfb8aa3b, v56
v_mul_f32 v59, 0xbfb8aa3b, v57
v_mfma_f32_16x16x32_bf16 v[84:87], a[84:87], a[20:23], v[84:87]
v_exp_f32 v58, v58
v_mfma_f32_16x16x32_bf16 v[76:79], a[84:87], a[4:7], v[76:79]
ds_read_b64_tr_b16 a[188:189], v222 offset:27784
ds_read_b64_tr_b16 a[190:191], v222 offset:32392
v_mfma_f32_16x16x32_bf16 v[76:79], a[80:83], a[0:3], v[76:79]
s_waitcnt vmcnt(1)
buffer_load_dword v230, v229, s[20:23], s95 offen sc0 sc1
v_mfma_f32_16x16x32_bf16 v[76:79], a[88:91], a[8:11], v[76:79]
v_exp_f32 v59, v59
s_waitcnt lgkmcnt(8)
v_mfma_f32_16x16x32_bf16 v[76:79], a[92:95], a[12:15], v[76:79]
v_add_f32 v58, 1.0, v58
v_add_f32 v59, 1.0, v59
v_mfma_f32_16x16x32_bf16 v[84:87], a[92:95], a[28:31], v[84:87]
v_rcp_f32 v58, v58
v_mfma_f32_16x16x32_bf16 v[84:87], a[88:91], a[24:27], v[84:87]
v_rcp_f32 v59, v59
v_mfma_f32_16x16x32_bf16 v[92:95], a[88:91], a[40:43], v[92:95]
v_mul_f32 v56, v56, v58
v_mul_f32 v57, v57, v59
v_mfma_f32_16x16x32_bf16 v[92:95], a[92:95], a[44:47], v[92:95]
v_cvt_pk_bf16_f32 v58, v56, v57
v_lshlrev_b32 v56, 16, v58
v_mfma_f32_16x16x32_bf16 v[100:103], a[92:95], a[60:63], v[100:103]
v_and_b32 v57, 0xffff0000, v58
v_accvgpr_read_b32 v19, a212
v_mfma_f32_16x16x32_bf16 v[100:103], a[88:91], a[56:59], v[100:103]
v_lshlrev_b32 v18, 16, v19
v_and_b32 v19, 0xffff0000, v19
v_mfma_f32_16x16x32_bf16 v[144:147], a[128:131], a[208:211], v[144:147]
v_accvgpr_read_b32 v21, a213
v_lshlrev_b32 v20, 16, v21
v_mfma_f32_16x16x32_bf16 v[144:147], a[132:135], a[244:247], v[144:147]
v_and_b32 v21, 0xffff0000, v21
v_accvgpr_read_b32 v23, a214
v_mfma_f32_16x16x32_bf16 v[144:147], a[136:139], a[248:251], v[144:147]
v_lshlrev_b32 v22, 16, v23
v_and_b32 v23, 0xffff0000, v23
v_mfma_f32_16x16x32_bf16 v[144:147], a[140:143], a[252:255], v[144:147]
v_accvgpr_read_b32 v25, a215
v_lshlrev_b32 v24, 16, v25
v_mfma_f32_16x16x32_bf16 v[144:147], a[144:147], a[16:19], v[144:147]
v_and_b32 v25, 0xffff0000, v25
v_accvgpr_read_b32 v27, a216
v_mfma_f32_16x16x32_bf16 v[144:147], a[148:151], a[20:23], v[144:147]
v_lshlrev_b32 v26, 16, v27
v_and_b32 v27, 0xffff0000, v27
v_mfma_f32_16x16x32_bf16 v[144:147], a[152:155], a[24:27], v[144:147]
v_accvgpr_read_b32 v29, a217
v_lshlrev_b32 v28, 16, v29
v_mfma_f32_16x16x32_bf16 v[144:147], a[156:159], a[28:31], v[144:147]
v_and_b32 v29, 0xffff0000, v29
v_accvgpr_read_b32 v31, a218
s_waitcnt lgkmcnt(0)
v_mfma_f32_16x16x32_bf16 v[148:151], a[188:191], a[28:31], v[148:151]
s_add_u32 s39, s44, 0
v_lshlrev_b32 v30, 16, v31
v_mfma_f32_16x16x32_bf16 v[148:151], a[184:187], a[24:27], v[148:151]
v_cvt_pk_bf16_f32 v80, v80, v81
v_cvt_pk_bf16_f32 v81, v82, v83
v_mfma_f32_16x16x32_bf16 v[148:151], a[180:183], a[20:23], v[148:151]
v_cvt_pk_bf16_f32 v82, v84, v85
v_cvt_pk_bf16_f32 v83, v86, v87
v_mfma_f32_16x16x32_bf16 v[148:151], a[176:179], a[16:19], v[148:151]
buffer_store_dwordx4 v[80:83], v244, s[20:23], s39 offen offset:1024 sc0 sc1
v_mfma_f32_16x16x32_bf16 v[148:151], a[172:175], a[252:255], v[148:151]
v_cvt_pk_bf16_f32 v88, v88, v89
v_cvt_pk_bf16_f32 v89, v90, v91
v_mfma_f32_16x16x32_bf16 v[148:151], a[168:171], a[248:251], v[148:151]
v_cvt_pk_bf16_f32 v90, v92, v93
v_cvt_pk_bf16_f32 v91, v94, v95
v_mfma_f32_16x16x32_bf16 v[148:151], a[164:167], a[244:247], v[148:151]
buffer_store_dwordx4 v[88:91], v244, s[20:23], s39 offen offset:2048 sc0 sc1
v_mfma_f32_16x16x32_bf16 v[148:151], a[160:163], a[208:211], v[148:151]
v_cvt_pk_bf16_f32 v96, v96, v97
v_cvt_pk_bf16_f32 v97, v98, v99
v_mfma_f32_16x16x32_bf16 v[156:159], a[160:163], a[96:99], v[156:159]
v_cvt_pk_bf16_f32 v98, v100, v101
v_cvt_pk_bf16_f32 v99, v102, v103
v_mfma_f32_16x16x32_bf16 v[156:159], a[164:167], a[100:103], v[156:159]
buffer_store_dwordx4 v[96:99], v244, s[20:23], s39 offen offset:3072 sc0 sc1
v_mfma_f32_16x16x32_bf16 v[156:159], a[168:171], a[104:107], v[156:159]
s_add_u32 s39, s44, 8192
v_and_b32 v31, 0xffff0000, v31
v_mfma_f32_16x16x32_bf16 v[156:159], a[172:175], a[108:111], v[156:159]
s_waitcnt vmcnt(3)
v_cmp_gt_u32 vcc, 1, v230
v_mfma_f32_16x16x32_bf16 v[156:159], a[176:179], a[32:35], v[156:159]
v_accvgpr_read_b32 v33, a219
v_lshlrev_b32 v32, 16, v33
v_mfma_f32_16x16x32_bf16 v[156:159], a[180:183], a[36:39], v[156:159]
s_and_b32 s29, vcc_lo, 0xff
s_cbranch_scc1 SP_P1B
SP_P1B_RET:
v_mfma_f32_16x16x32_bf16 v[156:159], a[184:187], a[40:43], v[156:159]
v_and_b32 v33, 0xffff0000, v33
v_accvgpr_read_b32 v35, a220
v_mfma_f32_16x16x32_bf16 v[156:159], a[188:191], a[44:47], v[156:159]
v_cvt_pk_bf16_f32 v144, v144, v145
v_cvt_pk_bf16_f32 v145, v146, v147
v_mfma_f32_16x16x32_bf16 v[152:155], a[156:159], a[44:47], v[152:155]
v_cvt_pk_bf16_f32 v146, v148, v149
v_cvt_pk_bf16_f32 v147, v150, v151
v_mfma_f32_16x16x32_bf16 v[152:155], a[152:155], a[40:43], v[152:155]
buffer_store_dwordx4 v[144:147], v244, s[20:23], s39 offen offset:1024 sc0 sc1
v_mfma_f32_16x16x32_bf16 v[152:155], a[148:151], a[36:39], v[152:155]
buffer_load_dwordx4 v[104:107], v244, s[20:23], s68 offen sc0 sc1
v_mfma_f32_16x16x32_bf16 v[152:155], a[144:147], a[32:35], v[152:155]
v_lshlrev_b32 v34, 16, v35
v_and_b32 v35, 0xffff0000, v35
v_mfma_f32_16x16x32_bf16 v[152:155], a[140:143], a[108:111], v[152:155]
v_accvgpr_read_b32 v37, a221
v_lshlrev_b32 v36, 16, v37
v_mfma_f32_16x16x32_bf16 v[152:155], a[136:139], a[104:107], v[152:155]
buffer_load_dwordx4 v[108:111], v244, s[20:23], s69 offen sc0 sc1
v_mfma_f32_16x16x32_bf16 v[152:155], a[132:135], a[100:103], v[152:155]
v_and_b32 v37, 0xffff0000, v37
v_mfma_f32_16x16x32_bf16 v[152:155], a[128:131], a[96:99], v[152:155]
s_mov_b32 s90, 0x3f80
s_mov_b32 s91, 0x3f800000
v_mfma_f32_16x16x32_bf16 v[160:163], a[128:131], a[112:115], v[160:163]
buffer_load_dwordx4 v[112:115], v244, s[20:23], s70 offen sc0 sc1
v_mfma_f32_16x16x32_bf16 v[160:163], a[132:135], a[116:119], v[160:163]
v_mov_b32 v66, 0
v_mov_b32 v67, 0
v_mfma_f32_16x16x32_bf16 v[160:163], a[136:139], a[120:123], v[160:163]
v_mov_b32 v68, 0
v_mov_b32 v69, 0
v_mfma_f32_16x16x32_bf16 v[160:163], a[140:143], a[124:127], v[160:163]
buffer_load_dwordx4 v[116:119], v244, s[20:23], s71 offen sc0 sc1
v_mfma_f32_16x16x32_bf16 v[160:163], a[144:147], a[48:51], v[160:163]
v_mfma_f32_16x16x32_bf16 v[160:163], a[148:151], a[52:55], v[160:163]
v_mfma_f32_16x16x32_bf16 v[160:163], a[152:155], a[56:59], v[160:163]
buffer_load_dwordx2 v[200:201], v226, s[20:23], s72 offen sc0 sc1
v_mfma_f32_16x16x32_bf16 v[160:163], a[156:159], a[60:63], v[160:163]
v_cvt_pk_bf16_f32 v152, v152, v153
v_cvt_pk_bf16_f32 v153, v154, v155
v_mfma_f32_16x16x32_bf16 v[164:167], a[188:191], a[60:63], v[164:167]
v_cvt_pk_bf16_f32 v154, v156, v157
v_cvt_pk_bf16_f32 v155, v158, v159
v_mfma_f32_16x16x32_bf16 v[164:167], a[184:187], a[56:59], v[164:167]
buffer_store_dwordx4 v[152:155], v244, s[20:23], s39 offen offset:2048 sc0 sc1
v_mfma_f32_16x16x32_bf16 v[164:167], a[180:183], a[52:55], v[164:167]
buffer_load_dwordx2 v[202:203], v226, s[20:23], s73 offen sc0 sc1
v_mfma_f32_16x16x32_bf16 v[164:167], a[176:179], a[48:51], v[164:167]
v_mfma_f32_16x16x32_bf16 v[164:167], a[172:175], a[124:127], v[164:167]
v_mfma_f32_16x16x32_bf16 v[164:167], a[168:171], a[120:123], v[164:167]
buffer_load_dwordx2 v[204:205], v226, s[20:23], s74 offen sc0 sc1
v_mfma_f32_16x16x32_bf16 v[164:167], a[164:167], a[116:119], v[164:167]
v_mfma_f32_16x16x32_bf16 v[164:167], a[160:163], a[112:115], v[164:167]
v_mfma_f32_16x16x32_bf16 v[140:143], a[160:163], a[192:195], v[140:143]
buffer_load_dwordx2 v[206:207], v226, s[20:23], s75 offen sc0 sc1
v_mfma_f32_16x16x32_bf16 v[140:143], a[164:167], a[196:199], v[140:143]
v_mfma_f32_16x16x32_bf16 v[140:143], a[168:171], a[200:203], v[140:143]
v_mfma_f32_16x16x32_bf16 v[140:143], a[172:175], a[204:207], v[140:143]
buffer_load_dwordx2 v[208:209], v226, s[20:23], s84 offen sc0 sc1
v_mfma_f32_16x16x32_bf16 v[140:143], a[176:179], a[0:3], v[140:143]
v_mfma_f32_16x16x32_bf16 v[140:143], a[180:183], a[4:7], v[140:143]
v_mfma_f32_16x16x32_bf16 v[140:143], a[184:187], a[8:11], v[140:143]
buffer_load_dwordx2 v[210:211], v226, s[20:23], s85 offen sc0 sc1
v_mfma_f32_16x16x32_bf16 v[140:143], a[188:191], a[12:15], v[140:143]
v_cvt_pk_bf16_f32 v160, v160, v161
v_cvt_pk_bf16_f32 v161, v162, v163
v_mfma_f32_16x16x32_bf16 v[136:139], a[156:159], a[12:15], v[136:139]
v_cvt_pk_bf16_f32 v162, v164, v165
v_cvt_pk_bf16_f32 v163, v166, v167
v_mfma_f32_16x16x32_bf16 v[136:139], a[152:155], a[8:11], v[136:139]
buffer_store_dwordx4 v[160:163], v244, s[20:23], s39 offen offset:3072 sc0 sc1
v_mfma_f32_16x16x32_bf16 v[136:139], a[148:151], a[4:7], v[136:139]
buffer_load_dwordx2 v[212:213], v226, s[20:23], s86 offen sc0 sc1
v_mfma_f32_16x16x32_bf16 v[136:139], a[144:147], a[0:3], v[136:139]
v_mfma_f32_16x16x32_bf16 v[136:139], a[140:143], a[204:207], v[136:139]
v_mfma_f32_16x16x32_bf16 v[136:139], a[136:139], a[200:203], v[136:139]
buffer_load_dwordx2 v[214:215], v226, s[20:23], s87 offen sc0 sc1
v_mfma_f32_16x16x32_bf16 v[136:139], a[132:135], a[196:199], v[136:139]
v_mfma_f32_16x16x32_bf16 v[136:139], a[128:131], a[192:195], v[136:139]
buffer_load_dwordx4 v[120:123], v243, s[20:23], s68 offen sc0 sc1
buffer_load_dwordx4 v[124:127], v243, s[20:23], s69 offen sc0 sc1
buffer_load_dwordx4 v[128:131], v243, s[20:23], s70 offen sc0 sc1
buffer_load_dwordx4 v[132:135], v243, s[20:23], s71 offen sc0 sc1
s_lshl_b32 s50, s34, 2
s_lshl_b32 s50, 15, s50
s_waitcnt vmcnt(6)
buffer_store_dword v246, v254, s[20:23], s28 offen sc0 sc1
s_waitcnt vmcnt(18)
v_dot2c_f32_bf16 v72, s90, v104
v_dot2c_f32_bf16 v73, s91, v104
v_dot2c_f32_bf16 v74, s90, v105
v_dot2c_f32_bf16 v75, s91, v105
v_dot2c_f32_bf16 v76, s90, v106
v_dot2c_f32_bf16 v77, s91, v106
v_dot2c_f32_bf16 v78, s90, v107
v_dot2c_f32_bf16 v79, s91, v107
s_waitcnt vmcnt(17)
v_dot2c_f32_bf16 v72, s90, v108
v_dot2c_f32_bf16 v73, s91, v108
v_dot2c_f32_bf16 v74, s90, v109
v_dot2c_f32_bf16 v75, s91, v109
v_dot2c_f32_bf16 v76, s90, v110
v_dot2c_f32_bf16 v77, s91, v110
v_dot2c_f32_bf16 v78, s90, v111
v_dot2c_f32_bf16 v79, s91, v111
s_waitcnt vmcnt(16)
v_dot2c_f32_bf16 v72, s90, v112
v_dot2c_f32_bf16 v73, s91, v112
v_dot2c_f32_bf16 v74, s90, v113
v_dot2c_f32_bf16 v75, s91, v113
v_dot2c_f32_bf16 v76, s90, v114
v_dot2c_f32_bf16 v77, s91, v114
v_dot2c_f32_bf16 v78, s90, v115
v_dot2c_f32_bf16 v79, s91, v115
s_waitcnt vmcnt(15)
v_dot2c_f32_bf16 v72, s90, v116
v_dot2c_f32_bf16 v73, s91, v116
v_dot2c_f32_bf16 v74, s90, v117
v_dot2c_f32_bf16 v75, s91, v117
v_dot2c_f32_bf16 v76, s90, v118
v_dot2c_f32_bf16 v77, s91, v118
v_dot2c_f32_bf16 v78, s90, v119
v_dot2c_f32_bf16 v79, s91, v119
buffer_load_dword v230, v229, s[20:23], s95 offen sc0 sc1
s_waitcnt vmcnt(5)
v_dot2c_f32_bf16 v136, s90, v120
v_dot2c_f32_bf16 v137, s91, v120
v_dot2c_f32_bf16 v138, s90, v121
v_dot2c_f32_bf16 v139, s91, v121
v_dot2c_f32_bf16 v140, s90, v122
v_dot2c_f32_bf16 v141, s91, v122
v_dot2c_f32_bf16 v142, s90, v123
v_dot2c_f32_bf16 v143, s91, v123
s_waitcnt vmcnt(4)
v_dot2c_f32_bf16 v136, s90, v124
v_dot2c_f32_bf16 v137, s91, v124
v_dot2c_f32_bf16 v138, s90, v125
v_dot2c_f32_bf16 v139, s91, v125
v_dot2c_f32_bf16 v140, s90, v126
v_dot2c_f32_bf16 v141, s91, v126
v_dot2c_f32_bf16 v142, s90, v127
v_dot2c_f32_bf16 v143, s91, v127
s_waitcnt vmcnt(3)
v_dot2c_f32_bf16 v136, s90, v128
v_dot2c_f32_bf16 v137, s91, v128
v_dot2c_f32_bf16 v138, s90, v129
v_dot2c_f32_bf16 v139, s91, v129
v_dot2c_f32_bf16 v140, s90, v130
v_dot2c_f32_bf16 v141, s91, v130
v_dot2c_f32_bf16 v142, s90, v131
v_dot2c_f32_bf16 v143, s91, v131
s_waitcnt vmcnt(2)
v_dot2c_f32_bf16 v136, s90, v132
v_dot2c_f32_bf16 v137, s91, v132
v_dot2c_f32_bf16 v138, s90, v133
v_dot2c_f32_bf16 v139, s91, v133
v_dot2c_f32_bf16 v140, s90, v134
v_dot2c_f32_bf16 v141, s91, v134
v_dot2c_f32_bf16 v142, s90, v135
v_dot2c_f32_bf16 v143, s91, v135
s_waitcnt vmcnt(0)
v_cmp_gt_u32 vcc, 2, v230
s_nop 0
s_and_b32 s29, vcc_lo, s50
s_cbranch_scc0 SP_P2B_RET
SP_P2B:
s_sleep 0
s_add_u32 s100, s100, 1
s_bitcmp1_b32 s100, 19
s_cbranch_scc1 K_END
buffer_load_dword v230, v229, s[20:23], s95 offen sc0 sc1
s_waitcnt vmcnt(0)
v_cmp_gt_u32 vcc, 2, v230
s_nop 0
s_and_b32 s29, vcc_lo, s50
s_cbranch_scc1 SP_P2B
SP_P2B_RET:
buffer_load_dwordx4 v[168:171], v244, s[20:23], s65 offen sc0 sc1
buffer_load_dwordx4 v[172:175], v244, s[20:23], s66 offen sc0 sc1
buffer_load_dwordx4 v[176:179], v244, s[20:23], s67 offen sc0 sc1
buffer_load_dwordx4 v[180:183], v243, s[20:23], s65 offen sc0 sc1
buffer_load_dwordx4 v[184:187], v243, s[20:23], s66 offen sc0 sc1
buffer_load_dwordx4 v[188:191], v243, s[20:23], s67 offen sc0 sc1
s_waitcnt vmcnt(21)
v_dot2c_f32_bf16 v66, s90, v200
v_dot2c_f32_bf16 v67, s91, v200
v_dot2c_f32_bf16 v68, s90, v201
v_dot2c_f32_bf16 v69, s91, v201
s_waitcnt vmcnt(19)
v_dot2c_f32_bf16 v66, s90, v202
v_dot2c_f32_bf16 v67, s91, v202
v_dot2c_f32_bf16 v68, s90, v203
v_dot2c_f32_bf16 v69, s91, v203
s_waitcnt vmcnt(18)
v_dot2c_f32_bf16 v66, s90, v204
v_dot2c_f32_bf16 v67, s91, v204
v_dot2c_f32_bf16 v68, s90, v205
v_dot2c_f32_bf16 v69, s91, v205
s_waitcnt vmcnt(17)
v_dot2c_f32_bf16 v66, s90, v206
v_dot2c_f32_bf16 v67, s91, v206
v_dot2c_f32_bf16 v68, s90, v207
v_dot2c_f32_bf16 v69, s91, v207
s_waitcnt vmcnt(16)
v_dot2c_f32_bf16 v66, s90, v208
v_dot2c_f32_bf16 v67, s91, v208
v_dot2c_f32_bf16 v68, s90, v209
v_dot2c_f32_bf16 v69, s91, v209
s_waitcnt vmcnt(15)
v_dot2c_f32_bf16 v66, s90, v210
v_dot2c_f32_bf16 v67, s91, v210
v_dot2c_f32_bf16 v68, s90, v211
v_dot2c_f32_bf16 v69, s91, v211
s_waitcnt vmcnt(13)
v_dot2c_f32_bf16 v66, s90, v212
v_dot2c_f32_bf16 v67, s91, v212
v_dot2c_f32_bf16 v68, s90, v213
v_dot2c_f32_bf16 v69, s91, v213
s_waitcnt vmcnt(12)
v_dot2c_f32_bf16 v66, s90, v214
v_dot2c_f32_bf16 v67, s91, v214
v_dot2c_f32_bf16 v68, s90, v215
v_dot2c_f32_bf16 v69, s91, v215
s_cmp_eq_u32 s34, 0
s_cselect_b32 s29, 0, 0x7fbffff0
s_nop 2
v_cvt_pk_bf16_f32 v58, v66, v67
v_cvt_pk_bf16_f32 v59, v68, v69
v_lshlrev_b32 v66, 16, v58
v_and_b32 v67, 0xffff0000, v58
v_lshlrev_b32 v68, 16, v59
v_and_b32 v69, 0xffff0000, v59
v_pk_mul_f32 v[66:67], v[66:67], v[54:55]
v_pk_mul_f32 v[68:69], v[68:69], v[56:57]
v_cvt_pk_bf16_f32 v58, v66, v67
v_cvt_pk_bf16_f32 v59, v68, v69
v_lshlrev_b32 v66, 16, v58
v_and_b32 v67, 0xffff0000, v58
v_lshlrev_b32 v68, 16, v59
v_and_b32 v69, 0xffff0000, v59
v_pk_add_f32 v[66:67], v[66:67], v[34:35]
v_pk_add_f32 v[68:69], v[68:69], v[36:37]
v_cvt_pk_bf16_f32 v66, v66, v67
v_cvt_pk_bf16_f32 v67, v68, v69
buffer_store_dwordx2 v[66:67], v249, s[60:63], s29 offen
s_waitcnt vmcnt(6)
v_dot2c_f32_bf16 v72, s90, v168
v_dot2c_f32_bf16 v73, s91, v168
v_dot2c_f32_bf16 v74, s90, v169
v_dot2c_f32_bf16 v75, s91, v169
v_dot2c_f32_bf16 v76, s90, v170
v_dot2c_f32_bf16 v77, s91, v170
v_dot2c_f32_bf16 v78, s90, v171
v_dot2c_f32_bf16 v79, s91, v171
s_waitcnt vmcnt(5)
v_dot2c_f32_bf16 v72, s90, v172
v_dot2c_f32_bf16 v73, s91, v172
v_dot2c_f32_bf16 v74, s90, v173
v_dot2c_f32_bf16 v75, s91, v173
v_dot2c_f32_bf16 v76, s90, v174
v_dot2c_f32_bf16 v77, s91, v174
v_dot2c_f32_bf16 v78, s90, v175
v_dot2c_f32_bf16 v79, s91, v175
s_waitcnt vmcnt(4)
v_dot2c_f32_bf16 v72, s90, v176
v_dot2c_f32_bf16 v73, s91, v176
v_dot2c_f32_bf16 v74, s90, v177
v_dot2c_f32_bf16 v75, s91, v177
v_dot2c_f32_bf16 v76, s90, v178
v_dot2c_f32_bf16 v77, s91, v178
v_dot2c_f32_bf16 v78, s90, v179
v_dot2c_f32_bf16 v79, s91, v179
s_nop 2
v_cvt_pk_bf16_f32 v58, v72, v73
v_cvt_pk_bf16_f32 v59, v74, v75
v_cvt_pk_bf16_f32 v60, v76, v77
v_cvt_pk_bf16_f32 v61, v78, v79
v_lshlrev_b32 v72, 16, v58
v_and_b32 v73, 0xffff0000, v58
v_lshlrev_b32 v74, 16, v59
v_and_b32 v75, 0xffff0000, v59
v_lshlrev_b32 v76, 16, v60
v_and_b32 v77, 0xffff0000, v60
v_lshlrev_b32 v78, 16, v61
v_and_b32 v79, 0xffff0000, v61
v_pk_mul_f32 v[72:73], v[72:73], v[38:39]
v_pk_mul_f32 v[74:75], v[74:75], v[40:41]
v_pk_mul_f32 v[76:77], v[76:77], v[42:43]
v_pk_mul_f32 v[78:79], v[78:79], v[44:45]
v_cvt_pk_bf16_f32 v58, v72, v73
v_cvt_pk_bf16_f32 v59, v74, v75
v_cvt_pk_bf16_f32 v60, v76, v77
v_cvt_pk_bf16_f32 v61, v78, v79
v_lshlrev_b32 v72, 16, v58
v_and_b32 v73, 0xffff0000, v58
v_lshlrev_b32 v74, 16, v59
v_and_b32 v75, 0xffff0000, v59
v_lshlrev_b32 v76, 16, v60
v_and_b32 v77, 0xffff0000, v60
v_lshlrev_b32 v78, 16, v61
v_and_b32 v79, 0xffff0000, v61
v_pk_add_f32 v[72:73], v[72:73], v[18:19]
v_pk_add_f32 v[74:75], v[74:75], v[20:21]
v_pk_add_f32 v[76:77], v[76:77], v[22:23]
v_pk_add_f32 v[78:79], v[78:79], v[24:25]
v_cvt_pk_bf16_f32 v72, v72, v73
v_cvt_pk_bf16_f32 v73, v74, v75
v_cvt_pk_bf16_f32 v74, v76, v77
v_cvt_pk_bf16_f32 v75, v78, v79
buffer_store_dwordx4 v[72:75], v248, s[60:63], 0 offen
s_waitcnt vmcnt(4)
v_dot2c_f32_bf16 v136, s90, v180
v_dot2c_f32_bf16 v137, s91, v180
v_dot2c_f32_bf16 v138, s90, v181
v_dot2c_f32_bf16 v139, s91, v181
v_dot2c_f32_bf16 v140, s90, v182
v_dot2c_f32_bf16 v141, s91, v182
v_dot2c_f32_bf16 v142, s90, v183
v_dot2c_f32_bf16 v143, s91, v183
s_waitcnt vmcnt(3)
v_dot2c_f32_bf16 v136, s90, v184
v_dot2c_f32_bf16 v137, s91, v184
v_dot2c_f32_bf16 v138, s90, v185
v_dot2c_f32_bf16 v139, s91, v185
v_dot2c_f32_bf16 v140, s90, v186
v_dot2c_f32_bf16 v141, s91, v186
v_dot2c_f32_bf16 v142, s90, v187
v_dot2c_f32_bf16 v143, s91, v187
s_waitcnt vmcnt(2)
v_dot2c_f32_bf16 v136, s90, v188
v_dot2c_f32_bf16 v137, s91, v188
v_dot2c_f32_bf16 v138, s90, v189
v_dot2c_f32_bf16 v139, s91, v189
v_dot2c_f32_bf16 v140, s90, v190
v_dot2c_f32_bf16 v141, s91, v190
v_dot2c_f32_bf16 v142, s90, v191
v_dot2c_f32_bf16 v143, s91, v191
s_nop 2
v_cvt_pk_bf16_f32 v58, v136, v137
v_cvt_pk_bf16_f32 v59, v138, v139
v_cvt_pk_bf16_f32 v60, v140, v141
v_cvt_pk_bf16_f32 v61, v142, v143
v_lshlrev_b32 v136, 16, v58
v_and_b32 v137, 0xffff0000, v58
v_lshlrev_b32 v138, 16, v59
v_and_b32 v139, 0xffff0000, v59
v_lshlrev_b32 v140, 16, v60
v_and_b32 v141, 0xffff0000, v60
v_lshlrev_b32 v142, 16, v61
v_and_b32 v143, 0xffff0000, v61
v_pk_mul_f32 v[136:137], v[136:137], v[46:47]
v_pk_mul_f32 v[138:139], v[138:139], v[48:49]
v_pk_mul_f32 v[140:141], v[140:141], v[50:51]
v_pk_mul_f32 v[142:143], v[142:143], v[52:53]
v_cvt_pk_bf16_f32 v58, v136, v137
v_cvt_pk_bf16_f32 v59, v138, v139
v_cvt_pk_bf16_f32 v60, v140, v141
v_cvt_pk_bf16_f32 v61, v142, v143
v_lshlrev_b32 v136, 16, v58
v_and_b32 v137, 0xffff0000, v58
v_lshlrev_b32 v138, 16, v59
v_and_b32 v139, 0xffff0000, v59
v_lshlrev_b32 v140, 16, v60
v_and_b32 v141, 0xffff0000, v60
v_lshlrev_b32 v142, 16, v61
v_and_b32 v143, 0xffff0000, v61
v_pk_add_f32 v[136:137], v[136:137], v[26:27]
v_pk_add_f32 v[138:139], v[138:139], v[28:29]
v_pk_add_f32 v[140:141], v[140:141], v[30:31]
v_pk_add_f32 v[142:143], v[142:143], v[32:33]
v_cvt_pk_bf16_f32 v136, v136, v137
v_cvt_pk_bf16_f32 v137, v138, v139
v_cvt_pk_bf16_f32 v138, v140, v141
v_cvt_pk_bf16_f32 v139, v142, v143
buffer_store_dwordx4 v[136:139], v248, s[60:63], 0 offen offset:128
s_endpgm
SP_O1B:
s_sleep 1
s_add_u32 s100, s100, 1
s_bitcmp1_b32 s100, 19
s_cbranch_scc1 K_END
buffer_load_dword v230, v229, s[20:23], s94 offen sc0 sc1
s_waitcnt vmcnt(0)
v_cmp_gt_u32 vcc, 1, v230
s_bitcmp1_b32 vcc_lo, s39
s_cbranch_scc1 SP_O1B
s_branch SP_O1B_RET
SP_O2B:
s_sleep 1
s_add_u32 s100, s100, 1
s_bitcmp1_b32 s100, 19
s_cbranch_scc1 K_END
buffer_load_dword v230, v229, s[20:23], s94 offen sc0 sc1
s_waitcnt vmcnt(0)
v_cmp_gt_u32 vcc, 1, v230
s_and_b32 s29, vcc_lo, 15
s_cbranch_scc1 SP_O2B
s_branch SP_O2B_RET
SP_O3B:
s_sleep 1
s_add_u32 s100, s100, 1
s_bitcmp1_b32 s100, 19
s_cbranch_scc1 K_END
buffer_load_dword v230, v229, s[20:23], s94 offen sc0 sc1
s_waitcnt vmcnt(0)
v_cmp_gt_u32 vcc, 2, v230
s_and_b32 s29, vcc_lo, 15
s_cbranch_scc1 SP_O3B
s_branch SP_O3B_RET
SP_P1B:
s_sleep 1
s_add_u32 s100, s100, 1
s_bitcmp1_b32 s100, 19
s_cbranch_scc1 K_END
buffer_load_dword v230, v229, s[20:23], s95 offen sc0 sc1
s_waitcnt vmcnt(0)
v_cmp_gt_u32 vcc, 1, v230
s_and_b32 s29, vcc_lo, 0xff
s_cbranch_scc1 SP_P1B
s_branch SP_P1B_RET
F_NOTYET:
s_bitcmp1_b32 s51, 30
s_cbranch_scc1 F_BSENT
s_bitset1_b32 s51, 30
s_mov_b32 s46, 0x60
s_mov_b32 s50, s28
s_add_u32 s28, s45, 0x0
buffer_store_dwordx4 v[72:75], v169, s[20:23], s28 offen offset:0 sc0 sc1
buffer_store_dwordx4 v[76:79], v169, s[20:23], s28 offen offset:2048 sc0 sc1
s_add_u32 s28, s28, 4096
buffer_store_dwordx4 v[80:83], v169, s[20:23], s28 offen offset:0 sc0 sc1
buffer_store_dwordx4 v[84:87], v169, s[20:23], s28 offen offset:2048 sc0 sc1
s_add_u32 s28, s28, 4096
buffer_store_dwordx4 v[88:91], v169, s[20:23], s28 offen offset:0 sc0 sc1
buffer_store_dwordx4 v[92:95], v169, s[20:23], s28 offen offset:2048 sc0 sc1
s_add_u32 s28, s28, 4096
buffer_store_dwordx4 v[96:99], v169, s[20:23], s28 offen offset:0 sc0 sc1
buffer_store_dwordx4 v[100:103], v169, s[20:23], s28 offen offset:2048 sc0 sc1
s_add_u32 s28, s28, 4096
buffer_store_dwordx4 v[104:107], v169, s[20:23], s28 offen offset:0 sc0 sc1
s_lshl_b32 s28, s3, 2
s_add_u32 s28, s28, 0x240000
buffer_store_dword v65, v64, s[20:23], s28 offen sc0 sc1
s_mov_b32 s28, s50
s_or_b32 s29, s38, 0x40
v_mov_b32 v62, s29
v_mov_b32 v63, s35
s_lshl_b32 s29, s36, 5
s_waitcnt vmcnt(0)
s_mov_b64 exec, 1
buffer_store_byte v62, v63, s[24:27], s29 offen sc0 sc1
s_mov_b64 exec, -1
F_BSENT:
s_lshl_b32 s29, s36, 5
buffer_load_dword v62, v64, s[24:27], s29 offen sc0 sc1
s_waitcnt vmcnt(0)
v_and_b32 v63, 0x40404040, v62
v_cmp_ne_u32 vcc, 0x40404040, v63
s_cbranch_vccnz F_NOB
s_mul_i32 s29, s38, 0x01010101
v_and_b32 v62, 0x0f0f0f0f, v62
v_cmp_ne_u32 vcc, s29, v62
v_mov_b32 v60, 0
s_cbranch_vccnz F_GO
v_mov_b32 v60, 1
s_branch F_GO
F_NOB:
s_sleep 1
s_add_u32 s100, s100, 1
s_bitcmp1_b32 s100, 19
s_cbranch_scc1 K_END
s_branch F_POLL
Q_REDO:
s_mov_b32 s4, 0
s_mov_b32 s51, 0
s_waitcnt vmcnt(0) lgkmcnt(0)
s_branch Q_START
K_FALLBACK:
s_mov_b32 s43, 1
s_mov_b32 s3, 0
s_mov_b32 s86, 0x30000
s_mov_b32 s66, 0
s_mov_b32 s70, 0
s_mov_b32 s74, 0
s_waitcnt vmcnt(0) lgkmcnt(0)
s_barrier
v_mov_b32 v254, 0x7ffffff0
v_mov_b32 v136, 0xff800000
v_mov_b32 v140, 0xff800000
v_mov_b32 v144, 0xff800000
v_mov_b32 v148, 0xff800000
s_mov_b32 s32, 0
s_mov_b32 s33, 32
K_FBLOOP:
s_add_u32 m0, s30, 81920
s_nop 0
buffer_load_dwordx4 v228, s[8:11], s32 offen offset:0  lds
buffer_load_dwordx4 v229, s[8:11], s32 offen offset:1024  lds
buffer_load_dwordx4 v230, s[8:11], s32 offen offset:2048  lds
buffer_load_dwordx4 v231, s[8:11], s32 offen offset:3072  lds
s_waitcnt vmcnt(0)
s_barrier
ds_read_b128 a[144:147], v216 offset:16384
ds_read_b128 a[148:151], v217 offset:16384
ds_read_b128 a[152:155], v218 offset:16384
ds_read_b128 a[156:159], v219 offset:16384
ds_read_b128 a[160:163], v216 offset:20480
ds_read_b128 a[164:167], v217 offset:20480
ds_read_b128 a[168:171], v218 offset:20480
ds_read_b128 a[172:175], v219 offset:20480
s_waitcnt lgkmcnt(0)
v_mfma_f32_16x16x32_bf16 v[8:11], a[144:147], v[152:155], 0
v_mfma_f32_16x16x32_bf16 v[16:19], a[144:147], v[168:171], 0
v_mfma_f32_16x16x32_bf16 v[24:27], a[144:147], v[184:187], 0
v_mfma_f32_16x16x32_bf16 v[32:35], a[144:147], v[200:203], 0
v_mfma_f32_16x16x32_bf16 v[8:11], a[148:151], v[156:159], v[8:11]
v_mfma_f32_16x16x32_bf16 v[16:19], a[148:151], v[172:175], v[16:19]
v_mfma_f32_16x16x32_bf16 v[24:27], a[148:151], v[188:191], v[24:27]
v_mfma_f32_16x16x32_bf16 v[32:35], a[148:151], v[204:207], v[32:35]
v_mfma_f32_16x16x32_bf16 v[8:11], a[152:155], v[160:163], v[8:11]
v_mfma_f32_16x16x32_bf16 v[16:19], a[152:155], v[176:179], v[16:19]
v_mfma_f32_16x16x32_bf16 v[24:27], a[152:155], v[192:195], v[24:27]
v_mfma_f32_16x16x32_bf16 v[32:35], a[152:155], v[208:211], v[32:35]
v_mfma_f32_16x16x32_bf16 v[8:11], a[156:159], v[164:167], v[8:11]
v_mfma_f32_16x16x32_bf16 v[16:19], a[156:159], v[180:183], v[16:19]
v_mfma_f32_16x16x32_bf16 v[24:27], a[156:159], v[196:199], v[24:27]
v_mfma_f32_16x16x32_bf16 v[32:35], a[156:159], v[212:215], v[32:35]
v_mfma_f32_16x16x32_bf16 v[12:15], a[160:163], v[152:155], 0
v_mfma_f32_16x16x32_bf16 v[20:23], a[160:163], v[168:171], 0
v_mfma_f32_16x16x32_bf16 v[28:31], a[160:163], v[184:187], 0
v_mfma_f32_16x16x32_bf16 v[36:39], a[160:163], v[200:203], 0
v_mfma_f32_16x16x32_bf16 v[12:15], a[164:167], v[156:159], v[12:15]
v_mfma_f32_16x16x32_bf16 v[20:23], a[164:167], v[172:175], v[20:23]
v_mfma_f32_16x16x32_bf16 v[28:31], a[164:167], v[188:191], v[28:31]
v_mfma_f32_16x16x32_bf16 v[36:39], a[164:167], v[204:207], v[36:39]
v_mfma_f32_16x16x32_bf16 v[12:15], a[168:171], v[160:163], v[12:15]
v_mfma_f32_16x16x32_bf16 v[20:23], a[168:171], v[176:179], v[20:23]
v_mfma_f32_16x16x32_bf16 v[28:31], a[168:171], v[192:195], v[28:31]
v_mfma_f32_16x16x32_bf16 v[36:39], a[168:171], v[208:211], v[36:39]
v_mfma_f32_16x16x32_bf16 v[12:15], a[172:175], v[164:167], v[12:15]
v_mfma_f32_16x16x32_bf16 v[20:23], a[172:175], v[180:183], v[20:23]
v_mfma_f32_16x16x32_bf16 v[28:31], a[172:175], v[196:199], v[28:31]
v_mfma_f32_16x16x32_bf16 v[36:39], a[172:175], v[212:215], v[36:39]
s_nop 7
s_nop 3
v_max3_f32 v136, v136, v8, v9
v_max3_f32 v136, v136, v10, v11
v_max3_f32 v136, v136, v12, v13
v_max3_f32 v136, v136, v14, v15
v_max3_f32 v140, v140, v16, v17
v_max3_f32 v140, v140, v18, v19
v_max3_f32 v140, v140, v20, v21
v_max3_f32 v140, v140, v22, v23
v_max3_f32 v144, v144, v24, v25
v_max3_f32 v144, v144, v26, v27
v_max3_f32 v144, v144, v28, v29
v_max3_f32 v144, v144, v30, v31
v_max3_f32 v148, v148, v32, v33
v_max3_f32 v148, v148, v34, v35
v_max3_f32 v148, v148, v36, v37
v_max3_f32 v148, v148, v38, v39
ds_read_b128 a[144:147], v216 offset:24576
ds_read_b128 a[148:151], v217 offset:24576
ds_read_b128 a[152:155], v218 offset:24576
ds_read_b128 a[156:159], v219 offset:24576
ds_read_b128 a[160:163], v216 offset:28672
ds_read_b128 a[164:167], v217 offset:28672
ds_read_b128 a[168:171], v218 offset:28672
ds_read_b128 a[172:175], v219 offset:28672
s_waitcnt lgkmcnt(0)
v_mfma_f32_16x16x32_bf16 v[8:11], a[144:147], v[152:155], 0
v_mfma_f32_16x16x32_bf16 v[16:19], a[144:147], v[168:171], 0
v_mfma_f32_16x16x32_bf16 v[24:27], a[144:147], v[184:187], 0
v_mfma_f32_16x16x32_bf16 v[32:35], a[144:147], v[200:203], 0
v_mfma_f32_16x16x32_bf16 v[8:11], a[148:151], v[156:159], v[8:11]
v_mfma_f32_16x16x32_bf16 v[16:19], a[148:151], v[172:175], v[16:19]
v_mfma_f32_16x16x32_bf16 v[24:27], a[148:151], v[188:191], v[24:27]
v_mfma_f32_16x16x32_bf16 v[32:35], a[148:151], v[204:207], v[32:35]
v_mfma_f32_16x16x32_bf16 v[8:11], a[152:155], v[160:163], v[8:11]
v_mfma_f32_16x16x32_bf16 v[16:19], a[152:155], v[176:179], v[16:19]
v_mfma_f32_16x16x32_bf16 v[24:27], a[152:155], v[192:195], v[24:27]
v_mfma_f32_16x16x32_bf16 v[32:35], a[152:155], v[208:211], v[32:35]
v_mfma_f32_16x16x32_bf16 v[8:11], a[156:159], v[164:167], v[8:11]
v_mfma_f32_16x16x32_bf16 v[16:19], a[156:159], v[180:183], v[16:19]
v_mfma_f32_16x16x32_bf16 v[24:27], a[156:159], v[196:199], v[24:27]
v_mfma_f32_16x16x32_bf16 v[32:35], a[156:159], v[212:215], v[32:35]
v_mfma_f32_16x16x32_bf16 v[12:15], a[160:163], v[152:155], 0
v_mfma_f32_16x16x32_bf16 v[20:23], a[160:163], v[168:171], 0
v_mfma_f32_16x16x32_bf16 v[28:31], a[160:163], v[184:187], 0
v_mfma_f32_16x16x32_bf16 v[36:39], a[160:163], v[200:203], 0
v_mfma_f32_16x16x32_bf16 v[12:15], a[164:167], v[156:159], v[12:15]
v_mfma_f32_16x16x32_bf16 v[20:23], a[164:167], v[172:175], v[20:23]
v_mfma_f32_16x16x32_bf16 v[28:31], a[164:167], v[188:191], v[28:31]
v_mfma_f32_16x16x32_bf16 v[36:39], a[164:167], v[204:207], v[36:39]
v_mfma_f32_16x16x32_bf16 v[12:15], a[168:171], v[160:163], v[12:15]
v_mfma_f32_16x16x32_bf16 v[20:23], a[168:171], v[176:179], v[20:23]
v_mfma_f32_16x16x32_bf16 v[28:31], a[168:171], v[192:195], v[28:31]
v_mfma_f32_16x16x32_bf16 v[36:39], a[168:171], v[208:211], v[36:39]
v_mfma_f32_16x16x32_bf16 v[12:15], a[172:175], v[164:167], v[12:15]
v_mfma_f32_16x16x32_bf16 v[20:23], a[172:175], v[180:183], v[20:23]
v_mfma_f32_16x16x32_bf16 v[28:31], a[172:175], v[196:199], v[28:31]
v_mfma_f32_16x16x32_bf16 v[36:39], a[172:175], v[212:215], v[36:39]
s_nop 7
s_nop 3
v_max3_f32 v136, v136, v8, v9
v_max3_f32 v136, v136, v10, v11
v_max3_f32 v136, v136, v12, v13
v_max3_f32 v136, v136, v14, v15
v_max3_f32 v140, v140, v16, v17
v_max3_f32 v140, v140, v18, v19
v_max3_f32 v140, v140, v20, v21
v_max3_f32 v140, v140, v22, v23
v_max3_f32 v144, v144, v24, v25
v_max3_f32 v144, v144, v26, v27
v_max3_f32 v144, v144, v28, v29
v_max3_f32 v144, v144, v30, v31
v_max3_f32 v148, v148, v32, v33
v_max3_f32 v148, v148, v34, v35
v_max3_f32 v148, v148, v36, v37
v_max3_f32 v148, v148, v38, v39
s_barrier
s_add_u32 s32, s32, 16384
s_sub_u32 s33, s33, 1
s_cmp_lg_u32 s33, 0
s_cbranch_scc1 K_FBLOOP
v_mov_b32 v246, v136
s_nop 1
v_permlane16_swap_b32 v136, v246
v_max_f32 v136, v136, v246
v_mov_b32 v246, v136
s_nop 1
v_permlane32_swap_b32 v136, v246
v_max_f32 v136, v136, v246
v_sub_f32 v136, 0, v136
v_mov_b32 v137, v136
v_mov_b32 v138, v136
v_mov_b32 v139, v136
v_mov_b32 v246, v140
s_nop 1
v_permlane16_swap_b32 v140, v246
v_max_f32 v140, v140, v246
v_mov_b32 v246, v140
s_nop 1
v_permlane32_swap_b32 v140, v246
v_max_f32 v140, v140, v246
v_sub_f32 v140, 0, v140
v_mov_b32 v141, v140
v_mov_b32 v142, v140
v_mov_b32 v143, v140
v_mov_b32 v246, v144
s_nop 1
v_permlane16_swap_b32 v144, v246
v_max_f32 v144, v144, v246
v_mov_b32 v246, v144
s_nop 1
v_permlane32_swap_b32 v144, v246
v_max_f32 v144, v144, v246
v_sub_f32 v144, 0, v144
v_mov_b32 v145, v144
v_mov_b32 v146, v144
v_mov_b32 v147, v144
v_mov_b32 v246, v148
s_nop 1
v_permlane16_swap_b32 v148, v246
v_max_f32 v148, v148, v246
v_mov_b32 v246, v148
s_nop 1
v_permlane32_swap_b32 v148, v246
v_max_f32 v148, v148, v246
v_sub_f32 v148, 0, v148
v_mov_b32 v149, v148
v_mov_b32 v150, v148
v_mov_b32 v151, v148
s_add_u32 s32, s7, 0
s_add_u32 m0, s30, 81920
s_nop 0
buffer_load_dwordx4 v228, s[8:11], s32 offen offset:0  lds
buffer_load_dwordx4 v229, s[8:11], s32 offen offset:1024  lds
buffer_load_dwordx4 v230, s[8:11], s32 offen offset:2048  lds
buffer_load_dwordx4 v231, s[8:11], s32 offen offset:3072  lds
s_add_u32 s32, s7, 16384
s_add_u32 m0, s30, 114688
s_nop 0
buffer_load_dwordx4 v228, s[8:11], s32 offen offset:0  lds
buffer_load_dwordx4 v229, s[8:11], s32 offen offset:1024  lds
buffer_load_dwordx4 v230, s[8:11], s32 offen offset:2048  lds
buffer_load_dwordx4 v231, s[8:11], s32 offen offset:3072  lds
s_add_u32 s39, s7, 0
s_add_u32 m0, s30, 131072
s_nop 0
buffer_load_dwordx4 v232, s[12:15], s39 offen offset:0  lds
buffer_load_dwordx4 v233, s[12:15], s39 offen offset:1024  lds
buffer_load_dwordx4 v232, s[12:15], s39 offen offset:2048  lds
buffer_load_dwordx4 v233, s[12:15], s39 offen offset:3072  lds
s_add_u32 s32, s7, 32768
s_add_u32 m0, s30, 65536
s_nop 0
buffer_load_dwordx4 v228, s[8:11], s32 offen offset:0  lds
buffer_load_dwordx4 v229, s[8:11], s32 offen offset:1024  lds
buffer_load_dwordx4 v230, s[8:11], s32 offen offset:2048  lds
buffer_load_dwordx4 v231, s[8:11], s32 offen offset:3072  lds
s_add_u32 s39, s7, 16384
s_add_u32 m0, s30, 147456
s_nop 0
buffer_load_dwordx4 v232, s[12:15], s39 offen offset:0  lds
buffer_load_dwordx4 v233, s[12:15], s39 offen offset:1024  lds
buffer_load_dwordx4 v232, s[12:15], s39 offen offset:2048  lds
buffer_load_dwordx4 v233, s[12:15], s39 offen offset:3072  lds
s_waitcnt vmcnt(0)
s_barrier
ds_read_b128 a[144:147], v216 offset:16384
ds_read_b128 a[148:151], v217 offset:16384
ds_read_b128 a[152:155], v218 offset:16384
ds_read_b128 a[156:159], v219 offset:16384
ds_read_b128 a[160:163], v216 offset:20480
ds_read_b128 a[164:167], v217 offset:20480
ds_read_b128 a[168:171], v218 offset:20480
ds_read_b128 a[172:175], v219 offset:20480
s_add_u32 s32, s7, 32768
s_add_u32 s39, s7, 16384
s_mul_i32 s88, s37, 864
s_mov_b32 s87, s88
v_accvgpr_write_b32 a128, 0
v_accvgpr_write_b32 a129, 0
v_accvgpr_write_b32 a130, 0
v_accvgpr_write_b32 a131, 0
v_accvgpr_write_b32 a132, 0
v_accvgpr_write_b32 a133, 0
v_accvgpr_write_b32 a134, 0
v_accvgpr_write_b32 a135, 0
v_lshrrev_b32 v240, 2, v1
v_mul_u32_u24 v240, 0x2400, v240
v_and_b32 v246, 3, v1
v_lshl_add_u32 v240, v246, 4, v240
v_mul_u32_u24 v243, 3641, v1
v_lshrrev_b32 v243, 16, v243
v_mul_u32_u24 v243, 864, v243
v_add_u32 v243, v243, v244
s_waitcnt lgkmcnt(0)
v_mfma_f32_16x16x32_bf16 v[8:11], a[144:147], v[152:155], v[136:139]
v_mfma_f32_16x16x32_bf16 v[16:19], a[144:147], v[168:171], v[140:143]
v_mfma_f32_16x16x32_bf16 v[24:27], a[144:147], v[184:187], v[144:147]
v_mfma_f32_16x16x32_bf16 v[32:35], a[144:147], v[200:203], v[148:151]
ds_read_b128 a[144:147], v216 offset:24576
v_mfma_f32_16x16x32_bf16 v[8:11], a[148:151], v[156:159], v[8:11]
v_mfma_f32_16x16x32_bf16 v[16:19], a[148:151], v[172:175], v[16:19]
v_mfma_f32_16x16x32_bf16 v[24:27], a[148:151], v[188:191], v[24:27]
v_mfma_f32_16x16x32_bf16 v[32:35], a[148:151], v[204:207], v[32:35]
ds_read_b128 a[148:151], v217 offset:24576
v_mfma_f32_16x16x32_bf16 v[8:11], a[152:155], v[160:163], v[8:11]
v_mfma_f32_16x16x32_bf16 v[16:19], a[152:155], v[176:179], v[16:19]
v_mfma_f32_16x16x32_bf16 v[24:27], a[152:155], v[192:195], v[24:27]
v_mfma_f32_16x16x32_bf16 v[32:35], a[152:155], v[208:211], v[32:35]
ds_read_b128 a[152:155], v218 offset:24576
v_mfma_f32_16x16x32_bf16 v[8:11], a[156:159], v[164:167], v[8:11]
v_mfma_f32_16x16x32_bf16 v[16:19], a[156:159], v[180:183], v[16:19]
v_mfma_f32_16x16x32_bf16 v[24:27], a[156:159], v[196:199], v[24:27]
v_mfma_f32_16x16x32_bf16 v[32:35], a[156:159], v[212:215], v[32:35]
ds_read_b128 a[156:159], v219 offset:24576
v_mfma_f32_16x16x32_bf16 v[12:15], a[160:163], v[152:155], v[136:139]
v_mfma_f32_16x16x32_bf16 v[20:23], a[160:163], v[168:171], v[140:143]
v_mfma_f32_16x16x32_bf16 v[28:31], a[160:163], v[184:187], v[144:147]
v_mfma_f32_16x16x32_bf16 v[36:39], a[160:163], v[200:203], v[148:151]
ds_read_b128 a[160:163], v216 offset:28672
v_mfma_f32_16x16x32_bf16 v[12:15], a[164:167], v[156:159], v[12:15]
v_mfma_f32_16x16x32_bf16 v[20:23], a[164:167], v[172:175], v[20:23]
v_mfma_f32_16x16x32_bf16 v[28:31], a[164:167], v[188:191], v[28:31]
v_mfma_f32_16x16x32_bf16 v[36:39], a[164:167], v[204:207], v[36:39]
ds_read_b128 a[164:167], v217 offset:28672
v_mfma_f32_16x16x32_bf16 v[12:15], a[168:171], v[160:163], v[12:15]
v_mfma_f32_16x16x32_bf16 v[20:23], a[168:171], v[176:179], v[20:23]
v_mfma_f32_16x16x32_bf16 v[28:31], a[168:171], v[192:195], v[28:31]
v_mfma_f32_16x16x32_bf16 v[36:39], a[168:171], v[208:211], v[36:39]
ds_read_b128 a[168:171], v218 offset:28672
v_mfma_f32_16x16x32_bf16 v[12:15], a[172:175], v[164:167], v[12:15]
v_mfma_f32_16x16x32_bf16 v[20:23], a[172:175], v[180:183], v[20:23]
v_mfma_f32_16x16x32_bf16 v[28:31], a[172:175], v[196:199], v[28:31]
v_mfma_f32_16x16x32_bf16 v[36:39], a[172:175], v[212:215], v[36:39]
ds_read_b128 a[172:175], v219 offset:28672
s_nop 7
s_branch K_BODY0
K_CODE_END:
.section .rodata,"a"
.p2align 6
.amdhsa_kernel recurrent_scan__gqa_block_cached__moe_arch_mod__prompt_kernel
  .amdhsa_next_free_vgpr 512
  .amdhsa_next_free_sgpr 102
  .amdhsa_accum_offset 256
  .amdhsa_group_segment_fixed_size 0
  .amdhsa_kernarg_size 104
  .amdhsa_user_sgpr_count 2
  .amdhsa_user_sgpr_kernarg_segment_ptr 1
  .amdhsa_system_sgpr_workgroup_id_x 1
  .amdhsa_float_denorm_mode_32 3
.end_amdhsa_kernel
```

```asm
; @launch grid=(256,1,1) block=(256,1,1) lds=163840
.amdgcn_target "amdgcn-amd-amdhsa--gfx950"
.text
.globl recurrent_scan__gqa_block_cached__moe_arch_mod__prompt_kernel
.p2align 8
.type recurrent_scan__gqa_block_cached__moe_arch_mod__prompt_kernel,@function
recurrent_scan__gqa_block_cached__moe_arch_mod__prompt_kernel:
s_cmp_ge_u32 s2, 256
s_cbranch_scc1 K_END
s_mov_b32 s100, 0
s_load_dwordx16 s[64:79], s[0:1], 0
s_load_dwordx8 s[80:87], s[0:1], 64
s_load_dwordx2 s[88:89], s[0:1], 96
s_lshr_b32 s35, s2, 3
s_and_b32 s36, s2, 7
s_mul_i32 s5, s36, 9
s_lshr_b32 s5, s5, 2
s_lshl_b32 s3, s36, 8
s_lshl_b32 s28, s35, 3
s_add_u32 s3, s3, s28
v_lshrrev_b32 v5, 5, v0
v_add_u32 v5, s3, v5
v_and_b32 v6, 31, v0
v_mul_u32_u24 v7, 0x480, v5
v_lshl_add_u32 v7, v6, 2, v7
v_and_b32 v1, 63, v0
v_lshrrev_b32 v2, 6, v0
v_lshlrev_b32 v8, 2, v6
v_readfirstlane_b32 s37, v2
v_and_b32 v3, 15, v1
v_lshrrev_b32 v4, 4, v1
s_getpc_b64 s[96:97]
PC_a:
s_sub_u32 s96, s96, PC_a-recurrent_scan__gqa_block_cached__moe_arch_mod__prompt_kernel
s_subb_u32 s97, s97, 0
s_lshl_b32 s50, s35, 2
s_add_u32 s50, s50, s37
s_min_u32 s50, s50, ((K_HOT_END-recurrent_scan__gqa_block_cached__moe_arch_mod__prompt_kernel)>>10)-1
s_lshl_b32 s50, s50, 10
v_lshlrev_b32 v11, 4, v1
v_add_u32 v11, s50, v11
global_load_dwordx4 v[172:175], v11, s[96:97]
s_waitcnt lgkmcnt(0)
s_mov_b32 s52, s64
s_and_b32 s53, s65, 0xffff
s_mov_b32 s54, 0x240000
s_mov_b32 s55, 0x00020000
buffer_load_dword v18, v7, s[52:55], 0 offen offset:0
buffer_load_dword v19, v7, s[52:55], 0 offen offset:128
buffer_load_dword v20, v7, s[52:55], 0 offen offset:256
buffer_load_dword v21, v7, s[52:55], 0 offen offset:384
buffer_load_dword v22, v7, s[52:55], 0 offen offset:512
buffer_load_dword v23, v7, s[52:55], 0 offen offset:640
buffer_load_dword v24, v7, s[52:55], 0 offen offset:768
buffer_load_dword v25, v7, s[52:55], 0 offen offset:896
buffer_load_dword v26, v7, s[52:55], 0 offen offset:1024
s_mov_b32 s28, 0x24c000
s_load_dwordx2 s[6:7], s[88:89], s28
s_mov_b32 s92, s76
s_and_b32 s93, s77, 0xffff
s_mov_b32 s94, 0x480
s_mov_b32 s95, 0x00020000
buffer_load_dword v28, v8, s[92:95], 0 offen offset:0
buffer_load_dword v29, v8, s[92:95], 0 offen offset:128
buffer_load_dword v30, v8, s[92:95], 0 offen offset:256
buffer_load_dword v31, v8, s[92:95], 0 offen offset:384
buffer_load_dword v32, v8, s[92:95], 0 offen offset:512
buffer_load_dword v33, v8, s[92:95], 0 offen offset:640
buffer_load_dword v34, v8, s[92:95], 0 offen offset:768
buffer_load_dword v35, v8, s[92:95], 0 offen offset:896
buffer_load_dword v36, v8, s[92:95], 0 offen offset:1024
s_mov_b32 s20, s88
s_and_b32 s21, s89, 0xffff
s_mov_b32 s22, 0x8000000
s_mov_b32 s23, 0x00020000
s_lshr_b32 s45, s3, 4
s_mul_i32 s45, s45, 18432
s_and_b32 s29, s3, 15
s_lshl_b32 s29, s29, 4
s_add_u32 s45, s45, s29
v_lshrrev_b32 v9, 1, v0
v_lshlrev_b32 v9, 8, v9
v_and_b32 v10, 1, v0
v_lshl_add_u32 v9, v10, 6, v9
s_add_u32 s29, s45, 0x1800000
v_add_u32 v9, s29, v9
s_lshl_b32 s28, s36, 8
s_add_u32 s28, s28, 0x24ac00
v_lshlrev_b32 v10, 6, v0
v_add_u32 v10, s28, v10
v_cmp_lt_u32 vcc, 143, v0
s_lshl_b32 s29, s3, 2
s_add_u32 s29, s29, 0x1a40000
v_cndmask_b32 v9, v9, v10, vcc
v_mov_b32 v10, s29
v_cmp_lt_u32 vcc, 147, v0
s_nop 1
v_cndmask_b32 v9, v9, v10, vcc
buffer_load_dword v176, v9, s[20:23], 0 offen sc1
s_mov_b32 s16, s70
s_and_b32 s17, s71, 0xffff
s_mov_b32 s18, 0x480000
s_mov_b32 s19, 0x00020000
v_add_u32 v9, 0, v4
v_lshlrev_b32 v10, 1, v9
v_xor_b32 v10, v10, v3
v_lshlrev_b32 v10, 4, v10
v_lshl_add_u32 v238, v9, 13, v10
v_add_u32 v9, 4, v4
v_lshlrev_b32 v10, 1, v9
v_xor_b32 v10, v10, v3
v_lshlrev_b32 v10, 4, v10
v_lshl_add_u32 v239, v9, 13, v10
v_subrev_u32 v239, 1024, v239
s_cmp_eq_u32 s37, 0
s_cbranch_scc1 F_NOWQ
s_sub_u32 s28, s37, 1
s_lshl_b32 s49, s28, 11
s_lshl_b32 s28, s28, 16
s_lshl_b32 s34, s35, 8
s_add_u32 s34, s34, s28
s_lshl_b32 s28, s5, 18
s_add_u32 s34, s34, s28
s_add_u32 m0, s49, 65536
s_nop 0
buffer_load_dwordx4 v238, s[16:19], s34 offen offset:0 lds
buffer_load_dwordx4 v239, s[16:19], s34 offen offset:1024 lds
s_add_u32 s34, s34, 196608
s_sub_u32 s51, s34, 4718592
s_cselect_b32 s34, s34, s51
s_add_u32 m0, s49, 71680
s_nop 0
buffer_load_dwordx4 v238, s[16:19], s34 offen offset:0 lds
buffer_load_dwordx4 v239, s[16:19], s34 offen offset:1024 lds
s_add_u32 s34, s34, 196608
s_sub_u32 s51, s34, 4718592
s_cselect_b32 s34, s34, s51
s_add_u32 m0, s49, 77824
s_nop 0
buffer_load_dwordx4 v238, s[16:19], s34 offen offset:0 lds
buffer_load_dwordx4 v239, s[16:19], s34 offen offset:1024 lds
s_add_u32 s34, s34, 196608
s_sub_u32 s51, s34, 4718592
s_cselect_b32 s34, s34, s51
s_add_u32 m0, s49, 83968
s_nop 0
buffer_load_dwordx4 v238, s[16:19], s34 offen offset:0 lds
buffer_load_dwordx4 v239, s[16:19], s34 offen offset:1024 lds
s_add_u32 s34, s34, 196608
s_sub_u32 s51, s34, 4718592
s_cselect_b32 s34, s34, s51
s_add_u32 m0, s49, 90112
s_nop 0
buffer_load_dwordx4 v238, s[16:19], s34 offen offset:0 lds
buffer_load_dwordx4 v239, s[16:19], s34 offen offset:1024 lds
s_add_u32 s34, s34, 196608
s_sub_u32 s51, s34, 4718592
s_cselect_b32 s34, s34, s51
F_NOWQ:
s_getreg_b32 s38, hwreg(HW_REG_XCC_ID, 0, 4)
s_mov_b32 s24, s86
s_and_b32 s25, s87, 0xffff
s_mov_b32 s26, 0x100
s_mov_b32 s27, 0x00020000
s_add_u32 s28, s2, s37
s_cbranch_scc1 F_NOX
s_cmp_eq_u32 s28, 0
s_cbranch_scc0 F_NOX
s_or_b32 s28, s38, 0x80
v_mov_b32 v9, s28
v_mov_b32 v10, 0
s_mov_b64 exec, 1
buffer_store_byte v9, v10, s[24:27], 0 offen sc0 sc1
s_mov_b64 exec, -1
s_waitcnt vmcnt(2)
F_NOX:
v_and_b32 v66, 7, v1
v_mul_u32_u24 v67, 1168, v66
v_lshrrev_b32 v68, 5, v1
v_lshl_add_u32 v67, v68, 6, v67
v_bfe_u32 v69, v1, 3, 2
v_lshl_add_u32 v67, v69, 3, v67
v_add_u32 v168, 0x24000, v67
v_lshlrev_b32 v70, 10, v68
v_lshl_add_u32 v71, v69, 4, v66
v_lshl_add_u32 v169, v71, 4, v70
v_lshlrev_b32 v244, 4, v1
v_bfe_u32 v9, v1, 2, 2
v_and_b32 v10, 3, v1
v_lshl_add_u32 v11, v4, 2, v9
v_and_b32 v12, 7, v11
v_lshrrev_b32 v14, 1, v10
v_xor_b32 v14, v14, v12
v_and_b32 v15, 1, v10
v_lshlrev_b32 v15, 4, v15
v_lshl_add_u32 v15, v11, 8, v15
v_add_u32 v15, 0x10000, v15
v_xor_b32 v16, 0, v14
v_lshl_add_u32 v234, v16, 5, v15
v_xor_b32 v16, 2, v14
v_lshl_add_u32 v235, v16, 5, v15
v_xor_b32 v16, 4, v14
v_lshl_add_u32 v236, v16, 5, v15
v_xor_b32 v16, 6, v14
v_lshl_add_u32 v237, v16, 5, v15
s_lshl2_add_u32 s50, s36, s37
s_lshr_b32 s29, s35, 2
s_add_u32 s28, s29, 0
s_and_b32 s28, s28, 3
s_lshl2_add_u32 s28, s50, s28
s_mul_i32 s28, s28, 18432
v_add_u32 v240, s28, v244
s_add_u32 s28, s29, 1
s_and_b32 s28, s28, 3
s_lshl2_add_u32 s28, s50, s28
s_mul_i32 s28, s28, 18432
v_add_u32 v241, s28, v244
s_add_u32 s28, s29, 2
s_and_b32 s28, s28, 3
s_lshl2_add_u32 s28, s50, s28
s_mul_i32 s28, s28, 18432
v_add_u32 v242, s28, v244
s_add_u32 s28, s29, 3
s_and_b32 s28, s28, 3
s_lshl2_add_u32 s28, s50, s28
s_mul_i32 s28, s28, 18432
v_add_u32 v243, s28, v244
s_mov_b32 s40, 0x3e0293ee
s_mov_b32 s41, 0x3e0293ee
s_mov_b32 s76, 0x3ae38e39
s_mov_b32 s77, 0x3727c5ac
s_mov_b32 s75, 0xffff0000
s_cmp_eq_u32 s37, 0
s_cbranch_scc0 F_W1
s_waitcnt vmcnt(10)
s_branch F_W2
F_W1:
s_waitcnt vmcnt(20)
F_W2:
v_lshlrev_b32 v40, 16, v18
v_and_b32 v41, s75, v18
v_lshlrev_b32 v42, 16, v19
v_and_b32 v43, s75, v19
v_lshlrev_b32 v44, 16, v20
v_and_b32 v45, s75, v20
v_lshlrev_b32 v46, 16, v21
v_and_b32 v47, s75, v21
v_lshlrev_b32 v48, 16, v22
v_and_b32 v49, s75, v22
v_lshlrev_b32 v50, 16, v23
v_and_b32 v51, s75, v23
v_lshlrev_b32 v52, 16, v24
v_and_b32 v53, s75, v24
v_lshlrev_b32 v54, 16, v25
v_and_b32 v55, s75, v25
v_lshlrev_b32 v56, 16, v26
v_and_b32 v57, s75, v26
v_pk_add_f32 v[60:61], v[40:41], v[42:43]
v_pk_add_f32 v[62:63], v[44:45], v[46:47]
v_pk_add_f32 v[60:61], v[60:61], v[48:49]
v_pk_add_f32 v[62:63], v[62:63], v[50:51]
v_pk_add_f32 v[60:61], v[60:61], v[52:53]
v_pk_add_f32 v[62:63], v[62:63], v[54:55]
v_pk_add_f32 v[60:61], v[60:61], v[56:57]
v_pk_add_f32 v[60:61], v[60:61], v[62:63]
v_add_f32 v60, v60, v61
s_nop 1
v_add_f32_dpp v61, v60, v60 row_ror:8 row_mask:0xf bank_mask:0xf
s_nop 1
v_add_f32_dpp v60, v61, v61 row_ror:4 row_mask:0xf bank_mask:0xf
s_nop 1
v_add_f32_dpp v61, v60, v60 row_ror:2 row_mask:0xf bank_mask:0xf
s_nop 1
v_add_f32_dpp v60, v61, v61 row_ror:1 row_mask:0xf bank_mask:0xf
v_mov_b32 v61, v60
s_nop 1
v_permlane16_swap_b32 v60, v61
v_add_f32 v60, v60, v61
v_mul_f32 v60, s76, v60
v_mov_b32 v61, v60
v_pk_add_f32 v[66:67], v[40:41], v[60:61] neg_lo:[0,1] neg_hi:[0,1]
v_pk_mul_f32 v[62:63], v[66:67], v[66:67]
v_pk_add_f32 v[68:69], v[42:43], v[60:61] neg_lo:[0,1] neg_hi:[0,1]
v_pk_fma_f32 v[62:63], v[68:69], v[68:69], v[62:63]
v_pk_add_f32 v[66:67], v[44:45], v[60:61] neg_lo:[0,1] neg_hi:[0,1]
v_pk_fma_f32 v[62:63], v[66:67], v[66:67], v[62:63]
v_pk_add_f32 v[68:69], v[46:47], v[60:61] neg_lo:[0,1] neg_hi:[0,1]
v_pk_fma_f32 v[62:63], v[68:69], v[68:69], v[62:63]
v_pk_add_f32 v[66:67], v[48:49], v[60:61] neg_lo:[0,1] neg_hi:[0,1]
v_pk_fma_f32 v[62:63], v[66:67], v[66:67], v[62:63]
v_pk_add_f32 v[68:69], v[50:51], v[60:61] neg_lo:[0,1] neg_hi:[0,1]
v_pk_fma_f32 v[62:63], v[68:69], v[68:69], v[62:63]
v_pk_add_f32 v[66:67], v[52:53], v[60:61] neg_lo:[0,1] neg_hi:[0,1]
v_pk_fma_f32 v[62:63], v[66:67], v[66:67], v[62:63]
v_pk_add_f32 v[68:69], v[54:55], v[60:61] neg_lo:[0,1] neg_hi:[0,1]
v_pk_fma_f32 v[62:63], v[68:69], v[68:69], v[62:63]
v_pk_add_f32 v[66:67], v[56:57], v[60:61] neg_lo:[0,1] neg_hi:[0,1]
v_pk_fma_f32 v[62:63], v[66:67], v[66:67], v[62:63]
v_add_f32 v61, v62, v63
s_nop 1
v_add_f32_dpp v62, v61, v61 row_ror:8 row_mask:0xf bank_mask:0xf
s_nop 1
v_add_f32_dpp v61, v62, v62 row_ror:4 row_mask:0xf bank_mask:0xf
s_nop 1
v_add_f32_dpp v62, v61, v61 row_ror:2 row_mask:0xf bank_mask:0xf
s_nop 1
v_add_f32_dpp v61, v62, v62 row_ror:1 row_mask:0xf bank_mask:0xf
v_mov_b32 v62, v61
s_nop 1
v_permlane16_swap_b32 v61, v62
v_add_f32 v61, v61, v62
v_mul_f32 v61, s76, v61
v_cvt_pk_bf16_f32 v60, v60, v60
v_lshlrev_b32 v60, 16, v60
v_cvt_pk_bf16_f32 v61, v61, v61
v_lshlrev_b32 v61, 16, v61
v_add_f32 v61, s77, v61
v_cvt_pk_bf16_f32 v61, v61, v61
v_lshlrev_b32 v61, 16, v61
v_sqrt_f32 v61, v61
s_nop 0
v_cvt_pk_bf16_f32 v61, v61, v61
v_lshlrev_b32 v61, 16, v61
v_rcp_f32 v62, v61
v_mov_b32 v63, 0
v_lshrrev_b32 v69, 5, v0
v_mul_u32_u24 v65, 1168, v69
v_lshl_add_u32 v65, v6, 2, v65
v_add_u32 v209, 0x24000, v65
s_cmp_eq_u32 s37, 0
s_cbranch_scc0 F_W3
s_waitcnt vmcnt(1)
F_W3:
s_waitcnt vmcnt(11)
v_mov_b32 v70, v60
v_mov_b32 v71, v60
v_mov_b32 v72, v61
v_mov_b32 v73, v61
v_mov_b32 v74, v62
v_mov_b32 v75, v62
v_pk_add_f32 v[40:41], v[40:41], v[70:71] neg_lo:[0,1] neg_hi:[0,1]
v_cvt_pk_bf16_f32 v68, v40, v41
v_lshlrev_b32 v40, 16, v68
v_and_b32 v41, s75, v68
v_pk_mul_f32 v[66:67], v[40:41], v[74:75]
v_pk_fma_f32 v[40:41], v[66:67], v[72:73], v[40:41] neg_lo:[1,0,0] neg_hi:[1,0,0]
v_pk_fma_f32 v[66:67], v[40:41], v[74:75], v[66:67]
v_cvt_pk_bf16_f32 v200, v66, v67
v_pk_mul_f32 v[66:67], v[66:67], s[40:41]
v_dot2_f32_bf16 v63, v200, v28, v63
v_cvt_pk_bf16_f32 v18, v66, v67
ds_write_b32 v209, v18 offset:0
v_pk_add_f32 v[42:43], v[42:43], v[70:71] neg_lo:[0,1] neg_hi:[0,1]
v_cvt_pk_bf16_f32 v68, v42, v43
v_lshlrev_b32 v42, 16, v68
v_and_b32 v43, s75, v68
v_pk_mul_f32 v[66:67], v[42:43], v[74:75]
v_pk_fma_f32 v[42:43], v[66:67], v[72:73], v[42:43] neg_lo:[1,0,0] neg_hi:[1,0,0]
v_pk_fma_f32 v[66:67], v[42:43], v[74:75], v[66:67]
v_cvt_pk_bf16_f32 v201, v66, v67
v_pk_mul_f32 v[66:67], v[66:67], s[40:41]
v_dot2_f32_bf16 v63, v201, v29, v63
v_cvt_pk_bf16_f32 v19, v66, v67
ds_write_b32 v209, v19 offset:128
v_pk_add_f32 v[44:45], v[44:45], v[70:71] neg_lo:[0,1] neg_hi:[0,1]
v_cvt_pk_bf16_f32 v68, v44, v45
v_lshlrev_b32 v44, 16, v68
v_and_b32 v45, s75, v68
v_pk_mul_f32 v[66:67], v[44:45], v[74:75]
v_pk_fma_f32 v[44:45], v[66:67], v[72:73], v[44:45] neg_lo:[1,0,0] neg_hi:[1,0,0]
v_pk_fma_f32 v[66:67], v[44:45], v[74:75], v[66:67]
v_cvt_pk_bf16_f32 v202, v66, v67
v_pk_mul_f32 v[66:67], v[66:67], s[40:41]
v_dot2_f32_bf16 v63, v202, v30, v63
v_cvt_pk_bf16_f32 v20, v66, v67
ds_write_b32 v209, v20 offset:256
v_pk_add_f32 v[46:47], v[46:47], v[70:71] neg_lo:[0,1] neg_hi:[0,1]
v_cvt_pk_bf16_f32 v68, v46, v47
v_lshlrev_b32 v46, 16, v68
v_and_b32 v47, s75, v68
v_pk_mul_f32 v[66:67], v[46:47], v[74:75]
v_pk_fma_f32 v[46:47], v[66:67], v[72:73], v[46:47] neg_lo:[1,0,0] neg_hi:[1,0,0]
v_pk_fma_f32 v[66:67], v[46:47], v[74:75], v[66:67]
v_cvt_pk_bf16_f32 v203, v66, v67
v_pk_mul_f32 v[66:67], v[66:67], s[40:41]
v_dot2_f32_bf16 v63, v203, v31, v63
v_cvt_pk_bf16_f32 v21, v66, v67
ds_write_b32 v209, v21 offset:384
v_pk_add_f32 v[48:49], v[48:49], v[70:71] neg_lo:[0,1] neg_hi:[0,1]
v_cvt_pk_bf16_f32 v68, v48, v49
v_lshlrev_b32 v48, 16, v68
v_and_b32 v49, s75, v68
v_pk_mul_f32 v[66:67], v[48:49], v[74:75]
v_pk_fma_f32 v[48:49], v[66:67], v[72:73], v[48:49] neg_lo:[1,0,0] neg_hi:[1,0,0]
v_pk_fma_f32 v[66:67], v[48:49], v[74:75], v[66:67]
v_cvt_pk_bf16_f32 v204, v66, v67
v_pk_mul_f32 v[66:67], v[66:67], s[40:41]
v_dot2_f32_bf16 v63, v204, v32, v63
v_cvt_pk_bf16_f32 v22, v66, v67
ds_write_b32 v209, v22 offset:512
v_pk_add_f32 v[50:51], v[50:51], v[70:71] neg_lo:[0,1] neg_hi:[0,1]
v_cvt_pk_bf16_f32 v68, v50, v51
v_lshlrev_b32 v50, 16, v68
v_and_b32 v51, s75, v68
v_pk_mul_f32 v[66:67], v[50:51], v[74:75]
v_pk_fma_f32 v[50:51], v[66:67], v[72:73], v[50:51] neg_lo:[1,0,0] neg_hi:[1,0,0]
v_pk_fma_f32 v[66:67], v[50:51], v[74:75], v[66:67]
v_cvt_pk_bf16_f32 v205, v66, v67
v_pk_mul_f32 v[66:67], v[66:67], s[40:41]
v_dot2_f32_bf16 v63, v205, v33, v63
v_cvt_pk_bf16_f32 v23, v66, v67
ds_write_b32 v209, v23 offset:640
v_pk_add_f32 v[52:53], v[52:53], v[70:71] neg_lo:[0,1] neg_hi:[0,1]
v_cvt_pk_bf16_f32 v68, v52, v53
v_lshlrev_b32 v52, 16, v68
v_and_b32 v53, s75, v68
v_pk_mul_f32 v[66:67], v[52:53], v[74:75]
v_pk_fma_f32 v[52:53], v[66:67], v[72:73], v[52:53] neg_lo:[1,0,0] neg_hi:[1,0,0]
v_pk_fma_f32 v[66:67], v[52:53], v[74:75], v[66:67]
v_cvt_pk_bf16_f32 v206, v66, v67
v_pk_mul_f32 v[66:67], v[66:67], s[40:41]
v_dot2_f32_bf16 v63, v206, v34, v63
v_cvt_pk_bf16_f32 v24, v66, v67
ds_write_b32 v209, v24 offset:768
v_pk_add_f32 v[54:55], v[54:55], v[70:71] neg_lo:[0,1] neg_hi:[0,1]
v_cvt_pk_bf16_f32 v68, v54, v55
v_lshlrev_b32 v54, 16, v68
v_and_b32 v55, s75, v68
v_pk_mul_f32 v[66:67], v[54:55], v[74:75]
v_pk_fma_f32 v[54:55], v[66:67], v[72:73], v[54:55] neg_lo:[1,0,0] neg_hi:[1,0,0]
v_pk_fma_f32 v[66:67], v[54:55], v[74:75], v[66:67]
v_cvt_pk_bf16_f32 v207, v66, v67
v_pk_mul_f32 v[66:67], v[66:67], s[40:41]
v_dot2_f32_bf16 v63, v207, v35, v63
v_cvt_pk_bf16_f32 v25, v66, v67
ds_write_b32 v209, v25 offset:896
v_pk_add_f32 v[56:57], v[56:57], v[70:71] neg_lo:[0,1] neg_hi:[0,1]
v_cvt_pk_bf16_f32 v68, v56, v57
v_lshlrev_b32 v56, 16, v68
v_and_b32 v57, s75, v68
v_pk_mul_f32 v[66:67], v[56:57], v[74:75]
v_pk_fma_f32 v[56:57], v[66:67], v[72:73], v[56:57] neg_lo:[1,0,0] neg_hi:[1,0,0]
v_pk_fma_f32 v[66:67], v[56:57], v[74:75], v[66:67]
v_cvt_pk_bf16_f32 v208, v66, v67
v_pk_mul_f32 v[66:67], v[66:67], s[40:41]
v_dot2_f32_bf16 v63, v208, v36, v63
v_cvt_pk_bf16_f32 v26, v66, v67
ds_write_b32 v209, v26 offset:1024
s_nop 2
s_nop 1
v_add_f32_dpp v62, v63, v63 row_ror:8 row_mask:0xf bank_mask:0xf
s_nop 1
v_add_f32_dpp v63, v62, v62 row_ror:4 row_mask:0xf bank_mask:0xf
s_nop 1
v_add_f32_dpp v62, v63, v63 row_ror:2 row_mask:0xf bank_mask:0xf
s_nop 1
v_add_f32_dpp v63, v62, v62 row_ror:1 row_mask:0xf bank_mask:0xf
v_mov_b32 v62, v63
s_nop 1
v_permlane16_swap_b32 v63, v62
v_add_f32 v63, v63, v62
v_cvt_pk_bf16_f32 v63, v63, v63
v_lshlrev_b32 v63, 16, v63
v_ashrrev_i32 v66, 31, v63
v_or_b32 v66, 0x80000000, v66
v_xor_b32 v63, v63, v66
v_and_b32 v63, s75, v63
v_sub_u32 v66, 0xffff, v5
v_or_b32 v63, v63, v66
v_lshlrev_b32 v66, 2, v69
v_add_u32 v66, 0x26480, v66
ds_write_b32 v66, v63
v_and_b32 v64, 7, v1
v_lshlrev_b32 v64, 2, v64
s_waitcnt lgkmcnt(0)
s_barrier
s_mul_i32 s101, s6, 0x9e3779b1
s_add_u32 s101, s101, 0x7f4a7c15
s_mul_i32 s47, s7, 0x85ebca6b
s_add_u32 s47, s47, 0x165667b1
s_cmp_eq_u32 s37, 0
s_cbranch_scc0 F_OTHER
ds_read2_b64 v[72:75], v168 offset0:0 offset1:4
ds_read2_b64 v[76:79], v168 offset0:16 offset1:20
ds_read2_b64 v[80:83], v168 offset0:32 offset1:36
ds_read2_b64 v[84:87], v168 offset0:48 offset1:52
ds_read2_b64 v[88:91], v168 offset0:64 offset1:68
ds_read2_b64 v[92:95], v168 offset0:80 offset1:84
ds_read2_b64 v[96:99], v168 offset0:96 offset1:100
ds_read2_b64 v[100:103], v168 offset0:112 offset1:116
ds_read2_b64 v[104:107], v168 offset0:128 offset1:132
v_add_u32 v65, 0x26480, v64
ds_read_b32 v65, v65
s_add_u32 s28, s45, 0x1800000
s_waitcnt lgkmcnt(9)
buffer_store_dwordx4 v[72:75], v169, s[20:23], s28 offen offset:0
s_waitcnt lgkmcnt(8)
buffer_store_dwordx4 v[76:79], v169, s[20:23], s28 offen offset:2048
s_add_u32 s28, s28, 4096
s_waitcnt lgkmcnt(7)
buffer_store_dwordx4 v[80:83], v169, s[20:23], s28 offen offset:0
s_waitcnt lgkmcnt(6)
buffer_store_dwordx4 v[84:87], v169, s[20:23], s28 offen offset:2048
s_add_u32 s28, s28, 4096
s_waitcnt lgkmcnt(5)
buffer_store_dwordx4 v[88:91], v169, s[20:23], s28 offen offset:0
s_waitcnt lgkmcnt(4)
buffer_store_dwordx4 v[92:95], v169, s[20:23], s28 offen offset:2048
s_add_u32 s28, s28, 4096
s_waitcnt lgkmcnt(3)
buffer_store_dwordx4 v[96:99], v169, s[20:23], s28 offen offset:0
s_waitcnt lgkmcnt(2)
buffer_store_dwordx4 v[100:103], v169, s[20:23], s28 offen offset:2048
s_add_u32 s28, s28, 4096
s_waitcnt lgkmcnt(1)
buffer_store_dwordx4 v[104:107], v169, s[20:23], s28 offen offset:0
s_lshl_b32 s28, s3, 2
s_add_u32 s28, s28, 0x1a40000
s_waitcnt lgkmcnt(0)
buffer_store_dword v65, v64, s[20:23], s28 offen
s_and_b32 s29, s101, -16
s_or_b32 s29, s29, s38
v_mov_b32 v58, s29
v_mov_b32 v59, s47
s_lshl_b32 s29, s35, 3
v_mov_b32 v61, s29
s_lshl_b32 s28, s36, 8
s_add_u32 s28, s28, 0x24d000
s_waitcnt vmcnt(0)
s_mov_b64 exec, 1
buffer_store_dwordx2 v[58:59], v61, s[20:23], s28 offen
s_mov_b64 exec, -1
s_branch F_JOIN
F_END0:
.p2align 12
K_P1:
F_OTHER:
STUB_0:
s_mov_b64 exec, 0
s_cmp_eq_u32 s37, 1
s_cbranch_scc1 STUB_A1
s_cmp_eq_u32 s37, 2
s_cbranch_scc1 STUB_A2
s_cmp_eq_u32 s37, 3
s_cbranch_scc1 STUB_A3
s_mov_b64 exec, -1
HOP_R1:
s_add_u32 m0, s49, 96256
s_nop 0
buffer_load_dwordx4 v238, s[16:19], s34 offen offset:0 lds
buffer_load_dwordx4 v239, s[16:19], s34 offen offset:1024 lds
s_add_u32 s34, s34, 196608
s_sub_u32 s51, s34, 4718592
s_cselect_b32 s34, s34, s51
s_add_u32 m0, s49, 102400
s_nop 0
buffer_load_dwordx4 v238, s[16:19], s34 offen offset:0 lds
buffer_load_dwordx4 v239, s[16:19], s34 offen offset:1024 lds
s_add_u32 s34, s34, 196608
s_sub_u32 s51, s34, 4718592
s_cselect_b32 s34, s34, s51
s_add_u32 m0, s49, 108544
s_nop 0
buffer_load_dwordx4 v238, s[16:19], s34 offen offset:0 lds
buffer_load_dwordx4 v239, s[16:19], s34 offen offset:1024 lds
s_add_u32 s34, s34, 196608
s_sub_u32 s51, s34, 4718592
s_cselect_b32 s34, s34, s51
s_mov_b64 exec, 0
s_cmp_eq_u32 s37, 1
s_cbranch_scc1 STUB_B1
s_cmp_eq_u32 s37, 2
s_cbranch_scc1 STUB_B2
s_cmp_eq_u32 s37, 3
s_cbranch_scc1 STUB_B3
s_mov_b64 exec, -1
HOP_R2:
F_JOIN:
s_lshl_b32 s49, s37, 11
s_lshl_b32 s28, s37, 16
s_lshl_b32 s34, s35, 8
s_add_u32 s34, s34, s28
s_lshl_b32 s28, s5, 18
s_add_u32 s34, s34, s28
s_add_u32 s34, s34, 1572864
s_sub_u32 s51, s34, 4718592
s_cselect_b32 s34, s34, s51
s_lshl_b32 s30, s37, 12
s_lshl_b32 s31, s37, 10
s_lshl_b32 s92, s36, 5
s_add_u32 s92, s92, s35
s_lshl2_add_u32 s92, s92, s37
s_lshl_b32 s44, s92, 14
s_add_u32 s44, s44, 0x400000
s_mov_b32 s42, 0x5f800000
s_mov_b32 s43, 0
s_lshr_b32 s92, s35, 1
s_lshl_b32 s92, s92, 19
s_add_u32 s66, s66, s92
s_addc_u32 s67, s67, 0
s_add_u32 s68, s68, s92
s_addc_u32 s69, s69, 0
s_mov_b32 s8, s66
s_and_b32 s9, s67, 0xffff
s_mov_b32 s10, 0x80000
s_mov_b32 s11, 0x00020000
s_mov_b32 s12, s68
s_and_b32 s13, s69, 0xffff
s_mov_b32 s14, 0x80000
s_mov_b32 s15, 0x00020000
s_mov_b32 s56, s72
s_and_b32 s57, s73, 0xffff
s_mov_b32 s58, 0x480000
s_mov_b32 s59, 0x00020000
s_mov_b32 s60, s84
s_and_b32 s61, s85, 0xffff
s_mov_b32 s62, 0x240000
s_mov_b32 s63, 0x00020000
s_mov_b32 s64, s78
s_and_b32 s65, s79, 0xffff
s_mov_b32 s66, 0x510000
s_mov_b32 s67, 0x00020000
s_mov_b32 s68, s80
s_and_b32 s69, s81, 0xffff
s_mov_b32 s70, 0x510000
s_mov_b32 s71, 0x00020000
s_mov_b32 s72, s82
s_and_b32 s73, s83, 0xffff
s_mov_b32 s74, 0x510000
s_mov_b32 s75, 0x00020000
s_lshr_b32 s92, s35, 2
s_mul_i32 s89, s92, 589824
s_and_b32 s92, s35, 3
s_mul_i32 s92, s92, 288
s_add_u32 s89, s89, s92
s_cmp_eq_u32 s37, 0
s_cbranch_scc1 F_W0P
s_waitcnt vmcnt(0)
s_branch F_BAR2
HOP_RET1:
s_mov_b64 exec, -1
s_branch HOP_R1
HOP_RET2:
s_mov_b64 exec, -1
s_branch HOP_R2
F_W0P:
s_mov_b32 s46, 0x20
s_lshl_b32 s28, s36, 8
s_add_u32 s28, s28, 0x24d000
v_and_b32 v61, 31, v1
v_lshlrev_b32 v61, 3, v61
s_mov_b32 s51, 0
v_mov_b32 v60, 3
F_POLL:
buffer_load_dwordx2 v[62:63], v61, s[20:23], s28 offen sc0 sc1
s_waitcnt vmcnt(0)
v_cmp_ne_u64 vcc, v[62:63], v[58:59]
s_cbranch_vccz F_GO
s_add_u32 s51, s51, 1
s_and_b32 s29, s51, 31
s_cbranch_scc1 F_POLL
s_branch F_NOTYET
F_GO:
v_mov_b32 v61, 156864
ds_write_b32 v61, v60
s_waitcnt lgkmcnt(0)
F_BAR2:
s_barrier
s_lshl_b32 s7, s36, 31
s_mov_b32 s7, 0
v_mov_b32 v246, 156864
ds_read_b32 v246, v246
s_mov_b32 s4, 0x1800000
s_mov_b32 s51, 3
Q_START:
s_lshl_b32 s28, s5, 10
s_add_u32 s28, s28, s4
s_add_u32 s6, s4, 18432
buffer_load_dwordx4 a[0:3], v240, s[20:23], s28 offen sc0 sc1
buffer_load_dwordx4 a[4:7], v241, s[20:23], s28 offen sc0 sc1
buffer_load_dwordx4 a[8:11], v242, s[20:23], s28 offen sc0 sc1
buffer_load_dwordx4 a[12:15], v243, s[20:23], s28 offen sc0 sc1
s_waitcnt lgkmcnt(0)
v_readfirstlane_b32 s48, v246
ds_read_b64_tr_b16 a[144:145], v234 offset:0
ds_read_b64_tr_b16 a[146:147], v234 offset:4096
ds_read_b64_tr_b16 a[148:149], v234 offset:8
ds_read_b64_tr_b16 a[150:151], v234 offset:4104
ds_read_b64_tr_b16 a[152:153], v235 offset:0
ds_read_b64_tr_b16 a[154:155], v235 offset:4096
ds_read_b64_tr_b16 a[156:157], v235 offset:8
ds_read_b64_tr_b16 a[158:159], v235 offset:4104
ds_read_b64_tr_b16 a[160:161], v236 offset:0
ds_read_b64_tr_b16 a[162:163], v236 offset:4096
ds_read_b64_tr_b16 a[164:165], v236 offset:8
ds_read_b64_tr_b16 a[166:167], v236 offset:4104
ds_read_b64_tr_b16 a[168:169], v237 offset:0
ds_read_b64_tr_b16 a[170:171], v237 offset:4096
ds_read_b64_tr_b16 a[172:173], v237 offset:8
ds_read_b64_tr_b16 a[174:175], v237 offset:4104
s_cmp_lt_u32 s48, s51
s_cbranch_scc1 Q_REDO
s_add_u32 s28, s28, 1024
s_cmp_lt_u32 s28, s6
s_cselect_b32 s28, s28, s4
buffer_load_dwordx4 a[16:19], v240, s[20:23], s28 offen sc0 sc1
buffer_load_dwordx4 a[20:23], v241, s[20:23], s28 offen sc0 sc1
buffer_load_dwordx4 a[24:27], v242, s[20:23], s28 offen sc0 sc1
buffer_load_dwordx4 a[28:31], v243, s[20:23], s28 offen sc0 sc1
s_lshl_b32 s29, s36, 10
s_add_u32 s29, s29, s4
s_add_u32 s29, s29, 0x240000
buffer_load_dwordx4 v[136:139], v244, s[20:23], s29 offen sc0 sc1
s_add_u32 s28, s28, 1024
s_cmp_lt_u32 s28, s6
s_cselect_b32 s28, s28, s4
buffer_load_dwordx4 a[32:35], v240, s[20:23], s28 offen sc0 sc1
buffer_load_dwordx4 a[36:39], v241, s[20:23], s28 offen sc0 sc1
buffer_load_dwordx4 a[40:43], v242, s[20:23], s28 offen sc0 sc1
buffer_load_dwordx4 a[44:47], v243, s[20:23], s28 offen sc0 sc1
s_waitcnt vmcnt(9)
s_waitcnt lgkmcnt(8)
v_mfma_f32_16x16x32_bf16 v[8:11], a[144:147], a[0:3], 0
ds_read_b64_tr_b16 a[176:177], v234 offset:8192
v_mov_b32 v143, 0
v_mfma_f32_16x16x32_bf16 v[40:43], a[144:147], a[4:7], 0
ds_read_b64_tr_b16 a[178:179], v234 offset:12288
ds_write_b32 v209, v200 offset:0
v_mfma_f32_16x16x32_bf16 v[72:75], a[144:147], a[8:11], 0
s_add_u32 s28, s28, 1024
s_cmp_lt_u32 s28, s6
s_cselect_b32 s28, s28, s4
v_mfma_f32_16x16x32_bf16 v[104:107], a[144:147], a[12:15], 0
ds_read_b64_tr_b16 a[180:181], v234 offset:8200
ds_write_b32 v209, v201 offset:128
v_mfma_f32_16x16x32_bf16 v[108:111], a[148:151], a[12:15], 0
ds_read_b64_tr_b16 a[182:183], v234 offset:12296
ds_write_b32 v209, v202 offset:256
v_mfma_f32_16x16x32_bf16 v[76:79], a[148:151], a[8:11], 0
buffer_load_dwordx4 a[48:51], v240, s[20:23], s28 offen sc0 sc1
v_mfma_f32_16x16x32_bf16 v[44:47], a[148:151], a[4:7], 0
ds_read_b64_tr_b16 a[184:185], v235 offset:8192
ds_write_b32 v209, v203 offset:384
v_mfma_f32_16x16x32_bf16 v[12:15], a[148:151], a[0:3], 0
ds_read_b64_tr_b16 a[186:187], v235 offset:12288
ds_write_b32 v209, v204 offset:512
v_mfma_f32_16x16x32_bf16 v[16:19], a[152:155], a[0:3], 0
buffer_load_dwordx4 a[52:55], v241, s[20:23], s28 offen sc0 sc1
v_mfma_f32_16x16x32_bf16 v[48:51], a[152:155], a[4:7], 0
ds_read_b64_tr_b16 a[188:189], v235 offset:8200
ds_write_b32 v209, v205 offset:640
v_mfma_f32_16x16x32_bf16 v[80:83], a[152:155], a[8:11], 0
ds_read_b64_tr_b16 a[190:191], v235 offset:12296
ds_write_b32 v209, v206 offset:768
v_mfma_f32_16x16x32_bf16 v[112:115], a[152:155], a[12:15], 0
buffer_load_dwordx4 a[56:59], v242, s[20:23], s28 offen sc0 sc1
v_mfma_f32_16x16x32_bf16 v[116:119], a[156:159], a[12:15], 0
ds_read_b64_tr_b16 a[192:193], v236 offset:8192
ds_write_b32 v209, v207 offset:896
v_mfma_f32_16x16x32_bf16 v[84:87], a[156:159], a[8:11], 0
buffer_load_dwordx4 a[60:63], v243, s[20:23], s28 offen sc0 sc1
v_mfma_f32_16x16x32_bf16 v[52:55], a[156:159], a[4:7], 0
ds_read_b64_tr_b16 a[194:195], v236 offset:12288
ds_write_b32 v209, v208 offset:1024
v_mfma_f32_16x16x32_bf16 v[20:23], a[156:159], a[0:3], 0
ds_read_b64_tr_b16 a[196:197], v236 offset:8200
v_add_u32 v184, 0, v4
s_waitcnt lgkmcnt(8)
v_mfma_f32_16x16x32_bf16 v[24:27], a[160:163], a[0:3], 0
s_add_u32 s28, s28, 1024
s_cmp_lt_u32 s28, s6
s_cselect_b32 s28, s28, s4
v_mfma_f32_16x16x32_bf16 v[56:59], a[160:163], a[4:7], 0
ds_read_b64_tr_b16 a[198:199], v236 offset:12296
v_xor_b32 v184, v184, v3
v_mfma_f32_16x16x32_bf16 v[88:91], a[160:163], a[8:11], 0
ds_read_b64_tr_b16 a[200:201], v237 offset:8192
v_lshlrev_b32 v184, 4, v184
v_mfma_f32_16x16x32_bf16 v[120:123], a[160:163], a[12:15], 0
buffer_load_dwordx4 a[64:67], v240, s[20:23], s28 offen sc0 sc1
v_mfma_f32_16x16x32_bf16 v[124:127], a[164:167], a[12:15], 0
ds_read_b64_tr_b16 a[202:203], v237 offset:12288
v_lshl_add_u32 v184, v3, 8, v184
v_mfma_f32_16x16x32_bf16 v[92:95], a[164:167], a[8:11], 0
ds_read_b64_tr_b16 a[204:205], v237 offset:8200
v_add_u32 v216, 0x10000, v184
v_mfma_f32_16x16x32_bf16 v[60:63], a[164:167], a[4:7], 0
buffer_load_dwordx4 a[68:71], v241, s[20:23], s28 offen sc0 sc1
v_mfma_f32_16x16x32_bf16 v[28:31], a[164:167], a[0:3], 0
ds_read_b64_tr_b16 a[206:207], v237 offset:12296
v_add_u32 v184, 4, v4
v_mfma_f32_16x16x32_bf16 v[32:35], a[168:171], a[0:3], 0
buffer_load_dwordx4 a[72:75], v242, s[20:23], s28 offen sc0 sc1
v_mfma_f32_16x16x32_bf16 v[64:67], a[168:171], a[4:7], 0
buffer_load_dwordx4 a[76:79], v243, s[20:23], s28 offen sc0 sc1
v_mfma_f32_16x16x32_bf16 v[96:99], a[168:171], a[8:11], 0
s_add_u32 m0, s49, 114688
v_xor_b32 v184, v184, v3
v_mfma_f32_16x16x32_bf16 v[128:131], a[168:171], a[12:15], 0
buffer_load_dwordx4 v238, s[16:19], s34 offen offset:0 lds
v_mfma_f32_16x16x32_bf16 v[132:135], a[172:175], a[12:15], 0
buffer_load_dwordx4 v239, s[16:19], s34 offen offset:1024 lds
v_mfma_f32_16x16x32_bf16 v[100:103], a[172:175], a[8:11], 0
s_add_u32 s34, s34, 262144
s_sub_u32 s51, s34, 4718592
s_cselect_b32 s34, s34, s51
v_mfma_f32_16x16x32_bf16 v[68:71], a[172:175], a[4:7], 0
s_mov_b32 s90, 0x01010101
s_mov_b32 s91, 0x01010101
v_mfma_f32_16x16x32_bf16 v[36:39], a[172:175], a[0:3], 0
v_lshlrev_b32 v184, 4, v184
v_lshl_add_u32 v184, v3, 8, v184
s_waitcnt vmcnt(15)
v_mfma_f32_16x16x32_bf16 v[8:11], a[176:179], a[16:19], v[8:11]
ds_read_b64_tr_b16 a[144:145], v234 offset:16384
v_add_u32 v217, 0x10000, v184
v_mfma_f32_16x16x32_bf16 v[40:43], a[176:179], a[20:23], v[40:43]
ds_read_b64_tr_b16 a[146:147], v234 offset:20480
v_add_u32 v184, 8, v4
v_mfma_f32_16x16x32_bf16 v[72:75], a[176:179], a[24:27], v[72:75]
s_add_u32 s28, s28, 1024
s_cmp_lt_u32 s28, s6
s_cselect_b32 s28, s28, s4
v_mfma_f32_16x16x32_bf16 v[104:107], a[176:179], a[28:31], v[104:107]
ds_read_b64_tr_b16 a[148:149], v234 offset:16392
v_xor_b32 v184, v184, v3
v_mfma_f32_16x16x32_bf16 v[108:111], a[180:183], a[28:31], v[108:111]
ds_read_b64_tr_b16 a[150:151], v234 offset:20488
v_lshlrev_b32 v184, 4, v184
v_mfma_f32_16x16x32_bf16 v[76:79], a[180:183], a[24:27], v[76:79]
buffer_load_dwordx4 a[80:83], v240, s[20:23], s28 offen sc0 sc1
v_mfma_f32_16x16x32_bf16 v[44:47], a[180:183], a[20:23], v[44:47]
ds_read_b64_tr_b16 a[152:153], v235 offset:16384
v_lshl_add_u32 v184, v3, 8, v184
v_mfma_f32_16x16x32_bf16 v[12:15], a[180:183], a[16:19], v[12:15]
ds_read_b64_tr_b16 a[154:155], v235 offset:20480
v_add_u32 v218, 0x10000, v184
v_mfma_f32_16x16x32_bf16 v[16:19], a[184:187], a[16:19], v[16:19]
buffer_load_dwordx4 a[84:87], v241, s[20:23], s28 offen sc0 sc1
v_mfma_f32_16x16x32_bf16 v[48:51], a[184:187], a[20:23], v[48:51]
ds_read_b64_tr_b16 a[156:157], v235 offset:16392
v_add_u32 v184, 12, v4
v_mfma_f32_16x16x32_bf16 v[80:83], a[184:187], a[24:27], v[80:83]
ds_read_b64_tr_b16 a[158:159], v235 offset:20488
v_xor_b32 v184, v184, v3
v_mfma_f32_16x16x32_bf16 v[112:115], a[184:187], a[28:31], v[112:115]
buffer_load_dwordx4 a[88:91], v242, s[20:23], s28 offen sc0 sc1
s_waitcnt lgkmcnt(8)
v_mfma_f32_16x16x32_bf16 v[116:119], a[188:191], a[28:31], v[116:119]
ds_read_b64_tr_b16 a[160:161], v236 offset:16384
v_lshlrev_b32 v184, 4, v184
v_mfma_f32_16x16x32_bf16 v[84:87], a[188:191], a[24:27], v[84:87]
buffer_load_dwordx4 a[92:95], v243, s[20:23], s28 offen sc0 sc1
v_mfma_f32_16x16x32_bf16 v[52:55], a[188:191], a[20:23], v[52:55]
ds_read_b64_tr_b16 a[162:163], v236 offset:20480
v_lshl_add_u32 v184, v3, 8, v184
v_mfma_f32_16x16x32_bf16 v[20:23], a[188:191], a[16:19], v[20:23]
ds_read_b64_tr_b16 a[164:165], v236 offset:16392
v_add_u32 v219, 0x10000, v184
v_mfma_f32_16x16x32_bf16 v[24:27], a[192:195], a[16:19], v[24:27]
s_add_u32 m0, s49, 122880
v_bfe_u32 v184, v1, 2, 2
v_mfma_f32_16x16x32_bf16 v[56:59], a[192:195], a[20:23], v[56:59]
ds_read_b64_tr_b16 a[166:167], v236 offset:20488
v_and_b32 v185, 3, v1
v_mfma_f32_16x16x32_bf16 v[88:91], a[192:195], a[24:27], v[88:91]
ds_read_b64_tr_b16 a[168:169], v237 offset:16384
v_lshl_add_u32 v186, v4, 2, v184
v_mfma_f32_16x16x32_bf16 v[120:123], a[192:195], a[28:31], v[120:123]
s_waitcnt vmcnt(18)
v_max3_u32 v140, v136, v137, v138
v_mfma_f32_16x16x32_bf16 v[124:127], a[196:199], a[28:31], v[124:127]
ds_read_b64_tr_b16 a[170:171], v237 offset:20480
v_max_u32 v140, v140, v139
v_mfma_f32_16x16x32_bf16 v[92:95], a[196:199], a[24:27], v[92:95]
ds_read_b64_tr_b16 a[172:173], v237 offset:16392
v_and_b32 v187, 7, v186
v_mfma_f32_16x16x32_bf16 v[60:63], a[196:199], a[20:23], v[60:63]
buffer_load_dwordx4 v238, s[16:19], s34 offen offset:0 lds
v_mfma_f32_16x16x32_bf16 v[28:31], a[196:199], a[16:19], v[28:31]
ds_read_b64_tr_b16 a[174:175], v237 offset:20488
v_max_u32_dpp v141, v140, v140 row_ror:8 row_mask:0xf bank_mask:0xf
v_mfma_f32_16x16x32_bf16 v[32:35], a[200:203], a[16:19], v[32:35]
buffer_load_dwordx4 v239, s[16:19], s34 offen offset:1024 lds
v_mfma_f32_16x16x32_bf16 v[64:67], a[200:203], a[20:23], v[64:67]
v_max_u32_dpp v140, v141, v141 row_ror:4 row_mask:0xf bank_mask:0xf
v_lshlrev_b32 v188, 8, v186
v_mfma_f32_16x16x32_bf16 v[96:99], a[200:203], a[24:27], v[96:99]
s_add_u32 s34, s34, 262144
s_sub_u32 s51, s34, 4718592
s_cselect_b32 s34, s34, s51
v_mfma_f32_16x16x32_bf16 v[128:131], a[200:203], a[28:31], v[128:131]
v_max_u32_dpp v141, v140, v140 row_ror:2 row_mask:0xf bank_mask:0xf
v_lshl_add_u32 v188, v185, 3, v188
v_mfma_f32_16x16x32_bf16 v[132:135], a[204:207], a[28:31], v[132:135]
v_add_u32 v188, 0x18000, v188
v_xor_b32 v189, 0, v187
v_mfma_f32_16x16x32_bf16 v[100:103], a[204:207], a[24:27], v[100:103]
v_max_u32_dpp v140, v141, v141 row_ror:1 row_mask:0xf bank_mask:0xf
v_mov_b32 v141, v140
v_mfma_f32_16x16x32_bf16 v[68:71], a[204:207], a[20:23], v[68:71]
v_lshl_add_u32 v220, v189, 5, v188
v_xor_b32 v189, 1, v187
v_mfma_f32_16x16x32_bf16 v[36:39], a[204:207], a[16:19], v[36:39]
v_permlane16_swap_b32 v140, v141
v_max_u32 v140, v140, v141
s_waitcnt vmcnt(16)
s_waitcnt lgkmcnt(8)
v_mfma_f32_16x16x32_bf16 v[8:11], a[144:147], a[32:35], v[8:11]
ds_read_b64_tr_b16 a[176:177], v234 offset:24576
v_mov_b32 v141, v140
v_mfma_f32_16x16x32_bf16 v[40:43], a[144:147], a[36:39], v[40:43]
ds_read_b64_tr_b16 a[178:179], v234 offset:28672
v_lshl_add_u32 v221, v189, 5, v188
v_mfma_f32_16x16x32_bf16 v[72:75], a[144:147], a[40:43], v[72:75]
s_add_u32 s28, s28, 1024
s_cmp_lt_u32 s28, s6
s_cselect_b32 s28, s28, s4
v_mfma_f32_16x16x32_bf16 v[104:107], a[144:147], a[44:47], v[104:107]
ds_read_b64_tr_b16 a[180:181], v234 offset:24584
v_permlane32_swap_b32 v140, v141
v_mfma_f32_16x16x32_bf16 v[108:111], a[148:151], a[44:47], v[108:111]
ds_read_b64_tr_b16 a[182:183], v234 offset:28680
v_max_u32 v140, v140, v141
v_mfma_f32_16x16x32_bf16 v[76:79], a[148:151], a[40:43], v[76:79]
buffer_load_dwordx4 a[96:99], v240, s[20:23], s28 offen sc0 sc1
v_mfma_f32_16x16x32_bf16 v[44:47], a[148:151], a[36:39], v[44:47]
ds_read_b64_tr_b16 a[184:185], v235 offset:24576
v_add_u32 v143, v143, v140
v_mfma_f32_16x16x32_bf16 v[12:15], a[148:151], a[32:35], v[12:15]
ds_read_b64_tr_b16 a[186:187], v235 offset:28672
v_sub_u32 v136, v136, v140
v_mfma_f32_16x16x32_bf16 v[16:19], a[152:155], a[32:35], v[16:19]
buffer_load_dwordx4 a[100:103], v241, s[20:23], s28 offen sc0 sc1
v_mfma_f32_16x16x32_bf16 v[48:51], a[152:155], a[36:39], v[48:51]
ds_read_b64_tr_b16 a[188:189], v235 offset:24584
v_sub_u32 v137, v137, v140
v_mfma_f32_16x16x32_bf16 v[80:83], a[152:155], a[40:43], v[80:83]
ds_read_b64_tr_b16 a[190:191], v235 offset:28680
v_sub_u32 v138, v138, v140
v_mfma_f32_16x16x32_bf16 v[112:115], a[152:155], a[44:47], v[112:115]
buffer_load_dwordx4 a[104:107], v242, s[20:23], s28 offen sc0 sc1
v_mfma_f32_16x16x32_bf16 v[116:119], a[156:159], a[44:47], v[116:119]
ds_read_b64_tr_b16 a[192:193], v236 offset:24576
v_sub_u32 v139, v139, v140
v_mfma_f32_16x16x32_bf16 v[84:87], a[156:159], a[40:43], v[84:87]
buffer_load_dwordx4 a[108:111], v243, s[20:23], s28 offen sc0 sc1
v_mfma_f32_16x16x32_bf16 v[52:55], a[156:159], a[36:39], v[52:55]
ds_read_b64_tr_b16 a[194:195], v236 offset:28672
v_cndmask_b32 v142, v142, v143, s[90:91]
v_mfma_f32_16x16x32_bf16 v[20:23], a[156:159], a[32:35], v[20:23]
ds_read_b64_tr_b16 a[196:197], v236 offset:24584
s_lshl_b64 s[90:91], s[90:91], 1
s_waitcnt lgkmcnt(8)
v_mfma_f32_16x16x32_bf16 v[24:27], a[160:163], a[32:35], v[24:27]
s_add_u32 m0, s49, 131072
v_max3_u32 v140, v136, v137, v138
v_mfma_f32_16x16x32_bf16 v[56:59], a[160:163], a[36:39], v[56:59]
ds_read_b64_tr_b16 a[198:199], v236 offset:28680
v_max_u32 v140, v140, v139
v_mfma_f32_16x16x32_bf16 v[88:91], a[160:163], a[40:43], v[88:91]
ds_read_b64_tr_b16 a[200:201], v237 offset:24576
v_xor_b32 v189, 2, v187
v_mfma_f32_16x16x32_bf16 v[120:123], a[160:163], a[44:47], v[120:123]
v_max_u32_dpp v141, v140, v140 row_ror:8 row_mask:0xf bank_mask:0xf
v_lshl_add_u32 v222, v189, 5, v188
v_mfma_f32_16x16x32_bf16 v[124:127], a[164:167], a[44:47], v[124:127]
ds_read_b64_tr_b16 a[202:203], v237 offset:28672
v_xor_b32 v189, 3, v187
v_mfma_f32_16x16x32_bf16 v[92:95], a[164:167], a[40:43], v[92:95]
ds_read_b64_tr_b16 a[204:205], v237 offset:24584
v_max_u32_dpp v140, v141, v141 row_ror:4 row_mask:0xf bank_mask:0xf
v_mfma_f32_16x16x32_bf16 v[60:63], a[164:167], a[36:39], v[60:63]
buffer_load_dwordx4 v238, s[16:19], s34 offen offset:0 lds
v_mfma_f32_16x16x32_bf16 v[28:31], a[164:167], a[32:35], v[28:31]
ds_read_b64_tr_b16 a[206:207], v237 offset:28680
v_max_u32_dpp v141, v140, v140 row_ror:2 row_mask:0xf bank_mask:0xf
v_mfma_f32_16x16x32_bf16 v[32:35], a[168:171], a[32:35], v[32:35]
buffer_load_dwordx4 v239, s[16:19], s34 offen offset:1024 lds
v_mfma_f32_16x16x32_bf16 v[64:67], a[168:171], a[36:39], v[64:67]
v_max_u32_dpp v140, v141, v141 row_ror:1 row_mask:0xf bank_mask:0xf
v_mov_b32 v141, v140
v_mfma_f32_16x16x32_bf16 v[96:99], a[168:171], a[40:43], v[96:99]
s_add_u32 s34, s34, 262144
s_sub_u32 s51, s34, 4718592
s_cselect_b32 s34, s34, s51
v_mfma_f32_16x16x32_bf16 v[128:131], a[168:171], a[44:47], v[128:131]
v_permlane16_swap_b32 v140, v141
v_max_u32 v140, v140, v141
v_mfma_f32_16x16x32_bf16 v[132:135], a[172:175], a[44:47], v[132:135]
v_mov_b32 v141, v140
v_lshl_add_u32 v223, v189, 5, v188
v_mfma_f32_16x16x32_bf16 v[100:103], a[172:175], a[40:43], v[100:103]
v_xor_b32 v189, 4, v187
v_lshl_add_u32 v224, v189, 5, v188
v_mfma_f32_16x16x32_bf16 v[68:71], a[172:175], a[36:39], v[68:71]
v_permlane32_swap_b32 v140, v141
v_max_u32 v140, v140, v141
v_mfma_f32_16x16x32_bf16 v[36:39], a[172:175], a[32:35], v[36:39]
v_add_u32 v143, v143, v140
v_sub_u32 v136, v136, v140
s_waitcnt vmcnt(18)
v_mfma_f32_16x16x32_bf16 v[8:11], a[176:179], a[48:51], v[8:11]
ds_read_b64_tr_b16 a[144:145], v234 offset:32768
v_sub_u32 v137, v137, v140
v_mfma_f32_16x16x32_bf16 v[40:43], a[176:179], a[52:55], v[40:43]
ds_read_b64_tr_b16 a[146:147], v234 offset:36864
v_sub_u32 v138, v138, v140
v_mfma_f32_16x16x32_bf16 v[72:75], a[176:179], a[56:59], v[72:75]
s_add_u32 s28, s28, 1024
s_cmp_lt_u32 s28, s6
s_cselect_b32 s28, s28, s4
v_mfma_f32_16x16x32_bf16 v[104:107], a[176:179], a[60:63], v[104:107]
ds_read_b64_tr_b16 a[148:149], v234 offset:32776
v_sub_u32 v139, v139, v140
s_waitcnt lgkmcnt(8)
v_mfma_f32_16x16x32_bf16 v[108:111], a[180:183], a[60:63], v[108:111]
ds_read_b64_tr_b16 a[150:151], v234 offset:36872
v_cndmask_b32 v142, v142, v143, s[90:91]
v_mfma_f32_16x16x32_bf16 v[76:79], a[180:183], a[56:59], v[76:79]
buffer_load_dwordx4 a[112:115], v240, s[20:23], s28 offen sc0 sc1
v_mfma_f32_16x16x32_bf16 v[44:47], a[180:183], a[52:55], v[44:47]
ds_read_b64_tr_b16 a[152:153], v235 offset:32768
s_lshl_b64 s[90:91], s[90:91], 1
v_mfma_f32_16x16x32_bf16 v[12:15], a[180:183], a[48:51], v[12:15]
ds_read_b64_tr_b16 a[154:155], v235 offset:36864
v_max3_u32 v140, v136, v137, v138
v_mfma_f32_16x16x32_bf16 v[16:19], a[184:187], a[48:51], v[16:19]
buffer_load_dwordx4 a[116:119], v241, s[20:23], s28 offen sc0 sc1
v_mfma_f32_16x16x32_bf16 v[48:51], a[184:187], a[52:55], v[48:51]
ds_read_b64_tr_b16 a[156:157], v235 offset:32776
v_max_u32 v140, v140, v139
v_mfma_f32_16x16x32_bf16 v[80:83], a[184:187], a[56:59], v[80:83]
ds_read_b64_tr_b16 a[158:159], v235 offset:36872
v_xor_b32 v189, 5, v187
v_mfma_f32_16x16x32_bf16 v[112:115], a[184:187], a[60:63], v[112:115]
buffer_load_dwordx4 a[120:123], v242, s[20:23], s28 offen sc0 sc1
v_mfma_f32_16x16x32_bf16 v[116:119], a[188:191], a[60:63], v[116:119]
ds_read_b64_tr_b16 a[160:161], v236 offset:32768
v_max_u32_dpp v141, v140, v140 row_ror:8 row_mask:0xf bank_mask:0xf
v_mfma_f32_16x16x32_bf16 v[84:87], a[188:191], a[56:59], v[84:87]
buffer_load_dwordx4 a[124:127], v243, s[20:23], s28 offen sc0 sc1
v_mfma_f32_16x16x32_bf16 v[52:55], a[188:191], a[52:55], v[52:55]
ds_read_b64_tr_b16 a[162:163], v236 offset:36864
v_max_u32_dpp v140, v141, v141 row_ror:4 row_mask:0xf bank_mask:0xf
v_mfma_f32_16x16x32_bf16 v[20:23], a[188:191], a[48:51], v[20:23]
ds_read_b64_tr_b16 a[164:165], v236 offset:32776
v_lshl_add_u32 v225, v189, 5, v188
v_mfma_f32_16x16x32_bf16 v[24:27], a[192:195], a[48:51], v[24:27]
s_add_u32 m0, s49, 139264
v_max_u32_dpp v141, v140, v140 row_ror:2 row_mask:0xf bank_mask:0xf
v_mfma_f32_16x16x32_bf16 v[56:59], a[192:195], a[52:55], v[56:59]
ds_read_b64_tr_b16 a[166:167], v236 offset:36872
v_xor_b32 v189, 6, v187
v_mfma_f32_16x16x32_bf16 v[88:91], a[192:195], a[56:59], v[88:91]
ds_read_b64_tr_b16 a[168:169], v237 offset:32768
v_max_u32_dpp v140, v141, v141 row_ror:1 row_mask:0xf bank_mask:0xf
v_mfma_f32_16x16x32_bf16 v[120:123], a[192:195], a[60:63], v[120:123]
v_mov_b32 v141, v140
v_lshl_add_u32 v226, v189, 5, v188
s_waitcnt lgkmcnt(8)
v_mfma_f32_16x16x32_bf16 v[124:127], a[196:199], a[60:63], v[124:127]
ds_read_b64_tr_b16 a[170:171], v237 offset:36864
v_xor_b32 v189, 7, v187
v_mfma_f32_16x16x32_bf16 v[92:95], a[196:199], a[56:59], v[92:95]
ds_read_b64_tr_b16 a[172:173], v237 offset:32776
v_permlane16_swap_b32 v140, v141
v_mfma_f32_16x16x32_bf16 v[60:63], a[196:199], a[52:55], v[60:63]
buffer_load_dwordx4 v238, s[16:19], s34 offen offset:0 lds
v_mfma_f32_16x16x32_bf16 v[28:31], a[196:199], a[48:51], v[28:31]
ds_read_b64_tr_b16 a[174:175], v237 offset:36872
v_max_u32 v140, v140, v141
v_mfma_f32_16x16x32_bf16 v[32:35], a[200:203], a[48:51], v[32:35]
buffer_load_dwordx4 v239, s[16:19], s34 offen offset:1024 lds
v_mfma_f32_16x16x32_bf16 v[64:67], a[200:203], a[52:55], v[64:67]
v_mov_b32 v141, v140
v_lshl_add_u32 v227, v189, 5, v188
v_mfma_f32_16x16x32_bf16 v[96:99], a[200:203], a[56:59], v[96:99]
s_add_u32 s34, s34, 262144
s_sub_u32 s51, s34, 4718592
s_cselect_b32 s34, s34, s51
v_mfma_f32_16x16x32_bf16 v[128:131], a[200:203], a[60:63], v[128:131]
v_permlane32_swap_b32 v140, v141
v_max_u32 v140, v140, v141
v_mfma_f32_16x16x32_bf16 v[132:135], a[204:207], a[60:63], v[132:135]
v_add_u32 v143, v143, v140
v_sub_u32 v136, v136, v140
v_mfma_f32_16x16x32_bf16 v[100:103], a[204:207], a[56:59], v[100:103]
v_sub_u32 v137, v137, v140
v_sub_u32 v138, v138, v140
v_mfma_f32_16x16x32_bf16 v[68:71], a[204:207], a[52:55], v[68:71]
v_sub_u32 v139, v139, v140
v_cndmask_b32 v142, v142, v143, s[90:91]
v_mfma_f32_16x16x32_bf16 v[36:39], a[204:207], a[48:51], v[36:39]
s_lshl_b64 s[90:91], s[90:91], 1
v_add_u32 v184, 0, v4
s_waitcnt vmcnt(20)
v_mfma_f32_16x16x32_bf16 v[8:11], a[144:147], a[64:67], v[8:11]
ds_read_b64_tr_b16 a[176:177], v234 offset:40960
v_max3_u32 v140, v136, v137, v138
v_mfma_f32_16x16x32_bf16 v[40:43], a[144:147], a[68:71], v[40:43]
ds_read_b64_tr_b16 a[178:179], v234 offset:45056
v_max_u32 v140, v140, v139
v_mfma_f32_16x16x32_bf16 v[72:75], a[144:147], a[72:75], v[72:75]
s_add_u32 s28, s28, 1024
s_cmp_lt_u32 s28, s6
s_cselect_b32 s28, s28, s4
v_mfma_f32_16x16x32_bf16 v[104:107], a[144:147], a[76:79], v[104:107]
ds_read_b64_tr_b16 a[180:181], v234 offset:40968
v_max_u32_dpp v141, v140, v140 row_ror:8 row_mask:0xf bank_mask:0xf
v_mfma_f32_16x16x32_bf16 v[108:111], a[148:151], a[76:79], v[108:111]
ds_read_b64_tr_b16 a[182:183], v234 offset:45064
v_xor_b32 v184, v184, v3
v_mfma_f32_16x16x32_bf16 v[76:79], a[148:151], a[72:75], v[76:79]
buffer_load_dwordx4 a[0:3], v240, s[20:23], s28 offen sc0 sc1
v_mfma_f32_16x16x32_bf16 v[44:47], a[148:151], a[68:71], v[44:47]
ds_read_b64_tr_b16 a[184:185], v235 offset:40960
v_max_u32_dpp v140, v141, v141 row_ror:4 row_mask:0xf bank_mask:0xf
v_mfma_f32_16x16x32_bf16 v[12:15], a[148:151], a[64:67], v[12:15]
ds_read_b64_tr_b16 a[186:187], v235 offset:45056
v_lshlrev_b32 v184, 4, v184
s_waitcnt lgkmcnt(8)
v_mfma_f32_16x16x32_bf16 v[16:19], a[152:155], a[64:67], v[16:19]
buffer_load_dwordx4 a[4:7], v241, s[20:23], s28 offen sc0 sc1
v_mfma_f32_16x16x32_bf16 v[48:51], a[152:155], a[68:71], v[48:51]
ds_read_b64_tr_b16 a[188:189], v235 offset:40968
v_max_u32_dpp v141, v140, v140 row_ror:2 row_mask:0xf bank_mask:0xf
v_mfma_f32_16x16x32_bf16 v[80:83], a[152:155], a[72:75], v[80:83]
ds_read_b64_tr_b16 a[190:191], v235 offset:45064
v_lshl_add_u32 v184, v4, 8, v184
v_mfma_f32_16x16x32_bf16 v[112:115], a[152:155], a[76:79], v[112:115]
buffer_load_dwordx4 a[8:11], v242, s[20:23], s28 offen sc0 sc1
v_mfma_f32_16x16x32_bf16 v[116:119], a[156:159], a[76:79], v[116:119]
ds_read_b64_tr_b16 a[192:193], v236 offset:40960
v_max_u32_dpp v140, v141, v141 row_ror:1 row_mask:0xf bank_mask:0xf
v_mfma_f32_16x16x32_bf16 v[84:87], a[156:159], a[72:75], v[84:87]
buffer_load_dwordx4 a[12:15], v243, s[20:23], s28 offen sc0 sc1
v_mfma_f32_16x16x32_bf16 v[52:55], a[156:159], a[68:71], v[52:55]
ds_read_b64_tr_b16 a[194:195], v236 offset:45056
v_mov_b32 v141, v140
v_mfma_f32_16x16x32_bf16 v[20:23], a[156:159], a[64:67], v[20:23]
ds_read_b64_tr_b16 a[196:197], v236 offset:40968
v_add_u32 v228, s30, v184
v_mfma_f32_16x16x32_bf16 v[24:27], a[160:163], a[64:67], v[24:27]
s_add_u32 m0, s49, 0
v_permlane16_swap_b32 v140, v141
v_mfma_f32_16x16x32_bf16 v[56:59], a[160:163], a[68:71], v[56:59]
ds_read_b64_tr_b16 a[198:199], v236 offset:45064
v_max_u32 v140, v140, v141
v_mfma_f32_16x16x32_bf16 v[88:91], a[160:163], a[72:75], v[88:91]
ds_read_b64_tr_b16 a[200:201], v237 offset:40960
v_mov_b32 v141, v140
v_mfma_f32_16x16x32_bf16 v[120:123], a[160:163], a[76:79], v[120:123]
v_add_u32 v184, 4, v4
v_xor_b32 v184, v184, v3
v_mfma_f32_16x16x32_bf16 v[124:127], a[164:167], a[76:79], v[124:127]
ds_read_b64_tr_b16 a[202:203], v237 offset:45056
v_permlane32_swap_b32 v140, v141
STUB_1:
STUB_A1:
s_cbranch_execz STUB_4
v_mfma_f32_16x16x32_bf16 v[92:95], a[164:167], a[72:75], v[92:95]
ds_read_b64_tr_b16 a[204:205], v237 offset:40968
v_max_u32 v140, v140, v141
v_mfma_f32_16x16x32_bf16 v[60:63], a[164:167], a[68:71], v[60:63]
buffer_load_dwordx4 v238, s[16:19], s34 offen offset:0 lds
v_mfma_f32_16x16x32_bf16 v[28:31], a[164:167], a[64:67], v[28:31]
ds_read_b64_tr_b16 a[206:207], v237 offset:45064
v_add_u32 v143, v143, v140
v_mfma_f32_16x16x32_bf16 v[32:35], a[168:171], a[64:67], v[32:35]
buffer_load_dwordx4 v239, s[16:19], s34 offen offset:1024 lds
v_mfma_f32_16x16x32_bf16 v[64:67], a[168:171], a[68:71], v[64:67]
v_sub_u32 v136, v136, v140
v_sub_u32 v137, v137, v140
v_mfma_f32_16x16x32_bf16 v[96:99], a[168:171], a[72:75], v[96:99]
s_add_u32 s34, s34, 262144
s_sub_u32 s51, s34, 4718592
s_cselect_b32 s34, s34, s51
v_mfma_f32_16x16x32_bf16 v[128:131], a[168:171], a[76:79], v[128:131]
v_sub_u32 v138, v138, v140
v_sub_u32 v139, v139, v140
s_waitcnt lgkmcnt(8)
v_mfma_f32_16x16x32_bf16 v[132:135], a[172:175], a[76:79], v[132:135]
v_cndmask_b32 v142, v142, v143, s[90:91]
v_lshlrev_b32 v184, 4, v184
v_mfma_f32_16x16x32_bf16 v[100:103], a[172:175], a[72:75], v[100:103]
s_lshl_b64 s[90:91], s[90:91], 1
v_lshl_add_u32 v184, v4, 8, v184
v_mfma_f32_16x16x32_bf16 v[68:71], a[172:175], a[68:71], v[68:71]
v_max3_u32 v140, v136, v137, v138
v_max_u32 v140, v140, v139
v_mfma_f32_16x16x32_bf16 v[36:39], a[172:175], a[64:67], v[36:39]
v_add_u32 v229, s30, v184
v_add_u32 v184, 8, v4
s_waitcnt vmcnt(20)
v_mfma_f32_16x16x32_bf16 v[8:11], a[176:179], a[80:83], v[8:11]
v_max_u32_dpp v141, v140, v140 row_ror:8 row_mask:0xf bank_mask:0xf
v_xor_b32 v184, v184, v3
v_mfma_f32_16x16x32_bf16 v[40:43], a[176:179], a[84:87], v[40:43]
s_waitcnt vmcnt(12) lgkmcnt(0)
s_barrier
v_mfma_f32_16x16x32_bf16 v[72:75], a[176:179], a[88:91], v[72:75]
ds_read_b64_tr_b16 a[144:145], v234 offset:49152
v_max_u32_dpp v140, v141, v141 row_ror:4 row_mask:0xf bank_mask:0xf
v_mfma_f32_16x16x32_bf16 v[104:107], a[176:179], a[92:95], v[104:107]
ds_read_b64_tr_b16 a[146:147], v234 offset:53248
v_lshlrev_b32 v184, 4, v184
v_mfma_f32_16x16x32_bf16 v[108:111], a[180:183], a[92:95], v[108:111]
ds_read_b64_tr_b16 a[148:149], v234 offset:49160
v_max_u32_dpp v141, v140, v140 row_ror:2 row_mask:0xf bank_mask:0xf
v_mfma_f32_16x16x32_bf16 v[76:79], a[180:183], a[88:91], v[76:79]
s_add_u32 s28, s28, 1024
s_cmp_lt_u32 s28, s6
s_cselect_b32 s28, s28, s4
v_mfma_f32_16x16x32_bf16 v[44:47], a[180:183], a[84:87], v[44:47]
ds_read_b64_tr_b16 a[150:151], v234 offset:53256
v_max_u32_dpp v140, v141, v141 row_ror:1 row_mask:0xf bank_mask:0xf
v_mfma_f32_16x16x32_bf16 v[12:15], a[180:183], a[80:83], v[12:15]
ds_read_b64_tr_b16 a[152:153], v235 offset:49152
v_mov_b32 v141, v140
v_mfma_f32_16x16x32_bf16 v[16:19], a[184:187], a[80:83], v[16:19]
buffer_load_dwordx4 a[16:19], v240, s[20:23], s28 offen sc0 sc1
v_mfma_f32_16x16x32_bf16 v[48:51], a[184:187], a[84:87], v[48:51]
ds_read_b64_tr_b16 a[154:155], v235 offset:53248
v_permlane16_swap_b32 v140, v141
v_mfma_f32_16x16x32_bf16 v[80:83], a[184:187], a[88:91], v[80:83]
ds_read_b64_tr_b16 a[156:157], v235 offset:49160
v_max_u32 v140, v140, v141
v_mfma_f32_16x16x32_bf16 v[112:115], a[184:187], a[92:95], v[112:115]
buffer_load_dwordx4 a[20:23], v241, s[20:23], s28 offen sc0 sc1
v_mfma_f32_16x16x32_bf16 v[116:119], a[188:191], a[92:95], v[116:119]
ds_read_b64_tr_b16 a[158:159], v235 offset:53256
v_mov_b32 v141, v140
v_mfma_f32_16x16x32_bf16 v[84:87], a[188:191], a[88:91], v[84:87]
ds_read_b64_tr_b16 a[160:161], v236 offset:49152
v_lshl_add_u32 v184, v4, 8, v184
v_mfma_f32_16x16x32_bf16 v[52:55], a[188:191], a[84:87], v[52:55]
ds_read_b64_tr_b16 a[162:163], v236 offset:53248
v_permlane32_swap_b32 v140, v141
v_mfma_f32_16x16x32_bf16 v[20:23], a[188:191], a[80:83], v[20:23]
buffer_load_dwordx4 a[24:27], v242, s[20:23], s28 offen sc0 sc1
v_mfma_f32_16x16x32_bf16 v[24:27], a[192:195], a[80:83], v[24:27]
ds_read_b64_tr_b16 a[164:165], v236 offset:49160
v_max_u32 v140, v140, v141
v_mfma_f32_16x16x32_bf16 v[56:59], a[192:195], a[84:87], v[56:59]
ds_read_b64_tr_b16 a[166:167], v236 offset:53256
v_add_u32 v143, v143, v140
v_mfma_f32_16x16x32_bf16 v[88:91], a[192:195], a[88:91], v[88:91]
buffer_load_dwordx4 a[28:31], v243, s[20:23], s28 offen sc0 sc1
v_mfma_f32_16x16x32_bf16 v[120:123], a[192:195], a[92:95], v[120:123]
ds_read_b64_tr_b16 a[168:169], v237 offset:49152
s_add_u32 m0, s49, 8192
v_mfma_f32_16x16x32_bf16 v[124:127], a[196:199], a[92:95], v[124:127]
ds_read_b64_tr_b16 a[170:171], v237 offset:53248
v_sub_u32 v136, v136, v140
v_mfma_f32_16x16x32_bf16 v[92:95], a[196:199], a[88:91], v[92:95]
buffer_load_dwordx4 v238, s[16:19], s34 offen offset:0 lds
v_mfma_f32_16x16x32_bf16 v[60:63], a[196:199], a[84:87], v[60:63]
ds_read_b64_tr_b16 a[172:173], v237 offset:49160
v_sub_u32 v137, v137, v140
v_mfma_f32_16x16x32_bf16 v[28:31], a[196:199], a[80:83], v[28:31]
ds_read_b64_tr_b16 a[174:175], v237 offset:53256
v_sub_u32 v138, v138, v140
v_mfma_f32_16x16x32_bf16 v[32:35], a[200:203], a[80:83], v[32:35]
buffer_load_dwordx4 v239, s[16:19], s34 offen offset:1024 lds
v_mfma_f32_16x16x32_bf16 v[64:67], a[200:203], a[84:87], v[64:67]
v_sub_u32 v139, v139, v140
v_cndmask_b32 v142, v142, v143, s[90:91]
v_mfma_f32_16x16x32_bf16 v[96:99], a[200:203], a[88:91], v[96:99]
s_add_u32 s34, s34, 262144
s_sub_u32 s51, s34, 4718592
s_cselect_b32 s34, s34, s51
v_mfma_f32_16x16x32_bf16 v[128:131], a[200:203], a[92:95], v[128:131]
s_lshl_b64 s[90:91], s[90:91], 1
v_add_u32 v230, s30, v184
v_mfma_f32_16x16x32_bf16 v[132:135], a[204:207], a[92:95], v[132:135]
v_max3_u32 v140, v136, v137, v138
v_max_u32 v140, v140, v139
v_mfma_f32_16x16x32_bf16 v[100:103], a[204:207], a[88:91], v[100:103]
v_add_u32 v184, 12, v4
v_xor_b32 v184, v184, v3
v_mfma_f32_16x16x32_bf16 v[68:71], a[204:207], a[84:87], v[68:71]
v_max_u32_dpp v141, v140, v140 row_ror:8 row_mask:0xf bank_mask:0xf
v_mov_b32 v192, 0
v_mfma_f32_16x16x32_bf16 v[36:39], a[204:207], a[80:83], v[36:39]
buffer_load_dword v193, v192, s[24:27], 0 offen sc0 sc1
s_waitcnt vmcnt(21)
s_waitcnt lgkmcnt(8)
v_mfma_f32_16x16x32_bf16 v[8:11], a[144:147], a[96:99], v[8:11]
ds_read_b64_tr_b16 a[176:177], v234 offset:57344
v_max_u32_dpp v140, v141, v141 row_ror:4 row_mask:0xf bank_mask:0xf
v_mfma_f32_16x16x32_bf16 v[40:43], a[144:147], a[100:103], v[40:43]
ds_read_b64_tr_b16 a[178:179], v234 offset:61440
v_lshlrev_b32 v184, 4, v184
v_mfma_f32_16x16x32_bf16 v[72:75], a[144:147], a[104:107], v[72:75]
s_add_u32 s28, s28, 1024
s_cmp_lt_u32 s28, s6
s_cselect_b32 s28, s28, s4
v_mfma_f32_16x16x32_bf16 v[104:107], a[144:147], a[108:111], v[104:107]
ds_read_b64_tr_b16 a[180:181], v234 offset:57352
v_max_u32_dpp v141, v140, v140 row_ror:2 row_mask:0xf bank_mask:0xf
v_mfma_f32_16x16x32_bf16 v[108:111], a[148:151], a[108:111], v[108:111]
ds_read_b64_tr_b16 a[182:183], v234 offset:61448
v_lshl_add_u32 v184, v4, 8, v184
v_mfma_f32_16x16x32_bf16 v[76:79], a[148:151], a[104:107], v[76:79]
buffer_load_dwordx4 a[32:35], v240, s[20:23], s28 offen sc0 sc1
v_mfma_f32_16x16x32_bf16 v[44:47], a[148:151], a[100:103], v[44:47]
ds_read_b64_tr_b16 a[184:185], v235 offset:57344
v_max_u32_dpp v140, v141, v141 row_ror:1 row_mask:0xf bank_mask:0xf
v_mfma_f32_16x16x32_bf16 v[12:15], a[148:151], a[96:99], v[12:15]
ds_read_b64_tr_b16 a[186:187], v235 offset:61440
v_mov_b32 v141, v140
v_mfma_f32_16x16x32_bf16 v[16:19], a[152:155], a[96:99], v[16:19]
buffer_load_dwordx4 a[36:39], v241, s[20:23], s28 offen sc0 sc1
v_mfma_f32_16x16x32_bf16 v[48:51], a[152:155], a[100:103], v[48:51]
ds_read_b64_tr_b16 a[188:189], v235 offset:57352
v_permlane16_swap_b32 v140, v141
v_mfma_f32_16x16x32_bf16 v[80:83], a[152:155], a[104:107], v[80:83]
ds_read_b64_tr_b16 a[190:191], v235 offset:61448
v_max_u32 v140, v140, v141
v_mfma_f32_16x16x32_bf16 v[112:115], a[152:155], a[108:111], v[112:115]
buffer_load_dwordx4 a[40:43], v242, s[20:23], s28 offen sc0 sc1
v_mfma_f32_16x16x32_bf16 v[116:119], a[156:159], a[108:111], v[116:119]
ds_read_b64_tr_b16 a[192:193], v236 offset:57344
v_mov_b32 v141, v140
v_mfma_f32_16x16x32_bf16 v[84:87], a[156:159], a[104:107], v[84:87]
buffer_load_dwordx4 a[44:47], v243, s[20:23], s28 offen sc0 sc1
v_mfma_f32_16x16x32_bf16 v[52:55], a[156:159], a[100:103], v[52:55]
ds_read_b64_tr_b16 a[194:195], v236 offset:61440
v_permlane32_swap_b32 v140, v141
v_mfma_f32_16x16x32_bf16 v[20:23], a[156:159], a[96:99], v[20:23]
ds_read_b64_tr_b16 a[196:197], v236 offset:57352
v_max_u32 v140, v140, v141
s_waitcnt lgkmcnt(8)
v_mfma_f32_16x16x32_bf16 v[24:27], a[160:163], a[96:99], v[24:27]
s_add_u32 m0, s49, 16384
v_add_u32 v143, v143, v140
v_mfma_f32_16x16x32_bf16 v[56:59], a[160:163], a[100:103], v[56:59]
ds_read_b64_tr_b16 a[198:199], v236 offset:61448
v_sub_u32 v136, v136, v140
v_mfma_f32_16x16x32_bf16 v[88:91], a[160:163], a[104:107], v[88:91]
ds_read_b64_tr_b16 a[200:201], v237 offset:57344
v_sub_u32 v137, v137, v140
v_mfma_f32_16x16x32_bf16 v[120:123], a[160:163], a[108:111], v[120:123]
v_sub_u32 v138, v138, v140
v_sub_u32 v139, v139, v140
v_mfma_f32_16x16x32_bf16 v[124:127], a[164:167], a[108:111], v[124:127]
ds_read_b64_tr_b16 a[202:203], v237 offset:61440
v_cndmask_b32 v142, v142, v143, s[90:91]
v_mfma_f32_16x16x32_bf16 v[92:95], a[164:167], a[104:107], v[92:95]
ds_read_b64_tr_b16 a[204:205], v237 offset:57352
s_lshl_b64 s[90:91], s[90:91], 1
v_mfma_f32_16x16x32_bf16 v[60:63], a[164:167], a[100:103], v[60:63]
buffer_load_dwordx4 v238, s[16:19], s34 offen offset:0 lds
v_mfma_f32_16x16x32_bf16 v[28:31], a[164:167], a[96:99], v[28:31]
ds_read_b64_tr_b16 a[206:207], v237 offset:61448
v_max3_u32 v140, v136, v137, v138
v_mfma_f32_16x16x32_bf16 v[32:35], a[168:171], a[96:99], v[32:35]
buffer_load_dwordx4 v239, s[16:19], s34 offen offset:1024 lds
v_mfma_f32_16x16x32_bf16 v[64:67], a[168:171], a[100:103], v[64:67]
v_max_u32 v140, v140, v139
v_add_u32 v231, s30, v184
v_mfma_f32_16x16x32_bf16 v[96:99], a[168:171], a[104:107], v[96:99]
s_add_u32 s34, s34, 262144
s_sub_u32 s51, s34, 4718592
s_cselect_b32 s34, s34, s51
v_mfma_f32_16x16x32_bf16 v[128:131], a[168:171], a[108:111], v[128:131]
v_max_u32_dpp v141, v140, v140 row_ror:8 row_mask:0xf bank_mask:0xf
v_add_u32 v184, 0, v4
v_mfma_f32_16x16x32_bf16 v[132:135], a[172:175], a[108:111], v[132:135]
v_lshlrev_b32 v184, 1, v184
v_xor_b32 v184, v184, v3
v_mfma_f32_16x16x32_bf16 v[100:103], a[172:175], a[104:107], v[100:103]
v_max_u32_dpp v140, v141, v141 row_ror:4 row_mask:0xf bank_mask:0xf
v_lshlrev_b32 v184, 4, v184
v_mfma_f32_16x16x32_bf16 v[68:71], a[172:175], a[100:103], v[68:71]
v_lshl_add_u32 v184, v4, 8, v184
v_add_u32 v232, s30, v184
v_mfma_f32_16x16x32_bf16 v[36:39], a[172:175], a[96:99], v[36:39]
v_max_u32_dpp v141, v140, v140 row_ror:2 row_mask:0xf bank_mask:0xf
v_add_u32 v184, 4, v4
s_waitcnt vmcnt(21)
v_mfma_f32_16x16x32_bf16 v[8:11], a[176:179], a[112:115], v[8:11]
v_add_u32 v234, 0x10000, v234
v_add_u32 v235, 0x10000, v235
v_mfma_f32_16x16x32_bf16 v[40:43], a[176:179], a[116:119], v[40:43]
v_add_u32 v236, 0x10000, v236
v_add_u32 v237, 0x10000, v237
v_mfma_f32_16x16x32_bf16 v[72:75], a[176:179], a[120:123], v[72:75]
v_max_u32_dpp v140, v141, v141 row_ror:1 row_mask:0xf bank_mask:0xf
v_mov_b32 v141, v140
v_mfma_f32_16x16x32_bf16 v[104:107], a[176:179], a[124:127], v[104:107]
ds_read_b64_tr_b16 a[144:145], v234 offset:0
v_lshlrev_b32 v184, 1, v184
s_waitcnt lgkmcnt(8)
v_mfma_f32_16x16x32_bf16 v[108:111], a[180:183], a[124:127], v[108:111]
ds_read_b64_tr_b16 a[146:147], v234 offset:4096
v_permlane16_swap_b32 v140, v141
v_mfma_f32_16x16x32_bf16 v[76:79], a[180:183], a[120:123], v[76:79]
ds_read_b64_tr_b16 a[148:149], v234 offset:8
v_max_u32 v140, v140, v141
v_mfma_f32_16x16x32_bf16 v[44:47], a[180:183], a[116:119], v[44:47]
s_add_u32 s28, s28, 1024
s_cmp_lt_u32 s28, s6
s_cselect_b32 s28, s28, s4
v_mfma_f32_16x16x32_bf16 v[12:15], a[180:183], a[112:115], v[12:15]
ds_read_b64_tr_b16 a[150:151], v234 offset:4104
v_mov_b32 v141, v140
v_mfma_f32_16x16x32_bf16 v[16:19], a[184:187], a[112:115], v[16:19]
ds_read_b64_tr_b16 a[152:153], v235 offset:0
v_xor_b32 v184, v184, v3
v_mfma_f32_16x16x32_bf16 v[48:51], a[184:187], a[116:119], v[48:51]
ds_read_b64_tr_b16 a[154:155], v235 offset:4096
v_permlane32_swap_b32 v140, v141
v_mfma_f32_16x16x32_bf16 v[80:83], a[184:187], a[120:123], v[80:83]
buffer_load_dwordx4 a[48:51], v240, s[20:23], s28 offen sc0 sc1
v_mfma_f32_16x16x32_bf16 v[112:115], a[184:187], a[124:127], v[112:115]
ds_read_b64_tr_b16 a[156:157], v235 offset:8
v_max_u32 v140, v140, v141
v_mfma_f32_16x16x32_bf16 v[116:119], a[188:191], a[124:127], v[116:119]
ds_read_b64_tr_b16 a[158:159], v235 offset:4104
v_add_u32 v143, v143, v140
v_mfma_f32_16x16x32_bf16 v[84:87], a[188:191], a[120:123], v[84:87]
buffer_load_dwordx4 a[52:55], v241, s[20:23], s28 offen sc0 sc1
v_mfma_f32_16x16x32_bf16 v[52:55], a[188:191], a[116:119], v[52:55]
ds_read_b64_tr_b16 a[160:161], v236 offset:0
v_sub_u32 v136, v136, v140
v_mfma_f32_16x16x32_bf16 v[20:23], a[188:191], a[112:115], v[20:23]
ds_read_b64_tr_b16 a[162:163], v236 offset:4096
v_sub_u32 v137, v137, v140
s_waitcnt lgkmcnt(8)
v_mfma_f32_16x16x32_bf16 v[24:27], a[192:195], a[112:115], v[24:27]
ds_read_b64_tr_b16 a[164:165], v236 offset:8
v_sub_u32 v138, v138, v140
v_mfma_f32_16x16x32_bf16 v[56:59], a[192:195], a[116:119], v[56:59]
buffer_load_dwordx4 a[56:59], v242, s[20:23], s28 offen sc0 sc1
v_mfma_f32_16x16x32_bf16 v[88:91], a[192:195], a[120:123], v[88:91]
ds_read_b64_tr_b16 a[166:167], v236 offset:4104
v_sub_u32 v139, v139, v140
v_mfma_f32_16x16x32_bf16 v[120:123], a[192:195], a[124:127], v[120:123]
ds_read_b64_tr_b16 a[168:169], v237 offset:0
v_cndmask_b32 v142, v142, v143, s[90:91]
v_mfma_f32_16x16x32_bf16 v[124:127], a[196:199], a[124:127], v[124:127]
ds_read_b64_tr_b16 a[170:171], v237 offset:4096
s_lshl_b64 s[90:91], s[90:91], 1
v_mfma_f32_16x16x32_bf16 v[92:95], a[196:199], a[120:123], v[92:95]
buffer_load_dwordx4 a[60:63], v243, s[20:23], s28 offen sc0 sc1
v_mfma_f32_16x16x32_bf16 v[60:63], a[196:199], a[116:119], v[60:63]
ds_read_b64_tr_b16 a[172:173], v237 offset:8
s_add_u32 m0, s49, 24576
v_mfma_f32_16x16x32_bf16 v[28:31], a[196:199], a[112:115], v[28:31]
ds_read_b64_tr_b16 a[174:175], v237 offset:4104
v_max3_u32 v140, v136, v137, v138
v_mfma_f32_16x16x32_bf16 v[32:35], a[200:203], a[112:115], v[32:35]
buffer_load_dwordx4 v238, s[16:19], s34 offen offset:0 lds
v_mfma_f32_16x16x32_bf16 v[64:67], a[200:203], a[116:119], v[64:67]
buffer_load_dwordx4 v239, s[16:19], s34 offen offset:1024 lds
v_mfma_f32_16x16x32_bf16 v[96:99], a[200:203], a[120:123], v[96:99]
v_max_u32 v140, v140, v139
v_lshlrev_b32 v184, 4, v184
v_mfma_f32_16x16x32_bf16 v[128:131], a[200:203], a[124:127], v[128:131]
s_add_u32 s34, s34, 262144
s_sub_u32 s51, s34, 4718592
s_cselect_b32 s34, s34, s51
v_mfma_f32_16x16x32_bf16 v[132:135], a[204:207], a[124:127], v[132:135]
v_max_u32_dpp v141, v140, v140 row_ror:8 row_mask:0xf bank_mask:0xf
v_lshl_add_u32 v184, v4, 8, v184
v_mfma_f32_16x16x32_bf16 v[100:103], a[204:207], a[120:123], v[100:103]
v_add_u32 v233, s30, v184
v_bfe_u32 v184, v1, 1, 1
v_mfma_f32_16x16x32_bf16 v[68:71], a[204:207], a[116:119], v[68:71]
v_max_u32_dpp v140, v141, v141 row_ror:4 row_mask:0xf bank_mask:0xf
v_lshrrev_b32 v185, 5, v1
v_mfma_f32_16x16x32_bf16 v[36:39], a[204:207], a[112:115], v[36:39]
v_cmp_eq_u32 vcc, v184, v185
v_mov_b32 v186, 0x3f803f80
s_waitcnt vmcnt(21)
v_mfma_f32_16x16x32_bf16 v[8:11], a[144:147], a[0:3], v[8:11]
v_max_u32_dpp v141, v140, v140 row_ror:2 row_mask:0xf bank_mask:0xf
v_mfma_f32_16x16x32_bf16 v[40:43], a[144:147], a[4:7], v[40:43]
s_waitcnt vmcnt(13) lgkmcnt(0)
s_barrier
v_mfma_f32_16x16x32_bf16 v[72:75], a[144:147], a[8:11], v[72:75]
ds_read_b64_tr_b16 a[176:177], v234 offset:8192
v_max_u32_dpp v140, v141, v141 row_ror:1 row_mask:0xf bank_mask:0xf
v_mfma_f32_16x16x32_bf16 v[104:107], a[144:147], a[12:15], v[104:107]
ds_read_b64_tr_b16 a[178:179], v234 offset:12288
v_mov_b32 v141, v140
v_mfma_f32_16x16x32_bf16 v[108:111], a[148:151], a[12:15], v[108:111]
ds_read_b64_tr_b16 a[180:181], v234 offset:8200
v_cndmask_b32 v186, 0, v186, vcc
v_mfma_f32_16x16x32_bf16 v[76:79], a[148:151], a[8:11], v[76:79]
s_add_u32 s28, s28, 1024
s_cmp_lt_u32 s28, s6
s_cselect_b32 s28, s28, s4
v_mfma_f32_16x16x32_bf16 v[44:47], a[148:151], a[4:7], v[44:47]
ds_read_b64_tr_b16 a[182:183], v234 offset:12296
v_permlane16_swap_b32 v140, v141
v_mfma_f32_16x16x32_bf16 v[12:15], a[148:151], a[0:3], v[12:15]
ds_read_b64_tr_b16 a[184:185], v235 offset:8192
v_max_u32 v140, v140, v141
v_mfma_f32_16x16x32_bf16 v[16:19], a[152:155], a[0:3], v[16:19]
buffer_load_dwordx4 a[64:67], v240, s[20:23], s28 offen sc0 sc1
v_mfma_f32_16x16x32_bf16 v[48:51], a[152:155], a[4:7], v[48:51]
ds_read_b64_tr_b16 a[186:187], v235 offset:12288
v_mov_b32 v141, v140
v_mfma_f32_16x16x32_bf16 v[80:83], a[152:155], a[8:11], v[80:83]
ds_read_b64_tr_b16 a[188:189], v235 offset:8200
v_and_b32 v184, 1, v1
v_mfma_f32_16x16x32_bf16 v[112:115], a[152:155], a[12:15], v[112:115]
buffer_load_dwordx4 a[68:71], v241, s[20:23], s28 offen sc0 sc1
v_mfma_f32_16x16x32_bf16 v[116:119], a[156:159], a[12:15], v[116:119]
ds_read_b64_tr_b16 a[190:191], v235 offset:12296
v_permlane32_swap_b32 v140, v141
v_mfma_f32_16x16x32_bf16 v[84:87], a[156:159], a[8:11], v[84:87]
ds_read_b64_tr_b16 a[192:193], v236 offset:8192
v_max_u32 v140, v140, v141
v_mfma_f32_16x16x32_bf16 v[52:55], a[156:159], a[4:7], v[52:55]
ds_read_b64_tr_b16 a[194:195], v236 offset:12288
v_add_u32 v143, v143, v140
v_mfma_f32_16x16x32_bf16 v[20:23], a[156:159], a[0:3], v[20:23]
buffer_load_dwordx4 a[72:75], v242, s[20:23], s28 offen sc0 sc1
v_mfma_f32_16x16x32_bf16 v[24:27], a[160:163], a[0:3], v[24:27]
ds_read_b64_tr_b16 a[196:197], v236 offset:8200
v_cndmask_b32 v142, v142, v143, s[90:91]
v_mfma_f32_16x16x32_bf16 v[56:59], a[160:163], a[4:7], v[56:59]
ds_read_b64_tr_b16 a[198:199], v236 offset:12296
v_cmp_eq_u32 vcc, 1, v184
v_mfma_f32_16x16x32_bf16 v[88:91], a[160:163], a[8:11], v[88:91]
buffer_load_dwordx4 a[76:79], v243, s[20:23], s28 offen sc0 sc1
v_mfma_f32_16x16x32_bf16 v[120:123], a[160:163], a[12:15], v[120:123]
ds_read_b64_tr_b16 a[200:201], v237 offset:8192
s_add_u32 m0, s49, 32768
v_mfma_f32_16x16x32_bf16 v[124:127], a[164:167], a[12:15], v[124:127]
ds_read_b64_tr_b16 a[202:203], v237 offset:12288
v_mov_b32 v184, 0x44444444
v_mfma_f32_16x16x32_bf16 v[92:95], a[164:167], a[8:11], v[92:95]
buffer_load_dwordx4 v238, s[16:19], s34 offen offset:0 lds
v_mfma_f32_16x16x32_bf16 v[60:63], a[164:167], a[4:7], v[60:63]
ds_read_b64_tr_b16 a[204:205], v237 offset:8200
v_mov_b32 v185, 0xeeeeeeee
v_mfma_f32_16x16x32_bf16 v[28:31], a[164:167], a[0:3], v[28:31]
ds_read_b64_tr_b16 a[206:207], v237 offset:12296
v_mfma_f32_16x16x32_bf16 v[32:35], a[168:171], a[0:3], v[32:35]
buffer_load_dwordx4 v239, s[16:19], s34 offen offset:1024 lds
v_mfma_f32_16x16x32_bf16 v[64:67], a[168:171], a[4:7], v[64:67]
v_cndmask_b32 v245, v184, v185, vcc
v_accvgpr_write_b32 a208, v186
v_mfma_f32_16x16x32_bf16 v[96:99], a[168:171], a[8:11], v[96:99]
s_add_u32 s34, s34, 262144
s_sub_u32 s51, s34, 4718592
s_cselect_b32 s34, s34, s51
v_mfma_f32_16x16x32_bf16 v[128:131], a[168:171], a[12:15], v[128:131]
v_accvgpr_write_b32 a209, v186
v_accvgpr_write_b32 a210, v186
v_mfma_f32_16x16x32_bf16 v[132:135], a[172:175], a[12:15], v[132:135]
v_accvgpr_write_b32 a211, v186
v_mfma_f32_16x16x32_bf16 v[100:103], a[172:175], a[8:11], v[100:103]
s_lshl_b32 s92, s36, 9
s_lshr_b32 s93, s35, 2
v_mfma_f32_16x16x32_bf16 v[68:71], a[172:175], a[4:7], v[68:71]
s_and_b32 s94, s35, 3
s_lshl_b32 s95, s93, 6
v_mfma_f32_16x16x32_bf16 v[36:39], a[172:175], a[0:3], v[36:39]
s_add_u32 s95, s95, s92
s_lshl2_add_u32 s95, s94, s95
s_waitcnt vmcnt(21)
s_waitcnt lgkmcnt(8)
v_mfma_f32_16x16x32_bf16 v[8:11], a[176:179], a[16:19], v[8:11]
v_add_u32 v234, 0xfffe0000, v234
v_add_u32 v235, 0xfffe0000, v235
v_mfma_f32_16x16x32_bf16 v[40:43], a[176:179], a[20:23], v[40:43]
v_add_u32 v236, 0xfffe0000, v236
v_add_u32 v237, 0xfffe0000, v237
v_mfma_f32_16x16x32_bf16 v[72:75], a[176:179], a[24:27], v[72:75]
s_add_u32 s95, s95, 0x248000
v_mfma_f32_16x16x32_bf16 v[104:107], a[176:179], a[28:31], v[104:107]
ds_read_b64_tr_b16 a[144:145], v234 offset:0
v_lshlrev_b32 v170, 4, v1
v_mfma_f32_16x16x32_bf16 v[108:111], a[180:183], a[28:31], v[108:111]
ds_read_b64_tr_b16 a[146:147], v234 offset:4096
v_add_u32 v170, s95, v170
v_mfma_f32_16x16x32_bf16 v[76:79], a[180:183], a[24:27], v[76:79]
ds_read_b64_tr_b16 a[148:149], v234 offset:8
s_lshl_b32 s95, s94, 7
v_mfma_f32_16x16x32_bf16 v[44:47], a[180:183], a[20:23], v[44:47]
s_add_u32 s28, s28, 1024
s_cmp_lt_u32 s28, s6
s_cselect_b32 s28, s28, s4
v_mfma_f32_16x16x32_bf16 v[12:15], a[180:183], a[16:19], v[12:15]
ds_read_b64_tr_b16 a[150:151], v234 offset:4104
s_add_u32 s95, s95, s92
v_mfma_f32_16x16x32_bf16 v[16:19], a[184:187], a[16:19], v[16:19]
ds_read_b64_tr_b16 a[152:153], v235 offset:0
s_lshl2_add_u32 s95, s93, s95
v_mfma_f32_16x16x32_bf16 v[48:51], a[184:187], a[20:23], v[48:51]
ds_read_b64_tr_b16 a[154:155], v235 offset:4096
s_add_u32 s95, s95, 0x249f80
v_mfma_f32_16x16x32_bf16 v[80:83], a[184:187], a[24:27], v[80:83]
buffer_load_dwordx4 a[80:83], v240, s[20:23], s28 offen sc0 sc1
v_mfma_f32_16x16x32_bf16 v[112:115], a[184:187], a[28:31], v[112:115]
ds_read_b64_tr_b16 a[156:157], v235 offset:8
v_lshlrev_b32 v184, 5, v1
v_mfma_f32_16x16x32_bf16 v[116:119], a[188:191], a[28:31], v[116:119]
ds_read_b64_tr_b16 a[158:159], v235 offset:4104
v_add_u32 v184, s95, v184
v_mfma_f32_16x16x32_bf16 v[84:87], a[188:191], a[24:27], v[84:87]
buffer_load_dwordx4 a[84:87], v241, s[20:23], s28 offen sc0 sc1
v_mfma_f32_16x16x32_bf16 v[52:55], a[188:191], a[20:23], v[52:55]
ds_read_b64_tr_b16 a[160:161], v236 offset:0
v_cmp_lt_u32 vcc, 3, v1
v_mfma_f32_16x16x32_bf16 v[20:23], a[188:191], a[16:19], v[20:23]
ds_read_b64_tr_b16 a[162:163], v236 offset:4096
s_waitcnt lgkmcnt(8)
v_mfma_f32_16x16x32_bf16 v[24:27], a[192:195], a[16:19], v[24:27]
ds_read_b64_tr_b16 a[164:165], v236 offset:8
v_cndmask_b32 v170, v170, v184, vcc
v_mfma_f32_16x16x32_bf16 v[56:59], a[192:195], a[20:23], v[56:59]
buffer_load_dwordx4 a[88:91], v242, s[20:23], s28 offen sc0 sc1
v_mfma_f32_16x16x32_bf16 v[88:91], a[192:195], a[24:27], v[88:91]
ds_read_b64_tr_b16 a[166:167], v236 offset:4104
s_mov_b32 s95, 0x7fffbff0
v_mfma_f32_16x16x32_bf16 v[120:123], a[192:195], a[28:31], v[120:123]
ds_read_b64_tr_b16 a[168:169], v237 offset:0
v_mfma_f32_16x16x32_bf16 v[124:127], a[196:199], a[28:31], v[124:127]
ds_read_b64_tr_b16 a[170:171], v237 offset:4096
v_mfma_f32_16x16x32_bf16 v[92:95], a[196:199], a[24:27], v[92:95]
buffer_load_dwordx4 a[92:95], v243, s[20:23], s28 offen sc0 sc1
v_mfma_f32_16x16x32_bf16 v[60:63], a[196:199], a[20:23], v[60:63]
ds_read_b64_tr_b16 a[172:173], v237 offset:8
s_add_u32 m0, s49, 40960
v_mfma_f32_16x16x32_bf16 v[28:31], a[196:199], a[16:19], v[28:31]
ds_read_b64_tr_b16 a[174:175], v237 offset:4104
v_mfma_f32_16x16x32_bf16 v[32:35], a[200:203], a[16:19], v[32:35]
buffer_load_dwordx4 v238, s[16:19], s34 offen offset:0 lds
v_mfma_f32_16x16x32_bf16 v[64:67], a[200:203], a[20:23], v[64:67]
buffer_load_dwordx4 v239, s[16:19], s34 offen offset:1024 lds
v_mfma_f32_16x16x32_bf16 v[96:99], a[200:203], a[24:27], v[96:99]
s_cmp_eq_u32 s2, 0
s_cselect_b32 s95, 0x242c00, s95
v_mfma_f32_16x16x32_bf16 v[128:131], a[200:203], a[28:31], v[128:131]
s_add_u32 s34, s34, 262144
s_sub_u32 s51, s34, 4718592
s_cselect_b32 s34, s34, s51
v_mfma_f32_16x16x32_bf16 v[132:135], a[204:207], a[28:31], v[132:135]
v_lshlrev_b32 v184, 7, v1
v_add_u32 v184, s95, v184
v_mfma_f32_16x16x32_bf16 v[100:103], a[204:207], a[24:27], v[100:103]
v_cmp_lt_u32 vcc, 7, v1
v_mfma_f32_16x16x32_bf16 v[68:71], a[204:207], a[20:23], v[68:71]
v_mfma_f32_16x16x32_bf16 v[36:39], a[204:207], a[16:19], v[36:39]
v_cndmask_b32 v170, v170, v184, vcc
v_mov_b32 v184, 0x7ffffff0
s_waitcnt vmcnt(20)
v_mfma_f32_16x16x32_bf16 v[8:11], a[144:147], a[32:35], v[8:11]
ds_read_b64_tr_b16 a[176:177], v234 offset:8192
v_mov_b32 v171, 0
v_mfma_f32_16x16x32_bf16 v[40:43], a[144:147], a[36:39], v[40:43]
ds_read_b64_tr_b16 a[178:179], v234 offset:12288
v_cmp_lt_u32 vcc, 9, v0
v_mfma_f32_16x16x32_bf16 v[72:75], a[144:147], a[40:43], v[72:75]
s_add_u32 s28, s28, 1024
s_cmp_lt_u32 s28, s6
s_cselect_b32 s28, s28, s4
v_mfma_f32_16x16x32_bf16 v[104:107], a[144:147], a[44:47], v[104:107]
ds_read_b64_tr_b16 a[180:181], v234 offset:8200
v_cndmask_b32 v170, v170, v184, vcc
s_waitcnt lgkmcnt(8)
v_mfma_f32_16x16x32_bf16 v[108:111], a[148:151], a[44:47], v[108:111]
ds_read_b64_tr_b16 a[182:183], v234 offset:12296
v_mov_b32 v254, 0x7ffffff0
v_mfma_f32_16x16x32_bf16 v[76:79], a[148:151], a[40:43], v[76:79]
buffer_load_dwordx4 a[96:99], v240, s[20:23], s28 offen sc0 sc1
v_mfma_f32_16x16x32_bf16 v[44:47], a[148:151], a[36:39], v[44:47]
ds_read_b64_tr_b16 a[184:185], v235 offset:8192
s_lshl_b32 s92, s36, 5
v_mfma_f32_16x16x32_bf16 v[12:15], a[148:151], a[32:35], v[12:15]
ds_read_b64_tr_b16 a[186:187], v235 offset:12288
s_add_u32 s92, s92, s35
v_mfma_f32_16x16x32_bf16 v[16:19], a[152:155], a[32:35], v[16:19]
buffer_load_dwordx4 a[100:103], v241, s[20:23], s28 offen sc0 sc1
v_mfma_f32_16x16x32_bf16 v[48:51], a[152:155], a[36:39], v[48:51]
ds_read_b64_tr_b16 a[188:189], v235 offset:8200
v_mfma_f32_16x16x32_bf16 v[80:83], a[152:155], a[40:43], v[80:83]
ds_read_b64_tr_b16 a[190:191], v235 offset:12296
v_mfma_f32_16x16x32_bf16 v[112:115], a[152:155], a[44:47], v[112:115]
buffer_load_dwordx4 a[104:107], v242, s[20:23], s28 offen sc0 sc1
v_mfma_f32_16x16x32_bf16 v[116:119], a[156:159], a[44:47], v[116:119]
ds_read_b64_tr_b16 a[192:193], v236 offset:8192
v_mfma_f32_16x16x32_bf16 v[84:87], a[156:159], a[40:43], v[84:87]
buffer_load_dwordx4 a[108:111], v243, s[20:23], s28 offen sc0 sc1
v_mfma_f32_16x16x32_bf16 v[52:55], a[156:159], a[36:39], v[52:55]
ds_read_b64_tr_b16 a[194:195], v236 offset:12288
v_mfma_f32_16x16x32_bf16 v[20:23], a[156:159], a[32:35], v[20:23]
ds_read_b64_tr_b16 a[196:197], v236 offset:8200
v_mfma_f32_16x16x32_bf16 v[24:27], a[160:163], a[32:35], v[24:27]
s_add_u32 m0, s49, 49152
v_mfma_f32_16x16x32_bf16 v[56:59], a[160:163], a[36:39], v[56:59]
ds_read_b64_tr_b16 a[198:199], v236 offset:12296
v_mfma_f32_16x16x32_bf16 v[88:91], a[160:163], a[40:43], v[88:91]
ds_read_b64_tr_b16 a[200:201], v237 offset:8192
v_mfma_f32_16x16x32_bf16 v[120:123], a[160:163], a[44:47], v[120:123]
s_cmp_eq_u32 s37, 0
s_cselect_b32 s92, s92, 0x7ffffff0
s_waitcnt lgkmcnt(8)
v_mfma_f32_16x16x32_bf16 v[124:127], a[164:167], a[44:47], v[124:127]
ds_read_b64_tr_b16 a[202:203], v237 offset:12288
v_mfma_f32_16x16x32_bf16 v[92:95], a[164:167], a[40:43], v[92:95]
ds_read_b64_tr_b16 a[204:205], v237 offset:8200
v_writelane_b32 v254, s92, 0
v_mfma_f32_16x16x32_bf16 v[60:63], a[164:167], a[36:39], v[60:63]
buffer_load_dwordx4 v238, s[16:19], s34 offen offset:0 lds
v_mfma_f32_16x16x32_bf16 v[28:31], a[164:167], a[32:35], v[28:31]
ds_read_b64_tr_b16 a[206:207], v237 offset:12296
s_or_b32 s92, s38, s46
v_mfma_f32_16x16x32_bf16 v[32:35], a[168:171], a[32:35], v[32:35]
buffer_load_dwordx4 v239, s[16:19], s34 offen offset:1024 lds
v_mfma_f32_16x16x32_bf16 v[64:67], a[168:171], a[36:39], v[64:67]
v_mov_b32 v255, s92
v_add_u32 v184, 0, v0
v_mfma_f32_16x16x32_bf16 v[96:99], a[168:171], a[40:43], v[96:99]
s_add_u32 s34, s34, 262144
s_sub_u32 s51, s34, 4718592
s_cselect_b32 s34, s34, s51
v_mfma_f32_16x16x32_bf16 v[128:131], a[168:171], a[44:47], v[128:131]
v_mul_u32_u24 v185, 911, v184
v_lshrrev_b32 v185, 16, v185
v_mfma_f32_16x16x32_bf16 v[132:135], a[172:175], a[44:47], v[132:135]
v_add_u32 v184, v184, v185
v_lshlrev_b32 v184, 4, v184
v_mfma_f32_16x16x32_bf16 v[100:103], a[172:175], a[40:43], v[100:103]
v_add_u32 v178, 0x24000, v184
v_add_u32 v184, 256, v0
v_mfma_f32_16x16x32_bf16 v[68:71], a[172:175], a[36:39], v[68:71]
v_mul_u32_u24 v185, 911, v184
v_lshrrev_b32 v185, 16, v185
v_mfma_f32_16x16x32_bf16 v[36:39], a[172:175], a[32:35], v[36:39]
v_add_u32 v184, v184, v185
v_lshlrev_b32 v184, 4, v184
s_waitcnt vmcnt(20)
v_mfma_f32_16x16x32_bf16 v[8:11], a[176:179], a[48:51], v[8:11]
v_add_u32 v179, 0x24000, v184
v_add_u32 v184, 512, v0
v_mfma_f32_16x16x32_bf16 v[40:43], a[176:179], a[52:55], v[40:43]
s_waitcnt vmcnt(12) lgkmcnt(0)
s_barrier
v_mfma_f32_16x16x32_bf16 v[72:75], a[176:179], a[56:59], v[72:75]
ds_read_b64_tr_b16 a[144:145], v234 offset:16384
v_mul_u32_u24 v185, 911, v184
v_mfma_f32_16x16x32_bf16 v[104:107], a[176:179], a[60:63], v[104:107]
ds_read_b64_tr_b16 a[146:147], v234 offset:20480
STUB_2:
STUB_A2:
s_cbranch_execz STUB_5
v_lshrrev_b32 v185, 16, v185
v_mfma_f32_16x16x32_bf16 v[108:111], a[180:183], a[60:63], v[108:111]
ds_read_b64_tr_b16 a[148:149], v234 offset:16392
v_add_u32 v184, v184, v185
v_mfma_f32_16x16x32_bf16 v[76:79], a[180:183], a[56:59], v[76:79]
s_add_u32 s28, s28, 1024
s_cmp_lt_u32 s28, s6
s_cselect_b32 s28, s28, s4
v_mfma_f32_16x16x32_bf16 v[44:47], a[180:183], a[52:55], v[44:47]
ds_read_b64_tr_b16 a[150:151], v234 offset:20488
v_lshlrev_b32 v184, 4, v184
v_mfma_f32_16x16x32_bf16 v[12:15], a[180:183], a[48:51], v[12:15]
ds_read_b64_tr_b16 a[152:153], v235 offset:16384
v_add_u32 v180, 0x24000, v184
v_mfma_f32_16x16x32_bf16 v[16:19], a[184:187], a[48:51], v[16:19]
buffer_load_dwordx4 a[112:115], v240, s[20:23], s28 offen sc0 sc1
v_mfma_f32_16x16x32_bf16 v[48:51], a[184:187], a[52:55], v[48:51]
ds_read_b64_tr_b16 a[154:155], v235 offset:20480
v_mfma_f32_16x16x32_bf16 v[80:83], a[184:187], a[56:59], v[80:83]
ds_read_b64_tr_b16 a[156:157], v235 offset:16392
v_mfma_f32_16x16x32_bf16 v[112:115], a[184:187], a[60:63], v[112:115]
buffer_load_dwordx4 a[116:119], v241, s[20:23], s28 offen sc0 sc1
v_mfma_f32_16x16x32_bf16 v[116:119], a[188:191], a[60:63], v[116:119]
ds_read_b64_tr_b16 a[158:159], v235 offset:20488
v_mfma_f32_16x16x32_bf16 v[84:87], a[188:191], a[56:59], v[84:87]
ds_read_b64_tr_b16 a[160:161], v236 offset:16384
v_mfma_f32_16x16x32_bf16 v[52:55], a[188:191], a[52:55], v[52:55]
ds_read_b64_tr_b16 a[162:163], v236 offset:20480
v_mfma_f32_16x16x32_bf16 v[20:23], a[188:191], a[48:51], v[20:23]
buffer_load_dwordx4 a[120:123], v242, s[20:23], s28 offen sc0 sc1
v_mfma_f32_16x16x32_bf16 v[24:27], a[192:195], a[48:51], v[24:27]
ds_read_b64_tr_b16 a[164:165], v236 offset:16392
v_mfma_f32_16x16x32_bf16 v[56:59], a[192:195], a[52:55], v[56:59]
ds_read_b64_tr_b16 a[166:167], v236 offset:20488
v_mfma_f32_16x16x32_bf16 v[88:91], a[192:195], a[56:59], v[88:91]
buffer_load_dwordx4 a[124:127], v243, s[20:23], s28 offen sc0 sc1
v_mfma_f32_16x16x32_bf16 v[120:123], a[192:195], a[60:63], v[120:123]
ds_read_b64_tr_b16 a[168:169], v237 offset:16384
s_add_u32 m0, s49, 57344
v_mfma_f32_16x16x32_bf16 v[124:127], a[196:199], a[60:63], v[124:127]
ds_read_b64_tr_b16 a[170:171], v237 offset:20480
v_mfma_f32_16x16x32_bf16 v[92:95], a[196:199], a[56:59], v[92:95]
buffer_load_dwordx4 v238, s[16:19], s34 offen offset:0 lds
v_mfma_f32_16x16x32_bf16 v[60:63], a[196:199], a[52:55], v[60:63]
ds_read_b64_tr_b16 a[172:173], v237 offset:16392
v_mfma_f32_16x16x32_bf16 v[28:31], a[196:199], a[48:51], v[28:31]
ds_read_b64_tr_b16 a[174:175], v237 offset:20488
v_mfma_f32_16x16x32_bf16 v[32:35], a[200:203], a[48:51], v[32:35]
buffer_load_dwordx4 v239, s[16:19], s34 offen offset:1024 lds
v_mfma_f32_16x16x32_bf16 v[64:67], a[200:203], a[52:55], v[64:67]
s_waitcnt vmcnt(36)
v_readfirstlane_b32 s92, v193
v_mfma_f32_16x16x32_bf16 v[96:99], a[200:203], a[56:59], v[96:99]
s_add_u32 s34, s34, 262144
s_sub_u32 s51, s34, 4718592
s_cselect_b32 s34, s34, s51
v_mfma_f32_16x16x32_bf16 v[128:131], a[200:203], a[60:63], v[128:131]
s_and_b32 s93, s92, 0xf0
s_cbranch_scc0 SP_X0
SP_X0_RET:
v_mfma_f32_16x16x32_bf16 v[132:135], a[204:207], a[60:63], v[132:135]
s_add_u32 s92, s92, s36
s_and_b32 s92, s92, 7
v_mfma_f32_16x16x32_bf16 v[100:103], a[204:207], a[56:59], v[100:103]
s_lshl_b32 s92, s92, 2
s_lshr_b32 s92, 0x63724150, s92
v_mfma_f32_16x16x32_bf16 v[68:71], a[204:207], a[52:55], v[68:71]
s_and_b32 s92, s92, 7
s_lshl_b32 s93, s92, 5
v_mfma_f32_16x16x32_bf16 v[36:39], a[204:207], a[48:51], v[36:39]
s_add_u32 s40, s93, s35
s_lshr_b32 s93, s35, 1
s_waitcnt vmcnt(20)
s_waitcnt lgkmcnt(8)
v_mfma_f32_16x16x32_bf16 v[8:11], a[144:147], a[64:67], v[8:11]
ds_read_b64_tr_b16 a[176:177], v234 offset:24576
s_lshl2_add_u32 s93, s93, s92
v_mfma_f32_16x16x32_bf16 v[40:43], a[144:147], a[68:71], v[40:43]
ds_read_b64_tr_b16 a[178:179], v234 offset:28672
s_and_b32 s94, s35, 1
v_mfma_f32_16x16x32_bf16 v[72:75], a[144:147], a[72:75], v[72:75]
s_add_u32 s28, s28, 1024
s_cmp_lt_u32 s28, s6
s_cselect_b32 s28, s28, s4
v_mfma_f32_16x16x32_bf16 v[104:107], a[144:147], a[76:79], v[104:107]
ds_read_b64_tr_b16 a[180:181], v234 offset:24584
s_lshl1_add_u32 s93, s93, s94
v_mfma_f32_16x16x32_bf16 v[108:111], a[148:151], a[76:79], v[108:111]
ds_read_b64_tr_b16 a[182:183], v234 offset:28680
v_mfma_f32_16x16x32_bf16 v[76:79], a[148:151], a[72:75], v[76:79]
buffer_load_dwordx4 a[0:3], v240, s[20:23], s28 offen sc0 sc1
v_mfma_f32_16x16x32_bf16 v[44:47], a[148:151], a[68:71], v[44:47]
ds_read_b64_tr_b16 a[184:185], v235 offset:24576
v_mfma_f32_16x16x32_bf16 v[12:15], a[148:151], a[64:67], v[12:15]
ds_read_b64_tr_b16 a[186:187], v235 offset:28672
v_mfma_f32_16x16x32_bf16 v[16:19], a[152:155], a[64:67], v[16:19]
buffer_load_dwordx4 a[4:7], v241, s[20:23], s28 offen sc0 sc1
v_mfma_f32_16x16x32_bf16 v[48:51], a[152:155], a[68:71], v[48:51]
ds_read_b64_tr_b16 a[188:189], v235 offset:24584
v_mfma_f32_16x16x32_bf16 v[80:83], a[152:155], a[72:75], v[80:83]
ds_read_b64_tr_b16 a[190:191], v235 offset:28680
v_mfma_f32_16x16x32_bf16 v[112:115], a[152:155], a[76:79], v[112:115]
buffer_load_dwordx4 a[8:11], v242, s[20:23], s28 offen sc0 sc1
v_mfma_f32_16x16x32_bf16 v[116:119], a[156:159], a[76:79], v[116:119]
ds_read_b64_tr_b16 a[192:193], v236 offset:24576
v_mfma_f32_16x16x32_bf16 v[84:87], a[156:159], a[72:75], v[84:87]
buffer_load_dwordx4 a[12:15], v243, s[20:23], s28 offen sc0 sc1
v_mfma_f32_16x16x32_bf16 v[52:55], a[156:159], a[68:71], v[52:55]
ds_read_b64_tr_b16 a[194:195], v236 offset:28672
s_add_u32 s32, s7, 0
v_mfma_f32_16x16x32_bf16 v[20:23], a[156:159], a[64:67], v[20:23]
ds_read_b64_tr_b16 a[196:197], v236 offset:24584
s_waitcnt lgkmcnt(8)
v_mfma_f32_16x16x32_bf16 v[24:27], a[160:163], a[64:67], v[24:27]
s_add_u32 m0, s30, 81920
v_mfma_f32_16x16x32_bf16 v[56:59], a[160:163], a[68:71], v[56:59]
ds_read_b64_tr_b16 a[198:199], v236 offset:28680
v_mfma_f32_16x16x32_bf16 v[88:91], a[160:163], a[72:75], v[88:91]
ds_read_b64_tr_b16 a[200:201], v237 offset:24576
v_mfma_f32_16x16x32_bf16 v[120:123], a[160:163], a[76:79], v[120:123]
buffer_load_dwordx4 v228, s[8:11], s32 offen offset:0  lds
v_mfma_f32_16x16x32_bf16 v[124:127], a[164:167], a[76:79], v[124:127]
ds_read_b64_tr_b16 a[202:203], v237 offset:28672
v_mfma_f32_16x16x32_bf16 v[92:95], a[164:167], a[72:75], v[92:95]
ds_read_b64_tr_b16 a[204:205], v237 offset:24584
v_mfma_f32_16x16x32_bf16 v[60:63], a[164:167], a[68:71], v[60:63]
buffer_load_dwordx4 v229, s[8:11], s32 offen offset:1024  lds
v_mfma_f32_16x16x32_bf16 v[28:31], a[164:167], a[64:67], v[28:31]
ds_read_b64_tr_b16 a[206:207], v237 offset:28680
v_mfma_f32_16x16x32_bf16 v[32:35], a[168:171], a[64:67], v[32:35]
buffer_load_dwordx4 v230, s[8:11], s32 offen offset:2048  lds
v_mfma_f32_16x16x32_bf16 v[64:67], a[168:171], a[68:71], v[64:67]
s_cmp_lt_u32 s92, 4
s_cselect_b32 s40, s93, s40
v_mfma_f32_16x16x32_bf16 v[96:99], a[168:171], a[72:75], v[96:99]
s_mov_b32 s92, s40
s_lshl_b32 s84, s92, 6
v_mfma_f32_16x16x32_bf16 v[128:131], a[168:171], a[76:79], v[128:131]
buffer_load_dwordx4 v231, s[8:11], s32 offen offset:3072  lds
v_mfma_f32_16x16x32_bf16 v[132:135], a[172:175], a[76:79], v[132:135]
s_mul_i32 s93, s37, 147456
s_add_u32 s84, s84, s93
v_mfma_f32_16x16x32_bf16 v[100:103], a[172:175], a[72:75], v[100:103]
s_mul_i32 s85, s92, 36864
s_add_u32 s85, s85, s31
v_mfma_f32_16x16x32_bf16 v[68:71], a[172:175], a[68:71], v[68:71]
s_cmp_lt_u32 s40, 144
s_cselect_b32 s86, s31, 0x30000
s_cselect_b32 s84, s84, 0x40000000
s_cselect_b32 s85, s85, 0x40000000
v_mfma_f32_16x16x32_bf16 v[36:39], a[172:175], a[64:67], v[36:39]
s_waitcnt vmcnt(22)
v_mfma_f32_16x16x32_bf16 v[8:11], a[176:179], a[80:83], v[8:11]
ds_read_b64_tr_b16 a[144:145], v234 offset:32768
v_mfma_f32_16x16x32_bf16 v[40:43], a[176:179], a[84:87], v[40:43]
ds_read_b64_tr_b16 a[146:147], v234 offset:36864
v_mfma_f32_16x16x32_bf16 v[72:75], a[176:179], a[88:91], v[72:75]
s_add_u32 s28, s28, 1024
s_cmp_lt_u32 s28, s6
s_cselect_b32 s28, s28, s4
v_mfma_f32_16x16x32_bf16 v[104:107], a[176:179], a[92:95], v[104:107]
ds_read_b64_tr_b16 a[148:149], v234 offset:32776
s_waitcnt lgkmcnt(8)
v_mfma_f32_16x16x32_bf16 v[108:111], a[180:183], a[92:95], v[108:111]
ds_read_b64_tr_b16 a[150:151], v234 offset:36872
v_mfma_f32_16x16x32_bf16 v[76:79], a[180:183], a[88:91], v[76:79]
v_mfma_f32_16x16x32_bf16 v[44:47], a[180:183], a[84:87], v[44:47]
ds_read_b64_tr_b16 a[152:153], v235 offset:32768
v_mfma_f32_16x16x32_bf16 v[12:15], a[180:183], a[80:83], v[12:15]
ds_read_b64_tr_b16 a[154:155], v235 offset:36864
v_mfma_f32_16x16x32_bf16 v[16:19], a[184:187], a[80:83], v[16:19]
buffer_load_dwordx4 a[16:19], v240, s[20:23], s28 offen sc0 sc1
v_mfma_f32_16x16x32_bf16 v[48:51], a[184:187], a[84:87], v[48:51]
ds_read_b64_tr_b16 a[156:157], v235 offset:32776
v_mfma_f32_16x16x32_bf16 v[80:83], a[184:187], a[88:91], v[80:83]
ds_read_b64_tr_b16 a[158:159], v235 offset:36872
v_mfma_f32_16x16x32_bf16 v[112:115], a[184:187], a[92:95], v[112:115]
v_mfma_f32_16x16x32_bf16 v[116:119], a[188:191], a[92:95], v[116:119]
ds_read_b64_tr_b16 a[160:161], v236 offset:32768
v_mfma_f32_16x16x32_bf16 v[84:87], a[188:191], a[88:91], v[84:87]
buffer_load_dwordx4 a[20:23], v241, s[20:23], s28 offen sc0 sc1
v_mfma_f32_16x16x32_bf16 v[52:55], a[188:191], a[84:87], v[52:55]
ds_read_b64_tr_b16 a[162:163], v236 offset:36864
v_mfma_f32_16x16x32_bf16 v[20:23], a[188:191], a[80:83], v[20:23]
ds_read_b64_tr_b16 a[164:165], v236 offset:32776
v_mfma_f32_16x16x32_bf16 v[24:27], a[192:195], a[80:83], v[24:27]
v_mfma_f32_16x16x32_bf16 v[56:59], a[192:195], a[84:87], v[56:59]
ds_read_b64_tr_b16 a[166:167], v236 offset:36872
v_mfma_f32_16x16x32_bf16 v[88:91], a[192:195], a[88:91], v[88:91]
ds_read_b64_tr_b16 a[168:169], v237 offset:32768
v_mfma_f32_16x16x32_bf16 v[120:123], a[192:195], a[92:95], v[120:123]
buffer_load_dwordx4 a[24:27], v242, s[20:23], s28 offen sc0 sc1
s_waitcnt lgkmcnt(8)
v_mfma_f32_16x16x32_bf16 v[124:127], a[196:199], a[92:95], v[124:127]
ds_read_b64_tr_b16 a[170:171], v237 offset:36864
v_mfma_f32_16x16x32_bf16 v[92:95], a[196:199], a[88:91], v[92:95]
ds_read_b64_tr_b16 a[172:173], v237 offset:32776
v_mfma_f32_16x16x32_bf16 v[60:63], a[196:199], a[84:87], v[60:63]
v_lshlrev_b32 v136, 3, v1
v_mov_b32 v137, 0x7ffffff0
v_mfma_f32_16x16x32_bf16 v[28:31], a[196:199], a[80:83], v[28:31]
ds_read_b64_tr_b16 a[174:175], v237 offset:36872
v_mfma_f32_16x16x32_bf16 v[32:35], a[200:203], a[80:83], v[32:35]
buffer_load_dwordx4 a[28:31], v243, s[20:23], s28 offen sc0 sc1
v_mfma_f32_16x16x32_bf16 v[64:67], a[200:203], a[84:87], v[64:67]
v_cmp_lt_u32 vcc, 7, v1
v_mov_b32 v143, s47
v_mfma_f32_16x16x32_bf16 v[96:99], a[200:203], a[88:91], v[96:99]
v_mfma_f32_16x16x32_bf16 v[128:131], a[200:203], a[92:95], v[128:131]
v_cndmask_b32 v136, v136, v137, vcc
v_mfma_f32_16x16x32_bf16 v[132:135], a[204:207], a[92:95], v[132:135]
s_lshl_b32 s29, s36, 6
s_add_u32 s29, s29, 0x242000
v_mfma_f32_16x16x32_bf16 v[100:103], a[204:207], a[88:91], v[100:103]
s_add_u32 s50, s35, s37
s_cmp_eq_u32 s50, 0
s_cselect_b32 s29, s29, 0x7ffffff0
v_mfma_f32_16x16x32_bf16 v[68:71], a[204:207], a[84:87], v[68:71]
v_mfma_f32_16x16x32_bf16 v[36:39], a[204:207], a[80:83], v[36:39]
s_waitcnt vmcnt(20)
v_mfma_f32_16x16x32_bf16 v[8:11], a[144:147], a[96:99], v[8:11]
v_mfma_f32_16x16x32_bf16 v[40:43], a[144:147], a[100:103], v[40:43]
s_waitcnt vmcnt(12) lgkmcnt(0)
s_barrier
v_mfma_f32_16x16x32_bf16 v[72:75], a[144:147], a[104:107], v[72:75]
ds_read_b64_tr_b16 a[176:177], v234 offset:40960
s_add_u32 s32, s7, 16384
v_mfma_f32_16x16x32_bf16 v[104:107], a[144:147], a[108:111], v[104:107]
ds_read_b64_tr_b16 a[178:179], v234 offset:45056
v_mfma_f32_16x16x32_bf16 v[108:111], a[148:151], a[108:111], v[108:111]
ds_read_b64_tr_b16 a[180:181], v234 offset:40968
v_mfma_f32_16x16x32_bf16 v[76:79], a[148:151], a[104:107], v[76:79]
buffer_store_dwordx2 v[142:143], v136, s[20:23], s29 offen sc0 sc1
v_mfma_f32_16x16x32_bf16 v[44:47], a[148:151], a[100:103], v[44:47]
ds_read_b64_tr_b16 a[182:183], v234 offset:45064
s_add_u32 m0, s30, 114688
v_mfma_f32_16x16x32_bf16 v[12:15], a[148:151], a[96:99], v[12:15]
ds_read_b64_tr_b16 a[184:185], v235 offset:40960
v_mfma_f32_16x16x32_bf16 v[16:19], a[152:155], a[96:99], v[16:19]
buffer_store_dword v171, v170, s[20:23], 0 offen sc0 sc1
v_mfma_f32_16x16x32_bf16 v[48:51], a[152:155], a[100:103], v[48:51]
ds_read_b64_tr_b16 a[186:187], v235 offset:45056
ds_read_b128 v[152:155], v178
v_mfma_f32_16x16x32_bf16 v[80:83], a[152:155], a[104:107], v[80:83]
ds_read_b64_tr_b16 a[188:189], v235 offset:40968
ds_read_b128 v[156:159], v179
v_mfma_f32_16x16x32_bf16 v[112:115], a[152:155], a[108:111], v[112:115]
buffer_load_dwordx4 v228, s[8:11], s32 offen offset:0  lds
v_mfma_f32_16x16x32_bf16 v[116:119], a[156:159], a[108:111], v[116:119]
ds_read_b64_tr_b16 a[190:191], v235 offset:45064
ds_read_b128 v[160:163], v180
v_mfma_f32_16x16x32_bf16 v[84:87], a[156:159], a[104:107], v[84:87]
ds_read_b64_tr_b16 a[192:193], v236 offset:40960
v_mfma_f32_16x16x32_bf16 v[52:55], a[156:159], a[100:103], v[52:55]
ds_read_b64_tr_b16 a[194:195], v236 offset:45056
v_mfma_f32_16x16x32_bf16 v[20:23], a[156:159], a[96:99], v[20:23]
s_mul_i32 s45, s3, 1152
s_add_u32 s45, s45, s31
v_mfma_f32_16x16x32_bf16 v[24:27], a[160:163], a[96:99], v[24:27]
ds_read_b64_tr_b16 a[196:197], v236 offset:40968
s_add_u32 s45, s45, 0x1c00000
v_mfma_f32_16x16x32_bf16 v[56:59], a[160:163], a[100:103], v[56:59]
ds_read_b64_tr_b16 a[198:199], v236 offset:45064
v_mfma_f32_16x16x32_bf16 v[88:91], a[160:163], a[104:107], v[88:91]
buffer_load_dwordx4 v229, s[8:11], s32 offen offset:1024  lds
v_mfma_f32_16x16x32_bf16 v[120:123], a[160:163], a[108:111], v[120:123]
ds_read_b64_tr_b16 a[200:201], v237 offset:40960
v_mfma_f32_16x16x32_bf16 v[124:127], a[164:167], a[108:111], v[124:127]
ds_read_b64_tr_b16 a[202:203], v237 offset:45056
v_mfma_f32_16x16x32_bf16 v[92:95], a[164:167], a[104:107], v[92:95]
buffer_load_dwordx4 v230, s[8:11], s32 offen offset:2048  lds
v_mfma_f32_16x16x32_bf16 v[60:63], a[164:167], a[100:103], v[60:63]
ds_read_b64_tr_b16 a[204:205], v237 offset:40968
v_mfma_f32_16x16x32_bf16 v[28:31], a[164:167], a[96:99], v[28:31]
ds_read_b64_tr_b16 a[206:207], v237 offset:45064
v_mfma_f32_16x16x32_bf16 v[32:35], a[168:171], a[96:99], v[32:35]
s_waitcnt lgkmcnt(8)
buffer_store_dwordx4 v[152:155], v244, s[20:23], s45 offen sc0 sc1
v_mfma_f32_16x16x32_bf16 v[64:67], a[168:171], a[100:103], v[64:67]
buffer_load_dwordx4 v231, s[8:11], s32 offen offset:3072  lds
v_mfma_f32_16x16x32_bf16 v[96:99], a[168:171], a[104:107], v[96:99]
v_mfma_f32_16x16x32_bf16 v[128:131], a[168:171], a[108:111], v[128:131]
v_mfma_f32_16x16x32_bf16 v[132:135], a[172:175], a[108:111], v[132:135]
v_mfma_f32_16x16x32_bf16 v[100:103], a[172:175], a[104:107], v[100:103]
v_mfma_f32_16x16x32_bf16 v[68:71], a[172:175], a[100:103], v[68:71]
s_add_u32 s45, s45, 4096
buffer_store_dwordx4 v[156:159], v244, s[20:23], s45 offen sc0 sc1
v_mfma_f32_16x16x32_bf16 v[36:39], a[172:175], a[96:99], v[36:39]
s_waitcnt vmcnt(22)
v_mfma_f32_16x16x32_bf16 v[8:11], a[176:179], a[112:115], v[8:11]
ds_read_b64_tr_b16 a[144:145], v234 offset:49152
v_mfma_f32_16x16x32_bf16 v[40:43], a[176:179], a[116:119], v[40:43]
ds_read_b64_tr_b16 a[146:147], v234 offset:53248
v_mfma_f32_16x16x32_bf16 v[72:75], a[176:179], a[120:123], v[72:75]
v_mfma_f32_16x16x32_bf16 v[104:107], a[176:179], a[124:127], v[104:107]
ds_read_b64_tr_b16 a[148:149], v234 offset:49160
v_mfma_f32_16x16x32_bf16 v[108:111], a[180:183], a[124:127], v[108:111]
ds_read_b64_tr_b16 a[150:151], v234 offset:53256
v_mfma_f32_16x16x32_bf16 v[76:79], a[180:183], a[120:123], v[76:79]
s_add_u32 s45, s45, 4096
s_cmp_eq_u32 s37, 0
s_cselect_b32 s45, s45, 0x7ffffff0
buffer_store_dwordx4 v[160:163], v244, s[20:23], s45 offen sc0 sc1
v_mfma_f32_16x16x32_bf16 v[44:47], a[180:183], a[116:119], v[44:47]
ds_read_b64_tr_b16 a[152:153], v235 offset:49152
s_mul_i32 s88, s37, 864
v_mfma_f32_16x16x32_bf16 v[12:15], a[180:183], a[112:115], v[12:15]
ds_read_b64_tr_b16 a[154:155], v235 offset:53248
s_mov_b32 s87, s88
v_mfma_f32_16x16x32_bf16 v[16:19], a[184:187], a[112:115], v[16:19]
v_accvgpr_write_b32 a128, 0
v_accvgpr_write_b32 a129, 0
v_mfma_f32_16x16x32_bf16 v[48:51], a[184:187], a[116:119], v[48:51]
ds_read_b64_tr_b16 a[156:157], v235 offset:49160
v_accvgpr_write_b32 a130, 0
v_mfma_f32_16x16x32_bf16 v[80:83], a[184:187], a[120:123], v[80:83]
ds_read_b64_tr_b16 a[158:159], v235 offset:53256
v_accvgpr_write_b32 a131, 0
v_mfma_f32_16x16x32_bf16 v[112:115], a[184:187], a[124:127], v[112:115]
v_accvgpr_write_b32 a132, 0
v_accvgpr_write_b32 a133, 0
v_mfma_f32_16x16x32_bf16 v[116:119], a[188:191], a[124:127], v[116:119]
ds_read_b64_tr_b16 a[160:161], v236 offset:49152
v_accvgpr_write_b32 a134, 0
v_mfma_f32_16x16x32_bf16 v[84:87], a[188:191], a[120:123], v[84:87]
v_accvgpr_write_b32 a135, 0
v_lshrrev_b32 v240, 2, v1
v_mfma_f32_16x16x32_bf16 v[52:55], a[188:191], a[116:119], v[52:55]
ds_read_b64_tr_b16 a[162:163], v236 offset:53248
v_mul_u32_u24 v240, 0x2400, v240
v_mfma_f32_16x16x32_bf16 v[20:23], a[188:191], a[112:115], v[20:23]
ds_read_b64_tr_b16 a[164:165], v236 offset:49160
v_and_b32 v246, 3, v1
s_waitcnt lgkmcnt(8)
v_mfma_f32_16x16x32_bf16 v[24:27], a[192:195], a[112:115], v[24:27]
v_lshl_add_u32 v240, v246, 4, v240
v_mul_u32_u24 v243, 3641, v1
v_mfma_f32_16x16x32_bf16 v[56:59], a[192:195], a[116:119], v[56:59]
ds_read_b64_tr_b16 a[166:167], v236 offset:53256
v_lshrrev_b32 v243, 16, v243
v_mfma_f32_16x16x32_bf16 v[88:91], a[192:195], a[120:123], v[88:91]
ds_read_b64_tr_b16 a[168:169], v237 offset:49152
v_mul_u32_u24 v243, 864, v243
v_mfma_f32_16x16x32_bf16 v[120:123], a[192:195], a[124:127], v[120:123]
v_add_u32 v243, v243, v244
v_mfma_f32_16x16x32_bf16 v[124:127], a[196:199], a[124:127], v[124:127]
ds_read_b64_tr_b16 a[170:171], v237 offset:53248
s_sub_u32 s92, s40, 0
v_mfma_f32_16x16x32_bf16 v[92:95], a[196:199], a[120:123], v[92:95]
ds_read_b64_tr_b16 a[172:173], v237 offset:49160
v_mfma_f32_16x16x32_bf16 v[60:63], a[196:199], a[116:119], v[60:63]
s_cmp_lt_u32 s92, 72
s_cselect_b32 s3, 4, 0
v_mfma_f32_16x16x32_bf16 v[28:31], a[196:199], a[112:115], v[28:31]
ds_read_b64_tr_b16 a[174:175], v237 offset:53256
v_mfma_f32_16x16x32_bf16 v[32:35], a[200:203], a[112:115], v[32:35]
s_cmp_lt_u32 s40, 144
s_cselect_b32 s3, 5, s3
v_mfma_f32_16x16x32_bf16 v[64:67], a[200:203], a[116:119], v[64:67]
v_mfma_f32_16x16x32_bf16 v[96:99], a[200:203], a[120:123], v[96:99]
v_mfma_f32_16x16x32_bf16 v[128:131], a[200:203], a[124:127], v[128:131]
v_mfma_f32_16x16x32_bf16 v[132:135], a[204:207], a[124:127], v[132:135]
v_mfma_f32_16x16x32_bf16 v[100:103], a[204:207], a[120:123], v[100:103]
v_mfma_f32_16x16x32_bf16 v[68:71], a[204:207], a[116:119], v[68:71]
v_mfma_f32_16x16x32_bf16 v[36:39], a[204:207], a[112:115], v[36:39]
s_waitcnt vmcnt(17)
v_mfma_f32_16x16x32_bf16 v[8:11], a[144:147], a[0:3], v[8:11]
ds_read_b64_tr_b16 a[176:177], v234 offset:57344
s_add_u32 s39, s7, 0
v_mfma_f32_16x16x32_bf16 v[40:43], a[144:147], a[4:7], v[40:43]
ds_read_b64_tr_b16 a[178:179], v234 offset:61440
v_mfma_f32_16x16x32_bf16 v[72:75], a[144:147], a[8:11], v[72:75]
v_mfma_f32_16x16x32_bf16 v[104:107], a[144:147], a[12:15], v[104:107]
ds_read_b64_tr_b16 a[180:181], v234 offset:57352
s_waitcnt lgkmcnt(8)
v_mfma_f32_16x16x32_bf16 v[108:111], a[148:151], a[12:15], v[108:111]
ds_read_b64_tr_b16 a[182:183], v234 offset:61448
v_mfma_f32_16x16x32_bf16 v[76:79], a[148:151], a[8:11], v[76:79]
s_add_u32 m0, s30, 131072
v_mfma_f32_16x16x32_bf16 v[44:47], a[148:151], a[4:7], v[44:47]
ds_read_b64_tr_b16 a[184:185], v235 offset:57344
v_mfma_f32_16x16x32_bf16 v[12:15], a[148:151], a[0:3], v[12:15]
ds_read_b64_tr_b16 a[186:187], v235 offset:61440
v_mfma_f32_16x16x32_bf16 v[16:19], a[152:155], a[0:3], v[16:19]
v_mfma_f32_16x16x32_bf16 v[48:51], a[152:155], a[4:7], v[48:51]
ds_read_b64_tr_b16 a[188:189], v235 offset:57352
v_mfma_f32_16x16x32_bf16 v[80:83], a[152:155], a[8:11], v[80:83]
ds_read_b64_tr_b16 a[190:191], v235 offset:61448
v_mfma_f32_16x16x32_bf16 v[112:115], a[152:155], a[12:15], v[112:115]
buffer_load_dwordx4 v232, s[12:15], s39 offen offset:0  lds
v_mfma_f32_16x16x32_bf16 v[116:119], a[156:159], a[12:15], v[116:119]
ds_read_b64_tr_b16 a[192:193], v236 offset:57344
v_mfma_f32_16x16x32_bf16 v[84:87], a[156:159], a[8:11], v[84:87]
v_mfma_f32_16x16x32_bf16 v[52:55], a[156:159], a[4:7], v[52:55]
ds_read_b64_tr_b16 a[194:195], v236 offset:61440
v_mfma_f32_16x16x32_bf16 v[20:23], a[156:159], a[0:3], v[20:23]
ds_read_b64_tr_b16 a[196:197], v236 offset:57352
v_mfma_f32_16x16x32_bf16 v[24:27], a[160:163], a[0:3], v[24:27]
buffer_load_dwordx4 v233, s[12:15], s39 offen offset:1024  lds
v_mfma_f32_16x16x32_bf16 v[56:59], a[160:163], a[4:7], v[56:59]
ds_read_b64_tr_b16 a[198:199], v236 offset:61448
v_mfma_f32_16x16x32_bf16 v[88:91], a[160:163], a[8:11], v[88:91]
ds_read_b64_tr_b16 a[200:201], v237 offset:57344
v_mfma_f32_16x16x32_bf16 v[120:123], a[160:163], a[12:15], v[120:123]
s_waitcnt lgkmcnt(8)
v_mfma_f32_16x16x32_bf16 v[124:127], a[164:167], a[12:15], v[124:127]
ds_read_b64_tr_b16 a[202:203], v237 offset:61440
v_mfma_f32_16x16x32_bf16 v[92:95], a[164:167], a[8:11], v[92:95]
ds_read_b64_tr_b16 a[204:205], v237 offset:57352
v_mfma_f32_16x16x32_bf16 v[60:63], a[164:167], a[4:7], v[60:63]
buffer_load_dwordx4 v232, s[12:15], s39 offen offset:2048  lds
v_mfma_f32_16x16x32_bf16 v[28:31], a[164:167], a[0:3], v[28:31]
ds_read_b64_tr_b16 a[206:207], v237 offset:61448
v_mfma_f32_16x16x32_bf16 v[32:35], a[168:171], a[0:3], v[32:35]
v_mfma_f32_16x16x32_bf16 v[64:67], a[168:171], a[4:7], v[64:67]
buffer_load_dwordx4 v233, s[12:15], s39 offen offset:3072  lds
v_mfma_f32_16x16x32_bf16 v[96:99], a[168:171], a[8:11], v[96:99]
v_mfma_f32_16x16x32_bf16 v[128:131], a[168:171], a[12:15], v[128:131]
v_mfma_f32_16x16x32_bf16 v[132:135], a[172:175], a[12:15], v[132:135]
v_mfma_f32_16x16x32_bf16 v[100:103], a[172:175], a[8:11], v[100:103]
v_mfma_f32_16x16x32_bf16 v[68:71], a[172:175], a[4:7], v[68:71]
v_mfma_f32_16x16x32_bf16 v[36:39], a[172:175], a[0:3], v[36:39]
s_waitcnt vmcnt(13)
v_mfma_f32_16x16x32_bf16 v[8:11], a[176:179], a[16:19], v[8:11]
v_mfma_f32_16x16x32_bf16 v[12:15], a[180:183], a[16:19], v[12:15]
s_waitcnt vmcnt(17) lgkmcnt(0)
s_barrier
v_mfma_f32_16x16x32_bf16 v[16:19], a[184:187], a[16:19], v[16:19]
ds_read_b128 a[144:147], v216 offset:16384
ds_read_b128 a[148:151], v217 offset:16384
v_mfma_f32_16x16x32_bf16 v[20:23], a[188:191], a[16:19], v[20:23]
ds_read_b128 a[152:155], v218 offset:16384
ds_read_b128 a[156:159], v219 offset:16384
v_mfma_f32_16x16x32_bf16 v[24:27], a[192:195], a[16:19], v[24:27]
ds_read_b128 a[160:163], v216 offset:20480
ds_read_b128 a[164:167], v217 offset:20480
v_mfma_f32_16x16x32_bf16 v[28:31], a[196:199], a[16:19], v[28:31]
ds_read_b128 a[168:171], v218 offset:20480
ds_read_b128 a[172:175], v219 offset:20480
v_mfma_f32_16x16x32_bf16 v[32:35], a[200:203], a[16:19], v[32:35]
s_add_u32 s32, s7, 32768
v_mfma_f32_16x16x32_bf16 v[36:39], a[204:207], a[16:19], v[36:39]
s_add_u32 m0, s30, 65536
v_mfma_f32_16x16x32_bf16 v[40:43], a[176:179], a[20:23], v[40:43]
v_cvt_pk_bf16_f32 v152, v8, v9
v_cvt_pk_bf16_f32 v153, v10, v11
v_mfma_f32_16x16x32_bf16 v[44:47], a[180:183], a[20:23], v[44:47]
v_cvt_pk_bf16_f32 v154, v12, v13
v_cvt_pk_bf16_f32 v155, v14, v15
v_mfma_f32_16x16x32_bf16 v[48:51], a[184:187], a[20:23], v[48:51]
v_cvt_pk_bf16_f32 v156, v16, v17
v_cvt_pk_bf16_f32 v157, v18, v19
v_mfma_f32_16x16x32_bf16 v[52:55], a[188:191], a[20:23], v[52:55]
v_cvt_pk_bf16_f32 v158, v20, v21
v_cvt_pk_bf16_f32 v159, v22, v23
v_mfma_f32_16x16x32_bf16 v[56:59], a[192:195], a[20:23], v[56:59]
v_cvt_pk_bf16_f32 v160, v24, v25
v_cvt_pk_bf16_f32 v161, v26, v27
v_mfma_f32_16x16x32_bf16 v[60:63], a[196:199], a[20:23], v[60:63]
v_cvt_pk_bf16_f32 v162, v28, v29
v_cvt_pk_bf16_f32 v163, v30, v31
v_mfma_f32_16x16x32_bf16 v[64:67], a[200:203], a[20:23], v[64:67]
v_cvt_pk_bf16_f32 v164, v32, v33
v_cvt_pk_bf16_f32 v165, v34, v35
v_mfma_f32_16x16x32_bf16 v[68:71], a[204:207], a[20:23], v[68:71]
v_cvt_pk_bf16_f32 v166, v36, v37
v_cvt_pk_bf16_f32 v167, v38, v39
v_mfma_f32_16x16x32_bf16 v[72:75], a[176:179], a[24:27], v[72:75]
v_cvt_pk_bf16_f32 v168, v40, v41
v_cvt_pk_bf16_f32 v169, v42, v43
v_mfma_f32_16x16x32_bf16 v[76:79], a[180:183], a[24:27], v[76:79]
v_cvt_pk_bf16_f32 v170, v44, v45
v_cvt_pk_bf16_f32 v171, v46, v47
v_mfma_f32_16x16x32_bf16 v[80:83], a[184:187], a[24:27], v[80:83]
v_cvt_pk_bf16_f32 v172, v48, v49
v_cvt_pk_bf16_f32 v173, v50, v51
v_mfma_f32_16x16x32_bf16 v[84:87], a[188:191], a[24:27], v[84:87]
v_cvt_pk_bf16_f32 v174, v52, v53
v_cvt_pk_bf16_f32 v175, v54, v55
v_mfma_f32_16x16x32_bf16 v[88:91], a[192:195], a[24:27], v[88:91]
v_cvt_pk_bf16_f32 v176, v56, v57
v_cvt_pk_bf16_f32 v177, v58, v59
v_mfma_f32_16x16x32_bf16 v[92:95], a[196:199], a[24:27], v[92:95]
v_cvt_pk_bf16_f32 v178, v60, v61
v_cvt_pk_bf16_f32 v179, v62, v63
v_mfma_f32_16x16x32_bf16 v[96:99], a[200:203], a[24:27], v[96:99]
v_cvt_pk_bf16_f32 v180, v64, v65
v_cvt_pk_bf16_f32 v181, v66, v67
v_mfma_f32_16x16x32_bf16 v[100:103], a[204:207], a[24:27], v[100:103]
v_cvt_pk_bf16_f32 v182, v68, v69
v_cvt_pk_bf16_f32 v183, v70, v71
v_mfma_f32_16x16x32_bf16 v[104:107], a[176:179], a[28:31], v[104:107]
v_cvt_pk_bf16_f32 v184, v72, v73
v_cvt_pk_bf16_f32 v185, v74, v75
v_mfma_f32_16x16x32_bf16 v[108:111], a[180:183], a[28:31], v[108:111]
v_cvt_pk_bf16_f32 v186, v76, v77
v_cvt_pk_bf16_f32 v187, v78, v79
v_mfma_f32_16x16x32_bf16 v[112:115], a[184:187], a[28:31], v[112:115]
v_cvt_pk_bf16_f32 v188, v80, v81
v_cvt_pk_bf16_f32 v189, v82, v83
v_mfma_f32_16x16x32_bf16 v[116:119], a[188:191], a[28:31], v[116:119]
v_cvt_pk_bf16_f32 v190, v84, v85
v_cvt_pk_bf16_f32 v191, v86, v87
v_mfma_f32_16x16x32_bf16 v[120:123], a[192:195], a[28:31], v[120:123]
v_cvt_pk_bf16_f32 v192, v88, v89
v_cvt_pk_bf16_f32 v193, v90, v91
v_mfma_f32_16x16x32_bf16 v[124:127], a[196:199], a[28:31], v[124:127]
v_cvt_pk_bf16_f32 v194, v92, v93
v_cvt_pk_bf16_f32 v195, v94, v95
v_mfma_f32_16x16x32_bf16 v[128:131], a[200:203], a[28:31], v[128:131]
v_cvt_pk_bf16_f32 v196, v96, v97
v_cvt_pk_bf16_f32 v197, v98, v99
v_mfma_f32_16x16x32_bf16 v[132:135], a[204:207], a[28:31], v[132:135]
v_cvt_pk_bf16_f32 v198, v100, v101
v_cvt_pk_bf16_f32 v199, v102, v103
s_waitcnt lgkmcnt(7)
v_mfma_f32_16x16x32_bf16 v[8:11], a[144:147], v[152:155], 0
v_cvt_pk_bf16_f32 v200, v104, v105
v_cvt_pk_bf16_f32 v201, v106, v107
s_waitcnt lgkmcnt(6)
v_mfma_f32_16x16x32_bf16 v[8:11], a[148:151], v[156:159], v[8:11]
v_cvt_pk_bf16_f32 v202, v108, v109
v_cvt_pk_bf16_f32 v203, v110, v111
s_waitcnt lgkmcnt(5)
v_mfma_f32_16x16x32_bf16 v[8:11], a[152:155], v[160:163], v[8:11]
v_cvt_pk_bf16_f32 v204, v112, v113
v_cvt_pk_bf16_f32 v205, v114, v115
s_waitcnt lgkmcnt(4)
v_mfma_f32_16x16x32_bf16 v[8:11], a[156:159], v[164:167], v[8:11]
v_cvt_pk_bf16_f32 v206, v116, v117
v_cvt_pk_bf16_f32 v207, v118, v119
s_waitcnt lgkmcnt(3)
v_mfma_f32_16x16x32_bf16 v[12:15], a[160:163], v[152:155], 0
v_cvt_pk_bf16_f32 v208, v120, v121
v_cvt_pk_bf16_f32 v209, v122, v123
s_waitcnt lgkmcnt(2)
v_mfma_f32_16x16x32_bf16 v[12:15], a[164:167], v[156:159], v[12:15]
v_cvt_pk_bf16_f32 v210, v124, v125
v_cvt_pk_bf16_f32 v211, v126, v127
s_waitcnt lgkmcnt(1)
v_mfma_f32_16x16x32_bf16 v[12:15], a[168:171], v[160:163], v[12:15]
v_cvt_pk_bf16_f32 v212, v128, v129
v_cvt_pk_bf16_f32 v213, v130, v131
s_waitcnt lgkmcnt(0)
v_mfma_f32_16x16x32_bf16 v[12:15], a[172:175], v[164:167], v[12:15]
v_cvt_pk_bf16_f32 v214, v132, v133
v_cvt_pk_bf16_f32 v215, v134, v135
v_mfma_f32_16x16x32_bf16 v[16:19], a[144:147], v[168:171], 0
buffer_load_dwordx4 v228, s[8:11], s32 offen offset:0  lds
v_mfma_f32_16x16x32_bf16 v[16:19], a[148:151], v[172:175], v[16:19]
buffer_load_dwordx4 v229, s[8:11], s32 offen offset:1024  lds
STUB_3:
STUB_A3:
s_cbranch_execz STUB_6
v_mfma_f32_16x16x32_bf16 v[16:19], a[152:155], v[176:179], v[16:19]
buffer_load_dwordx4 v230, s[8:11], s32 offen offset:2048  lds
v_mfma_f32_16x16x32_bf16 v[16:19], a[156:159], v[180:183], v[16:19]
buffer_load_dwordx4 v231, s[8:11], s32 offen offset:3072  lds
v_max3_f32 v248, v8, v9, v10
v_mfma_f32_16x16x32_bf16 v[20:23], a[160:163], v[168:171], 0
s_add_u32 s39, s7, 16384
s_add_u32 m0, s30, 147456
v_mfma_f32_16x16x32_bf16 v[20:23], a[164:167], v[172:175], v[20:23]
buffer_load_dwordx4 v232, s[12:15], s39 offen offset:0  lds
v_mfma_f32_16x16x32_bf16 v[20:23], a[168:171], v[176:179], v[20:23]
buffer_load_dwordx4 v233, s[12:15], s39 offen offset:1024  lds
v_mfma_f32_16x16x32_bf16 v[20:23], a[172:175], v[180:183], v[20:23]
v_max3_f32 v248, v248, v11, v12
v_max3_f32 v248, v248, v13, v14
v_mfma_f32_16x16x32_bf16 v[24:27], a[144:147], v[184:187], 0
v_max_f32 v248, v248, v15
v_mov_b32 v249, v248
v_mfma_f32_16x16x32_bf16 v[24:27], a[148:151], v[188:191], v[24:27]
s_nop 0
v_permlane16_swap_b32 v248, v249
v_mfma_f32_16x16x32_bf16 v[24:27], a[152:155], v[192:195], v[24:27]
v_max_f32 v248, v248, v249
v_mov_b32 v249, v248
v_mfma_f32_16x16x32_bf16 v[24:27], a[156:159], v[196:199], v[24:27]
s_nop 0
v_permlane32_swap_b32 v248, v249
v_mfma_f32_16x16x32_bf16 v[28:31], a[160:163], v[184:187], 0
v_max_f32 v248, v248, v249
v_sub_f32 v136, 0, v248
v_sub_f32 v137, 0, v248
v_mfma_f32_16x16x32_bf16 v[28:31], a[164:167], v[188:191], v[28:31]
v_sub_f32 v138, 0, v248
v_sub_f32 v139, 0, v248
v_sub_f32 v8, v8, v248
v_mfma_f32_16x16x32_bf16 v[28:31], a[168:171], v[192:195], v[28:31]
v_sub_f32 v9, v9, v248
v_sub_f32 v10, v10, v248
v_sub_f32 v11, v11, v248
v_mfma_f32_16x16x32_bf16 v[28:31], a[172:175], v[196:199], v[28:31]
v_sub_f32 v12, v12, v248
v_sub_f32 v13, v13, v248
v_sub_f32 v14, v14, v248
v_mfma_f32_16x16x32_bf16 v[32:35], a[144:147], v[200:203], 0
v_sub_f32 v15, v15, v248
v_max3_f32 v250, v16, v17, v18
v_max3_f32 v250, v250, v19, v20
v_mfma_f32_16x16x32_bf16 v[32:35], a[148:151], v[204:207], v[32:35]
v_max3_f32 v250, v250, v21, v22
v_max_f32 v250, v250, v23
v_mov_b32 v251, v250
v_mfma_f32_16x16x32_bf16 v[32:35], a[152:155], v[208:211], v[32:35]
s_nop 0
v_permlane16_swap_b32 v250, v251
v_max_f32 v250, v250, v251
v_mfma_f32_16x16x32_bf16 v[32:35], a[156:159], v[212:215], v[32:35]
v_mov_b32 v251, v250
s_nop 1
v_permlane32_swap_b32 v250, v251
v_mfma_f32_16x16x32_bf16 v[36:39], a[160:163], v[200:203], 0
v_max_f32 v250, v250, v251
v_sub_f32 v140, 0, v250
v_sub_f32 v141, 0, v250
v_mfma_f32_16x16x32_bf16 v[36:39], a[164:167], v[204:207], v[36:39]
v_sub_f32 v142, 0, v250
v_sub_f32 v143, 0, v250
v_sub_f32 v16, v16, v250
v_mfma_f32_16x16x32_bf16 v[36:39], a[168:171], v[208:211], v[36:39]
v_sub_f32 v17, v17, v250
v_sub_f32 v18, v18, v250
v_sub_f32 v19, v19, v250
v_mfma_f32_16x16x32_bf16 v[36:39], a[172:175], v[212:215], v[36:39]
v_sub_f32 v20, v20, v250
v_sub_f32 v21, v21, v250
v_sub_f32 v22, v22, v250
ds_read_b128 a[144:147], v216 offset:24576
ds_read_b128 a[148:151], v217 offset:24576
ds_read_b128 a[152:155], v218 offset:24576
ds_read_b128 a[156:159], v219 offset:24576
ds_read_b128 a[160:163], v216 offset:28672
ds_read_b128 a[164:167], v217 offset:28672
ds_read_b128 a[168:171], v218 offset:28672
ds_read_b128 a[172:175], v219 offset:28672
buffer_load_dwordx4 v232, s[12:15], s39 offen offset:2048  lds
buffer_load_dwordx4 v233, s[12:15], s39 offen offset:3072  lds
s_add_u32 s32, s7, 32768
s_add_u32 s39, s7, 16384
v_sub_f32 v23, v23, v250
v_max3_f32 v248, v24, v25, v26
v_max3_f32 v248, v248, v27, v28
v_max3_f32 v248, v248, v29, v30
v_max_f32 v248, v248, v31
s_nop 3
v_max3_f32 v250, v32, v33, v34
v_max3_f32 v250, v250, v35, v36
v_max3_f32 v250, v250, v37, v38
v_max_f32 v250, v250, v39
v_mov_b32 v249, v248
v_mov_b32 v251, v250
s_nop 0
v_permlane16_swap_b32 v248, v249
v_permlane16_swap_b32 v250, v251
v_max_f32 v248, v248, v249
v_max_f32 v250, v250, v251
v_mov_b32 v249, v248
v_mov_b32 v251, v250
s_nop 0
v_permlane32_swap_b32 v248, v249
v_permlane32_swap_b32 v250, v251
v_max_f32 v248, v248, v249
v_max_f32 v250, v250, v251
v_sub_f32 v144, 0, v248
v_sub_f32 v148, 0, v250
v_sub_f32 v145, 0, v248
v_sub_f32 v149, 0, v250
v_sub_f32 v146, 0, v248
v_sub_f32 v150, 0, v250
v_sub_f32 v147, 0, v248
v_sub_f32 v151, 0, v250
v_sub_f32 v24, v24, v248
v_sub_f32 v32, v32, v250
v_sub_f32 v25, v25, v248
v_sub_f32 v33, v33, v250
v_sub_f32 v26, v26, v248
v_sub_f32 v34, v34, v250
v_sub_f32 v27, v27, v248
v_sub_f32 v35, v35, v250
v_sub_f32 v28, v28, v248
v_sub_f32 v36, v36, v250
v_sub_f32 v29, v29, v248
v_sub_f32 v37, v37, v250
v_sub_f32 v30, v30, v248
v_sub_f32 v38, v38, v250
v_sub_f32 v31, v31, v248
v_sub_f32 v39, v39, v250
K_BODY0:
s_waitcnt lgkmcnt(0)
v_mfma_f32_16x16x32_bf16 v[40:43], a[144:147], v[152:155], v[136:139]
v_exp_f32 v8, v8
v_exp_f32 v9, v9
v_mfma_f32_16x16x32_bf16 v[40:43], a[148:151], v[156:159], v[40:43]
v_cvt_pk_bf16_f32 v72, v8, v9
v_exp_f32 v10, v10
v_mfma_f32_16x16x32_bf16 v[40:43], a[152:155], v[160:163], v[40:43]
v_exp_f32 v11, v11
v_mfma_f32_16x16x32_bf16 v[40:43], a[156:159], v[164:167], v[40:43]
v_cvt_pk_bf16_f32 v73, v10, v11
v_exp_f32 v12, v12
v_mfma_f32_16x16x32_bf16 v[48:51], a[156:159], v[180:183], v[140:143]
v_exp_f32 v13, v13
v_mfma_f32_16x16x32_bf16 v[48:51], a[152:155], v[176:179], v[48:51]
v_cvt_pk_bf16_f32 v74, v12, v13
v_exp_f32 v14, v14
v_mfma_f32_16x16x32_bf16 v[48:51], a[148:151], v[172:175], v[48:51]
v_exp_f32 v15, v15
v_mfma_f32_16x16x32_bf16 v[48:51], a[144:147], v[168:171], v[48:51]
v_exp_f32 v16, v16
v_exp_f32 v17, v17
v_mfma_f32_16x16x32_bf16 v[56:59], a[144:147], v[184:187], v[144:147]
v_cvt_pk_bf16_f32 v75, v14, v15
v_cvt_pk_bf16_f32 v76, v16, v17
v_exp_f32 v18, v18
v_mfma_f32_16x16x32_bf16 v[56:59], a[148:151], v[188:191], v[56:59]
v_exp_f32 v19, v19
v_mfma_f32_16x16x32_bf16 v[56:59], a[152:155], v[192:195], v[56:59]
v_cvt_pk_bf16_f32 v77, v18, v19
v_exp_f32 v20, v20
v_mfma_f32_16x16x32_bf16 v[56:59], a[156:159], v[196:199], v[56:59]
v_exp_f32 v21, v21
v_mfma_f32_16x16x32_bf16 v[64:67], a[156:159], v[212:215], v[148:151]
s_waitcnt vmcnt(8) lgkmcnt(0)
s_barrier
v_exp_f32 v22, v22
v_mfma_f32_16x16x32_bf16 v[64:67], a[152:155], v[208:211], v[64:67]
ds_read_b64_tr_b16 a[176:177], v220 offset:32768
v_cvt_pk_bf16_f32 v78, v20, v21
v_exp_f32 v23, v23
v_mfma_f32_16x16x32_bf16 v[64:67], a[148:151], v[204:207], v[64:67]
v_exp_f32 v24, v24
v_exp_f32 v25, v25
v_mfma_f32_16x16x32_bf16 v[64:67], a[144:147], v[200:203], v[64:67]
v_cvt_pk_bf16_f32 v79, v22, v23
v_cvt_pk_bf16_f32 v80, v24, v25
v_exp_f32 v26, v26
v_mfma_f32_16x16x32_bf16 v[44:47], a[160:163], v[152:155], v[136:139]
ds_read_b64_tr_b16 a[178:179], v220 offset:36864
ds_read_b64_tr_b16 a[180:181], v221 offset:32768
v_exp_f32 v27, v27
v_mfma_f32_16x16x32_bf16 v[44:47], a[164:167], v[156:159], v[44:47]
ds_read_b64_tr_b16 a[182:183], v221 offset:36864
v_cvt_pk_bf16_f32 v81, v26, v27
v_exp_f32 v28, v28
v_mfma_f32_16x16x32_bf16 v[44:47], a[168:171], v[160:163], v[44:47]
ds_read_b64_tr_b16 a[184:185], v222 offset:32768
ds_read_b64_tr_b16 a[186:187], v222 offset:36864
v_exp_f32 v29, v29
v_mfma_f32_16x16x32_bf16 v[44:47], a[172:175], v[164:167], v[44:47]
ds_read_b64_tr_b16 a[188:189], v223 offset:32768
v_cvt_pk_bf16_f32 v82, v28, v29
v_exp_f32 v30, v30
v_mfma_f32_16x16x32_bf16 v[52:55], a[172:175], v[180:183], v[140:143]
ds_read_b64_tr_b16 a[190:191], v223 offset:36864
ds_read_b128 a[156:159], v219 offset:49152
v_exp_f32 v31, v31
v_mfma_f32_16x16x32_bf16 v[52:55], a[168:171], v[176:179], v[52:55]
v_exp_f32 v32, v32
v_exp_f32 v33, v33
v_mfma_f32_16x16x32_bf16 v[52:55], a[164:167], v[172:175], v[52:55]
v_cvt_pk_bf16_f32 v83, v30, v31
v_cvt_pk_bf16_f32 v84, v32, v33
v_exp_f32 v34, v34
v_mfma_f32_16x16x32_bf16 v[52:55], a[160:163], v[168:171], v[52:55]
ds_read_b64_tr_b16 a[192:193], v224 offset:32768
ds_read_b64_tr_b16 a[194:195], v224 offset:36864
v_exp_f32 v35, v35
v_mfma_f32_16x16x32_bf16 v[60:63], a[160:163], v[184:187], v[144:147]
ds_read_b128 a[152:155], v218 offset:49152
v_cvt_pk_bf16_f32 v85, v34, v35
v_exp_f32 v36, v36
v_mfma_f32_16x16x32_bf16 v[60:63], a[164:167], v[188:191], v[60:63]
ds_read_b128 a[148:151], v217 offset:49152
ds_read_b128 a[144:147], v216 offset:49152
v_exp_f32 v37, v37
v_mfma_f32_16x16x32_bf16 v[60:63], a[168:171], v[192:195], v[60:63]
ds_read_b64_tr_b16 a[196:197], v225 offset:32768
v_cvt_pk_bf16_f32 v86, v36, v37
v_exp_f32 v38, v38
v_mfma_f32_16x16x32_bf16 v[60:63], a[172:175], v[196:199], v[60:63]
ds_read_b64_tr_b16 a[198:199], v225 offset:36864
ds_read_b64_tr_b16 a[200:201], v226 offset:32768
v_exp_f32 v39, v39
v_mfma_f32_16x16x32_bf16 v[68:71], a[172:175], v[212:215], v[148:151]
ds_read_b64_tr_b16 a[202:203], v226 offset:36864
ds_read_b64_tr_b16 a[204:205], v227 offset:32768
ds_read_b64_tr_b16 a[206:207], v227 offset:36864
v_cvt_pk_bf16_f32 v87, v38, v39
v_mfma_f32_16x16x32_bf16 v[68:71], a[168:171], v[208:211], v[68:71]
ds_read_b128 a[172:175], v219 offset:53248
ds_read_b128 a[168:171], v218 offset:53248
s_add_u32 s32, s32, 16384
s_add_u32 m0, s30, 81920
v_mfma_f32_16x16x32_bf16 v[68:71], a[164:167], v[204:207], v[68:71]
ds_read_b128 a[164:167], v217 offset:53248
buffer_load_dwordx4 v228, s[8:11], s32 offen offset:0  lds
v_mfma_f32_16x16x32_bf16 v[68:71], a[160:163], v[200:203], v[68:71]
ds_read_b128 a[160:163], v216 offset:53248
buffer_load_dwordx4 v229, s[8:11], s32 offen offset:1024  lds
buffer_load_dwordx4 v230, s[8:11], s32 offen offset:2048  lds
buffer_load_dwordx4 v231, s[8:11], s32 offen offset:3072  lds
buffer_store_byte v255, v254, s[24:27], 0 offen sc0 sc1
s_waitcnt lgkmcnt(8)
v_mfma_f32_16x16x32_bf16 v[8:11], a[144:147], v[152:155], v[136:139]
ds_read_b64_tr_b16 a[212:213], v220 offset:40960
v_exp_f32 v40, v40
v_mfma_f32_16x16x32_bf16 v[8:11], a[148:151], v[156:159], v[8:11]
ds_read_b64_tr_b16 a[214:215], v220 offset:45056
v_exp_f32 v41, v41
v_mfma_f32_16x16x32_bf16 v[8:11], a[152:155], v[160:163], v[8:11]
v_cvt_pk_bf16_f32 v88, v40, v41
v_exp_f32 v42, v42
v_mfma_f32_16x16x32_bf16 v[8:11], a[156:159], v[164:167], v[8:11]
s_add_u32 s39, s39, 16384
v_mfma_f32_16x16x32_bf16 v[16:19], a[156:159], v[180:183], v[140:143]
v_exp_f32 v43, v43
v_mfma_f32_16x16x32_bf16 v[16:19], a[152:155], v[176:179], v[16:19]
v_cvt_pk_bf16_f32 v89, v42, v43
v_exp_f32 v44, v44
v_mfma_f32_16x16x32_bf16 v[16:19], a[148:151], v[172:175], v[16:19]
ds_read_b64_tr_b16 a[216:217], v221 offset:40960
ds_read_b64_tr_b16 a[218:219], v221 offset:45056
v_mfma_f32_16x16x32_bf16 v[16:19], a[144:147], v[168:171], v[16:19]
v_exp_f32 v45, v45
v_mfma_f32_16x16x32_bf16 v[24:27], a[144:147], v[184:187], v[144:147]
v_cvt_pk_bf16_f32 v90, v44, v45
v_exp_f32 v46, v46
v_mfma_f32_16x16x32_bf16 v[24:27], a[148:151], v[188:191], v[24:27]
s_add_u32 m0, s30, 98304
v_mfma_f32_16x16x32_bf16 v[24:27], a[152:155], v[192:195], v[24:27]
ds_read_b64_tr_b16 a[220:221], v222 offset:40960
v_exp_f32 v47, v47
v_mfma_f32_16x16x32_bf16 v[24:27], a[156:159], v[196:199], v[24:27]
v_cvt_pk_bf16_f32 v91, v46, v47
v_exp_f32 v48, v48
v_mfma_f32_16x16x32_bf16 v[32:35], a[156:159], v[212:215], v[148:151]
ds_read_b64_tr_b16 a[222:223], v222 offset:45056
v_exp_f32 v49, v49
v_mfma_f32_16x16x32_bf16 v[32:35], a[152:155], v[208:211], v[32:35]
ds_read_b128 a[156:159], v219 offset:57344
ds_read_b128 a[152:155], v218 offset:57344
v_cvt_pk_bf16_f32 v92, v48, v49
v_mfma_f32_16x16x32_bf16 v[32:35], a[148:151], v[204:207], v[32:35]
ds_read_b128 a[148:151], v217 offset:57344
v_exp_f32 v50, v50
v_mfma_f32_16x16x32_bf16 v[32:35], a[144:147], v[200:203], v[32:35]
ds_read_b128 a[144:147], v216 offset:57344
v_exp_f32 v51, v51
v_mfma_f32_16x16x32_bf16 a[8:11], v[80:83], a[176:179], 0
ds_read_b64_tr_b16 a[224:225], v223 offset:40960
ds_read_b64_tr_b16 a[226:227], v223 offset:45056
v_cvt_pk_bf16_f32 v93, v50, v51
v_mfma_f32_16x16x32_bf16 a[12:15], v[84:87], a[176:179], 0
v_exp_f32 v52, v52
v_mfma_f32_16x16x32_bf16 a[28:31], v[84:87], a[180:183], 0
v_exp_f32 v53, v53
v_mfma_f32_16x16x32_bf16 a[24:27], v[80:83], a[180:183], 0
buffer_load_dwordx4 v232, s[12:15], s39 offen offset:0  lds
v_cvt_pk_bf16_f32 v94, v52, v53
v_mfma_f32_16x16x32_bf16 a[40:43], v[80:83], a[184:187], 0
ds_read_b64_tr_b16 a[228:229], v224 offset:40960
v_exp_f32 v54, v54
v_mfma_f32_16x16x32_bf16 a[44:47], v[84:87], a[184:187], 0
ds_read_b64_tr_b16 a[230:231], v224 offset:45056
v_exp_f32 v55, v55
v_mfma_f32_16x16x32_bf16 a[60:63], v[84:87], a[188:191], 0
v_cvt_pk_bf16_f32 v95, v54, v55
v_mfma_f32_16x16x32_bf16 a[56:59], v[80:83], a[188:191], 0
v_exp_f32 v56, v56
v_smfmac_f32_16x16x64_bf16 a[128:131], a[208:211], v[72:79], v245
v_exp_f32 v57, v57
s_waitcnt lgkmcnt(8)
v_mfma_f32_16x16x32_bf16 v[12:15], a[160:163], v[152:155], v[136:139]
v_cvt_pk_bf16_f32 v96, v56, v57
v_exp_f32 v58, v58
v_mfma_f32_16x16x32_bf16 v[12:15], a[164:167], v[156:159], v[12:15]
ds_read_b64_tr_b16 a[232:233], v225 offset:40960
ds_read_b64_tr_b16 a[234:235], v225 offset:45056
v_mfma_f32_16x16x32_bf16 v[12:15], a[168:171], v[160:163], v[12:15]
v_exp_f32 v59, v59
v_mfma_f32_16x16x32_bf16 v[12:15], a[172:175], v[164:167], v[12:15]
v_cvt_pk_bf16_f32 v97, v58, v59
v_exp_f32 v60, v60
v_mfma_f32_16x16x32_bf16 v[20:23], a[172:175], v[180:183], v[140:143]
buffer_load_dwordx4 v233, s[12:15], s39 offen offset:1024  lds
v_mfma_f32_16x16x32_bf16 v[20:23], a[168:171], v[176:179], v[20:23]
ds_read_b64_tr_b16 a[236:237], v226 offset:40960
v_exp_f32 v61, v61
v_mfma_f32_16x16x32_bf16 v[20:23], a[164:167], v[172:175], v[20:23]
v_cvt_pk_bf16_f32 v98, v60, v61
v_exp_f32 v62, v62
v_mfma_f32_16x16x32_bf16 v[20:23], a[160:163], v[168:171], v[20:23]
ds_read_b64_tr_b16 a[238:239], v226 offset:45056
buffer_load_dwordx4 v232, s[12:15], s39 offen offset:2048  lds
v_mfma_f32_16x16x32_bf16 v[28:31], a[160:163], v[184:187], v[144:147]
v_exp_f32 v63, v63
v_mfma_f32_16x16x32_bf16 v[28:31], a[164:167], v[188:191], v[28:31]
v_cvt_pk_bf16_f32 v99, v62, v63
v_exp_f32 v64, v64
v_mfma_f32_16x16x32_bf16 v[28:31], a[168:171], v[192:195], v[28:31]
ds_read_b64_tr_b16 a[240:241], v227 offset:40960
v_exp_f32 v65, v65
v_mfma_f32_16x16x32_bf16 v[28:31], a[172:175], v[196:199], v[28:31]
ds_read_b64_tr_b16 a[242:243], v227 offset:45056
v_cvt_pk_bf16_f32 v100, v64, v65
v_mfma_f32_16x16x32_bf16 v[36:39], a[172:175], v[212:215], v[148:151]
ds_read_b128 a[172:175], v219 offset:61440
v_exp_f32 v66, v66
v_mfma_f32_16x16x32_bf16 v[36:39], a[168:171], v[208:211], v[36:39]
ds_read_b128 a[168:171], v218 offset:61440
v_exp_f32 v67, v67
v_mfma_f32_16x16x32_bf16 v[36:39], a[164:167], v[204:207], v[36:39]
ds_read_b128 a[164:167], v217 offset:61440
v_cvt_pk_bf16_f32 v101, v66, v67
v_mfma_f32_16x16x32_bf16 v[36:39], a[160:163], v[200:203], v[36:39]
ds_read_b128 a[160:163], v216 offset:61440
v_exp_f32 v68, v68
v_mfma_f32_16x16x32_bf16 a[72:75], v[80:83], a[192:195], 0
v_exp_f32 v69, v69
v_mfma_f32_16x16x32_bf16 a[76:79], v[84:87], a[192:195], 0
buffer_load_dwordx4 v233, s[12:15], s39 offen offset:3072  lds
v_cvt_pk_bf16_f32 v102, v68, v69
v_mfma_f32_16x16x32_bf16 a[92:95], v[84:87], a[196:199], 0
v_exp_f32 v70, v70
v_mfma_f32_16x16x32_bf16 a[88:91], v[80:83], a[196:199], 0
v_exp_f32 v71, v71
v_mfma_f32_16x16x32_bf16 a[104:107], v[80:83], a[200:203], 0
v_cvt_pk_bf16_f32 v103, v70, v71
v_mfma_f32_16x16x32_bf16 a[108:111], v[84:87], a[200:203], 0
v_mfma_f32_16x16x32_bf16 a[124:127], v[84:87], a[204:207], 0
v_mfma_f32_16x16x32_bf16 a[120:123], v[80:83], a[204:207], 0
v_smfmac_f32_16x16x64_bf16 a[132:135], a[208:211], v[80:87], v245
s_waitcnt lgkmcnt(8)
v_mfma_f32_16x16x32_bf16 v[40:43], a[144:147], v[152:155], v[136:139]
v_exp_f32 v8, v8
v_mfma_f32_16x16x32_bf16 v[40:43], a[148:151], v[156:159], v[40:43]
v_exp_f32 v9, v9
v_mfma_f32_16x16x32_bf16 v[40:43], a[152:155], v[160:163], v[40:43]
v_cvt_pk_bf16_f32 v104, v8, v9
v_lshlrev_b32 v250, 3, v1
v_mfma_f32_16x16x32_bf16 v[40:43], a[156:159], v[164:167], v[40:43]
v_exp_f32 v10, v10
v_mfma_f32_16x16x32_bf16 v[48:51], a[156:159], v[180:183], v[140:143]
v_mfma_f32_16x16x32_bf16 v[48:51], a[152:155], v[176:179], v[48:51]
v_exp_f32 v11, v11
v_mfma_f32_16x16x32_bf16 v[48:51], a[148:151], v[172:175], v[48:51]
v_cvt_pk_bf16_f32 v105, v10, v11
v_mfma_f32_16x16x32_bf16 v[48:51], a[144:147], v[168:171], v[48:51]
v_exp_f32 v12, v12
v_mfma_f32_16x16x32_bf16 v[56:59], a[144:147], v[184:187], v[144:147]
v_mfma_f32_16x16x32_bf16 v[56:59], a[148:151], v[188:191], v[56:59]
v_exp_f32 v13, v13
v_mfma_f32_16x16x32_bf16 v[56:59], a[152:155], v[192:195], v[56:59]
v_cvt_pk_bf16_f32 v106, v12, v13
v_mfma_f32_16x16x32_bf16 v[56:59], a[156:159], v[196:199], v[56:59]
v_exp_f32 v14, v14
v_mfma_f32_16x16x32_bf16 v[64:67], a[156:159], v[212:215], v[148:151]
s_waitcnt vmcnt(9) lgkmcnt(0)
s_barrier
v_mfma_f32_16x16x32_bf16 v[64:67], a[152:155], v[208:211], v[64:67]
v_exp_f32 v15, v15
v_mfma_f32_16x16x32_bf16 v[64:67], a[148:151], v[204:207], v[64:67]
ds_read_b128 a[156:159], v219 offset:0
v_cvt_pk_bf16_f32 v107, v14, v15
v_mfma_f32_16x16x32_bf16 v[64:67], a[144:147], v[200:203], v[64:67]
v_exp_f32 v16, v16
v_mfma_f32_16x16x32_bf16 a[0:3], v[88:91], a[212:215], 0
ds_read_b128 a[152:155], v218 offset:0
ds_read_b128 a[148:151], v217 offset:0
v_mfma_f32_16x16x32_bf16 a[0:3], v[72:75], a[176:179], a[0:3]
v_exp_f32 v17, v17
v_mfma_f32_16x16x32_bf16 a[4:7], v[76:79], a[176:179], 0
ds_read_b128 a[144:147], v216 offset:0
v_cvt_pk_bf16_f32 v108, v16, v17
v_mfma_f32_16x16x32_bf16 a[4:7], v[92:95], a[212:215], a[4:7]
v_exp_f32 v18, v18
v_mfma_f32_16x16x32_bf16 a[20:23], v[92:95], a[216:219], 0
ds_read_b64_tr_b16 a[176:177], v220 offset:49152
ds_read_b64_tr_b16 a[178:179], v220 offset:53248
v_mfma_f32_16x16x32_bf16 a[20:23], v[76:79], a[180:183], a[20:23]
v_exp_f32 v19, v19
v_mfma_f32_16x16x32_bf16 a[16:19], v[72:75], a[180:183], 0
ds_read_b64_tr_b16 a[180:181], v221 offset:49152
v_cvt_pk_bf16_f32 v109, v18, v19
v_mfma_f32_16x16x32_bf16 a[16:19], v[88:91], a[216:219], a[16:19]
v_exp_f32 v20, v20
v_mfma_f32_16x16x32_bf16 a[32:35], v[88:91], a[220:223], 0
ds_read_b64_tr_b16 a[182:183], v221 offset:53248
s_add_u32 s32, s32, 16384
v_mfma_f32_16x16x32_bf16 a[32:35], v[72:75], a[184:187], a[32:35]
v_exp_f32 v21, v21
v_mfma_f32_16x16x32_bf16 a[36:39], v[76:79], a[184:187], 0
ds_read_b64_tr_b16 a[184:185], v222 offset:49152
v_cvt_pk_bf16_f32 v110, v20, v21
v_mfma_f32_16x16x32_bf16 a[36:39], v[92:95], a[220:223], a[36:39]
v_exp_f32 v22, v22
v_mfma_f32_16x16x32_bf16 a[52:55], v[92:95], a[224:227], 0
ds_read_b64_tr_b16 a[186:187], v222 offset:53248
s_add_u32 m0, s30, 114688
v_mfma_f32_16x16x32_bf16 a[52:55], v[76:79], a[188:191], a[52:55]
v_exp_f32 v23, v23
v_mfma_f32_16x16x32_bf16 a[48:51], v[72:75], a[188:191], 0
ds_read_b64_tr_b16 a[188:189], v223 offset:49152
v_cvt_pk_bf16_f32 v111, v22, v23
v_mfma_f32_16x16x32_bf16 a[48:51], v[88:91], a[224:227], a[48:51]
v_exp_f32 v24, v24
v_smfmac_f32_16x16x64_bf16 a[128:131], a[208:211], v[88:95], v245
v_exp_f32 v25, v25
v_mfma_f32_16x16x32_bf16 v[44:47], a[160:163], v[152:155], v[136:139]
ds_read_b64_tr_b16 a[190:191], v223 offset:53248
v_cvt_pk_bf16_f32 v112, v24, v25
v_mfma_f32_16x16x32_bf16 v[44:47], a[164:167], v[156:159], v[44:47]
v_exp_f32 v26, v26
v_mfma_f32_16x16x32_bf16 v[44:47], a[168:171], v[160:163], v[44:47]
buffer_load_dwordx4 v228, s[8:11], s32 offen offset:0  lds
v_mfma_f32_16x16x32_bf16 v[44:47], a[172:175], v[164:167], v[44:47]
v_exp_f32 v27, v27
v_mfma_f32_16x16x32_bf16 v[52:55], a[172:175], v[180:183], v[140:143]
v_cvt_pk_bf16_f32 v113, v26, v27
v_mfma_f32_16x16x32_bf16 v[52:55], a[168:171], v[176:179], v[52:55]
v_exp_f32 v28, v28
v_mfma_f32_16x16x32_bf16 v[52:55], a[164:167], v[172:175], v[52:55]
buffer_load_dwordx4 v229, s[8:11], s32 offen offset:1024  lds
v_mfma_f32_16x16x32_bf16 v[52:55], a[160:163], v[168:171], v[52:55]
v_exp_f32 v29, v29
v_mfma_f32_16x16x32_bf16 v[60:63], a[160:163], v[184:187], v[144:147]
v_cvt_pk_bf16_f32 v114, v28, v29
v_mfma_f32_16x16x32_bf16 v[60:63], a[164:167], v[188:191], v[60:63]
v_exp_f32 v30, v30
v_mfma_f32_16x16x32_bf16 v[60:63], a[168:171], v[192:195], v[60:63]
buffer_load_dwordx4 v230, s[8:11], s32 offen offset:2048  lds
v_mfma_f32_16x16x32_bf16 v[60:63], a[172:175], v[196:199], v[60:63]
v_exp_f32 v31, v31
v_mfma_f32_16x16x32_bf16 v[68:71], a[172:175], v[212:215], v[148:151]
ds_read_b128 a[172:175], v219 offset:4096
v_cvt_pk_bf16_f32 v115, v30, v31
v_mfma_f32_16x16x32_bf16 v[68:71], a[168:171], v[208:211], v[68:71]
v_exp_f32 v32, v32
v_mfma_f32_16x16x32_bf16 v[68:71], a[164:167], v[204:207], v[68:71]
ds_read_b128 a[168:171], v218 offset:4096
ds_read_b128 a[164:167], v217 offset:4096
v_mfma_f32_16x16x32_bf16 v[68:71], a[160:163], v[200:203], v[68:71]
v_exp_f32 v33, v33
v_mfma_f32_16x16x32_bf16 a[64:67], v[88:91], a[228:231], 0
ds_read_b128 a[160:163], v216 offset:4096
v_cvt_pk_bf16_f32 v116, v32, v33
v_mfma_f32_16x16x32_bf16 a[64:67], v[72:75], a[192:195], a[64:67]
v_exp_f32 v34, v34
v_mfma_f32_16x16x32_bf16 a[68:71], v[76:79], a[192:195], 0
ds_read_b64_tr_b16 a[192:193], v224 offset:49152
ds_read_b64_tr_b16 a[194:195], v224 offset:53248
v_mfma_f32_16x16x32_bf16 a[68:71], v[92:95], a[228:231], a[68:71]
v_exp_f32 v35, v35
v_mfma_f32_16x16x32_bf16 a[84:87], v[92:95], a[232:235], 0
v_cvt_pk_bf16_f32 v117, v34, v35
v_mfma_f32_16x16x32_bf16 a[84:87], v[76:79], a[196:199], a[84:87]
v_exp_f32 v36, v36
v_mfma_f32_16x16x32_bf16 a[80:83], v[72:75], a[196:199], 0
ds_read_b64_tr_b16 a[196:197], v225 offset:49152
ds_read_b64_tr_b16 a[198:199], v225 offset:53248
v_mfma_f32_16x16x32_bf16 a[80:83], v[88:91], a[232:235], a[80:83]
v_exp_f32 v37, v37
v_mfma_f32_16x16x32_bf16 a[96:99], v[88:91], a[236:239], 0
v_cvt_pk_bf16_f32 v118, v36, v37
v_mfma_f32_16x16x32_bf16 a[96:99], v[72:75], a[200:203], a[96:99]
v_exp_f32 v38, v38
v_mfma_f32_16x16x32_bf16 a[100:103], v[76:79], a[200:203], 0
ds_read_b64_tr_b16 a[200:201], v226 offset:49152
ds_read_b64_tr_b16 a[202:203], v226 offset:53248
v_mfma_f32_16x16x32_bf16 a[100:103], v[92:95], a[236:239], a[100:103]
v_exp_f32 v39, v39
v_mfma_f32_16x16x32_bf16 a[116:119], v[92:95], a[240:243], 0
v_cvt_pk_bf16_f32 v119, v38, v39
v_mfma_f32_16x16x32_bf16 a[116:119], v[76:79], a[204:207], a[116:119]
buffer_load_dwordx4 v231, s[8:11], s32 offen offset:3072  lds
v_mfma_f32_16x16x32_bf16 a[112:115], v[72:75], a[204:207], 0
ds_read_b64_tr_b16 a[204:205], v227 offset:49152
ds_read_b64_tr_b16 a[206:207], v227 offset:53248
v_mfma_f32_16x16x32_bf16 a[112:115], v[88:91], a[240:243], a[112:115]
s_add_u32 m0, s86, 0
s_add_u32 s50, s84, 0
buffer_load_dwordx4 v240, s[64:67], s50 offen lds
v_smfmac_f32_16x16x64_bf16 a[132:135], a[208:211], v[96:103], v245
s_add_u32 m0, s86, 4096
s_add_u32 s50, s84, 589824
buffer_load_dwordx4 v240, s[64:67], s50 offen lds
s_waitcnt lgkmcnt(8)
v_mfma_f32_16x16x32_bf16 v[8:11], a[144:147], v[152:155], v[136:139]
v_exp_f32 v40, v40
v_mfma_f32_16x16x32_bf16 v[8:11], a[148:151], v[156:159], v[8:11]
v_exp_f32 v41, v41
v_mfma_f32_16x16x32_bf16 v[8:11], a[152:155], v[160:163], v[8:11]
v_cvt_pk_bf16_f32 v72, v40, v41
v_mfma_f32_16x16x32_bf16 v[8:11], a[156:159], v[164:167], v[8:11]
v_exp_f32 v42, v42
v_mfma_f32_16x16x32_bf16 v[16:19], a[156:159], v[180:183], v[140:143]
s_add_u32 s39, s39, 16384
v_mfma_f32_16x16x32_bf16 v[16:19], a[152:155], v[176:179], v[16:19]
v_exp_f32 v43, v43
v_mfma_f32_16x16x32_bf16 v[16:19], a[148:151], v[172:175], v[16:19]
v_cvt_pk_bf16_f32 v73, v42, v43
v_mfma_f32_16x16x32_bf16 v[16:19], a[144:147], v[168:171], v[16:19]
v_exp_f32 v44, v44
v_mfma_f32_16x16x32_bf16 v[24:27], a[144:147], v[184:187], v[144:147]
s_mov_b32 s29, 0x242000
buffer_load_dwordx2 v[248:249], v250, s[20:23], s29 offen sc0 sc1
v_mfma_f32_16x16x32_bf16 v[24:27], a[148:151], v[188:191], v[24:27]
v_exp_f32 v45, v45
v_mfma_f32_16x16x32_bf16 v[24:27], a[152:155], v[192:195], v[24:27]
s_add_u32 m0, s30, 131072
v_cvt_pk_bf16_f32 v74, v44, v45
v_mfma_f32_16x16x32_bf16 v[24:27], a[156:159], v[196:199], v[24:27]
v_exp_f32 v46, v46
v_mfma_f32_16x16x32_bf16 v[32:35], a[156:159], v[212:215], v[148:151]
ds_read_b128 a[156:159], v219 offset:8192
v_mfma_f32_16x16x32_bf16 v[32:35], a[152:155], v[208:211], v[32:35]
v_exp_f32 v47, v47
v_mfma_f32_16x16x32_bf16 v[32:35], a[148:151], v[204:207], v[32:35]
ds_read_b128 a[152:155], v218 offset:8192
v_cvt_pk_bf16_f32 v75, v46, v47
v_mfma_f32_16x16x32_bf16 v[32:35], a[144:147], v[200:203], v[32:35]
v_exp_f32 v48, v48
v_mfma_f32_16x16x32_bf16 a[8:11], v[112:115], a[176:179], a[8:11]
ds_read_b128 a[148:151], v217 offset:8192
ds_read_b128 a[144:147], v216 offset:8192
v_mfma_f32_16x16x32_bf16 a[8:11], v[96:99], a[212:215], a[8:11]
v_exp_f32 v49, v49
v_mfma_f32_16x16x32_bf16 a[12:15], v[100:103], a[212:215], a[12:15]
ds_read_b64_tr_b16 a[212:213], v220 offset:57344
v_cvt_pk_bf16_f32 v76, v48, v49
v_mfma_f32_16x16x32_bf16 a[12:15], v[116:119], a[176:179], a[12:15]
v_exp_f32 v50, v50
v_mfma_f32_16x16x32_bf16 a[28:31], v[116:119], a[180:183], a[28:31]
ds_read_b64_tr_b16 a[214:215], v220 offset:61440
v_mfma_f32_16x16x32_bf16 a[28:31], v[100:103], a[216:219], a[28:31]
v_exp_f32 v51, v51
v_mfma_f32_16x16x32_bf16 a[24:27], v[96:99], a[216:219], a[24:27]
ds_read_b64_tr_b16 a[216:217], v221 offset:57344
v_cvt_pk_bf16_f32 v77, v50, v51
v_mfma_f32_16x16x32_bf16 a[24:27], v[112:115], a[180:183], a[24:27]
v_exp_f32 v52, v52
v_mfma_f32_16x16x32_bf16 a[40:43], v[112:115], a[184:187], a[40:43]
ds_read_b64_tr_b16 a[218:219], v221 offset:61440
v_mfma_f32_16x16x32_bf16 a[40:43], v[96:99], a[220:223], a[40:43]
v_exp_f32 v53, v53
v_mfma_f32_16x16x32_bf16 a[44:47], v[100:103], a[220:223], a[44:47]
ds_read_b64_tr_b16 a[220:221], v222 offset:57344
v_cvt_pk_bf16_f32 v78, v52, v53
v_mfma_f32_16x16x32_bf16 a[44:47], v[116:119], a[184:187], a[44:47]
v_exp_f32 v54, v54
v_mfma_f32_16x16x32_bf16 a[60:63], v[116:119], a[188:191], a[60:63]
ds_read_b64_tr_b16 a[222:223], v222 offset:61440
v_mfma_f32_16x16x32_bf16 a[60:63], v[100:103], a[224:227], a[60:63]
v_exp_f32 v55, v55
v_mfma_f32_16x16x32_bf16 a[56:59], v[96:99], a[224:227], a[56:59]
ds_read_b64_tr_b16 a[224:225], v223 offset:57344
v_cvt_pk_bf16_f32 v79, v54, v55
v_mfma_f32_16x16x32_bf16 a[56:59], v[112:115], a[188:191], a[56:59]
v_exp_f32 v56, v56
v_smfmac_f32_16x16x64_bf16 a[128:131], a[208:211], v[104:111], v245
v_exp_f32 v57, v57
v_mfma_f32_16x16x32_bf16 v[12:15], a[160:163], v[152:155], v[136:139]
ds_read_b64_tr_b16 a[226:227], v223 offset:61440
v_cvt_pk_bf16_f32 v80, v56, v57
v_mfma_f32_16x16x32_bf16 v[12:15], a[164:167], v[156:159], v[12:15]
v_exp_f32 v58, v58
v_mfma_f32_16x16x32_bf16 v[12:15], a[168:171], v[160:163], v[12:15]
buffer_load_dwordx4 v232, s[12:15], s39 offen offset:0  lds
v_mfma_f32_16x16x32_bf16 v[12:15], a[172:175], v[164:167], v[12:15]
STUB_4:
s_cbranch_execz STUB_7
v_exp_f32 v59, v59
v_mfma_f32_16x16x32_bf16 v[20:23], a[172:175], v[180:183], v[140:143]
v_cvt_pk_bf16_f32 v81, v58, v59
v_mfma_f32_16x16x32_bf16 v[20:23], a[168:171], v[176:179], v[20:23]
v_exp_f32 v60, v60
v_mfma_f32_16x16x32_bf16 v[20:23], a[164:167], v[172:175], v[20:23]
buffer_load_dwordx4 v233, s[12:15], s39 offen offset:1024  lds
v_mfma_f32_16x16x32_bf16 v[20:23], a[160:163], v[168:171], v[20:23]
v_exp_f32 v61, v61
v_mfma_f32_16x16x32_bf16 v[28:31], a[160:163], v[184:187], v[144:147]
v_cvt_pk_bf16_f32 v82, v60, v61
v_mfma_f32_16x16x32_bf16 v[28:31], a[164:167], v[188:191], v[28:31]
v_exp_f32 v62, v62
v_mfma_f32_16x16x32_bf16 v[28:31], a[168:171], v[192:195], v[28:31]
buffer_load_dwordx4 v232, s[12:15], s39 offen offset:2048  lds
v_mfma_f32_16x16x32_bf16 v[28:31], a[172:175], v[196:199], v[28:31]
v_exp_f32 v63, v63
v_mfma_f32_16x16x32_bf16 v[36:39], a[172:175], v[212:215], v[148:151]
ds_read_b128 a[172:175], v219 offset:12288
v_cvt_pk_bf16_f32 v83, v62, v63
v_mfma_f32_16x16x32_bf16 v[36:39], a[168:171], v[208:211], v[36:39]
v_exp_f32 v64, v64
v_mfma_f32_16x16x32_bf16 v[36:39], a[164:167], v[204:207], v[36:39]
ds_read_b128 a[168:171], v218 offset:12288
ds_read_b128 a[164:167], v217 offset:12288
v_mfma_f32_16x16x32_bf16 v[36:39], a[160:163], v[200:203], v[36:39]
v_exp_f32 v65, v65
s_waitcnt lgkmcnt(8)
v_mfma_f32_16x16x32_bf16 a[72:75], v[112:115], a[192:195], a[72:75]
ds_read_b128 a[160:163], v216 offset:12288
v_cvt_pk_bf16_f32 v84, v64, v65
v_mfma_f32_16x16x32_bf16 a[72:75], v[96:99], a[228:231], a[72:75]
v_exp_f32 v66, v66
v_mfma_f32_16x16x32_bf16 a[76:79], v[100:103], a[228:231], a[76:79]
ds_read_b64_tr_b16 a[228:229], v224 offset:57344
ds_read_b64_tr_b16 a[230:231], v224 offset:61440
v_mfma_f32_16x16x32_bf16 a[76:79], v[116:119], a[192:195], a[76:79]
v_exp_f32 v67, v67
v_mfma_f32_16x16x32_bf16 a[92:95], v[116:119], a[196:199], a[92:95]
v_cvt_pk_bf16_f32 v85, v66, v67
v_mfma_f32_16x16x32_bf16 a[92:95], v[100:103], a[232:235], a[92:95]
v_exp_f32 v68, v68
v_mfma_f32_16x16x32_bf16 a[88:91], v[96:99], a[232:235], a[88:91]
ds_read_b64_tr_b16 a[232:233], v225 offset:57344
ds_read_b64_tr_b16 a[234:235], v225 offset:61440
v_mfma_f32_16x16x32_bf16 a[88:91], v[112:115], a[196:199], a[88:91]
v_exp_f32 v69, v69
v_mfma_f32_16x16x32_bf16 a[104:107], v[112:115], a[200:203], a[104:107]
v_cvt_pk_bf16_f32 v86, v68, v69
v_mfma_f32_16x16x32_bf16 a[104:107], v[96:99], a[236:239], a[104:107]
v_exp_f32 v70, v70
v_mfma_f32_16x16x32_bf16 a[108:111], v[100:103], a[236:239], a[108:111]
ds_read_b64_tr_b16 a[236:237], v226 offset:57344
ds_read_b64_tr_b16 a[238:239], v226 offset:61440
v_mfma_f32_16x16x32_bf16 a[108:111], v[116:119], a[200:203], a[108:111]
v_exp_f32 v71, v71
v_mfma_f32_16x16x32_bf16 a[124:127], v[116:119], a[204:207], a[124:127]
v_cvt_pk_bf16_f32 v87, v70, v71
v_mfma_f32_16x16x32_bf16 a[124:127], v[100:103], a[240:243], a[124:127]
buffer_load_dwordx4 v233, s[12:15], s39 offen offset:3072  lds
v_mfma_f32_16x16x32_bf16 a[120:123], v[96:99], a[240:243], a[120:123]
ds_read_b64_tr_b16 a[240:241], v227 offset:57344
ds_read_b64_tr_b16 a[242:243], v227 offset:61440
v_mfma_f32_16x16x32_bf16 a[120:123], v[112:115], a[204:207], a[120:123]
s_add_u32 m0, s86, 8192
s_add_u32 s50, s84, 1179648
buffer_load_dwordx4 v240, s[64:67], s50 offen lds
v_smfmac_f32_16x16x64_bf16 a[132:135], a[208:211], v[112:119], v245
s_add_u32 m0, s86, 12288
s_add_u32 s50, s84, 1769472
buffer_load_dwordx4 v240, s[64:67], s50 offen lds
s_mov_b32 s33, 9
s_cmp_lt_u32 s86, 0x10000
s_cbranch_scc0 K_LOOPIN
v_mfma_f32_16x16x32_bf16 v[40:43], a[144:147], v[152:155], v[136:139]
v_exp_f32 v8, v8
v_mfma_f32_16x16x32_bf16 v[40:43], a[148:151], v[156:159], v[40:43]
v_bfe_u32 v246, v1, 2, 2
v_lshl_add_u32 v241, v4, 3, v246
v_mfma_f32_16x16x32_bf16 v[40:43], a[152:155], v[160:163], v[40:43]
v_exp_f32 v9, v9
v_mfma_f32_16x16x32_bf16 v[40:43], a[156:159], v[164:167], v[40:43]
v_cvt_pk_bf16_f32 v88, v8, v9
v_lshl_add_u32 v246, v4, 2, v246
v_mfma_f32_16x16x32_bf16 v[48:51], a[156:159], v[180:183], v[140:143]
v_exp_f32 v10, v10
v_mfma_f32_16x16x32_bf16 v[48:51], a[152:155], v[176:179], v[48:51]
v_and_b32 v247, 3, v1
v_lshlrev_b32 v247, 3, v247
v_mfma_f32_16x16x32_bf16 v[48:51], a[148:151], v[172:175], v[48:51]
v_lshl_add_u32 v241, v241, 6, v247
v_mfma_f32_16x16x32_bf16 v[48:51], a[144:147], v[168:171], v[48:51]
v_exp_f32 v11, v11
v_mfma_f32_16x16x32_bf16 v[56:59], a[144:147], v[184:187], v[144:147]
s_and_b32 s28, s37, 1
v_cvt_pk_bf16_f32 v89, v10, v11
v_mfma_f32_16x16x32_bf16 v[56:59], a[148:151], v[188:191], v[56:59]
v_exp_f32 v12, v12
v_mfma_f32_16x16x32_bf16 v[56:59], a[152:155], v[192:195], v[56:59]
s_lshl_b32 s28, s28, 5
s_lshr_b32 s29, s37, 1
v_mfma_f32_16x16x32_bf16 v[56:59], a[156:159], v[196:199], v[56:59]
s_lshl_b32 s29, s29, 15
s_add_u32 s28, s28, s29
v_mfma_f32_16x16x32_bf16 v[64:67], a[156:159], v[212:215], v[148:151]
s_waitcnt vmcnt(13) lgkmcnt(0)
s_barrier
v_mfma_f32_16x16x32_bf16 v[64:67], a[152:155], v[208:211], v[64:67]
v_exp_f32 v13, v13
v_mfma_f32_16x16x32_bf16 v[64:67], a[148:151], v[204:207], v[64:67]
v_exp_f32 v14, v14
v_mfma_f32_16x16x32_bf16 v[64:67], a[144:147], v[200:203], v[64:67]
ds_read_b128 a[156:159], v219 offset:16384
v_cvt_pk_bf16_f32 v90, v12, v13
v_mfma_f32_16x16x32_bf16 a[0:3], v[72:75], a[212:215], a[0:3]
ds_read_b128 a[152:155], v218 offset:16384
ds_read_b128 a[148:151], v217 offset:16384
v_mfma_f32_16x16x32_bf16 a[0:3], v[104:107], a[176:179], a[0:3]
v_exp_f32 v15, v15
v_mfma_f32_16x16x32_bf16 a[4:7], v[108:111], a[176:179], a[4:7]
ds_read_b128 a[144:147], v216 offset:16384
v_cvt_pk_bf16_f32 v91, v14, v15
v_mfma_f32_16x16x32_bf16 a[4:7], v[76:79], a[212:215], a[4:7]
v_exp_f32 v16, v16
v_mfma_f32_16x16x32_bf16 a[8:11], v[80:83], a[212:215], a[8:11]
ds_read_b64_tr_b16 a[176:177], v220 offset:0
ds_read_b64_tr_b16 a[178:179], v220 offset:4096
v_mfma_f32_16x16x32_bf16 a[12:15], v[84:87], a[212:215], a[12:15]
v_exp_f32 v17, v17
v_mfma_f32_16x16x32_bf16 a[28:31], v[84:87], a[216:219], a[28:31]
s_add_u32 s32, s32, 16384
v_cvt_pk_bf16_f32 v92, v16, v17
v_mfma_f32_16x16x32_bf16 a[24:27], v[80:83], a[216:219], a[24:27]
s_add_u32 m0, s30, 65536
v_add_u32 v241, s28, v241
v_mfma_f32_16x16x32_bf16 a[20:23], v[76:79], a[216:219], a[20:23]
v_exp_f32 v18, v18
v_mfma_f32_16x16x32_bf16 a[20:23], v[108:111], a[180:183], a[20:23]
v_mul_u32_u24 v242, 0x480, v246
v_add_u32 v242, v242, v247
v_mfma_f32_16x16x32_bf16 a[16:19], v[104:107], a[180:183], a[16:19]
v_exp_f32 v19, v19
v_mfma_f32_16x16x32_bf16 a[16:19], v[72:75], a[216:219], a[16:19]
ds_read_b64_tr_b16 a[180:181], v221 offset:0
v_cvt_pk_bf16_f32 v93, v18, v19
v_mfma_f32_16x16x32_bf16 a[32:35], v[72:75], a[220:223], a[32:35]
ds_read_b64_tr_b16 a[182:183], v221 offset:4096
s_mul_i32 s28, s37, 288
v_mfma_f32_16x16x32_bf16 a[32:35], v[104:107], a[184:187], a[32:35]
v_exp_f32 v20, v20
v_mfma_f32_16x16x32_bf16 a[36:39], v[108:111], a[184:187], a[36:39]
ds_read_b64_tr_b16 a[184:185], v222 offset:0
ds_read_b64_tr_b16 a[186:187], v222 offset:4096
v_mfma_f32_16x16x32_bf16 a[36:39], v[76:79], a[220:223], a[36:39]
v_exp_f32 v21, v21
v_mfma_f32_16x16x32_bf16 a[40:43], v[80:83], a[220:223], a[40:43]
s_add_u32 s28, s28, 8192
v_cvt_pk_bf16_f32 v94, v20, v21
v_mfma_f32_16x16x32_bf16 a[44:47], v[84:87], a[220:223], a[44:47]
buffer_load_dwordx4 v228, s[8:11], s32 offen offset:0  lds
v_mfma_f32_16x16x32_bf16 a[60:63], v[84:87], a[224:227], a[60:63]
v_exp_f32 v22, v22
v_mfma_f32_16x16x32_bf16 a[56:59], v[80:83], a[224:227], a[56:59]
v_add_u32 v242, s28, v242
v_mfma_f32_16x16x32_bf16 a[52:55], v[76:79], a[224:227], a[52:55]
v_exp_f32 v23, v23
v_mfma_f32_16x16x32_bf16 a[52:55], v[108:111], a[188:191], a[52:55]
v_cvt_pk_bf16_f32 v95, v22, v23
v_mfma_f32_16x16x32_bf16 a[48:51], v[104:107], a[188:191], a[48:51]
ds_read_b64_tr_b16 a[188:189], v223 offset:0
ds_read_b64_tr_b16 a[190:191], v223 offset:4096
v_mfma_f32_16x16x32_bf16 a[48:51], v[72:75], a[224:227], a[48:51]
v_exp_f32 v24, v24
v_smfmac_f32_16x16x64_bf16 a[128:131], a[208:211], v[72:79], v245
buffer_load_dwordx4 v229, s[8:11], s32 offen offset:1024  lds
v_mfma_f32_16x16x32_bf16 v[44:47], a[160:163], v[152:155], v[136:139]
v_exp_f32 v25, v25
v_mfma_f32_16x16x32_bf16 v[44:47], a[164:167], v[156:159], v[44:47]
v_cvt_pk_bf16_f32 v96, v24, v25
v_mfma_f32_16x16x32_bf16 v[44:47], a[168:171], v[160:163], v[44:47]
v_exp_f32 v26, v26
v_mfma_f32_16x16x32_bf16 v[44:47], a[172:175], v[164:167], v[44:47]
v_mfma_f32_16x16x32_bf16 v[52:55], a[172:175], v[180:183], v[140:143]
buffer_load_dwordx4 v230, s[8:11], s32 offen offset:2048  lds
v_mfma_f32_16x16x32_bf16 v[52:55], a[168:171], v[176:179], v[52:55]
v_exp_f32 v27, v27
v_mfma_f32_16x16x32_bf16 v[52:55], a[164:167], v[172:175], v[52:55]
v_cvt_pk_bf16_f32 v97, v26, v27
v_mfma_f32_16x16x32_bf16 v[52:55], a[160:163], v[168:171], v[52:55]
v_exp_f32 v28, v28
v_mfma_f32_16x16x32_bf16 v[60:63], a[160:163], v[184:187], v[144:147]
v_mfma_f32_16x16x32_bf16 v[60:63], a[164:167], v[188:191], v[60:63]
v_mfma_f32_16x16x32_bf16 v[60:63], a[168:171], v[192:195], v[60:63]
v_exp_f32 v29, v29
v_mfma_f32_16x16x32_bf16 v[60:63], a[172:175], v[196:199], v[60:63]
v_cvt_pk_bf16_f32 v98, v28, v29
v_mfma_f32_16x16x32_bf16 v[68:71], a[172:175], v[212:215], v[148:151]
v_exp_f32 v30, v30
v_mfma_f32_16x16x32_bf16 v[68:71], a[168:171], v[208:211], v[68:71]
ds_read_b128 a[172:175], v219 offset:20480
ds_read_b128 a[168:171], v218 offset:20480
v_mfma_f32_16x16x32_bf16 v[68:71], a[164:167], v[204:207], v[68:71]
ds_read_b128 a[164:167], v217 offset:20480
v_mfma_f32_16x16x32_bf16 v[68:71], a[160:163], v[200:203], v[68:71]
v_exp_f32 v31, v31
v_mfma_f32_16x16x32_bf16 a[64:67], v[72:75], a[228:231], a[64:67]
ds_read_b128 a[160:163], v216 offset:20480
v_cvt_pk_bf16_f32 v99, v30, v31
v_mfma_f32_16x16x32_bf16 a[64:67], v[104:107], a[192:195], a[64:67]
v_exp_f32 v32, v32
v_mfma_f32_16x16x32_bf16 a[68:71], v[108:111], a[192:195], a[68:71]
ds_read_b64_tr_b16 a[192:193], v224 offset:0
ds_read_b64_tr_b16 a[194:195], v224 offset:4096
v_mfma_f32_16x16x32_bf16 a[68:71], v[76:79], a[228:231], a[68:71]
v_exp_f32 v33, v33
v_mfma_f32_16x16x32_bf16 a[72:75], v[80:83], a[228:231], a[72:75]
v_cvt_pk_bf16_f32 v100, v32, v33
v_mfma_f32_16x16x32_bf16 a[76:79], v[84:87], a[228:231], a[76:79]
buffer_load_dwordx4 v231, s[8:11], s32 offen offset:3072  lds
v_mfma_f32_16x16x32_bf16 a[92:95], v[84:87], a[232:235], a[92:95]
v_exp_f32 v34, v34
v_mfma_f32_16x16x32_bf16 a[88:91], v[80:83], a[232:235], a[88:91]
s_add_u32 m0, s86, 16384
s_add_u32 s50, s84, 2359296
buffer_load_dwordx4 v240, s[64:67], s50 offen lds
v_mfma_f32_16x16x32_bf16 a[84:87], v[76:79], a[232:235], a[84:87]
v_exp_f32 v35, v35
v_mfma_f32_16x16x32_bf16 a[84:87], v[108:111], a[196:199], a[84:87]
v_cvt_pk_bf16_f32 v101, v34, v35
v_mfma_f32_16x16x32_bf16 a[80:83], v[104:107], a[196:199], a[80:83]
ds_read_b64_tr_b16 a[196:197], v225 offset:0
ds_read_b64_tr_b16 a[198:199], v225 offset:4096
v_mfma_f32_16x16x32_bf16 a[80:83], v[72:75], a[232:235], a[80:83]
v_exp_f32 v36, v36
v_mfma_f32_16x16x32_bf16 a[96:99], v[72:75], a[236:239], a[96:99]
s_add_u32 m0, s86, 20480
s_add_u32 s50, s84, 2949120
buffer_load_dwordx4 v240, s[64:67], s50 offen lds
v_mfma_f32_16x16x32_bf16 a[96:99], v[104:107], a[200:203], a[96:99]
v_exp_f32 v37, v37
v_mfma_f32_16x16x32_bf16 a[100:103], v[108:111], a[200:203], a[100:103]
ds_read_b64_tr_b16 a[200:201], v226 offset:0
v_cvt_pk_bf16_f32 v102, v36, v37
v_mfma_f32_16x16x32_bf16 a[100:103], v[76:79], a[236:239], a[100:103]
ds_read_b64_tr_b16 a[202:203], v226 offset:4096
v_mfma_f32_16x16x32_bf16 a[104:107], v[80:83], a[236:239], a[104:107]
v_exp_f32 v38, v38
v_mfma_f32_16x16x32_bf16 a[108:111], v[84:87], a[236:239], a[108:111]
v_mfma_f32_16x16x32_bf16 a[124:127], v[84:87], a[240:243], a[124:127]
v_exp_f32 v39, v39
v_mfma_f32_16x16x32_bf16 a[120:123], v[80:83], a[240:243], a[120:123]
v_cvt_pk_bf16_f32 v103, v38, v39
v_mfma_f32_16x16x32_bf16 a[116:119], v[76:79], a[240:243], a[116:119]
v_mfma_f32_16x16x32_bf16 a[116:119], v[108:111], a[204:207], a[116:119]
v_mfma_f32_16x16x32_bf16 a[112:115], v[104:107], a[204:207], a[112:115]
ds_read_b64_tr_b16 a[204:205], v227 offset:0
ds_read_b64_tr_b16 a[206:207], v227 offset:4096
v_mfma_f32_16x16x32_bf16 a[112:115], v[72:75], a[240:243], a[112:115]
v_smfmac_f32_16x16x64_bf16 a[132:135], a[208:211], v[80:87], v245
s_waitcnt lgkmcnt(8)
v_mfma_f32_16x16x32_bf16 v[8:11], a[144:147], v[152:155], v[136:139]
v_exp_f32 v40, v40
v_mfma_f32_16x16x32_bf16 v[8:11], a[148:151], v[156:159], v[8:11]
v_exp_f32 v41, v41
v_mfma_f32_16x16x32_bf16 v[8:11], a[152:155], v[160:163], v[8:11]
v_cvt_pk_bf16_f32 v72, v40, v41
v_mfma_f32_16x16x32_bf16 v[8:11], a[156:159], v[164:167], v[8:11]
v_exp_f32 v42, v42
v_mfma_f32_16x16x32_bf16 v[16:19], a[156:159], v[180:183], v[140:143]
s_add_u32 s39, s39, 16384
v_mfma_f32_16x16x32_bf16 v[16:19], a[152:155], v[176:179], v[16:19]
v_exp_f32 v43, v43
v_mfma_f32_16x16x32_bf16 v[16:19], a[148:151], v[172:175], v[16:19]
v_cvt_pk_bf16_f32 v73, v42, v43
v_mfma_f32_16x16x32_bf16 v[16:19], a[144:147], v[168:171], v[16:19]
v_exp_f32 v44, v44
v_mfma_f32_16x16x32_bf16 v[24:27], a[144:147], v[184:187], v[144:147]
v_mfma_f32_16x16x32_bf16 v[24:27], a[148:151], v[188:191], v[24:27]
v_exp_f32 v45, v45
v_mfma_f32_16x16x32_bf16 v[24:27], a[152:155], v[192:195], v[24:27]
s_add_u32 m0, s30, 147456
v_cvt_pk_bf16_f32 v74, v44, v45
v_mfma_f32_16x16x32_bf16 v[24:27], a[156:159], v[196:199], v[24:27]
v_exp_f32 v46, v46
v_mfma_f32_16x16x32_bf16 v[32:35], a[156:159], v[212:215], v[148:151]
ds_read_b128 a[156:159], v219 offset:24576
v_mfma_f32_16x16x32_bf16 v[32:35], a[152:155], v[208:211], v[32:35]
v_exp_f32 v47, v47
v_mfma_f32_16x16x32_bf16 v[32:35], a[148:151], v[204:207], v[32:35]
ds_read_b128 a[152:155], v218 offset:24576
v_cvt_pk_bf16_f32 v75, v46, v47
v_mfma_f32_16x16x32_bf16 v[32:35], a[144:147], v[200:203], v[32:35]
v_exp_f32 v48, v48
v_mfma_f32_16x16x32_bf16 a[0:3], v[88:91], a[176:179], a[0:3]
ds_read_b128 a[148:151], v217 offset:24576
ds_read_b128 a[144:147], v216 offset:24576
v_mfma_f32_16x16x32_bf16 a[4:7], v[92:95], a[176:179], a[4:7]
v_exp_f32 v49, v49
v_mfma_f32_16x16x32_bf16 a[8:11], v[96:99], a[176:179], a[8:11]
v_cvt_pk_bf16_f32 v76, v48, v49
v_mfma_f32_16x16x32_bf16 a[12:15], v[100:103], a[176:179], a[12:15]
v_exp_f32 v50, v50
v_mfma_f32_16x16x32_bf16 a[28:31], v[100:103], a[180:183], a[28:31]
ds_read_b64_tr_b16 a[176:177], v220 offset:8192
ds_read_b64_tr_b16 a[178:179], v220 offset:12288
v_mfma_f32_16x16x32_bf16 a[24:27], v[96:99], a[180:183], a[24:27]
v_exp_f32 v51, v51
v_mfma_f32_16x16x32_bf16 a[20:23], v[92:95], a[180:183], a[20:23]
v_cvt_pk_bf16_f32 v77, v50, v51
v_mfma_f32_16x16x32_bf16 a[16:19], v[88:91], a[180:183], a[16:19]
v_exp_f32 v52, v52
v_mfma_f32_16x16x32_bf16 a[32:35], v[88:91], a[184:187], a[32:35]
ds_read_b64_tr_b16 a[180:181], v221 offset:8192
ds_read_b64_tr_b16 a[182:183], v221 offset:12288
v_mfma_f32_16x16x32_bf16 a[36:39], v[92:95], a[184:187], a[36:39]
v_exp_f32 v53, v53
v_mfma_f32_16x16x32_bf16 a[40:43], v[96:99], a[184:187], a[40:43]
v_cvt_pk_bf16_f32 v78, v52, v53
v_mfma_f32_16x16x32_bf16 a[44:47], v[100:103], a[184:187], a[44:47]
v_exp_f32 v54, v54
v_mfma_f32_16x16x32_bf16 a[60:63], v[100:103], a[188:191], a[60:63]
ds_read_b64_tr_b16 a[184:185], v222 offset:8192
ds_read_b64_tr_b16 a[186:187], v222 offset:12288
v_mfma_f32_16x16x32_bf16 a[56:59], v[96:99], a[188:191], a[56:59]
v_exp_f32 v55, v55
v_mfma_f32_16x16x32_bf16 a[52:55], v[92:95], a[188:191], a[52:55]
v_cvt_pk_bf16_f32 v79, v54, v55
v_mfma_f32_16x16x32_bf16 a[48:51], v[88:91], a[188:191], a[48:51]
v_exp_f32 v56, v56
v_smfmac_f32_16x16x64_bf16 a[128:131], a[208:211], v[88:95], v245
v_exp_f32 v57, v57
v_mfma_f32_16x16x32_bf16 v[12:15], a[160:163], v[152:155], v[136:139]
ds_read_b64_tr_b16 a[188:189], v223 offset:8192
v_cvt_pk_bf16_f32 v80, v56, v57
v_mfma_f32_16x16x32_bf16 v[12:15], a[164:167], v[156:159], v[12:15]
v_exp_f32 v58, v58
v_mfma_f32_16x16x32_bf16 v[12:15], a[168:171], v[160:163], v[12:15]
ds_read_b64_tr_b16 a[190:191], v223 offset:12288
v_mfma_f32_16x16x32_bf16 v[12:15], a[172:175], v[164:167], v[12:15]
v_exp_f32 v59, v59
v_mfma_f32_16x16x32_bf16 v[20:23], a[172:175], v[180:183], v[140:143]
v_cvt_pk_bf16_f32 v81, v58, v59
v_mfma_f32_16x16x32_bf16 v[20:23], a[168:171], v[176:179], v[20:23]
v_exp_f32 v60, v60
v_mfma_f32_16x16x32_bf16 v[20:23], a[164:167], v[172:175], v[20:23]
buffer_load_dwordx4 v232, s[12:15], s39 offen offset:0  lds
v_mfma_f32_16x16x32_bf16 v[20:23], a[160:163], v[168:171], v[20:23]
v_exp_f32 v61, v61
v_mfma_f32_16x16x32_bf16 v[28:31], a[160:163], v[184:187], v[144:147]
v_cvt_pk_bf16_f32 v82, v60, v61
v_mfma_f32_16x16x32_bf16 v[28:31], a[164:167], v[188:191], v[28:31]
v_exp_f32 v62, v62
v_mfma_f32_16x16x32_bf16 v[28:31], a[168:171], v[192:195], v[28:31]
buffer_load_dwordx4 v233, s[12:15], s39 offen offset:1024  lds
v_mfma_f32_16x16x32_bf16 v[28:31], a[172:175], v[196:199], v[28:31]
v_exp_f32 v63, v63
v_mfma_f32_16x16x32_bf16 v[36:39], a[172:175], v[212:215], v[148:151]
ds_read_b128 a[172:175], v219 offset:28672
v_cvt_pk_bf16_f32 v83, v62, v63
v_mfma_f32_16x16x32_bf16 v[36:39], a[168:171], v[208:211], v[36:39]
v_exp_f32 v64, v64
v_mfma_f32_16x16x32_bf16 v[36:39], a[164:167], v[204:207], v[36:39]
ds_read_b128 a[168:171], v218 offset:28672
ds_read_b128 a[164:167], v217 offset:28672
v_mfma_f32_16x16x32_bf16 v[36:39], a[160:163], v[200:203], v[36:39]
v_exp_f32 v65, v65
s_waitcnt lgkmcnt(8)
v_mfma_f32_16x16x32_bf16 a[64:67], v[88:91], a[192:195], a[64:67]
ds_read_b128 a[160:163], v216 offset:28672
v_cvt_pk_bf16_f32 v84, v64, v65
v_mfma_f32_16x16x32_bf16 a[68:71], v[92:95], a[192:195], a[68:71]
v_exp_f32 v66, v66
v_mfma_f32_16x16x32_bf16 a[72:75], v[96:99], a[192:195], a[72:75]
buffer_load_dwordx4 v232, s[12:15], s39 offen offset:2048  lds
v_mfma_f32_16x16x32_bf16 a[76:79], v[100:103], a[192:195], a[76:79]
v_exp_f32 v67, v67
v_mfma_f32_16x16x32_bf16 a[92:95], v[100:103], a[196:199], a[92:95]
ds_read_b64_tr_b16 a[192:193], v224 offset:8192
v_cvt_pk_bf16_f32 v85, v66, v67
v_mfma_f32_16x16x32_bf16 a[88:91], v[96:99], a[196:199], a[88:91]
v_exp_f32 v68, v68
v_mfma_f32_16x16x32_bf16 a[84:87], v[92:95], a[196:199], a[84:87]
ds_read_b64_tr_b16 a[194:195], v224 offset:12288
v_mfma_f32_16x16x32_bf16 a[80:83], v[88:91], a[196:199], a[80:83]
v_exp_f32 v69, v69
v_mfma_f32_16x16x32_bf16 a[96:99], v[88:91], a[200:203], a[96:99]
ds_read_b64_tr_b16 a[196:197], v225 offset:8192
v_cvt_pk_bf16_f32 v86, v68, v69
v_mfma_f32_16x16x32_bf16 a[100:103], v[92:95], a[200:203], a[100:103]
v_exp_f32 v70, v70
v_mfma_f32_16x16x32_bf16 a[104:107], v[96:99], a[200:203], a[104:107]
ds_read_b64_tr_b16 a[198:199], v225 offset:12288
v_mfma_f32_16x16x32_bf16 a[108:111], v[100:103], a[200:203], a[108:111]
v_exp_f32 v71, v71
v_mfma_f32_16x16x32_bf16 a[124:127], v[100:103], a[204:207], a[124:127]
ds_read_b64_tr_b16 a[200:201], v226 offset:8192
v_cvt_pk_bf16_f32 v87, v70, v71
v_mfma_f32_16x16x32_bf16 a[120:123], v[96:99], a[204:207], a[120:123]
ds_read_b64_tr_b16 a[202:203], v226 offset:12288
v_mfma_f32_16x16x32_bf16 a[116:119], v[92:95], a[204:207], a[116:119]
buffer_load_dwordx4 v233, s[12:15], s39 offen offset:3072  lds
v_mfma_f32_16x16x32_bf16 a[112:115], v[88:91], a[204:207], a[112:115]
ds_read_b64_tr_b16 a[204:205], v227 offset:8192
ds_read_b64_tr_b16 a[206:207], v227 offset:12288
v_smfmac_f32_16x16x64_bf16 a[132:135], a[208:211], v[96:103], v245
s_add_u32 m0, s86, 24576
s_add_u32 s50, s84, 3538944
buffer_load_dwordx4 v240, s[64:67], s50 offen lds
s_add_u32 m0, s86, 28672
s_add_u32 s50, s84, 4128768
buffer_load_dwordx4 v240, s[64:67], s50 offen lds
v_mfma_f32_16x16x32_bf16 v[40:43], a[144:147], v[152:155], v[136:139]
v_exp_f32 v8, v8
v_mfma_f32_16x16x32_bf16 v[40:43], a[148:151], v[156:159], v[40:43]
v_exp_f32 v9, v9
v_mfma_f32_16x16x32_bf16 v[40:43], a[152:155], v[160:163], v[40:43]
v_cvt_pk_bf16_f32 v88, v8, v9
v_mfma_f32_16x16x32_bf16 v[40:43], a[156:159], v[164:167], v[40:43]
v_exp_f32 v10, v10
v_mfma_f32_16x16x32_bf16 v[48:51], a[156:159], v[180:183], v[140:143]
v_mfma_f32_16x16x32_bf16 v[48:51], a[152:155], v[176:179], v[48:51]
v_exp_f32 v11, v11
v_mfma_f32_16x16x32_bf16 v[48:51], a[148:151], v[172:175], v[48:51]
v_cvt_pk_bf16_f32 v89, v10, v11
v_mfma_f32_16x16x32_bf16 v[48:51], a[144:147], v[168:171], v[48:51]
v_exp_f32 v12, v12
v_mfma_f32_16x16x32_bf16 v[56:59], a[144:147], v[184:187], v[144:147]
v_mfma_f32_16x16x32_bf16 v[56:59], a[148:151], v[188:191], v[56:59]
v_exp_f32 v13, v13
v_mfma_f32_16x16x32_bf16 v[56:59], a[152:155], v[192:195], v[56:59]
v_cvt_pk_bf16_f32 v90, v12, v13
v_mfma_f32_16x16x32_bf16 v[56:59], a[156:159], v[196:199], v[56:59]
v_exp_f32 v14, v14
v_mfma_f32_16x16x32_bf16 v[64:67], a[156:159], v[212:215], v[148:151]
s_waitcnt vmcnt(12) lgkmcnt(0)
s_barrier
v_mfma_f32_16x16x32_bf16 v[64:67], a[152:155], v[208:211], v[64:67]
v_exp_f32 v15, v15
v_mfma_f32_16x16x32_bf16 v[64:67], a[148:151], v[204:207], v[64:67]
ds_read_b128 a[156:159], v219 offset:49152
v_cvt_pk_bf16_f32 v91, v14, v15
v_mfma_f32_16x16x32_bf16 v[64:67], a[144:147], v[200:203], v[64:67]
v_exp_f32 v16, v16
v_mfma_f32_16x16x32_bf16 a[0:3], v[72:75], a[176:179], a[0:3]
ds_read_b128 a[152:155], v218 offset:49152
ds_read_b128 a[148:151], v217 offset:49152
v_mfma_f32_16x16x32_bf16 a[4:7], v[76:79], a[176:179], a[4:7]
v_exp_f32 v17, v17
v_mfma_f32_16x16x32_bf16 a[8:11], v[80:83], a[176:179], a[8:11]
ds_read_b128 a[144:147], v216 offset:49152
v_cvt_pk_bf16_f32 v92, v16, v17
v_mfma_f32_16x16x32_bf16 a[12:15], v[84:87], a[176:179], a[12:15]
v_exp_f32 v18, v18
v_mfma_f32_16x16x32_bf16 a[28:31], v[84:87], a[180:183], a[28:31]
ds_read_b64_tr_b16 a[176:177], v220 offset:32768
ds_read_b64_tr_b16 a[178:179], v220 offset:36864
v_mfma_f32_16x16x32_bf16 a[24:27], v[80:83], a[180:183], a[24:27]
v_exp_f32 v19, v19
v_mfma_f32_16x16x32_bf16 a[20:23], v[76:79], a[180:183], a[20:23]
s_add_u32 s32, s32, 16384
v_cvt_pk_bf16_f32 v93, v18, v19
v_mfma_f32_16x16x32_bf16 a[16:19], v[72:75], a[180:183], a[16:19]
v_exp_f32 v20, v20
v_mfma_f32_16x16x32_bf16 a[32:35], v[72:75], a[184:187], a[32:35]
ds_read_b64_tr_b16 a[180:181], v221 offset:32768
ds_read_b64_tr_b16 a[182:183], v221 offset:36864
v_mfma_f32_16x16x32_bf16 a[36:39], v[76:79], a[184:187], a[36:39]
v_exp_f32 v21, v21
v_mfma_f32_16x16x32_bf16 a[40:43], v[80:83], a[184:187], a[40:43]
s_add_u32 m0, s30, 81920
v_cvt_pk_bf16_f32 v94, v20, v21
v_mfma_f32_16x16x32_bf16 a[44:47], v[84:87], a[184:187], a[44:47]
v_exp_f32 v22, v22
v_mfma_f32_16x16x32_bf16 a[60:63], v[84:87], a[188:191], a[60:63]
ds_read_b64_tr_b16 a[184:185], v222 offset:32768
ds_read_b64_tr_b16 a[186:187], v222 offset:36864
v_mfma_f32_16x16x32_bf16 a[56:59], v[80:83], a[188:191], a[56:59]
v_exp_f32 v23, v23
v_mfma_f32_16x16x32_bf16 a[52:55], v[76:79], a[188:191], a[52:55]
v_cvt_pk_bf16_f32 v95, v22, v23
v_mfma_f32_16x16x32_bf16 a[48:51], v[72:75], a[188:191], a[48:51]
v_exp_f32 v24, v24
v_smfmac_f32_16x16x64_bf16 a[128:131], a[208:211], v[72:79], v245
v_exp_f32 v25, v25
v_mfma_f32_16x16x32_bf16 v[44:47], a[160:163], v[152:155], v[136:139]
ds_read_b64_tr_b16 a[188:189], v223 offset:32768
v_cvt_pk_bf16_f32 v96, v24, v25
v_mfma_f32_16x16x32_bf16 v[44:47], a[164:167], v[156:159], v[44:47]
v_exp_f32 v26, v26
v_mfma_f32_16x16x32_bf16 v[44:47], a[168:171], v[160:163], v[44:47]
ds_read_b64_tr_b16 a[190:191], v223 offset:36864
v_mfma_f32_16x16x32_bf16 v[44:47], a[172:175], v[164:167], v[44:47]
v_exp_f32 v27, v27
v_mfma_f32_16x16x32_bf16 v[52:55], a[172:175], v[180:183], v[140:143]
v_cvt_pk_bf16_f32 v97, v26, v27
v_mfma_f32_16x16x32_bf16 v[52:55], a[168:171], v[176:179], v[52:55]
v_exp_f32 v28, v28
v_mfma_f32_16x16x32_bf16 v[52:55], a[164:167], v[172:175], v[52:55]
buffer_load_dwordx4 v228, s[8:11], s32 offen offset:0  lds
v_mfma_f32_16x16x32_bf16 v[52:55], a[160:163], v[168:171], v[52:55]
v_exp_f32 v29, v29
v_mfma_f32_16x16x32_bf16 v[60:63], a[160:163], v[184:187], v[144:147]
v_cmp_ne_u32 vcc, s47, v249
s_cbranch_vccnz SP_CAND
SP_CAND_RET:
v_cvt_pk_bf16_f32 v98, v28, v29
v_mfma_f32_16x16x32_bf16 v[60:63], a[164:167], v[188:191], v[60:63]
v_exp_f32 v30, v30
v_mfma_f32_16x16x32_bf16 v[60:63], a[168:171], v[192:195], v[60:63]
buffer_load_dwordx4 v229, s[8:11], s32 offen offset:1024  lds
v_mfma_f32_16x16x32_bf16 v[60:63], a[172:175], v[196:199], v[60:63]
v_exp_f32 v31, v31
v_mfma_f32_16x16x32_bf16 v[68:71], a[172:175], v[212:215], v[148:151]
ds_read_b128 a[172:175], v219 offset:53248
v_cvt_pk_bf16_f32 v99, v30, v31
v_mfma_f32_16x16x32_bf16 v[68:71], a[168:171], v[208:211], v[68:71]
v_exp_f32 v32, v32
v_mfma_f32_16x16x32_bf16 v[68:71], a[164:167], v[204:207], v[68:71]
ds_read_b128 a[168:171], v218 offset:53248
ds_read_b128 a[164:167], v217 offset:53248
v_mfma_f32_16x16x32_bf16 v[68:71], a[160:163], v[200:203], v[68:71]
v_mov_b32 v251, 0
v_exp_f32 v33, v33
v_mfma_f32_16x16x32_bf16 a[64:67], v[72:75], a[192:195], a[64:67]
ds_read_b128 a[160:163], v216 offset:53248
v_cvt_pk_bf16_f32 v100, v32, v33
v_mfma_f32_16x16x32_bf16 a[68:71], v[76:79], a[192:195], a[68:71]
v_exp_f32 v34, v34
v_mfma_f32_16x16x32_bf16 a[72:75], v[80:83], a[192:195], a[72:75]
buffer_load_dwordx4 v230, s[8:11], s32 offen offset:2048  lds
v_mfma_f32_16x16x32_bf16 a[76:79], v[84:87], a[192:195], a[76:79]
v_exp_f32 v35, v35
v_mfma_f32_16x16x32_bf16 a[92:95], v[84:87], a[196:199], a[92:95]
ds_read_b64_tr_b16 a[192:193], v224 offset:32768
v_cvt_pk_bf16_f32 v101, v34, v35
v_mfma_f32_16x16x32_bf16 a[88:91], v[80:83], a[196:199], a[88:91]
v_exp_f32 v36, v36
v_mfma_f32_16x16x32_bf16 a[84:87], v[76:79], a[196:199], a[84:87]
ds_read_b64_tr_b16 a[194:195], v224 offset:36864
s_mov_b32 s90, 0x01010101
s_mov_b32 s91, 0x01010101
v_mfma_f32_16x16x32_bf16 a[80:83], v[72:75], a[196:199], a[80:83]
v_exp_f32 v37, v37
v_mfma_f32_16x16x32_bf16 a[96:99], v[72:75], a[200:203], a[96:99]
ds_read_b64_tr_b16 a[196:197], v225 offset:32768
v_cvt_pk_bf16_f32 v102, v36, v37
v_mfma_f32_16x16x32_bf16 a[100:103], v[76:79], a[200:203], a[100:103]
v_exp_f32 v38, v38
v_mfma_f32_16x16x32_bf16 a[104:107], v[80:83], a[200:203], a[104:107]
ds_read_b64_tr_b16 a[198:199], v225 offset:36864
v_max_u32_dpp v250, v248, v248 row_ror:8 row_mask:0xf bank_mask:0xf
v_mfma_f32_16x16x32_bf16 a[108:111], v[84:87], a[200:203], a[108:111]
v_exp_f32 v39, v39
v_mfma_f32_16x16x32_bf16 a[124:127], v[84:87], a[204:207], a[124:127]
ds_read_b64_tr_b16 a[200:201], v226 offset:32768
v_cvt_pk_bf16_f32 v103, v38, v39
v_mfma_f32_16x16x32_bf16 a[120:123], v[80:83], a[204:207], a[120:123]
ds_read_b64_tr_b16 a[202:203], v226 offset:36864
v_max_u32_dpp v249, v250, v250 row_ror:4 row_mask:0xf bank_mask:0xf
v_mfma_f32_16x16x32_bf16 a[116:119], v[76:79], a[204:207], a[116:119]
buffer_load_dwordx4 v231, s[8:11], s32 offen offset:3072  lds
v_mfma_f32_16x16x32_bf16 a[112:115], v[72:75], a[204:207], a[112:115]
ds_read_b64_tr_b16 a[204:205], v227 offset:32768
ds_read_b64_tr_b16 a[206:207], v227 offset:36864
v_smfmac_f32_16x16x64_bf16 a[132:135], a[208:211], v[80:87], v245
s_add_u32 m0, s86, 32768
s_add_u32 s50, s84, 0
buffer_load_dwordx4 v240, s[68:71], s50 offen lds
s_add_u32 m0, s86, 36864
s_add_u32 s50, s84, 589824
buffer_load_dwordx4 v240, s[68:71], s50 offen lds
s_waitcnt lgkmcnt(8)
v_mfma_f32_16x16x32_bf16 v[8:11], a[144:147], v[152:155], v[136:139]
v_exp_f32 v40, v40
v_mfma_f32_16x16x32_bf16 v[8:11], a[148:151], v[156:159], v[8:11]
v_exp_f32 v41, v41
v_mfma_f32_16x16x32_bf16 v[8:11], a[152:155], v[160:163], v[8:11]
v_cvt_pk_bf16_f32 v72, v40, v41
v_max_u32_dpp v250, v249, v249 row_ror:2 row_mask:0xf bank_mask:0xf
v_mfma_f32_16x16x32_bf16 v[8:11], a[156:159], v[164:167], v[8:11]
STUB_5:
s_cbranch_execz STUB_8
v_exp_f32 v42, v42
v_mfma_f32_16x16x32_bf16 v[16:19], a[156:159], v[180:183], v[140:143]
s_add_u32 s39, s39, 16384
v_max_u32_dpp v249, v250, v250 row_ror:1 row_mask:0xf bank_mask:0xf
v_mfma_f32_16x16x32_bf16 v[16:19], a[152:155], v[176:179], v[16:19]
v_exp_f32 v43, v43
v_mfma_f32_16x16x32_bf16 v[16:19], a[148:151], v[172:175], v[16:19]
v_cvt_pk_bf16_f32 v73, v42, v43
v_mov_b32 v250, v249
v_mfma_f32_16x16x32_bf16 v[16:19], a[144:147], v[168:171], v[16:19]
v_exp_f32 v44, v44
v_mfma_f32_16x16x32_bf16 v[24:27], a[144:147], v[184:187], v[144:147]
v_permlane16_swap_b32 v249, v250
v_max_u32 v249, v249, v250
v_mfma_f32_16x16x32_bf16 v[24:27], a[148:151], v[188:191], v[24:27]
v_exp_f32 v45, v45
v_mfma_f32_16x16x32_bf16 v[24:27], a[152:155], v[192:195], v[24:27]
s_add_u32 m0, s30, 98304
v_cvt_pk_bf16_f32 v74, v44, v45
v_mfma_f32_16x16x32_bf16 v[24:27], a[156:159], v[196:199], v[24:27]
v_exp_f32 v46, v46
v_mfma_f32_16x16x32_bf16 v[32:35], a[156:159], v[212:215], v[148:151]
ds_read_b128 a[156:159], v219 offset:57344
v_mov_b32 v250, v249
v_mfma_f32_16x16x32_bf16 v[32:35], a[152:155], v[208:211], v[32:35]
v_exp_f32 v47, v47
v_mfma_f32_16x16x32_bf16 v[32:35], a[148:151], v[204:207], v[32:35]
ds_read_b128 a[152:155], v218 offset:57344
v_cvt_pk_bf16_f32 v75, v46, v47
v_mfma_f32_16x16x32_bf16 v[32:35], a[144:147], v[200:203], v[32:35]
v_exp_f32 v48, v48
v_mfma_f32_16x16x32_bf16 a[0:3], v[88:91], a[176:179], a[0:3]
ds_read_b128 a[148:151], v217 offset:57344
ds_read_b128 a[144:147], v216 offset:57344
v_mfma_f32_16x16x32_bf16 a[4:7], v[92:95], a[176:179], a[4:7]
v_exp_f32 v49, v49
v_mfma_f32_16x16x32_bf16 a[8:11], v[96:99], a[176:179], a[8:11]
v_cvt_pk_bf16_f32 v76, v48, v49
v_permlane32_swap_b32 v249, v250
v_mfma_f32_16x16x32_bf16 a[12:15], v[100:103], a[176:179], a[12:15]
v_exp_f32 v50, v50
v_mfma_f32_16x16x32_bf16 a[28:31], v[100:103], a[180:183], a[28:31]
ds_read_b64_tr_b16 a[176:177], v220 offset:40960
ds_read_b64_tr_b16 a[178:179], v220 offset:45056
v_mfma_f32_16x16x32_bf16 a[24:27], v[96:99], a[180:183], a[24:27]
v_exp_f32 v51, v51
v_mfma_f32_16x16x32_bf16 a[20:23], v[92:95], a[180:183], a[20:23]
v_cvt_pk_bf16_f32 v77, v50, v51
v_max_u32 v249, v249, v250
v_mfma_f32_16x16x32_bf16 a[16:19], v[88:91], a[180:183], a[16:19]
v_exp_f32 v52, v52
v_mfma_f32_16x16x32_bf16 a[32:35], v[88:91], a[184:187], a[32:35]
ds_read_b64_tr_b16 a[180:181], v221 offset:40960
ds_read_b64_tr_b16 a[182:183], v221 offset:45056
v_mfma_f32_16x16x32_bf16 a[36:39], v[92:95], a[184:187], a[36:39]
v_exp_f32 v53, v53
v_mfma_f32_16x16x32_bf16 a[40:43], v[96:99], a[184:187], a[40:43]
v_cvt_pk_bf16_f32 v78, v52, v53
v_add_u32 v251, v251, v249
v_mfma_f32_16x16x32_bf16 a[44:47], v[100:103], a[184:187], a[44:47]
v_exp_f32 v54, v54
v_mfma_f32_16x16x32_bf16 a[60:63], v[100:103], a[188:191], a[60:63]
ds_read_b64_tr_b16 a[184:185], v222 offset:40960
ds_read_b64_tr_b16 a[186:187], v222 offset:45056
v_mfma_f32_16x16x32_bf16 a[56:59], v[96:99], a[188:191], a[56:59]
v_exp_f32 v55, v55
v_mfma_f32_16x16x32_bf16 a[52:55], v[92:95], a[188:191], a[52:55]
v_cvt_pk_bf16_f32 v79, v54, v55
v_sub_u32 v248, v248, v249
v_mfma_f32_16x16x32_bf16 a[48:51], v[88:91], a[188:191], a[48:51]
v_exp_f32 v56, v56
v_smfmac_f32_16x16x64_bf16 a[128:131], a[208:211], v[88:95], v245
v_exp_f32 v57, v57
v_mfma_f32_16x16x32_bf16 v[12:15], a[160:163], v[152:155], v[136:139]
ds_read_b64_tr_b16 a[188:189], v223 offset:40960
v_cvt_pk_bf16_f32 v80, v56, v57
v_mfma_f32_16x16x32_bf16 v[12:15], a[164:167], v[156:159], v[12:15]
v_exp_f32 v58, v58
v_mfma_f32_16x16x32_bf16 v[12:15], a[168:171], v[160:163], v[12:15]
ds_read_b64_tr_b16 a[190:191], v223 offset:45056
v_cndmask_b32 v252, v252, v251, s[90:91]
v_mfma_f32_16x16x32_bf16 v[12:15], a[172:175], v[164:167], v[12:15]
v_exp_f32 v59, v59
v_mfma_f32_16x16x32_bf16 v[20:23], a[172:175], v[180:183], v[140:143]
s_lshl_b64 s[90:91], s[90:91], 1
v_cvt_pk_bf16_f32 v81, v58, v59
v_mfma_f32_16x16x32_bf16 v[20:23], a[168:171], v[176:179], v[20:23]
v_exp_f32 v60, v60
v_mfma_f32_16x16x32_bf16 v[20:23], a[164:167], v[172:175], v[20:23]
buffer_load_dwordx4 v232, s[12:15], s39 offen offset:0  lds
v_mfma_f32_16x16x32_bf16 v[20:23], a[160:163], v[168:171], v[20:23]
v_exp_f32 v61, v61
v_mfma_f32_16x16x32_bf16 v[28:31], a[160:163], v[184:187], v[144:147]
v_cvt_pk_bf16_f32 v82, v60, v61
v_max_u32_dpp v250, v248, v248 row_ror:8 row_mask:0xf bank_mask:0xf
v_mfma_f32_16x16x32_bf16 v[28:31], a[164:167], v[188:191], v[28:31]
v_exp_f32 v62, v62
v_mfma_f32_16x16x32_bf16 v[28:31], a[168:171], v[192:195], v[28:31]
buffer_load_dwordx4 v233, s[12:15], s39 offen offset:1024  lds
v_mfma_f32_16x16x32_bf16 v[28:31], a[172:175], v[196:199], v[28:31]
v_exp_f32 v63, v63
v_mfma_f32_16x16x32_bf16 v[36:39], a[172:175], v[212:215], v[148:151]
ds_read_b128 a[172:175], v219 offset:61440
v_cvt_pk_bf16_f32 v83, v62, v63
v_mfma_f32_16x16x32_bf16 v[36:39], a[168:171], v[208:211], v[36:39]
v_exp_f32 v64, v64
v_mfma_f32_16x16x32_bf16 v[36:39], a[164:167], v[204:207], v[36:39]
ds_read_b128 a[168:171], v218 offset:61440
ds_read_b128 a[164:167], v217 offset:61440
v_mfma_f32_16x16x32_bf16 v[36:39], a[160:163], v[200:203], v[36:39]
v_exp_f32 v65, v65
s_waitcnt lgkmcnt(8)
v_mfma_f32_16x16x32_bf16 a[64:67], v[88:91], a[192:195], a[64:67]
ds_read_b128 a[160:163], v216 offset:61440
v_cvt_pk_bf16_f32 v84, v64, v65
v_mfma_f32_16x16x32_bf16 a[68:71], v[92:95], a[192:195], a[68:71]
v_exp_f32 v66, v66
v_mfma_f32_16x16x32_bf16 a[72:75], v[96:99], a[192:195], a[72:75]
buffer_load_dwordx4 v232, s[12:15], s39 offen offset:2048  lds
v_mfma_f32_16x16x32_bf16 a[76:79], v[100:103], a[192:195], a[76:79]
v_exp_f32 v67, v67
v_mfma_f32_16x16x32_bf16 a[92:95], v[100:103], a[196:199], a[92:95]
ds_read_b64_tr_b16 a[192:193], v224 offset:40960
v_cvt_pk_bf16_f32 v85, v66, v67
v_mfma_f32_16x16x32_bf16 a[88:91], v[96:99], a[196:199], a[88:91]
v_exp_f32 v68, v68
v_mfma_f32_16x16x32_bf16 a[84:87], v[92:95], a[196:199], a[84:87]
ds_read_b64_tr_b16 a[194:195], v224 offset:45056
v_max_u32_dpp v249, v250, v250 row_ror:4 row_mask:0xf bank_mask:0xf
v_mfma_f32_16x16x32_bf16 a[80:83], v[88:91], a[196:199], a[80:83]
v_exp_f32 v69, v69
v_mfma_f32_16x16x32_bf16 a[96:99], v[88:91], a[200:203], a[96:99]
ds_read_b64_tr_b16 a[196:197], v225 offset:40960
v_cvt_pk_bf16_f32 v86, v68, v69
v_mfma_f32_16x16x32_bf16 a[100:103], v[92:95], a[200:203], a[100:103]
v_exp_f32 v70, v70
v_mfma_f32_16x16x32_bf16 a[104:107], v[96:99], a[200:203], a[104:107]
ds_read_b64_tr_b16 a[198:199], v225 offset:45056
v_max_u32_dpp v250, v249, v249 row_ror:2 row_mask:0xf bank_mask:0xf
v_mfma_f32_16x16x32_bf16 a[108:111], v[100:103], a[200:203], a[108:111]
v_exp_f32 v71, v71
v_mfma_f32_16x16x32_bf16 a[124:127], v[100:103], a[204:207], a[124:127]
ds_read_b64_tr_b16 a[200:201], v226 offset:40960
v_cvt_pk_bf16_f32 v87, v70, v71
v_mfma_f32_16x16x32_bf16 a[120:123], v[96:99], a[204:207], a[120:123]
ds_read_b64_tr_b16 a[202:203], v226 offset:45056
v_max_u32_dpp v249, v250, v250 row_ror:1 row_mask:0xf bank_mask:0xf
v_mfma_f32_16x16x32_bf16 a[116:119], v[92:95], a[204:207], a[116:119]
buffer_load_dwordx4 v233, s[12:15], s39 offen offset:3072  lds
v_mfma_f32_16x16x32_bf16 a[112:115], v[88:91], a[204:207], a[112:115]
ds_read_b64_tr_b16 a[204:205], v227 offset:40960
ds_read_b64_tr_b16 a[206:207], v227 offset:45056
v_smfmac_f32_16x16x64_bf16 a[132:135], a[208:211], v[96:103], v245
s_add_u32 m0, s86, 40960
s_add_u32 s50, s84, 1179648
buffer_load_dwordx4 v240, s[68:71], s50 offen lds
s_add_u32 m0, s86, 45056
s_add_u32 s50, s84, 1769472
buffer_load_dwordx4 v240, s[68:71], s50 offen lds
v_mfma_f32_16x16x32_bf16 v[40:43], a[144:147], v[152:155], v[136:139]
v_exp_f32 v8, v8
v_mfma_f32_16x16x32_bf16 v[40:43], a[148:151], v[156:159], v[40:43]
v_exp_f32 v9, v9
v_mfma_f32_16x16x32_bf16 v[40:43], a[152:155], v[160:163], v[40:43]
v_cvt_pk_bf16_f32 v88, v8, v9
v_lshlrev_b32 v246, 2, v1
v_mfma_f32_16x16x32_bf16 v[40:43], a[156:159], v[164:167], v[40:43]
v_exp_f32 v10, v10
v_mfma_f32_16x16x32_bf16 v[48:51], a[156:159], v[180:183], v[140:143]
v_mov_b32 v250, v249
v_mfma_f32_16x16x32_bf16 v[48:51], a[152:155], v[176:179], v[48:51]
v_exp_f32 v11, v11
v_mfma_f32_16x16x32_bf16 v[48:51], a[148:151], v[172:175], v[48:51]
v_cvt_pk_bf16_f32 v89, v10, v11
v_permlane16_swap_b32 v249, v250
v_mfma_f32_16x16x32_bf16 v[48:51], a[144:147], v[168:171], v[48:51]
v_exp_f32 v12, v12
v_mfma_f32_16x16x32_bf16 v[56:59], a[144:147], v[184:187], v[144:147]
v_max_u32 v249, v249, v250
v_mov_b32 v250, v249
v_mfma_f32_16x16x32_bf16 v[56:59], a[148:151], v[188:191], v[56:59]
v_exp_f32 v13, v13
v_mfma_f32_16x16x32_bf16 v[56:59], a[152:155], v[192:195], v[56:59]
v_cvt_pk_bf16_f32 v90, v12, v13
v_permlane32_swap_b32 v249, v250
v_mfma_f32_16x16x32_bf16 v[56:59], a[156:159], v[196:199], v[56:59]
v_exp_f32 v14, v14
v_mfma_f32_16x16x32_bf16 v[64:67], a[156:159], v[212:215], v[148:151]
s_waitcnt vmcnt(12) lgkmcnt(0)
s_barrier
v_mfma_f32_16x16x32_bf16 v[64:67], a[152:155], v[208:211], v[64:67]
v_exp_f32 v15, v15
v_mfma_f32_16x16x32_bf16 v[64:67], a[148:151], v[204:207], v[64:67]
ds_read_b128 a[156:159], v219 offset:0
v_cvt_pk_bf16_f32 v91, v14, v15
v_mfma_f32_16x16x32_bf16 v[64:67], a[144:147], v[200:203], v[64:67]
v_exp_f32 v16, v16
v_mfma_f32_16x16x32_bf16 a[0:3], v[72:75], a[176:179], a[0:3]
ds_read_b128 a[152:155], v218 offset:0
ds_read_b128 a[148:151], v217 offset:0
v_mfma_f32_16x16x32_bf16 a[4:7], v[76:79], a[176:179], a[4:7]
v_exp_f32 v17, v17
v_mfma_f32_16x16x32_bf16 a[8:11], v[80:83], a[176:179], a[8:11]
ds_read_b128 a[144:147], v216 offset:0
v_cvt_pk_bf16_f32 v92, v16, v17
v_mfma_f32_16x16x32_bf16 a[12:15], v[84:87], a[176:179], a[12:15]
v_exp_f32 v18, v18
v_mfma_f32_16x16x32_bf16 a[28:31], v[84:87], a[180:183], a[28:31]
ds_read_b64_tr_b16 a[176:177], v220 offset:49152
ds_read_b64_tr_b16 a[178:179], v220 offset:53248
v_mfma_f32_16x16x32_bf16 a[24:27], v[80:83], a[180:183], a[24:27]
v_exp_f32 v19, v19
v_mfma_f32_16x16x32_bf16 a[20:23], v[76:79], a[180:183], a[20:23]
s_add_u32 s32, s32, 16384
v_cvt_pk_bf16_f32 v93, v18, v19
v_mfma_f32_16x16x32_bf16 a[16:19], v[72:75], a[180:183], a[16:19]
v_exp_f32 v20, v20
v_mfma_f32_16x16x32_bf16 a[32:35], v[72:75], a[184:187], a[32:35]
ds_read_b64_tr_b16 a[180:181], v221 offset:49152
ds_read_b64_tr_b16 a[182:183], v221 offset:53248
v_mfma_f32_16x16x32_bf16 a[36:39], v[76:79], a[184:187], a[36:39]
v_exp_f32 v21, v21
v_mfma_f32_16x16x32_bf16 a[40:43], v[80:83], a[184:187], a[40:43]
s_add_u32 m0, s30, 114688
v_cvt_pk_bf16_f32 v94, v20, v21
v_mfma_f32_16x16x32_bf16 a[44:47], v[84:87], a[184:187], a[44:47]
v_exp_f32 v22, v22
v_mfma_f32_16x16x32_bf16 a[60:63], v[84:87], a[188:191], a[60:63]
ds_read_b64_tr_b16 a[184:185], v222 offset:49152
ds_read_b64_tr_b16 a[186:187], v222 offset:53248
v_mfma_f32_16x16x32_bf16 a[56:59], v[80:83], a[188:191], a[56:59]
v_exp_f32 v23, v23
v_mfma_f32_16x16x32_bf16 a[52:55], v[76:79], a[188:191], a[52:55]
v_cvt_pk_bf16_f32 v95, v22, v23
v_max_u32 v249, v249, v250
v_mfma_f32_16x16x32_bf16 a[48:51], v[72:75], a[188:191], a[48:51]
v_exp_f32 v24, v24
v_smfmac_f32_16x16x64_bf16 a[128:131], a[208:211], v[72:79], v245
v_exp_f32 v25, v25
v_mfma_f32_16x16x32_bf16 v[44:47], a[160:163], v[152:155], v[136:139]
ds_read_b64_tr_b16 a[188:189], v223 offset:49152
v_cvt_pk_bf16_f32 v96, v24, v25
v_mfma_f32_16x16x32_bf16 v[44:47], a[164:167], v[156:159], v[44:47]
v_exp_f32 v26, v26
v_mfma_f32_16x16x32_bf16 v[44:47], a[168:171], v[160:163], v[44:47]
ds_read_b64_tr_b16 a[190:191], v223 offset:53248
v_add_u32 v251, v251, v249
v_mfma_f32_16x16x32_bf16 v[44:47], a[172:175], v[164:167], v[44:47]
v_exp_f32 v27, v27
v_mfma_f32_16x16x32_bf16 v[52:55], a[172:175], v[180:183], v[140:143]
v_cvt_pk_bf16_f32 v97, v26, v27
v_sub_u32 v248, v248, v249
v_mfma_f32_16x16x32_bf16 v[52:55], a[168:171], v[176:179], v[52:55]
v_exp_f32 v28, v28
v_mfma_f32_16x16x32_bf16 v[52:55], a[164:167], v[172:175], v[52:55]
buffer_load_dwordx4 v228, s[8:11], s32 offen offset:0  lds
v_mfma_f32_16x16x32_bf16 v[52:55], a[160:163], v[168:171], v[52:55]
v_exp_f32 v29, v29
v_mfma_f32_16x16x32_bf16 v[60:63], a[160:163], v[184:187], v[144:147]
v_cvt_pk_bf16_f32 v98, v28, v29
v_cndmask_b32 v252, v252, v251, s[90:91]
v_mfma_f32_16x16x32_bf16 v[60:63], a[164:167], v[188:191], v[60:63]
v_exp_f32 v30, v30
v_mfma_f32_16x16x32_bf16 v[60:63], a[168:171], v[192:195], v[60:63]
buffer_load_dwordx4 v229, s[8:11], s32 offen offset:1024  lds
v_mfma_f32_16x16x32_bf16 v[60:63], a[172:175], v[196:199], v[60:63]
v_exp_f32 v31, v31
v_mfma_f32_16x16x32_bf16 v[68:71], a[172:175], v[212:215], v[148:151]
ds_read_b128 a[172:175], v219 offset:4096
v_cvt_pk_bf16_f32 v99, v30, v31
v_mfma_f32_16x16x32_bf16 v[68:71], a[168:171], v[208:211], v[68:71]
v_exp_f32 v32, v32
v_mfma_f32_16x16x32_bf16 v[68:71], a[164:167], v[204:207], v[68:71]
ds_read_b128 a[168:171], v218 offset:4096
ds_read_b128 a[164:167], v217 offset:4096
v_mfma_f32_16x16x32_bf16 v[68:71], a[160:163], v[200:203], v[68:71]
v_exp_f32 v33, v33
v_mfma_f32_16x16x32_bf16 a[64:67], v[72:75], a[192:195], a[64:67]
ds_read_b128 a[160:163], v216 offset:4096
v_cvt_pk_bf16_f32 v100, v32, v33
v_mfma_f32_16x16x32_bf16 a[68:71], v[76:79], a[192:195], a[68:71]
v_exp_f32 v34, v34
v_mfma_f32_16x16x32_bf16 a[72:75], v[80:83], a[192:195], a[72:75]
buffer_load_dwordx4 v230, s[8:11], s32 offen offset:2048  lds
v_mfma_f32_16x16x32_bf16 a[76:79], v[84:87], a[192:195], a[76:79]
s_lshl_b64 s[90:91], s[90:91], 1
v_exp_f32 v35, v35
v_mfma_f32_16x16x32_bf16 a[92:95], v[84:87], a[196:199], a[92:95]
ds_read_b64_tr_b16 a[192:193], v224 offset:49152
v_cvt_pk_bf16_f32 v101, v34, v35
v_mfma_f32_16x16x32_bf16 a[88:91], v[80:83], a[196:199], a[88:91]
v_exp_f32 v36, v36
v_mfma_f32_16x16x32_bf16 a[84:87], v[76:79], a[196:199], a[84:87]
ds_read_b64_tr_b16 a[194:195], v224 offset:53248
v_max_u32_dpp v250, v248, v248 row_ror:8 row_mask:0xf bank_mask:0xf
v_mfma_f32_16x16x32_bf16 a[80:83], v[72:75], a[196:199], a[80:83]
v_exp_f32 v37, v37
v_mfma_f32_16x16x32_bf16 a[96:99], v[72:75], a[200:203], a[96:99]
ds_read_b64_tr_b16 a[196:197], v225 offset:49152
v_cvt_pk_bf16_f32 v102, v36, v37
v_mfma_f32_16x16x32_bf16 a[100:103], v[76:79], a[200:203], a[100:103]
v_exp_f32 v38, v38
v_mfma_f32_16x16x32_bf16 a[104:107], v[80:83], a[200:203], a[104:107]
ds_read_b64_tr_b16 a[198:199], v225 offset:53248
v_max_u32_dpp v249, v250, v250 row_ror:4 row_mask:0xf bank_mask:0xf
v_mfma_f32_16x16x32_bf16 a[108:111], v[84:87], a[200:203], a[108:111]
v_exp_f32 v39, v39
v_mfma_f32_16x16x32_bf16 a[124:127], v[84:87], a[204:207], a[124:127]
ds_read_b64_tr_b16 a[200:201], v226 offset:49152
v_cvt_pk_bf16_f32 v103, v38, v39
v_mfma_f32_16x16x32_bf16 a[120:123], v[80:83], a[204:207], a[120:123]
ds_read_b64_tr_b16 a[202:203], v226 offset:53248
v_max_u32_dpp v250, v249, v249 row_ror:2 row_mask:0xf bank_mask:0xf
v_mfma_f32_16x16x32_bf16 a[116:119], v[76:79], a[204:207], a[116:119]
buffer_load_dwordx4 v231, s[8:11], s32 offen offset:3072  lds
v_mfma_f32_16x16x32_bf16 a[112:115], v[72:75], a[204:207], a[112:115]
ds_read_b64_tr_b16 a[204:205], v227 offset:49152
ds_read_b64_tr_b16 a[206:207], v227 offset:53248
v_smfmac_f32_16x16x64_bf16 a[132:135], a[208:211], v[80:87], v245
s_add_u32 m0, s86, 49152
s_add_u32 s50, s84, 2359296
buffer_load_dwordx4 v240, s[68:71], s50 offen lds
s_add_u32 m0, s86, 53248
s_add_u32 s50, s84, 2949120
buffer_load_dwordx4 v240, s[68:71], s50 offen lds
s_waitcnt lgkmcnt(8)
v_mfma_f32_16x16x32_bf16 v[8:11], a[144:147], v[152:155], v[136:139]
v_exp_f32 v40, v40
v_mfma_f32_16x16x32_bf16 v[8:11], a[148:151], v[156:159], v[8:11]
v_exp_f32 v41, v41
v_mfma_f32_16x16x32_bf16 v[8:11], a[152:155], v[160:163], v[8:11]
v_cvt_pk_bf16_f32 v72, v40, v41
v_max_u32_dpp v249, v250, v250 row_ror:1 row_mask:0xf bank_mask:0xf
v_mfma_f32_16x16x32_bf16 v[8:11], a[156:159], v[164:167], v[8:11]
v_exp_f32 v42, v42
v_mfma_f32_16x16x32_bf16 v[16:19], a[156:159], v[180:183], v[140:143]
s_add_u32 s39, s39, 16384
v_mov_b32 v250, v249
v_mfma_f32_16x16x32_bf16 v[16:19], a[152:155], v[176:179], v[16:19]
v_exp_f32 v43, v43
v_mfma_f32_16x16x32_bf16 v[16:19], a[148:151], v[172:175], v[16:19]
v_cvt_pk_bf16_f32 v73, v42, v43
v_permlane16_swap_b32 v249, v250
v_mfma_f32_16x16x32_bf16 v[16:19], a[144:147], v[168:171], v[16:19]
v_exp_f32 v44, v44
v_mfma_f32_16x16x32_bf16 v[24:27], a[144:147], v[184:187], v[144:147]
buffer_load_dword v253, v246, s[24:27], 0 offen sc0 sc1
v_mfma_f32_16x16x32_bf16 v[24:27], a[148:151], v[188:191], v[24:27]
v_exp_f32 v45, v45
v_mfma_f32_16x16x32_bf16 v[24:27], a[152:155], v[192:195], v[24:27]
s_add_u32 m0, s30, 131072
v_cvt_pk_bf16_f32 v74, v44, v45
v_mfma_f32_16x16x32_bf16 v[24:27], a[156:159], v[196:199], v[24:27]
v_exp_f32 v46, v46
v_mfma_f32_16x16x32_bf16 v[32:35], a[156:159], v[212:215], v[148:151]
ds_read_b128 a[156:159], v219 offset:8192
v_max_u32 v249, v249, v250
v_mfma_f32_16x16x32_bf16 v[32:35], a[152:155], v[208:211], v[32:35]
v_exp_f32 v47, v47
v_mfma_f32_16x16x32_bf16 v[32:35], a[148:151], v[204:207], v[32:35]
ds_read_b128 a[152:155], v218 offset:8192
v_cvt_pk_bf16_f32 v75, v46, v47
v_mfma_f32_16x16x32_bf16 v[32:35], a[144:147], v[200:203], v[32:35]
v_exp_f32 v48, v48
v_mfma_f32_16x16x32_bf16 a[0:3], v[88:91], a[176:179], a[0:3]
ds_read_b128 a[148:151], v217 offset:8192
ds_read_b128 a[144:147], v216 offset:8192
v_mfma_f32_16x16x32_bf16 a[4:7], v[92:95], a[176:179], a[4:7]
v_exp_f32 v49, v49
v_mfma_f32_16x16x32_bf16 a[8:11], v[96:99], a[176:179], a[8:11]
v_cvt_pk_bf16_f32 v76, v48, v49
v_mov_b32 v250, v249
v_mfma_f32_16x16x32_bf16 a[12:15], v[100:103], a[176:179], a[12:15]
v_exp_f32 v50, v50
v_mfma_f32_16x16x32_bf16 a[28:31], v[100:103], a[180:183], a[28:31]
ds_read_b64_tr_b16 a[176:177], v220 offset:57344
ds_read_b64_tr_b16 a[178:179], v220 offset:61440
v_mfma_f32_16x16x32_bf16 a[24:27], v[96:99], a[180:183], a[24:27]
v_exp_f32 v51, v51
v_mfma_f32_16x16x32_bf16 a[20:23], v[92:95], a[180:183], a[20:23]
v_cvt_pk_bf16_f32 v77, v50, v51
v_permlane32_swap_b32 v249, v250
v_mfma_f32_16x16x32_bf16 a[16:19], v[88:91], a[180:183], a[16:19]
v_exp_f32 v52, v52
v_mfma_f32_16x16x32_bf16 a[32:35], v[88:91], a[184:187], a[32:35]
ds_read_b64_tr_b16 a[180:181], v221 offset:57344
ds_read_b64_tr_b16 a[182:183], v221 offset:61440
v_mfma_f32_16x16x32_bf16 a[36:39], v[92:95], a[184:187], a[36:39]
v_exp_f32 v53, v53
v_mfma_f32_16x16x32_bf16 a[40:43], v[96:99], a[184:187], a[40:43]
v_cvt_pk_bf16_f32 v78, v52, v53
v_max_u32 v249, v249, v250
v_mfma_f32_16x16x32_bf16 a[44:47], v[100:103], a[184:187], a[44:47]
v_exp_f32 v54, v54
v_mfma_f32_16x16x32_bf16 a[60:63], v[100:103], a[188:191], a[60:63]
ds_read_b64_tr_b16 a[184:185], v222 offset:57344
ds_read_b64_tr_b16 a[186:187], v222 offset:61440
v_mfma_f32_16x16x32_bf16 a[56:59], v[96:99], a[188:191], a[56:59]
v_exp_f32 v55, v55
v_mfma_f32_16x16x32_bf16 a[52:55], v[92:95], a[188:191], a[52:55]
v_cvt_pk_bf16_f32 v79, v54, v55
v_add_u32 v251, v251, v249
v_mfma_f32_16x16x32_bf16 a[48:51], v[88:91], a[188:191], a[48:51]
v_exp_f32 v56, v56
v_smfmac_f32_16x16x64_bf16 a[128:131], a[208:211], v[88:95], v245
v_exp_f32 v57, v57
v_mfma_f32_16x16x32_bf16 v[12:15], a[160:163], v[152:155], v[136:139]
ds_read_b64_tr_b16 a[188:189], v223 offset:57344
v_cvt_pk_bf16_f32 v80, v56, v57
v_mfma_f32_16x16x32_bf16 v[12:15], a[164:167], v[156:159], v[12:15]
v_exp_f32 v58, v58
v_mfma_f32_16x16x32_bf16 v[12:15], a[168:171], v[160:163], v[12:15]
ds_read_b64_tr_b16 a[190:191], v223 offset:61440
v_sub_u32 v248, v248, v249
v_mfma_f32_16x16x32_bf16 v[12:15], a[172:175], v[164:167], v[12:15]
v_exp_f32 v59, v59
v_mfma_f32_16x16x32_bf16 v[20:23], a[172:175], v[180:183], v[140:143]
v_cvt_pk_bf16_f32 v81, v58, v59
v_cndmask_b32 v252, v252, v251, s[90:91]
v_mfma_f32_16x16x32_bf16 v[20:23], a[168:171], v[176:179], v[20:23]
v_exp_f32 v60, v60
v_mfma_f32_16x16x32_bf16 v[20:23], a[164:167], v[172:175], v[20:23]
buffer_load_dwordx4 v232, s[12:15], s39 offen offset:0  lds
v_mfma_f32_16x16x32_bf16 v[20:23], a[160:163], v[168:171], v[20:23]
v_exp_f32 v61, v61
v_mfma_f32_16x16x32_bf16 v[28:31], a[160:163], v[184:187], v[144:147]
s_lshl_b64 s[90:91], s[90:91], 1
v_cvt_pk_bf16_f32 v82, v60, v61
v_mfma_f32_16x16x32_bf16 v[28:31], a[164:167], v[188:191], v[28:31]
v_exp_f32 v62, v62
v_mfma_f32_16x16x32_bf16 v[28:31], a[168:171], v[192:195], v[28:31]
buffer_load_dwordx4 v233, s[12:15], s39 offen offset:1024  lds
v_mfma_f32_16x16x32_bf16 v[28:31], a[172:175], v[196:199], v[28:31]
v_exp_f32 v63, v63
v_mfma_f32_16x16x32_bf16 v[36:39], a[172:175], v[212:215], v[148:151]
ds_read_b128 a[172:175], v219 offset:12288
v_cvt_pk_bf16_f32 v83, v62, v63
v_mfma_f32_16x16x32_bf16 v[36:39], a[168:171], v[208:211], v[36:39]
v_exp_f32 v64, v64
v_mfma_f32_16x16x32_bf16 v[36:39], a[164:167], v[204:207], v[36:39]
ds_read_b128 a[168:171], v218 offset:12288
ds_read_b128 a[164:167], v217 offset:12288
v_mfma_f32_16x16x32_bf16 v[36:39], a[160:163], v[200:203], v[36:39]
v_exp_f32 v65, v65
s_waitcnt lgkmcnt(8)
v_mfma_f32_16x16x32_bf16 a[64:67], v[88:91], a[192:195], a[64:67]
ds_read_b128 a[160:163], v216 offset:12288
v_cvt_pk_bf16_f32 v84, v64, v65
v_mfma_f32_16x16x32_bf16 a[68:71], v[92:95], a[192:195], a[68:71]
v_exp_f32 v66, v66
v_mfma_f32_16x16x32_bf16 a[72:75], v[96:99], a[192:195], a[72:75]
buffer_load_dwordx4 v232, s[12:15], s39 offen offset:2048  lds
v_mfma_f32_16x16x32_bf16 a[76:79], v[100:103], a[192:195], a[76:79]
v_exp_f32 v67, v67
v_mfma_f32_16x16x32_bf16 a[92:95], v[100:103], a[196:199], a[92:95]
ds_read_b64_tr_b16 a[192:193], v224 offset:57344
v_cvt_pk_bf16_f32 v85, v66, v67
v_mfma_f32_16x16x32_bf16 a[88:91], v[96:99], a[196:199], a[88:91]
v_max_u32_dpp v250, v248, v248 row_ror:8 row_mask:0xf bank_mask:0xf
v_exp_f32 v68, v68
v_mfma_f32_16x16x32_bf16 a[84:87], v[92:95], a[196:199], a[84:87]
ds_read_b64_tr_b16 a[194:195], v224 offset:61440
v_mfma_f32_16x16x32_bf16 a[80:83], v[88:91], a[196:199], a[80:83]
v_exp_f32 v69, v69
v_mfma_f32_16x16x32_bf16 a[96:99], v[88:91], a[200:203], a[96:99]
ds_read_b64_tr_b16 a[196:197], v225 offset:57344
v_cvt_pk_bf16_f32 v86, v68, v69
v_mfma_f32_16x16x32_bf16 a[100:103], v[92:95], a[200:203], a[100:103]
v_exp_f32 v70, v70
v_mfma_f32_16x16x32_bf16 a[104:107], v[96:99], a[200:203], a[104:107]
ds_read_b64_tr_b16 a[198:199], v225 offset:61440
v_max_u32_dpp v249, v250, v250 row_ror:4 row_mask:0xf bank_mask:0xf
v_mfma_f32_16x16x32_bf16 a[108:111], v[100:103], a[200:203], a[108:111]
v_exp_f32 v71, v71
v_mfma_f32_16x16x32_bf16 a[124:127], v[100:103], a[204:207], a[124:127]
ds_read_b64_tr_b16 a[200:201], v226 offset:57344
v_cvt_pk_bf16_f32 v87, v70, v71
v_mfma_f32_16x16x32_bf16 a[120:123], v[96:99], a[204:207], a[120:123]
ds_read_b64_tr_b16 a[202:203], v226 offset:61440
v_max_u32_dpp v250, v249, v249 row_ror:2 row_mask:0xf bank_mask:0xf
v_mfma_f32_16x16x32_bf16 a[116:119], v[92:95], a[204:207], a[116:119]
buffer_load_dwordx4 v233, s[12:15], s39 offen offset:3072  lds
v_mfma_f32_16x16x32_bf16 a[112:115], v[88:91], a[204:207], a[112:115]
ds_read_b64_tr_b16 a[204:205], v227 offset:57344
ds_read_b64_tr_b16 a[206:207], v227 offset:61440
v_smfmac_f32_16x16x64_bf16 a[132:135], a[208:211], v[96:103], v245
s_add_u32 m0, s86, 57344
s_add_u32 s50, s84, 3538944
buffer_load_dwordx4 v240, s[68:71], s50 offen lds
s_add_u32 m0, s86, 61440
s_add_u32 s50, s84, 4128768
buffer_load_dwordx4 v240, s[68:71], s50 offen lds
v_mfma_f32_16x16x32_bf16 v[40:43], a[144:147], v[152:155], v[136:139]
v_exp_f32 v8, v8
v_mfma_f32_16x16x32_bf16 v[40:43], a[148:151], v[156:159], v[40:43]
v_exp_f32 v9, v9
v_mfma_f32_16x16x32_bf16 v[40:43], a[152:155], v[160:163], v[40:43]
v_cvt_pk_bf16_f32 v88, v8, v9
v_max_u32_dpp v249, v250, v250 row_ror:1 row_mask:0xf bank_mask:0xf
v_mfma_f32_16x16x32_bf16 v[40:43], a[156:159], v[164:167], v[40:43]
v_exp_f32 v10, v10
v_mfma_f32_16x16x32_bf16 v[48:51], a[156:159], v[180:183], v[140:143]
v_mov_b32 v250, v249
v_mfma_f32_16x16x32_bf16 v[48:51], a[152:155], v[176:179], v[48:51]
v_exp_f32 v11, v11
v_mfma_f32_16x16x32_bf16 v[48:51], a[148:151], v[172:175], v[48:51]
v_cvt_pk_bf16_f32 v89, v10, v11
v_permlane16_swap_b32 v249, v250
v_mfma_f32_16x16x32_bf16 v[48:51], a[144:147], v[168:171], v[48:51]
v_exp_f32 v12, v12
v_mfma_f32_16x16x32_bf16 v[56:59], a[144:147], v[184:187], v[144:147]
v_max_u32 v249, v249, v250
v_mov_b32 v250, v249
v_mfma_f32_16x16x32_bf16 v[56:59], a[148:151], v[188:191], v[56:59]
v_exp_f32 v13, v13
v_mfma_f32_16x16x32_bf16 v[56:59], a[152:155], v[192:195], v[56:59]
v_cvt_pk_bf16_f32 v90, v12, v13
v_permlane32_swap_b32 v249, v250
v_mfma_f32_16x16x32_bf16 v[56:59], a[156:159], v[196:199], v[56:59]
v_exp_f32 v14, v14
v_mfma_f32_16x16x32_bf16 v[64:67], a[156:159], v[212:215], v[148:151]
s_waitcnt vmcnt(13) lgkmcnt(0)
s_barrier
v_mfma_f32_16x16x32_bf16 v[64:67], a[152:155], v[208:211], v[64:67]
v_exp_f32 v15, v15
v_mfma_f32_16x16x32_bf16 v[64:67], a[148:151], v[204:207], v[64:67]
ds_read_b128 a[156:159], v219 offset:16384
v_cvt_pk_bf16_f32 v91, v14, v15
v_mfma_f32_16x16x32_bf16 v[64:67], a[144:147], v[200:203], v[64:67]
v_exp_f32 v16, v16
v_mfma_f32_16x16x32_bf16 a[0:3], v[72:75], a[176:179], a[0:3]
ds_read_b128 a[152:155], v218 offset:16384
ds_read_b128 a[148:151], v217 offset:16384
v_mfma_f32_16x16x32_bf16 a[4:7], v[76:79], a[176:179], a[4:7]
v_exp_f32 v17, v17
v_mfma_f32_16x16x32_bf16 a[8:11], v[80:83], a[176:179], a[8:11]
ds_read_b128 a[144:147], v216 offset:16384
v_cvt_pk_bf16_f32 v92, v16, v17
v_mfma_f32_16x16x32_bf16 a[12:15], v[84:87], a[176:179], a[12:15]
v_exp_f32 v18, v18
v_mfma_f32_16x16x32_bf16 a[28:31], v[84:87], a[180:183], a[28:31]
ds_read_b64_tr_b16 a[176:177], v220 offset:0
ds_read_b64_tr_b16 a[178:179], v220 offset:4096
v_mfma_f32_16x16x32_bf16 a[24:27], v[80:83], a[180:183], a[24:27]
v_exp_f32 v19, v19
v_mfma_f32_16x16x32_bf16 a[20:23], v[76:79], a[180:183], a[20:23]
s_add_u32 s32, s32, 16384
v_cvt_pk_bf16_f32 v93, v18, v19
v_mfma_f32_16x16x32_bf16 a[16:19], v[72:75], a[180:183], a[16:19]
v_exp_f32 v20, v20
v_mfma_f32_16x16x32_bf16 a[32:35], v[72:75], a[184:187], a[32:35]
ds_read_b64_tr_b16 a[180:181], v221 offset:0
ds_read_b64_tr_b16 a[182:183], v221 offset:4096
v_mfma_f32_16x16x32_bf16 a[36:39], v[76:79], a[184:187], a[36:39]
v_exp_f32 v21, v21
v_mfma_f32_16x16x32_bf16 a[40:43], v[80:83], a[184:187], a[40:43]
s_add_u32 m0, s30, 65536
v_cvt_pk_bf16_f32 v94, v20, v21
v_mfma_f32_16x16x32_bf16 a[44:47], v[84:87], a[184:187], a[44:47]
v_exp_f32 v22, v22
v_mfma_f32_16x16x32_bf16 a[60:63], v[84:87], a[188:191], a[60:63]
ds_read_b64_tr_b16 a[184:185], v222 offset:0
ds_read_b64_tr_b16 a[186:187], v222 offset:4096
v_mfma_f32_16x16x32_bf16 a[56:59], v[80:83], a[188:191], a[56:59]
v_max_u32 v249, v249, v250
v_exp_f32 v23, v23
v_mfma_f32_16x16x32_bf16 a[52:55], v[76:79], a[188:191], a[52:55]
v_cvt_pk_bf16_f32 v95, v22, v23
v_add_u32 v251, v251, v249
v_mfma_f32_16x16x32_bf16 a[48:51], v[72:75], a[188:191], a[48:51]
v_exp_f32 v24, v24
v_smfmac_f32_16x16x64_bf16 a[128:131], a[208:211], v[72:79], v245
v_exp_f32 v25, v25
v_mfma_f32_16x16x32_bf16 v[44:47], a[160:163], v[152:155], v[136:139]
ds_read_b64_tr_b16 a[188:189], v223 offset:0
v_cvt_pk_bf16_f32 v96, v24, v25
v_mfma_f32_16x16x32_bf16 v[44:47], a[164:167], v[156:159], v[44:47]
v_exp_f32 v26, v26
v_mfma_f32_16x16x32_bf16 v[44:47], a[168:171], v[160:163], v[44:47]
ds_read_b64_tr_b16 a[190:191], v223 offset:4096
v_sub_u32 v248, v248, v249
v_mfma_f32_16x16x32_bf16 v[44:47], a[172:175], v[164:167], v[44:47]
v_exp_f32 v27, v27
v_mfma_f32_16x16x32_bf16 v[52:55], a[172:175], v[180:183], v[140:143]
v_cvt_pk_bf16_f32 v97, v26, v27
v_cndmask_b32 v252, v252, v251, s[90:91]
v_mfma_f32_16x16x32_bf16 v[52:55], a[168:171], v[176:179], v[52:55]
v_exp_f32 v28, v28
v_mfma_f32_16x16x32_bf16 v[52:55], a[164:167], v[172:175], v[52:55]
buffer_load_dwordx4 v228, s[8:11], s32 offen offset:0  lds
v_mfma_f32_16x16x32_bf16 v[52:55], a[160:163], v[168:171], v[52:55]
STUB_6:
s_cbranch_execz STUB_9
v_exp_f32 v29, v29
v_mfma_f32_16x16x32_bf16 v[60:63], a[160:163], v[184:187], v[144:147]
s_lshl_b64 s[90:91], s[90:91], 1
v_cvt_pk_bf16_f32 v98, v28, v29
v_mfma_f32_16x16x32_bf16 v[60:63], a[164:167], v[188:191], v[60:63]
v_exp_f32 v30, v30
v_mfma_f32_16x16x32_bf16 v[60:63], a[168:171], v[192:195], v[60:63]
buffer_load_dwordx4 v229, s[8:11], s32 offen offset:1024  lds
v_mfma_f32_16x16x32_bf16 v[60:63], a[172:175], v[196:199], v[60:63]
v_exp_f32 v31, v31
v_mfma_f32_16x16x32_bf16 v[68:71], a[172:175], v[212:215], v[148:151]
ds_read_b128 a[172:175], v219 offset:20480
v_cvt_pk_bf16_f32 v99, v30, v31
v_mfma_f32_16x16x32_bf16 v[68:71], a[168:171], v[208:211], v[68:71]
v_exp_f32 v32, v32
v_mfma_f32_16x16x32_bf16 v[68:71], a[164:167], v[204:207], v[68:71]
ds_read_b128 a[168:171], v218 offset:20480
ds_read_b128 a[164:167], v217 offset:20480
v_mfma_f32_16x16x32_bf16 v[68:71], a[160:163], v[200:203], v[68:71]
v_exp_f32 v33, v33
v_mfma_f32_16x16x32_bf16 a[64:67], v[72:75], a[192:195], a[64:67]
ds_read_b128 a[160:163], v216 offset:20480
v_cvt_pk_bf16_f32 v100, v32, v33
v_mfma_f32_16x16x32_bf16 a[68:71], v[76:79], a[192:195], a[68:71]
v_exp_f32 v34, v34
v_mfma_f32_16x16x32_bf16 a[72:75], v[80:83], a[192:195], a[72:75]
buffer_load_dwordx4 v230, s[8:11], s32 offen offset:2048  lds
v_mfma_f32_16x16x32_bf16 a[76:79], v[84:87], a[192:195], a[76:79]
v_max_u32_dpp v250, v248, v248 row_ror:8 row_mask:0xf bank_mask:0xf
v_exp_f32 v35, v35
v_mfma_f32_16x16x32_bf16 a[92:95], v[84:87], a[196:199], a[92:95]
ds_read_b64_tr_b16 a[192:193], v224 offset:0
v_cvt_pk_bf16_f32 v101, v34, v35
v_mfma_f32_16x16x32_bf16 a[88:91], v[80:83], a[196:199], a[88:91]
v_exp_f32 v36, v36
v_mfma_f32_16x16x32_bf16 a[84:87], v[76:79], a[196:199], a[84:87]
ds_read_b64_tr_b16 a[194:195], v224 offset:4096
v_max_u32_dpp v249, v250, v250 row_ror:4 row_mask:0xf bank_mask:0xf
v_mfma_f32_16x16x32_bf16 a[80:83], v[72:75], a[196:199], a[80:83]
v_exp_f32 v37, v37
v_mfma_f32_16x16x32_bf16 a[96:99], v[72:75], a[200:203], a[96:99]
ds_read_b64_tr_b16 a[196:197], v225 offset:0
v_cvt_pk_bf16_f32 v102, v36, v37
v_mfma_f32_16x16x32_bf16 a[100:103], v[76:79], a[200:203], a[100:103]
v_exp_f32 v38, v38
v_mfma_f32_16x16x32_bf16 a[104:107], v[80:83], a[200:203], a[104:107]
ds_read_b64_tr_b16 a[198:199], v225 offset:4096
v_max_u32_dpp v250, v249, v249 row_ror:2 row_mask:0xf bank_mask:0xf
v_mfma_f32_16x16x32_bf16 a[108:111], v[84:87], a[200:203], a[108:111]
v_exp_f32 v39, v39
v_mfma_f32_16x16x32_bf16 a[124:127], v[84:87], a[204:207], a[124:127]
ds_read_b64_tr_b16 a[200:201], v226 offset:0
v_cvt_pk_bf16_f32 v103, v38, v39
v_mfma_f32_16x16x32_bf16 a[120:123], v[80:83], a[204:207], a[120:123]
ds_read_b64_tr_b16 a[202:203], v226 offset:4096
v_max_u32_dpp v249, v250, v250 row_ror:1 row_mask:0xf bank_mask:0xf
v_mfma_f32_16x16x32_bf16 a[116:119], v[76:79], a[204:207], a[116:119]
buffer_load_dwordx4 v231, s[8:11], s32 offen offset:3072  lds
v_mfma_f32_16x16x32_bf16 a[112:115], v[72:75], a[204:207], a[112:115]
ds_read_b64_tr_b16 a[204:205], v227 offset:0
ds_read_b64_tr_b16 a[206:207], v227 offset:4096
v_smfmac_f32_16x16x64_bf16 a[132:135], a[208:211], v[80:87], v245
v_mov_b32 v250, v249
s_waitcnt lgkmcnt(8)
v_mfma_f32_16x16x32_bf16 v[8:11], a[144:147], v[152:155], v[136:139]
v_exp_f32 v40, v40
v_mfma_f32_16x16x32_bf16 v[8:11], a[148:151], v[156:159], v[8:11]
v_exp_f32 v41, v41
v_mfma_f32_16x16x32_bf16 v[8:11], a[152:155], v[160:163], v[8:11]
v_cvt_pk_bf16_f32 v72, v40, v41
v_permlane16_swap_b32 v249, v250
v_mfma_f32_16x16x32_bf16 v[8:11], a[156:159], v[164:167], v[8:11]
v_exp_f32 v42, v42
v_mfma_f32_16x16x32_bf16 v[16:19], a[156:159], v[180:183], v[140:143]
s_add_u32 s39, s39, 16384
v_max_u32 v249, v249, v250
v_mfma_f32_16x16x32_bf16 v[16:19], a[152:155], v[176:179], v[16:19]
v_exp_f32 v43, v43
v_mfma_f32_16x16x32_bf16 v[16:19], a[148:151], v[172:175], v[16:19]
v_cvt_pk_bf16_f32 v73, v42, v43
v_mov_b32 v250, v249
v_mfma_f32_16x16x32_bf16 v[16:19], a[144:147], v[168:171], v[16:19]
v_exp_f32 v44, v44
v_mfma_f32_16x16x32_bf16 v[24:27], a[144:147], v[184:187], v[144:147]
v_permlane32_swap_b32 v249, v250
v_max_u32 v249, v249, v250
v_mfma_f32_16x16x32_bf16 v[24:27], a[148:151], v[188:191], v[24:27]
v_exp_f32 v45, v45
v_mfma_f32_16x16x32_bf16 v[24:27], a[152:155], v[192:195], v[24:27]
v_cvt_pk_bf16_f32 v74, v44, v45
v_add_u32 v251, v251, v249
v_mfma_f32_16x16x32_bf16 v[24:27], a[156:159], v[196:199], v[24:27]
v_exp_f32 v46, v46
v_mfma_f32_16x16x32_bf16 v[32:35], a[156:159], v[212:215], v[148:151]
ds_read_b128 a[156:159], v219 offset:24576
s_add_u32 m0, s30, 147456
v_mfma_f32_16x16x32_bf16 v[32:35], a[152:155], v[208:211], v[32:35]
v_exp_f32 v47, v47
v_mfma_f32_16x16x32_bf16 v[32:35], a[148:151], v[204:207], v[32:35]
ds_read_b128 a[152:155], v218 offset:24576
v_cvt_pk_bf16_f32 v75, v46, v47
v_mfma_f32_16x16x32_bf16 v[32:35], a[144:147], v[200:203], v[32:35]
v_exp_f32 v48, v48
v_mfma_f32_16x16x32_bf16 a[0:3], v[88:91], a[176:179], a[0:3]
ds_read_b128 a[148:151], v217 offset:24576
ds_read_b128 a[144:147], v216 offset:24576
v_mfma_f32_16x16x32_bf16 a[4:7], v[92:95], a[176:179], a[4:7]
v_exp_f32 v49, v49
v_mfma_f32_16x16x32_bf16 a[8:11], v[96:99], a[176:179], a[8:11]
v_cvt_pk_bf16_f32 v76, v48, v49
v_sub_u32 v248, v248, v249
v_mfma_f32_16x16x32_bf16 a[12:15], v[100:103], a[176:179], a[12:15]
v_exp_f32 v50, v50
v_mfma_f32_16x16x32_bf16 a[28:31], v[100:103], a[180:183], a[28:31]
ds_read_b64_tr_b16 a[176:177], v220 offset:8192
ds_read_b64_tr_b16 a[178:179], v220 offset:12288
v_mfma_f32_16x16x32_bf16 a[24:27], v[96:99], a[180:183], a[24:27]
v_exp_f32 v51, v51
v_mfma_f32_16x16x32_bf16 a[20:23], v[92:95], a[180:183], a[20:23]
v_cvt_pk_bf16_f32 v77, v50, v51
v_cndmask_b32 v252, v252, v251, s[90:91]
v_mfma_f32_16x16x32_bf16 a[16:19], v[88:91], a[180:183], a[16:19]
v_exp_f32 v52, v52
v_mfma_f32_16x16x32_bf16 a[32:35], v[88:91], a[184:187], a[32:35]
ds_read_b64_tr_b16 a[180:181], v221 offset:8192
ds_read_b64_tr_b16 a[182:183], v221 offset:12288
v_mfma_f32_16x16x32_bf16 a[36:39], v[92:95], a[184:187], a[36:39]
v_exp_f32 v53, v53
v_mfma_f32_16x16x32_bf16 a[40:43], v[96:99], a[184:187], a[40:43]
s_lshl_b64 s[90:91], s[90:91], 1
v_cvt_pk_bf16_f32 v78, v52, v53
v_mfma_f32_16x16x32_bf16 a[44:47], v[100:103], a[184:187], a[44:47]
v_exp_f32 v54, v54
v_mfma_f32_16x16x32_bf16 a[60:63], v[100:103], a[188:191], a[60:63]
ds_read_b64_tr_b16 a[184:185], v222 offset:8192
ds_read_b64_tr_b16 a[186:187], v222 offset:12288
v_mfma_f32_16x16x32_bf16 a[56:59], v[96:99], a[188:191], a[56:59]
v_exp_f32 v55, v55
v_mfma_f32_16x16x32_bf16 a[52:55], v[92:95], a[188:191], a[52:55]
v_cvt_pk_bf16_f32 v79, v54, v55
v_max_u32_dpp v250, v248, v248 row_ror:8 row_mask:0xf bank_mask:0xf
v_mfma_f32_16x16x32_bf16 a[48:51], v[88:91], a[188:191], a[48:51]
v_exp_f32 v56, v56
v_smfmac_f32_16x16x64_bf16 a[128:131], a[208:211], v[88:95], v245
v_exp_f32 v57, v57
v_mfma_f32_16x16x32_bf16 v[12:15], a[160:163], v[152:155], v[136:139]
ds_read_b64_tr_b16 a[188:189], v223 offset:8192
v_cvt_pk_bf16_f32 v80, v56, v57
v_mfma_f32_16x16x32_bf16 v[12:15], a[164:167], v[156:159], v[12:15]
v_exp_f32 v58, v58
v_mfma_f32_16x16x32_bf16 v[12:15], a[168:171], v[160:163], v[12:15]
ds_read_b64_tr_b16 a[190:191], v223 offset:12288
v_max_u32_dpp v249, v250, v250 row_ror:4 row_mask:0xf bank_mask:0xf
v_mfma_f32_16x16x32_bf16 v[12:15], a[172:175], v[164:167], v[12:15]
v_exp_f32 v59, v59
v_mfma_f32_16x16x32_bf16 v[20:23], a[172:175], v[180:183], v[140:143]
v_cvt_pk_bf16_f32 v81, v58, v59
v_max_u32_dpp v250, v249, v249 row_ror:2 row_mask:0xf bank_mask:0xf
v_mfma_f32_16x16x32_bf16 v[20:23], a[168:171], v[176:179], v[20:23]
v_exp_f32 v60, v60
v_mfma_f32_16x16x32_bf16 v[20:23], a[164:167], v[172:175], v[20:23]
buffer_load_dwordx4 v232, s[12:15], s39 offen offset:0  lds
v_mfma_f32_16x16x32_bf16 v[20:23], a[160:163], v[168:171], v[20:23]
v_exp_f32 v61, v61
v_mfma_f32_16x16x32_bf16 v[28:31], a[160:163], v[184:187], v[144:147]
v_cvt_pk_bf16_f32 v82, v60, v61
v_max_u32_dpp v249, v250, v250 row_ror:1 row_mask:0xf bank_mask:0xf
v_mfma_f32_16x16x32_bf16 v[28:31], a[164:167], v[188:191], v[28:31]
v_exp_f32 v62, v62
v_mfma_f32_16x16x32_bf16 v[28:31], a[168:171], v[192:195], v[28:31]
buffer_load_dwordx4 v233, s[12:15], s39 offen offset:1024  lds
v_mfma_f32_16x16x32_bf16 v[28:31], a[172:175], v[196:199], v[28:31]
v_exp_f32 v63, v63
v_mfma_f32_16x16x32_bf16 v[36:39], a[172:175], v[212:215], v[148:151]
ds_read_b128 a[172:175], v219 offset:28672
v_cvt_pk_bf16_f32 v83, v62, v63
v_mfma_f32_16x16x32_bf16 v[36:39], a[168:171], v[208:211], v[36:39]
v_exp_f32 v64, v64
v_mfma_f32_16x16x32_bf16 v[36:39], a[164:167], v[204:207], v[36:39]
ds_read_b128 a[168:171], v218 offset:28672
ds_read_b128 a[164:167], v217 offset:28672
v_mfma_f32_16x16x32_bf16 v[36:39], a[160:163], v[200:203], v[36:39]
v_exp_f32 v65, v65
s_waitcnt lgkmcnt(8)
v_mfma_f32_16x16x32_bf16 a[64:67], v[88:91], a[192:195], a[64:67]
ds_read_b128 a[160:163], v216 offset:28672
v_cvt_pk_bf16_f32 v84, v64, v65
v_mfma_f32_16x16x32_bf16 a[68:71], v[92:95], a[192:195], a[68:71]
v_exp_f32 v66, v66
v_mfma_f32_16x16x32_bf16 a[72:75], v[96:99], a[192:195], a[72:75]
buffer_load_dwordx4 v232, s[12:15], s39 offen offset:2048  lds
v_mfma_f32_16x16x32_bf16 a[76:79], v[100:103], a[192:195], a[76:79]
v_exp_f32 v67, v67
v_mfma_f32_16x16x32_bf16 a[92:95], v[100:103], a[196:199], a[92:95]
ds_read_b64_tr_b16 a[192:193], v224 offset:8192
v_cvt_pk_bf16_f32 v85, v66, v67
v_mfma_f32_16x16x32_bf16 a[88:91], v[96:99], a[196:199], a[88:91]
v_exp_f32 v68, v68
v_mfma_f32_16x16x32_bf16 a[84:87], v[92:95], a[196:199], a[84:87]
ds_read_b64_tr_b16 a[194:195], v224 offset:12288
v_mov_b32 v250, v249
v_mfma_f32_16x16x32_bf16 a[80:83], v[88:91], a[196:199], a[80:83]
v_exp_f32 v69, v69
v_mfma_f32_16x16x32_bf16 a[96:99], v[88:91], a[200:203], a[96:99]
ds_read_b64_tr_b16 a[196:197], v225 offset:8192
v_cvt_pk_bf16_f32 v86, v68, v69
v_mfma_f32_16x16x32_bf16 a[100:103], v[92:95], a[200:203], a[100:103]
v_exp_f32 v70, v70
v_mfma_f32_16x16x32_bf16 a[104:107], v[96:99], a[200:203], a[104:107]
ds_read_b64_tr_b16 a[198:199], v225 offset:12288
v_permlane16_swap_b32 v249, v250
v_mfma_f32_16x16x32_bf16 a[108:111], v[100:103], a[200:203], a[108:111]
v_exp_f32 v71, v71
v_mfma_f32_16x16x32_bf16 a[124:127], v[100:103], a[204:207], a[124:127]
ds_read_b64_tr_b16 a[200:201], v226 offset:8192
v_cvt_pk_bf16_f32 v87, v70, v71
v_mfma_f32_16x16x32_bf16 a[120:123], v[96:99], a[204:207], a[120:123]
ds_read_b64_tr_b16 a[202:203], v226 offset:12288
v_max_u32 v249, v249, v250
v_mfma_f32_16x16x32_bf16 a[116:119], v[92:95], a[204:207], a[116:119]
buffer_load_dwordx4 v233, s[12:15], s39 offen offset:3072  lds
v_mfma_f32_16x16x32_bf16 a[112:115], v[88:91], a[204:207], a[112:115]
ds_read_b64_tr_b16 a[204:205], v227 offset:8192
ds_read_b64_tr_b16 a[206:207], v227 offset:12288
v_smfmac_f32_16x16x64_bf16 a[132:135], a[208:211], v[96:103], v245
v_mov_b32 v250, v249
v_mfma_f32_16x16x32_bf16 v[40:43], a[144:147], v[152:155], v[136:139]
v_exp_f32 v8, v8
v_mfma_f32_16x16x32_bf16 v[40:43], a[148:151], v[156:159], v[40:43]
v_exp_f32 v9, v9
v_mfma_f32_16x16x32_bf16 v[40:43], a[152:155], v[160:163], v[40:43]
v_cvt_pk_bf16_f32 v88, v8, v9
v_permlane32_swap_b32 v249, v250
v_mfma_f32_16x16x32_bf16 v[40:43], a[156:159], v[164:167], v[40:43]
v_exp_f32 v10, v10
v_mfma_f32_16x16x32_bf16 v[48:51], a[156:159], v[180:183], v[140:143]
v_max_u32 v249, v249, v250
v_add_u32 v251, v251, v249
v_mfma_f32_16x16x32_bf16 v[48:51], a[152:155], v[176:179], v[48:51]
v_exp_f32 v11, v11
v_mfma_f32_16x16x32_bf16 v[48:51], a[148:151], v[172:175], v[48:51]
v_cvt_pk_bf16_f32 v89, v10, v11
v_sub_u32 v248, v248, v249
v_mfma_f32_16x16x32_bf16 v[48:51], a[144:147], v[168:171], v[48:51]
v_exp_f32 v12, v12
v_mfma_f32_16x16x32_bf16 v[56:59], a[144:147], v[184:187], v[144:147]
v_cndmask_b32 v252, v252, v251, s[90:91]
v_mfma_f32_16x16x32_bf16 v[56:59], a[148:151], v[188:191], v[56:59]
v_exp_f32 v13, v13
v_mfma_f32_16x16x32_bf16 v[56:59], a[152:155], v[192:195], v[56:59]
s_lshl_b64 s[90:91], s[90:91], 1
v_cvt_pk_bf16_f32 v90, v12, v13
v_mfma_f32_16x16x32_bf16 v[56:59], a[156:159], v[196:199], v[56:59]
v_exp_f32 v14, v14
v_mfma_f32_16x16x32_bf16 v[64:67], a[156:159], v[212:215], v[148:151]
s_waitcnt vmcnt(8) lgkmcnt(0)
s_barrier
v_mfma_f32_16x16x32_bf16 v[64:67], a[152:155], v[208:211], v[64:67]
ds_read_b64_tr_b16 a[212:213], v241 offset:0
v_exp_f32 v15, v15
v_mfma_f32_16x16x32_bf16 v[64:67], a[148:151], v[204:207], v[64:67]
ds_read_b128 a[156:159], v219 offset:49152
ds_read_b64_tr_b16 a[214:215], v241 offset:256
v_cvt_pk_bf16_f32 v91, v14, v15
v_mfma_f32_16x16x32_bf16 v[64:67], a[144:147], v[200:203], v[64:67]
ds_read_b64_tr_b16 a[216:217], v241 offset:2048
v_exp_f32 v16, v16
v_mfma_f32_16x16x32_bf16 a[0:3], v[72:75], a[176:179], a[0:3]
ds_read_b128 a[152:155], v218 offset:49152
ds_read_b128 a[148:151], v217 offset:49152
ds_read_b64_tr_b16 a[218:219], v241 offset:2304
v_mfma_f32_16x16x32_bf16 a[4:7], v[76:79], a[176:179], a[4:7]
ds_read_b64_tr_b16 a[220:221], v241 offset:4096
v_exp_f32 v17, v17
v_mfma_f32_16x16x32_bf16 a[8:11], v[80:83], a[176:179], a[8:11]
ds_read_b128 a[144:147], v216 offset:49152
ds_read_b64_tr_b16 a[222:223], v241 offset:4352
v_cvt_pk_bf16_f32 v92, v16, v17
v_mfma_f32_16x16x32_bf16 a[12:15], v[84:87], a[176:179], a[12:15]
ds_read_b64_tr_b16 a[224:225], v241 offset:6144
v_exp_f32 v18, v18
v_mfma_f32_16x16x32_bf16 a[28:31], v[84:87], a[180:183], a[28:31]
ds_read_b64_tr_b16 a[176:177], v220 offset:32768
ds_read_b64_tr_b16 a[178:179], v220 offset:36864
ds_read_b64_tr_b16 a[226:227], v241 offset:6400
v_mfma_f32_16x16x32_bf16 a[24:27], v[80:83], a[180:183], a[24:27]
ds_read_b64_tr_b16 a[228:229], v241 offset:8192
v_exp_f32 v19, v19
v_mfma_f32_16x16x32_bf16 a[20:23], v[76:79], a[180:183], a[20:23]
s_add_u32 s32, s32, 16384
ds_read_b64_tr_b16 a[230:231], v241 offset:8448
v_cvt_pk_bf16_f32 v93, v18, v19
v_mfma_f32_16x16x32_bf16 a[16:19], v[72:75], a[180:183], a[16:19]
ds_read_b64_tr_b16 a[232:233], v241 offset:10240
v_exp_f32 v20, v20
v_mfma_f32_16x16x32_bf16 a[32:35], v[72:75], a[184:187], a[32:35]
ds_read_b64_tr_b16 a[180:181], v221 offset:32768
ds_read_b64_tr_b16 a[182:183], v221 offset:36864
ds_read_b64_tr_b16 a[234:235], v241 offset:10496
v_mfma_f32_16x16x32_bf16 a[36:39], v[76:79], a[184:187], a[36:39]
ds_read_b64_tr_b16 a[236:237], v241 offset:12288
v_exp_f32 v21, v21
v_mfma_f32_16x16x32_bf16 a[40:43], v[80:83], a[184:187], a[40:43]
s_add_u32 m0, s30, 81920
ds_read_b64_tr_b16 a[238:239], v241 offset:12544
v_cvt_pk_bf16_f32 v94, v20, v21
v_mfma_f32_16x16x32_bf16 a[44:47], v[84:87], a[184:187], a[44:47]
ds_read_b64_tr_b16 a[240:241], v241 offset:14336
v_exp_f32 v22, v22
v_mfma_f32_16x16x32_bf16 a[60:63], v[84:87], a[188:191], a[60:63]
ds_read_b64_tr_b16 a[184:185], v222 offset:32768
ds_read_b64_tr_b16 a[186:187], v222 offset:36864
ds_read_b64_tr_b16 a[242:243], v241 offset:14592
v_mfma_f32_16x16x32_bf16 a[56:59], v[80:83], a[188:191], a[56:59]
ds_read_b64_tr_b16 a[244:245], v241 offset:16384
v_exp_f32 v23, v23
v_mfma_f32_16x16x32_bf16 a[52:55], v[76:79], a[188:191], a[52:55]
ds_read_b64_tr_b16 a[246:247], v241 offset:16640
ds_read_b64_tr_b16 a[248:249], v241 offset:18432
v_cvt_pk_bf16_f32 v95, v22, v23
v_mfma_f32_16x16x32_bf16 a[48:51], v[72:75], a[188:191], a[48:51]
ds_read_b64_tr_b16 a[250:251], v241 offset:18688
v_exp_f32 v24, v24
v_smfmac_f32_16x16x64_bf16 a[128:131], a[208:211], v[72:79], v245
ds_read_b64_tr_b16 a[252:253], v241 offset:20480
v_exp_f32 v25, v25
v_mfma_f32_16x16x32_bf16 v[44:47], a[160:163], v[152:155], v[136:139]
ds_read_b64_tr_b16 a[188:189], v223 offset:32768
ds_read_b64_tr_b16 a[254:255], v241 offset:20736
v_cvt_pk_bf16_f32 v96, v24, v25
v_mfma_f32_16x16x32_bf16 v[44:47], a[164:167], v[156:159], v[44:47]
ds_read_b64_tr_b16 a[136:137], v241 offset:22528
v_exp_f32 v26, v26
v_mfma_f32_16x16x32_bf16 v[44:47], a[168:171], v[160:163], v[44:47]
ds_read_b64_tr_b16 a[190:191], v223 offset:36864
ds_read_b64_tr_b16 a[138:139], v241 offset:22784
v_mfma_f32_16x16x32_bf16 v[44:47], a[172:175], v[164:167], v[44:47]
v_exp_f32 v27, v27
v_mfma_f32_16x16x32_bf16 v[52:55], a[172:175], v[180:183], v[140:143]
ds_read_b64_tr_b16 a[140:141], v241 offset:24576
v_cvt_pk_bf16_f32 v97, v26, v27
v_mfma_f32_16x16x32_bf16 v[52:55], a[168:171], v[176:179], v[52:55]
v_exp_f32 v28, v28
v_mfma_f32_16x16x32_bf16 v[52:55], a[164:167], v[172:175], v[52:55]
buffer_load_dwordx4 v228, s[8:11], s32 offen offset:0  lds
v_mfma_f32_16x16x32_bf16 v[52:55], a[160:163], v[168:171], v[52:55]
v_exp_f32 v29, v29
v_mfma_f32_16x16x32_bf16 v[60:63], a[160:163], v[184:187], v[144:147]
ds_read_b64_tr_b16 a[142:143], v241 offset:24832
v_cvt_pk_bf16_f32 v98, v28, v29
v_mfma_f32_16x16x32_bf16 v[60:63], a[164:167], v[188:191], v[60:63]
v_exp_f32 v30, v30
v_mfma_f32_16x16x32_bf16 v[60:63], a[168:171], v[192:195], v[60:63]
buffer_load_dwordx4 v229, s[8:11], s32 offen offset:1024  lds
v_mfma_f32_16x16x32_bf16 v[60:63], a[172:175], v[196:199], v[60:63]
v_exp_f32 v31, v31
v_mfma_f32_16x16x32_bf16 v[68:71], a[172:175], v[212:215], v[148:151]
ds_read_b128 a[172:175], v219 offset:53248
v_cvt_pk_bf16_f32 v99, v30, v31
v_mfma_f32_16x16x32_bf16 v[68:71], a[168:171], v[208:211], v[68:71]
v_exp_f32 v32, v32
v_mfma_f32_16x16x32_bf16 v[68:71], a[164:167], v[204:207], v[68:71]
ds_read_b128 a[168:171], v218 offset:53248
ds_read_b128 a[164:167], v217 offset:53248
v_max_u32_dpp v250, v248, v248 row_ror:8 row_mask:0xf bank_mask:0xf
v_mfma_f32_16x16x32_bf16 v[68:71], a[160:163], v[200:203], v[68:71]
v_exp_f32 v33, v33
v_mfma_f32_16x16x32_bf16 a[64:67], v[72:75], a[192:195], a[64:67]
ds_read_b128 a[160:163], v216 offset:53248
ds_read_b64_tr_b16 v[104:105], v241 offset:26624
v_cvt_pk_bf16_f32 v100, v32, v33
v_mfma_f32_16x16x32_bf16 a[68:71], v[76:79], a[192:195], a[68:71]
v_exp_f32 v34, v34
v_mfma_f32_16x16x32_bf16 a[72:75], v[80:83], a[192:195], a[72:75]
buffer_load_dwordx4 v230, s[8:11], s32 offen offset:2048  lds
v_mfma_f32_16x16x32_bf16 a[76:79], v[84:87], a[192:195], a[76:79]
v_max_u32_dpp v249, v250, v250 row_ror:4 row_mask:0xf bank_mask:0xf
v_exp_f32 v35, v35
v_mfma_f32_16x16x32_bf16 a[92:95], v[84:87], a[196:199], a[92:95]
ds_read_b64_tr_b16 a[192:193], v224 offset:32768
v_cvt_pk_bf16_f32 v101, v34, v35
v_mfma_f32_16x16x32_bf16 a[88:91], v[80:83], a[196:199], a[88:91]
ds_read_b64_tr_b16 v[106:107], v241 offset:26880
v_exp_f32 v36, v36
v_mfma_f32_16x16x32_bf16 a[84:87], v[76:79], a[196:199], a[84:87]
ds_read_b64_tr_b16 a[194:195], v224 offset:36864
ds_read_b64_tr_b16 v[108:109], v241 offset:28672
v_mfma_f32_16x16x32_bf16 a[80:83], v[72:75], a[196:199], a[80:83]
v_max_u32_dpp v250, v249, v249 row_ror:2 row_mask:0xf bank_mask:0xf
v_exp_f32 v37, v37
v_mfma_f32_16x16x32_bf16 a[96:99], v[72:75], a[200:203], a[96:99]
ds_read_b64_tr_b16 a[196:197], v225 offset:32768
v_cvt_pk_bf16_f32 v102, v36, v37
v_mfma_f32_16x16x32_bf16 a[100:103], v[76:79], a[200:203], a[100:103]
v_exp_f32 v38, v38
v_mfma_f32_16x16x32_bf16 a[104:107], v[80:83], a[200:203], a[104:107]
ds_read_b64_tr_b16 a[198:199], v225 offset:36864
ds_read_b64_tr_b16 v[110:111], v241 offset:28928
v_mfma_f32_16x16x32_bf16 a[108:111], v[84:87], a[200:203], a[108:111]
v_exp_f32 v39, v39
v_mfma_f32_16x16x32_bf16 a[124:127], v[84:87], a[204:207], a[124:127]
ds_read_b64_tr_b16 a[200:201], v226 offset:32768
v_cvt_pk_bf16_f32 v103, v38, v39
v_max_u32_dpp v249, v250, v250 row_ror:1 row_mask:0xf bank_mask:0xf
v_mfma_f32_16x16x32_bf16 a[120:123], v[80:83], a[204:207], a[120:123]
ds_read_b64_tr_b16 a[202:203], v226 offset:36864
ds_read_b64_tr_b16 v[112:113], v241 offset:30720
v_mfma_f32_16x16x32_bf16 a[116:119], v[76:79], a[204:207], a[116:119]
buffer_load_dwordx4 v231, s[8:11], s32 offen offset:3072  lds
v_mfma_f32_16x16x32_bf16 a[112:115], v[72:75], a[204:207], a[112:115]
ds_read_b64_tr_b16 a[204:205], v227 offset:32768
ds_read_b64_tr_b16 a[206:207], v227 offset:36864
v_smfmac_f32_16x16x64_bf16 a[132:135], a[208:211], v[80:87], v245
ds_read_b64_tr_b16 v[114:115], v241 offset:30976
v_mov_b32 v250, v249
s_waitcnt lgkmcnt(8)
v_mfma_f32_16x16x32_bf16 v[8:11], a[144:147], v[152:155], v[136:139]
v_exp_f32 v40, v40
v_mfma_f32_16x16x32_bf16 v[8:11], a[148:151], v[156:159], v[8:11]
v_exp_f32 v41, v41
v_mfma_f32_16x16x32_bf16 v[8:11], a[152:155], v[160:163], v[8:11]
v_and_b32 v253, 0x20202020, v253
v_cvt_pk_bf16_f32 v72, v40, v41
v_mfma_f32_16x16x32_bf16 v[8:11], a[156:159], v[164:167], v[8:11]
v_exp_f32 v42, v42
v_mfma_f32_16x16x32_bf16 v[16:19], a[156:159], v[180:183], v[140:143]
s_add_u32 s39, s39, 16384
v_permlane16_swap_b32 v249, v250
v_mfma_f32_16x16x32_bf16 v[16:19], a[152:155], v[176:179], v[16:19]
v_exp_f32 v43, v43
v_mfma_f32_16x16x32_bf16 v[16:19], a[148:151], v[172:175], v[16:19]
v_cvt_pk_bf16_f32 v73, v42, v43
v_max_u32 v249, v249, v250
v_mfma_f32_16x16x32_bf16 v[16:19], a[144:147], v[168:171], v[16:19]
v_exp_f32 v44, v44
v_mfma_f32_16x16x32_bf16 v[24:27], a[144:147], v[184:187], v[144:147]
v_cmp_ne_u32 vcc, 0x20202020, v253
s_cbranch_vccnz SP_FL
SP_FL_RET:
v_mfma_f32_16x16x32_bf16 v[24:27], a[148:151], v[188:191], v[24:27]
v_exp_f32 v45, v45
v_mfma_f32_16x16x32_bf16 v[24:27], a[152:155], v[192:195], v[24:27]
v_cvt_pk_bf16_f32 v74, v44, v45
v_mov_b32 v246, s101
v_mfma_f32_16x16x32_bf16 v[24:27], a[156:159], v[196:199], v[24:27]
v_exp_f32 v46, v46
v_mfma_f32_16x16x32_bf16 v[32:35], a[156:159], v[212:215], v[148:151]
ds_read_b128 a[156:159], v219 offset:57344
s_add_u32 m0, s30, 98304
v_mfma_f32_16x16x32_bf16 v[32:35], a[152:155], v[208:211], v[32:35]
v_mov_b32 v250, v249
v_exp_f32 v47, v47
v_mfma_f32_16x16x32_bf16 v[32:35], a[148:151], v[204:207], v[32:35]
ds_read_b128 a[152:155], v218 offset:57344
v_cvt_pk_bf16_f32 v75, v46, v47
v_mfma_f32_16x16x32_bf16 v[32:35], a[144:147], v[200:203], v[32:35]
v_exp_f32 v48, v48
v_mfma_f32_16x16x32_bf16 a[0:3], v[88:91], a[176:179], a[0:3]
ds_read_b128 a[148:151], v217 offset:57344
ds_read_b128 a[144:147], v216 offset:57344
v_mfma_f32_16x16x32_bf16 a[4:7], v[92:95], a[176:179], a[4:7]
v_permlane32_swap_b32 v249, v250
v_exp_f32 v49, v49
v_mfma_f32_16x16x32_bf16 a[8:11], v[96:99], a[176:179], a[8:11]
v_cvt_pk_bf16_f32 v76, v48, v49
v_mov_b32 v247, s47
v_mfma_f32_16x16x32_bf16 a[12:15], v[100:103], a[176:179], a[12:15]
v_exp_f32 v50, v50
v_mfma_f32_16x16x32_bf16 a[28:31], v[100:103], a[180:183], a[28:31]
ds_read_b64_tr_b16 a[176:177], v220 offset:40960
ds_read_b64_tr_b16 a[178:179], v220 offset:45056
v_mfma_f32_16x16x32_bf16 a[24:27], v[96:99], a[180:183], a[24:27]
v_exp_f32 v51, v51
v_mfma_f32_16x16x32_bf16 a[20:23], v[92:95], a[180:183], a[20:23]
v_cvt_pk_bf16_f32 v77, v50, v51
v_mov_b32 v253, 0
v_max_u32 v249, v249, v250
v_mfma_f32_16x16x32_bf16 a[16:19], v[88:91], a[180:183], a[16:19]
v_exp_f32 v52, v52
v_mfma_f32_16x16x32_bf16 a[32:35], v[88:91], a[184:187], a[32:35]
ds_read_b64_tr_b16 a[180:181], v221 offset:40960
ds_read_b64_tr_b16 a[182:183], v221 offset:45056
v_mfma_f32_16x16x32_bf16 a[36:39], v[92:95], a[184:187], a[36:39]
v_exp_f32 v53, v53
v_mfma_f32_16x16x32_bf16 a[40:43], v[96:99], a[184:187], a[40:43]
s_add_u32 s29, s40, s37
v_cvt_pk_bf16_f32 v78, v52, v53
v_mfma_f32_16x16x32_bf16 a[44:47], v[100:103], a[184:187], a[44:47]
v_add_u32 v251, v251, v249
v_exp_f32 v54, v54
v_mfma_f32_16x16x32_bf16 a[60:63], v[100:103], a[188:191], a[60:63]
ds_read_b64_tr_b16 a[184:185], v222 offset:40960
ds_read_b64_tr_b16 a[186:187], v222 offset:45056
v_mfma_f32_16x16x32_bf16 a[56:59], v[96:99], a[188:191], a[56:59]
v_exp_f32 v55, v55
v_mfma_f32_16x16x32_bf16 a[52:55], v[92:95], a[188:191], a[52:55]
v_cvt_pk_bf16_f32 v79, v54, v55
v_sub_u32 v248, v248, v249
v_mfma_f32_16x16x32_bf16 a[48:51], v[88:91], a[188:191], a[48:51]
v_exp_f32 v56, v56
v_smfmac_f32_16x16x64_bf16 a[128:131], a[208:211], v[88:95], v245
v_exp_f32 v57, v57
v_mfma_f32_16x16x32_bf16 v[12:15], a[160:163], v[152:155], v[136:139]
ds_read_b64_tr_b16 a[188:189], v223 offset:40960
v_cvt_pk_bf16_f32 v80, v56, v57
v_mfma_f32_16x16x32_bf16 v[12:15], a[164:167], v[156:159], v[12:15]
v_exp_f32 v58, v58
v_mfma_f32_16x16x32_bf16 v[12:15], a[168:171], v[160:163], v[12:15]
ds_read_b64_tr_b16 a[190:191], v223 offset:45056
v_cndmask_b32 v252, v252, v251, s[90:91]
v_mfma_f32_16x16x32_bf16 v[12:15], a[172:175], v[164:167], v[12:15]
v_exp_f32 v59, v59
v_mfma_f32_16x16x32_bf16 v[20:23], a[172:175], v[180:183], v[140:143]
s_lshl_b64 s[90:91], s[90:91], 1
v_cvt_pk_bf16_f32 v81, v58, v59
v_mfma_f32_16x16x32_bf16 v[20:23], a[168:171], v[176:179], v[20:23]
v_exp_f32 v60, v60
v_mfma_f32_16x16x32_bf16 v[20:23], a[164:167], v[172:175], v[20:23]
buffer_load_dwordx4 v232, s[12:15], s39 offen offset:0  lds
v_mfma_f32_16x16x32_bf16 v[20:23], a[160:163], v[168:171], v[20:23]
v_exp_f32 v61, v61
v_mfma_f32_16x16x32_bf16 v[28:31], a[160:163], v[184:187], v[144:147]
v_cvt_pk_bf16_f32 v82, v60, v61
v_max_u32_dpp v250, v248, v248 row_ror:8 row_mask:0xf bank_mask:0xf
v_mfma_f32_16x16x32_bf16 v[28:31], a[164:167], v[188:191], v[28:31]
v_exp_f32 v62, v62
v_mfma_f32_16x16x32_bf16 v[28:31], a[168:171], v[192:195], v[28:31]
buffer_load_dwordx4 v233, s[12:15], s39 offen offset:1024  lds
v_mfma_f32_16x16x32_bf16 v[28:31], a[172:175], v[196:199], v[28:31]
v_exp_f32 v63, v63
v_mfma_f32_16x16x32_bf16 v[36:39], a[172:175], v[212:215], v[148:151]
ds_read_b128 a[172:175], v219 offset:61440
v_cvt_pk_bf16_f32 v83, v62, v63
v_mfma_f32_16x16x32_bf16 v[36:39], a[168:171], v[208:211], v[36:39]
v_exp_f32 v64, v64
v_mfma_f32_16x16x32_bf16 v[36:39], a[164:167], v[204:207], v[36:39]
ds_read_b128 a[168:171], v218 offset:61440
ds_read_b128 a[164:167], v217 offset:61440
v_mfma_f32_16x16x32_bf16 v[36:39], a[160:163], v[200:203], v[36:39]
v_exp_f32 v65, v65
v_mfma_f32_16x16x32_bf16 a[64:67], v[88:91], a[192:195], a[64:67]
ds_read_b128 a[160:163], v216 offset:61440
v_cvt_pk_bf16_f32 v84, v64, v65
v_max_u32_dpp v249, v250, v250 row_ror:4 row_mask:0xf bank_mask:0xf
v_mfma_f32_16x16x32_bf16 a[68:71], v[92:95], a[192:195], a[68:71]
v_exp_f32 v66, v66
v_mfma_f32_16x16x32_bf16 a[72:75], v[96:99], a[192:195], a[72:75]
buffer_load_dwordx4 v232, s[12:15], s39 offen offset:2048  lds
v_mfma_f32_16x16x32_bf16 a[76:79], v[100:103], a[192:195], a[76:79]
v_exp_f32 v67, v67
s_waitcnt lgkmcnt(8)
v_mfma_f32_16x16x32_bf16 a[92:95], v[100:103], a[196:199], a[92:95]
ds_read_b64_tr_b16 a[192:193], v224 offset:40960
v_cvt_pk_bf16_f32 v85, v66, v67
v_mfma_f32_16x16x32_bf16 a[88:91], v[96:99], a[196:199], a[88:91]
v_max_u32_dpp v250, v249, v249 row_ror:2 row_mask:0xf bank_mask:0xf
v_exp_f32 v68, v68
v_mfma_f32_16x16x32_bf16 a[84:87], v[92:95], a[196:199], a[84:87]
ds_read_b64_tr_b16 a[194:195], v224 offset:45056
s_cmp_eq_u32 s29, 0
s_cselect_b32 s29, 0x24c000, -16
v_mfma_f32_16x16x32_bf16 a[80:83], v[88:91], a[196:199], a[80:83]
v_exp_f32 v69, v69
v_mfma_f32_16x16x32_bf16 a[96:99], v[88:91], a[200:203], a[96:99]
ds_read_b64_tr_b16 a[196:197], v225 offset:40960
v_cvt_pk_bf16_f32 v86, v68, v69
v_mfma_f32_16x16x32_bf16 a[100:103], v[92:95], a[200:203], a[100:103]
v_max_u32_dpp v249, v250, v250 row_ror:1 row_mask:0xf bank_mask:0xf
v_exp_f32 v70, v70
v_mfma_f32_16x16x32_bf16 a[104:107], v[96:99], a[200:203], a[104:107]
ds_read_b64_tr_b16 a[198:199], v225 offset:45056
buffer_store_dwordx2 v[246:247], v253, s[20:23], s29 offen
v_mfma_f32_16x16x32_bf16 a[108:111], v[100:103], a[200:203], a[108:111]
v_exp_f32 v71, v71
v_mfma_f32_16x16x32_bf16 a[124:127], v[100:103], a[204:207], a[124:127]
ds_read_b64_tr_b16 a[200:201], v226 offset:40960
v_cvt_pk_bf16_f32 v87, v70, v71
v_mfma_f32_16x16x32_bf16 a[120:123], v[96:99], a[204:207], a[120:123]
ds_read_b64_tr_b16 a[202:203], v226 offset:45056
v_mov_b32 v250, v249
v_mfma_f32_16x16x32_bf16 a[116:119], v[92:95], a[204:207], a[116:119]
buffer_load_dwordx4 v233, s[12:15], s39 offen offset:3072  lds
v_mfma_f32_16x16x32_bf16 a[112:115], v[88:91], a[204:207], a[112:115]
ds_read_b64_tr_b16 a[204:205], v227 offset:40960
ds_read_b64_tr_b16 a[206:207], v227 offset:45056
v_smfmac_f32_16x16x64_bf16 a[132:135], a[208:211], v[96:103], v245
STUB_7:
s_cbranch_execz STUB_10
v_permlane16_swap_b32 v249, v250
v_max_u32 v249, v249, v250
v_mfma_f32_16x16x32_bf16 v[40:43], a[144:147], v[152:155], v[136:139]
v_exp_f32 v8, v8
v_mfma_f32_16x16x32_bf16 v[40:43], a[148:151], v[156:159], v[40:43]
v_exp_f32 v9, v9
v_mfma_f32_16x16x32_bf16 v[40:43], a[152:155], v[160:163], v[40:43]
v_cvt_pk_bf16_f32 v88, v8, v9
v_mov_b32 v250, v249
v_mfma_f32_16x16x32_bf16 v[40:43], a[156:159], v[164:167], v[40:43]
v_exp_f32 v10, v10
v_mfma_f32_16x16x32_bf16 v[48:51], a[156:159], v[180:183], v[140:143]
v_permlane32_swap_b32 v249, v250
v_max_u32 v249, v249, v250
v_mfma_f32_16x16x32_bf16 v[48:51], a[152:155], v[176:179], v[48:51]
v_exp_f32 v11, v11
v_mfma_f32_16x16x32_bf16 v[48:51], a[148:151], v[172:175], v[48:51]
v_cvt_pk_bf16_f32 v89, v10, v11
v_add_u32 v251, v251, v249
v_mfma_f32_16x16x32_bf16 v[48:51], a[144:147], v[168:171], v[48:51]
v_exp_f32 v12, v12
v_mfma_f32_16x16x32_bf16 v[56:59], a[144:147], v[184:187], v[144:147]
v_cndmask_b32 v252, v252, v251, s[90:91]
v_mfma_f32_16x16x32_bf16 v[56:59], a[148:151], v[188:191], v[56:59]
v_exp_f32 v13, v13
v_mfma_f32_16x16x32_bf16 v[56:59], a[152:155], v[192:195], v[56:59]
v_cvt_pk_bf16_f32 v90, v12, v13
v_mov_b32 v236, v252
v_mfma_f32_16x16x32_bf16 v[56:59], a[156:159], v[196:199], v[56:59]
v_exp_f32 v14, v14
v_mfma_f32_16x16x32_bf16 v[64:67], a[156:159], v[212:215], v[148:151]
s_waitcnt vmcnt(9) lgkmcnt(0)
s_barrier
v_mfma_f32_16x16x32_bf16 v[64:67], a[152:155], v[208:211], v[64:67]
v_exp_f32 v15, v15
v_mfma_f32_16x16x32_bf16 v[64:67], a[148:151], v[204:207], v[64:67]
ds_read_b128 a[156:159], v219 offset:0
v_cvt_pk_bf16_f32 v91, v14, v15
v_mfma_f32_16x16x32_bf16 v[64:67], a[144:147], v[200:203], v[64:67]
v_exp_f32 v16, v16
v_mfma_f32_16x16x32_bf16 a[0:3], v[72:75], a[176:179], a[0:3]
ds_read_b128 a[152:155], v218 offset:0
ds_read_b128 a[148:151], v217 offset:0
v_mfma_f32_16x16x32_bf16 a[4:7], v[76:79], a[176:179], a[4:7]
v_exp_f32 v17, v17
v_mfma_f32_16x16x32_bf16 a[8:11], v[80:83], a[176:179], a[8:11]
ds_read_b128 a[144:147], v216 offset:0
v_cvt_pk_bf16_f32 v92, v16, v17
v_mfma_f32_16x16x32_bf16 a[12:15], v[84:87], a[176:179], a[12:15]
v_exp_f32 v18, v18
v_mfma_f32_16x16x32_bf16 a[28:31], v[84:87], a[180:183], a[28:31]
ds_read_b64_tr_b16 a[176:177], v220 offset:49152
ds_read_b64_tr_b16 a[178:179], v220 offset:53248
v_mfma_f32_16x16x32_bf16 a[24:27], v[80:83], a[180:183], a[24:27]
v_exp_f32 v19, v19
v_mfma_f32_16x16x32_bf16 a[20:23], v[76:79], a[180:183], a[20:23]
s_add_u32 s32, s32, 16384
v_cvt_pk_bf16_f32 v93, v18, v19
v_mfma_f32_16x16x32_bf16 a[16:19], v[72:75], a[180:183], a[16:19]
v_exp_f32 v20, v20
v_mfma_f32_16x16x32_bf16 a[32:35], v[72:75], a[184:187], a[32:35]
ds_read_b64_tr_b16 a[180:181], v221 offset:49152
ds_read_b64_tr_b16 a[182:183], v221 offset:53248
v_mfma_f32_16x16x32_bf16 a[36:39], v[76:79], a[184:187], a[36:39]
v_exp_f32 v21, v21
v_mfma_f32_16x16x32_bf16 a[40:43], v[80:83], a[184:187], a[40:43]
s_add_u32 m0, s30, 114688
v_cvt_pk_bf16_f32 v94, v20, v21
v_mfma_f32_16x16x32_bf16 a[44:47], v[84:87], a[184:187], a[44:47]
v_exp_f32 v22, v22
v_mfma_f32_16x16x32_bf16 a[60:63], v[84:87], a[188:191], a[60:63]
ds_read_b64_tr_b16 a[184:185], v222 offset:49152
ds_read_b64_tr_b16 a[186:187], v222 offset:53248
v_mfma_f32_16x16x32_bf16 a[56:59], v[80:83], a[188:191], a[56:59]
v_exp_f32 v23, v23
v_mfma_f32_16x16x32_bf16 a[52:55], v[76:79], a[188:191], a[52:55]
v_cvt_pk_bf16_f32 v95, v22, v23
v_and_b32 v252, 0xffff, v252
v_mfma_f32_16x16x32_bf16 a[48:51], v[72:75], a[188:191], a[48:51]
v_exp_f32 v24, v24
v_smfmac_f32_16x16x64_bf16 a[128:131], a[208:211], v[72:79], v245
v_exp_f32 v25, v25
v_mfma_f32_16x16x32_bf16 v[44:47], a[160:163], v[152:155], v[136:139]
ds_read_b64_tr_b16 a[188:189], v223 offset:49152
v_cvt_pk_bf16_f32 v96, v24, v25
v_mfma_f32_16x16x32_bf16 v[44:47], a[164:167], v[156:159], v[44:47]
v_exp_f32 v26, v26
v_mfma_f32_16x16x32_bf16 v[44:47], a[168:171], v[160:163], v[44:47]
ds_read_b64_tr_b16 a[190:191], v223 offset:53248
v_sub_u32 v252, 0xffff, v252
v_mfma_f32_16x16x32_bf16 v[44:47], a[172:175], v[164:167], v[44:47]
v_exp_f32 v27, v27
v_mfma_f32_16x16x32_bf16 v[52:55], a[172:175], v[180:183], v[140:143]
v_cvt_pk_bf16_f32 v97, v26, v27
v_mul_u32_u24 v252, 0x480, v252
v_mfma_f32_16x16x32_bf16 v[52:55], a[168:171], v[176:179], v[52:55]
v_exp_f32 v28, v28
v_mfma_f32_16x16x32_bf16 v[52:55], a[164:167], v[172:175], v[52:55]
buffer_load_dwordx4 v228, s[8:11], s32 offen offset:0  lds
v_mfma_f32_16x16x32_bf16 v[52:55], a[160:163], v[168:171], v[52:55]
v_exp_f32 v29, v29
v_mfma_f32_16x16x32_bf16 v[60:63], a[160:163], v[184:187], v[144:147]
v_cvt_pk_bf16_f32 v98, v28, v29
v_lshrrev_b32 v249, 3, v0
v_mfma_f32_16x16x32_bf16 v[60:63], a[164:167], v[188:191], v[60:63]
v_exp_f32 v30, v30
v_mfma_f32_16x16x32_bf16 v[60:63], a[168:171], v[192:195], v[60:63]
buffer_load_dwordx4 v229, s[8:11], s32 offen offset:1024  lds
v_mfma_f32_16x16x32_bf16 v[60:63], a[172:175], v[196:199], v[60:63]
v_exp_f32 v31, v31
v_mfma_f32_16x16x32_bf16 v[68:71], a[172:175], v[212:215], v[148:151]
ds_read_b128 a[172:175], v219 offset:4096
v_cvt_pk_bf16_f32 v99, v30, v31
v_mfma_f32_16x16x32_bf16 v[68:71], a[168:171], v[208:211], v[68:71]
v_exp_f32 v32, v32
v_mfma_f32_16x16x32_bf16 v[68:71], a[164:167], v[204:207], v[68:71]
ds_read_b128 a[168:171], v218 offset:4096
ds_read_b128 a[164:167], v217 offset:4096
v_mfma_f32_16x16x32_bf16 v[68:71], a[160:163], v[200:203], v[68:71]
v_exp_f32 v33, v33
v_mfma_f32_16x16x32_bf16 a[64:67], v[72:75], a[192:195], a[64:67]
ds_read_b128 a[160:163], v216 offset:4096
v_cvt_pk_bf16_f32 v100, v32, v33
v_mfma_f32_16x16x32_bf16 a[68:71], v[76:79], a[192:195], a[68:71]
v_exp_f32 v34, v34
v_mfma_f32_16x16x32_bf16 a[72:75], v[80:83], a[192:195], a[72:75]
buffer_load_dwordx4 v230, s[8:11], s32 offen offset:2048  lds
v_mfma_f32_16x16x32_bf16 a[76:79], v[84:87], a[192:195], a[76:79]
v_exp_f32 v35, v35
v_mfma_f32_16x16x32_bf16 a[92:95], v[84:87], a[196:199], a[92:95]
ds_read_b64_tr_b16 a[192:193], v224 offset:49152
v_cvt_pk_bf16_f32 v101, v34, v35
v_mfma_f32_16x16x32_bf16 a[88:91], v[80:83], a[196:199], a[88:91]
v_exp_f32 v36, v36
v_mfma_f32_16x16x32_bf16 a[84:87], v[76:79], a[196:199], a[84:87]
ds_read_b64_tr_b16 a[194:195], v224 offset:53248
v_lshl_add_u32 v252, v249, 4, v252
v_mfma_f32_16x16x32_bf16 a[80:83], v[72:75], a[196:199], a[80:83]
v_exp_f32 v37, v37
v_mfma_f32_16x16x32_bf16 a[96:99], v[72:75], a[200:203], a[96:99]
ds_read_b64_tr_b16 a[196:197], v225 offset:49152
v_cvt_pk_bf16_f32 v102, v36, v37
v_mfma_f32_16x16x32_bf16 a[100:103], v[76:79], a[200:203], a[100:103]
v_exp_f32 v38, v38
v_mfma_f32_16x16x32_bf16 a[104:107], v[80:83], a[200:203], a[104:107]
ds_read_b64_tr_b16 a[198:199], v225 offset:53248
v_mfma_f32_16x16x32_bf16 a[108:111], v[84:87], a[200:203], a[108:111]
v_exp_f32 v39, v39
v_mfma_f32_16x16x32_bf16 a[124:127], v[84:87], a[204:207], a[124:127]
ds_read_b64_tr_b16 a[200:201], v226 offset:49152
v_cvt_pk_bf16_f32 v103, v38, v39
v_mfma_f32_16x16x32_bf16 a[120:123], v[80:83], a[204:207], a[120:123]
ds_read_b64_tr_b16 a[202:203], v226 offset:53248
v_mfma_f32_16x16x32_bf16 a[116:119], v[76:79], a[204:207], a[116:119]
buffer_load_dwordx4 v231, s[8:11], s32 offen offset:3072  lds
v_mfma_f32_16x16x32_bf16 a[112:115], v[72:75], a[204:207], a[112:115]
ds_read_b64_tr_b16 a[204:205], v227 offset:49152
ds_read_b64_tr_b16 a[206:207], v227 offset:53248
v_smfmac_f32_16x16x64_bf16 a[132:135], a[208:211], v[80:87], v245
s_add_u32 m0, s86, 0
s_add_u32 s50, s84, 4718592
buffer_load_dwordx4 v240, s[64:67], s50 offen lds
s_add_u32 m0, s86, 4096
s_add_u32 s50, s84, 4718592
buffer_load_dwordx4 v240, s[68:71], s50 offen lds
s_add_u32 m0, s86, 8192
s_add_u32 s50, s85, 0
buffer_load_dwordx4 v244, s[72:75], s50 offen lds
s_add_u32 m0, s86, 12288
s_add_u32 s50, s85, 4096
buffer_load_dwordx4 v244, s[72:75], s50 offen lds
s_waitcnt lgkmcnt(8)
v_mfma_f32_16x16x32_bf16 v[8:11], a[144:147], v[152:155], v[136:139]
v_exp_f32 v40, v40
v_mfma_f32_16x16x32_bf16 v[8:11], a[148:151], v[156:159], v[8:11]
v_exp_f32 v41, v41
v_mfma_f32_16x16x32_bf16 v[8:11], a[152:155], v[160:163], v[8:11]
v_cvt_pk_bf16_f32 v72, v40, v41
v_mfma_f32_16x16x32_bf16 v[8:11], a[156:159], v[164:167], v[8:11]
v_exp_f32 v42, v42
v_mfma_f32_16x16x32_bf16 v[16:19], a[156:159], v[180:183], v[140:143]
s_add_u32 s39, s39, 16384
v_mfma_f32_16x16x32_bf16 v[16:19], a[152:155], v[176:179], v[16:19]
v_exp_f32 v43, v43
v_mfma_f32_16x16x32_bf16 v[16:19], a[148:151], v[172:175], v[16:19]
v_cvt_pk_bf16_f32 v73, v42, v43
v_mfma_f32_16x16x32_bf16 v[16:19], a[144:147], v[168:171], v[16:19]
v_exp_f32 v44, v44
v_mfma_f32_16x16x32_bf16 v[24:27], a[144:147], v[184:187], v[144:147]
s_add_u32 m0, s30, 131072
v_mfma_f32_16x16x32_bf16 v[24:27], a[148:151], v[188:191], v[24:27]
v_exp_f32 v45, v45
v_mfma_f32_16x16x32_bf16 v[24:27], a[152:155], v[192:195], v[24:27]
v_cvt_pk_bf16_f32 v74, v44, v45
v_mfma_f32_16x16x32_bf16 v[24:27], a[156:159], v[196:199], v[24:27]
v_exp_f32 v46, v46
v_mfma_f32_16x16x32_bf16 v[32:35], a[156:159], v[212:215], v[148:151]
ds_read_b128 a[156:159], v219 offset:8192
v_mfma_f32_16x16x32_bf16 v[32:35], a[152:155], v[208:211], v[32:35]
v_exp_f32 v47, v47
v_mfma_f32_16x16x32_bf16 v[32:35], a[148:151], v[204:207], v[32:35]
ds_read_b128 a[152:155], v218 offset:8192
v_cvt_pk_bf16_f32 v75, v46, v47
v_mfma_f32_16x16x32_bf16 v[32:35], a[144:147], v[200:203], v[32:35]
v_exp_f32 v48, v48
v_mfma_f32_16x16x32_bf16 a[0:3], v[88:91], a[176:179], a[0:3]
ds_read_b128 a[148:151], v217 offset:8192
ds_read_b128 a[144:147], v216 offset:8192
v_mfma_f32_16x16x32_bf16 a[4:7], v[92:95], a[176:179], a[4:7]
v_exp_f32 v49, v49
v_mfma_f32_16x16x32_bf16 a[8:11], v[96:99], a[176:179], a[8:11]
v_cvt_pk_bf16_f32 v76, v48, v49
v_mfma_f32_16x16x32_bf16 a[12:15], v[100:103], a[176:179], a[12:15]
v_exp_f32 v50, v50
v_mfma_f32_16x16x32_bf16 a[28:31], v[100:103], a[180:183], a[28:31]
ds_read_b64_tr_b16 a[176:177], v220 offset:57344
ds_read_b64_tr_b16 a[178:179], v220 offset:61440
v_mfma_f32_16x16x32_bf16 a[24:27], v[96:99], a[180:183], a[24:27]
v_exp_f32 v51, v51
v_mfma_f32_16x16x32_bf16 a[20:23], v[92:95], a[180:183], a[20:23]
v_cvt_pk_bf16_f32 v77, v50, v51
v_mfma_f32_16x16x32_bf16 a[16:19], v[88:91], a[180:183], a[16:19]
v_exp_f32 v52, v52
v_mfma_f32_16x16x32_bf16 a[32:35], v[88:91], a[184:187], a[32:35]
ds_read_b64_tr_b16 a[180:181], v221 offset:57344
ds_read_b64_tr_b16 a[182:183], v221 offset:61440
v_mfma_f32_16x16x32_bf16 a[36:39], v[92:95], a[184:187], a[36:39]
v_exp_f32 v53, v53
v_mfma_f32_16x16x32_bf16 a[40:43], v[96:99], a[184:187], a[40:43]
v_cvt_pk_bf16_f32 v78, v52, v53
v_mfma_f32_16x16x32_bf16 a[44:47], v[100:103], a[184:187], a[44:47]
v_exp_f32 v54, v54
v_mfma_f32_16x16x32_bf16 a[60:63], v[100:103], a[188:191], a[60:63]
ds_read_b64_tr_b16 a[184:185], v222 offset:57344
ds_read_b64_tr_b16 a[186:187], v222 offset:61440
v_mfma_f32_16x16x32_bf16 a[56:59], v[96:99], a[188:191], a[56:59]
v_exp_f32 v55, v55
v_mfma_f32_16x16x32_bf16 a[52:55], v[92:95], a[188:191], a[52:55]
v_cvt_pk_bf16_f32 v79, v54, v55
v_mfma_f32_16x16x32_bf16 a[48:51], v[88:91], a[188:191], a[48:51]
v_exp_f32 v56, v56
v_smfmac_f32_16x16x64_bf16 a[128:131], a[208:211], v[88:95], v245
v_exp_f32 v57, v57
v_mfma_f32_16x16x32_bf16 v[12:15], a[160:163], v[152:155], v[136:139]
ds_read_b64_tr_b16 a[188:189], v223 offset:57344
v_cvt_pk_bf16_f32 v80, v56, v57
v_mfma_f32_16x16x32_bf16 v[12:15], a[164:167], v[156:159], v[12:15]
v_exp_f32 v58, v58
v_mfma_f32_16x16x32_bf16 v[12:15], a[168:171], v[160:163], v[12:15]
ds_read_b64_tr_b16 a[190:191], v223 offset:61440
v_mfma_f32_16x16x32_bf16 v[12:15], a[172:175], v[164:167], v[12:15]
v_exp_f32 v59, v59
v_mfma_f32_16x16x32_bf16 v[20:23], a[172:175], v[180:183], v[140:143]
v_cvt_pk_bf16_f32 v81, v58, v59
v_mfma_f32_16x16x32_bf16 v[20:23], a[168:171], v[176:179], v[20:23]
v_exp_f32 v60, v60
v_mfma_f32_16x16x32_bf16 v[20:23], a[164:167], v[172:175], v[20:23]
buffer_load_dwordx4 v232, s[12:15], s39 offen offset:0  lds
v_mfma_f32_16x16x32_bf16 v[20:23], a[160:163], v[168:171], v[20:23]
v_exp_f32 v61, v61
v_mfma_f32_16x16x32_bf16 v[28:31], a[160:163], v[184:187], v[144:147]
v_cvt_pk_bf16_f32 v82, v60, v61
v_mfma_f32_16x16x32_bf16 v[28:31], a[164:167], v[188:191], v[28:31]
v_exp_f32 v62, v62
v_mfma_f32_16x16x32_bf16 v[28:31], a[168:171], v[192:195], v[28:31]
buffer_load_dwordx4 v233, s[12:15], s39 offen offset:1024  lds
v_mfma_f32_16x16x32_bf16 v[28:31], a[172:175], v[196:199], v[28:31]
v_exp_f32 v63, v63
v_mfma_f32_16x16x32_bf16 v[36:39], a[172:175], v[212:215], v[148:151]
ds_read_b128 a[172:175], v219 offset:12288
v_cvt_pk_bf16_f32 v83, v62, v63
v_mfma_f32_16x16x32_bf16 v[36:39], a[168:171], v[208:211], v[36:39]
v_exp_f32 v64, v64
v_mfma_f32_16x16x32_bf16 v[36:39], a[164:167], v[204:207], v[36:39]
ds_read_b128 a[168:171], v218 offset:12288
ds_read_b128 a[164:167], v217 offset:12288
v_mfma_f32_16x16x32_bf16 v[36:39], a[160:163], v[200:203], v[36:39]
v_exp_f32 v65, v65
s_waitcnt lgkmcnt(8)
v_mfma_f32_16x16x32_bf16 a[64:67], v[88:91], a[192:195], a[64:67]
ds_read_b128 a[160:163], v216 offset:12288
v_cvt_pk_bf16_f32 v84, v64, v65
v_mfma_f32_16x16x32_bf16 a[68:71], v[92:95], a[192:195], a[68:71]
v_exp_f32 v66, v66
v_mfma_f32_16x16x32_bf16 a[72:75], v[96:99], a[192:195], a[72:75]
buffer_load_dwordx4 v232, s[12:15], s39 offen offset:2048  lds
v_mfma_f32_16x16x32_bf16 a[76:79], v[100:103], a[192:195], a[76:79]
v_exp_f32 v67, v67
v_mfma_f32_16x16x32_bf16 a[92:95], v[100:103], a[196:199], a[92:95]
ds_read_b64_tr_b16 a[192:193], v224 offset:57344
v_cvt_pk_bf16_f32 v85, v66, v67
v_mfma_f32_16x16x32_bf16 a[88:91], v[96:99], a[196:199], a[88:91]
v_exp_f32 v68, v68
v_mfma_f32_16x16x32_bf16 a[84:87], v[92:95], a[196:199], a[84:87]
ds_read_b64_tr_b16 a[194:195], v224 offset:61440
v_mfma_f32_16x16x32_bf16 a[80:83], v[88:91], a[196:199], a[80:83]
v_exp_f32 v69, v69
v_mfma_f32_16x16x32_bf16 a[96:99], v[88:91], a[200:203], a[96:99]
ds_read_b64_tr_b16 a[196:197], v225 offset:57344
v_cvt_pk_bf16_f32 v86, v68, v69
v_mfma_f32_16x16x32_bf16 a[100:103], v[92:95], a[200:203], a[100:103]
v_exp_f32 v70, v70
v_mfma_f32_16x16x32_bf16 a[104:107], v[96:99], a[200:203], a[104:107]
ds_read_b64_tr_b16 a[198:199], v225 offset:61440
v_mfma_f32_16x16x32_bf16 a[108:111], v[100:103], a[200:203], a[108:111]
v_exp_f32 v71, v71
v_mfma_f32_16x16x32_bf16 a[124:127], v[100:103], a[204:207], a[124:127]
ds_read_b64_tr_b16 a[200:201], v226 offset:57344
v_cvt_pk_bf16_f32 v87, v70, v71
v_mfma_f32_16x16x32_bf16 a[120:123], v[96:99], a[204:207], a[120:123]
ds_read_b64_tr_b16 a[202:203], v226 offset:61440
v_mfma_f32_16x16x32_bf16 a[116:119], v[92:95], a[204:207], a[116:119]
buffer_load_dwordx4 v233, s[12:15], s39 offen offset:3072  lds
v_mfma_f32_16x16x32_bf16 a[112:115], v[88:91], a[204:207], a[112:115]
ds_read_b64_tr_b16 a[204:205], v227 offset:57344
ds_read_b64_tr_b16 a[206:207], v227 offset:61440
v_smfmac_f32_16x16x64_bf16 a[132:135], a[208:211], v[96:103], v245
s_add_u32 m0, s86, 45056
s_mov_b32 s50, 29360128
buffer_load_dwordx4 v252, s[20:23], s50 offen sc0 sc1 lds
s_add_u32 m0, s86, 49152
s_mov_b32 s50, 29360640
buffer_load_dwordx4 v252, s[20:23], s50 offen sc0 sc1 lds
s_add_u32 m0, s86, 53248
s_mov_b32 s50, 29361152
buffer_load_dwordx4 v252, s[20:23], s50 offen sc0 sc1 lds
s_add_u32 m0, s86, 16384
s_add_u32 s50, s85, 8192
buffer_load_dwordx4 v244, s[72:75], s50 offen lds
v_mfma_f32_16x16x32_bf16 v[40:43], a[144:147], v[152:155], v[136:139]
v_mov_b32 v248, v236
v_exp_f32 v8, v8
v_mfma_f32_16x16x32_bf16 v[40:43], a[148:151], v[156:159], v[40:43]
v_mov_b32 v249, s47
v_exp_f32 v9, v9
v_mfma_f32_16x16x32_bf16 v[40:43], a[152:155], v[160:163], v[40:43]
v_cvt_pk_bf16_f32 v88, v8, v9
v_and_b32 v250, 7, v1
v_lshlrev_b32 v250, 3, v250
v_mfma_f32_16x16x32_bf16 v[40:43], a[156:159], v[164:167], v[40:43]
s_add_u32 s29, s40, s37
v_exp_f32 v10, v10
v_mfma_f32_16x16x32_bf16 v[48:51], a[156:159], v[180:183], v[140:143]
s_cmp_eq_u32 s29, 0
s_mov_b32 s29, 0x7ffffff0
s_cselect_b32 s29, 0x242800, s29
v_mfma_f32_16x16x32_bf16 v[48:51], a[152:155], v[176:179], v[48:51]
v_exp_f32 v11, v11
v_mfma_f32_16x16x32_bf16 v[48:51], a[148:151], v[172:175], v[48:51]
v_cvt_pk_bf16_f32 v89, v10, v11
v_mfma_f32_16x16x32_bf16 v[48:51], a[144:147], v[168:171], v[48:51]
v_exp_f32 v12, v12
v_mfma_f32_16x16x32_bf16 v[56:59], a[144:147], v[184:187], v[144:147]
v_mfma_f32_16x16x32_bf16 v[56:59], a[148:151], v[188:191], v[56:59]
v_exp_f32 v13, v13
v_mfma_f32_16x16x32_bf16 v[56:59], a[152:155], v[192:195], v[56:59]
v_cvt_pk_bf16_f32 v90, v12, v13
v_mfma_f32_16x16x32_bf16 v[56:59], a[156:159], v[196:199], v[56:59]
v_exp_f32 v14, v14
v_mfma_f32_16x16x32_bf16 v[64:67], a[156:159], v[212:215], v[148:151]
s_waitcnt vmcnt(16) lgkmcnt(0)
s_barrier
v_mfma_f32_16x16x32_bf16 v[64:67], a[152:155], v[208:211], v[64:67]
v_exp_f32 v15, v15
v_mfma_f32_16x16x32_bf16 v[64:67], a[148:151], v[204:207], v[64:67]
ds_read_b128 a[156:159], v219 offset:16384
v_cvt_pk_bf16_f32 v91, v14, v15
v_mfma_f32_16x16x32_bf16 v[64:67], a[144:147], v[200:203], v[64:67]
v_exp_f32 v16, v16
v_mfma_f32_16x16x32_bf16 a[0:3], v[72:75], a[176:179], a[0:3]
ds_read_b128 a[152:155], v218 offset:16384
ds_read_b128 a[148:151], v217 offset:16384
v_mfma_f32_16x16x32_bf16 a[4:7], v[76:79], a[176:179], a[4:7]
v_exp_f32 v17, v17
v_mfma_f32_16x16x32_bf16 a[8:11], v[80:83], a[176:179], a[8:11]
ds_read_b128 a[144:147], v216 offset:16384
v_cvt_pk_bf16_f32 v92, v16, v17
v_mfma_f32_16x16x32_bf16 a[12:15], v[84:87], a[176:179], a[12:15]
v_exp_f32 v18, v18
v_mfma_f32_16x16x32_bf16 a[28:31], v[84:87], a[180:183], a[28:31]
ds_read_b64_tr_b16 a[176:177], v220 offset:0
ds_read_b64_tr_b16 a[178:179], v220 offset:4096
v_mfma_f32_16x16x32_bf16 a[24:27], v[80:83], a[180:183], a[24:27]
v_exp_f32 v19, v19
v_mfma_f32_16x16x32_bf16 a[20:23], v[76:79], a[180:183], a[20:23]
s_add_u32 s32, s32, 16384
v_cvt_pk_bf16_f32 v93, v18, v19
v_mfma_f32_16x16x32_bf16 a[16:19], v[72:75], a[180:183], a[16:19]
v_exp_f32 v20, v20
v_mfma_f32_16x16x32_bf16 a[32:35], v[72:75], a[184:187], a[32:35]
ds_read_b64_tr_b16 a[180:181], v221 offset:0
ds_read_b64_tr_b16 a[182:183], v221 offset:4096
v_mfma_f32_16x16x32_bf16 a[36:39], v[76:79], a[184:187], a[36:39]
v_exp_f32 v21, v21
v_mfma_f32_16x16x32_bf16 a[40:43], v[80:83], a[184:187], a[40:43]
s_add_u32 m0, s30, 65536
v_cvt_pk_bf16_f32 v94, v20, v21
v_mfma_f32_16x16x32_bf16 a[44:47], v[84:87], a[184:187], a[44:47]
v_exp_f32 v22, v22
v_mfma_f32_16x16x32_bf16 a[60:63], v[84:87], a[188:191], a[60:63]
ds_read_b64_tr_b16 a[184:185], v222 offset:0
ds_read_b64_tr_b16 a[186:187], v222 offset:4096
v_mfma_f32_16x16x32_bf16 a[56:59], v[80:83], a[188:191], a[56:59]
v_exp_f32 v23, v23
v_mfma_f32_16x16x32_bf16 a[52:55], v[76:79], a[188:191], a[52:55]
buffer_store_dwordx2 v[248:249], v250, s[20:23], s29 offen sc0 sc1
v_cvt_pk_bf16_f32 v95, v22, v23
v_mfma_f32_16x16x32_bf16 a[48:51], v[72:75], a[188:191], a[48:51]
v_ashrrev_i32 v246, 31, v236
v_exp_f32 v24, v24
v_smfmac_f32_16x16x64_bf16 a[128:131], a[208:211], v[72:79], v245
v_not_b32 v246, v246
v_exp_f32 v25, v25
v_mfma_f32_16x16x32_bf16 v[44:47], a[160:163], v[152:155], v[136:139]
ds_read_b64_tr_b16 a[188:189], v223 offset:0
v_cvt_pk_bf16_f32 v96, v24, v25
v_or_b32 v246, 0x80000000, v246
v_mfma_f32_16x16x32_bf16 v[44:47], a[164:167], v[156:159], v[44:47]
v_xor_b32 v236, v236, v246
v_exp_f32 v26, v26
v_mfma_f32_16x16x32_bf16 v[44:47], a[168:171], v[160:163], v[44:47]
ds_read_b64_tr_b16 a[190:191], v223 offset:4096
v_and_b32 v236, 0xffff0000, v236
v_mul_f32 v236, 0xbfb8aa3b, v236
v_mfma_f32_16x16x32_bf16 v[44:47], a[172:175], v[164:167], v[44:47]
v_exp_f32 v27, v27
v_mfma_f32_16x16x32_bf16 v[52:55], a[172:175], v[180:183], v[140:143]
v_cvt_pk_bf16_f32 v97, v26, v27
v_exp_f32 v236, v236
v_mfma_f32_16x16x32_bf16 v[52:55], a[168:171], v[176:179], v[52:55]
v_add_f32 v236, 1.0, v236
v_exp_f32 v28, v28
v_mfma_f32_16x16x32_bf16 v[52:55], a[164:167], v[172:175], v[52:55]
buffer_load_dwordx4 v228, s[8:11], s32 offen offset:0  lds
v_mfma_f32_16x16x32_bf16 v[52:55], a[160:163], v[168:171], v[52:55]
v_exp_f32 v29, v29
v_mfma_f32_16x16x32_bf16 v[60:63], a[160:163], v[184:187], v[144:147]
v_cvt_pk_bf16_f32 v98, v28, v29
v_rcp_f32 v236, v236
v_mfma_f32_16x16x32_bf16 v[60:63], a[164:167], v[188:191], v[60:63]
v_cvt_pk_bf16_f32 v236, v236, v236
v_exp_f32 v30, v30
v_mfma_f32_16x16x32_bf16 v[60:63], a[168:171], v[192:195], v[60:63]
buffer_load_dwordx4 v229, s[8:11], s32 offen offset:1024  lds
v_lshlrev_b32 v236, 16, v236
v_mfma_f32_16x16x32_bf16 v[60:63], a[172:175], v[196:199], v[60:63]
v_exp_f32 v31, v31
v_mfma_f32_16x16x32_bf16 v[68:71], a[172:175], v[212:215], v[148:151]
ds_read_b128 a[172:175], v219 offset:20480
s_lshr_b32 s28, s37, 1
v_cvt_pk_bf16_f32 v99, v30, v31
v_mfma_f32_16x16x32_bf16 v[68:71], a[168:171], v[208:211], v[68:71]
v_exp_f32 v32, v32
v_mfma_f32_16x16x32_bf16 v[68:71], a[164:167], v[204:207], v[68:71]
ds_read_b128 a[168:171], v218 offset:20480
ds_read_b128 a[164:167], v217 offset:20480
v_mfma_f32_16x16x32_bf16 v[68:71], a[160:163], v[200:203], v[68:71]
v_exp_f32 v33, v33
v_mfma_f32_16x16x32_bf16 a[64:67], v[72:75], a[192:195], a[64:67]
ds_read_b128 a[160:163], v216 offset:20480
s_mul_i32 s28, s28, 28672
v_cvt_pk_bf16_f32 v100, v32, v33
v_mfma_f32_16x16x32_bf16 a[68:71], v[76:79], a[192:195], a[68:71]
v_exp_f32 v34, v34
v_mfma_f32_16x16x32_bf16 a[72:75], v[80:83], a[192:195], a[72:75]
buffer_load_dwordx4 v230, s[8:11], s32 offen offset:2048  lds
v_mfma_f32_16x16x32_bf16 a[76:79], v[84:87], a[192:195], a[76:79]
v_exp_f32 v35, v35
v_mfma_f32_16x16x32_bf16 a[92:95], v[84:87], a[196:199], a[92:95]
ds_read_b64_tr_b16 a[192:193], v224 offset:0
v_cvt_pk_bf16_f32 v101, v34, v35
v_mfma_f32_16x16x32_bf16 a[88:91], v[80:83], a[196:199], a[88:91]
v_subrev_u32 v241, s28, v241
v_exp_f32 v36, v36
v_mfma_f32_16x16x32_bf16 a[84:87], v[76:79], a[196:199], a[84:87]
ds_read_b64_tr_b16 a[194:195], v224 offset:4096
v_and_b32 v239, 7, v1
v_mfma_f32_16x16x32_bf16 a[80:83], v[72:75], a[196:199], a[80:83]
v_exp_f32 v37, v37
v_mfma_f32_16x16x32_bf16 a[96:99], v[72:75], a[200:203], a[96:99]
ds_read_b64_tr_b16 a[196:197], v225 offset:0
v_cvt_pk_bf16_f32 v102, v36, v37
v_mfma_f32_16x16x32_bf16 a[100:103], v[76:79], a[200:203], a[100:103]
v_exp_f32 v38, v38
v_mfma_f32_16x16x32_bf16 a[104:107], v[80:83], a[200:203], a[104:107]
ds_read_b64_tr_b16 a[198:199], v225 offset:4096
v_lshl_add_u32 v239, v4, 3, v239
v_mfma_f32_16x16x32_bf16 a[108:111], v[84:87], a[200:203], a[108:111]
v_exp_f32 v39, v39
v_mfma_f32_16x16x32_bf16 a[124:127], v[84:87], a[204:207], a[124:127]
ds_read_b64_tr_b16 a[200:201], v226 offset:0
v_cvt_pk_bf16_f32 v103, v38, v39
v_mfma_f32_16x16x32_bf16 a[120:123], v[80:83], a[204:207], a[120:123]
ds_read_b64_tr_b16 a[202:203], v226 offset:4096
v_lshlrev_b32 v239, 4, v239
v_mfma_f32_16x16x32_bf16 a[116:119], v[76:79], a[204:207], a[116:119]
buffer_load_dwordx4 v231, s[8:11], s32 offen offset:3072  lds
v_mfma_f32_16x16x32_bf16 a[112:115], v[72:75], a[204:207], a[112:115]
ds_read_b64_tr_b16 a[204:205], v227 offset:0
ds_read_b64_tr_b16 a[206:207], v227 offset:4096
v_smfmac_f32_16x16x64_bf16 a[132:135], a[208:211], v[80:87], v245
s_add_u32 m0, s86, 20480
s_add_u32 s50, s85, 12288
buffer_load_dwordx4 v244, s[72:75], s50 offen lds
s_add_u32 m0, s86, 24576
s_add_u32 s50, s85, 16384
buffer_load_dwordx4 v244, s[72:75], s50 offen lds
s_add_u32 m0, s86, 28672
s_add_u32 s50, s85, 20480
buffer_load_dwordx4 v244, s[72:75], s50 offen lds
s_waitcnt lgkmcnt(8)
v_mfma_f32_16x16x32_bf16 v[8:11], a[144:147], v[152:155], v[136:139]
v_exp_f32 v40, v40
v_mfma_f32_16x16x32_bf16 v[8:11], a[148:151], v[156:159], v[8:11]
v_exp_f32 v41, v41
v_mfma_f32_16x16x32_bf16 v[8:11], a[152:155], v[160:163], v[8:11]
v_cvt_pk_bf16_f32 v72, v40, v41
v_add_u32 v237, s31, v244
v_mfma_f32_16x16x32_bf16 v[8:11], a[156:159], v[164:167], v[8:11]
v_exp_f32 v42, v42
v_mfma_f32_16x16x32_bf16 v[16:19], a[156:159], v[180:183], v[140:143]
s_add_u32 s39, s39, 16384
v_lshl_add_u32 v238, v4, 3, v3
v_mfma_f32_16x16x32_bf16 v[16:19], a[152:155], v[176:179], v[16:19]
v_exp_f32 v43, v43
v_mfma_f32_16x16x32_bf16 v[16:19], a[148:151], v[172:175], v[16:19]
v_cvt_pk_bf16_f32 v73, v42, v43
v_lshlrev_b32 v238, 4, v238
v_mfma_f32_16x16x32_bf16 v[16:19], a[144:147], v[168:171], v[16:19]
v_exp_f32 v44, v44
v_mfma_f32_16x16x32_bf16 v[24:27], a[144:147], v[184:187], v[144:147]
v_mov_b32 v246, 0x7ffffff0
v_cmp_lt_u32 vcc, 7, v3
v_mfma_f32_16x16x32_bf16 v[24:27], a[148:151], v[188:191], v[24:27]
v_exp_f32 v45, v45
v_mfma_f32_16x16x32_bf16 v[24:27], a[152:155], v[192:195], v[24:27]
s_add_u32 m0, s30, 147456
v_cvt_pk_bf16_f32 v74, v44, v45
v_mfma_f32_16x16x32_bf16 v[24:27], a[156:159], v[196:199], v[24:27]
v_exp_f32 v46, v46
v_mfma_f32_16x16x32_bf16 v[32:35], a[156:159], v[212:215], v[148:151]
ds_read_b128 a[156:159], v219 offset:24576
v_cndmask_b32 v238, v238, v246, vcc
v_mfma_f32_16x16x32_bf16 v[32:35], a[152:155], v[208:211], v[32:35]
v_exp_f32 v47, v47
v_mfma_f32_16x16x32_bf16 v[32:35], a[148:151], v[204:207], v[32:35]
ds_read_b128 a[152:155], v218 offset:24576
v_cvt_pk_bf16_f32 v75, v46, v47
v_mfma_f32_16x16x32_bf16 v[32:35], a[144:147], v[200:203], v[32:35]
v_exp_f32 v48, v48
v_mfma_f32_16x16x32_bf16 a[0:3], v[88:91], a[176:179], a[0:3]
ds_read_b128 a[148:151], v217 offset:24576
ds_read_b128 a[144:147], v216 offset:24576
v_mfma_f32_16x16x32_bf16 a[4:7], v[92:95], a[176:179], a[4:7]
v_exp_f32 v49, v49
v_mfma_f32_16x16x32_bf16 a[8:11], v[96:99], a[176:179], a[8:11]
s_mul_i32 s28, s40, 18432
v_cvt_pk_bf16_f32 v76, v48, v49
v_mfma_f32_16x16x32_bf16 a[12:15], v[100:103], a[176:179], a[12:15]
v_exp_f32 v50, v50
v_mfma_f32_16x16x32_bf16 a[28:31], v[100:103], a[180:183], a[28:31]
ds_read_b64_tr_b16 a[176:177], v220 offset:8192
ds_read_b64_tr_b16 a[178:179], v220 offset:12288
v_mfma_f32_16x16x32_bf16 a[24:27], v[96:99], a[180:183], a[24:27]
v_exp_f32 v51, v51
v_mfma_f32_16x16x32_bf16 a[20:23], v[92:95], a[180:183], a[20:23]
s_mul_i32 s29, s37, 4608
v_cvt_pk_bf16_f32 v77, v50, v51
v_mfma_f32_16x16x32_bf16 a[16:19], v[88:91], a[180:183], a[16:19]
v_exp_f32 v52, v52
v_mfma_f32_16x16x32_bf16 a[32:35], v[88:91], a[184:187], a[32:35]
ds_read_b64_tr_b16 a[180:181], v221 offset:8192
ds_read_b64_tr_b16 a[182:183], v221 offset:12288
v_mfma_f32_16x16x32_bf16 a[36:39], v[92:95], a[184:187], a[36:39]
v_exp_f32 v53, v53
v_mfma_f32_16x16x32_bf16 a[40:43], v[96:99], a[184:187], a[40:43]
s_add_u32 s28, s28, s29
v_cvt_pk_bf16_f32 v78, v52, v53
v_mfma_f32_16x16x32_bf16 a[44:47], v[100:103], a[184:187], a[44:47]
v_exp_f32 v54, v54
v_mfma_f32_16x16x32_bf16 a[60:63], v[100:103], a[188:191], a[60:63]
ds_read_b64_tr_b16 a[184:185], v222 offset:8192
ds_read_b64_tr_b16 a[186:187], v222 offset:12288
v_mfma_f32_16x16x32_bf16 a[56:59], v[96:99], a[188:191], a[56:59]
v_exp_f32 v55, v55
v_mfma_f32_16x16x32_bf16 a[52:55], v[92:95], a[188:191], a[52:55]
s_add_u32 s28, s28, 0x2000000
STUB_8:
s_cbranch_execz STUB_11
v_cvt_pk_bf16_f32 v79, v54, v55
v_mfma_f32_16x16x32_bf16 a[48:51], v[88:91], a[188:191], a[48:51]
v_exp_f32 v56, v56
v_smfmac_f32_16x16x64_bf16 a[128:131], a[208:211], v[88:95], v245
v_exp_f32 v57, v57
v_mfma_f32_16x16x32_bf16 v[12:15], a[160:163], v[152:155], v[136:139]
ds_read_b64_tr_b16 a[188:189], v223 offset:8192
v_cvt_pk_bf16_f32 v80, v56, v57
v_mfma_f32_16x16x32_bf16 v[12:15], a[164:167], v[156:159], v[12:15]
v_exp_f32 v58, v58
v_mfma_f32_16x16x32_bf16 v[12:15], a[168:171], v[160:163], v[12:15]
ds_read_b64_tr_b16 a[190:191], v223 offset:12288
v_mfma_f32_16x16x32_bf16 v[12:15], a[172:175], v[164:167], v[12:15]
v_exp_f32 v59, v59
v_mfma_f32_16x16x32_bf16 v[20:23], a[172:175], v[180:183], v[140:143]
v_cvt_pk_bf16_f32 v81, v58, v59
v_mfma_f32_16x16x32_bf16 v[20:23], a[168:171], v[176:179], v[20:23]
v_exp_f32 v60, v60
v_mfma_f32_16x16x32_bf16 v[20:23], a[164:167], v[172:175], v[20:23]
buffer_load_dwordx4 v232, s[12:15], s39 offen offset:0  lds
v_mfma_f32_16x16x32_bf16 v[20:23], a[160:163], v[168:171], v[20:23]
v_exp_f32 v61, v61
v_mfma_f32_16x16x32_bf16 v[28:31], a[160:163], v[184:187], v[144:147]
v_cvt_pk_bf16_f32 v82, v60, v61
v_mfma_f32_16x16x32_bf16 v[28:31], a[164:167], v[188:191], v[28:31]
v_exp_f32 v62, v62
v_mfma_f32_16x16x32_bf16 v[28:31], a[168:171], v[192:195], v[28:31]
buffer_load_dwordx4 v233, s[12:15], s39 offen offset:1024  lds
v_mfma_f32_16x16x32_bf16 v[28:31], a[172:175], v[196:199], v[28:31]
v_exp_f32 v63, v63
v_mfma_f32_16x16x32_bf16 v[36:39], a[172:175], v[212:215], v[148:151]
ds_read_b128 a[172:175], v219 offset:28672
v_cvt_pk_bf16_f32 v83, v62, v63
v_mfma_f32_16x16x32_bf16 v[36:39], a[168:171], v[208:211], v[36:39]
v_exp_f32 v64, v64
v_mfma_f32_16x16x32_bf16 v[36:39], a[164:167], v[204:207], v[36:39]
ds_read_b128 a[168:171], v218 offset:28672
ds_read_b128 a[164:167], v217 offset:28672
v_mfma_f32_16x16x32_bf16 v[36:39], a[160:163], v[200:203], v[36:39]
v_exp_f32 v65, v65
s_waitcnt lgkmcnt(8)
v_mfma_f32_16x16x32_bf16 a[64:67], v[88:91], a[192:195], a[64:67]
ds_read_b128 a[160:163], v216 offset:28672
v_cvt_pk_bf16_f32 v84, v64, v65
v_mfma_f32_16x16x32_bf16 a[68:71], v[92:95], a[192:195], a[68:71]
v_exp_f32 v66, v66
v_mfma_f32_16x16x32_bf16 a[72:75], v[96:99], a[192:195], a[72:75]
buffer_load_dwordx4 v232, s[12:15], s39 offen offset:2048  lds
v_mfma_f32_16x16x32_bf16 a[76:79], v[100:103], a[192:195], a[76:79]
v_exp_f32 v67, v67
v_mfma_f32_16x16x32_bf16 a[92:95], v[100:103], a[196:199], a[92:95]
ds_read_b64_tr_b16 a[192:193], v224 offset:8192
v_cvt_pk_bf16_f32 v85, v66, v67
v_mfma_f32_16x16x32_bf16 a[88:91], v[96:99], a[196:199], a[88:91]
v_exp_f32 v68, v68
v_mfma_f32_16x16x32_bf16 a[84:87], v[92:95], a[196:199], a[84:87]
ds_read_b64_tr_b16 a[194:195], v224 offset:12288
s_cmp_lt_u32 s37, 2
s_cselect_b64 s[90:91], -1, 0
v_mfma_f32_16x16x32_bf16 a[80:83], v[88:91], a[196:199], a[80:83]
v_exp_f32 v69, v69
v_mfma_f32_16x16x32_bf16 a[96:99], v[88:91], a[200:203], a[96:99]
ds_read_b64_tr_b16 a[196:197], v225 offset:8192
v_cvt_pk_bf16_f32 v86, v68, v69
v_mfma_f32_16x16x32_bf16 a[100:103], v[92:95], a[200:203], a[100:103]
v_exp_f32 v70, v70
v_mfma_f32_16x16x32_bf16 a[104:107], v[96:99], a[200:203], a[104:107]
ds_read_b64_tr_b16 a[198:199], v225 offset:12288
v_mfma_f32_16x16x32_bf16 a[108:111], v[100:103], a[200:203], a[108:111]
v_exp_f32 v71, v71
v_mfma_f32_16x16x32_bf16 a[124:127], v[100:103], a[204:207], a[124:127]
ds_read_b64_tr_b16 a[200:201], v226 offset:8192
v_cvt_pk_bf16_f32 v87, v70, v71
v_mfma_f32_16x16x32_bf16 a[120:123], v[96:99], a[204:207], a[120:123]
ds_read_b64_tr_b16 a[202:203], v226 offset:12288
v_mfma_f32_16x16x32_bf16 a[116:119], v[92:95], a[204:207], a[116:119]
buffer_load_dwordx4 v233, s[12:15], s39 offen offset:3072  lds
v_mfma_f32_16x16x32_bf16 a[112:115], v[88:91], a[204:207], a[112:115]
ds_read_b64_tr_b16 a[204:205], v227 offset:8192
ds_read_b64_tr_b16 a[206:207], v227 offset:12288
v_smfmac_f32_16x16x64_bf16 a[132:135], a[208:211], v[96:103], v245
s_add_u32 m0, s86, 32768
s_add_u32 s50, s85, 24576
buffer_load_dwordx4 v244, s[72:75], s50 offen lds
s_add_u32 m0, s86, 36864
s_add_u32 s50, s85, 28672
buffer_load_dwordx4 v244, s[72:75], s50 offen lds
s_add_u32 m0, s86, 40960
s_add_u32 s50, s85, 32768
buffer_load_dwordx4 v244, s[72:75], s50 offen lds
v_mfma_f32_16x16x32_bf16 v[40:43], a[144:147], v[152:155], v[136:139]
v_exp_f32 v8, v8
v_mfma_f32_16x16x32_bf16 v[40:43], a[148:151], v[156:159], v[40:43]
v_exp_f32 v9, v9
v_mfma_f32_16x16x32_bf16 v[40:43], a[152:155], v[160:163], v[40:43]
v_cvt_pk_bf16_f32 v88, v8, v9
v_mfma_f32_16x16x32_bf16 v[40:43], a[156:159], v[164:167], v[40:43]
v_exp_f32 v10, v10
v_mfma_f32_16x16x32_bf16 v[48:51], a[156:159], v[180:183], v[140:143]
v_mfma_f32_16x16x32_bf16 v[48:51], a[152:155], v[176:179], v[48:51]
v_exp_f32 v11, v11
v_mfma_f32_16x16x32_bf16 v[48:51], a[148:151], v[172:175], v[48:51]
v_cvt_pk_bf16_f32 v89, v10, v11
v_mfma_f32_16x16x32_bf16 v[48:51], a[144:147], v[168:171], v[48:51]
v_exp_f32 v12, v12
v_mfma_f32_16x16x32_bf16 v[56:59], a[144:147], v[184:187], v[144:147]
v_mfma_f32_16x16x32_bf16 v[56:59], a[148:151], v[188:191], v[56:59]
v_exp_f32 v13, v13
v_mfma_f32_16x16x32_bf16 v[56:59], a[152:155], v[192:195], v[56:59]
v_cvt_pk_bf16_f32 v90, v12, v13
v_mfma_f32_16x16x32_bf16 v[56:59], a[156:159], v[196:199], v[56:59]
v_exp_f32 v14, v14
v_mfma_f32_16x16x32_bf16 v[64:67], a[156:159], v[212:215], v[148:151]
s_waitcnt vmcnt(15) lgkmcnt(0)
s_barrier
v_mfma_f32_16x16x32_bf16 v[64:67], a[152:155], v[208:211], v[64:67]
ds_read_b128 v[124:127], v239 offset:45056
v_exp_f32 v15, v15
v_mfma_f32_16x16x32_bf16 v[64:67], a[148:151], v[204:207], v[64:67]
ds_read_b128 a[156:159], v219 offset:49152
ds_read_b128 v[128:131], v239 offset:45568
v_cvt_pk_bf16_f32 v91, v14, v15
v_mfma_f32_16x16x32_bf16 v[64:67], a[144:147], v[200:203], v[64:67]
ds_read_b128 v[248:251], v239 offset:46080
v_exp_f32 v16, v16
v_mfma_f32_16x16x32_bf16 a[0:3], v[72:75], a[176:179], a[0:3]
ds_read_b128 a[152:155], v218 offset:49152
ds_read_b128 a[148:151], v217 offset:49152
ds_read_b128 v[252:255], v239 offset:46592
v_mfma_f32_16x16x32_bf16 a[4:7], v[76:79], a[176:179], a[4:7]
ds_read_b64_tr_b16 v[116:117], v241 offset:0
v_exp_f32 v17, v17
v_mfma_f32_16x16x32_bf16 a[8:11], v[80:83], a[176:179], a[8:11]
ds_read_b128 a[144:147], v216 offset:49152
ds_read_b64_tr_b16 v[118:119], v241 offset:256
v_cvt_pk_bf16_f32 v92, v16, v17
v_mfma_f32_16x16x32_bf16 a[12:15], v[84:87], a[176:179], a[12:15]
ds_read_b64_tr_b16 v[120:121], v241 offset:2048
v_exp_f32 v18, v18
v_mfma_f32_16x16x32_bf16 a[28:31], v[84:87], a[180:183], a[28:31]
ds_read_b64_tr_b16 a[176:177], v220 offset:32768
ds_read_b64_tr_b16 a[178:179], v220 offset:36864
ds_read_b64_tr_b16 v[122:123], v241 offset:2304
v_mfma_f32_16x16x32_bf16 a[24:27], v[80:83], a[180:183], a[24:27]
v_exp_f32 v19, v19
v_mfma_f32_16x16x32_bf16 a[20:23], v[76:79], a[180:183], a[20:23]
s_add_u32 s32, s32, 16384
v_cvt_pk_bf16_f32 v93, v18, v19
v_mfma_f32_16x16x32_bf16 a[16:19], v[72:75], a[180:183], a[16:19]
v_exp_f32 v20, v20
v_mfma_f32_16x16x32_bf16 a[32:35], v[72:75], a[184:187], a[32:35]
ds_read_b64_tr_b16 a[180:181], v221 offset:32768
ds_read_b64_tr_b16 a[182:183], v221 offset:36864
v_mfma_f32_16x16x32_bf16 a[36:39], v[76:79], a[184:187], a[36:39]
v_exp_f32 v21, v21
v_mfma_f32_16x16x32_bf16 a[40:43], v[80:83], a[184:187], a[40:43]
s_add_u32 m0, s30, 81920
v_cvt_pk_bf16_f32 v94, v20, v21
s_waitcnt lgkmcnt(8)
v_mfma_f32_16x16x32_bf16 v[132:135], a[212:215], v[124:127], 0
ds_read_b128 v[124:127], v239 offset:47104
v_mfma_f32_16x16x32_bf16 a[44:47], v[84:87], a[184:187], a[44:47]
v_exp_f32 v22, v22
v_mfma_f32_16x16x32_bf16 a[60:63], v[84:87], a[188:191], a[60:63]
ds_read_b64_tr_b16 a[184:185], v222 offset:32768
ds_read_b64_tr_b16 a[186:187], v222 offset:36864
v_mfma_f32_16x16x32_bf16 v[132:135], a[216:219], v[128:131], v[132:135]
ds_read_b128 v[128:131], v239 offset:47616
v_mfma_f32_16x16x32_bf16 a[56:59], v[80:83], a[188:191], a[56:59]
v_exp_f32 v23, v23
v_mfma_f32_16x16x32_bf16 a[52:55], v[76:79], a[188:191], a[52:55]
v_cvt_pk_bf16_f32 v95, v22, v23
v_mfma_f32_16x16x32_bf16 v[132:135], a[220:223], v[248:251], v[132:135]
buffer_load_dwordx4 v228, s[8:11], s32 offen offset:0  lds
ds_read_b128 v[248:251], v239 offset:48128
v_mfma_f32_16x16x32_bf16 a[48:51], v[72:75], a[188:191], a[48:51]
v_exp_f32 v24, v24
v_smfmac_f32_16x16x64_bf16 a[128:131], a[208:211], v[72:79], v245
v_exp_f32 v25, v25
v_mfma_f32_16x16x32_bf16 v[132:135], a[224:227], v[252:255], v[132:135]
ds_read_b64_tr_b16 a[188:189], v223 offset:32768
ds_read_b64_tr_b16 a[190:191], v223 offset:36864
ds_read_b128 v[252:255], v239 offset:48640
v_mfma_f32_16x16x32_bf16 v[44:47], a[160:163], v[152:155], v[136:139]
v_cvt_pk_bf16_f32 v96, v24, v25
v_mfma_f32_16x16x32_bf16 v[44:47], a[164:167], v[156:159], v[44:47]
v_exp_f32 v26, v26
s_waitcnt lgkmcnt(7)
v_mfma_f32_16x16x32_bf16 v[132:135], a[228:231], v[124:127], v[132:135]
ds_read_b128 v[124:127], v239 offset:49152
v_mfma_f32_16x16x32_bf16 v[44:47], a[168:171], v[160:163], v[44:47]
v_mfma_f32_16x16x32_bf16 v[44:47], a[172:175], v[164:167], v[44:47]
v_exp_f32 v27, v27
s_waitcnt lgkmcnt(5)
v_mfma_f32_16x16x32_bf16 v[132:135], a[232:235], v[128:131], v[132:135]
ds_read_b128 v[128:131], v239 offset:49664
v_mfma_f32_16x16x32_bf16 v[52:55], a[172:175], v[180:183], v[140:143]
v_cvt_pk_bf16_f32 v97, v26, v27
v_mfma_f32_16x16x32_bf16 v[52:55], a[168:171], v[176:179], v[52:55]
v_exp_f32 v28, v28
s_waitcnt lgkmcnt(5)
v_mfma_f32_16x16x32_bf16 v[132:135], a[236:239], v[248:251], v[132:135]
buffer_load_dwordx4 v229, s[8:11], s32 offen offset:1024  lds
ds_read_b128 v[248:251], v239 offset:50176
v_mfma_f32_16x16x32_bf16 v[52:55], a[164:167], v[172:175], v[52:55]
v_mfma_f32_16x16x32_bf16 v[52:55], a[160:163], v[168:171], v[52:55]
v_exp_f32 v29, v29
s_waitcnt lgkmcnt(3)
v_mfma_f32_16x16x32_bf16 v[132:135], a[240:243], v[252:255], v[132:135]
ds_read_b128 v[252:255], v239 offset:50688
v_mfma_f32_16x16x32_bf16 v[60:63], a[160:163], v[184:187], v[144:147]
v_cvt_pk_bf16_f32 v98, v28, v29
v_mfma_f32_16x16x32_bf16 v[60:63], a[164:167], v[188:191], v[60:63]
v_exp_f32 v30, v30
s_waitcnt lgkmcnt(3)
v_mfma_f32_16x16x32_bf16 v[132:135], a[244:247], v[124:127], v[132:135]
ds_read_b128 v[124:127], v239 offset:51200
v_mfma_f32_16x16x32_bf16 v[60:63], a[168:171], v[192:195], v[60:63]
v_mfma_f32_16x16x32_bf16 v[60:63], a[172:175], v[196:199], v[60:63]
v_exp_f32 v31, v31
s_waitcnt lgkmcnt(3)
v_mfma_f32_16x16x32_bf16 v[132:135], a[248:251], v[128:131], v[132:135]
buffer_load_dwordx4 v230, s[8:11], s32 offen offset:2048  lds
ds_read_b128 v[128:131], v239 offset:51712
v_mfma_f32_16x16x32_bf16 v[68:71], a[172:175], v[212:215], v[148:151]
ds_read_b128 a[172:175], v219 offset:53248
v_cvt_pk_bf16_f32 v99, v30, v31
v_mfma_f32_16x16x32_bf16 v[68:71], a[168:171], v[208:211], v[68:71]
v_exp_f32 v32, v32
s_waitcnt lgkmcnt(4)
v_mfma_f32_16x16x32_bf16 v[132:135], a[252:255], v[248:251], v[132:135]
ds_read_b128 a[168:171], v218 offset:53248
ds_read_b128 v[248:251], v239 offset:52224
v_mfma_f32_16x16x32_bf16 v[68:71], a[164:167], v[204:207], v[68:71]
ds_read_b128 a[164:167], v217 offset:53248
v_mfma_f32_16x16x32_bf16 v[68:71], a[160:163], v[200:203], v[68:71]
v_exp_f32 v33, v33
s_waitcnt lgkmcnt(6)
v_mfma_f32_16x16x32_bf16 v[132:135], a[136:139], v[252:255], v[132:135]
ds_read_b128 a[160:163], v216 offset:53248
ds_read_b128 v[252:255], v239 offset:52736
v_mfma_f32_16x16x32_bf16 a[64:67], v[72:75], a[192:195], a[64:67]
v_cvt_pk_bf16_f32 v100, v32, v33
v_mfma_f32_16x16x32_bf16 a[68:71], v[76:79], a[192:195], a[68:71]
v_exp_f32 v34, v34
s_waitcnt lgkmcnt(7)
v_mfma_f32_16x16x32_bf16 v[132:135], a[140:143], v[124:127], v[132:135]
ds_read_b128 v[124:127], v239 offset:53248
v_mfma_f32_16x16x32_bf16 a[72:75], v[80:83], a[192:195], a[72:75]
buffer_load_dwordx4 v231, s[8:11], s32 offen offset:3072  lds
v_mfma_f32_16x16x32_bf16 a[76:79], v[84:87], a[192:195], a[76:79]
v_exp_f32 v35, v35
s_waitcnt lgkmcnt(7)
v_mfma_f32_16x16x32_bf16 v[132:135], v[104:107], v[128:131], v[132:135]
ds_read_b64_tr_b16 a[192:193], v224 offset:32768
ds_read_b64_tr_b16 a[194:195], v224 offset:36864
ds_read_b128 v[128:131], v239 offset:53760
v_mfma_f32_16x16x32_bf16 a[92:95], v[84:87], a[196:199], a[92:95]
v_cvt_pk_bf16_f32 v101, v34, v35
v_mfma_f32_16x16x32_bf16 a[88:91], v[80:83], a[196:199], a[88:91]
v_exp_f32 v36, v36
s_waitcnt lgkmcnt(7)
v_mfma_f32_16x16x32_bf16 v[132:135], v[108:111], v[248:251], v[132:135]
v_mfma_f32_16x16x32_bf16 a[84:87], v[76:79], a[196:199], a[84:87]
v_mfma_f32_16x16x32_bf16 a[80:83], v[72:75], a[196:199], a[80:83]
v_exp_f32 v37, v37
s_waitcnt lgkmcnt(4)
v_mfma_f32_16x16x32_bf16 v[132:135], v[112:115], v[252:255], v[132:135]
ds_read_b64_tr_b16 a[196:197], v225 offset:32768
ds_read_b64_tr_b16 a[198:199], v225 offset:36864
v_mfma_f32_16x16x32_bf16 a[96:99], v[72:75], a[200:203], a[96:99]
v_cvt_pk_bf16_f32 v102, v36, v37
v_mfma_f32_16x16x32_bf16 a[100:103], v[76:79], a[200:203], a[100:103]
v_exp_f32 v38, v38
s_waitcnt lgkmcnt(5)
v_mfma_f32_16x16x32_bf16 v[132:135], v[116:119], v[124:127], v[132:135]
v_mfma_f32_16x16x32_bf16 a[104:107], v[80:83], a[200:203], a[104:107]
v_mfma_f32_16x16x32_bf16 a[108:111], v[84:87], a[200:203], a[108:111]
v_exp_f32 v39, v39
s_waitcnt lgkmcnt(2)
v_mfma_f32_16x16x32_bf16 v[132:135], v[120:123], v[128:131], v[132:135]
ds_read_b64_tr_b16 a[200:201], v226 offset:32768
ds_read_b64_tr_b16 a[202:203], v226 offset:36864
v_mfma_f32_16x16x32_bf16 a[124:127], v[84:87], a[204:207], a[124:127]
v_cvt_pk_bf16_f32 v103, v38, v39
v_mfma_f32_16x16x32_bf16 a[120:123], v[80:83], a[204:207], a[120:123]
v_mfma_f32_16x16x32_bf16 a[116:119], v[76:79], a[204:207], a[116:119]
v_mfma_f32_16x16x32_bf16 a[112:115], v[72:75], a[204:207], a[112:115]
ds_read_b64_tr_b16 a[204:205], v227 offset:32768
ds_read_b64_tr_b16 a[206:207], v227 offset:36864
v_smfmac_f32_16x16x64_bf16 a[132:135], a[208:211], v[80:87], v245
v_mfma_f32_16x16x32_bf16 v[8:11], a[144:147], v[152:155], v[136:139]
v_exp_f32 v40, v40
v_mfma_f32_16x16x32_bf16 v[8:11], a[148:151], v[156:159], v[8:11]
v_exp_f32 v41, v41
v_mfma_f32_16x16x32_bf16 v[8:11], a[152:155], v[160:163], v[8:11]
v_cvt_pk_bf16_f32 v72, v40, v41
v_cvt_pk_bf16_f32 v104, v132, v133
v_cvt_pk_bf16_f32 v105, v134, v135
v_mfma_f32_16x16x32_bf16 v[8:11], a[156:159], v[164:167], v[8:11]
v_lshlrev_b32 v132, 16, v104
v_exp_f32 v42, v42
v_mfma_f32_16x16x32_bf16 v[16:19], a[156:159], v[180:183], v[140:143]
s_add_u32 s39, s39, 16384
v_and_b32 v133, 0xffff0000, v104
v_lshlrev_b32 v134, 16, v105
v_mfma_f32_16x16x32_bf16 v[16:19], a[152:155], v[176:179], v[16:19]
v_and_b32 v135, 0xffff0000, v105
v_exp_f32 v43, v43
v_mfma_f32_16x16x32_bf16 v[16:19], a[148:151], v[172:175], v[16:19]
v_cvt_pk_bf16_f32 v73, v42, v43
v_mul_f32 v104, 0xbfb8aa3b, v132
v_mul_f32 v105, 0xbfb8aa3b, v133
v_mfma_f32_16x16x32_bf16 v[16:19], a[144:147], v[168:171], v[16:19]
v_mul_f32 v106, 0xbfb8aa3b, v134
v_exp_f32 v44, v44
v_mfma_f32_16x16x32_bf16 v[24:27], a[144:147], v[184:187], v[144:147]
v_mul_f32 v107, 0xbfb8aa3b, v135
v_exp_f32 v104, v104
v_mfma_f32_16x16x32_bf16 v[24:27], a[148:151], v[188:191], v[24:27]
v_exp_f32 v45, v45
v_mfma_f32_16x16x32_bf16 v[24:27], a[152:155], v[192:195], v[24:27]
v_cvt_pk_bf16_f32 v74, v44, v45
v_exp_f32 v105, v105
v_mfma_f32_16x16x32_bf16 v[24:27], a[156:159], v[196:199], v[24:27]
v_exp_f32 v46, v46
v_mfma_f32_16x16x32_bf16 v[32:35], a[156:159], v[212:215], v[148:151]
ds_read_b128 a[156:159], v219 offset:57344
s_add_u32 m0, s30, 98304
v_mfma_f32_16x16x32_bf16 v[32:35], a[152:155], v[208:211], v[32:35]
v_exp_f32 v47, v47
v_mfma_f32_16x16x32_bf16 v[32:35], a[148:151], v[204:207], v[32:35]
ds_read_b128 a[152:155], v218 offset:57344
v_cvt_pk_bf16_f32 v75, v46, v47
v_mfma_f32_16x16x32_bf16 v[32:35], a[144:147], v[200:203], v[32:35]
v_exp_f32 v48, v48
v_mfma_f32_16x16x32_bf16 a[0:3], v[88:91], a[176:179], a[0:3]
ds_read_b128 a[148:151], v217 offset:57344
ds_read_b128 a[144:147], v216 offset:57344
v_mfma_f32_16x16x32_bf16 a[4:7], v[92:95], a[176:179], a[4:7]
v_exp_f32 v49, v49
v_mfma_f32_16x16x32_bf16 a[8:11], v[96:99], a[176:179], a[8:11]
v_cvt_pk_bf16_f32 v76, v48, v49
v_exp_f32 v106, v106
v_mfma_f32_16x16x32_bf16 a[12:15], v[100:103], a[176:179], a[12:15]
v_exp_f32 v50, v50
v_mfma_f32_16x16x32_bf16 a[28:31], v[100:103], a[180:183], a[28:31]
ds_read_b64_tr_b16 a[176:177], v220 offset:40960
ds_read_b64_tr_b16 a[178:179], v220 offset:45056
v_mfma_f32_16x16x32_bf16 a[24:27], v[96:99], a[180:183], a[24:27]
v_exp_f32 v51, v51
v_mfma_f32_16x16x32_bf16 a[20:23], v[92:95], a[180:183], a[20:23]
v_cvt_pk_bf16_f32 v77, v50, v51
v_exp_f32 v107, v107
v_mfma_f32_16x16x32_bf16 a[16:19], v[88:91], a[180:183], a[16:19]
v_add_f32 v104, 1.0, v104
v_exp_f32 v52, v52
v_mfma_f32_16x16x32_bf16 a[32:35], v[88:91], a[184:187], a[32:35]
ds_read_b64_tr_b16 a[180:181], v221 offset:40960
ds_read_b64_tr_b16 a[182:183], v221 offset:45056
v_add_f32 v105, 1.0, v105
v_mfma_f32_16x16x32_bf16 a[36:39], v[92:95], a[184:187], a[36:39]
v_add_f32 v106, 1.0, v106
v_exp_f32 v53, v53
v_mfma_f32_16x16x32_bf16 a[40:43], v[96:99], a[184:187], a[40:43]
v_cvt_pk_bf16_f32 v78, v52, v53
v_add_f32 v107, 1.0, v107
v_mfma_f32_16x16x32_bf16 a[44:47], v[100:103], a[184:187], a[44:47]
v_exp_f32 v54, v54
v_mfma_f32_16x16x32_bf16 a[60:63], v[100:103], a[188:191], a[60:63]
ds_read_b64_tr_b16 a[184:185], v222 offset:40960
ds_read_b64_tr_b16 a[186:187], v222 offset:45056
v_mfma_f32_16x16x32_bf16 a[56:59], v[96:99], a[188:191], a[56:59]
v_exp_f32 v55, v55
v_mfma_f32_16x16x32_bf16 a[52:55], v[92:95], a[188:191], a[52:55]
v_cvt_pk_bf16_f32 v79, v54, v55
v_rcp_f32 v104, v104
v_mfma_f32_16x16x32_bf16 a[48:51], v[88:91], a[188:191], a[48:51]
v_exp_f32 v56, v56
v_smfmac_f32_16x16x64_bf16 a[128:131], a[208:211], v[88:95], v245
v_exp_f32 v57, v57
v_mfma_f32_16x16x32_bf16 v[12:15], a[160:163], v[152:155], v[136:139]
ds_read_b64_tr_b16 a[188:189], v223 offset:40960
v_cvt_pk_bf16_f32 v80, v56, v57
v_mfma_f32_16x16x32_bf16 v[12:15], a[164:167], v[156:159], v[12:15]
v_exp_f32 v58, v58
v_mfma_f32_16x16x32_bf16 v[12:15], a[168:171], v[160:163], v[12:15]
ds_read_b64_tr_b16 a[190:191], v223 offset:45056
v_rcp_f32 v105, v105
v_mfma_f32_16x16x32_bf16 v[12:15], a[172:175], v[164:167], v[12:15]
v_exp_f32 v59, v59
v_mfma_f32_16x16x32_bf16 v[20:23], a[172:175], v[180:183], v[140:143]
v_cvt_pk_bf16_f32 v81, v58, v59
v_rcp_f32 v106, v106
v_mfma_f32_16x16x32_bf16 v[20:23], a[168:171], v[176:179], v[20:23]
v_exp_f32 v60, v60
v_mfma_f32_16x16x32_bf16 v[20:23], a[164:167], v[172:175], v[20:23]
buffer_load_dwordx4 v232, s[12:15], s39 offen offset:0  lds
v_mfma_f32_16x16x32_bf16 v[20:23], a[160:163], v[168:171], v[20:23]
v_exp_f32 v61, v61
v_mfma_f32_16x16x32_bf16 v[28:31], a[160:163], v[184:187], v[144:147]
v_cvt_pk_bf16_f32 v82, v60, v61
v_rcp_f32 v107, v107
v_mfma_f32_16x16x32_bf16 v[28:31], a[164:167], v[188:191], v[28:31]
v_mul_f32 v104, v132, v104
v_exp_f32 v62, v62
v_mfma_f32_16x16x32_bf16 v[28:31], a[168:171], v[192:195], v[28:31]
buffer_load_dwordx4 v233, s[12:15], s39 offen offset:1024  lds
v_mul_f32 v105, v133, v105
v_mfma_f32_16x16x32_bf16 v[28:31], a[172:175], v[196:199], v[28:31]
v_mul_f32 v106, v134, v106
v_exp_f32 v63, v63
v_mfma_f32_16x16x32_bf16 v[36:39], a[172:175], v[212:215], v[148:151]
ds_read_b128 a[172:175], v219 offset:61440
v_cvt_pk_bf16_f32 v83, v62, v63
v_mul_f32 v107, v135, v107
v_mfma_f32_16x16x32_bf16 v[36:39], a[168:171], v[208:211], v[36:39]
v_cvt_pk_bf16_f32 v108, v104, v105
v_exp_f32 v64, v64
v_mfma_f32_16x16x32_bf16 v[36:39], a[164:167], v[204:207], v[36:39]
ds_read_b128 a[168:171], v218 offset:61440
ds_read_b128 a[164:167], v217 offset:61440
v_cvt_pk_bf16_f32 v109, v106, v107
v_mfma_f32_16x16x32_bf16 v[36:39], a[160:163], v[200:203], v[36:39]
v_lshlrev_b32 v104, 16, v108
v_exp_f32 v65, v65
v_mfma_f32_16x16x32_bf16 a[64:67], v[88:91], a[192:195], a[64:67]
ds_read_b128 a[160:163], v216 offset:61440
v_cvt_pk_bf16_f32 v84, v64, v65
v_and_b32 v105, 0xffff0000, v108
v_mfma_f32_16x16x32_bf16 a[68:71], v[92:95], a[192:195], a[68:71]
v_lshlrev_b32 v106, 16, v109
v_exp_f32 v66, v66
v_mfma_f32_16x16x32_bf16 a[72:75], v[96:99], a[192:195], a[72:75]
buffer_load_dwordx4 v232, s[12:15], s39 offen offset:2048  lds
v_and_b32 v107, 0xffff0000, v109
v_mfma_f32_16x16x32_bf16 a[76:79], v[100:103], a[192:195], a[76:79]
v_cndmask_b32 v132, v132, v104, s[90:91]
v_exp_f32 v67, v67
s_waitcnt lgkmcnt(8)
v_mfma_f32_16x16x32_bf16 a[92:95], v[100:103], a[196:199], a[92:95]
ds_read_b64_tr_b16 a[192:193], v224 offset:40960
v_cvt_pk_bf16_f32 v85, v66, v67
v_cndmask_b32 v133, v133, v105, s[90:91]
v_mfma_f32_16x16x32_bf16 a[88:91], v[96:99], a[196:199], a[88:91]
v_cndmask_b32 v134, v134, v106, s[90:91]
v_exp_f32 v68, v68
v_mfma_f32_16x16x32_bf16 a[84:87], v[92:95], a[196:199], a[84:87]
ds_read_b64_tr_b16 a[194:195], v224 offset:45056
v_cndmask_b32 v135, v135, v107, s[90:91]
v_mfma_f32_16x16x32_bf16 a[80:83], v[88:91], a[196:199], a[80:83]
ds_write_b128 v237, v[132:135] offset:54272
v_exp_f32 v69, v69
v_mfma_f32_16x16x32_bf16 a[96:99], v[88:91], a[200:203], a[96:99]
ds_read_b64_tr_b16 a[196:197], v225 offset:40960
v_cvt_pk_bf16_f32 v86, v68, v69
v_mfma_f32_16x16x32_bf16 a[100:103], v[92:95], a[200:203], a[100:103]
v_exp_f32 v70, v70
v_mfma_f32_16x16x32_bf16 a[104:107], v[96:99], a[200:203], a[104:107]
ds_read_b64_tr_b16 a[198:199], v225 offset:45056
v_mfma_f32_16x16x32_bf16 a[108:111], v[100:103], a[200:203], a[108:111]
v_exp_f32 v71, v71
v_mfma_f32_16x16x32_bf16 a[124:127], v[100:103], a[204:207], a[124:127]
ds_read_b64_tr_b16 a[200:201], v226 offset:40960
v_cvt_pk_bf16_f32 v87, v70, v71
v_mfma_f32_16x16x32_bf16 a[120:123], v[96:99], a[204:207], a[120:123]
ds_read_b64_tr_b16 a[202:203], v226 offset:45056
v_mfma_f32_16x16x32_bf16 a[116:119], v[92:95], a[204:207], a[116:119]
buffer_load_dwordx4 v233, s[12:15], s39 offen offset:3072  lds
v_mfma_f32_16x16x32_bf16 a[112:115], v[88:91], a[204:207], a[112:115]
ds_read_b64_tr_b16 a[204:205], v227 offset:40960
ds_read_b64_tr_b16 a[206:207], v227 offset:45056
v_smfmac_f32_16x16x64_bf16 a[132:135], a[208:211], v[96:103], v245
v_mfma_f32_16x16x32_bf16 v[40:43], a[144:147], v[152:155], v[136:139]
v_exp_f32 v8, v8
v_mfma_f32_16x16x32_bf16 v[40:43], a[148:151], v[156:159], v[40:43]
v_exp_f32 v9, v9
v_mfma_f32_16x16x32_bf16 v[40:43], a[152:155], v[160:163], v[40:43]
v_cvt_pk_bf16_f32 v104, v8, v9
v_mfma_f32_16x16x32_bf16 v[40:43], a[156:159], v[164:167], v[40:43]
v_exp_f32 v10, v10
v_mfma_f32_16x16x32_bf16 v[48:51], a[156:159], v[180:183], v[140:143]
v_mfma_f32_16x16x32_bf16 v[48:51], a[152:155], v[176:179], v[48:51]
v_exp_f32 v11, v11
v_mfma_f32_16x16x32_bf16 v[48:51], a[148:151], v[172:175], v[48:51]
v_cvt_pk_bf16_f32 v105, v10, v11
v_mfma_f32_16x16x32_bf16 v[48:51], a[144:147], v[168:171], v[48:51]
v_exp_f32 v12, v12
v_mfma_f32_16x16x32_bf16 v[56:59], a[144:147], v[184:187], v[144:147]
v_mfma_f32_16x16x32_bf16 v[56:59], a[148:151], v[188:191], v[56:59]
v_exp_f32 v13, v13
v_mfma_f32_16x16x32_bf16 v[56:59], a[152:155], v[192:195], v[56:59]
v_cvt_pk_bf16_f32 v106, v12, v13
v_mfma_f32_16x16x32_bf16 v[56:59], a[156:159], v[196:199], v[56:59]
v_exp_f32 v14, v14
v_mfma_f32_16x16x32_bf16 v[64:67], a[156:159], v[212:215], v[148:151]
s_waitcnt vmcnt(8) lgkmcnt(0)
s_barrier
v_mfma_f32_16x16x32_bf16 v[64:67], a[152:155], v[208:211], v[64:67]
ds_read_b128 v[120:123], v244 offset:54272
v_exp_f32 v15, v15
v_mfma_f32_16x16x32_bf16 v[64:67], a[148:151], v[204:207], v[64:67]
ds_read_b128 a[156:159], v219 offset:0
ds_read_b128 v[124:127], v244 offset:55296
v_cvt_pk_bf16_f32 v107, v14, v15
v_mfma_f32_16x16x32_bf16 v[64:67], a[144:147], v[200:203], v[64:67]
ds_read_b128 v[128:131], v244 offset:56320
v_exp_f32 v16, v16
v_mfma_f32_16x16x32_bf16 a[0:3], v[72:75], a[176:179], a[0:3]
ds_read_b128 a[152:155], v218 offset:0
ds_read_b128 a[148:151], v217 offset:0
ds_read_b128 v[132:135], v244 offset:57344
v_mfma_f32_16x16x32_bf16 a[4:7], v[76:79], a[176:179], a[4:7]
ds_read_b64_tr_b16 a[212:213], v242 offset:0
v_exp_f32 v17, v17
v_mfma_f32_16x16x32_bf16 a[8:11], v[80:83], a[176:179], a[8:11]
ds_read_b128 a[144:147], v216 offset:0
ds_read_b64_tr_b16 a[214:215], v242 offset:18432
v_cvt_pk_bf16_f32 v108, v16, v17
v_mfma_f32_16x16x32_bf16 a[12:15], v[84:87], a[176:179], a[12:15]
ds_read_b64_tr_b16 a[216:217], v242 offset:32
v_exp_f32 v18, v18
v_mfma_f32_16x16x32_bf16 a[28:31], v[84:87], a[180:183], a[28:31]
ds_read_b64_tr_b16 a[176:177], v220 offset:49152
ds_read_b64_tr_b16 a[178:179], v220 offset:53248
ds_read_b64_tr_b16 a[218:219], v242 offset:18464
v_mfma_f32_16x16x32_bf16 a[24:27], v[80:83], a[180:183], a[24:27]
ds_read_b64_tr_b16 a[220:221], v242 offset:64
v_exp_f32 v19, v19
v_mfma_f32_16x16x32_bf16 a[20:23], v[76:79], a[180:183], a[20:23]
s_add_u32 s32, s32, 16384
ds_read_b64_tr_b16 a[222:223], v242 offset:18496
v_cvt_pk_bf16_f32 v109, v18, v19
v_mfma_f32_16x16x32_bf16 a[16:19], v[72:75], a[180:183], a[16:19]
ds_read_b64_tr_b16 a[224:225], v242 offset:96
v_exp_f32 v20, v20
v_mfma_f32_16x16x32_bf16 a[32:35], v[72:75], a[184:187], a[32:35]
ds_read_b64_tr_b16 a[180:181], v221 offset:49152
ds_read_b64_tr_b16 a[182:183], v221 offset:53248
ds_read_b64_tr_b16 a[226:227], v242 offset:18528
v_mfma_f32_16x16x32_bf16 a[36:39], v[76:79], a[184:187], a[36:39]
ds_read_b64_tr_b16 a[228:229], v242 offset:128
v_exp_f32 v21, v21
v_mfma_f32_16x16x32_bf16 a[40:43], v[80:83], a[184:187], a[40:43]
s_add_u32 m0, s30, 114688
ds_read_b64_tr_b16 a[230:231], v242 offset:18560
v_cvt_pk_bf16_f32 v110, v20, v21
v_mfma_f32_16x16x32_bf16 a[44:47], v[84:87], a[184:187], a[44:47]
ds_read_b64_tr_b16 a[232:233], v242 offset:160
v_exp_f32 v22, v22
v_mfma_f32_16x16x32_bf16 a[60:63], v[84:87], a[188:191], a[60:63]
ds_read_b64_tr_b16 a[184:185], v222 offset:49152
ds_read_b64_tr_b16 a[186:187], v222 offset:53248
ds_read_b64_tr_b16 a[234:235], v242 offset:18592
v_mfma_f32_16x16x32_bf16 a[56:59], v[80:83], a[188:191], a[56:59]
ds_read_b64_tr_b16 a[236:237], v242 offset:192
v_exp_f32 v23, v23
v_mfma_f32_16x16x32_bf16 a[52:55], v[76:79], a[188:191], a[52:55]
ds_read_b64_tr_b16 a[238:239], v242 offset:18624
ds_read_b64_tr_b16 a[240:241], v242 offset:224
v_cvt_pk_bf16_f32 v111, v22, v23
v_mfma_f32_16x16x32_bf16 a[48:51], v[72:75], a[188:191], a[48:51]
ds_read_b64_tr_b16 a[242:243], v242 offset:18656
v_exp_f32 v24, v24
v_smfmac_f32_16x16x64_bf16 a[128:131], a[208:211], v[72:79], v245
ds_read_b64_tr_b16 a[244:245], v242 offset:256
v_exp_f32 v25, v25
v_mfma_f32_16x16x32_bf16 v[44:47], a[160:163], v[152:155], v[136:139]
ds_read_b64_tr_b16 a[188:189], v223 offset:49152
ds_read_b64_tr_b16 a[246:247], v242 offset:18688
v_cvt_pk_bf16_f32 v112, v24, v25
v_mfma_f32_16x16x32_bf16 v[44:47], a[164:167], v[156:159], v[44:47]
s_waitcnt lgkmcnt(8)
v_mul_f32 v120, v120, v128
v_exp_f32 v26, v26
v_mfma_f32_16x16x32_bf16 v[44:47], a[168:171], v[160:163], v[44:47]
ds_read_b64_tr_b16 a[190:191], v223 offset:53248
v_mul_f32 v121, v121, v129
v_mul_f32 v122, v122, v130
v_mfma_f32_16x16x32_bf16 v[44:47], a[172:175], v[164:167], v[44:47]
v_mul_f32 v123, v123, v131
v_exp_f32 v27, v27
v_mfma_f32_16x16x32_bf16 v[52:55], a[172:175], v[180:183], v[140:143]
v_cvt_pk_bf16_f32 v113, v26, v27
v_mul_f32 v124, v124, v132
v_mul_f32 v125, v125, v133
v_mfma_f32_16x16x32_bf16 v[52:55], a[168:171], v[176:179], v[52:55]
STUB_9:
s_cbranch_execz STUB_12
v_mul_f32 v126, v126, v134
v_exp_f32 v28, v28
v_mfma_f32_16x16x32_bf16 v[52:55], a[164:167], v[172:175], v[52:55]
buffer_load_dwordx4 v228, s[8:11], s32 offen offset:0  lds
v_mul_f32 v127, v127, v135
v_mfma_f32_16x16x32_bf16 v[52:55], a[160:163], v[168:171], v[52:55]
v_cvt_pk_bf16_f32 v248, v120, v121
v_exp_f32 v29, v29
v_mfma_f32_16x16x32_bf16 v[60:63], a[160:163], v[184:187], v[144:147]
v_cvt_pk_bf16_f32 v114, v28, v29
v_cvt_pk_bf16_f32 v249, v122, v123
v_cvt_pk_bf16_f32 v250, v124, v125
v_mfma_f32_16x16x32_bf16 v[60:63], a[164:167], v[188:191], v[60:63]
v_cvt_pk_bf16_f32 v251, v126, v127
v_exp_f32 v30, v30
v_mfma_f32_16x16x32_bf16 v[60:63], a[168:171], v[192:195], v[60:63]
buffer_load_dwordx4 v229, s[8:11], s32 offen offset:1024  lds
v_mfma_f32_16x16x32_bf16 v[60:63], a[172:175], v[196:199], v[60:63]
v_exp_f32 v31, v31
v_mfma_f32_16x16x32_bf16 a[248:251], a[212:215], v[248:251], 0
buffer_load_dwordx4 v230, s[8:11], s32 offen offset:2048  lds
v_mfma_f32_16x16x32_bf16 v[68:71], a[172:175], v[212:215], v[148:151]
ds_read_b128 a[172:175], v219 offset:4096
v_cvt_pk_bf16_f32 v115, v30, v31
v_mfma_f32_16x16x32_bf16 a[212:215], a[216:219], v[248:251], 0
v_mfma_f32_16x16x32_bf16 v[68:71], a[168:171], v[208:211], v[68:71]
v_exp_f32 v32, v32
v_mfma_f32_16x16x32_bf16 a[216:219], a[220:223], v[248:251], 0
ds_read_b128 a[168:171], v218 offset:4096
v_mfma_f32_16x16x32_bf16 v[68:71], a[164:167], v[204:207], v[68:71]
ds_read_b128 a[164:167], v217 offset:4096
v_mfma_f32_16x16x32_bf16 a[220:223], a[224:227], v[248:251], 0
v_mfma_f32_16x16x32_bf16 v[68:71], a[160:163], v[200:203], v[68:71]
v_exp_f32 v33, v33
v_mfma_f32_16x16x32_bf16 a[224:227], a[228:231], v[248:251], 0
ds_read_b128 a[160:163], v216 offset:4096
v_mfma_f32_16x16x32_bf16 a[64:67], v[72:75], a[192:195], a[64:67]
v_cvt_pk_bf16_f32 v116, v32, v33
s_waitcnt lgkmcnt(8)
v_mfma_f32_16x16x32_bf16 a[228:231], a[232:235], v[248:251], 0
v_mfma_f32_16x16x32_bf16 a[68:71], v[76:79], a[192:195], a[68:71]
v_exp_f32 v34, v34
v_mfma_f32_16x16x32_bf16 a[232:235], a[236:239], v[248:251], 0
v_mfma_f32_16x16x32_bf16 a[72:75], v[80:83], a[192:195], a[72:75]
buffer_load_dwordx4 v231, s[8:11], s32 offen offset:3072  lds
v_mfma_f32_16x16x32_bf16 a[236:239], a[240:243], v[248:251], 0
v_mfma_f32_16x16x32_bf16 a[76:79], v[84:87], a[192:195], a[76:79]
v_exp_f32 v35, v35
s_waitcnt lgkmcnt(5)
v_mfma_f32_16x16x32_bf16 a[240:243], a[244:247], v[248:251], 0
ds_read_b64_tr_b16 a[192:193], v224 offset:49152
ds_read_b64_tr_b16 a[194:195], v224 offset:53248
v_mfma_f32_16x16x32_bf16 a[92:95], v[84:87], a[196:199], a[92:95]
v_cvt_pk_bf16_f32 v117, v34, v35
v_mfma_f32_16x16x32_bf16 a[88:91], v[80:83], a[196:199], a[88:91]
v_exp_f32 v36, v36
v_mfma_f32_16x16x32_bf16 a[84:87], v[76:79], a[196:199], a[84:87]
v_mfma_f32_16x16x32_bf16 a[80:83], v[72:75], a[196:199], a[80:83]
v_exp_f32 v37, v37
v_mfma_f32_16x16x32_bf16 a[96:99], v[72:75], a[200:203], a[96:99]
ds_read_b64_tr_b16 a[196:197], v225 offset:49152
v_cvt_pk_bf16_f32 v118, v36, v37
v_mfma_f32_16x16x32_bf16 a[100:103], v[76:79], a[200:203], a[100:103]
v_exp_f32 v38, v38
v_mfma_f32_16x16x32_bf16 a[104:107], v[80:83], a[200:203], a[104:107]
ds_read_b64_tr_b16 a[198:199], v225 offset:53248
v_mfma_f32_16x16x32_bf16 a[108:111], v[84:87], a[200:203], a[108:111]
v_exp_f32 v39, v39
v_mfma_f32_16x16x32_bf16 a[124:127], v[84:87], a[204:207], a[124:127]
ds_read_b64_tr_b16 a[200:201], v226 offset:49152
v_cvt_pk_bf16_f32 v119, v38, v39
v_mfma_f32_16x16x32_bf16 a[120:123], v[80:83], a[204:207], a[120:123]
ds_read_b64_tr_b16 a[202:203], v226 offset:53248
buffer_store_dwordx4 a[248:251], v238, s[20:23], s28 offen offset:0 sc0 sc1
v_mfma_f32_16x16x32_bf16 a[116:119], v[76:79], a[204:207], a[116:119]
v_mfma_f32_16x16x32_bf16 a[112:115], v[72:75], a[204:207], a[112:115]
ds_read_b64_tr_b16 a[204:205], v227 offset:49152
ds_read_b64_tr_b16 a[206:207], v227 offset:53248
v_smfmac_f32_16x16x64_bf16 a[132:135], a[208:211], v[80:87], v245
buffer_store_dwordx4 a[212:215], v238, s[20:23], s28 offen offset:512 sc0 sc1
v_mfma_f32_16x16x32_bf16 v[8:11], a[144:147], v[152:155], v[136:139]
v_exp_f32 v40, v40
v_mfma_f32_16x16x32_bf16 v[8:11], a[148:151], v[156:159], v[8:11]
buffer_store_dwordx4 a[216:219], v238, s[20:23], s28 offen offset:1024 sc0 sc1
v_exp_f32 v41, v41
v_mfma_f32_16x16x32_bf16 v[8:11], a[152:155], v[160:163], v[8:11]
v_cvt_pk_bf16_f32 v72, v40, v41
v_exp_f32 v42, v42
v_mfma_f32_16x16x32_bf16 v[8:11], a[156:159], v[164:167], v[8:11]
s_add_u32 s39, s39, 16384
buffer_store_dwordx4 a[220:223], v238, s[20:23], s28 offen offset:1536 sc0 sc1
v_mfma_f32_16x16x32_bf16 v[16:19], a[156:159], v[180:183], v[140:143]
v_exp_f32 v43, v43
v_mfma_f32_16x16x32_bf16 v[16:19], a[152:155], v[176:179], v[16:19]
v_cvt_pk_bf16_f32 v73, v42, v43
v_exp_f32 v44, v44
v_mfma_f32_16x16x32_bf16 v[16:19], a[148:151], v[172:175], v[16:19]
buffer_store_dwordx4 a[224:227], v238, s[20:23], s28 offen offset:2048 sc0 sc1
v_mfma_f32_16x16x32_bf16 v[16:19], a[144:147], v[168:171], v[16:19]
v_exp_f32 v45, v45
v_mfma_f32_16x16x32_bf16 v[24:27], a[144:147], v[184:187], v[144:147]
v_cvt_pk_bf16_f32 v74, v44, v45
v_exp_f32 v46, v46
v_mfma_f32_16x16x32_bf16 v[24:27], a[148:151], v[188:191], v[24:27]
s_add_u32 m0, s30, 131072
s_nop 0
buffer_store_dwordx4 a[228:231], v238, s[20:23], s28 offen offset:2560 sc0 sc1
v_mfma_f32_16x16x32_bf16 v[24:27], a[152:155], v[192:195], v[24:27]
v_exp_f32 v47, v47
v_mfma_f32_16x16x32_bf16 v[24:27], a[156:159], v[196:199], v[24:27]
v_cvt_pk_bf16_f32 v75, v46, v47
v_exp_f32 v48, v48
v_mfma_f32_16x16x32_bf16 v[32:35], a[156:159], v[212:215], v[148:151]
ds_read_b128 a[156:159], v219 offset:8192
v_exp_f32 v49, v49
v_mfma_f32_16x16x32_bf16 v[32:35], a[152:155], v[208:211], v[32:35]
ds_read_b128 a[152:155], v218 offset:8192
buffer_store_dwordx4 a[232:235], v238, s[20:23], s28 offen offset:3072 sc0 sc1
v_cvt_pk_bf16_f32 v76, v48, v49
v_mfma_f32_16x16x32_bf16 v[32:35], a[148:151], v[204:207], v[32:35]
ds_read_b128 a[148:151], v217 offset:8192
v_exp_f32 v50, v50
v_mfma_f32_16x16x32_bf16 v[32:35], a[144:147], v[200:203], v[32:35]
ds_read_b128 a[144:147], v216 offset:8192
v_exp_f32 v51, v51
v_mfma_f32_16x16x32_bf16 a[8:11], v[112:115], a[176:179], a[8:11]
buffer_load_dwordx4 v232, s[12:15], s39 offen offset:0  lds
v_cvt_pk_bf16_f32 v77, v50, v51
v_mfma_f32_16x16x32_bf16 a[12:15], v[116:119], a[176:179], a[12:15]
buffer_store_dwordx4 a[236:239], v238, s[20:23], s28 offen offset:3584 sc0 sc1
v_exp_f32 v52, v52
v_mfma_f32_16x16x32_bf16 a[28:31], v[116:119], a[180:183], a[28:31]
s_add_u32 s28, s28, 4096
v_exp_f32 v53, v53
v_mfma_f32_16x16x32_bf16 a[24:27], v[112:115], a[180:183], a[24:27]
v_cvt_pk_bf16_f32 v78, v52, v53
v_mfma_f32_16x16x32_bf16 a[40:43], v[112:115], a[184:187], a[40:43]
buffer_store_dwordx4 a[240:243], v238, s[20:23], s28 offen offset:0 sc0 sc1
v_exp_f32 v54, v54
v_mfma_f32_16x16x32_bf16 a[44:47], v[116:119], a[184:187], a[44:47]
v_exp_f32 v55, v55
s_waitcnt lgkmcnt(8)
v_mfma_f32_16x16x32_bf16 a[60:63], v[116:119], a[188:191], a[60:63]
ds_read_b64_tr_b16 a[212:213], v220 offset:57344
ds_read_b64_tr_b16 a[214:215], v220 offset:61440
v_cvt_pk_bf16_f32 v79, v54, v55
v_mfma_f32_16x16x32_bf16 a[56:59], v[112:115], a[188:191], a[56:59]
v_exp_f32 v56, v56
v_smfmac_f32_16x16x64_bf16 a[128:131], a[208:211], v[104:111], v245
ds_read_b64_tr_b16 a[216:217], v221 offset:57344
v_exp_f32 v57, v57
v_mfma_f32_16x16x32_bf16 v[12:15], a[160:163], v[152:155], v[136:139]
v_cvt_pk_bf16_f32 v80, v56, v57
v_exp_f32 v58, v58
v_mfma_f32_16x16x32_bf16 v[12:15], a[164:167], v[156:159], v[12:15]
ds_read_b64_tr_b16 a[218:219], v221 offset:61440
buffer_load_dwordx4 v233, s[12:15], s39 offen offset:1024  lds
v_mfma_f32_16x16x32_bf16 v[12:15], a[168:171], v[160:163], v[12:15]
ds_read_b64_tr_b16 a[220:221], v222 offset:57344
v_exp_f32 v59, v59
v_mfma_f32_16x16x32_bf16 v[12:15], a[172:175], v[164:167], v[12:15]
v_cvt_pk_bf16_f32 v81, v58, v59
v_exp_f32 v60, v60
v_mfma_f32_16x16x32_bf16 v[20:23], a[172:175], v[180:183], v[140:143]
ds_read_b64_tr_b16 a[222:223], v222 offset:61440
buffer_load_dwordx4 v232, s[12:15], s39 offen offset:2048  lds
v_mfma_f32_16x16x32_bf16 v[20:23], a[168:171], v[176:179], v[20:23]
ds_read_b64_tr_b16 a[224:225], v223 offset:57344
v_exp_f32 v61, v61
v_mfma_f32_16x16x32_bf16 v[20:23], a[164:167], v[172:175], v[20:23]
v_cvt_pk_bf16_f32 v82, v60, v61
v_exp_f32 v62, v62
v_mfma_f32_16x16x32_bf16 v[20:23], a[160:163], v[168:171], v[20:23]
ds_read_b64_tr_b16 a[226:227], v223 offset:61440
v_mfma_f32_16x16x32_bf16 v[28:31], a[160:163], v[184:187], v[144:147]
ds_read_b64_tr_b16 a[228:229], v224 offset:57344
v_exp_f32 v63, v63
v_mfma_f32_16x16x32_bf16 v[28:31], a[164:167], v[188:191], v[28:31]
v_cvt_pk_bf16_f32 v83, v62, v63
v_exp_f32 v64, v64
v_mfma_f32_16x16x32_bf16 v[28:31], a[168:171], v[192:195], v[28:31]
ds_read_b64_tr_b16 a[230:231], v224 offset:61440
v_exp_f32 v65, v65
v_mfma_f32_16x16x32_bf16 v[28:31], a[172:175], v[196:199], v[28:31]
ds_read_b64_tr_b16 a[232:233], v225 offset:57344
ds_read_b64_tr_b16 a[234:235], v225 offset:61440
v_cvt_pk_bf16_f32 v84, v64, v65
v_mfma_f32_16x16x32_bf16 v[36:39], a[172:175], v[212:215], v[148:151]
ds_read_b128 a[172:175], v219 offset:12288
v_exp_f32 v66, v66
v_mfma_f32_16x16x32_bf16 v[36:39], a[168:171], v[208:211], v[36:39]
ds_read_b128 a[168:171], v218 offset:12288
v_exp_f32 v67, v67
v_mfma_f32_16x16x32_bf16 v[36:39], a[164:167], v[204:207], v[36:39]
ds_read_b64_tr_b16 a[236:237], v226 offset:57344
ds_read_b64_tr_b16 a[238:239], v226 offset:61440
v_cvt_pk_bf16_f32 v85, v66, v67
v_mfma_f32_16x16x32_bf16 v[36:39], a[160:163], v[200:203], v[36:39]
ds_read_b128 a[164:167], v217 offset:12288
v_exp_f32 v68, v68
v_mfma_f32_16x16x32_bf16 a[72:75], v[112:115], a[192:195], a[72:75]
ds_read_b128 a[160:163], v216 offset:12288
v_exp_f32 v69, v69
v_mfma_f32_16x16x32_bf16 a[76:79], v[116:119], a[192:195], a[76:79]
ds_read_b64_tr_b16 a[240:241], v227 offset:57344
ds_read_b64_tr_b16 a[242:243], v227 offset:61440
v_cvt_pk_bf16_f32 v86, v68, v69
v_mfma_f32_16x16x32_bf16 a[92:95], v[116:119], a[196:199], a[92:95]
v_exp_f32 v70, v70
v_mfma_f32_16x16x32_bf16 a[88:91], v[112:115], a[196:199], a[88:91]
v_exp_f32 v71, v71
s_waitcnt lgkmcnt(8)
v_mfma_f32_16x16x32_bf16 a[104:107], v[112:115], a[200:203], a[104:107]
buffer_load_dwordx4 v233, s[12:15], s39 offen offset:3072  lds
v_cvt_pk_bf16_f32 v87, v70, v71
v_mfma_f32_16x16x32_bf16 a[108:111], v[116:119], a[200:203], a[108:111]
v_mfma_f32_16x16x32_bf16 a[124:127], v[116:119], a[204:207], a[124:127]
v_mfma_f32_16x16x32_bf16 a[120:123], v[112:115], a[204:207], a[120:123]
v_smfmac_f32_16x16x64_bf16 a[132:135], a[208:211], v[112:119], v245
s_mov_b32 s33, 6
K_LOOPIN:
s_waitcnt lgkmcnt(0)
v_lshlrev_b32 v241, 4, v1
s_mov_b32 s46, s44
.p2align 6
K_LOOP:
s_cmp_eq_u32 s33, s3
s_cbranch_scc1 K_EVT
K_EVT_RET:
v_mfma_f32_16x16x32_bf16 v[40:43], a[144:147], v[152:155], v[136:139]
v_exp_f32 v8, v8
v_mfma_f32_16x16x32_bf16 v[40:43], a[148:151], v[156:159], v[40:43]
v_exp_f32 v9, v9
v_mfma_f32_16x16x32_bf16 v[40:43], a[152:155], v[160:163], v[40:43]
v_cvt_pk_bf16_f32 v88, v8, v9
v_mfma_f32_16x16x32_bf16 v[40:43], a[156:159], v[164:167], v[40:43]
v_exp_f32 v10, v10
v_mfma_f32_16x16x32_bf16 v[48:51], a[156:159], v[180:183], v[140:143]
v_mfma_f32_16x16x32_bf16 v[48:51], a[152:155], v[176:179], v[48:51]
v_exp_f32 v11, v11
v_mfma_f32_16x16x32_bf16 v[48:51], a[148:151], v[172:175], v[48:51]
v_cvt_pk_bf16_f32 v89, v10, v11
v_mfma_f32_16x16x32_bf16 v[48:51], a[144:147], v[168:171], v[48:51]
v_exp_f32 v12, v12
v_mfma_f32_16x16x32_bf16 v[56:59], a[144:147], v[184:187], v[144:147]
v_mfma_f32_16x16x32_bf16 v[56:59], a[148:151], v[188:191], v[56:59]
v_exp_f32 v13, v13
v_mfma_f32_16x16x32_bf16 v[56:59], a[152:155], v[192:195], v[56:59]
v_cvt_pk_bf16_f32 v90, v12, v13
v_mfma_f32_16x16x32_bf16 v[56:59], a[156:159], v[196:199], v[56:59]
v_exp_f32 v14, v14
v_mfma_f32_16x16x32_bf16 v[64:67], a[156:159], v[212:215], v[148:151]
s_waitcnt vmcnt(10) lgkmcnt(0)
s_barrier
v_mfma_f32_16x16x32_bf16 v[64:67], a[152:155], v[208:211], v[64:67]
v_exp_f32 v15, v15
v_mfma_f32_16x16x32_bf16 v[64:67], a[148:151], v[204:207], v[64:67]
ds_read_b128 a[156:159], v219 offset:16384
v_cvt_pk_bf16_f32 v91, v14, v15
v_mfma_f32_16x16x32_bf16 v[64:67], a[144:147], v[200:203], v[64:67]
v_exp_f32 v16, v16
v_mfma_f32_16x16x32_bf16 a[0:3], v[72:75], a[212:215], a[0:3]
ds_read_b128 a[152:155], v218 offset:16384
ds_read_b128 a[148:151], v217 offset:16384
v_mfma_f32_16x16x32_bf16 a[0:3], v[104:107], a[176:179], a[0:3]
v_exp_f32 v17, v17
v_mfma_f32_16x16x32_bf16 a[4:7], v[108:111], a[176:179], a[4:7]
ds_read_b128 a[144:147], v216 offset:16384
v_cvt_pk_bf16_f32 v92, v16, v17
v_mfma_f32_16x16x32_bf16 a[4:7], v[76:79], a[212:215], a[4:7]
v_exp_f32 v18, v18
v_mfma_f32_16x16x32_bf16 a[20:23], v[76:79], a[216:219], a[20:23]
ds_read_b64_tr_b16 a[176:177], v220 offset:0
ds_read_b64_tr_b16 a[178:179], v220 offset:4096
v_mfma_f32_16x16x32_bf16 a[20:23], v[108:111], a[180:183], a[20:23]
v_exp_f32 v19, v19
v_mfma_f32_16x16x32_bf16 a[16:19], v[104:107], a[180:183], a[16:19]
ds_read_b64_tr_b16 a[180:181], v221 offset:0
v_cvt_pk_bf16_f32 v93, v18, v19
v_mfma_f32_16x16x32_bf16 a[16:19], v[72:75], a[216:219], a[16:19]
v_exp_f32 v20, v20
v_mfma_f32_16x16x32_bf16 a[32:35], v[72:75], a[220:223], a[32:35]
ds_read_b64_tr_b16 a[182:183], v221 offset:4096
s_add_u32 s32, s32, 16384
v_mfma_f32_16x16x32_bf16 a[32:35], v[104:107], a[184:187], a[32:35]
v_exp_f32 v21, v21
v_mfma_f32_16x16x32_bf16 a[36:39], v[108:111], a[184:187], a[36:39]
ds_read_b64_tr_b16 a[184:185], v222 offset:0
v_cvt_pk_bf16_f32 v94, v20, v21
v_mfma_f32_16x16x32_bf16 a[36:39], v[76:79], a[220:223], a[36:39]
v_exp_f32 v22, v22
v_mfma_f32_16x16x32_bf16 a[52:55], v[76:79], a[224:227], a[52:55]
ds_read_b64_tr_b16 a[186:187], v222 offset:4096
s_add_u32 m0, s30, 65536
v_mfma_f32_16x16x32_bf16 a[52:55], v[108:111], a[188:191], a[52:55]
v_exp_f32 v23, v23
v_mfma_f32_16x16x32_bf16 a[48:51], v[104:107], a[188:191], a[48:51]
ds_read_b64_tr_b16 a[188:189], v223 offset:0
v_cvt_pk_bf16_f32 v95, v22, v23
v_mfma_f32_16x16x32_bf16 a[48:51], v[72:75], a[224:227], a[48:51]
v_exp_f32 v24, v24
v_smfmac_f32_16x16x64_bf16 a[128:131], a[208:211], v[72:79], v245
v_exp_f32 v25, v25
v_mfma_f32_16x16x32_bf16 v[44:47], a[160:163], v[152:155], v[136:139]
ds_read_b64_tr_b16 a[190:191], v223 offset:4096
v_cvt_pk_bf16_f32 v96, v24, v25
v_mfma_f32_16x16x32_bf16 v[44:47], a[164:167], v[156:159], v[44:47]
v_exp_f32 v26, v26
v_mfma_f32_16x16x32_bf16 v[44:47], a[168:171], v[160:163], v[44:47]
buffer_load_dwordx4 v228, s[8:11], s32 offen offset:0  lds
v_mfma_f32_16x16x32_bf16 v[44:47], a[172:175], v[164:167], v[44:47]
v_exp_f32 v27, v27
v_mfma_f32_16x16x32_bf16 v[52:55], a[172:175], v[180:183], v[140:143]
v_cvt_pk_bf16_f32 v97, v26, v27
v_mfma_f32_16x16x32_bf16 v[52:55], a[168:171], v[176:179], v[52:55]
v_exp_f32 v28, v28
v_mfma_f32_16x16x32_bf16 v[52:55], a[164:167], v[172:175], v[52:55]
buffer_load_dwordx4 v229, s[8:11], s32 offen offset:1024  lds
v_mfma_f32_16x16x32_bf16 v[52:55], a[160:163], v[168:171], v[52:55]
v_exp_f32 v29, v29
v_mfma_f32_16x16x32_bf16 v[60:63], a[160:163], v[184:187], v[144:147]
v_cvt_pk_bf16_f32 v98, v28, v29
v_mfma_f32_16x16x32_bf16 v[60:63], a[164:167], v[188:191], v[60:63]
v_exp_f32 v30, v30
v_mfma_f32_16x16x32_bf16 v[60:63], a[168:171], v[192:195], v[60:63]
buffer_load_dwordx4 v230, s[8:11], s32 offen offset:2048  lds
v_mfma_f32_16x16x32_bf16 v[60:63], a[172:175], v[196:199], v[60:63]
v_exp_f32 v31, v31
v_mfma_f32_16x16x32_bf16 v[68:71], a[172:175], v[212:215], v[148:151]
ds_read_b128 a[172:175], v219 offset:20480
v_cvt_pk_bf16_f32 v99, v30, v31
v_mfma_f32_16x16x32_bf16 v[68:71], a[168:171], v[208:211], v[68:71]
v_exp_f32 v32, v32
v_mfma_f32_16x16x32_bf16 v[68:71], a[164:167], v[204:207], v[68:71]
ds_read_b128 a[168:171], v218 offset:20480
ds_read_b128 a[164:167], v217 offset:20480
v_mfma_f32_16x16x32_bf16 v[68:71], a[160:163], v[200:203], v[68:71]
v_exp_f32 v33, v33
v_mfma_f32_16x16x32_bf16 a[64:67], v[72:75], a[228:231], a[64:67]
ds_read_b128 a[160:163], v216 offset:20480
v_cvt_pk_bf16_f32 v100, v32, v33
v_mfma_f32_16x16x32_bf16 a[64:67], v[104:107], a[192:195], a[64:67]
v_exp_f32 v34, v34
v_mfma_f32_16x16x32_bf16 a[68:71], v[108:111], a[192:195], a[68:71]
ds_read_b64_tr_b16 a[192:193], v224 offset:0
ds_read_b64_tr_b16 a[194:195], v224 offset:4096
v_mfma_f32_16x16x32_bf16 a[68:71], v[76:79], a[228:231], a[68:71]
v_exp_f32 v35, v35
v_mfma_f32_16x16x32_bf16 a[84:87], v[76:79], a[232:235], a[84:87]
v_cvt_pk_bf16_f32 v101, v34, v35
v_mfma_f32_16x16x32_bf16 a[84:87], v[108:111], a[196:199], a[84:87]
v_exp_f32 v36, v36
v_mfma_f32_16x16x32_bf16 a[80:83], v[104:107], a[196:199], a[80:83]
ds_read_b64_tr_b16 a[196:197], v225 offset:0
ds_read_b64_tr_b16 a[198:199], v225 offset:4096
v_mfma_f32_16x16x32_bf16 a[80:83], v[72:75], a[232:235], a[80:83]
v_exp_f32 v37, v37
v_mfma_f32_16x16x32_bf16 a[96:99], v[72:75], a[236:239], a[96:99]
v_cvt_pk_bf16_f32 v102, v36, v37
v_mfma_f32_16x16x32_bf16 a[96:99], v[104:107], a[200:203], a[96:99]
v_exp_f32 v38, v38
v_mfma_f32_16x16x32_bf16 a[100:103], v[108:111], a[200:203], a[100:103]
ds_read_b64_tr_b16 a[200:201], v226 offset:0
ds_read_b64_tr_b16 a[202:203], v226 offset:4096
v_mfma_f32_16x16x32_bf16 a[100:103], v[76:79], a[236:239], a[100:103]
v_exp_f32 v39, v39
v_mfma_f32_16x16x32_bf16 a[116:119], v[76:79], a[240:243], a[116:119]
v_cvt_pk_bf16_f32 v103, v38, v39
v_mfma_f32_16x16x32_bf16 a[116:119], v[108:111], a[204:207], a[116:119]
buffer_load_dwordx4 v231, s[8:11], s32 offen offset:3072  lds
v_mfma_f32_16x16x32_bf16 a[112:115], v[104:107], a[204:207], a[112:115]
ds_read_b64_tr_b16 a[204:205], v227 offset:0
ds_read_b64_tr_b16 a[206:207], v227 offset:4096
v_mfma_f32_16x16x32_bf16 a[112:115], v[72:75], a[240:243], a[112:115]
s_mov_b32 m0, s87
s_lshl2_add_u32 s50, s87, s89
buffer_load_dwordx4 v243, s[56:59], s50 offen  lds
v_smfmac_f32_16x16x64_bf16 a[132:135], a[208:211], v[80:87], v245
s_add_u32 s87, s87, 3456
s_min_u32 s87, s87, 63936
s_waitcnt lgkmcnt(8)
v_mfma_f32_16x16x32_bf16 v[8:11], a[144:147], v[152:155], v[136:139]
v_exp_f32 v40, v40
v_mfma_f32_16x16x32_bf16 v[8:11], a[148:151], v[156:159], v[8:11]
v_exp_f32 v41, v41
v_mfma_f32_16x16x32_bf16 v[8:11], a[152:155], v[160:163], v[8:11]
v_cvt_pk_bf16_f32 v104, v40, v41
v_mfma_f32_16x16x32_bf16 v[8:11], a[156:159], v[164:167], v[8:11]
v_exp_f32 v42, v42
v_mfma_f32_16x16x32_bf16 v[16:19], a[156:159], v[180:183], v[140:143]
s_add_u32 s39, s39, 16384
v_mfma_f32_16x16x32_bf16 v[16:19], a[152:155], v[176:179], v[16:19]
v_exp_f32 v43, v43
v_mfma_f32_16x16x32_bf16 v[16:19], a[148:151], v[172:175], v[16:19]
v_cvt_pk_bf16_f32 v105, v42, v43
v_mfma_f32_16x16x32_bf16 v[16:19], a[144:147], v[168:171], v[16:19]
v_exp_f32 v44, v44
v_mfma_f32_16x16x32_bf16 v[24:27], a[144:147], v[184:187], v[144:147]
v_mfma_f32_16x16x32_bf16 v[24:27], a[148:151], v[188:191], v[24:27]
v_exp_f32 v45, v45
v_mfma_f32_16x16x32_bf16 v[24:27], a[152:155], v[192:195], v[24:27]
s_add_u32 m0, s30, 147456
v_cvt_pk_bf16_f32 v106, v44, v45
v_mfma_f32_16x16x32_bf16 v[24:27], a[156:159], v[196:199], v[24:27]
v_exp_f32 v46, v46
v_mfma_f32_16x16x32_bf16 v[32:35], a[156:159], v[212:215], v[148:151]
ds_read_b128 a[156:159], v219 offset:24576
v_mfma_f32_16x16x32_bf16 v[32:35], a[152:155], v[208:211], v[32:35]
v_exp_f32 v47, v47
v_mfma_f32_16x16x32_bf16 v[32:35], a[148:151], v[204:207], v[32:35]
ds_read_b128 a[152:155], v218 offset:24576
v_cvt_pk_bf16_f32 v107, v46, v47
v_mfma_f32_16x16x32_bf16 v[32:35], a[144:147], v[200:203], v[32:35]
v_exp_f32 v48, v48
v_mfma_f32_16x16x32_bf16 a[8:11], v[96:99], a[176:179], a[8:11]
ds_read_b128 a[148:151], v217 offset:24576
ds_read_b128 a[144:147], v216 offset:24576
v_mfma_f32_16x16x32_bf16 a[8:11], v[80:83], a[212:215], a[8:11]
v_exp_f32 v49, v49
v_mfma_f32_16x16x32_bf16 a[12:15], v[84:87], a[212:215], a[12:15]
ds_read_b64_tr_b16 a[212:213], v220 offset:8192
v_cvt_pk_bf16_f32 v108, v48, v49
v_mfma_f32_16x16x32_bf16 a[12:15], v[100:103], a[176:179], a[12:15]
v_exp_f32 v50, v50
v_mfma_f32_16x16x32_bf16 a[28:31], v[100:103], a[180:183], a[28:31]
ds_read_b64_tr_b16 a[214:215], v220 offset:12288
v_mfma_f32_16x16x32_bf16 a[28:31], v[84:87], a[216:219], a[28:31]
v_exp_f32 v51, v51
v_mfma_f32_16x16x32_bf16 a[24:27], v[80:83], a[216:219], a[24:27]
ds_read_b64_tr_b16 a[216:217], v221 offset:8192
v_cvt_pk_bf16_f32 v109, v50, v51
v_mfma_f32_16x16x32_bf16 a[24:27], v[96:99], a[180:183], a[24:27]
v_exp_f32 v52, v52
v_mfma_f32_16x16x32_bf16 a[40:43], v[96:99], a[184:187], a[40:43]
ds_read_b64_tr_b16 a[218:219], v221 offset:12288
v_mfma_f32_16x16x32_bf16 a[40:43], v[80:83], a[220:223], a[40:43]
v_exp_f32 v53, v53
v_mfma_f32_16x16x32_bf16 a[44:47], v[84:87], a[220:223], a[44:47]
ds_read_b64_tr_b16 a[220:221], v222 offset:8192
v_cvt_pk_bf16_f32 v110, v52, v53
v_mfma_f32_16x16x32_bf16 a[44:47], v[100:103], a[184:187], a[44:47]
v_exp_f32 v54, v54
v_mfma_f32_16x16x32_bf16 a[60:63], v[100:103], a[188:191], a[60:63]
ds_read_b64_tr_b16 a[222:223], v222 offset:12288
v_mfma_f32_16x16x32_bf16 a[60:63], v[84:87], a[224:227], a[60:63]
v_exp_f32 v55, v55
v_mfma_f32_16x16x32_bf16 a[56:59], v[80:83], a[224:227], a[56:59]
ds_read_b64_tr_b16 a[224:225], v223 offset:8192
v_cvt_pk_bf16_f32 v111, v54, v55
v_mfma_f32_16x16x32_bf16 a[56:59], v[96:99], a[188:191], a[56:59]
v_exp_f32 v56, v56
v_smfmac_f32_16x16x64_bf16 a[128:131], a[208:211], v[88:95], v245
v_exp_f32 v57, v57
v_mfma_f32_16x16x32_bf16 v[12:15], a[160:163], v[152:155], v[136:139]
ds_read_b64_tr_b16 a[226:227], v223 offset:12288
v_cvt_pk_bf16_f32 v112, v56, v57
v_mfma_f32_16x16x32_bf16 v[12:15], a[164:167], v[156:159], v[12:15]
v_exp_f32 v58, v58
v_mfma_f32_16x16x32_bf16 v[12:15], a[168:171], v[160:163], v[12:15]
buffer_load_dwordx4 v232, s[12:15], s39 offen offset:0  lds
v_mfma_f32_16x16x32_bf16 v[12:15], a[172:175], v[164:167], v[12:15]
v_exp_f32 v59, v59
v_mfma_f32_16x16x32_bf16 v[20:23], a[172:175], v[180:183], v[140:143]
v_cvt_pk_bf16_f32 v113, v58, v59
v_mfma_f32_16x16x32_bf16 v[20:23], a[168:171], v[176:179], v[20:23]
v_exp_f32 v60, v60
v_mfma_f32_16x16x32_bf16 v[20:23], a[164:167], v[172:175], v[20:23]
buffer_load_dwordx4 v233, s[12:15], s39 offen offset:1024  lds
v_mfma_f32_16x16x32_bf16 v[20:23], a[160:163], v[168:171], v[20:23]
v_exp_f32 v61, v61
v_mfma_f32_16x16x32_bf16 v[28:31], a[160:163], v[184:187], v[144:147]
v_cvt_pk_bf16_f32 v114, v60, v61
v_mfma_f32_16x16x32_bf16 v[28:31], a[164:167], v[188:191], v[28:31]
v_exp_f32 v62, v62
v_mfma_f32_16x16x32_bf16 v[28:31], a[168:171], v[192:195], v[28:31]
buffer_load_dwordx4 v232, s[12:15], s39 offen offset:2048  lds
v_mfma_f32_16x16x32_bf16 v[28:31], a[172:175], v[196:199], v[28:31]
v_exp_f32 v63, v63
v_mfma_f32_16x16x32_bf16 v[36:39], a[172:175], v[212:215], v[148:151]
ds_read_b128 a[172:175], v219 offset:28672
v_cvt_pk_bf16_f32 v115, v62, v63
v_mfma_f32_16x16x32_bf16 v[36:39], a[168:171], v[208:211], v[36:39]
v_exp_f32 v64, v64
v_mfma_f32_16x16x32_bf16 v[36:39], a[164:167], v[204:207], v[36:39]
ds_read_b128 a[168:171], v218 offset:28672
ds_read_b128 a[164:167], v217 offset:28672
v_mfma_f32_16x16x32_bf16 v[36:39], a[160:163], v[200:203], v[36:39]
v_exp_f32 v65, v65
s_waitcnt lgkmcnt(8)
v_mfma_f32_16x16x32_bf16 a[72:75], v[96:99], a[192:195], a[72:75]
ds_read_b128 a[160:163], v216 offset:28672
v_cvt_pk_bf16_f32 v116, v64, v65
v_mfma_f32_16x16x32_bf16 a[72:75], v[80:83], a[228:231], a[72:75]
v_exp_f32 v66, v66
v_mfma_f32_16x16x32_bf16 a[76:79], v[84:87], a[228:231], a[76:79]
ds_read_b64_tr_b16 a[228:229], v224 offset:8192
ds_read_b64_tr_b16 a[230:231], v224 offset:12288
v_mfma_f32_16x16x32_bf16 a[76:79], v[100:103], a[192:195], a[76:79]
v_exp_f32 v67, v67
v_mfma_f32_16x16x32_bf16 a[92:95], v[100:103], a[196:199], a[92:95]
v_cvt_pk_bf16_f32 v117, v66, v67
v_mfma_f32_16x16x32_bf16 a[92:95], v[84:87], a[232:235], a[92:95]
v_exp_f32 v68, v68
v_mfma_f32_16x16x32_bf16 a[88:91], v[80:83], a[232:235], a[88:91]
ds_read_b64_tr_b16 a[232:233], v225 offset:8192
ds_read_b64_tr_b16 a[234:235], v225 offset:12288
v_mfma_f32_16x16x32_bf16 a[88:91], v[96:99], a[196:199], a[88:91]
v_exp_f32 v69, v69
v_mfma_f32_16x16x32_bf16 a[104:107], v[96:99], a[200:203], a[104:107]
v_cvt_pk_bf16_f32 v118, v68, v69
v_mfma_f32_16x16x32_bf16 a[104:107], v[80:83], a[236:239], a[104:107]
v_exp_f32 v70, v70
v_mfma_f32_16x16x32_bf16 a[108:111], v[84:87], a[236:239], a[108:111]
ds_read_b64_tr_b16 a[236:237], v226 offset:8192
ds_read_b64_tr_b16 a[238:239], v226 offset:12288
v_mfma_f32_16x16x32_bf16 a[108:111], v[100:103], a[200:203], a[108:111]
v_exp_f32 v71, v71
v_mfma_f32_16x16x32_bf16 a[124:127], v[100:103], a[204:207], a[124:127]
v_cvt_pk_bf16_f32 v119, v70, v71
v_mfma_f32_16x16x32_bf16 a[124:127], v[84:87], a[240:243], a[124:127]
buffer_load_dwordx4 v233, s[12:15], s39 offen offset:3072  lds
v_mfma_f32_16x16x32_bf16 a[120:123], v[80:83], a[240:243], a[120:123]
ds_read_b64_tr_b16 a[240:241], v227 offset:8192
ds_read_b64_tr_b16 a[242:243], v227 offset:12288
v_mfma_f32_16x16x32_bf16 a[120:123], v[96:99], a[204:207], a[120:123]
buffer_load_dword v242, v241, s[20:23], s46 offen sc1
v_smfmac_f32_16x16x64_bf16 a[132:135], a[208:211], v[96:103], v245
v_add_u32 v241, 1024, v241
v_and_b32 v241, 0x3fff, v241
v_mfma_f32_16x16x32_bf16 v[40:43], a[144:147], v[152:155], v[136:139]
v_exp_f32 v8, v8
v_mfma_f32_16x16x32_bf16 v[40:43], a[148:151], v[156:159], v[40:43]
v_exp_f32 v9, v9
v_mfma_f32_16x16x32_bf16 v[40:43], a[152:155], v[160:163], v[40:43]
v_cvt_pk_bf16_f32 v72, v8, v9
v_mfma_f32_16x16x32_bf16 v[40:43], a[156:159], v[164:167], v[40:43]
v_exp_f32 v10, v10
v_mfma_f32_16x16x32_bf16 v[48:51], a[156:159], v[180:183], v[140:143]
v_mfma_f32_16x16x32_bf16 v[48:51], a[152:155], v[176:179], v[48:51]
v_exp_f32 v11, v11
v_mfma_f32_16x16x32_bf16 v[48:51], a[148:151], v[172:175], v[48:51]
v_cvt_pk_bf16_f32 v73, v10, v11
v_mfma_f32_16x16x32_bf16 v[48:51], a[144:147], v[168:171], v[48:51]
v_exp_f32 v12, v12
v_mfma_f32_16x16x32_bf16 v[56:59], a[144:147], v[184:187], v[144:147]
v_mfma_f32_16x16x32_bf16 v[56:59], a[148:151], v[188:191], v[56:59]
v_exp_f32 v13, v13
v_mfma_f32_16x16x32_bf16 v[56:59], a[152:155], v[192:195], v[56:59]
v_cvt_pk_bf16_f32 v74, v12, v13
v_mfma_f32_16x16x32_bf16 v[56:59], a[156:159], v[196:199], v[56:59]
v_exp_f32 v14, v14
v_mfma_f32_16x16x32_bf16 v[64:67], a[156:159], v[212:215], v[148:151]
s_waitcnt vmcnt(10) lgkmcnt(0)
s_barrier
v_mfma_f32_16x16x32_bf16 v[64:67], a[152:155], v[208:211], v[64:67]
v_exp_f32 v15, v15
v_mfma_f32_16x16x32_bf16 v[64:67], a[148:151], v[204:207], v[64:67]
ds_read_b128 a[156:159], v219 offset:49152
v_cvt_pk_bf16_f32 v75, v14, v15
v_mfma_f32_16x16x32_bf16 v[64:67], a[144:147], v[200:203], v[64:67]
v_exp_f32 v16, v16
v_mfma_f32_16x16x32_bf16 a[0:3], v[104:107], a[212:215], a[0:3]
ds_read_b128 a[152:155], v218 offset:49152
ds_read_b128 a[148:151], v217 offset:49152
v_mfma_f32_16x16x32_bf16 a[0:3], v[88:91], a[176:179], a[0:3]
v_exp_f32 v17, v17
v_mfma_f32_16x16x32_bf16 a[4:7], v[92:95], a[176:179], a[4:7]
ds_read_b128 a[144:147], v216 offset:49152
v_cvt_pk_bf16_f32 v76, v16, v17
v_mfma_f32_16x16x32_bf16 a[4:7], v[108:111], a[212:215], a[4:7]
v_exp_f32 v18, v18
v_mfma_f32_16x16x32_bf16 a[20:23], v[108:111], a[216:219], a[20:23]
ds_read_b64_tr_b16 a[176:177], v220 offset:32768
ds_read_b64_tr_b16 a[178:179], v220 offset:36864
v_mfma_f32_16x16x32_bf16 a[20:23], v[92:95], a[180:183], a[20:23]
v_exp_f32 v19, v19
v_mfma_f32_16x16x32_bf16 a[16:19], v[88:91], a[180:183], a[16:19]
ds_read_b64_tr_b16 a[180:181], v221 offset:32768
v_cvt_pk_bf16_f32 v77, v18, v19
v_mfma_f32_16x16x32_bf16 a[16:19], v[104:107], a[216:219], a[16:19]
v_exp_f32 v20, v20
v_mfma_f32_16x16x32_bf16 a[32:35], v[104:107], a[220:223], a[32:35]
ds_read_b64_tr_b16 a[182:183], v221 offset:36864
STUB_10:
s_cbranch_execz HOP_RET1
s_add_u32 s32, s32, 16384
v_mfma_f32_16x16x32_bf16 a[32:35], v[88:91], a[184:187], a[32:35]
v_exp_f32 v21, v21
v_mfma_f32_16x16x32_bf16 a[36:39], v[92:95], a[184:187], a[36:39]
ds_read_b64_tr_b16 a[184:185], v222 offset:32768
v_cvt_pk_bf16_f32 v78, v20, v21
v_mfma_f32_16x16x32_bf16 a[36:39], v[108:111], a[220:223], a[36:39]
v_exp_f32 v22, v22
v_mfma_f32_16x16x32_bf16 a[52:55], v[108:111], a[224:227], a[52:55]
ds_read_b64_tr_b16 a[186:187], v222 offset:36864
s_add_u32 m0, s30, 81920
v_mfma_f32_16x16x32_bf16 a[52:55], v[92:95], a[188:191], a[52:55]
v_exp_f32 v23, v23
v_mfma_f32_16x16x32_bf16 a[48:51], v[88:91], a[188:191], a[48:51]
ds_read_b64_tr_b16 a[188:189], v223 offset:32768
v_cvt_pk_bf16_f32 v79, v22, v23
v_mfma_f32_16x16x32_bf16 a[48:51], v[104:107], a[224:227], a[48:51]
v_exp_f32 v24, v24
v_smfmac_f32_16x16x64_bf16 a[128:131], a[208:211], v[104:111], v245
v_exp_f32 v25, v25
v_mfma_f32_16x16x32_bf16 v[44:47], a[160:163], v[152:155], v[136:139]
ds_read_b64_tr_b16 a[190:191], v223 offset:36864
v_cvt_pk_bf16_f32 v80, v24, v25
v_mfma_f32_16x16x32_bf16 v[44:47], a[164:167], v[156:159], v[44:47]
v_exp_f32 v26, v26
v_mfma_f32_16x16x32_bf16 v[44:47], a[168:171], v[160:163], v[44:47]
buffer_load_dwordx4 v228, s[8:11], s32 offen offset:0  lds
v_mfma_f32_16x16x32_bf16 v[44:47], a[172:175], v[164:167], v[44:47]
v_exp_f32 v27, v27
v_mfma_f32_16x16x32_bf16 v[52:55], a[172:175], v[180:183], v[140:143]
v_cvt_pk_bf16_f32 v81, v26, v27
v_mfma_f32_16x16x32_bf16 v[52:55], a[168:171], v[176:179], v[52:55]
v_exp_f32 v28, v28
v_mfma_f32_16x16x32_bf16 v[52:55], a[164:167], v[172:175], v[52:55]
buffer_load_dwordx4 v229, s[8:11], s32 offen offset:1024  lds
v_mfma_f32_16x16x32_bf16 v[52:55], a[160:163], v[168:171], v[52:55]
v_exp_f32 v29, v29
v_mfma_f32_16x16x32_bf16 v[60:63], a[160:163], v[184:187], v[144:147]
v_cvt_pk_bf16_f32 v82, v28, v29
v_mfma_f32_16x16x32_bf16 v[60:63], a[164:167], v[188:191], v[60:63]
v_exp_f32 v30, v30
v_mfma_f32_16x16x32_bf16 v[60:63], a[168:171], v[192:195], v[60:63]
buffer_load_dwordx4 v230, s[8:11], s32 offen offset:2048  lds
v_mfma_f32_16x16x32_bf16 v[60:63], a[172:175], v[196:199], v[60:63]
v_exp_f32 v31, v31
v_mfma_f32_16x16x32_bf16 v[68:71], a[172:175], v[212:215], v[148:151]
ds_read_b128 a[172:175], v219 offset:53248
v_cvt_pk_bf16_f32 v83, v30, v31
v_mfma_f32_16x16x32_bf16 v[68:71], a[168:171], v[208:211], v[68:71]
v_exp_f32 v32, v32
v_mfma_f32_16x16x32_bf16 v[68:71], a[164:167], v[204:207], v[68:71]
ds_read_b128 a[168:171], v218 offset:53248
ds_read_b128 a[164:167], v217 offset:53248
v_mfma_f32_16x16x32_bf16 v[68:71], a[160:163], v[200:203], v[68:71]
v_exp_f32 v33, v33
v_mfma_f32_16x16x32_bf16 a[64:67], v[104:107], a[228:231], a[64:67]
ds_read_b128 a[160:163], v216 offset:53248
v_cvt_pk_bf16_f32 v84, v32, v33
v_mfma_f32_16x16x32_bf16 a[64:67], v[88:91], a[192:195], a[64:67]
v_exp_f32 v34, v34
v_mfma_f32_16x16x32_bf16 a[68:71], v[92:95], a[192:195], a[68:71]
ds_read_b64_tr_b16 a[192:193], v224 offset:32768
ds_read_b64_tr_b16 a[194:195], v224 offset:36864
v_mfma_f32_16x16x32_bf16 a[68:71], v[108:111], a[228:231], a[68:71]
v_exp_f32 v35, v35
v_mfma_f32_16x16x32_bf16 a[84:87], v[108:111], a[232:235], a[84:87]
v_cvt_pk_bf16_f32 v85, v34, v35
v_mfma_f32_16x16x32_bf16 a[84:87], v[92:95], a[196:199], a[84:87]
v_exp_f32 v36, v36
v_mfma_f32_16x16x32_bf16 a[80:83], v[88:91], a[196:199], a[80:83]
ds_read_b64_tr_b16 a[196:197], v225 offset:32768
ds_read_b64_tr_b16 a[198:199], v225 offset:36864
v_mfma_f32_16x16x32_bf16 a[80:83], v[104:107], a[232:235], a[80:83]
v_exp_f32 v37, v37
v_mfma_f32_16x16x32_bf16 a[96:99], v[104:107], a[236:239], a[96:99]
v_cvt_pk_bf16_f32 v86, v36, v37
v_mfma_f32_16x16x32_bf16 a[96:99], v[88:91], a[200:203], a[96:99]
v_exp_f32 v38, v38
v_mfma_f32_16x16x32_bf16 a[100:103], v[92:95], a[200:203], a[100:103]
ds_read_b64_tr_b16 a[200:201], v226 offset:32768
ds_read_b64_tr_b16 a[202:203], v226 offset:36864
v_mfma_f32_16x16x32_bf16 a[100:103], v[108:111], a[236:239], a[100:103]
v_exp_f32 v39, v39
v_mfma_f32_16x16x32_bf16 a[116:119], v[108:111], a[240:243], a[116:119]
v_cvt_pk_bf16_f32 v87, v38, v39
v_mfma_f32_16x16x32_bf16 a[116:119], v[92:95], a[204:207], a[116:119]
buffer_load_dwordx4 v231, s[8:11], s32 offen offset:3072  lds
v_mfma_f32_16x16x32_bf16 a[112:115], v[88:91], a[204:207], a[112:115]
ds_read_b64_tr_b16 a[204:205], v227 offset:32768
ds_read_b64_tr_b16 a[206:207], v227 offset:36864
v_mfma_f32_16x16x32_bf16 a[112:115], v[104:107], a[240:243], a[112:115]
s_mov_b32 m0, s87
s_lshl2_add_u32 s50, s87, s89
buffer_load_dwordx4 v243, s[56:59], s50 offen  lds
v_smfmac_f32_16x16x64_bf16 a[132:135], a[208:211], v[112:119], v245
s_add_u32 s87, s87, 3456
s_min_u32 s87, s87, 63936
s_waitcnt lgkmcnt(8)
v_mfma_f32_16x16x32_bf16 v[8:11], a[144:147], v[152:155], v[136:139]
v_exp_f32 v40, v40
v_mfma_f32_16x16x32_bf16 v[8:11], a[148:151], v[156:159], v[8:11]
v_exp_f32 v41, v41
v_mfma_f32_16x16x32_bf16 v[8:11], a[152:155], v[160:163], v[8:11]
v_cvt_pk_bf16_f32 v88, v40, v41
v_mfma_f32_16x16x32_bf16 v[8:11], a[156:159], v[164:167], v[8:11]
v_exp_f32 v42, v42
v_mfma_f32_16x16x32_bf16 v[16:19], a[156:159], v[180:183], v[140:143]
s_add_u32 s39, s39, 16384
v_mfma_f32_16x16x32_bf16 v[16:19], a[152:155], v[176:179], v[16:19]
v_exp_f32 v43, v43
v_mfma_f32_16x16x32_bf16 v[16:19], a[148:151], v[172:175], v[16:19]
v_cvt_pk_bf16_f32 v89, v42, v43
v_mfma_f32_16x16x32_bf16 v[16:19], a[144:147], v[168:171], v[16:19]
v_exp_f32 v44, v44
v_mfma_f32_16x16x32_bf16 v[24:27], a[144:147], v[184:187], v[144:147]
v_mfma_f32_16x16x32_bf16 v[24:27], a[148:151], v[188:191], v[24:27]
v_exp_f32 v45, v45
v_mfma_f32_16x16x32_bf16 v[24:27], a[152:155], v[192:195], v[24:27]
s_add_u32 m0, s30, 98304
v_cvt_pk_bf16_f32 v90, v44, v45
v_mfma_f32_16x16x32_bf16 v[24:27], a[156:159], v[196:199], v[24:27]
v_exp_f32 v46, v46
v_mfma_f32_16x16x32_bf16 v[32:35], a[156:159], v[212:215], v[148:151]
ds_read_b128 a[156:159], v219 offset:57344
v_mfma_f32_16x16x32_bf16 v[32:35], a[152:155], v[208:211], v[32:35]
v_exp_f32 v47, v47
v_mfma_f32_16x16x32_bf16 v[32:35], a[148:151], v[204:207], v[32:35]
ds_read_b128 a[152:155], v218 offset:57344
v_cvt_pk_bf16_f32 v91, v46, v47
v_mfma_f32_16x16x32_bf16 v[32:35], a[144:147], v[200:203], v[32:35]
v_exp_f32 v48, v48
v_mfma_f32_16x16x32_bf16 a[8:11], v[80:83], a[176:179], a[8:11]
ds_read_b128 a[148:151], v217 offset:57344
ds_read_b128 a[144:147], v216 offset:57344
v_mfma_f32_16x16x32_bf16 a[8:11], v[112:115], a[212:215], a[8:11]
v_exp_f32 v49, v49
v_mfma_f32_16x16x32_bf16 a[12:15], v[116:119], a[212:215], a[12:15]
ds_read_b64_tr_b16 a[212:213], v220 offset:40960
v_cvt_pk_bf16_f32 v92, v48, v49
v_mfma_f32_16x16x32_bf16 a[12:15], v[84:87], a[176:179], a[12:15]
v_exp_f32 v50, v50
v_mfma_f32_16x16x32_bf16 a[28:31], v[84:87], a[180:183], a[28:31]
ds_read_b64_tr_b16 a[214:215], v220 offset:45056
v_mfma_f32_16x16x32_bf16 a[28:31], v[116:119], a[216:219], a[28:31]
v_exp_f32 v51, v51
v_mfma_f32_16x16x32_bf16 a[24:27], v[112:115], a[216:219], a[24:27]
ds_read_b64_tr_b16 a[216:217], v221 offset:40960
v_cvt_pk_bf16_f32 v93, v50, v51
v_mfma_f32_16x16x32_bf16 a[24:27], v[80:83], a[180:183], a[24:27]
v_exp_f32 v52, v52
v_mfma_f32_16x16x32_bf16 a[40:43], v[80:83], a[184:187], a[40:43]
ds_read_b64_tr_b16 a[218:219], v221 offset:45056
v_mfma_f32_16x16x32_bf16 a[40:43], v[112:115], a[220:223], a[40:43]
v_exp_f32 v53, v53
v_mfma_f32_16x16x32_bf16 a[44:47], v[116:119], a[220:223], a[44:47]
ds_read_b64_tr_b16 a[220:221], v222 offset:40960
v_cvt_pk_bf16_f32 v94, v52, v53
v_mfma_f32_16x16x32_bf16 a[44:47], v[84:87], a[184:187], a[44:47]
v_exp_f32 v54, v54
v_mfma_f32_16x16x32_bf16 a[60:63], v[84:87], a[188:191], a[60:63]
ds_read_b64_tr_b16 a[222:223], v222 offset:45056
v_mfma_f32_16x16x32_bf16 a[60:63], v[116:119], a[224:227], a[60:63]
v_exp_f32 v55, v55
v_mfma_f32_16x16x32_bf16 a[56:59], v[112:115], a[224:227], a[56:59]
ds_read_b64_tr_b16 a[224:225], v223 offset:40960
v_cvt_pk_bf16_f32 v95, v54, v55
v_mfma_f32_16x16x32_bf16 a[56:59], v[80:83], a[188:191], a[56:59]
v_exp_f32 v56, v56
v_smfmac_f32_16x16x64_bf16 a[128:131], a[208:211], v[72:79], v245
v_exp_f32 v57, v57
v_mfma_f32_16x16x32_bf16 v[12:15], a[160:163], v[152:155], v[136:139]
ds_read_b64_tr_b16 a[226:227], v223 offset:45056
v_cvt_pk_bf16_f32 v96, v56, v57
v_mfma_f32_16x16x32_bf16 v[12:15], a[164:167], v[156:159], v[12:15]
v_exp_f32 v58, v58
v_mfma_f32_16x16x32_bf16 v[12:15], a[168:171], v[160:163], v[12:15]
buffer_load_dwordx4 v232, s[12:15], s39 offen offset:0  lds
v_mfma_f32_16x16x32_bf16 v[12:15], a[172:175], v[164:167], v[12:15]
v_exp_f32 v59, v59
v_mfma_f32_16x16x32_bf16 v[20:23], a[172:175], v[180:183], v[140:143]
v_cvt_pk_bf16_f32 v97, v58, v59
v_mfma_f32_16x16x32_bf16 v[20:23], a[168:171], v[176:179], v[20:23]
v_exp_f32 v60, v60
v_mfma_f32_16x16x32_bf16 v[20:23], a[164:167], v[172:175], v[20:23]
buffer_load_dwordx4 v233, s[12:15], s39 offen offset:1024  lds
v_mfma_f32_16x16x32_bf16 v[20:23], a[160:163], v[168:171], v[20:23]
v_exp_f32 v61, v61
v_mfma_f32_16x16x32_bf16 v[28:31], a[160:163], v[184:187], v[144:147]
v_cvt_pk_bf16_f32 v98, v60, v61
v_mfma_f32_16x16x32_bf16 v[28:31], a[164:167], v[188:191], v[28:31]
v_exp_f32 v62, v62
v_mfma_f32_16x16x32_bf16 v[28:31], a[168:171], v[192:195], v[28:31]
buffer_load_dwordx4 v232, s[12:15], s39 offen offset:2048  lds
v_mfma_f32_16x16x32_bf16 v[28:31], a[172:175], v[196:199], v[28:31]
v_exp_f32 v63, v63
v_mfma_f32_16x16x32_bf16 v[36:39], a[172:175], v[212:215], v[148:151]
ds_read_b128 a[172:175], v219 offset:61440
v_cvt_pk_bf16_f32 v99, v62, v63
v_mfma_f32_16x16x32_bf16 v[36:39], a[168:171], v[208:211], v[36:39]
v_exp_f32 v64, v64
v_mfma_f32_16x16x32_bf16 v[36:39], a[164:167], v[204:207], v[36:39]
ds_read_b128 a[168:171], v218 offset:61440
ds_read_b128 a[164:167], v217 offset:61440
v_mfma_f32_16x16x32_bf16 v[36:39], a[160:163], v[200:203], v[36:39]
v_exp_f32 v65, v65
s_waitcnt lgkmcnt(8)
v_mfma_f32_16x16x32_bf16 a[72:75], v[80:83], a[192:195], a[72:75]
ds_read_b128 a[160:163], v216 offset:61440
v_cvt_pk_bf16_f32 v100, v64, v65
v_mfma_f32_16x16x32_bf16 a[72:75], v[112:115], a[228:231], a[72:75]
v_exp_f32 v66, v66
v_mfma_f32_16x16x32_bf16 a[76:79], v[116:119], a[228:231], a[76:79]
ds_read_b64_tr_b16 a[228:229], v224 offset:40960
ds_read_b64_tr_b16 a[230:231], v224 offset:45056
v_mfma_f32_16x16x32_bf16 a[76:79], v[84:87], a[192:195], a[76:79]
v_exp_f32 v67, v67
v_mfma_f32_16x16x32_bf16 a[92:95], v[84:87], a[196:199], a[92:95]
v_cvt_pk_bf16_f32 v101, v66, v67
v_mfma_f32_16x16x32_bf16 a[92:95], v[116:119], a[232:235], a[92:95]
v_exp_f32 v68, v68
v_mfma_f32_16x16x32_bf16 a[88:91], v[112:115], a[232:235], a[88:91]
ds_read_b64_tr_b16 a[232:233], v225 offset:40960
ds_read_b64_tr_b16 a[234:235], v225 offset:45056
v_mfma_f32_16x16x32_bf16 a[88:91], v[80:83], a[196:199], a[88:91]
v_exp_f32 v69, v69
v_mfma_f32_16x16x32_bf16 a[104:107], v[80:83], a[200:203], a[104:107]
v_cvt_pk_bf16_f32 v102, v68, v69
v_mfma_f32_16x16x32_bf16 a[104:107], v[112:115], a[236:239], a[104:107]
v_exp_f32 v70, v70
v_mfma_f32_16x16x32_bf16 a[108:111], v[116:119], a[236:239], a[108:111]
ds_read_b64_tr_b16 a[236:237], v226 offset:40960
ds_read_b64_tr_b16 a[238:239], v226 offset:45056
v_mfma_f32_16x16x32_bf16 a[108:111], v[84:87], a[200:203], a[108:111]
v_exp_f32 v71, v71
v_mfma_f32_16x16x32_bf16 a[124:127], v[84:87], a[204:207], a[124:127]
v_cvt_pk_bf16_f32 v103, v70, v71
v_mfma_f32_16x16x32_bf16 a[124:127], v[116:119], a[240:243], a[124:127]
buffer_load_dwordx4 v233, s[12:15], s39 offen offset:3072  lds
v_mfma_f32_16x16x32_bf16 a[120:123], v[112:115], a[240:243], a[120:123]
ds_read_b64_tr_b16 a[240:241], v227 offset:40960
ds_read_b64_tr_b16 a[242:243], v227 offset:45056
v_mfma_f32_16x16x32_bf16 a[120:123], v[80:83], a[204:207], a[120:123]
buffer_load_dword v242, v241, s[20:23], s46 offen sc1
v_smfmac_f32_16x16x64_bf16 a[132:135], a[208:211], v[80:87], v245
v_add_u32 v241, 1024, v241
v_and_b32 v241, 0x3fff, v241
v_mfma_f32_16x16x32_bf16 v[40:43], a[144:147], v[152:155], v[136:139]
v_exp_f32 v8, v8
v_mfma_f32_16x16x32_bf16 v[40:43], a[148:151], v[156:159], v[40:43]
v_exp_f32 v9, v9
v_mfma_f32_16x16x32_bf16 v[40:43], a[152:155], v[160:163], v[40:43]
v_cvt_pk_bf16_f32 v104, v8, v9
v_mfma_f32_16x16x32_bf16 v[40:43], a[156:159], v[164:167], v[40:43]
v_exp_f32 v10, v10
v_mfma_f32_16x16x32_bf16 v[48:51], a[156:159], v[180:183], v[140:143]
v_mfma_f32_16x16x32_bf16 v[48:51], a[152:155], v[176:179], v[48:51]
v_exp_f32 v11, v11
v_mfma_f32_16x16x32_bf16 v[48:51], a[148:151], v[172:175], v[48:51]
v_cvt_pk_bf16_f32 v105, v10, v11
v_mfma_f32_16x16x32_bf16 v[48:51], a[144:147], v[168:171], v[48:51]
v_exp_f32 v12, v12
v_mfma_f32_16x16x32_bf16 v[56:59], a[144:147], v[184:187], v[144:147]
v_mfma_f32_16x16x32_bf16 v[56:59], a[148:151], v[188:191], v[56:59]
v_exp_f32 v13, v13
v_mfma_f32_16x16x32_bf16 v[56:59], a[152:155], v[192:195], v[56:59]
v_cvt_pk_bf16_f32 v106, v12, v13
v_mfma_f32_16x16x32_bf16 v[56:59], a[156:159], v[196:199], v[56:59]
v_exp_f32 v14, v14
v_mfma_f32_16x16x32_bf16 v[64:67], a[156:159], v[212:215], v[148:151]
s_waitcnt vmcnt(10) lgkmcnt(0)
s_barrier
v_mfma_f32_16x16x32_bf16 v[64:67], a[152:155], v[208:211], v[64:67]
v_exp_f32 v15, v15
v_mfma_f32_16x16x32_bf16 v[64:67], a[148:151], v[204:207], v[64:67]
ds_read_b128 a[156:159], v219 offset:0
v_cvt_pk_bf16_f32 v107, v14, v15
v_mfma_f32_16x16x32_bf16 v[64:67], a[144:147], v[200:203], v[64:67]
v_exp_f32 v16, v16
v_mfma_f32_16x16x32_bf16 a[0:3], v[88:91], a[212:215], a[0:3]
ds_read_b128 a[152:155], v218 offset:0
ds_read_b128 a[148:151], v217 offset:0
v_mfma_f32_16x16x32_bf16 a[0:3], v[72:75], a[176:179], a[0:3]
v_exp_f32 v17, v17
v_mfma_f32_16x16x32_bf16 a[4:7], v[76:79], a[176:179], a[4:7]
ds_read_b128 a[144:147], v216 offset:0
v_cvt_pk_bf16_f32 v108, v16, v17
v_mfma_f32_16x16x32_bf16 a[4:7], v[92:95], a[212:215], a[4:7]
v_exp_f32 v18, v18
v_mfma_f32_16x16x32_bf16 a[20:23], v[92:95], a[216:219], a[20:23]
ds_read_b64_tr_b16 a[176:177], v220 offset:49152
ds_read_b64_tr_b16 a[178:179], v220 offset:53248
v_mfma_f32_16x16x32_bf16 a[20:23], v[76:79], a[180:183], a[20:23]
v_exp_f32 v19, v19
v_mfma_f32_16x16x32_bf16 a[16:19], v[72:75], a[180:183], a[16:19]
ds_read_b64_tr_b16 a[180:181], v221 offset:49152
v_cvt_pk_bf16_f32 v109, v18, v19
v_mfma_f32_16x16x32_bf16 a[16:19], v[88:91], a[216:219], a[16:19]
v_exp_f32 v20, v20
v_mfma_f32_16x16x32_bf16 a[32:35], v[88:91], a[220:223], a[32:35]
ds_read_b64_tr_b16 a[182:183], v221 offset:53248
s_add_u32 s32, s32, 16384
v_mfma_f32_16x16x32_bf16 a[32:35], v[72:75], a[184:187], a[32:35]
v_exp_f32 v21, v21
v_mfma_f32_16x16x32_bf16 a[36:39], v[76:79], a[184:187], a[36:39]
ds_read_b64_tr_b16 a[184:185], v222 offset:49152
v_cvt_pk_bf16_f32 v110, v20, v21
v_mfma_f32_16x16x32_bf16 a[36:39], v[92:95], a[220:223], a[36:39]
v_exp_f32 v22, v22
v_mfma_f32_16x16x32_bf16 a[52:55], v[92:95], a[224:227], a[52:55]
ds_read_b64_tr_b16 a[186:187], v222 offset:53248
s_add_u32 m0, s30, 114688
v_mfma_f32_16x16x32_bf16 a[52:55], v[76:79], a[188:191], a[52:55]
v_exp_f32 v23, v23
v_mfma_f32_16x16x32_bf16 a[48:51], v[72:75], a[188:191], a[48:51]
ds_read_b64_tr_b16 a[188:189], v223 offset:49152
v_cvt_pk_bf16_f32 v111, v22, v23
v_mfma_f32_16x16x32_bf16 a[48:51], v[88:91], a[224:227], a[48:51]
v_exp_f32 v24, v24
v_smfmac_f32_16x16x64_bf16 a[128:131], a[208:211], v[88:95], v245
v_exp_f32 v25, v25
v_mfma_f32_16x16x32_bf16 v[44:47], a[160:163], v[152:155], v[136:139]
ds_read_b64_tr_b16 a[190:191], v223 offset:53248
v_cvt_pk_bf16_f32 v112, v24, v25
v_mfma_f32_16x16x32_bf16 v[44:47], a[164:167], v[156:159], v[44:47]
v_exp_f32 v26, v26
v_mfma_f32_16x16x32_bf16 v[44:47], a[168:171], v[160:163], v[44:47]
buffer_load_dwordx4 v228, s[8:11], s32 offen offset:0  lds
v_mfma_f32_16x16x32_bf16 v[44:47], a[172:175], v[164:167], v[44:47]
v_exp_f32 v27, v27
v_mfma_f32_16x16x32_bf16 v[52:55], a[172:175], v[180:183], v[140:143]
v_cvt_pk_bf16_f32 v113, v26, v27
v_mfma_f32_16x16x32_bf16 v[52:55], a[168:171], v[176:179], v[52:55]
v_exp_f32 v28, v28
v_mfma_f32_16x16x32_bf16 v[52:55], a[164:167], v[172:175], v[52:55]
buffer_load_dwordx4 v229, s[8:11], s32 offen offset:1024  lds
v_mfma_f32_16x16x32_bf16 v[52:55], a[160:163], v[168:171], v[52:55]
v_exp_f32 v29, v29
v_mfma_f32_16x16x32_bf16 v[60:63], a[160:163], v[184:187], v[144:147]
v_cvt_pk_bf16_f32 v114, v28, v29
v_mfma_f32_16x16x32_bf16 v[60:63], a[164:167], v[188:191], v[60:63]
v_exp_f32 v30, v30
v_mfma_f32_16x16x32_bf16 v[60:63], a[168:171], v[192:195], v[60:63]
buffer_load_dwordx4 v230, s[8:11], s32 offen offset:2048  lds
v_mfma_f32_16x16x32_bf16 v[60:63], a[172:175], v[196:199], v[60:63]
v_exp_f32 v31, v31
v_mfma_f32_16x16x32_bf16 v[68:71], a[172:175], v[212:215], v[148:151]
ds_read_b128 a[172:175], v219 offset:4096
v_cvt_pk_bf16_f32 v115, v30, v31
v_mfma_f32_16x16x32_bf16 v[68:71], a[168:171], v[208:211], v[68:71]
v_exp_f32 v32, v32
v_mfma_f32_16x16x32_bf16 v[68:71], a[164:167], v[204:207], v[68:71]
ds_read_b128 a[168:171], v218 offset:4096
ds_read_b128 a[164:167], v217 offset:4096
v_mfma_f32_16x16x32_bf16 v[68:71], a[160:163], v[200:203], v[68:71]
v_exp_f32 v33, v33
v_mfma_f32_16x16x32_bf16 a[64:67], v[88:91], a[228:231], a[64:67]
ds_read_b128 a[160:163], v216 offset:4096
v_cvt_pk_bf16_f32 v116, v32, v33
v_mfma_f32_16x16x32_bf16 a[64:67], v[72:75], a[192:195], a[64:67]
v_exp_f32 v34, v34
v_mfma_f32_16x16x32_bf16 a[68:71], v[76:79], a[192:195], a[68:71]
ds_read_b64_tr_b16 a[192:193], v224 offset:49152
ds_read_b64_tr_b16 a[194:195], v224 offset:53248
v_mfma_f32_16x16x32_bf16 a[68:71], v[92:95], a[228:231], a[68:71]
v_exp_f32 v35, v35
v_mfma_f32_16x16x32_bf16 a[84:87], v[92:95], a[232:235], a[84:87]
v_cvt_pk_bf16_f32 v117, v34, v35
v_mfma_f32_16x16x32_bf16 a[84:87], v[76:79], a[196:199], a[84:87]
v_exp_f32 v36, v36
v_mfma_f32_16x16x32_bf16 a[80:83], v[72:75], a[196:199], a[80:83]
ds_read_b64_tr_b16 a[196:197], v225 offset:49152
ds_read_b64_tr_b16 a[198:199], v225 offset:53248
v_mfma_f32_16x16x32_bf16 a[80:83], v[88:91], a[232:235], a[80:83]
v_exp_f32 v37, v37
v_mfma_f32_16x16x32_bf16 a[96:99], v[88:91], a[236:239], a[96:99]
v_cvt_pk_bf16_f32 v118, v36, v37
v_mfma_f32_16x16x32_bf16 a[96:99], v[72:75], a[200:203], a[96:99]
v_exp_f32 v38, v38
v_mfma_f32_16x16x32_bf16 a[100:103], v[76:79], a[200:203], a[100:103]
ds_read_b64_tr_b16 a[200:201], v226 offset:49152
ds_read_b64_tr_b16 a[202:203], v226 offset:53248
v_mfma_f32_16x16x32_bf16 a[100:103], v[92:95], a[236:239], a[100:103]
v_exp_f32 v39, v39
v_mfma_f32_16x16x32_bf16 a[116:119], v[92:95], a[240:243], a[116:119]
v_cvt_pk_bf16_f32 v119, v38, v39
v_mfma_f32_16x16x32_bf16 a[116:119], v[76:79], a[204:207], a[116:119]
buffer_load_dwordx4 v231, s[8:11], s32 offen offset:3072  lds
v_mfma_f32_16x16x32_bf16 a[112:115], v[72:75], a[204:207], a[112:115]
ds_read_b64_tr_b16 a[204:205], v227 offset:49152
ds_read_b64_tr_b16 a[206:207], v227 offset:53248
v_mfma_f32_16x16x32_bf16 a[112:115], v[88:91], a[240:243], a[112:115]
s_mov_b32 m0, s87
s_lshl2_add_u32 s50, s87, s89
buffer_load_dwordx4 v243, s[56:59], s50 offen  lds
v_smfmac_f32_16x16x64_bf16 a[132:135], a[208:211], v[96:103], v245
s_add_u32 s87, s87, 3456
s_min_u32 s87, s87, 63936
s_waitcnt lgkmcnt(8)
v_mfma_f32_16x16x32_bf16 v[8:11], a[144:147], v[152:155], v[136:139]
v_exp_f32 v40, v40
v_mfma_f32_16x16x32_bf16 v[8:11], a[148:151], v[156:159], v[8:11]
v_exp_f32 v41, v41
v_mfma_f32_16x16x32_bf16 v[8:11], a[152:155], v[160:163], v[8:11]
v_cvt_pk_bf16_f32 v72, v40, v41
v_mfma_f32_16x16x32_bf16 v[8:11], a[156:159], v[164:167], v[8:11]
v_exp_f32 v42, v42
v_mfma_f32_16x16x32_bf16 v[16:19], a[156:159], v[180:183], v[140:143]
s_add_u32 s39, s39, 16384
v_mfma_f32_16x16x32_bf16 v[16:19], a[152:155], v[176:179], v[16:19]
v_exp_f32 v43, v43
v_mfma_f32_16x16x32_bf16 v[16:19], a[148:151], v[172:175], v[16:19]
v_cvt_pk_bf16_f32 v73, v42, v43
v_mfma_f32_16x16x32_bf16 v[16:19], a[144:147], v[168:171], v[16:19]
v_exp_f32 v44, v44
v_mfma_f32_16x16x32_bf16 v[24:27], a[144:147], v[184:187], v[144:147]
v_mfma_f32_16x16x32_bf16 v[24:27], a[148:151], v[188:191], v[24:27]
v_exp_f32 v45, v45
v_mfma_f32_16x16x32_bf16 v[24:27], a[152:155], v[192:195], v[24:27]
s_add_u32 m0, s30, 131072
v_cvt_pk_bf16_f32 v74, v44, v45
v_mfma_f32_16x16x32_bf16 v[24:27], a[156:159], v[196:199], v[24:27]
v_exp_f32 v46, v46
v_mfma_f32_16x16x32_bf16 v[32:35], a[156:159], v[212:215], v[148:151]
ds_read_b128 a[156:159], v219 offset:8192
v_mfma_f32_16x16x32_bf16 v[32:35], a[152:155], v[208:211], v[32:35]
v_exp_f32 v47, v47
v_mfma_f32_16x16x32_bf16 v[32:35], a[148:151], v[204:207], v[32:35]
ds_read_b128 a[152:155], v218 offset:8192
v_cvt_pk_bf16_f32 v75, v46, v47
v_mfma_f32_16x16x32_bf16 v[32:35], a[144:147], v[200:203], v[32:35]
v_exp_f32 v48, v48
v_mfma_f32_16x16x32_bf16 a[8:11], v[112:115], a[176:179], a[8:11]
ds_read_b128 a[148:151], v217 offset:8192
ds_read_b128 a[144:147], v216 offset:8192
v_mfma_f32_16x16x32_bf16 a[8:11], v[96:99], a[212:215], a[8:11]
v_exp_f32 v49, v49
v_mfma_f32_16x16x32_bf16 a[12:15], v[100:103], a[212:215], a[12:15]
ds_read_b64_tr_b16 a[212:213], v220 offset:57344
v_cvt_pk_bf16_f32 v76, v48, v49
v_mfma_f32_16x16x32_bf16 a[12:15], v[116:119], a[176:179], a[12:15]
v_exp_f32 v50, v50
v_mfma_f32_16x16x32_bf16 a[28:31], v[116:119], a[180:183], a[28:31]
ds_read_b64_tr_b16 a[214:215], v220 offset:61440
v_mfma_f32_16x16x32_bf16 a[28:31], v[100:103], a[216:219], a[28:31]
v_exp_f32 v51, v51
v_mfma_f32_16x16x32_bf16 a[24:27], v[96:99], a[216:219], a[24:27]
ds_read_b64_tr_b16 a[216:217], v221 offset:57344
v_cvt_pk_bf16_f32 v77, v50, v51
v_mfma_f32_16x16x32_bf16 a[24:27], v[112:115], a[180:183], a[24:27]
v_exp_f32 v52, v52
v_mfma_f32_16x16x32_bf16 a[40:43], v[112:115], a[184:187], a[40:43]
ds_read_b64_tr_b16 a[218:219], v221 offset:61440
v_mfma_f32_16x16x32_bf16 a[40:43], v[96:99], a[220:223], a[40:43]
v_exp_f32 v53, v53
v_mfma_f32_16x16x32_bf16 a[44:47], v[100:103], a[220:223], a[44:47]
ds_read_b64_tr_b16 a[220:221], v222 offset:57344
v_cvt_pk_bf16_f32 v78, v52, v53
v_mfma_f32_16x16x32_bf16 a[44:47], v[116:119], a[184:187], a[44:47]
v_exp_f32 v54, v54
v_mfma_f32_16x16x32_bf16 a[60:63], v[116:119], a[188:191], a[60:63]
ds_read_b64_tr_b16 a[222:223], v222 offset:61440
v_mfma_f32_16x16x32_bf16 a[60:63], v[100:103], a[224:227], a[60:63]
v_exp_f32 v55, v55
v_mfma_f32_16x16x32_bf16 a[56:59], v[96:99], a[224:227], a[56:59]
ds_read_b64_tr_b16 a[224:225], v223 offset:57344
v_cvt_pk_bf16_f32 v79, v54, v55
v_mfma_f32_16x16x32_bf16 a[56:59], v[112:115], a[188:191], a[56:59]
v_exp_f32 v56, v56
v_smfmac_f32_16x16x64_bf16 a[128:131], a[208:211], v[104:111], v245
v_exp_f32 v57, v57
v_mfma_f32_16x16x32_bf16 v[12:15], a[160:163], v[152:155], v[136:139]
ds_read_b64_tr_b16 a[226:227], v223 offset:61440
v_cvt_pk_bf16_f32 v80, v56, v57
v_mfma_f32_16x16x32_bf16 v[12:15], a[164:167], v[156:159], v[12:15]
v_exp_f32 v58, v58
v_mfma_f32_16x16x32_bf16 v[12:15], a[168:171], v[160:163], v[12:15]
buffer_load_dwordx4 v232, s[12:15], s39 offen offset:0  lds
v_mfma_f32_16x16x32_bf16 v[12:15], a[172:175], v[164:167], v[12:15]
v_exp_f32 v59, v59
v_mfma_f32_16x16x32_bf16 v[20:23], a[172:175], v[180:183], v[140:143]
v_cvt_pk_bf16_f32 v81, v58, v59
v_mfma_f32_16x16x32_bf16 v[20:23], a[168:171], v[176:179], v[20:23]
v_exp_f32 v60, v60
v_mfma_f32_16x16x32_bf16 v[20:23], a[164:167], v[172:175], v[20:23]
buffer_load_dwordx4 v233, s[12:15], s39 offen offset:1024  lds
v_mfma_f32_16x16x32_bf16 v[20:23], a[160:163], v[168:171], v[20:23]
v_exp_f32 v61, v61
v_mfma_f32_16x16x32_bf16 v[28:31], a[160:163], v[184:187], v[144:147]
v_cvt_pk_bf16_f32 v82, v60, v61
v_mfma_f32_16x16x32_bf16 v[28:31], a[164:167], v[188:191], v[28:31]
v_exp_f32 v62, v62
v_mfma_f32_16x16x32_bf16 v[28:31], a[168:171], v[192:195], v[28:31]
buffer_load_dwordx4 v232, s[12:15], s39 offen offset:2048  lds
v_mfma_f32_16x16x32_bf16 v[28:31], a[172:175], v[196:199], v[28:31]
v_exp_f32 v63, v63
v_mfma_f32_16x16x32_bf16 v[36:39], a[172:175], v[212:215], v[148:151]
ds_read_b128 a[172:175], v219 offset:12288
v_cvt_pk_bf16_f32 v83, v62, v63
v_mfma_f32_16x16x32_bf16 v[36:39], a[168:171], v[208:211], v[36:39]
v_exp_f32 v64, v64
v_mfma_f32_16x16x32_bf16 v[36:39], a[164:167], v[204:207], v[36:39]
ds_read_b128 a[168:171], v218 offset:12288
ds_read_b128 a[164:167], v217 offset:12288
v_mfma_f32_16x16x32_bf16 v[36:39], a[160:163], v[200:203], v[36:39]
v_exp_f32 v65, v65
s_waitcnt lgkmcnt(8)
v_mfma_f32_16x16x32_bf16 a[72:75], v[112:115], a[192:195], a[72:75]
ds_read_b128 a[160:163], v216 offset:12288
v_cvt_pk_bf16_f32 v84, v64, v65
v_mfma_f32_16x16x32_bf16 a[72:75], v[96:99], a[228:231], a[72:75]
v_exp_f32 v66, v66
v_mfma_f32_16x16x32_bf16 a[76:79], v[100:103], a[228:231], a[76:79]
ds_read_b64_tr_b16 a[228:229], v224 offset:57344
ds_read_b64_tr_b16 a[230:231], v224 offset:61440
v_mfma_f32_16x16x32_bf16 a[76:79], v[116:119], a[192:195], a[76:79]
v_exp_f32 v67, v67
v_mfma_f32_16x16x32_bf16 a[92:95], v[116:119], a[196:199], a[92:95]
v_cvt_pk_bf16_f32 v85, v66, v67
v_mfma_f32_16x16x32_bf16 a[92:95], v[100:103], a[232:235], a[92:95]
v_exp_f32 v68, v68
v_mfma_f32_16x16x32_bf16 a[88:91], v[96:99], a[232:235], a[88:91]
ds_read_b64_tr_b16 a[232:233], v225 offset:57344
ds_read_b64_tr_b16 a[234:235], v225 offset:61440
v_mfma_f32_16x16x32_bf16 a[88:91], v[112:115], a[196:199], a[88:91]
v_exp_f32 v69, v69
v_mfma_f32_16x16x32_bf16 a[104:107], v[112:115], a[200:203], a[104:107]
v_cvt_pk_bf16_f32 v86, v68, v69
v_mfma_f32_16x16x32_bf16 a[104:107], v[96:99], a[236:239], a[104:107]
v_exp_f32 v70, v70
v_mfma_f32_16x16x32_bf16 a[108:111], v[100:103], a[236:239], a[108:111]
ds_read_b64_tr_b16 a[236:237], v226 offset:57344
ds_read_b64_tr_b16 a[238:239], v226 offset:61440
v_mfma_f32_16x16x32_bf16 a[108:111], v[116:119], a[200:203], a[108:111]
v_exp_f32 v71, v71
v_mfma_f32_16x16x32_bf16 a[124:127], v[116:119], a[204:207], a[124:127]
v_cvt_pk_bf16_f32 v87, v70, v71
v_mfma_f32_16x16x32_bf16 a[124:127], v[100:103], a[240:243], a[124:127]
buffer_load_dwordx4 v233, s[12:15], s39 offen offset:3072  lds
v_mfma_f32_16x16x32_bf16 a[120:123], v[96:99], a[240:243], a[120:123]
ds_read_b64_tr_b16 a[240:241], v227 offset:57344
ds_read_b64_tr_b16 a[242:243], v227 offset:61440
v_mfma_f32_16x16x32_bf16 a[120:123], v[112:115], a[204:207], a[120:123]
buffer_load_dword v242, v241, s[20:23], s46 offen sc1
v_smfmac_f32_16x16x64_bf16 a[132:135], a[208:211], v[112:119], v245
v_add_u32 v241, 1024, v241
v_and_b32 v241, 0x3fff, v241
s_sub_u32 s33, s33, 1
s_cmp_lg_u32 s33, 0
s_cbranch_scc1 K_LOOP
K_LAST:
v_mfma_f32_16x16x32_bf16 v[40:43], a[144:147], v[152:155], v[136:139]
v_and_b32 v122, 7, v1
v_exp_f32 v8, v8
v_mfma_f32_16x16x32_bf16 v[40:43], a[148:151], v[156:159], v[40:43]
v_lshlrev_b32 v122, 3, v122
v_exp_f32 v9, v9
v_mfma_f32_16x16x32_bf16 v[40:43], a[152:155], v[160:163], v[40:43]
v_cvt_pk_bf16_f32 v88, v8, v9
v_mfma_f32_16x16x32_bf16 v[40:43], a[156:159], v[164:167], v[40:43]
v_exp_f32 v10, v10
v_mfma_f32_16x16x32_bf16 v[48:51], a[156:159], v[180:183], v[140:143]
v_mfma_f32_16x16x32_bf16 v[48:51], a[152:155], v[176:179], v[48:51]
v_exp_f32 v11, v11
v_mfma_f32_16x16x32_bf16 v[48:51], a[148:151], v[172:175], v[48:51]
v_cvt_pk_bf16_f32 v89, v10, v11
v_mfma_f32_16x16x32_bf16 v[48:51], a[144:147], v[168:171], v[48:51]
v_exp_f32 v12, v12
v_mfma_f32_16x16x32_bf16 v[56:59], a[144:147], v[184:187], v[144:147]
v_mfma_f32_16x16x32_bf16 v[56:59], a[148:151], v[188:191], v[56:59]
v_exp_f32 v13, v13
v_mfma_f32_16x16x32_bf16 v[56:59], a[152:155], v[192:195], v[56:59]
v_cvt_pk_bf16_f32 v90, v12, v13
v_mfma_f32_16x16x32_bf16 v[56:59], a[156:159], v[196:199], v[56:59]
v_exp_f32 v14, v14
v_mfma_f32_16x16x32_bf16 v[64:67], a[156:159], v[212:215], v[148:151]
s_waitcnt vmcnt(10) lgkmcnt(0)
s_barrier
v_mfma_f32_16x16x32_bf16 v[64:67], a[152:155], v[208:211], v[64:67]
v_exp_f32 v15, v15
v_mfma_f32_16x16x32_bf16 v[64:67], a[148:151], v[204:207], v[64:67]
ds_read_b128 a[156:159], v219 offset:16384
v_cvt_pk_bf16_f32 v91, v14, v15
STUB_11:
s_cbranch_execz HOP_RET1
v_mfma_f32_16x16x32_bf16 v[64:67], a[144:147], v[200:203], v[64:67]
v_exp_f32 v16, v16
v_mfma_f32_16x16x32_bf16 a[0:3], v[72:75], a[212:215], a[0:3]
ds_read_b128 a[152:155], v218 offset:16384
ds_read_b128 a[148:151], v217 offset:16384
v_mfma_f32_16x16x32_bf16 a[0:3], v[104:107], a[176:179], a[0:3]
v_exp_f32 v17, v17
v_mfma_f32_16x16x32_bf16 a[4:7], v[108:111], a[176:179], a[4:7]
ds_read_b128 a[144:147], v216 offset:16384
v_cvt_pk_bf16_f32 v92, v16, v17
v_mfma_f32_16x16x32_bf16 a[4:7], v[76:79], a[212:215], a[4:7]
v_exp_f32 v18, v18
v_mfma_f32_16x16x32_bf16 a[20:23], v[76:79], a[216:219], a[20:23]
ds_read_b64_tr_b16 a[176:177], v220 offset:0
ds_read_b64_tr_b16 a[178:179], v220 offset:4096
v_mfma_f32_16x16x32_bf16 a[20:23], v[108:111], a[180:183], a[20:23]
v_exp_f32 v19, v19
v_mfma_f32_16x16x32_bf16 a[16:19], v[104:107], a[180:183], a[16:19]
ds_read_b64_tr_b16 a[180:181], v221 offset:0
v_cvt_pk_bf16_f32 v93, v18, v19
v_mfma_f32_16x16x32_bf16 a[16:19], v[72:75], a[216:219], a[16:19]
v_exp_f32 v20, v20
v_mfma_f32_16x16x32_bf16 a[32:35], v[72:75], a[220:223], a[32:35]
ds_read_b64_tr_b16 a[182:183], v221 offset:4096
v_mfma_f32_16x16x32_bf16 a[32:35], v[104:107], a[184:187], a[32:35]
v_exp_f32 v21, v21
v_mfma_f32_16x16x32_bf16 a[36:39], v[108:111], a[184:187], a[36:39]
ds_read_b64_tr_b16 a[184:185], v222 offset:0
v_cvt_pk_bf16_f32 v94, v20, v21
v_mfma_f32_16x16x32_bf16 a[36:39], v[76:79], a[220:223], a[36:39]
v_exp_f32 v22, v22
v_mfma_f32_16x16x32_bf16 a[52:55], v[76:79], a[224:227], a[52:55]
ds_read_b64_tr_b16 a[186:187], v222 offset:4096
v_mfma_f32_16x16x32_bf16 a[52:55], v[108:111], a[188:191], a[52:55]
v_exp_f32 v23, v23
v_mfma_f32_16x16x32_bf16 a[48:51], v[104:107], a[188:191], a[48:51]
ds_read_b64_tr_b16 a[188:189], v223 offset:0
v_cvt_pk_bf16_f32 v95, v22, v23
v_mfma_f32_16x16x32_bf16 a[48:51], v[72:75], a[224:227], a[48:51]
v_exp_f32 v24, v24
v_smfmac_f32_16x16x64_bf16 a[128:131], a[208:211], v[72:79], v245
v_exp_f32 v25, v25
v_mfma_f32_16x16x32_bf16 v[44:47], a[160:163], v[152:155], v[136:139]
ds_read_b64_tr_b16 a[190:191], v223 offset:4096
v_cvt_pk_bf16_f32 v96, v24, v25
v_mfma_f32_16x16x32_bf16 v[44:47], a[164:167], v[156:159], v[44:47]
v_exp_f32 v26, v26
v_mfma_f32_16x16x32_bf16 v[44:47], a[168:171], v[160:163], v[44:47]
s_add_u32 m0, s88, 62208
s_lshl2_add_u32 s50, m0, s89
buffer_load_dwordx4 v243, s[56:59], s50 offen  lds
v_mfma_f32_16x16x32_bf16 v[44:47], a[172:175], v[164:167], v[44:47]
v_exp_f32 v27, v27
v_mfma_f32_16x16x32_bf16 v[52:55], a[172:175], v[180:183], v[140:143]
v_cvt_pk_bf16_f32 v97, v26, v27
v_mfma_f32_16x16x32_bf16 v[52:55], a[168:171], v[176:179], v[52:55]
v_exp_f32 v28, v28
v_mfma_f32_16x16x32_bf16 v[52:55], a[164:167], v[172:175], v[52:55]
s_add_u32 m0, s88, 65664
s_lshl2_add_u32 s50, m0, s89
buffer_load_dwordx4 v243, s[56:59], s50 offen  lds
v_mfma_f32_16x16x32_bf16 v[52:55], a[160:163], v[168:171], v[52:55]
v_exp_f32 v29, v29
v_mfma_f32_16x16x32_bf16 v[60:63], a[160:163], v[184:187], v[144:147]
v_cvt_pk_bf16_f32 v98, v28, v29
v_mfma_f32_16x16x32_bf16 v[60:63], a[164:167], v[188:191], v[60:63]
v_exp_f32 v30, v30
v_mfma_f32_16x16x32_bf16 v[60:63], a[168:171], v[192:195], v[60:63]
s_mov_b32 s93, 0x242800
buffer_load_dwordx2 v[120:121], v122, s[20:23], s93 offen sc0 sc1
v_mfma_f32_16x16x32_bf16 v[60:63], a[172:175], v[196:199], v[60:63]
v_and_b32 v246, 15, v1
v_exp_f32 v31, v31
v_mfma_f32_16x16x32_bf16 v[68:71], a[172:175], v[212:215], v[148:151]
ds_read_b128 a[172:175], v219 offset:20480
v_cvt_pk_bf16_f32 v99, v30, v31
v_lshrrev_b32 v247, 3, v246
v_mfma_f32_16x16x32_bf16 v[68:71], a[168:171], v[208:211], v[68:71]
v_and_b32 v246, 7, v246
v_exp_f32 v32, v32
v_mfma_f32_16x16x32_bf16 v[68:71], a[164:167], v[204:207], v[68:71]
ds_read_b128 a[168:171], v218 offset:20480
ds_read_b128 a[164:167], v217 offset:20480
v_lshlrev_b32 v246, 6, v246
v_mfma_f32_16x16x32_bf16 v[68:71], a[160:163], v[200:203], v[68:71]
v_lshl_add_u32 v246, v247, 13, v246
v_exp_f32 v33, v33
v_mfma_f32_16x16x32_bf16 a[64:67], v[72:75], a[228:231], a[64:67]
ds_read_b128 a[160:163], v216 offset:20480
v_cvt_pk_bf16_f32 v100, v32, v33
v_mfma_f32_16x16x32_bf16 a[64:67], v[104:107], a[192:195], a[64:67]
v_exp_f32 v34, v34
v_mfma_f32_16x16x32_bf16 a[68:71], v[108:111], a[192:195], a[68:71]
ds_read_b64_tr_b16 a[192:193], v224 offset:0
ds_read_b64_tr_b16 a[194:195], v224 offset:4096
v_mfma_f32_16x16x32_bf16 a[68:71], v[76:79], a[228:231], a[68:71]
v_exp_f32 v35, v35
v_mfma_f32_16x16x32_bf16 a[84:87], v[76:79], a[232:235], a[84:87]
s_lshl_b32 s28, s36, 9
s_add_u32 s28, s28, 0x248000
v_cvt_pk_bf16_f32 v101, v34, v35
v_mfma_f32_16x16x32_bf16 a[84:87], v[108:111], a[196:199], a[84:87]
v_exp_f32 v36, v36
v_mfma_f32_16x16x32_bf16 a[80:83], v[104:107], a[196:199], a[80:83]
ds_read_b64_tr_b16 a[196:197], v225 offset:0
ds_read_b64_tr_b16 a[198:199], v225 offset:4096
v_mfma_f32_16x16x32_bf16 a[80:83], v[72:75], a[232:235], a[80:83]
v_exp_f32 v37, v37
v_mfma_f32_16x16x32_bf16 a[96:99], v[72:75], a[236:239], a[96:99]
buffer_load_dword v242, v246, s[20:23], s28 offen sc1
v_cvt_pk_bf16_f32 v102, v36, v37
v_mfma_f32_16x16x32_bf16 a[96:99], v[104:107], a[200:203], a[96:99]
v_bfe_u32 v246, v1, 2, 2
v_exp_f32 v38, v38
v_mfma_f32_16x16x32_bf16 a[100:103], v[108:111], a[200:203], a[100:103]
ds_read_b64_tr_b16 a[200:201], v226 offset:0
ds_read_b64_tr_b16 a[202:203], v226 offset:4096
v_lshl_add_u32 v246, v4, 2, v246
v_mfma_f32_16x16x32_bf16 a[100:103], v[76:79], a[236:239], a[100:103]
v_mul_u32_u24 v246, 288, v246
v_exp_f32 v39, v39
v_mfma_f32_16x16x32_bf16 a[116:119], v[76:79], a[240:243], a[116:119]
v_cvt_pk_bf16_f32 v103, v38, v39
v_and_b32 v247, 3, v1
v_lshl_add_u32 v236, v247, 3, v246
v_mfma_f32_16x16x32_bf16 a[116:119], v[108:111], a[204:207], a[116:119]
s_add_u32 m0, s88, 69120
s_lshl2_add_u32 s50, m0, s89
buffer_load_dwordx4 v243, s[56:59], s50 offen  lds
v_mfma_f32_16x16x32_bf16 a[112:115], v[104:107], a[204:207], a[112:115]
ds_read_b64_tr_b16 a[204:205], v227 offset:0
ds_read_b64_tr_b16 a[206:207], v227 offset:4096
v_add_u32 v236, 256, v236
v_mfma_f32_16x16x32_bf16 a[112:115], v[72:75], a[240:243], a[112:115]
v_lshl_add_u32 v246, v247, 4, v246
v_smfmac_f32_16x16x64_bf16 a[132:135], a[208:211], v[80:87], v245
s_lshr_b32 s28, s35, 4
s_lshl_b32 s28, s28, 6
s_waitcnt lgkmcnt(8)
v_mfma_f32_16x16x32_bf16 v[8:11], a[144:147], v[152:155], v[136:139]
v_add_u32 v234, s28, v246
v_exp_f32 v40, v40
v_mfma_f32_16x16x32_bf16 v[8:11], a[148:151], v[156:159], v[8:11]
s_xor_b32 s28, s28, 64
v_exp_f32 v41, v41
v_mfma_f32_16x16x32_bf16 v[8:11], a[152:155], v[160:163], v[8:11]
v_cvt_pk_bf16_f32 v104, v40, v41
v_add_u32 v235, s28, v246
v_mfma_f32_16x16x32_bf16 v[8:11], a[156:159], v[164:167], v[8:11]
v_exp_f32 v42, v42
v_mfma_f32_16x16x32_bf16 v[16:19], a[156:159], v[180:183], v[140:143]
s_add_u32 s39, s39, 16384
s_add_u32 s28, s35, 0
s_and_b32 s28, s28, 3
v_mfma_f32_16x16x32_bf16 v[16:19], a[152:155], v[176:179], v[16:19]
s_mul_i32 s28, s28, 36864
v_exp_f32 v43, v43
v_mfma_f32_16x16x32_bf16 v[16:19], a[148:151], v[172:175], v[16:19]
v_cvt_pk_bf16_f32 v105, v42, v43
v_add_u32 v237, s28, v234
v_add_u32 v238, s28, v235
v_mfma_f32_16x16x32_bf16 v[16:19], a[144:147], v[168:171], v[16:19]
v_add_u32 v239, s28, v236
v_exp_f32 v44, v44
v_mfma_f32_16x16x32_bf16 v[24:27], a[144:147], v[184:187], v[144:147]
v_mov_b32 v254, 0x7ffffff0
v_mfma_f32_16x16x32_bf16 v[24:27], a[148:151], v[188:191], v[24:27]
s_lshl2_add_u32 s92, s36, s37
v_exp_f32 v45, v45
v_mfma_f32_16x16x32_bf16 v[24:27], a[152:155], v[192:195], v[24:27]
s_add_u32 m0, s30, 147456
s_bfe_u32 s93, s35, 0x20002
v_cvt_pk_bf16_f32 v106, v44, v45
v_mfma_f32_16x16x32_bf16 v[24:27], a[156:159], v[196:199], v[24:27]
s_lshl2_add_u32 s92, s92, s93
v_exp_f32 v46, v46
v_mfma_f32_16x16x32_bf16 v[32:35], a[156:159], v[212:215], v[148:151]
ds_read_b128 a[156:159], v219 offset:24576
s_lshl_b32 s93, s92, 4
v_mfma_f32_16x16x32_bf16 v[32:35], a[152:155], v[208:211], v[32:35]
v_add_u32 v132, s93, v3
v_exp_f32 v47, v47
v_mfma_f32_16x16x32_bf16 v[32:35], a[148:151], v[204:207], v[32:35]
ds_read_b128 a[152:155], v218 offset:24576
v_cvt_pk_bf16_f32 v107, v46, v47
v_writelane_b32 v254, 0, 0
v_mfma_f32_16x16x32_bf16 v[32:35], a[144:147], v[200:203], v[32:35]
s_and_b32 s93, s35, 3
v_exp_f32 v48, v48
v_mfma_f32_16x16x32_bf16 a[8:11], v[96:99], a[176:179], a[8:11]
ds_read_b128 a[148:151], v217 offset:24576
ds_read_b128 a[144:147], v216 offset:24576
s_mul_i32 s93, s93, 144
v_mfma_f32_16x16x32_bf16 a[8:11], v[80:83], a[212:215], a[8:11]
v_lshlrev_b32 v251, 2, v4
v_exp_f32 v49, v49
v_mfma_f32_16x16x32_bf16 a[12:15], v[84:87], a[212:215], a[12:15]
ds_read_b64_tr_b16 a[212:213], v220 offset:8192
v_cvt_pk_bf16_f32 v108, v48, v49
v_add_u32 v251, s93, v251
v_mfma_f32_16x16x32_bf16 a[12:15], v[100:103], a[176:179], a[12:15]
v_add_u32 v251, 128, v251
v_exp_f32 v50, v50
v_mfma_f32_16x16x32_bf16 a[28:31], v[100:103], a[180:183], a[28:31]
ds_read_b64_tr_b16 a[214:215], v220 offset:12288
v_lshlrev_b32 v250, 3, v4
v_mfma_f32_16x16x32_bf16 a[28:31], v[84:87], a[216:219], a[28:31]
s_lshr_b32 s90, s35, 4
v_exp_f32 v51, v51
v_mfma_f32_16x16x32_bf16 a[24:27], v[80:83], a[216:219], a[24:27]
ds_read_b64_tr_b16 a[216:217], v221 offset:8192
s_lshl_b32 s90, s90, 5
v_cvt_pk_bf16_f32 v109, v50, v51
v_mfma_f32_16x16x32_bf16 a[24:27], v[96:99], a[180:183], a[24:27]
s_add_u32 s93, s93, s90
v_exp_f32 v52, v52
v_mfma_f32_16x16x32_bf16 a[40:43], v[96:99], a[184:187], a[40:43]
ds_read_b64_tr_b16 a[218:219], v221 offset:12288
v_add_u32 v250, s93, v250
v_lshlrev_b32 v250, 1, v250
v_mfma_f32_16x16x32_bf16 a[40:43], v[80:83], a[220:223], a[40:43]
v_lshlrev_b32 v251, 1, v251
v_exp_f32 v53, v53
v_mfma_f32_16x16x32_bf16 a[44:47], v[84:87], a[220:223], a[44:47]
ds_read_b64_tr_b16 a[220:221], v222 offset:8192
v_cvt_pk_bf16_f32 v110, v52, v53
v_mul_u32_u24 v133, 0x480, v132
v_mfma_f32_16x16x32_bf16 a[44:47], v[100:103], a[184:187], a[44:47]
v_add_u32 v248, v133, v250
v_exp_f32 v54, v54
v_mfma_f32_16x16x32_bf16 a[60:63], v[100:103], a[188:191], a[60:63]
ds_read_b64_tr_b16 a[222:223], v222 offset:12288
v_add_u32 v249, v133, v251
v_mov_b32 v135, 0x7fffbff0
v_mfma_f32_16x16x32_bf16 a[60:63], v[84:87], a[224:227], a[60:63]
v_exp_f32 v55, v55
v_mfma_f32_16x16x32_bf16 a[56:59], v[80:83], a[224:227], a[56:59]
ds_read_b64_tr_b16 a[224:225], v223 offset:8192
v_cvt_pk_bf16_f32 v111, v54, v55
v_mfma_f32_16x16x32_bf16 a[56:59], v[96:99], a[188:191], a[56:59]
v_exp_f32 v56, v56
v_smfmac_f32_16x16x64_bf16 a[128:131], a[208:211], v[88:95], v245
v_exp_f32 v57, v57
v_mfma_f32_16x16x32_bf16 v[12:15], a[160:163], v[152:155], v[136:139]
ds_read_b64_tr_b16 a[226:227], v223 offset:12288
v_cvt_pk_bf16_f32 v112, v56, v57
v_mfma_f32_16x16x32_bf16 v[12:15], a[164:167], v[156:159], v[12:15]
v_exp_f32 v58, v58
v_mfma_f32_16x16x32_bf16 v[12:15], a[168:171], v[160:163], v[12:15]
buffer_load_dwordx4 v232, s[12:15], s39 offen offset:0  lds
v_mfma_f32_16x16x32_bf16 v[12:15], a[172:175], v[164:167], v[12:15]
v_exp_f32 v59, v59
v_mfma_f32_16x16x32_bf16 v[20:23], a[172:175], v[180:183], v[140:143]
v_cvt_pk_bf16_f32 v113, v58, v59
v_mfma_f32_16x16x32_bf16 v[20:23], a[168:171], v[176:179], v[20:23]
v_exp_f32 v60, v60
v_mfma_f32_16x16x32_bf16 v[20:23], a[164:167], v[172:175], v[20:23]
buffer_load_dwordx4 v233, s[12:15], s39 offen offset:1024  lds
v_mfma_f32_16x16x32_bf16 v[20:23], a[160:163], v[168:171], v[20:23]
v_exp_f32 v61, v61
v_mfma_f32_16x16x32_bf16 v[28:31], a[160:163], v[184:187], v[144:147]
buffer_load_dwordx4 a[244:247], v248, s[52:55], 0 offen offset:0
v_cvt_pk_bf16_f32 v114, v60, v61
v_mfma_f32_16x16x32_bf16 v[28:31], a[164:167], v[188:191], v[28:31]
v_exp_f32 v62, v62
v_mfma_f32_16x16x32_bf16 v[28:31], a[168:171], v[192:195], v[28:31]
buffer_load_dwordx4 v232, s[12:15], s39 offen offset:2048  lds
v_mfma_f32_16x16x32_bf16 v[28:31], a[172:175], v[196:199], v[28:31]
v_exp_f32 v63, v63
v_mfma_f32_16x16x32_bf16 v[36:39], a[172:175], v[212:215], v[148:151]
ds_read_b128 a[172:175], v219 offset:28672
v_cvt_pk_bf16_f32 v115, v62, v63
v_mfma_f32_16x16x32_bf16 v[36:39], a[168:171], v[208:211], v[36:39]
v_exp_f32 v64, v64
v_mfma_f32_16x16x32_bf16 v[36:39], a[164:167], v[204:207], v[36:39]
ds_read_b128 a[168:171], v218 offset:28672
ds_read_b128 a[164:167], v217 offset:28672
v_mfma_f32_16x16x32_bf16 v[36:39], a[160:163], v[200:203], v[36:39]
v_exp_f32 v65, v65
s_waitcnt lgkmcnt(8)
v_mfma_f32_16x16x32_bf16 a[72:75], v[96:99], a[192:195], a[72:75]
ds_read_b128 a[160:163], v216 offset:28672
v_cvt_pk_bf16_f32 v116, v64, v65
v_mfma_f32_16x16x32_bf16 a[72:75], v[80:83], a[228:231], a[72:75]
v_exp_f32 v66, v66
v_mfma_f32_16x16x32_bf16 a[76:79], v[84:87], a[228:231], a[76:79]
ds_read_b64_tr_b16 a[228:229], v224 offset:8192
ds_read_b64_tr_b16 a[230:231], v224 offset:12288
v_mfma_f32_16x16x32_bf16 a[76:79], v[100:103], a[192:195], a[76:79]
v_exp_f32 v67, v67
v_mfma_f32_16x16x32_bf16 a[92:95], v[100:103], a[196:199], a[92:95]
buffer_load_dwordx4 a[248:251], v248, s[52:55], 0 offen offset:128
v_cvt_pk_bf16_f32 v117, v66, v67
v_mfma_f32_16x16x32_bf16 a[92:95], v[84:87], a[232:235], a[92:95]
v_exp_f32 v68, v68
v_mfma_f32_16x16x32_bf16 a[88:91], v[80:83], a[232:235], a[88:91]
ds_read_b64_tr_b16 a[232:233], v225 offset:8192
ds_read_b64_tr_b16 a[234:235], v225 offset:12288
v_mfma_f32_16x16x32_bf16 a[88:91], v[96:99], a[196:199], a[88:91]
v_exp_f32 v69, v69
v_mfma_f32_16x16x32_bf16 a[104:107], v[96:99], a[200:203], a[104:107]
v_cvt_pk_bf16_f32 v118, v68, v69
v_mfma_f32_16x16x32_bf16 a[104:107], v[80:83], a[236:239], a[104:107]
v_exp_f32 v70, v70
v_mfma_f32_16x16x32_bf16 a[108:111], v[84:87], a[236:239], a[108:111]
ds_read_b64_tr_b16 a[236:237], v226 offset:8192
ds_read_b64_tr_b16 a[238:239], v226 offset:12288
v_mfma_f32_16x16x32_bf16 a[108:111], v[100:103], a[200:203], a[108:111]
v_exp_f32 v71, v71
v_mfma_f32_16x16x32_bf16 a[124:127], v[100:103], a[204:207], a[124:127]
v_cvt_pk_bf16_f32 v119, v70, v71
v_mfma_f32_16x16x32_bf16 a[124:127], v[84:87], a[240:243], a[124:127]
buffer_load_dwordx4 v233, s[12:15], s39 offen offset:3072  lds
v_mfma_f32_16x16x32_bf16 a[120:123], v[80:83], a[240:243], a[120:123]
ds_read_b64_tr_b16 a[240:241], v227 offset:8192
ds_read_b64_tr_b16 a[242:243], v227 offset:12288
v_mfma_f32_16x16x32_bf16 a[120:123], v[96:99], a[204:207], a[120:123]
s_add_u32 m0, s88, 72576
s_lshl2_add_u32 s50, m0, s89
buffer_load_dwordx4 v243, s[56:59], s50 offen  lds
v_smfmac_f32_16x16x64_bf16 a[132:135], a[208:211], v[96:103], v245
s_add_u32 m0, s88, 76032
s_lshl2_add_u32 s50, m0, s89
buffer_load_dwordx4 v243, s[56:59], s50 offen  lds
v_mfma_f32_16x16x32_bf16 v[40:43], a[144:147], v[152:155], v[136:139]
v_exp_f32 v8, v8
v_mfma_f32_16x16x32_bf16 v[40:43], a[148:151], v[156:159], v[40:43]
v_exp_f32 v9, v9
v_mfma_f32_16x16x32_bf16 v[40:43], a[152:155], v[160:163], v[40:43]
v_cvt_pk_bf16_f32 v72, v8, v9
v_mfma_f32_16x16x32_bf16 v[40:43], a[156:159], v[164:167], v[40:43]
v_exp_f32 v10, v10
v_mfma_f32_16x16x32_bf16 v[48:51], a[156:159], v[180:183], v[140:143]
v_mfma_f32_16x16x32_bf16 v[48:51], a[152:155], v[176:179], v[48:51]
v_exp_f32 v11, v11
v_mfma_f32_16x16x32_bf16 v[48:51], a[148:151], v[172:175], v[48:51]
v_cvt_pk_bf16_f32 v73, v10, v11
v_mfma_f32_16x16x32_bf16 v[48:51], a[144:147], v[168:171], v[48:51]
v_exp_f32 v12, v12
v_mfma_f32_16x16x32_bf16 v[56:59], a[144:147], v[184:187], v[144:147]
v_mfma_f32_16x16x32_bf16 v[56:59], a[148:151], v[188:191], v[56:59]
v_exp_f32 v13, v13
v_mfma_f32_16x16x32_bf16 v[56:59], a[152:155], v[192:195], v[56:59]
v_cvt_pk_bf16_f32 v74, v12, v13
v_mfma_f32_16x16x32_bf16 v[56:59], a[156:159], v[196:199], v[56:59]
v_exp_f32 v14, v14
v_mfma_f32_16x16x32_bf16 v[64:67], a[156:159], v[212:215], v[148:151]
s_waitcnt vmcnt(13) lgkmcnt(0)
s_barrier
v_mfma_f32_16x16x32_bf16 v[64:67], a[152:155], v[208:211], v[64:67]
v_exp_f32 v15, v15
v_mfma_f32_16x16x32_bf16 v[64:67], a[148:151], v[204:207], v[64:67]
ds_read_b128 a[156:159], v219 offset:49152
v_cvt_pk_bf16_f32 v75, v14, v15
v_mfma_f32_16x16x32_bf16 v[64:67], a[144:147], v[200:203], v[64:67]
v_exp_f32 v16, v16
v_mfma_f32_16x16x32_bf16 a[0:3], v[104:107], a[212:215], a[0:3]
ds_read_b128 a[152:155], v218 offset:49152
ds_read_b128 a[148:151], v217 offset:49152
v_mfma_f32_16x16x32_bf16 a[0:3], v[88:91], a[176:179], a[0:3]
v_exp_f32 v17, v17
v_mfma_f32_16x16x32_bf16 a[4:7], v[92:95], a[176:179], a[4:7]
ds_read_b128 a[144:147], v216 offset:49152
v_cvt_pk_bf16_f32 v76, v16, v17
v_mfma_f32_16x16x32_bf16 a[4:7], v[108:111], a[212:215], a[4:7]
v_exp_f32 v18, v18
v_mfma_f32_16x16x32_bf16 a[20:23], v[108:111], a[216:219], a[20:23]
ds_read_b64_tr_b16 a[176:177], v220 offset:32768
ds_read_b64_tr_b16 a[178:179], v220 offset:36864
v_mfma_f32_16x16x32_bf16 a[20:23], v[92:95], a[180:183], a[20:23]
v_exp_f32 v19, v19
v_mfma_f32_16x16x32_bf16 a[16:19], v[88:91], a[180:183], a[16:19]
ds_read_b64_tr_b16 a[180:181], v221 offset:32768
v_cvt_pk_bf16_f32 v77, v18, v19
v_mfma_f32_16x16x32_bf16 a[16:19], v[104:107], a[216:219], a[16:19]
v_exp_f32 v20, v20
v_mfma_f32_16x16x32_bf16 a[32:35], v[104:107], a[220:223], a[32:35]
ds_read_b64_tr_b16 a[182:183], v221 offset:36864
buffer_load_dwordx2 a[252:253], v249, s[52:55], 0 offen
v_mfma_f32_16x16x32_bf16 a[32:35], v[88:91], a[184:187], a[32:35]
v_exp_f32 v21, v21
v_mfma_f32_16x16x32_bf16 a[36:39], v[92:95], a[184:187], a[36:39]
ds_read_b64_tr_b16 a[184:185], v222 offset:32768
v_cvt_pk_bf16_f32 v78, v20, v21
v_mfma_f32_16x16x32_bf16 a[36:39], v[108:111], a[220:223], a[36:39]
v_exp_f32 v22, v22
v_mfma_f32_16x16x32_bf16 a[52:55], v[108:111], a[224:227], a[52:55]
ds_read_b64_tr_b16 a[186:187], v222 offset:36864
v_mfma_f32_16x16x32_bf16 a[52:55], v[92:95], a[188:191], a[52:55]
v_exp_f32 v23, v23
v_mfma_f32_16x16x32_bf16 a[48:51], v[88:91], a[188:191], a[48:51]
ds_read_b64_tr_b16 a[188:189], v223 offset:32768
v_cvt_pk_bf16_f32 v79, v22, v23
v_mfma_f32_16x16x32_bf16 a[48:51], v[104:107], a[224:227], a[48:51]
v_exp_f32 v24, v24
v_smfmac_f32_16x16x64_bf16 a[128:131], a[208:211], v[104:111], v245
v_exp_f32 v25, v25
v_mfma_f32_16x16x32_bf16 v[44:47], a[160:163], v[152:155], v[136:139]
ds_read_b64_tr_b16 a[190:191], v223 offset:36864
v_cvt_pk_bf16_f32 v80, v24, v25
v_mfma_f32_16x16x32_bf16 v[44:47], a[164:167], v[156:159], v[44:47]
v_exp_f32 v26, v26
v_mfma_f32_16x16x32_bf16 v[44:47], a[168:171], v[160:163], v[44:47]
s_add_u32 m0, s88, 79488
s_lshl2_add_u32 s50, m0, s89
buffer_load_dwordx4 v243, s[56:59], s50 offen  lds
v_mfma_f32_16x16x32_bf16 v[44:47], a[172:175], v[164:167], v[44:47]
v_exp_f32 v27, v27
v_mfma_f32_16x16x32_bf16 v[52:55], a[172:175], v[180:183], v[140:143]
v_cvt_pk_bf16_f32 v81, v26, v27
v_mfma_f32_16x16x32_bf16 v[52:55], a[168:171], v[176:179], v[52:55]
v_exp_f32 v28, v28
v_mfma_f32_16x16x32_bf16 v[52:55], a[164:167], v[172:175], v[52:55]
s_add_u32 m0, s88, 82944
s_lshl2_add_u32 s50, m0, s89
buffer_load_dwordx4 v243, s[56:59], s50 offen  lds
v_mfma_f32_16x16x32_bf16 v[52:55], a[160:163], v[168:171], v[52:55]
v_exp_f32 v29, v29
v_mfma_f32_16x16x32_bf16 v[60:63], a[160:163], v[184:187], v[144:147]
v_cvt_pk_bf16_f32 v82, v28, v29
v_mfma_f32_16x16x32_bf16 v[60:63], a[164:167], v[188:191], v[60:63]
v_exp_f32 v30, v30
v_mfma_f32_16x16x32_bf16 v[60:63], a[168:171], v[192:195], v[60:63]
s_add_u32 m0, s88, 86400
s_lshl2_add_u32 s50, m0, s89
buffer_load_dwordx4 v243, s[56:59], s50 offen  lds
v_mfma_f32_16x16x32_bf16 v[60:63], a[172:175], v[196:199], v[60:63]
v_exp_f32 v31, v31
v_mfma_f32_16x16x32_bf16 v[68:71], a[172:175], v[212:215], v[148:151]
ds_read_b128 a[172:175], v219 offset:53248
v_cvt_pk_bf16_f32 v83, v30, v31
v_mfma_f32_16x16x32_bf16 v[68:71], a[168:171], v[208:211], v[68:71]
v_exp_f32 v32, v32
v_mfma_f32_16x16x32_bf16 v[68:71], a[164:167], v[204:207], v[68:71]
ds_read_b128 a[168:171], v218 offset:53248
ds_read_b128 a[164:167], v217 offset:53248
v_mfma_f32_16x16x32_bf16 v[68:71], a[160:163], v[200:203], v[68:71]
v_exp_f32 v33, v33
v_mfma_f32_16x16x32_bf16 a[64:67], v[104:107], a[228:231], a[64:67]
ds_read_b128 a[160:163], v216 offset:53248
v_cvt_pk_bf16_f32 v84, v32, v33
v_mfma_f32_16x16x32_bf16 a[64:67], v[88:91], a[192:195], a[64:67]
v_exp_f32 v34, v34
v_mfma_f32_16x16x32_bf16 a[68:71], v[92:95], a[192:195], a[68:71]
ds_read_b64_tr_b16 a[192:193], v224 offset:32768
ds_read_b64_tr_b16 a[194:195], v224 offset:36864
v_mfma_f32_16x16x32_bf16 a[68:71], v[108:111], a[228:231], a[68:71]
v_exp_f32 v35, v35
v_mfma_f32_16x16x32_bf16 a[84:87], v[108:111], a[232:235], a[84:87]
v_cvt_pk_bf16_f32 v85, v34, v35
v_mfma_f32_16x16x32_bf16 a[84:87], v[92:95], a[196:199], a[84:87]
v_exp_f32 v36, v36
v_mfma_f32_16x16x32_bf16 a[80:83], v[88:91], a[196:199], a[80:83]
ds_read_b64_tr_b16 a[196:197], v225 offset:32768
ds_read_b64_tr_b16 a[198:199], v225 offset:36864
v_mfma_f32_16x16x32_bf16 a[80:83], v[104:107], a[232:235], a[80:83]
v_exp_f32 v37, v37
v_mfma_f32_16x16x32_bf16 a[96:99], v[104:107], a[236:239], a[96:99]
v_cvt_pk_bf16_f32 v86, v36, v37
v_mfma_f32_16x16x32_bf16 a[96:99], v[88:91], a[200:203], a[96:99]
v_exp_f32 v38, v38
v_mfma_f32_16x16x32_bf16 a[100:103], v[92:95], a[200:203], a[100:103]
ds_read_b64_tr_b16 a[200:201], v226 offset:32768
ds_read_b64_tr_b16 a[202:203], v226 offset:36864
v_mfma_f32_16x16x32_bf16 a[100:103], v[108:111], a[236:239], a[100:103]
v_exp_f32 v39, v39
v_mfma_f32_16x16x32_bf16 a[116:119], v[108:111], a[240:243], a[116:119]
v_cvt_pk_bf16_f32 v87, v38, v39
v_mfma_f32_16x16x32_bf16 a[116:119], v[92:95], a[204:207], a[116:119]
s_add_u32 m0, s88, 89856
s_lshl2_add_u32 s50, m0, s89
buffer_load_dwordx4 v243, s[56:59], s50 offen  lds
v_mfma_f32_16x16x32_bf16 a[112:115], v[88:91], a[204:207], a[112:115]
ds_read_b64_tr_b16 a[204:205], v227 offset:32768
ds_read_b64_tr_b16 a[206:207], v227 offset:36864
v_mfma_f32_16x16x32_bf16 a[112:115], v[104:107], a[240:243], a[112:115]
s_add_u32 m0, s88, 93312
s_lshl2_add_u32 s50, m0, s89
buffer_load_dwordx4 v243, s[56:59], s50 offen  lds
v_smfmac_f32_16x16x64_bf16 a[132:135], a[208:211], v[112:119], v245
s_waitcnt vmcnt(16)
v_cmp_ne_u32 vcc, s47, v121
s_cbranch_vccnz SP_FK
SP_FK_RET:
s_waitcnt lgkmcnt(8)
v_mfma_f32_16x16x32_bf16 v[8:11], a[144:147], v[152:155], v[136:139]
v_exp_f32 v40, v40
v_mfma_f32_16x16x32_bf16 v[8:11], a[148:151], v[156:159], v[8:11]
v_exp_f32 v41, v41
v_mfma_f32_16x16x32_bf16 v[8:11], a[152:155], v[160:163], v[8:11]
v_cvt_pk_bf16_f32 v88, v40, v41
v_mfma_f32_16x16x32_bf16 v[8:11], a[156:159], v[164:167], v[8:11]
v_exp_f32 v42, v42
v_mfma_f32_16x16x32_bf16 v[16:19], a[156:159], v[180:183], v[140:143]
s_add_u32 m0, s88, 96768
s_lshl2_add_u32 s50, m0, s89
buffer_load_dwordx4 v243, s[56:59], s50 offen  lds
v_mfma_f32_16x16x32_bf16 v[16:19], a[152:155], v[176:179], v[16:19]
v_exp_f32 v43, v43
v_mfma_f32_16x16x32_bf16 v[16:19], a[148:151], v[172:175], v[16:19]
v_cvt_pk_bf16_f32 v89, v42, v43
v_mfma_f32_16x16x32_bf16 v[16:19], a[144:147], v[168:171], v[16:19]
v_exp_f32 v44, v44
v_mfma_f32_16x16x32_bf16 v[24:27], a[144:147], v[184:187], v[144:147]
s_mov_b32 s93, 0x243080
buffer_load_dword v246, v254, s[20:23], s93 offen sc0 sc1
v_mfma_f32_16x16x32_bf16 v[24:27], a[148:151], v[188:191], v[24:27]
s_mov_b32 s92, 0x1c00000
v_exp_f32 v45, v45
v_mfma_f32_16x16x32_bf16 v[24:27], a[152:155], v[192:195], v[24:27]
v_cvt_pk_bf16_f32 v90, v44, v45
v_mfma_f32_16x16x32_bf16 v[24:27], a[156:159], v[196:199], v[24:27]
v_exp_f32 v46, v46
v_mfma_f32_16x16x32_bf16 v[32:35], a[156:159], v[212:215], v[148:151]
ds_read_b128 a[156:159], v219 offset:57344
v_mfma_f32_16x16x32_bf16 v[32:35], a[152:155], v[208:211], v[32:35]
v_exp_f32 v47, v47
v_mfma_f32_16x16x32_bf16 v[32:35], a[148:151], v[204:207], v[32:35]
ds_read_b128 a[152:155], v218 offset:57344
v_cvt_pk_bf16_f32 v91, v46, v47
v_mfma_f32_16x16x32_bf16 v[32:35], a[144:147], v[200:203], v[32:35]
v_exp_f32 v48, v48
v_mfma_f32_16x16x32_bf16 a[8:11], v[80:83], a[176:179], a[8:11]
ds_read_b128 a[148:151], v217 offset:57344
ds_read_b128 a[144:147], v216 offset:57344
v_mfma_f32_16x16x32_bf16 a[8:11], v[112:115], a[212:215], a[8:11]
v_exp_f32 v49, v49
v_mfma_f32_16x16x32_bf16 a[12:15], v[116:119], a[212:215], a[12:15]
ds_read_b64_tr_b16 a[212:213], v220 offset:40960
v_cvt_pk_bf16_f32 v92, v48, v49
v_mfma_f32_16x16x32_bf16 a[12:15], v[84:87], a[176:179], a[12:15]
v_exp_f32 v50, v50
v_mfma_f32_16x16x32_bf16 a[28:31], v[84:87], a[180:183], a[28:31]
ds_read_b64_tr_b16 a[214:215], v220 offset:45056
buffer_load_dwordx4 a[136:139], v248, s[20:23], s92 offen offset:0 sc0 sc1
v_mfma_f32_16x16x32_bf16 a[28:31], v[116:119], a[216:219], a[28:31]
v_exp_f32 v51, v51
v_mfma_f32_16x16x32_bf16 a[24:27], v[112:115], a[216:219], a[24:27]
ds_read_b64_tr_b16 a[216:217], v221 offset:40960
v_cvt_pk_bf16_f32 v93, v50, v51
v_mfma_f32_16x16x32_bf16 a[24:27], v[80:83], a[180:183], a[24:27]
v_exp_f32 v52, v52
v_mfma_f32_16x16x32_bf16 a[40:43], v[80:83], a[184:187], a[40:43]
ds_read_b64_tr_b16 a[218:219], v221 offset:45056
v_mfma_f32_16x16x32_bf16 a[40:43], v[112:115], a[220:223], a[40:43]
v_exp_f32 v53, v53
v_mfma_f32_16x16x32_bf16 a[44:47], v[116:119], a[220:223], a[44:47]
ds_read_b64_tr_b16 a[220:221], v222 offset:40960
v_cvt_pk_bf16_f32 v94, v52, v53
v_mfma_f32_16x16x32_bf16 a[44:47], v[84:87], a[184:187], a[44:47]
v_exp_f32 v54, v54
v_mfma_f32_16x16x32_bf16 a[60:63], v[84:87], a[188:191], a[60:63]
ds_read_b64_tr_b16 a[222:223], v222 offset:45056
v_mfma_f32_16x16x32_bf16 a[60:63], v[116:119], a[224:227], a[60:63]
v_exp_f32 v55, v55
v_mfma_f32_16x16x32_bf16 a[56:59], v[112:115], a[224:227], a[56:59]
ds_read_b64_tr_b16 a[224:225], v223 offset:40960
v_cvt_pk_bf16_f32 v95, v54, v55
v_mfma_f32_16x16x32_bf16 a[56:59], v[80:83], a[188:191], a[56:59]
v_exp_f32 v56, v56
v_smfmac_f32_16x16x64_bf16 a[128:131], a[208:211], v[72:79], v245
v_exp_f32 v57, v57
v_mfma_f32_16x16x32_bf16 v[12:15], a[160:163], v[152:155], v[136:139]
ds_read_b64_tr_b16 a[226:227], v223 offset:45056
v_cvt_pk_bf16_f32 v96, v56, v57
v_mfma_f32_16x16x32_bf16 v[12:15], a[164:167], v[156:159], v[12:15]
v_exp_f32 v58, v58
v_mfma_f32_16x16x32_bf16 v[12:15], a[168:171], v[160:163], v[12:15]
s_add_u32 m0, s88, 100224
s_lshl2_add_u32 s50, m0, s89
buffer_load_dwordx4 v243, s[56:59], s50 offen  lds
v_mfma_f32_16x16x32_bf16 v[12:15], a[172:175], v[164:167], v[12:15]
v_exp_f32 v59, v59
v_mfma_f32_16x16x32_bf16 v[20:23], a[172:175], v[180:183], v[140:143]
buffer_load_dwordx4 a[140:143], v248, s[20:23], s92 offen offset:128 sc0 sc1
v_cvt_pk_bf16_f32 v97, v58, v59
v_mfma_f32_16x16x32_bf16 v[20:23], a[168:171], v[176:179], v[20:23]
v_exp_f32 v60, v60
v_mfma_f32_16x16x32_bf16 v[20:23], a[164:167], v[172:175], v[20:23]
s_add_u32 m0, s88, 103680
s_lshl2_add_u32 s50, m0, s89
buffer_load_dwordx4 v243, s[56:59], s50 offen  lds
v_mfma_f32_16x16x32_bf16 v[20:23], a[160:163], v[168:171], v[20:23]
v_exp_f32 v61, v61
v_mfma_f32_16x16x32_bf16 v[28:31], a[160:163], v[184:187], v[144:147]
v_cvt_pk_bf16_f32 v98, v60, v61
v_mfma_f32_16x16x32_bf16 v[28:31], a[164:167], v[188:191], v[28:31]
v_exp_f32 v62, v62
v_mfma_f32_16x16x32_bf16 v[28:31], a[168:171], v[192:195], v[28:31]
s_add_u32 m0, s88, 107136
s_lshl2_add_u32 s50, m0, s89
buffer_load_dwordx4 v243, s[56:59], s50 offen  lds
v_mfma_f32_16x16x32_bf16 v[28:31], a[172:175], v[196:199], v[28:31]
v_exp_f32 v63, v63
v_mfma_f32_16x16x32_bf16 v[36:39], a[172:175], v[212:215], v[148:151]
ds_read_b128 a[172:175], v219 offset:61440
STUB_12:
s_cbranch_execz HOP_RET1
v_cvt_pk_bf16_f32 v99, v62, v63
v_mfma_f32_16x16x32_bf16 v[36:39], a[168:171], v[208:211], v[36:39]
v_exp_f32 v64, v64
v_mfma_f32_16x16x32_bf16 v[36:39], a[164:167], v[204:207], v[36:39]
ds_read_b128 a[168:171], v218 offset:61440
ds_read_b128 a[164:167], v217 offset:61440
v_mfma_f32_16x16x32_bf16 v[36:39], a[160:163], v[200:203], v[36:39]
v_exp_f32 v65, v65
s_waitcnt lgkmcnt(8)
v_mfma_f32_16x16x32_bf16 a[72:75], v[80:83], a[192:195], a[72:75]
ds_read_b128 a[160:163], v216 offset:61440
v_cvt_pk_bf16_f32 v100, v64, v65
v_mfma_f32_16x16x32_bf16 a[72:75], v[112:115], a[228:231], a[72:75]
v_exp_f32 v66, v66
v_mfma_f32_16x16x32_bf16 a[76:79], v[116:119], a[228:231], a[76:79]
ds_read_b64_tr_b16 a[228:229], v224 offset:40960
ds_read_b64_tr_b16 a[230:231], v224 offset:45056
v_mfma_f32_16x16x32_bf16 a[76:79], v[84:87], a[192:195], a[76:79]
v_exp_f32 v67, v67
v_mfma_f32_16x16x32_bf16 a[92:95], v[84:87], a[196:199], a[92:95]
buffer_load_dwordx2 a[254:255], v249, s[20:23], s92 offen sc0 sc1
v_cvt_pk_bf16_f32 v101, v66, v67
v_mfma_f32_16x16x32_bf16 a[92:95], v[116:119], a[232:235], a[92:95]
v_sub_u32 v133, 0xffff, v132
v_exp_f32 v68, v68
v_mfma_f32_16x16x32_bf16 a[88:91], v[112:115], a[232:235], a[88:91]
ds_read_b64_tr_b16 a[232:233], v225 offset:40960
ds_read_b64_tr_b16 a[234:235], v225 offset:45056
v_and_b32 v120, 0xffff, v120
v_mfma_f32_16x16x32_bf16 a[88:91], v[80:83], a[196:199], a[88:91]
v_readlane_b32 s93, v120, 0
v_exp_f32 v69, v69
v_mfma_f32_16x16x32_bf16 a[104:107], v[80:83], a[200:203], a[104:107]
v_cvt_pk_bf16_f32 v102, v68, v69
v_mfma_f32_16x16x32_bf16 a[104:107], v[112:115], a[236:239], a[104:107]
v_cmp_eq_u32 s[90:91], s93, v133
v_exp_f32 v70, v70
v_mfma_f32_16x16x32_bf16 a[108:111], v[116:119], a[236:239], a[108:111]
ds_read_b64_tr_b16 a[236:237], v226 offset:40960
ds_read_b64_tr_b16 a[238:239], v226 offset:45056
v_mov_b32 v134, 0
v_mfma_f32_16x16x32_bf16 a[108:111], v[84:87], a[200:203], a[108:111]
v_cndmask_b32 v135, v135, v134, s[90:91]
v_exp_f32 v71, v71
v_mfma_f32_16x16x32_bf16 a[124:127], v[84:87], a[204:207], a[124:127]
v_cvt_pk_bf16_f32 v103, v70, v71
v_readlane_b32 s93, v120, 1
v_mfma_f32_16x16x32_bf16 a[124:127], v[116:119], a[240:243], a[124:127]
s_add_u32 m0, s88, 110592
s_lshl2_add_u32 s50, m0, s89
buffer_load_dwordx4 v243, s[56:59], s50 offen  lds
v_mfma_f32_16x16x32_bf16 a[120:123], v[112:115], a[240:243], a[120:123]
ds_read_b64_tr_b16 a[240:241], v227 offset:40960
ds_read_b64_tr_b16 a[242:243], v227 offset:45056
v_cmp_eq_u32 s[90:91], s93, v133
v_mfma_f32_16x16x32_bf16 a[120:123], v[80:83], a[204:207], a[120:123]
v_mov_b32 v134, 1152
v_smfmac_f32_16x16x64_bf16 a[132:135], a[208:211], v[80:87], v245
v_cndmask_b32 v135, v135, v134, s[90:91]
v_mfma_f32_16x16x32_bf16 v[40:43], a[144:147], v[152:155], v[136:139]
v_readlane_b32 s93, v120, 2
v_exp_f32 v8, v8
v_mfma_f32_16x16x32_bf16 v[40:43], a[148:151], v[156:159], v[40:43]
v_exp_f32 v9, v9
v_mfma_f32_16x16x32_bf16 v[40:43], a[152:155], v[160:163], v[40:43]
v_cvt_pk_bf16_f32 v104, v8, v9
v_cmp_eq_u32 s[90:91], s93, v133
v_mov_b32 v134, 2304
v_mfma_f32_16x16x32_bf16 v[40:43], a[156:159], v[164:167], v[40:43]
v_cndmask_b32 v135, v135, v134, s[90:91]
v_exp_f32 v10, v10
v_mfma_f32_16x16x32_bf16 v[48:51], a[156:159], v[180:183], v[140:143]
v_readlane_b32 s93, v120, 3
v_mfma_f32_16x16x32_bf16 v[48:51], a[152:155], v[176:179], v[48:51]
v_exp_f32 v11, v11
v_mfma_f32_16x16x32_bf16 v[48:51], a[148:151], v[172:175], v[48:51]
v_cvt_pk_bf16_f32 v105, v10, v11
v_cmp_eq_u32 s[90:91], s93, v133
v_mov_b32 v134, 3456
v_mfma_f32_16x16x32_bf16 v[48:51], a[144:147], v[168:171], v[48:51]
v_cndmask_b32 v135, v135, v134, s[90:91]
v_exp_f32 v12, v12
v_mfma_f32_16x16x32_bf16 v[56:59], a[144:147], v[184:187], v[144:147]
v_readlane_b32 s93, v120, 4
v_mfma_f32_16x16x32_bf16 v[56:59], a[148:151], v[188:191], v[56:59]
v_exp_f32 v13, v13
v_mfma_f32_16x16x32_bf16 v[56:59], a[152:155], v[192:195], v[56:59]
v_cvt_pk_bf16_f32 v106, v12, v13
v_cmp_eq_u32 s[90:91], s93, v133
v_mov_b32 v134, 4608
v_mfma_f32_16x16x32_bf16 v[56:59], a[156:159], v[196:199], v[56:59]
v_cndmask_b32 v135, v135, v134, s[90:91]
v_exp_f32 v14, v14
v_mfma_f32_16x16x32_bf16 v[64:67], a[156:159], v[212:215], v[148:151]
s_waitcnt vmcnt(15) lgkmcnt(0)
s_barrier
v_readlane_b32 s93, v120, 5
v_mfma_f32_16x16x32_bf16 v[64:67], a[152:155], v[208:211], v[64:67]
v_exp_f32 v15, v15
v_mfma_f32_16x16x32_bf16 v[64:67], a[148:151], v[204:207], v[64:67]
v_cvt_pk_bf16_f32 v107, v14, v15
v_cmp_eq_u32 s[90:91], s93, v133
v_mov_b32 v134, 5760
v_mfma_f32_16x16x32_bf16 v[64:67], a[144:147], v[200:203], v[64:67]
v_cndmask_b32 v135, v135, v134, s[90:91]
v_exp_f32 v16, v16
v_mfma_f32_16x16x32_bf16 a[0:3], v[88:91], a[212:215], a[0:3]
s_add_u32 m0, s88, 114048
s_lshl2_add_u32 s50, m0, s89
buffer_load_dwordx4 v243, s[56:59], s50 offen  lds
v_mfma_f32_16x16x32_bf16 a[0:3], v[72:75], a[176:179], a[0:3]
v_readlane_b32 s93, v120, 6
v_exp_f32 v17, v17
v_mfma_f32_16x16x32_bf16 a[4:7], v[76:79], a[176:179], a[4:7]
ds_read_b64_tr_b16 a[176:177], v220 offset:49152
v_cvt_pk_bf16_f32 v108, v16, v17
v_mfma_f32_16x16x32_bf16 a[4:7], v[92:95], a[212:215], a[4:7]
v_cmp_eq_u32 s[90:91], s93, v133
v_exp_f32 v18, v18
v_mfma_f32_16x16x32_bf16 a[20:23], v[92:95], a[216:219], a[20:23]
ds_read_b64_tr_b16 a[178:179], v220 offset:53248
v_mov_b32 v134, 6912
v_mfma_f32_16x16x32_bf16 a[20:23], v[76:79], a[180:183], a[20:23]
v_cndmask_b32 v135, v135, v134, s[90:91]
v_exp_f32 v19, v19
v_mfma_f32_16x16x32_bf16 a[16:19], v[72:75], a[180:183], a[16:19]
ds_read_b64_tr_b16 a[180:181], v221 offset:49152
v_cvt_pk_bf16_f32 v109, v18, v19
v_readlane_b32 s93, v120, 7
v_mfma_f32_16x16x32_bf16 a[16:19], v[88:91], a[216:219], a[16:19]
v_exp_f32 v20, v20
v_mfma_f32_16x16x32_bf16 a[32:35], v[88:91], a[220:223], a[32:35]
ds_read_b64_tr_b16 a[182:183], v221 offset:53248
v_cmp_eq_u32 s[90:91], s93, v133
v_mov_b32 v134, 8064
v_mfma_f32_16x16x32_bf16 a[32:35], v[72:75], a[184:187], a[32:35]
v_cndmask_b32 v135, v135, v134, s[90:91]
v_exp_f32 v21, v21
v_mfma_f32_16x16x32_bf16 a[36:39], v[76:79], a[184:187], a[36:39]
ds_read_b64_tr_b16 a[184:185], v222 offset:49152
v_cvt_pk_bf16_f32 v110, v20, v21
v_mfma_f32_16x16x32_bf16 a[36:39], v[92:95], a[220:223], a[36:39]
v_exp_f32 v22, v22
v_mfma_f32_16x16x32_bf16 a[52:55], v[92:95], a[224:227], a[52:55]
ds_read_b64_tr_b16 a[186:187], v222 offset:53248
v_add_u32 v250, v250, v135
v_mfma_f32_16x16x32_bf16 a[52:55], v[76:79], a[188:191], a[52:55]
v_exp_f32 v23, v23
v_mfma_f32_16x16x32_bf16 a[48:51], v[72:75], a[188:191], a[48:51]
ds_read_b64_tr_b16 a[188:189], v223 offset:49152
v_cvt_pk_bf16_f32 v111, v22, v23
v_mfma_f32_16x16x32_bf16 a[48:51], v[88:91], a[224:227], a[48:51]
v_exp_f32 v24, v24
v_smfmac_f32_16x16x64_bf16 a[128:131], a[208:211], v[88:95], v245
v_exp_f32 v25, v25
v_mfma_f32_16x16x32_bf16 v[44:47], a[160:163], v[152:155], v[136:139]
ds_read_b64_tr_b16 a[190:191], v223 offset:53248
v_cvt_pk_bf16_f32 v112, v24, v25
v_mfma_f32_16x16x32_bf16 v[44:47], a[164:167], v[156:159], v[44:47]
v_add_u32 v251, v251, v135
v_exp_f32 v26, v26
v_mfma_f32_16x16x32_bf16 v[44:47], a[168:171], v[160:163], v[44:47]
s_add_u32 m0, s88, 117504
s_lshl2_add_u32 s50, m0, s89
buffer_load_dwordx4 v243, s[56:59], s50 offen  lds
v_mfma_f32_16x16x32_bf16 v[44:47], a[172:175], v[164:167], v[44:47]
v_exp_f32 v27, v27
v_mfma_f32_16x16x32_bf16 v[52:55], a[172:175], v[180:183], v[140:143]
v_cvt_pk_bf16_f32 v113, v26, v27
v_lshrrev_b32 v134, 14, v135
v_mfma_f32_16x16x32_bf16 v[52:55], a[168:171], v[176:179], v[52:55]
v_exp_f32 v28, v28
v_mfma_f32_16x16x32_bf16 v[52:55], a[164:167], v[172:175], v[52:55]
s_add_u32 m0, s88, 120960
s_lshl2_add_u32 s50, m0, s89
buffer_load_dwordx4 v243, s[56:59], s50 offen  lds
v_mfma_f32_16x16x32_bf16 v[52:55], a[160:163], v[168:171], v[52:55]
v_exp_f32 v29, v29
v_mfma_f32_16x16x32_bf16 v[60:63], a[160:163], v[184:187], v[144:147]
v_cvt_pk_bf16_f32 v114, v28, v29
v_cmp_eq_u32 s[90:91], 0, v134
v_mfma_f32_16x16x32_bf16 v[60:63], a[164:167], v[188:191], v[60:63]
v_exp_f32 v30, v30
v_mfma_f32_16x16x32_bf16 v[60:63], a[168:171], v[192:195], v[60:63]
s_add_u32 m0, s88, 124416
s_lshl2_add_u32 s50, m0, s89
buffer_load_dwordx4 v243, s[56:59], s50 offen  lds
v_mfma_f32_16x16x32_bf16 v[60:63], a[172:175], v[196:199], v[60:63]
v_exp_f32 v31, v31
v_mfma_f32_16x16x32_bf16 v[68:71], a[172:175], v[212:215], v[148:151]
v_cvt_pk_bf16_f32 v115, v30, v31
v_mfma_f32_16x16x32_bf16 v[68:71], a[168:171], v[208:211], v[68:71]
v_exp_f32 v32, v32
v_mfma_f32_16x16x32_bf16 v[68:71], a[164:167], v[204:207], v[68:71]
s_add_u32 m0, s88, 127872
s_lshl2_add_u32 s50, m0, s89
buffer_load_dwordx4 v243, s[56:59], s50 offen  lds
v_mfma_f32_16x16x32_bf16 v[68:71], a[160:163], v[200:203], v[68:71]
v_exp_f32 v33, v33
v_mfma_f32_16x16x32_bf16 a[64:67], v[88:91], a[228:231], a[64:67]
v_cvt_pk_bf16_f32 v116, v32, v33
s_waitcnt vmcnt(12)
v_readfirstlane_b32 s93, v246
v_mfma_f32_16x16x32_bf16 a[64:67], v[72:75], a[192:195], a[64:67]
v_exp_f32 v34, v34
v_mfma_f32_16x16x32_bf16 a[68:71], v[76:79], a[192:195], a[68:71]
ds_read_b64_tr_b16 a[192:193], v224 offset:49152
ds_read_b64_tr_b16 a[194:195], v224 offset:53248
v_mfma_f32_16x16x32_bf16 a[68:71], v[92:95], a[228:231], a[68:71]
v_exp_f32 v35, v35
v_mfma_f32_16x16x32_bf16 a[84:87], v[92:95], a[232:235], a[84:87]
v_cvt_pk_bf16_f32 v117, v34, v35
v_mfma_f32_16x16x32_bf16 a[84:87], v[76:79], a[196:199], a[84:87]
v_exp_f32 v36, v36
v_mfma_f32_16x16x32_bf16 a[80:83], v[72:75], a[196:199], a[80:83]
ds_read_b64_tr_b16 a[196:197], v225 offset:49152
ds_read_b64_tr_b16 a[198:199], v225 offset:53248
v_mfma_f32_16x16x32_bf16 a[80:83], v[88:91], a[232:235], a[80:83]
v_exp_f32 v37, v37
v_mfma_f32_16x16x32_bf16 a[96:99], v[88:91], a[236:239], a[96:99]
s_cmp_eq_u64 s[90:91], 0
s_cselect_b32 s93, 144, s93
v_cvt_pk_bf16_f32 v118, v36, v37
v_mfma_f32_16x16x32_bf16 a[96:99], v[72:75], a[200:203], a[96:99]
v_exp_f32 v38, v38
v_mfma_f32_16x16x32_bf16 a[100:103], v[76:79], a[200:203], a[100:103]
ds_read_b64_tr_b16 a[200:201], v226 offset:49152
ds_read_b64_tr_b16 a[202:203], v226 offset:53248
v_mfma_f32_16x16x32_bf16 a[100:103], v[92:95], a[236:239], a[100:103]
v_exp_f32 v39, v39
v_mfma_f32_16x16x32_bf16 a[116:119], v[92:95], a[240:243], a[116:119]
v_cvt_pk_bf16_f32 v119, v38, v39
v_mfma_f32_16x16x32_bf16 a[116:119], v[76:79], a[204:207], a[116:119]
s_add_u32 m0, s88, 131328
s_lshl2_add_u32 s50, m0, s89
buffer_load_dwordx4 v243, s[56:59], s50 offen  lds
v_mfma_f32_16x16x32_bf16 a[112:115], v[72:75], a[204:207], a[112:115]
ds_read_b64_tr_b16 a[204:205], v227 offset:49152
ds_read_b64_tr_b16 a[206:207], v227 offset:53248
v_mfma_f32_16x16x32_bf16 a[112:115], v[88:91], a[240:243], a[112:115]
s_add_u32 m0, s88, 134784
s_lshl2_add_u32 s50, m0, s89
buffer_load_dwordx4 v243, s[56:59], s50 offen  lds
v_smfmac_f32_16x16x64_bf16 a[132:135], a[208:211], v[96:103], v245
s_cmp_lt_u32 s93, 144
s_cbranch_scc1 SP_Y
SP_Y_RET:
s_waitcnt lgkmcnt(8)
v_mfma_f32_16x16x32_bf16 a[0:3], v[104:107], a[176:179], a[0:3]
v_exp_f32 v40, v40
v_mfma_f32_16x16x32_bf16 a[4:7], v[108:111], a[176:179], a[4:7]
s_mov_b32 s93, 0x244000
v_exp_f32 v41, v41
v_mfma_f32_16x16x32_bf16 a[8:11], v[112:115], a[176:179], a[8:11]
v_cvt_pk_bf16_f32 v72, v40, v41
v_exp_f32 v42, v42
v_mfma_f32_16x16x32_bf16 a[8:11], v[96:99], a[212:215], a[8:11]
s_add_u32 m0, s88, 138240
s_lshl2_add_u32 s50, m0, s89
buffer_load_dwordx4 v243, s[56:59], s50 offen  lds
v_mfma_f32_16x16x32_bf16 a[12:15], v[100:103], a[212:215], a[12:15]
ds_read_b64_tr_b16 a[212:213], v220 offset:57344
v_exp_f32 v43, v43
v_mfma_f32_16x16x32_bf16 a[12:15], v[116:119], a[176:179], a[12:15]
v_cvt_pk_bf16_f32 v73, v42, v43
v_exp_f32 v44, v44
v_mfma_f32_16x16x32_bf16 a[28:31], v[116:119], a[180:183], a[28:31]
ds_read_b64_tr_b16 a[214:215], v220 offset:61440
buffer_load_dwordx4 a[144:147], v250, s[20:23], s93 offen offset:0 sc0 sc1
v_mfma_f32_16x16x32_bf16 a[28:31], v[100:103], a[216:219], a[28:31]
v_exp_f32 v45, v45
v_mfma_f32_16x16x32_bf16 a[24:27], v[96:99], a[216:219], a[24:27]
v_cvt_pk_bf16_f32 v74, v44, v45
v_exp_f32 v46, v46
v_mfma_f32_16x16x32_bf16 a[24:27], v[112:115], a[180:183], a[24:27]
ds_read_b64_tr_b16 a[216:217], v221 offset:57344
ds_read_b64_tr_b16 a[218:219], v221 offset:61440
v_mfma_f32_16x16x32_bf16 a[20:23], v[108:111], a[180:183], a[20:23]
v_exp_f32 v47, v47
v_mfma_f32_16x16x32_bf16 a[16:19], v[104:107], a[180:183], a[16:19]
v_cvt_pk_bf16_f32 v75, v46, v47
v_exp_f32 v48, v48
v_mfma_f32_16x16x32_bf16 a[32:35], v[104:107], a[184:187], a[32:35]
v_exp_f32 v49, v49
v_mfma_f32_16x16x32_bf16 a[36:39], v[108:111], a[184:187], a[36:39]
buffer_load_dwordx4 a[148:151], v250, s[20:23], s93 offen offset:128 sc0 sc1
v_cvt_pk_bf16_f32 v76, v48, v49
v_mfma_f32_16x16x32_bf16 a[40:43], v[112:115], a[184:187], a[40:43]
v_exp_f32 v50, v50
v_mfma_f32_16x16x32_bf16 a[40:43], v[96:99], a[220:223], a[40:43]
v_exp_f32 v51, v51
v_mfma_f32_16x16x32_bf16 a[44:47], v[100:103], a[220:223], a[44:47]
ds_read_b64_tr_b16 a[220:221], v222 offset:57344
ds_read_b64_tr_b16 a[222:223], v222 offset:61440
v_cvt_pk_bf16_f32 v77, v50, v51
v_mfma_f32_16x16x32_bf16 a[44:47], v[116:119], a[184:187], a[44:47]
v_exp_f32 v52, v52
v_mfma_f32_16x16x32_bf16 a[60:63], v[116:119], a[188:191], a[60:63]
v_exp_f32 v53, v53
v_mfma_f32_16x16x32_bf16 a[60:63], v[100:103], a[224:227], a[60:63]
buffer_load_dwordx2 a[152:153], v251, s[20:23], s93 offen sc0 sc1
v_cvt_pk_bf16_f32 v78, v52, v53
v_mfma_f32_16x16x32_bf16 a[56:59], v[96:99], a[224:227], a[56:59]
ds_read_b64_tr_b16 a[224:225], v223 offset:57344
v_exp_f32 v54, v54
v_mfma_f32_16x16x32_bf16 a[56:59], v[112:115], a[188:191], a[56:59]
ds_read_b64_tr_b16 a[226:227], v223 offset:61440
v_exp_f32 v55, v55
v_mfma_f32_16x16x32_bf16 a[52:55], v[108:111], a[188:191], a[52:55]
v_cvt_pk_bf16_f32 v79, v54, v55
v_mfma_f32_16x16x32_bf16 a[48:51], v[104:107], a[188:191], a[48:51]
v_exp_f32 v56, v56
v_smfmac_f32_16x16x64_bf16 a[128:131], a[208:211], v[104:111], v245
v_exp_f32 v57, v57
s_waitcnt lgkmcnt(8)
v_mfma_f32_16x16x32_bf16 a[64:67], v[104:107], a[192:195], a[64:67]
v_cvt_pk_bf16_f32 v80, v56, v57
v_exp_f32 v58, v58
v_mfma_f32_16x16x32_bf16 a[68:71], v[108:111], a[192:195], a[68:71]
s_add_u32 m0, s88, 141696
s_lshl2_add_u32 s50, m0, s89
buffer_load_dwordx4 v243, s[56:59], s50 offen  lds
v_mfma_f32_16x16x32_bf16 a[72:75], v[112:115], a[192:195], a[72:75]
v_exp_f32 v59, v59
v_mfma_f32_16x16x32_bf16 a[72:75], v[96:99], a[228:231], a[72:75]
v_cvt_pk_bf16_f32 v81, v58, v59
v_exp_f32 v60, v60
v_mfma_f32_16x16x32_bf16 a[76:79], v[100:103], a[228:231], a[76:79]
ds_read_b64_tr_b16 a[228:229], v224 offset:57344
ds_read_b64_tr_b16 a[230:231], v224 offset:61440
v_mfma_f32_16x16x32_bf16 a[76:79], v[116:119], a[192:195], a[76:79]
v_exp_f32 v61, v61
v_mfma_f32_16x16x32_bf16 a[92:95], v[116:119], a[196:199], a[92:95]
v_cvt_pk_bf16_f32 v82, v60, v61
v_exp_f32 v62, v62
v_mfma_f32_16x16x32_bf16 a[92:95], v[100:103], a[232:235], a[92:95]
s_add_u32 m0, s88, 145152
s_min_u32 m0, m0, 146880
s_lshl2_add_u32 s50, m0, s89
s_cmp_ge_u32 s37, 2
s_cselect_b32 exec_hi, 15, -1
buffer_load_dwordx4 v243, s[56:59], s50 offen  lds
s_mov_b32 exec_hi, -1
v_mfma_f32_16x16x32_bf16 a[88:91], v[96:99], a[232:235], a[88:91]
ds_read_b64_tr_b16 a[232:233], v225 offset:57344
v_exp_f32 v63, v63
v_mfma_f32_16x16x32_bf16 a[88:91], v[112:115], a[196:199], a[88:91]
v_cvt_pk_bf16_f32 v83, v62, v63
v_exp_f32 v64, v64
v_mfma_f32_16x16x32_bf16 a[84:87], v[108:111], a[196:199], a[84:87]
ds_read_b64_tr_b16 a[234:235], v225 offset:61440
v_exp_f32 v65, v65
v_mfma_f32_16x16x32_bf16 a[80:83], v[104:107], a[196:199], a[80:83]
v_cvt_pk_bf16_f32 v84, v64, v65
v_mfma_f32_16x16x32_bf16 a[96:99], v[104:107], a[200:203], a[96:99]
v_exp_f32 v66, v66
v_mfma_f32_16x16x32_bf16 a[100:103], v[108:111], a[200:203], a[100:103]
v_exp_f32 v67, v67
v_mfma_f32_16x16x32_bf16 a[104:107], v[112:115], a[200:203], a[104:107]
v_cvt_pk_bf16_f32 v85, v66, v67
v_mfma_f32_16x16x32_bf16 a[104:107], v[96:99], a[236:239], a[104:107]
v_exp_f32 v68, v68
v_mfma_f32_16x16x32_bf16 a[108:111], v[100:103], a[236:239], a[108:111]
ds_read_b64_tr_b16 a[236:237], v226 offset:57344
v_exp_f32 v69, v69
v_mfma_f32_16x16x32_bf16 a[108:111], v[116:119], a[200:203], a[108:111]
ds_read_b64_tr_b16 a[238:239], v226 offset:61440
v_cvt_pk_bf16_f32 v86, v68, v69
v_mfma_f32_16x16x32_bf16 a[124:127], v[116:119], a[204:207], a[124:127]
v_exp_f32 v70, v70
v_mfma_f32_16x16x32_bf16 a[124:127], v[100:103], a[240:243], a[124:127]
v_exp_f32 v71, v71
v_mfma_f32_16x16x32_bf16 a[120:123], v[96:99], a[240:243], a[120:123]
ds_read_b64_tr_b16 a[240:241], v227 offset:57344
ds_read_b64_tr_b16 a[242:243], v227 offset:61440
v_cvt_pk_bf16_f32 v87, v70, v71
v_mfma_f32_16x16x32_bf16 a[120:123], v[112:115], a[204:207], a[120:123]
v_mfma_f32_16x16x32_bf16 a[116:119], v[108:111], a[204:207], a[116:119]
v_mfma_f32_16x16x32_bf16 a[112:115], v[104:107], a[204:207], a[112:115]
v_smfmac_f32_16x16x64_bf16 a[132:135], a[208:211], v[112:119], v245
K_TAIL:
s_cmp_eq_u32 s48, 0
s_cbranch_scc1 K_MIXED
s_waitcnt lgkmcnt(0)
s_barrier
s_add_u32 s28, s30, 147456
v_smfmac_f32_16x16x64_bf16 a[128:131], a[208:211], v[72:79], v245
v_lshrrev_b32 v132, 1, v1
v_and_b32 v132, 8, v132
v_smfmac_f32_16x16x64_bf16 a[132:135], a[208:211], v[80:87], v245
v_xor_b32 v132, v132, v1
v_lshlrev_b32 v132, 4, v132
v_mfma_f32_16x16x32_bf16 a[0:3], v[72:75], a[212:215], a[0:3]
v_add_u32 v132, s28, v132
v_lshlrev_b32 v133, 3, v1
v_mfma_f32_16x16x32_bf16 a[16:19], v[72:75], a[216:219], a[16:19]
v_and_b32 v133, 8, v133
v_lshrrev_b32 v134, 2, v1
v_mfma_f32_16x16x32_bf16 a[32:35], v[72:75], a[220:223], a[32:35]
v_xor_b32 v133, v133, v134
v_and_b32 v134, 3, v1
v_mfma_f32_16x16x32_bf16 a[48:51], v[72:75], a[224:227], a[48:51]
v_lshl_add_u32 v133, v134, 4, v133
v_lshlrev_b32 v133, 4, v133
v_mfma_f32_16x16x32_bf16 a[64:67], v[72:75], a[228:231], a[64:67]
v_add_u32 v133, s28, v133
v_lshlrev_b32 v134, 2, v1
v_mfma_f32_16x16x32_bf16 a[80:83], v[72:75], a[232:235], a[80:83]
v_add_u32 v134, s28, v134
v_lshlrev_b32 v135, 4, v4
v_mfma_f32_16x16x32_bf16 a[96:99], v[72:75], a[236:239], a[96:99]
v_add_u32 v135, s28, v135
v_mfma_f32_16x16x32_bf16 a[112:115], v[72:75], a[240:243], a[112:115]
v_mfma_f32_16x16x32_bf16 a[4:7], v[76:79], a[212:215], a[4:7]
v_accvgpr_read_b32 v120, a128
v_accvgpr_read_b32 v124, a129
v_accvgpr_read_b32 v121, a130
v_mfma_f32_16x16x32_bf16 a[20:23], v[76:79], a[216:219], a[20:23]
v_accvgpr_read_b32 v125, a131
v_accvgpr_read_b32 v122, a132
v_accvgpr_read_b32 v126, a133
v_mfma_f32_16x16x32_bf16 a[36:39], v[76:79], a[220:223], a[36:39]
v_accvgpr_read_b32 v123, a134
v_accvgpr_read_b32 v127, a135
v_add_f32 v120, v120, v124
v_mfma_f32_16x16x32_bf16 a[52:55], v[76:79], a[224:227], a[52:55]
v_add_f32 v121, v121, v125
v_add_f32 v122, v122, v126
v_add_f32 v123, v123, v127
v_mfma_f32_16x16x32_bf16 a[68:71], v[76:79], a[228:231], a[68:71]
v_rcp_f32 v124, v120
v_rcp_f32 v125, v121
v_rcp_f32 v126, v122
v_mfma_f32_16x16x32_bf16 a[84:87], v[76:79], a[232:235], a[84:87]
v_rcp_f32 v127, v123
ds_write_b32 v134, v124 offset:0
ds_write_b32 v134, v125 offset:256
v_mfma_f32_16x16x32_bf16 a[100:103], v[76:79], a[236:239], a[100:103]
ds_write_b32 v134, v126 offset:512
ds_write_b32 v134, v127 offset:768
ds_read_b128 v[88:91], v135 offset:0
v_mfma_f32_16x16x32_bf16 a[116:119], v[76:79], a[240:243], a[116:119]
ds_read_b128 v[92:95], v135 offset:256
ds_read_b128 v[96:99], v135 offset:512
ds_read_b128 v[100:103], v135 offset:768
s_add_u32 s92, s44, 4096
s_add_u32 s93, s44, 8192
s_add_u32 s51, s44, 12288
v_mfma_f32_16x16x32_bf16 a[8:11], v[80:83], a[212:215], a[8:11]
v_accvgpr_read_b32 v104, a0
v_accvgpr_read_b32 v105, a1
v_accvgpr_read_b32 v106, a2
v_accvgpr_read_b32 v107, a3
v_mfma_f32_16x16x32_bf16 a[24:27], v[80:83], a[216:219], a[24:27]
v_accvgpr_read_b32 v108, a16
v_accvgpr_read_b32 v109, a17
v_accvgpr_read_b32 v110, a18
v_accvgpr_read_b32 v111, a19
s_waitcnt lgkmcnt(0)
v_pk_mul_f32 v[104:105], v[104:105], v[88:89]
v_pk_mul_f32 v[106:107], v[106:107], v[90:91]
v_pk_mul_f32 v[108:109], v[108:109], v[88:89]
v_pk_mul_f32 v[110:111], v[110:111], v[90:91]
v_cvt_pk_bf16_f32 v104, v104, v105
v_cvt_pk_bf16_f32 v105, v106, v107
v_cvt_pk_bf16_f32 v106, v108, v109
v_cvt_pk_bf16_f32 v107, v110, v111
v_mfma_f32_16x16x32_bf16 a[40:43], v[80:83], a[220:223], a[40:43]
v_accvgpr_read_b32 v112, a32
v_accvgpr_read_b32 v113, a33
v_accvgpr_read_b32 v114, a34
v_accvgpr_read_b32 v115, a35
ds_write_b128 v132, v[104:107] offset:0
v_mfma_f32_16x16x32_bf16 a[56:59], v[80:83], a[224:227], a[56:59]
v_accvgpr_read_b32 v116, a48
v_accvgpr_read_b32 v117, a49
v_accvgpr_read_b32 v118, a50
v_accvgpr_read_b32 v119, a51
ds_read_b64_tr_b16 v[8:9], v133 offset:0
ds_read_b64_tr_b16 v[10:11], v133 offset:8
v_pk_mul_f32 v[112:113], v[112:113], v[88:89]
v_pk_mul_f32 v[114:115], v[114:115], v[90:91]
v_pk_mul_f32 v[116:117], v[116:117], v[88:89]
v_pk_mul_f32 v[118:119], v[118:119], v[90:91]
v_cvt_pk_bf16_f32 v112, v112, v113
v_cvt_pk_bf16_f32 v113, v114, v115
v_cvt_pk_bf16_f32 v114, v116, v117
v_cvt_pk_bf16_f32 v115, v118, v119
v_mfma_f32_16x16x32_bf16 a[72:75], v[80:83], a[228:231], a[72:75]
v_accvgpr_read_b32 v104, a64
v_accvgpr_read_b32 v105, a65
v_accvgpr_read_b32 v106, a66
v_accvgpr_read_b32 v107, a67
ds_write_b128 v132, v[112:115] offset:1024
v_mfma_f32_16x16x32_bf16 a[88:91], v[80:83], a[232:235], a[88:91]
v_accvgpr_read_b32 v108, a80
v_accvgpr_read_b32 v109, a81
v_accvgpr_read_b32 v110, a82
v_accvgpr_read_b32 v111, a83
ds_read_b64_tr_b16 v[12:13], v133 offset:1024
ds_read_b64_tr_b16 v[14:15], v133 offset:1032
v_pk_mul_f32 v[104:105], v[104:105], v[88:89]
v_pk_mul_f32 v[106:107], v[106:107], v[90:91]
v_pk_mul_f32 v[108:109], v[108:109], v[88:89]
v_pk_mul_f32 v[110:111], v[110:111], v[90:91]
s_waitcnt lgkmcnt(3)
buffer_store_dwordx4 v[8:11], v244, s[20:23], s44 offen offset:0
v_cvt_pk_bf16_f32 v104, v104, v105
v_cvt_pk_bf16_f32 v105, v106, v107
v_cvt_pk_bf16_f32 v106, v108, v109
v_cvt_pk_bf16_f32 v107, v110, v111
v_mfma_f32_16x16x32_bf16 a[104:107], v[80:83], a[236:239], a[104:107]
v_accvgpr_read_b32 v112, a96
v_accvgpr_read_b32 v113, a97
v_accvgpr_read_b32 v114, a98
v_accvgpr_read_b32 v115, a99
ds_write_b128 v132, v[104:107] offset:2048
v_mfma_f32_16x16x32_bf16 a[120:123], v[80:83], a[240:243], a[120:123]
v_accvgpr_read_b32 v116, a112
v_accvgpr_read_b32 v117, a113
v_accvgpr_read_b32 v118, a114
v_accvgpr_read_b32 v119, a115
ds_read_b64_tr_b16 v[16:17], v133 offset:2048
ds_read_b64_tr_b16 v[18:19], v133 offset:2056
v_pk_mul_f32 v[112:113], v[112:113], v[88:89]
v_pk_mul_f32 v[114:115], v[114:115], v[90:91]
v_pk_mul_f32 v[116:117], v[116:117], v[88:89]
v_pk_mul_f32 v[118:119], v[118:119], v[90:91]
s_waitcnt lgkmcnt(3)
buffer_store_dwordx4 v[12:15], v244, s[20:23], s44 offen offset:1024
v_cvt_pk_bf16_f32 v112, v112, v113
v_cvt_pk_bf16_f32 v113, v114, v115
v_cvt_pk_bf16_f32 v114, v116, v117
v_cvt_pk_bf16_f32 v115, v118, v119
v_mfma_f32_16x16x32_bf16 a[12:15], v[84:87], a[212:215], a[12:15]
v_accvgpr_read_b32 v104, a4
v_accvgpr_read_b32 v105, a5
v_accvgpr_read_b32 v106, a6
v_accvgpr_read_b32 v107, a7
ds_write_b128 v132, v[112:115] offset:3072
v_mfma_f32_16x16x32_bf16 a[28:31], v[84:87], a[216:219], a[28:31]
v_accvgpr_read_b32 v108, a20
v_accvgpr_read_b32 v109, a21
v_accvgpr_read_b32 v110, a22
v_accvgpr_read_b32 v111, a23
ds_read_b64_tr_b16 v[20:21], v133 offset:3072
ds_read_b64_tr_b16 v[22:23], v133 offset:3080
v_pk_mul_f32 v[104:105], v[104:105], v[92:93]
v_pk_mul_f32 v[106:107], v[106:107], v[94:95]
v_pk_mul_f32 v[108:109], v[108:109], v[92:93]
v_pk_mul_f32 v[110:111], v[110:111], v[94:95]
s_waitcnt lgkmcnt(3)
buffer_store_dwordx4 v[16:19], v244, s[20:23], s44 offen offset:2048
v_cvt_pk_bf16_f32 v104, v104, v105
v_cvt_pk_bf16_f32 v105, v106, v107
v_cvt_pk_bf16_f32 v106, v108, v109
v_cvt_pk_bf16_f32 v107, v110, v111
v_mfma_f32_16x16x32_bf16 a[44:47], v[84:87], a[220:223], a[44:47]
v_accvgpr_read_b32 v112, a36
v_accvgpr_read_b32 v113, a37
v_accvgpr_read_b32 v114, a38
v_accvgpr_read_b32 v115, a39
ds_write_b128 v132, v[104:107] offset:0
v_mfma_f32_16x16x32_bf16 a[60:63], v[84:87], a[224:227], a[60:63]
v_accvgpr_read_b32 v116, a52
v_accvgpr_read_b32 v117, a53
v_accvgpr_read_b32 v118, a54
v_accvgpr_read_b32 v119, a55
ds_read_b64_tr_b16 v[24:25], v133 offset:0
ds_read_b64_tr_b16 v[26:27], v133 offset:8
v_pk_mul_f32 v[112:113], v[112:113], v[92:93]
v_pk_mul_f32 v[114:115], v[114:115], v[94:95]
v_pk_mul_f32 v[116:117], v[116:117], v[92:93]
v_pk_mul_f32 v[118:119], v[118:119], v[94:95]
s_waitcnt lgkmcnt(3)
buffer_store_dwordx4 v[20:23], v244, s[20:23], s44 offen offset:3072
v_cvt_pk_bf16_f32 v112, v112, v113
v_cvt_pk_bf16_f32 v113, v114, v115
v_cvt_pk_bf16_f32 v114, v116, v117
STUB_13:
STUB_B1:
s_cbranch_execz STUB_16
v_cvt_pk_bf16_f32 v115, v118, v119
v_mfma_f32_16x16x32_bf16 a[76:79], v[84:87], a[228:231], a[76:79]
v_accvgpr_read_b32 v104, a68
v_accvgpr_read_b32 v105, a69
v_accvgpr_read_b32 v106, a70
v_accvgpr_read_b32 v107, a71
ds_write_b128 v132, v[112:115] offset:1024
v_mfma_f32_16x16x32_bf16 a[92:95], v[84:87], a[232:235], a[92:95]
v_accvgpr_read_b32 v108, a84
v_accvgpr_read_b32 v109, a85
v_accvgpr_read_b32 v110, a86
v_accvgpr_read_b32 v111, a87
ds_read_b64_tr_b16 v[28:29], v133 offset:1024
ds_read_b64_tr_b16 v[30:31], v133 offset:1032
v_pk_mul_f32 v[104:105], v[104:105], v[92:93]
v_pk_mul_f32 v[106:107], v[106:107], v[94:95]
v_pk_mul_f32 v[108:109], v[108:109], v[92:93]
v_pk_mul_f32 v[110:111], v[110:111], v[94:95]
s_waitcnt lgkmcnt(3)
buffer_store_dwordx4 v[24:27], v244, s[20:23], s92 offen offset:0
v_cvt_pk_bf16_f32 v104, v104, v105
v_cvt_pk_bf16_f32 v105, v106, v107
v_cvt_pk_bf16_f32 v106, v108, v109
v_cvt_pk_bf16_f32 v107, v110, v111
v_mfma_f32_16x16x32_bf16 a[108:111], v[84:87], a[236:239], a[108:111]
v_accvgpr_read_b32 v112, a100
v_accvgpr_read_b32 v113, a101
v_accvgpr_read_b32 v114, a102
v_accvgpr_read_b32 v115, a103
ds_write_b128 v132, v[104:107] offset:2048
v_mfma_f32_16x16x32_bf16 a[124:127], v[84:87], a[240:243], a[124:127]
v_accvgpr_read_b32 v116, a116
v_accvgpr_read_b32 v117, a117
v_accvgpr_read_b32 v118, a118
v_accvgpr_read_b32 v119, a119
ds_read_b64_tr_b16 v[32:33], v133 offset:2048
ds_read_b64_tr_b16 v[34:35], v133 offset:2056
v_pk_mul_f32 v[112:113], v[112:113], v[92:93]
v_pk_mul_f32 v[114:115], v[114:115], v[94:95]
v_pk_mul_f32 v[116:117], v[116:117], v[92:93]
v_pk_mul_f32 v[118:119], v[118:119], v[94:95]
s_waitcnt lgkmcnt(3)
buffer_store_dwordx4 v[28:31], v244, s[20:23], s92 offen offset:1024
v_cvt_pk_bf16_f32 v112, v112, v113
v_cvt_pk_bf16_f32 v113, v114, v115
v_cvt_pk_bf16_f32 v114, v116, v117
v_cvt_pk_bf16_f32 v115, v118, v119
v_accvgpr_read_b32 v104, a8
v_accvgpr_read_b32 v105, a9
v_accvgpr_read_b32 v106, a10
v_accvgpr_read_b32 v107, a11
ds_write_b128 v132, v[112:115] offset:3072
v_accvgpr_read_b32 v108, a24
v_accvgpr_read_b32 v109, a25
v_accvgpr_read_b32 v110, a26
v_accvgpr_read_b32 v111, a27
ds_read_b64_tr_b16 v[36:37], v133 offset:3072
ds_read_b64_tr_b16 v[38:39], v133 offset:3080
v_pk_mul_f32 v[104:105], v[104:105], v[96:97]
v_pk_mul_f32 v[106:107], v[106:107], v[98:99]
v_pk_mul_f32 v[108:109], v[108:109], v[96:97]
v_pk_mul_f32 v[110:111], v[110:111], v[98:99]
s_waitcnt lgkmcnt(3)
buffer_store_dwordx4 v[32:35], v244, s[20:23], s92 offen offset:2048
v_cvt_pk_bf16_f32 v104, v104, v105
v_cvt_pk_bf16_f32 v105, v106, v107
v_cvt_pk_bf16_f32 v106, v108, v109
v_cvt_pk_bf16_f32 v107, v110, v111
v_accvgpr_read_b32 v112, a40
v_accvgpr_read_b32 v113, a41
v_accvgpr_read_b32 v114, a42
v_accvgpr_read_b32 v115, a43
ds_write_b128 v132, v[104:107] offset:0
v_accvgpr_read_b32 v116, a56
v_accvgpr_read_b32 v117, a57
v_accvgpr_read_b32 v118, a58
v_accvgpr_read_b32 v119, a59
ds_read_b64_tr_b16 v[40:41], v133 offset:0
ds_read_b64_tr_b16 v[42:43], v133 offset:8
v_pk_mul_f32 v[112:113], v[112:113], v[96:97]
v_pk_mul_f32 v[114:115], v[114:115], v[98:99]
v_pk_mul_f32 v[116:117], v[116:117], v[96:97]
v_pk_mul_f32 v[118:119], v[118:119], v[98:99]
s_waitcnt lgkmcnt(3)
buffer_store_dwordx4 v[36:39], v244, s[20:23], s92 offen offset:3072
v_cvt_pk_bf16_f32 v112, v112, v113
v_cvt_pk_bf16_f32 v113, v114, v115
v_cvt_pk_bf16_f32 v114, v116, v117
v_cvt_pk_bf16_f32 v115, v118, v119
v_accvgpr_read_b32 v104, a72
v_accvgpr_read_b32 v105, a73
v_accvgpr_read_b32 v106, a74
v_accvgpr_read_b32 v107, a75
ds_write_b128 v132, v[112:115] offset:1024
v_accvgpr_read_b32 v108, a88
v_accvgpr_read_b32 v109, a89
v_accvgpr_read_b32 v110, a90
v_accvgpr_read_b32 v111, a91
ds_read_b64_tr_b16 v[44:45], v133 offset:1024
ds_read_b64_tr_b16 v[46:47], v133 offset:1032
v_pk_mul_f32 v[104:105], v[104:105], v[96:97]
v_pk_mul_f32 v[106:107], v[106:107], v[98:99]
v_pk_mul_f32 v[108:109], v[108:109], v[96:97]
v_pk_mul_f32 v[110:111], v[110:111], v[98:99]
s_waitcnt lgkmcnt(3)
buffer_store_dwordx4 v[40:43], v244, s[20:23], s93 offen offset:0
v_cvt_pk_bf16_f32 v104, v104, v105
v_cvt_pk_bf16_f32 v105, v106, v107
v_cvt_pk_bf16_f32 v106, v108, v109
v_cvt_pk_bf16_f32 v107, v110, v111
v_accvgpr_read_b32 v112, a104
v_accvgpr_read_b32 v113, a105
v_accvgpr_read_b32 v114, a106
v_accvgpr_read_b32 v115, a107
ds_write_b128 v132, v[104:107] offset:2048
v_accvgpr_read_b32 v116, a120
v_accvgpr_read_b32 v117, a121
v_accvgpr_read_b32 v118, a122
v_accvgpr_read_b32 v119, a123
ds_read_b64_tr_b16 v[48:49], v133 offset:2048
ds_read_b64_tr_b16 v[50:51], v133 offset:2056
v_pk_mul_f32 v[112:113], v[112:113], v[96:97]
v_pk_mul_f32 v[114:115], v[114:115], v[98:99]
v_pk_mul_f32 v[116:117], v[116:117], v[96:97]
v_pk_mul_f32 v[118:119], v[118:119], v[98:99]
s_waitcnt lgkmcnt(3)
buffer_store_dwordx4 v[44:47], v244, s[20:23], s93 offen offset:1024
v_cvt_pk_bf16_f32 v112, v112, v113
v_cvt_pk_bf16_f32 v113, v114, v115
v_cvt_pk_bf16_f32 v114, v116, v117
v_cvt_pk_bf16_f32 v115, v118, v119
v_accvgpr_read_b32 v104, a12
v_accvgpr_read_b32 v105, a13
v_accvgpr_read_b32 v106, a14
v_accvgpr_read_b32 v107, a15
ds_write_b128 v132, v[112:115] offset:3072
v_accvgpr_read_b32 v108, a28
v_accvgpr_read_b32 v109, a29
v_accvgpr_read_b32 v110, a30
v_accvgpr_read_b32 v111, a31
ds_read_b64_tr_b16 v[52:53], v133 offset:3072
ds_read_b64_tr_b16 v[54:55], v133 offset:3080
v_pk_mul_f32 v[104:105], v[104:105], v[100:101]
v_pk_mul_f32 v[106:107], v[106:107], v[102:103]
v_pk_mul_f32 v[108:109], v[108:109], v[100:101]
v_pk_mul_f32 v[110:111], v[110:111], v[102:103]
s_waitcnt lgkmcnt(3)
buffer_store_dwordx4 v[48:51], v244, s[20:23], s93 offen offset:2048
v_cvt_pk_bf16_f32 v104, v104, v105
v_cvt_pk_bf16_f32 v105, v106, v107
v_cvt_pk_bf16_f32 v106, v108, v109
v_cvt_pk_bf16_f32 v107, v110, v111
v_accvgpr_read_b32 v112, a44
v_accvgpr_read_b32 v113, a45
v_accvgpr_read_b32 v114, a46
v_accvgpr_read_b32 v115, a47
ds_write_b128 v132, v[104:107] offset:0
v_accvgpr_read_b32 v116, a60
v_accvgpr_read_b32 v117, a61
v_accvgpr_read_b32 v118, a62
v_accvgpr_read_b32 v119, a63
ds_read_b64_tr_b16 v[56:57], v133 offset:0
ds_read_b64_tr_b16 v[58:59], v133 offset:8
v_pk_mul_f32 v[112:113], v[112:113], v[100:101]
v_pk_mul_f32 v[114:115], v[114:115], v[102:103]
v_pk_mul_f32 v[116:117], v[116:117], v[100:101]
v_pk_mul_f32 v[118:119], v[118:119], v[102:103]
s_waitcnt lgkmcnt(3)
buffer_store_dwordx4 v[52:55], v244, s[20:23], s93 offen offset:3072
v_cvt_pk_bf16_f32 v112, v112, v113
v_cvt_pk_bf16_f32 v113, v114, v115
v_cvt_pk_bf16_f32 v114, v116, v117
v_cvt_pk_bf16_f32 v115, v118, v119
v_accvgpr_read_b32 v104, a76
v_accvgpr_read_b32 v105, a77
v_accvgpr_read_b32 v106, a78
v_accvgpr_read_b32 v107, a79
ds_write_b128 v132, v[112:115] offset:1024
v_accvgpr_read_b32 v108, a92
v_accvgpr_read_b32 v109, a93
v_accvgpr_read_b32 v110, a94
v_accvgpr_read_b32 v111, a95
ds_read_b64_tr_b16 v[60:61], v133 offset:1024
ds_read_b64_tr_b16 v[62:63], v133 offset:1032
v_pk_mul_f32 v[104:105], v[104:105], v[100:101]
v_pk_mul_f32 v[106:107], v[106:107], v[102:103]
v_pk_mul_f32 v[108:109], v[108:109], v[100:101]
v_pk_mul_f32 v[110:111], v[110:111], v[102:103]
s_waitcnt lgkmcnt(3)
buffer_store_dwordx4 v[56:59], v244, s[20:23], s51 offen offset:0
v_cvt_pk_bf16_f32 v104, v104, v105
v_cvt_pk_bf16_f32 v105, v106, v107
v_cvt_pk_bf16_f32 v106, v108, v109
v_cvt_pk_bf16_f32 v107, v110, v111
v_accvgpr_read_b32 v112, a108
v_accvgpr_read_b32 v113, a109
v_accvgpr_read_b32 v114, a110
v_accvgpr_read_b32 v115, a111
ds_write_b128 v132, v[104:107] offset:2048
v_accvgpr_read_b32 v116, a124
v_accvgpr_read_b32 v117, a125
v_accvgpr_read_b32 v118, a126
v_accvgpr_read_b32 v119, a127
ds_read_b64_tr_b16 v[64:65], v133 offset:2048
ds_read_b64_tr_b16 v[66:67], v133 offset:2056
v_pk_mul_f32 v[112:113], v[112:113], v[100:101]
v_pk_mul_f32 v[114:115], v[114:115], v[102:103]
v_pk_mul_f32 v[116:117], v[116:117], v[100:101]
v_pk_mul_f32 v[118:119], v[118:119], v[102:103]
s_waitcnt lgkmcnt(3)
buffer_store_dwordx4 v[60:63], v244, s[20:23], s51 offen offset:1024
v_cvt_pk_bf16_f32 v112, v112, v113
v_cvt_pk_bf16_f32 v113, v114, v115
v_cvt_pk_bf16_f32 v114, v116, v117
v_cvt_pk_bf16_f32 v115, v118, v119
ds_write_b128 v132, v[112:115] offset:3072
ds_read_b64_tr_b16 v[68:69], v133 offset:3072
ds_read_b64_tr_b16 v[70:71], v133 offset:3080
s_waitcnt lgkmcnt(3)
buffer_store_dwordx4 v[64:67], v244, s[20:23], s51 offen offset:2048
v_max3_f32 v104, v120, v121, v122
v_max_f32 v104, v104, v123
v_add_f32 v105, v120, v121
v_add_f32 v105, v105, v122
v_add_f32 v105, v105, v123
v_cmp_nge_f32 vcc, s42, v104
v_cmp_u_f32 s[28:29], v105, v105
s_or_b64 vcc, vcc, s[28:29]
s_cmp_lg_u64 vcc, 0
s_cselect_b32 s28, 1, 0
v_mov_b32 v104, s28
v_mov_b32 v106, 147456
s_waitcnt lgkmcnt(0)
buffer_store_dwordx4 v[68:71], v244, s[20:23], s51 offen offset:3072
ds_write_b32 v134, v104
s_waitcnt vmcnt(16) lgkmcnt(0)
s_barrier
ds_read2st64_b32 v[110:111], v106 offset0:32 offset1:48
ds_read2st64_b32 v[108:109], v106 offset0:0 offset1:16
ds_read_b64_tr_b16 a[64:65], v237 offset:0
ds_read_b64_tr_b16 a[66:67], v237 offset:4608
ds_read_b64_tr_b16 a[68:69], v237 offset:9216
ds_read_b64_tr_b16 a[70:71], v237 offset:13824
ds_read_b64_tr_b16 a[72:73], v237 offset:8
ds_read_b64_tr_b16 a[74:75], v237 offset:4616
ds_read_b64_tr_b16 a[76:77], v237 offset:9224
ds_read_b64_tr_b16 a[78:79], v237 offset:13832
ds_read_b64_tr_b16 a[80:81], v238 offset:0
ds_read_b64_tr_b16 a[82:83], v238 offset:4608
ds_read_b64_tr_b16 a[84:85], v238 offset:9216
ds_read_b64_tr_b16 a[86:87], v238 offset:13824
s_waitcnt lgkmcnt(12)
v_or_b32 v108, v108, v109
v_or3_b32 v108, v108, v110, v111
s_nop 0
v_readfirstlane_b32 s28, v108
s_cmp_gt_u32 s28, s43
s_cbranch_scc1 K_FALLBACK
s_waitcnt lgkmcnt(8)
v_mfma_f32_16x16x32_bf16 v[96:99], a[64:67], v[56:59], 0
ds_read_b64_tr_b16 a[88:89], v238 offset:8
ds_read_b64_tr_b16 a[90:91], v238 offset:4616
v_mfma_f32_16x16x32_bf16 v[96:99], a[68:71], v[60:63], v[96:99]
s_lshr_b32 s32, s35, 2
s_and_b32 s33, s35, 3
v_mfma_f32_16x16x32_bf16 v[88:91], a[68:71], v[44:47], 0
s_lshl_b32 s94, s36, 9
s_lshl_b32 s28, s32, 6
v_mfma_f32_16x16x32_bf16 v[88:91], a[64:67], v[40:43], v[88:91]
s_lshr_b32 s34, s32, 2
v_mfma_f32_16x16x32_bf16 v[80:83], a[64:67], v[24:27], 0
ds_read_b64_tr_b16 a[92:93], v238 offset:9224
ds_read_b64_tr_b16 a[94:95], v238 offset:13832
v_mfma_f32_16x16x32_bf16 v[80:83], a[68:71], v[28:31], v[80:83]
s_add_u32 s94, s94, s28
s_lshl_b32 s28, s37, 4
v_mfma_f32_16x16x32_bf16 v[72:75], a[68:71], v[12:15], 0
s_add_u32 s94, s94, s28
s_add_u32 s94, s94, 0x248000
v_mfma_f32_16x16x32_bf16 v[72:75], a[64:67], v[8:11], v[72:75]
v_mov_b32 v231, 1
v_and_b32 v229, 7, v1
s_waitcnt lgkmcnt(8)
v_mfma_f32_16x16x32_bf16 v[76:79], a[72:75], v[8:11], 0
ds_read_b64_tr_b16 a[64:65], v237 offset:128
ds_read_b64_tr_b16 a[66:67], v237 offset:4736
v_mfma_f32_16x16x32_bf16 v[76:79], a[76:79], v[12:15], v[76:79]
v_lshlrev_b32 v229, 2, v229
v_lshlrev_b32 v226, 3, v1
v_mfma_f32_16x16x32_bf16 v[84:87], a[76:79], v[28:31], 0
s_lshl2_add_u32 s29, s33, s94
v_mfma_f32_16x16x32_bf16 v[84:87], a[72:75], v[24:27], v[84:87]
v_mfma_f32_16x16x32_bf16 v[92:95], a[72:75], v[40:43], 0
ds_read_b64_tr_b16 a[68:69], v237 offset:9344
ds_read_b64_tr_b16 a[70:71], v237 offset:13952
v_mfma_f32_16x16x32_bf16 v[92:95], a[76:79], v[44:47], v[92:95]
v_mfma_f32_16x16x32_bf16 v[100:103], a[76:79], v[60:63], 0
v_mfma_f32_16x16x32_bf16 v[100:103], a[72:75], v[56:59], v[100:103]
s_waitcnt lgkmcnt(8)
v_mfma_f32_16x16x32_bf16 v[128:131], a[80:83], v[56:59], 0
ds_read_b64_tr_b16 a[72:73], v237 offset:136
ds_read_b64_tr_b16 a[74:75], v237 offset:4744
v_mfma_f32_16x16x32_bf16 v[128:131], a[84:87], v[60:63], v[128:131]
v_mfma_f32_16x16x32_bf16 v[120:123], a[84:87], v[44:47], 0
v_mfma_f32_16x16x32_bf16 v[120:123], a[80:83], v[40:43], v[120:123]
v_mfma_f32_16x16x32_bf16 v[112:115], a[80:83], v[24:27], 0
ds_read_b64_tr_b16 a[76:77], v237 offset:9352
ds_read_b64_tr_b16 a[78:79], v237 offset:13960
v_mfma_f32_16x16x32_bf16 v[112:115], a[84:87], v[28:31], v[112:115]
s_waitcnt vmcnt(0)
buffer_store_dword v231, v254, s[20:23], s29 offen
v_mfma_f32_16x16x32_bf16 v[104:107], a[84:87], v[12:15], 0
s_add_u32 s28, s35, 1
s_and_b32 s28, s28, 3
v_mfma_f32_16x16x32_bf16 v[104:107], a[80:83], v[8:11], v[104:107]
s_mul_i32 s28, s28, 36864
s_waitcnt lgkmcnt(8)
v_mfma_f32_16x16x32_bf16 v[108:111], a[88:91], v[8:11], 0
ds_read_b64_tr_b16 a[80:81], v238 offset:128
ds_read_b64_tr_b16 a[82:83], v238 offset:4736
v_mfma_f32_16x16x32_bf16 v[108:111], a[92:95], v[12:15], v[108:111]
v_add_u32 v216, s28, v234
v_add_u32 v217, s28, v235
v_mfma_f32_16x16x32_bf16 v[116:119], a[92:95], v[28:31], 0
v_add_u32 v218, s28, v236
v_mfma_f32_16x16x32_bf16 v[116:119], a[88:91], v[24:27], v[116:119]
v_mfma_f32_16x16x32_bf16 v[124:127], a[88:91], v[40:43], 0
ds_read_b64_tr_b16 a[84:85], v238 offset:9344
ds_read_b64_tr_b16 a[86:87], v238 offset:13952
v_mfma_f32_16x16x32_bf16 v[124:127], a[92:95], v[44:47], v[124:127]
v_mfma_f32_16x16x32_bf16 v[132:135], a[92:95], v[60:63], 0
v_mfma_f32_16x16x32_bf16 v[132:135], a[88:91], v[56:59], v[132:135]
s_waitcnt lgkmcnt(8)
v_mfma_f32_16x16x32_bf16 v[160:163], a[64:67], v[56:59], 0
ds_read_b64_tr_b16 a[88:89], v238 offset:136
ds_read_b64_tr_b16 a[90:91], v238 offset:4744
v_mfma_f32_16x16x32_bf16 v[160:163], a[68:71], v[60:63], v[160:163]
v_mfma_f32_16x16x32_bf16 v[152:155], a[68:71], v[44:47], 0
v_mfma_f32_16x16x32_bf16 v[152:155], a[64:67], v[40:43], v[152:155]
v_mfma_f32_16x16x32_bf16 v[144:147], a[64:67], v[24:27], 0
ds_read_b64_tr_b16 a[92:93], v238 offset:9352
ds_read_b64_tr_b16 a[94:95], v238 offset:13960
v_mfma_f32_16x16x32_bf16 v[144:147], a[68:71], v[28:31], v[144:147]
v_mfma_f32_16x16x32_bf16 v[136:139], a[68:71], v[12:15], 0
v_mfma_f32_16x16x32_bf16 v[136:139], a[64:67], v[8:11], v[136:139]
s_waitcnt lgkmcnt(8)
v_mfma_f32_16x16x32_bf16 v[140:143], a[72:75], v[8:11], 0
ds_read_b64_tr_b16 a[64:65], v239 offset:0
ds_read_b64_tr_b16 a[66:67], v239 offset:4608
v_mfma_f32_16x16x32_bf16 v[140:143], a[76:79], v[12:15], v[140:143]
buffer_load_dword v230, v229, s[20:23], s94 offen sc0 sc1
v_mfma_f32_16x16x32_bf16 v[148:151], a[76:79], v[28:31], 0
s_add_u32 s39, s35, 1
s_and_b32 s39, s39, 3
v_mfma_f32_16x16x32_bf16 v[148:151], a[72:75], v[24:27], v[148:151]
s_add_u32 s28, s33, 1
s_and_b32 s28, s28, 3
v_mfma_f32_16x16x32_bf16 v[156:159], a[72:75], v[40:43], 0
ds_read_b64_tr_b16 a[68:69], v239 offset:9216
ds_read_b64_tr_b16 a[70:71], v239 offset:13824
v_mfma_f32_16x16x32_bf16 v[156:159], a[76:79], v[44:47], v[156:159]
s_sub_u32 s28, s28, s33
s_lshl_b32 s28, s28, 16
v_mfma_f32_16x16x32_bf16 v[164:167], a[76:79], v[60:63], 0
s_add_u32 s64, s28, s44
s_add_u32 s65, s64, 4096
v_mfma_f32_16x16x32_bf16 v[164:167], a[72:75], v[56:59], v[164:167]
s_add_u32 s66, s64, 8192
s_add_u32 s67, s64, 12288
s_waitcnt lgkmcnt(8)
v_mfma_f32_16x16x32_bf16 v[192:195], a[80:83], v[56:59], 0
ds_read_b64_tr_b16 a[72:73], v237 offset:18432
ds_read_b64_tr_b16 a[74:75], v237 offset:23040
v_mfma_f32_16x16x32_bf16 v[192:195], a[84:87], v[60:63], v[192:195]
s_add_u32 s28, s35, 2
s_and_b32 s28, s28, 3
v_mfma_f32_16x16x32_bf16 v[184:187], a[84:87], v[44:47], 0
s_mul_i32 s28, s28, 36864
v_mfma_f32_16x16x32_bf16 v[184:187], a[80:83], v[40:43], v[184:187]
v_add_u32 v219, s28, v234
v_add_u32 v220, s28, v235
v_mfma_f32_16x16x32_bf16 v[176:179], a[80:83], v[24:27], 0
ds_read_b64_tr_b16 a[76:77], v237 offset:27648
ds_read_b64_tr_b16 a[78:79], v237 offset:32256
v_mfma_f32_16x16x32_bf16 v[176:179], a[84:87], v[28:31], v[176:179]
v_add_u32 v221, s28, v236
v_mfma_f32_16x16x32_bf16 v[168:171], a[84:87], v[12:15], 0
s_add_u32 s28, s35, 3
s_and_b32 s28, s28, 3
v_mfma_f32_16x16x32_bf16 v[168:171], a[80:83], v[8:11], v[168:171]
s_mul_i32 s28, s28, 36864
s_waitcnt lgkmcnt(8)
v_mfma_f32_16x16x32_bf16 v[172:175], a[88:91], v[8:11], 0
ds_read_b64_tr_b16 a[80:81], v237 offset:18440
ds_read_b64_tr_b16 a[82:83], v237 offset:23048
v_mfma_f32_16x16x32_bf16 v[172:175], a[92:95], v[12:15], v[172:175]
v_add_u32 v222, s28, v234
v_add_u32 v223, s28, v235
v_mfma_f32_16x16x32_bf16 v[180:183], a[92:95], v[28:31], 0
v_add_u32 v224, s28, v236
v_mfma_f32_16x16x32_bf16 v[180:183], a[88:91], v[24:27], v[180:183]
v_mfma_f32_16x16x32_bf16 v[188:191], a[88:91], v[40:43], 0
ds_read_b64_tr_b16 a[84:85], v237 offset:27656
ds_read_b64_tr_b16 a[86:87], v237 offset:32264
v_mfma_f32_16x16x32_bf16 v[188:191], a[92:95], v[44:47], v[188:191]
v_mfma_f32_16x16x32_bf16 v[196:199], a[92:95], v[60:63], 0
s_waitcnt vmcnt(0)
v_cmp_gt_u32 vcc, 1, v230
v_mfma_f32_16x16x32_bf16 v[196:199], a[88:91], v[56:59], v[196:199]
s_waitcnt lgkmcnt(8)
v_mfma_f32_16x16x32_bf16 v[212:215], a[64:67], v[56:59], 0
ds_read_b64_tr_b16 a[88:89], v238 offset:18432
ds_read_b64_tr_b16 a[90:91], v238 offset:23040
v_mfma_f32_16x16x32_bf16 v[212:215], a[68:71], v[60:63], v[212:215]
s_bitcmp1_b32 vcc_lo, s39
s_cbranch_scc1 SP_O1A
SP_O1A_RET:
v_mfma_f32_16x16x32_bf16 v[208:211], a[68:71], v[44:47], 0
buffer_load_dwordx4 a[156:159], v244, s[20:23], s64 offen offset:0 sc0 sc1
v_mfma_f32_16x16x32_bf16 v[208:211], a[64:67], v[40:43], v[208:211]
v_mfma_f32_16x16x32_bf16 v[204:207], a[64:67], v[24:27], 0
ds_read_b64_tr_b16 a[92:93], v238 offset:27648
ds_read_b64_tr_b16 a[94:95], v238 offset:32256
v_mfma_f32_16x16x32_bf16 v[204:207], a[68:71], v[28:31], v[204:207]
v_mfma_f32_16x16x32_bf16 v[200:203], a[68:71], v[12:15], 0
buffer_load_dwordx4 a[172:175], v244, s[20:23], s65 offen offset:0 sc0 sc1
v_mfma_f32_16x16x32_bf16 v[200:203], a[64:67], v[8:11], v[200:203]
s_waitcnt lgkmcnt(8)
v_mfma_f32_16x16x32_bf16 v[72:75], a[72:75], v[16:19], v[72:75]
ds_read_b64_tr_b16 a[64:65], v238 offset:18440
ds_read_b64_tr_b16 a[66:67], v238 offset:23048
v_mfma_f32_16x16x32_bf16 v[72:75], a[76:79], v[20:23], v[72:75]
v_mfma_f32_16x16x32_bf16 v[80:83], a[76:79], v[36:39], v[80:83]
buffer_load_dwordx4 a[188:191], v244, s[20:23], s66 offen offset:0 sc0 sc1
v_mfma_f32_16x16x32_bf16 v[80:83], a[72:75], v[32:35], v[80:83]
v_mfma_f32_16x16x32_bf16 v[88:91], a[72:75], v[48:51], v[88:91]
ds_read_b64_tr_b16 a[68:69], v238 offset:27656
ds_read_b64_tr_b16 a[70:71], v238 offset:32264
v_mfma_f32_16x16x32_bf16 v[88:91], a[76:79], v[52:55], v[88:91]
v_mfma_f32_16x16x32_bf16 v[96:99], a[76:79], v[68:71], v[96:99]
buffer_load_dwordx4 a[204:207], v244, s[20:23], s67 offen offset:0 sc0 sc1
v_mfma_f32_16x16x32_bf16 v[96:99], a[72:75], v[64:67], v[96:99]
s_waitcnt lgkmcnt(8)
v_mfma_f32_16x16x32_bf16 v[100:103], a[80:83], v[64:67], v[100:103]
ds_read_b64_tr_b16 a[72:73], v237 offset:18560
ds_read_b64_tr_b16 a[74:75], v237 offset:23168
v_mfma_f32_16x16x32_bf16 v[100:103], a[84:87], v[68:71], v[100:103]
v_mfma_f32_16x16x32_bf16 v[92:95], a[84:87], v[52:55], v[92:95]
buffer_load_dwordx4 a[160:163], v244, s[20:23], s64 offen offset:1024 sc0 sc1
v_mfma_f32_16x16x32_bf16 v[92:95], a[80:83], v[48:51], v[92:95]
v_mfma_f32_16x16x32_bf16 v[84:87], a[80:83], v[32:35], v[84:87]
ds_read_b64_tr_b16 a[76:77], v237 offset:27776
ds_read_b64_tr_b16 a[78:79], v237 offset:32384
v_mfma_f32_16x16x32_bf16 v[84:87], a[84:87], v[36:39], v[84:87]
v_mfma_f32_16x16x32_bf16 v[76:79], a[84:87], v[20:23], v[76:79]
buffer_load_dwordx4 a[176:179], v244, s[20:23], s65 offen offset:1024 sc0 sc1
v_mfma_f32_16x16x32_bf16 v[76:79], a[80:83], v[16:19], v[76:79]
s_waitcnt lgkmcnt(8)
v_mfma_f32_16x16x32_bf16 v[104:107], a[88:91], v[16:19], v[104:107]
ds_read_b64_tr_b16 a[80:81], v237 offset:18568
ds_read_b64_tr_b16 a[82:83], v237 offset:23176
v_mfma_f32_16x16x32_bf16 v[104:107], a[92:95], v[20:23], v[104:107]
v_mfma_f32_16x16x32_bf16 v[112:115], a[92:95], v[36:39], v[112:115]
buffer_load_dwordx4 a[192:195], v244, s[20:23], s66 offen offset:1024 sc0 sc1
v_mfma_f32_16x16x32_bf16 v[112:115], a[88:91], v[32:35], v[112:115]
v_mfma_f32_16x16x32_bf16 v[120:123], a[88:91], v[48:51], v[120:123]
ds_read_b64_tr_b16 a[84:85], v237 offset:27784
ds_read_b64_tr_b16 a[86:87], v237 offset:32392
v_mfma_f32_16x16x32_bf16 v[120:123], a[92:95], v[52:55], v[120:123]
v_mfma_f32_16x16x32_bf16 v[128:131], a[92:95], v[68:71], v[128:131]
buffer_load_dwordx4 a[208:211], v244, s[20:23], s67 offen offset:1024 sc0 sc1
v_mfma_f32_16x16x32_bf16 v[128:131], a[88:91], v[64:67], v[128:131]
s_waitcnt lgkmcnt(8)
v_mfma_f32_16x16x32_bf16 v[132:135], a[64:67], v[64:67], v[132:135]
ds_read_b64_tr_b16 a[88:89], v238 offset:18560
ds_read_b64_tr_b16 a[90:91], v238 offset:23168
v_mfma_f32_16x16x32_bf16 v[132:135], a[68:71], v[68:71], v[132:135]
v_mfma_f32_16x16x32_bf16 v[124:127], a[68:71], v[52:55], v[124:127]
buffer_load_dwordx4 a[164:167], v244, s[20:23], s64 offen offset:2048 sc0 sc1
v_mfma_f32_16x16x32_bf16 v[124:127], a[64:67], v[48:51], v[124:127]
buffer_load_dword v230, v229, s[20:23], s94 offen sc0 sc1
v_mfma_f32_16x16x32_bf16 v[116:119], a[64:67], v[32:35], v[116:119]
ds_read_b64_tr_b16 a[92:93], v238 offset:27776
ds_read_b64_tr_b16 a[94:95], v238 offset:32384
v_mfma_f32_16x16x32_bf16 v[116:119], a[68:71], v[36:39], v[116:119]
v_mfma_f32_16x16x32_bf16 v[108:111], a[68:71], v[20:23], v[108:111]
v_mfma_f32_16x16x32_bf16 v[108:111], a[64:67], v[16:19], v[108:111]
buffer_load_dwordx4 a[180:183], v244, s[20:23], s65 offen offset:2048 sc0 sc1
s_waitcnt lgkmcnt(8)
v_mfma_f32_16x16x32_bf16 v[136:139], a[72:75], v[16:19], v[136:139]
ds_read_b64_tr_b16 a[64:65], v238 offset:18568
ds_read_b64_tr_b16 a[66:67], v238 offset:23176
v_mfma_f32_16x16x32_bf16 v[136:139], a[76:79], v[20:23], v[136:139]
v_mfma_f32_16x16x32_bf16 v[144:147], a[76:79], v[36:39], v[144:147]
v_mfma_f32_16x16x32_bf16 v[144:147], a[72:75], v[32:35], v[144:147]
buffer_load_dwordx4 a[196:199], v244, s[20:23], s66 offen offset:2048 sc0 sc1
v_mfma_f32_16x16x32_bf16 v[152:155], a[72:75], v[48:51], v[152:155]
ds_read_b64_tr_b16 a[68:69], v238 offset:27784
ds_read_b64_tr_b16 a[70:71], v238 offset:32392
v_mfma_f32_16x16x32_bf16 v[152:155], a[76:79], v[52:55], v[152:155]
v_mfma_f32_16x16x32_bf16 v[160:163], a[76:79], v[68:71], v[160:163]
v_mfma_f32_16x16x32_bf16 v[160:163], a[72:75], v[64:67], v[160:163]
buffer_load_dwordx4 a[212:215], v244, s[20:23], s67 offen offset:2048 sc0 sc1
s_waitcnt lgkmcnt(8)
v_mfma_f32_16x16x32_bf16 v[164:167], a[80:83], v[64:67], v[164:167]
ds_read_b64_tr_b16 a[72:73], v239 offset:18432
ds_read_b64_tr_b16 a[74:75], v239 offset:23040
v_mfma_f32_16x16x32_bf16 v[164:167], a[84:87], v[68:71], v[164:167]
v_mfma_f32_16x16x32_bf16 v[156:159], a[84:87], v[52:55], v[156:159]
v_mfma_f32_16x16x32_bf16 v[156:159], a[80:83], v[48:51], v[156:159]
buffer_load_dwordx4 a[168:171], v244, s[20:23], s64 offen offset:3072 sc0 sc1
v_mfma_f32_16x16x32_bf16 v[148:151], a[80:83], v[32:35], v[148:151]
ds_read_b64_tr_b16 a[76:77], v239 offset:27648
ds_read_b64_tr_b16 a[78:79], v239 offset:32256
v_mfma_f32_16x16x32_bf16 v[148:151], a[84:87], v[36:39], v[148:151]
v_mfma_f32_16x16x32_bf16 v[140:143], a[84:87], v[20:23], v[140:143]
v_mfma_f32_16x16x32_bf16 v[140:143], a[80:83], v[16:19], v[140:143]
buffer_load_dwordx4 a[184:187], v244, s[20:23], s65 offen offset:3072 sc0 sc1
s_waitcnt lgkmcnt(8)
v_mfma_f32_16x16x32_bf16 v[168:171], a[88:91], v[16:19], v[168:171]
ds_read_b64_tr_b16 a[80:81], v216 offset:0
ds_read_b64_tr_b16 a[82:83], v216 offset:4608
v_mfma_f32_16x16x32_bf16 v[168:171], a[92:95], v[20:23], v[168:171]
v_mfma_f32_16x16x32_bf16 v[176:179], a[92:95], v[36:39], v[176:179]
v_mfma_f32_16x16x32_bf16 v[176:179], a[88:91], v[32:35], v[176:179]
buffer_load_dwordx4 a[200:203], v244, s[20:23], s66 offen offset:3072 sc0 sc1
v_mfma_f32_16x16x32_bf16 v[184:187], a[88:91], v[48:51], v[184:187]
ds_read_b64_tr_b16 a[84:85], v216 offset:9216
ds_read_b64_tr_b16 a[86:87], v216 offset:13824
v_mfma_f32_16x16x32_bf16 v[184:187], a[92:95], v[52:55], v[184:187]
v_mfma_f32_16x16x32_bf16 v[192:195], a[92:95], v[68:71], v[192:195]
v_mfma_f32_16x16x32_bf16 v[192:195], a[88:91], v[64:67], v[192:195]
buffer_load_dwordx4 a[216:219], v244, s[20:23], s67 offen offset:3072 sc0 sc1
s_waitcnt lgkmcnt(8)
v_mfma_f32_16x16x32_bf16 v[196:199], a[64:67], v[64:67], v[196:199]
ds_read_b64_tr_b16 a[88:89], v216 offset:8
ds_read_b64_tr_b16 a[90:91], v216 offset:4616
v_mfma_f32_16x16x32_bf16 v[196:199], a[68:71], v[68:71], v[196:199]
s_add_u32 s28, s33, 2
s_and_b32 s28, s28, 3
v_mfma_f32_16x16x32_bf16 v[188:191], a[68:71], v[52:55], v[188:191]
s_sub_u32 s28, s28, s33
s_lshl_b32 s28, s28, 16
v_mfma_f32_16x16x32_bf16 v[188:191], a[64:67], v[48:51], v[188:191]
s_add_u32 s64, s28, s44
s_add_u32 s65, s64, 4096
v_mfma_f32_16x16x32_bf16 v[180:183], a[64:67], v[32:35], v[180:183]
ds_read_b64_tr_b16 a[92:93], v216 offset:9224
ds_read_b64_tr_b16 a[94:95], v216 offset:13832
v_mfma_f32_16x16x32_bf16 v[180:183], a[68:71], v[36:39], v[180:183]
s_add_u32 s66, s64, 8192
s_add_u32 s67, s64, 12288
v_mfma_f32_16x16x32_bf16 v[172:175], a[68:71], v[20:23], v[172:175]
s_waitcnt vmcnt(7)
v_cmp_gt_u32 vcc, 1, v230
v_mfma_f32_16x16x32_bf16 v[172:175], a[64:67], v[16:19], v[172:175]
s_waitcnt lgkmcnt(8)
v_mfma_f32_16x16x32_bf16 v[200:203], a[72:75], v[16:19], v[200:203]
ds_read_b64_tr_b16 a[64:65], v217 offset:0
ds_read_b64_tr_b16 a[66:67], v217 offset:4608
STUB_14:
STUB_B2:
s_cbranch_execz STUB_17
v_mfma_f32_16x16x32_bf16 v[200:203], a[76:79], v[20:23], v[200:203]
s_and_b32 s29, vcc_lo, 15
s_cbranch_scc1 SP_O2A
SP_O2A_RET:
v_mfma_f32_16x16x32_bf16 v[204:207], a[76:79], v[36:39], v[204:207]
buffer_load_dwordx4 a[220:223], v244, s[20:23], s64 offen offset:0 sc0 sc1
v_mfma_f32_16x16x32_bf16 v[204:207], a[72:75], v[32:35], v[204:207]
v_mfma_f32_16x16x32_bf16 v[208:211], a[72:75], v[48:51], v[208:211]
ds_read_b64_tr_b16 a[68:69], v217 offset:9216
ds_read_b64_tr_b16 a[70:71], v217 offset:13824
v_mfma_f32_16x16x32_bf16 v[208:211], a[76:79], v[52:55], v[208:211]
v_mfma_f32_16x16x32_bf16 v[212:215], a[76:79], v[68:71], v[212:215]
buffer_load_dwordx4 a[236:239], v244, s[20:23], s65 offen offset:0 sc0 sc1
v_mfma_f32_16x16x32_bf16 v[212:215], a[72:75], v[64:67], v[212:215]
s_waitcnt vmcnt(15)
s_waitcnt lgkmcnt(8)
v_mfma_f32_16x16x32_bf16 v[96:99], a[80:83], a[204:207], v[96:99]
ds_read_b64_tr_b16 a[72:73], v217 offset:8
ds_read_b64_tr_b16 a[74:75], v217 offset:4616
s_waitcnt vmcnt(11)
v_mfma_f32_16x16x32_bf16 v[96:99], a[84:87], a[208:211], v[96:99]
v_mfma_f32_16x16x32_bf16 v[88:91], a[84:87], a[192:195], v[88:91]
buffer_load_dwordx4 a[96:99], v244, s[20:23], s66 offen offset:0 sc0 sc1
v_mfma_f32_16x16x32_bf16 v[88:91], a[80:83], a[188:191], v[88:91]
v_accvgpr_read_b32 v39, a136
v_accvgpr_read_b32 v59, a144
v_mfma_f32_16x16x32_bf16 v[80:83], a[80:83], a[172:175], v[80:83]
ds_read_b64_tr_b16 a[76:77], v217 offset:9224
ds_read_b64_tr_b16 a[78:79], v217 offset:13832
v_mfma_f32_16x16x32_bf16 v[80:83], a[84:87], a[176:179], v[80:83]
v_lshlrev_b32 v38, 16, v39
v_and_b32 v39, 0xffff0000, v39
v_mfma_f32_16x16x32_bf16 v[72:75], a[84:87], a[160:163], v[72:75]
buffer_load_dwordx4 a[112:115], v244, s[20:23], s67 offen offset:0 sc0 sc1
v_mfma_f32_16x16x32_bf16 v[72:75], a[80:83], a[156:159], v[72:75]
v_lshlrev_b32 v58, 16, v59
v_and_b32 v59, 0xffff0000, v59
s_waitcnt lgkmcnt(8)
v_mfma_f32_16x16x32_bf16 v[76:79], a[88:91], a[156:159], v[76:79]
ds_read_b64_tr_b16 a[80:81], v216 offset:128
ds_read_b64_tr_b16 a[82:83], v216 offset:4736
v_mfma_f32_16x16x32_bf16 v[76:79], a[92:95], a[160:163], v[76:79]
v_add_f32 v38, v38, v58
v_add_f32 v39, v39, v59
v_mfma_f32_16x16x32_bf16 v[84:87], a[92:95], a[176:179], v[84:87]
buffer_load_dwordx4 a[224:227], v244, s[20:23], s64 offen offset:1024 sc0 sc1
v_mfma_f32_16x16x32_bf16 v[84:87], a[88:91], a[172:175], v[84:87]
v_cvt_pk_bf16_f32 v58, v38, v39
v_lshlrev_b32 v38, 16, v58
v_mfma_f32_16x16x32_bf16 v[92:95], a[88:91], a[188:191], v[92:95]
ds_read_b64_tr_b16 a[84:85], v216 offset:9344
ds_read_b64_tr_b16 a[86:87], v216 offset:13952
v_mfma_f32_16x16x32_bf16 v[92:95], a[92:95], a[192:195], v[92:95]
v_and_b32 v39, 0xffff0000, v58
v_mul_f32 v58, 0xbfb8aa3b, v38
v_mfma_f32_16x16x32_bf16 v[100:103], a[92:95], a[208:211], v[100:103]
buffer_load_dwordx4 a[240:243], v244, s[20:23], s65 offen offset:1024 sc0 sc1
v_mfma_f32_16x16x32_bf16 v[100:103], a[88:91], a[204:207], v[100:103]
v_mul_f32 v59, 0xbfb8aa3b, v39
s_waitcnt lgkmcnt(8)
v_mfma_f32_16x16x32_bf16 v[128:131], a[64:67], a[204:207], v[128:131]
ds_read_b64_tr_b16 a[88:89], v216 offset:136
ds_read_b64_tr_b16 a[90:91], v216 offset:4744
v_mfma_f32_16x16x32_bf16 v[128:131], a[68:71], a[208:211], v[128:131]
v_exp_f32 v58, v58
v_mfma_f32_16x16x32_bf16 v[120:123], a[68:71], a[192:195], v[120:123]
buffer_load_dwordx4 a[100:103], v244, s[20:23], s66 offen offset:1024 sc0 sc1
v_mfma_f32_16x16x32_bf16 v[120:123], a[64:67], a[188:191], v[120:123]
v_exp_f32 v59, v59
v_mfma_f32_16x16x32_bf16 v[112:115], a[64:67], a[172:175], v[112:115]
ds_read_b64_tr_b16 a[92:93], v216 offset:9352
ds_read_b64_tr_b16 a[94:95], v216 offset:13960
v_mfma_f32_16x16x32_bf16 v[112:115], a[68:71], a[176:179], v[112:115]
v_add_f32 v58, 1.0, v58
v_add_f32 v59, 1.0, v59
v_mfma_f32_16x16x32_bf16 v[104:107], a[68:71], a[160:163], v[104:107]
buffer_load_dwordx4 a[116:119], v244, s[20:23], s67 offen offset:1024 sc0 sc1
v_mfma_f32_16x16x32_bf16 v[104:107], a[64:67], a[156:159], v[104:107]
v_rcp_f32 v58, v58
s_waitcnt lgkmcnt(8)
v_mfma_f32_16x16x32_bf16 v[108:111], a[72:75], a[156:159], v[108:111]
ds_read_b64_tr_b16 a[64:65], v217 offset:128
ds_read_b64_tr_b16 a[66:67], v217 offset:4736
v_mfma_f32_16x16x32_bf16 v[108:111], a[76:79], a[160:163], v[108:111]
v_rcp_f32 v59, v59
v_mfma_f32_16x16x32_bf16 v[116:119], a[76:79], a[176:179], v[116:119]
buffer_load_dwordx4 a[228:231], v244, s[20:23], s64 offen offset:2048 sc0 sc1
v_mfma_f32_16x16x32_bf16 v[116:119], a[72:75], a[172:175], v[116:119]
v_mul_f32 v38, v38, v58
v_mul_f32 v39, v39, v59
v_mfma_f32_16x16x32_bf16 v[124:127], a[72:75], a[188:191], v[124:127]
ds_read_b64_tr_b16 a[68:69], v217 offset:9344
ds_read_b64_tr_b16 a[70:71], v217 offset:13952
v_mfma_f32_16x16x32_bf16 v[124:127], a[76:79], a[192:195], v[124:127]
v_cvt_pk_bf16_f32 v58, v38, v39
v_lshlrev_b32 v38, 16, v58
v_mfma_f32_16x16x32_bf16 v[132:135], a[76:79], a[208:211], v[132:135]
buffer_load_dwordx4 a[128:131], v244, s[20:23], s65 offen offset:2048 sc0 sc1
v_mfma_f32_16x16x32_bf16 v[132:135], a[72:75], a[204:207], v[132:135]
v_and_b32 v39, 0xffff0000, v58
v_accvgpr_read_b32 v41, a137
s_waitcnt lgkmcnt(8)
v_mfma_f32_16x16x32_bf16 v[160:163], a[80:83], a[204:207], v[160:163]
ds_read_b64_tr_b16 a[72:73], v217 offset:136
ds_read_b64_tr_b16 a[74:75], v217 offset:4744
v_mfma_f32_16x16x32_bf16 v[160:163], a[84:87], a[208:211], v[160:163]
v_accvgpr_read_b32 v59, a145
v_lshlrev_b32 v40, 16, v41
v_mfma_f32_16x16x32_bf16 v[152:155], a[84:87], a[192:195], v[152:155]
buffer_load_dwordx4 a[104:107], v244, s[20:23], s66 offen offset:2048 sc0 sc1
v_mfma_f32_16x16x32_bf16 v[152:155], a[80:83], a[188:191], v[152:155]
v_and_b32 v41, 0xffff0000, v41
v_lshlrev_b32 v58, 16, v59
v_mfma_f32_16x16x32_bf16 v[144:147], a[80:83], a[172:175], v[144:147]
ds_read_b64_tr_b16 a[76:77], v217 offset:9352
ds_read_b64_tr_b16 a[78:79], v217 offset:13960
v_mfma_f32_16x16x32_bf16 v[144:147], a[84:87], a[176:179], v[144:147]
v_and_b32 v59, 0xffff0000, v59
v_add_f32 v40, v40, v58
v_mfma_f32_16x16x32_bf16 v[136:139], a[84:87], a[160:163], v[136:139]
buffer_load_dwordx4 a[120:123], v244, s[20:23], s67 offen offset:2048 sc0 sc1
v_mfma_f32_16x16x32_bf16 v[136:139], a[80:83], a[156:159], v[136:139]
v_add_f32 v41, v41, v59
v_cvt_pk_bf16_f32 v58, v40, v41
s_waitcnt lgkmcnt(8)
v_mfma_f32_16x16x32_bf16 v[140:143], a[88:91], a[156:159], v[140:143]
ds_read_b64_tr_b16 a[80:81], v218 offset:0
ds_read_b64_tr_b16 a[82:83], v218 offset:4608
v_mfma_f32_16x16x32_bf16 v[140:143], a[92:95], a[160:163], v[140:143]
v_lshlrev_b32 v40, 16, v58
v_and_b32 v41, 0xffff0000, v58
v_mfma_f32_16x16x32_bf16 v[148:151], a[92:95], a[176:179], v[148:151]
buffer_load_dwordx4 a[232:235], v244, s[20:23], s64 offen offset:3072 sc0 sc1
v_mfma_f32_16x16x32_bf16 v[148:151], a[88:91], a[172:175], v[148:151]
v_mul_f32 v58, 0xbfb8aa3b, v40
v_mul_f32 v59, 0xbfb8aa3b, v41
v_mfma_f32_16x16x32_bf16 v[156:159], a[88:91], a[188:191], v[156:159]
ds_read_b64_tr_b16 a[84:85], v218 offset:9216
ds_read_b64_tr_b16 a[86:87], v218 offset:13824
v_mfma_f32_16x16x32_bf16 v[156:159], a[92:95], a[192:195], v[156:159]
v_exp_f32 v58, v58
v_mfma_f32_16x16x32_bf16 v[164:167], a[92:95], a[208:211], v[164:167]
buffer_load_dwordx4 a[132:135], v244, s[20:23], s65 offen offset:3072 sc0 sc1
v_mfma_f32_16x16x32_bf16 v[164:167], a[88:91], a[204:207], v[164:167]
v_exp_f32 v59, v59
s_waitcnt lgkmcnt(8)
v_mfma_f32_16x16x32_bf16 v[192:195], a[64:67], a[204:207], v[192:195]
ds_read_b64_tr_b16 a[88:89], v216 offset:18432
ds_read_b64_tr_b16 a[90:91], v216 offset:23040
v_mfma_f32_16x16x32_bf16 v[192:195], a[68:71], a[208:211], v[192:195]
v_add_f32 v58, 1.0, v58
v_add_f32 v59, 1.0, v59
v_mfma_f32_16x16x32_bf16 v[184:187], a[68:71], a[192:195], v[184:187]
buffer_load_dwordx4 a[108:111], v244, s[20:23], s66 offen offset:3072 sc0 sc1
v_mfma_f32_16x16x32_bf16 v[184:187], a[64:67], a[188:191], v[184:187]
v_rcp_f32 v58, v58
v_mfma_f32_16x16x32_bf16 v[176:179], a[64:67], a[172:175], v[176:179]
ds_read_b64_tr_b16 a[92:93], v216 offset:27648
ds_read_b64_tr_b16 a[94:95], v216 offset:32256
v_mfma_f32_16x16x32_bf16 v[176:179], a[68:71], a[176:179], v[176:179]
v_rcp_f32 v59, v59
v_mfma_f32_16x16x32_bf16 v[168:171], a[68:71], a[160:163], v[168:171]
buffer_load_dwordx4 a[124:127], v244, s[20:23], s67 offen offset:3072 sc0 sc1
v_mfma_f32_16x16x32_bf16 v[168:171], a[64:67], a[156:159], v[168:171]
s_add_u32 s28, s33, 3
s_and_b32 s28, s28, 3
s_waitcnt lgkmcnt(8)
v_mfma_f32_16x16x32_bf16 v[172:175], a[72:75], a[156:159], v[172:175]
ds_read_b64_tr_b16 a[64:65], v216 offset:18440
ds_read_b64_tr_b16 a[66:67], v216 offset:23048
v_mfma_f32_16x16x32_bf16 v[172:175], a[76:79], a[160:163], v[172:175]
s_sub_u32 s28, s28, s33
s_lshl_b32 s28, s28, 16
v_mfma_f32_16x16x32_bf16 v[180:183], a[76:79], a[176:179], v[180:183]
s_add_u32 s64, s28, s44
s_add_u32 s65, s64, 4096
v_mfma_f32_16x16x32_bf16 v[180:183], a[72:75], a[172:175], v[180:183]
s_add_u32 s66, s64, 8192
s_add_u32 s67, s64, 12288
v_mfma_f32_16x16x32_bf16 v[188:191], a[72:75], a[188:191], v[188:191]
ds_read_b64_tr_b16 a[68:69], v216 offset:27656
ds_read_b64_tr_b16 a[70:71], v216 offset:32264
v_mfma_f32_16x16x32_bf16 v[188:191], a[76:79], a[192:195], v[188:191]
buffer_load_dwordx4 a[0:3], v244, s[20:23], s64 offen offset:0 sc0 sc1
v_mfma_f32_16x16x32_bf16 v[196:199], a[76:79], a[208:211], v[196:199]
v_mul_f32 v40, v40, v58
v_mul_f32 v41, v41, v59
v_mfma_f32_16x16x32_bf16 v[196:199], a[72:75], a[204:207], v[196:199]
v_cvt_pk_bf16_f32 v58, v40, v41
v_lshlrev_b32 v40, 16, v58
s_waitcnt lgkmcnt(8)
v_mfma_f32_16x16x32_bf16 v[212:215], a[80:83], a[204:207], v[212:215]
ds_read_b64_tr_b16 a[72:73], v217 offset:18432
ds_read_b64_tr_b16 a[74:75], v217 offset:23040
v_mfma_f32_16x16x32_bf16 v[212:215], a[84:87], a[208:211], v[212:215]
buffer_load_dwordx4 a[16:19], v244, s[20:23], s65 offen offset:0 sc0 sc1
v_mfma_f32_16x16x32_bf16 v[208:211], a[84:87], a[192:195], v[208:211]
v_and_b32 v41, 0xffff0000, v58
v_accvgpr_read_b32 v43, a138
v_mfma_f32_16x16x32_bf16 v[208:211], a[80:83], a[188:191], v[208:211]
v_accvgpr_read_b32 v59, a146
v_lshlrev_b32 v42, 16, v43
v_mfma_f32_16x16x32_bf16 v[204:207], a[80:83], a[172:175], v[204:207]
ds_read_b64_tr_b16 a[76:77], v217 offset:27648
ds_read_b64_tr_b16 a[78:79], v217 offset:32256
v_mfma_f32_16x16x32_bf16 v[204:207], a[84:87], a[176:179], v[204:207]
buffer_load_dwordx4 a[32:35], v244, s[20:23], s66 offen offset:0 sc0 sc1
v_mfma_f32_16x16x32_bf16 v[200:203], a[84:87], a[160:163], v[200:203]
v_and_b32 v43, 0xffff0000, v43
v_lshlrev_b32 v58, 16, v59
v_mfma_f32_16x16x32_bf16 v[200:203], a[80:83], a[156:159], v[200:203]
v_and_b32 v59, 0xffff0000, v59
v_add_f32 v42, v42, v58
s_waitcnt vmcnt(23)
s_waitcnt lgkmcnt(8)
v_mfma_f32_16x16x32_bf16 v[72:75], a[88:91], a[164:167], v[72:75]
ds_read_b64_tr_b16 a[80:81], v217 offset:18440
ds_read_b64_tr_b16 a[82:83], v217 offset:23048
s_waitcnt vmcnt(19)
v_mfma_f32_16x16x32_bf16 v[72:75], a[92:95], a[168:171], v[72:75]
buffer_load_dwordx4 a[48:51], v244, s[20:23], s67 offen offset:0 sc0 sc1
v_mfma_f32_16x16x32_bf16 v[80:83], a[92:95], a[184:187], v[80:83]
v_add_f32 v43, v43, v59
v_cvt_pk_bf16_f32 v58, v42, v43
v_mfma_f32_16x16x32_bf16 v[80:83], a[88:91], a[180:183], v[80:83]
v_lshlrev_b32 v42, 16, v58
v_and_b32 v43, 0xffff0000, v58
v_mfma_f32_16x16x32_bf16 v[88:91], a[88:91], a[196:199], v[88:91]
ds_read_b64_tr_b16 a[84:85], v217 offset:27656
ds_read_b64_tr_b16 a[86:87], v217 offset:32264
v_mfma_f32_16x16x32_bf16 v[88:91], a[92:95], a[200:203], v[88:91]
buffer_load_dwordx4 a[4:7], v244, s[20:23], s64 offen offset:1024 sc0 sc1
v_mfma_f32_16x16x32_bf16 v[96:99], a[92:95], a[216:219], v[96:99]
v_mul_f32 v58, 0xbfb8aa3b, v42
v_mul_f32 v59, 0xbfb8aa3b, v43
v_mfma_f32_16x16x32_bf16 v[96:99], a[88:91], a[212:215], v[96:99]
v_exp_f32 v58, v58
s_waitcnt lgkmcnt(8)
v_mfma_f32_16x16x32_bf16 v[100:103], a[64:67], a[212:215], v[100:103]
ds_read_b64_tr_b16 a[88:89], v216 offset:18560
ds_read_b64_tr_b16 a[90:91], v216 offset:23168
v_mfma_f32_16x16x32_bf16 v[100:103], a[68:71], a[216:219], v[100:103]
buffer_load_dwordx4 a[20:23], v244, s[20:23], s65 offen offset:1024 sc0 sc1
v_mfma_f32_16x16x32_bf16 v[92:95], a[68:71], a[200:203], v[92:95]
v_exp_f32 v59, v59
v_mfma_f32_16x16x32_bf16 v[92:95], a[64:67], a[196:199], v[92:95]
v_add_f32 v58, 1.0, v58
v_add_f32 v59, 1.0, v59
v_mfma_f32_16x16x32_bf16 v[84:87], a[64:67], a[180:183], v[84:87]
ds_read_b64_tr_b16 a[92:93], v216 offset:27776
ds_read_b64_tr_b16 a[94:95], v216 offset:32384
v_mfma_f32_16x16x32_bf16 v[84:87], a[68:71], a[184:187], v[84:87]
buffer_load_dwordx4 a[36:39], v244, s[20:23], s66 offen offset:1024 sc0 sc1
v_mfma_f32_16x16x32_bf16 v[76:79], a[68:71], a[168:171], v[76:79]
v_rcp_f32 v58, v58
v_mfma_f32_16x16x32_bf16 v[76:79], a[64:67], a[164:167], v[76:79]
v_rcp_f32 v59, v59
s_waitcnt lgkmcnt(8)
v_mfma_f32_16x16x32_bf16 v[104:107], a[72:75], a[164:167], v[104:107]
ds_read_b64_tr_b16 a[64:65], v216 offset:18568
ds_read_b64_tr_b16 a[66:67], v216 offset:23176
v_mfma_f32_16x16x32_bf16 v[104:107], a[76:79], a[168:171], v[104:107]
buffer_load_dwordx4 a[52:55], v244, s[20:23], s67 offen offset:1024 sc0 sc1
v_mfma_f32_16x16x32_bf16 v[112:115], a[76:79], a[184:187], v[112:115]
v_mul_f32 v42, v42, v58
v_mul_f32 v43, v43, v59
v_mfma_f32_16x16x32_bf16 v[112:115], a[72:75], a[180:183], v[112:115]
v_cvt_pk_bf16_f32 v58, v42, v43
v_lshlrev_b32 v42, 16, v58
v_mfma_f32_16x16x32_bf16 v[120:123], a[72:75], a[196:199], v[120:123]
ds_read_b64_tr_b16 a[68:69], v216 offset:27784
ds_read_b64_tr_b16 a[70:71], v216 offset:32392
v_mfma_f32_16x16x32_bf16 v[120:123], a[76:79], a[200:203], v[120:123]
buffer_load_dwordx4 a[8:11], v244, s[20:23], s64 offen offset:2048 sc0 sc1
v_mfma_f32_16x16x32_bf16 v[128:131], a[76:79], a[216:219], v[128:131]
v_and_b32 v43, 0xffff0000, v58
v_accvgpr_read_b32 v45, a139
v_mfma_f32_16x16x32_bf16 v[128:131], a[72:75], a[212:215], v[128:131]
v_accvgpr_read_b32 v59, a147
v_lshlrev_b32 v44, 16, v45
s_waitcnt lgkmcnt(8)
v_mfma_f32_16x16x32_bf16 v[132:135], a[80:83], a[212:215], v[132:135]
ds_read_b64_tr_b16 a[72:73], v217 offset:18560
ds_read_b64_tr_b16 a[74:75], v217 offset:23168
v_mfma_f32_16x16x32_bf16 v[132:135], a[84:87], a[216:219], v[132:135]
buffer_load_dwordx4 a[24:27], v244, s[20:23], s65 offen offset:2048 sc0 sc1
v_mfma_f32_16x16x32_bf16 v[124:127], a[84:87], a[200:203], v[124:127]
v_and_b32 v45, 0xffff0000, v45
v_lshlrev_b32 v58, 16, v59
v_mfma_f32_16x16x32_bf16 v[124:127], a[80:83], a[196:199], v[124:127]
v_and_b32 v59, 0xffff0000, v59
v_add_f32 v44, v44, v58
v_mfma_f32_16x16x32_bf16 v[116:119], a[80:83], a[180:183], v[116:119]
ds_read_b64_tr_b16 a[76:77], v217 offset:27776
ds_read_b64_tr_b16 a[78:79], v217 offset:32384
v_mfma_f32_16x16x32_bf16 v[116:119], a[84:87], a[184:187], v[116:119]
buffer_load_dwordx4 a[40:43], v244, s[20:23], s66 offen offset:2048 sc0 sc1
v_mfma_f32_16x16x32_bf16 v[108:111], a[84:87], a[168:171], v[108:111]
v_add_f32 v45, v45, v59
v_cvt_pk_bf16_f32 v58, v44, v45
v_mfma_f32_16x16x32_bf16 v[108:111], a[80:83], a[164:167], v[108:111]
v_lshlrev_b32 v44, 16, v58
v_and_b32 v45, 0xffff0000, v58
s_waitcnt lgkmcnt(8)
v_mfma_f32_16x16x32_bf16 v[136:139], a[88:91], a[164:167], v[136:139]
ds_read_b64_tr_b16 a[80:81], v217 offset:18568
ds_read_b64_tr_b16 a[82:83], v217 offset:23176
v_mfma_f32_16x16x32_bf16 v[136:139], a[92:95], a[168:171], v[136:139]
buffer_load_dwordx4 a[56:59], v244, s[20:23], s67 offen offset:2048 sc0 sc1
v_mfma_f32_16x16x32_bf16 v[144:147], a[92:95], a[184:187], v[144:147]
v_mul_f32 v58, 0xbfb8aa3b, v44
v_mul_f32 v59, 0xbfb8aa3b, v45
v_mfma_f32_16x16x32_bf16 v[144:147], a[88:91], a[180:183], v[144:147]
v_exp_f32 v58, v58
v_mfma_f32_16x16x32_bf16 v[152:155], a[88:91], a[196:199], v[152:155]
ds_read_b64_tr_b16 a[84:85], v217 offset:27784
ds_read_b64_tr_b16 a[86:87], v217 offset:32392
v_mfma_f32_16x16x32_bf16 v[152:155], a[92:95], a[200:203], v[152:155]
buffer_load_dwordx4 a[12:15], v244, s[20:23], s64 offen offset:3072 sc0 sc1
v_mfma_f32_16x16x32_bf16 v[160:163], a[92:95], a[216:219], v[160:163]
v_exp_f32 v59, v59
v_mfma_f32_16x16x32_bf16 v[160:163], a[88:91], a[212:215], v[160:163]
v_add_f32 v58, 1.0, v58
v_add_f32 v59, 1.0, v59
s_waitcnt lgkmcnt(8)
v_mfma_f32_16x16x32_bf16 v[164:167], a[64:67], a[212:215], v[164:167]
ds_read_b64_tr_b16 a[88:89], v218 offset:18432
ds_read_b64_tr_b16 a[90:91], v218 offset:23040
v_mfma_f32_16x16x32_bf16 v[164:167], a[68:71], a[216:219], v[164:167]
buffer_load_dwordx4 a[28:31], v244, s[20:23], s65 offen offset:3072 sc0 sc1
v_mfma_f32_16x16x32_bf16 v[156:159], a[68:71], a[200:203], v[156:159]
v_rcp_f32 v58, v58
v_mfma_f32_16x16x32_bf16 v[156:159], a[64:67], a[196:199], v[156:159]
v_rcp_f32 v59, v59
v_mfma_f32_16x16x32_bf16 v[148:151], a[64:67], a[180:183], v[148:151]
ds_read_b64_tr_b16 a[92:93], v218 offset:27648
ds_read_b64_tr_b16 a[94:95], v218 offset:32256
v_mfma_f32_16x16x32_bf16 v[148:151], a[68:71], a[184:187], v[148:151]
buffer_load_dwordx4 a[44:47], v244, s[20:23], s66 offen offset:3072 sc0 sc1
v_mfma_f32_16x16x32_bf16 v[140:143], a[68:71], a[168:171], v[140:143]
v_mul_f32 v44, v44, v58
v_mul_f32 v45, v45, v59
v_mfma_f32_16x16x32_bf16 v[140:143], a[64:67], a[164:167], v[140:143]
v_cvt_pk_bf16_f32 v58, v44, v45
v_lshlrev_b32 v44, 16, v58
s_waitcnt lgkmcnt(8)
v_mfma_f32_16x16x32_bf16 v[168:171], a[72:75], a[164:167], v[168:171]
ds_read_b64_tr_b16 a[64:65], v220 offset:0
ds_read_b64_tr_b16 a[66:67], v220 offset:4608
v_mfma_f32_16x16x32_bf16 v[168:171], a[76:79], a[168:171], v[168:171]
buffer_load_dwordx4 a[60:63], v244, s[20:23], s67 offen offset:3072 sc0 sc1
v_mfma_f32_16x16x32_bf16 v[176:179], a[76:79], a[184:187], v[176:179]
s_lshl2_add_u32 s28, s36, s33
s_lshl2_add_u32 s28, s28, s37
v_mfma_f32_16x16x32_bf16 v[176:179], a[72:75], a[180:183], v[176:179]
s_lshl_b32 s95, s28, 5
s_add_u32 s95, s95, 0x24a000
v_mfma_f32_16x16x32_bf16 v[184:187], a[72:75], a[196:199], v[184:187]
ds_read_b64_tr_b16 a[68:69], v220 offset:9216
ds_read_b64_tr_b16 a[70:71], v220 offset:13824
v_mfma_f32_16x16x32_bf16 v[184:187], a[76:79], a[200:203], v[184:187]
s_lshl_b32 s28, s32, 18
s_sub_u32 s49, s44, s28
v_mfma_f32_16x16x32_bf16 v[192:195], a[76:79], a[216:219], v[192:195]
v_add_u32 v243, 0x2000, v244
v_mov_b32 v246, 2
v_mfma_f32_16x16x32_bf16 v[192:195], a[72:75], a[212:215], v[192:195]
s_lshl2_add_u32 s29, s33, s94
v_and_b32 v45, 0xffff0000, v58
s_waitcnt lgkmcnt(8)
v_mfma_f32_16x16x32_bf16 v[196:199], a[80:83], a[212:215], v[196:199]
ds_read_b64_tr_b16 a[72:73], v220 offset:18432
ds_read_b64_tr_b16 a[74:75], v220 offset:23040
v_mfma_f32_16x16x32_bf16 v[196:199], a[84:87], a[216:219], v[196:199]
v_accvgpr_read_b32 v47, a140
v_accvgpr_read_b32 v59, a148
v_mfma_f32_16x16x32_bf16 v[188:191], a[84:87], a[200:203], v[188:191]
v_lshlrev_b32 v46, 16, v47
v_and_b32 v47, 0xffff0000, v47
v_mfma_f32_16x16x32_bf16 v[188:191], a[80:83], a[196:199], v[188:191]
v_lshlrev_b32 v58, 16, v59
v_and_b32 v59, 0xffff0000, v59
v_mfma_f32_16x16x32_bf16 v[180:183], a[80:83], a[180:183], v[180:183]
ds_read_b64_tr_b16 a[76:77], v220 offset:27648
ds_read_b64_tr_b16 a[78:79], v220 offset:32256
v_mfma_f32_16x16x32_bf16 v[180:183], a[84:87], a[184:187], v[180:183]
v_add_f32 v46, v46, v58
v_add_f32 v47, v47, v59
v_mfma_f32_16x16x32_bf16 v[172:175], a[84:87], a[168:171], v[172:175]
v_cvt_pk_bf16_f32 v58, v46, v47
v_lshlrev_b32 v46, 16, v58
v_mfma_f32_16x16x32_bf16 v[172:175], a[80:83], a[164:167], v[172:175]
v_and_b32 v47, 0xffff0000, v58
v_mul_f32 v58, 0xbfb8aa3b, v46
s_waitcnt lgkmcnt(8)
v_mfma_f32_16x16x32_bf16 v[200:203], a[88:91], a[164:167], v[200:203]
ds_read_b64_tr_b16 a[80:81], v223 offset:0
ds_read_b64_tr_b16 a[82:83], v223 offset:4608
v_mfma_f32_16x16x32_bf16 v[200:203], a[92:95], a[168:171], v[200:203]
v_mul_f32 v59, 0xbfb8aa3b, v47
v_mfma_f32_16x16x32_bf16 v[204:207], a[92:95], a[184:187], v[204:207]
v_exp_f32 v58, v58
v_mfma_f32_16x16x32_bf16 v[204:207], a[88:91], a[180:183], v[204:207]
v_exp_f32 v59, v59
v_mfma_f32_16x16x32_bf16 v[208:211], a[88:91], a[196:199], v[208:211]
ds_read_b64_tr_b16 a[84:85], v223 offset:9216
ds_read_b64_tr_b16 a[86:87], v223 offset:13824
v_mfma_f32_16x16x32_bf16 v[208:211], a[92:95], a[200:203], v[208:211]
v_add_f32 v58, 1.0, v58
v_add_f32 v59, 1.0, v59
v_mfma_f32_16x16x32_bf16 v[212:215], a[92:95], a[216:219], v[212:215]
v_rcp_f32 v58, v58
v_mfma_f32_16x16x32_bf16 v[212:215], a[88:91], a[212:215], v[212:215]
v_rcp_f32 v59, v59
s_waitcnt vmcnt(28)
s_waitcnt lgkmcnt(8)
v_mfma_f32_16x16x32_bf16 v[128:131], a[64:67], a[112:115], v[128:131]
ds_read_b64_tr_b16 a[88:89], v223 offset:18432
ds_read_b64_tr_b16 a[90:91], v223 offset:23040
s_waitcnt vmcnt(24)
v_mfma_f32_16x16x32_bf16 v[128:131], a[68:71], a[116:119], v[128:131]
v_mul_f32 v46, v46, v58
v_mul_f32 v47, v47, v59
v_mfma_f32_16x16x32_bf16 v[120:123], a[68:71], a[100:103], v[120:123]
v_cvt_pk_bf16_f32 v58, v46, v47
v_lshlrev_b32 v46, 16, v58
v_mfma_f32_16x16x32_bf16 v[120:123], a[64:67], a[96:99], v[120:123]
v_and_b32 v47, 0xffff0000, v58
v_accvgpr_read_b32 v49, a141
v_mfma_f32_16x16x32_bf16 v[112:115], a[64:67], a[236:239], v[112:115]
ds_read_b64_tr_b16 a[92:93], v223 offset:27648
ds_read_b64_tr_b16 a[94:95], v223 offset:32256
v_mfma_f32_16x16x32_bf16 v[112:115], a[68:71], a[240:243], v[112:115]
v_accvgpr_read_b32 v59, a149
v_lshlrev_b32 v48, 16, v49
v_mfma_f32_16x16x32_bf16 v[104:107], a[68:71], a[224:227], v[104:107]
v_and_b32 v49, 0xffff0000, v49
v_lshlrev_b32 v58, 16, v59
v_mfma_f32_16x16x32_bf16 v[104:107], a[64:67], a[220:223], v[104:107]
s_waitcnt vmcnt(0)
buffer_store_dword v246, v254, s[20:23], s29 offen
s_waitcnt vmcnt(21)
s_waitcnt lgkmcnt(8)
v_mfma_f32_16x16x32_bf16 v[104:107], a[72:75], a[228:231], v[104:107]
ds_read_b64_tr_b16 a[64:65], v220 offset:8
ds_read_b64_tr_b16 a[66:67], v220 offset:4616
s_waitcnt vmcnt(17)
v_mfma_f32_16x16x32_bf16 v[104:107], a[76:79], a[232:235], v[104:107]
s_xor_b32 s28, s32, 0
s_sub_u32 s29, s32, s28
v_mfma_f32_16x16x32_bf16 v[112:115], a[76:79], a[132:135], v[112:115]
s_lshl_b32 s28, s28, 18
s_and_b32 s29, s29, 3
v_mfma_f32_16x16x32_bf16 v[112:115], a[72:75], a[128:131], v[112:115]
s_add_u32 s28, s28, s49
s_lshl_b32 s50, s29, 10
v_mfma_f32_16x16x32_bf16 v[120:123], a[72:75], a[104:107], v[120:123]
ds_read_b64_tr_b16 a[68:69], v220 offset:9224
ds_read_b64_tr_b16 a[70:71], v220 offset:13832
v_mfma_f32_16x16x32_bf16 v[120:123], a[76:79], a[108:111], v[120:123]
s_mul_i32 s29, s29, 0x1200
s_and_b32 s29, s29, 0x2200
v_mfma_f32_16x16x32_bf16 v[128:131], a[76:79], a[124:127], v[128:131]
s_add_u32 s72, s28, s29
v_and_b32 v59, 0xffff0000, v59
v_mfma_f32_16x16x32_bf16 v[128:131], a[72:75], a[120:123], v[128:131]
s_xor_b32 s28, s32, 1
s_sub_u32 s29, s32, s28
s_waitcnt vmcnt(13)
s_waitcnt lgkmcnt(8)
v_mfma_f32_16x16x32_bf16 v[128:131], a[80:83], a[48:51], v[128:131]
ds_read_b64_tr_b16 a[72:73], v220 offset:18440
ds_read_b64_tr_b16 a[74:75], v220 offset:23048
s_waitcnt vmcnt(9)
v_mfma_f32_16x16x32_bf16 v[128:131], a[84:87], a[52:55], v[128:131]
s_lshl_b32 s28, s28, 18
s_and_b32 s29, s29, 3
v_mfma_f32_16x16x32_bf16 v[120:123], a[84:87], a[36:39], v[120:123]
s_add_u32 s28, s28, s49
s_lshl_b32 s50, s29, 10
v_mfma_f32_16x16x32_bf16 v[120:123], a[80:83], a[32:35], v[120:123]
s_add_u32 s65, s28, s50
v_add_f32 v48, v48, v58
v_mfma_f32_16x16x32_bf16 v[112:115], a[80:83], a[16:19], v[112:115]
ds_read_b64_tr_b16 a[76:77], v220 offset:27656
ds_read_b64_tr_b16 a[78:79], v220 offset:32264
v_mfma_f32_16x16x32_bf16 v[112:115], a[84:87], a[20:23], v[112:115]
s_mul_i32 s29, s29, 0x1200
s_and_b32 s29, s29, 0x2200
v_mfma_f32_16x16x32_bf16 v[104:107], a[84:87], a[4:7], v[104:107]
s_add_u32 s73, s28, s29
v_add_f32 v49, v49, v59
v_mfma_f32_16x16x32_bf16 v[104:107], a[80:83], a[0:3], v[104:107]
s_xor_b32 s28, s32, 2
s_sub_u32 s29, s32, s28
s_waitcnt vmcnt(5)
s_waitcnt lgkmcnt(8)
v_mfma_f32_16x16x32_bf16 v[104:107], a[88:91], a[8:11], v[104:107]
ds_read_b64_tr_b16 a[80:81], v223 offset:8
ds_read_b64_tr_b16 a[82:83], v223 offset:4616
s_waitcnt vmcnt(1)
v_mfma_f32_16x16x32_bf16 v[104:107], a[92:95], a[12:15], v[104:107]
s_lshl_b32 s28, s28, 18
s_and_b32 s29, s29, 3
v_mfma_f32_16x16x32_bf16 v[112:115], a[92:95], a[28:31], v[112:115]
s_add_u32 s28, s28, s49
s_lshl_b32 s50, s29, 10
v_mfma_f32_16x16x32_bf16 v[112:115], a[88:91], a[24:27], v[112:115]
s_add_u32 s66, s28, s50
v_cvt_pk_bf16_f32 v58, v48, v49
v_mfma_f32_16x16x32_bf16 v[120:123], a[88:91], a[40:43], v[120:123]
ds_read_b64_tr_b16 a[84:85], v223 offset:9224
ds_read_b64_tr_b16 a[86:87], v223 offset:13832
v_mfma_f32_16x16x32_bf16 v[120:123], a[92:95], a[44:47], v[120:123]
s_mul_i32 s29, s29, 0x1200
s_and_b32 s29, s29, 0x2200
v_mfma_f32_16x16x32_bf16 v[128:131], a[92:95], a[60:63], v[128:131]
s_add_u32 s74, s28, s29
v_lshlrev_b32 v48, 16, v58
v_mfma_f32_16x16x32_bf16 v[128:131], a[88:91], a[56:59], v[128:131]
s_xor_b32 s28, s32, 3
s_sub_u32 s29, s32, s28
s_waitcnt lgkmcnt(8)
v_mfma_f32_16x16x32_bf16 v[132:135], a[64:67], a[112:115], v[132:135]
ds_read_b64_tr_b16 a[88:89], v223 offset:18440
ds_read_b64_tr_b16 a[90:91], v223 offset:23048
v_mfma_f32_16x16x32_bf16 v[132:135], a[68:71], a[116:119], v[132:135]
s_lshl_b32 s28, s28, 18
s_and_b32 s29, s29, 3
v_mfma_f32_16x16x32_bf16 v[124:127], a[68:71], a[100:103], v[124:127]
s_add_u32 s28, s28, s49
s_lshl_b32 s50, s29, 10
v_mfma_f32_16x16x32_bf16 v[124:127], a[64:67], a[96:99], v[124:127]
s_add_u32 s67, s28, s50
v_and_b32 v49, 0xffff0000, v58
v_mfma_f32_16x16x32_bf16 v[116:119], a[64:67], a[236:239], v[116:119]
ds_read_b64_tr_b16 a[92:93], v223 offset:27656
ds_read_b64_tr_b16 a[94:95], v223 offset:32264
v_mfma_f32_16x16x32_bf16 v[116:119], a[68:71], a[240:243], v[116:119]
s_mul_i32 s29, s29, 0x1200
s_and_b32 s29, s29, 0x2200
v_mfma_f32_16x16x32_bf16 v[108:111], a[68:71], a[224:227], v[108:111]
s_add_u32 s75, s28, s29
v_mul_f32 v58, 0xbfb8aa3b, v48
v_mfma_f32_16x16x32_bf16 v[108:111], a[64:67], a[220:223], v[108:111]
buffer_load_dword v230, v229, s[20:23], s94 offen sc0 sc1
s_waitcnt lgkmcnt(8)
v_mfma_f32_16x16x32_bf16 v[108:111], a[72:75], a[228:231], v[108:111]
ds_read_b64_tr_b16 a[64:65], v220 offset:128
ds_read_b64_tr_b16 a[66:67], v220 offset:4736
v_mfma_f32_16x16x32_bf16 v[108:111], a[76:79], a[232:235], v[108:111]
s_xor_b32 s28, s32, 4
s_sub_u32 s29, s32, s28
v_mfma_f32_16x16x32_bf16 v[116:119], a[76:79], a[132:135], v[116:119]
s_lshl_b32 s28, s28, 18
s_and_b32 s29, s29, 3
v_mfma_f32_16x16x32_bf16 v[116:119], a[72:75], a[128:131], v[116:119]
s_add_u32 s28, s28, s49
s_lshl_b32 s50, s29, 10
v_mfma_f32_16x16x32_bf16 v[124:127], a[72:75], a[104:107], v[124:127]
ds_read_b64_tr_b16 a[68:69], v220 offset:9344
ds_read_b64_tr_b16 a[70:71], v220 offset:13952
v_mfma_f32_16x16x32_bf16 v[124:127], a[76:79], a[108:111], v[124:127]
s_add_u32 s68, s28, s50
s_add_u32 s68, s68, 4096
v_mfma_f32_16x16x32_bf16 v[132:135], a[76:79], a[124:127], v[132:135]
s_mul_i32 s29, s29, 0x1200
s_and_b32 s29, s29, 0x2200
v_mfma_f32_16x16x32_bf16 v[132:135], a[72:75], a[120:123], v[132:135]
s_add_u32 s84, s28, s29
v_mul_f32 v59, 0xbfb8aa3b, v49
s_waitcnt lgkmcnt(8)
v_mfma_f32_16x16x32_bf16 v[132:135], a[80:83], a[48:51], v[132:135]
ds_read_b64_tr_b16 a[72:73], v220 offset:18560
ds_read_b64_tr_b16 a[74:75], v220 offset:23168
v_mfma_f32_16x16x32_bf16 v[132:135], a[84:87], a[52:55], v[132:135]
s_xor_b32 s28, s32, 5
s_sub_u32 s29, s32, s28
v_mfma_f32_16x16x32_bf16 v[124:127], a[84:87], a[36:39], v[124:127]
s_lshl_b32 s28, s28, 18
s_and_b32 s29, s29, 3
v_mfma_f32_16x16x32_bf16 v[124:127], a[80:83], a[32:35], v[124:127]
s_add_u32 s28, s28, s49
s_lshl_b32 s50, s29, 10
v_mfma_f32_16x16x32_bf16 v[116:119], a[80:83], a[16:19], v[116:119]
ds_read_b64_tr_b16 a[76:77], v220 offset:27776
ds_read_b64_tr_b16 a[78:79], v220 offset:32384
v_mfma_f32_16x16x32_bf16 v[116:119], a[84:87], a[20:23], v[116:119]
s_add_u32 s69, s28, s50
s_add_u32 s69, s69, 4096
v_mfma_f32_16x16x32_bf16 v[108:111], a[84:87], a[4:7], v[108:111]
s_mul_i32 s29, s29, 0x1200
s_and_b32 s29, s29, 0x2200
v_mfma_f32_16x16x32_bf16 v[108:111], a[80:83], a[0:3], v[108:111]
s_add_u32 s85, s28, s29
s_waitcnt lgkmcnt(8)
v_mfma_f32_16x16x32_bf16 v[108:111], a[88:91], a[8:11], v[108:111]
ds_read_b64_tr_b16 a[80:81], v223 offset:128
ds_read_b64_tr_b16 a[82:83], v223 offset:4736
v_mfma_f32_16x16x32_bf16 v[108:111], a[92:95], a[12:15], v[108:111]
STUB_15:
STUB_B3:
s_cbranch_execz STUB_18
s_xor_b32 s28, s32, 6
s_sub_u32 s29, s32, s28
v_mfma_f32_16x16x32_bf16 v[116:119], a[92:95], a[28:31], v[116:119]
s_lshl_b32 s28, s28, 18
s_and_b32 s29, s29, 3
v_mfma_f32_16x16x32_bf16 v[116:119], a[88:91], a[24:27], v[116:119]
s_add_u32 s28, s28, s49
s_lshl_b32 s50, s29, 10
v_mfma_f32_16x16x32_bf16 v[124:127], a[88:91], a[40:43], v[124:127]
ds_read_b64_tr_b16 a[84:85], v223 offset:9344
ds_read_b64_tr_b16 a[86:87], v223 offset:13952
v_mfma_f32_16x16x32_bf16 v[124:127], a[92:95], a[44:47], v[124:127]
s_add_u32 s70, s28, s50
s_add_u32 s70, s70, 4096
v_mfma_f32_16x16x32_bf16 v[132:135], a[92:95], a[60:63], v[132:135]
s_mul_i32 s29, s29, 0x1200
s_and_b32 s29, s29, 0x2200
v_mfma_f32_16x16x32_bf16 v[132:135], a[88:91], a[56:59], v[132:135]
s_add_u32 s86, s28, s29
s_waitcnt lgkmcnt(8)
v_mfma_f32_16x16x32_bf16 v[192:195], a[64:67], a[112:115], v[192:195]
ds_read_b64_tr_b16 a[88:89], v223 offset:18560
ds_read_b64_tr_b16 a[90:91], v223 offset:23168
v_mfma_f32_16x16x32_bf16 v[192:195], a[68:71], a[116:119], v[192:195]
s_xor_b32 s28, s32, 7
s_sub_u32 s29, s32, s28
v_mfma_f32_16x16x32_bf16 v[184:187], a[68:71], a[100:103], v[184:187]
s_lshl_b32 s28, s28, 18
s_and_b32 s29, s29, 3
v_mfma_f32_16x16x32_bf16 v[184:187], a[64:67], a[96:99], v[184:187]
s_add_u32 s28, s28, s49
s_lshl_b32 s50, s29, 10
v_mfma_f32_16x16x32_bf16 v[176:179], a[64:67], a[236:239], v[176:179]
ds_read_b64_tr_b16 a[92:93], v223 offset:27776
ds_read_b64_tr_b16 a[94:95], v223 offset:32384
v_mfma_f32_16x16x32_bf16 v[176:179], a[68:71], a[240:243], v[176:179]
s_add_u32 s71, s28, s50
s_add_u32 s71, s71, 4096
v_mfma_f32_16x16x32_bf16 v[168:171], a[68:71], a[224:227], v[168:171]
s_mul_i32 s29, s29, 0x1200
s_and_b32 s29, s29, 0x2200
v_mfma_f32_16x16x32_bf16 v[168:171], a[64:67], a[220:223], v[168:171]
s_add_u32 s87, s28, s29
s_waitcnt lgkmcnt(8)
v_mfma_f32_16x16x32_bf16 v[168:171], a[72:75], a[228:231], v[168:171]
ds_read_b64_tr_b16 a[64:65], v220 offset:136
ds_read_b64_tr_b16 a[66:67], v220 offset:4744
v_mfma_f32_16x16x32_bf16 v[168:171], a[76:79], a[232:235], v[168:171]
s_waitcnt vmcnt(0)
v_cmp_gt_u32 vcc, 2, v230
v_mfma_f32_16x16x32_bf16 v[176:179], a[76:79], a[132:135], v[176:179]
v_exp_f32 v58, v58
v_mfma_f32_16x16x32_bf16 v[176:179], a[72:75], a[128:131], v[176:179]
s_and_b32 s29, vcc_lo, 15
s_cbranch_scc1 SP_O3A
SP_O3A_RET:
v_mfma_f32_16x16x32_bf16 v[184:187], a[72:75], a[104:107], v[184:187]
ds_read_b64_tr_b16 a[68:69], v220 offset:9352
ds_read_b64_tr_b16 a[70:71], v220 offset:13960
v_mfma_f32_16x16x32_bf16 v[184:187], a[76:79], a[108:111], v[184:187]
s_add_u32 s39, s44, 4096
v_mfma_f32_16x16x32_bf16 v[192:195], a[76:79], a[124:127], v[192:195]
v_cvt_pk_bf16_f32 v104, v104, v105
v_cvt_pk_bf16_f32 v105, v106, v107
v_mfma_f32_16x16x32_bf16 v[192:195], a[72:75], a[120:123], v[192:195]
v_cvt_pk_bf16_f32 v106, v108, v109
v_cvt_pk_bf16_f32 v107, v110, v111
s_waitcnt lgkmcnt(8)
v_mfma_f32_16x16x32_bf16 v[192:195], a[80:83], a[48:51], v[192:195]
ds_read_b64_tr_b16 a[72:73], v220 offset:18568
ds_read_b64_tr_b16 a[74:75], v220 offset:23176
v_mfma_f32_16x16x32_bf16 v[192:195], a[84:87], a[52:55], v[192:195]
buffer_store_dwordx4 v[104:107], v244, s[20:23], s39 offen offset:0
v_mfma_f32_16x16x32_bf16 v[184:187], a[84:87], a[36:39], v[184:187]
v_cvt_pk_bf16_f32 v112, v112, v113
v_cvt_pk_bf16_f32 v113, v114, v115
v_mfma_f32_16x16x32_bf16 v[184:187], a[80:83], a[32:35], v[184:187]
v_cvt_pk_bf16_f32 v114, v116, v117
v_cvt_pk_bf16_f32 v115, v118, v119
v_mfma_f32_16x16x32_bf16 v[176:179], a[80:83], a[16:19], v[176:179]
ds_read_b64_tr_b16 a[76:77], v220 offset:27784
ds_read_b64_tr_b16 a[78:79], v220 offset:32392
v_mfma_f32_16x16x32_bf16 v[176:179], a[84:87], a[20:23], v[176:179]
buffer_store_dwordx4 v[112:115], v244, s[20:23], s39 offen offset:1024
v_mfma_f32_16x16x32_bf16 v[168:171], a[84:87], a[4:7], v[168:171]
v_cvt_pk_bf16_f32 v120, v120, v121
v_cvt_pk_bf16_f32 v121, v122, v123
v_mfma_f32_16x16x32_bf16 v[168:171], a[80:83], a[0:3], v[168:171]
v_cvt_pk_bf16_f32 v122, v124, v125
v_cvt_pk_bf16_f32 v123, v126, v127
s_waitcnt lgkmcnt(8)
v_mfma_f32_16x16x32_bf16 v[168:171], a[88:91], a[8:11], v[168:171]
ds_read_b64_tr_b16 a[80:81], v223 offset:136
ds_read_b64_tr_b16 a[82:83], v223 offset:4744
v_mfma_f32_16x16x32_bf16 v[168:171], a[92:95], a[12:15], v[168:171]
buffer_store_dwordx4 v[120:123], v244, s[20:23], s39 offen offset:2048
v_mfma_f32_16x16x32_bf16 v[176:179], a[92:95], a[28:31], v[176:179]
v_cvt_pk_bf16_f32 v128, v128, v129
v_cvt_pk_bf16_f32 v129, v130, v131
v_mfma_f32_16x16x32_bf16 v[176:179], a[88:91], a[24:27], v[176:179]
v_cvt_pk_bf16_f32 v130, v132, v133
v_cvt_pk_bf16_f32 v131, v134, v135
v_mfma_f32_16x16x32_bf16 v[184:187], a[88:91], a[40:43], v[184:187]
ds_read_b64_tr_b16 a[84:85], v223 offset:9352
ds_read_b64_tr_b16 a[86:87], v223 offset:13960
v_mfma_f32_16x16x32_bf16 v[184:187], a[92:95], a[44:47], v[184:187]
buffer_store_dwordx4 v[128:131], v244, s[20:23], s39 offen offset:3072
v_mfma_f32_16x16x32_bf16 v[192:195], a[92:95], a[60:63], v[192:195]
v_exp_f32 v59, v59
v_mfma_f32_16x16x32_bf16 v[192:195], a[88:91], a[56:59], v[192:195]
v_add_f32 v58, 1.0, v58
v_add_f32 v59, 1.0, v59
s_waitcnt lgkmcnt(8)
v_mfma_f32_16x16x32_bf16 v[196:199], a[64:67], a[112:115], v[196:199]
ds_read_b64_tr_b16 a[88:89], v223 offset:18568
ds_read_b64_tr_b16 a[90:91], v223 offset:23176
v_mfma_f32_16x16x32_bf16 v[196:199], a[68:71], a[116:119], v[196:199]
v_rcp_f32 v58, v58
v_mfma_f32_16x16x32_bf16 v[188:191], a[68:71], a[100:103], v[188:191]
v_rcp_f32 v59, v59
v_mfma_f32_16x16x32_bf16 v[188:191], a[64:67], a[96:99], v[188:191]
v_mul_f32 v48, v48, v58
v_mul_f32 v49, v49, v59
v_mfma_f32_16x16x32_bf16 v[180:183], a[64:67], a[236:239], v[180:183]
ds_read_b64_tr_b16 a[92:93], v223 offset:27784
ds_read_b64_tr_b16 a[94:95], v223 offset:32392
v_mfma_f32_16x16x32_bf16 v[180:183], a[68:71], a[240:243], v[180:183]
v_cvt_pk_bf16_f32 v58, v48, v49
v_lshlrev_b32 v48, 16, v58
v_mfma_f32_16x16x32_bf16 v[172:175], a[68:71], a[224:227], v[172:175]
v_and_b32 v49, 0xffff0000, v58
v_accvgpr_read_b32 v51, a142
v_mfma_f32_16x16x32_bf16 v[172:175], a[64:67], a[220:223], v[172:175]
v_accvgpr_read_b32 v59, a150
v_lshlrev_b32 v50, 16, v51
s_waitcnt lgkmcnt(8)
v_mfma_f32_16x16x32_bf16 v[172:175], a[72:75], a[228:231], v[172:175]
ds_read_b64_tr_b16 a[64:65], v221 offset:0
ds_read_b64_tr_b16 a[66:67], v221 offset:4608
v_mfma_f32_16x16x32_bf16 v[172:175], a[76:79], a[232:235], v[172:175]
v_and_b32 v51, 0xffff0000, v51
v_lshlrev_b32 v58, 16, v59
v_mfma_f32_16x16x32_bf16 v[180:183], a[76:79], a[132:135], v[180:183]
v_and_b32 v59, 0xffff0000, v59
v_add_f32 v50, v50, v58
v_mfma_f32_16x16x32_bf16 v[180:183], a[72:75], a[128:131], v[180:183]
v_add_f32 v51, v51, v59
v_cvt_pk_bf16_f32 v58, v50, v51
v_mfma_f32_16x16x32_bf16 v[188:191], a[72:75], a[104:107], v[188:191]
ds_read_b64_tr_b16 a[68:69], v221 offset:9216
ds_read_b64_tr_b16 a[70:71], v221 offset:13824
v_mfma_f32_16x16x32_bf16 v[188:191], a[76:79], a[108:111], v[188:191]
v_lshlrev_b32 v50, 16, v58
v_and_b32 v51, 0xffff0000, v58
v_mfma_f32_16x16x32_bf16 v[196:199], a[76:79], a[124:127], v[196:199]
v_mul_f32 v58, 0xbfb8aa3b, v50
v_mul_f32 v59, 0xbfb8aa3b, v51
v_mfma_f32_16x16x32_bf16 v[196:199], a[72:75], a[120:123], v[196:199]
v_exp_f32 v58, v58
s_waitcnt lgkmcnt(8)
v_mfma_f32_16x16x32_bf16 v[196:199], a[80:83], a[48:51], v[196:199]
ds_read_b64_tr_b16 a[72:73], v221 offset:18432
ds_read_b64_tr_b16 a[74:75], v221 offset:23040
v_mfma_f32_16x16x32_bf16 v[196:199], a[84:87], a[52:55], v[196:199]
v_exp_f32 v59, v59
v_mfma_f32_16x16x32_bf16 v[188:191], a[84:87], a[36:39], v[188:191]
v_add_f32 v58, 1.0, v58
v_add_f32 v59, 1.0, v59
v_mfma_f32_16x16x32_bf16 v[188:191], a[80:83], a[32:35], v[188:191]
v_rcp_f32 v58, v58
v_mfma_f32_16x16x32_bf16 v[180:183], a[80:83], a[16:19], v[180:183]
ds_read_b64_tr_b16 a[76:77], v221 offset:27648
ds_read_b64_tr_b16 a[78:79], v221 offset:32256
v_mfma_f32_16x16x32_bf16 v[180:183], a[84:87], a[20:23], v[180:183]
v_rcp_f32 v59, v59
v_mfma_f32_16x16x32_bf16 v[172:175], a[84:87], a[4:7], v[172:175]
v_mul_f32 v50, v50, v58
v_mul_f32 v51, v51, v59
v_mfma_f32_16x16x32_bf16 v[172:175], a[80:83], a[0:3], v[172:175]
v_cvt_pk_bf16_f32 v58, v50, v51
v_lshlrev_b32 v50, 16, v58
s_waitcnt lgkmcnt(8)
v_mfma_f32_16x16x32_bf16 v[172:175], a[88:91], a[8:11], v[172:175]
ds_read_b64_tr_b16 a[80:81], v224 offset:0
ds_read_b64_tr_b16 a[82:83], v224 offset:4608
v_mfma_f32_16x16x32_bf16 v[172:175], a[92:95], a[12:15], v[172:175]
v_and_b32 v51, 0xffff0000, v58
v_accvgpr_read_b32 v53, a143
v_mfma_f32_16x16x32_bf16 v[180:183], a[92:95], a[28:31], v[180:183]
v_accvgpr_read_b32 v59, a151
v_lshlrev_b32 v52, 16, v53
v_mfma_f32_16x16x32_bf16 v[180:183], a[88:91], a[24:27], v[180:183]
v_and_b32 v53, 0xffff0000, v53
v_lshlrev_b32 v58, 16, v59
v_mfma_f32_16x16x32_bf16 v[188:191], a[88:91], a[40:43], v[188:191]
ds_read_b64_tr_b16 a[84:85], v224 offset:9216
ds_read_b64_tr_b16 a[86:87], v224 offset:13824
v_mfma_f32_16x16x32_bf16 v[188:191], a[92:95], a[44:47], v[188:191]
v_and_b32 v59, 0xffff0000, v59
v_add_f32 v52, v52, v58
v_mfma_f32_16x16x32_bf16 v[196:199], a[92:95], a[60:63], v[196:199]
v_add_f32 v53, v53, v59
v_cvt_pk_bf16_f32 v58, v52, v53
v_mfma_f32_16x16x32_bf16 v[196:199], a[88:91], a[56:59], v[196:199]
v_lshlrev_b32 v52, 16, v58
v_and_b32 v53, 0xffff0000, v58
s_waitcnt lgkmcnt(8)
v_mfma_f32_16x16x32_bf16 v[212:215], a[64:67], a[112:115], v[212:215]
ds_read_b64_tr_b16 a[88:89], v224 offset:18432
ds_read_b64_tr_b16 a[90:91], v224 offset:23040
v_mfma_f32_16x16x32_bf16 v[212:215], a[68:71], a[116:119], v[212:215]
v_mul_f32 v58, 0xbfb8aa3b, v52
v_mul_f32 v59, 0xbfb8aa3b, v53
v_mfma_f32_16x16x32_bf16 v[208:211], a[68:71], a[100:103], v[208:211]
v_exp_f32 v58, v58
v_mfma_f32_16x16x32_bf16 v[208:211], a[64:67], a[96:99], v[208:211]
v_exp_f32 v59, v59
v_mfma_f32_16x16x32_bf16 v[204:207], a[64:67], a[236:239], v[204:207]
ds_read_b64_tr_b16 a[92:93], v224 offset:27648
ds_read_b64_tr_b16 a[94:95], v224 offset:32256
v_mfma_f32_16x16x32_bf16 v[204:207], a[68:71], a[240:243], v[204:207]
v_add_f32 v58, 1.0, v58
v_add_f32 v59, 1.0, v59
v_mfma_f32_16x16x32_bf16 v[200:203], a[68:71], a[224:227], v[200:203]
v_rcp_f32 v58, v58
v_mfma_f32_16x16x32_bf16 v[200:203], a[64:67], a[220:223], v[200:203]
v_rcp_f32 v59, v59
s_waitcnt lgkmcnt(8)
v_mfma_f32_16x16x32_bf16 v[200:203], a[72:75], a[228:231], v[200:203]
ds_read_b64_tr_b16 a[64:65], v219 offset:0
ds_read_b64_tr_b16 a[66:67], v219 offset:4608
v_mfma_f32_16x16x32_bf16 v[200:203], a[76:79], a[232:235], v[200:203]
s_add_u32 s39, s44, 12288
v_mul_f32 v52, v52, v58
v_mfma_f32_16x16x32_bf16 v[204:207], a[76:79], a[132:135], v[204:207]
v_cvt_pk_bf16_f32 v168, v168, v169
v_cvt_pk_bf16_f32 v169, v170, v171
v_mfma_f32_16x16x32_bf16 v[204:207], a[72:75], a[128:131], v[204:207]
v_cvt_pk_bf16_f32 v170, v172, v173
v_cvt_pk_bf16_f32 v171, v174, v175
v_mfma_f32_16x16x32_bf16 v[208:211], a[72:75], a[104:107], v[208:211]
ds_read_b64_tr_b16 a[68:69], v219 offset:9216
ds_read_b64_tr_b16 a[70:71], v219 offset:13824
v_mfma_f32_16x16x32_bf16 v[208:211], a[76:79], a[108:111], v[208:211]
buffer_store_dwordx4 v[168:171], v244, s[20:23], s39 offen offset:0
v_mfma_f32_16x16x32_bf16 v[212:215], a[76:79], a[124:127], v[212:215]
v_cvt_pk_bf16_f32 v176, v176, v177
v_cvt_pk_bf16_f32 v177, v178, v179
v_mfma_f32_16x16x32_bf16 v[212:215], a[72:75], a[120:123], v[212:215]
v_cvt_pk_bf16_f32 v178, v180, v181
v_cvt_pk_bf16_f32 v179, v182, v183
s_waitcnt lgkmcnt(8)
v_mfma_f32_16x16x32_bf16 v[212:215], a[80:83], a[48:51], v[212:215]
ds_read_b64_tr_b16 a[72:73], v219 offset:18432
ds_read_b64_tr_b16 a[74:75], v219 offset:23040
v_mfma_f32_16x16x32_bf16 v[212:215], a[84:87], a[52:55], v[212:215]
buffer_store_dwordx4 v[176:179], v244, s[20:23], s39 offen offset:1024
v_mfma_f32_16x16x32_bf16 v[208:211], a[84:87], a[36:39], v[208:211]
v_cvt_pk_bf16_f32 v184, v184, v185
v_cvt_pk_bf16_f32 v185, v186, v187
v_mfma_f32_16x16x32_bf16 v[208:211], a[80:83], a[32:35], v[208:211]
v_cvt_pk_bf16_f32 v186, v188, v189
v_cvt_pk_bf16_f32 v187, v190, v191
v_mfma_f32_16x16x32_bf16 v[204:207], a[80:83], a[16:19], v[204:207]
ds_read_b64_tr_b16 a[76:77], v219 offset:27648
ds_read_b64_tr_b16 a[78:79], v219 offset:32256
v_mfma_f32_16x16x32_bf16 v[204:207], a[84:87], a[20:23], v[204:207]
buffer_store_dwordx4 v[184:187], v244, s[20:23], s39 offen offset:2048
v_mfma_f32_16x16x32_bf16 v[200:203], a[84:87], a[4:7], v[200:203]
v_cvt_pk_bf16_f32 v192, v192, v193
v_cvt_pk_bf16_f32 v193, v194, v195
v_mfma_f32_16x16x32_bf16 v[200:203], a[80:83], a[0:3], v[200:203]
v_cvt_pk_bf16_f32 v194, v196, v197
v_cvt_pk_bf16_f32 v195, v198, v199
s_waitcnt lgkmcnt(8)
v_mfma_f32_16x16x32_bf16 v[200:203], a[88:91], a[8:11], v[200:203]
ds_read_b64_tr_b16 a[80:81], v222 offset:0
ds_read_b64_tr_b16 a[82:83], v222 offset:4608
v_mfma_f32_16x16x32_bf16 v[200:203], a[92:95], a[12:15], v[200:203]
buffer_store_dwordx4 v[192:195], v244, s[20:23], s39 offen offset:3072
v_mfma_f32_16x16x32_bf16 v[204:207], a[92:95], a[28:31], v[204:207]
ds_read_b64_tr_b16 a[156:157], v219 offset:128
ds_read_b64_tr_b16 a[158:159], v219 offset:4736
v_mfma_f32_16x16x32_bf16 v[204:207], a[88:91], a[24:27], v[204:207]
v_mul_f32 v53, v53, v59
v_cvt_pk_bf16_f32 v58, v52, v53
v_mfma_f32_16x16x32_bf16 v[208:211], a[88:91], a[40:43], v[208:211]
ds_read_b64_tr_b16 a[84:85], v222 offset:9216
ds_read_b64_tr_b16 a[86:87], v222 offset:13824
v_mfma_f32_16x16x32_bf16 v[208:211], a[92:95], a[44:47], v[208:211]
v_lshlrev_b32 v52, 16, v58
v_and_b32 v53, 0xffff0000, v58
v_mfma_f32_16x16x32_bf16 v[212:215], a[92:95], a[60:63], v[212:215]
ds_read_b64_tr_b16 a[160:161], v219 offset:9344
ds_read_b64_tr_b16 a[162:163], v219 offset:13952
v_mfma_f32_16x16x32_bf16 v[212:215], a[88:91], a[56:59], v[212:215]
v_accvgpr_read_b32 v55, a254
v_accvgpr_read_b32 v59, a152
s_waitcnt lgkmcnt(8)
v_mfma_f32_16x16x32_bf16 v[96:99], a[64:67], a[112:115], v[96:99]
ds_read_b64_tr_b16 a[88:89], v222 offset:18432
ds_read_b64_tr_b16 a[90:91], v222 offset:23040
v_mfma_f32_16x16x32_bf16 v[96:99], a[68:71], a[116:119], v[96:99]
v_lshlrev_b32 v54, 16, v55
v_and_b32 v55, 0xffff0000, v55
v_mfma_f32_16x16x32_bf16 v[88:91], a[68:71], a[100:103], v[88:91]
ds_read_b64_tr_b16 a[164:165], v219 offset:18560
ds_read_b64_tr_b16 a[166:167], v219 offset:23168
v_mfma_f32_16x16x32_bf16 v[88:91], a[64:67], a[96:99], v[88:91]
v_lshlrev_b32 v58, 16, v59
v_and_b32 v59, 0xffff0000, v59
v_mfma_f32_16x16x32_bf16 v[80:83], a[64:67], a[236:239], v[80:83]
ds_read_b64_tr_b16 a[92:93], v222 offset:27648
ds_read_b64_tr_b16 a[94:95], v222 offset:32256
v_mfma_f32_16x16x32_bf16 v[80:83], a[68:71], a[240:243], v[80:83]
v_add_f32 v54, v54, v58
v_add_f32 v55, v55, v59
v_mfma_f32_16x16x32_bf16 v[72:75], a[68:71], a[224:227], v[72:75]
ds_read_b64_tr_b16 a[168:169], v219 offset:27776
ds_read_b64_tr_b16 a[170:171], v219 offset:32384
v_mfma_f32_16x16x32_bf16 v[72:75], a[64:67], a[220:223], v[72:75]
v_cvt_pk_bf16_f32 v58, v54, v55
v_lshlrev_b32 v54, 16, v58
v_mfma_f32_16x16x32_bf16 v[72:75], a[72:75], a[228:231], v[72:75]
ds_read_b64_tr_b16 a[64:65], v219 offset:8
ds_read_b64_tr_b16 a[66:67], v219 offset:4616
v_mfma_f32_16x16x32_bf16 v[72:75], a[76:79], a[232:235], v[72:75]
s_add_u32 s39, s44, 8192
v_and_b32 v55, 0xffff0000, v58
v_mfma_f32_16x16x32_bf16 v[80:83], a[76:79], a[132:135], v[80:83]
ds_read_b64_tr_b16 a[172:173], v222 offset:128
ds_read_b64_tr_b16 a[174:175], v222 offset:4736
v_mfma_f32_16x16x32_bf16 v[80:83], a[72:75], a[128:131], v[80:83]
v_cvt_pk_bf16_f32 v200, v200, v201
v_cvt_pk_bf16_f32 v201, v202, v203
v_mfma_f32_16x16x32_bf16 v[88:91], a[72:75], a[104:107], v[88:91]
ds_read_b64_tr_b16 a[68:69], v219 offset:9224
ds_read_b64_tr_b16 a[70:71], v219 offset:13832
v_mfma_f32_16x16x32_bf16 v[88:91], a[76:79], a[108:111], v[88:91]
buffer_store_dwordx2 v[200:201], v226, s[20:23], s44 offen offset:0
v_mfma_f32_16x16x32_bf16 v[96:99], a[76:79], a[124:127], v[96:99]
ds_read_b64_tr_b16 a[176:177], v222 offset:9344
ds_read_b64_tr_b16 a[178:179], v222 offset:13952
v_mfma_f32_16x16x32_bf16 v[96:99], a[72:75], a[120:123], v[96:99]
v_cvt_pk_bf16_f32 v204, v204, v205
v_cvt_pk_bf16_f32 v205, v206, v207
s_waitcnt lgkmcnt(8)
v_mfma_f32_16x16x32_bf16 v[96:99], a[80:83], a[48:51], v[96:99]
ds_read_b64_tr_b16 a[72:73], v219 offset:18440
ds_read_b64_tr_b16 a[74:75], v219 offset:23048
v_mfma_f32_16x16x32_bf16 v[96:99], a[84:87], a[52:55], v[96:99]
buffer_store_dwordx2 v[204:205], v226, s[20:23], s44 offen offset:512
v_mfma_f32_16x16x32_bf16 v[88:91], a[84:87], a[36:39], v[88:91]
ds_read_b64_tr_b16 a[180:181], v222 offset:18560
ds_read_b64_tr_b16 a[182:183], v222 offset:23168
v_mfma_f32_16x16x32_bf16 v[88:91], a[80:83], a[32:35], v[88:91]
v_cvt_pk_bf16_f32 v208, v208, v209
v_cvt_pk_bf16_f32 v209, v210, v211
v_mfma_f32_16x16x32_bf16 v[80:83], a[80:83], a[16:19], v[80:83]
ds_read_b64_tr_b16 a[76:77], v219 offset:27656
ds_read_b64_tr_b16 a[78:79], v219 offset:32264
v_mfma_f32_16x16x32_bf16 v[80:83], a[84:87], a[20:23], v[80:83]
buffer_store_dwordx2 v[208:209], v226, s[20:23], s39 offen offset:0
v_mfma_f32_16x16x32_bf16 v[72:75], a[84:87], a[4:7], v[72:75]
ds_read_b64_tr_b16 a[184:185], v222 offset:27776
ds_read_b64_tr_b16 a[186:187], v222 offset:32384
v_mfma_f32_16x16x32_bf16 v[72:75], a[80:83], a[0:3], v[72:75]
v_cvt_pk_bf16_f32 v212, v212, v213
v_cvt_pk_bf16_f32 v213, v214, v215
v_mfma_f32_16x16x32_bf16 v[72:75], a[88:91], a[8:11], v[72:75]
ds_read_b64_tr_b16 a[80:81], v222 offset:8
ds_read_b64_tr_b16 a[82:83], v222 offset:4616
v_mfma_f32_16x16x32_bf16 v[72:75], a[92:95], a[12:15], v[72:75]
buffer_store_dwordx2 v[212:213], v226, s[20:23], s39 offen offset:512
v_mfma_f32_16x16x32_bf16 v[80:83], a[92:95], a[28:31], v[80:83]
ds_read_b64_tr_b16 a[188:189], v219 offset:136
ds_read_b64_tr_b16 a[190:191], v219 offset:4744
v_mfma_f32_16x16x32_bf16 v[80:83], a[88:91], a[24:27], v[80:83]
s_lshl2_add_u32 s28, s32, s95
v_mul_f32 v58, 0xbfb8aa3b, v54
v_mfma_f32_16x16x32_bf16 v[88:91], a[88:91], a[40:43], v[88:91]
ds_read_b64_tr_b16 a[84:85], v222 offset:9224
ds_read_b64_tr_b16 a[86:87], v222 offset:13832
v_mfma_f32_16x16x32_bf16 v[88:91], a[92:95], a[44:47], v[88:91]
v_mul_f32 v59, 0xbfb8aa3b, v55
v_mfma_f32_16x16x32_bf16 v[96:99], a[92:95], a[60:63], v[96:99]
ds_read_b64_tr_b16 a[192:193], v219 offset:9352
ds_read_b64_tr_b16 a[194:195], v219 offset:13960
v_mfma_f32_16x16x32_bf16 v[96:99], a[88:91], a[56:59], v[96:99]
v_exp_f32 v58, v58
s_waitcnt lgkmcnt(8)
v_mfma_f32_16x16x32_bf16 v[100:103], a[64:67], a[112:115], v[100:103]
ds_read_b64_tr_b16 a[88:89], v222 offset:18440
ds_read_b64_tr_b16 a[90:91], v222 offset:23048
v_mfma_f32_16x16x32_bf16 v[100:103], a[68:71], a[116:119], v[100:103]
v_exp_f32 v59, v59
v_mfma_f32_16x16x32_bf16 v[92:95], a[68:71], a[100:103], v[92:95]
ds_read_b64_tr_b16 a[196:197], v219 offset:18568
ds_read_b64_tr_b16 a[198:199], v219 offset:23176
v_mfma_f32_16x16x32_bf16 v[92:95], a[64:67], a[96:99], v[92:95]
v_add_f32 v58, 1.0, v58
v_add_f32 v59, 1.0, v59
v_mfma_f32_16x16x32_bf16 v[84:87], a[64:67], a[236:239], v[84:87]
ds_read_b64_tr_b16 a[92:93], v222 offset:27656
ds_read_b64_tr_b16 a[94:95], v222 offset:32264
v_mfma_f32_16x16x32_bf16 v[84:87], a[68:71], a[240:243], v[84:87]
v_rcp_f32 v58, v58
v_mfma_f32_16x16x32_bf16 v[76:79], a[68:71], a[224:227], v[76:79]
ds_read_b64_tr_b16 a[200:201], v219 offset:27784
ds_read_b64_tr_b16 a[202:203], v219 offset:32392
v_mfma_f32_16x16x32_bf16 v[76:79], a[64:67], a[220:223], v[76:79]
v_rcp_f32 v59, v59
v_mfma_f32_16x16x32_bf16 v[76:79], a[72:75], a[228:231], v[76:79]
v_mul_f32 v54, v54, v58
v_mul_f32 v55, v55, v59
v_mfma_f32_16x16x32_bf16 v[76:79], a[76:79], a[232:235], v[76:79]
v_cvt_pk_bf16_f32 v58, v54, v55
v_lshlrev_b32 v54, 16, v58
v_mfma_f32_16x16x32_bf16 v[84:87], a[76:79], a[132:135], v[84:87]
ds_read_b64_tr_b16 a[204:205], v222 offset:136
ds_read_b64_tr_b16 a[206:207], v222 offset:4744
v_mfma_f32_16x16x32_bf16 v[84:87], a[72:75], a[128:131], v[84:87]
v_and_b32 v55, 0xffff0000, v58
v_accvgpr_read_b32 v57, a255
v_mfma_f32_16x16x32_bf16 v[92:95], a[72:75], a[104:107], v[92:95]
v_accvgpr_read_b32 v59, a153
v_lshlrev_b32 v56, 16, v57
v_mfma_f32_16x16x32_bf16 v[92:95], a[76:79], a[108:111], v[92:95]
s_waitcnt vmcnt(0)
buffer_store_dword v231, v254, s[20:23], s28 offen
v_mfma_f32_16x16x32_bf16 v[100:103], a[76:79], a[124:127], v[100:103]
ds_read_b64_tr_b16 a[208:209], v222 offset:9352
ds_read_b64_tr_b16 a[210:211], v222 offset:13960
v_mfma_f32_16x16x32_bf16 v[100:103], a[72:75], a[120:123], v[100:103]
v_and_b32 v57, 0xffff0000, v57
v_lshlrev_b32 v58, 16, v59
s_waitcnt lgkmcnt(8)
v_mfma_f32_16x16x32_bf16 v[100:103], a[80:83], a[48:51], v[100:103]
v_and_b32 v59, 0xffff0000, v59
v_add_f32 v56, v56, v58
v_mfma_f32_16x16x32_bf16 v[100:103], a[84:87], a[52:55], v[100:103]
v_add_f32 v57, v57, v59
v_cvt_pk_bf16_f32 v58, v56, v57
v_mfma_f32_16x16x32_bf16 v[92:95], a[84:87], a[36:39], v[92:95]
ds_read_b64_tr_b16 a[212:213], v222 offset:18568
ds_read_b64_tr_b16 a[214:215], v222 offset:23176
v_mfma_f32_16x16x32_bf16 v[92:95], a[80:83], a[32:35], v[92:95]
v_lshlrev_b32 v56, 16, v58
v_and_b32 v57, 0xffff0000, v58
v_mfma_f32_16x16x32_bf16 v[84:87], a[80:83], a[16:19], v[84:87]
v_mul_f32 v58, 0xbfb8aa3b, v56
v_mul_f32 v59, 0xbfb8aa3b, v57
v_mfma_f32_16x16x32_bf16 v[84:87], a[84:87], a[20:23], v[84:87]
v_exp_f32 v58, v58
v_mfma_f32_16x16x32_bf16 v[76:79], a[84:87], a[4:7], v[76:79]
ds_read_b64_tr_b16 a[216:217], v222 offset:27784
ds_read_b64_tr_b16 a[218:219], v222 offset:32392
v_mfma_f32_16x16x32_bf16 v[76:79], a[80:83], a[0:3], v[76:79]
s_waitcnt vmcnt(1)
buffer_load_dword v230, v229, s[20:23], s95 offen sc0 sc1
v_mfma_f32_16x16x32_bf16 v[76:79], a[88:91], a[8:11], v[76:79]
v_exp_f32 v59, v59
s_waitcnt lgkmcnt(8)
v_mfma_f32_16x16x32_bf16 v[76:79], a[92:95], a[12:15], v[76:79]
v_add_f32 v58, 1.0, v58
v_add_f32 v59, 1.0, v59
v_mfma_f32_16x16x32_bf16 v[84:87], a[92:95], a[28:31], v[84:87]
v_rcp_f32 v58, v58
v_mfma_f32_16x16x32_bf16 v[84:87], a[88:91], a[24:27], v[84:87]
v_rcp_f32 v59, v59
v_mfma_f32_16x16x32_bf16 v[92:95], a[88:91], a[40:43], v[92:95]
v_mul_f32 v56, v56, v58
v_mul_f32 v57, v57, v59
v_mfma_f32_16x16x32_bf16 v[92:95], a[92:95], a[44:47], v[92:95]
v_cvt_pk_bf16_f32 v58, v56, v57
v_lshlrev_b32 v56, 16, v58
v_mfma_f32_16x16x32_bf16 v[100:103], a[92:95], a[60:63], v[100:103]
v_and_b32 v57, 0xffff0000, v58
v_accvgpr_read_b32 v19, a244
v_mfma_f32_16x16x32_bf16 v[100:103], a[88:91], a[56:59], v[100:103]
v_lshlrev_b32 v18, 16, v19
v_and_b32 v19, 0xffff0000, v19
v_mfma_f32_16x16x32_bf16 v[144:147], a[156:159], a[236:239], v[144:147]
v_accvgpr_read_b32 v21, a245
v_lshlrev_b32 v20, 16, v21
v_mfma_f32_16x16x32_bf16 v[144:147], a[160:163], a[240:243], v[144:147]
v_and_b32 v21, 0xffff0000, v21
v_accvgpr_read_b32 v23, a246
v_mfma_f32_16x16x32_bf16 v[144:147], a[164:167], a[128:131], v[144:147]
v_lshlrev_b32 v22, 16, v23
v_and_b32 v23, 0xffff0000, v23
v_mfma_f32_16x16x32_bf16 v[144:147], a[168:171], a[132:135], v[144:147]
v_accvgpr_read_b32 v25, a247
v_lshlrev_b32 v24, 16, v25
v_mfma_f32_16x16x32_bf16 v[144:147], a[172:175], a[16:19], v[144:147]
v_and_b32 v25, 0xffff0000, v25
v_accvgpr_read_b32 v27, a248
v_mfma_f32_16x16x32_bf16 v[144:147], a[176:179], a[20:23], v[144:147]
v_lshlrev_b32 v26, 16, v27
v_and_b32 v27, 0xffff0000, v27
v_mfma_f32_16x16x32_bf16 v[144:147], a[180:183], a[24:27], v[144:147]
v_accvgpr_read_b32 v29, a249
v_lshlrev_b32 v28, 16, v29
v_mfma_f32_16x16x32_bf16 v[144:147], a[184:187], a[28:31], v[144:147]
v_and_b32 v29, 0xffff0000, v29
v_accvgpr_read_b32 v31, a250
s_waitcnt lgkmcnt(0)
v_mfma_f32_16x16x32_bf16 v[148:151], a[216:219], a[28:31], v[148:151]
s_add_u32 s39, s44, 0
v_lshlrev_b32 v30, 16, v31
v_mfma_f32_16x16x32_bf16 v[148:151], a[212:215], a[24:27], v[148:151]
v_cvt_pk_bf16_f32 v80, v80, v81
v_cvt_pk_bf16_f32 v81, v82, v83
v_mfma_f32_16x16x32_bf16 v[148:151], a[208:211], a[20:23], v[148:151]
v_cvt_pk_bf16_f32 v82, v84, v85
v_cvt_pk_bf16_f32 v83, v86, v87
v_mfma_f32_16x16x32_bf16 v[148:151], a[204:207], a[16:19], v[148:151]
buffer_store_dwordx4 v[80:83], v244, s[20:23], s39 offen offset:1024
v_mfma_f32_16x16x32_bf16 v[148:151], a[200:203], a[132:135], v[148:151]
v_cvt_pk_bf16_f32 v88, v88, v89
v_cvt_pk_bf16_f32 v89, v90, v91
v_mfma_f32_16x16x32_bf16 v[148:151], a[196:199], a[128:131], v[148:151]
v_cvt_pk_bf16_f32 v90, v92, v93
v_cvt_pk_bf16_f32 v91, v94, v95
v_mfma_f32_16x16x32_bf16 v[148:151], a[192:195], a[240:243], v[148:151]
buffer_store_dwordx4 v[88:91], v244, s[20:23], s39 offen offset:2048
v_mfma_f32_16x16x32_bf16 v[148:151], a[188:191], a[236:239], v[148:151]
v_cvt_pk_bf16_f32 v96, v96, v97
v_cvt_pk_bf16_f32 v97, v98, v99
v_mfma_f32_16x16x32_bf16 v[156:159], a[188:191], a[96:99], v[156:159]
v_cvt_pk_bf16_f32 v98, v100, v101
v_cvt_pk_bf16_f32 v99, v102, v103
v_mfma_f32_16x16x32_bf16 v[156:159], a[192:195], a[100:103], v[156:159]
buffer_store_dwordx4 v[96:99], v244, s[20:23], s39 offen offset:3072
v_mfma_f32_16x16x32_bf16 v[156:159], a[196:199], a[104:107], v[156:159]
s_add_u32 s39, s44, 8192
v_and_b32 v31, 0xffff0000, v31
v_mfma_f32_16x16x32_bf16 v[156:159], a[200:203], a[108:111], v[156:159]
s_waitcnt vmcnt(3)
v_cmp_gt_u32 vcc, 1, v230
v_mfma_f32_16x16x32_bf16 v[156:159], a[204:207], a[32:35], v[156:159]
v_accvgpr_read_b32 v33, a251
v_lshlrev_b32 v32, 16, v33
v_mfma_f32_16x16x32_bf16 v[156:159], a[208:211], a[36:39], v[156:159]
s_and_b32 s29, vcc_lo, 0xff
s_cbranch_scc1 SP_P1A
SP_P1A_RET:
v_mfma_f32_16x16x32_bf16 v[156:159], a[212:215], a[40:43], v[156:159]
v_and_b32 v33, 0xffff0000, v33
v_accvgpr_read_b32 v35, a252
v_mfma_f32_16x16x32_bf16 v[156:159], a[216:219], a[44:47], v[156:159]
v_cvt_pk_bf16_f32 v144, v144, v145
v_cvt_pk_bf16_f32 v145, v146, v147
v_mfma_f32_16x16x32_bf16 v[152:155], a[184:187], a[44:47], v[152:155]
v_cvt_pk_bf16_f32 v146, v148, v149
v_cvt_pk_bf16_f32 v147, v150, v151
v_mfma_f32_16x16x32_bf16 v[152:155], a[180:183], a[40:43], v[152:155]
buffer_store_dwordx4 v[144:147], v244, s[20:23], s39 offen offset:1024
v_mfma_f32_16x16x32_bf16 v[152:155], a[176:179], a[36:39], v[152:155]
buffer_load_dwordx4 v[104:107], v244, s[20:23], s68 offen sc0 sc1
v_mfma_f32_16x16x32_bf16 v[152:155], a[172:175], a[32:35], v[152:155]
v_lshlrev_b32 v34, 16, v35
v_and_b32 v35, 0xffff0000, v35
v_mfma_f32_16x16x32_bf16 v[152:155], a[168:171], a[108:111], v[152:155]
v_accvgpr_read_b32 v37, a253
v_lshlrev_b32 v36, 16, v37
v_mfma_f32_16x16x32_bf16 v[152:155], a[164:167], a[104:107], v[152:155]
buffer_load_dwordx4 v[108:111], v244, s[20:23], s69 offen sc0 sc1
v_mfma_f32_16x16x32_bf16 v[152:155], a[160:163], a[100:103], v[152:155]
v_and_b32 v37, 0xffff0000, v37
v_mfma_f32_16x16x32_bf16 v[152:155], a[156:159], a[96:99], v[152:155]
s_mov_b32 s90, 0x3f80
s_mov_b32 s91, 0x3f800000
v_mfma_f32_16x16x32_bf16 v[160:163], a[156:159], a[112:115], v[160:163]
STUB_16:
s_cbranch_execz HOP_RET2
buffer_load_dwordx4 v[112:115], v244, s[20:23], s70 offen sc0 sc1
v_mfma_f32_16x16x32_bf16 v[160:163], a[160:163], a[116:119], v[160:163]
v_mov_b32 v66, 0
v_mov_b32 v67, 0
v_mfma_f32_16x16x32_bf16 v[160:163], a[164:167], a[120:123], v[160:163]
v_mov_b32 v68, 0
v_mov_b32 v69, 0
v_mfma_f32_16x16x32_bf16 v[160:163], a[168:171], a[124:127], v[160:163]
buffer_load_dwordx4 v[116:119], v244, s[20:23], s71 offen sc0 sc1
v_mfma_f32_16x16x32_bf16 v[160:163], a[172:175], a[48:51], v[160:163]
v_mfma_f32_16x16x32_bf16 v[160:163], a[176:179], a[52:55], v[160:163]
v_mfma_f32_16x16x32_bf16 v[160:163], a[180:183], a[56:59], v[160:163]
buffer_load_dwordx2 v[200:201], v226, s[20:23], s72 offen sc0 sc1
v_mfma_f32_16x16x32_bf16 v[160:163], a[184:187], a[60:63], v[160:163]
v_cvt_pk_bf16_f32 v152, v152, v153
v_cvt_pk_bf16_f32 v153, v154, v155
v_mfma_f32_16x16x32_bf16 v[164:167], a[216:219], a[60:63], v[164:167]
v_cvt_pk_bf16_f32 v154, v156, v157
v_cvt_pk_bf16_f32 v155, v158, v159
v_mfma_f32_16x16x32_bf16 v[164:167], a[212:215], a[56:59], v[164:167]
buffer_store_dwordx4 v[152:155], v244, s[20:23], s39 offen offset:2048
v_mfma_f32_16x16x32_bf16 v[164:167], a[208:211], a[52:55], v[164:167]
buffer_load_dwordx2 v[202:203], v226, s[20:23], s73 offen sc0 sc1
v_mfma_f32_16x16x32_bf16 v[164:167], a[204:207], a[48:51], v[164:167]
v_mfma_f32_16x16x32_bf16 v[164:167], a[200:203], a[124:127], v[164:167]
v_mfma_f32_16x16x32_bf16 v[164:167], a[196:199], a[120:123], v[164:167]
buffer_load_dwordx2 v[204:205], v226, s[20:23], s74 offen sc0 sc1
v_mfma_f32_16x16x32_bf16 v[164:167], a[192:195], a[116:119], v[164:167]
v_mfma_f32_16x16x32_bf16 v[164:167], a[188:191], a[112:115], v[164:167]
v_mfma_f32_16x16x32_bf16 v[140:143], a[188:191], a[220:223], v[140:143]
buffer_load_dwordx2 v[206:207], v226, s[20:23], s75 offen sc0 sc1
v_mfma_f32_16x16x32_bf16 v[140:143], a[192:195], a[224:227], v[140:143]
v_mfma_f32_16x16x32_bf16 v[140:143], a[196:199], a[228:231], v[140:143]
v_mfma_f32_16x16x32_bf16 v[140:143], a[200:203], a[232:235], v[140:143]
buffer_load_dwordx2 v[208:209], v226, s[20:23], s84 offen sc0 sc1
v_mfma_f32_16x16x32_bf16 v[140:143], a[204:207], a[0:3], v[140:143]
v_mfma_f32_16x16x32_bf16 v[140:143], a[208:211], a[4:7], v[140:143]
v_mfma_f32_16x16x32_bf16 v[140:143], a[212:215], a[8:11], v[140:143]
buffer_load_dwordx2 v[210:211], v226, s[20:23], s85 offen sc0 sc1
v_mfma_f32_16x16x32_bf16 v[140:143], a[216:219], a[12:15], v[140:143]
v_cvt_pk_bf16_f32 v160, v160, v161
v_cvt_pk_bf16_f32 v161, v162, v163
v_mfma_f32_16x16x32_bf16 v[136:139], a[184:187], a[12:15], v[136:139]
v_cvt_pk_bf16_f32 v162, v164, v165
v_cvt_pk_bf16_f32 v163, v166, v167
v_mfma_f32_16x16x32_bf16 v[136:139], a[180:183], a[8:11], v[136:139]
buffer_store_dwordx4 v[160:163], v244, s[20:23], s39 offen offset:3072
v_mfma_f32_16x16x32_bf16 v[136:139], a[176:179], a[4:7], v[136:139]
buffer_load_dwordx2 v[212:213], v226, s[20:23], s86 offen sc0 sc1
v_mfma_f32_16x16x32_bf16 v[136:139], a[172:175], a[0:3], v[136:139]
v_mfma_f32_16x16x32_bf16 v[136:139], a[168:171], a[232:235], v[136:139]
v_mfma_f32_16x16x32_bf16 v[136:139], a[164:167], a[228:231], v[136:139]
buffer_load_dwordx2 v[214:215], v226, s[20:23], s87 offen sc0 sc1
v_mfma_f32_16x16x32_bf16 v[136:139], a[160:163], a[224:227], v[136:139]
v_mfma_f32_16x16x32_bf16 v[136:139], a[156:159], a[220:223], v[136:139]
buffer_load_dwordx4 v[120:123], v243, s[20:23], s68 offen sc0 sc1
buffer_load_dwordx4 v[124:127], v243, s[20:23], s69 offen sc0 sc1
buffer_load_dwordx4 v[128:131], v243, s[20:23], s70 offen sc0 sc1
buffer_load_dwordx4 v[132:135], v243, s[20:23], s71 offen sc0 sc1
s_lshl_b32 s50, s34, 2
s_lshl_b32 s50, 15, s50
s_waitcnt vmcnt(6)
buffer_store_dword v246, v254, s[20:23], s28 offen
s_waitcnt vmcnt(18)
v_dot2c_f32_bf16 v72, s90, v104
v_dot2c_f32_bf16 v73, s91, v104
v_dot2c_f32_bf16 v74, s90, v105
v_dot2c_f32_bf16 v75, s91, v105
v_dot2c_f32_bf16 v76, s90, v106
v_dot2c_f32_bf16 v77, s91, v106
v_dot2c_f32_bf16 v78, s90, v107
v_dot2c_f32_bf16 v79, s91, v107
s_waitcnt vmcnt(17)
v_dot2c_f32_bf16 v72, s90, v108
v_dot2c_f32_bf16 v73, s91, v108
v_dot2c_f32_bf16 v74, s90, v109
v_dot2c_f32_bf16 v75, s91, v109
v_dot2c_f32_bf16 v76, s90, v110
v_dot2c_f32_bf16 v77, s91, v110
v_dot2c_f32_bf16 v78, s90, v111
v_dot2c_f32_bf16 v79, s91, v111
s_waitcnt vmcnt(16)
v_dot2c_f32_bf16 v72, s90, v112
v_dot2c_f32_bf16 v73, s91, v112
v_dot2c_f32_bf16 v74, s90, v113
v_dot2c_f32_bf16 v75, s91, v113
v_dot2c_f32_bf16 v76, s90, v114
v_dot2c_f32_bf16 v77, s91, v114
v_dot2c_f32_bf16 v78, s90, v115
v_dot2c_f32_bf16 v79, s91, v115
s_waitcnt vmcnt(15)
v_dot2c_f32_bf16 v72, s90, v116
v_dot2c_f32_bf16 v73, s91, v116
v_dot2c_f32_bf16 v74, s90, v117
v_dot2c_f32_bf16 v75, s91, v117
v_dot2c_f32_bf16 v76, s90, v118
v_dot2c_f32_bf16 v77, s91, v118
v_dot2c_f32_bf16 v78, s90, v119
v_dot2c_f32_bf16 v79, s91, v119
buffer_load_dword v230, v229, s[20:23], s95 offen sc0 sc1
s_waitcnt vmcnt(5)
v_dot2c_f32_bf16 v136, s90, v120
v_dot2c_f32_bf16 v137, s91, v120
v_dot2c_f32_bf16 v138, s90, v121
v_dot2c_f32_bf16 v139, s91, v121
v_dot2c_f32_bf16 v140, s90, v122
v_dot2c_f32_bf16 v141, s91, v122
v_dot2c_f32_bf16 v142, s90, v123
v_dot2c_f32_bf16 v143, s91, v123
s_waitcnt vmcnt(4)
v_dot2c_f32_bf16 v136, s90, v124
v_dot2c_f32_bf16 v137, s91, v124
v_dot2c_f32_bf16 v138, s90, v125
v_dot2c_f32_bf16 v139, s91, v125
v_dot2c_f32_bf16 v140, s90, v126
v_dot2c_f32_bf16 v141, s91, v126
v_dot2c_f32_bf16 v142, s90, v127
v_dot2c_f32_bf16 v143, s91, v127
s_waitcnt vmcnt(3)
v_dot2c_f32_bf16 v136, s90, v128
v_dot2c_f32_bf16 v137, s91, v128
v_dot2c_f32_bf16 v138, s90, v129
v_dot2c_f32_bf16 v139, s91, v129
v_dot2c_f32_bf16 v140, s90, v130
v_dot2c_f32_bf16 v141, s91, v130
v_dot2c_f32_bf16 v142, s90, v131
v_dot2c_f32_bf16 v143, s91, v131
s_waitcnt vmcnt(2)
v_dot2c_f32_bf16 v136, s90, v132
v_dot2c_f32_bf16 v137, s91, v132
v_dot2c_f32_bf16 v138, s90, v133
v_dot2c_f32_bf16 v139, s91, v133
v_dot2c_f32_bf16 v140, s90, v134
v_dot2c_f32_bf16 v141, s91, v134
v_dot2c_f32_bf16 v142, s90, v135
v_dot2c_f32_bf16 v143, s91, v135
s_waitcnt vmcnt(0)
v_cmp_gt_u32 vcc, 2, v230
s_nop 0
s_and_b32 s29, vcc_lo, s50
s_cbranch_scc0 SP_P2A_RET
SP_P2A:
s_sleep 0
s_add_u32 s100, s100, 1
s_bitcmp1_b32 s100, 19
s_cbranch_scc1 K_END
buffer_load_dword v230, v229, s[20:23], s95 offen sc0 sc1
s_waitcnt vmcnt(0)
v_cmp_gt_u32 vcc, 2, v230
s_nop 0
s_and_b32 s29, vcc_lo, s50
s_cbranch_scc1 SP_P2A
SP_P2A_RET:
buffer_load_dwordx4 v[168:171], v244, s[20:23], s65 offen sc0 sc1
buffer_load_dwordx4 v[172:175], v244, s[20:23], s66 offen sc0 sc1
buffer_load_dwordx4 v[176:179], v244, s[20:23], s67 offen sc0 sc1
buffer_load_dwordx4 v[180:183], v243, s[20:23], s65 offen sc0 sc1
buffer_load_dwordx4 v[184:187], v243, s[20:23], s66 offen sc0 sc1
buffer_load_dwordx4 v[188:191], v243, s[20:23], s67 offen sc0 sc1
s_waitcnt vmcnt(21)
v_dot2c_f32_bf16 v66, s90, v200
v_dot2c_f32_bf16 v67, s91, v200
v_dot2c_f32_bf16 v68, s90, v201
v_dot2c_f32_bf16 v69, s91, v201
s_waitcnt vmcnt(19)
v_dot2c_f32_bf16 v66, s90, v202
v_dot2c_f32_bf16 v67, s91, v202
v_dot2c_f32_bf16 v68, s90, v203
v_dot2c_f32_bf16 v69, s91, v203
s_waitcnt vmcnt(18)
v_dot2c_f32_bf16 v66, s90, v204
v_dot2c_f32_bf16 v67, s91, v204
v_dot2c_f32_bf16 v68, s90, v205
v_dot2c_f32_bf16 v69, s91, v205
s_waitcnt vmcnt(17)
v_dot2c_f32_bf16 v66, s90, v206
v_dot2c_f32_bf16 v67, s91, v206
v_dot2c_f32_bf16 v68, s90, v207
v_dot2c_f32_bf16 v69, s91, v207
s_waitcnt vmcnt(16)
v_dot2c_f32_bf16 v66, s90, v208
v_dot2c_f32_bf16 v67, s91, v208
v_dot2c_f32_bf16 v68, s90, v209
v_dot2c_f32_bf16 v69, s91, v209
s_waitcnt vmcnt(15)
v_dot2c_f32_bf16 v66, s90, v210
v_dot2c_f32_bf16 v67, s91, v210
v_dot2c_f32_bf16 v68, s90, v211
v_dot2c_f32_bf16 v69, s91, v211
s_waitcnt vmcnt(13)
v_dot2c_f32_bf16 v66, s90, v212
v_dot2c_f32_bf16 v67, s91, v212
v_dot2c_f32_bf16 v68, s90, v213
v_dot2c_f32_bf16 v69, s91, v213
s_waitcnt vmcnt(12)
v_dot2c_f32_bf16 v66, s90, v214
v_dot2c_f32_bf16 v67, s91, v214
v_dot2c_f32_bf16 v68, s90, v215
v_dot2c_f32_bf16 v69, s91, v215
s_cmp_eq_u32 s34, 0
s_cselect_b32 s29, 0, 0x7fbffff0
s_nop 2
v_cvt_pk_bf16_f32 v58, v66, v67
v_cvt_pk_bf16_f32 v59, v68, v69
v_lshlrev_b32 v66, 16, v58
v_and_b32 v67, 0xffff0000, v58
v_lshlrev_b32 v68, 16, v59
v_and_b32 v69, 0xffff0000, v59
v_pk_mul_f32 v[66:67], v[66:67], v[54:55]
v_pk_mul_f32 v[68:69], v[68:69], v[56:57]
v_cvt_pk_bf16_f32 v58, v66, v67
v_cvt_pk_bf16_f32 v59, v68, v69
v_lshlrev_b32 v66, 16, v58
v_and_b32 v67, 0xffff0000, v58
v_lshlrev_b32 v68, 16, v59
v_and_b32 v69, 0xffff0000, v59
v_pk_add_f32 v[66:67], v[66:67], v[34:35]
v_pk_add_f32 v[68:69], v[68:69], v[36:37]
v_cvt_pk_bf16_f32 v66, v66, v67
v_cvt_pk_bf16_f32 v67, v68, v69
buffer_store_dwordx2 v[66:67], v249, s[60:63], s29 offen
s_waitcnt vmcnt(6)
v_dot2c_f32_bf16 v72, s90, v168
v_dot2c_f32_bf16 v73, s91, v168
v_dot2c_f32_bf16 v74, s90, v169
v_dot2c_f32_bf16 v75, s91, v169
v_dot2c_f32_bf16 v76, s90, v170
v_dot2c_f32_bf16 v77, s91, v170
v_dot2c_f32_bf16 v78, s90, v171
v_dot2c_f32_bf16 v79, s91, v171
s_waitcnt vmcnt(5)
v_dot2c_f32_bf16 v72, s90, v172
v_dot2c_f32_bf16 v73, s91, v172
v_dot2c_f32_bf16 v74, s90, v173
v_dot2c_f32_bf16 v75, s91, v173
v_dot2c_f32_bf16 v76, s90, v174
v_dot2c_f32_bf16 v77, s91, v174
v_dot2c_f32_bf16 v78, s90, v175
v_dot2c_f32_bf16 v79, s91, v175
s_waitcnt vmcnt(4)
v_dot2c_f32_bf16 v72, s90, v176
v_dot2c_f32_bf16 v73, s91, v176
v_dot2c_f32_bf16 v74, s90, v177
v_dot2c_f32_bf16 v75, s91, v177
v_dot2c_f32_bf16 v76, s90, v178
v_dot2c_f32_bf16 v77, s91, v178
v_dot2c_f32_bf16 v78, s90, v179
v_dot2c_f32_bf16 v79, s91, v179
s_nop 2
v_cvt_pk_bf16_f32 v58, v72, v73
v_cvt_pk_bf16_f32 v59, v74, v75
v_cvt_pk_bf16_f32 v60, v76, v77
v_cvt_pk_bf16_f32 v61, v78, v79
v_lshlrev_b32 v72, 16, v58
v_and_b32 v73, 0xffff0000, v58
v_lshlrev_b32 v74, 16, v59
v_and_b32 v75, 0xffff0000, v59
v_lshlrev_b32 v76, 16, v60
v_and_b32 v77, 0xffff0000, v60
v_lshlrev_b32 v78, 16, v61
v_and_b32 v79, 0xffff0000, v61
v_pk_mul_f32 v[72:73], v[72:73], v[38:39]
v_pk_mul_f32 v[74:75], v[74:75], v[40:41]
v_pk_mul_f32 v[76:77], v[76:77], v[42:43]
v_pk_mul_f32 v[78:79], v[78:79], v[44:45]
v_cvt_pk_bf16_f32 v58, v72, v73
v_cvt_pk_bf16_f32 v59, v74, v75
v_cvt_pk_bf16_f32 v60, v76, v77
v_cvt_pk_bf16_f32 v61, v78, v79
v_lshlrev_b32 v72, 16, v58
v_and_b32 v73, 0xffff0000, v58
v_lshlrev_b32 v74, 16, v59
v_and_b32 v75, 0xffff0000, v59
v_lshlrev_b32 v76, 16, v60
v_and_b32 v77, 0xffff0000, v60
v_lshlrev_b32 v78, 16, v61
v_and_b32 v79, 0xffff0000, v61
v_pk_add_f32 v[72:73], v[72:73], v[18:19]
v_pk_add_f32 v[74:75], v[74:75], v[20:21]
v_pk_add_f32 v[76:77], v[76:77], v[22:23]
v_pk_add_f32 v[78:79], v[78:79], v[24:25]
v_cvt_pk_bf16_f32 v72, v72, v73
v_cvt_pk_bf16_f32 v73, v74, v75
v_cvt_pk_bf16_f32 v74, v76, v77
v_cvt_pk_bf16_f32 v75, v78, v79
buffer_store_dwordx4 v[72:75], v248, s[60:63], 0 offen
s_waitcnt vmcnt(4)
v_dot2c_f32_bf16 v136, s90, v180
v_dot2c_f32_bf16 v137, s91, v180
v_dot2c_f32_bf16 v138, s90, v181
v_dot2c_f32_bf16 v139, s91, v181
v_dot2c_f32_bf16 v140, s90, v182
v_dot2c_f32_bf16 v141, s91, v182
v_dot2c_f32_bf16 v142, s90, v183
v_dot2c_f32_bf16 v143, s91, v183
s_waitcnt vmcnt(3)
v_dot2c_f32_bf16 v136, s90, v184
v_dot2c_f32_bf16 v137, s91, v184
v_dot2c_f32_bf16 v138, s90, v185
v_dot2c_f32_bf16 v139, s91, v185
v_dot2c_f32_bf16 v140, s90, v186
v_dot2c_f32_bf16 v141, s91, v186
v_dot2c_f32_bf16 v142, s90, v187
v_dot2c_f32_bf16 v143, s91, v187
s_waitcnt vmcnt(2)
v_dot2c_f32_bf16 v136, s90, v188
v_dot2c_f32_bf16 v137, s91, v188
v_dot2c_f32_bf16 v138, s90, v189
v_dot2c_f32_bf16 v139, s91, v189
v_dot2c_f32_bf16 v140, s90, v190
v_dot2c_f32_bf16 v141, s91, v190
v_dot2c_f32_bf16 v142, s90, v191
v_dot2c_f32_bf16 v143, s91, v191
s_nop 2
v_cvt_pk_bf16_f32 v58, v136, v137
v_cvt_pk_bf16_f32 v59, v138, v139
v_cvt_pk_bf16_f32 v60, v140, v141
v_cvt_pk_bf16_f32 v61, v142, v143
v_lshlrev_b32 v136, 16, v58
v_and_b32 v137, 0xffff0000, v58
v_lshlrev_b32 v138, 16, v59
v_and_b32 v139, 0xffff0000, v59
v_lshlrev_b32 v140, 16, v60
v_and_b32 v141, 0xffff0000, v60
v_lshlrev_b32 v142, 16, v61
v_and_b32 v143, 0xffff0000, v61
v_pk_mul_f32 v[136:137], v[136:137], v[46:47]
v_pk_mul_f32 v[138:139], v[138:139], v[48:49]
v_pk_mul_f32 v[140:141], v[140:141], v[50:51]
v_pk_mul_f32 v[142:143], v[142:143], v[52:53]
v_cvt_pk_bf16_f32 v58, v136, v137
v_cvt_pk_bf16_f32 v59, v138, v139
v_cvt_pk_bf16_f32 v60, v140, v141
v_cvt_pk_bf16_f32 v61, v142, v143
v_lshlrev_b32 v136, 16, v58
v_and_b32 v137, 0xffff0000, v58
v_lshlrev_b32 v138, 16, v59
v_and_b32 v139, 0xffff0000, v59
v_lshlrev_b32 v140, 16, v60
v_and_b32 v141, 0xffff0000, v60
v_lshlrev_b32 v142, 16, v61
v_and_b32 v143, 0xffff0000, v61
v_pk_add_f32 v[136:137], v[136:137], v[26:27]
v_pk_add_f32 v[138:139], v[138:139], v[28:29]
v_pk_add_f32 v[140:141], v[140:141], v[30:31]
v_pk_add_f32 v[142:143], v[142:143], v[32:33]
v_cvt_pk_bf16_f32 v136, v136, v137
v_cvt_pk_bf16_f32 v137, v138, v139
v_cvt_pk_bf16_f32 v138, v140, v141
v_cvt_pk_bf16_f32 v139, v142, v143
buffer_store_dwordx4 v[136:139], v248, s[60:63], 0 offen offset:128
K_END:
s_endpgm
K_EVT:
STUB_17:
s_cbranch_execz HOP_RET2
s_sub_u32 s3, s33, 1
s_cmp_eq_u32 s33, 5
s_cbranch_scc0 EV_Y
s_sub_u32 s28, s40, 0
s_cmp_lt_u32 s28, 72
s_cselect_b32 s3, 4, 0
s_cmp_eq_u32 s37, 0
s_cbranch_scc0 K_EVT_RET
s_mov_b32 s28, 0x243000
EV_INC:
v_mov_b32 v246, 0
v_mov_b32 v247, 1
s_mov_b64 exec, 1
buffer_atomic_add v247, v246, s[20:23], s28 offen sc1
s_mov_b64 exec, -1
s_branch K_EVT_RET
EV_Y:
s_cmp_eq_u32 s33, 4
s_cbranch_scc0 EV_Y4
v_mov_b32 v246, 0
s_mov_b32 s28, 0x243000
buffer_load_dword v247, v246, s[20:23], s28 offen sc0 sc1
s_branch K_EVT_RET
EV_Y4:
s_cmp_eq_u32 s33, 1
s_cbranch_scc0 EV_Y5
s_mov_b32 s28, 0x243080
s_bitcmp0_b32 s37, 0
s_cbranch_scc1 EV_INC
s_branch K_EVT_RET
EV_Y5:
s_sub_u32 s29, s40, 0
s_lshr_b32 s28, s37, 1
s_lshl1_add_u32 s29, s29, s28
s_cmp_eq_u32 s33, 3
s_cbranch_scc0 EV_Y3
v_readfirstlane_b32 s28, v247
s_cmp_ge_u32 s28, 144
s_cbranch_scc0 EV_Y4SP
EV_Y4OK:
v_lshrrev_b32 v246, 3, v1
v_mul_u32_u24 v246, 18432, v246
v_and_b32 v247, 7, v1
v_lshl_add_u32 v246, v247, 4, v246
s_lshl_b32 s28, s29, 7
s_and_b32 s29, s37, 1
s_mul_i32 s29, s29, 1327104
s_add_u32 s28, s28, s29
s_add_u32 s28, s28, 0x2000000
buffer_load_dwordx4 v[120:123], v246, s[20:23], s28 offen sc0 sc1
s_add_u32 s28, s28, 147456
buffer_load_dwordx4 v[124:127], v246, s[20:23], s28 offen sc0 sc1
s_add_u32 s28, s28, 147456
buffer_load_dwordx4 v[128:131], v246, s[20:23], s28 offen sc0 sc1
s_add_u32 s28, s28, 147456
buffer_load_dwordx4 v[132:135], v246, s[20:23], s28 offen sc0 sc1
s_add_u32 s28, s28, 147456
buffer_load_dwordx4 v[248:251], v246, s[20:23], s28 offen sc0 sc1
s_add_u32 s28, s28, 147456
buffer_load_dwordx4 v[252:255], v246, s[20:23], s28 offen sc0 sc1
s_add_u32 s28, s28, 147456
buffer_load_dwordx4 a[136:139], v246, s[20:23], s28 offen sc0 sc1
s_add_u32 s28, s28, 147456
buffer_load_dwordx4 a[140:143], v246, s[20:23], s28 offen sc0 sc1
s_add_u32 s28, s28, 147456
buffer_load_dwordx4 a[244:247], v246, s[20:23], s28 offen sc0 sc1
s_branch K_EVT_RET
EV_Y3:
STUB_18:
s_cbranch_execz HOP_RET2
v_pk_add_f32 v[120:121], v[120:121], v[124:125]
v_pk_add_f32 v[122:123], v[122:123], v[126:127]
v_pk_add_f32 v[128:129], v[128:129], v[132:133]
v_pk_add_f32 v[130:131], v[130:131], v[134:135]
v_pk_add_f32 v[248:249], v[248:249], v[252:253]
v_pk_add_f32 v[250:251], v[250:251], v[254:255]
v_accvgpr_read_b32 v124, a136
v_accvgpr_read_b32 v125, a137
v_accvgpr_read_b32 v126, a138
v_accvgpr_read_b32 v127, a139
v_accvgpr_read_b32 v132, a140
v_accvgpr_read_b32 v133, a141
v_accvgpr_read_b32 v134, a142
v_accvgpr_read_b32 v135, a143
v_accvgpr_read_b32 v252, a244
v_accvgpr_read_b32 v253, a245
v_accvgpr_read_b32 v254, a246
v_accvgpr_read_b32 v255, a247
v_pk_add_f32 v[124:125], v[124:125], v[132:133]
v_pk_add_f32 v[126:127], v[126:127], v[134:135]
v_pk_add_f32 v[120:121], v[120:121], v[128:129]
v_pk_add_f32 v[122:123], v[122:123], v[130:131]
v_pk_add_f32 v[248:249], v[248:249], v[124:125]
v_pk_add_f32 v[250:251], v[250:251], v[126:127]
v_pk_add_f32 v[120:121], v[120:121], v[252:253]
v_pk_add_f32 v[122:123], v[122:123], v[254:255]
v_pk_add_f32 v[120:121], v[120:121], v[248:249]
v_pk_add_f32 v[122:123], v[122:123], v[250:251]
v_and_b32 v246, 7, v1
s_lshr_b32 s28, s37, 1
s_lshl_b32 s28, s28, 7
v_add_f32_dpp v124, v120, v120 row_ror:8 row_mask:0xf bank_mask:0xf
v_add_f32_dpp v125, v121, v121 row_ror:8 row_mask:0xf bank_mask:0xf
v_add_f32_dpp v126, v122, v122 row_ror:8 row_mask:0xf bank_mask:0xf
v_add_f32_dpp v127, v123, v123 row_ror:8 row_mask:0xf bank_mask:0xf
v_mov_b32 v120, v124
v_mov_b32 v121, v125
v_mov_b32 v122, v126
v_mov_b32 v123, v127
v_permlane16_swap_b32 v120, v124
v_permlane16_swap_b32 v121, v125
v_permlane16_swap_b32 v122, v126
v_permlane16_swap_b32 v123, v127
v_add_f32 v124, v120, v124
v_add_f32 v125, v121, v125
v_add_f32 v126, v122, v126
v_add_f32 v127, v123, v127
v_mov_b32 v120, v124
v_mov_b32 v121, v125
v_mov_b32 v122, v126
v_mov_b32 v123, v127
v_permlane32_swap_b32 v120, v124
v_permlane32_swap_b32 v121, v125
v_permlane32_swap_b32 v122, v126
v_permlane32_swap_b32 v123, v127
v_add_f32 v124, v120, v124
v_add_f32 v125, v121, v125
v_add_f32 v126, v122, v126
v_add_f32 v127, v123, v127
v_lshlrev_b32 v247, 4, v246
v_add_u32 v247, s28, v247
s_bitcmp1_b32 s37, 0
s_cbranch_scc0 EV_YE
ds_write_b128 v247, v[124:127] offset:65024
s_waitcnt lgkmcnt(0)
s_barrier
s_branch K_EVT_RET
EV_YE:
s_barrier
ds_read_b128 v[120:123], v247 offset:65024
v_mul_u32_u24 v246, 0x480, v246
s_lshl_b32 s28, s29, 3
s_add_u32 s28, s28, 0x244000
s_waitcnt lgkmcnt(0)
v_pk_add_f32 v[120:121], v[120:121], v[124:125]
v_pk_add_f32 v[122:123], v[122:123], v[126:127]
v_cvt_pk_bf16_f32 v124, v120, v121
v_cvt_pk_bf16_f32 v125, v122, v123
v_lshlrev_b32 v120, 16, v124
v_and_b32 v121, 0xffff0000, v124
v_lshlrev_b32 v122, 16, v125
v_and_b32 v123, 0xffff0000, v125
v_mul_f32 v120, v120, v236
v_mul_f32 v121, v121, v236
v_mul_f32 v122, v122, v236
v_mul_f32 v123, v123, v236
v_cvt_pk_bf16_f32 v124, v120, v121
v_cvt_pk_bf16_f32 v125, v122, v123
s_mov_b64 exec, 0xff
buffer_store_dwordx2 v[124:125], v246, s[20:23], s28 offen sc0 sc1
s_mov_b64 exec, -1
s_branch K_EVT_RET
SP_X0:
s_sleep 2
s_add_u32 s100, s100, 1
s_bitcmp1_b32 s100, 19
s_cbranch_scc1 K_END
buffer_load_dword v193, v192, s[24:27], 0 offen sc0 sc1
s_waitcnt vmcnt(0)
v_readfirstlane_b32 s92, v193
s_and_b32 s93, s92, 0xf0
s_cbranch_scc0 SP_X0
s_branch SP_X0_RET
SP_CAND:
s_sleep 2
s_add_u32 s100, s100, 1
s_bitcmp1_b32 s100, 19
s_cbranch_scc1 K_END
s_mov_b32 s29, 0x242000
buffer_load_dwordx2 v[248:249], v250, s[20:23], s29 offen sc0 sc1
s_waitcnt vmcnt(0)
v_cmp_ne_u32 vcc, s47, v249
s_cbranch_vccnz SP_CAND
s_branch SP_CAND_RET
SP_FL:
s_sleep 2
s_add_u32 s100, s100, 1
s_bitcmp1_b32 s100, 19
s_cbranch_scc1 K_END
buffer_load_dword v253, v246, s[24:27], 0 offen sc0 sc1
s_waitcnt vmcnt(0)
v_and_b32 v253, 0x20202020, v253
v_cmp_ne_u32 vcc, 0x20202020, v253
s_cbranch_vccnz SP_FL
s_branch SP_FL_RET
SP_FK:
s_sleep 4
s_add_u32 s100, s100, 1
s_bitcmp1_b32 s100, 19
s_cbranch_scc1 K_END
s_mov_b32 s93, 0x242800
buffer_load_dwordx2 v[120:121], v122, s[20:23], s93 offen sc0 sc1
s_waitcnt vmcnt(0)
v_cmp_ne_u32 vcc, s47, v121
s_cbranch_vccnz SP_FK
s_branch SP_FK_RET
SP_Y:
s_sleep 4
s_add_u32 s100, s100, 1
s_bitcmp1_b32 s100, 19
s_cbranch_scc1 K_END
s_mov_b32 s93, 0x243080
buffer_load_dword v246, v254, s[20:23], s93 offen sc0 sc1
s_waitcnt vmcnt(0)
v_readfirstlane_b32 s93, v246
s_cmp_lt_u32 s93, 144
s_cbranch_scc1 SP_Y
s_branch SP_Y_RET
SP_O1A:
s_sleep 1
s_add_u32 s100, s100, 1
s_bitcmp1_b32 s100, 19
s_cbranch_scc1 K_END
buffer_load_dword v230, v229, s[20:23], s94 offen sc0 sc1
s_waitcnt vmcnt(0)
v_cmp_gt_u32 vcc, 1, v230
s_bitcmp1_b32 vcc_lo, s39
s_cbranch_scc1 SP_O1A
s_branch SP_O1A_RET
SP_O2A:
s_sleep 1
s_add_u32 s100, s100, 1
s_bitcmp1_b32 s100, 19
s_cbranch_scc1 K_END
buffer_load_dword v230, v229, s[20:23], s94 offen sc0 sc1
s_waitcnt vmcnt(0)
v_cmp_gt_u32 vcc, 1, v230
s_and_b32 s29, vcc_lo, 15
s_cbranch_scc1 SP_O2A
s_branch SP_O2A_RET
SP_O3A:
s_sleep 1
s_add_u32 s100, s100, 1
s_bitcmp1_b32 s100, 19
s_cbranch_scc1 K_END
buffer_load_dword v230, v229, s[20:23], s94 offen sc0 sc1
s_waitcnt vmcnt(0)
v_cmp_gt_u32 vcc, 2, v230
s_and_b32 s29, vcc_lo, 15
s_cbranch_scc1 SP_O3A
s_branch SP_O3A_RET
SP_P1A:
s_sleep 1
s_add_u32 s100, s100, 1
s_bitcmp1_b32 s100, 19
s_cbranch_scc1 K_END
buffer_load_dword v230, v229, s[20:23], s95 offen sc0 sc1
s_waitcnt vmcnt(0)
v_cmp_gt_u32 vcc, 1, v230
s_and_b32 s29, vcc_lo, 0xff
s_cbranch_scc1 SP_P1A
s_branch SP_P1A_RET
EV_Y4SP:
s_sleep 8
s_add_u32 s100, s100, 1
s_bitcmp1_b32 s100, 19
s_cbranch_scc1 K_END
v_mov_b32 v246, 0
s_mov_b32 s28, 0x243000
buffer_load_dword v247, v246, s[20:23], s28 offen sc0 sc1
s_waitcnt vmcnt(0)
v_readfirstlane_b32 s28, v247
s_cmp_ge_u32 s28, 144
s_cbranch_scc0 EV_Y4SP
s_branch EV_Y4OK
K_HOT_END:
K_MIXED:
s_waitcnt lgkmcnt(0)
s_barrier
s_add_u32 s28, s30, 147456
v_smfmac_f32_16x16x64_bf16 a[128:131], a[208:211], v[72:79], v245
v_lshrrev_b32 v132, 1, v1
v_and_b32 v132, 8, v132
v_smfmac_f32_16x16x64_bf16 a[132:135], a[208:211], v[80:87], v245
v_xor_b32 v132, v132, v1
v_lshlrev_b32 v132, 4, v132
v_mfma_f32_16x16x32_bf16 a[0:3], v[72:75], a[212:215], a[0:3]
v_add_u32 v132, s28, v132
v_lshlrev_b32 v133, 3, v1
v_mfma_f32_16x16x32_bf16 a[16:19], v[72:75], a[216:219], a[16:19]
v_and_b32 v133, 8, v133
v_lshrrev_b32 v134, 2, v1
v_mfma_f32_16x16x32_bf16 a[32:35], v[72:75], a[220:223], a[32:35]
v_xor_b32 v133, v133, v134
v_and_b32 v134, 3, v1
v_mfma_f32_16x16x32_bf16 a[48:51], v[72:75], a[224:227], a[48:51]
v_lshl_add_u32 v133, v134, 4, v133
v_lshlrev_b32 v133, 4, v133
v_mfma_f32_16x16x32_bf16 a[64:67], v[72:75], a[228:231], a[64:67]
v_add_u32 v133, s28, v133
v_lshlrev_b32 v134, 2, v1
v_mfma_f32_16x16x32_bf16 a[80:83], v[72:75], a[232:235], a[80:83]
v_add_u32 v134, s28, v134
v_lshlrev_b32 v135, 4, v4
v_mfma_f32_16x16x32_bf16 a[96:99], v[72:75], a[236:239], a[96:99]
v_add_u32 v135, s28, v135
v_mfma_f32_16x16x32_bf16 a[112:115], v[72:75], a[240:243], a[112:115]
v_mfma_f32_16x16x32_bf16 a[4:7], v[76:79], a[212:215], a[4:7]
v_accvgpr_read_b32 v120, a128
v_accvgpr_read_b32 v124, a129
v_accvgpr_read_b32 v121, a130
v_mfma_f32_16x16x32_bf16 a[20:23], v[76:79], a[216:219], a[20:23]
v_accvgpr_read_b32 v125, a131
v_accvgpr_read_b32 v122, a132
v_accvgpr_read_b32 v126, a133
v_mfma_f32_16x16x32_bf16 a[36:39], v[76:79], a[220:223], a[36:39]
v_accvgpr_read_b32 v123, a134
v_accvgpr_read_b32 v127, a135
v_add_f32 v120, v120, v124
v_mfma_f32_16x16x32_bf16 a[52:55], v[76:79], a[224:227], a[52:55]
v_add_f32 v121, v121, v125
v_add_f32 v122, v122, v126
v_add_f32 v123, v123, v127
v_mfma_f32_16x16x32_bf16 a[68:71], v[76:79], a[228:231], a[68:71]
v_rcp_f32 v124, v120
v_rcp_f32 v125, v121
v_rcp_f32 v126, v122
v_mfma_f32_16x16x32_bf16 a[84:87], v[76:79], a[232:235], a[84:87]
v_rcp_f32 v127, v123
ds_write_b32 v134, v124 offset:0
ds_write_b32 v134, v125 offset:256
v_mfma_f32_16x16x32_bf16 a[100:103], v[76:79], a[236:239], a[100:103]
ds_write_b32 v134, v126 offset:512
ds_write_b32 v134, v127 offset:768
ds_read_b128 v[88:91], v135 offset:0
v_mfma_f32_16x16x32_bf16 a[116:119], v[76:79], a[240:243], a[116:119]
ds_read_b128 v[92:95], v135 offset:256
ds_read_b128 v[96:99], v135 offset:512
ds_read_b128 v[100:103], v135 offset:768
s_add_u32 s92, s44, 4096
s_add_u32 s93, s44, 8192
s_add_u32 s51, s44, 12288
v_mfma_f32_16x16x32_bf16 a[8:11], v[80:83], a[212:215], a[8:11]
v_accvgpr_read_b32 v104, a0
v_accvgpr_read_b32 v105, a1
v_accvgpr_read_b32 v106, a2
v_accvgpr_read_b32 v107, a3
v_mfma_f32_16x16x32_bf16 a[24:27], v[80:83], a[216:219], a[24:27]
v_accvgpr_read_b32 v108, a16
v_accvgpr_read_b32 v109, a17
v_accvgpr_read_b32 v110, a18
v_accvgpr_read_b32 v111, a19
s_waitcnt lgkmcnt(0)
v_pk_mul_f32 v[104:105], v[104:105], v[88:89]
v_pk_mul_f32 v[106:107], v[106:107], v[90:91]
v_pk_mul_f32 v[108:109], v[108:109], v[88:89]
v_pk_mul_f32 v[110:111], v[110:111], v[90:91]
v_cvt_pk_bf16_f32 v104, v104, v105
v_cvt_pk_bf16_f32 v105, v106, v107
v_cvt_pk_bf16_f32 v106, v108, v109
v_cvt_pk_bf16_f32 v107, v110, v111
v_mfma_f32_16x16x32_bf16 a[40:43], v[80:83], a[220:223], a[40:43]
v_accvgpr_read_b32 v112, a32
v_accvgpr_read_b32 v113, a33
v_accvgpr_read_b32 v114, a34
v_accvgpr_read_b32 v115, a35
ds_write_b128 v132, v[104:107] offset:0
v_mfma_f32_16x16x32_bf16 a[56:59], v[80:83], a[224:227], a[56:59]
v_accvgpr_read_b32 v116, a48
v_accvgpr_read_b32 v117, a49
v_accvgpr_read_b32 v118, a50
v_accvgpr_read_b32 v119, a51
ds_read_b64_tr_b16 v[8:9], v133 offset:0
ds_read_b64_tr_b16 v[10:11], v133 offset:8
v_pk_mul_f32 v[112:113], v[112:113], v[88:89]
v_pk_mul_f32 v[114:115], v[114:115], v[90:91]
v_pk_mul_f32 v[116:117], v[116:117], v[88:89]
v_pk_mul_f32 v[118:119], v[118:119], v[90:91]
v_cvt_pk_bf16_f32 v112, v112, v113
v_cvt_pk_bf16_f32 v113, v114, v115
v_cvt_pk_bf16_f32 v114, v116, v117
v_cvt_pk_bf16_f32 v115, v118, v119
v_mfma_f32_16x16x32_bf16 a[72:75], v[80:83], a[228:231], a[72:75]
v_accvgpr_read_b32 v104, a64
v_accvgpr_read_b32 v105, a65
v_accvgpr_read_b32 v106, a66
v_accvgpr_read_b32 v107, a67
ds_write_b128 v132, v[112:115] offset:1024
v_mfma_f32_16x16x32_bf16 a[88:91], v[80:83], a[232:235], a[88:91]
v_accvgpr_read_b32 v108, a80
v_accvgpr_read_b32 v109, a81
v_accvgpr_read_b32 v110, a82
v_accvgpr_read_b32 v111, a83
ds_read_b64_tr_b16 v[12:13], v133 offset:1024
ds_read_b64_tr_b16 v[14:15], v133 offset:1032
v_pk_mul_f32 v[104:105], v[104:105], v[88:89]
v_pk_mul_f32 v[106:107], v[106:107], v[90:91]
v_pk_mul_f32 v[108:109], v[108:109], v[88:89]
v_pk_mul_f32 v[110:111], v[110:111], v[90:91]
s_waitcnt lgkmcnt(3)
buffer_store_dwordx4 v[8:11], v244, s[20:23], s44 offen offset:0 sc0 sc1
v_cvt_pk_bf16_f32 v104, v104, v105
v_cvt_pk_bf16_f32 v105, v106, v107
v_cvt_pk_bf16_f32 v106, v108, v109
v_cvt_pk_bf16_f32 v107, v110, v111
v_mfma_f32_16x16x32_bf16 a[104:107], v[80:83], a[236:239], a[104:107]
v_accvgpr_read_b32 v112, a96
v_accvgpr_read_b32 v113, a97
v_accvgpr_read_b32 v114, a98
v_accvgpr_read_b32 v115, a99
ds_write_b128 v132, v[104:107] offset:2048
v_mfma_f32_16x16x32_bf16 a[120:123], v[80:83], a[240:243], a[120:123]
v_accvgpr_read_b32 v116, a112
v_accvgpr_read_b32 v117, a113
v_accvgpr_read_b32 v118, a114
v_accvgpr_read_b32 v119, a115
ds_read_b64_tr_b16 v[16:17], v133 offset:2048
ds_read_b64_tr_b16 v[18:19], v133 offset:2056
v_pk_mul_f32 v[112:113], v[112:113], v[88:89]
v_pk_mul_f32 v[114:115], v[114:115], v[90:91]
v_pk_mul_f32 v[116:117], v[116:117], v[88:89]
v_pk_mul_f32 v[118:119], v[118:119], v[90:91]
s_waitcnt lgkmcnt(3)
buffer_store_dwordx4 v[12:15], v244, s[20:23], s44 offen offset:1024 sc0 sc1
v_cvt_pk_bf16_f32 v112, v112, v113
v_cvt_pk_bf16_f32 v113, v114, v115
v_cvt_pk_bf16_f32 v114, v116, v117
v_cvt_pk_bf16_f32 v115, v118, v119
v_mfma_f32_16x16x32_bf16 a[12:15], v[84:87], a[212:215], a[12:15]
v_accvgpr_read_b32 v104, a4
v_accvgpr_read_b32 v105, a5
v_accvgpr_read_b32 v106, a6
v_accvgpr_read_b32 v107, a7
ds_write_b128 v132, v[112:115] offset:3072
v_mfma_f32_16x16x32_bf16 a[28:31], v[84:87], a[216:219], a[28:31]
v_accvgpr_read_b32 v108, a20
v_accvgpr_read_b32 v109, a21
v_accvgpr_read_b32 v110, a22
v_accvgpr_read_b32 v111, a23
ds_read_b64_tr_b16 v[20:21], v133 offset:3072
ds_read_b64_tr_b16 v[22:23], v133 offset:3080
v_pk_mul_f32 v[104:105], v[104:105], v[92:93]
v_pk_mul_f32 v[106:107], v[106:107], v[94:95]
v_pk_mul_f32 v[108:109], v[108:109], v[92:93]
v_pk_mul_f32 v[110:111], v[110:111], v[94:95]
s_waitcnt lgkmcnt(3)
buffer_store_dwordx4 v[16:19], v244, s[20:23], s44 offen offset:2048 sc0 sc1
v_cvt_pk_bf16_f32 v104, v104, v105
v_cvt_pk_bf16_f32 v105, v106, v107
v_cvt_pk_bf16_f32 v106, v108, v109
v_cvt_pk_bf16_f32 v107, v110, v111
v_mfma_f32_16x16x32_bf16 a[44:47], v[84:87], a[220:223], a[44:47]
v_accvgpr_read_b32 v112, a36
v_accvgpr_read_b32 v113, a37
v_accvgpr_read_b32 v114, a38
v_accvgpr_read_b32 v115, a39
ds_write_b128 v132, v[104:107] offset:0
v_mfma_f32_16x16x32_bf16 a[60:63], v[84:87], a[224:227], a[60:63]
v_accvgpr_read_b32 v116, a52
v_accvgpr_read_b32 v117, a53
v_accvgpr_read_b32 v118, a54
v_accvgpr_read_b32 v119, a55
ds_read_b64_tr_b16 v[24:25], v133 offset:0
ds_read_b64_tr_b16 v[26:27], v133 offset:8
v_pk_mul_f32 v[112:113], v[112:113], v[92:93]
v_pk_mul_f32 v[114:115], v[114:115], v[94:95]
v_pk_mul_f32 v[116:117], v[116:117], v[92:93]
v_pk_mul_f32 v[118:119], v[118:119], v[94:95]
s_waitcnt lgkmcnt(3)
buffer_store_dwordx4 v[20:23], v244, s[20:23], s44 offen offset:3072 sc0 sc1
v_cvt_pk_bf16_f32 v112, v112, v113
v_cvt_pk_bf16_f32 v113, v114, v115
v_cvt_pk_bf16_f32 v114, v116, v117
v_cvt_pk_bf16_f32 v115, v118, v119
v_mfma_f32_16x16x32_bf16 a[76:79], v[84:87], a[228:231], a[76:79]
v_accvgpr_read_b32 v104, a68
v_accvgpr_read_b32 v105, a69
v_accvgpr_read_b32 v106, a70
v_accvgpr_read_b32 v107, a71
ds_write_b128 v132, v[112:115] offset:1024
v_mfma_f32_16x16x32_bf16 a[92:95], v[84:87], a[232:235], a[92:95]
v_accvgpr_read_b32 v108, a84
v_accvgpr_read_b32 v109, a85
v_accvgpr_read_b32 v110, a86
v_accvgpr_read_b32 v111, a87
ds_read_b64_tr_b16 v[28:29], v133 offset:1024
ds_read_b64_tr_b16 v[30:31], v133 offset:1032
v_pk_mul_f32 v[104:105], v[104:105], v[92:93]
v_pk_mul_f32 v[106:107], v[106:107], v[94:95]
v_pk_mul_f32 v[108:109], v[108:109], v[92:93]
v_pk_mul_f32 v[110:111], v[110:111], v[94:95]
s_waitcnt lgkmcnt(3)
buffer_store_dwordx4 v[24:27], v244, s[20:23], s92 offen offset:0 sc0 sc1
v_cvt_pk_bf16_f32 v104, v104, v105
v_cvt_pk_bf16_f32 v105, v106, v107
v_cvt_pk_bf16_f32 v106, v108, v109
v_cvt_pk_bf16_f32 v107, v110, v111
v_mfma_f32_16x16x32_bf16 a[108:111], v[84:87], a[236:239], a[108:111]
v_accvgpr_read_b32 v112, a100
v_accvgpr_read_b32 v113, a101
v_accvgpr_read_b32 v114, a102
v_accvgpr_read_b32 v115, a103
ds_write_b128 v132, v[104:107] offset:2048
v_mfma_f32_16x16x32_bf16 a[124:127], v[84:87], a[240:243], a[124:127]
v_accvgpr_read_b32 v116, a116
v_accvgpr_read_b32 v117, a117
v_accvgpr_read_b32 v118, a118
v_accvgpr_read_b32 v119, a119
ds_read_b64_tr_b16 v[32:33], v133 offset:2048
ds_read_b64_tr_b16 v[34:35], v133 offset:2056
v_pk_mul_f32 v[112:113], v[112:113], v[92:93]
v_pk_mul_f32 v[114:115], v[114:115], v[94:95]
v_pk_mul_f32 v[116:117], v[116:117], v[92:93]
v_pk_mul_f32 v[118:119], v[118:119], v[94:95]
s_waitcnt lgkmcnt(3)
buffer_store_dwordx4 v[28:31], v244, s[20:23], s92 offen offset:1024 sc0 sc1
v_cvt_pk_bf16_f32 v112, v112, v113
v_cvt_pk_bf16_f32 v113, v114, v115
v_cvt_pk_bf16_f32 v114, v116, v117
v_cvt_pk_bf16_f32 v115, v118, v119
v_accvgpr_read_b32 v104, a8
v_accvgpr_read_b32 v105, a9
v_accvgpr_read_b32 v106, a10
v_accvgpr_read_b32 v107, a11
ds_write_b128 v132, v[112:115] offset:3072
v_accvgpr_read_b32 v108, a24
v_accvgpr_read_b32 v109, a25
v_accvgpr_read_b32 v110, a26
v_accvgpr_read_b32 v111, a27
ds_read_b64_tr_b16 v[36:37], v133 offset:3072
ds_read_b64_tr_b16 v[38:39], v133 offset:3080
v_pk_mul_f32 v[104:105], v[104:105], v[96:97]
v_pk_mul_f32 v[106:107], v[106:107], v[98:99]
v_pk_mul_f32 v[108:109], v[108:109], v[96:97]
v_pk_mul_f32 v[110:111], v[110:111], v[98:99]
s_waitcnt lgkmcnt(3)
buffer_store_dwordx4 v[32:35], v244, s[20:23], s92 offen offset:2048 sc0 sc1
v_cvt_pk_bf16_f32 v104, v104, v105
v_cvt_pk_bf16_f32 v105, v106, v107
v_cvt_pk_bf16_f32 v106, v108, v109
v_cvt_pk_bf16_f32 v107, v110, v111
v_accvgpr_read_b32 v112, a40
v_accvgpr_read_b32 v113, a41
v_accvgpr_read_b32 v114, a42
v_accvgpr_read_b32 v115, a43
ds_write_b128 v132, v[104:107] offset:0
v_accvgpr_read_b32 v116, a56
v_accvgpr_read_b32 v117, a57
v_accvgpr_read_b32 v118, a58
v_accvgpr_read_b32 v119, a59
ds_read_b64_tr_b16 v[40:41], v133 offset:0
ds_read_b64_tr_b16 v[42:43], v133 offset:8
v_pk_mul_f32 v[112:113], v[112:113], v[96:97]
v_pk_mul_f32 v[114:115], v[114:115], v[98:99]
v_pk_mul_f32 v[116:117], v[116:117], v[96:97]
v_pk_mul_f32 v[118:119], v[118:119], v[98:99]
s_waitcnt lgkmcnt(3)
buffer_store_dwordx4 v[36:39], v244, s[20:23], s92 offen offset:3072 sc0 sc1
v_cvt_pk_bf16_f32 v112, v112, v113
v_cvt_pk_bf16_f32 v113, v114, v115
v_cvt_pk_bf16_f32 v114, v116, v117
v_cvt_pk_bf16_f32 v115, v118, v119
v_accvgpr_read_b32 v104, a72
v_accvgpr_read_b32 v105, a73
v_accvgpr_read_b32 v106, a74
v_accvgpr_read_b32 v107, a75
ds_write_b128 v132, v[112:115] offset:1024
v_accvgpr_read_b32 v108, a88
v_accvgpr_read_b32 v109, a89
v_accvgpr_read_b32 v110, a90
v_accvgpr_read_b32 v111, a91
ds_read_b64_tr_b16 v[44:45], v133 offset:1024
ds_read_b64_tr_b16 v[46:47], v133 offset:1032
v_pk_mul_f32 v[104:105], v[104:105], v[96:97]
v_pk_mul_f32 v[106:107], v[106:107], v[98:99]
v_pk_mul_f32 v[108:109], v[108:109], v[96:97]
v_pk_mul_f32 v[110:111], v[110:111], v[98:99]
s_waitcnt lgkmcnt(3)
buffer_store_dwordx4 v[40:43], v244, s[20:23], s93 offen offset:0 sc0 sc1
v_cvt_pk_bf16_f32 v104, v104, v105
v_cvt_pk_bf16_f32 v105, v106, v107
v_cvt_pk_bf16_f32 v106, v108, v109
v_cvt_pk_bf16_f32 v107, v110, v111
v_accvgpr_read_b32 v112, a104
v_accvgpr_read_b32 v113, a105
v_accvgpr_read_b32 v114, a106
v_accvgpr_read_b32 v115, a107
ds_write_b128 v132, v[104:107] offset:2048
v_accvgpr_read_b32 v116, a120
v_accvgpr_read_b32 v117, a121
v_accvgpr_read_b32 v118, a122
v_accvgpr_read_b32 v119, a123
ds_read_b64_tr_b16 v[48:49], v133 offset:2048
ds_read_b64_tr_b16 v[50:51], v133 offset:2056
v_pk_mul_f32 v[112:113], v[112:113], v[96:97]
v_pk_mul_f32 v[114:115], v[114:115], v[98:99]
v_pk_mul_f32 v[116:117], v[116:117], v[96:97]
v_pk_mul_f32 v[118:119], v[118:119], v[98:99]
s_waitcnt lgkmcnt(3)
buffer_store_dwordx4 v[44:47], v244, s[20:23], s93 offen offset:1024 sc0 sc1
v_cvt_pk_bf16_f32 v112, v112, v113
v_cvt_pk_bf16_f32 v113, v114, v115
v_cvt_pk_bf16_f32 v114, v116, v117
v_cvt_pk_bf16_f32 v115, v118, v119
v_accvgpr_read_b32 v104, a12
v_accvgpr_read_b32 v105, a13
v_accvgpr_read_b32 v106, a14
v_accvgpr_read_b32 v107, a15
ds_write_b128 v132, v[112:115] offset:3072
v_accvgpr_read_b32 v108, a28
v_accvgpr_read_b32 v109, a29
v_accvgpr_read_b32 v110, a30
v_accvgpr_read_b32 v111, a31
ds_read_b64_tr_b16 v[52:53], v133 offset:3072
ds_read_b64_tr_b16 v[54:55], v133 offset:3080
v_pk_mul_f32 v[104:105], v[104:105], v[100:101]
v_pk_mul_f32 v[106:107], v[106:107], v[102:103]
v_pk_mul_f32 v[108:109], v[108:109], v[100:101]
v_pk_mul_f32 v[110:111], v[110:111], v[102:103]
s_waitcnt lgkmcnt(3)
buffer_store_dwordx4 v[48:51], v244, s[20:23], s93 offen offset:2048 sc0 sc1
v_cvt_pk_bf16_f32 v104, v104, v105
v_cvt_pk_bf16_f32 v105, v106, v107
v_cvt_pk_bf16_f32 v106, v108, v109
v_cvt_pk_bf16_f32 v107, v110, v111
v_accvgpr_read_b32 v112, a44
v_accvgpr_read_b32 v113, a45
v_accvgpr_read_b32 v114, a46
v_accvgpr_read_b32 v115, a47
ds_write_b128 v132, v[104:107] offset:0
v_accvgpr_read_b32 v116, a60
v_accvgpr_read_b32 v117, a61
v_accvgpr_read_b32 v118, a62
v_accvgpr_read_b32 v119, a63
ds_read_b64_tr_b16 v[56:57], v133 offset:0
ds_read_b64_tr_b16 v[58:59], v133 offset:8
v_pk_mul_f32 v[112:113], v[112:113], v[100:101]
v_pk_mul_f32 v[114:115], v[114:115], v[102:103]
v_pk_mul_f32 v[116:117], v[116:117], v[100:101]
v_pk_mul_f32 v[118:119], v[118:119], v[102:103]
s_waitcnt lgkmcnt(3)
buffer_store_dwordx4 v[52:55], v244, s[20:23], s93 offen offset:3072 sc0 sc1
v_cvt_pk_bf16_f32 v112, v112, v113
v_cvt_pk_bf16_f32 v113, v114, v115
v_cvt_pk_bf16_f32 v114, v116, v117
v_cvt_pk_bf16_f32 v115, v118, v119
v_accvgpr_read_b32 v104, a76
v_accvgpr_read_b32 v105, a77
v_accvgpr_read_b32 v106, a78
v_accvgpr_read_b32 v107, a79
ds_write_b128 v132, v[112:115] offset:1024
v_accvgpr_read_b32 v108, a92
v_accvgpr_read_b32 v109, a93
v_accvgpr_read_b32 v110, a94
v_accvgpr_read_b32 v111, a95
ds_read_b64_tr_b16 v[60:61], v133 offset:1024
ds_read_b64_tr_b16 v[62:63], v133 offset:1032
v_pk_mul_f32 v[104:105], v[104:105], v[100:101]
v_pk_mul_f32 v[106:107], v[106:107], v[102:103]
v_pk_mul_f32 v[108:109], v[108:109], v[100:101]
v_pk_mul_f32 v[110:111], v[110:111], v[102:103]
s_waitcnt lgkmcnt(3)
buffer_store_dwordx4 v[56:59], v244, s[20:23], s51 offen offset:0 sc0 sc1
v_cvt_pk_bf16_f32 v104, v104, v105
v_cvt_pk_bf16_f32 v105, v106, v107
v_cvt_pk_bf16_f32 v106, v108, v109
v_cvt_pk_bf16_f32 v107, v110, v111
v_accvgpr_read_b32 v112, a108
v_accvgpr_read_b32 v113, a109
v_accvgpr_read_b32 v114, a110
v_accvgpr_read_b32 v115, a111
ds_write_b128 v132, v[104:107] offset:2048
v_accvgpr_read_b32 v116, a124
v_accvgpr_read_b32 v117, a125
v_accvgpr_read_b32 v118, a126
v_accvgpr_read_b32 v119, a127
ds_read_b64_tr_b16 v[64:65], v133 offset:2048
ds_read_b64_tr_b16 v[66:67], v133 offset:2056
v_pk_mul_f32 v[112:113], v[112:113], v[100:101]
v_pk_mul_f32 v[114:115], v[114:115], v[102:103]
v_pk_mul_f32 v[116:117], v[116:117], v[100:101]
v_pk_mul_f32 v[118:119], v[118:119], v[102:103]
s_waitcnt lgkmcnt(3)
buffer_store_dwordx4 v[60:63], v244, s[20:23], s51 offen offset:1024 sc0 sc1
v_cvt_pk_bf16_f32 v112, v112, v113
v_cvt_pk_bf16_f32 v113, v114, v115
v_cvt_pk_bf16_f32 v114, v116, v117
v_cvt_pk_bf16_f32 v115, v118, v119
ds_write_b128 v132, v[112:115] offset:3072
ds_read_b64_tr_b16 v[68:69], v133 offset:3072
ds_read_b64_tr_b16 v[70:71], v133 offset:3080
s_waitcnt lgkmcnt(3)
buffer_store_dwordx4 v[64:67], v244, s[20:23], s51 offen offset:2048 sc0 sc1
v_max3_f32 v104, v120, v121, v122
v_max_f32 v104, v104, v123
v_add_f32 v105, v120, v121
v_add_f32 v105, v105, v122
v_add_f32 v105, v105, v123
v_cmp_nge_f32 vcc, s42, v104
v_cmp_u_f32 s[28:29], v105, v105
s_or_b64 vcc, vcc, s[28:29]
s_cmp_lg_u64 vcc, 0
s_cselect_b32 s28, 1, 0
v_mov_b32 v104, s28
v_mov_b32 v106, 147456
s_waitcnt lgkmcnt(0)
buffer_store_dwordx4 v[68:71], v244, s[20:23], s51 offen offset:3072 sc0 sc1
ds_write_b32 v134, v104
s_waitcnt vmcnt(16) lgkmcnt(0)
s_barrier
ds_read2st64_b32 v[110:111], v106 offset0:32 offset1:48
ds_read2st64_b32 v[108:109], v106 offset0:0 offset1:16
ds_read_b64_tr_b16 a[64:65], v237 offset:0
ds_read_b64_tr_b16 a[66:67], v237 offset:4608
ds_read_b64_tr_b16 a[68:69], v237 offset:9216
ds_read_b64_tr_b16 a[70:71], v237 offset:13824
ds_read_b64_tr_b16 a[72:73], v237 offset:8
ds_read_b64_tr_b16 a[74:75], v237 offset:4616
ds_read_b64_tr_b16 a[76:77], v237 offset:9224
ds_read_b64_tr_b16 a[78:79], v237 offset:13832
ds_read_b64_tr_b16 a[80:81], v238 offset:0
ds_read_b64_tr_b16 a[82:83], v238 offset:4608
ds_read_b64_tr_b16 a[84:85], v238 offset:9216
ds_read_b64_tr_b16 a[86:87], v238 offset:13824
s_waitcnt lgkmcnt(12)
v_or_b32 v108, v108, v109
v_or3_b32 v108, v108, v110, v111
s_nop 0
v_readfirstlane_b32 s28, v108
s_cmp_gt_u32 s28, s43
s_cbranch_scc1 K_FALLBACK
s_waitcnt lgkmcnt(8)
v_mfma_f32_16x16x32_bf16 v[96:99], a[64:67], v[56:59], 0
ds_read_b64_tr_b16 a[88:89], v238 offset:8
ds_read_b64_tr_b16 a[90:91], v238 offset:4616
v_mfma_f32_16x16x32_bf16 v[96:99], a[68:71], v[60:63], v[96:99]
s_lshr_b32 s32, s35, 2
s_and_b32 s33, s35, 3
v_mfma_f32_16x16x32_bf16 v[88:91], a[68:71], v[44:47], 0
s_lshl_b32 s94, s36, 9
s_lshl_b32 s28, s32, 6
v_mfma_f32_16x16x32_bf16 v[88:91], a[64:67], v[40:43], v[88:91]
s_lshr_b32 s34, s32, 2
v_mfma_f32_16x16x32_bf16 v[80:83], a[64:67], v[24:27], 0
ds_read_b64_tr_b16 a[92:93], v238 offset:9224
ds_read_b64_tr_b16 a[94:95], v238 offset:13832
v_mfma_f32_16x16x32_bf16 v[80:83], a[68:71], v[28:31], v[80:83]
s_add_u32 s94, s94, s28
s_lshl_b32 s28, s37, 4
v_mfma_f32_16x16x32_bf16 v[72:75], a[68:71], v[12:15], 0
s_add_u32 s94, s94, s28
s_add_u32 s94, s94, 0x248000
v_mfma_f32_16x16x32_bf16 v[72:75], a[64:67], v[8:11], v[72:75]
v_mov_b32 v231, 1
v_and_b32 v229, 7, v1
s_waitcnt lgkmcnt(8)
v_mfma_f32_16x16x32_bf16 v[76:79], a[72:75], v[8:11], 0
ds_read_b64_tr_b16 a[64:65], v237 offset:128
ds_read_b64_tr_b16 a[66:67], v237 offset:4736
v_mfma_f32_16x16x32_bf16 v[76:79], a[76:79], v[12:15], v[76:79]
v_lshlrev_b32 v229, 2, v229
v_lshlrev_b32 v226, 3, v1
v_mfma_f32_16x16x32_bf16 v[84:87], a[76:79], v[28:31], 0
s_lshl2_add_u32 s29, s33, s94
v_mfma_f32_16x16x32_bf16 v[84:87], a[72:75], v[24:27], v[84:87]
v_mfma_f32_16x16x32_bf16 v[92:95], a[72:75], v[40:43], 0
ds_read_b64_tr_b16 a[68:69], v237 offset:9344
ds_read_b64_tr_b16 a[70:71], v237 offset:13952
v_mfma_f32_16x16x32_bf16 v[92:95], a[76:79], v[44:47], v[92:95]
v_mfma_f32_16x16x32_bf16 v[100:103], a[76:79], v[60:63], 0
v_mfma_f32_16x16x32_bf16 v[100:103], a[72:75], v[56:59], v[100:103]
s_waitcnt lgkmcnt(8)
v_mfma_f32_16x16x32_bf16 v[128:131], a[80:83], v[56:59], 0
ds_read_b64_tr_b16 a[72:73], v237 offset:136
ds_read_b64_tr_b16 a[74:75], v237 offset:4744
v_mfma_f32_16x16x32_bf16 v[128:131], a[84:87], v[60:63], v[128:131]
v_mfma_f32_16x16x32_bf16 v[120:123], a[84:87], v[44:47], 0
v_mfma_f32_16x16x32_bf16 v[120:123], a[80:83], v[40:43], v[120:123]
v_mfma_f32_16x16x32_bf16 v[112:115], a[80:83], v[24:27], 0
ds_read_b64_tr_b16 a[76:77], v237 offset:9352
ds_read_b64_tr_b16 a[78:79], v237 offset:13960
v_mfma_f32_16x16x32_bf16 v[112:115], a[84:87], v[28:31], v[112:115]
s_waitcnt vmcnt(0)
buffer_store_dword v231, v254, s[20:23], s29 offen sc0 sc1
v_mfma_f32_16x16x32_bf16 v[104:107], a[84:87], v[12:15], 0
s_add_u32 s28, s35, 1
s_and_b32 s28, s28, 3
v_mfma_f32_16x16x32_bf16 v[104:107], a[80:83], v[8:11], v[104:107]
s_mul_i32 s28, s28, 36864
s_waitcnt lgkmcnt(8)
v_mfma_f32_16x16x32_bf16 v[108:111], a[88:91], v[8:11], 0
ds_read_b64_tr_b16 a[80:81], v238 offset:128
ds_read_b64_tr_b16 a[82:83], v238 offset:4736
v_mfma_f32_16x16x32_bf16 v[108:111], a[92:95], v[12:15], v[108:111]
v_add_u32 v216, s28, v234
v_add_u32 v217, s28, v235
v_mfma_f32_16x16x32_bf16 v[116:119], a[92:95], v[28:31], 0
v_add_u32 v218, s28, v236
v_mfma_f32_16x16x32_bf16 v[116:119], a[88:91], v[24:27], v[116:119]
v_mfma_f32_16x16x32_bf16 v[124:127], a[88:91], v[40:43], 0
ds_read_b64_tr_b16 a[84:85], v238 offset:9344
ds_read_b64_tr_b16 a[86:87], v238 offset:13952
v_mfma_f32_16x16x32_bf16 v[124:127], a[92:95], v[44:47], v[124:127]
v_mfma_f32_16x16x32_bf16 v[132:135], a[92:95], v[60:63], 0
v_mfma_f32_16x16x32_bf16 v[132:135], a[88:91], v[56:59], v[132:135]
s_waitcnt lgkmcnt(8)
v_mfma_f32_16x16x32_bf16 v[160:163], a[64:67], v[56:59], 0
ds_read_b64_tr_b16 a[88:89], v238 offset:136
ds_read_b64_tr_b16 a[90:91], v238 offset:4744
v_mfma_f32_16x16x32_bf16 v[160:163], a[68:71], v[60:63], v[160:163]
v_mfma_f32_16x16x32_bf16 v[152:155], a[68:71], v[44:47], 0
v_mfma_f32_16x16x32_bf16 v[152:155], a[64:67], v[40:43], v[152:155]
v_mfma_f32_16x16x32_bf16 v[144:147], a[64:67], v[24:27], 0
ds_read_b64_tr_b16 a[92:93], v238 offset:9352
ds_read_b64_tr_b16 a[94:95], v238 offset:13960
v_mfma_f32_16x16x32_bf16 v[144:147], a[68:71], v[28:31], v[144:147]
v_mfma_f32_16x16x32_bf16 v[136:139], a[68:71], v[12:15], 0
v_mfma_f32_16x16x32_bf16 v[136:139], a[64:67], v[8:11], v[136:139]
s_waitcnt lgkmcnt(8)
v_mfma_f32_16x16x32_bf16 v[140:143], a[72:75], v[8:11], 0
ds_read_b64_tr_b16 a[64:65], v239 offset:0
ds_read_b64_tr_b16 a[66:67], v239 offset:4608
v_mfma_f32_16x16x32_bf16 v[140:143], a[76:79], v[12:15], v[140:143]
buffer_load_dword v230, v229, s[20:23], s94 offen sc0 sc1
v_mfma_f32_16x16x32_bf16 v[148:151], a[76:79], v[28:31], 0
s_add_u32 s39, s35, 1
s_and_b32 s39, s39, 3
v_mfma_f32_16x16x32_bf16 v[148:151], a[72:75], v[24:27], v[148:151]
s_add_u32 s28, s33, 1
s_and_b32 s28, s28, 3
v_mfma_f32_16x16x32_bf16 v[156:159], a[72:75], v[40:43], 0
ds_read_b64_tr_b16 a[68:69], v239 offset:9216
ds_read_b64_tr_b16 a[70:71], v239 offset:13824
v_mfma_f32_16x16x32_bf16 v[156:159], a[76:79], v[44:47], v[156:159]
s_sub_u32 s28, s28, s33
s_lshl_b32 s28, s28, 16
v_mfma_f32_16x16x32_bf16 v[164:167], a[76:79], v[60:63], 0
s_add_u32 s64, s28, s44
s_add_u32 s65, s64, 4096
v_mfma_f32_16x16x32_bf16 v[164:167], a[72:75], v[56:59], v[164:167]
s_add_u32 s66, s64, 8192
s_add_u32 s67, s64, 12288
s_waitcnt lgkmcnt(8)
v_mfma_f32_16x16x32_bf16 v[192:195], a[80:83], v[56:59], 0
ds_read_b64_tr_b16 a[72:73], v237 offset:18432
ds_read_b64_tr_b16 a[74:75], v237 offset:23040
v_mfma_f32_16x16x32_bf16 v[192:195], a[84:87], v[60:63], v[192:195]
s_add_u32 s28, s35, 2
s_and_b32 s28, s28, 3
v_mfma_f32_16x16x32_bf16 v[184:187], a[84:87], v[44:47], 0
s_mul_i32 s28, s28, 36864
v_mfma_f32_16x16x32_bf16 v[184:187], a[80:83], v[40:43], v[184:187]
v_add_u32 v219, s28, v234
v_add_u32 v220, s28, v235
v_mfma_f32_16x16x32_bf16 v[176:179], a[80:83], v[24:27], 0
ds_read_b64_tr_b16 a[76:77], v237 offset:27648
ds_read_b64_tr_b16 a[78:79], v237 offset:32256
v_mfma_f32_16x16x32_bf16 v[176:179], a[84:87], v[28:31], v[176:179]
v_add_u32 v221, s28, v236
v_mfma_f32_16x16x32_bf16 v[168:171], a[84:87], v[12:15], 0
s_add_u32 s28, s35, 3
s_and_b32 s28, s28, 3
v_mfma_f32_16x16x32_bf16 v[168:171], a[80:83], v[8:11], v[168:171]
s_mul_i32 s28, s28, 36864
s_waitcnt lgkmcnt(8)
v_mfma_f32_16x16x32_bf16 v[172:175], a[88:91], v[8:11], 0
ds_read_b64_tr_b16 a[80:81], v237 offset:18440
ds_read_b64_tr_b16 a[82:83], v237 offset:23048
v_mfma_f32_16x16x32_bf16 v[172:175], a[92:95], v[12:15], v[172:175]
v_add_u32 v222, s28, v234
v_add_u32 v223, s28, v235
v_mfma_f32_16x16x32_bf16 v[180:183], a[92:95], v[28:31], 0
v_add_u32 v224, s28, v236
v_mfma_f32_16x16x32_bf16 v[180:183], a[88:91], v[24:27], v[180:183]
v_mfma_f32_16x16x32_bf16 v[188:191], a[88:91], v[40:43], 0
ds_read_b64_tr_b16 a[84:85], v237 offset:27656
ds_read_b64_tr_b16 a[86:87], v237 offset:32264
v_mfma_f32_16x16x32_bf16 v[188:191], a[92:95], v[44:47], v[188:191]
v_mfma_f32_16x16x32_bf16 v[196:199], a[92:95], v[60:63], 0
s_waitcnt vmcnt(0)
v_cmp_gt_u32 vcc, 1, v230
v_mfma_f32_16x16x32_bf16 v[196:199], a[88:91], v[56:59], v[196:199]
s_waitcnt lgkmcnt(8)
v_mfma_f32_16x16x32_bf16 v[212:215], a[64:67], v[56:59], 0
ds_read_b64_tr_b16 a[88:89], v238 offset:18432
ds_read_b64_tr_b16 a[90:91], v238 offset:23040
v_mfma_f32_16x16x32_bf16 v[212:215], a[68:71], v[60:63], v[212:215]
s_bitcmp1_b32 vcc_lo, s39
s_cbranch_scc1 SP_O1B
SP_O1B_RET:
v_mfma_f32_16x16x32_bf16 v[208:211], a[68:71], v[44:47], 0
buffer_load_dwordx4 a[156:159], v244, s[20:23], s64 offen offset:0 sc0 sc1
v_mfma_f32_16x16x32_bf16 v[208:211], a[64:67], v[40:43], v[208:211]
v_mfma_f32_16x16x32_bf16 v[204:207], a[64:67], v[24:27], 0
ds_read_b64_tr_b16 a[92:93], v238 offset:27648
ds_read_b64_tr_b16 a[94:95], v238 offset:32256
v_mfma_f32_16x16x32_bf16 v[204:207], a[68:71], v[28:31], v[204:207]
v_mfma_f32_16x16x32_bf16 v[200:203], a[68:71], v[12:15], 0
buffer_load_dwordx4 a[172:175], v244, s[20:23], s65 offen offset:0 sc0 sc1
v_mfma_f32_16x16x32_bf16 v[200:203], a[64:67], v[8:11], v[200:203]
s_waitcnt lgkmcnt(8)
v_mfma_f32_16x16x32_bf16 v[72:75], a[72:75], v[16:19], v[72:75]
ds_read_b64_tr_b16 a[64:65], v238 offset:18440
ds_read_b64_tr_b16 a[66:67], v238 offset:23048
v_mfma_f32_16x16x32_bf16 v[72:75], a[76:79], v[20:23], v[72:75]
v_mfma_f32_16x16x32_bf16 v[80:83], a[76:79], v[36:39], v[80:83]
buffer_load_dwordx4 a[188:191], v244, s[20:23], s66 offen offset:0 sc0 sc1
v_mfma_f32_16x16x32_bf16 v[80:83], a[72:75], v[32:35], v[80:83]
v_mfma_f32_16x16x32_bf16 v[88:91], a[72:75], v[48:51], v[88:91]
ds_read_b64_tr_b16 a[68:69], v238 offset:27656
ds_read_b64_tr_b16 a[70:71], v238 offset:32264
v_mfma_f32_16x16x32_bf16 v[88:91], a[76:79], v[52:55], v[88:91]
v_mfma_f32_16x16x32_bf16 v[96:99], a[76:79], v[68:71], v[96:99]
buffer_load_dwordx4 a[204:207], v244, s[20:23], s67 offen offset:0 sc0 sc1
v_mfma_f32_16x16x32_bf16 v[96:99], a[72:75], v[64:67], v[96:99]
s_waitcnt lgkmcnt(8)
v_mfma_f32_16x16x32_bf16 v[100:103], a[80:83], v[64:67], v[100:103]
ds_read_b64_tr_b16 a[72:73], v237 offset:18560
ds_read_b64_tr_b16 a[74:75], v237 offset:23168
v_mfma_f32_16x16x32_bf16 v[100:103], a[84:87], v[68:71], v[100:103]
v_mfma_f32_16x16x32_bf16 v[92:95], a[84:87], v[52:55], v[92:95]
buffer_load_dwordx4 a[160:163], v244, s[20:23], s64 offen offset:1024 sc0 sc1
v_mfma_f32_16x16x32_bf16 v[92:95], a[80:83], v[48:51], v[92:95]
v_mfma_f32_16x16x32_bf16 v[84:87], a[80:83], v[32:35], v[84:87]
ds_read_b64_tr_b16 a[76:77], v237 offset:27776
ds_read_b64_tr_b16 a[78:79], v237 offset:32384
v_mfma_f32_16x16x32_bf16 v[84:87], a[84:87], v[36:39], v[84:87]
v_mfma_f32_16x16x32_bf16 v[76:79], a[84:87], v[20:23], v[76:79]
buffer_load_dwordx4 a[176:179], v244, s[20:23], s65 offen offset:1024 sc0 sc1
v_mfma_f32_16x16x32_bf16 v[76:79], a[80:83], v[16:19], v[76:79]
s_waitcnt lgkmcnt(8)
v_mfma_f32_16x16x32_bf16 v[104:107], a[88:91], v[16:19], v[104:107]
ds_read_b64_tr_b16 a[80:81], v237 offset:18568
ds_read_b64_tr_b16 a[82:83], v237 offset:23176
v_mfma_f32_16x16x32_bf16 v[104:107], a[92:95], v[20:23], v[104:107]
v_mfma_f32_16x16x32_bf16 v[112:115], a[92:95], v[36:39], v[112:115]
buffer_load_dwordx4 a[192:195], v244, s[20:23], s66 offen offset:1024 sc0 sc1
v_mfma_f32_16x16x32_bf16 v[112:115], a[88:91], v[32:35], v[112:115]
v_mfma_f32_16x16x32_bf16 v[120:123], a[88:91], v[48:51], v[120:123]
ds_read_b64_tr_b16 a[84:85], v237 offset:27784
ds_read_b64_tr_b16 a[86:87], v237 offset:32392
v_mfma_f32_16x16x32_bf16 v[120:123], a[92:95], v[52:55], v[120:123]
v_mfma_f32_16x16x32_bf16 v[128:131], a[92:95], v[68:71], v[128:131]
buffer_load_dwordx4 a[208:211], v244, s[20:23], s67 offen offset:1024 sc0 sc1
v_mfma_f32_16x16x32_bf16 v[128:131], a[88:91], v[64:67], v[128:131]
s_waitcnt lgkmcnt(8)
v_mfma_f32_16x16x32_bf16 v[132:135], a[64:67], v[64:67], v[132:135]
ds_read_b64_tr_b16 a[88:89], v238 offset:18560
ds_read_b64_tr_b16 a[90:91], v238 offset:23168
v_mfma_f32_16x16x32_bf16 v[132:135], a[68:71], v[68:71], v[132:135]
v_mfma_f32_16x16x32_bf16 v[124:127], a[68:71], v[52:55], v[124:127]
buffer_load_dwordx4 a[164:167], v244, s[20:23], s64 offen offset:2048 sc0 sc1
v_mfma_f32_16x16x32_bf16 v[124:127], a[64:67], v[48:51], v[124:127]
buffer_load_dword v230, v229, s[20:23], s94 offen sc0 sc1
v_mfma_f32_16x16x32_bf16 v[116:119], a[64:67], v[32:35], v[116:119]
ds_read_b64_tr_b16 a[92:93], v238 offset:27776
ds_read_b64_tr_b16 a[94:95], v238 offset:32384
v_mfma_f32_16x16x32_bf16 v[116:119], a[68:71], v[36:39], v[116:119]
v_mfma_f32_16x16x32_bf16 v[108:111], a[68:71], v[20:23], v[108:111]
v_mfma_f32_16x16x32_bf16 v[108:111], a[64:67], v[16:19], v[108:111]
buffer_load_dwordx4 a[180:183], v244, s[20:23], s65 offen offset:2048 sc0 sc1
s_waitcnt lgkmcnt(8)
v_mfma_f32_16x16x32_bf16 v[136:139], a[72:75], v[16:19], v[136:139]
ds_read_b64_tr_b16 a[64:65], v238 offset:18568
ds_read_b64_tr_b16 a[66:67], v238 offset:23176
v_mfma_f32_16x16x32_bf16 v[136:139], a[76:79], v[20:23], v[136:139]
v_mfma_f32_16x16x32_bf16 v[144:147], a[76:79], v[36:39], v[144:147]
v_mfma_f32_16x16x32_bf16 v[144:147], a[72:75], v[32:35], v[144:147]
buffer_load_dwordx4 a[196:199], v244, s[20:23], s66 offen offset:2048 sc0 sc1
v_mfma_f32_16x16x32_bf16 v[152:155], a[72:75], v[48:51], v[152:155]
ds_read_b64_tr_b16 a[68:69], v238 offset:27784
ds_read_b64_tr_b16 a[70:71], v238 offset:32392
v_mfma_f32_16x16x32_bf16 v[152:155], a[76:79], v[52:55], v[152:155]
v_mfma_f32_16x16x32_bf16 v[160:163], a[76:79], v[68:71], v[160:163]
v_mfma_f32_16x16x32_bf16 v[160:163], a[72:75], v[64:67], v[160:163]
buffer_load_dwordx4 a[212:215], v244, s[20:23], s67 offen offset:2048 sc0 sc1
s_waitcnt lgkmcnt(8)
v_mfma_f32_16x16x32_bf16 v[164:167], a[80:83], v[64:67], v[164:167]
ds_read_b64_tr_b16 a[72:73], v239 offset:18432
ds_read_b64_tr_b16 a[74:75], v239 offset:23040
v_mfma_f32_16x16x32_bf16 v[164:167], a[84:87], v[68:71], v[164:167]
v_mfma_f32_16x16x32_bf16 v[156:159], a[84:87], v[52:55], v[156:159]
v_mfma_f32_16x16x32_bf16 v[156:159], a[80:83], v[48:51], v[156:159]
buffer_load_dwordx4 a[168:171], v244, s[20:23], s64 offen offset:3072 sc0 sc1
v_mfma_f32_16x16x32_bf16 v[148:151], a[80:83], v[32:35], v[148:151]
ds_read_b64_tr_b16 a[76:77], v239 offset:27648
ds_read_b64_tr_b16 a[78:79], v239 offset:32256
v_mfma_f32_16x16x32_bf16 v[148:151], a[84:87], v[36:39], v[148:151]
v_mfma_f32_16x16x32_bf16 v[140:143], a[84:87], v[20:23], v[140:143]
v_mfma_f32_16x16x32_bf16 v[140:143], a[80:83], v[16:19], v[140:143]
buffer_load_dwordx4 a[184:187], v244, s[20:23], s65 offen offset:3072 sc0 sc1
s_waitcnt lgkmcnt(8)
v_mfma_f32_16x16x32_bf16 v[168:171], a[88:91], v[16:19], v[168:171]
ds_read_b64_tr_b16 a[80:81], v216 offset:0
ds_read_b64_tr_b16 a[82:83], v216 offset:4608
v_mfma_f32_16x16x32_bf16 v[168:171], a[92:95], v[20:23], v[168:171]
v_mfma_f32_16x16x32_bf16 v[176:179], a[92:95], v[36:39], v[176:179]
v_mfma_f32_16x16x32_bf16 v[176:179], a[88:91], v[32:35], v[176:179]
buffer_load_dwordx4 a[200:203], v244, s[20:23], s66 offen offset:3072 sc0 sc1
v_mfma_f32_16x16x32_bf16 v[184:187], a[88:91], v[48:51], v[184:187]
ds_read_b64_tr_b16 a[84:85], v216 offset:9216
ds_read_b64_tr_b16 a[86:87], v216 offset:13824
v_mfma_f32_16x16x32_bf16 v[184:187], a[92:95], v[52:55], v[184:187]
v_mfma_f32_16x16x32_bf16 v[192:195], a[92:95], v[68:71], v[192:195]
v_mfma_f32_16x16x32_bf16 v[192:195], a[88:91], v[64:67], v[192:195]
buffer_load_dwordx4 a[216:219], v244, s[20:23], s67 offen offset:3072 sc0 sc1
s_waitcnt lgkmcnt(8)
v_mfma_f32_16x16x32_bf16 v[196:199], a[64:67], v[64:67], v[196:199]
ds_read_b64_tr_b16 a[88:89], v216 offset:8
ds_read_b64_tr_b16 a[90:91], v216 offset:4616
v_mfma_f32_16x16x32_bf16 v[196:199], a[68:71], v[68:71], v[196:199]
s_add_u32 s28, s33, 2
s_and_b32 s28, s28, 3
v_mfma_f32_16x16x32_bf16 v[188:191], a[68:71], v[52:55], v[188:191]
s_sub_u32 s28, s28, s33
s_lshl_b32 s28, s28, 16
v_mfma_f32_16x16x32_bf16 v[188:191], a[64:67], v[48:51], v[188:191]
s_add_u32 s64, s28, s44
s_add_u32 s65, s64, 4096
v_mfma_f32_16x16x32_bf16 v[180:183], a[64:67], v[32:35], v[180:183]
ds_read_b64_tr_b16 a[92:93], v216 offset:9224
ds_read_b64_tr_b16 a[94:95], v216 offset:13832
v_mfma_f32_16x16x32_bf16 v[180:183], a[68:71], v[36:39], v[180:183]
s_add_u32 s66, s64, 8192
s_add_u32 s67, s64, 12288
v_mfma_f32_16x16x32_bf16 v[172:175], a[68:71], v[20:23], v[172:175]
s_waitcnt vmcnt(7)
v_cmp_gt_u32 vcc, 1, v230
v_mfma_f32_16x16x32_bf16 v[172:175], a[64:67], v[16:19], v[172:175]
s_waitcnt lgkmcnt(8)
v_mfma_f32_16x16x32_bf16 v[200:203], a[72:75], v[16:19], v[200:203]
ds_read_b64_tr_b16 a[64:65], v217 offset:0
ds_read_b64_tr_b16 a[66:67], v217 offset:4608
v_mfma_f32_16x16x32_bf16 v[200:203], a[76:79], v[20:23], v[200:203]
s_and_b32 s29, vcc_lo, 15
s_cbranch_scc1 SP_O2B
SP_O2B_RET:
v_mfma_f32_16x16x32_bf16 v[204:207], a[76:79], v[36:39], v[204:207]
buffer_load_dwordx4 a[220:223], v244, s[20:23], s64 offen offset:0 sc0 sc1
v_mfma_f32_16x16x32_bf16 v[204:207], a[72:75], v[32:35], v[204:207]
v_mfma_f32_16x16x32_bf16 v[208:211], a[72:75], v[48:51], v[208:211]
ds_read_b64_tr_b16 a[68:69], v217 offset:9216
ds_read_b64_tr_b16 a[70:71], v217 offset:13824
v_mfma_f32_16x16x32_bf16 v[208:211], a[76:79], v[52:55], v[208:211]
v_mfma_f32_16x16x32_bf16 v[212:215], a[76:79], v[68:71], v[212:215]
buffer_load_dwordx4 a[236:239], v244, s[20:23], s65 offen offset:0 sc0 sc1
v_mfma_f32_16x16x32_bf16 v[212:215], a[72:75], v[64:67], v[212:215]
s_waitcnt vmcnt(15)
s_waitcnt lgkmcnt(8)
v_mfma_f32_16x16x32_bf16 v[96:99], a[80:83], a[204:207], v[96:99]
ds_read_b64_tr_b16 a[72:73], v217 offset:8
ds_read_b64_tr_b16 a[74:75], v217 offset:4616
s_waitcnt vmcnt(11)
v_mfma_f32_16x16x32_bf16 v[96:99], a[84:87], a[208:211], v[96:99]
v_mfma_f32_16x16x32_bf16 v[88:91], a[84:87], a[192:195], v[88:91]
buffer_load_dwordx4 a[96:99], v244, s[20:23], s66 offen offset:0 sc0 sc1
v_mfma_f32_16x16x32_bf16 v[88:91], a[80:83], a[188:191], v[88:91]
v_accvgpr_read_b32 v39, a136
v_accvgpr_read_b32 v59, a144
v_mfma_f32_16x16x32_bf16 v[80:83], a[80:83], a[172:175], v[80:83]
ds_read_b64_tr_b16 a[76:77], v217 offset:9224
ds_read_b64_tr_b16 a[78:79], v217 offset:13832
v_mfma_f32_16x16x32_bf16 v[80:83], a[84:87], a[176:179], v[80:83]
v_lshlrev_b32 v38, 16, v39
v_and_b32 v39, 0xffff0000, v39
v_mfma_f32_16x16x32_bf16 v[72:75], a[84:87], a[160:163], v[72:75]
buffer_load_dwordx4 a[112:115], v244, s[20:23], s67 offen offset:0 sc0 sc1
v_mfma_f32_16x16x32_bf16 v[72:75], a[80:83], a[156:159], v[72:75]
v_lshlrev_b32 v58, 16, v59
v_and_b32 v59, 0xffff0000, v59
s_waitcnt lgkmcnt(8)
v_mfma_f32_16x16x32_bf16 v[76:79], a[88:91], a[156:159], v[76:79]
ds_read_b64_tr_b16 a[80:81], v216 offset:128
ds_read_b64_tr_b16 a[82:83], v216 offset:4736
v_mfma_f32_16x16x32_bf16 v[76:79], a[92:95], a[160:163], v[76:79]
v_add_f32 v38, v38, v58
v_add_f32 v39, v39, v59
v_mfma_f32_16x16x32_bf16 v[84:87], a[92:95], a[176:179], v[84:87]
buffer_load_dwordx4 a[224:227], v244, s[20:23], s64 offen offset:1024 sc0 sc1
v_mfma_f32_16x16x32_bf16 v[84:87], a[88:91], a[172:175], v[84:87]
v_cvt_pk_bf16_f32 v58, v38, v39
v_lshlrev_b32 v38, 16, v58
v_mfma_f32_16x16x32_bf16 v[92:95], a[88:91], a[188:191], v[92:95]
ds_read_b64_tr_b16 a[84:85], v216 offset:9344
ds_read_b64_tr_b16 a[86:87], v216 offset:13952
v_mfma_f32_16x16x32_bf16 v[92:95], a[92:95], a[192:195], v[92:95]
v_and_b32 v39, 0xffff0000, v58
v_mul_f32 v58, 0xbfb8aa3b, v38
v_mfma_f32_16x16x32_bf16 v[100:103], a[92:95], a[208:211], v[100:103]
buffer_load_dwordx4 a[240:243], v244, s[20:23], s65 offen offset:1024 sc0 sc1
v_mfma_f32_16x16x32_bf16 v[100:103], a[88:91], a[204:207], v[100:103]
v_mul_f32 v59, 0xbfb8aa3b, v39
s_waitcnt lgkmcnt(8)
v_mfma_f32_16x16x32_bf16 v[128:131], a[64:67], a[204:207], v[128:131]
ds_read_b64_tr_b16 a[88:89], v216 offset:136
ds_read_b64_tr_b16 a[90:91], v216 offset:4744
v_mfma_f32_16x16x32_bf16 v[128:131], a[68:71], a[208:211], v[128:131]
v_exp_f32 v58, v58
v_mfma_f32_16x16x32_bf16 v[120:123], a[68:71], a[192:195], v[120:123]
buffer_load_dwordx4 a[100:103], v244, s[20:23], s66 offen offset:1024 sc0 sc1
v_mfma_f32_16x16x32_bf16 v[120:123], a[64:67], a[188:191], v[120:123]
v_exp_f32 v59, v59
v_mfma_f32_16x16x32_bf16 v[112:115], a[64:67], a[172:175], v[112:115]
ds_read_b64_tr_b16 a[92:93], v216 offset:9352
ds_read_b64_tr_b16 a[94:95], v216 offset:13960
v_mfma_f32_16x16x32_bf16 v[112:115], a[68:71], a[176:179], v[112:115]
v_add_f32 v58, 1.0, v58
v_add_f32 v59, 1.0, v59
v_mfma_f32_16x16x32_bf16 v[104:107], a[68:71], a[160:163], v[104:107]
buffer_load_dwordx4 a[116:119], v244, s[20:23], s67 offen offset:1024 sc0 sc1
v_mfma_f32_16x16x32_bf16 v[104:107], a[64:67], a[156:159], v[104:107]
v_rcp_f32 v58, v58
s_waitcnt lgkmcnt(8)
v_mfma_f32_16x16x32_bf16 v[108:111], a[72:75], a[156:159], v[108:111]
ds_read_b64_tr_b16 a[64:65], v217 offset:128
ds_read_b64_tr_b16 a[66:67], v217 offset:4736
v_mfma_f32_16x16x32_bf16 v[108:111], a[76:79], a[160:163], v[108:111]
v_rcp_f32 v59, v59
v_mfma_f32_16x16x32_bf16 v[116:119], a[76:79], a[176:179], v[116:119]
buffer_load_dwordx4 a[228:231], v244, s[20:23], s64 offen offset:2048 sc0 sc1
v_mfma_f32_16x16x32_bf16 v[116:119], a[72:75], a[172:175], v[116:119]
v_mul_f32 v38, v38, v58
v_mul_f32 v39, v39, v59
v_mfma_f32_16x16x32_bf16 v[124:127], a[72:75], a[188:191], v[124:127]
ds_read_b64_tr_b16 a[68:69], v217 offset:9344
ds_read_b64_tr_b16 a[70:71], v217 offset:13952
v_mfma_f32_16x16x32_bf16 v[124:127], a[76:79], a[192:195], v[124:127]
v_cvt_pk_bf16_f32 v58, v38, v39
v_lshlrev_b32 v38, 16, v58
v_mfma_f32_16x16x32_bf16 v[132:135], a[76:79], a[208:211], v[132:135]
buffer_load_dwordx4 a[128:131], v244, s[20:23], s65 offen offset:2048 sc0 sc1
v_mfma_f32_16x16x32_bf16 v[132:135], a[72:75], a[204:207], v[132:135]
v_and_b32 v39, 0xffff0000, v58
v_accvgpr_read_b32 v41, a137
s_waitcnt lgkmcnt(8)
v_mfma_f32_16x16x32_bf16 v[160:163], a[80:83], a[204:207], v[160:163]
ds_read_b64_tr_b16 a[72:73], v217 offset:136
ds_read_b64_tr_b16 a[74:75], v217 offset:4744
v_mfma_f32_16x16x32_bf16 v[160:163], a[84:87], a[208:211], v[160:163]
v_accvgpr_read_b32 v59, a145
v_lshlrev_b32 v40, 16, v41
v_mfma_f32_16x16x32_bf16 v[152:155], a[84:87], a[192:195], v[152:155]
buffer_load_dwordx4 a[104:107], v244, s[20:23], s66 offen offset:2048 sc0 sc1
v_mfma_f32_16x16x32_bf16 v[152:155], a[80:83], a[188:191], v[152:155]
v_and_b32 v41, 0xffff0000, v41
v_lshlrev_b32 v58, 16, v59
v_mfma_f32_16x16x32_bf16 v[144:147], a[80:83], a[172:175], v[144:147]
ds_read_b64_tr_b16 a[76:77], v217 offset:9352
ds_read_b64_tr_b16 a[78:79], v217 offset:13960
v_mfma_f32_16x16x32_bf16 v[144:147], a[84:87], a[176:179], v[144:147]
v_and_b32 v59, 0xffff0000, v59
v_add_f32 v40, v40, v58
v_mfma_f32_16x16x32_bf16 v[136:139], a[84:87], a[160:163], v[136:139]
buffer_load_dwordx4 a[120:123], v244, s[20:23], s67 offen offset:2048 sc0 sc1
v_mfma_f32_16x16x32_bf16 v[136:139], a[80:83], a[156:159], v[136:139]
v_add_f32 v41, v41, v59
v_cvt_pk_bf16_f32 v58, v40, v41
s_waitcnt lgkmcnt(8)
v_mfma_f32_16x16x32_bf16 v[140:143], a[88:91], a[156:159], v[140:143]
ds_read_b64_tr_b16 a[80:81], v218 offset:0
ds_read_b64_tr_b16 a[82:83], v218 offset:4608
v_mfma_f32_16x16x32_bf16 v[140:143], a[92:95], a[160:163], v[140:143]
v_lshlrev_b32 v40, 16, v58
v_and_b32 v41, 0xffff0000, v58
v_mfma_f32_16x16x32_bf16 v[148:151], a[92:95], a[176:179], v[148:151]
buffer_load_dwordx4 a[232:235], v244, s[20:23], s64 offen offset:3072 sc0 sc1
v_mfma_f32_16x16x32_bf16 v[148:151], a[88:91], a[172:175], v[148:151]
v_mul_f32 v58, 0xbfb8aa3b, v40
v_mul_f32 v59, 0xbfb8aa3b, v41
v_mfma_f32_16x16x32_bf16 v[156:159], a[88:91], a[188:191], v[156:159]
ds_read_b64_tr_b16 a[84:85], v218 offset:9216
ds_read_b64_tr_b16 a[86:87], v218 offset:13824
v_mfma_f32_16x16x32_bf16 v[156:159], a[92:95], a[192:195], v[156:159]
v_exp_f32 v58, v58
v_mfma_f32_16x16x32_bf16 v[164:167], a[92:95], a[208:211], v[164:167]
buffer_load_dwordx4 a[132:135], v244, s[20:23], s65 offen offset:3072 sc0 sc1
v_mfma_f32_16x16x32_bf16 v[164:167], a[88:91], a[204:207], v[164:167]
v_exp_f32 v59, v59
s_waitcnt lgkmcnt(8)
v_mfma_f32_16x16x32_bf16 v[192:195], a[64:67], a[204:207], v[192:195]
ds_read_b64_tr_b16 a[88:89], v216 offset:18432
ds_read_b64_tr_b16 a[90:91], v216 offset:23040
v_mfma_f32_16x16x32_bf16 v[192:195], a[68:71], a[208:211], v[192:195]
v_add_f32 v58, 1.0, v58
v_add_f32 v59, 1.0, v59
v_mfma_f32_16x16x32_bf16 v[184:187], a[68:71], a[192:195], v[184:187]
buffer_load_dwordx4 a[108:111], v244, s[20:23], s66 offen offset:3072 sc0 sc1
v_mfma_f32_16x16x32_bf16 v[184:187], a[64:67], a[188:191], v[184:187]
v_rcp_f32 v58, v58
v_mfma_f32_16x16x32_bf16 v[176:179], a[64:67], a[172:175], v[176:179]
ds_read_b64_tr_b16 a[92:93], v216 offset:27648
ds_read_b64_tr_b16 a[94:95], v216 offset:32256
v_mfma_f32_16x16x32_bf16 v[176:179], a[68:71], a[176:179], v[176:179]
v_rcp_f32 v59, v59
v_mfma_f32_16x16x32_bf16 v[168:171], a[68:71], a[160:163], v[168:171]
buffer_load_dwordx4 a[124:127], v244, s[20:23], s67 offen offset:3072 sc0 sc1
v_mfma_f32_16x16x32_bf16 v[168:171], a[64:67], a[156:159], v[168:171]
s_add_u32 s28, s33, 3
s_and_b32 s28, s28, 3
s_waitcnt lgkmcnt(8)
v_mfma_f32_16x16x32_bf16 v[172:175], a[72:75], a[156:159], v[172:175]
ds_read_b64_tr_b16 a[64:65], v216 offset:18440
ds_read_b64_tr_b16 a[66:67], v216 offset:23048
v_mfma_f32_16x16x32_bf16 v[172:175], a[76:79], a[160:163], v[172:175]
s_sub_u32 s28, s28, s33
s_lshl_b32 s28, s28, 16
v_mfma_f32_16x16x32_bf16 v[180:183], a[76:79], a[176:179], v[180:183]
s_add_u32 s64, s28, s44
s_add_u32 s65, s64, 4096
v_mfma_f32_16x16x32_bf16 v[180:183], a[72:75], a[172:175], v[180:183]
s_add_u32 s66, s64, 8192
s_add_u32 s67, s64, 12288
v_mfma_f32_16x16x32_bf16 v[188:191], a[72:75], a[188:191], v[188:191]
ds_read_b64_tr_b16 a[68:69], v216 offset:27656
ds_read_b64_tr_b16 a[70:71], v216 offset:32264
v_mfma_f32_16x16x32_bf16 v[188:191], a[76:79], a[192:195], v[188:191]
buffer_load_dwordx4 a[0:3], v244, s[20:23], s64 offen offset:0 sc0 sc1
v_mfma_f32_16x16x32_bf16 v[196:199], a[76:79], a[208:211], v[196:199]
v_mul_f32 v40, v40, v58
v_mul_f32 v41, v41, v59
v_mfma_f32_16x16x32_bf16 v[196:199], a[72:75], a[204:207], v[196:199]
v_cvt_pk_bf16_f32 v58, v40, v41
v_lshlrev_b32 v40, 16, v58
s_waitcnt lgkmcnt(8)
v_mfma_f32_16x16x32_bf16 v[212:215], a[80:83], a[204:207], v[212:215]
ds_read_b64_tr_b16 a[72:73], v217 offset:18432
ds_read_b64_tr_b16 a[74:75], v217 offset:23040
v_mfma_f32_16x16x32_bf16 v[212:215], a[84:87], a[208:211], v[212:215]
buffer_load_dwordx4 a[16:19], v244, s[20:23], s65 offen offset:0 sc0 sc1
v_mfma_f32_16x16x32_bf16 v[208:211], a[84:87], a[192:195], v[208:211]
v_and_b32 v41, 0xffff0000, v58
v_accvgpr_read_b32 v43, a138
v_mfma_f32_16x16x32_bf16 v[208:211], a[80:83], a[188:191], v[208:211]
v_accvgpr_read_b32 v59, a146
v_lshlrev_b32 v42, 16, v43
v_mfma_f32_16x16x32_bf16 v[204:207], a[80:83], a[172:175], v[204:207]
ds_read_b64_tr_b16 a[76:77], v217 offset:27648
ds_read_b64_tr_b16 a[78:79], v217 offset:32256
v_mfma_f32_16x16x32_bf16 v[204:207], a[84:87], a[176:179], v[204:207]
buffer_load_dwordx4 a[32:35], v244, s[20:23], s66 offen offset:0 sc0 sc1
v_mfma_f32_16x16x32_bf16 v[200:203], a[84:87], a[160:163], v[200:203]
v_and_b32 v43, 0xffff0000, v43
v_lshlrev_b32 v58, 16, v59
v_mfma_f32_16x16x32_bf16 v[200:203], a[80:83], a[156:159], v[200:203]
v_and_b32 v59, 0xffff0000, v59
v_add_f32 v42, v42, v58
s_waitcnt vmcnt(23)
s_waitcnt lgkmcnt(8)
v_mfma_f32_16x16x32_bf16 v[72:75], a[88:91], a[164:167], v[72:75]
ds_read_b64_tr_b16 a[80:81], v217 offset:18440
ds_read_b64_tr_b16 a[82:83], v217 offset:23048
s_waitcnt vmcnt(19)
v_mfma_f32_16x16x32_bf16 v[72:75], a[92:95], a[168:171], v[72:75]
buffer_load_dwordx4 a[48:51], v244, s[20:23], s67 offen offset:0 sc0 sc1
v_mfma_f32_16x16x32_bf16 v[80:83], a[92:95], a[184:187], v[80:83]
v_add_f32 v43, v43, v59
v_cvt_pk_bf16_f32 v58, v42, v43
v_mfma_f32_16x16x32_bf16 v[80:83], a[88:91], a[180:183], v[80:83]
v_lshlrev_b32 v42, 16, v58
v_and_b32 v43, 0xffff0000, v58
v_mfma_f32_16x16x32_bf16 v[88:91], a[88:91], a[196:199], v[88:91]
ds_read_b64_tr_b16 a[84:85], v217 offset:27656
ds_read_b64_tr_b16 a[86:87], v217 offset:32264
v_mfma_f32_16x16x32_bf16 v[88:91], a[92:95], a[200:203], v[88:91]
buffer_load_dwordx4 a[4:7], v244, s[20:23], s64 offen offset:1024 sc0 sc1
v_mfma_f32_16x16x32_bf16 v[96:99], a[92:95], a[216:219], v[96:99]
v_mul_f32 v58, 0xbfb8aa3b, v42
v_mul_f32 v59, 0xbfb8aa3b, v43
v_mfma_f32_16x16x32_bf16 v[96:99], a[88:91], a[212:215], v[96:99]
v_exp_f32 v58, v58
s_waitcnt lgkmcnt(8)
v_mfma_f32_16x16x32_bf16 v[100:103], a[64:67], a[212:215], v[100:103]
ds_read_b64_tr_b16 a[88:89], v216 offset:18560
ds_read_b64_tr_b16 a[90:91], v216 offset:23168
v_mfma_f32_16x16x32_bf16 v[100:103], a[68:71], a[216:219], v[100:103]
buffer_load_dwordx4 a[20:23], v244, s[20:23], s65 offen offset:1024 sc0 sc1
v_mfma_f32_16x16x32_bf16 v[92:95], a[68:71], a[200:203], v[92:95]
v_exp_f32 v59, v59
v_mfma_f32_16x16x32_bf16 v[92:95], a[64:67], a[196:199], v[92:95]
v_add_f32 v58, 1.0, v58
v_add_f32 v59, 1.0, v59
v_mfma_f32_16x16x32_bf16 v[84:87], a[64:67], a[180:183], v[84:87]
ds_read_b64_tr_b16 a[92:93], v216 offset:27776
ds_read_b64_tr_b16 a[94:95], v216 offset:32384
v_mfma_f32_16x16x32_bf16 v[84:87], a[68:71], a[184:187], v[84:87]
buffer_load_dwordx4 a[36:39], v244, s[20:23], s66 offen offset:1024 sc0 sc1
v_mfma_f32_16x16x32_bf16 v[76:79], a[68:71], a[168:171], v[76:79]
v_rcp_f32 v58, v58
v_mfma_f32_16x16x32_bf16 v[76:79], a[64:67], a[164:167], v[76:79]
v_rcp_f32 v59, v59
s_waitcnt lgkmcnt(8)
v_mfma_f32_16x16x32_bf16 v[104:107], a[72:75], a[164:167], v[104:107]
ds_read_b64_tr_b16 a[64:65], v216 offset:18568
ds_read_b64_tr_b16 a[66:67], v216 offset:23176
v_mfma_f32_16x16x32_bf16 v[104:107], a[76:79], a[168:171], v[104:107]
buffer_load_dwordx4 a[52:55], v244, s[20:23], s67 offen offset:1024 sc0 sc1
v_mfma_f32_16x16x32_bf16 v[112:115], a[76:79], a[184:187], v[112:115]
v_mul_f32 v42, v42, v58
v_mul_f32 v43, v43, v59
v_mfma_f32_16x16x32_bf16 v[112:115], a[72:75], a[180:183], v[112:115]
v_cvt_pk_bf16_f32 v58, v42, v43
v_lshlrev_b32 v42, 16, v58
v_mfma_f32_16x16x32_bf16 v[120:123], a[72:75], a[196:199], v[120:123]
ds_read_b64_tr_b16 a[68:69], v216 offset:27784
ds_read_b64_tr_b16 a[70:71], v216 offset:32392
v_mfma_f32_16x16x32_bf16 v[120:123], a[76:79], a[200:203], v[120:123]
buffer_load_dwordx4 a[8:11], v244, s[20:23], s64 offen offset:2048 sc0 sc1
v_mfma_f32_16x16x32_bf16 v[128:131], a[76:79], a[216:219], v[128:131]
v_and_b32 v43, 0xffff0000, v58
v_accvgpr_read_b32 v45, a139
v_mfma_f32_16x16x32_bf16 v[128:131], a[72:75], a[212:215], v[128:131]
v_accvgpr_read_b32 v59, a147
v_lshlrev_b32 v44, 16, v45
s_waitcnt lgkmcnt(8)
v_mfma_f32_16x16x32_bf16 v[132:135], a[80:83], a[212:215], v[132:135]
ds_read_b64_tr_b16 a[72:73], v217 offset:18560
ds_read_b64_tr_b16 a[74:75], v217 offset:23168
v_mfma_f32_16x16x32_bf16 v[132:135], a[84:87], a[216:219], v[132:135]
buffer_load_dwordx4 a[24:27], v244, s[20:23], s65 offen offset:2048 sc0 sc1
v_mfma_f32_16x16x32_bf16 v[124:127], a[84:87], a[200:203], v[124:127]
v_and_b32 v45, 0xffff0000, v45
v_lshlrev_b32 v58, 16, v59
v_mfma_f32_16x16x32_bf16 v[124:127], a[80:83], a[196:199], v[124:127]
v_and_b32 v59, 0xffff0000, v59
v_add_f32 v44, v44, v58
v_mfma_f32_16x16x32_bf16 v[116:119], a[80:83], a[180:183], v[116:119]
ds_read_b64_tr_b16 a[76:77], v217 offset:27776
ds_read_b64_tr_b16 a[78:79], v217 offset:32384
v_mfma_f32_16x16x32_bf16 v[116:119], a[84:87], a[184:187], v[116:119]
buffer_load_dwordx4 a[40:43], v244, s[20:23], s66 offen offset:2048 sc0 sc1
v_mfma_f32_16x16x32_bf16 v[108:111], a[84:87], a[168:171], v[108:111]
v_add_f32 v45, v45, v59
v_cvt_pk_bf16_f32 v58, v44, v45
v_mfma_f32_16x16x32_bf16 v[108:111], a[80:83], a[164:167], v[108:111]
v_lshlrev_b32 v44, 16, v58
v_and_b32 v45, 0xffff0000, v58
s_waitcnt lgkmcnt(8)
v_mfma_f32_16x16x32_bf16 v[136:139], a[88:91], a[164:167], v[136:139]
ds_read_b64_tr_b16 a[80:81], v217 offset:18568
ds_read_b64_tr_b16 a[82:83], v217 offset:23176
v_mfma_f32_16x16x32_bf16 v[136:139], a[92:95], a[168:171], v[136:139]
buffer_load_dwordx4 a[56:59], v244, s[20:23], s67 offen offset:2048 sc0 sc1
v_mfma_f32_16x16x32_bf16 v[144:147], a[92:95], a[184:187], v[144:147]
v_mul_f32 v58, 0xbfb8aa3b, v44
v_mul_f32 v59, 0xbfb8aa3b, v45
v_mfma_f32_16x16x32_bf16 v[144:147], a[88:91], a[180:183], v[144:147]
v_exp_f32 v58, v58
v_mfma_f32_16x16x32_bf16 v[152:155], a[88:91], a[196:199], v[152:155]
ds_read_b64_tr_b16 a[84:85], v217 offset:27784
ds_read_b64_tr_b16 a[86:87], v217 offset:32392
v_mfma_f32_16x16x32_bf16 v[152:155], a[92:95], a[200:203], v[152:155]
buffer_load_dwordx4 a[12:15], v244, s[20:23], s64 offen offset:3072 sc0 sc1
v_mfma_f32_16x16x32_bf16 v[160:163], a[92:95], a[216:219], v[160:163]
v_exp_f32 v59, v59
v_mfma_f32_16x16x32_bf16 v[160:163], a[88:91], a[212:215], v[160:163]
v_add_f32 v58, 1.0, v58
v_add_f32 v59, 1.0, v59
s_waitcnt lgkmcnt(8)
v_mfma_f32_16x16x32_bf16 v[164:167], a[64:67], a[212:215], v[164:167]
ds_read_b64_tr_b16 a[88:89], v218 offset:18432
ds_read_b64_tr_b16 a[90:91], v218 offset:23040
v_mfma_f32_16x16x32_bf16 v[164:167], a[68:71], a[216:219], v[164:167]
buffer_load_dwordx4 a[28:31], v244, s[20:23], s65 offen offset:3072 sc0 sc1
v_mfma_f32_16x16x32_bf16 v[156:159], a[68:71], a[200:203], v[156:159]
v_rcp_f32 v58, v58
v_mfma_f32_16x16x32_bf16 v[156:159], a[64:67], a[196:199], v[156:159]
v_rcp_f32 v59, v59
v_mfma_f32_16x16x32_bf16 v[148:151], a[64:67], a[180:183], v[148:151]
ds_read_b64_tr_b16 a[92:93], v218 offset:27648
ds_read_b64_tr_b16 a[94:95], v218 offset:32256
v_mfma_f32_16x16x32_bf16 v[148:151], a[68:71], a[184:187], v[148:151]
buffer_load_dwordx4 a[44:47], v244, s[20:23], s66 offen offset:3072 sc0 sc1
v_mfma_f32_16x16x32_bf16 v[140:143], a[68:71], a[168:171], v[140:143]
v_mul_f32 v44, v44, v58
v_mul_f32 v45, v45, v59
v_mfma_f32_16x16x32_bf16 v[140:143], a[64:67], a[164:167], v[140:143]
v_cvt_pk_bf16_f32 v58, v44, v45
v_lshlrev_b32 v44, 16, v58
s_waitcnt lgkmcnt(8)
v_mfma_f32_16x16x32_bf16 v[168:171], a[72:75], a[164:167], v[168:171]
ds_read_b64_tr_b16 a[64:65], v220 offset:0
ds_read_b64_tr_b16 a[66:67], v220 offset:4608
v_mfma_f32_16x16x32_bf16 v[168:171], a[76:79], a[168:171], v[168:171]
buffer_load_dwordx4 a[60:63], v244, s[20:23], s67 offen offset:3072 sc0 sc1
v_mfma_f32_16x16x32_bf16 v[176:179], a[76:79], a[184:187], v[176:179]
s_lshl2_add_u32 s28, s36, s33
s_lshl2_add_u32 s28, s28, s37
v_mfma_f32_16x16x32_bf16 v[176:179], a[72:75], a[180:183], v[176:179]
s_lshl_b32 s95, s28, 5
s_add_u32 s95, s95, 0x24a000
v_mfma_f32_16x16x32_bf16 v[184:187], a[72:75], a[196:199], v[184:187]
ds_read_b64_tr_b16 a[68:69], v220 offset:9216
ds_read_b64_tr_b16 a[70:71], v220 offset:13824
v_mfma_f32_16x16x32_bf16 v[184:187], a[76:79], a[200:203], v[184:187]
s_lshl_b32 s28, s32, 18
s_sub_u32 s49, s44, s28
v_mfma_f32_16x16x32_bf16 v[192:195], a[76:79], a[216:219], v[192:195]
v_add_u32 v243, 0x2000, v244
v_mov_b32 v246, 2
v_mfma_f32_16x16x32_bf16 v[192:195], a[72:75], a[212:215], v[192:195]
s_lshl2_add_u32 s29, s33, s94
v_and_b32 v45, 0xffff0000, v58
s_waitcnt lgkmcnt(8)
v_mfma_f32_16x16x32_bf16 v[196:199], a[80:83], a[212:215], v[196:199]
ds_read_b64_tr_b16 a[72:73], v220 offset:18432
ds_read_b64_tr_b16 a[74:75], v220 offset:23040
v_mfma_f32_16x16x32_bf16 v[196:199], a[84:87], a[216:219], v[196:199]
v_accvgpr_read_b32 v47, a140
v_accvgpr_read_b32 v59, a148
v_mfma_f32_16x16x32_bf16 v[188:191], a[84:87], a[200:203], v[188:191]
v_lshlrev_b32 v46, 16, v47
v_and_b32 v47, 0xffff0000, v47
v_mfma_f32_16x16x32_bf16 v[188:191], a[80:83], a[196:199], v[188:191]
v_lshlrev_b32 v58, 16, v59
v_and_b32 v59, 0xffff0000, v59
v_mfma_f32_16x16x32_bf16 v[180:183], a[80:83], a[180:183], v[180:183]
ds_read_b64_tr_b16 a[76:77], v220 offset:27648
ds_read_b64_tr_b16 a[78:79], v220 offset:32256
v_mfma_f32_16x16x32_bf16 v[180:183], a[84:87], a[184:187], v[180:183]
v_add_f32 v46, v46, v58
v_add_f32 v47, v47, v59
v_mfma_f32_16x16x32_bf16 v[172:175], a[84:87], a[168:171], v[172:175]
v_cvt_pk_bf16_f32 v58, v46, v47
v_lshlrev_b32 v46, 16, v58
v_mfma_f32_16x16x32_bf16 v[172:175], a[80:83], a[164:167], v[172:175]
v_and_b32 v47, 0xffff0000, v58
v_mul_f32 v58, 0xbfb8aa3b, v46
s_waitcnt lgkmcnt(8)
v_mfma_f32_16x16x32_bf16 v[200:203], a[88:91], a[164:167], v[200:203]
ds_read_b64_tr_b16 a[80:81], v223 offset:0
ds_read_b64_tr_b16 a[82:83], v223 offset:4608
v_mfma_f32_16x16x32_bf16 v[200:203], a[92:95], a[168:171], v[200:203]
v_mul_f32 v59, 0xbfb8aa3b, v47
v_mfma_f32_16x16x32_bf16 v[204:207], a[92:95], a[184:187], v[204:207]
v_exp_f32 v58, v58
v_mfma_f32_16x16x32_bf16 v[204:207], a[88:91], a[180:183], v[204:207]
v_exp_f32 v59, v59
v_mfma_f32_16x16x32_bf16 v[208:211], a[88:91], a[196:199], v[208:211]
ds_read_b64_tr_b16 a[84:85], v223 offset:9216
ds_read_b64_tr_b16 a[86:87], v223 offset:13824
v_mfma_f32_16x16x32_bf16 v[208:211], a[92:95], a[200:203], v[208:211]
v_add_f32 v58, 1.0, v58
v_add_f32 v59, 1.0, v59
v_mfma_f32_16x16x32_bf16 v[212:215], a[92:95], a[216:219], v[212:215]
v_rcp_f32 v58, v58
v_mfma_f32_16x16x32_bf16 v[212:215], a[88:91], a[212:215], v[212:215]
v_rcp_f32 v59, v59
s_waitcnt vmcnt(28)
s_waitcnt lgkmcnt(8)
v_mfma_f32_16x16x32_bf16 v[128:131], a[64:67], a[112:115], v[128:131]
ds_read_b64_tr_b16 a[88:89], v223 offset:18432
ds_read_b64_tr_b16 a[90:91], v223 offset:23040
s_waitcnt vmcnt(24)
v_mfma_f32_16x16x32_bf16 v[128:131], a[68:71], a[116:119], v[128:131]
v_mul_f32 v46, v46, v58
v_mul_f32 v47, v47, v59
v_mfma_f32_16x16x32_bf16 v[120:123], a[68:71], a[100:103], v[120:123]
v_cvt_pk_bf16_f32 v58, v46, v47
v_lshlrev_b32 v46, 16, v58
v_mfma_f32_16x16x32_bf16 v[120:123], a[64:67], a[96:99], v[120:123]
v_and_b32 v47, 0xffff0000, v58
v_accvgpr_read_b32 v49, a141
v_mfma_f32_16x16x32_bf16 v[112:115], a[64:67], a[236:239], v[112:115]
ds_read_b64_tr_b16 a[92:93], v223 offset:27648
ds_read_b64_tr_b16 a[94:95], v223 offset:32256
v_mfma_f32_16x16x32_bf16 v[112:115], a[68:71], a[240:243], v[112:115]
v_accvgpr_read_b32 v59, a149
v_lshlrev_b32 v48, 16, v49
v_mfma_f32_16x16x32_bf16 v[104:107], a[68:71], a[224:227], v[104:107]
v_and_b32 v49, 0xffff0000, v49
v_lshlrev_b32 v58, 16, v59
v_mfma_f32_16x16x32_bf16 v[104:107], a[64:67], a[220:223], v[104:107]
s_waitcnt vmcnt(0)
buffer_store_dword v246, v254, s[20:23], s29 offen sc0 sc1
s_waitcnt vmcnt(21)
s_waitcnt lgkmcnt(8)
v_mfma_f32_16x16x32_bf16 v[104:107], a[72:75], a[228:231], v[104:107]
ds_read_b64_tr_b16 a[64:65], v220 offset:8
ds_read_b64_tr_b16 a[66:67], v220 offset:4616
s_waitcnt vmcnt(17)
v_mfma_f32_16x16x32_bf16 v[104:107], a[76:79], a[232:235], v[104:107]
s_xor_b32 s28, s32, 0
s_sub_u32 s29, s32, s28
v_mfma_f32_16x16x32_bf16 v[112:115], a[76:79], a[132:135], v[112:115]
s_lshl_b32 s28, s28, 18
s_and_b32 s29, s29, 3
v_mfma_f32_16x16x32_bf16 v[112:115], a[72:75], a[128:131], v[112:115]
s_add_u32 s28, s28, s49
s_lshl_b32 s50, s29, 10
v_mfma_f32_16x16x32_bf16 v[120:123], a[72:75], a[104:107], v[120:123]
ds_read_b64_tr_b16 a[68:69], v220 offset:9224
ds_read_b64_tr_b16 a[70:71], v220 offset:13832
v_mfma_f32_16x16x32_bf16 v[120:123], a[76:79], a[108:111], v[120:123]
s_mul_i32 s29, s29, 0x1200
s_and_b32 s29, s29, 0x2200
v_mfma_f32_16x16x32_bf16 v[128:131], a[76:79], a[124:127], v[128:131]
s_add_u32 s72, s28, s29
v_and_b32 v59, 0xffff0000, v59
v_mfma_f32_16x16x32_bf16 v[128:131], a[72:75], a[120:123], v[128:131]
s_xor_b32 s28, s32, 1
s_sub_u32 s29, s32, s28
s_waitcnt vmcnt(13)
s_waitcnt lgkmcnt(8)
v_mfma_f32_16x16x32_bf16 v[128:131], a[80:83], a[48:51], v[128:131]
ds_read_b64_tr_b16 a[72:73], v220 offset:18440
ds_read_b64_tr_b16 a[74:75], v220 offset:23048
s_waitcnt vmcnt(9)
v_mfma_f32_16x16x32_bf16 v[128:131], a[84:87], a[52:55], v[128:131]
s_lshl_b32 s28, s28, 18
s_and_b32 s29, s29, 3
v_mfma_f32_16x16x32_bf16 v[120:123], a[84:87], a[36:39], v[120:123]
s_add_u32 s28, s28, s49
s_lshl_b32 s50, s29, 10
v_mfma_f32_16x16x32_bf16 v[120:123], a[80:83], a[32:35], v[120:123]
s_add_u32 s65, s28, s50
v_add_f32 v48, v48, v58
v_mfma_f32_16x16x32_bf16 v[112:115], a[80:83], a[16:19], v[112:115]
ds_read_b64_tr_b16 a[76:77], v220 offset:27656
ds_read_b64_tr_b16 a[78:79], v220 offset:32264
v_mfma_f32_16x16x32_bf16 v[112:115], a[84:87], a[20:23], v[112:115]
s_mul_i32 s29, s29, 0x1200
s_and_b32 s29, s29, 0x2200
v_mfma_f32_16x16x32_bf16 v[104:107], a[84:87], a[4:7], v[104:107]
s_add_u32 s73, s28, s29
v_add_f32 v49, v49, v59
v_mfma_f32_16x16x32_bf16 v[104:107], a[80:83], a[0:3], v[104:107]
s_xor_b32 s28, s32, 2
s_sub_u32 s29, s32, s28
s_waitcnt vmcnt(5)
s_waitcnt lgkmcnt(8)
v_mfma_f32_16x16x32_bf16 v[104:107], a[88:91], a[8:11], v[104:107]
ds_read_b64_tr_b16 a[80:81], v223 offset:8
ds_read_b64_tr_b16 a[82:83], v223 offset:4616
s_waitcnt vmcnt(1)
v_mfma_f32_16x16x32_bf16 v[104:107], a[92:95], a[12:15], v[104:107]
s_lshl_b32 s28, s28, 18
s_and_b32 s29, s29, 3
v_mfma_f32_16x16x32_bf16 v[112:115], a[92:95], a[28:31], v[112:115]
s_add_u32 s28, s28, s49
s_lshl_b32 s50, s29, 10
v_mfma_f32_16x16x32_bf16 v[112:115], a[88:91], a[24:27], v[112:115]
s_add_u32 s66, s28, s50
v_cvt_pk_bf16_f32 v58, v48, v49
v_mfma_f32_16x16x32_bf16 v[120:123], a[88:91], a[40:43], v[120:123]
ds_read_b64_tr_b16 a[84:85], v223 offset:9224
ds_read_b64_tr_b16 a[86:87], v223 offset:13832
v_mfma_f32_16x16x32_bf16 v[120:123], a[92:95], a[44:47], v[120:123]
s_mul_i32 s29, s29, 0x1200
s_and_b32 s29, s29, 0x2200
v_mfma_f32_16x16x32_bf16 v[128:131], a[92:95], a[60:63], v[128:131]
s_add_u32 s74, s28, s29
v_lshlrev_b32 v48, 16, v58
v_mfma_f32_16x16x32_bf16 v[128:131], a[88:91], a[56:59], v[128:131]
s_xor_b32 s28, s32, 3
s_sub_u32 s29, s32, s28
s_waitcnt lgkmcnt(8)
v_mfma_f32_16x16x32_bf16 v[132:135], a[64:67], a[112:115], v[132:135]
ds_read_b64_tr_b16 a[88:89], v223 offset:18440
ds_read_b64_tr_b16 a[90:91], v223 offset:23048
v_mfma_f32_16x16x32_bf16 v[132:135], a[68:71], a[116:119], v[132:135]
s_lshl_b32 s28, s28, 18
s_and_b32 s29, s29, 3
v_mfma_f32_16x16x32_bf16 v[124:127], a[68:71], a[100:103], v[124:127]
s_add_u32 s28, s28, s49
s_lshl_b32 s50, s29, 10
v_mfma_f32_16x16x32_bf16 v[124:127], a[64:67], a[96:99], v[124:127]
s_add_u32 s67, s28, s50
v_and_b32 v49, 0xffff0000, v58
v_mfma_f32_16x16x32_bf16 v[116:119], a[64:67], a[236:239], v[116:119]
ds_read_b64_tr_b16 a[92:93], v223 offset:27656
ds_read_b64_tr_b16 a[94:95], v223 offset:32264
v_mfma_f32_16x16x32_bf16 v[116:119], a[68:71], a[240:243], v[116:119]
s_mul_i32 s29, s29, 0x1200
s_and_b32 s29, s29, 0x2200
v_mfma_f32_16x16x32_bf16 v[108:111], a[68:71], a[224:227], v[108:111]
s_add_u32 s75, s28, s29
v_mul_f32 v58, 0xbfb8aa3b, v48
v_mfma_f32_16x16x32_bf16 v[108:111], a[64:67], a[220:223], v[108:111]
buffer_load_dword v230, v229, s[20:23], s94 offen sc0 sc1
s_waitcnt lgkmcnt(8)
v_mfma_f32_16x16x32_bf16 v[108:111], a[72:75], a[228:231], v[108:111]
ds_read_b64_tr_b16 a[64:65], v220 offset:128
ds_read_b64_tr_b16 a[66:67], v220 offset:4736
v_mfma_f32_16x16x32_bf16 v[108:111], a[76:79], a[232:235], v[108:111]
s_xor_b32 s28, s32, 4
s_sub_u32 s29, s32, s28
v_mfma_f32_16x16x32_bf16 v[116:119], a[76:79], a[132:135], v[116:119]
s_lshl_b32 s28, s28, 18
s_and_b32 s29, s29, 3
v_mfma_f32_16x16x32_bf16 v[116:119], a[72:75], a[128:131], v[116:119]
s_add_u32 s28, s28, s49
s_lshl_b32 s50, s29, 10
v_mfma_f32_16x16x32_bf16 v[124:127], a[72:75], a[104:107], v[124:127]
ds_read_b64_tr_b16 a[68:69], v220 offset:9344
ds_read_b64_tr_b16 a[70:71], v220 offset:13952
v_mfma_f32_16x16x32_bf16 v[124:127], a[76:79], a[108:111], v[124:127]
s_add_u32 s68, s28, s50
s_add_u32 s68, s68, 4096
v_mfma_f32_16x16x32_bf16 v[132:135], a[76:79], a[124:127], v[132:135]
s_mul_i32 s29, s29, 0x1200
s_and_b32 s29, s29, 0x2200
v_mfma_f32_16x16x32_bf16 v[132:135], a[72:75], a[120:123], v[132:135]
s_add_u32 s84, s28, s29
v_mul_f32 v59, 0xbfb8aa3b, v49
s_waitcnt lgkmcnt(8)
v_mfma_f32_16x16x32_bf16 v[132:135], a[80:83], a[48:51], v[132:135]
ds_read_b64_tr_b16 a[72:73], v220 offset:18560
ds_read_b64_tr_b16 a[74:75], v220 offset:23168
v_mfma_f32_16x16x32_bf16 v[132:135], a[84:87], a[52:55], v[132:135]
s_xor_b32 s28, s32, 5
s_sub_u32 s29, s32, s28
v_mfma_f32_16x16x32_bf16 v[124:127], a[84:87], a[36:39], v[124:127]
s_lshl_b32 s28, s28, 18
s_and_b32 s29, s29, 3
v_mfma_f32_16x16x32_bf16 v[124:127], a[80:83], a[32:35], v[124:127]
s_add_u32 s28, s28, s49
s_lshl_b32 s50, s29, 10
v_mfma_f32_16x16x32_bf16 v[116:119], a[80:83], a[16:19], v[116:119]
ds_read_b64_tr_b16 a[76:77], v220 offset:27776
ds_read_b64_tr_b16 a[78:79], v220 offset:32384
v_mfma_f32_16x16x32_bf16 v[116:119], a[84:87], a[20:23], v[116:119]
s_add_u32 s69, s28, s50
s_add_u32 s69, s69, 4096
v_mfma_f32_16x16x32_bf16 v[108:111], a[84:87], a[4:7], v[108:111]
s_mul_i32 s29, s29, 0x1200
s_and_b32 s29, s29, 0x2200
v_mfma_f32_16x16x32_bf16 v[108:111], a[80:83], a[0:3], v[108:111]
s_add_u32 s85, s28, s29
s_waitcnt lgkmcnt(8)
v_mfma_f32_16x16x32_bf16 v[108:111], a[88:91], a[8:11], v[108:111]
ds_read_b64_tr_b16 a[80:81], v223 offset:128
ds_read_b64_tr_b16 a[82:83], v223 offset:4736
v_mfma_f32_16x16x32_bf16 v[108:111], a[92:95], a[12:15], v[108:111]
s_xor_b32 s28, s32, 6
s_sub_u32 s29, s32, s28
v_mfma_f32_16x16x32_bf16 v[116:119], a[92:95], a[28:31], v[116:119]
s_lshl_b32 s28, s28, 18
s_and_b32 s29, s29, 3
v_mfma_f32_16x16x32_bf16 v[116:119], a[88:91], a[24:27], v[116:119]
s_add_u32 s28, s28, s49
s_lshl_b32 s50, s29, 10
v_mfma_f32_16x16x32_bf16 v[124:127], a[88:91], a[40:43], v[124:127]
ds_read_b64_tr_b16 a[84:85], v223 offset:9344
ds_read_b64_tr_b16 a[86:87], v223 offset:13952
v_mfma_f32_16x16x32_bf16 v[124:127], a[92:95], a[44:47], v[124:127]
s_add_u32 s70, s28, s50
s_add_u32 s70, s70, 4096
v_mfma_f32_16x16x32_bf16 v[132:135], a[92:95], a[60:63], v[132:135]
s_mul_i32 s29, s29, 0x1200
s_and_b32 s29, s29, 0x2200
v_mfma_f32_16x16x32_bf16 v[132:135], a[88:91], a[56:59], v[132:135]
s_add_u32 s86, s28, s29
s_waitcnt lgkmcnt(8)
v_mfma_f32_16x16x32_bf16 v[192:195], a[64:67], a[112:115], v[192:195]
ds_read_b64_tr_b16 a[88:89], v223 offset:18560
ds_read_b64_tr_b16 a[90:91], v223 offset:23168
v_mfma_f32_16x16x32_bf16 v[192:195], a[68:71], a[116:119], v[192:195]
s_xor_b32 s28, s32, 7
s_sub_u32 s29, s32, s28
v_mfma_f32_16x16x32_bf16 v[184:187], a[68:71], a[100:103], v[184:187]
s_lshl_b32 s28, s28, 18
s_and_b32 s29, s29, 3
v_mfma_f32_16x16x32_bf16 v[184:187], a[64:67], a[96:99], v[184:187]
s_add_u32 s28, s28, s49
s_lshl_b32 s50, s29, 10
v_mfma_f32_16x16x32_bf16 v[176:179], a[64:67], a[236:239], v[176:179]
ds_read_b64_tr_b16 a[92:93], v223 offset:27776
ds_read_b64_tr_b16 a[94:95], v223 offset:32384
v_mfma_f32_16x16x32_bf16 v[176:179], a[68:71], a[240:243], v[176:179]
s_add_u32 s71, s28, s50
s_add_u32 s71, s71, 4096
v_mfma_f32_16x16x32_bf16 v[168:171], a[68:71], a[224:227], v[168:171]
s_mul_i32 s29, s29, 0x1200
s_and_b32 s29, s29, 0x2200
v_mfma_f32_16x16x32_bf16 v[168:171], a[64:67], a[220:223], v[168:171]
s_add_u32 s87, s28, s29
s_waitcnt lgkmcnt(8)
v_mfma_f32_16x16x32_bf16 v[168:171], a[72:75], a[228:231], v[168:171]
ds_read_b64_tr_b16 a[64:65], v220 offset:136
ds_read_b64_tr_b16 a[66:67], v220 offset:4744
v_mfma_f32_16x16x32_bf16 v[168:171], a[76:79], a[232:235], v[168:171]
s_waitcnt vmcnt(0)
v_cmp_gt_u32 vcc, 2, v230
v_mfma_f32_16x16x32_bf16 v[176:179], a[76:79], a[132:135], v[176:179]
v_exp_f32 v58, v58
v_mfma_f32_16x16x32_bf16 v[176:179], a[72:75], a[128:131], v[176:179]
s_and_b32 s29, vcc_lo, 15
s_cbranch_scc1 SP_O3B
SP_O3B_RET:
v_mfma_f32_16x16x32_bf16 v[184:187], a[72:75], a[104:107], v[184:187]
ds_read_b64_tr_b16 a[68:69], v220 offset:9352
ds_read_b64_tr_b16 a[70:71], v220 offset:13960
v_mfma_f32_16x16x32_bf16 v[184:187], a[76:79], a[108:111], v[184:187]
s_add_u32 s39, s44, 4096
v_mfma_f32_16x16x32_bf16 v[192:195], a[76:79], a[124:127], v[192:195]
v_cvt_pk_bf16_f32 v104, v104, v105
v_cvt_pk_bf16_f32 v105, v106, v107
v_mfma_f32_16x16x32_bf16 v[192:195], a[72:75], a[120:123], v[192:195]
v_cvt_pk_bf16_f32 v106, v108, v109
v_cvt_pk_bf16_f32 v107, v110, v111
s_waitcnt lgkmcnt(8)
v_mfma_f32_16x16x32_bf16 v[192:195], a[80:83], a[48:51], v[192:195]
ds_read_b64_tr_b16 a[72:73], v220 offset:18568
ds_read_b64_tr_b16 a[74:75], v220 offset:23176
v_mfma_f32_16x16x32_bf16 v[192:195], a[84:87], a[52:55], v[192:195]
buffer_store_dwordx4 v[104:107], v244, s[20:23], s39 offen offset:0 sc0 sc1
v_mfma_f32_16x16x32_bf16 v[184:187], a[84:87], a[36:39], v[184:187]
v_cvt_pk_bf16_f32 v112, v112, v113
v_cvt_pk_bf16_f32 v113, v114, v115
v_mfma_f32_16x16x32_bf16 v[184:187], a[80:83], a[32:35], v[184:187]
v_cvt_pk_bf16_f32 v114, v116, v117
v_cvt_pk_bf16_f32 v115, v118, v119
v_mfma_f32_16x16x32_bf16 v[176:179], a[80:83], a[16:19], v[176:179]
ds_read_b64_tr_b16 a[76:77], v220 offset:27784
ds_read_b64_tr_b16 a[78:79], v220 offset:32392
v_mfma_f32_16x16x32_bf16 v[176:179], a[84:87], a[20:23], v[176:179]
buffer_store_dwordx4 v[112:115], v244, s[20:23], s39 offen offset:1024 sc0 sc1
v_mfma_f32_16x16x32_bf16 v[168:171], a[84:87], a[4:7], v[168:171]
v_cvt_pk_bf16_f32 v120, v120, v121
v_cvt_pk_bf16_f32 v121, v122, v123
v_mfma_f32_16x16x32_bf16 v[168:171], a[80:83], a[0:3], v[168:171]
v_cvt_pk_bf16_f32 v122, v124, v125
v_cvt_pk_bf16_f32 v123, v126, v127
s_waitcnt lgkmcnt(8)
v_mfma_f32_16x16x32_bf16 v[168:171], a[88:91], a[8:11], v[168:171]
ds_read_b64_tr_b16 a[80:81], v223 offset:136
ds_read_b64_tr_b16 a[82:83], v223 offset:4744
v_mfma_f32_16x16x32_bf16 v[168:171], a[92:95], a[12:15], v[168:171]
buffer_store_dwordx4 v[120:123], v244, s[20:23], s39 offen offset:2048 sc0 sc1
v_mfma_f32_16x16x32_bf16 v[176:179], a[92:95], a[28:31], v[176:179]
v_cvt_pk_bf16_f32 v128, v128, v129
v_cvt_pk_bf16_f32 v129, v130, v131
v_mfma_f32_16x16x32_bf16 v[176:179], a[88:91], a[24:27], v[176:179]
v_cvt_pk_bf16_f32 v130, v132, v133
v_cvt_pk_bf16_f32 v131, v134, v135
v_mfma_f32_16x16x32_bf16 v[184:187], a[88:91], a[40:43], v[184:187]
ds_read_b64_tr_b16 a[84:85], v223 offset:9352
ds_read_b64_tr_b16 a[86:87], v223 offset:13960
v_mfma_f32_16x16x32_bf16 v[184:187], a[92:95], a[44:47], v[184:187]
buffer_store_dwordx4 v[128:131], v244, s[20:23], s39 offen offset:3072 sc0 sc1
v_mfma_f32_16x16x32_bf16 v[192:195], a[92:95], a[60:63], v[192:195]
v_exp_f32 v59, v59
v_mfma_f32_16x16x32_bf16 v[192:195], a[88:91], a[56:59], v[192:195]
v_add_f32 v58, 1.0, v58
v_add_f32 v59, 1.0, v59
s_waitcnt lgkmcnt(8)
v_mfma_f32_16x16x32_bf16 v[196:199], a[64:67], a[112:115], v[196:199]
ds_read_b64_tr_b16 a[88:89], v223 offset:18568
ds_read_b64_tr_b16 a[90:91], v223 offset:23176
v_mfma_f32_16x16x32_bf16 v[196:199], a[68:71], a[116:119], v[196:199]
v_rcp_f32 v58, v58
v_mfma_f32_16x16x32_bf16 v[188:191], a[68:71], a[100:103], v[188:191]
v_rcp_f32 v59, v59
v_mfma_f32_16x16x32_bf16 v[188:191], a[64:67], a[96:99], v[188:191]
v_mul_f32 v48, v48, v58
v_mul_f32 v49, v49, v59
v_mfma_f32_16x16x32_bf16 v[180:183], a[64:67], a[236:239], v[180:183]
ds_read_b64_tr_b16 a[92:93], v223 offset:27784
ds_read_b64_tr_b16 a[94:95], v223 offset:32392
v_mfma_f32_16x16x32_bf16 v[180:183], a[68:71], a[240:243], v[180:183]
v_cvt_pk_bf16_f32 v58, v48, v49
v_lshlrev_b32 v48, 16, v58
v_mfma_f32_16x16x32_bf16 v[172:175], a[68:71], a[224:227], v[172:175]
v_and_b32 v49, 0xffff0000, v58
v_accvgpr_read_b32 v51, a142
v_mfma_f32_16x16x32_bf16 v[172:175], a[64:67], a[220:223], v[172:175]
v_accvgpr_read_b32 v59, a150
v_lshlrev_b32 v50, 16, v51
s_waitcnt lgkmcnt(8)
v_mfma_f32_16x16x32_bf16 v[172:175], a[72:75], a[228:231], v[172:175]
ds_read_b64_tr_b16 a[64:65], v221 offset:0
ds_read_b64_tr_b16 a[66:67], v221 offset:4608
v_mfma_f32_16x16x32_bf16 v[172:175], a[76:79], a[232:235], v[172:175]
v_and_b32 v51, 0xffff0000, v51
v_lshlrev_b32 v58, 16, v59
v_mfma_f32_16x16x32_bf16 v[180:183], a[76:79], a[132:135], v[180:183]
v_and_b32 v59, 0xffff0000, v59
v_add_f32 v50, v50, v58
v_mfma_f32_16x16x32_bf16 v[180:183], a[72:75], a[128:131], v[180:183]
v_add_f32 v51, v51, v59
v_cvt_pk_bf16_f32 v58, v50, v51
v_mfma_f32_16x16x32_bf16 v[188:191], a[72:75], a[104:107], v[188:191]
ds_read_b64_tr_b16 a[68:69], v221 offset:9216
ds_read_b64_tr_b16 a[70:71], v221 offset:13824
v_mfma_f32_16x16x32_bf16 v[188:191], a[76:79], a[108:111], v[188:191]
v_lshlrev_b32 v50, 16, v58
v_and_b32 v51, 0xffff0000, v58
v_mfma_f32_16x16x32_bf16 v[196:199], a[76:79], a[124:127], v[196:199]
v_mul_f32 v58, 0xbfb8aa3b, v50
v_mul_f32 v59, 0xbfb8aa3b, v51
v_mfma_f32_16x16x32_bf16 v[196:199], a[72:75], a[120:123], v[196:199]
v_exp_f32 v58, v58
s_waitcnt lgkmcnt(8)
v_mfma_f32_16x16x32_bf16 v[196:199], a[80:83], a[48:51], v[196:199]
ds_read_b64_tr_b16 a[72:73], v221 offset:18432
ds_read_b64_tr_b16 a[74:75], v221 offset:23040
v_mfma_f32_16x16x32_bf16 v[196:199], a[84:87], a[52:55], v[196:199]
v_exp_f32 v59, v59
v_mfma_f32_16x16x32_bf16 v[188:191], a[84:87], a[36:39], v[188:191]
v_add_f32 v58, 1.0, v58
v_add_f32 v59, 1.0, v59
v_mfma_f32_16x16x32_bf16 v[188:191], a[80:83], a[32:35], v[188:191]
v_rcp_f32 v58, v58
v_mfma_f32_16x16x32_bf16 v[180:183], a[80:83], a[16:19], v[180:183]
ds_read_b64_tr_b16 a[76:77], v221 offset:27648
ds_read_b64_tr_b16 a[78:79], v221 offset:32256
v_mfma_f32_16x16x32_bf16 v[180:183], a[84:87], a[20:23], v[180:183]
v_rcp_f32 v59, v59
v_mfma_f32_16x16x32_bf16 v[172:175], a[84:87], a[4:7], v[172:175]
v_mul_f32 v50, v50, v58
v_mul_f32 v51, v51, v59
v_mfma_f32_16x16x32_bf16 v[172:175], a[80:83], a[0:3], v[172:175]
v_cvt_pk_bf16_f32 v58, v50, v51
v_lshlrev_b32 v50, 16, v58
s_waitcnt lgkmcnt(8)
v_mfma_f32_16x16x32_bf16 v[172:175], a[88:91], a[8:11], v[172:175]
ds_read_b64_tr_b16 a[80:81], v224 offset:0
ds_read_b64_tr_b16 a[82:83], v224 offset:4608
v_mfma_f32_16x16x32_bf16 v[172:175], a[92:95], a[12:15], v[172:175]
v_and_b32 v51, 0xffff0000, v58
v_accvgpr_read_b32 v53, a143
v_mfma_f32_16x16x32_bf16 v[180:183], a[92:95], a[28:31], v[180:183]
v_accvgpr_read_b32 v59, a151
v_lshlrev_b32 v52, 16, v53
v_mfma_f32_16x16x32_bf16 v[180:183], a[88:91], a[24:27], v[180:183]
v_and_b32 v53, 0xffff0000, v53
v_lshlrev_b32 v58, 16, v59
v_mfma_f32_16x16x32_bf16 v[188:191], a[88:91], a[40:43], v[188:191]
ds_read_b64_tr_b16 a[84:85], v224 offset:9216
ds_read_b64_tr_b16 a[86:87], v224 offset:13824
v_mfma_f32_16x16x32_bf16 v[188:191], a[92:95], a[44:47], v[188:191]
v_and_b32 v59, 0xffff0000, v59
v_add_f32 v52, v52, v58
v_mfma_f32_16x16x32_bf16 v[196:199], a[92:95], a[60:63], v[196:199]
v_add_f32 v53, v53, v59
v_cvt_pk_bf16_f32 v58, v52, v53
v_mfma_f32_16x16x32_bf16 v[196:199], a[88:91], a[56:59], v[196:199]
v_lshlrev_b32 v52, 16, v58
v_and_b32 v53, 0xffff0000, v58
s_waitcnt lgkmcnt(8)
v_mfma_f32_16x16x32_bf16 v[212:215], a[64:67], a[112:115], v[212:215]
ds_read_b64_tr_b16 a[88:89], v224 offset:18432
ds_read_b64_tr_b16 a[90:91], v224 offset:23040
v_mfma_f32_16x16x32_bf16 v[212:215], a[68:71], a[116:119], v[212:215]
v_mul_f32 v58, 0xbfb8aa3b, v52
v_mul_f32 v59, 0xbfb8aa3b, v53
v_mfma_f32_16x16x32_bf16 v[208:211], a[68:71], a[100:103], v[208:211]
v_exp_f32 v58, v58
v_mfma_f32_16x16x32_bf16 v[208:211], a[64:67], a[96:99], v[208:211]
v_exp_f32 v59, v59
v_mfma_f32_16x16x32_bf16 v[204:207], a[64:67], a[236:239], v[204:207]
ds_read_b64_tr_b16 a[92:93], v224 offset:27648
ds_read_b64_tr_b16 a[94:95], v224 offset:32256
v_mfma_f32_16x16x32_bf16 v[204:207], a[68:71], a[240:243], v[204:207]
v_add_f32 v58, 1.0, v58
v_add_f32 v59, 1.0, v59
v_mfma_f32_16x16x32_bf16 v[200:203], a[68:71], a[224:227], v[200:203]
v_rcp_f32 v58, v58
v_mfma_f32_16x16x32_bf16 v[200:203], a[64:67], a[220:223], v[200:203]
v_rcp_f32 v59, v59
s_waitcnt lgkmcnt(8)
v_mfma_f32_16x16x32_bf16 v[200:203], a[72:75], a[228:231], v[200:203]
ds_read_b64_tr_b16 a[64:65], v219 offset:0
ds_read_b64_tr_b16 a[66:67], v219 offset:4608
v_mfma_f32_16x16x32_bf16 v[200:203], a[76:79], a[232:235], v[200:203]
s_add_u32 s39, s44, 12288
v_mul_f32 v52, v52, v58
v_mfma_f32_16x16x32_bf16 v[204:207], a[76:79], a[132:135], v[204:207]
v_cvt_pk_bf16_f32 v168, v168, v169
v_cvt_pk_bf16_f32 v169, v170, v171
v_mfma_f32_16x16x32_bf16 v[204:207], a[72:75], a[128:131], v[204:207]
v_cvt_pk_bf16_f32 v170, v172, v173
v_cvt_pk_bf16_f32 v171, v174, v175
v_mfma_f32_16x16x32_bf16 v[208:211], a[72:75], a[104:107], v[208:211]
ds_read_b64_tr_b16 a[68:69], v219 offset:9216
ds_read_b64_tr_b16 a[70:71], v219 offset:13824
v_mfma_f32_16x16x32_bf16 v[208:211], a[76:79], a[108:111], v[208:211]
buffer_store_dwordx4 v[168:171], v244, s[20:23], s39 offen offset:0 sc0 sc1
v_mfma_f32_16x16x32_bf16 v[212:215], a[76:79], a[124:127], v[212:215]
v_cvt_pk_bf16_f32 v176, v176, v177
v_cvt_pk_bf16_f32 v177, v178, v179
v_mfma_f32_16x16x32_bf16 v[212:215], a[72:75], a[120:123], v[212:215]
v_cvt_pk_bf16_f32 v178, v180, v181
v_cvt_pk_bf16_f32 v179, v182, v183
s_waitcnt lgkmcnt(8)
v_mfma_f32_16x16x32_bf16 v[212:215], a[80:83], a[48:51], v[212:215]
ds_read_b64_tr_b16 a[72:73], v219 offset:18432
ds_read_b64_tr_b16 a[74:75], v219 offset:23040
v_mfma_f32_16x16x32_bf16 v[212:215], a[84:87], a[52:55], v[212:215]
buffer_store_dwordx4 v[176:179], v244, s[20:23], s39 offen offset:1024 sc0 sc1
v_mfma_f32_16x16x32_bf16 v[208:211], a[84:87], a[36:39], v[208:211]
v_cvt_pk_bf16_f32 v184, v184, v185
v_cvt_pk_bf16_f32 v185, v186, v187
v_mfma_f32_16x16x32_bf16 v[208:211], a[80:83], a[32:35], v[208:211]
v_cvt_pk_bf16_f32 v186, v188, v189
v_cvt_pk_bf16_f32 v187, v190, v191
v_mfma_f32_16x16x32_bf16 v[204:207], a[80:83], a[16:19], v[204:207]
ds_read_b64_tr_b16 a[76:77], v219 offset:27648
ds_read_b64_tr_b16 a[78:79], v219 offset:32256
v_mfma_f32_16x16x32_bf16 v[204:207], a[84:87], a[20:23], v[204:207]
buffer_store_dwordx4 v[184:187], v244, s[20:23], s39 offen offset:2048 sc0 sc1
v_mfma_f32_16x16x32_bf16 v[200:203], a[84:87], a[4:7], v[200:203]
v_cvt_pk_bf16_f32 v192, v192, v193
v_cvt_pk_bf16_f32 v193, v194, v195
v_mfma_f32_16x16x32_bf16 v[200:203], a[80:83], a[0:3], v[200:203]
v_cvt_pk_bf16_f32 v194, v196, v197
v_cvt_pk_bf16_f32 v195, v198, v199
s_waitcnt lgkmcnt(8)
v_mfma_f32_16x16x32_bf16 v[200:203], a[88:91], a[8:11], v[200:203]
ds_read_b64_tr_b16 a[80:81], v222 offset:0
ds_read_b64_tr_b16 a[82:83], v222 offset:4608
v_mfma_f32_16x16x32_bf16 v[200:203], a[92:95], a[12:15], v[200:203]
buffer_store_dwordx4 v[192:195], v244, s[20:23], s39 offen offset:3072 sc0 sc1
v_mfma_f32_16x16x32_bf16 v[204:207], a[92:95], a[28:31], v[204:207]
ds_read_b64_tr_b16 a[156:157], v219 offset:128
ds_read_b64_tr_b16 a[158:159], v219 offset:4736
v_mfma_f32_16x16x32_bf16 v[204:207], a[88:91], a[24:27], v[204:207]
v_mul_f32 v53, v53, v59
v_cvt_pk_bf16_f32 v58, v52, v53
v_mfma_f32_16x16x32_bf16 v[208:211], a[88:91], a[40:43], v[208:211]
ds_read_b64_tr_b16 a[84:85], v222 offset:9216
ds_read_b64_tr_b16 a[86:87], v222 offset:13824
v_mfma_f32_16x16x32_bf16 v[208:211], a[92:95], a[44:47], v[208:211]
v_lshlrev_b32 v52, 16, v58
v_and_b32 v53, 0xffff0000, v58
v_mfma_f32_16x16x32_bf16 v[212:215], a[92:95], a[60:63], v[212:215]
ds_read_b64_tr_b16 a[160:161], v219 offset:9344
ds_read_b64_tr_b16 a[162:163], v219 offset:13952
v_mfma_f32_16x16x32_bf16 v[212:215], a[88:91], a[56:59], v[212:215]
v_accvgpr_read_b32 v55, a254
v_accvgpr_read_b32 v59, a152
s_waitcnt lgkmcnt(8)
v_mfma_f32_16x16x32_bf16 v[96:99], a[64:67], a[112:115], v[96:99]
ds_read_b64_tr_b16 a[88:89], v222 offset:18432
ds_read_b64_tr_b16 a[90:91], v222 offset:23040
v_mfma_f32_16x16x32_bf16 v[96:99], a[68:71], a[116:119], v[96:99]
v_lshlrev_b32 v54, 16, v55
v_and_b32 v55, 0xffff0000, v55
v_mfma_f32_16x16x32_bf16 v[88:91], a[68:71], a[100:103], v[88:91]
ds_read_b64_tr_b16 a[164:165], v219 offset:18560
ds_read_b64_tr_b16 a[166:167], v219 offset:23168
v_mfma_f32_16x16x32_bf16 v[88:91], a[64:67], a[96:99], v[88:91]
v_lshlrev_b32 v58, 16, v59
v_and_b32 v59, 0xffff0000, v59
v_mfma_f32_16x16x32_bf16 v[80:83], a[64:67], a[236:239], v[80:83]
ds_read_b64_tr_b16 a[92:93], v222 offset:27648
ds_read_b64_tr_b16 a[94:95], v222 offset:32256
v_mfma_f32_16x16x32_bf16 v[80:83], a[68:71], a[240:243], v[80:83]
v_add_f32 v54, v54, v58
v_add_f32 v55, v55, v59
v_mfma_f32_16x16x32_bf16 v[72:75], a[68:71], a[224:227], v[72:75]
ds_read_b64_tr_b16 a[168:169], v219 offset:27776
ds_read_b64_tr_b16 a[170:171], v219 offset:32384
v_mfma_f32_16x16x32_bf16 v[72:75], a[64:67], a[220:223], v[72:75]
v_cvt_pk_bf16_f32 v58, v54, v55
v_lshlrev_b32 v54, 16, v58
v_mfma_f32_16x16x32_bf16 v[72:75], a[72:75], a[228:231], v[72:75]
ds_read_b64_tr_b16 a[64:65], v219 offset:8
ds_read_b64_tr_b16 a[66:67], v219 offset:4616
v_mfma_f32_16x16x32_bf16 v[72:75], a[76:79], a[232:235], v[72:75]
s_add_u32 s39, s44, 8192
v_and_b32 v55, 0xffff0000, v58
v_mfma_f32_16x16x32_bf16 v[80:83], a[76:79], a[132:135], v[80:83]
ds_read_b64_tr_b16 a[172:173], v222 offset:128
ds_read_b64_tr_b16 a[174:175], v222 offset:4736
v_mfma_f32_16x16x32_bf16 v[80:83], a[72:75], a[128:131], v[80:83]
v_cvt_pk_bf16_f32 v200, v200, v201
v_cvt_pk_bf16_f32 v201, v202, v203
v_mfma_f32_16x16x32_bf16 v[88:91], a[72:75], a[104:107], v[88:91]
ds_read_b64_tr_b16 a[68:69], v219 offset:9224
ds_read_b64_tr_b16 a[70:71], v219 offset:13832
v_mfma_f32_16x16x32_bf16 v[88:91], a[76:79], a[108:111], v[88:91]
buffer_store_dwordx2 v[200:201], v226, s[20:23], s44 offen offset:0 sc0 sc1
v_mfma_f32_16x16x32_bf16 v[96:99], a[76:79], a[124:127], v[96:99]
ds_read_b64_tr_b16 a[176:177], v222 offset:9344
ds_read_b64_tr_b16 a[178:179], v222 offset:13952
v_mfma_f32_16x16x32_bf16 v[96:99], a[72:75], a[120:123], v[96:99]
v_cvt_pk_bf16_f32 v204, v204, v205
v_cvt_pk_bf16_f32 v205, v206, v207
s_waitcnt lgkmcnt(8)
v_mfma_f32_16x16x32_bf16 v[96:99], a[80:83], a[48:51], v[96:99]
ds_read_b64_tr_b16 a[72:73], v219 offset:18440
ds_read_b64_tr_b16 a[74:75], v219 offset:23048
v_mfma_f32_16x16x32_bf16 v[96:99], a[84:87], a[52:55], v[96:99]
buffer_store_dwordx2 v[204:205], v226, s[20:23], s44 offen offset:512 sc0 sc1
v_mfma_f32_16x16x32_bf16 v[88:91], a[84:87], a[36:39], v[88:91]
ds_read_b64_tr_b16 a[180:181], v222 offset:18560
ds_read_b64_tr_b16 a[182:183], v222 offset:23168
v_mfma_f32_16x16x32_bf16 v[88:91], a[80:83], a[32:35], v[88:91]
v_cvt_pk_bf16_f32 v208, v208, v209
v_cvt_pk_bf16_f32 v209, v210, v211
v_mfma_f32_16x16x32_bf16 v[80:83], a[80:83], a[16:19], v[80:83]
ds_read_b64_tr_b16 a[76:77], v219 offset:27656
ds_read_b64_tr_b16 a[78:79], v219 offset:32264
v_mfma_f32_16x16x32_bf16 v[80:83], a[84:87], a[20:23], v[80:83]
buffer_store_dwordx2 v[208:209], v226, s[20:23], s39 offen offset:0 sc0 sc1
v_mfma_f32_16x16x32_bf16 v[72:75], a[84:87], a[4:7], v[72:75]
ds_read_b64_tr_b16 a[184:185], v222 offset:27776
ds_read_b64_tr_b16 a[186:187], v222 offset:32384
v_mfma_f32_16x16x32_bf16 v[72:75], a[80:83], a[0:3], v[72:75]
v_cvt_pk_bf16_f32 v212, v212, v213
v_cvt_pk_bf16_f32 v213, v214, v215
v_mfma_f32_16x16x32_bf16 v[72:75], a[88:91], a[8:11], v[72:75]
ds_read_b64_tr_b16 a[80:81], v222 offset:8
ds_read_b64_tr_b16 a[82:83], v222 offset:4616
v_mfma_f32_16x16x32_bf16 v[72:75], a[92:95], a[12:15], v[72:75]
buffer_store_dwordx2 v[212:213], v226, s[20:23], s39 offen offset:512 sc0 sc1
v_mfma_f32_16x16x32_bf16 v[80:83], a[92:95], a[28:31], v[80:83]
ds_read_b64_tr_b16 a[188:189], v219 offset:136
ds_read_b64_tr_b16 a[190:191], v219 offset:4744
v_mfma_f32_16x16x32_bf16 v[80:83], a[88:91], a[24:27], v[80:83]
s_lshl2_add_u32 s28, s32, s95
v_mul_f32 v58, 0xbfb8aa3b, v54
v_mfma_f32_16x16x32_bf16 v[88:91], a[88:91], a[40:43], v[88:91]
ds_read_b64_tr_b16 a[84:85], v222 offset:9224
ds_read_b64_tr_b16 a[86:87], v222 offset:13832
v_mfma_f32_16x16x32_bf16 v[88:91], a[92:95], a[44:47], v[88:91]
v_mul_f32 v59, 0xbfb8aa3b, v55
v_mfma_f32_16x16x32_bf16 v[96:99], a[92:95], a[60:63], v[96:99]
ds_read_b64_tr_b16 a[192:193], v219 offset:9352
ds_read_b64_tr_b16 a[194:195], v219 offset:13960
v_mfma_f32_16x16x32_bf16 v[96:99], a[88:91], a[56:59], v[96:99]
v_exp_f32 v58, v58
s_waitcnt lgkmcnt(8)
v_mfma_f32_16x16x32_bf16 v[100:103], a[64:67], a[112:115], v[100:103]
ds_read_b64_tr_b16 a[88:89], v222 offset:18440
ds_read_b64_tr_b16 a[90:91], v222 offset:23048
v_mfma_f32_16x16x32_bf16 v[100:103], a[68:71], a[116:119], v[100:103]
v_exp_f32 v59, v59
v_mfma_f32_16x16x32_bf16 v[92:95], a[68:71], a[100:103], v[92:95]
ds_read_b64_tr_b16 a[196:197], v219 offset:18568
ds_read_b64_tr_b16 a[198:199], v219 offset:23176
v_mfma_f32_16x16x32_bf16 v[92:95], a[64:67], a[96:99], v[92:95]
v_add_f32 v58, 1.0, v58
v_add_f32 v59, 1.0, v59
v_mfma_f32_16x16x32_bf16 v[84:87], a[64:67], a[236:239], v[84:87]
ds_read_b64_tr_b16 a[92:93], v222 offset:27656
ds_read_b64_tr_b16 a[94:95], v222 offset:32264
v_mfma_f32_16x16x32_bf16 v[84:87], a[68:71], a[240:243], v[84:87]
v_rcp_f32 v58, v58
v_mfma_f32_16x16x32_bf16 v[76:79], a[68:71], a[224:227], v[76:79]
ds_read_b64_tr_b16 a[200:201], v219 offset:27784
ds_read_b64_tr_b16 a[202:203], v219 offset:32392
v_mfma_f32_16x16x32_bf16 v[76:79], a[64:67], a[220:223], v[76:79]
v_rcp_f32 v59, v59
v_mfma_f32_16x16x32_bf16 v[76:79], a[72:75], a[228:231], v[76:79]
v_mul_f32 v54, v54, v58
v_mul_f32 v55, v55, v59
v_mfma_f32_16x16x32_bf16 v[76:79], a[76:79], a[232:235], v[76:79]
v_cvt_pk_bf16_f32 v58, v54, v55
v_lshlrev_b32 v54, 16, v58
v_mfma_f32_16x16x32_bf16 v[84:87], a[76:79], a[132:135], v[84:87]
ds_read_b64_tr_b16 a[204:205], v222 offset:136
ds_read_b64_tr_b16 a[206:207], v222 offset:4744
v_mfma_f32_16x16x32_bf16 v[84:87], a[72:75], a[128:131], v[84:87]
v_and_b32 v55, 0xffff0000, v58
v_accvgpr_read_b32 v57, a255
v_mfma_f32_16x16x32_bf16 v[92:95], a[72:75], a[104:107], v[92:95]
v_accvgpr_read_b32 v59, a153
v_lshlrev_b32 v56, 16, v57
v_mfma_f32_16x16x32_bf16 v[92:95], a[76:79], a[108:111], v[92:95]
s_waitcnt vmcnt(0)
buffer_store_dword v231, v254, s[20:23], s28 offen sc0 sc1
v_mfma_f32_16x16x32_bf16 v[100:103], a[76:79], a[124:127], v[100:103]
ds_read_b64_tr_b16 a[208:209], v222 offset:9352
ds_read_b64_tr_b16 a[210:211], v222 offset:13960
v_mfma_f32_16x16x32_bf16 v[100:103], a[72:75], a[120:123], v[100:103]
v_and_b32 v57, 0xffff0000, v57
v_lshlrev_b32 v58, 16, v59
s_waitcnt lgkmcnt(8)
v_mfma_f32_16x16x32_bf16 v[100:103], a[80:83], a[48:51], v[100:103]
v_and_b32 v59, 0xffff0000, v59
v_add_f32 v56, v56, v58
v_mfma_f32_16x16x32_bf16 v[100:103], a[84:87], a[52:55], v[100:103]
v_add_f32 v57, v57, v59
v_cvt_pk_bf16_f32 v58, v56, v57
v_mfma_f32_16x16x32_bf16 v[92:95], a[84:87], a[36:39], v[92:95]
ds_read_b64_tr_b16 a[212:213], v222 offset:18568
ds_read_b64_tr_b16 a[214:215], v222 offset:23176
v_mfma_f32_16x16x32_bf16 v[92:95], a[80:83], a[32:35], v[92:95]
v_lshlrev_b32 v56, 16, v58
v_and_b32 v57, 0xffff0000, v58
v_mfma_f32_16x16x32_bf16 v[84:87], a[80:83], a[16:19], v[84:87]
v_mul_f32 v58, 0xbfb8aa3b, v56
v_mul_f32 v59, 0xbfb8aa3b, v57
v_mfma_f32_16x16x32_bf16 v[84:87], a[84:87], a[20:23], v[84:87]
v_exp_f32 v58, v58
v_mfma_f32_16x16x32_bf16 v[76:79], a[84:87], a[4:7], v[76:79]
ds_read_b64_tr_b16 a[216:217], v222 offset:27784
ds_read_b64_tr_b16 a[218:219], v222 offset:32392
v_mfma_f32_16x16x32_bf16 v[76:79], a[80:83], a[0:3], v[76:79]
s_waitcnt vmcnt(1)
buffer_load_dword v230, v229, s[20:23], s95 offen sc0 sc1
v_mfma_f32_16x16x32_bf16 v[76:79], a[88:91], a[8:11], v[76:79]
v_exp_f32 v59, v59
s_waitcnt lgkmcnt(8)
v_mfma_f32_16x16x32_bf16 v[76:79], a[92:95], a[12:15], v[76:79]
v_add_f32 v58, 1.0, v58
v_add_f32 v59, 1.0, v59
v_mfma_f32_16x16x32_bf16 v[84:87], a[92:95], a[28:31], v[84:87]
v_rcp_f32 v58, v58
v_mfma_f32_16x16x32_bf16 v[84:87], a[88:91], a[24:27], v[84:87]
v_rcp_f32 v59, v59
v_mfma_f32_16x16x32_bf16 v[92:95], a[88:91], a[40:43], v[92:95]
v_mul_f32 v56, v56, v58
v_mul_f32 v57, v57, v59
v_mfma_f32_16x16x32_bf16 v[92:95], a[92:95], a[44:47], v[92:95]
v_cvt_pk_bf16_f32 v58, v56, v57
v_lshlrev_b32 v56, 16, v58
v_mfma_f32_16x16x32_bf16 v[100:103], a[92:95], a[60:63], v[100:103]
v_and_b32 v57, 0xffff0000, v58
v_accvgpr_read_b32 v19, a244
v_mfma_f32_16x16x32_bf16 v[100:103], a[88:91], a[56:59], v[100:103]
v_lshlrev_b32 v18, 16, v19
v_and_b32 v19, 0xffff0000, v19
v_mfma_f32_16x16x32_bf16 v[144:147], a[156:159], a[236:239], v[144:147]
v_accvgpr_read_b32 v21, a245
v_lshlrev_b32 v20, 16, v21
v_mfma_f32_16x16x32_bf16 v[144:147], a[160:163], a[240:243], v[144:147]
v_and_b32 v21, 0xffff0000, v21
v_accvgpr_read_b32 v23, a246
v_mfma_f32_16x16x32_bf16 v[144:147], a[164:167], a[128:131], v[144:147]
v_lshlrev_b32 v22, 16, v23
v_and_b32 v23, 0xffff0000, v23
v_mfma_f32_16x16x32_bf16 v[144:147], a[168:171], a[132:135], v[144:147]
v_accvgpr_read_b32 v25, a247
v_lshlrev_b32 v24, 16, v25
v_mfma_f32_16x16x32_bf16 v[144:147], a[172:175], a[16:19], v[144:147]
v_and_b32 v25, 0xffff0000, v25
v_accvgpr_read_b32 v27, a248
v_mfma_f32_16x16x32_bf16 v[144:147], a[176:179], a[20:23], v[144:147]
v_lshlrev_b32 v26, 16, v27
v_and_b32 v27, 0xffff0000, v27
v_mfma_f32_16x16x32_bf16 v[144:147], a[180:183], a[24:27], v[144:147]
v_accvgpr_read_b32 v29, a249
v_lshlrev_b32 v28, 16, v29
v_mfma_f32_16x16x32_bf16 v[144:147], a[184:187], a[28:31], v[144:147]
v_and_b32 v29, 0xffff0000, v29
v_accvgpr_read_b32 v31, a250
s_waitcnt lgkmcnt(0)
v_mfma_f32_16x16x32_bf16 v[148:151], a[216:219], a[28:31], v[148:151]
s_add_u32 s39, s44, 0
v_lshlrev_b32 v30, 16, v31
v_mfma_f32_16x16x32_bf16 v[148:151], a[212:215], a[24:27], v[148:151]
v_cvt_pk_bf16_f32 v80, v80, v81
v_cvt_pk_bf16_f32 v81, v82, v83
v_mfma_f32_16x16x32_bf16 v[148:151], a[208:211], a[20:23], v[148:151]
v_cvt_pk_bf16_f32 v82, v84, v85
v_cvt_pk_bf16_f32 v83, v86, v87
v_mfma_f32_16x16x32_bf16 v[148:151], a[204:207], a[16:19], v[148:151]
buffer_store_dwordx4 v[80:83], v244, s[20:23], s39 offen offset:1024 sc0 sc1
v_mfma_f32_16x16x32_bf16 v[148:151], a[200:203], a[132:135], v[148:151]
v_cvt_pk_bf16_f32 v88, v88, v89
v_cvt_pk_bf16_f32 v89, v90, v91
v_mfma_f32_16x16x32_bf16 v[148:151], a[196:199], a[128:131], v[148:151]
v_cvt_pk_bf16_f32 v90, v92, v93
v_cvt_pk_bf16_f32 v91, v94, v95
v_mfma_f32_16x16x32_bf16 v[148:151], a[192:195], a[240:243], v[148:151]
buffer_store_dwordx4 v[88:91], v244, s[20:23], s39 offen offset:2048 sc0 sc1
v_mfma_f32_16x16x32_bf16 v[148:151], a[188:191], a[236:239], v[148:151]
v_cvt_pk_bf16_f32 v96, v96, v97
v_cvt_pk_bf16_f32 v97, v98, v99
v_mfma_f32_16x16x32_bf16 v[156:159], a[188:191], a[96:99], v[156:159]
v_cvt_pk_bf16_f32 v98, v100, v101
v_cvt_pk_bf16_f32 v99, v102, v103
v_mfma_f32_16x16x32_bf16 v[156:159], a[192:195], a[100:103], v[156:159]
buffer_store_dwordx4 v[96:99], v244, s[20:23], s39 offen offset:3072 sc0 sc1
v_mfma_f32_16x16x32_bf16 v[156:159], a[196:199], a[104:107], v[156:159]
s_add_u32 s39, s44, 8192
v_and_b32 v31, 0xffff0000, v31
v_mfma_f32_16x16x32_bf16 v[156:159], a[200:203], a[108:111], v[156:159]
s_waitcnt vmcnt(3)
v_cmp_gt_u32 vcc, 1, v230
v_mfma_f32_16x16x32_bf16 v[156:159], a[204:207], a[32:35], v[156:159]
v_accvgpr_read_b32 v33, a251
v_lshlrev_b32 v32, 16, v33
v_mfma_f32_16x16x32_bf16 v[156:159], a[208:211], a[36:39], v[156:159]
s_and_b32 s29, vcc_lo, 0xff
s_cbranch_scc1 SP_P1B
SP_P1B_RET:
v_mfma_f32_16x16x32_bf16 v[156:159], a[212:215], a[40:43], v[156:159]
v_and_b32 v33, 0xffff0000, v33
v_accvgpr_read_b32 v35, a252
v_mfma_f32_16x16x32_bf16 v[156:159], a[216:219], a[44:47], v[156:159]
v_cvt_pk_bf16_f32 v144, v144, v145
v_cvt_pk_bf16_f32 v145, v146, v147
v_mfma_f32_16x16x32_bf16 v[152:155], a[184:187], a[44:47], v[152:155]
v_cvt_pk_bf16_f32 v146, v148, v149
v_cvt_pk_bf16_f32 v147, v150, v151
v_mfma_f32_16x16x32_bf16 v[152:155], a[180:183], a[40:43], v[152:155]
buffer_store_dwordx4 v[144:147], v244, s[20:23], s39 offen offset:1024 sc0 sc1
v_mfma_f32_16x16x32_bf16 v[152:155], a[176:179], a[36:39], v[152:155]
buffer_load_dwordx4 v[104:107], v244, s[20:23], s68 offen sc0 sc1
v_mfma_f32_16x16x32_bf16 v[152:155], a[172:175], a[32:35], v[152:155]
v_lshlrev_b32 v34, 16, v35
v_and_b32 v35, 0xffff0000, v35
v_mfma_f32_16x16x32_bf16 v[152:155], a[168:171], a[108:111], v[152:155]
v_accvgpr_read_b32 v37, a253
v_lshlrev_b32 v36, 16, v37
v_mfma_f32_16x16x32_bf16 v[152:155], a[164:167], a[104:107], v[152:155]
buffer_load_dwordx4 v[108:111], v244, s[20:23], s69 offen sc0 sc1
v_mfma_f32_16x16x32_bf16 v[152:155], a[160:163], a[100:103], v[152:155]
v_and_b32 v37, 0xffff0000, v37
v_mfma_f32_16x16x32_bf16 v[152:155], a[156:159], a[96:99], v[152:155]
s_mov_b32 s90, 0x3f80
s_mov_b32 s91, 0x3f800000
v_mfma_f32_16x16x32_bf16 v[160:163], a[156:159], a[112:115], v[160:163]
buffer_load_dwordx4 v[112:115], v244, s[20:23], s70 offen sc0 sc1
v_mfma_f32_16x16x32_bf16 v[160:163], a[160:163], a[116:119], v[160:163]
v_mov_b32 v66, 0
v_mov_b32 v67, 0
v_mfma_f32_16x16x32_bf16 v[160:163], a[164:167], a[120:123], v[160:163]
v_mov_b32 v68, 0
v_mov_b32 v69, 0
v_mfma_f32_16x16x32_bf16 v[160:163], a[168:171], a[124:127], v[160:163]
buffer_load_dwordx4 v[116:119], v244, s[20:23], s71 offen sc0 sc1
v_mfma_f32_16x16x32_bf16 v[160:163], a[172:175], a[48:51], v[160:163]
v_mfma_f32_16x16x32_bf16 v[160:163], a[176:179], a[52:55], v[160:163]
v_mfma_f32_16x16x32_bf16 v[160:163], a[180:183], a[56:59], v[160:163]
buffer_load_dwordx2 v[200:201], v226, s[20:23], s72 offen sc0 sc1
v_mfma_f32_16x16x32_bf16 v[160:163], a[184:187], a[60:63], v[160:163]
v_cvt_pk_bf16_f32 v152, v152, v153
v_cvt_pk_bf16_f32 v153, v154, v155
v_mfma_f32_16x16x32_bf16 v[164:167], a[216:219], a[60:63], v[164:167]
v_cvt_pk_bf16_f32 v154, v156, v157
v_cvt_pk_bf16_f32 v155, v158, v159
v_mfma_f32_16x16x32_bf16 v[164:167], a[212:215], a[56:59], v[164:167]
buffer_store_dwordx4 v[152:155], v244, s[20:23], s39 offen offset:2048 sc0 sc1
v_mfma_f32_16x16x32_bf16 v[164:167], a[208:211], a[52:55], v[164:167]
buffer_load_dwordx2 v[202:203], v226, s[20:23], s73 offen sc0 sc1
v_mfma_f32_16x16x32_bf16 v[164:167], a[204:207], a[48:51], v[164:167]
v_mfma_f32_16x16x32_bf16 v[164:167], a[200:203], a[124:127], v[164:167]
v_mfma_f32_16x16x32_bf16 v[164:167], a[196:199], a[120:123], v[164:167]
buffer_load_dwordx2 v[204:205], v226, s[20:23], s74 offen sc0 sc1
v_mfma_f32_16x16x32_bf16 v[164:167], a[192:195], a[116:119], v[164:167]
v_mfma_f32_16x16x32_bf16 v[164:167], a[188:191], a[112:115], v[164:167]
v_mfma_f32_16x16x32_bf16 v[140:143], a[188:191], a[220:223], v[140:143]
buffer_load_dwordx2 v[206:207], v226, s[20:23], s75 offen sc0 sc1
v_mfma_f32_16x16x32_bf16 v[140:143], a[192:195], a[224:227], v[140:143]
v_mfma_f32_16x16x32_bf16 v[140:143], a[196:199], a[228:231], v[140:143]
v_mfma_f32_16x16x32_bf16 v[140:143], a[200:203], a[232:235], v[140:143]
buffer_load_dwordx2 v[208:209], v226, s[20:23], s84 offen sc0 sc1
v_mfma_f32_16x16x32_bf16 v[140:143], a[204:207], a[0:3], v[140:143]
v_mfma_f32_16x16x32_bf16 v[140:143], a[208:211], a[4:7], v[140:143]
v_mfma_f32_16x16x32_bf16 v[140:143], a[212:215], a[8:11], v[140:143]
buffer_load_dwordx2 v[210:211], v226, s[20:23], s85 offen sc0 sc1
v_mfma_f32_16x16x32_bf16 v[140:143], a[216:219], a[12:15], v[140:143]
v_cvt_pk_bf16_f32 v160, v160, v161
v_cvt_pk_bf16_f32 v161, v162, v163
v_mfma_f32_16x16x32_bf16 v[136:139], a[184:187], a[12:15], v[136:139]
v_cvt_pk_bf16_f32 v162, v164, v165
v_cvt_pk_bf16_f32 v163, v166, v167
v_mfma_f32_16x16x32_bf16 v[136:139], a[180:183], a[8:11], v[136:139]
buffer_store_dwordx4 v[160:163], v244, s[20:23], s39 offen offset:3072 sc0 sc1
v_mfma_f32_16x16x32_bf16 v[136:139], a[176:179], a[4:7], v[136:139]
buffer_load_dwordx2 v[212:213], v226, s[20:23], s86 offen sc0 sc1
v_mfma_f32_16x16x32_bf16 v[136:139], a[172:175], a[0:3], v[136:139]
v_mfma_f32_16x16x32_bf16 v[136:139], a[168:171], a[232:235], v[136:139]
v_mfma_f32_16x16x32_bf16 v[136:139], a[164:167], a[228:231], v[136:139]
buffer_load_dwordx2 v[214:215], v226, s[20:23], s87 offen sc0 sc1
v_mfma_f32_16x16x32_bf16 v[136:139], a[160:163], a[224:227], v[136:139]
v_mfma_f32_16x16x32_bf16 v[136:139], a[156:159], a[220:223], v[136:139]
buffer_load_dwordx4 v[120:123], v243, s[20:23], s68 offen sc0 sc1
buffer_load_dwordx4 v[124:127], v243, s[20:23], s69 offen sc0 sc1
buffer_load_dwordx4 v[128:131], v243, s[20:23], s70 offen sc0 sc1
buffer_load_dwordx4 v[132:135], v243, s[20:23], s71 offen sc0 sc1
s_lshl_b32 s50, s34, 2
s_lshl_b32 s50, 15, s50
s_waitcnt vmcnt(6)
buffer_store_dword v246, v254, s[20:23], s28 offen sc0 sc1
s_waitcnt vmcnt(18)
v_dot2c_f32_bf16 v72, s90, v104
v_dot2c_f32_bf16 v73, s91, v104
v_dot2c_f32_bf16 v74, s90, v105
v_dot2c_f32_bf16 v75, s91, v105
v_dot2c_f32_bf16 v76, s90, v106
v_dot2c_f32_bf16 v77, s91, v106
v_dot2c_f32_bf16 v78, s90, v107
v_dot2c_f32_bf16 v79, s91, v107
s_waitcnt vmcnt(17)
v_dot2c_f32_bf16 v72, s90, v108
v_dot2c_f32_bf16 v73, s91, v108
v_dot2c_f32_bf16 v74, s90, v109
v_dot2c_f32_bf16 v75, s91, v109
v_dot2c_f32_bf16 v76, s90, v110
v_dot2c_f32_bf16 v77, s91, v110
v_dot2c_f32_bf16 v78, s90, v111
v_dot2c_f32_bf16 v79, s91, v111
s_waitcnt vmcnt(16)
v_dot2c_f32_bf16 v72, s90, v112
v_dot2c_f32_bf16 v73, s91, v112
v_dot2c_f32_bf16 v74, s90, v113
v_dot2c_f32_bf16 v75, s91, v113
v_dot2c_f32_bf16 v76, s90, v114
v_dot2c_f32_bf16 v77, s91, v114
v_dot2c_f32_bf16 v78, s90, v115
v_dot2c_f32_bf16 v79, s91, v115
s_waitcnt vmcnt(15)
v_dot2c_f32_bf16 v72, s90, v116
v_dot2c_f32_bf16 v73, s91, v116
v_dot2c_f32_bf16 v74, s90, v117
v_dot2c_f32_bf16 v75, s91, v117
v_dot2c_f32_bf16 v76, s90, v118
v_dot2c_f32_bf16 v77, s91, v118
v_dot2c_f32_bf16 v78, s90, v119
v_dot2c_f32_bf16 v79, s91, v119
buffer_load_dword v230, v229, s[20:23], s95 offen sc0 sc1
s_waitcnt vmcnt(5)
v_dot2c_f32_bf16 v136, s90, v120
v_dot2c_f32_bf16 v137, s91, v120
v_dot2c_f32_bf16 v138, s90, v121
v_dot2c_f32_bf16 v139, s91, v121
v_dot2c_f32_bf16 v140, s90, v122
v_dot2c_f32_bf16 v141, s91, v122
v_dot2c_f32_bf16 v142, s90, v123
v_dot2c_f32_bf16 v143, s91, v123
s_waitcnt vmcnt(4)
v_dot2c_f32_bf16 v136, s90, v124
v_dot2c_f32_bf16 v137, s91, v124
v_dot2c_f32_bf16 v138, s90, v125
v_dot2c_f32_bf16 v139, s91, v125
v_dot2c_f32_bf16 v140, s90, v126
v_dot2c_f32_bf16 v141, s91, v126
v_dot2c_f32_bf16 v142, s90, v127
v_dot2c_f32_bf16 v143, s91, v127
s_waitcnt vmcnt(3)
v_dot2c_f32_bf16 v136, s90, v128
v_dot2c_f32_bf16 v137, s91, v128
v_dot2c_f32_bf16 v138, s90, v129
v_dot2c_f32_bf16 v139, s91, v129
v_dot2c_f32_bf16 v140, s90, v130
v_dot2c_f32_bf16 v141, s91, v130
v_dot2c_f32_bf16 v142, s90, v131
v_dot2c_f32_bf16 v143, s91, v131
s_waitcnt vmcnt(2)
v_dot2c_f32_bf16 v136, s90, v132
v_dot2c_f32_bf16 v137, s91, v132
v_dot2c_f32_bf16 v138, s90, v133
v_dot2c_f32_bf16 v139, s91, v133
v_dot2c_f32_bf16 v140, s90, v134
v_dot2c_f32_bf16 v141, s91, v134
v_dot2c_f32_bf16 v142, s90, v135
v_dot2c_f32_bf16 v143, s91, v135
s_waitcnt vmcnt(0)
v_cmp_gt_u32 vcc, 2, v230
s_nop 0
s_and_b32 s29, vcc_lo, s50
s_cbranch_scc0 SP_P2B_RET
SP_P2B:
s_sleep 0
s_add_u32 s100, s100, 1
s_bitcmp1_b32 s100, 19
s_cbranch_scc1 K_END
buffer_load_dword v230, v229, s[20:23], s95 offen sc0 sc1
s_waitcnt vmcnt(0)
v_cmp_gt_u32 vcc, 2, v230
s_nop 0
s_and_b32 s29, vcc_lo, s50
s_cbranch_scc1 SP_P2B
SP_P2B_RET:
buffer_load_dwordx4 v[168:171], v244, s[20:23], s65 offen sc0 sc1
buffer_load_dwordx4 v[172:175], v244, s[20:23], s66 offen sc0 sc1
buffer_load_dwordx4 v[176:179], v244, s[20:23], s67 offen sc0 sc1
buffer_load_dwordx4 v[180:183], v243, s[20:23], s65 offen sc0 sc1
buffer_load_dwordx4 v[184:187], v243, s[20:23], s66 offen sc0 sc1
buffer_load_dwordx4 v[188:191], v243, s[20:23], s67 offen sc0 sc1
s_waitcnt vmcnt(21)
v_dot2c_f32_bf16 v66, s90, v200
v_dot2c_f32_bf16 v67, s91, v200
v_dot2c_f32_bf16 v68, s90, v201
v_dot2c_f32_bf16 v69, s91, v201
s_waitcnt vmcnt(19)
v_dot2c_f32_bf16 v66, s90, v202
v_dot2c_f32_bf16 v67, s91, v202
v_dot2c_f32_bf16 v68, s90, v203
v_dot2c_f32_bf16 v69, s91, v203
s_waitcnt vmcnt(18)
v_dot2c_f32_bf16 v66, s90, v204
v_dot2c_f32_bf16 v67, s91, v204
v_dot2c_f32_bf16 v68, s90, v205
v_dot2c_f32_bf16 v69, s91, v205
s_waitcnt vmcnt(17)
v_dot2c_f32_bf16 v66, s90, v206
v_dot2c_f32_bf16 v67, s91, v206
v_dot2c_f32_bf16 v68, s90, v207
v_dot2c_f32_bf16 v69, s91, v207
s_waitcnt vmcnt(16)
v_dot2c_f32_bf16 v66, s90, v208
v_dot2c_f32_bf16 v67, s91, v208
v_dot2c_f32_bf16 v68, s90, v209
v_dot2c_f32_bf16 v69, s91, v209
s_waitcnt vmcnt(15)
v_dot2c_f32_bf16 v66, s90, v210
v_dot2c_f32_bf16 v67, s91, v210
v_dot2c_f32_bf16 v68, s90, v211
v_dot2c_f32_bf16 v69, s91, v211
s_waitcnt vmcnt(13)
v_dot2c_f32_bf16 v66, s90, v212
v_dot2c_f32_bf16 v67, s91, v212
v_dot2c_f32_bf16 v68, s90, v213
v_dot2c_f32_bf16 v69, s91, v213
s_waitcnt vmcnt(12)
v_dot2c_f32_bf16 v66, s90, v214
v_dot2c_f32_bf16 v67, s91, v214
v_dot2c_f32_bf16 v68, s90, v215
v_dot2c_f32_bf16 v69, s91, v215
s_cmp_eq_u32 s34, 0
s_cselect_b32 s29, 0, 0x7fbffff0
s_nop 2
v_cvt_pk_bf16_f32 v58, v66, v67
v_cvt_pk_bf16_f32 v59, v68, v69
v_lshlrev_b32 v66, 16, v58
v_and_b32 v67, 0xffff0000, v58
v_lshlrev_b32 v68, 16, v59
v_and_b32 v69, 0xffff0000, v59
v_pk_mul_f32 v[66:67], v[66:67], v[54:55]
v_pk_mul_f32 v[68:69], v[68:69], v[56:57]
v_cvt_pk_bf16_f32 v58, v66, v67
v_cvt_pk_bf16_f32 v59, v68, v69
v_lshlrev_b32 v66, 16, v58
v_and_b32 v67, 0xffff0000, v58
v_lshlrev_b32 v68, 16, v59
v_and_b32 v69, 0xffff0000, v59
v_pk_add_f32 v[66:67], v[66:67], v[34:35]
v_pk_add_f32 v[68:69], v[68:69], v[36:37]
v_cvt_pk_bf16_f32 v66, v66, v67
v_cvt_pk_bf16_f32 v67, v68, v69
buffer_store_dwordx2 v[66:67], v249, s[60:63], s29 offen
s_waitcnt vmcnt(6)
v_dot2c_f32_bf16 v72, s90, v168
v_dot2c_f32_bf16 v73, s91, v168
v_dot2c_f32_bf16 v74, s90, v169
v_dot2c_f32_bf16 v75, s91, v169
v_dot2c_f32_bf16 v76, s90, v170
v_dot2c_f32_bf16 v77, s91, v170
v_dot2c_f32_bf16 v78, s90, v171
v_dot2c_f32_bf16 v79, s91, v171
s_waitcnt vmcnt(5)
v_dot2c_f32_bf16 v72, s90, v172
v_dot2c_f32_bf16 v73, s91, v172
v_dot2c_f32_bf16 v74, s90, v173
v_dot2c_f32_bf16 v75, s91, v173
v_dot2c_f32_bf16 v76, s90, v174
v_dot2c_f32_bf16 v77, s91, v174
v_dot2c_f32_bf16 v78, s90, v175
v_dot2c_f32_bf16 v79, s91, v175
s_waitcnt vmcnt(4)
v_dot2c_f32_bf16 v72, s90, v176
v_dot2c_f32_bf16 v73, s91, v176
v_dot2c_f32_bf16 v74, s90, v177
v_dot2c_f32_bf16 v75, s91, v177
v_dot2c_f32_bf16 v76, s90, v178
v_dot2c_f32_bf16 v77, s91, v178
v_dot2c_f32_bf16 v78, s90, v179
v_dot2c_f32_bf16 v79, s91, v179
s_nop 2
v_cvt_pk_bf16_f32 v58, v72, v73
v_cvt_pk_bf16_f32 v59, v74, v75
v_cvt_pk_bf16_f32 v60, v76, v77
v_cvt_pk_bf16_f32 v61, v78, v79
v_lshlrev_b32 v72, 16, v58
v_and_b32 v73, 0xffff0000, v58
v_lshlrev_b32 v74, 16, v59
v_and_b32 v75, 0xffff0000, v59
v_lshlrev_b32 v76, 16, v60
v_and_b32 v77, 0xffff0000, v60
v_lshlrev_b32 v78, 16, v61
v_and_b32 v79, 0xffff0000, v61
v_pk_mul_f32 v[72:73], v[72:73], v[38:39]
v_pk_mul_f32 v[74:75], v[74:75], v[40:41]
v_pk_mul_f32 v[76:77], v[76:77], v[42:43]
v_pk_mul_f32 v[78:79], v[78:79], v[44:45]
v_cvt_pk_bf16_f32 v58, v72, v73
v_cvt_pk_bf16_f32 v59, v74, v75
v_cvt_pk_bf16_f32 v60, v76, v77
v_cvt_pk_bf16_f32 v61, v78, v79
v_lshlrev_b32 v72, 16, v58
v_and_b32 v73, 0xffff0000, v58
v_lshlrev_b32 v74, 16, v59
v_and_b32 v75, 0xffff0000, v59
v_lshlrev_b32 v76, 16, v60
v_and_b32 v77, 0xffff0000, v60
v_lshlrev_b32 v78, 16, v61
v_and_b32 v79, 0xffff0000, v61
v_pk_add_f32 v[72:73], v[72:73], v[18:19]
v_pk_add_f32 v[74:75], v[74:75], v[20:21]
v_pk_add_f32 v[76:77], v[76:77], v[22:23]
v_pk_add_f32 v[78:79], v[78:79], v[24:25]
v_cvt_pk_bf16_f32 v72, v72, v73
v_cvt_pk_bf16_f32 v73, v74, v75
v_cvt_pk_bf16_f32 v74, v76, v77
v_cvt_pk_bf16_f32 v75, v78, v79
buffer_store_dwordx4 v[72:75], v248, s[60:63], 0 offen
s_waitcnt vmcnt(4)
v_dot2c_f32_bf16 v136, s90, v180
v_dot2c_f32_bf16 v137, s91, v180
v_dot2c_f32_bf16 v138, s90, v181
v_dot2c_f32_bf16 v139, s91, v181
v_dot2c_f32_bf16 v140, s90, v182
v_dot2c_f32_bf16 v141, s91, v182
v_dot2c_f32_bf16 v142, s90, v183
v_dot2c_f32_bf16 v143, s91, v183
s_waitcnt vmcnt(3)
v_dot2c_f32_bf16 v136, s90, v184
v_dot2c_f32_bf16 v137, s91, v184
v_dot2c_f32_bf16 v138, s90, v185
v_dot2c_f32_bf16 v139, s91, v185
v_dot2c_f32_bf16 v140, s90, v186
v_dot2c_f32_bf16 v141, s91, v186
v_dot2c_f32_bf16 v142, s90, v187
v_dot2c_f32_bf16 v143, s91, v187
s_waitcnt vmcnt(2)
v_dot2c_f32_bf16 v136, s90, v188
v_dot2c_f32_bf16 v137, s91, v188
v_dot2c_f32_bf16 v138, s90, v189
v_dot2c_f32_bf16 v139, s91, v189
v_dot2c_f32_bf16 v140, s90, v190
v_dot2c_f32_bf16 v141, s91, v190
v_dot2c_f32_bf16 v142, s90, v191
v_dot2c_f32_bf16 v143, s91, v191
s_nop 2
v_cvt_pk_bf16_f32 v58, v136, v137
v_cvt_pk_bf16_f32 v59, v138, v139
v_cvt_pk_bf16_f32 v60, v140, v141
v_cvt_pk_bf16_f32 v61, v142, v143
v_lshlrev_b32 v136, 16, v58
v_and_b32 v137, 0xffff0000, v58
v_lshlrev_b32 v138, 16, v59
v_and_b32 v139, 0xffff0000, v59
v_lshlrev_b32 v140, 16, v60
v_and_b32 v141, 0xffff0000, v60
v_lshlrev_b32 v142, 16, v61
v_and_b32 v143, 0xffff0000, v61
v_pk_mul_f32 v[136:137], v[136:137], v[46:47]
v_pk_mul_f32 v[138:139], v[138:139], v[48:49]
v_pk_mul_f32 v[140:141], v[140:141], v[50:51]
v_pk_mul_f32 v[142:143], v[142:143], v[52:53]
v_cvt_pk_bf16_f32 v58, v136, v137
v_cvt_pk_bf16_f32 v59, v138, v139
v_cvt_pk_bf16_f32 v60, v140, v141
v_cvt_pk_bf16_f32 v61, v142, v143
v_lshlrev_b32 v136, 16, v58
v_and_b32 v137, 0xffff0000, v58
v_lshlrev_b32 v138, 16, v59
v_and_b32 v139, 0xffff0000, v59
v_lshlrev_b32 v140, 16, v60
v_and_b32 v141, 0xffff0000, v60
v_lshlrev_b32 v142, 16, v61
v_and_b32 v143, 0xffff0000, v61
v_pk_add_f32 v[136:137], v[136:137], v[26:27]
v_pk_add_f32 v[138:139], v[138:139], v[28:29]
v_pk_add_f32 v[140:141], v[140:141], v[30:31]
v_pk_add_f32 v[142:143], v[142:143], v[32:33]
v_cvt_pk_bf16_f32 v136, v136, v137
v_cvt_pk_bf16_f32 v137, v138, v139
v_cvt_pk_bf16_f32 v138, v140, v141
v_cvt_pk_bf16_f32 v139, v142, v143
buffer_store_dwordx4 v[136:139], v248, s[60:63], 0 offen offset:128
s_endpgm
SP_O1B:
s_sleep 1
s_add_u32 s100, s100, 1
s_bitcmp1_b32 s100, 19
s_cbranch_scc1 K_END
buffer_load_dword v230, v229, s[20:23], s94 offen sc0 sc1
s_waitcnt vmcnt(0)
v_cmp_gt_u32 vcc, 1, v230
s_bitcmp1_b32 vcc_lo, s39
s_cbranch_scc1 SP_O1B
s_branch SP_O1B_RET
SP_O2B:
s_sleep 1
s_add_u32 s100, s100, 1
s_bitcmp1_b32 s100, 19
s_cbranch_scc1 K_END
buffer_load_dword v230, v229, s[20:23], s94 offen sc0 sc1
s_waitcnt vmcnt(0)
v_cmp_gt_u32 vcc, 1, v230
s_and_b32 s29, vcc_lo, 15
s_cbranch_scc1 SP_O2B
s_branch SP_O2B_RET
SP_O3B:
s_sleep 1
s_add_u32 s100, s100, 1
s_bitcmp1_b32 s100, 19
s_cbranch_scc1 K_END
buffer_load_dword v230, v229, s[20:23], s94 offen sc0 sc1
s_waitcnt vmcnt(0)
v_cmp_gt_u32 vcc, 2, v230
s_and_b32 s29, vcc_lo, 15
s_cbranch_scc1 SP_O3B
s_branch SP_O3B_RET
SP_P1B:
s_sleep 1
s_add_u32 s100, s100, 1
s_bitcmp1_b32 s100, 19
s_cbranch_scc1 K_END
buffer_load_dword v230, v229, s[20:23], s95 offen sc0 sc1
s_waitcnt vmcnt(0)
v_cmp_gt_u32 vcc, 1, v230
s_and_b32 s29, vcc_lo, 0xff
s_cbranch_scc1 SP_P1B
s_branch SP_P1B_RET
F_NOTYET:
s_bitcmp1_b32 s51, 30
s_cbranch_scc1 F_BSENT
s_bitset1_b32 s51, 30
s_mov_b32 s46, 0x60
s_mov_b32 s50, s28
s_add_u32 s28, s45, 0x0
buffer_store_dwordx4 v[72:75], v169, s[20:23], s28 offen offset:0 sc0 sc1
buffer_store_dwordx4 v[76:79], v169, s[20:23], s28 offen offset:2048 sc0 sc1
s_add_u32 s28, s28, 4096
buffer_store_dwordx4 v[80:83], v169, s[20:23], s28 offen offset:0 sc0 sc1
buffer_store_dwordx4 v[84:87], v169, s[20:23], s28 offen offset:2048 sc0 sc1
s_add_u32 s28, s28, 4096
buffer_store_dwordx4 v[88:91], v169, s[20:23], s28 offen offset:0 sc0 sc1
buffer_store_dwordx4 v[92:95], v169, s[20:23], s28 offen offset:2048 sc0 sc1
s_add_u32 s28, s28, 4096
buffer_store_dwordx4 v[96:99], v169, s[20:23], s28 offen offset:0 sc0 sc1
buffer_store_dwordx4 v[100:103], v169, s[20:23], s28 offen offset:2048 sc0 sc1
s_add_u32 s28, s28, 4096
buffer_store_dwordx4 v[104:107], v169, s[20:23], s28 offen offset:0 sc0 sc1
s_lshl_b32 s28, s3, 2
s_add_u32 s28, s28, 0x240000
buffer_store_dword v65, v64, s[20:23], s28 offen sc0 sc1
s_mov_b32 s28, s50
s_or_b32 s29, s38, 0x40
v_mov_b32 v62, s29
v_mov_b32 v63, s35
s_lshl_b32 s29, s36, 5
s_waitcnt vmcnt(0)
s_mov_b64 exec, 1
buffer_store_byte v62, v63, s[24:27], s29 offen sc0 sc1
s_mov_b64 exec, -1
F_BSENT:
s_lshl_b32 s29, s36, 5
buffer_load_dword v62, v64, s[24:27], s29 offen sc0 sc1
s_waitcnt vmcnt(0)
v_and_b32 v63, 0x40404040, v62
v_cmp_ne_u32 vcc, 0x40404040, v63
s_cbranch_vccnz F_NOB
s_mul_i32 s29, s38, 0x01010101
v_and_b32 v62, 0x0f0f0f0f, v62
v_cmp_ne_u32 vcc, s29, v62
v_mov_b32 v60, 0
s_cbranch_vccnz F_GO
v_mov_b32 v60, 1
s_branch F_GO
F_NOB:
s_sleep 1
s_add_u32 s100, s100, 1
s_bitcmp1_b32 s100, 19
s_cbranch_scc1 K_END
s_branch F_POLL
Q_REDO:
s_mov_b32 s4, 0
s_mov_b32 s51, 0
s_waitcnt vmcnt(0) lgkmcnt(0)
s_branch Q_START
K_FALLBACK:
s_mov_b32 s43, 1
s_mov_b32 s3, 0
s_mov_b32 s86, 0x30000
s_mov_b32 s66, 0
s_mov_b32 s70, 0
s_mov_b32 s74, 0
s_waitcnt vmcnt(0) lgkmcnt(0)
s_barrier
v_mov_b32 v254, 0x7ffffff0
v_mov_b32 v136, 0xff800000
v_mov_b32 v140, 0xff800000
v_mov_b32 v144, 0xff800000
v_mov_b32 v148, 0xff800000
s_mov_b32 s32, 0
s_mov_b32 s33, 32
K_FBLOOP:
s_add_u32 m0, s30, 81920
s_nop 0
buffer_load_dwordx4 v228, s[8:11], s32 offen offset:0  lds
buffer_load_dwordx4 v229, s[8:11], s32 offen offset:1024  lds
buffer_load_dwordx4 v230, s[8:11], s32 offen offset:2048  lds
buffer_load_dwordx4 v231, s[8:11], s32 offen offset:3072  lds
s_waitcnt vmcnt(0)
s_barrier
ds_read_b128 a[144:147], v216 offset:16384
ds_read_b128 a[148:151], v217 offset:16384
ds_read_b128 a[152:155], v218 offset:16384
ds_read_b128 a[156:159], v219 offset:16384
ds_read_b128 a[160:163], v216 offset:20480
ds_read_b128 a[164:167], v217 offset:20480
ds_read_b128 a[168:171], v218 offset:20480
ds_read_b128 a[172:175], v219 offset:20480
s_waitcnt lgkmcnt(0)
v_mfma_f32_16x16x32_bf16 v[8:11], a[144:147], v[152:155], 0
v_mfma_f32_16x16x32_bf16 v[16:19], a[144:147], v[168:171], 0
v_mfma_f32_16x16x32_bf16 v[24:27], a[144:147], v[184:187], 0
v_mfma_f32_16x16x32_bf16 v[32:35], a[144:147], v[200:203], 0
v_mfma_f32_16x16x32_bf16 v[8:11], a[148:151], v[156:159], v[8:11]
v_mfma_f32_16x16x32_bf16 v[16:19], a[148:151], v[172:175], v[16:19]
v_mfma_f32_16x16x32_bf16 v[24:27], a[148:151], v[188:191], v[24:27]
v_mfma_f32_16x16x32_bf16 v[32:35], a[148:151], v[204:207], v[32:35]
v_mfma_f32_16x16x32_bf16 v[8:11], a[152:155], v[160:163], v[8:11]
v_mfma_f32_16x16x32_bf16 v[16:19], a[152:155], v[176:179], v[16:19]
v_mfma_f32_16x16x32_bf16 v[24:27], a[152:155], v[192:195], v[24:27]
v_mfma_f32_16x16x32_bf16 v[32:35], a[152:155], v[208:211], v[32:35]
v_mfma_f32_16x16x32_bf16 v[8:11], a[156:159], v[164:167], v[8:11]
v_mfma_f32_16x16x32_bf16 v[16:19], a[156:159], v[180:183], v[16:19]
v_mfma_f32_16x16x32_bf16 v[24:27], a[156:159], v[196:199], v[24:27]
v_mfma_f32_16x16x32_bf16 v[32:35], a[156:159], v[212:215], v[32:35]
v_mfma_f32_16x16x32_bf16 v[12:15], a[160:163], v[152:155], 0
v_mfma_f32_16x16x32_bf16 v[20:23], a[160:163], v[168:171], 0
v_mfma_f32_16x16x32_bf16 v[28:31], a[160:163], v[184:187], 0
v_mfma_f32_16x16x32_bf16 v[36:39], a[160:163], v[200:203], 0
v_mfma_f32_16x16x32_bf16 v[12:15], a[164:167], v[156:159], v[12:15]
v_mfma_f32_16x16x32_bf16 v[20:23], a[164:167], v[172:175], v[20:23]
v_mfma_f32_16x16x32_bf16 v[28:31], a[164:167], v[188:191], v[28:31]
v_mfma_f32_16x16x32_bf16 v[36:39], a[164:167], v[204:207], v[36:39]
v_mfma_f32_16x16x32_bf16 v[12:15], a[168:171], v[160:163], v[12:15]
v_mfma_f32_16x16x32_bf16 v[20:23], a[168:171], v[176:179], v[20:23]
v_mfma_f32_16x16x32_bf16 v[28:31], a[168:171], v[192:195], v[28:31]
v_mfma_f32_16x16x32_bf16 v[36:39], a[168:171], v[208:211], v[36:39]
v_mfma_f32_16x16x32_bf16 v[12:15], a[172:175], v[164:167], v[12:15]
v_mfma_f32_16x16x32_bf16 v[20:23], a[172:175], v[180:183], v[20:23]
v_mfma_f32_16x16x32_bf16 v[28:31], a[172:175], v[196:199], v[28:31]
v_mfma_f32_16x16x32_bf16 v[36:39], a[172:175], v[212:215], v[36:39]
s_nop 7
s_nop 3
v_max3_f32 v136, v136, v8, v9
v_max3_f32 v136, v136, v10, v11
v_max3_f32 v136, v136, v12, v13
v_max3_f32 v136, v136, v14, v15
v_max3_f32 v140, v140, v16, v17
v_max3_f32 v140, v140, v18, v19
v_max3_f32 v140, v140, v20, v21
v_max3_f32 v140, v140, v22, v23
v_max3_f32 v144, v144, v24, v25
v_max3_f32 v144, v144, v26, v27
v_max3_f32 v144, v144, v28, v29
v_max3_f32 v144, v144, v30, v31
v_max3_f32 v148, v148, v32, v33
v_max3_f32 v148, v148, v34, v35
v_max3_f32 v148, v148, v36, v37
v_max3_f32 v148, v148, v38, v39
ds_read_b128 a[144:147], v216 offset:24576
ds_read_b128 a[148:151], v217 offset:24576
ds_read_b128 a[152:155], v218 offset:24576
ds_read_b128 a[156:159], v219 offset:24576
ds_read_b128 a[160:163], v216 offset:28672
ds_read_b128 a[164:167], v217 offset:28672
ds_read_b128 a[168:171], v218 offset:28672
ds_read_b128 a[172:175], v219 offset:28672
s_waitcnt lgkmcnt(0)
v_mfma_f32_16x16x32_bf16 v[8:11], a[144:147], v[152:155], 0
v_mfma_f32_16x16x32_bf16 v[16:19], a[144:147], v[168:171], 0
v_mfma_f32_16x16x32_bf16 v[24:27], a[144:147], v[184:187], 0
v_mfma_f32_16x16x32_bf16 v[32:35], a[144:147], v[200:203], 0
v_mfma_f32_16x16x32_bf16 v[8:11], a[148:151], v[156:159], v[8:11]
v_mfma_f32_16x16x32_bf16 v[16:19], a[148:151], v[172:175], v[16:19]
v_mfma_f32_16x16x32_bf16 v[24:27], a[148:151], v[188:191], v[24:27]
v_mfma_f32_16x16x32_bf16 v[32:35], a[148:151], v[204:207], v[32:35]
v_mfma_f32_16x16x32_bf16 v[8:11], a[152:155], v[160:163], v[8:11]
v_mfma_f32_16x16x32_bf16 v[16:19], a[152:155], v[176:179], v[16:19]
v_mfma_f32_16x16x32_bf16 v[24:27], a[152:155], v[192:195], v[24:27]
v_mfma_f32_16x16x32_bf16 v[32:35], a[152:155], v[208:211], v[32:35]
v_mfma_f32_16x16x32_bf16 v[8:11], a[156:159], v[164:167], v[8:11]
v_mfma_f32_16x16x32_bf16 v[16:19], a[156:159], v[180:183], v[16:19]
v_mfma_f32_16x16x32_bf16 v[24:27], a[156:159], v[196:199], v[24:27]
v_mfma_f32_16x16x32_bf16 v[32:35], a[156:159], v[212:215], v[32:35]
v_mfma_f32_16x16x32_bf16 v[12:15], a[160:163], v[152:155], 0
v_mfma_f32_16x16x32_bf16 v[20:23], a[160:163], v[168:171], 0
v_mfma_f32_16x16x32_bf16 v[28:31], a[160:163], v[184:187], 0
v_mfma_f32_16x16x32_bf16 v[36:39], a[160:163], v[200:203], 0
v_mfma_f32_16x16x32_bf16 v[12:15], a[164:167], v[156:159], v[12:15]
v_mfma_f32_16x16x32_bf16 v[20:23], a[164:167], v[172:175], v[20:23]
v_mfma_f32_16x16x32_bf16 v[28:31], a[164:167], v[188:191], v[28:31]
v_mfma_f32_16x16x32_bf16 v[36:39], a[164:167], v[204:207], v[36:39]
v_mfma_f32_16x16x32_bf16 v[12:15], a[168:171], v[160:163], v[12:15]
v_mfma_f32_16x16x32_bf16 v[20:23], a[168:171], v[176:179], v[20:23]
v_mfma_f32_16x16x32_bf16 v[28:31], a[168:171], v[192:195], v[28:31]
v_mfma_f32_16x16x32_bf16 v[36:39], a[168:171], v[208:211], v[36:39]
v_mfma_f32_16x16x32_bf16 v[12:15], a[172:175], v[164:167], v[12:15]
v_mfma_f32_16x16x32_bf16 v[20:23], a[172:175], v[180:183], v[20:23]
v_mfma_f32_16x16x32_bf16 v[28:31], a[172:175], v[196:199], v[28:31]
v_mfma_f32_16x16x32_bf16 v[36:39], a[172:175], v[212:215], v[36:39]
s_nop 7
s_nop 3
v_max3_f32 v136, v136, v8, v9
v_max3_f32 v136, v136, v10, v11
v_max3_f32 v136, v136, v12, v13
v_max3_f32 v136, v136, v14, v15
v_max3_f32 v140, v140, v16, v17
v_max3_f32 v140, v140, v18, v19
v_max3_f32 v140, v140, v20, v21
v_max3_f32 v140, v140, v22, v23
v_max3_f32 v144, v144, v24, v25
v_max3_f32 v144, v144, v26, v27
v_max3_f32 v144, v144, v28, v29
v_max3_f32 v144, v144, v30, v31
v_max3_f32 v148, v148, v32, v33
v_max3_f32 v148, v148, v34, v35
v_max3_f32 v148, v148, v36, v37
v_max3_f32 v148, v148, v38, v39
s_barrier
s_add_u32 s32, s32, 16384
s_sub_u32 s33, s33, 1
s_cmp_lg_u32 s33, 0
s_cbranch_scc1 K_FBLOOP
v_mov_b32 v246, v136
s_nop 1
v_permlane16_swap_b32 v136, v246
v_max_f32 v136, v136, v246
v_mov_b32 v246, v136
s_nop 1
v_permlane32_swap_b32 v136, v246
v_max_f32 v136, v136, v246
v_sub_f32 v136, 0, v136
v_mov_b32 v137, v136
v_mov_b32 v138, v136
v_mov_b32 v139, v136
v_mov_b32 v246, v140
s_nop 1
v_permlane16_swap_b32 v140, v246
v_max_f32 v140, v140, v246
v_mov_b32 v246, v140
s_nop 1
v_permlane32_swap_b32 v140, v246
v_max_f32 v140, v140, v246
v_sub_f32 v140, 0, v140
v_mov_b32 v141, v140
v_mov_b32 v142, v140
v_mov_b32 v143, v140
v_mov_b32 v246, v144
s_nop 1
v_permlane16_swap_b32 v144, v246
v_max_f32 v144, v144, v246
v_mov_b32 v246, v144
s_nop 1
v_permlane32_swap_b32 v144, v246
v_max_f32 v144, v144, v246
v_sub_f32 v144, 0, v144
v_mov_b32 v145, v144
v_mov_b32 v146, v144
v_mov_b32 v147, v144
v_mov_b32 v246, v148
s_nop 1
v_permlane16_swap_b32 v148, v246
v_max_f32 v148, v148, v246
v_mov_b32 v246, v148
s_nop 1
v_permlane32_swap_b32 v148, v246
v_max_f32 v148, v148, v246
v_sub_f32 v148, 0, v148
v_mov_b32 v149, v148
v_mov_b32 v150, v148
v_mov_b32 v151, v148
s_add_u32 s32, s7, 0
s_add_u32 m0, s30, 81920
s_nop 0
buffer_load_dwordx4 v228, s[8:11], s32 offen offset:0  lds
buffer_load_dwordx4 v229, s[8:11], s32 offen offset:1024  lds
buffer_load_dwordx4 v230, s[8:11], s32 offen offset:2048  lds
buffer_load_dwordx4 v231, s[8:11], s32 offen offset:3072  lds
s_add_u32 s32, s7, 16384
s_add_u32 m0, s30, 114688
s_nop 0
buffer_load_dwordx4 v228, s[8:11], s32 offen offset:0  lds
buffer_load_dwordx4 v229, s[8:11], s32 offen offset:1024  lds
buffer_load_dwordx4 v230, s[8:11], s32 offen offset:2048  lds
buffer_load_dwordx4 v231, s[8:11], s32 offen offset:3072  lds
s_add_u32 s39, s7, 0
s_add_u32 m0, s30, 131072
s_nop 0
buffer_load_dwordx4 v232, s[12:15], s39 offen offset:0  lds
buffer_load_dwordx4 v233, s[12:15], s39 offen offset:1024  lds
buffer_load_dwordx4 v232, s[12:15], s39 offen offset:2048  lds
buffer_load_dwordx4 v233, s[12:15], s39 offen offset:3072  lds
s_add_u32 s32, s7, 32768
s_add_u32 m0, s30, 65536
s_nop 0
buffer_load_dwordx4 v228, s[8:11], s32 offen offset:0  lds
buffer_load_dwordx4 v229, s[8:11], s32 offen offset:1024  lds
buffer_load_dwordx4 v230, s[8:11], s32 offen offset:2048  lds
buffer_load_dwordx4 v231, s[8:11], s32 offen offset:3072  lds
s_add_u32 s39, s7, 16384
s_add_u32 m0, s30, 147456
s_nop 0
buffer_load_dwordx4 v232, s[12:15], s39 offen offset:0  lds
buffer_load_dwordx4 v233, s[12:15], s39 offen offset:1024  lds
buffer_load_dwordx4 v232, s[12:15], s39 offen offset:2048  lds
buffer_load_dwordx4 v233, s[12:15], s39 offen offset:3072  lds
s_waitcnt vmcnt(0)
s_barrier
ds_read_b128 a[144:147], v216 offset:16384
ds_read_b128 a[148:151], v217 offset:16384
ds_read_b128 a[152:155], v218 offset:16384
ds_read_b128 a[156:159], v219 offset:16384
ds_read_b128 a[160:163], v216 offset:20480
ds_read_b128 a[164:167], v217 offset:20480
ds_read_b128 a[168:171], v218 offset:20480
ds_read_b128 a[172:175], v219 offset:20480
s_add_u32 s32, s7, 32768
s_add_u32 s39, s7, 16384
s_mul_i32 s88, s37, 864
s_mov_b32 s87, s88
v_accvgpr_write_b32 a128, 0
v_accvgpr_write_b32 a129, 0
v_accvgpr_write_b32 a130, 0
v_accvgpr_write_b32 a131, 0
v_accvgpr_write_b32 a132, 0
v_accvgpr_write_b32 a133, 0
v_accvgpr_write_b32 a134, 0
v_accvgpr_write_b32 a135, 0
v_lshrrev_b32 v240, 2, v1
v_mul_u32_u24 v240, 0x2400, v240
v_and_b32 v246, 3, v1
v_lshl_add_u32 v240, v246, 4, v240
v_mul_u32_u24 v243, 3641, v1
v_lshrrev_b32 v243, 16, v243
v_mul_u32_u24 v243, 864, v243
v_add_u32 v243, v243, v244
s_waitcnt lgkmcnt(0)
v_mfma_f32_16x16x32_bf16 v[8:11], a[144:147], v[152:155], v[136:139]
v_mfma_f32_16x16x32_bf16 v[16:19], a[144:147], v[168:171], v[140:143]
v_mfma_f32_16x16x32_bf16 v[24:27], a[144:147], v[184:187], v[144:147]
v_mfma_f32_16x16x32_bf16 v[32:35], a[144:147], v[200:203], v[148:151]
ds_read_b128 a[144:147], v216 offset:24576
v_mfma_f32_16x16x32_bf16 v[8:11], a[148:151], v[156:159], v[8:11]
v_mfma_f32_16x16x32_bf16 v[16:19], a[148:151], v[172:175], v[16:19]
v_mfma_f32_16x16x32_bf16 v[24:27], a[148:151], v[188:191], v[24:27]
v_mfma_f32_16x16x32_bf16 v[32:35], a[148:151], v[204:207], v[32:35]
ds_read_b128 a[148:151], v217 offset:24576
v_mfma_f32_16x16x32_bf16 v[8:11], a[152:155], v[160:163], v[8:11]
v_mfma_f32_16x16x32_bf16 v[16:19], a[152:155], v[176:179], v[16:19]
v_mfma_f32_16x16x32_bf16 v[24:27], a[152:155], v[192:195], v[24:27]
v_mfma_f32_16x16x32_bf16 v[32:35], a[152:155], v[208:211], v[32:35]
ds_read_b128 a[152:155], v218 offset:24576
v_mfma_f32_16x16x32_bf16 v[8:11], a[156:159], v[164:167], v[8:11]
v_mfma_f32_16x16x32_bf16 v[16:19], a[156:159], v[180:183], v[16:19]
v_mfma_f32_16x16x32_bf16 v[24:27], a[156:159], v[196:199], v[24:27]
v_mfma_f32_16x16x32_bf16 v[32:35], a[156:159], v[212:215], v[32:35]
ds_read_b128 a[156:159], v219 offset:24576
v_mfma_f32_16x16x32_bf16 v[12:15], a[160:163], v[152:155], v[136:139]
v_mfma_f32_16x16x32_bf16 v[20:23], a[160:163], v[168:171], v[140:143]
v_mfma_f32_16x16x32_bf16 v[28:31], a[160:163], v[184:187], v[144:147]
v_mfma_f32_16x16x32_bf16 v[36:39], a[160:163], v[200:203], v[148:151]
ds_read_b128 a[160:163], v216 offset:28672
v_mfma_f32_16x16x32_bf16 v[12:15], a[164:167], v[156:159], v[12:15]
v_mfma_f32_16x16x32_bf16 v[20:23], a[164:167], v[172:175], v[20:23]
v_mfma_f32_16x16x32_bf16 v[28:31], a[164:167], v[188:191], v[28:31]
v_mfma_f32_16x16x32_bf16 v[36:39], a[164:167], v[204:207], v[36:39]
ds_read_b128 a[164:167], v217 offset:28672
v_mfma_f32_16x16x32_bf16 v[12:15], a[168:171], v[160:163], v[12:15]
v_mfma_f32_16x16x32_bf16 v[20:23], a[168:171], v[176:179], v[20:23]
v_mfma_f32_16x16x32_bf16 v[28:31], a[168:171], v[192:195], v[28:31]
v_mfma_f32_16x16x32_bf16 v[36:39], a[168:171], v[208:211], v[36:39]
ds_read_b128 a[168:171], v218 offset:28672
v_mfma_f32_16x16x32_bf16 v[12:15], a[172:175], v[164:167], v[12:15]
v_mfma_f32_16x16x32_bf16 v[20:23], a[172:175], v[180:183], v[20:23]
v_mfma_f32_16x16x32_bf16 v[28:31], a[172:175], v[196:199], v[28:31]
v_mfma_f32_16x16x32_bf16 v[36:39], a[172:175], v[212:215], v[36:39]
ds_read_b128 a[172:175], v219 offset:28672
s_nop 7
s_branch K_BODY0
K_CODE_END:
.section .rodata,"a"
.p2align 6
.amdhsa_kernel recurrent_scan__gqa_block_cached__moe_arch_mod__prompt_kernel
  .amdhsa_next_free_vgpr 512
  .amdhsa_next_free_sgpr 102
  .amdhsa_accum_offset 256
  .amdhsa_group_segment_fixed_size 0
  .amdhsa_kernarg_size 104
  .amdhsa_user_sgpr_count 2
  .amdhsa_user_sgpr_kernarg_segment_ptr 1
  .amdhsa_system_sgpr_workgroup_id_x 1
  .amdhsa_float_denorm_mode_32 3
.end_amdhsa_kernel
```

```asm
; @launch grid=(256,1,1) block=(256,1,1) lds=163840
.amdgcn_target "amdgcn-amd-amdhsa--gfx950"
.text
.globl recurrent_scan__gqa_block_cached__moe_arch_mod__prompt_kernel
.p2align 8
.type recurrent_scan__gqa_block_cached__moe_arch_mod__prompt_kernel,@function
recurrent_scan__gqa_block_cached__moe_arch_mod__prompt_kernel:
s_cmp_ge_u32 s2, 256
s_cbranch_scc1 K_END
s_mov_b32 s100, 0
s_load_dwordx16 s[64:79], s[0:1], 0
s_load_dwordx8 s[80:87], s[0:1], 64
s_load_dwordx2 s[88:89], s[0:1], 96
s_lshr_b32 s35, s2, 3
s_and_b32 s36, s2, 7
s_mul_i32 s5, s36, 9
s_lshr_b32 s5, s5, 2
s_lshl_b32 s3, s36, 8
s_lshl_b32 s28, s35, 3
s_add_u32 s3, s3, s28
v_lshrrev_b32 v5, 5, v0
v_add_u32 v5, s3, v5
v_and_b32 v6, 31, v0
v_mul_u32_u24 v7, 0x480, v5
v_lshl_add_u32 v7, v6, 2, v7
v_and_b32 v1, 63, v0
v_lshrrev_b32 v2, 6, v0
v_lshlrev_b32 v8, 2, v6
v_readfirstlane_b32 s37, v2
v_and_b32 v3, 15, v1
v_lshrrev_b32 v4, 4, v1
s_getpc_b64 s[96:97]
PC_a:
s_sub_u32 s96, s96, PC_a-recurrent_scan__gqa_block_cached__moe_arch_mod__prompt_kernel
s_subb_u32 s97, s97, 0
s_lshl_b32 s50, s35, 2
s_add_u32 s50, s50, s37
s_min_u32 s50, s50, ((K_HOT_END-recurrent_scan__gqa_block_cached__moe_arch_mod__prompt_kernel)>>10)-1
s_lshl_b32 s50, s50, 10
v_lshlrev_b32 v11, 4, v1
v_add_u32 v11, s50, v11
global_load_dwordx4 v[172:175], v11, s[96:97]
s_waitcnt lgkmcnt(0)
s_mov_b32 s52, s64
s_and_b32 s53, s65, 0xffff
s_mov_b32 s54, 0x240000
s_mov_b32 s55, 0x00020000
buffer_load_dword v18, v7, s[52:55], 0 offen offset:0
buffer_load_dword v19, v7, s[52:55], 0 offen offset:128
buffer_load_dword v20, v7, s[52:55], 0 offen offset:256
buffer_load_dword v21, v7, s[52:55], 0 offen offset:384
buffer_load_dword v22, v7, s[52:55], 0 offen offset:512
buffer_load_dword v23, v7, s[52:55], 0 offen offset:640
buffer_load_dword v24, v7, s[52:55], 0 offen offset:768
buffer_load_dword v25, v7, s[52:55], 0 offen offset:896
buffer_load_dword v26, v7, s[52:55], 0 offen offset:1024
s_mov_b32 s28, 0x24c000
s_load_dwordx2 s[6:7], s[88:89], s28
s_mov_b32 s92, s76
s_and_b32 s93, s77, 0xffff
s_mov_b32 s94, 0x480
s_mov_b32 s95, 0x00020000
buffer_load_dword v28, v8, s[92:95], 0 offen offset:0
buffer_load_dword v29, v8, s[92:95], 0 offen offset:128
buffer_load_dword v30, v8, s[92:95], 0 offen offset:256
buffer_load_dword v31, v8, s[92:95], 0 offen offset:384
buffer_load_dword v32, v8, s[92:95], 0 offen offset:512
buffer_load_dword v33, v8, s[92:95], 0 offen offset:640
buffer_load_dword v34, v8, s[92:95], 0 offen offset:768
buffer_load_dword v35, v8, s[92:95], 0 offen offset:896
buffer_load_dword v36, v8, s[92:95], 0 offen offset:1024
s_mov_b32 s20, s88
s_and_b32 s21, s89, 0xffff
s_mov_b32 s22, 0x8000000
s_mov_b32 s23, 0x00020000
s_lshr_b32 s45, s3, 4
s_mul_i32 s45, s45, 18432
s_and_b32 s29, s3, 15
s_lshl_b32 s29, s29, 4
s_add_u32 s45, s45, s29
v_lshrrev_b32 v9, 1, v0
v_lshlrev_b32 v9, 8, v9
v_and_b32 v10, 1, v0
v_lshl_add_u32 v9, v10, 6, v9
s_add_u32 s29, s45, 0x1800000
v_add_u32 v9, s29, v9
s_lshl_b32 s28, s36, 8
s_add_u32 s28, s28, 0x24ac00
v_lshlrev_b32 v10, 6, v0
v_add_u32 v10, s28, v10
v_cmp_lt_u32 vcc, 143, v0
s_lshl_b32 s29, s3, 2
s_add_u32 s29, s29, 0x1a40000
v_cndmask_b32 v9, v9, v10, vcc
v_mov_b32 v10, s29
v_cmp_lt_u32 vcc, 147, v0
s_nop 1
v_cndmask_b32 v9, v9, v10, vcc
buffer_load_dword v176, v9, s[20:23], 0 offen sc1
s_mov_b32 s16, s70
s_and_b32 s17, s71, 0xffff
s_mov_b32 s18, 0x480000
s_mov_b32 s19, 0x00020000
v_add_u32 v9, 0, v4
v_lshlrev_b32 v10, 1, v9
v_xor_b32 v10, v10, v3
v_lshlrev_b32 v10, 4, v10
v_lshl_add_u32 v238, v9, 13, v10
v_add_u32 v9, 4, v4
v_lshlrev_b32 v10, 1, v9
v_xor_b32 v10, v10, v3
v_lshlrev_b32 v10, 4, v10
v_lshl_add_u32 v239, v9, 13, v10
v_subrev_u32 v239, 1024, v239
s_cmp_eq_u32 s37, 0
s_cbranch_scc1 F_NOWQ
s_sub_u32 s28, s37, 1
s_lshl_b32 s49, s28, 11
s_lshl_b32 s28, s28, 16
s_lshl_b32 s34, s35, 8
s_add_u32 s34, s34, s28
s_lshl_b32 s28, s5, 18
s_add_u32 s34, s34, s28
s_add_u32 m0, s49, 65536
s_nop 0
buffer_load_dwordx4 v238, s[16:19], s34 offen offset:0 lds
buffer_load_dwordx4 v239, s[16:19], s34 offen offset:1024 lds
s_add_u32 s34, s34, 196608
s_sub_u32 s51, s34, 4718592
s_cselect_b32 s34, s34, s51
s_add_u32 m0, s49, 71680
s_nop 0
buffer_load_dwordx4 v238, s[16:19], s34 offen offset:0 lds
buffer_load_dwordx4 v239, s[16:19], s34 offen offset:1024 lds
s_add_u32 s34, s34, 196608
s_sub_u32 s51, s34, 4718592
s_cselect_b32 s34, s34, s51
s_add_u32 m0, s49, 77824
s_nop 0
buffer_load_dwordx4 v238, s[16:19], s34 offen offset:0 lds
buffer_load_dwordx4 v239, s[16:19], s34 offen offset:1024 lds
s_add_u32 s34, s34, 196608
s_sub_u32 s51, s34, 4718592
s_cselect_b32 s34, s34, s51
s_add_u32 m0, s49, 83968
s_nop 0
buffer_load_dwordx4 v238, s[16:19], s34 offen offset:0 lds
buffer_load_dwordx4 v239, s[16:19], s34 offen offset:1024 lds
s_add_u32 s34, s34, 196608
s_sub_u32 s51, s34, 4718592
s_cselect_b32 s34, s34, s51
s_add_u32 m0, s49, 90112
s_nop 0
buffer_load_dwordx4 v238, s[16:19], s34 offen offset:0 lds
buffer_load_dwordx4 v239, s[16:19], s34 offen offset:1024 lds
s_add_u32 s34, s34, 196608
s_sub_u32 s51, s34, 4718592
s_cselect_b32 s34, s34, s51
F_NOWQ:
s_getreg_b32 s38, hwreg(HW_REG_XCC_ID, 0, 4)
s_mov_b32 s24, s86
s_and_b32 s25, s87, 0xffff
s_mov_b32 s26, 0x100
s_mov_b32 s27, 0x00020000
s_add_u32 s28, s2, s37
s_cbranch_scc1 F_NOX
s_cmp_eq_u32 s28, 0
s_cbranch_scc0 F_NOX
s_or_b32 s28, s38, 0x80
v_mov_b32 v9, s28
v_mov_b32 v10, 0
s_mov_b64 exec, 1
buffer_store_byte v9, v10, s[24:27], 0 offen sc0 sc1
s_mov_b64 exec, -1
s_waitcnt vmcnt(2)
F_NOX:
v_and_b32 v66, 7, v1
v_mul_u32_u24 v67, 1168, v66
v_lshrrev_b32 v68, 5, v1
v_lshl_add_u32 v67, v68, 6, v67
v_bfe_u32 v69, v1, 3, 2
v_lshl_add_u32 v67, v69, 3, v67
v_add_u32 v168, 0x24000, v67
v_lshlrev_b32 v70, 10, v68
v_lshl_add_u32 v71, v69, 4, v66
v_lshl_add_u32 v169, v71, 4, v70
v_lshlrev_b32 v244, 4, v1
v_bfe_u32 v9, v1, 2, 2
v_and_b32 v10, 3, v1
v_lshl_add_u32 v11, v4, 2, v9
v_and_b32 v12, 7, v11
v_lshrrev_b32 v14, 1, v10
v_xor_b32 v14, v14, v12
v_and_b32 v15, 1, v10
v_lshlrev_b32 v15, 4, v15
v_lshl_add_u32 v15, v11, 8, v15
v_add_u32 v15, 0x10000, v15
v_xor_b32 v16, 0, v14
v_lshl_add_u32 v234, v16, 5, v15
v_xor_b32 v16, 2, v14
v_lshl_add_u32 v235, v16, 5, v15
v_xor_b32 v16, 4, v14
v_lshl_add_u32 v236, v16, 5, v15
v_xor_b32 v16, 6, v14
v_lshl_add_u32 v237, v16, 5, v15
s_lshl2_add_u32 s50, s36, s37
s_lshr_b32 s29, s35, 2
s_add_u32 s28, s29, 0
s_and_b32 s28, s28, 3
s_lshl2_add_u32 s28, s50, s28
s_mul_i32 s28, s28, 18432
v_add_u32 v240, s28, v244
s_add_u32 s28, s29, 1
s_and_b32 s28, s28, 3
s_lshl2_add_u32 s28, s50, s28
s_mul_i32 s28, s28, 18432
v_add_u32 v241, s28, v244
s_add_u32 s28, s29, 2
s_and_b32 s28, s28, 3
s_lshl2_add_u32 s28, s50, s28
s_mul_i32 s28, s28, 18432
v_add_u32 v242, s28, v244
s_add_u32 s28, s29, 3
s_and_b32 s28, s28, 3
s_lshl2_add_u32 s28, s50, s28
s_mul_i32 s28, s28, 18432
v_add_u32 v243, s28, v244
s_mov_b32 s40, 0x3e0293ee
s_mov_b32 s41, 0x3e0293ee
s_mov_b32 s76, 0x3ae38e39
s_mov_b32 s77, 0x3727c5ac
s_mov_b32 s75, 0xffff0000
s_cmp_eq_u32 s37, 0
s_cbranch_scc0 F_W1
s_waitcnt vmcnt(10)
s_branch F_W2
F_W1:
s_waitcnt vmcnt(20)
F_W2:
v_lshlrev_b32 v40, 16, v18
v_and_b32 v41, s75, v18
v_lshlrev_b32 v42, 16, v19
v_and_b32 v43, s75, v19
v_lshlrev_b32 v44, 16, v20
v_and_b32 v45, s75, v20
v_lshlrev_b32 v46, 16, v21
v_and_b32 v47, s75, v21
v_lshlrev_b32 v48, 16, v22
v_and_b32 v49, s75, v22
v_lshlrev_b32 v50, 16, v23
v_and_b32 v51, s75, v23
v_lshlrev_b32 v52, 16, v24
v_and_b32 v53, s75, v24
v_lshlrev_b32 v54, 16, v25
v_and_b32 v55, s75, v25
v_lshlrev_b32 v56, 16, v26
v_and_b32 v57, s75, v26
v_pk_add_f32 v[60:61], v[40:41], v[42:43]
v_pk_add_f32 v[62:63], v[44:45], v[46:47]
v_pk_add_f32 v[60:61], v[60:61], v[48:49]
v_pk_add_f32 v[62:63], v[62:63], v[50:51]
v_pk_add_f32 v[60:61], v[60:61], v[52:53]
v_pk_add_f32 v[62:63], v[62:63], v[54:55]
v_pk_add_f32 v[60:61], v[60:61], v[56:57]
v_pk_add_f32 v[60:61], v[60:61], v[62:63]
v_add_f32 v60, v60, v61
s_nop 1
v_add_f32_dpp v61, v60, v60 row_ror:8 row_mask:0xf bank_mask:0xf
s_nop 1
v_add_f32_dpp v60, v61, v61 row_ror:4 row_mask:0xf bank_mask:0xf
s_nop 1
v_add_f32_dpp v61, v60, v60 row_ror:2 row_mask:0xf bank_mask:0xf
s_nop 1
v_add_f32_dpp v60, v61, v61 row_ror:1 row_mask:0xf bank_mask:0xf
v_mov_b32 v61, v60
s_nop 1
v_permlane16_swap_b32 v60, v61
v_add_f32 v60, v60, v61
v_mul_f32 v60, s76, v60
v_mov_b32 v61, v60
v_pk_add_f32 v[66:67], v[40:41], v[60:61] neg_lo:[0,1] neg_hi:[0,1]
v_pk_mul_f32 v[62:63], v[66:67], v[66:67]
v_pk_add_f32 v[68:69], v[42:43], v[60:61] neg_lo:[0,1] neg_hi:[0,1]
v_pk_fma_f32 v[62:63], v[68:69], v[68:69], v[62:63]
v_pk_add_f32 v[66:67], v[44:45], v[60:61] neg_lo:[0,1] neg_hi:[0,1]
v_pk_fma_f32 v[62:63], v[66:67], v[66:67], v[62:63]
v_pk_add_f32 v[68:69], v[46:47], v[60:61] neg_lo:[0,1] neg_hi:[0,1]
v_pk_fma_f32 v[62:63], v[68:69], v[68:69], v[62:63]
v_pk_add_f32 v[66:67], v[48:49], v[60:61] neg_lo:[0,1] neg_hi:[0,1]
v_pk_fma_f32 v[62:63], v[66:67], v[66:67], v[62:63]
v_pk_add_f32 v[68:69], v[50:51], v[60:61] neg_lo:[0,1] neg_hi:[0,1]
v_pk_fma_f32 v[62:63], v[68:69], v[68:69], v[62:63]
v_pk_add_f32 v[66:67], v[52:53], v[60:61] neg_lo:[0,1] neg_hi:[0,1]
v_pk_fma_f32 v[62:63], v[66:67], v[66:67], v[62:63]
v_pk_add_f32 v[68:69], v[54:55], v[60:61] neg_lo:[0,1] neg_hi:[0,1]
v_pk_fma_f32 v[62:63], v[68:69], v[68:69], v[62:63]
v_pk_add_f32 v[66:67], v[56:57], v[60:61] neg_lo:[0,1] neg_hi:[0,1]
v_pk_fma_f32 v[62:63], v[66:67], v[66:67], v[62:63]
v_add_f32 v61, v62, v63
s_nop 1
v_add_f32_dpp v62, v61, v61 row_ror:8 row_mask:0xf bank_mask:0xf
s_nop 1
v_add_f32_dpp v61, v62, v62 row_ror:4 row_mask:0xf bank_mask:0xf
s_nop 1
v_add_f32_dpp v62, v61, v61 row_ror:2 row_mask:0xf bank_mask:0xf
s_nop 1
v_add_f32_dpp v61, v62, v62 row_ror:1 row_mask:0xf bank_mask:0xf
v_mov_b32 v62, v61
s_nop 1
v_permlane16_swap_b32 v61, v62
v_add_f32 v61, v61, v62
v_mul_f32 v61, s76, v61
v_cvt_pk_bf16_f32 v60, v60, v60
v_lshlrev_b32 v60, 16, v60
v_cvt_pk_bf16_f32 v61, v61, v61
v_lshlrev_b32 v61, 16, v61
v_add_f32 v61, s77, v61
v_cvt_pk_bf16_f32 v61, v61, v61
v_lshlrev_b32 v61, 16, v61
v_sqrt_f32 v61, v61
s_nop 0
v_cvt_pk_bf16_f32 v61, v61, v61
v_lshlrev_b32 v61, 16, v61
v_rcp_f32 v62, v61
v_mov_b32 v63, 0
v_lshrrev_b32 v69, 5, v0
v_mul_u32_u24 v65, 1168, v69
v_lshl_add_u32 v65, v6, 2, v65
v_add_u32 v209, 0x24000, v65
s_cmp_eq_u32 s37, 0
s_cbranch_scc0 F_W3
s_waitcnt vmcnt(1)
F_W3:
s_waitcnt vmcnt(11)
v_mov_b32 v70, v60
v_mov_b32 v71, v60
v_mov_b32 v72, v61
v_mov_b32 v73, v61
v_mov_b32 v74, v62
v_mov_b32 v75, v62
v_pk_add_f32 v[40:41], v[40:41], v[70:71] neg_lo:[0,1] neg_hi:[0,1]
v_cvt_pk_bf16_f32 v68, v40, v41
v_lshlrev_b32 v40, 16, v68
v_and_b32 v41, s75, v68
v_pk_mul_f32 v[66:67], v[40:41], v[74:75]
v_pk_fma_f32 v[40:41], v[66:67], v[72:73], v[40:41] neg_lo:[1,0,0] neg_hi:[1,0,0]
v_pk_fma_f32 v[66:67], v[40:41], v[74:75], v[66:67]
v_cvt_pk_bf16_f32 v200, v66, v67
v_pk_mul_f32 v[66:67], v[66:67], s[40:41]
v_dot2_f32_bf16 v63, v200, v28, v63
v_cvt_pk_bf16_f32 v18, v66, v67
ds_write_b32 v209, v18 offset:0
v_pk_add_f32 v[42:43], v[42:43], v[70:71] neg_lo:[0,1] neg_hi:[0,1]
v_cvt_pk_bf16_f32 v68, v42, v43
v_lshlrev_b32 v42, 16, v68
v_and_b32 v43, s75, v68
v_pk_mul_f32 v[66:67], v[42:43], v[74:75]
v_pk_fma_f32 v[42:43], v[66:67], v[72:73], v[42:43] neg_lo:[1,0,0] neg_hi:[1,0,0]
v_pk_fma_f32 v[66:67], v[42:43], v[74:75], v[66:67]
v_cvt_pk_bf16_f32 v201, v66, v67
v_pk_mul_f32 v[66:67], v[66:67], s[40:41]
v_dot2_f32_bf16 v63, v201, v29, v63
v_cvt_pk_bf16_f32 v19, v66, v67
ds_write_b32 v209, v19 offset:128
v_pk_add_f32 v[44:45], v[44:45], v[70:71] neg_lo:[0,1] neg_hi:[0,1]
v_cvt_pk_bf16_f32 v68, v44, v45
v_lshlrev_b32 v44, 16, v68
v_and_b32 v45, s75, v68
v_pk_mul_f32 v[66:67], v[44:45], v[74:75]
v_pk_fma_f32 v[44:45], v[66:67], v[72:73], v[44:45] neg_lo:[1,0,0] neg_hi:[1,0,0]
v_pk_fma_f32 v[66:67], v[44:45], v[74:75], v[66:67]
v_cvt_pk_bf16_f32 v202, v66, v67
v_pk_mul_f32 v[66:67], v[66:67], s[40:41]
v_dot2_f32_bf16 v63, v202, v30, v63
v_cvt_pk_bf16_f32 v20, v66, v67
ds_write_b32 v209, v20 offset:256
v_pk_add_f32 v[46:47], v[46:47], v[70:71] neg_lo:[0,1] neg_hi:[0,1]
v_cvt_pk_bf16_f32 v68, v46, v47
v_lshlrev_b32 v46, 16, v68
v_and_b32 v47, s75, v68
v_pk_mul_f32 v[66:67], v[46:47], v[74:75]
v_pk_fma_f32 v[46:47], v[66:67], v[72:73], v[46:47] neg_lo:[1,0,0] neg_hi:[1,0,0]
v_pk_fma_f32 v[66:67], v[46:47], v[74:75], v[66:67]
v_cvt_pk_bf16_f32 v203, v66, v67
v_pk_mul_f32 v[66:67], v[66:67], s[40:41]
v_dot2_f32_bf16 v63, v203, v31, v63
v_cvt_pk_bf16_f32 v21, v66, v67
ds_write_b32 v209, v21 offset:384
v_pk_add_f32 v[48:49], v[48:49], v[70:71] neg_lo:[0,1] neg_hi:[0,1]
v_cvt_pk_bf16_f32 v68, v48, v49
v_lshlrev_b32 v48, 16, v68
v_and_b32 v49, s75, v68
v_pk_mul_f32 v[66:67], v[48:49], v[74:75]
v_pk_fma_f32 v[48:49], v[66:67], v[72:73], v[48:49] neg_lo:[1,0,0] neg_hi:[1,0,0]
v_pk_fma_f32 v[66:67], v[48:49], v[74:75], v[66:67]
v_cvt_pk_bf16_f32 v204, v66, v67
v_pk_mul_f32 v[66:67], v[66:67], s[40:41]
v_dot2_f32_bf16 v63, v204, v32, v63
v_cvt_pk_bf16_f32 v22, v66, v67
ds_write_b32 v209, v22 offset:512
v_pk_add_f32 v[50:51], v[50:51], v[70:71] neg_lo:[0,1] neg_hi:[0,1]
v_cvt_pk_bf16_f32 v68, v50, v51
v_lshlrev_b32 v50, 16, v68
v_and_b32 v51, s75, v68
v_pk_mul_f32 v[66:67], v[50:51], v[74:75]
v_pk_fma_f32 v[50:51], v[66:67], v[72:73], v[50:51] neg_lo:[1,0,0] neg_hi:[1,0,0]
v_pk_fma_f32 v[66:67], v[50:51], v[74:75], v[66:67]
v_cvt_pk_bf16_f32 v205, v66, v67
v_pk_mul_f32 v[66:67], v[66:67], s[40:41]
v_dot2_f32_bf16 v63, v205, v33, v63
v_cvt_pk_bf16_f32 v23, v66, v67
ds_write_b32 v209, v23 offset:640
v_pk_add_f32 v[52:53], v[52:53], v[70:71] neg_lo:[0,1] neg_hi:[0,1]
v_cvt_pk_bf16_f32 v68, v52, v53
v_lshlrev_b32 v52, 16, v68
v_and_b32 v53, s75, v68
v_pk_mul_f32 v[66:67], v[52:53], v[74:75]
v_pk_fma_f32 v[52:53], v[66:67], v[72:73], v[52:53] neg_lo:[1,0,0] neg_hi:[1,0,0]
v_pk_fma_f32 v[66:67], v[52:53], v[74:75], v[66:67]
v_cvt_pk_bf16_f32 v206, v66, v67
v_pk_mul_f32 v[66:67], v[66:67], s[40:41]
v_dot2_f32_bf16 v63, v206, v34, v63
v_cvt_pk_bf16_f32 v24, v66, v67
ds_write_b32 v209, v24 offset:768
v_pk_add_f32 v[54:55], v[54:55], v[70:71] neg_lo:[0,1] neg_hi:[0,1]
v_cvt_pk_bf16_f32 v68, v54, v55
v_lshlrev_b32 v54, 16, v68
v_and_b32 v55, s75, v68
v_pk_mul_f32 v[66:67], v[54:55], v[74:75]
v_pk_fma_f32 v[54:55], v[66:67], v[72:73], v[54:55] neg_lo:[1,0,0] neg_hi:[1,0,0]
v_pk_fma_f32 v[66:67], v[54:55], v[74:75], v[66:67]
v_cvt_pk_bf16_f32 v207, v66, v67
v_pk_mul_f32 v[66:67], v[66:67], s[40:41]
v_dot2_f32_bf16 v63, v207, v35, v63
v_cvt_pk_bf16_f32 v25, v66, v67
ds_write_b32 v209, v25 offset:896
v_pk_add_f32 v[56:57], v[56:57], v[70:71] neg_lo:[0,1] neg_hi:[0,1]
v_cvt_pk_bf16_f32 v68, v56, v57
v_lshlrev_b32 v56, 16, v68
v_and_b32 v57, s75, v68
v_pk_mul_f32 v[66:67], v[56:57], v[74:75]
v_pk_fma_f32 v[56:57], v[66:67], v[72:73], v[56:57] neg_lo:[1,0,0] neg_hi:[1,0,0]
v_pk_fma_f32 v[66:67], v[56:57], v[74:75], v[66:67]
v_cvt_pk_bf16_f32 v208, v66, v67
v_pk_mul_f32 v[66:67], v[66:67], s[40:41]
v_dot2_f32_bf16 v63, v208, v36, v63
v_cvt_pk_bf16_f32 v26, v66, v67
ds_write_b32 v209, v26 offset:1024
s_nop 2
s_nop 1
v_add_f32_dpp v62, v63, v63 row_ror:8 row_mask:0xf bank_mask:0xf
s_nop 1
v_add_f32_dpp v63, v62, v62 row_ror:4 row_mask:0xf bank_mask:0xf
s_nop 1
v_add_f32_dpp v62, v63, v63 row_ror:2 row_mask:0xf bank_mask:0xf
s_nop 1
v_add_f32_dpp v63, v62, v62 row_ror:1 row_mask:0xf bank_mask:0xf
v_mov_b32 v62, v63
s_nop 1
v_permlane16_swap_b32 v63, v62
v_add_f32 v63, v63, v62
v_cvt_pk_bf16_f32 v63, v63, v63
v_lshlrev_b32 v63, 16, v63
v_ashrrev_i32 v66, 31, v63
v_or_b32 v66, 0x80000000, v66
v_xor_b32 v63, v63, v66
v_and_b32 v63, s75, v63
v_sub_u32 v66, 0xffff, v5
v_or_b32 v63, v63, v66
v_lshlrev_b32 v66, 2, v69
v_add_u32 v66, 0x26480, v66
ds_write_b32 v66, v63
v_and_b32 v64, 7, v1
v_lshlrev_b32 v64, 2, v64
s_waitcnt lgkmcnt(0)
s_barrier
s_mul_i32 s101, s6, 0x9e3779b1
s_add_u32 s101, s101, 0x7f4a7c15
s_mul_i32 s47, s7, 0x85ebca6b
s_add_u32 s47, s47, 0x165667b1
s_cmp_eq_u32 s37, 0
s_cbranch_scc0 F_OTHER
ds_read2_b64 v[72:75], v168 offset0:0 offset1:4
ds_read2_b64 v[76:79], v168 offset0:16 offset1:20
ds_read2_b64 v[80:83], v168 offset0:32 offset1:36
ds_read2_b64 v[84:87], v168 offset0:48 offset1:52
ds_read2_b64 v[88:91], v168 offset0:64 offset1:68
ds_read2_b64 v[92:95], v168 offset0:80 offset1:84
ds_read2_b64 v[96:99], v168 offset0:96 offset1:100
ds_read2_b64 v[100:103], v168 offset0:112 offset1:116
ds_read2_b64 v[104:107], v168 offset0:128 offset1:132
v_add_u32 v65, 0x26480, v64
ds_read_b32 v65, v65
s_add_u32 s28, s45, 0x1800000
s_waitcnt lgkmcnt(9)
buffer_store_dwordx4 v[72:75], v169, s[20:23], s28 offen offset:0
s_waitcnt lgkmcnt(8)
buffer_store_dwordx4 v[76:79], v169, s[20:23], s28 offen offset:2048
s_add_u32 s28, s28, 4096
s_waitcnt lgkmcnt(7)
buffer_store_dwordx4 v[80:83], v169, s[20:23], s28 offen offset:0
s_waitcnt lgkmcnt(6)
buffer_store_dwordx4 v[84:87], v169, s[20:23], s28 offen offset:2048
s_add_u32 s28, s28, 4096
s_waitcnt lgkmcnt(5)
buffer_store_dwordx4 v[88:91], v169, s[20:23], s28 offen offset:0
s_waitcnt lgkmcnt(4)
buffer_store_dwordx4 v[92:95], v169, s[20:23], s28 offen offset:2048
s_add_u32 s28, s28, 4096
s_waitcnt lgkmcnt(3)
buffer_store_dwordx4 v[96:99], v169, s[20:23], s28 offen offset:0
s_waitcnt lgkmcnt(2)
buffer_store_dwordx4 v[100:103], v169, s[20:23], s28 offen offset:2048
s_add_u32 s28, s28, 4096
s_waitcnt lgkmcnt(1)
buffer_store_dwordx4 v[104:107], v169, s[20:23], s28 offen offset:0
s_lshl_b32 s28, s3, 2
s_add_u32 s28, s28, 0x1a40000
s_waitcnt lgkmcnt(0)
buffer_store_dword v65, v64, s[20:23], s28 offen
s_and_b32 s29, s101, -16
s_or_b32 s29, s29, s38
v_mov_b32 v58, s29
v_mov_b32 v59, s47
s_lshl_b32 s29, s35, 3
v_mov_b32 v61, s29
s_lshl_b32 s28, s36, 8
s_add_u32 s28, s28, 0x24d000
s_waitcnt vmcnt(0)
s_mov_b64 exec, 1
buffer_store_dwordx2 v[58:59], v61, s[20:23], s28 offen
s_mov_b64 exec, -1
s_branch F_JOIN
F_END0:
.p2align 12
K_P1:
F_OTHER:
STUB_0:
s_mov_b64 exec, 0
s_cmp_eq_u32 s37, 1
s_cbranch_scc1 STUB_A1
s_cmp_eq_u32 s37, 2
s_cbranch_scc1 STUB_A2
s_cmp_eq_u32 s37, 3
s_cbranch_scc1 STUB_A3
s_mov_b64 exec, -1
HOP_R1:
s_add_u32 m0, s49, 96256
s_nop 0
buffer_load_dwordx4 v238, s[16:19], s34 offen offset:0 lds
buffer_load_dwordx4 v239, s[16:19], s34 offen offset:1024 lds
s_add_u32 s34, s34, 196608
s_sub_u32 s51, s34, 4718592
s_cselect_b32 s34, s34, s51
s_add_u32 m0, s49, 102400
s_nop 0
buffer_load_dwordx4 v238, s[16:19], s34 offen offset:0 lds
buffer_load_dwordx4 v239, s[16:19], s34 offen offset:1024 lds
s_add_u32 s34, s34, 196608
s_sub_u32 s51, s34, 4718592
s_cselect_b32 s34, s34, s51
s_add_u32 m0, s49, 108544
s_nop 0
buffer_load_dwordx4 v238, s[16:19], s34 offen offset:0 lds
buffer_load_dwordx4 v239, s[16:19], s34 offen offset:1024 lds
s_add_u32 s34, s34, 196608
s_sub_u32 s51, s34, 4718592
s_cselect_b32 s34, s34, s51
s_mov_b64 exec, 0
s_cmp_eq_u32 s37, 1
s_cbranch_scc1 STUB_B1
s_cmp_eq_u32 s37, 2
s_cbranch_scc1 STUB_B2
s_cmp_eq_u32 s37, 3
s_cbranch_scc1 STUB_B3
s_mov_b64 exec, -1
HOP_R2:
F_JOIN:
s_lshl_b32 s49, s37, 11
s_lshl_b32 s28, s37, 16
s_lshl_b32 s34, s35, 8
s_add_u32 s34, s34, s28
s_lshl_b32 s28, s5, 18
s_add_u32 s34, s34, s28
s_add_u32 s34, s34, 1572864
s_sub_u32 s51, s34, 4718592
s_cselect_b32 s34, s34, s51
s_lshl_b32 s30, s37, 12
s_lshl_b32 s31, s37, 10
s_lshl_b32 s92, s36, 5
s_add_u32 s92, s92, s35
s_lshl2_add_u32 s92, s92, s37
s_lshl_b32 s44, s92, 14
s_add_u32 s44, s44, 0x400000
s_mov_b32 s42, 0x5f800000
s_mov_b32 s43, 0
s_lshr_b32 s92, s35, 1
s_lshl_b32 s92, s92, 19
s_add_u32 s66, s66, s92
s_addc_u32 s67, s67, 0
s_add_u32 s68, s68, s92
s_addc_u32 s69, s69, 0
s_mov_b32 s8, s66
s_and_b32 s9, s67, 0xffff
s_mov_b32 s10, 0x80000
s_mov_b32 s11, 0x00020000
s_mov_b32 s12, s68
s_and_b32 s13, s69, 0xffff
s_mov_b32 s14, 0x80000
s_mov_b32 s15, 0x00020000
s_mov_b32 s56, s72
s_and_b32 s57, s73, 0xffff
s_mov_b32 s58, 0x480000
s_mov_b32 s59, 0x00020000
s_mov_b32 s60, s84
s_and_b32 s61, s85, 0xffff
s_mov_b32 s62, 0x240000
s_mov_b32 s63, 0x00020000
s_mov_b32 s64, s78
s_and_b32 s65, s79, 0xffff
s_mov_b32 s66, 0x510000
s_mov_b32 s67, 0x00020000
s_mov_b32 s68, s80
s_and_b32 s69, s81, 0xffff
s_mov_b32 s70, 0x510000
s_mov_b32 s71, 0x00020000
s_mov_b32 s72, s82
s_and_b32 s73, s83, 0xffff
s_mov_b32 s74, 0x510000
s_mov_b32 s75, 0x00020000
s_lshr_b32 s92, s35, 2
s_mul_i32 s89, s92, 589824
s_and_b32 s92, s35, 3
s_mul_i32 s92, s92, 288
s_add_u32 s89, s89, s92
s_cmp_eq_u32 s37, 0
s_cbranch_scc1 F_W0P
s_waitcnt vmcnt(0)
s_branch F_BAR2
HOP_RET1:
s_mov_b64 exec, -1
s_branch HOP_R1
HOP_RET2:
s_mov_b64 exec, -1
s_branch HOP_R2
F_W0P:
s_mov_b32 s46, 0x20
s_lshl_b32 s28, s36, 8
s_add_u32 s28, s28, 0x24d000
v_and_b32 v61, 31, v1
v_lshlrev_b32 v61, 3, v61
s_mov_b32 s51, 0
v_mov_b32 v60, 3
F_POLL:
buffer_load_dwordx2 v[62:63], v61, s[20:23], s28 offen sc0 sc1
s_waitcnt vmcnt(0)
v_cmp_ne_u64 vcc, v[62:63], v[58:59]
s_cbranch_vccz F_GO
s_add_u32 s51, s51, 1
s_and_b32 s29, s51, 31
s_cbranch_scc1 F_POLL
s_branch F_NOTYET
F_GO:
v_mov_b32 v61, 156864
ds_write_b32 v61, v60
s_waitcnt lgkmcnt(0)
F_BAR2:
s_barrier
s_lshl_b32 s7, s36, 31
s_mov_b32 s7, 0
v_mov_b32 v246, 156864
ds_read_b32 v246, v246
s_mov_b32 s4, 0x1800000
s_mov_b32 s51, 3
Q_START:
s_lshl_b32 s28, s5, 10
s_add_u32 s28, s28, s4
s_add_u32 s6, s4, 18432
buffer_load_dwordx4 a[0:3], v240, s[20:23], s28 offen sc0 sc1
buffer_load_dwordx4 a[4:7], v241, s[20:23], s28 offen sc0 sc1
buffer_load_dwordx4 a[8:11], v242, s[20:23], s28 offen sc0 sc1
buffer_load_dwordx4 a[12:15], v243, s[20:23], s28 offen sc0 sc1
s_waitcnt lgkmcnt(0)
v_readfirstlane_b32 s48, v246
ds_read_b64_tr_b16 a[144:145], v234 offset:0
ds_read_b64_tr_b16 a[146:147], v234 offset:4096
ds_read_b64_tr_b16 a[148:149], v234 offset:8
ds_read_b64_tr_b16 a[150:151], v234 offset:4104
ds_read_b64_tr_b16 a[152:153], v235 offset:0
ds_read_b64_tr_b16 a[154:155], v235 offset:4096
ds_read_b64_tr_b16 a[156:157], v235 offset:8
ds_read_b64_tr_b16 a[158:159], v235 offset:4104
ds_read_b64_tr_b16 a[160:161], v236 offset:0
ds_read_b64_tr_b16 a[162:163], v236 offset:4096
ds_read_b64_tr_b16 a[164:165], v236 offset:8
ds_read_b64_tr_b16 a[166:167], v236 offset:4104
ds_read_b64_tr_b16 a[168:169], v237 offset:0
ds_read_b64_tr_b16 a[170:171], v237 offset:4096
ds_read_b64_tr_b16 a[172:173], v237 offset:8
ds_read_b64_tr_b16 a[174:175], v237 offset:4104
s_cmp_lt_u32 s48, s51
s_cbranch_scc1 Q_REDO
s_add_u32 s28, s28, 1024
s_cmp_lt_u32 s28, s6
s_cselect_b32 s28, s28, s4
buffer_load_dwordx4 a[16:19], v240, s[20:23], s28 offen sc0 sc1
buffer_load_dwordx4 a[20:23], v241, s[20:23], s28 offen sc0 sc1
buffer_load_dwordx4 a[24:27], v242, s[20:23], s28 offen sc0 sc1
buffer_load_dwordx4 a[28:31], v243, s[20:23], s28 offen sc0 sc1
s_lshl_b32 s29, s36, 10
s_add_u32 s29, s29, s4
s_add_u32 s29, s29, 0x240000
buffer_load_dwordx4 v[136:139], v244, s[20:23], s29 offen sc0 sc1
s_add_u32 s28, s28, 1024
s_cmp_lt_u32 s28, s6
s_cselect_b32 s28, s28, s4
buffer_load_dwordx4 a[32:35], v240, s[20:23], s28 offen sc0 sc1
buffer_load_dwordx4 a[36:39], v241, s[20:23], s28 offen sc0 sc1
buffer_load_dwordx4 a[40:43], v242, s[20:23], s28 offen sc0 sc1
buffer_load_dwordx4 a[44:47], v243, s[20:23], s28 offen sc0 sc1
s_waitcnt vmcnt(9)
s_waitcnt lgkmcnt(8)
v_mfma_f32_16x16x32_bf16 v[8:11], a[144:147], a[0:3], 0
ds_read_b64_tr_b16 a[176:177], v234 offset:8192
v_mov_b32 v143, 0
v_mfma_f32_16x16x32_bf16 v[40:43], a[144:147], a[4:7], 0
ds_read_b64_tr_b16 a[178:179], v234 offset:12288
ds_write_b32 v209, v200 offset:0
v_mfma_f32_16x16x32_bf16 v[72:75], a[144:147], a[8:11], 0
s_add_u32 s28, s28, 1024
s_cmp_lt_u32 s28, s6
s_cselect_b32 s28, s28, s4
v_mfma_f32_16x16x32_bf16 v[104:107], a[144:147], a[12:15], 0
ds_read_b64_tr_b16 a[180:181], v234 offset:8200
ds_write_b32 v209, v201 offset:128
v_mfma_f32_16x16x32_bf16 v[108:111], a[148:151], a[12:15], 0
ds_read_b64_tr_b16 a[182:183], v234 offset:12296
ds_write_b32 v209, v202 offset:256
v_mfma_f32_16x16x32_bf16 v[76:79], a[148:151], a[8:11], 0
buffer_load_dwordx4 a[48:51], v240, s[20:23], s28 offen sc0 sc1
v_mfma_f32_16x16x32_bf16 v[44:47], a[148:151], a[4:7], 0
ds_read_b64_tr_b16 a[184:185], v235 offset:8192
ds_write_b32 v209, v203 offset:384
v_mfma_f32_16x16x32_bf16 v[12:15], a[148:151], a[0:3], 0
ds_read_b64_tr_b16 a[186:187], v235 offset:12288
ds_write_b32 v209, v204 offset:512
v_mfma_f32_16x16x32_bf16 v[16:19], a[152:155], a[0:3], 0
buffer_load_dwordx4 a[52:55], v241, s[20:23], s28 offen sc0 sc1
v_mfma_f32_16x16x32_bf16 v[48:51], a[152:155], a[4:7], 0
ds_read_b64_tr_b16 a[188:189], v235 offset:8200
ds_write_b32 v209, v205 offset:640
v_mfma_f32_16x16x32_bf16 v[80:83], a[152:155], a[8:11], 0
ds_read_b64_tr_b16 a[190:191], v235 offset:12296
ds_write_b32 v209, v206 offset:768
v_mfma_f32_16x16x32_bf16 v[112:115], a[152:155], a[12:15], 0
buffer_load_dwordx4 a[56:59], v242, s[20:23], s28 offen sc0 sc1
v_mfma_f32_16x16x32_bf16 v[116:119], a[156:159], a[12:15], 0
ds_read_b64_tr_b16 a[192:193], v236 offset:8192
ds_write_b32 v209, v207 offset:896
v_mfma_f32_16x16x32_bf16 v[84:87], a[156:159], a[8:11], 0
buffer_load_dwordx4 a[60:63], v243, s[20:23], s28 offen sc0 sc1
v_mfma_f32_16x16x32_bf16 v[52:55], a[156:159], a[4:7], 0
ds_read_b64_tr_b16 a[194:195], v236 offset:12288
ds_write_b32 v209, v208 offset:1024
v_mfma_f32_16x16x32_bf16 v[20:23], a[156:159], a[0:3], 0
ds_read_b64_tr_b16 a[196:197], v236 offset:8200
v_add_u32 v184, 0, v4
s_waitcnt lgkmcnt(8)
v_mfma_f32_16x16x32_bf16 v[24:27], a[160:163], a[0:3], 0
s_add_u32 s28, s28, 1024
s_cmp_lt_u32 s28, s6
s_cselect_b32 s28, s28, s4
v_mfma_f32_16x16x32_bf16 v[56:59], a[160:163], a[4:7], 0
ds_read_b64_tr_b16 a[198:199], v236 offset:12296
v_xor_b32 v184, v184, v3
v_mfma_f32_16x16x32_bf16 v[88:91], a[160:163], a[8:11], 0
ds_read_b64_tr_b16 a[200:201], v237 offset:8192
v_lshlrev_b32 v184, 4, v184
v_mfma_f32_16x16x32_bf16 v[120:123], a[160:163], a[12:15], 0
buffer_load_dwordx4 a[64:67], v240, s[20:23], s28 offen sc0 sc1
v_mfma_f32_16x16x32_bf16 v[124:127], a[164:167], a[12:15], 0
ds_read_b64_tr_b16 a[202:203], v237 offset:12288
v_lshl_add_u32 v184, v3, 8, v184
v_mfma_f32_16x16x32_bf16 v[92:95], a[164:167], a[8:11], 0
ds_read_b64_tr_b16 a[204:205], v237 offset:8200
v_add_u32 v216, 0x10000, v184
v_mfma_f32_16x16x32_bf16 v[60:63], a[164:167], a[4:7], 0
buffer_load_dwordx4 a[68:71], v241, s[20:23], s28 offen sc0 sc1
v_mfma_f32_16x16x32_bf16 v[28:31], a[164:167], a[0:3], 0
ds_read_b64_tr_b16 a[206:207], v237 offset:12296
v_add_u32 v184, 4, v4
v_mfma_f32_16x16x32_bf16 v[32:35], a[168:171], a[0:3], 0
buffer_load_dwordx4 a[72:75], v242, s[20:23], s28 offen sc0 sc1
v_mfma_f32_16x16x32_bf16 v[64:67], a[168:171], a[4:7], 0
buffer_load_dwordx4 a[76:79], v243, s[20:23], s28 offen sc0 sc1
v_mfma_f32_16x16x32_bf16 v[96:99], a[168:171], a[8:11], 0
s_add_u32 m0, s49, 114688
v_xor_b32 v184, v184, v3
v_mfma_f32_16x16x32_bf16 v[128:131], a[168:171], a[12:15], 0
buffer_load_dwordx4 v238, s[16:19], s34 offen offset:0 lds
v_mfma_f32_16x16x32_bf16 v[132:135], a[172:175], a[12:15], 0
buffer_load_dwordx4 v239, s[16:19], s34 offen offset:1024 lds
v_mfma_f32_16x16x32_bf16 v[100:103], a[172:175], a[8:11], 0
s_add_u32 s34, s34, 262144
s_sub_u32 s51, s34, 4718592
s_cselect_b32 s34, s34, s51
v_mfma_f32_16x16x32_bf16 v[68:71], a[172:175], a[4:7], 0
s_mov_b32 s90, 0x01010101
s_mov_b32 s91, 0x01010101
v_mfma_f32_16x16x32_bf16 v[36:39], a[172:175], a[0:3], 0
v_lshlrev_b32 v184, 4, v184
v_lshl_add_u32 v184, v3, 8, v184
s_waitcnt vmcnt(15)
v_mfma_f32_16x16x32_bf16 v[8:11], a[176:179], a[16:19], v[8:11]
ds_read_b64_tr_b16 a[144:145], v234 offset:16384
v_add_u32 v217, 0x10000, v184
v_mfma_f32_16x16x32_bf16 v[40:43], a[176:179], a[20:23], v[40:43]
ds_read_b64_tr_b16 a[146:147], v234 offset:20480
v_add_u32 v184, 8, v4
v_mfma_f32_16x16x32_bf16 v[72:75], a[176:179], a[24:27], v[72:75]
s_add_u32 s28, s28, 1024
s_cmp_lt_u32 s28, s6
s_cselect_b32 s28, s28, s4
v_mfma_f32_16x16x32_bf16 v[104:107], a[176:179], a[28:31], v[104:107]
ds_read_b64_tr_b16 a[148:149], v234 offset:16392
v_xor_b32 v184, v184, v3
v_mfma_f32_16x16x32_bf16 v[108:111], a[180:183], a[28:31], v[108:111]
ds_read_b64_tr_b16 a[150:151], v234 offset:20488
v_lshlrev_b32 v184, 4, v184
v_mfma_f32_16x16x32_bf16 v[76:79], a[180:183], a[24:27], v[76:79]
buffer_load_dwordx4 a[80:83], v240, s[20:23], s28 offen sc0 sc1
v_mfma_f32_16x16x32_bf16 v[44:47], a[180:183], a[20:23], v[44:47]
ds_read_b64_tr_b16 a[152:153], v235 offset:16384
v_lshl_add_u32 v184, v3, 8, v184
v_mfma_f32_16x16x32_bf16 v[12:15], a[180:183], a[16:19], v[12:15]
ds_read_b64_tr_b16 a[154:155], v235 offset:20480
v_add_u32 v218, 0x10000, v184
v_mfma_f32_16x16x32_bf16 v[16:19], a[184:187], a[16:19], v[16:19]
buffer_load_dwordx4 a[84:87], v241, s[20:23], s28 offen sc0 sc1
v_mfma_f32_16x16x32_bf16 v[48:51], a[184:187], a[20:23], v[48:51]
ds_read_b64_tr_b16 a[156:157], v235 offset:16392
v_add_u32 v184, 12, v4
v_mfma_f32_16x16x32_bf16 v[80:83], a[184:187], a[24:27], v[80:83]
ds_read_b64_tr_b16 a[158:159], v235 offset:20488
v_xor_b32 v184, v184, v3
v_mfma_f32_16x16x32_bf16 v[112:115], a[184:187], a[28:31], v[112:115]
buffer_load_dwordx4 a[88:91], v242, s[20:23], s28 offen sc0 sc1
s_waitcnt lgkmcnt(8)
v_mfma_f32_16x16x32_bf16 v[116:119], a[188:191], a[28:31], v[116:119]
ds_read_b64_tr_b16 a[160:161], v236 offset:16384
v_lshlrev_b32 v184, 4, v184
v_mfma_f32_16x16x32_bf16 v[84:87], a[188:191], a[24:27], v[84:87]
buffer_load_dwordx4 a[92:95], v243, s[20:23], s28 offen sc0 sc1
v_mfma_f32_16x16x32_bf16 v[52:55], a[188:191], a[20:23], v[52:55]
ds_read_b64_tr_b16 a[162:163], v236 offset:20480
v_lshl_add_u32 v184, v3, 8, v184
v_mfma_f32_16x16x32_bf16 v[20:23], a[188:191], a[16:19], v[20:23]
ds_read_b64_tr_b16 a[164:165], v236 offset:16392
v_add_u32 v219, 0x10000, v184
v_mfma_f32_16x16x32_bf16 v[24:27], a[192:195], a[16:19], v[24:27]
s_add_u32 m0, s49, 122880
v_bfe_u32 v184, v1, 2, 2
v_mfma_f32_16x16x32_bf16 v[56:59], a[192:195], a[20:23], v[56:59]
ds_read_b64_tr_b16 a[166:167], v236 offset:20488
v_and_b32 v185, 3, v1
v_mfma_f32_16x16x32_bf16 v[88:91], a[192:195], a[24:27], v[88:91]
ds_read_b64_tr_b16 a[168:169], v237 offset:16384
v_lshl_add_u32 v186, v4, 2, v184
v_mfma_f32_16x16x32_bf16 v[120:123], a[192:195], a[28:31], v[120:123]
s_waitcnt vmcnt(18)
v_max3_u32 v140, v136, v137, v138
v_mfma_f32_16x16x32_bf16 v[124:127], a[196:199], a[28:31], v[124:127]
ds_read_b64_tr_b16 a[170:171], v237 offset:20480
v_max_u32 v140, v140, v139
v_mfma_f32_16x16x32_bf16 v[92:95], a[196:199], a[24:27], v[92:95]
ds_read_b64_tr_b16 a[172:173], v237 offset:16392
v_and_b32 v187, 7, v186
v_mfma_f32_16x16x32_bf16 v[60:63], a[196:199], a[20:23], v[60:63]
buffer_load_dwordx4 v238, s[16:19], s34 offen offset:0 lds
v_mfma_f32_16x16x32_bf16 v[28:31], a[196:199], a[16:19], v[28:31]
ds_read_b64_tr_b16 a[174:175], v237 offset:20488
v_max_u32_dpp v141, v140, v140 row_ror:8 row_mask:0xf bank_mask:0xf
v_mfma_f32_16x16x32_bf16 v[32:35], a[200:203], a[16:19], v[32:35]
buffer_load_dwordx4 v239, s[16:19], s34 offen offset:1024 lds
v_mfma_f32_16x16x32_bf16 v[64:67], a[200:203], a[20:23], v[64:67]
v_max_u32_dpp v140, v141, v141 row_ror:4 row_mask:0xf bank_mask:0xf
v_lshlrev_b32 v188, 8, v186
v_mfma_f32_16x16x32_bf16 v[96:99], a[200:203], a[24:27], v[96:99]
s_add_u32 s34, s34, 262144
s_sub_u32 s51, s34, 4718592
s_cselect_b32 s34, s34, s51
v_mfma_f32_16x16x32_bf16 v[128:131], a[200:203], a[28:31], v[128:131]
v_max_u32_dpp v141, v140, v140 row_ror:2 row_mask:0xf bank_mask:0xf
v_lshl_add_u32 v188, v185, 3, v188
v_mfma_f32_16x16x32_bf16 v[132:135], a[204:207], a[28:31], v[132:135]
v_add_u32 v188, 0x18000, v188
v_xor_b32 v189, 0, v187
v_mfma_f32_16x16x32_bf16 v[100:103], a[204:207], a[24:27], v[100:103]
v_max_u32_dpp v140, v141, v141 row_ror:1 row_mask:0xf bank_mask:0xf
v_mov_b32 v141, v140
v_mfma_f32_16x16x32_bf16 v[68:71], a[204:207], a[20:23], v[68:71]
v_lshl_add_u32 v220, v189, 5, v188
v_xor_b32 v189, 1, v187
v_mfma_f32_16x16x32_bf16 v[36:39], a[204:207], a[16:19], v[36:39]
v_permlane16_swap_b32 v140, v141
v_max_u32 v140, v140, v141
s_waitcnt vmcnt(16)
s_waitcnt lgkmcnt(8)
v_mfma_f32_16x16x32_bf16 v[8:11], a[144:147], a[32:35], v[8:11]
ds_read_b64_tr_b16 a[176:177], v234 offset:24576
v_mov_b32 v141, v140
v_mfma_f32_16x16x32_bf16 v[40:43], a[144:147], a[36:39], v[40:43]
ds_read_b64_tr_b16 a[178:179], v234 offset:28672
v_lshl_add_u32 v221, v189, 5, v188
v_mfma_f32_16x16x32_bf16 v[72:75], a[144:147], a[40:43], v[72:75]
s_add_u32 s28, s28, 1024
s_cmp_lt_u32 s28, s6
s_cselect_b32 s28, s28, s4
v_mfma_f32_16x16x32_bf16 v[104:107], a[144:147], a[44:47], v[104:107]
ds_read_b64_tr_b16 a[180:181], v234 offset:24584
v_permlane32_swap_b32 v140, v141
v_mfma_f32_16x16x32_bf16 v[108:111], a[148:151], a[44:47], v[108:111]
ds_read_b64_tr_b16 a[182:183], v234 offset:28680
v_max_u32 v140, v140, v141
v_mfma_f32_16x16x32_bf16 v[76:79], a[148:151], a[40:43], v[76:79]
buffer_load_dwordx4 a[96:99], v240, s[20:23], s28 offen sc0 sc1
v_mfma_f32_16x16x32_bf16 v[44:47], a[148:151], a[36:39], v[44:47]
ds_read_b64_tr_b16 a[184:185], v235 offset:24576
v_add_u32 v143, v143, v140
v_mfma_f32_16x16x32_bf16 v[12:15], a[148:151], a[32:35], v[12:15]
ds_read_b64_tr_b16 a[186:187], v235 offset:28672
v_sub_u32 v136, v136, v140
v_mfma_f32_16x16x32_bf16 v[16:19], a[152:155], a[32:35], v[16:19]
buffer_load_dwordx4 a[100:103], v241, s[20:23], s28 offen sc0 sc1
v_mfma_f32_16x16x32_bf16 v[48:51], a[152:155], a[36:39], v[48:51]
ds_read_b64_tr_b16 a[188:189], v235 offset:24584
v_sub_u32 v137, v137, v140
v_mfma_f32_16x16x32_bf16 v[80:83], a[152:155], a[40:43], v[80:83]
ds_read_b64_tr_b16 a[190:191], v235 offset:28680
v_sub_u32 v138, v138, v140
v_mfma_f32_16x16x32_bf16 v[112:115], a[152:155], a[44:47], v[112:115]
buffer_load_dwordx4 a[104:107], v242, s[20:23], s28 offen sc0 sc1
v_mfma_f32_16x16x32_bf16 v[116:119], a[156:159], a[44:47], v[116:119]
ds_read_b64_tr_b16 a[192:193], v236 offset:24576
v_sub_u32 v139, v139, v140
v_mfma_f32_16x16x32_bf16 v[84:87], a[156:159], a[40:43], v[84:87]
buffer_load_dwordx4 a[108:111], v243, s[20:23], s28 offen sc0 sc1
v_mfma_f32_16x16x32_bf16 v[52:55], a[156:159], a[36:39], v[52:55]
ds_read_b64_tr_b16 a[194:195], v236 offset:28672
v_cndmask_b32 v142, v142, v143, s[90:91]
v_mfma_f32_16x16x32_bf16 v[20:23], a[156:159], a[32:35], v[20:23]
ds_read_b64_tr_b16 a[196:197], v236 offset:24584
s_lshl_b64 s[90:91], s[90:91], 1
s_waitcnt lgkmcnt(8)
v_mfma_f32_16x16x32_bf16 v[24:27], a[160:163], a[32:35], v[24:27]
s_add_u32 m0, s49, 131072
v_max3_u32 v140, v136, v137, v138
v_mfma_f32_16x16x32_bf16 v[56:59], a[160:163], a[36:39], v[56:59]
ds_read_b64_tr_b16 a[198:199], v236 offset:28680
v_max_u32 v140, v140, v139
v_mfma_f32_16x16x32_bf16 v[88:91], a[160:163], a[40:43], v[88:91]
ds_read_b64_tr_b16 a[200:201], v237 offset:24576
v_xor_b32 v189, 2, v187
v_mfma_f32_16x16x32_bf16 v[120:123], a[160:163], a[44:47], v[120:123]
v_max_u32_dpp v141, v140, v140 row_ror:8 row_mask:0xf bank_mask:0xf
v_lshl_add_u32 v222, v189, 5, v188
v_mfma_f32_16x16x32_bf16 v[124:127], a[164:167], a[44:47], v[124:127]
ds_read_b64_tr_b16 a[202:203], v237 offset:28672
v_xor_b32 v189, 3, v187
v_mfma_f32_16x16x32_bf16 v[92:95], a[164:167], a[40:43], v[92:95]
ds_read_b64_tr_b16 a[204:205], v237 offset:24584
v_max_u32_dpp v140, v141, v141 row_ror:4 row_mask:0xf bank_mask:0xf
v_mfma_f32_16x16x32_bf16 v[60:63], a[164:167], a[36:39], v[60:63]
buffer_load_dwordx4 v238, s[16:19], s34 offen offset:0 lds
v_mfma_f32_16x16x32_bf16 v[28:31], a[164:167], a[32:35], v[28:31]
ds_read_b64_tr_b16 a[206:207], v237 offset:28680
v_max_u32_dpp v141, v140, v140 row_ror:2 row_mask:0xf bank_mask:0xf
v_mfma_f32_16x16x32_bf16 v[32:35], a[168:171], a[32:35], v[32:35]
buffer_load_dwordx4 v239, s[16:19], s34 offen offset:1024 lds
v_mfma_f32_16x16x32_bf16 v[64:67], a[168:171], a[36:39], v[64:67]
v_max_u32_dpp v140, v141, v141 row_ror:1 row_mask:0xf bank_mask:0xf
v_mov_b32 v141, v140
v_mfma_f32_16x16x32_bf16 v[96:99], a[168:171], a[40:43], v[96:99]
s_add_u32 s34, s34, 262144
s_sub_u32 s51, s34, 4718592
s_cselect_b32 s34, s34, s51
v_mfma_f32_16x16x32_bf16 v[128:131], a[168:171], a[44:47], v[128:131]
v_permlane16_swap_b32 v140, v141
v_max_u32 v140, v140, v141
v_mfma_f32_16x16x32_bf16 v[132:135], a[172:175], a[44:47], v[132:135]
v_mov_b32 v141, v140
v_lshl_add_u32 v223, v189, 5, v188
v_mfma_f32_16x16x32_bf16 v[100:103], a[172:175], a[40:43], v[100:103]
v_xor_b32 v189, 4, v187
v_lshl_add_u32 v224, v189, 5, v188
v_mfma_f32_16x16x32_bf16 v[68:71], a[172:175], a[36:39], v[68:71]
v_permlane32_swap_b32 v140, v141
v_max_u32 v140, v140, v141
v_mfma_f32_16x16x32_bf16 v[36:39], a[172:175], a[32:35], v[36:39]
v_add_u32 v143, v143, v140
v_sub_u32 v136, v136, v140
s_waitcnt vmcnt(18)
v_mfma_f32_16x16x32_bf16 v[8:11], a[176:179], a[48:51], v[8:11]
ds_read_b64_tr_b16 a[144:145], v234 offset:32768
v_sub_u32 v137, v137, v140
v_mfma_f32_16x16x32_bf16 v[40:43], a[176:179], a[52:55], v[40:43]
ds_read_b64_tr_b16 a[146:147], v234 offset:36864
v_sub_u32 v138, v138, v140
v_mfma_f32_16x16x32_bf16 v[72:75], a[176:179], a[56:59], v[72:75]
s_add_u32 s28, s28, 1024
s_cmp_lt_u32 s28, s6
s_cselect_b32 s28, s28, s4
v_mfma_f32_16x16x32_bf16 v[104:107], a[176:179], a[60:63], v[104:107]
ds_read_b64_tr_b16 a[148:149], v234 offset:32776
v_sub_u32 v139, v139, v140
s_waitcnt lgkmcnt(8)
v_mfma_f32_16x16x32_bf16 v[108:111], a[180:183], a[60:63], v[108:111]
ds_read_b64_tr_b16 a[150:151], v234 offset:36872
v_cndmask_b32 v142, v142, v143, s[90:91]
v_mfma_f32_16x16x32_bf16 v[76:79], a[180:183], a[56:59], v[76:79]
buffer_load_dwordx4 a[112:115], v240, s[20:23], s28 offen sc0 sc1
v_mfma_f32_16x16x32_bf16 v[44:47], a[180:183], a[52:55], v[44:47]
ds_read_b64_tr_b16 a[152:153], v235 offset:32768
s_lshl_b64 s[90:91], s[90:91], 1
v_mfma_f32_16x16x32_bf16 v[12:15], a[180:183], a[48:51], v[12:15]
ds_read_b64_tr_b16 a[154:155], v235 offset:36864
v_max3_u32 v140, v136, v137, v138
v_mfma_f32_16x16x32_bf16 v[16:19], a[184:187], a[48:51], v[16:19]
buffer_load_dwordx4 a[116:119], v241, s[20:23], s28 offen sc0 sc1
v_mfma_f32_16x16x32_bf16 v[48:51], a[184:187], a[52:55], v[48:51]
ds_read_b64_tr_b16 a[156:157], v235 offset:32776
v_max_u32 v140, v140, v139
v_mfma_f32_16x16x32_bf16 v[80:83], a[184:187], a[56:59], v[80:83]
ds_read_b64_tr_b16 a[158:159], v235 offset:36872
v_xor_b32 v189, 5, v187
v_mfma_f32_16x16x32_bf16 v[112:115], a[184:187], a[60:63], v[112:115]
buffer_load_dwordx4 a[120:123], v242, s[20:23], s28 offen sc0 sc1
v_mfma_f32_16x16x32_bf16 v[116:119], a[188:191], a[60:63], v[116:119]
ds_read_b64_tr_b16 a[160:161], v236 offset:32768
v_max_u32_dpp v141, v140, v140 row_ror:8 row_mask:0xf bank_mask:0xf
v_mfma_f32_16x16x32_bf16 v[84:87], a[188:191], a[56:59], v[84:87]
buffer_load_dwordx4 a[124:127], v243, s[20:23], s28 offen sc0 sc1
v_mfma_f32_16x16x32_bf16 v[52:55], a[188:191], a[52:55], v[52:55]
ds_read_b64_tr_b16 a[162:163], v236 offset:36864
v_max_u32_dpp v140, v141, v141 row_ror:4 row_mask:0xf bank_mask:0xf
v_mfma_f32_16x16x32_bf16 v[20:23], a[188:191], a[48:51], v[20:23]
ds_read_b64_tr_b16 a[164:165], v236 offset:32776
v_lshl_add_u32 v225, v189, 5, v188
v_mfma_f32_16x16x32_bf16 v[24:27], a[192:195], a[48:51], v[24:27]
s_add_u32 m0, s49, 139264
v_max_u32_dpp v141, v140, v140 row_ror:2 row_mask:0xf bank_mask:0xf
v_mfma_f32_16x16x32_bf16 v[56:59], a[192:195], a[52:55], v[56:59]
ds_read_b64_tr_b16 a[166:167], v236 offset:36872
v_xor_b32 v189, 6, v187
v_mfma_f32_16x16x32_bf16 v[88:91], a[192:195], a[56:59], v[88:91]
ds_read_b64_tr_b16 a[168:169], v237 offset:32768
v_max_u32_dpp v140, v141, v141 row_ror:1 row_mask:0xf bank_mask:0xf
v_mfma_f32_16x16x32_bf16 v[120:123], a[192:195], a[60:63], v[120:123]
v_mov_b32 v141, v140
v_lshl_add_u32 v226, v189, 5, v188
s_waitcnt lgkmcnt(8)
v_mfma_f32_16x16x32_bf16 v[124:127], a[196:199], a[60:63], v[124:127]
ds_read_b64_tr_b16 a[170:171], v237 offset:36864
v_xor_b32 v189, 7, v187
v_mfma_f32_16x16x32_bf16 v[92:95], a[196:199], a[56:59], v[92:95]
ds_read_b64_tr_b16 a[172:173], v237 offset:32776
v_permlane16_swap_b32 v140, v141
v_mfma_f32_16x16x32_bf16 v[60:63], a[196:199], a[52:55], v[60:63]
buffer_load_dwordx4 v238, s[16:19], s34 offen offset:0 lds
v_mfma_f32_16x16x32_bf16 v[28:31], a[196:199], a[48:51], v[28:31]
ds_read_b64_tr_b16 a[174:175], v237 offset:36872
v_max_u32 v140, v140, v141
v_mfma_f32_16x16x32_bf16 v[32:35], a[200:203], a[48:51], v[32:35]
buffer_load_dwordx4 v239, s[16:19], s34 offen offset:1024 lds
v_mfma_f32_16x16x32_bf16 v[64:67], a[200:203], a[52:55], v[64:67]
v_mov_b32 v141, v140
v_lshl_add_u32 v227, v189, 5, v188
v_mfma_f32_16x16x32_bf16 v[96:99], a[200:203], a[56:59], v[96:99]
s_add_u32 s34, s34, 262144
s_sub_u32 s51, s34, 4718592
s_cselect_b32 s34, s34, s51
v_mfma_f32_16x16x32_bf16 v[128:131], a[200:203], a[60:63], v[128:131]
v_permlane32_swap_b32 v140, v141
v_max_u32 v140, v140, v141
v_mfma_f32_16x16x32_bf16 v[132:135], a[204:207], a[60:63], v[132:135]
v_add_u32 v143, v143, v140
v_sub_u32 v136, v136, v140
v_mfma_f32_16x16x32_bf16 v[100:103], a[204:207], a[56:59], v[100:103]
v_sub_u32 v137, v137, v140
v_sub_u32 v138, v138, v140
v_mfma_f32_16x16x32_bf16 v[68:71], a[204:207], a[52:55], v[68:71]
v_sub_u32 v139, v139, v140
v_cndmask_b32 v142, v142, v143, s[90:91]
v_mfma_f32_16x16x32_bf16 v[36:39], a[204:207], a[48:51], v[36:39]
s_lshl_b64 s[90:91], s[90:91], 1
v_add_u32 v184, 0, v4
s_waitcnt vmcnt(20)
v_mfma_f32_16x16x32_bf16 v[8:11], a[144:147], a[64:67], v[8:11]
ds_read_b64_tr_b16 a[176:177], v234 offset:40960
v_max3_u32 v140, v136, v137, v138
v_mfma_f32_16x16x32_bf16 v[40:43], a[144:147], a[68:71], v[40:43]
ds_read_b64_tr_b16 a[178:179], v234 offset:45056
v_max_u32 v140, v140, v139
v_mfma_f32_16x16x32_bf16 v[72:75], a[144:147], a[72:75], v[72:75]
s_add_u32 s28, s28, 1024
s_cmp_lt_u32 s28, s6
s_cselect_b32 s28, s28, s4
v_mfma_f32_16x16x32_bf16 v[104:107], a[144:147], a[76:79], v[104:107]
ds_read_b64_tr_b16 a[180:181], v234 offset:40968
v_max_u32_dpp v141, v140, v140 row_ror:8 row_mask:0xf bank_mask:0xf
v_mfma_f32_16x16x32_bf16 v[108:111], a[148:151], a[76:79], v[108:111]
ds_read_b64_tr_b16 a[182:183], v234 offset:45064
v_xor_b32 v184, v184, v3
v_mfma_f32_16x16x32_bf16 v[76:79], a[148:151], a[72:75], v[76:79]
buffer_load_dwordx4 a[0:3], v240, s[20:23], s28 offen sc0 sc1
v_mfma_f32_16x16x32_bf16 v[44:47], a[148:151], a[68:71], v[44:47]
ds_read_b64_tr_b16 a[184:185], v235 offset:40960
v_max_u32_dpp v140, v141, v141 row_ror:4 row_mask:0xf bank_mask:0xf
v_mfma_f32_16x16x32_bf16 v[12:15], a[148:151], a[64:67], v[12:15]
ds_read_b64_tr_b16 a[186:187], v235 offset:45056
v_lshlrev_b32 v184, 4, v184
s_waitcnt lgkmcnt(8)
v_mfma_f32_16x16x32_bf16 v[16:19], a[152:155], a[64:67], v[16:19]
buffer_load_dwordx4 a[4:7], v241, s[20:23], s28 offen sc0 sc1
v_mfma_f32_16x16x32_bf16 v[48:51], a[152:155], a[68:71], v[48:51]
ds_read_b64_tr_b16 a[188:189], v235 offset:40968
v_max_u32_dpp v141, v140, v140 row_ror:2 row_mask:0xf bank_mask:0xf
v_mfma_f32_16x16x32_bf16 v[80:83], a[152:155], a[72:75], v[80:83]
ds_read_b64_tr_b16 a[190:191], v235 offset:45064
v_lshl_add_u32 v184, v4, 8, v184
v_mfma_f32_16x16x32_bf16 v[112:115], a[152:155], a[76:79], v[112:115]
buffer_load_dwordx4 a[8:11], v242, s[20:23], s28 offen sc0 sc1
v_mfma_f32_16x16x32_bf16 v[116:119], a[156:159], a[76:79], v[116:119]
ds_read_b64_tr_b16 a[192:193], v236 offset:40960
v_max_u32_dpp v140, v141, v141 row_ror:1 row_mask:0xf bank_mask:0xf
v_mfma_f32_16x16x32_bf16 v[84:87], a[156:159], a[72:75], v[84:87]
buffer_load_dwordx4 a[12:15], v243, s[20:23], s28 offen sc0 sc1
v_mfma_f32_16x16x32_bf16 v[52:55], a[156:159], a[68:71], v[52:55]
ds_read_b64_tr_b16 a[194:195], v236 offset:45056
v_mov_b32 v141, v140
v_mfma_f32_16x16x32_bf16 v[20:23], a[156:159], a[64:67], v[20:23]
ds_read_b64_tr_b16 a[196:197], v236 offset:40968
v_add_u32 v228, s30, v184
v_mfma_f32_16x16x32_bf16 v[24:27], a[160:163], a[64:67], v[24:27]
s_add_u32 m0, s49, 0
v_permlane16_swap_b32 v140, v141
v_mfma_f32_16x16x32_bf16 v[56:59], a[160:163], a[68:71], v[56:59]
ds_read_b64_tr_b16 a[198:199], v236 offset:45064
v_max_u32 v140, v140, v141
v_mfma_f32_16x16x32_bf16 v[88:91], a[160:163], a[72:75], v[88:91]
ds_read_b64_tr_b16 a[200:201], v237 offset:40960
v_mov_b32 v141, v140
v_mfma_f32_16x16x32_bf16 v[120:123], a[160:163], a[76:79], v[120:123]
v_add_u32 v184, 4, v4
v_xor_b32 v184, v184, v3
v_mfma_f32_16x16x32_bf16 v[124:127], a[164:167], a[76:79], v[124:127]
ds_read_b64_tr_b16 a[202:203], v237 offset:45056
v_permlane32_swap_b32 v140, v141
STUB_1:
STUB_A1:
s_cbranch_execz STUB_4
v_mfma_f32_16x16x32_bf16 v[92:95], a[164:167], a[72:75], v[92:95]
ds_read_b64_tr_b16 a[204:205], v237 offset:40968
v_max_u32 v140, v140, v141
v_mfma_f32_16x16x32_bf16 v[60:63], a[164:167], a[68:71], v[60:63]
buffer_load_dwordx4 v238, s[16:19], s34 offen offset:0 lds
v_mfma_f32_16x16x32_bf16 v[28:31], a[164:167], a[64:67], v[28:31]
ds_read_b64_tr_b16 a[206:207], v237 offset:45064
v_add_u32 v143, v143, v140
v_mfma_f32_16x16x32_bf16 v[32:35], a[168:171], a[64:67], v[32:35]
buffer_load_dwordx4 v239, s[16:19], s34 offen offset:1024 lds
v_mfma_f32_16x16x32_bf16 v[64:67], a[168:171], a[68:71], v[64:67]
v_sub_u32 v136, v136, v140
v_sub_u32 v137, v137, v140
v_mfma_f32_16x16x32_bf16 v[96:99], a[168:171], a[72:75], v[96:99]
s_add_u32 s34, s34, 262144
s_sub_u32 s51, s34, 4718592
s_cselect_b32 s34, s34, s51
v_mfma_f32_16x16x32_bf16 v[128:131], a[168:171], a[76:79], v[128:131]
v_sub_u32 v138, v138, v140
v_sub_u32 v139, v139, v140
s_waitcnt lgkmcnt(8)
v_mfma_f32_16x16x32_bf16 v[132:135], a[172:175], a[76:79], v[132:135]
v_cndmask_b32 v142, v142, v143, s[90:91]
v_lshlrev_b32 v184, 4, v184
v_mfma_f32_16x16x32_bf16 v[100:103], a[172:175], a[72:75], v[100:103]
s_lshl_b64 s[90:91], s[90:91], 1
v_lshl_add_u32 v184, v4, 8, v184
v_mfma_f32_16x16x32_bf16 v[68:71], a[172:175], a[68:71], v[68:71]
v_max3_u32 v140, v136, v137, v138
v_max_u32 v140, v140, v139
v_mfma_f32_16x16x32_bf16 v[36:39], a[172:175], a[64:67], v[36:39]
v_add_u32 v229, s30, v184
v_add_u32 v184, 8, v4
s_waitcnt vmcnt(20)
v_mfma_f32_16x16x32_bf16 v[8:11], a[176:179], a[80:83], v[8:11]
v_max_u32_dpp v141, v140, v140 row_ror:8 row_mask:0xf bank_mask:0xf
v_xor_b32 v184, v184, v3
v_mfma_f32_16x16x32_bf16 v[40:43], a[176:179], a[84:87], v[40:43]
s_waitcnt vmcnt(12) lgkmcnt(0)
s_barrier
v_mfma_f32_16x16x32_bf16 v[72:75], a[176:179], a[88:91], v[72:75]
ds_read_b64_tr_b16 a[144:145], v234 offset:49152
v_max_u32_dpp v140, v141, v141 row_ror:4 row_mask:0xf bank_mask:0xf
v_mfma_f32_16x16x32_bf16 v[104:107], a[176:179], a[92:95], v[104:107]
ds_read_b64_tr_b16 a[146:147], v234 offset:53248
v_lshlrev_b32 v184, 4, v184
v_mfma_f32_16x16x32_bf16 v[108:111], a[180:183], a[92:95], v[108:111]
ds_read_b64_tr_b16 a[148:149], v234 offset:49160
v_max_u32_dpp v141, v140, v140 row_ror:2 row_mask:0xf bank_mask:0xf
v_mfma_f32_16x16x32_bf16 v[76:79], a[180:183], a[88:91], v[76:79]
s_add_u32 s28, s28, 1024
s_cmp_lt_u32 s28, s6
s_cselect_b32 s28, s28, s4
v_mfma_f32_16x16x32_bf16 v[44:47], a[180:183], a[84:87], v[44:47]
ds_read_b64_tr_b16 a[150:151], v234 offset:53256
v_max_u32_dpp v140, v141, v141 row_ror:1 row_mask:0xf bank_mask:0xf
v_mfma_f32_16x16x32_bf16 v[12:15], a[180:183], a[80:83], v[12:15]
ds_read_b64_tr_b16 a[152:153], v235 offset:49152
v_mov_b32 v141, v140
v_mfma_f32_16x16x32_bf16 v[16:19], a[184:187], a[80:83], v[16:19]
buffer_load_dwordx4 a[16:19], v240, s[20:23], s28 offen sc0 sc1
v_mfma_f32_16x16x32_bf16 v[48:51], a[184:187], a[84:87], v[48:51]
ds_read_b64_tr_b16 a[154:155], v235 offset:53248
v_permlane16_swap_b32 v140, v141
v_mfma_f32_16x16x32_bf16 v[80:83], a[184:187], a[88:91], v[80:83]
ds_read_b64_tr_b16 a[156:157], v235 offset:49160
v_max_u32 v140, v140, v141
v_mfma_f32_16x16x32_bf16 v[112:115], a[184:187], a[92:95], v[112:115]
buffer_load_dwordx4 a[20:23], v241, s[20:23], s28 offen sc0 sc1
v_mfma_f32_16x16x32_bf16 v[116:119], a[188:191], a[92:95], v[116:119]
ds_read_b64_tr_b16 a[158:159], v235 offset:53256
v_mov_b32 v141, v140
v_mfma_f32_16x16x32_bf16 v[84:87], a[188:191], a[88:91], v[84:87]
ds_read_b64_tr_b16 a[160:161], v236 offset:49152
v_lshl_add_u32 v184, v4, 8, v184
v_mfma_f32_16x16x32_bf16 v[52:55], a[188:191], a[84:87], v[52:55]
ds_read_b64_tr_b16 a[162:163], v236 offset:53248
v_permlane32_swap_b32 v140, v141
v_mfma_f32_16x16x32_bf16 v[20:23], a[188:191], a[80:83], v[20:23]
buffer_load_dwordx4 a[24:27], v242, s[20:23], s28 offen sc0 sc1
v_mfma_f32_16x16x32_bf16 v[24:27], a[192:195], a[80:83], v[24:27]
ds_read_b64_tr_b16 a[164:165], v236 offset:49160
v_max_u32 v140, v140, v141
v_mfma_f32_16x16x32_bf16 v[56:59], a[192:195], a[84:87], v[56:59]
ds_read_b64_tr_b16 a[166:167], v236 offset:53256
v_add_u32 v143, v143, v140
v_mfma_f32_16x16x32_bf16 v[88:91], a[192:195], a[88:91], v[88:91]
buffer_load_dwordx4 a[28:31], v243, s[20:23], s28 offen sc0 sc1
v_mfma_f32_16x16x32_bf16 v[120:123], a[192:195], a[92:95], v[120:123]
ds_read_b64_tr_b16 a[168:169], v237 offset:49152
s_add_u32 m0, s49, 8192
v_mfma_f32_16x16x32_bf16 v[124:127], a[196:199], a[92:95], v[124:127]
ds_read_b64_tr_b16 a[170:171], v237 offset:53248
v_sub_u32 v136, v136, v140
v_mfma_f32_16x16x32_bf16 v[92:95], a[196:199], a[88:91], v[92:95]
buffer_load_dwordx4 v238, s[16:19], s34 offen offset:0 lds
v_mfma_f32_16x16x32_bf16 v[60:63], a[196:199], a[84:87], v[60:63]
ds_read_b64_tr_b16 a[172:173], v237 offset:49160
v_sub_u32 v137, v137, v140
v_mfma_f32_16x16x32_bf16 v[28:31], a[196:199], a[80:83], v[28:31]
ds_read_b64_tr_b16 a[174:175], v237 offset:53256
v_sub_u32 v138, v138, v140
v_mfma_f32_16x16x32_bf16 v[32:35], a[200:203], a[80:83], v[32:35]
buffer_load_dwordx4 v239, s[16:19], s34 offen offset:1024 lds
v_mfma_f32_16x16x32_bf16 v[64:67], a[200:203], a[84:87], v[64:67]
v_sub_u32 v139, v139, v140
v_cndmask_b32 v142, v142, v143, s[90:91]
v_mfma_f32_16x16x32_bf16 v[96:99], a[200:203], a[88:91], v[96:99]
s_add_u32 s34, s34, 262144
s_sub_u32 s51, s34, 4718592
s_cselect_b32 s34, s34, s51
v_mfma_f32_16x16x32_bf16 v[128:131], a[200:203], a[92:95], v[128:131]
s_lshl_b64 s[90:91], s[90:91], 1
v_add_u32 v230, s30, v184
v_mfma_f32_16x16x32_bf16 v[132:135], a[204:207], a[92:95], v[132:135]
v_max3_u32 v140, v136, v137, v138
v_max_u32 v140, v140, v139
v_mfma_f32_16x16x32_bf16 v[100:103], a[204:207], a[88:91], v[100:103]
v_add_u32 v184, 12, v4
v_xor_b32 v184, v184, v3
v_mfma_f32_16x16x32_bf16 v[68:71], a[204:207], a[84:87], v[68:71]
v_max_u32_dpp v141, v140, v140 row_ror:8 row_mask:0xf bank_mask:0xf
v_mov_b32 v192, 0
v_mfma_f32_16x16x32_bf16 v[36:39], a[204:207], a[80:83], v[36:39]
buffer_load_dword v193, v192, s[24:27], 0 offen sc0 sc1
s_waitcnt vmcnt(21)
s_waitcnt lgkmcnt(8)
v_mfma_f32_16x16x32_bf16 v[8:11], a[144:147], a[96:99], v[8:11]
ds_read_b64_tr_b16 a[176:177], v234 offset:57344
v_max_u32_dpp v140, v141, v141 row_ror:4 row_mask:0xf bank_mask:0xf
v_mfma_f32_16x16x32_bf16 v[40:43], a[144:147], a[100:103], v[40:43]
ds_read_b64_tr_b16 a[178:179], v234 offset:61440
v_lshlrev_b32 v184, 4, v184
v_mfma_f32_16x16x32_bf16 v[72:75], a[144:147], a[104:107], v[72:75]
s_add_u32 s28, s28, 1024
s_cmp_lt_u32 s28, s6
s_cselect_b32 s28, s28, s4
v_mfma_f32_16x16x32_bf16 v[104:107], a[144:147], a[108:111], v[104:107]
ds_read_b64_tr_b16 a[180:181], v234 offset:57352
v_max_u32_dpp v141, v140, v140 row_ror:2 row_mask:0xf bank_mask:0xf
v_mfma_f32_16x16x32_bf16 v[108:111], a[148:151], a[108:111], v[108:111]
ds_read_b64_tr_b16 a[182:183], v234 offset:61448
v_lshl_add_u32 v184, v4, 8, v184
v_mfma_f32_16x16x32_bf16 v[76:79], a[148:151], a[104:107], v[76:79]
buffer_load_dwordx4 a[32:35], v240, s[20:23], s28 offen sc0 sc1
v_mfma_f32_16x16x32_bf16 v[44:47], a[148:151], a[100:103], v[44:47]
ds_read_b64_tr_b16 a[184:185], v235 offset:57344
v_max_u32_dpp v140, v141, v141 row_ror:1 row_mask:0xf bank_mask:0xf
v_mfma_f32_16x16x32_bf16 v[12:15], a[148:151], a[96:99], v[12:15]
ds_read_b64_tr_b16 a[186:187], v235 offset:61440
v_mov_b32 v141, v140
v_mfma_f32_16x16x32_bf16 v[16:19], a[152:155], a[96:99], v[16:19]
buffer_load_dwordx4 a[36:39], v241, s[20:23], s28 offen sc0 sc1
v_mfma_f32_16x16x32_bf16 v[48:51], a[152:155], a[100:103], v[48:51]
ds_read_b64_tr_b16 a[188:189], v235 offset:57352
v_permlane16_swap_b32 v140, v141
v_mfma_f32_16x16x32_bf16 v[80:83], a[152:155], a[104:107], v[80:83]
ds_read_b64_tr_b16 a[190:191], v235 offset:61448
v_max_u32 v140, v140, v141
v_mfma_f32_16x16x32_bf16 v[112:115], a[152:155], a[108:111], v[112:115]
buffer_load_dwordx4 a[40:43], v242, s[20:23], s28 offen sc0 sc1
v_mfma_f32_16x16x32_bf16 v[116:119], a[156:159], a[108:111], v[116:119]
ds_read_b64_tr_b16 a[192:193], v236 offset:57344
v_mov_b32 v141, v140
v_mfma_f32_16x16x32_bf16 v[84:87], a[156:159], a[104:107], v[84:87]
buffer_load_dwordx4 a[44:47], v243, s[20:23], s28 offen sc0 sc1
v_mfma_f32_16x16x32_bf16 v[52:55], a[156:159], a[100:103], v[52:55]
ds_read_b64_tr_b16 a[194:195], v236 offset:61440
v_permlane32_swap_b32 v140, v141
v_mfma_f32_16x16x32_bf16 v[20:23], a[156:159], a[96:99], v[20:23]
ds_read_b64_tr_b16 a[196:197], v236 offset:57352
v_max_u32 v140, v140, v141
s_waitcnt lgkmcnt(8)
v_mfma_f32_16x16x32_bf16 v[24:27], a[160:163], a[96:99], v[24:27]
s_add_u32 m0, s49, 16384
v_add_u32 v143, v143, v140
v_mfma_f32_16x16x32_bf16 v[56:59], a[160:163], a[100:103], v[56:59]
ds_read_b64_tr_b16 a[198:199], v236 offset:61448
v_sub_u32 v136, v136, v140
v_mfma_f32_16x16x32_bf16 v[88:91], a[160:163], a[104:107], v[88:91]
ds_read_b64_tr_b16 a[200:201], v237 offset:57344
v_sub_u32 v137, v137, v140
v_mfma_f32_16x16x32_bf16 v[120:123], a[160:163], a[108:111], v[120:123]
v_sub_u32 v138, v138, v140
v_sub_u32 v139, v139, v140
v_mfma_f32_16x16x32_bf16 v[124:127], a[164:167], a[108:111], v[124:127]
ds_read_b64_tr_b16 a[202:203], v237 offset:61440
v_cndmask_b32 v142, v142, v143, s[90:91]
v_mfma_f32_16x16x32_bf16 v[92:95], a[164:167], a[104:107], v[92:95]
ds_read_b64_tr_b16 a[204:205], v237 offset:57352
s_lshl_b64 s[90:91], s[90:91], 1
v_mfma_f32_16x16x32_bf16 v[60:63], a[164:167], a[100:103], v[60:63]
buffer_load_dwordx4 v238, s[16:19], s34 offen offset:0 lds
v_mfma_f32_16x16x32_bf16 v[28:31], a[164:167], a[96:99], v[28:31]
ds_read_b64_tr_b16 a[206:207], v237 offset:61448
v_max3_u32 v140, v136, v137, v138
v_mfma_f32_16x16x32_bf16 v[32:35], a[168:171], a[96:99], v[32:35]
buffer_load_dwordx4 v239, s[16:19], s34 offen offset:1024 lds
v_mfma_f32_16x16x32_bf16 v[64:67], a[168:171], a[100:103], v[64:67]
v_max_u32 v140, v140, v139
v_add_u32 v231, s30, v184
v_mfma_f32_16x16x32_bf16 v[96:99], a[168:171], a[104:107], v[96:99]
s_add_u32 s34, s34, 262144
s_sub_u32 s51, s34, 4718592
s_cselect_b32 s34, s34, s51
v_mfma_f32_16x16x32_bf16 v[128:131], a[168:171], a[108:111], v[128:131]
v_max_u32_dpp v141, v140, v140 row_ror:8 row_mask:0xf bank_mask:0xf
v_add_u32 v184, 0, v4
v_mfma_f32_16x16x32_bf16 v[132:135], a[172:175], a[108:111], v[132:135]
v_lshlrev_b32 v184, 1, v184
v_xor_b32 v184, v184, v3
v_mfma_f32_16x16x32_bf16 v[100:103], a[172:175], a[104:107], v[100:103]
v_max_u32_dpp v140, v141, v141 row_ror:4 row_mask:0xf bank_mask:0xf
v_lshlrev_b32 v184, 4, v184
v_mfma_f32_16x16x32_bf16 v[68:71], a[172:175], a[100:103], v[68:71]
v_lshl_add_u32 v184, v4, 8, v184
v_add_u32 v232, s30, v184
v_mfma_f32_16x16x32_bf16 v[36:39], a[172:175], a[96:99], v[36:39]
v_max_u32_dpp v141, v140, v140 row_ror:2 row_mask:0xf bank_mask:0xf
v_add_u32 v184, 4, v4
s_waitcnt vmcnt(21)
v_mfma_f32_16x16x32_bf16 v[8:11], a[176:179], a[112:115], v[8:11]
v_add_u32 v234, 0x10000, v234
v_add_u32 v235, 0x10000, v235
v_mfma_f32_16x16x32_bf16 v[40:43], a[176:179], a[116:119], v[40:43]
v_add_u32 v236, 0x10000, v236
v_add_u32 v237, 0x10000, v237
v_mfma_f32_16x16x32_bf16 v[72:75], a[176:179], a[120:123], v[72:75]
v_max_u32_dpp v140, v141, v141 row_ror:1 row_mask:0xf bank_mask:0xf
v_mov_b32 v141, v140
v_mfma_f32_16x16x32_bf16 v[104:107], a[176:179], a[124:127], v[104:107]
ds_read_b64_tr_b16 a[144:145], v234 offset:0
v_lshlrev_b32 v184, 1, v184
s_waitcnt lgkmcnt(8)
v_mfma_f32_16x16x32_bf16 v[108:111], a[180:183], a[124:127], v[108:111]
ds_read_b64_tr_b16 a[146:147], v234 offset:4096
v_permlane16_swap_b32 v140, v141
v_mfma_f32_16x16x32_bf16 v[76:79], a[180:183], a[120:123], v[76:79]
ds_read_b64_tr_b16 a[148:149], v234 offset:8
v_max_u32 v140, v140, v141
v_mfma_f32_16x16x32_bf16 v[44:47], a[180:183], a[116:119], v[44:47]
s_add_u32 s28, s28, 1024
s_cmp_lt_u32 s28, s6
s_cselect_b32 s28, s28, s4
v_mfma_f32_16x16x32_bf16 v[12:15], a[180:183], a[112:115], v[12:15]
ds_read_b64_tr_b16 a[150:151], v234 offset:4104
v_mov_b32 v141, v140
v_mfma_f32_16x16x32_bf16 v[16:19], a[184:187], a[112:115], v[16:19]
ds_read_b64_tr_b16 a[152:153], v235 offset:0
v_xor_b32 v184, v184, v3
v_mfma_f32_16x16x32_bf16 v[48:51], a[184:187], a[116:119], v[48:51]
ds_read_b64_tr_b16 a[154:155], v235 offset:4096
v_permlane32_swap_b32 v140, v141
v_mfma_f32_16x16x32_bf16 v[80:83], a[184:187], a[120:123], v[80:83]
buffer_load_dwordx4 a[48:51], v240, s[20:23], s28 offen sc0 sc1
v_mfma_f32_16x16x32_bf16 v[112:115], a[184:187], a[124:127], v[112:115]
ds_read_b64_tr_b16 a[156:157], v235 offset:8
v_max_u32 v140, v140, v141
v_mfma_f32_16x16x32_bf16 v[116:119], a[188:191], a[124:127], v[116:119]
ds_read_b64_tr_b16 a[158:159], v235 offset:4104
v_add_u32 v143, v143, v140
v_mfma_f32_16x16x32_bf16 v[84:87], a[188:191], a[120:123], v[84:87]
buffer_load_dwordx4 a[52:55], v241, s[20:23], s28 offen sc0 sc1
v_mfma_f32_16x16x32_bf16 v[52:55], a[188:191], a[116:119], v[52:55]
ds_read_b64_tr_b16 a[160:161], v236 offset:0
v_sub_u32 v136, v136, v140
v_mfma_f32_16x16x32_bf16 v[20:23], a[188:191], a[112:115], v[20:23]
ds_read_b64_tr_b16 a[162:163], v236 offset:4096
v_sub_u32 v137, v137, v140
s_waitcnt lgkmcnt(8)
v_mfma_f32_16x16x32_bf16 v[24:27], a[192:195], a[112:115], v[24:27]
ds_read_b64_tr_b16 a[164:165], v236 offset:8
v_sub_u32 v138, v138, v140
v_mfma_f32_16x16x32_bf16 v[56:59], a[192:195], a[116:119], v[56:59]
buffer_load_dwordx4 a[56:59], v242, s[20:23], s28 offen sc0 sc1
v_mfma_f32_16x16x32_bf16 v[88:91], a[192:195], a[120:123], v[88:91]
ds_read_b64_tr_b16 a[166:167], v236 offset:4104
v_sub_u32 v139, v139, v140
v_mfma_f32_16x16x32_bf16 v[120:123], a[192:195], a[124:127], v[120:123]
ds_read_b64_tr_b16 a[168:169], v237 offset:0
v_cndmask_b32 v142, v142, v143, s[90:91]
v_mfma_f32_16x16x32_bf16 v[124:127], a[196:199], a[124:127], v[124:127]
ds_read_b64_tr_b16 a[170:171], v237 offset:4096
s_lshl_b64 s[90:91], s[90:91], 1
v_mfma_f32_16x16x32_bf16 v[92:95], a[196:199], a[120:123], v[92:95]
buffer_load_dwordx4 a[60:63], v243, s[20:23], s28 offen sc0 sc1
v_mfma_f32_16x16x32_bf16 v[60:63], a[196:199], a[116:119], v[60:63]
ds_read_b64_tr_b16 a[172:173], v237 offset:8
s_add_u32 m0, s49, 24576
v_mfma_f32_16x16x32_bf16 v[28:31], a[196:199], a[112:115], v[28:31]
ds_read_b64_tr_b16 a[174:175], v237 offset:4104
v_max3_u32 v140, v136, v137, v138
v_mfma_f32_16x16x32_bf16 v[32:35], a[200:203], a[112:115], v[32:35]
buffer_load_dwordx4 v238, s[16:19], s34 offen offset:0 lds
v_mfma_f32_16x16x32_bf16 v[64:67], a[200:203], a[116:119], v[64:67]
buffer_load_dwordx4 v239, s[16:19], s34 offen offset:1024 lds
v_mfma_f32_16x16x32_bf16 v[96:99], a[200:203], a[120:123], v[96:99]
v_max_u32 v140, v140, v139
v_lshlrev_b32 v184, 4, v184
v_mfma_f32_16x16x32_bf16 v[128:131], a[200:203], a[124:127], v[128:131]
s_add_u32 s34, s34, 262144
s_sub_u32 s51, s34, 4718592
s_cselect_b32 s34, s34, s51
v_mfma_f32_16x16x32_bf16 v[132:135], a[204:207], a[124:127], v[132:135]
v_max_u32_dpp v141, v140, v140 row_ror:8 row_mask:0xf bank_mask:0xf
v_lshl_add_u32 v184, v4, 8, v184
v_mfma_f32_16x16x32_bf16 v[100:103], a[204:207], a[120:123], v[100:103]
v_add_u32 v233, s30, v184
v_bfe_u32 v184, v1, 1, 1
v_mfma_f32_16x16x32_bf16 v[68:71], a[204:207], a[116:119], v[68:71]
v_max_u32_dpp v140, v141, v141 row_ror:4 row_mask:0xf bank_mask:0xf
v_lshrrev_b32 v185, 5, v1
v_mfma_f32_16x16x32_bf16 v[36:39], a[204:207], a[112:115], v[36:39]
v_cmp_eq_u32 vcc, v184, v185
v_mov_b32 v186, 0x3f803f80
s_waitcnt vmcnt(21)
v_mfma_f32_16x16x32_bf16 v[8:11], a[144:147], a[0:3], v[8:11]
v_max_u32_dpp v141, v140, v140 row_ror:2 row_mask:0xf bank_mask:0xf
v_mfma_f32_16x16x32_bf16 v[40:43], a[144:147], a[4:7], v[40:43]
s_waitcnt vmcnt(13) lgkmcnt(0)
s_barrier
v_mfma_f32_16x16x32_bf16 v[72:75], a[144:147], a[8:11], v[72:75]
ds_read_b64_tr_b16 a[176:177], v234 offset:8192
v_max_u32_dpp v140, v141, v141 row_ror:1 row_mask:0xf bank_mask:0xf
v_mfma_f32_16x16x32_bf16 v[104:107], a[144:147], a[12:15], v[104:107]
ds_read_b64_tr_b16 a[178:179], v234 offset:12288
v_mov_b32 v141, v140
v_mfma_f32_16x16x32_bf16 v[108:111], a[148:151], a[12:15], v[108:111]
ds_read_b64_tr_b16 a[180:181], v234 offset:8200
v_cndmask_b32 v186, 0, v186, vcc
v_mfma_f32_16x16x32_bf16 v[76:79], a[148:151], a[8:11], v[76:79]
s_add_u32 s28, s28, 1024
s_cmp_lt_u32 s28, s6
s_cselect_b32 s28, s28, s4
v_mfma_f32_16x16x32_bf16 v[44:47], a[148:151], a[4:7], v[44:47]
ds_read_b64_tr_b16 a[182:183], v234 offset:12296
v_permlane16_swap_b32 v140, v141
v_mfma_f32_16x16x32_bf16 v[12:15], a[148:151], a[0:3], v[12:15]
ds_read_b64_tr_b16 a[184:185], v235 offset:8192
v_max_u32 v140, v140, v141
v_mfma_f32_16x16x32_bf16 v[16:19], a[152:155], a[0:3], v[16:19]
buffer_load_dwordx4 a[64:67], v240, s[20:23], s28 offen sc0 sc1
v_mfma_f32_16x16x32_bf16 v[48:51], a[152:155], a[4:7], v[48:51]
ds_read_b64_tr_b16 a[186:187], v235 offset:12288
v_mov_b32 v141, v140
v_mfma_f32_16x16x32_bf16 v[80:83], a[152:155], a[8:11], v[80:83]
ds_read_b64_tr_b16 a[188:189], v235 offset:8200
v_and_b32 v184, 1, v1
v_mfma_f32_16x16x32_bf16 v[112:115], a[152:155], a[12:15], v[112:115]
buffer_load_dwordx4 a[68:71], v241, s[20:23], s28 offen sc0 sc1
v_mfma_f32_16x16x32_bf16 v[116:119], a[156:159], a[12:15], v[116:119]
ds_read_b64_tr_b16 a[190:191], v235 offset:12296
v_permlane32_swap_b32 v140, v141
v_mfma_f32_16x16x32_bf16 v[84:87], a[156:159], a[8:11], v[84:87]
ds_read_b64_tr_b16 a[192:193], v236 offset:8192
v_max_u32 v140, v140, v141
v_mfma_f32_16x16x32_bf16 v[52:55], a[156:159], a[4:7], v[52:55]
ds_read_b64_tr_b16 a[194:195], v236 offset:12288
v_add_u32 v143, v143, v140
v_mfma_f32_16x16x32_bf16 v[20:23], a[156:159], a[0:3], v[20:23]
buffer_load_dwordx4 a[72:75], v242, s[20:23], s28 offen sc0 sc1
v_mfma_f32_16x16x32_bf16 v[24:27], a[160:163], a[0:3], v[24:27]
ds_read_b64_tr_b16 a[196:197], v236 offset:8200
v_cndmask_b32 v142, v142, v143, s[90:91]
v_mfma_f32_16x16x32_bf16 v[56:59], a[160:163], a[4:7], v[56:59]
ds_read_b64_tr_b16 a[198:199], v236 offset:12296
v_cmp_eq_u32 vcc, 1, v184
v_mfma_f32_16x16x32_bf16 v[88:91], a[160:163], a[8:11], v[88:91]
buffer_load_dwordx4 a[76:79], v243, s[20:23], s28 offen sc0 sc1
v_mfma_f32_16x16x32_bf16 v[120:123], a[160:163], a[12:15], v[120:123]
ds_read_b64_tr_b16 a[200:201], v237 offset:8192
s_add_u32 m0, s49, 32768
v_mfma_f32_16x16x32_bf16 v[124:127], a[164:167], a[12:15], v[124:127]
ds_read_b64_tr_b16 a[202:203], v237 offset:12288
v_mov_b32 v184, 0x44444444
v_mfma_f32_16x16x32_bf16 v[92:95], a[164:167], a[8:11], v[92:95]
buffer_load_dwordx4 v238, s[16:19], s34 offen offset:0 lds
v_mfma_f32_16x16x32_bf16 v[60:63], a[164:167], a[4:7], v[60:63]
ds_read_b64_tr_b16 a[204:205], v237 offset:8200
v_mov_b32 v185, 0xeeeeeeee
v_mfma_f32_16x16x32_bf16 v[28:31], a[164:167], a[0:3], v[28:31]
ds_read_b64_tr_b16 a[206:207], v237 offset:12296
v_mfma_f32_16x16x32_bf16 v[32:35], a[168:171], a[0:3], v[32:35]
buffer_load_dwordx4 v239, s[16:19], s34 offen offset:1024 lds
v_mfma_f32_16x16x32_bf16 v[64:67], a[168:171], a[4:7], v[64:67]
v_cndmask_b32 v245, v184, v185, vcc
v_accvgpr_write_b32 a208, v186
v_mfma_f32_16x16x32_bf16 v[96:99], a[168:171], a[8:11], v[96:99]
s_add_u32 s34, s34, 262144
s_sub_u32 s51, s34, 4718592
s_cselect_b32 s34, s34, s51
v_mfma_f32_16x16x32_bf16 v[128:131], a[168:171], a[12:15], v[128:131]
v_accvgpr_write_b32 a209, v186
v_accvgpr_write_b32 a210, v186
v_mfma_f32_16x16x32_bf16 v[132:135], a[172:175], a[12:15], v[132:135]
v_accvgpr_write_b32 a211, v186
v_mfma_f32_16x16x32_bf16 v[100:103], a[172:175], a[8:11], v[100:103]
s_lshl_b32 s92, s36, 9
s_lshr_b32 s93, s35, 2
v_mfma_f32_16x16x32_bf16 v[68:71], a[172:175], a[4:7], v[68:71]
s_and_b32 s94, s35, 3
s_lshl_b32 s95, s93, 6
v_mfma_f32_16x16x32_bf16 v[36:39], a[172:175], a[0:3], v[36:39]
s_add_u32 s95, s95, s92
s_lshl2_add_u32 s95, s94, s95
s_waitcnt vmcnt(21)
s_waitcnt lgkmcnt(8)
v_mfma_f32_16x16x32_bf16 v[8:11], a[176:179], a[16:19], v[8:11]
v_add_u32 v234, 0xfffe0000, v234
v_add_u32 v235, 0xfffe0000, v235
v_mfma_f32_16x16x32_bf16 v[40:43], a[176:179], a[20:23], v[40:43]
v_add_u32 v236, 0xfffe0000, v236
v_add_u32 v237, 0xfffe0000, v237
v_mfma_f32_16x16x32_bf16 v[72:75], a[176:179], a[24:27], v[72:75]
s_add_u32 s95, s95, 0x248000
v_mfma_f32_16x16x32_bf16 v[104:107], a[176:179], a[28:31], v[104:107]
ds_read_b64_tr_b16 a[144:145], v234 offset:0
v_lshlrev_b32 v170, 4, v1
v_mfma_f32_16x16x32_bf16 v[108:111], a[180:183], a[28:31], v[108:111]
ds_read_b64_tr_b16 a[146:147], v234 offset:4096
v_add_u32 v170, s95, v170
v_mfma_f32_16x16x32_bf16 v[76:79], a[180:183], a[24:27], v[76:79]
ds_read_b64_tr_b16 a[148:149], v234 offset:8
s_lshl_b32 s95, s94, 7
v_mfma_f32_16x16x32_bf16 v[44:47], a[180:183], a[20:23], v[44:47]
s_add_u32 s28, s28, 1024
s_cmp_lt_u32 s28, s6
s_cselect_b32 s28, s28, s4
v_mfma_f32_16x16x32_bf16 v[12:15], a[180:183], a[16:19], v[12:15]
ds_read_b64_tr_b16 a[150:151], v234 offset:4104
s_add_u32 s95, s95, s92
v_mfma_f32_16x16x32_bf16 v[16:19], a[184:187], a[16:19], v[16:19]
ds_read_b64_tr_b16 a[152:153], v235 offset:0
s_lshl2_add_u32 s95, s93, s95
v_mfma_f32_16x16x32_bf16 v[48:51], a[184:187], a[20:23], v[48:51]
ds_read_b64_tr_b16 a[154:155], v235 offset:4096
s_add_u32 s95, s95, 0x249f80
v_mfma_f32_16x16x32_bf16 v[80:83], a[184:187], a[24:27], v[80:83]
buffer_load_dwordx4 a[80:83], v240, s[20:23], s28 offen sc0 sc1
v_mfma_f32_16x16x32_bf16 v[112:115], a[184:187], a[28:31], v[112:115]
ds_read_b64_tr_b16 a[156:157], v235 offset:8
v_lshlrev_b32 v184, 5, v1
v_mfma_f32_16x16x32_bf16 v[116:119], a[188:191], a[28:31], v[116:119]
ds_read_b64_tr_b16 a[158:159], v235 offset:4104
v_add_u32 v184, s95, v184
v_mfma_f32_16x16x32_bf16 v[84:87], a[188:191], a[24:27], v[84:87]
buffer_load_dwordx4 a[84:87], v241, s[20:23], s28 offen sc0 sc1
v_mfma_f32_16x16x32_bf16 v[52:55], a[188:191], a[20:23], v[52:55]
ds_read_b64_tr_b16 a[160:161], v236 offset:0
v_cmp_lt_u32 vcc, 3, v1
v_mfma_f32_16x16x32_bf16 v[20:23], a[188:191], a[16:19], v[20:23]
ds_read_b64_tr_b16 a[162:163], v236 offset:4096
s_waitcnt lgkmcnt(8)
v_mfma_f32_16x16x32_bf16 v[24:27], a[192:195], a[16:19], v[24:27]
ds_read_b64_tr_b16 a[164:165], v236 offset:8
v_cndmask_b32 v170, v170, v184, vcc
v_mfma_f32_16x16x32_bf16 v[56:59], a[192:195], a[20:23], v[56:59]
buffer_load_dwordx4 a[88:91], v242, s[20:23], s28 offen sc0 sc1
v_mfma_f32_16x16x32_bf16 v[88:91], a[192:195], a[24:27], v[88:91]
ds_read_b64_tr_b16 a[166:167], v236 offset:4104
s_mov_b32 s95, 0x7fffbff0
v_mfma_f32_16x16x32_bf16 v[120:123], a[192:195], a[28:31], v[120:123]
ds_read_b64_tr_b16 a[168:169], v237 offset:0
v_mfma_f32_16x16x32_bf16 v[124:127], a[196:199], a[28:31], v[124:127]
ds_read_b64_tr_b16 a[170:171], v237 offset:4096
v_mfma_f32_16x16x32_bf16 v[92:95], a[196:199], a[24:27], v[92:95]
buffer_load_dwordx4 a[92:95], v243, s[20:23], s28 offen sc0 sc1
v_mfma_f32_16x16x32_bf16 v[60:63], a[196:199], a[20:23], v[60:63]
ds_read_b64_tr_b16 a[172:173], v237 offset:8
s_add_u32 m0, s49, 40960
v_mfma_f32_16x16x32_bf16 v[28:31], a[196:199], a[16:19], v[28:31]
ds_read_b64_tr_b16 a[174:175], v237 offset:4104
v_mfma_f32_16x16x32_bf16 v[32:35], a[200:203], a[16:19], v[32:35]
buffer_load_dwordx4 v238, s[16:19], s34 offen offset:0 lds
v_mfma_f32_16x16x32_bf16 v[64:67], a[200:203], a[20:23], v[64:67]
buffer_load_dwordx4 v239, s[16:19], s34 offen offset:1024 lds
v_mfma_f32_16x16x32_bf16 v[96:99], a[200:203], a[24:27], v[96:99]
s_cmp_eq_u32 s2, 0
s_cselect_b32 s95, 0x242c00, s95
v_mfma_f32_16x16x32_bf16 v[128:131], a[200:203], a[28:31], v[128:131]
s_add_u32 s34, s34, 262144
s_sub_u32 s51, s34, 4718592
s_cselect_b32 s34, s34, s51
v_mfma_f32_16x16x32_bf16 v[132:135], a[204:207], a[28:31], v[132:135]
v_lshlrev_b32 v184, 7, v1
v_add_u32 v184, s95, v184
v_mfma_f32_16x16x32_bf16 v[100:103], a[204:207], a[24:27], v[100:103]
v_cmp_lt_u32 vcc, 7, v1
v_mfma_f32_16x16x32_bf16 v[68:71], a[204:207], a[20:23], v[68:71]
v_mfma_f32_16x16x32_bf16 v[36:39], a[204:207], a[16:19], v[36:39]
v_cndmask_b32 v170, v170, v184, vcc
v_mov_b32 v184, 0x7ffffff0
s_waitcnt vmcnt(20)
v_mfma_f32_16x16x32_bf16 v[8:11], a[144:147], a[32:35], v[8:11]
ds_read_b64_tr_b16 a[176:177], v234 offset:8192
v_mov_b32 v171, 0
v_mfma_f32_16x16x32_bf16 v[40:43], a[144:147], a[36:39], v[40:43]
ds_read_b64_tr_b16 a[178:179], v234 offset:12288
v_cmp_lt_u32 vcc, 9, v0
v_mfma_f32_16x16x32_bf16 v[72:75], a[144:147], a[40:43], v[72:75]
s_add_u32 s28, s28, 1024
s_cmp_lt_u32 s28, s6
s_cselect_b32 s28, s28, s4
v_mfma_f32_16x16x32_bf16 v[104:107], a[144:147], a[44:47], v[104:107]
ds_read_b64_tr_b16 a[180:181], v234 offset:8200
v_cndmask_b32 v170, v170, v184, vcc
s_waitcnt lgkmcnt(8)
v_mfma_f32_16x16x32_bf16 v[108:111], a[148:151], a[44:47], v[108:111]
ds_read_b64_tr_b16 a[182:183], v234 offset:12296
v_mov_b32 v254, 0x7ffffff0
v_mfma_f32_16x16x32_bf16 v[76:79], a[148:151], a[40:43], v[76:79]
buffer_load_dwordx4 a[96:99], v240, s[20:23], s28 offen sc0 sc1
v_mfma_f32_16x16x32_bf16 v[44:47], a[148:151], a[36:39], v[44:47]
ds_read_b64_tr_b16 a[184:185], v235 offset:8192
s_lshl_b32 s92, s36, 5
v_mfma_f32_16x16x32_bf16 v[12:15], a[148:151], a[32:35], v[12:15]
ds_read_b64_tr_b16 a[186:187], v235 offset:12288
s_add_u32 s92, s92, s35
v_mfma_f32_16x16x32_bf16 v[16:19], a[152:155], a[32:35], v[16:19]
buffer_load_dwordx4 a[100:103], v241, s[20:23], s28 offen sc0 sc1
v_mfma_f32_16x16x32_bf16 v[48:51], a[152:155], a[36:39], v[48:51]
ds_read_b64_tr_b16 a[188:189], v235 offset:8200
v_mfma_f32_16x16x32_bf16 v[80:83], a[152:155], a[40:43], v[80:83]
ds_read_b64_tr_b16 a[190:191], v235 offset:12296
v_mfma_f32_16x16x32_bf16 v[112:115], a[152:155], a[44:47], v[112:115]
buffer_load_dwordx4 a[104:107], v242, s[20:23], s28 offen sc0 sc1
v_mfma_f32_16x16x32_bf16 v[116:119], a[156:159], a[44:47], v[116:119]
ds_read_b64_tr_b16 a[192:193], v236 offset:8192
v_mfma_f32_16x16x32_bf16 v[84:87], a[156:159], a[40:43], v[84:87]
buffer_load_dwordx4 a[108:111], v243, s[20:23], s28 offen sc0 sc1
v_mfma_f32_16x16x32_bf16 v[52:55], a[156:159], a[36:39], v[52:55]
ds_read_b64_tr_b16 a[194:195], v236 offset:12288
v_mfma_f32_16x16x32_bf16 v[20:23], a[156:159], a[32:35], v[20:23]
ds_read_b64_tr_b16 a[196:197], v236 offset:8200
v_mfma_f32_16x16x32_bf16 v[24:27], a[160:163], a[32:35], v[24:27]
s_add_u32 m0, s49, 49152
v_mfma_f32_16x16x32_bf16 v[56:59], a[160:163], a[36:39], v[56:59]
ds_read_b64_tr_b16 a[198:199], v236 offset:12296
v_mfma_f32_16x16x32_bf16 v[88:91], a[160:163], a[40:43], v[88:91]
ds_read_b64_tr_b16 a[200:201], v237 offset:8192
v_mfma_f32_16x16x32_bf16 v[120:123], a[160:163], a[44:47], v[120:123]
s_cmp_eq_u32 s37, 0
s_cselect_b32 s92, s92, 0x7ffffff0
s_waitcnt lgkmcnt(8)
v_mfma_f32_16x16x32_bf16 v[124:127], a[164:167], a[44:47], v[124:127]
ds_read_b64_tr_b16 a[202:203], v237 offset:12288
v_mfma_f32_16x16x32_bf16 v[92:95], a[164:167], a[40:43], v[92:95]
ds_read_b64_tr_b16 a[204:205], v237 offset:8200
v_writelane_b32 v254, s92, 0
v_mfma_f32_16x16x32_bf16 v[60:63], a[164:167], a[36:39], v[60:63]
buffer_load_dwordx4 v238, s[16:19], s34 offen offset:0 lds
v_mfma_f32_16x16x32_bf16 v[28:31], a[164:167], a[32:35], v[28:31]
ds_read_b64_tr_b16 a[206:207], v237 offset:12296
s_or_b32 s92, s38, s46
v_mfma_f32_16x16x32_bf16 v[32:35], a[168:171], a[32:35], v[32:35]
buffer_load_dwordx4 v239, s[16:19], s34 offen offset:1024 lds
v_mfma_f32_16x16x32_bf16 v[64:67], a[168:171], a[36:39], v[64:67]
v_mov_b32 v255, s92
v_add_u32 v184, 0, v0
v_mfma_f32_16x16x32_bf16 v[96:99], a[168:171], a[40:43], v[96:99]
s_add_u32 s34, s34, 262144
s_sub_u32 s51, s34, 4718592
s_cselect_b32 s34, s34, s51
v_mfma_f32_16x16x32_bf16 v[128:131], a[168:171], a[44:47], v[128:131]
v_mul_u32_u24 v185, 911, v184
v_lshrrev_b32 v185, 16, v185
v_mfma_f32_16x16x32_bf16 v[132:135], a[172:175], a[44:47], v[132:135]
v_add_u32 v184, v184, v185
v_lshlrev_b32 v184, 4, v184
v_mfma_f32_16x16x32_bf16 v[100:103], a[172:175], a[40:43], v[100:103]
v_add_u32 v178, 0x24000, v184
v_add_u32 v184, 256, v0
v_mfma_f32_16x16x32_bf16 v[68:71], a[172:175], a[36:39], v[68:71]
v_mul_u32_u24 v185, 911, v184
v_lshrrev_b32 v185, 16, v185
v_mfma_f32_16x16x32_bf16 v[36:39], a[172:175], a[32:35], v[36:39]
v_add_u32 v184, v184, v185
v_lshlrev_b32 v184, 4, v184
s_waitcnt vmcnt(20)
v_mfma_f32_16x16x32_bf16 v[8:11], a[176:179], a[48:51], v[8:11]
v_add_u32 v179, 0x24000, v184
v_add_u32 v184, 512, v0
v_mfma_f32_16x16x32_bf16 v[40:43], a[176:179], a[52:55], v[40:43]
s_waitcnt vmcnt(12) lgkmcnt(0)
s_barrier
v_mfma_f32_16x16x32_bf16 v[72:75], a[176:179], a[56:59], v[72:75]
ds_read_b64_tr_b16 a[144:145], v234 offset:16384
v_mul_u32_u24 v185, 911, v184
v_mfma_f32_16x16x32_bf16 v[104:107], a[176:179], a[60:63], v[104:107]
ds_read_b64_tr_b16 a[146:147], v234 offset:20480
STUB_2:
STUB_A2:
s_cbranch_execz STUB_5
v_lshrrev_b32 v185, 16, v185
v_mfma_f32_16x16x32_bf16 v[108:111], a[180:183], a[60:63], v[108:111]
ds_read_b64_tr_b16 a[148:149], v234 offset:16392
v_add_u32 v184, v184, v185
v_mfma_f32_16x16x32_bf16 v[76:79], a[180:183], a[56:59], v[76:79]
s_add_u32 s28, s28, 1024
s_cmp_lt_u32 s28, s6
s_cselect_b32 s28, s28, s4
v_mfma_f32_16x16x32_bf16 v[44:47], a[180:183], a[52:55], v[44:47]
ds_read_b64_tr_b16 a[150:151], v234 offset:20488
v_lshlrev_b32 v184, 4, v184
v_mfma_f32_16x16x32_bf16 v[12:15], a[180:183], a[48:51], v[12:15]
ds_read_b64_tr_b16 a[152:153], v235 offset:16384
v_add_u32 v180, 0x24000, v184
v_mfma_f32_16x16x32_bf16 v[16:19], a[184:187], a[48:51], v[16:19]
buffer_load_dwordx4 a[112:115], v240, s[20:23], s28 offen sc0 sc1
v_mfma_f32_16x16x32_bf16 v[48:51], a[184:187], a[52:55], v[48:51]
ds_read_b64_tr_b16 a[154:155], v235 offset:20480
v_mfma_f32_16x16x32_bf16 v[80:83], a[184:187], a[56:59], v[80:83]
ds_read_b64_tr_b16 a[156:157], v235 offset:16392
v_mfma_f32_16x16x32_bf16 v[112:115], a[184:187], a[60:63], v[112:115]
buffer_load_dwordx4 a[116:119], v241, s[20:23], s28 offen sc0 sc1
v_mfma_f32_16x16x32_bf16 v[116:119], a[188:191], a[60:63], v[116:119]
ds_read_b64_tr_b16 a[158:159], v235 offset:20488
v_mfma_f32_16x16x32_bf16 v[84:87], a[188:191], a[56:59], v[84:87]
ds_read_b64_tr_b16 a[160:161], v236 offset:16384
v_mfma_f32_16x16x32_bf16 v[52:55], a[188:191], a[52:55], v[52:55]
ds_read_b64_tr_b16 a[162:163], v236 offset:20480
v_mfma_f32_16x16x32_bf16 v[20:23], a[188:191], a[48:51], v[20:23]
buffer_load_dwordx4 a[120:123], v242, s[20:23], s28 offen sc0 sc1
v_mfma_f32_16x16x32_bf16 v[24:27], a[192:195], a[48:51], v[24:27]
ds_read_b64_tr_b16 a[164:165], v236 offset:16392
v_mfma_f32_16x16x32_bf16 v[56:59], a[192:195], a[52:55], v[56:59]
ds_read_b64_tr_b16 a[166:167], v236 offset:20488
v_mfma_f32_16x16x32_bf16 v[88:91], a[192:195], a[56:59], v[88:91]
buffer_load_dwordx4 a[124:127], v243, s[20:23], s28 offen sc0 sc1
v_mfma_f32_16x16x32_bf16 v[120:123], a[192:195], a[60:63], v[120:123]
ds_read_b64_tr_b16 a[168:169], v237 offset:16384
s_add_u32 m0, s49, 57344
v_mfma_f32_16x16x32_bf16 v[124:127], a[196:199], a[60:63], v[124:127]
ds_read_b64_tr_b16 a[170:171], v237 offset:20480
v_mfma_f32_16x16x32_bf16 v[92:95], a[196:199], a[56:59], v[92:95]
buffer_load_dwordx4 v238, s[16:19], s34 offen offset:0 lds
v_mfma_f32_16x16x32_bf16 v[60:63], a[196:199], a[52:55], v[60:63]
ds_read_b64_tr_b16 a[172:173], v237 offset:16392
v_mfma_f32_16x16x32_bf16 v[28:31], a[196:199], a[48:51], v[28:31]
ds_read_b64_tr_b16 a[174:175], v237 offset:20488
v_mfma_f32_16x16x32_bf16 v[32:35], a[200:203], a[48:51], v[32:35]
buffer_load_dwordx4 v239, s[16:19], s34 offen offset:1024 lds
v_mfma_f32_16x16x32_bf16 v[64:67], a[200:203], a[52:55], v[64:67]
s_waitcnt vmcnt(36)
v_readfirstlane_b32 s92, v193
v_mfma_f32_16x16x32_bf16 v[96:99], a[200:203], a[56:59], v[96:99]
s_add_u32 s34, s34, 262144
s_sub_u32 s51, s34, 4718592
s_cselect_b32 s34, s34, s51
v_mfma_f32_16x16x32_bf16 v[128:131], a[200:203], a[60:63], v[128:131]
s_and_b32 s93, s92, 0xf0
s_cbranch_scc0 SP_X0
SP_X0_RET:
v_mfma_f32_16x16x32_bf16 v[132:135], a[204:207], a[60:63], v[132:135]
s_add_u32 s92, s92, s36
s_and_b32 s92, s92, 7
v_mfma_f32_16x16x32_bf16 v[100:103], a[204:207], a[56:59], v[100:103]
s_lshl_b32 s92, s92, 2
s_lshr_b32 s92, 0x63724150, s92
v_mfma_f32_16x16x32_bf16 v[68:71], a[204:207], a[52:55], v[68:71]
s_and_b32 s92, s92, 7
s_lshl_b32 s93, s92, 5
v_mfma_f32_16x16x32_bf16 v[36:39], a[204:207], a[48:51], v[36:39]
s_add_u32 s40, s93, s35
s_lshr_b32 s93, s35, 1
s_waitcnt vmcnt(20)
s_waitcnt lgkmcnt(8)
v_mfma_f32_16x16x32_bf16 v[8:11], a[144:147], a[64:67], v[8:11]
ds_read_b64_tr_b16 a[176:177], v234 offset:24576
s_lshl2_add_u32 s93, s93, s92
v_mfma_f32_16x16x32_bf16 v[40:43], a[144:147], a[68:71], v[40:43]
ds_read_b64_tr_b16 a[178:179], v234 offset:28672
s_and_b32 s94, s35, 1
v_mfma_f32_16x16x32_bf16 v[72:75], a[144:147], a[72:75], v[72:75]
s_add_u32 s28, s28, 1024
s_cmp_lt_u32 s28, s6
s_cselect_b32 s28, s28, s4
v_mfma_f32_16x16x32_bf16 v[104:107], a[144:147], a[76:79], v[104:107]
ds_read_b64_tr_b16 a[180:181], v234 offset:24584
s_lshl1_add_u32 s93, s93, s94
v_mfma_f32_16x16x32_bf16 v[108:111], a[148:151], a[76:79], v[108:111]
ds_read_b64_tr_b16 a[182:183], v234 offset:28680
v_mfma_f32_16x16x32_bf16 v[76:79], a[148:151], a[72:75], v[76:79]
buffer_load_dwordx4 a[0:3], v240, s[20:23], s28 offen sc0 sc1
v_mfma_f32_16x16x32_bf16 v[44:47], a[148:151], a[68:71], v[44:47]
ds_read_b64_tr_b16 a[184:185], v235 offset:24576
v_mfma_f32_16x16x32_bf16 v[12:15], a[148:151], a[64:67], v[12:15]
ds_read_b64_tr_b16 a[186:187], v235 offset:28672
v_mfma_f32_16x16x32_bf16 v[16:19], a[152:155], a[64:67], v[16:19]
buffer_load_dwordx4 a[4:7], v241, s[20:23], s28 offen sc0 sc1
v_mfma_f32_16x16x32_bf16 v[48:51], a[152:155], a[68:71], v[48:51]
ds_read_b64_tr_b16 a[188:189], v235 offset:24584
v_mfma_f32_16x16x32_bf16 v[80:83], a[152:155], a[72:75], v[80:83]
ds_read_b64_tr_b16 a[190:191], v235 offset:28680
v_mfma_f32_16x16x32_bf16 v[112:115], a[152:155], a[76:79], v[112:115]
buffer_load_dwordx4 a[8:11], v242, s[20:23], s28 offen sc0 sc1
v_mfma_f32_16x16x32_bf16 v[116:119], a[156:159], a[76:79], v[116:119]
ds_read_b64_tr_b16 a[192:193], v236 offset:24576
v_mfma_f32_16x16x32_bf16 v[84:87], a[156:159], a[72:75], v[84:87]
buffer_load_dwordx4 a[12:15], v243, s[20:23], s28 offen sc0 sc1
v_mfma_f32_16x16x32_bf16 v[52:55], a[156:159], a[68:71], v[52:55]
ds_read_b64_tr_b16 a[194:195], v236 offset:28672
s_add_u32 s32, s7, 0
v_mfma_f32_16x16x32_bf16 v[20:23], a[156:159], a[64:67], v[20:23]
ds_read_b64_tr_b16 a[196:197], v236 offset:24584
s_waitcnt lgkmcnt(8)
v_mfma_f32_16x16x32_bf16 v[24:27], a[160:163], a[64:67], v[24:27]
s_add_u32 m0, s30, 81920
v_mfma_f32_16x16x32_bf16 v[56:59], a[160:163], a[68:71], v[56:59]
ds_read_b64_tr_b16 a[198:199], v236 offset:28680
v_mfma_f32_16x16x32_bf16 v[88:91], a[160:163], a[72:75], v[88:91]
ds_read_b64_tr_b16 a[200:201], v237 offset:24576
v_mfma_f32_16x16x32_bf16 v[120:123], a[160:163], a[76:79], v[120:123]
buffer_load_dwordx4 v228, s[8:11], s32 offen offset:0  lds
v_mfma_f32_16x16x32_bf16 v[124:127], a[164:167], a[76:79], v[124:127]
ds_read_b64_tr_b16 a[202:203], v237 offset:28672
v_mfma_f32_16x16x32_bf16 v[92:95], a[164:167], a[72:75], v[92:95]
ds_read_b64_tr_b16 a[204:205], v237 offset:24584
v_mfma_f32_16x16x32_bf16 v[60:63], a[164:167], a[68:71], v[60:63]
buffer_load_dwordx4 v229, s[8:11], s32 offen offset:1024  lds
v_mfma_f32_16x16x32_bf16 v[28:31], a[164:167], a[64:67], v[28:31]
ds_read_b64_tr_b16 a[206:207], v237 offset:28680
v_mfma_f32_16x16x32_bf16 v[32:35], a[168:171], a[64:67], v[32:35]
buffer_load_dwordx4 v230, s[8:11], s32 offen offset:2048  lds
v_mfma_f32_16x16x32_bf16 v[64:67], a[168:171], a[68:71], v[64:67]
s_cmp_lt_u32 s92, 4
s_cselect_b32 s40, s93, s40
v_mfma_f32_16x16x32_bf16 v[96:99], a[168:171], a[72:75], v[96:99]
s_mov_b32 s92, s40
s_lshl_b32 s84, s92, 6
v_mfma_f32_16x16x32_bf16 v[128:131], a[168:171], a[76:79], v[128:131]
buffer_load_dwordx4 v231, s[8:11], s32 offen offset:3072  lds
v_mfma_f32_16x16x32_bf16 v[132:135], a[172:175], a[76:79], v[132:135]
s_mul_i32 s93, s37, 147456
s_add_u32 s84, s84, s93
v_mfma_f32_16x16x32_bf16 v[100:103], a[172:175], a[72:75], v[100:103]
s_mul_i32 s85, s92, 36864
s_add_u32 s85, s85, s31
v_mfma_f32_16x16x32_bf16 v[68:71], a[172:175], a[68:71], v[68:71]
s_cmp_lt_u32 s40, 144
s_cselect_b32 s86, s31, 0x30000
s_cselect_b32 s84, s84, 0x40000000
s_cselect_b32 s85, s85, 0x40000000
v_mfma_f32_16x16x32_bf16 v[36:39], a[172:175], a[64:67], v[36:39]
s_waitcnt vmcnt(22)
v_mfma_f32_16x16x32_bf16 v[8:11], a[176:179], a[80:83], v[8:11]
ds_read_b64_tr_b16 a[144:145], v234 offset:32768
v_mfma_f32_16x16x32_bf16 v[40:43], a[176:179], a[84:87], v[40:43]
ds_read_b64_tr_b16 a[146:147], v234 offset:36864
v_mfma_f32_16x16x32_bf16 v[72:75], a[176:179], a[88:91], v[72:75]
s_add_u32 s28, s28, 1024
s_cmp_lt_u32 s28, s6
s_cselect_b32 s28, s28, s4
v_mfma_f32_16x16x32_bf16 v[104:107], a[176:179], a[92:95], v[104:107]
ds_read_b64_tr_b16 a[148:149], v234 offset:32776
s_waitcnt lgkmcnt(8)
v_mfma_f32_16x16x32_bf16 v[108:111], a[180:183], a[92:95], v[108:111]
ds_read_b64_tr_b16 a[150:151], v234 offset:36872
v_mfma_f32_16x16x32_bf16 v[76:79], a[180:183], a[88:91], v[76:79]
v_mfma_f32_16x16x32_bf16 v[44:47], a[180:183], a[84:87], v[44:47]
ds_read_b64_tr_b16 a[152:153], v235 offset:32768
v_mfma_f32_16x16x32_bf16 v[12:15], a[180:183], a[80:83], v[12:15]
ds_read_b64_tr_b16 a[154:155], v235 offset:36864
v_mfma_f32_16x16x32_bf16 v[16:19], a[184:187], a[80:83], v[16:19]
buffer_load_dwordx4 a[16:19], v240, s[20:23], s28 offen sc0 sc1
v_mfma_f32_16x16x32_bf16 v[48:51], a[184:187], a[84:87], v[48:51]
ds_read_b64_tr_b16 a[156:157], v235 offset:32776
v_mfma_f32_16x16x32_bf16 v[80:83], a[184:187], a[88:91], v[80:83]
ds_read_b64_tr_b16 a[158:159], v235 offset:36872
v_mfma_f32_16x16x32_bf16 v[112:115], a[184:187], a[92:95], v[112:115]
v_mfma_f32_16x16x32_bf16 v[116:119], a[188:191], a[92:95], v[116:119]
ds_read_b64_tr_b16 a[160:161], v236 offset:32768
v_mfma_f32_16x16x32_bf16 v[84:87], a[188:191], a[88:91], v[84:87]
buffer_load_dwordx4 a[20:23], v241, s[20:23], s28 offen sc0 sc1
v_mfma_f32_16x16x32_bf16 v[52:55], a[188:191], a[84:87], v[52:55]
ds_read_b64_tr_b16 a[162:163], v236 offset:36864
v_mfma_f32_16x16x32_bf16 v[20:23], a[188:191], a[80:83], v[20:23]
ds_read_b64_tr_b16 a[164:165], v236 offset:32776
v_mfma_f32_16x16x32_bf16 v[24:27], a[192:195], a[80:83], v[24:27]
v_mfma_f32_16x16x32_bf16 v[56:59], a[192:195], a[84:87], v[56:59]
ds_read_b64_tr_b16 a[166:167], v236 offset:36872
v_mfma_f32_16x16x32_bf16 v[88:91], a[192:195], a[88:91], v[88:91]
ds_read_b64_tr_b16 a[168:169], v237 offset:32768
v_mfma_f32_16x16x32_bf16 v[120:123], a[192:195], a[92:95], v[120:123]
buffer_load_dwordx4 a[24:27], v242, s[20:23], s28 offen sc0 sc1
s_waitcnt lgkmcnt(8)
v_mfma_f32_16x16x32_bf16 v[124:127], a[196:199], a[92:95], v[124:127]
ds_read_b64_tr_b16 a[170:171], v237 offset:36864
v_mfma_f32_16x16x32_bf16 v[92:95], a[196:199], a[88:91], v[92:95]
ds_read_b64_tr_b16 a[172:173], v237 offset:32776
v_mfma_f32_16x16x32_bf16 v[60:63], a[196:199], a[84:87], v[60:63]
v_lshlrev_b32 v136, 3, v1
v_mov_b32 v137, 0x7ffffff0
v_mfma_f32_16x16x32_bf16 v[28:31], a[196:199], a[80:83], v[28:31]
ds_read_b64_tr_b16 a[174:175], v237 offset:36872
v_mfma_f32_16x16x32_bf16 v[32:35], a[200:203], a[80:83], v[32:35]
buffer_load_dwordx4 a[28:31], v243, s[20:23], s28 offen sc0 sc1
v_mfma_f32_16x16x32_bf16 v[64:67], a[200:203], a[84:87], v[64:67]
v_cmp_lt_u32 vcc, 7, v1
v_mov_b32 v143, s47
v_mfma_f32_16x16x32_bf16 v[96:99], a[200:203], a[88:91], v[96:99]
v_mfma_f32_16x16x32_bf16 v[128:131], a[200:203], a[92:95], v[128:131]
v_cndmask_b32 v136, v136, v137, vcc
v_mfma_f32_16x16x32_bf16 v[132:135], a[204:207], a[92:95], v[132:135]
s_lshl_b32 s29, s36, 6
s_add_u32 s29, s29, 0x242000
v_mfma_f32_16x16x32_bf16 v[100:103], a[204:207], a[88:91], v[100:103]
s_add_u32 s50, s35, s37
s_cmp_eq_u32 s50, 0
s_cselect_b32 s29, s29, 0x7ffffff0
v_mfma_f32_16x16x32_bf16 v[68:71], a[204:207], a[84:87], v[68:71]
v_mfma_f32_16x16x32_bf16 v[36:39], a[204:207], a[80:83], v[36:39]
s_waitcnt vmcnt(20)
v_mfma_f32_16x16x32_bf16 v[8:11], a[144:147], a[96:99], v[8:11]
v_mfma_f32_16x16x32_bf16 v[40:43], a[144:147], a[100:103], v[40:43]
s_waitcnt vmcnt(12) lgkmcnt(0)
s_barrier
v_mfma_f32_16x16x32_bf16 v[72:75], a[144:147], a[104:107], v[72:75]
ds_read_b64_tr_b16 a[176:177], v234 offset:40960
s_add_u32 s32, s7, 16384
v_mfma_f32_16x16x32_bf16 v[104:107], a[144:147], a[108:111], v[104:107]
ds_read_b64_tr_b16 a[178:179], v234 offset:45056
v_mfma_f32_16x16x32_bf16 v[108:111], a[148:151], a[108:111], v[108:111]
ds_read_b64_tr_b16 a[180:181], v234 offset:40968
v_mfma_f32_16x16x32_bf16 v[76:79], a[148:151], a[104:107], v[76:79]
buffer_store_dwordx2 v[142:143], v136, s[20:23], s29 offen sc0 sc1
v_mfma_f32_16x16x32_bf16 v[44:47], a[148:151], a[100:103], v[44:47]
ds_read_b64_tr_b16 a[182:183], v234 offset:45064
s_add_u32 m0, s30, 114688
v_mfma_f32_16x16x32_bf16 v[12:15], a[148:151], a[96:99], v[12:15]
ds_read_b64_tr_b16 a[184:185], v235 offset:40960
v_mfma_f32_16x16x32_bf16 v[16:19], a[152:155], a[96:99], v[16:19]
buffer_store_dword v171, v170, s[20:23], 0 offen sc0 sc1
v_mfma_f32_16x16x32_bf16 v[48:51], a[152:155], a[100:103], v[48:51]
ds_read_b64_tr_b16 a[186:187], v235 offset:45056
ds_read_b128 v[152:155], v178
v_mfma_f32_16x16x32_bf16 v[80:83], a[152:155], a[104:107], v[80:83]
ds_read_b64_tr_b16 a[188:189], v235 offset:40968
ds_read_b128 v[156:159], v179
v_mfma_f32_16x16x32_bf16 v[112:115], a[152:155], a[108:111], v[112:115]
buffer_load_dwordx4 v228, s[8:11], s32 offen offset:0  lds
v_mfma_f32_16x16x32_bf16 v[116:119], a[156:159], a[108:111], v[116:119]
ds_read_b64_tr_b16 a[190:191], v235 offset:45064
ds_read_b128 v[160:163], v180
v_mfma_f32_16x16x32_bf16 v[84:87], a[156:159], a[104:107], v[84:87]
ds_read_b64_tr_b16 a[192:193], v236 offset:40960
v_mfma_f32_16x16x32_bf16 v[52:55], a[156:159], a[100:103], v[52:55]
ds_read_b64_tr_b16 a[194:195], v236 offset:45056
v_mfma_f32_16x16x32_bf16 v[20:23], a[156:159], a[96:99], v[20:23]
s_mul_i32 s45, s3, 1152
s_add_u32 s45, s45, s31
v_mfma_f32_16x16x32_bf16 v[24:27], a[160:163], a[96:99], v[24:27]
ds_read_b64_tr_b16 a[196:197], v236 offset:40968
s_add_u32 s45, s45, 0x1c00000
v_mfma_f32_16x16x32_bf16 v[56:59], a[160:163], a[100:103], v[56:59]
ds_read_b64_tr_b16 a[198:199], v236 offset:45064
v_mfma_f32_16x16x32_bf16 v[88:91], a[160:163], a[104:107], v[88:91]
buffer_load_dwordx4 v229, s[8:11], s32 offen offset:1024  lds
v_mfma_f32_16x16x32_bf16 v[120:123], a[160:163], a[108:111], v[120:123]
ds_read_b64_tr_b16 a[200:201], v237 offset:40960
v_mfma_f32_16x16x32_bf16 v[124:127], a[164:167], a[108:111], v[124:127]
ds_read_b64_tr_b16 a[202:203], v237 offset:45056
v_mfma_f32_16x16x32_bf16 v[92:95], a[164:167], a[104:107], v[92:95]
buffer_load_dwordx4 v230, s[8:11], s32 offen offset:2048  lds
v_mfma_f32_16x16x32_bf16 v[60:63], a[164:167], a[100:103], v[60:63]
ds_read_b64_tr_b16 a[204:205], v237 offset:40968
v_mfma_f32_16x16x32_bf16 v[28:31], a[164:167], a[96:99], v[28:31]
ds_read_b64_tr_b16 a[206:207], v237 offset:45064
v_mfma_f32_16x16x32_bf16 v[32:35], a[168:171], a[96:99], v[32:35]
s_waitcnt lgkmcnt(8)
buffer_store_dwordx4 v[152:155], v244, s[20:23], s45 offen sc0 sc1
v_mfma_f32_16x16x32_bf16 v[64:67], a[168:171], a[100:103], v[64:67]
buffer_load_dwordx4 v231, s[8:11], s32 offen offset:3072  lds
v_mfma_f32_16x16x32_bf16 v[96:99], a[168:171], a[104:107], v[96:99]
v_mfma_f32_16x16x32_bf16 v[128:131], a[168:171], a[108:111], v[128:131]
v_mfma_f32_16x16x32_bf16 v[132:135], a[172:175], a[108:111], v[132:135]
v_mfma_f32_16x16x32_bf16 v[100:103], a[172:175], a[104:107], v[100:103]
v_mfma_f32_16x16x32_bf16 v[68:71], a[172:175], a[100:103], v[68:71]
s_add_u32 s45, s45, 4096
buffer_store_dwordx4 v[156:159], v244, s[20:23], s45 offen sc0 sc1
v_mfma_f32_16x16x32_bf16 v[36:39], a[172:175], a[96:99], v[36:39]
s_waitcnt vmcnt(22)
v_mfma_f32_16x16x32_bf16 v[8:11], a[176:179], a[112:115], v[8:11]
ds_read_b64_tr_b16 a[144:145], v234 offset:49152
v_mfma_f32_16x16x32_bf16 v[40:43], a[176:179], a[116:119], v[40:43]
ds_read_b64_tr_b16 a[146:147], v234 offset:53248
v_mfma_f32_16x16x32_bf16 v[72:75], a[176:179], a[120:123], v[72:75]
v_mfma_f32_16x16x32_bf16 v[104:107], a[176:179], a[124:127], v[104:107]
ds_read_b64_tr_b16 a[148:149], v234 offset:49160
v_mfma_f32_16x16x32_bf16 v[108:111], a[180:183], a[124:127], v[108:111]
ds_read_b64_tr_b16 a[150:151], v234 offset:53256
v_mfma_f32_16x16x32_bf16 v[76:79], a[180:183], a[120:123], v[76:79]
s_add_u32 s45, s45, 4096
s_cmp_eq_u32 s37, 0
s_cselect_b32 s45, s45, 0x7ffffff0
buffer_store_dwordx4 v[160:163], v244, s[20:23], s45 offen sc0 sc1
v_mfma_f32_16x16x32_bf16 v[44:47], a[180:183], a[116:119], v[44:47]
ds_read_b64_tr_b16 a[152:153], v235 offset:49152
s_mul_i32 s88, s37, 864
v_mfma_f32_16x16x32_bf16 v[12:15], a[180:183], a[112:115], v[12:15]
ds_read_b64_tr_b16 a[154:155], v235 offset:53248
s_mov_b32 s87, s88
v_mfma_f32_16x16x32_bf16 v[16:19], a[184:187], a[112:115], v[16:19]
v_accvgpr_write_b32 a128, 0
v_accvgpr_write_b32 a129, 0
v_mfma_f32_16x16x32_bf16 v[48:51], a[184:187], a[116:119], v[48:51]
ds_read_b64_tr_b16 a[156:157], v235 offset:49160
v_accvgpr_write_b32 a130, 0
v_mfma_f32_16x16x32_bf16 v[80:83], a[184:187], a[120:123], v[80:83]
ds_read_b64_tr_b16 a[158:159], v235 offset:53256
v_accvgpr_write_b32 a131, 0
v_mfma_f32_16x16x32_bf16 v[112:115], a[184:187], a[124:127], v[112:115]
v_accvgpr_write_b32 a132, 0
v_accvgpr_write_b32 a133, 0
v_mfma_f32_16x16x32_bf16 v[116:119], a[188:191], a[124:127], v[116:119]
ds_read_b64_tr_b16 a[160:161], v236 offset:49152
v_accvgpr_write_b32 a134, 0
v_mfma_f32_16x16x32_bf16 v[84:87], a[188:191], a[120:123], v[84:87]
v_accvgpr_write_b32 a135, 0
v_lshrrev_b32 v240, 2, v1
v_mfma_f32_16x16x32_bf16 v[52:55], a[188:191], a[116:119], v[52:55]
ds_read_b64_tr_b16 a[162:163], v236 offset:53248
v_mul_u32_u24 v240, 0x2400, v240
v_mfma_f32_16x16x32_bf16 v[20:23], a[188:191], a[112:115], v[20:23]
ds_read_b64_tr_b16 a[164:165], v236 offset:49160
v_and_b32 v246, 3, v1
s_waitcnt lgkmcnt(8)
v_mfma_f32_16x16x32_bf16 v[24:27], a[192:195], a[112:115], v[24:27]
v_lshl_add_u32 v240, v246, 4, v240
v_mul_u32_u24 v243, 3641, v1
v_mfma_f32_16x16x32_bf16 v[56:59], a[192:195], a[116:119], v[56:59]
ds_read_b64_tr_b16 a[166:167], v236 offset:53256
v_lshrrev_b32 v243, 16, v243
v_mfma_f32_16x16x32_bf16 v[88:91], a[192:195], a[120:123], v[88:91]
ds_read_b64_tr_b16 a[168:169], v237 offset:49152
v_mul_u32_u24 v243, 864, v243
v_mfma_f32_16x16x32_bf16 v[120:123], a[192:195], a[124:127], v[120:123]
v_add_u32 v243, v243, v244
v_mfma_f32_16x16x32_bf16 v[124:127], a[196:199], a[124:127], v[124:127]
ds_read_b64_tr_b16 a[170:171], v237 offset:53248
s_sub_u32 s92, s40, 0
v_mfma_f32_16x16x32_bf16 v[92:95], a[196:199], a[120:123], v[92:95]
ds_read_b64_tr_b16 a[172:173], v237 offset:49160
v_mfma_f32_16x16x32_bf16 v[60:63], a[196:199], a[116:119], v[60:63]
s_cmp_lt_u32 s92, 72
s_cselect_b32 s3, 4, 0
v_mfma_f32_16x16x32_bf16 v[28:31], a[196:199], a[112:115], v[28:31]
ds_read_b64_tr_b16 a[174:175], v237 offset:53256
v_mfma_f32_16x16x32_bf16 v[32:35], a[200:203], a[112:115], v[32:35]
s_cmp_lt_u32 s40, 144
s_cselect_b32 s3, 5, s3
v_mfma_f32_16x16x32_bf16 v[64:67], a[200:203], a[116:119], v[64:67]
v_mfma_f32_16x16x32_bf16 v[96:99], a[200:203], a[120:123], v[96:99]
v_mfma_f32_16x16x32_bf16 v[128:131], a[200:203], a[124:127], v[128:131]
v_mfma_f32_16x16x32_bf16 v[132:135], a[204:207], a[124:127], v[132:135]
v_mfma_f32_16x16x32_bf16 v[100:103], a[204:207], a[120:123], v[100:103]
v_mfma_f32_16x16x32_bf16 v[68:71], a[204:207], a[116:119], v[68:71]
v_mfma_f32_16x16x32_bf16 v[36:39], a[204:207], a[112:115], v[36:39]
s_waitcnt vmcnt(17)
v_mfma_f32_16x16x32_bf16 v[8:11], a[144:147], a[0:3], v[8:11]
ds_read_b64_tr_b16 a[176:177], v234 offset:57344
s_add_u32 s39, s7, 0
v_mfma_f32_16x16x32_bf16 v[40:43], a[144:147], a[4:7], v[40:43]
ds_read_b64_tr_b16 a[178:179], v234 offset:61440
v_mfma_f32_16x16x32_bf16 v[72:75], a[144:147], a[8:11], v[72:75]
v_mfma_f32_16x16x32_bf16 v[104:107], a[144:147], a[12:15], v[104:107]
ds_read_b64_tr_b16 a[180:181], v234 offset:57352
s_waitcnt lgkmcnt(8)
v_mfma_f32_16x16x32_bf16 v[108:111], a[148:151], a[12:15], v[108:111]
ds_read_b64_tr_b16 a[182:183], v234 offset:61448
v_mfma_f32_16x16x32_bf16 v[76:79], a[148:151], a[8:11], v[76:79]
s_add_u32 m0, s30, 131072
v_mfma_f32_16x16x32_bf16 v[44:47], a[148:151], a[4:7], v[44:47]
ds_read_b64_tr_b16 a[184:185], v235 offset:57344
v_mfma_f32_16x16x32_bf16 v[12:15], a[148:151], a[0:3], v[12:15]
ds_read_b64_tr_b16 a[186:187], v235 offset:61440
v_mfma_f32_16x16x32_bf16 v[16:19], a[152:155], a[0:3], v[16:19]
v_mfma_f32_16x16x32_bf16 v[48:51], a[152:155], a[4:7], v[48:51]
ds_read_b64_tr_b16 a[188:189], v235 offset:57352
v_mfma_f32_16x16x32_bf16 v[80:83], a[152:155], a[8:11], v[80:83]
ds_read_b64_tr_b16 a[190:191], v235 offset:61448
v_mfma_f32_16x16x32_bf16 v[112:115], a[152:155], a[12:15], v[112:115]
buffer_load_dwordx4 v232, s[12:15], s39 offen offset:0  lds
v_mfma_f32_16x16x32_bf16 v[116:119], a[156:159], a[12:15], v[116:119]
ds_read_b64_tr_b16 a[192:193], v236 offset:57344
v_mfma_f32_16x16x32_bf16 v[84:87], a[156:159], a[8:11], v[84:87]
v_mfma_f32_16x16x32_bf16 v[52:55], a[156:159], a[4:7], v[52:55]
ds_read_b64_tr_b16 a[194:195], v236 offset:61440
v_mfma_f32_16x16x32_bf16 v[20:23], a[156:159], a[0:3], v[20:23]
ds_read_b64_tr_b16 a[196:197], v236 offset:57352
v_mfma_f32_16x16x32_bf16 v[24:27], a[160:163], a[0:3], v[24:27]
buffer_load_dwordx4 v233, s[12:15], s39 offen offset:1024  lds
v_mfma_f32_16x16x32_bf16 v[56:59], a[160:163], a[4:7], v[56:59]
ds_read_b64_tr_b16 a[198:199], v236 offset:61448
v_mfma_f32_16x16x32_bf16 v[88:91], a[160:163], a[8:11], v[88:91]
ds_read_b64_tr_b16 a[200:201], v237 offset:57344
v_mfma_f32_16x16x32_bf16 v[120:123], a[160:163], a[12:15], v[120:123]
s_waitcnt lgkmcnt(8)
v_mfma_f32_16x16x32_bf16 v[124:127], a[164:167], a[12:15], v[124:127]
ds_read_b64_tr_b16 a[202:203], v237 offset:61440
v_mfma_f32_16x16x32_bf16 v[92:95], a[164:167], a[8:11], v[92:95]
ds_read_b64_tr_b16 a[204:205], v237 offset:57352
v_mfma_f32_16x16x32_bf16 v[60:63], a[164:167], a[4:7], v[60:63]
buffer_load_dwordx4 v232, s[12:15], s39 offen offset:2048  lds
v_mfma_f32_16x16x32_bf16 v[28:31], a[164:167], a[0:3], v[28:31]
ds_read_b64_tr_b16 a[206:207], v237 offset:61448
v_mfma_f32_16x16x32_bf16 v[32:35], a[168:171], a[0:3], v[32:35]
v_mfma_f32_16x16x32_bf16 v[64:67], a[168:171], a[4:7], v[64:67]
buffer_load_dwordx4 v233, s[12:15], s39 offen offset:3072  lds
v_mfma_f32_16x16x32_bf16 v[96:99], a[168:171], a[8:11], v[96:99]
v_mfma_f32_16x16x32_bf16 v[128:131], a[168:171], a[12:15], v[128:131]
v_mfma_f32_16x16x32_bf16 v[132:135], a[172:175], a[12:15], v[132:135]
v_mfma_f32_16x16x32_bf16 v[100:103], a[172:175], a[8:11], v[100:103]
v_mfma_f32_16x16x32_bf16 v[68:71], a[172:175], a[4:7], v[68:71]
v_mfma_f32_16x16x32_bf16 v[36:39], a[172:175], a[0:3], v[36:39]
s_waitcnt vmcnt(13)
v_mfma_f32_16x16x32_bf16 v[8:11], a[176:179], a[16:19], v[8:11]
v_mfma_f32_16x16x32_bf16 v[12:15], a[180:183], a[16:19], v[12:15]
s_waitcnt vmcnt(17) lgkmcnt(0)
s_barrier
v_mfma_f32_16x16x32_bf16 v[16:19], a[184:187], a[16:19], v[16:19]
ds_read_b128 a[144:147], v216 offset:16384
ds_read_b128 a[148:151], v217 offset:16384
v_mfma_f32_16x16x32_bf16 v[20:23], a[188:191], a[16:19], v[20:23]
ds_read_b128 a[152:155], v218 offset:16384
ds_read_b128 a[156:159], v219 offset:16384
v_mfma_f32_16x16x32_bf16 v[24:27], a[192:195], a[16:19], v[24:27]
ds_read_b128 a[160:163], v216 offset:20480
ds_read_b128 a[164:167], v217 offset:20480
v_mfma_f32_16x16x32_bf16 v[28:31], a[196:199], a[16:19], v[28:31]
ds_read_b128 a[168:171], v218 offset:20480
ds_read_b128 a[172:175], v219 offset:20480
v_mfma_f32_16x16x32_bf16 v[32:35], a[200:203], a[16:19], v[32:35]
s_add_u32 s32, s7, 32768
v_mfma_f32_16x16x32_bf16 v[36:39], a[204:207], a[16:19], v[36:39]
s_add_u32 m0, s30, 65536
v_mfma_f32_16x16x32_bf16 v[40:43], a[176:179], a[20:23], v[40:43]
v_cvt_pk_bf16_f32 v152, v8, v9
v_cvt_pk_bf16_f32 v153, v10, v11
v_mfma_f32_16x16x32_bf16 v[44:47], a[180:183], a[20:23], v[44:47]
v_cvt_pk_bf16_f32 v154, v12, v13
v_cvt_pk_bf16_f32 v155, v14, v15
v_mfma_f32_16x16x32_bf16 v[48:51], a[184:187], a[20:23], v[48:51]
v_cvt_pk_bf16_f32 v156, v16, v17
v_cvt_pk_bf16_f32 v157, v18, v19
v_mfma_f32_16x16x32_bf16 v[52:55], a[188:191], a[20:23], v[52:55]
v_cvt_pk_bf16_f32 v158, v20, v21
v_cvt_pk_bf16_f32 v159, v22, v23
v_mfma_f32_16x16x32_bf16 v[56:59], a[192:195], a[20:23], v[56:59]
v_cvt_pk_bf16_f32 v160, v24, v25
v_cvt_pk_bf16_f32 v161, v26, v27
v_mfma_f32_16x16x32_bf16 v[60:63], a[196:199], a[20:23], v[60:63]
v_cvt_pk_bf16_f32 v162, v28, v29
v_cvt_pk_bf16_f32 v163, v30, v31
v_mfma_f32_16x16x32_bf16 v[64:67], a[200:203], a[20:23], v[64:67]
v_cvt_pk_bf16_f32 v164, v32, v33
v_cvt_pk_bf16_f32 v165, v34, v35
v_mfma_f32_16x16x32_bf16 v[68:71], a[204:207], a[20:23], v[68:71]
v_cvt_pk_bf16_f32 v166, v36, v37
v_cvt_pk_bf16_f32 v167, v38, v39
v_mfma_f32_16x16x32_bf16 v[72:75], a[176:179], a[24:27], v[72:75]
v_cvt_pk_bf16_f32 v168, v40, v41
v_cvt_pk_bf16_f32 v169, v42, v43
v_mfma_f32_16x16x32_bf16 v[76:79], a[180:183], a[24:27], v[76:79]
v_cvt_pk_bf16_f32 v170, v44, v45
v_cvt_pk_bf16_f32 v171, v46, v47
v_mfma_f32_16x16x32_bf16 v[80:83], a[184:187], a[24:27], v[80:83]
v_cvt_pk_bf16_f32 v172, v48, v49
v_cvt_pk_bf16_f32 v173, v50, v51
v_mfma_f32_16x16x32_bf16 v[84:87], a[188:191], a[24:27], v[84:87]
v_cvt_pk_bf16_f32 v174, v52, v53
v_cvt_pk_bf16_f32 v175, v54, v55
v_mfma_f32_16x16x32_bf16 v[88:91], a[192:195], a[24:27], v[88:91]
v_cvt_pk_bf16_f32 v176, v56, v57
v_cvt_pk_bf16_f32 v177, v58, v59
v_mfma_f32_16x16x32_bf16 v[92:95], a[196:199], a[24:27], v[92:95]
v_cvt_pk_bf16_f32 v178, v60, v61
v_cvt_pk_bf16_f32 v179, v62, v63
v_mfma_f32_16x16x32_bf16 v[96:99], a[200:203], a[24:27], v[96:99]
v_cvt_pk_bf16_f32 v180, v64, v65
v_cvt_pk_bf16_f32 v181, v66, v67
v_mfma_f32_16x16x32_bf16 v[100:103], a[204:207], a[24:27], v[100:103]
v_cvt_pk_bf16_f32 v182, v68, v69
v_cvt_pk_bf16_f32 v183, v70, v71
v_mfma_f32_16x16x32_bf16 v[104:107], a[176:179], a[28:31], v[104:107]
v_cvt_pk_bf16_f32 v184, v72, v73
v_cvt_pk_bf16_f32 v185, v74, v75
v_mfma_f32_16x16x32_bf16 v[108:111], a[180:183], a[28:31], v[108:111]
v_cvt_pk_bf16_f32 v186, v76, v77
v_cvt_pk_bf16_f32 v187, v78, v79
v_mfma_f32_16x16x32_bf16 v[112:115], a[184:187], a[28:31], v[112:115]
v_cvt_pk_bf16_f32 v188, v80, v81
v_cvt_pk_bf16_f32 v189, v82, v83
v_mfma_f32_16x16x32_bf16 v[116:119], a[188:191], a[28:31], v[116:119]
v_cvt_pk_bf16_f32 v190, v84, v85
v_cvt_pk_bf16_f32 v191, v86, v87
v_mfma_f32_16x16x32_bf16 v[120:123], a[192:195], a[28:31], v[120:123]
v_cvt_pk_bf16_f32 v192, v88, v89
v_cvt_pk_bf16_f32 v193, v90, v91
v_mfma_f32_16x16x32_bf16 v[124:127], a[196:199], a[28:31], v[124:127]
v_cvt_pk_bf16_f32 v194, v92, v93
v_cvt_pk_bf16_f32 v195, v94, v95
v_mfma_f32_16x16x32_bf16 v[128:131], a[200:203], a[28:31], v[128:131]
v_cvt_pk_bf16_f32 v196, v96, v97
v_cvt_pk_bf16_f32 v197, v98, v99
v_mfma_f32_16x16x32_bf16 v[132:135], a[204:207], a[28:31], v[132:135]
v_cvt_pk_bf16_f32 v198, v100, v101
v_cvt_pk_bf16_f32 v199, v102, v103
s_waitcnt lgkmcnt(7)
v_mfma_f32_16x16x32_bf16 v[8:11], a[144:147], v[152:155], 0
v_cvt_pk_bf16_f32 v200, v104, v105
v_cvt_pk_bf16_f32 v201, v106, v107
s_waitcnt lgkmcnt(6)
v_mfma_f32_16x16x32_bf16 v[8:11], a[148:151], v[156:159], v[8:11]
v_cvt_pk_bf16_f32 v202, v108, v109
v_cvt_pk_bf16_f32 v203, v110, v111
s_waitcnt lgkmcnt(5)
v_mfma_f32_16x16x32_bf16 v[8:11], a[152:155], v[160:163], v[8:11]
v_cvt_pk_bf16_f32 v204, v112, v113
v_cvt_pk_bf16_f32 v205, v114, v115
s_waitcnt lgkmcnt(4)
v_mfma_f32_16x16x32_bf16 v[8:11], a[156:159], v[164:167], v[8:11]
v_cvt_pk_bf16_f32 v206, v116, v117
v_cvt_pk_bf16_f32 v207, v118, v119
s_waitcnt lgkmcnt(3)
v_mfma_f32_16x16x32_bf16 v[12:15], a[160:163], v[152:155], 0
v_cvt_pk_bf16_f32 v208, v120, v121
v_cvt_pk_bf16_f32 v209, v122, v123
s_waitcnt lgkmcnt(2)
v_mfma_f32_16x16x32_bf16 v[12:15], a[164:167], v[156:159], v[12:15]
v_cvt_pk_bf16_f32 v210, v124, v125
v_cvt_pk_bf16_f32 v211, v126, v127
s_waitcnt lgkmcnt(1)
v_mfma_f32_16x16x32_bf16 v[12:15], a[168:171], v[160:163], v[12:15]
v_cvt_pk_bf16_f32 v212, v128, v129
v_cvt_pk_bf16_f32 v213, v130, v131
s_waitcnt lgkmcnt(0)
v_mfma_f32_16x16x32_bf16 v[12:15], a[172:175], v[164:167], v[12:15]
v_cvt_pk_bf16_f32 v214, v132, v133
v_cvt_pk_bf16_f32 v215, v134, v135
v_mfma_f32_16x16x32_bf16 v[16:19], a[144:147], v[168:171], 0
buffer_load_dwordx4 v228, s[8:11], s32 offen offset:0  lds
v_mfma_f32_16x16x32_bf16 v[16:19], a[148:151], v[172:175], v[16:19]
buffer_load_dwordx4 v229, s[8:11], s32 offen offset:1024  lds
STUB_3:
STUB_A3:
s_cbranch_execz STUB_6
v_mfma_f32_16x16x32_bf16 v[16:19], a[152:155], v[176:179], v[16:19]
buffer_load_dwordx4 v230, s[8:11], s32 offen offset:2048  lds
v_mfma_f32_16x16x32_bf16 v[16:19], a[156:159], v[180:183], v[16:19]
buffer_load_dwordx4 v231, s[8:11], s32 offen offset:3072  lds
v_max3_f32 v248, v8, v9, v10
v_mfma_f32_16x16x32_bf16 v[20:23], a[160:163], v[168:171], 0
s_add_u32 s39, s7, 16384
s_add_u32 m0, s30, 147456
v_mfma_f32_16x16x32_bf16 v[20:23], a[164:167], v[172:175], v[20:23]
buffer_load_dwordx4 v232, s[12:15], s39 offen offset:0  lds
v_mfma_f32_16x16x32_bf16 v[20:23], a[168:171], v[176:179], v[20:23]
buffer_load_dwordx4 v233, s[12:15], s39 offen offset:1024  lds
v_mfma_f32_16x16x32_bf16 v[20:23], a[172:175], v[180:183], v[20:23]
v_max3_f32 v248, v248, v11, v12
v_max3_f32 v248, v248, v13, v14
v_mfma_f32_16x16x32_bf16 v[24:27], a[144:147], v[184:187], 0
v_max_f32 v248, v248, v15
v_mov_b32 v249, v248
v_mfma_f32_16x16x32_bf16 v[24:27], a[148:151], v[188:191], v[24:27]
s_nop 0
v_permlane16_swap_b32 v248, v249
v_mfma_f32_16x16x32_bf16 v[24:27], a[152:155], v[192:195], v[24:27]
v_max_f32 v248, v248, v249
v_mov_b32 v249, v248
v_mfma_f32_16x16x32_bf16 v[24:27], a[156:159], v[196:199], v[24:27]
s_nop 0
v_permlane32_swap_b32 v248, v249
v_mfma_f32_16x16x32_bf16 v[28:31], a[160:163], v[184:187], 0
v_max_f32 v248, v248, v249
v_sub_f32 v136, 0, v248
v_sub_f32 v137, 0, v248
v_mfma_f32_16x16x32_bf16 v[28:31], a[164:167], v[188:191], v[28:31]
v_sub_f32 v138, 0, v248
v_sub_f32 v139, 0, v248
v_sub_f32 v8, v8, v248
v_mfma_f32_16x16x32_bf16 v[28:31], a[168:171], v[192:195], v[28:31]
v_sub_f32 v9, v9, v248
v_sub_f32 v10, v10, v248
v_sub_f32 v11, v11, v248
v_mfma_f32_16x16x32_bf16 v[28:31], a[172:175], v[196:199], v[28:31]
v_sub_f32 v12, v12, v248
v_sub_f32 v13, v13, v248
v_sub_f32 v14, v14, v248
v_mfma_f32_16x16x32_bf16 v[32:35], a[144:147], v[200:203], 0
v_sub_f32 v15, v15, v248
v_max3_f32 v250, v16, v17, v18
v_max3_f32 v250, v250, v19, v20
v_mfma_f32_16x16x32_bf16 v[32:35], a[148:151], v[204:207], v[32:35]
v_max3_f32 v250, v250, v21, v22
v_max_f32 v250, v250, v23
v_mov_b32 v251, v250
v_mfma_f32_16x16x32_bf16 v[32:35], a[152:155], v[208:211], v[32:35]
s_nop 0
v_permlane16_swap_b32 v250, v251
v_max_f32 v250, v250, v251
v_mfma_f32_16x16x32_bf16 v[32:35], a[156:159], v[212:215], v[32:35]
v_mov_b32 v251, v250
s_nop 1
v_permlane32_swap_b32 v250, v251
v_mfma_f32_16x16x32_bf16 v[36:39], a[160:163], v[200:203], 0
v_max_f32 v250, v250, v251
v_sub_f32 v140, 0, v250
v_sub_f32 v141, 0, v250
v_mfma_f32_16x16x32_bf16 v[36:39], a[164:167], v[204:207], v[36:39]
v_sub_f32 v142, 0, v250
v_sub_f32 v143, 0, v250
v_sub_f32 v16, v16, v250
v_mfma_f32_16x16x32_bf16 v[36:39], a[168:171], v[208:211], v[36:39]
v_sub_f32 v17, v17, v250
v_sub_f32 v18, v18, v250
v_sub_f32 v19, v19, v250
v_mfma_f32_16x16x32_bf16 v[36:39], a[172:175], v[212:215], v[36:39]
v_sub_f32 v20, v20, v250
v_sub_f32 v21, v21, v250
v_sub_f32 v22, v22, v250
ds_read_b128 a[144:147], v216 offset:24576
ds_read_b128 a[148:151], v217 offset:24576
ds_read_b128 a[152:155], v218 offset:24576
ds_read_b128 a[156:159], v219 offset:24576
ds_read_b128 a[160:163], v216 offset:28672
ds_read_b128 a[164:167], v217 offset:28672
ds_read_b128 a[168:171], v218 offset:28672
ds_read_b128 a[172:175], v219 offset:28672
buffer_load_dwordx4 v232, s[12:15], s39 offen offset:2048  lds
buffer_load_dwordx4 v233, s[12:15], s39 offen offset:3072  lds
s_add_u32 s32, s7, 32768
s_add_u32 s39, s7, 16384
v_sub_f32 v23, v23, v250
v_max3_f32 v248, v24, v25, v26
v_max3_f32 v248, v248, v27, v28
v_max3_f32 v248, v248, v29, v30
v_max_f32 v248, v248, v31
s_nop 3
v_max3_f32 v250, v32, v33, v34
v_max3_f32 v250, v250, v35, v36
v_max3_f32 v250, v250, v37, v38
v_max_f32 v250, v250, v39
v_mov_b32 v249, v248
v_mov_b32 v251, v250
s_nop 0
v_permlane16_swap_b32 v248, v249
v_permlane16_swap_b32 v250, v251
v_max_f32 v248, v248, v249
v_max_f32 v250, v250, v251
v_mov_b32 v249, v248
v_mov_b32 v251, v250
s_nop 0
v_permlane32_swap_b32 v248, v249
v_permlane32_swap_b32 v250, v251
v_max_f32 v248, v248, v249
v_max_f32 v250, v250, v251
v_sub_f32 v144, 0, v248
v_sub_f32 v148, 0, v250
v_sub_f32 v145, 0, v248
v_sub_f32 v149, 0, v250
v_sub_f32 v146, 0, v248
v_sub_f32 v150, 0, v250
v_sub_f32 v147, 0, v248
v_sub_f32 v151, 0, v250
v_sub_f32 v24, v24, v248
v_sub_f32 v32, v32, v250
v_sub_f32 v25, v25, v248
v_sub_f32 v33, v33, v250
v_sub_f32 v26, v26, v248
v_sub_f32 v34, v34, v250
v_sub_f32 v27, v27, v248
v_sub_f32 v35, v35, v250
v_sub_f32 v28, v28, v248
v_sub_f32 v36, v36, v250
v_sub_f32 v29, v29, v248
v_sub_f32 v37, v37, v250
v_sub_f32 v30, v30, v248
v_sub_f32 v38, v38, v250
v_sub_f32 v31, v31, v248
v_sub_f32 v39, v39, v250
K_BODY0:
s_waitcnt lgkmcnt(7)
v_mfma_f32_16x16x32_bf16 v[40:43], a[144:147], v[152:155], v[136:139]
v_exp_f32 v8, v8
v_exp_f32 v9, v9
s_waitcnt lgkmcnt(6)
v_mfma_f32_16x16x32_bf16 v[40:43], a[148:151], v[156:159], v[40:43]
v_cvt_pk_bf16_f32 v72, v8, v9
v_exp_f32 v10, v10
s_waitcnt lgkmcnt(5)
v_mfma_f32_16x16x32_bf16 v[40:43], a[152:155], v[160:163], v[40:43]
v_exp_f32 v11, v11
s_waitcnt lgkmcnt(4)
v_mfma_f32_16x16x32_bf16 v[40:43], a[156:159], v[164:167], v[40:43]
v_cvt_pk_bf16_f32 v73, v10, v11
v_exp_f32 v12, v12
v_mfma_f32_16x16x32_bf16 v[48:51], a[156:159], v[180:183], v[140:143]
v_exp_f32 v13, v13
v_mfma_f32_16x16x32_bf16 v[48:51], a[152:155], v[176:179], v[48:51]
v_cvt_pk_bf16_f32 v74, v12, v13
v_exp_f32 v14, v14
v_mfma_f32_16x16x32_bf16 v[48:51], a[148:151], v[172:175], v[48:51]
v_exp_f32 v15, v15
v_mfma_f32_16x16x32_bf16 v[48:51], a[144:147], v[168:171], v[48:51]
v_exp_f32 v16, v16
v_exp_f32 v17, v17
v_mfma_f32_16x16x32_bf16 v[56:59], a[144:147], v[184:187], v[144:147]
v_cvt_pk_bf16_f32 v75, v14, v15
v_cvt_pk_bf16_f32 v76, v16, v17
v_exp_f32 v18, v18
v_mfma_f32_16x16x32_bf16 v[56:59], a[148:151], v[188:191], v[56:59]
v_exp_f32 v19, v19
v_mfma_f32_16x16x32_bf16 v[56:59], a[152:155], v[192:195], v[56:59]
v_cvt_pk_bf16_f32 v77, v18, v19
v_exp_f32 v20, v20
v_mfma_f32_16x16x32_bf16 v[56:59], a[156:159], v[196:199], v[56:59]
v_exp_f32 v21, v21
v_mfma_f32_16x16x32_bf16 v[64:67], a[156:159], v[212:215], v[148:151]
s_waitcnt vmcnt(8) lgkmcnt(0)
s_barrier
v_exp_f32 v22, v22
v_mfma_f32_16x16x32_bf16 v[64:67], a[152:155], v[208:211], v[64:67]
ds_read_b64_tr_b16 a[176:177], v220 offset:32768
v_cvt_pk_bf16_f32 v78, v20, v21
v_exp_f32 v23, v23
v_mfma_f32_16x16x32_bf16 v[64:67], a[148:151], v[204:207], v[64:67]
v_exp_f32 v24, v24
v_exp_f32 v25, v25
v_mfma_f32_16x16x32_bf16 v[64:67], a[144:147], v[200:203], v[64:67]
v_cvt_pk_bf16_f32 v79, v22, v23
v_cvt_pk_bf16_f32 v80, v24, v25
v_exp_f32 v26, v26
v_mfma_f32_16x16x32_bf16 v[44:47], a[160:163], v[152:155], v[136:139]
ds_read_b64_tr_b16 a[178:179], v220 offset:36864
ds_read_b64_tr_b16 a[180:181], v221 offset:32768
v_exp_f32 v27, v27
v_mfma_f32_16x16x32_bf16 v[44:47], a[164:167], v[156:159], v[44:47]
ds_read_b64_tr_b16 a[182:183], v221 offset:36864
v_cvt_pk_bf16_f32 v81, v26, v27
v_exp_f32 v28, v28
v_mfma_f32_16x16x32_bf16 v[44:47], a[168:171], v[160:163], v[44:47]
ds_read_b64_tr_b16 a[184:185], v222 offset:32768
ds_read_b64_tr_b16 a[186:187], v222 offset:36864
v_exp_f32 v29, v29
v_mfma_f32_16x16x32_bf16 v[44:47], a[172:175], v[164:167], v[44:47]
ds_read_b64_tr_b16 a[188:189], v223 offset:32768
v_cvt_pk_bf16_f32 v82, v28, v29
v_exp_f32 v30, v30
v_mfma_f32_16x16x32_bf16 v[52:55], a[172:175], v[180:183], v[140:143]
ds_read_b64_tr_b16 a[190:191], v223 offset:36864
ds_read_b128 a[156:159], v219 offset:49152
v_exp_f32 v31, v31
v_mfma_f32_16x16x32_bf16 v[52:55], a[168:171], v[176:179], v[52:55]
v_exp_f32 v32, v32
v_exp_f32 v33, v33
v_mfma_f32_16x16x32_bf16 v[52:55], a[164:167], v[172:175], v[52:55]
v_cvt_pk_bf16_f32 v83, v30, v31
v_cvt_pk_bf16_f32 v84, v32, v33
v_exp_f32 v34, v34
v_mfma_f32_16x16x32_bf16 v[52:55], a[160:163], v[168:171], v[52:55]
ds_read_b64_tr_b16 a[192:193], v224 offset:32768
ds_read_b64_tr_b16 a[194:195], v224 offset:36864
v_exp_f32 v35, v35
v_mfma_f32_16x16x32_bf16 v[60:63], a[160:163], v[184:187], v[144:147]
ds_read_b128 a[152:155], v218 offset:49152
v_cvt_pk_bf16_f32 v85, v34, v35
v_exp_f32 v36, v36
v_mfma_f32_16x16x32_bf16 v[60:63], a[164:167], v[188:191], v[60:63]
ds_read_b128 a[148:151], v217 offset:49152
ds_read_b128 a[144:147], v216 offset:49152
v_exp_f32 v37, v37
v_mfma_f32_16x16x32_bf16 v[60:63], a[168:171], v[192:195], v[60:63]
ds_read_b64_tr_b16 a[196:197], v225 offset:32768
v_cvt_pk_bf16_f32 v86, v36, v37
v_exp_f32 v38, v38
v_mfma_f32_16x16x32_bf16 v[60:63], a[172:175], v[196:199], v[60:63]
ds_read_b64_tr_b16 a[198:199], v225 offset:36864
ds_read_b64_tr_b16 a[200:201], v226 offset:32768
v_exp_f32 v39, v39
v_mfma_f32_16x16x32_bf16 v[68:71], a[172:175], v[212:215], v[148:151]
ds_read_b64_tr_b16 a[202:203], v226 offset:36864
ds_read_b64_tr_b16 a[204:205], v227 offset:32768
ds_read_b64_tr_b16 a[206:207], v227 offset:36864
v_cvt_pk_bf16_f32 v87, v38, v39
v_mfma_f32_16x16x32_bf16 v[68:71], a[168:171], v[208:211], v[68:71]
ds_read_b128 a[172:175], v219 offset:53248
ds_read_b128 a[168:171], v218 offset:53248
s_add_u32 s32, s32, 16384
s_add_u32 m0, s30, 81920
v_mfma_f32_16x16x32_bf16 v[68:71], a[164:167], v[204:207], v[68:71]
ds_read_b128 a[164:167], v217 offset:53248
buffer_load_dwordx4 v228, s[8:11], s32 offen offset:0  lds
v_mfma_f32_16x16x32_bf16 v[68:71], a[160:163], v[200:203], v[68:71]
ds_read_b128 a[160:163], v216 offset:53248
buffer_load_dwordx4 v229, s[8:11], s32 offen offset:1024  lds
buffer_load_dwordx4 v230, s[8:11], s32 offen offset:2048  lds
buffer_load_dwordx4 v231, s[8:11], s32 offen offset:3072  lds
buffer_store_byte v255, v254, s[24:27], 0 offen sc0 sc1
s_waitcnt lgkmcnt(8)
v_mfma_f32_16x16x32_bf16 v[8:11], a[144:147], v[152:155], v[136:139]
ds_read_b64_tr_b16 a[212:213], v220 offset:40960
v_exp_f32 v40, v40
v_mfma_f32_16x16x32_bf16 v[8:11], a[148:151], v[156:159], v[8:11]
ds_read_b64_tr_b16 a[214:215], v220 offset:45056
v_exp_f32 v41, v41
v_mfma_f32_16x16x32_bf16 v[8:11], a[152:155], v[160:163], v[8:11]
v_cvt_pk_bf16_f32 v88, v40, v41
v_exp_f32 v42, v42
v_mfma_f32_16x16x32_bf16 v[8:11], a[156:159], v[164:167], v[8:11]
s_add_u32 s39, s39, 16384
v_mfma_f32_16x16x32_bf16 v[16:19], a[156:159], v[180:183], v[140:143]
v_exp_f32 v43, v43
v_mfma_f32_16x16x32_bf16 v[16:19], a[152:155], v[176:179], v[16:19]
v_cvt_pk_bf16_f32 v89, v42, v43
v_exp_f32 v44, v44
v_mfma_f32_16x16x32_bf16 v[16:19], a[148:151], v[172:175], v[16:19]
ds_read_b64_tr_b16 a[216:217], v221 offset:40960
ds_read_b64_tr_b16 a[218:219], v221 offset:45056
v_mfma_f32_16x16x32_bf16 v[16:19], a[144:147], v[168:171], v[16:19]
v_exp_f32 v45, v45
v_mfma_f32_16x16x32_bf16 v[24:27], a[144:147], v[184:187], v[144:147]
v_cvt_pk_bf16_f32 v90, v44, v45
v_exp_f32 v46, v46
v_mfma_f32_16x16x32_bf16 v[24:27], a[148:151], v[188:191], v[24:27]
s_add_u32 m0, s30, 98304
v_mfma_f32_16x16x32_bf16 v[24:27], a[152:155], v[192:195], v[24:27]
ds_read_b64_tr_b16 a[220:221], v222 offset:40960
v_exp_f32 v47, v47
v_mfma_f32_16x16x32_bf16 v[24:27], a[156:159], v[196:199], v[24:27]
v_cvt_pk_bf16_f32 v91, v46, v47
v_exp_f32 v48, v48
v_mfma_f32_16x16x32_bf16 v[32:35], a[156:159], v[212:215], v[148:151]
ds_read_b64_tr_b16 a[222:223], v222 offset:45056
v_exp_f32 v49, v49
v_mfma_f32_16x16x32_bf16 v[32:35], a[152:155], v[208:211], v[32:35]
ds_read_b128 a[156:159], v219 offset:57344
ds_read_b128 a[152:155], v218 offset:57344
v_cvt_pk_bf16_f32 v92, v48, v49
v_mfma_f32_16x16x32_bf16 v[32:35], a[148:151], v[204:207], v[32:35]
ds_read_b128 a[148:151], v217 offset:57344
v_exp_f32 v50, v50
v_mfma_f32_16x16x32_bf16 v[32:35], a[144:147], v[200:203], v[32:35]
ds_read_b128 a[144:147], v216 offset:57344
v_exp_f32 v51, v51
v_mfma_f32_16x16x32_bf16 a[8:11], v[80:83], a[176:179], 0
ds_read_b64_tr_b16 a[224:225], v223 offset:40960
ds_read_b64_tr_b16 a[226:227], v223 offset:45056
v_cvt_pk_bf16_f32 v93, v50, v51
v_mfma_f32_16x16x32_bf16 a[12:15], v[84:87], a[176:179], 0
v_exp_f32 v52, v52
v_mfma_f32_16x16x32_bf16 a[28:31], v[84:87], a[180:183], 0
v_exp_f32 v53, v53
v_mfma_f32_16x16x32_bf16 a[24:27], v[80:83], a[180:183], 0
buffer_load_dwordx4 v232, s[12:15], s39 offen offset:0  lds
v_cvt_pk_bf16_f32 v94, v52, v53
v_mfma_f32_16x16x32_bf16 a[40:43], v[80:83], a[184:187], 0
ds_read_b64_tr_b16 a[228:229], v224 offset:40960
v_exp_f32 v54, v54
v_mfma_f32_16x16x32_bf16 a[44:47], v[84:87], a[184:187], 0
ds_read_b64_tr_b16 a[230:231], v224 offset:45056
v_exp_f32 v55, v55
v_mfma_f32_16x16x32_bf16 a[60:63], v[84:87], a[188:191], 0
v_cvt_pk_bf16_f32 v95, v54, v55
v_mfma_f32_16x16x32_bf16 a[56:59], v[80:83], a[188:191], 0
v_exp_f32 v56, v56
v_smfmac_f32_16x16x64_bf16 a[128:131], a[208:211], v[72:79], v245
v_exp_f32 v57, v57
s_waitcnt lgkmcnt(8)
v_mfma_f32_16x16x32_bf16 v[12:15], a[160:163], v[152:155], v[136:139]
v_cvt_pk_bf16_f32 v96, v56, v57
v_exp_f32 v58, v58
v_mfma_f32_16x16x32_bf16 v[12:15], a[164:167], v[156:159], v[12:15]
ds_read_b64_tr_b16 a[232:233], v225 offset:40960
ds_read_b64_tr_b16 a[234:235], v225 offset:45056
v_mfma_f32_16x16x32_bf16 v[12:15], a[168:171], v[160:163], v[12:15]
v_exp_f32 v59, v59
v_mfma_f32_16x16x32_bf16 v[12:15], a[172:175], v[164:167], v[12:15]
v_cvt_pk_bf16_f32 v97, v58, v59
v_exp_f32 v60, v60
v_mfma_f32_16x16x32_bf16 v[20:23], a[172:175], v[180:183], v[140:143]
buffer_load_dwordx4 v233, s[12:15], s39 offen offset:1024  lds
v_mfma_f32_16x16x32_bf16 v[20:23], a[168:171], v[176:179], v[20:23]
ds_read_b64_tr_b16 a[236:237], v226 offset:40960
v_exp_f32 v61, v61
v_mfma_f32_16x16x32_bf16 v[20:23], a[164:167], v[172:175], v[20:23]
v_cvt_pk_bf16_f32 v98, v60, v61
v_exp_f32 v62, v62
v_mfma_f32_16x16x32_bf16 v[20:23], a[160:163], v[168:171], v[20:23]
ds_read_b64_tr_b16 a[238:239], v226 offset:45056
buffer_load_dwordx4 v232, s[12:15], s39 offen offset:2048  lds
v_mfma_f32_16x16x32_bf16 v[28:31], a[160:163], v[184:187], v[144:147]
v_exp_f32 v63, v63
v_mfma_f32_16x16x32_bf16 v[28:31], a[164:167], v[188:191], v[28:31]
v_cvt_pk_bf16_f32 v99, v62, v63
v_exp_f32 v64, v64
v_mfma_f32_16x16x32_bf16 v[28:31], a[168:171], v[192:195], v[28:31]
ds_read_b64_tr_b16 a[240:241], v227 offset:40960
v_exp_f32 v65, v65
v_mfma_f32_16x16x32_bf16 v[28:31], a[172:175], v[196:199], v[28:31]
ds_read_b64_tr_b16 a[242:243], v227 offset:45056
v_cvt_pk_bf16_f32 v100, v64, v65
v_mfma_f32_16x16x32_bf16 v[36:39], a[172:175], v[212:215], v[148:151]
ds_read_b128 a[172:175], v219 offset:61440
v_exp_f32 v66, v66
v_mfma_f32_16x16x32_bf16 v[36:39], a[168:171], v[208:211], v[36:39]
ds_read_b128 a[168:171], v218 offset:61440
v_exp_f32 v67, v67
v_mfma_f32_16x16x32_bf16 v[36:39], a[164:167], v[204:207], v[36:39]
ds_read_b128 a[164:167], v217 offset:61440
v_cvt_pk_bf16_f32 v101, v66, v67
v_mfma_f32_16x16x32_bf16 v[36:39], a[160:163], v[200:203], v[36:39]
ds_read_b128 a[160:163], v216 offset:61440
v_exp_f32 v68, v68
v_mfma_f32_16x16x32_bf16 a[72:75], v[80:83], a[192:195], 0
v_exp_f32 v69, v69
v_mfma_f32_16x16x32_bf16 a[76:79], v[84:87], a[192:195], 0
buffer_load_dwordx4 v233, s[12:15], s39 offen offset:3072  lds
v_cvt_pk_bf16_f32 v102, v68, v69
v_mfma_f32_16x16x32_bf16 a[92:95], v[84:87], a[196:199], 0
v_exp_f32 v70, v70
v_mfma_f32_16x16x32_bf16 a[88:91], v[80:83], a[196:199], 0
v_exp_f32 v71, v71
v_mfma_f32_16x16x32_bf16 a[104:107], v[80:83], a[200:203], 0
v_cvt_pk_bf16_f32 v103, v70, v71
v_mfma_f32_16x16x32_bf16 a[108:111], v[84:87], a[200:203], 0
v_mfma_f32_16x16x32_bf16 a[124:127], v[84:87], a[204:207], 0
v_mfma_f32_16x16x32_bf16 a[120:123], v[80:83], a[204:207], 0
v_smfmac_f32_16x16x64_bf16 a[132:135], a[208:211], v[80:87], v245
s_waitcnt lgkmcnt(8)
v_mfma_f32_16x16x32_bf16 v[40:43], a[144:147], v[152:155], v[136:139]
v_exp_f32 v8, v8
v_mfma_f32_16x16x32_bf16 v[40:43], a[148:151], v[156:159], v[40:43]
v_exp_f32 v9, v9
v_mfma_f32_16x16x32_bf16 v[40:43], a[152:155], v[160:163], v[40:43]
v_cvt_pk_bf16_f32 v104, v8, v9
v_lshlrev_b32 v250, 3, v1
v_mfma_f32_16x16x32_bf16 v[40:43], a[156:159], v[164:167], v[40:43]
v_exp_f32 v10, v10
v_mfma_f32_16x16x32_bf16 v[48:51], a[156:159], v[180:183], v[140:143]
v_mfma_f32_16x16x32_bf16 v[48:51], a[152:155], v[176:179], v[48:51]
v_exp_f32 v11, v11
v_mfma_f32_16x16x32_bf16 v[48:51], a[148:151], v[172:175], v[48:51]
v_cvt_pk_bf16_f32 v105, v10, v11
v_mfma_f32_16x16x32_bf16 v[48:51], a[144:147], v[168:171], v[48:51]
v_exp_f32 v12, v12
v_mfma_f32_16x16x32_bf16 v[56:59], a[144:147], v[184:187], v[144:147]
v_mfma_f32_16x16x32_bf16 v[56:59], a[148:151], v[188:191], v[56:59]
v_exp_f32 v13, v13
v_mfma_f32_16x16x32_bf16 v[56:59], a[152:155], v[192:195], v[56:59]
v_cvt_pk_bf16_f32 v106, v12, v13
v_mfma_f32_16x16x32_bf16 v[56:59], a[156:159], v[196:199], v[56:59]
v_exp_f32 v14, v14
v_mfma_f32_16x16x32_bf16 v[64:67], a[156:159], v[212:215], v[148:151]
s_waitcnt vmcnt(9) lgkmcnt(0)
s_barrier
v_mfma_f32_16x16x32_bf16 v[64:67], a[152:155], v[208:211], v[64:67]
v_exp_f32 v15, v15
v_mfma_f32_16x16x32_bf16 v[64:67], a[148:151], v[204:207], v[64:67]
ds_read_b128 a[156:159], v219 offset:0
v_cvt_pk_bf16_f32 v107, v14, v15
v_mfma_f32_16x16x32_bf16 v[64:67], a[144:147], v[200:203], v[64:67]
v_exp_f32 v16, v16
v_mfma_f32_16x16x32_bf16 a[0:3], v[88:91], a[212:215], 0
ds_read_b128 a[152:155], v218 offset:0
ds_read_b128 a[148:151], v217 offset:0
v_mfma_f32_16x16x32_bf16 a[0:3], v[72:75], a[176:179], a[0:3]
v_exp_f32 v17, v17
v_mfma_f32_16x16x32_bf16 a[4:7], v[76:79], a[176:179], 0
ds_read_b128 a[144:147], v216 offset:0
v_cvt_pk_bf16_f32 v108, v16, v17
v_mfma_f32_16x16x32_bf16 a[4:7], v[92:95], a[212:215], a[4:7]
v_exp_f32 v18, v18
v_mfma_f32_16x16x32_bf16 a[20:23], v[92:95], a[216:219], 0
ds_read_b64_tr_b16 a[176:177], v220 offset:49152
ds_read_b64_tr_b16 a[178:179], v220 offset:53248
v_mfma_f32_16x16x32_bf16 a[20:23], v[76:79], a[180:183], a[20:23]
v_exp_f32 v19, v19
v_mfma_f32_16x16x32_bf16 a[16:19], v[72:75], a[180:183], 0
ds_read_b64_tr_b16 a[180:181], v221 offset:49152
v_cvt_pk_bf16_f32 v109, v18, v19
v_mfma_f32_16x16x32_bf16 a[16:19], v[88:91], a[216:219], a[16:19]
v_exp_f32 v20, v20
v_mfma_f32_16x16x32_bf16 a[32:35], v[88:91], a[220:223], 0
ds_read_b64_tr_b16 a[182:183], v221 offset:53248
s_add_u32 s32, s32, 16384
v_mfma_f32_16x16x32_bf16 a[32:35], v[72:75], a[184:187], a[32:35]
v_exp_f32 v21, v21
v_mfma_f32_16x16x32_bf16 a[36:39], v[76:79], a[184:187], 0
ds_read_b64_tr_b16 a[184:185], v222 offset:49152
v_cvt_pk_bf16_f32 v110, v20, v21
v_mfma_f32_16x16x32_bf16 a[36:39], v[92:95], a[220:223], a[36:39]
v_exp_f32 v22, v22
v_mfma_f32_16x16x32_bf16 a[52:55], v[92:95], a[224:227], 0
ds_read_b64_tr_b16 a[186:187], v222 offset:53248
s_add_u32 m0, s30, 114688
v_mfma_f32_16x16x32_bf16 a[52:55], v[76:79], a[188:191], a[52:55]
v_exp_f32 v23, v23
v_mfma_f32_16x16x32_bf16 a[48:51], v[72:75], a[188:191], 0
ds_read_b64_tr_b16 a[188:189], v223 offset:49152
v_cvt_pk_bf16_f32 v111, v22, v23
v_mfma_f32_16x16x32_bf16 a[48:51], v[88:91], a[224:227], a[48:51]
v_exp_f32 v24, v24
v_smfmac_f32_16x16x64_bf16 a[128:131], a[208:211], v[88:95], v245
v_exp_f32 v25, v25
v_mfma_f32_16x16x32_bf16 v[44:47], a[160:163], v[152:155], v[136:139]
ds_read_b64_tr_b16 a[190:191], v223 offset:53248
v_cvt_pk_bf16_f32 v112, v24, v25
v_mfma_f32_16x16x32_bf16 v[44:47], a[164:167], v[156:159], v[44:47]
v_exp_f32 v26, v26
v_mfma_f32_16x16x32_bf16 v[44:47], a[168:171], v[160:163], v[44:47]
buffer_load_dwordx4 v228, s[8:11], s32 offen offset:0  lds
v_mfma_f32_16x16x32_bf16 v[44:47], a[172:175], v[164:167], v[44:47]
v_exp_f32 v27, v27
v_mfma_f32_16x16x32_bf16 v[52:55], a[172:175], v[180:183], v[140:143]
v_cvt_pk_bf16_f32 v113, v26, v27
v_mfma_f32_16x16x32_bf16 v[52:55], a[168:171], v[176:179], v[52:55]
v_exp_f32 v28, v28
v_mfma_f32_16x16x32_bf16 v[52:55], a[164:167], v[172:175], v[52:55]
buffer_load_dwordx4 v229, s[8:11], s32 offen offset:1024  lds
v_mfma_f32_16x16x32_bf16 v[52:55], a[160:163], v[168:171], v[52:55]
v_exp_f32 v29, v29
v_mfma_f32_16x16x32_bf16 v[60:63], a[160:163], v[184:187], v[144:147]
v_cvt_pk_bf16_f32 v114, v28, v29
v_mfma_f32_16x16x32_bf16 v[60:63], a[164:167], v[188:191], v[60:63]
v_exp_f32 v30, v30
v_mfma_f32_16x16x32_bf16 v[60:63], a[168:171], v[192:195], v[60:63]
buffer_load_dwordx4 v230, s[8:11], s32 offen offset:2048  lds
v_mfma_f32_16x16x32_bf16 v[60:63], a[172:175], v[196:199], v[60:63]
v_exp_f32 v31, v31
v_mfma_f32_16x16x32_bf16 v[68:71], a[172:175], v[212:215], v[148:151]
ds_read_b128 a[172:175], v219 offset:4096
v_cvt_pk_bf16_f32 v115, v30, v31
v_mfma_f32_16x16x32_bf16 v[68:71], a[168:171], v[208:211], v[68:71]
v_exp_f32 v32, v32
v_mfma_f32_16x16x32_bf16 v[68:71], a[164:167], v[204:207], v[68:71]
ds_read_b128 a[168:171], v218 offset:4096
ds_read_b128 a[164:167], v217 offset:4096
v_mfma_f32_16x16x32_bf16 v[68:71], a[160:163], v[200:203], v[68:71]
v_exp_f32 v33, v33
v_mfma_f32_16x16x32_bf16 a[64:67], v[88:91], a[228:231], 0
ds_read_b128 a[160:163], v216 offset:4096
v_cvt_pk_bf16_f32 v116, v32, v33
v_mfma_f32_16x16x32_bf16 a[64:67], v[72:75], a[192:195], a[64:67]
v_exp_f32 v34, v34
v_mfma_f32_16x16x32_bf16 a[68:71], v[76:79], a[192:195], 0
ds_read_b64_tr_b16 a[192:193], v224 offset:49152
ds_read_b64_tr_b16 a[194:195], v224 offset:53248
v_mfma_f32_16x16x32_bf16 a[68:71], v[92:95], a[228:231], a[68:71]
v_exp_f32 v35, v35
v_mfma_f32_16x16x32_bf16 a[84:87], v[92:95], a[232:235], 0
v_cvt_pk_bf16_f32 v117, v34, v35
v_mfma_f32_16x16x32_bf16 a[84:87], v[76:79], a[196:199], a[84:87]
v_exp_f32 v36, v36
v_mfma_f32_16x16x32_bf16 a[80:83], v[72:75], a[196:199], 0
ds_read_b64_tr_b16 a[196:197], v225 offset:49152
ds_read_b64_tr_b16 a[198:199], v225 offset:53248
v_mfma_f32_16x16x32_bf16 a[80:83], v[88:91], a[232:235], a[80:83]
v_exp_f32 v37, v37
v_mfma_f32_16x16x32_bf16 a[96:99], v[88:91], a[236:239], 0
v_cvt_pk_bf16_f32 v118, v36, v37
v_mfma_f32_16x16x32_bf16 a[96:99], v[72:75], a[200:203], a[96:99]
v_exp_f32 v38, v38
v_mfma_f32_16x16x32_bf16 a[100:103], v[76:79], a[200:203], 0
ds_read_b64_tr_b16 a[200:201], v226 offset:49152
ds_read_b64_tr_b16 a[202:203], v226 offset:53248
v_mfma_f32_16x16x32_bf16 a[100:103], v[92:95], a[236:239], a[100:103]
v_exp_f32 v39, v39
v_mfma_f32_16x16x32_bf16 a[116:119], v[92:95], a[240:243], 0
v_cvt_pk_bf16_f32 v119, v38, v39
v_mfma_f32_16x16x32_bf16 a[116:119], v[76:79], a[204:207], a[116:119]
buffer_load_dwordx4 v231, s[8:11], s32 offen offset:3072  lds
v_mfma_f32_16x16x32_bf16 a[112:115], v[72:75], a[204:207], 0
ds_read_b64_tr_b16 a[204:205], v227 offset:49152
ds_read_b64_tr_b16 a[206:207], v227 offset:53248
v_mfma_f32_16x16x32_bf16 a[112:115], v[88:91], a[240:243], a[112:115]
s_add_u32 m0, s86, 0
s_add_u32 s50, s84, 0
buffer_load_dwordx4 v240, s[64:67], s50 offen lds
v_smfmac_f32_16x16x64_bf16 a[132:135], a[208:211], v[96:103], v245
s_add_u32 m0, s86, 4096
s_add_u32 s50, s84, 589824
buffer_load_dwordx4 v240, s[64:67], s50 offen lds
s_waitcnt lgkmcnt(8)
v_mfma_f32_16x16x32_bf16 v[8:11], a[144:147], v[152:155], v[136:139]
v_exp_f32 v40, v40
v_mfma_f32_16x16x32_bf16 v[8:11], a[148:151], v[156:159], v[8:11]
v_exp_f32 v41, v41
v_mfma_f32_16x16x32_bf16 v[8:11], a[152:155], v[160:163], v[8:11]
v_cvt_pk_bf16_f32 v72, v40, v41
v_mfma_f32_16x16x32_bf16 v[8:11], a[156:159], v[164:167], v[8:11]
v_exp_f32 v42, v42
v_mfma_f32_16x16x32_bf16 v[16:19], a[156:159], v[180:183], v[140:143]
s_add_u32 s39, s39, 16384
v_mfma_f32_16x16x32_bf16 v[16:19], a[152:155], v[176:179], v[16:19]
v_exp_f32 v43, v43
v_mfma_f32_16x16x32_bf16 v[16:19], a[148:151], v[172:175], v[16:19]
v_cvt_pk_bf16_f32 v73, v42, v43
v_mfma_f32_16x16x32_bf16 v[16:19], a[144:147], v[168:171], v[16:19]
v_exp_f32 v44, v44
v_mfma_f32_16x16x32_bf16 v[24:27], a[144:147], v[184:187], v[144:147]
s_mov_b32 s29, 0x242000
buffer_load_dwordx2 v[248:249], v250, s[20:23], s29 offen sc0 sc1
v_mfma_f32_16x16x32_bf16 v[24:27], a[148:151], v[188:191], v[24:27]
v_exp_f32 v45, v45
v_mfma_f32_16x16x32_bf16 v[24:27], a[152:155], v[192:195], v[24:27]
s_add_u32 m0, s30, 131072
v_cvt_pk_bf16_f32 v74, v44, v45
v_mfma_f32_16x16x32_bf16 v[24:27], a[156:159], v[196:199], v[24:27]
v_exp_f32 v46, v46
v_mfma_f32_16x16x32_bf16 v[32:35], a[156:159], v[212:215], v[148:151]
ds_read_b128 a[156:159], v219 offset:8192
v_mfma_f32_16x16x32_bf16 v[32:35], a[152:155], v[208:211], v[32:35]
v_exp_f32 v47, v47
v_mfma_f32_16x16x32_bf16 v[32:35], a[148:151], v[204:207], v[32:35]
ds_read_b128 a[152:155], v218 offset:8192
v_cvt_pk_bf16_f32 v75, v46, v47
v_mfma_f32_16x16x32_bf16 v[32:35], a[144:147], v[200:203], v[32:35]
v_exp_f32 v48, v48
v_mfma_f32_16x16x32_bf16 a[8:11], v[112:115], a[176:179], a[8:11]
ds_read_b128 a[148:151], v217 offset:8192
ds_read_b128 a[144:147], v216 offset:8192
v_mfma_f32_16x16x32_bf16 a[8:11], v[96:99], a[212:215], a[8:11]
v_exp_f32 v49, v49
v_mfma_f32_16x16x32_bf16 a[12:15], v[100:103], a[212:215], a[12:15]
ds_read_b64_tr_b16 a[212:213], v220 offset:57344
v_cvt_pk_bf16_f32 v76, v48, v49
v_mfma_f32_16x16x32_bf16 a[12:15], v[116:119], a[176:179], a[12:15]
v_exp_f32 v50, v50
v_mfma_f32_16x16x32_bf16 a[28:31], v[116:119], a[180:183], a[28:31]
ds_read_b64_tr_b16 a[214:215], v220 offset:61440
v_mfma_f32_16x16x32_bf16 a[28:31], v[100:103], a[216:219], a[28:31]
v_exp_f32 v51, v51
v_mfma_f32_16x16x32_bf16 a[24:27], v[96:99], a[216:219], a[24:27]
ds_read_b64_tr_b16 a[216:217], v221 offset:57344
v_cvt_pk_bf16_f32 v77, v50, v51
v_mfma_f32_16x16x32_bf16 a[24:27], v[112:115], a[180:183], a[24:27]
v_exp_f32 v52, v52
v_mfma_f32_16x16x32_bf16 a[40:43], v[112:115], a[184:187], a[40:43]
ds_read_b64_tr_b16 a[218:219], v221 offset:61440
v_mfma_f32_16x16x32_bf16 a[40:43], v[96:99], a[220:223], a[40:43]
v_exp_f32 v53, v53
v_mfma_f32_16x16x32_bf16 a[44:47], v[100:103], a[220:223], a[44:47]
ds_read_b64_tr_b16 a[220:221], v222 offset:57344
v_cvt_pk_bf16_f32 v78, v52, v53
v_mfma_f32_16x16x32_bf16 a[44:47], v[116:119], a[184:187], a[44:47]
v_exp_f32 v54, v54
v_mfma_f32_16x16x32_bf16 a[60:63], v[116:119], a[188:191], a[60:63]
ds_read_b64_tr_b16 a[222:223], v222 offset:61440
v_mfma_f32_16x16x32_bf16 a[60:63], v[100:103], a[224:227], a[60:63]
v_exp_f32 v55, v55
v_mfma_f32_16x16x32_bf16 a[56:59], v[96:99], a[224:227], a[56:59]
ds_read_b64_tr_b16 a[224:225], v223 offset:57344
v_cvt_pk_bf16_f32 v79, v54, v55
v_mfma_f32_16x16x32_bf16 a[56:59], v[112:115], a[188:191], a[56:59]
v_exp_f32 v56, v56
v_smfmac_f32_16x16x64_bf16 a[128:131], a[208:211], v[104:111], v245
v_exp_f32 v57, v57
v_mfma_f32_16x16x32_bf16 v[12:15], a[160:163], v[152:155], v[136:139]
ds_read_b64_tr_b16 a[226:227], v223 offset:61440
v_cvt_pk_bf16_f32 v80, v56, v57
v_mfma_f32_16x16x32_bf16 v[12:15], a[164:167], v[156:159], v[12:15]
v_exp_f32 v58, v58
v_mfma_f32_16x16x32_bf16 v[12:15], a[168:171], v[160:163], v[12:15]
buffer_load_dwordx4 v232, s[12:15], s39 offen offset:0  lds
STUB_4:
s_cbranch_execz STUB_7
v_mfma_f32_16x16x32_bf16 v[12:15], a[172:175], v[164:167], v[12:15]
v_exp_f32 v59, v59
v_mfma_f32_16x16x32_bf16 v[20:23], a[172:175], v[180:183], v[140:143]
v_cvt_pk_bf16_f32 v81, v58, v59
v_mfma_f32_16x16x32_bf16 v[20:23], a[168:171], v[176:179], v[20:23]
v_exp_f32 v60, v60
v_mfma_f32_16x16x32_bf16 v[20:23], a[164:167], v[172:175], v[20:23]
buffer_load_dwordx4 v233, s[12:15], s39 offen offset:1024  lds
v_mfma_f32_16x16x32_bf16 v[20:23], a[160:163], v[168:171], v[20:23]
v_exp_f32 v61, v61
v_mfma_f32_16x16x32_bf16 v[28:31], a[160:163], v[184:187], v[144:147]
v_cvt_pk_bf16_f32 v82, v60, v61
v_mfma_f32_16x16x32_bf16 v[28:31], a[164:167], v[188:191], v[28:31]
v_exp_f32 v62, v62
v_mfma_f32_16x16x32_bf16 v[28:31], a[168:171], v[192:195], v[28:31]
buffer_load_dwordx4 v232, s[12:15], s39 offen offset:2048  lds
v_mfma_f32_16x16x32_bf16 v[28:31], a[172:175], v[196:199], v[28:31]
v_exp_f32 v63, v63
v_mfma_f32_16x16x32_bf16 v[36:39], a[172:175], v[212:215], v[148:151]
ds_read_b128 a[172:175], v219 offset:12288
v_cvt_pk_bf16_f32 v83, v62, v63
v_mfma_f32_16x16x32_bf16 v[36:39], a[168:171], v[208:211], v[36:39]
v_exp_f32 v64, v64
v_mfma_f32_16x16x32_bf16 v[36:39], a[164:167], v[204:207], v[36:39]
ds_read_b128 a[168:171], v218 offset:12288
ds_read_b128 a[164:167], v217 offset:12288
v_mfma_f32_16x16x32_bf16 v[36:39], a[160:163], v[200:203], v[36:39]
v_exp_f32 v65, v65
s_waitcnt lgkmcnt(8)
v_mfma_f32_16x16x32_bf16 a[72:75], v[112:115], a[192:195], a[72:75]
ds_read_b128 a[160:163], v216 offset:12288
v_cvt_pk_bf16_f32 v84, v64, v65
v_mfma_f32_16x16x32_bf16 a[72:75], v[96:99], a[228:231], a[72:75]
v_exp_f32 v66, v66
v_mfma_f32_16x16x32_bf16 a[76:79], v[100:103], a[228:231], a[76:79]
ds_read_b64_tr_b16 a[228:229], v224 offset:57344
ds_read_b64_tr_b16 a[230:231], v224 offset:61440
v_mfma_f32_16x16x32_bf16 a[76:79], v[116:119], a[192:195], a[76:79]
v_exp_f32 v67, v67
v_mfma_f32_16x16x32_bf16 a[92:95], v[116:119], a[196:199], a[92:95]
v_cvt_pk_bf16_f32 v85, v66, v67
v_mfma_f32_16x16x32_bf16 a[92:95], v[100:103], a[232:235], a[92:95]
v_exp_f32 v68, v68
v_mfma_f32_16x16x32_bf16 a[88:91], v[96:99], a[232:235], a[88:91]
ds_read_b64_tr_b16 a[232:233], v225 offset:57344
ds_read_b64_tr_b16 a[234:235], v225 offset:61440
v_mfma_f32_16x16x32_bf16 a[88:91], v[112:115], a[196:199], a[88:91]
v_exp_f32 v69, v69
v_mfma_f32_16x16x32_bf16 a[104:107], v[112:115], a[200:203], a[104:107]
v_cvt_pk_bf16_f32 v86, v68, v69
v_mfma_f32_16x16x32_bf16 a[104:107], v[96:99], a[236:239], a[104:107]
v_exp_f32 v70, v70
v_mfma_f32_16x16x32_bf16 a[108:111], v[100:103], a[236:239], a[108:111]
ds_read_b64_tr_b16 a[236:237], v226 offset:57344
ds_read_b64_tr_b16 a[238:239], v226 offset:61440
v_mfma_f32_16x16x32_bf16 a[108:111], v[116:119], a[200:203], a[108:111]
v_exp_f32 v71, v71
v_mfma_f32_16x16x32_bf16 a[124:127], v[116:119], a[204:207], a[124:127]
v_cvt_pk_bf16_f32 v87, v70, v71
v_mfma_f32_16x16x32_bf16 a[124:127], v[100:103], a[240:243], a[124:127]
buffer_load_dwordx4 v233, s[12:15], s39 offen offset:3072  lds
v_mfma_f32_16x16x32_bf16 a[120:123], v[96:99], a[240:243], a[120:123]
ds_read_b64_tr_b16 a[240:241], v227 offset:57344
ds_read_b64_tr_b16 a[242:243], v227 offset:61440
v_mfma_f32_16x16x32_bf16 a[120:123], v[112:115], a[204:207], a[120:123]
s_add_u32 m0, s86, 8192
s_add_u32 s50, s84, 1179648
buffer_load_dwordx4 v240, s[64:67], s50 offen lds
v_smfmac_f32_16x16x64_bf16 a[132:135], a[208:211], v[112:119], v245
s_add_u32 m0, s86, 12288
s_add_u32 s50, s84, 1769472
buffer_load_dwordx4 v240, s[64:67], s50 offen lds
s_mov_b32 s33, 9
s_cmp_lt_u32 s86, 0x10000
s_cbranch_scc0 K_LOOPIN
v_mfma_f32_16x16x32_bf16 v[40:43], a[144:147], v[152:155], v[136:139]
v_exp_f32 v8, v8
v_mfma_f32_16x16x32_bf16 v[40:43], a[148:151], v[156:159], v[40:43]
v_bfe_u32 v246, v1, 2, 2
v_lshl_add_u32 v241, v4, 3, v246
v_mfma_f32_16x16x32_bf16 v[40:43], a[152:155], v[160:163], v[40:43]
v_exp_f32 v9, v9
v_mfma_f32_16x16x32_bf16 v[40:43], a[156:159], v[164:167], v[40:43]
v_cvt_pk_bf16_f32 v88, v8, v9
v_lshl_add_u32 v246, v4, 2, v246
v_mfma_f32_16x16x32_bf16 v[48:51], a[156:159], v[180:183], v[140:143]
v_exp_f32 v10, v10
v_mfma_f32_16x16x32_bf16 v[48:51], a[152:155], v[176:179], v[48:51]
v_and_b32 v247, 3, v1
v_lshlrev_b32 v247, 3, v247
v_mfma_f32_16x16x32_bf16 v[48:51], a[148:151], v[172:175], v[48:51]
v_lshl_add_u32 v241, v241, 6, v247
v_mfma_f32_16x16x32_bf16 v[48:51], a[144:147], v[168:171], v[48:51]
v_exp_f32 v11, v11
v_mfma_f32_16x16x32_bf16 v[56:59], a[144:147], v[184:187], v[144:147]
s_and_b32 s28, s37, 1
v_cvt_pk_bf16_f32 v89, v10, v11
v_mfma_f32_16x16x32_bf16 v[56:59], a[148:151], v[188:191], v[56:59]
v_exp_f32 v12, v12
v_mfma_f32_16x16x32_bf16 v[56:59], a[152:155], v[192:195], v[56:59]
s_lshl_b32 s28, s28, 5
s_lshr_b32 s29, s37, 1
v_mfma_f32_16x16x32_bf16 v[56:59], a[156:159], v[196:199], v[56:59]
s_lshl_b32 s29, s29, 15
s_add_u32 s28, s28, s29
v_mfma_f32_16x16x32_bf16 v[64:67], a[156:159], v[212:215], v[148:151]
s_waitcnt vmcnt(13) lgkmcnt(0)
s_barrier
v_mfma_f32_16x16x32_bf16 v[64:67], a[152:155], v[208:211], v[64:67]
v_exp_f32 v13, v13
v_mfma_f32_16x16x32_bf16 v[64:67], a[148:151], v[204:207], v[64:67]
v_exp_f32 v14, v14
v_mfma_f32_16x16x32_bf16 v[64:67], a[144:147], v[200:203], v[64:67]
ds_read_b128 a[156:159], v219 offset:16384
v_cvt_pk_bf16_f32 v90, v12, v13
v_mfma_f32_16x16x32_bf16 a[0:3], v[72:75], a[212:215], a[0:3]
ds_read_b128 a[152:155], v218 offset:16384
ds_read_b128 a[148:151], v217 offset:16384
v_mfma_f32_16x16x32_bf16 a[0:3], v[104:107], a[176:179], a[0:3]
v_exp_f32 v15, v15
v_mfma_f32_16x16x32_bf16 a[4:7], v[108:111], a[176:179], a[4:7]
ds_read_b128 a[144:147], v216 offset:16384
v_cvt_pk_bf16_f32 v91, v14, v15
v_mfma_f32_16x16x32_bf16 a[4:7], v[76:79], a[212:215], a[4:7]
v_exp_f32 v16, v16
v_mfma_f32_16x16x32_bf16 a[8:11], v[80:83], a[212:215], a[8:11]
ds_read_b64_tr_b16 a[176:177], v220 offset:0
ds_read_b64_tr_b16 a[178:179], v220 offset:4096
v_mfma_f32_16x16x32_bf16 a[12:15], v[84:87], a[212:215], a[12:15]
v_exp_f32 v17, v17
v_mfma_f32_16x16x32_bf16 a[28:31], v[84:87], a[216:219], a[28:31]
s_add_u32 s32, s32, 16384
v_cvt_pk_bf16_f32 v92, v16, v17
v_mfma_f32_16x16x32_bf16 a[24:27], v[80:83], a[216:219], a[24:27]
s_add_u32 m0, s30, 65536
v_add_u32 v241, s28, v241
v_mfma_f32_16x16x32_bf16 a[20:23], v[76:79], a[216:219], a[20:23]
v_exp_f32 v18, v18
v_mfma_f32_16x16x32_bf16 a[20:23], v[108:111], a[180:183], a[20:23]
v_mul_u32_u24 v242, 0x480, v246
v_add_u32 v242, v242, v247
v_mfma_f32_16x16x32_bf16 a[16:19], v[104:107], a[180:183], a[16:19]
v_exp_f32 v19, v19
v_mfma_f32_16x16x32_bf16 a[16:19], v[72:75], a[216:219], a[16:19]
ds_read_b64_tr_b16 a[180:181], v221 offset:0
v_cvt_pk_bf16_f32 v93, v18, v19
v_mfma_f32_16x16x32_bf16 a[32:35], v[72:75], a[220:223], a[32:35]
ds_read_b64_tr_b16 a[182:183], v221 offset:4096
s_mul_i32 s28, s37, 288
v_mfma_f32_16x16x32_bf16 a[32:35], v[104:107], a[184:187], a[32:35]
v_exp_f32 v20, v20
v_mfma_f32_16x16x32_bf16 a[36:39], v[108:111], a[184:187], a[36:39]
ds_read_b64_tr_b16 a[184:185], v222 offset:0
ds_read_b64_tr_b16 a[186:187], v222 offset:4096
v_mfma_f32_16x16x32_bf16 a[36:39], v[76:79], a[220:223], a[36:39]
v_exp_f32 v21, v21
v_mfma_f32_16x16x32_bf16 a[40:43], v[80:83], a[220:223], a[40:43]
s_add_u32 s28, s28, 8192
v_cvt_pk_bf16_f32 v94, v20, v21
v_mfma_f32_16x16x32_bf16 a[44:47], v[84:87], a[220:223], a[44:47]
buffer_load_dwordx4 v228, s[8:11], s32 offen offset:0  lds
v_mfma_f32_16x16x32_bf16 a[60:63], v[84:87], a[224:227], a[60:63]
v_exp_f32 v22, v22
v_mfma_f32_16x16x32_bf16 a[56:59], v[80:83], a[224:227], a[56:59]
v_add_u32 v242, s28, v242
v_mfma_f32_16x16x32_bf16 a[52:55], v[76:79], a[224:227], a[52:55]
v_exp_f32 v23, v23
v_mfma_f32_16x16x32_bf16 a[52:55], v[108:111], a[188:191], a[52:55]
v_cvt_pk_bf16_f32 v95, v22, v23
v_mfma_f32_16x16x32_bf16 a[48:51], v[104:107], a[188:191], a[48:51]
ds_read_b64_tr_b16 a[188:189], v223 offset:0
ds_read_b64_tr_b16 a[190:191], v223 offset:4096
v_mfma_f32_16x16x32_bf16 a[48:51], v[72:75], a[224:227], a[48:51]
v_exp_f32 v24, v24
v_smfmac_f32_16x16x64_bf16 a[128:131], a[208:211], v[72:79], v245
buffer_load_dwordx4 v229, s[8:11], s32 offen offset:1024  lds
v_mfma_f32_16x16x32_bf16 v[44:47], a[160:163], v[152:155], v[136:139]
v_exp_f32 v25, v25
v_mfma_f32_16x16x32_bf16 v[44:47], a[164:167], v[156:159], v[44:47]
v_cvt_pk_bf16_f32 v96, v24, v25
v_mfma_f32_16x16x32_bf16 v[44:47], a[168:171], v[160:163], v[44:47]
v_exp_f32 v26, v26
v_mfma_f32_16x16x32_bf16 v[44:47], a[172:175], v[164:167], v[44:47]
v_mfma_f32_16x16x32_bf16 v[52:55], a[172:175], v[180:183], v[140:143]
buffer_load_dwordx4 v230, s[8:11], s32 offen offset:2048  lds
v_mfma_f32_16x16x32_bf16 v[52:55], a[168:171], v[176:179], v[52:55]
v_exp_f32 v27, v27
v_mfma_f32_16x16x32_bf16 v[52:55], a[164:167], v[172:175], v[52:55]
v_cvt_pk_bf16_f32 v97, v26, v27
v_mfma_f32_16x16x32_bf16 v[52:55], a[160:163], v[168:171], v[52:55]
v_exp_f32 v28, v28
v_mfma_f32_16x16x32_bf16 v[60:63], a[160:163], v[184:187], v[144:147]
v_mfma_f32_16x16x32_bf16 v[60:63], a[164:167], v[188:191], v[60:63]
v_mfma_f32_16x16x32_bf16 v[60:63], a[168:171], v[192:195], v[60:63]
v_exp_f32 v29, v29
v_mfma_f32_16x16x32_bf16 v[60:63], a[172:175], v[196:199], v[60:63]
v_cvt_pk_bf16_f32 v98, v28, v29
v_mfma_f32_16x16x32_bf16 v[68:71], a[172:175], v[212:215], v[148:151]
v_exp_f32 v30, v30
v_mfma_f32_16x16x32_bf16 v[68:71], a[168:171], v[208:211], v[68:71]
ds_read_b128 a[172:175], v219 offset:20480
ds_read_b128 a[168:171], v218 offset:20480
v_mfma_f32_16x16x32_bf16 v[68:71], a[164:167], v[204:207], v[68:71]
ds_read_b128 a[164:167], v217 offset:20480
v_mfma_f32_16x16x32_bf16 v[68:71], a[160:163], v[200:203], v[68:71]
v_exp_f32 v31, v31
v_mfma_f32_16x16x32_bf16 a[64:67], v[72:75], a[228:231], a[64:67]
ds_read_b128 a[160:163], v216 offset:20480
v_cvt_pk_bf16_f32 v99, v30, v31
v_mfma_f32_16x16x32_bf16 a[64:67], v[104:107], a[192:195], a[64:67]
v_exp_f32 v32, v32
v_mfma_f32_16x16x32_bf16 a[68:71], v[108:111], a[192:195], a[68:71]
ds_read_b64_tr_b16 a[192:193], v224 offset:0
ds_read_b64_tr_b16 a[194:195], v224 offset:4096
v_mfma_f32_16x16x32_bf16 a[68:71], v[76:79], a[228:231], a[68:71]
v_exp_f32 v33, v33
v_mfma_f32_16x16x32_bf16 a[72:75], v[80:83], a[228:231], a[72:75]
v_cvt_pk_bf16_f32 v100, v32, v33
v_mfma_f32_16x16x32_bf16 a[76:79], v[84:87], a[228:231], a[76:79]
buffer_load_dwordx4 v231, s[8:11], s32 offen offset:3072  lds
v_mfma_f32_16x16x32_bf16 a[92:95], v[84:87], a[232:235], a[92:95]
v_exp_f32 v34, v34
v_mfma_f32_16x16x32_bf16 a[88:91], v[80:83], a[232:235], a[88:91]
s_add_u32 m0, s86, 16384
s_add_u32 s50, s84, 2359296
buffer_load_dwordx4 v240, s[64:67], s50 offen lds
v_mfma_f32_16x16x32_bf16 a[84:87], v[76:79], a[232:235], a[84:87]
v_exp_f32 v35, v35
v_mfma_f32_16x16x32_bf16 a[84:87], v[108:111], a[196:199], a[84:87]
v_cvt_pk_bf16_f32 v101, v34, v35
v_mfma_f32_16x16x32_bf16 a[80:83], v[104:107], a[196:199], a[80:83]
ds_read_b64_tr_b16 a[196:197], v225 offset:0
ds_read_b64_tr_b16 a[198:199], v225 offset:4096
v_mfma_f32_16x16x32_bf16 a[80:83], v[72:75], a[232:235], a[80:83]
v_exp_f32 v36, v36
v_mfma_f32_16x16x32_bf16 a[96:99], v[72:75], a[236:239], a[96:99]
s_add_u32 m0, s86, 20480
s_add_u32 s50, s84, 2949120
buffer_load_dwordx4 v240, s[64:67], s50 offen lds
v_mfma_f32_16x16x32_bf16 a[96:99], v[104:107], a[200:203], a[96:99]
v_exp_f32 v37, v37
v_mfma_f32_16x16x32_bf16 a[100:103], v[108:111], a[200:203], a[100:103]
ds_read_b64_tr_b16 a[200:201], v226 offset:0
v_cvt_pk_bf16_f32 v102, v36, v37
v_mfma_f32_16x16x32_bf16 a[100:103], v[76:79], a[236:239], a[100:103]
ds_read_b64_tr_b16 a[202:203], v226 offset:4096
v_mfma_f32_16x16x32_bf16 a[104:107], v[80:83], a[236:239], a[104:107]
v_exp_f32 v38, v38
v_mfma_f32_16x16x32_bf16 a[108:111], v[84:87], a[236:239], a[108:111]
v_mfma_f32_16x16x32_bf16 a[124:127], v[84:87], a[240:243], a[124:127]
v_exp_f32 v39, v39
v_mfma_f32_16x16x32_bf16 a[120:123], v[80:83], a[240:243], a[120:123]
v_cvt_pk_bf16_f32 v103, v38, v39
v_mfma_f32_16x16x32_bf16 a[116:119], v[76:79], a[240:243], a[116:119]
v_mfma_f32_16x16x32_bf16 a[116:119], v[108:111], a[204:207], a[116:119]
v_mfma_f32_16x16x32_bf16 a[112:115], v[104:107], a[204:207], a[112:115]
ds_read_b64_tr_b16 a[204:205], v227 offset:0
ds_read_b64_tr_b16 a[206:207], v227 offset:4096
v_mfma_f32_16x16x32_bf16 a[112:115], v[72:75], a[240:243], a[112:115]
v_smfmac_f32_16x16x64_bf16 a[132:135], a[208:211], v[80:87], v245
s_waitcnt lgkmcnt(8)
v_mfma_f32_16x16x32_bf16 v[8:11], a[144:147], v[152:155], v[136:139]
v_exp_f32 v40, v40
v_mfma_f32_16x16x32_bf16 v[8:11], a[148:151], v[156:159], v[8:11]
v_exp_f32 v41, v41
v_mfma_f32_16x16x32_bf16 v[8:11], a[152:155], v[160:163], v[8:11]
v_cvt_pk_bf16_f32 v72, v40, v41
v_mfma_f32_16x16x32_bf16 v[8:11], a[156:159], v[164:167], v[8:11]
v_exp_f32 v42, v42
v_mfma_f32_16x16x32_bf16 v[16:19], a[156:159], v[180:183], v[140:143]
s_add_u32 s39, s39, 16384
v_mfma_f32_16x16x32_bf16 v[16:19], a[152:155], v[176:179], v[16:19]
v_exp_f32 v43, v43
v_mfma_f32_16x16x32_bf16 v[16:19], a[148:151], v[172:175], v[16:19]
v_cvt_pk_bf16_f32 v73, v42, v43
v_mfma_f32_16x16x32_bf16 v[16:19], a[144:147], v[168:171], v[16:19]
v_exp_f32 v44, v44
v_mfma_f32_16x16x32_bf16 v[24:27], a[144:147], v[184:187], v[144:147]
v_mfma_f32_16x16x32_bf16 v[24:27], a[148:151], v[188:191], v[24:27]
v_exp_f32 v45, v45
v_mfma_f32_16x16x32_bf16 v[24:27], a[152:155], v[192:195], v[24:27]
s_add_u32 m0, s30, 147456
v_cvt_pk_bf16_f32 v74, v44, v45
v_mfma_f32_16x16x32_bf16 v[24:27], a[156:159], v[196:199], v[24:27]
v_exp_f32 v46, v46
v_mfma_f32_16x16x32_bf16 v[32:35], a[156:159], v[212:215], v[148:151]
ds_read_b128 a[156:159], v219 offset:24576
v_mfma_f32_16x16x32_bf16 v[32:35], a[152:155], v[208:211], v[32:35]
v_exp_f32 v47, v47
v_mfma_f32_16x16x32_bf16 v[32:35], a[148:151], v[204:207], v[32:35]
ds_read_b128 a[152:155], v218 offset:24576
v_cvt_pk_bf16_f32 v75, v46, v47
v_mfma_f32_16x16x32_bf16 v[32:35], a[144:147], v[200:203], v[32:35]
v_exp_f32 v48, v48
v_mfma_f32_16x16x32_bf16 a[0:3], v[88:91], a[176:179], a[0:3]
ds_read_b128 a[148:151], v217 offset:24576
ds_read_b128 a[144:147], v216 offset:24576
v_mfma_f32_16x16x32_bf16 a[4:7], v[92:95], a[176:179], a[4:7]
v_exp_f32 v49, v49
v_mfma_f32_16x16x32_bf16 a[8:11], v[96:99], a[176:179], a[8:11]
v_cvt_pk_bf16_f32 v76, v48, v49
v_mfma_f32_16x16x32_bf16 a[12:15], v[100:103], a[176:179], a[12:15]
v_exp_f32 v50, v50
v_mfma_f32_16x16x32_bf16 a[28:31], v[100:103], a[180:183], a[28:31]
ds_read_b64_tr_b16 a[176:177], v220 offset:8192
ds_read_b64_tr_b16 a[178:179], v220 offset:12288
v_mfma_f32_16x16x32_bf16 a[24:27], v[96:99], a[180:183], a[24:27]
v_exp_f32 v51, v51
v_mfma_f32_16x16x32_bf16 a[20:23], v[92:95], a[180:183], a[20:23]
v_cvt_pk_bf16_f32 v77, v50, v51
v_mfma_f32_16x16x32_bf16 a[16:19], v[88:91], a[180:183], a[16:19]
v_exp_f32 v52, v52
v_mfma_f32_16x16x32_bf16 a[32:35], v[88:91], a[184:187], a[32:35]
ds_read_b64_tr_b16 a[180:181], v221 offset:8192
ds_read_b64_tr_b16 a[182:183], v221 offset:12288
v_mfma_f32_16x16x32_bf16 a[36:39], v[92:95], a[184:187], a[36:39]
v_exp_f32 v53, v53
v_mfma_f32_16x16x32_bf16 a[40:43], v[96:99], a[184:187], a[40:43]
v_cvt_pk_bf16_f32 v78, v52, v53
v_mfma_f32_16x16x32_bf16 a[44:47], v[100:103], a[184:187], a[44:47]
v_exp_f32 v54, v54
v_mfma_f32_16x16x32_bf16 a[60:63], v[100:103], a[188:191], a[60:63]
ds_read_b64_tr_b16 a[184:185], v222 offset:8192
ds_read_b64_tr_b16 a[186:187], v222 offset:12288
v_mfma_f32_16x16x32_bf16 a[56:59], v[96:99], a[188:191], a[56:59]
v_exp_f32 v55, v55
v_mfma_f32_16x16x32_bf16 a[52:55], v[92:95], a[188:191], a[52:55]
v_cvt_pk_bf16_f32 v79, v54, v55
v_mfma_f32_16x16x32_bf16 a[48:51], v[88:91], a[188:191], a[48:51]
v_exp_f32 v56, v56
v_smfmac_f32_16x16x64_bf16 a[128:131], a[208:211], v[88:95], v245
v_exp_f32 v57, v57
v_mfma_f32_16x16x32_bf16 v[12:15], a[160:163], v[152:155], v[136:139]
ds_read_b64_tr_b16 a[188:189], v223 offset:8192
v_cvt_pk_bf16_f32 v80, v56, v57
v_mfma_f32_16x16x32_bf16 v[12:15], a[164:167], v[156:159], v[12:15]
v_exp_f32 v58, v58
v_mfma_f32_16x16x32_bf16 v[12:15], a[168:171], v[160:163], v[12:15]
ds_read_b64_tr_b16 a[190:191], v223 offset:12288
v_mfma_f32_16x16x32_bf16 v[12:15], a[172:175], v[164:167], v[12:15]
v_exp_f32 v59, v59
v_mfma_f32_16x16x32_bf16 v[20:23], a[172:175], v[180:183], v[140:143]
v_cvt_pk_bf16_f32 v81, v58, v59
v_mfma_f32_16x16x32_bf16 v[20:23], a[168:171], v[176:179], v[20:23]
v_exp_f32 v60, v60
v_mfma_f32_16x16x32_bf16 v[20:23], a[164:167], v[172:175], v[20:23]
buffer_load_dwordx4 v232, s[12:15], s39 offen offset:0  lds
v_mfma_f32_16x16x32_bf16 v[20:23], a[160:163], v[168:171], v[20:23]
v_exp_f32 v61, v61
v_mfma_f32_16x16x32_bf16 v[28:31], a[160:163], v[184:187], v[144:147]
v_cvt_pk_bf16_f32 v82, v60, v61
v_mfma_f32_16x16x32_bf16 v[28:31], a[164:167], v[188:191], v[28:31]
v_exp_f32 v62, v62
v_mfma_f32_16x16x32_bf16 v[28:31], a[168:171], v[192:195], v[28:31]
buffer_load_dwordx4 v233, s[12:15], s39 offen offset:1024  lds
v_mfma_f32_16x16x32_bf16 v[28:31], a[172:175], v[196:199], v[28:31]
v_exp_f32 v63, v63
v_mfma_f32_16x16x32_bf16 v[36:39], a[172:175], v[212:215], v[148:151]
ds_read_b128 a[172:175], v219 offset:28672
v_cvt_pk_bf16_f32 v83, v62, v63
v_mfma_f32_16x16x32_bf16 v[36:39], a[168:171], v[208:211], v[36:39]
v_exp_f32 v64, v64
v_mfma_f32_16x16x32_bf16 v[36:39], a[164:167], v[204:207], v[36:39]
ds_read_b128 a[168:171], v218 offset:28672
ds_read_b128 a[164:167], v217 offset:28672
v_mfma_f32_16x16x32_bf16 v[36:39], a[160:163], v[200:203], v[36:39]
v_exp_f32 v65, v65
s_waitcnt lgkmcnt(8)
v_mfma_f32_16x16x32_bf16 a[64:67], v[88:91], a[192:195], a[64:67]
ds_read_b128 a[160:163], v216 offset:28672
v_cvt_pk_bf16_f32 v84, v64, v65
v_mfma_f32_16x16x32_bf16 a[68:71], v[92:95], a[192:195], a[68:71]
v_exp_f32 v66, v66
v_mfma_f32_16x16x32_bf16 a[72:75], v[96:99], a[192:195], a[72:75]
buffer_load_dwordx4 v232, s[12:15], s39 offen offset:2048  lds
v_mfma_f32_16x16x32_bf16 a[76:79], v[100:103], a[192:195], a[76:79]
v_exp_f32 v67, v67
v_mfma_f32_16x16x32_bf16 a[92:95], v[100:103], a[196:199], a[92:95]
ds_read_b64_tr_b16 a[192:193], v224 offset:8192
v_cvt_pk_bf16_f32 v85, v66, v67
v_mfma_f32_16x16x32_bf16 a[88:91], v[96:99], a[196:199], a[88:91]
v_exp_f32 v68, v68
v_mfma_f32_16x16x32_bf16 a[84:87], v[92:95], a[196:199], a[84:87]
ds_read_b64_tr_b16 a[194:195], v224 offset:12288
v_mfma_f32_16x16x32_bf16 a[80:83], v[88:91], a[196:199], a[80:83]
v_exp_f32 v69, v69
v_mfma_f32_16x16x32_bf16 a[96:99], v[88:91], a[200:203], a[96:99]
ds_read_b64_tr_b16 a[196:197], v225 offset:8192
v_cvt_pk_bf16_f32 v86, v68, v69
v_mfma_f32_16x16x32_bf16 a[100:103], v[92:95], a[200:203], a[100:103]
v_exp_f32 v70, v70
v_mfma_f32_16x16x32_bf16 a[104:107], v[96:99], a[200:203], a[104:107]
ds_read_b64_tr_b16 a[198:199], v225 offset:12288
v_mfma_f32_16x16x32_bf16 a[108:111], v[100:103], a[200:203], a[108:111]
v_exp_f32 v71, v71
v_mfma_f32_16x16x32_bf16 a[124:127], v[100:103], a[204:207], a[124:127]
ds_read_b64_tr_b16 a[200:201], v226 offset:8192
v_cvt_pk_bf16_f32 v87, v70, v71
v_mfma_f32_16x16x32_bf16 a[120:123], v[96:99], a[204:207], a[120:123]
ds_read_b64_tr_b16 a[202:203], v226 offset:12288
v_mfma_f32_16x16x32_bf16 a[116:119], v[92:95], a[204:207], a[116:119]
buffer_load_dwordx4 v233, s[12:15], s39 offen offset:3072  lds
v_mfma_f32_16x16x32_bf16 a[112:115], v[88:91], a[204:207], a[112:115]
ds_read_b64_tr_b16 a[204:205], v227 offset:8192
ds_read_b64_tr_b16 a[206:207], v227 offset:12288
v_smfmac_f32_16x16x64_bf16 a[132:135], a[208:211], v[96:103], v245
s_add_u32 m0, s86, 24576
s_add_u32 s50, s84, 3538944
buffer_load_dwordx4 v240, s[64:67], s50 offen lds
s_add_u32 m0, s86, 28672
s_add_u32 s50, s84, 4128768
buffer_load_dwordx4 v240, s[64:67], s50 offen lds
v_mfma_f32_16x16x32_bf16 v[40:43], a[144:147], v[152:155], v[136:139]
v_exp_f32 v8, v8
v_mfma_f32_16x16x32_bf16 v[40:43], a[148:151], v[156:159], v[40:43]
v_exp_f32 v9, v9
v_mfma_f32_16x16x32_bf16 v[40:43], a[152:155], v[160:163], v[40:43]
v_cvt_pk_bf16_f32 v88, v8, v9
v_mfma_f32_16x16x32_bf16 v[40:43], a[156:159], v[164:167], v[40:43]
v_exp_f32 v10, v10
v_mfma_f32_16x16x32_bf16 v[48:51], a[156:159], v[180:183], v[140:143]
v_mfma_f32_16x16x32_bf16 v[48:51], a[152:155], v[176:179], v[48:51]
v_exp_f32 v11, v11
v_mfma_f32_16x16x32_bf16 v[48:51], a[148:151], v[172:175], v[48:51]
v_cvt_pk_bf16_f32 v89, v10, v11
v_mfma_f32_16x16x32_bf16 v[48:51], a[144:147], v[168:171], v[48:51]
v_exp_f32 v12, v12
v_mfma_f32_16x16x32_bf16 v[56:59], a[144:147], v[184:187], v[144:147]
v_mfma_f32_16x16x32_bf16 v[56:59], a[148:151], v[188:191], v[56:59]
v_exp_f32 v13, v13
v_mfma_f32_16x16x32_bf16 v[56:59], a[152:155], v[192:195], v[56:59]
v_cvt_pk_bf16_f32 v90, v12, v13
v_mfma_f32_16x16x32_bf16 v[56:59], a[156:159], v[196:199], v[56:59]
v_exp_f32 v14, v14
v_mfma_f32_16x16x32_bf16 v[64:67], a[156:159], v[212:215], v[148:151]
s_waitcnt vmcnt(12) lgkmcnt(0)
s_barrier
v_mfma_f32_16x16x32_bf16 v[64:67], a[152:155], v[208:211], v[64:67]
v_exp_f32 v15, v15
v_mfma_f32_16x16x32_bf16 v[64:67], a[148:151], v[204:207], v[64:67]
ds_read_b128 a[156:159], v219 offset:49152
v_cvt_pk_bf16_f32 v91, v14, v15
v_mfma_f32_16x16x32_bf16 v[64:67], a[144:147], v[200:203], v[64:67]
v_exp_f32 v16, v16
v_mfma_f32_16x16x32_bf16 a[0:3], v[72:75], a[176:179], a[0:3]
ds_read_b128 a[152:155], v218 offset:49152
ds_read_b128 a[148:151], v217 offset:49152
v_mfma_f32_16x16x32_bf16 a[4:7], v[76:79], a[176:179], a[4:7]
v_exp_f32 v17, v17
v_mfma_f32_16x16x32_bf16 a[8:11], v[80:83], a[176:179], a[8:11]
ds_read_b128 a[144:147], v216 offset:49152
v_cvt_pk_bf16_f32 v92, v16, v17
v_mfma_f32_16x16x32_bf16 a[12:15], v[84:87], a[176:179], a[12:15]
v_exp_f32 v18, v18
v_mfma_f32_16x16x32_bf16 a[28:31], v[84:87], a[180:183], a[28:31]
ds_read_b64_tr_b16 a[176:177], v220 offset:32768
ds_read_b64_tr_b16 a[178:179], v220 offset:36864
v_mfma_f32_16x16x32_bf16 a[24:27], v[80:83], a[180:183], a[24:27]
v_exp_f32 v19, v19
v_mfma_f32_16x16x32_bf16 a[20:23], v[76:79], a[180:183], a[20:23]
s_add_u32 s32, s32, 16384
v_cvt_pk_bf16_f32 v93, v18, v19
v_mfma_f32_16x16x32_bf16 a[16:19], v[72:75], a[180:183], a[16:19]
v_exp_f32 v20, v20
v_mfma_f32_16x16x32_bf16 a[32:35], v[72:75], a[184:187], a[32:35]
ds_read_b64_tr_b16 a[180:181], v221 offset:32768
ds_read_b64_tr_b16 a[182:183], v221 offset:36864
v_mfma_f32_16x16x32_bf16 a[36:39], v[76:79], a[184:187], a[36:39]
v_exp_f32 v21, v21
v_mfma_f32_16x16x32_bf16 a[40:43], v[80:83], a[184:187], a[40:43]
s_add_u32 m0, s30, 81920
v_cvt_pk_bf16_f32 v94, v20, v21
v_mfma_f32_16x16x32_bf16 a[44:47], v[84:87], a[184:187], a[44:47]
v_exp_f32 v22, v22
v_mfma_f32_16x16x32_bf16 a[60:63], v[84:87], a[188:191], a[60:63]
ds_read_b64_tr_b16 a[184:185], v222 offset:32768
ds_read_b64_tr_b16 a[186:187], v222 offset:36864
v_mfma_f32_16x16x32_bf16 a[56:59], v[80:83], a[188:191], a[56:59]
v_exp_f32 v23, v23
v_mfma_f32_16x16x32_bf16 a[52:55], v[76:79], a[188:191], a[52:55]
v_cvt_pk_bf16_f32 v95, v22, v23
v_mfma_f32_16x16x32_bf16 a[48:51], v[72:75], a[188:191], a[48:51]
v_exp_f32 v24, v24
v_smfmac_f32_16x16x64_bf16 a[128:131], a[208:211], v[72:79], v245
v_exp_f32 v25, v25
v_mfma_f32_16x16x32_bf16 v[44:47], a[160:163], v[152:155], v[136:139]
ds_read_b64_tr_b16 a[188:189], v223 offset:32768
v_cvt_pk_bf16_f32 v96, v24, v25
v_mfma_f32_16x16x32_bf16 v[44:47], a[164:167], v[156:159], v[44:47]
v_exp_f32 v26, v26
v_mfma_f32_16x16x32_bf16 v[44:47], a[168:171], v[160:163], v[44:47]
ds_read_b64_tr_b16 a[190:191], v223 offset:36864
v_mfma_f32_16x16x32_bf16 v[44:47], a[172:175], v[164:167], v[44:47]
v_exp_f32 v27, v27
v_mfma_f32_16x16x32_bf16 v[52:55], a[172:175], v[180:183], v[140:143]
v_cvt_pk_bf16_f32 v97, v26, v27
v_mfma_f32_16x16x32_bf16 v[52:55], a[168:171], v[176:179], v[52:55]
v_exp_f32 v28, v28
v_mfma_f32_16x16x32_bf16 v[52:55], a[164:167], v[172:175], v[52:55]
buffer_load_dwordx4 v228, s[8:11], s32 offen offset:0  lds
v_mfma_f32_16x16x32_bf16 v[52:55], a[160:163], v[168:171], v[52:55]
v_exp_f32 v29, v29
v_mfma_f32_16x16x32_bf16 v[60:63], a[160:163], v[184:187], v[144:147]
v_cmp_ne_u32 vcc, s47, v249
s_cbranch_vccnz SP_CAND
SP_CAND_RET:
v_cvt_pk_bf16_f32 v98, v28, v29
v_mfma_f32_16x16x32_bf16 v[60:63], a[164:167], v[188:191], v[60:63]
v_exp_f32 v30, v30
v_mfma_f32_16x16x32_bf16 v[60:63], a[168:171], v[192:195], v[60:63]
buffer_load_dwordx4 v229, s[8:11], s32 offen offset:1024  lds
v_mfma_f32_16x16x32_bf16 v[60:63], a[172:175], v[196:199], v[60:63]
v_exp_f32 v31, v31
v_mfma_f32_16x16x32_bf16 v[68:71], a[172:175], v[212:215], v[148:151]
ds_read_b128 a[172:175], v219 offset:53248
v_cvt_pk_bf16_f32 v99, v30, v31
v_mfma_f32_16x16x32_bf16 v[68:71], a[168:171], v[208:211], v[68:71]
v_exp_f32 v32, v32
v_mfma_f32_16x16x32_bf16 v[68:71], a[164:167], v[204:207], v[68:71]
ds_read_b128 a[168:171], v218 offset:53248
ds_read_b128 a[164:167], v217 offset:53248
v_mfma_f32_16x16x32_bf16 v[68:71], a[160:163], v[200:203], v[68:71]
v_mov_b32 v251, 0
v_exp_f32 v33, v33
v_mfma_f32_16x16x32_bf16 a[64:67], v[72:75], a[192:195], a[64:67]
ds_read_b128 a[160:163], v216 offset:53248
v_cvt_pk_bf16_f32 v100, v32, v33
v_mfma_f32_16x16x32_bf16 a[68:71], v[76:79], a[192:195], a[68:71]
v_exp_f32 v34, v34
v_mfma_f32_16x16x32_bf16 a[72:75], v[80:83], a[192:195], a[72:75]
buffer_load_dwordx4 v230, s[8:11], s32 offen offset:2048  lds
v_mfma_f32_16x16x32_bf16 a[76:79], v[84:87], a[192:195], a[76:79]
v_exp_f32 v35, v35
v_mfma_f32_16x16x32_bf16 a[92:95], v[84:87], a[196:199], a[92:95]
ds_read_b64_tr_b16 a[192:193], v224 offset:32768
v_cvt_pk_bf16_f32 v101, v34, v35
v_mfma_f32_16x16x32_bf16 a[88:91], v[80:83], a[196:199], a[88:91]
v_exp_f32 v36, v36
v_mfma_f32_16x16x32_bf16 a[84:87], v[76:79], a[196:199], a[84:87]
ds_read_b64_tr_b16 a[194:195], v224 offset:36864
s_mov_b32 s90, 0x01010101
s_mov_b32 s91, 0x01010101
v_mfma_f32_16x16x32_bf16 a[80:83], v[72:75], a[196:199], a[80:83]
v_exp_f32 v37, v37
v_mfma_f32_16x16x32_bf16 a[96:99], v[72:75], a[200:203], a[96:99]
ds_read_b64_tr_b16 a[196:197], v225 offset:32768
v_cvt_pk_bf16_f32 v102, v36, v37
v_mfma_f32_16x16x32_bf16 a[100:103], v[76:79], a[200:203], a[100:103]
v_exp_f32 v38, v38
v_mfma_f32_16x16x32_bf16 a[104:107], v[80:83], a[200:203], a[104:107]
ds_read_b64_tr_b16 a[198:199], v225 offset:36864
v_max_u32_dpp v250, v248, v248 row_ror:8 row_mask:0xf bank_mask:0xf
v_mfma_f32_16x16x32_bf16 a[108:111], v[84:87], a[200:203], a[108:111]
v_exp_f32 v39, v39
v_mfma_f32_16x16x32_bf16 a[124:127], v[84:87], a[204:207], a[124:127]
ds_read_b64_tr_b16 a[200:201], v226 offset:32768
v_cvt_pk_bf16_f32 v103, v38, v39
v_mfma_f32_16x16x32_bf16 a[120:123], v[80:83], a[204:207], a[120:123]
ds_read_b64_tr_b16 a[202:203], v226 offset:36864
v_max_u32_dpp v249, v250, v250 row_ror:4 row_mask:0xf bank_mask:0xf
v_mfma_f32_16x16x32_bf16 a[116:119], v[76:79], a[204:207], a[116:119]
buffer_load_dwordx4 v231, s[8:11], s32 offen offset:3072  lds
v_mfma_f32_16x16x32_bf16 a[112:115], v[72:75], a[204:207], a[112:115]
ds_read_b64_tr_b16 a[204:205], v227 offset:32768
ds_read_b64_tr_b16 a[206:207], v227 offset:36864
v_smfmac_f32_16x16x64_bf16 a[132:135], a[208:211], v[80:87], v245
s_add_u32 m0, s86, 32768
s_add_u32 s50, s84, 0
buffer_load_dwordx4 v240, s[68:71], s50 offen lds
s_add_u32 m0, s86, 36864
s_add_u32 s50, s84, 589824
buffer_load_dwordx4 v240, s[68:71], s50 offen lds
s_waitcnt lgkmcnt(8)
v_mfma_f32_16x16x32_bf16 v[8:11], a[144:147], v[152:155], v[136:139]
v_exp_f32 v40, v40
v_mfma_f32_16x16x32_bf16 v[8:11], a[148:151], v[156:159], v[8:11]
v_exp_f32 v41, v41
v_mfma_f32_16x16x32_bf16 v[8:11], a[152:155], v[160:163], v[8:11]
v_cvt_pk_bf16_f32 v72, v40, v41
v_max_u32_dpp v250, v249, v249 row_ror:2 row_mask:0xf bank_mask:0xf
STUB_5:
s_cbranch_execz STUB_8
v_mfma_f32_16x16x32_bf16 v[8:11], a[156:159], v[164:167], v[8:11]
v_exp_f32 v42, v42
v_mfma_f32_16x16x32_bf16 v[16:19], a[156:159], v[180:183], v[140:143]
s_add_u32 s39, s39, 16384
v_max_u32_dpp v249, v250, v250 row_ror:1 row_mask:0xf bank_mask:0xf
v_mfma_f32_16x16x32_bf16 v[16:19], a[152:155], v[176:179], v[16:19]
v_exp_f32 v43, v43
v_mfma_f32_16x16x32_bf16 v[16:19], a[148:151], v[172:175], v[16:19]
v_cvt_pk_bf16_f32 v73, v42, v43
v_mov_b32 v250, v249
v_mfma_f32_16x16x32_bf16 v[16:19], a[144:147], v[168:171], v[16:19]
v_exp_f32 v44, v44
v_mfma_f32_16x16x32_bf16 v[24:27], a[144:147], v[184:187], v[144:147]
v_permlane16_swap_b32 v249, v250
v_max_u32 v249, v249, v250
v_mfma_f32_16x16x32_bf16 v[24:27], a[148:151], v[188:191], v[24:27]
v_exp_f32 v45, v45
v_mfma_f32_16x16x32_bf16 v[24:27], a[152:155], v[192:195], v[24:27]
s_add_u32 m0, s30, 98304
v_cvt_pk_bf16_f32 v74, v44, v45
v_mfma_f32_16x16x32_bf16 v[24:27], a[156:159], v[196:199], v[24:27]
v_exp_f32 v46, v46
v_mfma_f32_16x16x32_bf16 v[32:35], a[156:159], v[212:215], v[148:151]
ds_read_b128 a[156:159], v219 offset:57344
v_mov_b32 v250, v249
v_mfma_f32_16x16x32_bf16 v[32:35], a[152:155], v[208:211], v[32:35]
v_exp_f32 v47, v47
v_mfma_f32_16x16x32_bf16 v[32:35], a[148:151], v[204:207], v[32:35]
ds_read_b128 a[152:155], v218 offset:57344
v_cvt_pk_bf16_f32 v75, v46, v47
v_mfma_f32_16x16x32_bf16 v[32:35], a[144:147], v[200:203], v[32:35]
v_exp_f32 v48, v48
v_mfma_f32_16x16x32_bf16 a[0:3], v[88:91], a[176:179], a[0:3]
ds_read_b128 a[148:151], v217 offset:57344
ds_read_b128 a[144:147], v216 offset:57344
v_mfma_f32_16x16x32_bf16 a[4:7], v[92:95], a[176:179], a[4:7]
v_exp_f32 v49, v49
v_mfma_f32_16x16x32_bf16 a[8:11], v[96:99], a[176:179], a[8:11]
v_cvt_pk_bf16_f32 v76, v48, v49
v_permlane32_swap_b32 v249, v250
v_mfma_f32_16x16x32_bf16 a[12:15], v[100:103], a[176:179], a[12:15]
v_exp_f32 v50, v50
v_mfma_f32_16x16x32_bf16 a[28:31], v[100:103], a[180:183], a[28:31]
ds_read_b64_tr_b16 a[176:177], v220 offset:40960
ds_read_b64_tr_b16 a[178:179], v220 offset:45056
v_mfma_f32_16x16x32_bf16 a[24:27], v[96:99], a[180:183], a[24:27]
v_exp_f32 v51, v51
v_mfma_f32_16x16x32_bf16 a[20:23], v[92:95], a[180:183], a[20:23]
v_cvt_pk_bf16_f32 v77, v50, v51
v_max_u32 v249, v249, v250
v_mfma_f32_16x16x32_bf16 a[16:19], v[88:91], a[180:183], a[16:19]
v_exp_f32 v52, v52
v_mfma_f32_16x16x32_bf16 a[32:35], v[88:91], a[184:187], a[32:35]
ds_read_b64_tr_b16 a[180:181], v221 offset:40960
ds_read_b64_tr_b16 a[182:183], v221 offset:45056
v_mfma_f32_16x16x32_bf16 a[36:39], v[92:95], a[184:187], a[36:39]
v_exp_f32 v53, v53
v_mfma_f32_16x16x32_bf16 a[40:43], v[96:99], a[184:187], a[40:43]
v_cvt_pk_bf16_f32 v78, v52, v53
v_add_u32 v251, v251, v249
v_mfma_f32_16x16x32_bf16 a[44:47], v[100:103], a[184:187], a[44:47]
v_exp_f32 v54, v54
v_mfma_f32_16x16x32_bf16 a[60:63], v[100:103], a[188:191], a[60:63]
ds_read_b64_tr_b16 a[184:185], v222 offset:40960
ds_read_b64_tr_b16 a[186:187], v222 offset:45056
v_mfma_f32_16x16x32_bf16 a[56:59], v[96:99], a[188:191], a[56:59]
v_exp_f32 v55, v55
v_mfma_f32_16x16x32_bf16 a[52:55], v[92:95], a[188:191], a[52:55]
v_cvt_pk_bf16_f32 v79, v54, v55
v_sub_u32 v248, v248, v249
v_mfma_f32_16x16x32_bf16 a[48:51], v[88:91], a[188:191], a[48:51]
v_exp_f32 v56, v56
v_smfmac_f32_16x16x64_bf16 a[128:131], a[208:211], v[88:95], v245
v_exp_f32 v57, v57
v_mfma_f32_16x16x32_bf16 v[12:15], a[160:163], v[152:155], v[136:139]
ds_read_b64_tr_b16 a[188:189], v223 offset:40960
v_cvt_pk_bf16_f32 v80, v56, v57
v_mfma_f32_16x16x32_bf16 v[12:15], a[164:167], v[156:159], v[12:15]
v_exp_f32 v58, v58
v_mfma_f32_16x16x32_bf16 v[12:15], a[168:171], v[160:163], v[12:15]
ds_read_b64_tr_b16 a[190:191], v223 offset:45056
v_cndmask_b32 v252, v252, v251, s[90:91]
v_mfma_f32_16x16x32_bf16 v[12:15], a[172:175], v[164:167], v[12:15]
v_exp_f32 v59, v59
v_mfma_f32_16x16x32_bf16 v[20:23], a[172:175], v[180:183], v[140:143]
s_lshl_b64 s[90:91], s[90:91], 1
v_cvt_pk_bf16_f32 v81, v58, v59
v_mfma_f32_16x16x32_bf16 v[20:23], a[168:171], v[176:179], v[20:23]
v_exp_f32 v60, v60
v_mfma_f32_16x16x32_bf16 v[20:23], a[164:167], v[172:175], v[20:23]
buffer_load_dwordx4 v232, s[12:15], s39 offen offset:0  lds
v_mfma_f32_16x16x32_bf16 v[20:23], a[160:163], v[168:171], v[20:23]
v_exp_f32 v61, v61
v_mfma_f32_16x16x32_bf16 v[28:31], a[160:163], v[184:187], v[144:147]
v_cvt_pk_bf16_f32 v82, v60, v61
v_max_u32_dpp v250, v248, v248 row_ror:8 row_mask:0xf bank_mask:0xf
v_mfma_f32_16x16x32_bf16 v[28:31], a[164:167], v[188:191], v[28:31]
v_exp_f32 v62, v62
v_mfma_f32_16x16x32_bf16 v[28:31], a[168:171], v[192:195], v[28:31]
buffer_load_dwordx4 v233, s[12:15], s39 offen offset:1024  lds
v_mfma_f32_16x16x32_bf16 v[28:31], a[172:175], v[196:199], v[28:31]
v_exp_f32 v63, v63
v_mfma_f32_16x16x32_bf16 v[36:39], a[172:175], v[212:215], v[148:151]
ds_read_b128 a[172:175], v219 offset:61440
v_cvt_pk_bf16_f32 v83, v62, v63
v_mfma_f32_16x16x32_bf16 v[36:39], a[168:171], v[208:211], v[36:39]
v_exp_f32 v64, v64
v_mfma_f32_16x16x32_bf16 v[36:39], a[164:167], v[204:207], v[36:39]
ds_read_b128 a[168:171], v218 offset:61440
ds_read_b128 a[164:167], v217 offset:61440
v_mfma_f32_16x16x32_bf16 v[36:39], a[160:163], v[200:203], v[36:39]
v_exp_f32 v65, v65
s_waitcnt lgkmcnt(8)
v_mfma_f32_16x16x32_bf16 a[64:67], v[88:91], a[192:195], a[64:67]
ds_read_b128 a[160:163], v216 offset:61440
v_cvt_pk_bf16_f32 v84, v64, v65
v_mfma_f32_16x16x32_bf16 a[68:71], v[92:95], a[192:195], a[68:71]
v_exp_f32 v66, v66
v_mfma_f32_16x16x32_bf16 a[72:75], v[96:99], a[192:195], a[72:75]
buffer_load_dwordx4 v232, s[12:15], s39 offen offset:2048  lds
v_mfma_f32_16x16x32_bf16 a[76:79], v[100:103], a[192:195], a[76:79]
v_exp_f32 v67, v67
v_mfma_f32_16x16x32_bf16 a[92:95], v[100:103], a[196:199], a[92:95]
ds_read_b64_tr_b16 a[192:193], v224 offset:40960
v_cvt_pk_bf16_f32 v85, v66, v67
v_mfma_f32_16x16x32_bf16 a[88:91], v[96:99], a[196:199], a[88:91]
v_exp_f32 v68, v68
v_mfma_f32_16x16x32_bf16 a[84:87], v[92:95], a[196:199], a[84:87]
ds_read_b64_tr_b16 a[194:195], v224 offset:45056
v_max_u32_dpp v249, v250, v250 row_ror:4 row_mask:0xf bank_mask:0xf
v_mfma_f32_16x16x32_bf16 a[80:83], v[88:91], a[196:199], a[80:83]
v_exp_f32 v69, v69
v_mfma_f32_16x16x32_bf16 a[96:99], v[88:91], a[200:203], a[96:99]
ds_read_b64_tr_b16 a[196:197], v225 offset:40960
v_cvt_pk_bf16_f32 v86, v68, v69
v_mfma_f32_16x16x32_bf16 a[100:103], v[92:95], a[200:203], a[100:103]
v_exp_f32 v70, v70
v_mfma_f32_16x16x32_bf16 a[104:107], v[96:99], a[200:203], a[104:107]
ds_read_b64_tr_b16 a[198:199], v225 offset:45056
v_max_u32_dpp v250, v249, v249 row_ror:2 row_mask:0xf bank_mask:0xf
v_mfma_f32_16x16x32_bf16 a[108:111], v[100:103], a[200:203], a[108:111]
v_exp_f32 v71, v71
v_mfma_f32_16x16x32_bf16 a[124:127], v[100:103], a[204:207], a[124:127]
ds_read_b64_tr_b16 a[200:201], v226 offset:40960
v_cvt_pk_bf16_f32 v87, v70, v71
v_mfma_f32_16x16x32_bf16 a[120:123], v[96:99], a[204:207], a[120:123]
ds_read_b64_tr_b16 a[202:203], v226 offset:45056
v_max_u32_dpp v249, v250, v250 row_ror:1 row_mask:0xf bank_mask:0xf
v_mfma_f32_16x16x32_bf16 a[116:119], v[92:95], a[204:207], a[116:119]
buffer_load_dwordx4 v233, s[12:15], s39 offen offset:3072  lds
v_mfma_f32_16x16x32_bf16 a[112:115], v[88:91], a[204:207], a[112:115]
ds_read_b64_tr_b16 a[204:205], v227 offset:40960
ds_read_b64_tr_b16 a[206:207], v227 offset:45056
v_smfmac_f32_16x16x64_bf16 a[132:135], a[208:211], v[96:103], v245
s_add_u32 m0, s86, 40960
s_add_u32 s50, s84, 1179648
buffer_load_dwordx4 v240, s[68:71], s50 offen lds
s_add_u32 m0, s86, 45056
s_add_u32 s50, s84, 1769472
buffer_load_dwordx4 v240, s[68:71], s50 offen lds
v_mfma_f32_16x16x32_bf16 v[40:43], a[144:147], v[152:155], v[136:139]
v_exp_f32 v8, v8
v_mfma_f32_16x16x32_bf16 v[40:43], a[148:151], v[156:159], v[40:43]
v_exp_f32 v9, v9
v_mfma_f32_16x16x32_bf16 v[40:43], a[152:155], v[160:163], v[40:43]
v_cvt_pk_bf16_f32 v88, v8, v9
v_lshlrev_b32 v246, 2, v1
v_mfma_f32_16x16x32_bf16 v[40:43], a[156:159], v[164:167], v[40:43]
v_exp_f32 v10, v10
v_mfma_f32_16x16x32_bf16 v[48:51], a[156:159], v[180:183], v[140:143]
v_mov_b32 v250, v249
v_mfma_f32_16x16x32_bf16 v[48:51], a[152:155], v[176:179], v[48:51]
v_exp_f32 v11, v11
v_mfma_f32_16x16x32_bf16 v[48:51], a[148:151], v[172:175], v[48:51]
v_cvt_pk_bf16_f32 v89, v10, v11
v_permlane16_swap_b32 v249, v250
v_mfma_f32_16x16x32_bf16 v[48:51], a[144:147], v[168:171], v[48:51]
v_exp_f32 v12, v12
v_mfma_f32_16x16x32_bf16 v[56:59], a[144:147], v[184:187], v[144:147]
v_max_u32 v249, v249, v250
v_mov_b32 v250, v249
v_mfma_f32_16x16x32_bf16 v[56:59], a[148:151], v[188:191], v[56:59]
v_exp_f32 v13, v13
v_mfma_f32_16x16x32_bf16 v[56:59], a[152:155], v[192:195], v[56:59]
v_cvt_pk_bf16_f32 v90, v12, v13
v_permlane32_swap_b32 v249, v250
v_mfma_f32_16x16x32_bf16 v[56:59], a[156:159], v[196:199], v[56:59]
v_exp_f32 v14, v14
v_mfma_f32_16x16x32_bf16 v[64:67], a[156:159], v[212:215], v[148:151]
s_waitcnt vmcnt(12) lgkmcnt(0)
s_barrier
v_mfma_f32_16x16x32_bf16 v[64:67], a[152:155], v[208:211], v[64:67]
v_exp_f32 v15, v15
v_mfma_f32_16x16x32_bf16 v[64:67], a[148:151], v[204:207], v[64:67]
ds_read_b128 a[156:159], v219 offset:0
v_cvt_pk_bf16_f32 v91, v14, v15
v_mfma_f32_16x16x32_bf16 v[64:67], a[144:147], v[200:203], v[64:67]
v_exp_f32 v16, v16
v_mfma_f32_16x16x32_bf16 a[0:3], v[72:75], a[176:179], a[0:3]
ds_read_b128 a[152:155], v218 offset:0
ds_read_b128 a[148:151], v217 offset:0
v_mfma_f32_16x16x32_bf16 a[4:7], v[76:79], a[176:179], a[4:7]
v_exp_f32 v17, v17
v_mfma_f32_16x16x32_bf16 a[8:11], v[80:83], a[176:179], a[8:11]
ds_read_b128 a[144:147], v216 offset:0
v_cvt_pk_bf16_f32 v92, v16, v17
v_mfma_f32_16x16x32_bf16 a[12:15], v[84:87], a[176:179], a[12:15]
v_exp_f32 v18, v18
v_mfma_f32_16x16x32_bf16 a[28:31], v[84:87], a[180:183], a[28:31]
ds_read_b64_tr_b16 a[176:177], v220 offset:49152
ds_read_b64_tr_b16 a[178:179], v220 offset:53248
v_mfma_f32_16x16x32_bf16 a[24:27], v[80:83], a[180:183], a[24:27]
v_exp_f32 v19, v19
v_mfma_f32_16x16x32_bf16 a[20:23], v[76:79], a[180:183], a[20:23]
s_add_u32 s32, s32, 16384
v_cvt_pk_bf16_f32 v93, v18, v19
v_mfma_f32_16x16x32_bf16 a[16:19], v[72:75], a[180:183], a[16:19]
v_exp_f32 v20, v20
v_mfma_f32_16x16x32_bf16 a[32:35], v[72:75], a[184:187], a[32:35]
ds_read_b64_tr_b16 a[180:181], v221 offset:49152
ds_read_b64_tr_b16 a[182:183], v221 offset:53248
v_mfma_f32_16x16x32_bf16 a[36:39], v[76:79], a[184:187], a[36:39]
v_exp_f32 v21, v21
v_mfma_f32_16x16x32_bf16 a[40:43], v[80:83], a[184:187], a[40:43]
s_add_u32 m0, s30, 114688
v_cvt_pk_bf16_f32 v94, v20, v21
v_mfma_f32_16x16x32_bf16 a[44:47], v[84:87], a[184:187], a[44:47]
v_exp_f32 v22, v22
v_mfma_f32_16x16x32_bf16 a[60:63], v[84:87], a[188:191], a[60:63]
ds_read_b64_tr_b16 a[184:185], v222 offset:49152
ds_read_b64_tr_b16 a[186:187], v222 offset:53248
v_mfma_f32_16x16x32_bf16 a[56:59], v[80:83], a[188:191], a[56:59]
v_exp_f32 v23, v23
v_mfma_f32_16x16x32_bf16 a[52:55], v[76:79], a[188:191], a[52:55]
v_cvt_pk_bf16_f32 v95, v22, v23
v_max_u32 v249, v249, v250
v_mfma_f32_16x16x32_bf16 a[48:51], v[72:75], a[188:191], a[48:51]
v_exp_f32 v24, v24
v_smfmac_f32_16x16x64_bf16 a[128:131], a[208:211], v[72:79], v245
v_exp_f32 v25, v25
v_mfma_f32_16x16x32_bf16 v[44:47], a[160:163], v[152:155], v[136:139]
ds_read_b64_tr_b16 a[188:189], v223 offset:49152
v_cvt_pk_bf16_f32 v96, v24, v25
v_mfma_f32_16x16x32_bf16 v[44:47], a[164:167], v[156:159], v[44:47]
v_exp_f32 v26, v26
v_mfma_f32_16x16x32_bf16 v[44:47], a[168:171], v[160:163], v[44:47]
ds_read_b64_tr_b16 a[190:191], v223 offset:53248
v_add_u32 v251, v251, v249
v_mfma_f32_16x16x32_bf16 v[44:47], a[172:175], v[164:167], v[44:47]
v_exp_f32 v27, v27
v_mfma_f32_16x16x32_bf16 v[52:55], a[172:175], v[180:183], v[140:143]
v_cvt_pk_bf16_f32 v97, v26, v27
v_sub_u32 v248, v248, v249
v_mfma_f32_16x16x32_bf16 v[52:55], a[168:171], v[176:179], v[52:55]
v_exp_f32 v28, v28
v_mfma_f32_16x16x32_bf16 v[52:55], a[164:167], v[172:175], v[52:55]
buffer_load_dwordx4 v228, s[8:11], s32 offen offset:0  lds
v_mfma_f32_16x16x32_bf16 v[52:55], a[160:163], v[168:171], v[52:55]
v_exp_f32 v29, v29
v_mfma_f32_16x16x32_bf16 v[60:63], a[160:163], v[184:187], v[144:147]
v_cvt_pk_bf16_f32 v98, v28, v29
v_cndmask_b32 v252, v252, v251, s[90:91]
v_mfma_f32_16x16x32_bf16 v[60:63], a[164:167], v[188:191], v[60:63]
v_exp_f32 v30, v30
v_mfma_f32_16x16x32_bf16 v[60:63], a[168:171], v[192:195], v[60:63]
buffer_load_dwordx4 v229, s[8:11], s32 offen offset:1024  lds
v_mfma_f32_16x16x32_bf16 v[60:63], a[172:175], v[196:199], v[60:63]
v_exp_f32 v31, v31
v_mfma_f32_16x16x32_bf16 v[68:71], a[172:175], v[212:215], v[148:151]
ds_read_b128 a[172:175], v219 offset:4096
v_cvt_pk_bf16_f32 v99, v30, v31
v_mfma_f32_16x16x32_bf16 v[68:71], a[168:171], v[208:211], v[68:71]
v_exp_f32 v32, v32
v_mfma_f32_16x16x32_bf16 v[68:71], a[164:167], v[204:207], v[68:71]
ds_read_b128 a[168:171], v218 offset:4096
ds_read_b128 a[164:167], v217 offset:4096
v_mfma_f32_16x16x32_bf16 v[68:71], a[160:163], v[200:203], v[68:71]
v_exp_f32 v33, v33
v_mfma_f32_16x16x32_bf16 a[64:67], v[72:75], a[192:195], a[64:67]
ds_read_b128 a[160:163], v216 offset:4096
v_cvt_pk_bf16_f32 v100, v32, v33
v_mfma_f32_16x16x32_bf16 a[68:71], v[76:79], a[192:195], a[68:71]
v_exp_f32 v34, v34
v_mfma_f32_16x16x32_bf16 a[72:75], v[80:83], a[192:195], a[72:75]
buffer_load_dwordx4 v230, s[8:11], s32 offen offset:2048  lds
v_mfma_f32_16x16x32_bf16 a[76:79], v[84:87], a[192:195], a[76:79]
s_lshl_b64 s[90:91], s[90:91], 1
v_exp_f32 v35, v35
v_mfma_f32_16x16x32_bf16 a[92:95], v[84:87], a[196:199], a[92:95]
ds_read_b64_tr_b16 a[192:193], v224 offset:49152
v_cvt_pk_bf16_f32 v101, v34, v35
v_mfma_f32_16x16x32_bf16 a[88:91], v[80:83], a[196:199], a[88:91]
v_exp_f32 v36, v36
v_mfma_f32_16x16x32_bf16 a[84:87], v[76:79], a[196:199], a[84:87]
ds_read_b64_tr_b16 a[194:195], v224 offset:53248
v_max_u32_dpp v250, v248, v248 row_ror:8 row_mask:0xf bank_mask:0xf
v_mfma_f32_16x16x32_bf16 a[80:83], v[72:75], a[196:199], a[80:83]
v_exp_f32 v37, v37
v_mfma_f32_16x16x32_bf16 a[96:99], v[72:75], a[200:203], a[96:99]
ds_read_b64_tr_b16 a[196:197], v225 offset:49152
v_cvt_pk_bf16_f32 v102, v36, v37
v_mfma_f32_16x16x32_bf16 a[100:103], v[76:79], a[200:203], a[100:103]
v_exp_f32 v38, v38
v_mfma_f32_16x16x32_bf16 a[104:107], v[80:83], a[200:203], a[104:107]
ds_read_b64_tr_b16 a[198:199], v225 offset:53248
v_max_u32_dpp v249, v250, v250 row_ror:4 row_mask:0xf bank_mask:0xf
v_mfma_f32_16x16x32_bf16 a[108:111], v[84:87], a[200:203], a[108:111]
v_exp_f32 v39, v39
v_mfma_f32_16x16x32_bf16 a[124:127], v[84:87], a[204:207], a[124:127]
ds_read_b64_tr_b16 a[200:201], v226 offset:49152
v_cvt_pk_bf16_f32 v103, v38, v39
v_mfma_f32_16x16x32_bf16 a[120:123], v[80:83], a[204:207], a[120:123]
ds_read_b64_tr_b16 a[202:203], v226 offset:53248
v_max_u32_dpp v250, v249, v249 row_ror:2 row_mask:0xf bank_mask:0xf
v_mfma_f32_16x16x32_bf16 a[116:119], v[76:79], a[204:207], a[116:119]
buffer_load_dwordx4 v231, s[8:11], s32 offen offset:3072  lds
v_mfma_f32_16x16x32_bf16 a[112:115], v[72:75], a[204:207], a[112:115]
ds_read_b64_tr_b16 a[204:205], v227 offset:49152
ds_read_b64_tr_b16 a[206:207], v227 offset:53248
v_smfmac_f32_16x16x64_bf16 a[132:135], a[208:211], v[80:87], v245
s_add_u32 m0, s86, 49152
s_add_u32 s50, s84, 2359296
buffer_load_dwordx4 v240, s[68:71], s50 offen lds
s_add_u32 m0, s86, 53248
s_add_u32 s50, s84, 2949120
buffer_load_dwordx4 v240, s[68:71], s50 offen lds
s_waitcnt lgkmcnt(8)
v_mfma_f32_16x16x32_bf16 v[8:11], a[144:147], v[152:155], v[136:139]
v_exp_f32 v40, v40
v_mfma_f32_16x16x32_bf16 v[8:11], a[148:151], v[156:159], v[8:11]
v_exp_f32 v41, v41
v_mfma_f32_16x16x32_bf16 v[8:11], a[152:155], v[160:163], v[8:11]
v_cvt_pk_bf16_f32 v72, v40, v41
v_max_u32_dpp v249, v250, v250 row_ror:1 row_mask:0xf bank_mask:0xf
v_mfma_f32_16x16x32_bf16 v[8:11], a[156:159], v[164:167], v[8:11]
v_exp_f32 v42, v42
v_mfma_f32_16x16x32_bf16 v[16:19], a[156:159], v[180:183], v[140:143]
s_add_u32 s39, s39, 16384
v_mov_b32 v250, v249
v_mfma_f32_16x16x32_bf16 v[16:19], a[152:155], v[176:179], v[16:19]
v_exp_f32 v43, v43
v_mfma_f32_16x16x32_bf16 v[16:19], a[148:151], v[172:175], v[16:19]
v_cvt_pk_bf16_f32 v73, v42, v43
v_permlane16_swap_b32 v249, v250
v_mfma_f32_16x16x32_bf16 v[16:19], a[144:147], v[168:171], v[16:19]
v_exp_f32 v44, v44
v_mfma_f32_16x16x32_bf16 v[24:27], a[144:147], v[184:187], v[144:147]
buffer_load_dword v253, v246, s[24:27], 0 offen sc0 sc1
v_mfma_f32_16x16x32_bf16 v[24:27], a[148:151], v[188:191], v[24:27]
v_exp_f32 v45, v45
v_mfma_f32_16x16x32_bf16 v[24:27], a[152:155], v[192:195], v[24:27]
s_add_u32 m0, s30, 131072
v_cvt_pk_bf16_f32 v74, v44, v45
v_mfma_f32_16x16x32_bf16 v[24:27], a[156:159], v[196:199], v[24:27]
v_exp_f32 v46, v46
v_mfma_f32_16x16x32_bf16 v[32:35], a[156:159], v[212:215], v[148:151]
ds_read_b128 a[156:159], v219 offset:8192
v_max_u32 v249, v249, v250
v_mfma_f32_16x16x32_bf16 v[32:35], a[152:155], v[208:211], v[32:35]
v_exp_f32 v47, v47
v_mfma_f32_16x16x32_bf16 v[32:35], a[148:151], v[204:207], v[32:35]
ds_read_b128 a[152:155], v218 offset:8192
v_cvt_pk_bf16_f32 v75, v46, v47
v_mfma_f32_16x16x32_bf16 v[32:35], a[144:147], v[200:203], v[32:35]
v_exp_f32 v48, v48
v_mfma_f32_16x16x32_bf16 a[0:3], v[88:91], a[176:179], a[0:3]
ds_read_b128 a[148:151], v217 offset:8192
ds_read_b128 a[144:147], v216 offset:8192
v_mfma_f32_16x16x32_bf16 a[4:7], v[92:95], a[176:179], a[4:7]
v_exp_f32 v49, v49
v_mfma_f32_16x16x32_bf16 a[8:11], v[96:99], a[176:179], a[8:11]
v_cvt_pk_bf16_f32 v76, v48, v49
v_mov_b32 v250, v249
v_mfma_f32_16x16x32_bf16 a[12:15], v[100:103], a[176:179], a[12:15]
v_exp_f32 v50, v50
v_mfma_f32_16x16x32_bf16 a[28:31], v[100:103], a[180:183], a[28:31]
ds_read_b64_tr_b16 a[176:177], v220 offset:57344
ds_read_b64_tr_b16 a[178:179], v220 offset:61440
v_mfma_f32_16x16x32_bf16 a[24:27], v[96:99], a[180:183], a[24:27]
v_exp_f32 v51, v51
v_mfma_f32_16x16x32_bf16 a[20:23], v[92:95], a[180:183], a[20:23]
v_cvt_pk_bf16_f32 v77, v50, v51
v_permlane32_swap_b32 v249, v250
v_mfma_f32_16x16x32_bf16 a[16:19], v[88:91], a[180:183], a[16:19]
v_exp_f32 v52, v52
v_mfma_f32_16x16x32_bf16 a[32:35], v[88:91], a[184:187], a[32:35]
ds_read_b64_tr_b16 a[180:181], v221 offset:57344
ds_read_b64_tr_b16 a[182:183], v221 offset:61440
v_mfma_f32_16x16x32_bf16 a[36:39], v[92:95], a[184:187], a[36:39]
v_exp_f32 v53, v53
v_mfma_f32_16x16x32_bf16 a[40:43], v[96:99], a[184:187], a[40:43]
v_cvt_pk_bf16_f32 v78, v52, v53
v_max_u32 v249, v249, v250
v_mfma_f32_16x16x32_bf16 a[44:47], v[100:103], a[184:187], a[44:47]
v_exp_f32 v54, v54
v_mfma_f32_16x16x32_bf16 a[60:63], v[100:103], a[188:191], a[60:63]
ds_read_b64_tr_b16 a[184:185], v222 offset:57344
ds_read_b64_tr_b16 a[186:187], v222 offset:61440
v_mfma_f32_16x16x32_bf16 a[56:59], v[96:99], a[188:191], a[56:59]
v_exp_f32 v55, v55
v_mfma_f32_16x16x32_bf16 a[52:55], v[92:95], a[188:191], a[52:55]
v_cvt_pk_bf16_f32 v79, v54, v55
v_add_u32 v251, v251, v249
v_mfma_f32_16x16x32_bf16 a[48:51], v[88:91], a[188:191], a[48:51]
v_exp_f32 v56, v56
v_smfmac_f32_16x16x64_bf16 a[128:131], a[208:211], v[88:95], v245
v_exp_f32 v57, v57
v_mfma_f32_16x16x32_bf16 v[12:15], a[160:163], v[152:155], v[136:139]
ds_read_b64_tr_b16 a[188:189], v223 offset:57344
v_cvt_pk_bf16_f32 v80, v56, v57
v_mfma_f32_16x16x32_bf16 v[12:15], a[164:167], v[156:159], v[12:15]
v_exp_f32 v58, v58
v_mfma_f32_16x16x32_bf16 v[12:15], a[168:171], v[160:163], v[12:15]
ds_read_b64_tr_b16 a[190:191], v223 offset:61440
v_sub_u32 v248, v248, v249
v_mfma_f32_16x16x32_bf16 v[12:15], a[172:175], v[164:167], v[12:15]
v_exp_f32 v59, v59
v_mfma_f32_16x16x32_bf16 v[20:23], a[172:175], v[180:183], v[140:143]
v_cvt_pk_bf16_f32 v81, v58, v59
v_cndmask_b32 v252, v252, v251, s[90:91]
v_mfma_f32_16x16x32_bf16 v[20:23], a[168:171], v[176:179], v[20:23]
v_exp_f32 v60, v60
v_mfma_f32_16x16x32_bf16 v[20:23], a[164:167], v[172:175], v[20:23]
buffer_load_dwordx4 v232, s[12:15], s39 offen offset:0  lds
v_mfma_f32_16x16x32_bf16 v[20:23], a[160:163], v[168:171], v[20:23]
v_exp_f32 v61, v61
v_mfma_f32_16x16x32_bf16 v[28:31], a[160:163], v[184:187], v[144:147]
s_lshl_b64 s[90:91], s[90:91], 1
v_cvt_pk_bf16_f32 v82, v60, v61
v_mfma_f32_16x16x32_bf16 v[28:31], a[164:167], v[188:191], v[28:31]
v_exp_f32 v62, v62
v_mfma_f32_16x16x32_bf16 v[28:31], a[168:171], v[192:195], v[28:31]
buffer_load_dwordx4 v233, s[12:15], s39 offen offset:1024  lds
v_mfma_f32_16x16x32_bf16 v[28:31], a[172:175], v[196:199], v[28:31]
v_exp_f32 v63, v63
v_mfma_f32_16x16x32_bf16 v[36:39], a[172:175], v[212:215], v[148:151]
ds_read_b128 a[172:175], v219 offset:12288
v_cvt_pk_bf16_f32 v83, v62, v63
v_mfma_f32_16x16x32_bf16 v[36:39], a[168:171], v[208:211], v[36:39]
v_exp_f32 v64, v64
v_mfma_f32_16x16x32_bf16 v[36:39], a[164:167], v[204:207], v[36:39]
ds_read_b128 a[168:171], v218 offset:12288
ds_read_b128 a[164:167], v217 offset:12288
v_mfma_f32_16x16x32_bf16 v[36:39], a[160:163], v[200:203], v[36:39]
v_exp_f32 v65, v65
s_waitcnt lgkmcnt(8)
v_mfma_f32_16x16x32_bf16 a[64:67], v[88:91], a[192:195], a[64:67]
ds_read_b128 a[160:163], v216 offset:12288
v_cvt_pk_bf16_f32 v84, v64, v65
v_mfma_f32_16x16x32_bf16 a[68:71], v[92:95], a[192:195], a[68:71]
v_exp_f32 v66, v66
v_mfma_f32_16x16x32_bf16 a[72:75], v[96:99], a[192:195], a[72:75]
buffer_load_dwordx4 v232, s[12:15], s39 offen offset:2048  lds
v_mfma_f32_16x16x32_bf16 a[76:79], v[100:103], a[192:195], a[76:79]
v_exp_f32 v67, v67
v_mfma_f32_16x16x32_bf16 a[92:95], v[100:103], a[196:199], a[92:95]
ds_read_b64_tr_b16 a[192:193], v224 offset:57344
v_cvt_pk_bf16_f32 v85, v66, v67
v_mfma_f32_16x16x32_bf16 a[88:91], v[96:99], a[196:199], a[88:91]
v_max_u32_dpp v250, v248, v248 row_ror:8 row_mask:0xf bank_mask:0xf
v_exp_f32 v68, v68
v_mfma_f32_16x16x32_bf16 a[84:87], v[92:95], a[196:199], a[84:87]
ds_read_b64_tr_b16 a[194:195], v224 offset:61440
v_mfma_f32_16x16x32_bf16 a[80:83], v[88:91], a[196:199], a[80:83]
v_exp_f32 v69, v69
v_mfma_f32_16x16x32_bf16 a[96:99], v[88:91], a[200:203], a[96:99]
ds_read_b64_tr_b16 a[196:197], v225 offset:57344
v_cvt_pk_bf16_f32 v86, v68, v69
v_mfma_f32_16x16x32_bf16 a[100:103], v[92:95], a[200:203], a[100:103]
v_exp_f32 v70, v70
v_mfma_f32_16x16x32_bf16 a[104:107], v[96:99], a[200:203], a[104:107]
ds_read_b64_tr_b16 a[198:199], v225 offset:61440
v_max_u32_dpp v249, v250, v250 row_ror:4 row_mask:0xf bank_mask:0xf
v_mfma_f32_16x16x32_bf16 a[108:111], v[100:103], a[200:203], a[108:111]
v_exp_f32 v71, v71
v_mfma_f32_16x16x32_bf16 a[124:127], v[100:103], a[204:207], a[124:127]
ds_read_b64_tr_b16 a[200:201], v226 offset:57344
v_cvt_pk_bf16_f32 v87, v70, v71
v_mfma_f32_16x16x32_bf16 a[120:123], v[96:99], a[204:207], a[120:123]
ds_read_b64_tr_b16 a[202:203], v226 offset:61440
v_max_u32_dpp v250, v249, v249 row_ror:2 row_mask:0xf bank_mask:0xf
v_mfma_f32_16x16x32_bf16 a[116:119], v[92:95], a[204:207], a[116:119]
buffer_load_dwordx4 v233, s[12:15], s39 offen offset:3072  lds
v_mfma_f32_16x16x32_bf16 a[112:115], v[88:91], a[204:207], a[112:115]
ds_read_b64_tr_b16 a[204:205], v227 offset:57344
ds_read_b64_tr_b16 a[206:207], v227 offset:61440
v_smfmac_f32_16x16x64_bf16 a[132:135], a[208:211], v[96:103], v245
s_add_u32 m0, s86, 57344
s_add_u32 s50, s84, 3538944
buffer_load_dwordx4 v240, s[68:71], s50 offen lds
s_add_u32 m0, s86, 61440
s_add_u32 s50, s84, 4128768
buffer_load_dwordx4 v240, s[68:71], s50 offen lds
v_mfma_f32_16x16x32_bf16 v[40:43], a[144:147], v[152:155], v[136:139]
v_exp_f32 v8, v8
v_mfma_f32_16x16x32_bf16 v[40:43], a[148:151], v[156:159], v[40:43]
v_exp_f32 v9, v9
v_mfma_f32_16x16x32_bf16 v[40:43], a[152:155], v[160:163], v[40:43]
v_cvt_pk_bf16_f32 v88, v8, v9
v_max_u32_dpp v249, v250, v250 row_ror:1 row_mask:0xf bank_mask:0xf
v_mfma_f32_16x16x32_bf16 v[40:43], a[156:159], v[164:167], v[40:43]
v_exp_f32 v10, v10
v_mfma_f32_16x16x32_bf16 v[48:51], a[156:159], v[180:183], v[140:143]
v_mov_b32 v250, v249
v_mfma_f32_16x16x32_bf16 v[48:51], a[152:155], v[176:179], v[48:51]
v_exp_f32 v11, v11
v_mfma_f32_16x16x32_bf16 v[48:51], a[148:151], v[172:175], v[48:51]
v_cvt_pk_bf16_f32 v89, v10, v11
v_permlane16_swap_b32 v249, v250
v_mfma_f32_16x16x32_bf16 v[48:51], a[144:147], v[168:171], v[48:51]
v_exp_f32 v12, v12
v_mfma_f32_16x16x32_bf16 v[56:59], a[144:147], v[184:187], v[144:147]
v_max_u32 v249, v249, v250
v_mov_b32 v250, v249
v_mfma_f32_16x16x32_bf16 v[56:59], a[148:151], v[188:191], v[56:59]
v_exp_f32 v13, v13
v_mfma_f32_16x16x32_bf16 v[56:59], a[152:155], v[192:195], v[56:59]
v_cvt_pk_bf16_f32 v90, v12, v13
v_permlane32_swap_b32 v249, v250
v_mfma_f32_16x16x32_bf16 v[56:59], a[156:159], v[196:199], v[56:59]
v_exp_f32 v14, v14
v_mfma_f32_16x16x32_bf16 v[64:67], a[156:159], v[212:215], v[148:151]
s_waitcnt vmcnt(13) lgkmcnt(0)
s_barrier
v_mfma_f32_16x16x32_bf16 v[64:67], a[152:155], v[208:211], v[64:67]
v_exp_f32 v15, v15
v_mfma_f32_16x16x32_bf16 v[64:67], a[148:151], v[204:207], v[64:67]
ds_read_b128 a[156:159], v219 offset:16384
v_cvt_pk_bf16_f32 v91, v14, v15
v_mfma_f32_16x16x32_bf16 v[64:67], a[144:147], v[200:203], v[64:67]
v_exp_f32 v16, v16
v_mfma_f32_16x16x32_bf16 a[0:3], v[72:75], a[176:179], a[0:3]
ds_read_b128 a[152:155], v218 offset:16384
ds_read_b128 a[148:151], v217 offset:16384
v_mfma_f32_16x16x32_bf16 a[4:7], v[76:79], a[176:179], a[4:7]
v_exp_f32 v17, v17
v_mfma_f32_16x16x32_bf16 a[8:11], v[80:83], a[176:179], a[8:11]
ds_read_b128 a[144:147], v216 offset:16384
v_cvt_pk_bf16_f32 v92, v16, v17
v_mfma_f32_16x16x32_bf16 a[12:15], v[84:87], a[176:179], a[12:15]
v_exp_f32 v18, v18
v_mfma_f32_16x16x32_bf16 a[28:31], v[84:87], a[180:183], a[28:31]
ds_read_b64_tr_b16 a[176:177], v220 offset:0
ds_read_b64_tr_b16 a[178:179], v220 offset:4096
v_mfma_f32_16x16x32_bf16 a[24:27], v[80:83], a[180:183], a[24:27]
v_exp_f32 v19, v19
v_mfma_f32_16x16x32_bf16 a[20:23], v[76:79], a[180:183], a[20:23]
s_add_u32 s32, s32, 16384
v_cvt_pk_bf16_f32 v93, v18, v19
v_mfma_f32_16x16x32_bf16 a[16:19], v[72:75], a[180:183], a[16:19]
v_exp_f32 v20, v20
v_mfma_f32_16x16x32_bf16 a[32:35], v[72:75], a[184:187], a[32:35]
ds_read_b64_tr_b16 a[180:181], v221 offset:0
ds_read_b64_tr_b16 a[182:183], v221 offset:4096
v_mfma_f32_16x16x32_bf16 a[36:39], v[76:79], a[184:187], a[36:39]
v_exp_f32 v21, v21
v_mfma_f32_16x16x32_bf16 a[40:43], v[80:83], a[184:187], a[40:43]
s_add_u32 m0, s30, 65536
v_cvt_pk_bf16_f32 v94, v20, v21
v_mfma_f32_16x16x32_bf16 a[44:47], v[84:87], a[184:187], a[44:47]
v_exp_f32 v22, v22
v_mfma_f32_16x16x32_bf16 a[60:63], v[84:87], a[188:191], a[60:63]
ds_read_b64_tr_b16 a[184:185], v222 offset:0
ds_read_b64_tr_b16 a[186:187], v222 offset:4096
v_mfma_f32_16x16x32_bf16 a[56:59], v[80:83], a[188:191], a[56:59]
v_max_u32 v249, v249, v250
v_exp_f32 v23, v23
v_mfma_f32_16x16x32_bf16 a[52:55], v[76:79], a[188:191], a[52:55]
v_cvt_pk_bf16_f32 v95, v22, v23
v_add_u32 v251, v251, v249
v_mfma_f32_16x16x32_bf16 a[48:51], v[72:75], a[188:191], a[48:51]
v_exp_f32 v24, v24
v_smfmac_f32_16x16x64_bf16 a[128:131], a[208:211], v[72:79], v245
v_exp_f32 v25, v25
v_mfma_f32_16x16x32_bf16 v[44:47], a[160:163], v[152:155], v[136:139]
ds_read_b64_tr_b16 a[188:189], v223 offset:0
v_cvt_pk_bf16_f32 v96, v24, v25
v_mfma_f32_16x16x32_bf16 v[44:47], a[164:167], v[156:159], v[44:47]
v_exp_f32 v26, v26
v_mfma_f32_16x16x32_bf16 v[44:47], a[168:171], v[160:163], v[44:47]
ds_read_b64_tr_b16 a[190:191], v223 offset:4096
v_sub_u32 v248, v248, v249
v_mfma_f32_16x16x32_bf16 v[44:47], a[172:175], v[164:167], v[44:47]
v_exp_f32 v27, v27
v_mfma_f32_16x16x32_bf16 v[52:55], a[172:175], v[180:183], v[140:143]
v_cvt_pk_bf16_f32 v97, v26, v27
v_cndmask_b32 v252, v252, v251, s[90:91]
v_mfma_f32_16x16x32_bf16 v[52:55], a[168:171], v[176:179], v[52:55]
v_exp_f32 v28, v28
v_mfma_f32_16x16x32_bf16 v[52:55], a[164:167], v[172:175], v[52:55]
STUB_6:
s_cbranch_execz STUB_9
buffer_load_dwordx4 v228, s[8:11], s32 offen offset:0  lds
v_mfma_f32_16x16x32_bf16 v[52:55], a[160:163], v[168:171], v[52:55]
v_exp_f32 v29, v29
v_mfma_f32_16x16x32_bf16 v[60:63], a[160:163], v[184:187], v[144:147]
s_lshl_b64 s[90:91], s[90:91], 1
v_cvt_pk_bf16_f32 v98, v28, v29
v_mfma_f32_16x16x32_bf16 v[60:63], a[164:167], v[188:191], v[60:63]
v_exp_f32 v30, v30
v_mfma_f32_16x16x32_bf16 v[60:63], a[168:171], v[192:195], v[60:63]
buffer_load_dwordx4 v229, s[8:11], s32 offen offset:1024  lds
v_mfma_f32_16x16x32_bf16 v[60:63], a[172:175], v[196:199], v[60:63]
v_exp_f32 v31, v31
v_mfma_f32_16x16x32_bf16 v[68:71], a[172:175], v[212:215], v[148:151]
ds_read_b128 a[172:175], v219 offset:20480
v_cvt_pk_bf16_f32 v99, v30, v31
v_mfma_f32_16x16x32_bf16 v[68:71], a[168:171], v[208:211], v[68:71]
v_exp_f32 v32, v32
v_mfma_f32_16x16x32_bf16 v[68:71], a[164:167], v[204:207], v[68:71]
ds_read_b128 a[168:171], v218 offset:20480
ds_read_b128 a[164:167], v217 offset:20480
v_mfma_f32_16x16x32_bf16 v[68:71], a[160:163], v[200:203], v[68:71]
v_exp_f32 v33, v33
v_mfma_f32_16x16x32_bf16 a[64:67], v[72:75], a[192:195], a[64:67]
ds_read_b128 a[160:163], v216 offset:20480
v_cvt_pk_bf16_f32 v100, v32, v33
v_mfma_f32_16x16x32_bf16 a[68:71], v[76:79], a[192:195], a[68:71]
v_exp_f32 v34, v34
v_mfma_f32_16x16x32_bf16 a[72:75], v[80:83], a[192:195], a[72:75]
buffer_load_dwordx4 v230, s[8:11], s32 offen offset:2048  lds
v_mfma_f32_16x16x32_bf16 a[76:79], v[84:87], a[192:195], a[76:79]
v_max_u32_dpp v250, v248, v248 row_ror:8 row_mask:0xf bank_mask:0xf
v_exp_f32 v35, v35
v_mfma_f32_16x16x32_bf16 a[92:95], v[84:87], a[196:199], a[92:95]
ds_read_b64_tr_b16 a[192:193], v224 offset:0
v_cvt_pk_bf16_f32 v101, v34, v35
v_mfma_f32_16x16x32_bf16 a[88:91], v[80:83], a[196:199], a[88:91]
v_exp_f32 v36, v36
v_mfma_f32_16x16x32_bf16 a[84:87], v[76:79], a[196:199], a[84:87]
ds_read_b64_tr_b16 a[194:195], v224 offset:4096
v_max_u32_dpp v249, v250, v250 row_ror:4 row_mask:0xf bank_mask:0xf
v_mfma_f32_16x16x32_bf16 a[80:83], v[72:75], a[196:199], a[80:83]
v_exp_f32 v37, v37
v_mfma_f32_16x16x32_bf16 a[96:99], v[72:75], a[200:203], a[96:99]
ds_read_b64_tr_b16 a[196:197], v225 offset:0
v_cvt_pk_bf16_f32 v102, v36, v37
v_mfma_f32_16x16x32_bf16 a[100:103], v[76:79], a[200:203], a[100:103]
v_exp_f32 v38, v38
v_mfma_f32_16x16x32_bf16 a[104:107], v[80:83], a[200:203], a[104:107]
ds_read_b64_tr_b16 a[198:199], v225 offset:4096
v_max_u32_dpp v250, v249, v249 row_ror:2 row_mask:0xf bank_mask:0xf
v_mfma_f32_16x16x32_bf16 a[108:111], v[84:87], a[200:203], a[108:111]
v_exp_f32 v39, v39
v_mfma_f32_16x16x32_bf16 a[124:127], v[84:87], a[204:207], a[124:127]
ds_read_b64_tr_b16 a[200:201], v226 offset:0
v_cvt_pk_bf16_f32 v103, v38, v39
v_mfma_f32_16x16x32_bf16 a[120:123], v[80:83], a[204:207], a[120:123]
ds_read_b64_tr_b16 a[202:203], v226 offset:4096
v_max_u32_dpp v249, v250, v250 row_ror:1 row_mask:0xf bank_mask:0xf
v_mfma_f32_16x16x32_bf16 a[116:119], v[76:79], a[204:207], a[116:119]
buffer_load_dwordx4 v231, s[8:11], s32 offen offset:3072  lds
v_mfma_f32_16x16x32_bf16 a[112:115], v[72:75], a[204:207], a[112:115]
ds_read_b64_tr_b16 a[204:205], v227 offset:0
ds_read_b64_tr_b16 a[206:207], v227 offset:4096
v_smfmac_f32_16x16x64_bf16 a[132:135], a[208:211], v[80:87], v245
v_mov_b32 v250, v249
s_waitcnt lgkmcnt(8)
v_mfma_f32_16x16x32_bf16 v[8:11], a[144:147], v[152:155], v[136:139]
v_exp_f32 v40, v40
v_mfma_f32_16x16x32_bf16 v[8:11], a[148:151], v[156:159], v[8:11]
v_exp_f32 v41, v41
v_mfma_f32_16x16x32_bf16 v[8:11], a[152:155], v[160:163], v[8:11]
v_cvt_pk_bf16_f32 v72, v40, v41
v_permlane16_swap_b32 v249, v250
v_mfma_f32_16x16x32_bf16 v[8:11], a[156:159], v[164:167], v[8:11]
v_exp_f32 v42, v42
v_mfma_f32_16x16x32_bf16 v[16:19], a[156:159], v[180:183], v[140:143]
s_add_u32 s39, s39, 16384
v_max_u32 v249, v249, v250
v_mfma_f32_16x16x32_bf16 v[16:19], a[152:155], v[176:179], v[16:19]
v_exp_f32 v43, v43
v_mfma_f32_16x16x32_bf16 v[16:19], a[148:151], v[172:175], v[16:19]
v_cvt_pk_bf16_f32 v73, v42, v43
v_mov_b32 v250, v249
v_mfma_f32_16x16x32_bf16 v[16:19], a[144:147], v[168:171], v[16:19]
v_exp_f32 v44, v44
v_mfma_f32_16x16x32_bf16 v[24:27], a[144:147], v[184:187], v[144:147]
v_permlane32_swap_b32 v249, v250
v_max_u32 v249, v249, v250
v_mfma_f32_16x16x32_bf16 v[24:27], a[148:151], v[188:191], v[24:27]
v_exp_f32 v45, v45
v_mfma_f32_16x16x32_bf16 v[24:27], a[152:155], v[192:195], v[24:27]
v_cvt_pk_bf16_f32 v74, v44, v45
v_add_u32 v251, v251, v249
v_mfma_f32_16x16x32_bf16 v[24:27], a[156:159], v[196:199], v[24:27]
v_exp_f32 v46, v46
v_mfma_f32_16x16x32_bf16 v[32:35], a[156:159], v[212:215], v[148:151]
ds_read_b128 a[156:159], v219 offset:24576
s_add_u32 m0, s30, 147456
v_mfma_f32_16x16x32_bf16 v[32:35], a[152:155], v[208:211], v[32:35]
v_exp_f32 v47, v47
v_mfma_f32_16x16x32_bf16 v[32:35], a[148:151], v[204:207], v[32:35]
ds_read_b128 a[152:155], v218 offset:24576
v_cvt_pk_bf16_f32 v75, v46, v47
v_mfma_f32_16x16x32_bf16 v[32:35], a[144:147], v[200:203], v[32:35]
v_exp_f32 v48, v48
v_mfma_f32_16x16x32_bf16 a[0:3], v[88:91], a[176:179], a[0:3]
ds_read_b128 a[148:151], v217 offset:24576
ds_read_b128 a[144:147], v216 offset:24576
v_mfma_f32_16x16x32_bf16 a[4:7], v[92:95], a[176:179], a[4:7]
v_exp_f32 v49, v49
v_mfma_f32_16x16x32_bf16 a[8:11], v[96:99], a[176:179], a[8:11]
v_cvt_pk_bf16_f32 v76, v48, v49
v_sub_u32 v248, v248, v249
v_mfma_f32_16x16x32_bf16 a[12:15], v[100:103], a[176:179], a[12:15]
v_exp_f32 v50, v50
v_mfma_f32_16x16x32_bf16 a[28:31], v[100:103], a[180:183], a[28:31]
ds_read_b64_tr_b16 a[176:177], v220 offset:8192
ds_read_b64_tr_b16 a[178:179], v220 offset:12288
v_mfma_f32_16x16x32_bf16 a[24:27], v[96:99], a[180:183], a[24:27]
v_exp_f32 v51, v51
v_mfma_f32_16x16x32_bf16 a[20:23], v[92:95], a[180:183], a[20:23]
v_cvt_pk_bf16_f32 v77, v50, v51
v_cndmask_b32 v252, v252, v251, s[90:91]
v_mfma_f32_16x16x32_bf16 a[16:19], v[88:91], a[180:183], a[16:19]
v_exp_f32 v52, v52
v_mfma_f32_16x16x32_bf16 a[32:35], v[88:91], a[184:187], a[32:35]
ds_read_b64_tr_b16 a[180:181], v221 offset:8192
ds_read_b64_tr_b16 a[182:183], v221 offset:12288
v_mfma_f32_16x16x32_bf16 a[36:39], v[92:95], a[184:187], a[36:39]
v_exp_f32 v53, v53
v_mfma_f32_16x16x32_bf16 a[40:43], v[96:99], a[184:187], a[40:43]
s_lshl_b64 s[90:91], s[90:91], 1
v_cvt_pk_bf16_f32 v78, v52, v53
v_mfma_f32_16x16x32_bf16 a[44:47], v[100:103], a[184:187], a[44:47]
v_exp_f32 v54, v54
v_mfma_f32_16x16x32_bf16 a[60:63], v[100:103], a[188:191], a[60:63]
ds_read_b64_tr_b16 a[184:185], v222 offset:8192
ds_read_b64_tr_b16 a[186:187], v222 offset:12288
v_mfma_f32_16x16x32_bf16 a[56:59], v[96:99], a[188:191], a[56:59]
v_exp_f32 v55, v55
v_mfma_f32_16x16x32_bf16 a[52:55], v[92:95], a[188:191], a[52:55]
v_cvt_pk_bf16_f32 v79, v54, v55
v_max_u32_dpp v250, v248, v248 row_ror:8 row_mask:0xf bank_mask:0xf
v_mfma_f32_16x16x32_bf16 a[48:51], v[88:91], a[188:191], a[48:51]
v_exp_f32 v56, v56
v_smfmac_f32_16x16x64_bf16 a[128:131], a[208:211], v[88:95], v245
v_exp_f32 v57, v57
v_mfma_f32_16x16x32_bf16 v[12:15], a[160:163], v[152:155], v[136:139]
ds_read_b64_tr_b16 a[188:189], v223 offset:8192
v_cvt_pk_bf16_f32 v80, v56, v57
v_mfma_f32_16x16x32_bf16 v[12:15], a[164:167], v[156:159], v[12:15]
v_exp_f32 v58, v58
v_mfma_f32_16x16x32_bf16 v[12:15], a[168:171], v[160:163], v[12:15]
ds_read_b64_tr_b16 a[190:191], v223 offset:12288
v_max_u32_dpp v249, v250, v250 row_ror:4 row_mask:0xf bank_mask:0xf
v_mfma_f32_16x16x32_bf16 v[12:15], a[172:175], v[164:167], v[12:15]
v_exp_f32 v59, v59
v_mfma_f32_16x16x32_bf16 v[20:23], a[172:175], v[180:183], v[140:143]
v_cvt_pk_bf16_f32 v81, v58, v59
v_max_u32_dpp v250, v249, v249 row_ror:2 row_mask:0xf bank_mask:0xf
v_mfma_f32_16x16x32_bf16 v[20:23], a[168:171], v[176:179], v[20:23]
v_exp_f32 v60, v60
v_mfma_f32_16x16x32_bf16 v[20:23], a[164:167], v[172:175], v[20:23]
buffer_load_dwordx4 v232, s[12:15], s39 offen offset:0  lds
v_mfma_f32_16x16x32_bf16 v[20:23], a[160:163], v[168:171], v[20:23]
v_exp_f32 v61, v61
v_mfma_f32_16x16x32_bf16 v[28:31], a[160:163], v[184:187], v[144:147]
v_cvt_pk_bf16_f32 v82, v60, v61
v_max_u32_dpp v249, v250, v250 row_ror:1 row_mask:0xf bank_mask:0xf
v_mfma_f32_16x16x32_bf16 v[28:31], a[164:167], v[188:191], v[28:31]
v_exp_f32 v62, v62
v_mfma_f32_16x16x32_bf16 v[28:31], a[168:171], v[192:195], v[28:31]
buffer_load_dwordx4 v233, s[12:15], s39 offen offset:1024  lds
v_mfma_f32_16x16x32_bf16 v[28:31], a[172:175], v[196:199], v[28:31]
v_exp_f32 v63, v63
v_mfma_f32_16x16x32_bf16 v[36:39], a[172:175], v[212:215], v[148:151]
ds_read_b128 a[172:175], v219 offset:28672
v_cvt_pk_bf16_f32 v83, v62, v63
v_mfma_f32_16x16x32_bf16 v[36:39], a[168:171], v[208:211], v[36:39]
v_exp_f32 v64, v64
v_mfma_f32_16x16x32_bf16 v[36:39], a[164:167], v[204:207], v[36:39]
ds_read_b128 a[168:171], v218 offset:28672
ds_read_b128 a[164:167], v217 offset:28672
v_mfma_f32_16x16x32_bf16 v[36:39], a[160:163], v[200:203], v[36:39]
v_exp_f32 v65, v65
s_waitcnt lgkmcnt(8)
v_mfma_f32_16x16x32_bf16 a[64:67], v[88:91], a[192:195], a[64:67]
ds_read_b128 a[160:163], v216 offset:28672
v_cvt_pk_bf16_f32 v84, v64, v65
v_mfma_f32_16x16x32_bf16 a[68:71], v[92:95], a[192:195], a[68:71]
v_exp_f32 v66, v66
v_mfma_f32_16x16x32_bf16 a[72:75], v[96:99], a[192:195], a[72:75]
buffer_load_dwordx4 v232, s[12:15], s39 offen offset:2048  lds
v_mfma_f32_16x16x32_bf16 a[76:79], v[100:103], a[192:195], a[76:79]
v_exp_f32 v67, v67
v_mfma_f32_16x16x32_bf16 a[92:95], v[100:103], a[196:199], a[92:95]
ds_read_b64_tr_b16 a[192:193], v224 offset:8192
v_cvt_pk_bf16_f32 v85, v66, v67
v_mfma_f32_16x16x32_bf16 a[88:91], v[96:99], a[196:199], a[88:91]
v_exp_f32 v68, v68
v_mfma_f32_16x16x32_bf16 a[84:87], v[92:95], a[196:199], a[84:87]
ds_read_b64_tr_b16 a[194:195], v224 offset:12288
v_mov_b32 v250, v249
v_mfma_f32_16x16x32_bf16 a[80:83], v[88:91], a[196:199], a[80:83]
v_exp_f32 v69, v69
v_mfma_f32_16x16x32_bf16 a[96:99], v[88:91], a[200:203], a[96:99]
ds_read_b64_tr_b16 a[196:197], v225 offset:8192
v_cvt_pk_bf16_f32 v86, v68, v69
v_mfma_f32_16x16x32_bf16 a[100:103], v[92:95], a[200:203], a[100:103]
v_exp_f32 v70, v70
v_mfma_f32_16x16x32_bf16 a[104:107], v[96:99], a[200:203], a[104:107]
ds_read_b64_tr_b16 a[198:199], v225 offset:12288
v_permlane16_swap_b32 v249, v250
v_mfma_f32_16x16x32_bf16 a[108:111], v[100:103], a[200:203], a[108:111]
v_exp_f32 v71, v71
v_mfma_f32_16x16x32_bf16 a[124:127], v[100:103], a[204:207], a[124:127]
ds_read_b64_tr_b16 a[200:201], v226 offset:8192
v_cvt_pk_bf16_f32 v87, v70, v71
v_mfma_f32_16x16x32_bf16 a[120:123], v[96:99], a[204:207], a[120:123]
ds_read_b64_tr_b16 a[202:203], v226 offset:12288
v_max_u32 v249, v249, v250
v_mfma_f32_16x16x32_bf16 a[116:119], v[92:95], a[204:207], a[116:119]
buffer_load_dwordx4 v233, s[12:15], s39 offen offset:3072  lds
v_mfma_f32_16x16x32_bf16 a[112:115], v[88:91], a[204:207], a[112:115]
ds_read_b64_tr_b16 a[204:205], v227 offset:8192
ds_read_b64_tr_b16 a[206:207], v227 offset:12288
v_smfmac_f32_16x16x64_bf16 a[132:135], a[208:211], v[96:103], v245
v_mov_b32 v250, v249
v_mfma_f32_16x16x32_bf16 v[40:43], a[144:147], v[152:155], v[136:139]
v_exp_f32 v8, v8
v_mfma_f32_16x16x32_bf16 v[40:43], a[148:151], v[156:159], v[40:43]
v_exp_f32 v9, v9
v_mfma_f32_16x16x32_bf16 v[40:43], a[152:155], v[160:163], v[40:43]
v_cvt_pk_bf16_f32 v88, v8, v9
v_permlane32_swap_b32 v249, v250
v_mfma_f32_16x16x32_bf16 v[40:43], a[156:159], v[164:167], v[40:43]
v_exp_f32 v10, v10
v_mfma_f32_16x16x32_bf16 v[48:51], a[156:159], v[180:183], v[140:143]
v_max_u32 v249, v249, v250
v_add_u32 v251, v251, v249
v_mfma_f32_16x16x32_bf16 v[48:51], a[152:155], v[176:179], v[48:51]
v_exp_f32 v11, v11
v_mfma_f32_16x16x32_bf16 v[48:51], a[148:151], v[172:175], v[48:51]
v_cvt_pk_bf16_f32 v89, v10, v11
v_sub_u32 v248, v248, v249
v_mfma_f32_16x16x32_bf16 v[48:51], a[144:147], v[168:171], v[48:51]
v_exp_f32 v12, v12
v_mfma_f32_16x16x32_bf16 v[56:59], a[144:147], v[184:187], v[144:147]
v_cndmask_b32 v252, v252, v251, s[90:91]
v_mfma_f32_16x16x32_bf16 v[56:59], a[148:151], v[188:191], v[56:59]
v_exp_f32 v13, v13
v_mfma_f32_16x16x32_bf16 v[56:59], a[152:155], v[192:195], v[56:59]
s_lshl_b64 s[90:91], s[90:91], 1
v_cvt_pk_bf16_f32 v90, v12, v13
v_mfma_f32_16x16x32_bf16 v[56:59], a[156:159], v[196:199], v[56:59]
v_exp_f32 v14, v14
v_mfma_f32_16x16x32_bf16 v[64:67], a[156:159], v[212:215], v[148:151]
s_waitcnt vmcnt(8) lgkmcnt(0)
s_barrier
v_mfma_f32_16x16x32_bf16 v[64:67], a[152:155], v[208:211], v[64:67]
ds_read_b64_tr_b16 a[212:213], v241 offset:0
v_exp_f32 v15, v15
v_mfma_f32_16x16x32_bf16 v[64:67], a[148:151], v[204:207], v[64:67]
ds_read_b128 a[156:159], v219 offset:49152
ds_read_b64_tr_b16 a[214:215], v241 offset:256
v_cvt_pk_bf16_f32 v91, v14, v15
v_mfma_f32_16x16x32_bf16 v[64:67], a[144:147], v[200:203], v[64:67]
ds_read_b64_tr_b16 a[216:217], v241 offset:2048
v_exp_f32 v16, v16
v_mfma_f32_16x16x32_bf16 a[0:3], v[72:75], a[176:179], a[0:3]
ds_read_b128 a[152:155], v218 offset:49152
ds_read_b128 a[148:151], v217 offset:49152
ds_read_b64_tr_b16 a[218:219], v241 offset:2304
v_mfma_f32_16x16x32_bf16 a[4:7], v[76:79], a[176:179], a[4:7]
ds_read_b64_tr_b16 a[220:221], v241 offset:4096
v_exp_f32 v17, v17
v_mfma_f32_16x16x32_bf16 a[8:11], v[80:83], a[176:179], a[8:11]
ds_read_b128 a[144:147], v216 offset:49152
ds_read_b64_tr_b16 a[222:223], v241 offset:4352
v_cvt_pk_bf16_f32 v92, v16, v17
v_mfma_f32_16x16x32_bf16 a[12:15], v[84:87], a[176:179], a[12:15]
ds_read_b64_tr_b16 a[224:225], v241 offset:6144
v_exp_f32 v18, v18
v_mfma_f32_16x16x32_bf16 a[28:31], v[84:87], a[180:183], a[28:31]
ds_read_b64_tr_b16 a[176:177], v220 offset:32768
ds_read_b64_tr_b16 a[178:179], v220 offset:36864
ds_read_b64_tr_b16 a[226:227], v241 offset:6400
v_mfma_f32_16x16x32_bf16 a[24:27], v[80:83], a[180:183], a[24:27]
ds_read_b64_tr_b16 a[228:229], v241 offset:8192
v_exp_f32 v19, v19
v_mfma_f32_16x16x32_bf16 a[20:23], v[76:79], a[180:183], a[20:23]
s_add_u32 s32, s32, 16384
ds_read_b64_tr_b16 a[230:231], v241 offset:8448
v_cvt_pk_bf16_f32 v93, v18, v19
v_mfma_f32_16x16x32_bf16 a[16:19], v[72:75], a[180:183], a[16:19]
ds_read_b64_tr_b16 a[232:233], v241 offset:10240
v_exp_f32 v20, v20
v_mfma_f32_16x16x32_bf16 a[32:35], v[72:75], a[184:187], a[32:35]
ds_read_b64_tr_b16 a[180:181], v221 offset:32768
ds_read_b64_tr_b16 a[182:183], v221 offset:36864
ds_read_b64_tr_b16 a[234:235], v241 offset:10496
v_mfma_f32_16x16x32_bf16 a[36:39], v[76:79], a[184:187], a[36:39]
ds_read_b64_tr_b16 a[236:237], v241 offset:12288
v_exp_f32 v21, v21
v_mfma_f32_16x16x32_bf16 a[40:43], v[80:83], a[184:187], a[40:43]
s_add_u32 m0, s30, 81920
ds_read_b64_tr_b16 a[238:239], v241 offset:12544
v_cvt_pk_bf16_f32 v94, v20, v21
v_mfma_f32_16x16x32_bf16 a[44:47], v[84:87], a[184:187], a[44:47]
ds_read_b64_tr_b16 a[240:241], v241 offset:14336
v_exp_f32 v22, v22
v_mfma_f32_16x16x32_bf16 a[60:63], v[84:87], a[188:191], a[60:63]
ds_read_b64_tr_b16 a[184:185], v222 offset:32768
ds_read_b64_tr_b16 a[186:187], v222 offset:36864
ds_read_b64_tr_b16 a[242:243], v241 offset:14592
v_mfma_f32_16x16x32_bf16 a[56:59], v[80:83], a[188:191], a[56:59]
ds_read_b64_tr_b16 a[244:245], v241 offset:16384
v_exp_f32 v23, v23
v_mfma_f32_16x16x32_bf16 a[52:55], v[76:79], a[188:191], a[52:55]
ds_read_b64_tr_b16 a[246:247], v241 offset:16640
ds_read_b64_tr_b16 a[248:249], v241 offset:18432
v_cvt_pk_bf16_f32 v95, v22, v23
v_mfma_f32_16x16x32_bf16 a[48:51], v[72:75], a[188:191], a[48:51]
ds_read_b64_tr_b16 a[250:251], v241 offset:18688
v_exp_f32 v24, v24
v_smfmac_f32_16x16x64_bf16 a[128:131], a[208:211], v[72:79], v245
ds_read_b64_tr_b16 a[252:253], v241 offset:20480
v_exp_f32 v25, v25
v_mfma_f32_16x16x32_bf16 v[44:47], a[160:163], v[152:155], v[136:139]
ds_read_b64_tr_b16 a[188:189], v223 offset:32768
ds_read_b64_tr_b16 a[254:255], v241 offset:20736
v_cvt_pk_bf16_f32 v96, v24, v25
v_mfma_f32_16x16x32_bf16 v[44:47], a[164:167], v[156:159], v[44:47]
ds_read_b64_tr_b16 a[136:137], v241 offset:22528
v_exp_f32 v26, v26
v_mfma_f32_16x16x32_bf16 v[44:47], a[168:171], v[160:163], v[44:47]
ds_read_b64_tr_b16 a[190:191], v223 offset:36864
ds_read_b64_tr_b16 a[138:139], v241 offset:22784
v_mfma_f32_16x16x32_bf16 v[44:47], a[172:175], v[164:167], v[44:47]
v_exp_f32 v27, v27
v_mfma_f32_16x16x32_bf16 v[52:55], a[172:175], v[180:183], v[140:143]
ds_read_b64_tr_b16 a[140:141], v241 offset:24576
v_cvt_pk_bf16_f32 v97, v26, v27
v_mfma_f32_16x16x32_bf16 v[52:55], a[168:171], v[176:179], v[52:55]
v_exp_f32 v28, v28
v_mfma_f32_16x16x32_bf16 v[52:55], a[164:167], v[172:175], v[52:55]
buffer_load_dwordx4 v228, s[8:11], s32 offen offset:0  lds
v_mfma_f32_16x16x32_bf16 v[52:55], a[160:163], v[168:171], v[52:55]
v_exp_f32 v29, v29
v_mfma_f32_16x16x32_bf16 v[60:63], a[160:163], v[184:187], v[144:147]
ds_read_b64_tr_b16 a[142:143], v241 offset:24832
v_cvt_pk_bf16_f32 v98, v28, v29
v_mfma_f32_16x16x32_bf16 v[60:63], a[164:167], v[188:191], v[60:63]
v_exp_f32 v30, v30
v_mfma_f32_16x16x32_bf16 v[60:63], a[168:171], v[192:195], v[60:63]
buffer_load_dwordx4 v229, s[8:11], s32 offen offset:1024  lds
v_mfma_f32_16x16x32_bf16 v[60:63], a[172:175], v[196:199], v[60:63]
v_exp_f32 v31, v31
v_mfma_f32_16x16x32_bf16 v[68:71], a[172:175], v[212:215], v[148:151]
ds_read_b128 a[172:175], v219 offset:53248
v_cvt_pk_bf16_f32 v99, v30, v31
v_mfma_f32_16x16x32_bf16 v[68:71], a[168:171], v[208:211], v[68:71]
v_exp_f32 v32, v32
v_mfma_f32_16x16x32_bf16 v[68:71], a[164:167], v[204:207], v[68:71]
ds_read_b128 a[168:171], v218 offset:53248
ds_read_b128 a[164:167], v217 offset:53248
v_max_u32_dpp v250, v248, v248 row_ror:8 row_mask:0xf bank_mask:0xf
v_mfma_f32_16x16x32_bf16 v[68:71], a[160:163], v[200:203], v[68:71]
v_exp_f32 v33, v33
v_mfma_f32_16x16x32_bf16 a[64:67], v[72:75], a[192:195], a[64:67]
ds_read_b128 a[160:163], v216 offset:53248
ds_read_b64_tr_b16 v[104:105], v241 offset:26624
v_cvt_pk_bf16_f32 v100, v32, v33
v_mfma_f32_16x16x32_bf16 a[68:71], v[76:79], a[192:195], a[68:71]
v_exp_f32 v34, v34
v_mfma_f32_16x16x32_bf16 a[72:75], v[80:83], a[192:195], a[72:75]
buffer_load_dwordx4 v230, s[8:11], s32 offen offset:2048  lds
v_mfma_f32_16x16x32_bf16 a[76:79], v[84:87], a[192:195], a[76:79]
v_max_u32_dpp v249, v250, v250 row_ror:4 row_mask:0xf bank_mask:0xf
v_exp_f32 v35, v35
v_mfma_f32_16x16x32_bf16 a[92:95], v[84:87], a[196:199], a[92:95]
ds_read_b64_tr_b16 a[192:193], v224 offset:32768
v_cvt_pk_bf16_f32 v101, v34, v35
v_mfma_f32_16x16x32_bf16 a[88:91], v[80:83], a[196:199], a[88:91]
ds_read_b64_tr_b16 v[106:107], v241 offset:26880
v_exp_f32 v36, v36
v_mfma_f32_16x16x32_bf16 a[84:87], v[76:79], a[196:199], a[84:87]
ds_read_b64_tr_b16 a[194:195], v224 offset:36864
ds_read_b64_tr_b16 v[108:109], v241 offset:28672
v_mfma_f32_16x16x32_bf16 a[80:83], v[72:75], a[196:199], a[80:83]
v_max_u32_dpp v250, v249, v249 row_ror:2 row_mask:0xf bank_mask:0xf
v_exp_f32 v37, v37
v_mfma_f32_16x16x32_bf16 a[96:99], v[72:75], a[200:203], a[96:99]
ds_read_b64_tr_b16 a[196:197], v225 offset:32768
v_cvt_pk_bf16_f32 v102, v36, v37
v_mfma_f32_16x16x32_bf16 a[100:103], v[76:79], a[200:203], a[100:103]
v_exp_f32 v38, v38
v_mfma_f32_16x16x32_bf16 a[104:107], v[80:83], a[200:203], a[104:107]
ds_read_b64_tr_b16 a[198:199], v225 offset:36864
ds_read_b64_tr_b16 v[110:111], v241 offset:28928
v_mfma_f32_16x16x32_bf16 a[108:111], v[84:87], a[200:203], a[108:111]
v_exp_f32 v39, v39
v_mfma_f32_16x16x32_bf16 a[124:127], v[84:87], a[204:207], a[124:127]
ds_read_b64_tr_b16 a[200:201], v226 offset:32768
v_cvt_pk_bf16_f32 v103, v38, v39
v_max_u32_dpp v249, v250, v250 row_ror:1 row_mask:0xf bank_mask:0xf
v_mfma_f32_16x16x32_bf16 a[120:123], v[80:83], a[204:207], a[120:123]
ds_read_b64_tr_b16 a[202:203], v226 offset:36864
ds_read_b64_tr_b16 v[112:113], v241 offset:30720
v_mfma_f32_16x16x32_bf16 a[116:119], v[76:79], a[204:207], a[116:119]
buffer_load_dwordx4 v231, s[8:11], s32 offen offset:3072  lds
v_mfma_f32_16x16x32_bf16 a[112:115], v[72:75], a[204:207], a[112:115]
ds_read_b64_tr_b16 a[204:205], v227 offset:32768
ds_read_b64_tr_b16 a[206:207], v227 offset:36864
v_smfmac_f32_16x16x64_bf16 a[132:135], a[208:211], v[80:87], v245
ds_read_b64_tr_b16 v[114:115], v241 offset:30976
v_mov_b32 v250, v249
s_waitcnt lgkmcnt(8)
v_mfma_f32_16x16x32_bf16 v[8:11], a[144:147], v[152:155], v[136:139]
v_exp_f32 v40, v40
v_mfma_f32_16x16x32_bf16 v[8:11], a[148:151], v[156:159], v[8:11]
v_exp_f32 v41, v41
v_mfma_f32_16x16x32_bf16 v[8:11], a[152:155], v[160:163], v[8:11]
v_and_b32 v253, 0x20202020, v253
v_cvt_pk_bf16_f32 v72, v40, v41
v_mfma_f32_16x16x32_bf16 v[8:11], a[156:159], v[164:167], v[8:11]
v_exp_f32 v42, v42
v_mfma_f32_16x16x32_bf16 v[16:19], a[156:159], v[180:183], v[140:143]
s_add_u32 s39, s39, 16384
v_permlane16_swap_b32 v249, v250
v_mfma_f32_16x16x32_bf16 v[16:19], a[152:155], v[176:179], v[16:19]
v_exp_f32 v43, v43
v_mfma_f32_16x16x32_bf16 v[16:19], a[148:151], v[172:175], v[16:19]
v_cvt_pk_bf16_f32 v73, v42, v43
v_max_u32 v249, v249, v250
v_mfma_f32_16x16x32_bf16 v[16:19], a[144:147], v[168:171], v[16:19]
v_exp_f32 v44, v44
v_mfma_f32_16x16x32_bf16 v[24:27], a[144:147], v[184:187], v[144:147]
v_cmp_ne_u32 vcc, 0x20202020, v253
s_cbranch_vccnz SP_FL
SP_FL_RET:
v_mfma_f32_16x16x32_bf16 v[24:27], a[148:151], v[188:191], v[24:27]
v_exp_f32 v45, v45
v_mfma_f32_16x16x32_bf16 v[24:27], a[152:155], v[192:195], v[24:27]
v_cvt_pk_bf16_f32 v74, v44, v45
v_mov_b32 v246, s101
v_mfma_f32_16x16x32_bf16 v[24:27], a[156:159], v[196:199], v[24:27]
v_exp_f32 v46, v46
v_mfma_f32_16x16x32_bf16 v[32:35], a[156:159], v[212:215], v[148:151]
ds_read_b128 a[156:159], v219 offset:57344
s_add_u32 m0, s30, 98304
v_mfma_f32_16x16x32_bf16 v[32:35], a[152:155], v[208:211], v[32:35]
v_mov_b32 v250, v249
v_exp_f32 v47, v47
v_mfma_f32_16x16x32_bf16 v[32:35], a[148:151], v[204:207], v[32:35]
ds_read_b128 a[152:155], v218 offset:57344
v_cvt_pk_bf16_f32 v75, v46, v47
v_mfma_f32_16x16x32_bf16 v[32:35], a[144:147], v[200:203], v[32:35]
v_exp_f32 v48, v48
v_mfma_f32_16x16x32_bf16 a[0:3], v[88:91], a[176:179], a[0:3]
ds_read_b128 a[148:151], v217 offset:57344
ds_read_b128 a[144:147], v216 offset:57344
v_mfma_f32_16x16x32_bf16 a[4:7], v[92:95], a[176:179], a[4:7]
v_permlane32_swap_b32 v249, v250
v_exp_f32 v49, v49
v_mfma_f32_16x16x32_bf16 a[8:11], v[96:99], a[176:179], a[8:11]
v_cvt_pk_bf16_f32 v76, v48, v49
v_mov_b32 v247, s47
v_mfma_f32_16x16x32_bf16 a[12:15], v[100:103], a[176:179], a[12:15]
v_exp_f32 v50, v50
v_mfma_f32_16x16x32_bf16 a[28:31], v[100:103], a[180:183], a[28:31]
ds_read_b64_tr_b16 a[176:177], v220 offset:40960
ds_read_b64_tr_b16 a[178:179], v220 offset:45056
v_mfma_f32_16x16x32_bf16 a[24:27], v[96:99], a[180:183], a[24:27]
v_exp_f32 v51, v51
v_mfma_f32_16x16x32_bf16 a[20:23], v[92:95], a[180:183], a[20:23]
v_cvt_pk_bf16_f32 v77, v50, v51
v_mov_b32 v253, 0
v_max_u32 v249, v249, v250
v_mfma_f32_16x16x32_bf16 a[16:19], v[88:91], a[180:183], a[16:19]
v_exp_f32 v52, v52
v_mfma_f32_16x16x32_bf16 a[32:35], v[88:91], a[184:187], a[32:35]
ds_read_b64_tr_b16 a[180:181], v221 offset:40960
ds_read_b64_tr_b16 a[182:183], v221 offset:45056
v_mfma_f32_16x16x32_bf16 a[36:39], v[92:95], a[184:187], a[36:39]
v_exp_f32 v53, v53
v_mfma_f32_16x16x32_bf16 a[40:43], v[96:99], a[184:187], a[40:43]
s_add_u32 s29, s40, s37
v_cvt_pk_bf16_f32 v78, v52, v53
v_mfma_f32_16x16x32_bf16 a[44:47], v[100:103], a[184:187], a[44:47]
v_add_u32 v251, v251, v249
v_exp_f32 v54, v54
v_mfma_f32_16x16x32_bf16 a[60:63], v[100:103], a[188:191], a[60:63]
ds_read_b64_tr_b16 a[184:185], v222 offset:40960
ds_read_b64_tr_b16 a[186:187], v222 offset:45056
v_mfma_f32_16x16x32_bf16 a[56:59], v[96:99], a[188:191], a[56:59]
v_exp_f32 v55, v55
v_mfma_f32_16x16x32_bf16 a[52:55], v[92:95], a[188:191], a[52:55]
v_cvt_pk_bf16_f32 v79, v54, v55
v_sub_u32 v248, v248, v249
v_mfma_f32_16x16x32_bf16 a[48:51], v[88:91], a[188:191], a[48:51]
v_exp_f32 v56, v56
v_smfmac_f32_16x16x64_bf16 a[128:131], a[208:211], v[88:95], v245
v_exp_f32 v57, v57
v_mfma_f32_16x16x32_bf16 v[12:15], a[160:163], v[152:155], v[136:139]
ds_read_b64_tr_b16 a[188:189], v223 offset:40960
v_cvt_pk_bf16_f32 v80, v56, v57
v_mfma_f32_16x16x32_bf16 v[12:15], a[164:167], v[156:159], v[12:15]
v_exp_f32 v58, v58
v_mfma_f32_16x16x32_bf16 v[12:15], a[168:171], v[160:163], v[12:15]
ds_read_b64_tr_b16 a[190:191], v223 offset:45056
v_cndmask_b32 v252, v252, v251, s[90:91]
v_mfma_f32_16x16x32_bf16 v[12:15], a[172:175], v[164:167], v[12:15]
v_exp_f32 v59, v59
v_mfma_f32_16x16x32_bf16 v[20:23], a[172:175], v[180:183], v[140:143]
s_lshl_b64 s[90:91], s[90:91], 1
v_cvt_pk_bf16_f32 v81, v58, v59
v_mfma_f32_16x16x32_bf16 v[20:23], a[168:171], v[176:179], v[20:23]
v_exp_f32 v60, v60
v_mfma_f32_16x16x32_bf16 v[20:23], a[164:167], v[172:175], v[20:23]
buffer_load_dwordx4 v232, s[12:15], s39 offen offset:0  lds
v_mfma_f32_16x16x32_bf16 v[20:23], a[160:163], v[168:171], v[20:23]
v_exp_f32 v61, v61
v_mfma_f32_16x16x32_bf16 v[28:31], a[160:163], v[184:187], v[144:147]
v_cvt_pk_bf16_f32 v82, v60, v61
v_max_u32_dpp v250, v248, v248 row_ror:8 row_mask:0xf bank_mask:0xf
v_mfma_f32_16x16x32_bf16 v[28:31], a[164:167], v[188:191], v[28:31]
v_exp_f32 v62, v62
v_mfma_f32_16x16x32_bf16 v[28:31], a[168:171], v[192:195], v[28:31]
buffer_load_dwordx4 v233, s[12:15], s39 offen offset:1024  lds
v_mfma_f32_16x16x32_bf16 v[28:31], a[172:175], v[196:199], v[28:31]
v_exp_f32 v63, v63
v_mfma_f32_16x16x32_bf16 v[36:39], a[172:175], v[212:215], v[148:151]
ds_read_b128 a[172:175], v219 offset:61440
v_cvt_pk_bf16_f32 v83, v62, v63
v_mfma_f32_16x16x32_bf16 v[36:39], a[168:171], v[208:211], v[36:39]
v_exp_f32 v64, v64
v_mfma_f32_16x16x32_bf16 v[36:39], a[164:167], v[204:207], v[36:39]
ds_read_b128 a[168:171], v218 offset:61440
ds_read_b128 a[164:167], v217 offset:61440
v_mfma_f32_16x16x32_bf16 v[36:39], a[160:163], v[200:203], v[36:39]
v_exp_f32 v65, v65
v_mfma_f32_16x16x32_bf16 a[64:67], v[88:91], a[192:195], a[64:67]
ds_read_b128 a[160:163], v216 offset:61440
v_cvt_pk_bf16_f32 v84, v64, v65
v_max_u32_dpp v249, v250, v250 row_ror:4 row_mask:0xf bank_mask:0xf
v_mfma_f32_16x16x32_bf16 a[68:71], v[92:95], a[192:195], a[68:71]
v_exp_f32 v66, v66
v_mfma_f32_16x16x32_bf16 a[72:75], v[96:99], a[192:195], a[72:75]
buffer_load_dwordx4 v232, s[12:15], s39 offen offset:2048  lds
v_mfma_f32_16x16x32_bf16 a[76:79], v[100:103], a[192:195], a[76:79]
v_exp_f32 v67, v67
s_waitcnt lgkmcnt(8)
v_mfma_f32_16x16x32_bf16 a[92:95], v[100:103], a[196:199], a[92:95]
ds_read_b64_tr_b16 a[192:193], v224 offset:40960
v_cvt_pk_bf16_f32 v85, v66, v67
v_mfma_f32_16x16x32_bf16 a[88:91], v[96:99], a[196:199], a[88:91]
v_max_u32_dpp v250, v249, v249 row_ror:2 row_mask:0xf bank_mask:0xf
v_exp_f32 v68, v68
v_mfma_f32_16x16x32_bf16 a[84:87], v[92:95], a[196:199], a[84:87]
ds_read_b64_tr_b16 a[194:195], v224 offset:45056
s_cmp_eq_u32 s29, 0
s_cselect_b32 s29, 0x24c000, -16
v_mfma_f32_16x16x32_bf16 a[80:83], v[88:91], a[196:199], a[80:83]
v_exp_f32 v69, v69
v_mfma_f32_16x16x32_bf16 a[96:99], v[88:91], a[200:203], a[96:99]
ds_read_b64_tr_b16 a[196:197], v225 offset:40960
v_cvt_pk_bf16_f32 v86, v68, v69
v_mfma_f32_16x16x32_bf16 a[100:103], v[92:95], a[200:203], a[100:103]
v_max_u32_dpp v249, v250, v250 row_ror:1 row_mask:0xf bank_mask:0xf
v_exp_f32 v70, v70
v_mfma_f32_16x16x32_bf16 a[104:107], v[96:99], a[200:203], a[104:107]
ds_read_b64_tr_b16 a[198:199], v225 offset:45056
buffer_store_dwordx2 v[246:247], v253, s[20:23], s29 offen
v_mfma_f32_16x16x32_bf16 a[108:111], v[100:103], a[200:203], a[108:111]
v_exp_f32 v71, v71
v_mfma_f32_16x16x32_bf16 a[124:127], v[100:103], a[204:207], a[124:127]
ds_read_b64_tr_b16 a[200:201], v226 offset:40960
v_cvt_pk_bf16_f32 v87, v70, v71
v_mfma_f32_16x16x32_bf16 a[120:123], v[96:99], a[204:207], a[120:123]
ds_read_b64_tr_b16 a[202:203], v226 offset:45056
v_mov_b32 v250, v249
v_mfma_f32_16x16x32_bf16 a[116:119], v[92:95], a[204:207], a[116:119]
buffer_load_dwordx4 v233, s[12:15], s39 offen offset:3072  lds
v_mfma_f32_16x16x32_bf16 a[112:115], v[88:91], a[204:207], a[112:115]
ds_read_b64_tr_b16 a[204:205], v227 offset:40960
ds_read_b64_tr_b16 a[206:207], v227 offset:45056
STUB_7:
s_cbranch_execz STUB_10
v_smfmac_f32_16x16x64_bf16 a[132:135], a[208:211], v[96:103], v245
v_permlane16_swap_b32 v249, v250
v_max_u32 v249, v249, v250
v_mfma_f32_16x16x32_bf16 v[40:43], a[144:147], v[152:155], v[136:139]
v_exp_f32 v8, v8
v_mfma_f32_16x16x32_bf16 v[40:43], a[148:151], v[156:159], v[40:43]
v_exp_f32 v9, v9
v_mfma_f32_16x16x32_bf16 v[40:43], a[152:155], v[160:163], v[40:43]
v_cvt_pk_bf16_f32 v88, v8, v9
v_mov_b32 v250, v249
v_mfma_f32_16x16x32_bf16 v[40:43], a[156:159], v[164:167], v[40:43]
v_exp_f32 v10, v10
v_mfma_f32_16x16x32_bf16 v[48:51], a[156:159], v[180:183], v[140:143]
v_permlane32_swap_b32 v249, v250
v_max_u32 v249, v249, v250
v_mfma_f32_16x16x32_bf16 v[48:51], a[152:155], v[176:179], v[48:51]
v_exp_f32 v11, v11
v_mfma_f32_16x16x32_bf16 v[48:51], a[148:151], v[172:175], v[48:51]
v_cvt_pk_bf16_f32 v89, v10, v11
v_add_u32 v251, v251, v249
v_mfma_f32_16x16x32_bf16 v[48:51], a[144:147], v[168:171], v[48:51]
v_exp_f32 v12, v12
v_mfma_f32_16x16x32_bf16 v[56:59], a[144:147], v[184:187], v[144:147]
v_cndmask_b32 v252, v252, v251, s[90:91]
v_mfma_f32_16x16x32_bf16 v[56:59], a[148:151], v[188:191], v[56:59]
v_exp_f32 v13, v13
v_mfma_f32_16x16x32_bf16 v[56:59], a[152:155], v[192:195], v[56:59]
v_cvt_pk_bf16_f32 v90, v12, v13
v_mov_b32 v236, v252
v_mfma_f32_16x16x32_bf16 v[56:59], a[156:159], v[196:199], v[56:59]
v_exp_f32 v14, v14
v_mfma_f32_16x16x32_bf16 v[64:67], a[156:159], v[212:215], v[148:151]
s_waitcnt vmcnt(9) lgkmcnt(0)
s_barrier
v_mfma_f32_16x16x32_bf16 v[64:67], a[152:155], v[208:211], v[64:67]
v_exp_f32 v15, v15
v_mfma_f32_16x16x32_bf16 v[64:67], a[148:151], v[204:207], v[64:67]
ds_read_b128 a[156:159], v219 offset:0
v_cvt_pk_bf16_f32 v91, v14, v15
v_mfma_f32_16x16x32_bf16 v[64:67], a[144:147], v[200:203], v[64:67]
v_exp_f32 v16, v16
v_mfma_f32_16x16x32_bf16 a[0:3], v[72:75], a[176:179], a[0:3]
ds_read_b128 a[152:155], v218 offset:0
ds_read_b128 a[148:151], v217 offset:0
v_mfma_f32_16x16x32_bf16 a[4:7], v[76:79], a[176:179], a[4:7]
v_exp_f32 v17, v17
v_mfma_f32_16x16x32_bf16 a[8:11], v[80:83], a[176:179], a[8:11]
ds_read_b128 a[144:147], v216 offset:0
v_cvt_pk_bf16_f32 v92, v16, v17
v_mfma_f32_16x16x32_bf16 a[12:15], v[84:87], a[176:179], a[12:15]
v_exp_f32 v18, v18
v_mfma_f32_16x16x32_bf16 a[28:31], v[84:87], a[180:183], a[28:31]
ds_read_b64_tr_b16 a[176:177], v220 offset:49152
ds_read_b64_tr_b16 a[178:179], v220 offset:53248
v_mfma_f32_16x16x32_bf16 a[24:27], v[80:83], a[180:183], a[24:27]
v_exp_f32 v19, v19
v_mfma_f32_16x16x32_bf16 a[20:23], v[76:79], a[180:183], a[20:23]
s_add_u32 s32, s32, 16384
v_cvt_pk_bf16_f32 v93, v18, v19
v_mfma_f32_16x16x32_bf16 a[16:19], v[72:75], a[180:183], a[16:19]
v_exp_f32 v20, v20
v_mfma_f32_16x16x32_bf16 a[32:35], v[72:75], a[184:187], a[32:35]
ds_read_b64_tr_b16 a[180:181], v221 offset:49152
ds_read_b64_tr_b16 a[182:183], v221 offset:53248
v_mfma_f32_16x16x32_bf16 a[36:39], v[76:79], a[184:187], a[36:39]
v_exp_f32 v21, v21
v_mfma_f32_16x16x32_bf16 a[40:43], v[80:83], a[184:187], a[40:43]
s_add_u32 m0, s30, 114688
v_cvt_pk_bf16_f32 v94, v20, v21
v_mfma_f32_16x16x32_bf16 a[44:47], v[84:87], a[184:187], a[44:47]
v_exp_f32 v22, v22
v_mfma_f32_16x16x32_bf16 a[60:63], v[84:87], a[188:191], a[60:63]
ds_read_b64_tr_b16 a[184:185], v222 offset:49152
ds_read_b64_tr_b16 a[186:187], v222 offset:53248
v_mfma_f32_16x16x32_bf16 a[56:59], v[80:83], a[188:191], a[56:59]
v_exp_f32 v23, v23
v_mfma_f32_16x16x32_bf16 a[52:55], v[76:79], a[188:191], a[52:55]
v_cvt_pk_bf16_f32 v95, v22, v23
v_and_b32 v252, 0xffff, v252
v_mfma_f32_16x16x32_bf16 a[48:51], v[72:75], a[188:191], a[48:51]
v_exp_f32 v24, v24
v_smfmac_f32_16x16x64_bf16 a[128:131], a[208:211], v[72:79], v245
v_exp_f32 v25, v25
v_mfma_f32_16x16x32_bf16 v[44:47], a[160:163], v[152:155], v[136:139]
ds_read_b64_tr_b16 a[188:189], v223 offset:49152
v_cvt_pk_bf16_f32 v96, v24, v25
v_mfma_f32_16x16x32_bf16 v[44:47], a[164:167], v[156:159], v[44:47]
v_exp_f32 v26, v26
v_mfma_f32_16x16x32_bf16 v[44:47], a[168:171], v[160:163], v[44:47]
ds_read_b64_tr_b16 a[190:191], v223 offset:53248
v_sub_u32 v252, 0xffff, v252
v_mfma_f32_16x16x32_bf16 v[44:47], a[172:175], v[164:167], v[44:47]
v_exp_f32 v27, v27
v_mfma_f32_16x16x32_bf16 v[52:55], a[172:175], v[180:183], v[140:143]
v_cvt_pk_bf16_f32 v97, v26, v27
v_mul_u32_u24 v252, 0x480, v252
v_mfma_f32_16x16x32_bf16 v[52:55], a[168:171], v[176:179], v[52:55]
v_exp_f32 v28, v28
v_mfma_f32_16x16x32_bf16 v[52:55], a[164:167], v[172:175], v[52:55]
buffer_load_dwordx4 v228, s[8:11], s32 offen offset:0  lds
v_mfma_f32_16x16x32_bf16 v[52:55], a[160:163], v[168:171], v[52:55]
v_exp_f32 v29, v29
v_mfma_f32_16x16x32_bf16 v[60:63], a[160:163], v[184:187], v[144:147]
v_cvt_pk_bf16_f32 v98, v28, v29
v_lshrrev_b32 v249, 3, v0
v_mfma_f32_16x16x32_bf16 v[60:63], a[164:167], v[188:191], v[60:63]
v_exp_f32 v30, v30
v_mfma_f32_16x16x32_bf16 v[60:63], a[168:171], v[192:195], v[60:63]
buffer_load_dwordx4 v229, s[8:11], s32 offen offset:1024  lds
v_mfma_f32_16x16x32_bf16 v[60:63], a[172:175], v[196:199], v[60:63]
v_exp_f32 v31, v31
v_mfma_f32_16x16x32_bf16 v[68:71], a[172:175], v[212:215], v[148:151]
ds_read_b128 a[172:175], v219 offset:4096
v_cvt_pk_bf16_f32 v99, v30, v31
v_mfma_f32_16x16x32_bf16 v[68:71], a[168:171], v[208:211], v[68:71]
v_exp_f32 v32, v32
v_mfma_f32_16x16x32_bf16 v[68:71], a[164:167], v[204:207], v[68:71]
ds_read_b128 a[168:171], v218 offset:4096
ds_read_b128 a[164:167], v217 offset:4096
v_mfma_f32_16x16x32_bf16 v[68:71], a[160:163], v[200:203], v[68:71]
v_exp_f32 v33, v33
v_mfma_f32_16x16x32_bf16 a[64:67], v[72:75], a[192:195], a[64:67]
ds_read_b128 a[160:163], v216 offset:4096
v_cvt_pk_bf16_f32 v100, v32, v33
v_mfma_f32_16x16x32_bf16 a[68:71], v[76:79], a[192:195], a[68:71]
v_exp_f32 v34, v34
v_mfma_f32_16x16x32_bf16 a[72:75], v[80:83], a[192:195], a[72:75]
buffer_load_dwordx4 v230, s[8:11], s32 offen offset:2048  lds
v_mfma_f32_16x16x32_bf16 a[76:79], v[84:87], a[192:195], a[76:79]
v_exp_f32 v35, v35
v_mfma_f32_16x16x32_bf16 a[92:95], v[84:87], a[196:199], a[92:95]
ds_read_b64_tr_b16 a[192:193], v224 offset:49152
v_cvt_pk_bf16_f32 v101, v34, v35
v_mfma_f32_16x16x32_bf16 a[88:91], v[80:83], a[196:199], a[88:91]
v_exp_f32 v36, v36
v_mfma_f32_16x16x32_bf16 a[84:87], v[76:79], a[196:199], a[84:87]
ds_read_b64_tr_b16 a[194:195], v224 offset:53248
v_lshl_add_u32 v252, v249, 4, v252
v_mfma_f32_16x16x32_bf16 a[80:83], v[72:75], a[196:199], a[80:83]
v_exp_f32 v37, v37
v_mfma_f32_16x16x32_bf16 a[96:99], v[72:75], a[200:203], a[96:99]
ds_read_b64_tr_b16 a[196:197], v225 offset:49152
v_cvt_pk_bf16_f32 v102, v36, v37
v_mfma_f32_16x16x32_bf16 a[100:103], v[76:79], a[200:203], a[100:103]
v_exp_f32 v38, v38
v_mfma_f32_16x16x32_bf16 a[104:107], v[80:83], a[200:203], a[104:107]
ds_read_b64_tr_b16 a[198:199], v225 offset:53248
v_mfma_f32_16x16x32_bf16 a[108:111], v[84:87], a[200:203], a[108:111]
v_exp_f32 v39, v39
v_mfma_f32_16x16x32_bf16 a[124:127], v[84:87], a[204:207], a[124:127]
ds_read_b64_tr_b16 a[200:201], v226 offset:49152
v_cvt_pk_bf16_f32 v103, v38, v39
v_mfma_f32_16x16x32_bf16 a[120:123], v[80:83], a[204:207], a[120:123]
ds_read_b64_tr_b16 a[202:203], v226 offset:53248
v_mfma_f32_16x16x32_bf16 a[116:119], v[76:79], a[204:207], a[116:119]
buffer_load_dwordx4 v231, s[8:11], s32 offen offset:3072  lds
v_mfma_f32_16x16x32_bf16 a[112:115], v[72:75], a[204:207], a[112:115]
ds_read_b64_tr_b16 a[204:205], v227 offset:49152
ds_read_b64_tr_b16 a[206:207], v227 offset:53248
v_smfmac_f32_16x16x64_bf16 a[132:135], a[208:211], v[80:87], v245
s_add_u32 m0, s86, 0
s_add_u32 s50, s84, 4718592
buffer_load_dwordx4 v240, s[64:67], s50 offen lds
s_add_u32 m0, s86, 4096
s_add_u32 s50, s84, 4718592
buffer_load_dwordx4 v240, s[68:71], s50 offen lds
s_add_u32 m0, s86, 8192
s_add_u32 s50, s85, 0
buffer_load_dwordx4 v244, s[72:75], s50 offen lds
s_add_u32 m0, s86, 12288
s_add_u32 s50, s85, 4096
buffer_load_dwordx4 v244, s[72:75], s50 offen lds
s_waitcnt lgkmcnt(8)
v_mfma_f32_16x16x32_bf16 v[8:11], a[144:147], v[152:155], v[136:139]
v_exp_f32 v40, v40
v_mfma_f32_16x16x32_bf16 v[8:11], a[148:151], v[156:159], v[8:11]
v_exp_f32 v41, v41
v_mfma_f32_16x16x32_bf16 v[8:11], a[152:155], v[160:163], v[8:11]
v_cvt_pk_bf16_f32 v72, v40, v41
v_mfma_f32_16x16x32_bf16 v[8:11], a[156:159], v[164:167], v[8:11]
v_exp_f32 v42, v42
v_mfma_f32_16x16x32_bf16 v[16:19], a[156:159], v[180:183], v[140:143]
s_add_u32 s39, s39, 16384
v_mfma_f32_16x16x32_bf16 v[16:19], a[152:155], v[176:179], v[16:19]
v_exp_f32 v43, v43
v_mfma_f32_16x16x32_bf16 v[16:19], a[148:151], v[172:175], v[16:19]
v_cvt_pk_bf16_f32 v73, v42, v43
v_mfma_f32_16x16x32_bf16 v[16:19], a[144:147], v[168:171], v[16:19]
v_exp_f32 v44, v44
v_mfma_f32_16x16x32_bf16 v[24:27], a[144:147], v[184:187], v[144:147]
s_add_u32 m0, s30, 131072
v_mfma_f32_16x16x32_bf16 v[24:27], a[148:151], v[188:191], v[24:27]
v_exp_f32 v45, v45
v_mfma_f32_16x16x32_bf16 v[24:27], a[152:155], v[192:195], v[24:27]
v_cvt_pk_bf16_f32 v74, v44, v45
v_mfma_f32_16x16x32_bf16 v[24:27], a[156:159], v[196:199], v[24:27]
v_exp_f32 v46, v46
v_mfma_f32_16x16x32_bf16 v[32:35], a[156:159], v[212:215], v[148:151]
ds_read_b128 a[156:159], v219 offset:8192
v_mfma_f32_16x16x32_bf16 v[32:35], a[152:155], v[208:211], v[32:35]
v_exp_f32 v47, v47
v_mfma_f32_16x16x32_bf16 v[32:35], a[148:151], v[204:207], v[32:35]
ds_read_b128 a[152:155], v218 offset:8192
v_cvt_pk_bf16_f32 v75, v46, v47
v_mfma_f32_16x16x32_bf16 v[32:35], a[144:147], v[200:203], v[32:35]
v_exp_f32 v48, v48
v_mfma_f32_16x16x32_bf16 a[0:3], v[88:91], a[176:179], a[0:3]
ds_read_b128 a[148:151], v217 offset:8192
ds_read_b128 a[144:147], v216 offset:8192
v_mfma_f32_16x16x32_bf16 a[4:7], v[92:95], a[176:179], a[4:7]
v_exp_f32 v49, v49
v_mfma_f32_16x16x32_bf16 a[8:11], v[96:99], a[176:179], a[8:11]
v_cvt_pk_bf16_f32 v76, v48, v49
v_mfma_f32_16x16x32_bf16 a[12:15], v[100:103], a[176:179], a[12:15]
v_exp_f32 v50, v50
v_mfma_f32_16x16x32_bf16 a[28:31], v[100:103], a[180:183], a[28:31]
ds_read_b64_tr_b16 a[176:177], v220 offset:57344
ds_read_b64_tr_b16 a[178:179], v220 offset:61440
v_mfma_f32_16x16x32_bf16 a[24:27], v[96:99], a[180:183], a[24:27]
v_exp_f32 v51, v51
v_mfma_f32_16x16x32_bf16 a[20:23], v[92:95], a[180:183], a[20:23]
v_cvt_pk_bf16_f32 v77, v50, v51
v_mfma_f32_16x16x32_bf16 a[16:19], v[88:91], a[180:183], a[16:19]
v_exp_f32 v52, v52
v_mfma_f32_16x16x32_bf16 a[32:35], v[88:91], a[184:187], a[32:35]
ds_read_b64_tr_b16 a[180:181], v221 offset:57344
ds_read_b64_tr_b16 a[182:183], v221 offset:61440
v_mfma_f32_16x16x32_bf16 a[36:39], v[92:95], a[184:187], a[36:39]
v_exp_f32 v53, v53
v_mfma_f32_16x16x32_bf16 a[40:43], v[96:99], a[184:187], a[40:43]
v_cvt_pk_bf16_f32 v78, v52, v53
v_mfma_f32_16x16x32_bf16 a[44:47], v[100:103], a[184:187], a[44:47]
v_exp_f32 v54, v54
v_mfma_f32_16x16x32_bf16 a[60:63], v[100:103], a[188:191], a[60:63]
ds_read_b64_tr_b16 a[184:185], v222 offset:57344
ds_read_b64_tr_b16 a[186:187], v222 offset:61440
v_mfma_f32_16x16x32_bf16 a[56:59], v[96:99], a[188:191], a[56:59]
v_exp_f32 v55, v55
v_mfma_f32_16x16x32_bf16 a[52:55], v[92:95], a[188:191], a[52:55]
v_cvt_pk_bf16_f32 v79, v54, v55
v_mfma_f32_16x16x32_bf16 a[48:51], v[88:91], a[188:191], a[48:51]
v_exp_f32 v56, v56
v_smfmac_f32_16x16x64_bf16 a[128:131], a[208:211], v[88:95], v245
v_exp_f32 v57, v57
v_mfma_f32_16x16x32_bf16 v[12:15], a[160:163], v[152:155], v[136:139]
ds_read_b64_tr_b16 a[188:189], v223 offset:57344
v_cvt_pk_bf16_f32 v80, v56, v57
v_mfma_f32_16x16x32_bf16 v[12:15], a[164:167], v[156:159], v[12:15]
v_exp_f32 v58, v58
v_mfma_f32_16x16x32_bf16 v[12:15], a[168:171], v[160:163], v[12:15]
ds_read_b64_tr_b16 a[190:191], v223 offset:61440
v_mfma_f32_16x16x32_bf16 v[12:15], a[172:175], v[164:167], v[12:15]
v_exp_f32 v59, v59
v_mfma_f32_16x16x32_bf16 v[20:23], a[172:175], v[180:183], v[140:143]
v_cvt_pk_bf16_f32 v81, v58, v59
v_mfma_f32_16x16x32_bf16 v[20:23], a[168:171], v[176:179], v[20:23]
v_exp_f32 v60, v60
v_mfma_f32_16x16x32_bf16 v[20:23], a[164:167], v[172:175], v[20:23]
buffer_load_dwordx4 v232, s[12:15], s39 offen offset:0  lds
v_mfma_f32_16x16x32_bf16 v[20:23], a[160:163], v[168:171], v[20:23]
v_exp_f32 v61, v61
v_mfma_f32_16x16x32_bf16 v[28:31], a[160:163], v[184:187], v[144:147]
v_cvt_pk_bf16_f32 v82, v60, v61
v_mfma_f32_16x16x32_bf16 v[28:31], a[164:167], v[188:191], v[28:31]
v_exp_f32 v62, v62
v_mfma_f32_16x16x32_bf16 v[28:31], a[168:171], v[192:195], v[28:31]
buffer_load_dwordx4 v233, s[12:15], s39 offen offset:1024  lds
v_mfma_f32_16x16x32_bf16 v[28:31], a[172:175], v[196:199], v[28:31]
v_exp_f32 v63, v63
v_mfma_f32_16x16x32_bf16 v[36:39], a[172:175], v[212:215], v[148:151]
ds_read_b128 a[172:175], v219 offset:12288
v_cvt_pk_bf16_f32 v83, v62, v63
v_mfma_f32_16x16x32_bf16 v[36:39], a[168:171], v[208:211], v[36:39]
v_exp_f32 v64, v64
v_mfma_f32_16x16x32_bf16 v[36:39], a[164:167], v[204:207], v[36:39]
ds_read_b128 a[168:171], v218 offset:12288
ds_read_b128 a[164:167], v217 offset:12288
v_mfma_f32_16x16x32_bf16 v[36:39], a[160:163], v[200:203], v[36:39]
v_exp_f32 v65, v65
s_waitcnt lgkmcnt(8)
v_mfma_f32_16x16x32_bf16 a[64:67], v[88:91], a[192:195], a[64:67]
ds_read_b128 a[160:163], v216 offset:12288
v_cvt_pk_bf16_f32 v84, v64, v65
v_mfma_f32_16x16x32_bf16 a[68:71], v[92:95], a[192:195], a[68:71]
v_exp_f32 v66, v66
v_mfma_f32_16x16x32_bf16 a[72:75], v[96:99], a[192:195], a[72:75]
buffer_load_dwordx4 v232, s[12:15], s39 offen offset:2048  lds
v_mfma_f32_16x16x32_bf16 a[76:79], v[100:103], a[192:195], a[76:79]
v_exp_f32 v67, v67
v_mfma_f32_16x16x32_bf16 a[92:95], v[100:103], a[196:199], a[92:95]
ds_read_b64_tr_b16 a[192:193], v224 offset:57344
v_cvt_pk_bf16_f32 v85, v66, v67
v_mfma_f32_16x16x32_bf16 a[88:91], v[96:99], a[196:199], a[88:91]
v_exp_f32 v68, v68
v_mfma_f32_16x16x32_bf16 a[84:87], v[92:95], a[196:199], a[84:87]
ds_read_b64_tr_b16 a[194:195], v224 offset:61440
v_mfma_f32_16x16x32_bf16 a[80:83], v[88:91], a[196:199], a[80:83]
v_exp_f32 v69, v69
v_mfma_f32_16x16x32_bf16 a[96:99], v[88:91], a[200:203], a[96:99]
ds_read_b64_tr_b16 a[196:197], v225 offset:57344
v_cvt_pk_bf16_f32 v86, v68, v69
v_mfma_f32_16x16x32_bf16 a[100:103], v[92:95], a[200:203], a[100:103]
v_exp_f32 v70, v70
v_mfma_f32_16x16x32_bf16 a[104:107], v[96:99], a[200:203], a[104:107]
ds_read_b64_tr_b16 a[198:199], v225 offset:61440
v_mfma_f32_16x16x32_bf16 a[108:111], v[100:103], a[200:203], a[108:111]
v_exp_f32 v71, v71
v_mfma_f32_16x16x32_bf16 a[124:127], v[100:103], a[204:207], a[124:127]
ds_read_b64_tr_b16 a[200:201], v226 offset:57344
v_cvt_pk_bf16_f32 v87, v70, v71
v_mfma_f32_16x16x32_bf16 a[120:123], v[96:99], a[204:207], a[120:123]
ds_read_b64_tr_b16 a[202:203], v226 offset:61440
v_mfma_f32_16x16x32_bf16 a[116:119], v[92:95], a[204:207], a[116:119]
buffer_load_dwordx4 v233, s[12:15], s39 offen offset:3072  lds
v_mfma_f32_16x16x32_bf16 a[112:115], v[88:91], a[204:207], a[112:115]
ds_read_b64_tr_b16 a[204:205], v227 offset:57344
ds_read_b64_tr_b16 a[206:207], v227 offset:61440
v_smfmac_f32_16x16x64_bf16 a[132:135], a[208:211], v[96:103], v245
s_add_u32 m0, s86, 45056
s_mov_b32 s50, 29360128
buffer_load_dwordx4 v252, s[20:23], s50 offen sc0 sc1 lds
s_add_u32 m0, s86, 49152
s_mov_b32 s50, 29360640
buffer_load_dwordx4 v252, s[20:23], s50 offen sc0 sc1 lds
s_add_u32 m0, s86, 53248
s_mov_b32 s50, 29361152
buffer_load_dwordx4 v252, s[20:23], s50 offen sc0 sc1 lds
s_add_u32 m0, s86, 16384
s_add_u32 s50, s85, 8192
buffer_load_dwordx4 v244, s[72:75], s50 offen lds
v_mfma_f32_16x16x32_bf16 v[40:43], a[144:147], v[152:155], v[136:139]
v_mov_b32 v248, v236
v_exp_f32 v8, v8
v_mfma_f32_16x16x32_bf16 v[40:43], a[148:151], v[156:159], v[40:43]
v_mov_b32 v249, s47
v_exp_f32 v9, v9
v_mfma_f32_16x16x32_bf16 v[40:43], a[152:155], v[160:163], v[40:43]
v_cvt_pk_bf16_f32 v88, v8, v9
v_and_b32 v250, 7, v1
v_lshlrev_b32 v250, 3, v250
v_mfma_f32_16x16x32_bf16 v[40:43], a[156:159], v[164:167], v[40:43]
s_add_u32 s29, s40, s37
v_exp_f32 v10, v10
v_mfma_f32_16x16x32_bf16 v[48:51], a[156:159], v[180:183], v[140:143]
s_cmp_eq_u32 s29, 0
s_mov_b32 s29, 0x7ffffff0
s_cselect_b32 s29, 0x242800, s29
v_mfma_f32_16x16x32_bf16 v[48:51], a[152:155], v[176:179], v[48:51]
v_exp_f32 v11, v11
v_mfma_f32_16x16x32_bf16 v[48:51], a[148:151], v[172:175], v[48:51]
v_cvt_pk_bf16_f32 v89, v10, v11
v_mfma_f32_16x16x32_bf16 v[48:51], a[144:147], v[168:171], v[48:51]
v_exp_f32 v12, v12
v_mfma_f32_16x16x32_bf16 v[56:59], a[144:147], v[184:187], v[144:147]
v_mfma_f32_16x16x32_bf16 v[56:59], a[148:151], v[188:191], v[56:59]
v_exp_f32 v13, v13
v_mfma_f32_16x16x32_bf16 v[56:59], a[152:155], v[192:195], v[56:59]
v_cvt_pk_bf16_f32 v90, v12, v13
v_mfma_f32_16x16x32_bf16 v[56:59], a[156:159], v[196:199], v[56:59]
v_exp_f32 v14, v14
v_mfma_f32_16x16x32_bf16 v[64:67], a[156:159], v[212:215], v[148:151]
s_waitcnt vmcnt(16) lgkmcnt(0)
s_barrier
v_mfma_f32_16x16x32_bf16 v[64:67], a[152:155], v[208:211], v[64:67]
v_exp_f32 v15, v15
v_mfma_f32_16x16x32_bf16 v[64:67], a[148:151], v[204:207], v[64:67]
ds_read_b128 a[156:159], v219 offset:16384
v_cvt_pk_bf16_f32 v91, v14, v15
v_mfma_f32_16x16x32_bf16 v[64:67], a[144:147], v[200:203], v[64:67]
v_exp_f32 v16, v16
v_mfma_f32_16x16x32_bf16 a[0:3], v[72:75], a[176:179], a[0:3]
ds_read_b128 a[152:155], v218 offset:16384
ds_read_b128 a[148:151], v217 offset:16384
v_mfma_f32_16x16x32_bf16 a[4:7], v[76:79], a[176:179], a[4:7]
v_exp_f32 v17, v17
v_mfma_f32_16x16x32_bf16 a[8:11], v[80:83], a[176:179], a[8:11]
ds_read_b128 a[144:147], v216 offset:16384
v_cvt_pk_bf16_f32 v92, v16, v17
v_mfma_f32_16x16x32_bf16 a[12:15], v[84:87], a[176:179], a[12:15]
v_exp_f32 v18, v18
v_mfma_f32_16x16x32_bf16 a[28:31], v[84:87], a[180:183], a[28:31]
ds_read_b64_tr_b16 a[176:177], v220 offset:0
ds_read_b64_tr_b16 a[178:179], v220 offset:4096
v_mfma_f32_16x16x32_bf16 a[24:27], v[80:83], a[180:183], a[24:27]
v_exp_f32 v19, v19
v_mfma_f32_16x16x32_bf16 a[20:23], v[76:79], a[180:183], a[20:23]
s_add_u32 s32, s32, 16384
v_cvt_pk_bf16_f32 v93, v18, v19
v_mfma_f32_16x16x32_bf16 a[16:19], v[72:75], a[180:183], a[16:19]
v_exp_f32 v20, v20
v_mfma_f32_16x16x32_bf16 a[32:35], v[72:75], a[184:187], a[32:35]
ds_read_b64_tr_b16 a[180:181], v221 offset:0
ds_read_b64_tr_b16 a[182:183], v221 offset:4096
v_mfma_f32_16x16x32_bf16 a[36:39], v[76:79], a[184:187], a[36:39]
v_exp_f32 v21, v21
v_mfma_f32_16x16x32_bf16 a[40:43], v[80:83], a[184:187], a[40:43]
s_add_u32 m0, s30, 65536
v_cvt_pk_bf16_f32 v94, v20, v21
v_mfma_f32_16x16x32_bf16 a[44:47], v[84:87], a[184:187], a[44:47]
v_exp_f32 v22, v22
v_mfma_f32_16x16x32_bf16 a[60:63], v[84:87], a[188:191], a[60:63]
ds_read_b64_tr_b16 a[184:185], v222 offset:0
ds_read_b64_tr_b16 a[186:187], v222 offset:4096
v_mfma_f32_16x16x32_bf16 a[56:59], v[80:83], a[188:191], a[56:59]
v_exp_f32 v23, v23
v_mfma_f32_16x16x32_bf16 a[52:55], v[76:79], a[188:191], a[52:55]
buffer_store_dwordx2 v[248:249], v250, s[20:23], s29 offen sc0 sc1
v_cvt_pk_bf16_f32 v95, v22, v23
v_mfma_f32_16x16x32_bf16 a[48:51], v[72:75], a[188:191], a[48:51]
v_ashrrev_i32 v246, 31, v236
v_exp_f32 v24, v24
v_smfmac_f32_16x16x64_bf16 a[128:131], a[208:211], v[72:79], v245
v_not_b32 v246, v246
v_exp_f32 v25, v25
v_mfma_f32_16x16x32_bf16 v[44:47], a[160:163], v[152:155], v[136:139]
ds_read_b64_tr_b16 a[188:189], v223 offset:0
v_cvt_pk_bf16_f32 v96, v24, v25
v_or_b32 v246, 0x80000000, v246
v_mfma_f32_16x16x32_bf16 v[44:47], a[164:167], v[156:159], v[44:47]
v_xor_b32 v236, v236, v246
v_exp_f32 v26, v26
v_mfma_f32_16x16x32_bf16 v[44:47], a[168:171], v[160:163], v[44:47]
ds_read_b64_tr_b16 a[190:191], v223 offset:4096
v_and_b32 v236, 0xffff0000, v236
v_mul_f32 v236, 0xbfb8aa3b, v236
v_mfma_f32_16x16x32_bf16 v[44:47], a[172:175], v[164:167], v[44:47]
v_exp_f32 v27, v27
v_mfma_f32_16x16x32_bf16 v[52:55], a[172:175], v[180:183], v[140:143]
v_cvt_pk_bf16_f32 v97, v26, v27
v_exp_f32 v236, v236
v_mfma_f32_16x16x32_bf16 v[52:55], a[168:171], v[176:179], v[52:55]
v_add_f32 v236, 1.0, v236
v_exp_f32 v28, v28
v_mfma_f32_16x16x32_bf16 v[52:55], a[164:167], v[172:175], v[52:55]
buffer_load_dwordx4 v228, s[8:11], s32 offen offset:0  lds
v_mfma_f32_16x16x32_bf16 v[52:55], a[160:163], v[168:171], v[52:55]
v_exp_f32 v29, v29
v_mfma_f32_16x16x32_bf16 v[60:63], a[160:163], v[184:187], v[144:147]
v_cvt_pk_bf16_f32 v98, v28, v29
v_rcp_f32 v236, v236
v_mfma_f32_16x16x32_bf16 v[60:63], a[164:167], v[188:191], v[60:63]
v_cvt_pk_bf16_f32 v236, v236, v236
v_exp_f32 v30, v30
v_mfma_f32_16x16x32_bf16 v[60:63], a[168:171], v[192:195], v[60:63]
buffer_load_dwordx4 v229, s[8:11], s32 offen offset:1024  lds
v_lshlrev_b32 v236, 16, v236
v_mfma_f32_16x16x32_bf16 v[60:63], a[172:175], v[196:199], v[60:63]
v_exp_f32 v31, v31
v_mfma_f32_16x16x32_bf16 v[68:71], a[172:175], v[212:215], v[148:151]
ds_read_b128 a[172:175], v219 offset:20480
s_lshr_b32 s28, s37, 1
v_cvt_pk_bf16_f32 v99, v30, v31
v_mfma_f32_16x16x32_bf16 v[68:71], a[168:171], v[208:211], v[68:71]
v_exp_f32 v32, v32
v_mfma_f32_16x16x32_bf16 v[68:71], a[164:167], v[204:207], v[68:71]
ds_read_b128 a[168:171], v218 offset:20480
ds_read_b128 a[164:167], v217 offset:20480
v_mfma_f32_16x16x32_bf16 v[68:71], a[160:163], v[200:203], v[68:71]
v_exp_f32 v33, v33
v_mfma_f32_16x16x32_bf16 a[64:67], v[72:75], a[192:195], a[64:67]
ds_read_b128 a[160:163], v216 offset:20480
s_mul_i32 s28, s28, 28672
v_cvt_pk_bf16_f32 v100, v32, v33
v_mfma_f32_16x16x32_bf16 a[68:71], v[76:79], a[192:195], a[68:71]
v_exp_f32 v34, v34
v_mfma_f32_16x16x32_bf16 a[72:75], v[80:83], a[192:195], a[72:75]
buffer_load_dwordx4 v230, s[8:11], s32 offen offset:2048  lds
v_mfma_f32_16x16x32_bf16 a[76:79], v[84:87], a[192:195], a[76:79]
v_exp_f32 v35, v35
v_mfma_f32_16x16x32_bf16 a[92:95], v[84:87], a[196:199], a[92:95]
ds_read_b64_tr_b16 a[192:193], v224 offset:0
v_cvt_pk_bf16_f32 v101, v34, v35
v_mfma_f32_16x16x32_bf16 a[88:91], v[80:83], a[196:199], a[88:91]
v_subrev_u32 v241, s28, v241
v_exp_f32 v36, v36
v_mfma_f32_16x16x32_bf16 a[84:87], v[76:79], a[196:199], a[84:87]
ds_read_b64_tr_b16 a[194:195], v224 offset:4096
v_and_b32 v239, 7, v1
v_mfma_f32_16x16x32_bf16 a[80:83], v[72:75], a[196:199], a[80:83]
v_exp_f32 v37, v37
v_mfma_f32_16x16x32_bf16 a[96:99], v[72:75], a[200:203], a[96:99]
ds_read_b64_tr_b16 a[196:197], v225 offset:0
v_cvt_pk_bf16_f32 v102, v36, v37
v_mfma_f32_16x16x32_bf16 a[100:103], v[76:79], a[200:203], a[100:103]
v_exp_f32 v38, v38
v_mfma_f32_16x16x32_bf16 a[104:107], v[80:83], a[200:203], a[104:107]
ds_read_b64_tr_b16 a[198:199], v225 offset:4096
v_lshl_add_u32 v239, v4, 3, v239
v_mfma_f32_16x16x32_bf16 a[108:111], v[84:87], a[200:203], a[108:111]
v_exp_f32 v39, v39
v_mfma_f32_16x16x32_bf16 a[124:127], v[84:87], a[204:207], a[124:127]
ds_read_b64_tr_b16 a[200:201], v226 offset:0
v_cvt_pk_bf16_f32 v103, v38, v39
v_mfma_f32_16x16x32_bf16 a[120:123], v[80:83], a[204:207], a[120:123]
ds_read_b64_tr_b16 a[202:203], v226 offset:4096
v_lshlrev_b32 v239, 4, v239
v_mfma_f32_16x16x32_bf16 a[116:119], v[76:79], a[204:207], a[116:119]
buffer_load_dwordx4 v231, s[8:11], s32 offen offset:3072  lds
v_mfma_f32_16x16x32_bf16 a[112:115], v[72:75], a[204:207], a[112:115]
ds_read_b64_tr_b16 a[204:205], v227 offset:0
ds_read_b64_tr_b16 a[206:207], v227 offset:4096
v_smfmac_f32_16x16x64_bf16 a[132:135], a[208:211], v[80:87], v245
s_add_u32 m0, s86, 20480
s_add_u32 s50, s85, 12288
buffer_load_dwordx4 v244, s[72:75], s50 offen lds
s_add_u32 m0, s86, 24576
s_add_u32 s50, s85, 16384
buffer_load_dwordx4 v244, s[72:75], s50 offen lds
s_add_u32 m0, s86, 28672
s_add_u32 s50, s85, 20480
buffer_load_dwordx4 v244, s[72:75], s50 offen lds
s_waitcnt lgkmcnt(8)
v_mfma_f32_16x16x32_bf16 v[8:11], a[144:147], v[152:155], v[136:139]
v_exp_f32 v40, v40
v_mfma_f32_16x16x32_bf16 v[8:11], a[148:151], v[156:159], v[8:11]
v_exp_f32 v41, v41
v_mfma_f32_16x16x32_bf16 v[8:11], a[152:155], v[160:163], v[8:11]
v_cvt_pk_bf16_f32 v72, v40, v41
v_add_u32 v237, s31, v244
v_mfma_f32_16x16x32_bf16 v[8:11], a[156:159], v[164:167], v[8:11]
v_exp_f32 v42, v42
v_mfma_f32_16x16x32_bf16 v[16:19], a[156:159], v[180:183], v[140:143]
s_add_u32 s39, s39, 16384
v_lshl_add_u32 v238, v4, 3, v3
v_mfma_f32_16x16x32_bf16 v[16:19], a[152:155], v[176:179], v[16:19]
v_exp_f32 v43, v43
v_mfma_f32_16x16x32_bf16 v[16:19], a[148:151], v[172:175], v[16:19]
v_cvt_pk_bf16_f32 v73, v42, v43
v_lshlrev_b32 v238, 4, v238
v_mfma_f32_16x16x32_bf16 v[16:19], a[144:147], v[168:171], v[16:19]
v_exp_f32 v44, v44
v_mfma_f32_16x16x32_bf16 v[24:27], a[144:147], v[184:187], v[144:147]
v_mov_b32 v246, 0x7ffffff0
v_cmp_lt_u32 vcc, 7, v3
v_mfma_f32_16x16x32_bf16 v[24:27], a[148:151], v[188:191], v[24:27]
v_exp_f32 v45, v45
v_mfma_f32_16x16x32_bf16 v[24:27], a[152:155], v[192:195], v[24:27]
s_add_u32 m0, s30, 147456
v_cvt_pk_bf16_f32 v74, v44, v45
v_mfma_f32_16x16x32_bf16 v[24:27], a[156:159], v[196:199], v[24:27]
v_exp_f32 v46, v46
v_mfma_f32_16x16x32_bf16 v[32:35], a[156:159], v[212:215], v[148:151]
ds_read_b128 a[156:159], v219 offset:24576
v_cndmask_b32 v238, v238, v246, vcc
v_mfma_f32_16x16x32_bf16 v[32:35], a[152:155], v[208:211], v[32:35]
v_exp_f32 v47, v47
v_mfma_f32_16x16x32_bf16 v[32:35], a[148:151], v[204:207], v[32:35]
ds_read_b128 a[152:155], v218 offset:24576
v_cvt_pk_bf16_f32 v75, v46, v47
v_mfma_f32_16x16x32_bf16 v[32:35], a[144:147], v[200:203], v[32:35]
v_exp_f32 v48, v48
v_mfma_f32_16x16x32_bf16 a[0:3], v[88:91], a[176:179], a[0:3]
ds_read_b128 a[148:151], v217 offset:24576
ds_read_b128 a[144:147], v216 offset:24576
v_mfma_f32_16x16x32_bf16 a[4:7], v[92:95], a[176:179], a[4:7]
v_exp_f32 v49, v49
v_mfma_f32_16x16x32_bf16 a[8:11], v[96:99], a[176:179], a[8:11]
s_mul_i32 s28, s40, 18432
v_cvt_pk_bf16_f32 v76, v48, v49
v_mfma_f32_16x16x32_bf16 a[12:15], v[100:103], a[176:179], a[12:15]
v_exp_f32 v50, v50
v_mfma_f32_16x16x32_bf16 a[28:31], v[100:103], a[180:183], a[28:31]
ds_read_b64_tr_b16 a[176:177], v220 offset:8192
ds_read_b64_tr_b16 a[178:179], v220 offset:12288
v_mfma_f32_16x16x32_bf16 a[24:27], v[96:99], a[180:183], a[24:27]
v_exp_f32 v51, v51
v_mfma_f32_16x16x32_bf16 a[20:23], v[92:95], a[180:183], a[20:23]
s_mul_i32 s29, s37, 4608
v_cvt_pk_bf16_f32 v77, v50, v51
v_mfma_f32_16x16x32_bf16 a[16:19], v[88:91], a[180:183], a[16:19]
v_exp_f32 v52, v52
v_mfma_f32_16x16x32_bf16 a[32:35], v[88:91], a[184:187], a[32:35]
ds_read_b64_tr_b16 a[180:181], v221 offset:8192
ds_read_b64_tr_b16 a[182:183], v221 offset:12288
v_mfma_f32_16x16x32_bf16 a[36:39], v[92:95], a[184:187], a[36:39]
v_exp_f32 v53, v53
v_mfma_f32_16x16x32_bf16 a[40:43], v[96:99], a[184:187], a[40:43]
s_add_u32 s28, s28, s29
v_cvt_pk_bf16_f32 v78, v52, v53
v_mfma_f32_16x16x32_bf16 a[44:47], v[100:103], a[184:187], a[44:47]
v_exp_f32 v54, v54
v_mfma_f32_16x16x32_bf16 a[60:63], v[100:103], a[188:191], a[60:63]
ds_read_b64_tr_b16 a[184:185], v222 offset:8192
ds_read_b64_tr_b16 a[186:187], v222 offset:12288
v_mfma_f32_16x16x32_bf16 a[56:59], v[96:99], a[188:191], a[56:59]
v_exp_f32 v55, v55
v_mfma_f32_16x16x32_bf16 a[52:55], v[92:95], a[188:191], a[52:55]
STUB_8:
s_cbranch_execz STUB_11
s_add_u32 s28, s28, 0x2000000
v_cvt_pk_bf16_f32 v79, v54, v55
v_mfma_f32_16x16x32_bf16 a[48:51], v[88:91], a[188:191], a[48:51]
v_exp_f32 v56, v56
v_smfmac_f32_16x16x64_bf16 a[128:131], a[208:211], v[88:95], v245
v_exp_f32 v57, v57
v_mfma_f32_16x16x32_bf16 v[12:15], a[160:163], v[152:155], v[136:139]
ds_read_b64_tr_b16 a[188:189], v223 offset:8192
v_cvt_pk_bf16_f32 v80, v56, v57
v_mfma_f32_16x16x32_bf16 v[12:15], a[164:167], v[156:159], v[12:15]
v_exp_f32 v58, v58
v_mfma_f32_16x16x32_bf16 v[12:15], a[168:171], v[160:163], v[12:15]
ds_read_b64_tr_b16 a[190:191], v223 offset:12288
v_mfma_f32_16x16x32_bf16 v[12:15], a[172:175], v[164:167], v[12:15]
v_exp_f32 v59, v59
v_mfma_f32_16x16x32_bf16 v[20:23], a[172:175], v[180:183], v[140:143]
v_cvt_pk_bf16_f32 v81, v58, v59
v_mfma_f32_16x16x32_bf16 v[20:23], a[168:171], v[176:179], v[20:23]
v_exp_f32 v60, v60
v_mfma_f32_16x16x32_bf16 v[20:23], a[164:167], v[172:175], v[20:23]
buffer_load_dwordx4 v232, s[12:15], s39 offen offset:0  lds
v_mfma_f32_16x16x32_bf16 v[20:23], a[160:163], v[168:171], v[20:23]
v_exp_f32 v61, v61
v_mfma_f32_16x16x32_bf16 v[28:31], a[160:163], v[184:187], v[144:147]
v_cvt_pk_bf16_f32 v82, v60, v61
v_mfma_f32_16x16x32_bf16 v[28:31], a[164:167], v[188:191], v[28:31]
v_exp_f32 v62, v62
v_mfma_f32_16x16x32_bf16 v[28:31], a[168:171], v[192:195], v[28:31]
buffer_load_dwordx4 v233, s[12:15], s39 offen offset:1024  lds
v_mfma_f32_16x16x32_bf16 v[28:31], a[172:175], v[196:199], v[28:31]
v_exp_f32 v63, v63
v_mfma_f32_16x16x32_bf16 v[36:39], a[172:175], v[212:215], v[148:151]
ds_read_b128 a[172:175], v219 offset:28672
v_cvt_pk_bf16_f32 v83, v62, v63
v_mfma_f32_16x16x32_bf16 v[36:39], a[168:171], v[208:211], v[36:39]
v_exp_f32 v64, v64
v_mfma_f32_16x16x32_bf16 v[36:39], a[164:167], v[204:207], v[36:39]
ds_read_b128 a[168:171], v218 offset:28672
ds_read_b128 a[164:167], v217 offset:28672
v_mfma_f32_16x16x32_bf16 v[36:39], a[160:163], v[200:203], v[36:39]
v_exp_f32 v65, v65
s_waitcnt lgkmcnt(8)
v_mfma_f32_16x16x32_bf16 a[64:67], v[88:91], a[192:195], a[64:67]
ds_read_b128 a[160:163], v216 offset:28672
v_cvt_pk_bf16_f32 v84, v64, v65
v_mfma_f32_16x16x32_bf16 a[68:71], v[92:95], a[192:195], a[68:71]
v_exp_f32 v66, v66
v_mfma_f32_16x16x32_bf16 a[72:75], v[96:99], a[192:195], a[72:75]
buffer_load_dwordx4 v232, s[12:15], s39 offen offset:2048  lds
v_mfma_f32_16x16x32_bf16 a[76:79], v[100:103], a[192:195], a[76:79]
v_exp_f32 v67, v67
v_mfma_f32_16x16x32_bf16 a[92:95], v[100:103], a[196:199], a[92:95]
ds_read_b64_tr_b16 a[192:193], v224 offset:8192
v_cvt_pk_bf16_f32 v85, v66, v67
v_mfma_f32_16x16x32_bf16 a[88:91], v[96:99], a[196:199], a[88:91]
v_exp_f32 v68, v68
v_mfma_f32_16x16x32_bf16 a[84:87], v[92:95], a[196:199], a[84:87]
ds_read_b64_tr_b16 a[194:195], v224 offset:12288
s_cmp_lt_u32 s37, 2
s_cselect_b64 s[90:91], -1, 0
v_mfma_f32_16x16x32_bf16 a[80:83], v[88:91], a[196:199], a[80:83]
v_exp_f32 v69, v69
v_mfma_f32_16x16x32_bf16 a[96:99], v[88:91], a[200:203], a[96:99]
ds_read_b64_tr_b16 a[196:197], v225 offset:8192
v_cvt_pk_bf16_f32 v86, v68, v69
v_mfma_f32_16x16x32_bf16 a[100:103], v[92:95], a[200:203], a[100:103]
v_exp_f32 v70, v70
v_mfma_f32_16x16x32_bf16 a[104:107], v[96:99], a[200:203], a[104:107]
ds_read_b64_tr_b16 a[198:199], v225 offset:12288
v_mfma_f32_16x16x32_bf16 a[108:111], v[100:103], a[200:203], a[108:111]
v_exp_f32 v71, v71
v_mfma_f32_16x16x32_bf16 a[124:127], v[100:103], a[204:207], a[124:127]
ds_read_b64_tr_b16 a[200:201], v226 offset:8192
v_cvt_pk_bf16_f32 v87, v70, v71
v_mfma_f32_16x16x32_bf16 a[120:123], v[96:99], a[204:207], a[120:123]
ds_read_b64_tr_b16 a[202:203], v226 offset:12288
v_mfma_f32_16x16x32_bf16 a[116:119], v[92:95], a[204:207], a[116:119]
buffer_load_dwordx4 v233, s[12:15], s39 offen offset:3072  lds
v_mfma_f32_16x16x32_bf16 a[112:115], v[88:91], a[204:207], a[112:115]
ds_read_b64_tr_b16 a[204:205], v227 offset:8192
ds_read_b64_tr_b16 a[206:207], v227 offset:12288
v_smfmac_f32_16x16x64_bf16 a[132:135], a[208:211], v[96:103], v245
s_add_u32 m0, s86, 32768
s_add_u32 s50, s85, 24576
buffer_load_dwordx4 v244, s[72:75], s50 offen lds
s_add_u32 m0, s86, 36864
s_add_u32 s50, s85, 28672
buffer_load_dwordx4 v244, s[72:75], s50 offen lds
s_add_u32 m0, s86, 40960
s_add_u32 s50, s85, 32768
buffer_load_dwordx4 v244, s[72:75], s50 offen lds
v_mfma_f32_16x16x32_bf16 v[40:43], a[144:147], v[152:155], v[136:139]
v_exp_f32 v8, v8
v_mfma_f32_16x16x32_bf16 v[40:43], a[148:151], v[156:159], v[40:43]
v_exp_f32 v9, v9
v_mfma_f32_16x16x32_bf16 v[40:43], a[152:155], v[160:163], v[40:43]
v_cvt_pk_bf16_f32 v88, v8, v9
v_mfma_f32_16x16x32_bf16 v[40:43], a[156:159], v[164:167], v[40:43]
v_exp_f32 v10, v10
v_mfma_f32_16x16x32_bf16 v[48:51], a[156:159], v[180:183], v[140:143]
v_mfma_f32_16x16x32_bf16 v[48:51], a[152:155], v[176:179], v[48:51]
v_exp_f32 v11, v11
v_mfma_f32_16x16x32_bf16 v[48:51], a[148:151], v[172:175], v[48:51]
v_cvt_pk_bf16_f32 v89, v10, v11
v_mfma_f32_16x16x32_bf16 v[48:51], a[144:147], v[168:171], v[48:51]
v_exp_f32 v12, v12
v_mfma_f32_16x16x32_bf16 v[56:59], a[144:147], v[184:187], v[144:147]
v_mfma_f32_16x16x32_bf16 v[56:59], a[148:151], v[188:191], v[56:59]
v_exp_f32 v13, v13
v_mfma_f32_16x16x32_bf16 v[56:59], a[152:155], v[192:195], v[56:59]
v_cvt_pk_bf16_f32 v90, v12, v13
v_mfma_f32_16x16x32_bf16 v[56:59], a[156:159], v[196:199], v[56:59]
v_exp_f32 v14, v14
v_mfma_f32_16x16x32_bf16 v[64:67], a[156:159], v[212:215], v[148:151]
s_waitcnt vmcnt(15) lgkmcnt(0)
s_barrier
v_mfma_f32_16x16x32_bf16 v[64:67], a[152:155], v[208:211], v[64:67]
ds_read_b128 v[124:127], v239 offset:45056
v_exp_f32 v15, v15
v_mfma_f32_16x16x32_bf16 v[64:67], a[148:151], v[204:207], v[64:67]
ds_read_b128 a[156:159], v219 offset:49152
ds_read_b128 v[128:131], v239 offset:45568
v_cvt_pk_bf16_f32 v91, v14, v15
v_mfma_f32_16x16x32_bf16 v[64:67], a[144:147], v[200:203], v[64:67]
ds_read_b128 v[248:251], v239 offset:46080
v_exp_f32 v16, v16
v_mfma_f32_16x16x32_bf16 a[0:3], v[72:75], a[176:179], a[0:3]
ds_read_b128 a[152:155], v218 offset:49152
ds_read_b128 a[148:151], v217 offset:49152
ds_read_b128 v[252:255], v239 offset:46592
v_mfma_f32_16x16x32_bf16 a[4:7], v[76:79], a[176:179], a[4:7]
ds_read_b64_tr_b16 v[116:117], v241 offset:0
v_exp_f32 v17, v17
v_mfma_f32_16x16x32_bf16 a[8:11], v[80:83], a[176:179], a[8:11]
ds_read_b128 a[144:147], v216 offset:49152
ds_read_b64_tr_b16 v[118:119], v241 offset:256
v_cvt_pk_bf16_f32 v92, v16, v17
v_mfma_f32_16x16x32_bf16 a[12:15], v[84:87], a[176:179], a[12:15]
ds_read_b64_tr_b16 v[120:121], v241 offset:2048
v_exp_f32 v18, v18
v_mfma_f32_16x16x32_bf16 a[28:31], v[84:87], a[180:183], a[28:31]
ds_read_b64_tr_b16 a[176:177], v220 offset:32768
ds_read_b64_tr_b16 a[178:179], v220 offset:36864
ds_read_b64_tr_b16 v[122:123], v241 offset:2304
v_mfma_f32_16x16x32_bf16 a[24:27], v[80:83], a[180:183], a[24:27]
v_exp_f32 v19, v19
v_mfma_f32_16x16x32_bf16 a[20:23], v[76:79], a[180:183], a[20:23]
s_add_u32 s32, s32, 16384
v_cvt_pk_bf16_f32 v93, v18, v19
v_mfma_f32_16x16x32_bf16 a[16:19], v[72:75], a[180:183], a[16:19]
v_exp_f32 v20, v20
v_mfma_f32_16x16x32_bf16 a[32:35], v[72:75], a[184:187], a[32:35]
ds_read_b64_tr_b16 a[180:181], v221 offset:32768
ds_read_b64_tr_b16 a[182:183], v221 offset:36864
v_mfma_f32_16x16x32_bf16 a[36:39], v[76:79], a[184:187], a[36:39]
v_exp_f32 v21, v21
v_mfma_f32_16x16x32_bf16 a[40:43], v[80:83], a[184:187], a[40:43]
s_add_u32 m0, s30, 81920
v_cvt_pk_bf16_f32 v94, v20, v21
s_waitcnt lgkmcnt(8)
v_mfma_f32_16x16x32_bf16 v[132:135], a[212:215], v[124:127], 0
ds_read_b128 v[124:127], v239 offset:47104
v_mfma_f32_16x16x32_bf16 a[44:47], v[84:87], a[184:187], a[44:47]
v_exp_f32 v22, v22
v_mfma_f32_16x16x32_bf16 a[60:63], v[84:87], a[188:191], a[60:63]
ds_read_b64_tr_b16 a[184:185], v222 offset:32768
ds_read_b64_tr_b16 a[186:187], v222 offset:36864
v_mfma_f32_16x16x32_bf16 v[132:135], a[216:219], v[128:131], v[132:135]
ds_read_b128 v[128:131], v239 offset:47616
v_mfma_f32_16x16x32_bf16 a[56:59], v[80:83], a[188:191], a[56:59]
v_exp_f32 v23, v23
v_mfma_f32_16x16x32_bf16 a[52:55], v[76:79], a[188:191], a[52:55]
v_cvt_pk_bf16_f32 v95, v22, v23
v_mfma_f32_16x16x32_bf16 v[132:135], a[220:223], v[248:251], v[132:135]
buffer_load_dwordx4 v228, s[8:11], s32 offen offset:0  lds
ds_read_b128 v[248:251], v239 offset:48128
v_mfma_f32_16x16x32_bf16 a[48:51], v[72:75], a[188:191], a[48:51]
v_exp_f32 v24, v24
v_smfmac_f32_16x16x64_bf16 a[128:131], a[208:211], v[72:79], v245
v_exp_f32 v25, v25
v_mfma_f32_16x16x32_bf16 v[132:135], a[224:227], v[252:255], v[132:135]
ds_read_b64_tr_b16 a[188:189], v223 offset:32768
ds_read_b64_tr_b16 a[190:191], v223 offset:36864
ds_read_b128 v[252:255], v239 offset:48640
v_mfma_f32_16x16x32_bf16 v[44:47], a[160:163], v[152:155], v[136:139]
v_cvt_pk_bf16_f32 v96, v24, v25
v_mfma_f32_16x16x32_bf16 v[44:47], a[164:167], v[156:159], v[44:47]
v_exp_f32 v26, v26
s_waitcnt lgkmcnt(7)
v_mfma_f32_16x16x32_bf16 v[132:135], a[228:231], v[124:127], v[132:135]
ds_read_b128 v[124:127], v239 offset:49152
v_mfma_f32_16x16x32_bf16 v[44:47], a[168:171], v[160:163], v[44:47]
v_mfma_f32_16x16x32_bf16 v[44:47], a[172:175], v[164:167], v[44:47]
v_exp_f32 v27, v27
s_waitcnt lgkmcnt(5)
v_mfma_f32_16x16x32_bf16 v[132:135], a[232:235], v[128:131], v[132:135]
ds_read_b128 v[128:131], v239 offset:49664
v_mfma_f32_16x16x32_bf16 v[52:55], a[172:175], v[180:183], v[140:143]
v_cvt_pk_bf16_f32 v97, v26, v27
v_mfma_f32_16x16x32_bf16 v[52:55], a[168:171], v[176:179], v[52:55]
v_exp_f32 v28, v28
s_waitcnt lgkmcnt(5)
v_mfma_f32_16x16x32_bf16 v[132:135], a[236:239], v[248:251], v[132:135]
buffer_load_dwordx4 v229, s[8:11], s32 offen offset:1024  lds
ds_read_b128 v[248:251], v239 offset:50176
v_mfma_f32_16x16x32_bf16 v[52:55], a[164:167], v[172:175], v[52:55]
v_mfma_f32_16x16x32_bf16 v[52:55], a[160:163], v[168:171], v[52:55]
v_exp_f32 v29, v29
s_waitcnt lgkmcnt(3)
v_mfma_f32_16x16x32_bf16 v[132:135], a[240:243], v[252:255], v[132:135]
ds_read_b128 v[252:255], v239 offset:50688
v_mfma_f32_16x16x32_bf16 v[60:63], a[160:163], v[184:187], v[144:147]
v_cvt_pk_bf16_f32 v98, v28, v29
v_mfma_f32_16x16x32_bf16 v[60:63], a[164:167], v[188:191], v[60:63]
v_exp_f32 v30, v30
s_waitcnt lgkmcnt(3)
v_mfma_f32_16x16x32_bf16 v[132:135], a[244:247], v[124:127], v[132:135]
ds_read_b128 v[124:127], v239 offset:51200
v_mfma_f32_16x16x32_bf16 v[60:63], a[168:171], v[192:195], v[60:63]
v_mfma_f32_16x16x32_bf16 v[60:63], a[172:175], v[196:199], v[60:63]
v_exp_f32 v31, v31
s_waitcnt lgkmcnt(3)
v_mfma_f32_16x16x32_bf16 v[132:135], a[248:251], v[128:131], v[132:135]
buffer_load_dwordx4 v230, s[8:11], s32 offen offset:2048  lds
ds_read_b128 v[128:131], v239 offset:51712
v_mfma_f32_16x16x32_bf16 v[68:71], a[172:175], v[212:215], v[148:151]
ds_read_b128 a[172:175], v219 offset:53248
v_cvt_pk_bf16_f32 v99, v30, v31
v_mfma_f32_16x16x32_bf16 v[68:71], a[168:171], v[208:211], v[68:71]
v_exp_f32 v32, v32
s_waitcnt lgkmcnt(4)
v_mfma_f32_16x16x32_bf16 v[132:135], a[252:255], v[248:251], v[132:135]
ds_read_b128 a[168:171], v218 offset:53248
ds_read_b128 v[248:251], v239 offset:52224
v_mfma_f32_16x16x32_bf16 v[68:71], a[164:167], v[204:207], v[68:71]
ds_read_b128 a[164:167], v217 offset:53248
v_mfma_f32_16x16x32_bf16 v[68:71], a[160:163], v[200:203], v[68:71]
v_exp_f32 v33, v33
s_waitcnt lgkmcnt(6)
v_mfma_f32_16x16x32_bf16 v[132:135], a[136:139], v[252:255], v[132:135]
ds_read_b128 a[160:163], v216 offset:53248
ds_read_b128 v[252:255], v239 offset:52736
v_mfma_f32_16x16x32_bf16 a[64:67], v[72:75], a[192:195], a[64:67]
v_cvt_pk_bf16_f32 v100, v32, v33
v_mfma_f32_16x16x32_bf16 a[68:71], v[76:79], a[192:195], a[68:71]
v_exp_f32 v34, v34
s_waitcnt lgkmcnt(7)
v_mfma_f32_16x16x32_bf16 v[132:135], a[140:143], v[124:127], v[132:135]
ds_read_b128 v[124:127], v239 offset:53248
v_mfma_f32_16x16x32_bf16 a[72:75], v[80:83], a[192:195], a[72:75]
buffer_load_dwordx4 v231, s[8:11], s32 offen offset:3072  lds
v_mfma_f32_16x16x32_bf16 a[76:79], v[84:87], a[192:195], a[76:79]
v_exp_f32 v35, v35
s_waitcnt lgkmcnt(7)
v_mfma_f32_16x16x32_bf16 v[132:135], v[104:107], v[128:131], v[132:135]
ds_read_b64_tr_b16 a[192:193], v224 offset:32768
ds_read_b64_tr_b16 a[194:195], v224 offset:36864
ds_read_b128 v[128:131], v239 offset:53760
v_mfma_f32_16x16x32_bf16 a[92:95], v[84:87], a[196:199], a[92:95]
v_cvt_pk_bf16_f32 v101, v34, v35
v_mfma_f32_16x16x32_bf16 a[88:91], v[80:83], a[196:199], a[88:91]
v_exp_f32 v36, v36
s_waitcnt lgkmcnt(7)
v_mfma_f32_16x16x32_bf16 v[132:135], v[108:111], v[248:251], v[132:135]
v_mfma_f32_16x16x32_bf16 a[84:87], v[76:79], a[196:199], a[84:87]
v_mfma_f32_16x16x32_bf16 a[80:83], v[72:75], a[196:199], a[80:83]
v_exp_f32 v37, v37
s_waitcnt lgkmcnt(4)
v_mfma_f32_16x16x32_bf16 v[132:135], v[112:115], v[252:255], v[132:135]
ds_read_b64_tr_b16 a[196:197], v225 offset:32768
ds_read_b64_tr_b16 a[198:199], v225 offset:36864
v_mfma_f32_16x16x32_bf16 a[96:99], v[72:75], a[200:203], a[96:99]
v_cvt_pk_bf16_f32 v102, v36, v37
v_mfma_f32_16x16x32_bf16 a[100:103], v[76:79], a[200:203], a[100:103]
v_exp_f32 v38, v38
s_waitcnt lgkmcnt(5)
v_mfma_f32_16x16x32_bf16 v[132:135], v[116:119], v[124:127], v[132:135]
v_mfma_f32_16x16x32_bf16 a[104:107], v[80:83], a[200:203], a[104:107]
v_mfma_f32_16x16x32_bf16 a[108:111], v[84:87], a[200:203], a[108:111]
v_exp_f32 v39, v39
s_waitcnt lgkmcnt(2)
v_mfma_f32_16x16x32_bf16 v[132:135], v[120:123], v[128:131], v[132:135]
ds_read_b64_tr_b16 a[200:201], v226 offset:32768
ds_read_b64_tr_b16 a[202:203], v226 offset:36864
v_mfma_f32_16x16x32_bf16 a[124:127], v[84:87], a[204:207], a[124:127]
v_cvt_pk_bf16_f32 v103, v38, v39
v_mfma_f32_16x16x32_bf16 a[120:123], v[80:83], a[204:207], a[120:123]
v_mfma_f32_16x16x32_bf16 a[116:119], v[76:79], a[204:207], a[116:119]
v_mfma_f32_16x16x32_bf16 a[112:115], v[72:75], a[204:207], a[112:115]
ds_read_b64_tr_b16 a[204:205], v227 offset:32768
ds_read_b64_tr_b16 a[206:207], v227 offset:36864
v_smfmac_f32_16x16x64_bf16 a[132:135], a[208:211], v[80:87], v245
v_mfma_f32_16x16x32_bf16 v[8:11], a[144:147], v[152:155], v[136:139]
v_exp_f32 v40, v40
v_mfma_f32_16x16x32_bf16 v[8:11], a[148:151], v[156:159], v[8:11]
v_exp_f32 v41, v41
v_mfma_f32_16x16x32_bf16 v[8:11], a[152:155], v[160:163], v[8:11]
v_cvt_pk_bf16_f32 v72, v40, v41
v_cvt_pk_bf16_f32 v104, v132, v133
v_cvt_pk_bf16_f32 v105, v134, v135
v_mfma_f32_16x16x32_bf16 v[8:11], a[156:159], v[164:167], v[8:11]
v_lshlrev_b32 v132, 16, v104
v_exp_f32 v42, v42
v_mfma_f32_16x16x32_bf16 v[16:19], a[156:159], v[180:183], v[140:143]
s_add_u32 s39, s39, 16384
v_and_b32 v133, 0xffff0000, v104
v_lshlrev_b32 v134, 16, v105
v_mfma_f32_16x16x32_bf16 v[16:19], a[152:155], v[176:179], v[16:19]
v_and_b32 v135, 0xffff0000, v105
v_exp_f32 v43, v43
v_mfma_f32_16x16x32_bf16 v[16:19], a[148:151], v[172:175], v[16:19]
v_cvt_pk_bf16_f32 v73, v42, v43
v_mul_f32 v104, 0xbfb8aa3b, v132
v_mul_f32 v105, 0xbfb8aa3b, v133
v_mfma_f32_16x16x32_bf16 v[16:19], a[144:147], v[168:171], v[16:19]
v_mul_f32 v106, 0xbfb8aa3b, v134
v_exp_f32 v44, v44
v_mfma_f32_16x16x32_bf16 v[24:27], a[144:147], v[184:187], v[144:147]
v_mul_f32 v107, 0xbfb8aa3b, v135
v_exp_f32 v104, v104
v_mfma_f32_16x16x32_bf16 v[24:27], a[148:151], v[188:191], v[24:27]
v_exp_f32 v45, v45
v_mfma_f32_16x16x32_bf16 v[24:27], a[152:155], v[192:195], v[24:27]
v_cvt_pk_bf16_f32 v74, v44, v45
v_exp_f32 v105, v105
v_mfma_f32_16x16x32_bf16 v[24:27], a[156:159], v[196:199], v[24:27]
v_exp_f32 v46, v46
v_mfma_f32_16x16x32_bf16 v[32:35], a[156:159], v[212:215], v[148:151]
ds_read_b128 a[156:159], v219 offset:57344
s_add_u32 m0, s30, 98304
v_mfma_f32_16x16x32_bf16 v[32:35], a[152:155], v[208:211], v[32:35]
v_exp_f32 v47, v47
v_mfma_f32_16x16x32_bf16 v[32:35], a[148:151], v[204:207], v[32:35]
ds_read_b128 a[152:155], v218 offset:57344
v_cvt_pk_bf16_f32 v75, v46, v47
v_mfma_f32_16x16x32_bf16 v[32:35], a[144:147], v[200:203], v[32:35]
v_exp_f32 v48, v48
v_mfma_f32_16x16x32_bf16 a[0:3], v[88:91], a[176:179], a[0:3]
ds_read_b128 a[148:151], v217 offset:57344
ds_read_b128 a[144:147], v216 offset:57344
v_mfma_f32_16x16x32_bf16 a[4:7], v[92:95], a[176:179], a[4:7]
v_exp_f32 v49, v49
v_mfma_f32_16x16x32_bf16 a[8:11], v[96:99], a[176:179], a[8:11]
v_cvt_pk_bf16_f32 v76, v48, v49
v_exp_f32 v106, v106
v_mfma_f32_16x16x32_bf16 a[12:15], v[100:103], a[176:179], a[12:15]
v_exp_f32 v50, v50
v_mfma_f32_16x16x32_bf16 a[28:31], v[100:103], a[180:183], a[28:31]
ds_read_b64_tr_b16 a[176:177], v220 offset:40960
ds_read_b64_tr_b16 a[178:179], v220 offset:45056
v_mfma_f32_16x16x32_bf16 a[24:27], v[96:99], a[180:183], a[24:27]
v_exp_f32 v51, v51
v_mfma_f32_16x16x32_bf16 a[20:23], v[92:95], a[180:183], a[20:23]
v_cvt_pk_bf16_f32 v77, v50, v51
v_exp_f32 v107, v107
v_mfma_f32_16x16x32_bf16 a[16:19], v[88:91], a[180:183], a[16:19]
v_add_f32 v104, 1.0, v104
v_exp_f32 v52, v52
v_mfma_f32_16x16x32_bf16 a[32:35], v[88:91], a[184:187], a[32:35]
ds_read_b64_tr_b16 a[180:181], v221 offset:40960
ds_read_b64_tr_b16 a[182:183], v221 offset:45056
v_add_f32 v105, 1.0, v105
v_mfma_f32_16x16x32_bf16 a[36:39], v[92:95], a[184:187], a[36:39]
v_add_f32 v106, 1.0, v106
v_exp_f32 v53, v53
v_mfma_f32_16x16x32_bf16 a[40:43], v[96:99], a[184:187], a[40:43]
v_cvt_pk_bf16_f32 v78, v52, v53
v_add_f32 v107, 1.0, v107
v_mfma_f32_16x16x32_bf16 a[44:47], v[100:103], a[184:187], a[44:47]
v_exp_f32 v54, v54
v_mfma_f32_16x16x32_bf16 a[60:63], v[100:103], a[188:191], a[60:63]
ds_read_b64_tr_b16 a[184:185], v222 offset:40960
ds_read_b64_tr_b16 a[186:187], v222 offset:45056
v_mfma_f32_16x16x32_bf16 a[56:59], v[96:99], a[188:191], a[56:59]
v_exp_f32 v55, v55
v_mfma_f32_16x16x32_bf16 a[52:55], v[92:95], a[188:191], a[52:55]
v_cvt_pk_bf16_f32 v79, v54, v55
v_rcp_f32 v104, v104
v_mfma_f32_16x16x32_bf16 a[48:51], v[88:91], a[188:191], a[48:51]
v_exp_f32 v56, v56
v_smfmac_f32_16x16x64_bf16 a[128:131], a[208:211], v[88:95], v245
v_exp_f32 v57, v57
v_mfma_f32_16x16x32_bf16 v[12:15], a[160:163], v[152:155], v[136:139]
ds_read_b64_tr_b16 a[188:189], v223 offset:40960
v_cvt_pk_bf16_f32 v80, v56, v57
v_mfma_f32_16x16x32_bf16 v[12:15], a[164:167], v[156:159], v[12:15]
v_exp_f32 v58, v58
v_mfma_f32_16x16x32_bf16 v[12:15], a[168:171], v[160:163], v[12:15]
ds_read_b64_tr_b16 a[190:191], v223 offset:45056
v_rcp_f32 v105, v105
v_mfma_f32_16x16x32_bf16 v[12:15], a[172:175], v[164:167], v[12:15]
v_exp_f32 v59, v59
v_mfma_f32_16x16x32_bf16 v[20:23], a[172:175], v[180:183], v[140:143]
v_cvt_pk_bf16_f32 v81, v58, v59
v_rcp_f32 v106, v106
v_mfma_f32_16x16x32_bf16 v[20:23], a[168:171], v[176:179], v[20:23]
v_exp_f32 v60, v60
v_mfma_f32_16x16x32_bf16 v[20:23], a[164:167], v[172:175], v[20:23]
buffer_load_dwordx4 v232, s[12:15], s39 offen offset:0  lds
v_mfma_f32_16x16x32_bf16 v[20:23], a[160:163], v[168:171], v[20:23]
v_exp_f32 v61, v61
v_mfma_f32_16x16x32_bf16 v[28:31], a[160:163], v[184:187], v[144:147]
v_cvt_pk_bf16_f32 v82, v60, v61
v_rcp_f32 v107, v107
v_mfma_f32_16x16x32_bf16 v[28:31], a[164:167], v[188:191], v[28:31]
v_mul_f32 v104, v132, v104
v_exp_f32 v62, v62
v_mfma_f32_16x16x32_bf16 v[28:31], a[168:171], v[192:195], v[28:31]
buffer_load_dwordx4 v233, s[12:15], s39 offen offset:1024  lds
v_mul_f32 v105, v133, v105
v_mfma_f32_16x16x32_bf16 v[28:31], a[172:175], v[196:199], v[28:31]
v_mul_f32 v106, v134, v106
v_exp_f32 v63, v63
v_mfma_f32_16x16x32_bf16 v[36:39], a[172:175], v[212:215], v[148:151]
ds_read_b128 a[172:175], v219 offset:61440
v_cvt_pk_bf16_f32 v83, v62, v63
v_mul_f32 v107, v135, v107
v_mfma_f32_16x16x32_bf16 v[36:39], a[168:171], v[208:211], v[36:39]
v_cvt_pk_bf16_f32 v108, v104, v105
v_exp_f32 v64, v64
v_mfma_f32_16x16x32_bf16 v[36:39], a[164:167], v[204:207], v[36:39]
ds_read_b128 a[168:171], v218 offset:61440
ds_read_b128 a[164:167], v217 offset:61440
v_cvt_pk_bf16_f32 v109, v106, v107
v_mfma_f32_16x16x32_bf16 v[36:39], a[160:163], v[200:203], v[36:39]
v_lshlrev_b32 v104, 16, v108
v_exp_f32 v65, v65
v_mfma_f32_16x16x32_bf16 a[64:67], v[88:91], a[192:195], a[64:67]
ds_read_b128 a[160:163], v216 offset:61440
v_cvt_pk_bf16_f32 v84, v64, v65
v_and_b32 v105, 0xffff0000, v108
v_mfma_f32_16x16x32_bf16 a[68:71], v[92:95], a[192:195], a[68:71]
v_lshlrev_b32 v106, 16, v109
v_exp_f32 v66, v66
v_mfma_f32_16x16x32_bf16 a[72:75], v[96:99], a[192:195], a[72:75]
buffer_load_dwordx4 v232, s[12:15], s39 offen offset:2048  lds
v_and_b32 v107, 0xffff0000, v109
v_mfma_f32_16x16x32_bf16 a[76:79], v[100:103], a[192:195], a[76:79]
v_cndmask_b32 v132, v132, v104, s[90:91]
v_exp_f32 v67, v67
s_waitcnt lgkmcnt(8)
v_mfma_f32_16x16x32_bf16 a[92:95], v[100:103], a[196:199], a[92:95]
ds_read_b64_tr_b16 a[192:193], v224 offset:40960
v_cvt_pk_bf16_f32 v85, v66, v67
v_cndmask_b32 v133, v133, v105, s[90:91]
v_mfma_f32_16x16x32_bf16 a[88:91], v[96:99], a[196:199], a[88:91]
v_cndmask_b32 v134, v134, v106, s[90:91]
v_exp_f32 v68, v68
v_mfma_f32_16x16x32_bf16 a[84:87], v[92:95], a[196:199], a[84:87]
ds_read_b64_tr_b16 a[194:195], v224 offset:45056
v_cndmask_b32 v135, v135, v107, s[90:91]
v_mfma_f32_16x16x32_bf16 a[80:83], v[88:91], a[196:199], a[80:83]
ds_write_b128 v237, v[132:135] offset:54272
v_exp_f32 v69, v69
v_mfma_f32_16x16x32_bf16 a[96:99], v[88:91], a[200:203], a[96:99]
ds_read_b64_tr_b16 a[196:197], v225 offset:40960
v_cvt_pk_bf16_f32 v86, v68, v69
v_mfma_f32_16x16x32_bf16 a[100:103], v[92:95], a[200:203], a[100:103]
v_exp_f32 v70, v70
v_mfma_f32_16x16x32_bf16 a[104:107], v[96:99], a[200:203], a[104:107]
ds_read_b64_tr_b16 a[198:199], v225 offset:45056
v_mfma_f32_16x16x32_bf16 a[108:111], v[100:103], a[200:203], a[108:111]
v_exp_f32 v71, v71
v_mfma_f32_16x16x32_bf16 a[124:127], v[100:103], a[204:207], a[124:127]
ds_read_b64_tr_b16 a[200:201], v226 offset:40960
v_cvt_pk_bf16_f32 v87, v70, v71
v_mfma_f32_16x16x32_bf16 a[120:123], v[96:99], a[204:207], a[120:123]
ds_read_b64_tr_b16 a[202:203], v226 offset:45056
v_mfma_f32_16x16x32_bf16 a[116:119], v[92:95], a[204:207], a[116:119]
buffer_load_dwordx4 v233, s[12:15], s39 offen offset:3072  lds
v_mfma_f32_16x16x32_bf16 a[112:115], v[88:91], a[204:207], a[112:115]
ds_read_b64_tr_b16 a[204:205], v227 offset:40960
ds_read_b64_tr_b16 a[206:207], v227 offset:45056
v_smfmac_f32_16x16x64_bf16 a[132:135], a[208:211], v[96:103], v245
v_mfma_f32_16x16x32_bf16 v[40:43], a[144:147], v[152:155], v[136:139]
v_exp_f32 v8, v8
v_mfma_f32_16x16x32_bf16 v[40:43], a[148:151], v[156:159], v[40:43]
v_exp_f32 v9, v9
v_mfma_f32_16x16x32_bf16 v[40:43], a[152:155], v[160:163], v[40:43]
v_cvt_pk_bf16_f32 v104, v8, v9
v_mfma_f32_16x16x32_bf16 v[40:43], a[156:159], v[164:167], v[40:43]
v_exp_f32 v10, v10
v_mfma_f32_16x16x32_bf16 v[48:51], a[156:159], v[180:183], v[140:143]
v_mfma_f32_16x16x32_bf16 v[48:51], a[152:155], v[176:179], v[48:51]
v_exp_f32 v11, v11
v_mfma_f32_16x16x32_bf16 v[48:51], a[148:151], v[172:175], v[48:51]
v_cvt_pk_bf16_f32 v105, v10, v11
v_mfma_f32_16x16x32_bf16 v[48:51], a[144:147], v[168:171], v[48:51]
v_exp_f32 v12, v12
v_mfma_f32_16x16x32_bf16 v[56:59], a[144:147], v[184:187], v[144:147]
v_mfma_f32_16x16x32_bf16 v[56:59], a[148:151], v[188:191], v[56:59]
v_exp_f32 v13, v13
v_mfma_f32_16x16x32_bf16 v[56:59], a[152:155], v[192:195], v[56:59]
v_cvt_pk_bf16_f32 v106, v12, v13
v_mfma_f32_16x16x32_bf16 v[56:59], a[156:159], v[196:199], v[56:59]
v_exp_f32 v14, v14
v_mfma_f32_16x16x32_bf16 v[64:67], a[156:159], v[212:215], v[148:151]
s_waitcnt vmcnt(8) lgkmcnt(0)
s_barrier
v_mfma_f32_16x16x32_bf16 v[64:67], a[152:155], v[208:211], v[64:67]
ds_read_b128 v[120:123], v244 offset:54272
v_exp_f32 v15, v15
v_mfma_f32_16x16x32_bf16 v[64:67], a[148:151], v[204:207], v[64:67]
ds_read_b128 a[156:159], v219 offset:0
ds_read_b128 v[124:127], v244 offset:55296
v_cvt_pk_bf16_f32 v107, v14, v15
v_mfma_f32_16x16x32_bf16 v[64:67], a[144:147], v[200:203], v[64:67]
ds_read_b128 v[128:131], v244 offset:56320
v_exp_f32 v16, v16
v_mfma_f32_16x16x32_bf16 a[0:3], v[72:75], a[176:179], a[0:3]
ds_read_b128 a[152:155], v218 offset:0
ds_read_b128 a[148:151], v217 offset:0
ds_read_b128 v[132:135], v244 offset:57344
v_mfma_f32_16x16x32_bf16 a[4:7], v[76:79], a[176:179], a[4:7]
ds_read_b64_tr_b16 a[212:213], v242 offset:0
v_exp_f32 v17, v17
v_mfma_f32_16x16x32_bf16 a[8:11], v[80:83], a[176:179], a[8:11]
ds_read_b128 a[144:147], v216 offset:0
ds_read_b64_tr_b16 a[214:215], v242 offset:18432
v_cvt_pk_bf16_f32 v108, v16, v17
v_mfma_f32_16x16x32_bf16 a[12:15], v[84:87], a[176:179], a[12:15]
ds_read_b64_tr_b16 a[216:217], v242 offset:32
v_exp_f32 v18, v18
v_mfma_f32_16x16x32_bf16 a[28:31], v[84:87], a[180:183], a[28:31]
ds_read_b64_tr_b16 a[176:177], v220 offset:49152
ds_read_b64_tr_b16 a[178:179], v220 offset:53248
ds_read_b64_tr_b16 a[218:219], v242 offset:18464
v_mfma_f32_16x16x32_bf16 a[24:27], v[80:83], a[180:183], a[24:27]
ds_read_b64_tr_b16 a[220:221], v242 offset:64
v_exp_f32 v19, v19
v_mfma_f32_16x16x32_bf16 a[20:23], v[76:79], a[180:183], a[20:23]
s_add_u32 s32, s32, 16384
ds_read_b64_tr_b16 a[222:223], v242 offset:18496
v_cvt_pk_bf16_f32 v109, v18, v19
v_mfma_f32_16x16x32_bf16 a[16:19], v[72:75], a[180:183], a[16:19]
ds_read_b64_tr_b16 a[224:225], v242 offset:96
v_exp_f32 v20, v20
v_mfma_f32_16x16x32_bf16 a[32:35], v[72:75], a[184:187], a[32:35]
ds_read_b64_tr_b16 a[180:181], v221 offset:49152
ds_read_b64_tr_b16 a[182:183], v221 offset:53248
ds_read_b64_tr_b16 a[226:227], v242 offset:18528
v_mfma_f32_16x16x32_bf16 a[36:39], v[76:79], a[184:187], a[36:39]
ds_read_b64_tr_b16 a[228:229], v242 offset:128
v_exp_f32 v21, v21
v_mfma_f32_16x16x32_bf16 a[40:43], v[80:83], a[184:187], a[40:43]
s_add_u32 m0, s30, 114688
ds_read_b64_tr_b16 a[230:231], v242 offset:18560
v_cvt_pk_bf16_f32 v110, v20, v21
v_mfma_f32_16x16x32_bf16 a[44:47], v[84:87], a[184:187], a[44:47]
ds_read_b64_tr_b16 a[232:233], v242 offset:160
v_exp_f32 v22, v22
v_mfma_f32_16x16x32_bf16 a[60:63], v[84:87], a[188:191], a[60:63]
ds_read_b64_tr_b16 a[184:185], v222 offset:49152
ds_read_b64_tr_b16 a[186:187], v222 offset:53248
ds_read_b64_tr_b16 a[234:235], v242 offset:18592
v_mfma_f32_16x16x32_bf16 a[56:59], v[80:83], a[188:191], a[56:59]
ds_read_b64_tr_b16 a[236:237], v242 offset:192
v_exp_f32 v23, v23
v_mfma_f32_16x16x32_bf16 a[52:55], v[76:79], a[188:191], a[52:55]
ds_read_b64_tr_b16 a[238:239], v242 offset:18624
ds_read_b64_tr_b16 a[240:241], v242 offset:224
v_cvt_pk_bf16_f32 v111, v22, v23
v_mfma_f32_16x16x32_bf16 a[48:51], v[72:75], a[188:191], a[48:51]
ds_read_b64_tr_b16 a[242:243], v242 offset:18656
v_exp_f32 v24, v24
v_smfmac_f32_16x16x64_bf16 a[128:131], a[208:211], v[72:79], v245
ds_read_b64_tr_b16 a[244:245], v242 offset:256
v_exp_f32 v25, v25
v_mfma_f32_16x16x32_bf16 v[44:47], a[160:163], v[152:155], v[136:139]
ds_read_b64_tr_b16 a[188:189], v223 offset:49152
ds_read_b64_tr_b16 a[246:247], v242 offset:18688
v_cvt_pk_bf16_f32 v112, v24, v25
v_mfma_f32_16x16x32_bf16 v[44:47], a[164:167], v[156:159], v[44:47]
s_waitcnt lgkmcnt(8)
v_mul_f32 v120, v120, v128
v_exp_f32 v26, v26
v_mfma_f32_16x16x32_bf16 v[44:47], a[168:171], v[160:163], v[44:47]
ds_read_b64_tr_b16 a[190:191], v223 offset:53248
v_mul_f32 v121, v121, v129
v_mul_f32 v122, v122, v130
v_mfma_f32_16x16x32_bf16 v[44:47], a[172:175], v[164:167], v[44:47]
v_mul_f32 v123, v123, v131
v_exp_f32 v27, v27
v_mfma_f32_16x16x32_bf16 v[52:55], a[172:175], v[180:183], v[140:143]
v_cvt_pk_bf16_f32 v113, v26, v27
STUB_9:
s_cbranch_execz STUB_12
v_mul_f32 v124, v124, v132
v_mul_f32 v125, v125, v133
v_mfma_f32_16x16x32_bf16 v[52:55], a[168:171], v[176:179], v[52:55]
v_mul_f32 v126, v126, v134
v_exp_f32 v28, v28
v_mfma_f32_16x16x32_bf16 v[52:55], a[164:167], v[172:175], v[52:55]
buffer_load_dwordx4 v228, s[8:11], s32 offen offset:0  lds
v_mul_f32 v127, v127, v135
v_mfma_f32_16x16x32_bf16 v[52:55], a[160:163], v[168:171], v[52:55]
v_cvt_pk_bf16_f32 v248, v120, v121
v_exp_f32 v29, v29
v_mfma_f32_16x16x32_bf16 v[60:63], a[160:163], v[184:187], v[144:147]
v_cvt_pk_bf16_f32 v114, v28, v29
v_cvt_pk_bf16_f32 v249, v122, v123
v_cvt_pk_bf16_f32 v250, v124, v125
v_mfma_f32_16x16x32_bf16 v[60:63], a[164:167], v[188:191], v[60:63]
v_cvt_pk_bf16_f32 v251, v126, v127
v_exp_f32 v30, v30
v_mfma_f32_16x16x32_bf16 v[60:63], a[168:171], v[192:195], v[60:63]
buffer_load_dwordx4 v229, s[8:11], s32 offen offset:1024  lds
v_mfma_f32_16x16x32_bf16 v[60:63], a[172:175], v[196:199], v[60:63]
v_exp_f32 v31, v31
v_mfma_f32_16x16x32_bf16 a[248:251], a[212:215], v[248:251], 0
buffer_load_dwordx4 v230, s[8:11], s32 offen offset:2048  lds
v_mfma_f32_16x16x32_bf16 v[68:71], a[172:175], v[212:215], v[148:151]
ds_read_b128 a[172:175], v219 offset:4096
v_cvt_pk_bf16_f32 v115, v30, v31
v_mfma_f32_16x16x32_bf16 a[212:215], a[216:219], v[248:251], 0
v_mfma_f32_16x16x32_bf16 v[68:71], a[168:171], v[208:211], v[68:71]
v_exp_f32 v32, v32
v_mfma_f32_16x16x32_bf16 a[216:219], a[220:223], v[248:251], 0
ds_read_b128 a[168:171], v218 offset:4096
v_mfma_f32_16x16x32_bf16 v[68:71], a[164:167], v[204:207], v[68:71]
ds_read_b128 a[164:167], v217 offset:4096
v_mfma_f32_16x16x32_bf16 a[220:223], a[224:227], v[248:251], 0
v_mfma_f32_16x16x32_bf16 v[68:71], a[160:163], v[200:203], v[68:71]
v_exp_f32 v33, v33
v_mfma_f32_16x16x32_bf16 a[224:227], a[228:231], v[248:251], 0
ds_read_b128 a[160:163], v216 offset:4096
v_mfma_f32_16x16x32_bf16 a[64:67], v[72:75], a[192:195], a[64:67]
v_cvt_pk_bf16_f32 v116, v32, v33
s_waitcnt lgkmcnt(8)
v_mfma_f32_16x16x32_bf16 a[228:231], a[232:235], v[248:251], 0
v_mfma_f32_16x16x32_bf16 a[68:71], v[76:79], a[192:195], a[68:71]
v_exp_f32 v34, v34
v_mfma_f32_16x16x32_bf16 a[232:235], a[236:239], v[248:251], 0
v_mfma_f32_16x16x32_bf16 a[72:75], v[80:83], a[192:195], a[72:75]
buffer_load_dwordx4 v231, s[8:11], s32 offen offset:3072  lds
v_mfma_f32_16x16x32_bf16 a[236:239], a[240:243], v[248:251], 0
v_mfma_f32_16x16x32_bf16 a[76:79], v[84:87], a[192:195], a[76:79]
v_exp_f32 v35, v35
s_waitcnt lgkmcnt(5)
v_mfma_f32_16x16x32_bf16 a[240:243], a[244:247], v[248:251], 0
ds_read_b64_tr_b16 a[192:193], v224 offset:49152
ds_read_b64_tr_b16 a[194:195], v224 offset:53248
v_mfma_f32_16x16x32_bf16 a[92:95], v[84:87], a[196:199], a[92:95]
v_cvt_pk_bf16_f32 v117, v34, v35
v_mfma_f32_16x16x32_bf16 a[88:91], v[80:83], a[196:199], a[88:91]
v_exp_f32 v36, v36
v_mfma_f32_16x16x32_bf16 a[84:87], v[76:79], a[196:199], a[84:87]
v_mfma_f32_16x16x32_bf16 a[80:83], v[72:75], a[196:199], a[80:83]
v_exp_f32 v37, v37
v_mfma_f32_16x16x32_bf16 a[96:99], v[72:75], a[200:203], a[96:99]
ds_read_b64_tr_b16 a[196:197], v225 offset:49152
v_cvt_pk_bf16_f32 v118, v36, v37
v_mfma_f32_16x16x32_bf16 a[100:103], v[76:79], a[200:203], a[100:103]
v_exp_f32 v38, v38
v_mfma_f32_16x16x32_bf16 a[104:107], v[80:83], a[200:203], a[104:107]
ds_read_b64_tr_b16 a[198:199], v225 offset:53248
v_mfma_f32_16x16x32_bf16 a[108:111], v[84:87], a[200:203], a[108:111]
v_exp_f32 v39, v39
v_mfma_f32_16x16x32_bf16 a[124:127], v[84:87], a[204:207], a[124:127]
ds_read_b64_tr_b16 a[200:201], v226 offset:49152
v_cvt_pk_bf16_f32 v119, v38, v39
v_mfma_f32_16x16x32_bf16 a[120:123], v[80:83], a[204:207], a[120:123]
ds_read_b64_tr_b16 a[202:203], v226 offset:53248
buffer_store_dwordx4 a[248:251], v238, s[20:23], s28 offen offset:0 sc0 sc1
v_mfma_f32_16x16x32_bf16 a[116:119], v[76:79], a[204:207], a[116:119]
v_mfma_f32_16x16x32_bf16 a[112:115], v[72:75], a[204:207], a[112:115]
ds_read_b64_tr_b16 a[204:205], v227 offset:49152
ds_read_b64_tr_b16 a[206:207], v227 offset:53248
v_smfmac_f32_16x16x64_bf16 a[132:135], a[208:211], v[80:87], v245
buffer_store_dwordx4 a[212:215], v238, s[20:23], s28 offen offset:512 sc0 sc1
v_mfma_f32_16x16x32_bf16 v[8:11], a[144:147], v[152:155], v[136:139]
v_exp_f32 v40, v40
v_mfma_f32_16x16x32_bf16 v[8:11], a[148:151], v[156:159], v[8:11]
buffer_store_dwordx4 a[216:219], v238, s[20:23], s28 offen offset:1024 sc0 sc1
v_exp_f32 v41, v41
v_mfma_f32_16x16x32_bf16 v[8:11], a[152:155], v[160:163], v[8:11]
v_cvt_pk_bf16_f32 v72, v40, v41
v_exp_f32 v42, v42
v_mfma_f32_16x16x32_bf16 v[8:11], a[156:159], v[164:167], v[8:11]
s_add_u32 s39, s39, 16384
buffer_store_dwordx4 a[220:223], v238, s[20:23], s28 offen offset:1536 sc0 sc1
v_mfma_f32_16x16x32_bf16 v[16:19], a[156:159], v[180:183], v[140:143]
v_exp_f32 v43, v43
v_mfma_f32_16x16x32_bf16 v[16:19], a[152:155], v[176:179], v[16:19]
v_cvt_pk_bf16_f32 v73, v42, v43
v_exp_f32 v44, v44
v_mfma_f32_16x16x32_bf16 v[16:19], a[148:151], v[172:175], v[16:19]
buffer_store_dwordx4 a[224:227], v238, s[20:23], s28 offen offset:2048 sc0 sc1
v_mfma_f32_16x16x32_bf16 v[16:19], a[144:147], v[168:171], v[16:19]
v_exp_f32 v45, v45
v_mfma_f32_16x16x32_bf16 v[24:27], a[144:147], v[184:187], v[144:147]
v_cvt_pk_bf16_f32 v74, v44, v45
v_exp_f32 v46, v46
v_mfma_f32_16x16x32_bf16 v[24:27], a[148:151], v[188:191], v[24:27]
s_add_u32 m0, s30, 131072
s_nop 0
buffer_store_dwordx4 a[228:231], v238, s[20:23], s28 offen offset:2560 sc0 sc1
v_mfma_f32_16x16x32_bf16 v[24:27], a[152:155], v[192:195], v[24:27]
v_exp_f32 v47, v47
v_mfma_f32_16x16x32_bf16 v[24:27], a[156:159], v[196:199], v[24:27]
v_cvt_pk_bf16_f32 v75, v46, v47
v_exp_f32 v48, v48
v_mfma_f32_16x16x32_bf16 v[32:35], a[156:159], v[212:215], v[148:151]
ds_read_b128 a[156:159], v219 offset:8192
v_exp_f32 v49, v49
v_mfma_f32_16x16x32_bf16 v[32:35], a[152:155], v[208:211], v[32:35]
ds_read_b128 a[152:155], v218 offset:8192
buffer_store_dwordx4 a[232:235], v238, s[20:23], s28 offen offset:3072 sc0 sc1
v_cvt_pk_bf16_f32 v76, v48, v49
v_mfma_f32_16x16x32_bf16 v[32:35], a[148:151], v[204:207], v[32:35]
ds_read_b128 a[148:151], v217 offset:8192
v_exp_f32 v50, v50
v_mfma_f32_16x16x32_bf16 v[32:35], a[144:147], v[200:203], v[32:35]
ds_read_b128 a[144:147], v216 offset:8192
v_exp_f32 v51, v51
v_mfma_f32_16x16x32_bf16 a[8:11], v[112:115], a[176:179], a[8:11]
buffer_load_dwordx4 v232, s[12:15], s39 offen offset:0  lds
v_cvt_pk_bf16_f32 v77, v50, v51
v_mfma_f32_16x16x32_bf16 a[12:15], v[116:119], a[176:179], a[12:15]
buffer_store_dwordx4 a[236:239], v238, s[20:23], s28 offen offset:3584 sc0 sc1
v_exp_f32 v52, v52
v_mfma_f32_16x16x32_bf16 a[28:31], v[116:119], a[180:183], a[28:31]
s_add_u32 s28, s28, 4096
v_exp_f32 v53, v53
v_mfma_f32_16x16x32_bf16 a[24:27], v[112:115], a[180:183], a[24:27]
v_cvt_pk_bf16_f32 v78, v52, v53
v_mfma_f32_16x16x32_bf16 a[40:43], v[112:115], a[184:187], a[40:43]
buffer_store_dwordx4 a[240:243], v238, s[20:23], s28 offen offset:0 sc0 sc1
v_exp_f32 v54, v54
v_mfma_f32_16x16x32_bf16 a[44:47], v[116:119], a[184:187], a[44:47]
v_exp_f32 v55, v55
s_waitcnt lgkmcnt(8)
v_mfma_f32_16x16x32_bf16 a[60:63], v[116:119], a[188:191], a[60:63]
ds_read_b64_tr_b16 a[212:213], v220 offset:57344
ds_read_b64_tr_b16 a[214:215], v220 offset:61440
v_cvt_pk_bf16_f32 v79, v54, v55
v_mfma_f32_16x16x32_bf16 a[56:59], v[112:115], a[188:191], a[56:59]
v_exp_f32 v56, v56
v_smfmac_f32_16x16x64_bf16 a[128:131], a[208:211], v[104:111], v245
ds_read_b64_tr_b16 a[216:217], v221 offset:57344
v_exp_f32 v57, v57
v_mfma_f32_16x16x32_bf16 v[12:15], a[160:163], v[152:155], v[136:139]
v_cvt_pk_bf16_f32 v80, v56, v57
v_exp_f32 v58, v58
v_mfma_f32_16x16x32_bf16 v[12:15], a[164:167], v[156:159], v[12:15]
ds_read_b64_tr_b16 a[218:219], v221 offset:61440
buffer_load_dwordx4 v233, s[12:15], s39 offen offset:1024  lds
v_mfma_f32_16x16x32_bf16 v[12:15], a[168:171], v[160:163], v[12:15]
ds_read_b64_tr_b16 a[220:221], v222 offset:57344
v_exp_f32 v59, v59
v_mfma_f32_16x16x32_bf16 v[12:15], a[172:175], v[164:167], v[12:15]
v_cvt_pk_bf16_f32 v81, v58, v59
v_exp_f32 v60, v60
v_mfma_f32_16x16x32_bf16 v[20:23], a[172:175], v[180:183], v[140:143]
ds_read_b64_tr_b16 a[222:223], v222 offset:61440
buffer_load_dwordx4 v232, s[12:15], s39 offen offset:2048  lds
v_mfma_f32_16x16x32_bf16 v[20:23], a[168:171], v[176:179], v[20:23]
ds_read_b64_tr_b16 a[224:225], v223 offset:57344
v_exp_f32 v61, v61
v_mfma_f32_16x16x32_bf16 v[20:23], a[164:167], v[172:175], v[20:23]
v_cvt_pk_bf16_f32 v82, v60, v61
v_exp_f32 v62, v62
v_mfma_f32_16x16x32_bf16 v[20:23], a[160:163], v[168:171], v[20:23]
ds_read_b64_tr_b16 a[226:227], v223 offset:61440
v_mfma_f32_16x16x32_bf16 v[28:31], a[160:163], v[184:187], v[144:147]
ds_read_b64_tr_b16 a[228:229], v224 offset:57344
v_exp_f32 v63, v63
v_mfma_f32_16x16x32_bf16 v[28:31], a[164:167], v[188:191], v[28:31]
v_cvt_pk_bf16_f32 v83, v62, v63
v_exp_f32 v64, v64
v_mfma_f32_16x16x32_bf16 v[28:31], a[168:171], v[192:195], v[28:31]
ds_read_b64_tr_b16 a[230:231], v224 offset:61440
v_exp_f32 v65, v65
v_mfma_f32_16x16x32_bf16 v[28:31], a[172:175], v[196:199], v[28:31]
ds_read_b64_tr_b16 a[232:233], v225 offset:57344
ds_read_b64_tr_b16 a[234:235], v225 offset:61440
v_cvt_pk_bf16_f32 v84, v64, v65
v_mfma_f32_16x16x32_bf16 v[36:39], a[172:175], v[212:215], v[148:151]
ds_read_b128 a[172:175], v219 offset:12288
v_exp_f32 v66, v66
v_mfma_f32_16x16x32_bf16 v[36:39], a[168:171], v[208:211], v[36:39]
ds_read_b128 a[168:171], v218 offset:12288
v_exp_f32 v67, v67
v_mfma_f32_16x16x32_bf16 v[36:39], a[164:167], v[204:207], v[36:39]
ds_read_b64_tr_b16 a[236:237], v226 offset:57344
ds_read_b64_tr_b16 a[238:239], v226 offset:61440
v_cvt_pk_bf16_f32 v85, v66, v67
v_mfma_f32_16x16x32_bf16 v[36:39], a[160:163], v[200:203], v[36:39]
ds_read_b128 a[164:167], v217 offset:12288
v_exp_f32 v68, v68
v_mfma_f32_16x16x32_bf16 a[72:75], v[112:115], a[192:195], a[72:75]
ds_read_b128 a[160:163], v216 offset:12288
v_exp_f32 v69, v69
v_mfma_f32_16x16x32_bf16 a[76:79], v[116:119], a[192:195], a[76:79]
ds_read_b64_tr_b16 a[240:241], v227 offset:57344
ds_read_b64_tr_b16 a[242:243], v227 offset:61440
v_cvt_pk_bf16_f32 v86, v68, v69
v_mfma_f32_16x16x32_bf16 a[92:95], v[116:119], a[196:199], a[92:95]
v_exp_f32 v70, v70
v_mfma_f32_16x16x32_bf16 a[88:91], v[112:115], a[196:199], a[88:91]
v_exp_f32 v71, v71
s_waitcnt lgkmcnt(8)
v_mfma_f32_16x16x32_bf16 a[104:107], v[112:115], a[200:203], a[104:107]
buffer_load_dwordx4 v233, s[12:15], s39 offen offset:3072  lds
v_cvt_pk_bf16_f32 v87, v70, v71
v_mfma_f32_16x16x32_bf16 a[108:111], v[116:119], a[200:203], a[108:111]
v_mfma_f32_16x16x32_bf16 a[124:127], v[116:119], a[204:207], a[124:127]
v_mfma_f32_16x16x32_bf16 a[120:123], v[112:115], a[204:207], a[120:123]
v_smfmac_f32_16x16x64_bf16 a[132:135], a[208:211], v[112:119], v245
s_mov_b32 s33, 6
K_LOOPIN:
s_waitcnt lgkmcnt(0)
v_lshlrev_b32 v241, 4, v1
s_mov_b32 s46, s44
.p2align 6
K_LOOP:
s_cmp_eq_u32 s33, s3
s_cbranch_scc1 K_EVT
K_EVT_RET:
v_mfma_f32_16x16x32_bf16 v[40:43], a[144:147], v[152:155], v[136:139]
v_exp_f32 v8, v8
v_mfma_f32_16x16x32_bf16 v[40:43], a[148:151], v[156:159], v[40:43]
v_exp_f32 v9, v9
v_mfma_f32_16x16x32_bf16 v[40:43], a[152:155], v[160:163], v[40:43]
v_cvt_pk_bf16_f32 v88, v8, v9
v_mfma_f32_16x16x32_bf16 v[40:43], a[156:159], v[164:167], v[40:43]
v_exp_f32 v10, v10
v_mfma_f32_16x16x32_bf16 v[48:51], a[156:159], v[180:183], v[140:143]
v_mfma_f32_16x16x32_bf16 v[48:51], a[152:155], v[176:179], v[48:51]
v_exp_f32 v11, v11
v_mfma_f32_16x16x32_bf16 v[48:51], a[148:151], v[172:175], v[48:51]
v_cvt_pk_bf16_f32 v89, v10, v11
v_mfma_f32_16x16x32_bf16 v[48:51], a[144:147], v[168:171], v[48:51]
v_exp_f32 v12, v12
v_mfma_f32_16x16x32_bf16 v[56:59], a[144:147], v[184:187], v[144:147]
v_mfma_f32_16x16x32_bf16 v[56:59], a[148:151], v[188:191], v[56:59]
v_exp_f32 v13, v13
v_mfma_f32_16x16x32_bf16 v[56:59], a[152:155], v[192:195], v[56:59]
v_cvt_pk_bf16_f32 v90, v12, v13
v_mfma_f32_16x16x32_bf16 v[56:59], a[156:159], v[196:199], v[56:59]
v_exp_f32 v14, v14
v_mfma_f32_16x16x32_bf16 v[64:67], a[156:159], v[212:215], v[148:151]
s_waitcnt vmcnt(10) lgkmcnt(0)
s_barrier
v_mfma_f32_16x16x32_bf16 v[64:67], a[152:155], v[208:211], v[64:67]
v_exp_f32 v15, v15
v_mfma_f32_16x16x32_bf16 v[64:67], a[148:151], v[204:207], v[64:67]
ds_read_b128 a[156:159], v219 offset:16384
v_cvt_pk_bf16_f32 v91, v14, v15
v_mfma_f32_16x16x32_bf16 v[64:67], a[144:147], v[200:203], v[64:67]
v_exp_f32 v16, v16
v_mfma_f32_16x16x32_bf16 a[0:3], v[72:75], a[212:215], a[0:3]
ds_read_b128 a[152:155], v218 offset:16384
ds_read_b128 a[148:151], v217 offset:16384
v_mfma_f32_16x16x32_bf16 a[0:3], v[104:107], a[176:179], a[0:3]
v_exp_f32 v17, v17
v_mfma_f32_16x16x32_bf16 a[4:7], v[108:111], a[176:179], a[4:7]
ds_read_b128 a[144:147], v216 offset:16384
v_cvt_pk_bf16_f32 v92, v16, v17
v_mfma_f32_16x16x32_bf16 a[4:7], v[76:79], a[212:215], a[4:7]
v_exp_f32 v18, v18
v_mfma_f32_16x16x32_bf16 a[20:23], v[76:79], a[216:219], a[20:23]
ds_read_b64_tr_b16 a[176:177], v220 offset:0
ds_read_b64_tr_b16 a[178:179], v220 offset:4096
v_mfma_f32_16x16x32_bf16 a[20:23], v[108:111], a[180:183], a[20:23]
v_exp_f32 v19, v19
v_mfma_f32_16x16x32_bf16 a[16:19], v[104:107], a[180:183], a[16:19]
ds_read_b64_tr_b16 a[180:181], v221 offset:0
v_cvt_pk_bf16_f32 v93, v18, v19
v_mfma_f32_16x16x32_bf16 a[16:19], v[72:75], a[216:219], a[16:19]
v_exp_f32 v20, v20
v_mfma_f32_16x16x32_bf16 a[32:35], v[72:75], a[220:223], a[32:35]
ds_read_b64_tr_b16 a[182:183], v221 offset:4096
s_add_u32 s32, s32, 16384
v_mfma_f32_16x16x32_bf16 a[32:35], v[104:107], a[184:187], a[32:35]
v_exp_f32 v21, v21
v_mfma_f32_16x16x32_bf16 a[36:39], v[108:111], a[184:187], a[36:39]
ds_read_b64_tr_b16 a[184:185], v222 offset:0
v_cvt_pk_bf16_f32 v94, v20, v21
v_mfma_f32_16x16x32_bf16 a[36:39], v[76:79], a[220:223], a[36:39]
v_exp_f32 v22, v22
v_mfma_f32_16x16x32_bf16 a[52:55], v[76:79], a[224:227], a[52:55]
ds_read_b64_tr_b16 a[186:187], v222 offset:4096
s_add_u32 m0, s30, 65536
v_mfma_f32_16x16x32_bf16 a[52:55], v[108:111], a[188:191], a[52:55]
v_exp_f32 v23, v23
v_mfma_f32_16x16x32_bf16 a[48:51], v[104:107], a[188:191], a[48:51]
ds_read_b64_tr_b16 a[188:189], v223 offset:0
v_cvt_pk_bf16_f32 v95, v22, v23
v_mfma_f32_16x16x32_bf16 a[48:51], v[72:75], a[224:227], a[48:51]
v_exp_f32 v24, v24
v_smfmac_f32_16x16x64_bf16 a[128:131], a[208:211], v[72:79], v245
v_exp_f32 v25, v25
v_mfma_f32_16x16x32_bf16 v[44:47], a[160:163], v[152:155], v[136:139]
ds_read_b64_tr_b16 a[190:191], v223 offset:4096
v_cvt_pk_bf16_f32 v96, v24, v25
v_mfma_f32_16x16x32_bf16 v[44:47], a[164:167], v[156:159], v[44:47]
v_exp_f32 v26, v26
v_mfma_f32_16x16x32_bf16 v[44:47], a[168:171], v[160:163], v[44:47]
buffer_load_dwordx4 v228, s[8:11], s32 offen offset:0  lds
v_mfma_f32_16x16x32_bf16 v[44:47], a[172:175], v[164:167], v[44:47]
v_exp_f32 v27, v27
v_mfma_f32_16x16x32_bf16 v[52:55], a[172:175], v[180:183], v[140:143]
v_cvt_pk_bf16_f32 v97, v26, v27
v_mfma_f32_16x16x32_bf16 v[52:55], a[168:171], v[176:179], v[52:55]
v_exp_f32 v28, v28
v_mfma_f32_16x16x32_bf16 v[52:55], a[164:167], v[172:175], v[52:55]
buffer_load_dwordx4 v229, s[8:11], s32 offen offset:1024  lds
v_mfma_f32_16x16x32_bf16 v[52:55], a[160:163], v[168:171], v[52:55]
v_exp_f32 v29, v29
v_mfma_f32_16x16x32_bf16 v[60:63], a[160:163], v[184:187], v[144:147]
v_cvt_pk_bf16_f32 v98, v28, v29
v_mfma_f32_16x16x32_bf16 v[60:63], a[164:167], v[188:191], v[60:63]
v_exp_f32 v30, v30
v_mfma_f32_16x16x32_bf16 v[60:63], a[168:171], v[192:195], v[60:63]
buffer_load_dwordx4 v230, s[8:11], s32 offen offset:2048  lds
v_mfma_f32_16x16x32_bf16 v[60:63], a[172:175], v[196:199], v[60:63]
v_exp_f32 v31, v31
v_mfma_f32_16x16x32_bf16 v[68:71], a[172:175], v[212:215], v[148:151]
ds_read_b128 a[172:175], v219 offset:20480
v_cvt_pk_bf16_f32 v99, v30, v31
v_mfma_f32_16x16x32_bf16 v[68:71], a[168:171], v[208:211], v[68:71]
v_exp_f32 v32, v32
v_mfma_f32_16x16x32_bf16 v[68:71], a[164:167], v[204:207], v[68:71]
ds_read_b128 a[168:171], v218 offset:20480
ds_read_b128 a[164:167], v217 offset:20480
v_mfma_f32_16x16x32_bf16 v[68:71], a[160:163], v[200:203], v[68:71]
v_exp_f32 v33, v33
v_mfma_f32_16x16x32_bf16 a[64:67], v[72:75], a[228:231], a[64:67]
ds_read_b128 a[160:163], v216 offset:20480
v_cvt_pk_bf16_f32 v100, v32, v33
v_mfma_f32_16x16x32_bf16 a[64:67], v[104:107], a[192:195], a[64:67]
v_exp_f32 v34, v34
v_mfma_f32_16x16x32_bf16 a[68:71], v[108:111], a[192:195], a[68:71]
ds_read_b64_tr_b16 a[192:193], v224 offset:0
ds_read_b64_tr_b16 a[194:195], v224 offset:4096
v_mfma_f32_16x16x32_bf16 a[68:71], v[76:79], a[228:231], a[68:71]
v_exp_f32 v35, v35
v_mfma_f32_16x16x32_bf16 a[84:87], v[76:79], a[232:235], a[84:87]
v_cvt_pk_bf16_f32 v101, v34, v35
v_mfma_f32_16x16x32_bf16 a[84:87], v[108:111], a[196:199], a[84:87]
v_exp_f32 v36, v36
v_mfma_f32_16x16x32_bf16 a[80:83], v[104:107], a[196:199], a[80:83]
ds_read_b64_tr_b16 a[196:197], v225 offset:0
ds_read_b64_tr_b16 a[198:199], v225 offset:4096
v_mfma_f32_16x16x32_bf16 a[80:83], v[72:75], a[232:235], a[80:83]
v_exp_f32 v37, v37
v_mfma_f32_16x16x32_bf16 a[96:99], v[72:75], a[236:239], a[96:99]
v_cvt_pk_bf16_f32 v102, v36, v37
v_mfma_f32_16x16x32_bf16 a[96:99], v[104:107], a[200:203], a[96:99]
v_exp_f32 v38, v38
v_mfma_f32_16x16x32_bf16 a[100:103], v[108:111], a[200:203], a[100:103]
ds_read_b64_tr_b16 a[200:201], v226 offset:0
ds_read_b64_tr_b16 a[202:203], v226 offset:4096
v_mfma_f32_16x16x32_bf16 a[100:103], v[76:79], a[236:239], a[100:103]
v_exp_f32 v39, v39
v_mfma_f32_16x16x32_bf16 a[116:119], v[76:79], a[240:243], a[116:119]
v_cvt_pk_bf16_f32 v103, v38, v39
v_mfma_f32_16x16x32_bf16 a[116:119], v[108:111], a[204:207], a[116:119]
buffer_load_dwordx4 v231, s[8:11], s32 offen offset:3072  lds
v_mfma_f32_16x16x32_bf16 a[112:115], v[104:107], a[204:207], a[112:115]
ds_read_b64_tr_b16 a[204:205], v227 offset:0
ds_read_b64_tr_b16 a[206:207], v227 offset:4096
v_mfma_f32_16x16x32_bf16 a[112:115], v[72:75], a[240:243], a[112:115]
s_mov_b32 m0, s87
s_lshl2_add_u32 s50, s87, s89
buffer_load_dwordx4 v243, s[56:59], s50 offen  lds
v_smfmac_f32_16x16x64_bf16 a[132:135], a[208:211], v[80:87], v245
s_add_u32 s87, s87, 3456
s_min_u32 s87, s87, 63936
s_waitcnt lgkmcnt(8)
v_mfma_f32_16x16x32_bf16 v[8:11], a[144:147], v[152:155], v[136:139]
v_exp_f32 v40, v40
v_mfma_f32_16x16x32_bf16 v[8:11], a[148:151], v[156:159], v[8:11]
v_exp_f32 v41, v41
v_mfma_f32_16x16x32_bf16 v[8:11], a[152:155], v[160:163], v[8:11]
v_cvt_pk_bf16_f32 v104, v40, v41
v_mfma_f32_16x16x32_bf16 v[8:11], a[156:159], v[164:167], v[8:11]
v_exp_f32 v42, v42
v_mfma_f32_16x16x32_bf16 v[16:19], a[156:159], v[180:183], v[140:143]
s_add_u32 s39, s39, 16384
v_mfma_f32_16x16x32_bf16 v[16:19], a[152:155], v[176:179], v[16:19]
v_exp_f32 v43, v43
v_mfma_f32_16x16x32_bf16 v[16:19], a[148:151], v[172:175], v[16:19]
v_cvt_pk_bf16_f32 v105, v42, v43
v_mfma_f32_16x16x32_bf16 v[16:19], a[144:147], v[168:171], v[16:19]
v_exp_f32 v44, v44
v_mfma_f32_16x16x32_bf16 v[24:27], a[144:147], v[184:187], v[144:147]
v_mfma_f32_16x16x32_bf16 v[24:27], a[148:151], v[188:191], v[24:27]
v_exp_f32 v45, v45
v_mfma_f32_16x16x32_bf16 v[24:27], a[152:155], v[192:195], v[24:27]
s_add_u32 m0, s30, 147456
v_cvt_pk_bf16_f32 v106, v44, v45
v_mfma_f32_16x16x32_bf16 v[24:27], a[156:159], v[196:199], v[24:27]
v_exp_f32 v46, v46
v_mfma_f32_16x16x32_bf16 v[32:35], a[156:159], v[212:215], v[148:151]
ds_read_b128 a[156:159], v219 offset:24576
v_mfma_f32_16x16x32_bf16 v[32:35], a[152:155], v[208:211], v[32:35]
v_exp_f32 v47, v47
v_mfma_f32_16x16x32_bf16 v[32:35], a[148:151], v[204:207], v[32:35]
ds_read_b128 a[152:155], v218 offset:24576
v_cvt_pk_bf16_f32 v107, v46, v47
v_mfma_f32_16x16x32_bf16 v[32:35], a[144:147], v[200:203], v[32:35]
v_exp_f32 v48, v48
v_mfma_f32_16x16x32_bf16 a[8:11], v[96:99], a[176:179], a[8:11]
ds_read_b128 a[148:151], v217 offset:24576
ds_read_b128 a[144:147], v216 offset:24576
v_mfma_f32_16x16x32_bf16 a[8:11], v[80:83], a[212:215], a[8:11]
v_exp_f32 v49, v49
v_mfma_f32_16x16x32_bf16 a[12:15], v[84:87], a[212:215], a[12:15]
ds_read_b64_tr_b16 a[212:213], v220 offset:8192
v_cvt_pk_bf16_f32 v108, v48, v49
v_mfma_f32_16x16x32_bf16 a[12:15], v[100:103], a[176:179], a[12:15]
v_exp_f32 v50, v50
v_mfma_f32_16x16x32_bf16 a[28:31], v[100:103], a[180:183], a[28:31]
ds_read_b64_tr_b16 a[214:215], v220 offset:12288
v_mfma_f32_16x16x32_bf16 a[28:31], v[84:87], a[216:219], a[28:31]
v_exp_f32 v51, v51
v_mfma_f32_16x16x32_bf16 a[24:27], v[80:83], a[216:219], a[24:27]
ds_read_b64_tr_b16 a[216:217], v221 offset:8192
v_cvt_pk_bf16_f32 v109, v50, v51
v_mfma_f32_16x16x32_bf16 a[24:27], v[96:99], a[180:183], a[24:27]
v_exp_f32 v52, v52
v_mfma_f32_16x16x32_bf16 a[40:43], v[96:99], a[184:187], a[40:43]
ds_read_b64_tr_b16 a[218:219], v221 offset:12288
v_mfma_f32_16x16x32_bf16 a[40:43], v[80:83], a[220:223], a[40:43]
v_exp_f32 v53, v53
v_mfma_f32_16x16x32_bf16 a[44:47], v[84:87], a[220:223], a[44:47]
ds_read_b64_tr_b16 a[220:221], v222 offset:8192
v_cvt_pk_bf16_f32 v110, v52, v53
v_mfma_f32_16x16x32_bf16 a[44:47], v[100:103], a[184:187], a[44:47]
v_exp_f32 v54, v54
v_mfma_f32_16x16x32_bf16 a[60:63], v[100:103], a[188:191], a[60:63]
ds_read_b64_tr_b16 a[222:223], v222 offset:12288
v_mfma_f32_16x16x32_bf16 a[60:63], v[84:87], a[224:227], a[60:63]
v_exp_f32 v55, v55
v_mfma_f32_16x16x32_bf16 a[56:59], v[80:83], a[224:227], a[56:59]
ds_read_b64_tr_b16 a[224:225], v223 offset:8192
v_cvt_pk_bf16_f32 v111, v54, v55
v_mfma_f32_16x16x32_bf16 a[56:59], v[96:99], a[188:191], a[56:59]
v_exp_f32 v56, v56
v_smfmac_f32_16x16x64_bf16 a[128:131], a[208:211], v[88:95], v245
v_exp_f32 v57, v57
v_mfma_f32_16x16x32_bf16 v[12:15], a[160:163], v[152:155], v[136:139]
ds_read_b64_tr_b16 a[226:227], v223 offset:12288
v_cvt_pk_bf16_f32 v112, v56, v57
v_mfma_f32_16x16x32_bf16 v[12:15], a[164:167], v[156:159], v[12:15]
v_exp_f32 v58, v58
v_mfma_f32_16x16x32_bf16 v[12:15], a[168:171], v[160:163], v[12:15]
buffer_load_dwordx4 v232, s[12:15], s39 offen offset:0  lds
v_mfma_f32_16x16x32_bf16 v[12:15], a[172:175], v[164:167], v[12:15]
v_exp_f32 v59, v59
v_mfma_f32_16x16x32_bf16 v[20:23], a[172:175], v[180:183], v[140:143]
v_cvt_pk_bf16_f32 v113, v58, v59
v_mfma_f32_16x16x32_bf16 v[20:23], a[168:171], v[176:179], v[20:23]
v_exp_f32 v60, v60
v_mfma_f32_16x16x32_bf16 v[20:23], a[164:167], v[172:175], v[20:23]
buffer_load_dwordx4 v233, s[12:15], s39 offen offset:1024  lds
v_mfma_f32_16x16x32_bf16 v[20:23], a[160:163], v[168:171], v[20:23]
v_exp_f32 v61, v61
v_mfma_f32_16x16x32_bf16 v[28:31], a[160:163], v[184:187], v[144:147]
v_cvt_pk_bf16_f32 v114, v60, v61
v_mfma_f32_16x16x32_bf16 v[28:31], a[164:167], v[188:191], v[28:31]
v_exp_f32 v62, v62
v_mfma_f32_16x16x32_bf16 v[28:31], a[168:171], v[192:195], v[28:31]
buffer_load_dwordx4 v232, s[12:15], s39 offen offset:2048  lds
v_mfma_f32_16x16x32_bf16 v[28:31], a[172:175], v[196:199], v[28:31]
v_exp_f32 v63, v63
v_mfma_f32_16x16x32_bf16 v[36:39], a[172:175], v[212:215], v[148:151]
ds_read_b128 a[172:175], v219 offset:28672
v_cvt_pk_bf16_f32 v115, v62, v63
v_mfma_f32_16x16x32_bf16 v[36:39], a[168:171], v[208:211], v[36:39]
v_exp_f32 v64, v64
v_mfma_f32_16x16x32_bf16 v[36:39], a[164:167], v[204:207], v[36:39]
ds_read_b128 a[168:171], v218 offset:28672
ds_read_b128 a[164:167], v217 offset:28672
v_mfma_f32_16x16x32_bf16 v[36:39], a[160:163], v[200:203], v[36:39]
v_exp_f32 v65, v65
s_waitcnt lgkmcnt(8)
v_mfma_f32_16x16x32_bf16 a[72:75], v[96:99], a[192:195], a[72:75]
ds_read_b128 a[160:163], v216 offset:28672
v_cvt_pk_bf16_f32 v116, v64, v65
v_mfma_f32_16x16x32_bf16 a[72:75], v[80:83], a[228:231], a[72:75]
v_exp_f32 v66, v66
v_mfma_f32_16x16x32_bf16 a[76:79], v[84:87], a[228:231], a[76:79]
ds_read_b64_tr_b16 a[228:229], v224 offset:8192
ds_read_b64_tr_b16 a[230:231], v224 offset:12288
v_mfma_f32_16x16x32_bf16 a[76:79], v[100:103], a[192:195], a[76:79]
v_exp_f32 v67, v67
v_mfma_f32_16x16x32_bf16 a[92:95], v[100:103], a[196:199], a[92:95]
v_cvt_pk_bf16_f32 v117, v66, v67
v_mfma_f32_16x16x32_bf16 a[92:95], v[84:87], a[232:235], a[92:95]
v_exp_f32 v68, v68
v_mfma_f32_16x16x32_bf16 a[88:91], v[80:83], a[232:235], a[88:91]
ds_read_b64_tr_b16 a[232:233], v225 offset:8192
ds_read_b64_tr_b16 a[234:235], v225 offset:12288
v_mfma_f32_16x16x32_bf16 a[88:91], v[96:99], a[196:199], a[88:91]
v_exp_f32 v69, v69
v_mfma_f32_16x16x32_bf16 a[104:107], v[96:99], a[200:203], a[104:107]
v_cvt_pk_bf16_f32 v118, v68, v69
v_mfma_f32_16x16x32_bf16 a[104:107], v[80:83], a[236:239], a[104:107]
v_exp_f32 v70, v70
v_mfma_f32_16x16x32_bf16 a[108:111], v[84:87], a[236:239], a[108:111]
ds_read_b64_tr_b16 a[236:237], v226 offset:8192
ds_read_b64_tr_b16 a[238:239], v226 offset:12288
v_mfma_f32_16x16x32_bf16 a[108:111], v[100:103], a[200:203], a[108:111]
v_exp_f32 v71, v71
v_mfma_f32_16x16x32_bf16 a[124:127], v[100:103], a[204:207], a[124:127]
v_cvt_pk_bf16_f32 v119, v70, v71
v_mfma_f32_16x16x32_bf16 a[124:127], v[84:87], a[240:243], a[124:127]
buffer_load_dwordx4 v233, s[12:15], s39 offen offset:3072  lds
v_mfma_f32_16x16x32_bf16 a[120:123], v[80:83], a[240:243], a[120:123]
ds_read_b64_tr_b16 a[240:241], v227 offset:8192
ds_read_b64_tr_b16 a[242:243], v227 offset:12288
v_mfma_f32_16x16x32_bf16 a[120:123], v[96:99], a[204:207], a[120:123]
buffer_load_dword v242, v241, s[20:23], s46 offen sc1
v_smfmac_f32_16x16x64_bf16 a[132:135], a[208:211], v[96:103], v245
v_add_u32 v241, 1024, v241
v_and_b32 v241, 0x3fff, v241
v_mfma_f32_16x16x32_bf16 v[40:43], a[144:147], v[152:155], v[136:139]
v_exp_f32 v8, v8
v_mfma_f32_16x16x32_bf16 v[40:43], a[148:151], v[156:159], v[40:43]
v_exp_f32 v9, v9
v_mfma_f32_16x16x32_bf16 v[40:43], a[152:155], v[160:163], v[40:43]
v_cvt_pk_bf16_f32 v72, v8, v9
v_mfma_f32_16x16x32_bf16 v[40:43], a[156:159], v[164:167], v[40:43]
v_exp_f32 v10, v10
v_mfma_f32_16x16x32_bf16 v[48:51], a[156:159], v[180:183], v[140:143]
v_mfma_f32_16x16x32_bf16 v[48:51], a[152:155], v[176:179], v[48:51]
v_exp_f32 v11, v11
v_mfma_f32_16x16x32_bf16 v[48:51], a[148:151], v[172:175], v[48:51]
v_cvt_pk_bf16_f32 v73, v10, v11
v_mfma_f32_16x16x32_bf16 v[48:51], a[144:147], v[168:171], v[48:51]
v_exp_f32 v12, v12
v_mfma_f32_16x16x32_bf16 v[56:59], a[144:147], v[184:187], v[144:147]
v_mfma_f32_16x16x32_bf16 v[56:59], a[148:151], v[188:191], v[56:59]
v_exp_f32 v13, v13
v_mfma_f32_16x16x32_bf16 v[56:59], a[152:155], v[192:195], v[56:59]
v_cvt_pk_bf16_f32 v74, v12, v13
v_mfma_f32_16x16x32_bf16 v[56:59], a[156:159], v[196:199], v[56:59]
v_exp_f32 v14, v14
v_mfma_f32_16x16x32_bf16 v[64:67], a[156:159], v[212:215], v[148:151]
s_waitcnt vmcnt(10) lgkmcnt(0)
s_barrier
v_mfma_f32_16x16x32_bf16 v[64:67], a[152:155], v[208:211], v[64:67]
v_exp_f32 v15, v15
v_mfma_f32_16x16x32_bf16 v[64:67], a[148:151], v[204:207], v[64:67]
ds_read_b128 a[156:159], v219 offset:49152
v_cvt_pk_bf16_f32 v75, v14, v15
v_mfma_f32_16x16x32_bf16 v[64:67], a[144:147], v[200:203], v[64:67]
v_exp_f32 v16, v16
v_mfma_f32_16x16x32_bf16 a[0:3], v[104:107], a[212:215], a[0:3]
ds_read_b128 a[152:155], v218 offset:49152
ds_read_b128 a[148:151], v217 offset:49152
v_mfma_f32_16x16x32_bf16 a[0:3], v[88:91], a[176:179], a[0:3]
v_exp_f32 v17, v17
v_mfma_f32_16x16x32_bf16 a[4:7], v[92:95], a[176:179], a[4:7]
ds_read_b128 a[144:147], v216 offset:49152
v_cvt_pk_bf16_f32 v76, v16, v17
v_mfma_f32_16x16x32_bf16 a[4:7], v[108:111], a[212:215], a[4:7]
v_exp_f32 v18, v18
v_mfma_f32_16x16x32_bf16 a[20:23], v[108:111], a[216:219], a[20:23]
ds_read_b64_tr_b16 a[176:177], v220 offset:32768
ds_read_b64_tr_b16 a[178:179], v220 offset:36864
v_mfma_f32_16x16x32_bf16 a[20:23], v[92:95], a[180:183], a[20:23]
v_exp_f32 v19, v19
v_mfma_f32_16x16x32_bf16 a[16:19], v[88:91], a[180:183], a[16:19]
ds_read_b64_tr_b16 a[180:181], v221 offset:32768
v_cvt_pk_bf16_f32 v77, v18, v19
v_mfma_f32_16x16x32_bf16 a[16:19], v[104:107], a[216:219], a[16:19]
v_exp_f32 v20, v20
v_mfma_f32_16x16x32_bf16 a[32:35], v[104:107], a[220:223], a[32:35]
ds_read_b64_tr_b16 a[182:183], v221 offset:36864
STUB_10:
s_cbranch_execz HOP_RET1
s_add_u32 s32, s32, 16384
v_mfma_f32_16x16x32_bf16 a[32:35], v[88:91], a[184:187], a[32:35]
v_exp_f32 v21, v21
v_mfma_f32_16x16x32_bf16 a[36:39], v[92:95], a[184:187], a[36:39]
ds_read_b64_tr_b16 a[184:185], v222 offset:32768
v_cvt_pk_bf16_f32 v78, v20, v21
v_mfma_f32_16x16x32_bf16 a[36:39], v[108:111], a[220:223], a[36:39]
v_exp_f32 v22, v22
v_mfma_f32_16x16x32_bf16 a[52:55], v[108:111], a[224:227], a[52:55]
ds_read_b64_tr_b16 a[186:187], v222 offset:36864
s_add_u32 m0, s30, 81920
v_mfma_f32_16x16x32_bf16 a[52:55], v[92:95], a[188:191], a[52:55]
v_exp_f32 v23, v23
v_mfma_f32_16x16x32_bf16 a[48:51], v[88:91], a[188:191], a[48:51]
ds_read_b64_tr_b16 a[188:189], v223 offset:32768
v_cvt_pk_bf16_f32 v79, v22, v23
v_mfma_f32_16x16x32_bf16 a[48:51], v[104:107], a[224:227], a[48:51]
v_exp_f32 v24, v24
v_smfmac_f32_16x16x64_bf16 a[128:131], a[208:211], v[104:111], v245
v_exp_f32 v25, v25
v_mfma_f32_16x16x32_bf16 v[44:47], a[160:163], v[152:155], v[136:139]
ds_read_b64_tr_b16 a[190:191], v223 offset:36864
v_cvt_pk_bf16_f32 v80, v24, v25
v_mfma_f32_16x16x32_bf16 v[44:47], a[164:167], v[156:159], v[44:47]
v_exp_f32 v26, v26
v_mfma_f32_16x16x32_bf16 v[44:47], a[168:171], v[160:163], v[44:47]
buffer_load_dwordx4 v228, s[8:11], s32 offen offset:0  lds
v_mfma_f32_16x16x32_bf16 v[44:47], a[172:175], v[164:167], v[44:47]
v_exp_f32 v27, v27
v_mfma_f32_16x16x32_bf16 v[52:55], a[172:175], v[180:183], v[140:143]
v_cvt_pk_bf16_f32 v81, v26, v27
v_mfma_f32_16x16x32_bf16 v[52:55], a[168:171], v[176:179], v[52:55]
v_exp_f32 v28, v28
v_mfma_f32_16x16x32_bf16 v[52:55], a[164:167], v[172:175], v[52:55]
buffer_load_dwordx4 v229, s[8:11], s32 offen offset:1024  lds
v_mfma_f32_16x16x32_bf16 v[52:55], a[160:163], v[168:171], v[52:55]
v_exp_f32 v29, v29
v_mfma_f32_16x16x32_bf16 v[60:63], a[160:163], v[184:187], v[144:147]
v_cvt_pk_bf16_f32 v82, v28, v29
v_mfma_f32_16x16x32_bf16 v[60:63], a[164:167], v[188:191], v[60:63]
v_exp_f32 v30, v30
v_mfma_f32_16x16x32_bf16 v[60:63], a[168:171], v[192:195], v[60:63]
buffer_load_dwordx4 v230, s[8:11], s32 offen offset:2048  lds
v_mfma_f32_16x16x32_bf16 v[60:63], a[172:175], v[196:199], v[60:63]
v_exp_f32 v31, v31
v_mfma_f32_16x16x32_bf16 v[68:71], a[172:175], v[212:215], v[148:151]
ds_read_b128 a[172:175], v219 offset:53248
v_cvt_pk_bf16_f32 v83, v30, v31
v_mfma_f32_16x16x32_bf16 v[68:71], a[168:171], v[208:211], v[68:71]
v_exp_f32 v32, v32
v_mfma_f32_16x16x32_bf16 v[68:71], a[164:167], v[204:207], v[68:71]
ds_read_b128 a[168:171], v218 offset:53248
ds_read_b128 a[164:167], v217 offset:53248
v_mfma_f32_16x16x32_bf16 v[68:71], a[160:163], v[200:203], v[68:71]
v_exp_f32 v33, v33
v_mfma_f32_16x16x32_bf16 a[64:67], v[104:107], a[228:231], a[64:67]
ds_read_b128 a[160:163], v216 offset:53248
v_cvt_pk_bf16_f32 v84, v32, v33
v_mfma_f32_16x16x32_bf16 a[64:67], v[88:91], a[192:195], a[64:67]
v_exp_f32 v34, v34
v_mfma_f32_16x16x32_bf16 a[68:71], v[92:95], a[192:195], a[68:71]
ds_read_b64_tr_b16 a[192:193], v224 offset:32768
ds_read_b64_tr_b16 a[194:195], v224 offset:36864
v_mfma_f32_16x16x32_bf16 a[68:71], v[108:111], a[228:231], a[68:71]
v_exp_f32 v35, v35
v_mfma_f32_16x16x32_bf16 a[84:87], v[108:111], a[232:235], a[84:87]
v_cvt_pk_bf16_f32 v85, v34, v35
v_mfma_f32_16x16x32_bf16 a[84:87], v[92:95], a[196:199], a[84:87]
v_exp_f32 v36, v36
v_mfma_f32_16x16x32_bf16 a[80:83], v[88:91], a[196:199], a[80:83]
ds_read_b64_tr_b16 a[196:197], v225 offset:32768
ds_read_b64_tr_b16 a[198:199], v225 offset:36864
v_mfma_f32_16x16x32_bf16 a[80:83], v[104:107], a[232:235], a[80:83]
v_exp_f32 v37, v37
v_mfma_f32_16x16x32_bf16 a[96:99], v[104:107], a[236:239], a[96:99]
v_cvt_pk_bf16_f32 v86, v36, v37
v_mfma_f32_16x16x32_bf16 a[96:99], v[88:91], a[200:203], a[96:99]
v_exp_f32 v38, v38
v_mfma_f32_16x16x32_bf16 a[100:103], v[92:95], a[200:203], a[100:103]
ds_read_b64_tr_b16 a[200:201], v226 offset:32768
ds_read_b64_tr_b16 a[202:203], v226 offset:36864
v_mfma_f32_16x16x32_bf16 a[100:103], v[108:111], a[236:239], a[100:103]
v_exp_f32 v39, v39
v_mfma_f32_16x16x32_bf16 a[116:119], v[108:111], a[240:243], a[116:119]
v_cvt_pk_bf16_f32 v87, v38, v39
v_mfma_f32_16x16x32_bf16 a[116:119], v[92:95], a[204:207], a[116:119]
buffer_load_dwordx4 v231, s[8:11], s32 offen offset:3072  lds
v_mfma_f32_16x16x32_bf16 a[112:115], v[88:91], a[204:207], a[112:115]
ds_read_b64_tr_b16 a[204:205], v227 offset:32768
ds_read_b64_tr_b16 a[206:207], v227 offset:36864
v_mfma_f32_16x16x32_bf16 a[112:115], v[104:107], a[240:243], a[112:115]
s_mov_b32 m0, s87
s_lshl2_add_u32 s50, s87, s89
buffer_load_dwordx4 v243, s[56:59], s50 offen  lds
v_smfmac_f32_16x16x64_bf16 a[132:135], a[208:211], v[112:119], v245
s_add_u32 s87, s87, 3456
s_min_u32 s87, s87, 63936
s_waitcnt lgkmcnt(8)
v_mfma_f32_16x16x32_bf16 v[8:11], a[144:147], v[152:155], v[136:139]
v_exp_f32 v40, v40
v_mfma_f32_16x16x32_bf16 v[8:11], a[148:151], v[156:159], v[8:11]
v_exp_f32 v41, v41
v_mfma_f32_16x16x32_bf16 v[8:11], a[152:155], v[160:163], v[8:11]
v_cvt_pk_bf16_f32 v88, v40, v41
v_mfma_f32_16x16x32_bf16 v[8:11], a[156:159], v[164:167], v[8:11]
v_exp_f32 v42, v42
v_mfma_f32_16x16x32_bf16 v[16:19], a[156:159], v[180:183], v[140:143]
s_add_u32 s39, s39, 16384
v_mfma_f32_16x16x32_bf16 v[16:19], a[152:155], v[176:179], v[16:19]
v_exp_f32 v43, v43
v_mfma_f32_16x16x32_bf16 v[16:19], a[148:151], v[172:175], v[16:19]
v_cvt_pk_bf16_f32 v89, v42, v43
v_mfma_f32_16x16x32_bf16 v[16:19], a[144:147], v[168:171], v[16:19]
v_exp_f32 v44, v44
v_mfma_f32_16x16x32_bf16 v[24:27], a[144:147], v[184:187], v[144:147]
v_mfma_f32_16x16x32_bf16 v[24:27], a[148:151], v[188:191], v[24:27]
v_exp_f32 v45, v45
v_mfma_f32_16x16x32_bf16 v[24:27], a[152:155], v[192:195], v[24:27]
s_add_u32 m0, s30, 98304
v_cvt_pk_bf16_f32 v90, v44, v45
v_mfma_f32_16x16x32_bf16 v[24:27], a[156:159], v[196:199], v[24:27]
v_exp_f32 v46, v46
v_mfma_f32_16x16x32_bf16 v[32:35], a[156:159], v[212:215], v[148:151]
ds_read_b128 a[156:159], v219 offset:57344
v_mfma_f32_16x16x32_bf16 v[32:35], a[152:155], v[208:211], v[32:35]
v_exp_f32 v47, v47
v_mfma_f32_16x16x32_bf16 v[32:35], a[148:151], v[204:207], v[32:35]
ds_read_b128 a[152:155], v218 offset:57344
v_cvt_pk_bf16_f32 v91, v46, v47
v_mfma_f32_16x16x32_bf16 v[32:35], a[144:147], v[200:203], v[32:35]
v_exp_f32 v48, v48
v_mfma_f32_16x16x32_bf16 a[8:11], v[80:83], a[176:179], a[8:11]
ds_read_b128 a[148:151], v217 offset:57344
ds_read_b128 a[144:147], v216 offset:57344
v_mfma_f32_16x16x32_bf16 a[8:11], v[112:115], a[212:215], a[8:11]
v_exp_f32 v49, v49
v_mfma_f32_16x16x32_bf16 a[12:15], v[116:119], a[212:215], a[12:15]
ds_read_b64_tr_b16 a[212:213], v220 offset:40960
v_cvt_pk_bf16_f32 v92, v48, v49
v_mfma_f32_16x16x32_bf16 a[12:15], v[84:87], a[176:179], a[12:15]
v_exp_f32 v50, v50
v_mfma_f32_16x16x32_bf16 a[28:31], v[84:87], a[180:183], a[28:31]
ds_read_b64_tr_b16 a[214:215], v220 offset:45056
v_mfma_f32_16x16x32_bf16 a[28:31], v[116:119], a[216:219], a[28:31]
v_exp_f32 v51, v51
v_mfma_f32_16x16x32_bf16 a[24:27], v[112:115], a[216:219], a[24:27]
ds_read_b64_tr_b16 a[216:217], v221 offset:40960
v_cvt_pk_bf16_f32 v93, v50, v51
v_mfma_f32_16x16x32_bf16 a[24:27], v[80:83], a[180:183], a[24:27]
v_exp_f32 v52, v52
v_mfma_f32_16x16x32_bf16 a[40:43], v[80:83], a[184:187], a[40:43]
ds_read_b64_tr_b16 a[218:219], v221 offset:45056
v_mfma_f32_16x16x32_bf16 a[40:43], v[112:115], a[220:223], a[40:43]
v_exp_f32 v53, v53
v_mfma_f32_16x16x32_bf16 a[44:47], v[116:119], a[220:223], a[44:47]
ds_read_b64_tr_b16 a[220:221], v222 offset:40960
v_cvt_pk_bf16_f32 v94, v52, v53
v_mfma_f32_16x16x32_bf16 a[44:47], v[84:87], a[184:187], a[44:47]
v_exp_f32 v54, v54
v_mfma_f32_16x16x32_bf16 a[60:63], v[84:87], a[188:191], a[60:63]
ds_read_b64_tr_b16 a[222:223], v222 offset:45056
v_mfma_f32_16x16x32_bf16 a[60:63], v[116:119], a[224:227], a[60:63]
v_exp_f32 v55, v55
v_mfma_f32_16x16x32_bf16 a[56:59], v[112:115], a[224:227], a[56:59]
ds_read_b64_tr_b16 a[224:225], v223 offset:40960
v_cvt_pk_bf16_f32 v95, v54, v55
v_mfma_f32_16x16x32_bf16 a[56:59], v[80:83], a[188:191], a[56:59]
v_exp_f32 v56, v56
v_smfmac_f32_16x16x64_bf16 a[128:131], a[208:211], v[72:79], v245
v_exp_f32 v57, v57
v_mfma_f32_16x16x32_bf16 v[12:15], a[160:163], v[152:155], v[136:139]
ds_read_b64_tr_b16 a[226:227], v223 offset:45056
v_cvt_pk_bf16_f32 v96, v56, v57
v_mfma_f32_16x16x32_bf16 v[12:15], a[164:167], v[156:159], v[12:15]
v_exp_f32 v58, v58
v_mfma_f32_16x16x32_bf16 v[12:15], a[168:171], v[160:163], v[12:15]
buffer_load_dwordx4 v232, s[12:15], s39 offen offset:0  lds
v_mfma_f32_16x16x32_bf16 v[12:15], a[172:175], v[164:167], v[12:15]
v_exp_f32 v59, v59
v_mfma_f32_16x16x32_bf16 v[20:23], a[172:175], v[180:183], v[140:143]
v_cvt_pk_bf16_f32 v97, v58, v59
v_mfma_f32_16x16x32_bf16 v[20:23], a[168:171], v[176:179], v[20:23]
v_exp_f32 v60, v60
v_mfma_f32_16x16x32_bf16 v[20:23], a[164:167], v[172:175], v[20:23]
buffer_load_dwordx4 v233, s[12:15], s39 offen offset:1024  lds
v_mfma_f32_16x16x32_bf16 v[20:23], a[160:163], v[168:171], v[20:23]
v_exp_f32 v61, v61
v_mfma_f32_16x16x32_bf16 v[28:31], a[160:163], v[184:187], v[144:147]
v_cvt_pk_bf16_f32 v98, v60, v61
v_mfma_f32_16x16x32_bf16 v[28:31], a[164:167], v[188:191], v[28:31]
v_exp_f32 v62, v62
v_mfma_f32_16x16x32_bf16 v[28:31], a[168:171], v[192:195], v[28:31]
buffer_load_dwordx4 v232, s[12:15], s39 offen offset:2048  lds
v_mfma_f32_16x16x32_bf16 v[28:31], a[172:175], v[196:199], v[28:31]
v_exp_f32 v63, v63
v_mfma_f32_16x16x32_bf16 v[36:39], a[172:175], v[212:215], v[148:151]
ds_read_b128 a[172:175], v219 offset:61440
v_cvt_pk_bf16_f32 v99, v62, v63
v_mfma_f32_16x16x32_bf16 v[36:39], a[168:171], v[208:211], v[36:39]
v_exp_f32 v64, v64
v_mfma_f32_16x16x32_bf16 v[36:39], a[164:167], v[204:207], v[36:39]
ds_read_b128 a[168:171], v218 offset:61440
ds_read_b128 a[164:167], v217 offset:61440
v_mfma_f32_16x16x32_bf16 v[36:39], a[160:163], v[200:203], v[36:39]
v_exp_f32 v65, v65
s_waitcnt lgkmcnt(8)
v_mfma_f32_16x16x32_bf16 a[72:75], v[80:83], a[192:195], a[72:75]
ds_read_b128 a[160:163], v216 offset:61440
v_cvt_pk_bf16_f32 v100, v64, v65
v_mfma_f32_16x16x32_bf16 a[72:75], v[112:115], a[228:231], a[72:75]
v_exp_f32 v66, v66
v_mfma_f32_16x16x32_bf16 a[76:79], v[116:119], a[228:231], a[76:79]
ds_read_b64_tr_b16 a[228:229], v224 offset:40960
ds_read_b64_tr_b16 a[230:231], v224 offset:45056
v_mfma_f32_16x16x32_bf16 a[76:79], v[84:87], a[192:195], a[76:79]
v_exp_f32 v67, v67
v_mfma_f32_16x16x32_bf16 a[92:95], v[84:87], a[196:199], a[92:95]
v_cvt_pk_bf16_f32 v101, v66, v67
v_mfma_f32_16x16x32_bf16 a[92:95], v[116:119], a[232:235], a[92:95]
v_exp_f32 v68, v68
v_mfma_f32_16x16x32_bf16 a[88:91], v[112:115], a[232:235], a[88:91]
ds_read_b64_tr_b16 a[232:233], v225 offset:40960
ds_read_b64_tr_b16 a[234:235], v225 offset:45056
v_mfma_f32_16x16x32_bf16 a[88:91], v[80:83], a[196:199], a[88:91]
v_exp_f32 v69, v69
v_mfma_f32_16x16x32_bf16 a[104:107], v[80:83], a[200:203], a[104:107]
v_cvt_pk_bf16_f32 v102, v68, v69
v_mfma_f32_16x16x32_bf16 a[104:107], v[112:115], a[236:239], a[104:107]
v_exp_f32 v70, v70
v_mfma_f32_16x16x32_bf16 a[108:111], v[116:119], a[236:239], a[108:111]
ds_read_b64_tr_b16 a[236:237], v226 offset:40960
ds_read_b64_tr_b16 a[238:239], v226 offset:45056
v_mfma_f32_16x16x32_bf16 a[108:111], v[84:87], a[200:203], a[108:111]
v_exp_f32 v71, v71
v_mfma_f32_16x16x32_bf16 a[124:127], v[84:87], a[204:207], a[124:127]
v_cvt_pk_bf16_f32 v103, v70, v71
v_mfma_f32_16x16x32_bf16 a[124:127], v[116:119], a[240:243], a[124:127]
buffer_load_dwordx4 v233, s[12:15], s39 offen offset:3072  lds
v_mfma_f32_16x16x32_bf16 a[120:123], v[112:115], a[240:243], a[120:123]
ds_read_b64_tr_b16 a[240:241], v227 offset:40960
ds_read_b64_tr_b16 a[242:243], v227 offset:45056
v_mfma_f32_16x16x32_bf16 a[120:123], v[80:83], a[204:207], a[120:123]
buffer_load_dword v242, v241, s[20:23], s46 offen sc1
v_smfmac_f32_16x16x64_bf16 a[132:135], a[208:211], v[80:87], v245
v_add_u32 v241, 1024, v241
v_and_b32 v241, 0x3fff, v241
v_mfma_f32_16x16x32_bf16 v[40:43], a[144:147], v[152:155], v[136:139]
v_exp_f32 v8, v8
v_mfma_f32_16x16x32_bf16 v[40:43], a[148:151], v[156:159], v[40:43]
v_exp_f32 v9, v9
v_mfma_f32_16x16x32_bf16 v[40:43], a[152:155], v[160:163], v[40:43]
v_cvt_pk_bf16_f32 v104, v8, v9
v_mfma_f32_16x16x32_bf16 v[40:43], a[156:159], v[164:167], v[40:43]
v_exp_f32 v10, v10
v_mfma_f32_16x16x32_bf16 v[48:51], a[156:159], v[180:183], v[140:143]
v_mfma_f32_16x16x32_bf16 v[48:51], a[152:155], v[176:179], v[48:51]
v_exp_f32 v11, v11
v_mfma_f32_16x16x32_bf16 v[48:51], a[148:151], v[172:175], v[48:51]
v_cvt_pk_bf16_f32 v105, v10, v11
v_mfma_f32_16x16x32_bf16 v[48:51], a[144:147], v[168:171], v[48:51]
v_exp_f32 v12, v12
v_mfma_f32_16x16x32_bf16 v[56:59], a[144:147], v[184:187], v[144:147]
v_mfma_f32_16x16x32_bf16 v[56:59], a[148:151], v[188:191], v[56:59]
v_exp_f32 v13, v13
v_mfma_f32_16x16x32_bf16 v[56:59], a[152:155], v[192:195], v[56:59]
v_cvt_pk_bf16_f32 v106, v12, v13
v_mfma_f32_16x16x32_bf16 v[56:59], a[156:159], v[196:199], v[56:59]
v_exp_f32 v14, v14
v_mfma_f32_16x16x32_bf16 v[64:67], a[156:159], v[212:215], v[148:151]
s_waitcnt vmcnt(10) lgkmcnt(0)
s_barrier
v_mfma_f32_16x16x32_bf16 v[64:67], a[152:155], v[208:211], v[64:67]
v_exp_f32 v15, v15
v_mfma_f32_16x16x32_bf16 v[64:67], a[148:151], v[204:207], v[64:67]
ds_read_b128 a[156:159], v219 offset:0
v_cvt_pk_bf16_f32 v107, v14, v15
v_mfma_f32_16x16x32_bf16 v[64:67], a[144:147], v[200:203], v[64:67]
v_exp_f32 v16, v16
v_mfma_f32_16x16x32_bf16 a[0:3], v[88:91], a[212:215], a[0:3]
ds_read_b128 a[152:155], v218 offset:0
ds_read_b128 a[148:151], v217 offset:0
v_mfma_f32_16x16x32_bf16 a[0:3], v[72:75], a[176:179], a[0:3]
v_exp_f32 v17, v17
v_mfma_f32_16x16x32_bf16 a[4:7], v[76:79], a[176:179], a[4:7]
ds_read_b128 a[144:147], v216 offset:0
v_cvt_pk_bf16_f32 v108, v16, v17
v_mfma_f32_16x16x32_bf16 a[4:7], v[92:95], a[212:215], a[4:7]
v_exp_f32 v18, v18
v_mfma_f32_16x16x32_bf16 a[20:23], v[92:95], a[216:219], a[20:23]
ds_read_b64_tr_b16 a[176:177], v220 offset:49152
ds_read_b64_tr_b16 a[178:179], v220 offset:53248
v_mfma_f32_16x16x32_bf16 a[20:23], v[76:79], a[180:183], a[20:23]
v_exp_f32 v19, v19
v_mfma_f32_16x16x32_bf16 a[16:19], v[72:75], a[180:183], a[16:19]
ds_read_b64_tr_b16 a[180:181], v221 offset:49152
v_cvt_pk_bf16_f32 v109, v18, v19
v_mfma_f32_16x16x32_bf16 a[16:19], v[88:91], a[216:219], a[16:19]
v_exp_f32 v20, v20
v_mfma_f32_16x16x32_bf16 a[32:35], v[88:91], a[220:223], a[32:35]
ds_read_b64_tr_b16 a[182:183], v221 offset:53248
s_add_u32 s32, s32, 16384
v_mfma_f32_16x16x32_bf16 a[32:35], v[72:75], a[184:187], a[32:35]
v_exp_f32 v21, v21
v_mfma_f32_16x16x32_bf16 a[36:39], v[76:79], a[184:187], a[36:39]
ds_read_b64_tr_b16 a[184:185], v222 offset:49152
v_cvt_pk_bf16_f32 v110, v20, v21
v_mfma_f32_16x16x32_bf16 a[36:39], v[92:95], a[220:223], a[36:39]
v_exp_f32 v22, v22
v_mfma_f32_16x16x32_bf16 a[52:55], v[92:95], a[224:227], a[52:55]
ds_read_b64_tr_b16 a[186:187], v222 offset:53248
s_add_u32 m0, s30, 114688
v_mfma_f32_16x16x32_bf16 a[52:55], v[76:79], a[188:191], a[52:55]
v_exp_f32 v23, v23
v_mfma_f32_16x16x32_bf16 a[48:51], v[72:75], a[188:191], a[48:51]
ds_read_b64_tr_b16 a[188:189], v223 offset:49152
v_cvt_pk_bf16_f32 v111, v22, v23
v_mfma_f32_16x16x32_bf16 a[48:51], v[88:91], a[224:227], a[48:51]
v_exp_f32 v24, v24
v_smfmac_f32_16x16x64_bf16 a[128:131], a[208:211], v[88:95], v245
v_exp_f32 v25, v25
v_mfma_f32_16x16x32_bf16 v[44:47], a[160:163], v[152:155], v[136:139]
ds_read_b64_tr_b16 a[190:191], v223 offset:53248
v_cvt_pk_bf16_f32 v112, v24, v25
v_mfma_f32_16x16x32_bf16 v[44:47], a[164:167], v[156:159], v[44:47]
v_exp_f32 v26, v26
v_mfma_f32_16x16x32_bf16 v[44:47], a[168:171], v[160:163], v[44:47]
buffer_load_dwordx4 v228, s[8:11], s32 offen offset:0  lds
v_mfma_f32_16x16x32_bf16 v[44:47], a[172:175], v[164:167], v[44:47]
v_exp_f32 v27, v27
v_mfma_f32_16x16x32_bf16 v[52:55], a[172:175], v[180:183], v[140:143]
v_cvt_pk_bf16_f32 v113, v26, v27
v_mfma_f32_16x16x32_bf16 v[52:55], a[168:171], v[176:179], v[52:55]
v_exp_f32 v28, v28
v_mfma_f32_16x16x32_bf16 v[52:55], a[164:167], v[172:175], v[52:55]
buffer_load_dwordx4 v229, s[8:11], s32 offen offset:1024  lds
v_mfma_f32_16x16x32_bf16 v[52:55], a[160:163], v[168:171], v[52:55]
v_exp_f32 v29, v29
v_mfma_f32_16x16x32_bf16 v[60:63], a[160:163], v[184:187], v[144:147]
v_cvt_pk_bf16_f32 v114, v28, v29
v_mfma_f32_16x16x32_bf16 v[60:63], a[164:167], v[188:191], v[60:63]
v_exp_f32 v30, v30
v_mfma_f32_16x16x32_bf16 v[60:63], a[168:171], v[192:195], v[60:63]
buffer_load_dwordx4 v230, s[8:11], s32 offen offset:2048  lds
v_mfma_f32_16x16x32_bf16 v[60:63], a[172:175], v[196:199], v[60:63]
v_exp_f32 v31, v31
v_mfma_f32_16x16x32_bf16 v[68:71], a[172:175], v[212:215], v[148:151]
ds_read_b128 a[172:175], v219 offset:4096
v_cvt_pk_bf16_f32 v115, v30, v31
v_mfma_f32_16x16x32_bf16 v[68:71], a[168:171], v[208:211], v[68:71]
v_exp_f32 v32, v32
v_mfma_f32_16x16x32_bf16 v[68:71], a[164:167], v[204:207], v[68:71]
ds_read_b128 a[168:171], v218 offset:4096
ds_read_b128 a[164:167], v217 offset:4096
v_mfma_f32_16x16x32_bf16 v[68:71], a[160:163], v[200:203], v[68:71]
v_exp_f32 v33, v33
v_mfma_f32_16x16x32_bf16 a[64:67], v[88:91], a[228:231], a[64:67]
ds_read_b128 a[160:163], v216 offset:4096
v_cvt_pk_bf16_f32 v116, v32, v33
v_mfma_f32_16x16x32_bf16 a[64:67], v[72:75], a[192:195], a[64:67]
v_exp_f32 v34, v34
v_mfma_f32_16x16x32_bf16 a[68:71], v[76:79], a[192:195], a[68:71]
ds_read_b64_tr_b16 a[192:193], v224 offset:49152
ds_read_b64_tr_b16 a[194:195], v224 offset:53248
v_mfma_f32_16x16x32_bf16 a[68:71], v[92:95], a[228:231], a[68:71]
v_exp_f32 v35, v35
v_mfma_f32_16x16x32_bf16 a[84:87], v[92:95], a[232:235], a[84:87]
v_cvt_pk_bf16_f32 v117, v34, v35
v_mfma_f32_16x16x32_bf16 a[84:87], v[76:79], a[196:199], a[84:87]
v_exp_f32 v36, v36
v_mfma_f32_16x16x32_bf16 a[80:83], v[72:75], a[196:199], a[80:83]
ds_read_b64_tr_b16 a[196:197], v225 offset:49152
ds_read_b64_tr_b16 a[198:199], v225 offset:53248
v_mfma_f32_16x16x32_bf16 a[80:83], v[88:91], a[232:235], a[80:83]
v_exp_f32 v37, v37
v_mfma_f32_16x16x32_bf16 a[96:99], v[88:91], a[236:239], a[96:99]
v_cvt_pk_bf16_f32 v118, v36, v37
v_mfma_f32_16x16x32_bf16 a[96:99], v[72:75], a[200:203], a[96:99]
v_exp_f32 v38, v38
v_mfma_f32_16x16x32_bf16 a[100:103], v[76:79], a[200:203], a[100:103]
ds_read_b64_tr_b16 a[200:201], v226 offset:49152
ds_read_b64_tr_b16 a[202:203], v226 offset:53248
v_mfma_f32_16x16x32_bf16 a[100:103], v[92:95], a[236:239], a[100:103]
v_exp_f32 v39, v39
v_mfma_f32_16x16x32_bf16 a[116:119], v[92:95], a[240:243], a[116:119]
v_cvt_pk_bf16_f32 v119, v38, v39
v_mfma_f32_16x16x32_bf16 a[116:119], v[76:79], a[204:207], a[116:119]
buffer_load_dwordx4 v231, s[8:11], s32 offen offset:3072  lds
v_mfma_f32_16x16x32_bf16 a[112:115], v[72:75], a[204:207], a[112:115]
ds_read_b64_tr_b16 a[204:205], v227 offset:49152
ds_read_b64_tr_b16 a[206:207], v227 offset:53248
v_mfma_f32_16x16x32_bf16 a[112:115], v[88:91], a[240:243], a[112:115]
s_mov_b32 m0, s87
s_lshl2_add_u32 s50, s87, s89
buffer_load_dwordx4 v243, s[56:59], s50 offen  lds
v_smfmac_f32_16x16x64_bf16 a[132:135], a[208:211], v[96:103], v245
s_add_u32 s87, s87, 3456
s_min_u32 s87, s87, 63936
s_waitcnt lgkmcnt(8)
v_mfma_f32_16x16x32_bf16 v[8:11], a[144:147], v[152:155], v[136:139]
v_exp_f32 v40, v40
v_mfma_f32_16x16x32_bf16 v[8:11], a[148:151], v[156:159], v[8:11]
v_exp_f32 v41, v41
v_mfma_f32_16x16x32_bf16 v[8:11], a[152:155], v[160:163], v[8:11]
v_cvt_pk_bf16_f32 v72, v40, v41
v_mfma_f32_16x16x32_bf16 v[8:11], a[156:159], v[164:167], v[8:11]
v_exp_f32 v42, v42
v_mfma_f32_16x16x32_bf16 v[16:19], a[156:159], v[180:183], v[140:143]
s_add_u32 s39, s39, 16384
v_mfma_f32_16x16x32_bf16 v[16:19], a[152:155], v[176:179], v[16:19]
v_exp_f32 v43, v43
v_mfma_f32_16x16x32_bf16 v[16:19], a[148:151], v[172:175], v[16:19]
v_cvt_pk_bf16_f32 v73, v42, v43
v_mfma_f32_16x16x32_bf16 v[16:19], a[144:147], v[168:171], v[16:19]
v_exp_f32 v44, v44
v_mfma_f32_16x16x32_bf16 v[24:27], a[144:147], v[184:187], v[144:147]
v_mfma_f32_16x16x32_bf16 v[24:27], a[148:151], v[188:191], v[24:27]
v_exp_f32 v45, v45
v_mfma_f32_16x16x32_bf16 v[24:27], a[152:155], v[192:195], v[24:27]
s_add_u32 m0, s30, 131072
v_cvt_pk_bf16_f32 v74, v44, v45
v_mfma_f32_16x16x32_bf16 v[24:27], a[156:159], v[196:199], v[24:27]
v_exp_f32 v46, v46
v_mfma_f32_16x16x32_bf16 v[32:35], a[156:159], v[212:215], v[148:151]
ds_read_b128 a[156:159], v219 offset:8192
v_mfma_f32_16x16x32_bf16 v[32:35], a[152:155], v[208:211], v[32:35]
v_exp_f32 v47, v47
v_mfma_f32_16x16x32_bf16 v[32:35], a[148:151], v[204:207], v[32:35]
ds_read_b128 a[152:155], v218 offset:8192
v_cvt_pk_bf16_f32 v75, v46, v47
v_mfma_f32_16x16x32_bf16 v[32:35], a[144:147], v[200:203], v[32:35]
v_exp_f32 v48, v48
v_mfma_f32_16x16x32_bf16 a[8:11], v[112:115], a[176:179], a[8:11]
ds_read_b128 a[148:151], v217 offset:8192
ds_read_b128 a[144:147], v216 offset:8192
v_mfma_f32_16x16x32_bf16 a[8:11], v[96:99], a[212:215], a[8:11]
v_exp_f32 v49, v49
v_mfma_f32_16x16x32_bf16 a[12:15], v[100:103], a[212:215], a[12:15]
ds_read_b64_tr_b16 a[212:213], v220 offset:57344
v_cvt_pk_bf16_f32 v76, v48, v49
v_mfma_f32_16x16x32_bf16 a[12:15], v[116:119], a[176:179], a[12:15]
v_exp_f32 v50, v50
v_mfma_f32_16x16x32_bf16 a[28:31], v[116:119], a[180:183], a[28:31]
ds_read_b64_tr_b16 a[214:215], v220 offset:61440
v_mfma_f32_16x16x32_bf16 a[28:31], v[100:103], a[216:219], a[28:31]
v_exp_f32 v51, v51
v_mfma_f32_16x16x32_bf16 a[24:27], v[96:99], a[216:219], a[24:27]
ds_read_b64_tr_b16 a[216:217], v221 offset:57344
v_cvt_pk_bf16_f32 v77, v50, v51
v_mfma_f32_16x16x32_bf16 a[24:27], v[112:115], a[180:183], a[24:27]
v_exp_f32 v52, v52
v_mfma_f32_16x16x32_bf16 a[40:43], v[112:115], a[184:187], a[40:43]
ds_read_b64_tr_b16 a[218:219], v221 offset:61440
v_mfma_f32_16x16x32_bf16 a[40:43], v[96:99], a[220:223], a[40:43]
v_exp_f32 v53, v53
v_mfma_f32_16x16x32_bf16 a[44:47], v[100:103], a[220:223], a[44:47]
ds_read_b64_tr_b16 a[220:221], v222 offset:57344
v_cvt_pk_bf16_f32 v78, v52, v53
v_mfma_f32_16x16x32_bf16 a[44:47], v[116:119], a[184:187], a[44:47]
v_exp_f32 v54, v54
v_mfma_f32_16x16x32_bf16 a[60:63], v[116:119], a[188:191], a[60:63]
ds_read_b64_tr_b16 a[222:223], v222 offset:61440
v_mfma_f32_16x16x32_bf16 a[60:63], v[100:103], a[224:227], a[60:63]
v_exp_f32 v55, v55
v_mfma_f32_16x16x32_bf16 a[56:59], v[96:99], a[224:227], a[56:59]
ds_read_b64_tr_b16 a[224:225], v223 offset:57344
v_cvt_pk_bf16_f32 v79, v54, v55
v_mfma_f32_16x16x32_bf16 a[56:59], v[112:115], a[188:191], a[56:59]
v_exp_f32 v56, v56
v_smfmac_f32_16x16x64_bf16 a[128:131], a[208:211], v[104:111], v245
v_exp_f32 v57, v57
v_mfma_f32_16x16x32_bf16 v[12:15], a[160:163], v[152:155], v[136:139]
ds_read_b64_tr_b16 a[226:227], v223 offset:61440
v_cvt_pk_bf16_f32 v80, v56, v57
v_mfma_f32_16x16x32_bf16 v[12:15], a[164:167], v[156:159], v[12:15]
v_exp_f32 v58, v58
v_mfma_f32_16x16x32_bf16 v[12:15], a[168:171], v[160:163], v[12:15]
buffer_load_dwordx4 v232, s[12:15], s39 offen offset:0  lds
v_mfma_f32_16x16x32_bf16 v[12:15], a[172:175], v[164:167], v[12:15]
v_exp_f32 v59, v59
v_mfma_f32_16x16x32_bf16 v[20:23], a[172:175], v[180:183], v[140:143]
v_cvt_pk_bf16_f32 v81, v58, v59
v_mfma_f32_16x16x32_bf16 v[20:23], a[168:171], v[176:179], v[20:23]
v_exp_f32 v60, v60
v_mfma_f32_16x16x32_bf16 v[20:23], a[164:167], v[172:175], v[20:23]
buffer_load_dwordx4 v233, s[12:15], s39 offen offset:1024  lds
v_mfma_f32_16x16x32_bf16 v[20:23], a[160:163], v[168:171], v[20:23]
v_exp_f32 v61, v61
v_mfma_f32_16x16x32_bf16 v[28:31], a[160:163], v[184:187], v[144:147]
v_cvt_pk_bf16_f32 v82, v60, v61
v_mfma_f32_16x16x32_bf16 v[28:31], a[164:167], v[188:191], v[28:31]
v_exp_f32 v62, v62
v_mfma_f32_16x16x32_bf16 v[28:31], a[168:171], v[192:195], v[28:31]
buffer_load_dwordx4 v232, s[12:15], s39 offen offset:2048  lds
v_mfma_f32_16x16x32_bf16 v[28:31], a[172:175], v[196:199], v[28:31]
v_exp_f32 v63, v63
v_mfma_f32_16x16x32_bf16 v[36:39], a[172:175], v[212:215], v[148:151]
ds_read_b128 a[172:175], v219 offset:12288
v_cvt_pk_bf16_f32 v83, v62, v63
v_mfma_f32_16x16x32_bf16 v[36:39], a[168:171], v[208:211], v[36:39]
v_exp_f32 v64, v64
v_mfma_f32_16x16x32_bf16 v[36:39], a[164:167], v[204:207], v[36:39]
ds_read_b128 a[168:171], v218 offset:12288
ds_read_b128 a[164:167], v217 offset:12288
v_mfma_f32_16x16x32_bf16 v[36:39], a[160:163], v[200:203], v[36:39]
v_exp_f32 v65, v65
s_waitcnt lgkmcnt(8)
v_mfma_f32_16x16x32_bf16 a[72:75], v[112:115], a[192:195], a[72:75]
ds_read_b128 a[160:163], v216 offset:12288
v_cvt_pk_bf16_f32 v84, v64, v65
v_mfma_f32_16x16x32_bf16 a[72:75], v[96:99], a[228:231], a[72:75]
v_exp_f32 v66, v66
v_mfma_f32_16x16x32_bf16 a[76:79], v[100:103], a[228:231], a[76:79]
ds_read_b64_tr_b16 a[228:229], v224 offset:57344
ds_read_b64_tr_b16 a[230:231], v224 offset:61440
v_mfma_f32_16x16x32_bf16 a[76:79], v[116:119], a[192:195], a[76:79]
v_exp_f32 v67, v67
v_mfma_f32_16x16x32_bf16 a[92:95], v[116:119], a[196:199], a[92:95]
v_cvt_pk_bf16_f32 v85, v66, v67
v_mfma_f32_16x16x32_bf16 a[92:95], v[100:103], a[232:235], a[92:95]
v_exp_f32 v68, v68
v_mfma_f32_16x16x32_bf16 a[88:91], v[96:99], a[232:235], a[88:91]
ds_read_b64_tr_b16 a[232:233], v225 offset:57344
ds_read_b64_tr_b16 a[234:235], v225 offset:61440
v_mfma_f32_16x16x32_bf16 a[88:91], v[112:115], a[196:199], a[88:91]
v_exp_f32 v69, v69
v_mfma_f32_16x16x32_bf16 a[104:107], v[112:115], a[200:203], a[104:107]
v_cvt_pk_bf16_f32 v86, v68, v69
v_mfma_f32_16x16x32_bf16 a[104:107], v[96:99], a[236:239], a[104:107]
v_exp_f32 v70, v70
v_mfma_f32_16x16x32_bf16 a[108:111], v[100:103], a[236:239], a[108:111]
ds_read_b64_tr_b16 a[236:237], v226 offset:57344
ds_read_b64_tr_b16 a[238:239], v226 offset:61440
v_mfma_f32_16x16x32_bf16 a[108:111], v[116:119], a[200:203], a[108:111]
v_exp_f32 v71, v71
v_mfma_f32_16x16x32_bf16 a[124:127], v[116:119], a[204:207], a[124:127]
v_cvt_pk_bf16_f32 v87, v70, v71
v_mfma_f32_16x16x32_bf16 a[124:127], v[100:103], a[240:243], a[124:127]
buffer_load_dwordx4 v233, s[12:15], s39 offen offset:3072  lds
v_mfma_f32_16x16x32_bf16 a[120:123], v[96:99], a[240:243], a[120:123]
ds_read_b64_tr_b16 a[240:241], v227 offset:57344
ds_read_b64_tr_b16 a[242:243], v227 offset:61440
v_mfma_f32_16x16x32_bf16 a[120:123], v[112:115], a[204:207], a[120:123]
buffer_load_dword v242, v241, s[20:23], s46 offen sc1
v_smfmac_f32_16x16x64_bf16 a[132:135], a[208:211], v[112:119], v245
v_add_u32 v241, 1024, v241
v_and_b32 v241, 0x3fff, v241
s_sub_u32 s33, s33, 1
s_cmp_lg_u32 s33, 0
s_cbranch_scc1 K_LOOP
K_LAST:
v_mfma_f32_16x16x32_bf16 v[40:43], a[144:147], v[152:155], v[136:139]
v_and_b32 v122, 7, v1
v_exp_f32 v8, v8
v_mfma_f32_16x16x32_bf16 v[40:43], a[148:151], v[156:159], v[40:43]
v_lshlrev_b32 v122, 3, v122
v_exp_f32 v9, v9
v_mfma_f32_16x16x32_bf16 v[40:43], a[152:155], v[160:163], v[40:43]
v_cvt_pk_bf16_f32 v88, v8, v9
v_mfma_f32_16x16x32_bf16 v[40:43], a[156:159], v[164:167], v[40:43]
v_exp_f32 v10, v10
v_mfma_f32_16x16x32_bf16 v[48:51], a[156:159], v[180:183], v[140:143]
v_mfma_f32_16x16x32_bf16 v[48:51], a[152:155], v[176:179], v[48:51]
v_exp_f32 v11, v11
v_mfma_f32_16x16x32_bf16 v[48:51], a[148:151], v[172:175], v[48:51]
v_cvt_pk_bf16_f32 v89, v10, v11
v_mfma_f32_16x16x32_bf16 v[48:51], a[144:147], v[168:171], v[48:51]
v_exp_f32 v12, v12
v_mfma_f32_16x16x32_bf16 v[56:59], a[144:147], v[184:187], v[144:147]
v_mfma_f32_16x16x32_bf16 v[56:59], a[148:151], v[188:191], v[56:59]
v_exp_f32 v13, v13
v_mfma_f32_16x16x32_bf16 v[56:59], a[152:155], v[192:195], v[56:59]
v_cvt_pk_bf16_f32 v90, v12, v13
v_mfma_f32_16x16x32_bf16 v[56:59], a[156:159], v[196:199], v[56:59]
v_exp_f32 v14, v14
v_mfma_f32_16x16x32_bf16 v[64:67], a[156:159], v[212:215], v[148:151]
s_waitcnt vmcnt(10) lgkmcnt(0)
s_barrier
v_mfma_f32_16x16x32_bf16 v[64:67], a[152:155], v[208:211], v[64:67]
v_exp_f32 v15, v15
v_mfma_f32_16x16x32_bf16 v[64:67], a[148:151], v[204:207], v[64:67]
ds_read_b128 a[156:159], v219 offset:16384
v_cvt_pk_bf16_f32 v91, v14, v15
STUB_11:
s_cbranch_execz HOP_RET1
v_mfma_f32_16x16x32_bf16 v[64:67], a[144:147], v[200:203], v[64:67]
v_exp_f32 v16, v16
v_mfma_f32_16x16x32_bf16 a[0:3], v[72:75], a[212:215], a[0:3]
ds_read_b128 a[152:155], v218 offset:16384
ds_read_b128 a[148:151], v217 offset:16384
v_mfma_f32_16x16x32_bf16 a[0:3], v[104:107], a[176:179], a[0:3]
v_exp_f32 v17, v17
v_mfma_f32_16x16x32_bf16 a[4:7], v[108:111], a[176:179], a[4:7]
ds_read_b128 a[144:147], v216 offset:16384
v_cvt_pk_bf16_f32 v92, v16, v17
v_mfma_f32_16x16x32_bf16 a[4:7], v[76:79], a[212:215], a[4:7]
v_exp_f32 v18, v18
v_mfma_f32_16x16x32_bf16 a[20:23], v[76:79], a[216:219], a[20:23]
ds_read_b64_tr_b16 a[176:177], v220 offset:0
ds_read_b64_tr_b16 a[178:179], v220 offset:4096
v_mfma_f32_16x16x32_bf16 a[20:23], v[108:111], a[180:183], a[20:23]
v_exp_f32 v19, v19
v_mfma_f32_16x16x32_bf16 a[16:19], v[104:107], a[180:183], a[16:19]
ds_read_b64_tr_b16 a[180:181], v221 offset:0
v_cvt_pk_bf16_f32 v93, v18, v19
v_mfma_f32_16x16x32_bf16 a[16:19], v[72:75], a[216:219], a[16:19]
v_exp_f32 v20, v20
v_mfma_f32_16x16x32_bf16 a[32:35], v[72:75], a[220:223], a[32:35]
ds_read_b64_tr_b16 a[182:183], v221 offset:4096
v_mfma_f32_16x16x32_bf16 a[32:35], v[104:107], a[184:187], a[32:35]
v_exp_f32 v21, v21
v_mfma_f32_16x16x32_bf16 a[36:39], v[108:111], a[184:187], a[36:39]
ds_read_b64_tr_b16 a[184:185], v222 offset:0
v_cvt_pk_bf16_f32 v94, v20, v21
v_mfma_f32_16x16x32_bf16 a[36:39], v[76:79], a[220:223], a[36:39]
v_exp_f32 v22, v22
v_mfma_f32_16x16x32_bf16 a[52:55], v[76:79], a[224:227], a[52:55]
ds_read_b64_tr_b16 a[186:187], v222 offset:4096
v_mfma_f32_16x16x32_bf16 a[52:55], v[108:111], a[188:191], a[52:55]
v_exp_f32 v23, v23
v_mfma_f32_16x16x32_bf16 a[48:51], v[104:107], a[188:191], a[48:51]
ds_read_b64_tr_b16 a[188:189], v223 offset:0
v_cvt_pk_bf16_f32 v95, v22, v23
v_mfma_f32_16x16x32_bf16 a[48:51], v[72:75], a[224:227], a[48:51]
v_exp_f32 v24, v24
v_smfmac_f32_16x16x64_bf16 a[128:131], a[208:211], v[72:79], v245
v_exp_f32 v25, v25
v_mfma_f32_16x16x32_bf16 v[44:47], a[160:163], v[152:155], v[136:139]
ds_read_b64_tr_b16 a[190:191], v223 offset:4096
v_cvt_pk_bf16_f32 v96, v24, v25
v_mfma_f32_16x16x32_bf16 v[44:47], a[164:167], v[156:159], v[44:47]
v_exp_f32 v26, v26
v_mfma_f32_16x16x32_bf16 v[44:47], a[168:171], v[160:163], v[44:47]
s_add_u32 m0, s88, 62208
s_lshl2_add_u32 s50, m0, s89
buffer_load_dwordx4 v243, s[56:59], s50 offen  lds
v_mfma_f32_16x16x32_bf16 v[44:47], a[172:175], v[164:167], v[44:47]
v_exp_f32 v27, v27
v_mfma_f32_16x16x32_bf16 v[52:55], a[172:175], v[180:183], v[140:143]
v_cvt_pk_bf16_f32 v97, v26, v27
v_mfma_f32_16x16x32_bf16 v[52:55], a[168:171], v[176:179], v[52:55]
v_exp_f32 v28, v28
v_mfma_f32_16x16x32_bf16 v[52:55], a[164:167], v[172:175], v[52:55]
s_add_u32 m0, s88, 65664
s_lshl2_add_u32 s50, m0, s89
buffer_load_dwordx4 v243, s[56:59], s50 offen  lds
v_mfma_f32_16x16x32_bf16 v[52:55], a[160:163], v[168:171], v[52:55]
v_exp_f32 v29, v29
v_mfma_f32_16x16x32_bf16 v[60:63], a[160:163], v[184:187], v[144:147]
v_cvt_pk_bf16_f32 v98, v28, v29
v_mfma_f32_16x16x32_bf16 v[60:63], a[164:167], v[188:191], v[60:63]
v_exp_f32 v30, v30
v_mfma_f32_16x16x32_bf16 v[60:63], a[168:171], v[192:195], v[60:63]
s_mov_b32 s93, 0x242800
buffer_load_dwordx2 v[120:121], v122, s[20:23], s93 offen sc0 sc1
v_mfma_f32_16x16x32_bf16 v[60:63], a[172:175], v[196:199], v[60:63]
v_and_b32 v246, 15, v1
v_exp_f32 v31, v31
v_mfma_f32_16x16x32_bf16 v[68:71], a[172:175], v[212:215], v[148:151]
ds_read_b128 a[172:175], v219 offset:20480
v_cvt_pk_bf16_f32 v99, v30, v31
v_lshrrev_b32 v247, 3, v246
v_mfma_f32_16x16x32_bf16 v[68:71], a[168:171], v[208:211], v[68:71]
v_and_b32 v246, 7, v246
v_exp_f32 v32, v32
v_mfma_f32_16x16x32_bf16 v[68:71], a[164:167], v[204:207], v[68:71]
ds_read_b128 a[168:171], v218 offset:20480
ds_read_b128 a[164:167], v217 offset:20480
v_lshlrev_b32 v246, 6, v246
v_mfma_f32_16x16x32_bf16 v[68:71], a[160:163], v[200:203], v[68:71]
v_lshl_add_u32 v246, v247, 13, v246
v_exp_f32 v33, v33
v_mfma_f32_16x16x32_bf16 a[64:67], v[72:75], a[228:231], a[64:67]
ds_read_b128 a[160:163], v216 offset:20480
v_cvt_pk_bf16_f32 v100, v32, v33
v_mfma_f32_16x16x32_bf16 a[64:67], v[104:107], a[192:195], a[64:67]
v_exp_f32 v34, v34
v_mfma_f32_16x16x32_bf16 a[68:71], v[108:111], a[192:195], a[68:71]
ds_read_b64_tr_b16 a[192:193], v224 offset:0
ds_read_b64_tr_b16 a[194:195], v224 offset:4096
v_mfma_f32_16x16x32_bf16 a[68:71], v[76:79], a[228:231], a[68:71]
v_exp_f32 v35, v35
v_mfma_f32_16x16x32_bf16 a[84:87], v[76:79], a[232:235], a[84:87]
s_lshl_b32 s28, s36, 9
s_add_u32 s28, s28, 0x248000
v_cvt_pk_bf16_f32 v101, v34, v35
v_mfma_f32_16x16x32_bf16 a[84:87], v[108:111], a[196:199], a[84:87]
v_exp_f32 v36, v36
v_mfma_f32_16x16x32_bf16 a[80:83], v[104:107], a[196:199], a[80:83]
ds_read_b64_tr_b16 a[196:197], v225 offset:0
ds_read_b64_tr_b16 a[198:199], v225 offset:4096
v_mfma_f32_16x16x32_bf16 a[80:83], v[72:75], a[232:235], a[80:83]
v_exp_f32 v37, v37
v_mfma_f32_16x16x32_bf16 a[96:99], v[72:75], a[236:239], a[96:99]
buffer_load_dword v242, v246, s[20:23], s28 offen sc1
v_cvt_pk_bf16_f32 v102, v36, v37
v_mfma_f32_16x16x32_bf16 a[96:99], v[104:107], a[200:203], a[96:99]
v_bfe_u32 v246, v1, 2, 2
v_exp_f32 v38, v38
v_mfma_f32_16x16x32_bf16 a[100:103], v[108:111], a[200:203], a[100:103]
ds_read_b64_tr_b16 a[200:201], v226 offset:0
ds_read_b64_tr_b16 a[202:203], v226 offset:4096
v_lshl_add_u32 v246, v4, 2, v246
v_mfma_f32_16x16x32_bf16 a[100:103], v[76:79], a[236:239], a[100:103]
v_mul_u32_u24 v246, 288, v246
v_exp_f32 v39, v39
v_mfma_f32_16x16x32_bf16 a[116:119], v[76:79], a[240:243], a[116:119]
v_cvt_pk_bf16_f32 v103, v38, v39
v_and_b32 v247, 3, v1
v_lshl_add_u32 v236, v247, 3, v246
v_mfma_f32_16x16x32_bf16 a[116:119], v[108:111], a[204:207], a[116:119]
s_add_u32 m0, s88, 69120
s_lshl2_add_u32 s50, m0, s89
buffer_load_dwordx4 v243, s[56:59], s50 offen  lds
v_mfma_f32_16x16x32_bf16 a[112:115], v[104:107], a[204:207], a[112:115]
ds_read_b64_tr_b16 a[204:205], v227 offset:0
ds_read_b64_tr_b16 a[206:207], v227 offset:4096
v_add_u32 v236, 256, v236
v_mfma_f32_16x16x32_bf16 a[112:115], v[72:75], a[240:243], a[112:115]
v_lshl_add_u32 v246, v247, 4, v246
v_smfmac_f32_16x16x64_bf16 a[132:135], a[208:211], v[80:87], v245
s_lshr_b32 s28, s35, 4
s_lshl_b32 s28, s28, 6
s_waitcnt lgkmcnt(8)
v_mfma_f32_16x16x32_bf16 v[8:11], a[144:147], v[152:155], v[136:139]
v_add_u32 v234, s28, v246
v_exp_f32 v40, v40
v_mfma_f32_16x16x32_bf16 v[8:11], a[148:151], v[156:159], v[8:11]
s_xor_b32 s28, s28, 64
v_exp_f32 v41, v41
v_mfma_f32_16x16x32_bf16 v[8:11], a[152:155], v[160:163], v[8:11]
v_cvt_pk_bf16_f32 v104, v40, v41
v_add_u32 v235, s28, v246
v_mfma_f32_16x16x32_bf16 v[8:11], a[156:159], v[164:167], v[8:11]
v_exp_f32 v42, v42
v_mfma_f32_16x16x32_bf16 v[16:19], a[156:159], v[180:183], v[140:143]
s_add_u32 s39, s39, 16384
s_add_u32 s28, s35, 0
s_and_b32 s28, s28, 3
v_mfma_f32_16x16x32_bf16 v[16:19], a[152:155], v[176:179], v[16:19]
s_mul_i32 s28, s28, 36864
v_exp_f32 v43, v43
v_mfma_f32_16x16x32_bf16 v[16:19], a[148:151], v[172:175], v[16:19]
v_cvt_pk_bf16_f32 v105, v42, v43
v_add_u32 v237, s28, v234
v_add_u32 v238, s28, v235
v_mfma_f32_16x16x32_bf16 v[16:19], a[144:147], v[168:171], v[16:19]
v_add_u32 v239, s28, v236
v_exp_f32 v44, v44
v_mfma_f32_16x16x32_bf16 v[24:27], a[144:147], v[184:187], v[144:147]
v_mov_b32 v254, 0x7ffffff0
v_mfma_f32_16x16x32_bf16 v[24:27], a[148:151], v[188:191], v[24:27]
s_lshl2_add_u32 s92, s36, s37
v_exp_f32 v45, v45
v_mfma_f32_16x16x32_bf16 v[24:27], a[152:155], v[192:195], v[24:27]
s_add_u32 m0, s30, 147456
s_bfe_u32 s93, s35, 0x20002
v_cvt_pk_bf16_f32 v106, v44, v45
v_mfma_f32_16x16x32_bf16 v[24:27], a[156:159], v[196:199], v[24:27]
s_lshl2_add_u32 s92, s92, s93
v_exp_f32 v46, v46
v_mfma_f32_16x16x32_bf16 v[32:35], a[156:159], v[212:215], v[148:151]
ds_read_b128 a[156:159], v219 offset:24576
s_lshl_b32 s93, s92, 4
v_mfma_f32_16x16x32_bf16 v[32:35], a[152:155], v[208:211], v[32:35]
v_add_u32 v132, s93, v3
v_exp_f32 v47, v47
v_mfma_f32_16x16x32_bf16 v[32:35], a[148:151], v[204:207], v[32:35]
ds_read_b128 a[152:155], v218 offset:24576
v_cvt_pk_bf16_f32 v107, v46, v47
v_writelane_b32 v254, 0, 0
v_mfma_f32_16x16x32_bf16 v[32:35], a[144:147], v[200:203], v[32:35]
s_and_b32 s93, s35, 3
v_exp_f32 v48, v48
v_mfma_f32_16x16x32_bf16 a[8:11], v[96:99], a[176:179], a[8:11]
ds_read_b128 a[148:151], v217 offset:24576
ds_read_b128 a[144:147], v216 offset:24576
s_mul_i32 s93, s93, 144
v_mfma_f32_16x16x32_bf16 a[8:11], v[80:83], a[212:215], a[8:11]
v_lshlrev_b32 v251, 2, v4
v_exp_f32 v49, v49
v_mfma_f32_16x16x32_bf16 a[12:15], v[84:87], a[212:215], a[12:15]
ds_read_b64_tr_b16 a[212:213], v220 offset:8192
v_cvt_pk_bf16_f32 v108, v48, v49
v_add_u32 v251, s93, v251
v_mfma_f32_16x16x32_bf16 a[12:15], v[100:103], a[176:179], a[12:15]
v_add_u32 v251, 128, v251
v_exp_f32 v50, v50
v_mfma_f32_16x16x32_bf16 a[28:31], v[100:103], a[180:183], a[28:31]
ds_read_b64_tr_b16 a[214:215], v220 offset:12288
v_lshlrev_b32 v250, 3, v4
v_mfma_f32_16x16x32_bf16 a[28:31], v[84:87], a[216:219], a[28:31]
s_lshr_b32 s90, s35, 4
v_exp_f32 v51, v51
v_mfma_f32_16x16x32_bf16 a[24:27], v[80:83], a[216:219], a[24:27]
ds_read_b64_tr_b16 a[216:217], v221 offset:8192
s_lshl_b32 s90, s90, 5
v_cvt_pk_bf16_f32 v109, v50, v51
v_mfma_f32_16x16x32_bf16 a[24:27], v[96:99], a[180:183], a[24:27]
s_add_u32 s93, s93, s90
v_exp_f32 v52, v52
v_mfma_f32_16x16x32_bf16 a[40:43], v[96:99], a[184:187], a[40:43]
ds_read_b64_tr_b16 a[218:219], v221 offset:12288
v_add_u32 v250, s93, v250
v_lshlrev_b32 v250, 1, v250
v_mfma_f32_16x16x32_bf16 a[40:43], v[80:83], a[220:223], a[40:43]
v_lshlrev_b32 v251, 1, v251
v_exp_f32 v53, v53
v_mfma_f32_16x16x32_bf16 a[44:47], v[84:87], a[220:223], a[44:47]
ds_read_b64_tr_b16 a[220:221], v222 offset:8192
v_cvt_pk_bf16_f32 v110, v52, v53
v_mul_u32_u24 v133, 0x480, v132
v_mfma_f32_16x16x32_bf16 a[44:47], v[100:103], a[184:187], a[44:47]
v_add_u32 v248, v133, v250
v_exp_f32 v54, v54
v_mfma_f32_16x16x32_bf16 a[60:63], v[100:103], a[188:191], a[60:63]
ds_read_b64_tr_b16 a[222:223], v222 offset:12288
v_add_u32 v249, v133, v251
v_mov_b32 v135, 0x7fffbff0
v_mfma_f32_16x16x32_bf16 a[60:63], v[84:87], a[224:227], a[60:63]
v_exp_f32 v55, v55
v_mfma_f32_16x16x32_bf16 a[56:59], v[80:83], a[224:227], a[56:59]
ds_read_b64_tr_b16 a[224:225], v223 offset:8192
v_cvt_pk_bf16_f32 v111, v54, v55
v_mfma_f32_16x16x32_bf16 a[56:59], v[96:99], a[188:191], a[56:59]
v_exp_f32 v56, v56
v_smfmac_f32_16x16x64_bf16 a[128:131], a[208:211], v[88:95], v245
v_exp_f32 v57, v57
v_mfma_f32_16x16x32_bf16 v[12:15], a[160:163], v[152:155], v[136:139]
ds_read_b64_tr_b16 a[226:227], v223 offset:12288
v_cvt_pk_bf16_f32 v112, v56, v57
v_mfma_f32_16x16x32_bf16 v[12:15], a[164:167], v[156:159], v[12:15]
v_exp_f32 v58, v58
v_mfma_f32_16x16x32_bf16 v[12:15], a[168:171], v[160:163], v[12:15]
buffer_load_dwordx4 v232, s[12:15], s39 offen offset:0  lds
v_mfma_f32_16x16x32_bf16 v[12:15], a[172:175], v[164:167], v[12:15]
v_exp_f32 v59, v59
v_mfma_f32_16x16x32_bf16 v[20:23], a[172:175], v[180:183], v[140:143]
v_cvt_pk_bf16_f32 v113, v58, v59
v_mfma_f32_16x16x32_bf16 v[20:23], a[168:171], v[176:179], v[20:23]
v_exp_f32 v60, v60
v_mfma_f32_16x16x32_bf16 v[20:23], a[164:167], v[172:175], v[20:23]
buffer_load_dwordx4 v233, s[12:15], s39 offen offset:1024  lds
v_mfma_f32_16x16x32_bf16 v[20:23], a[160:163], v[168:171], v[20:23]
v_exp_f32 v61, v61
v_mfma_f32_16x16x32_bf16 v[28:31], a[160:163], v[184:187], v[144:147]
buffer_load_dwordx4 a[244:247], v248, s[52:55], 0 offen offset:0
v_cvt_pk_bf16_f32 v114, v60, v61
v_mfma_f32_16x16x32_bf16 v[28:31], a[164:167], v[188:191], v[28:31]
v_exp_f32 v62, v62
v_mfma_f32_16x16x32_bf16 v[28:31], a[168:171], v[192:195], v[28:31]
buffer_load_dwordx4 v232, s[12:15], s39 offen offset:2048  lds
v_mfma_f32_16x16x32_bf16 v[28:31], a[172:175], v[196:199], v[28:31]
v_exp_f32 v63, v63
v_mfma_f32_16x16x32_bf16 v[36:39], a[172:175], v[212:215], v[148:151]
ds_read_b128 a[172:175], v219 offset:28672
v_cvt_pk_bf16_f32 v115, v62, v63
v_mfma_f32_16x16x32_bf16 v[36:39], a[168:171], v[208:211], v[36:39]
v_exp_f32 v64, v64
v_mfma_f32_16x16x32_bf16 v[36:39], a[164:167], v[204:207], v[36:39]
ds_read_b128 a[168:171], v218 offset:28672
ds_read_b128 a[164:167], v217 offset:28672
v_mfma_f32_16x16x32_bf16 v[36:39], a[160:163], v[200:203], v[36:39]
v_exp_f32 v65, v65
s_waitcnt lgkmcnt(8)
v_mfma_f32_16x16x32_bf16 a[72:75], v[96:99], a[192:195], a[72:75]
ds_read_b128 a[160:163], v216 offset:28672
v_cvt_pk_bf16_f32 v116, v64, v65
v_mfma_f32_16x16x32_bf16 a[72:75], v[80:83], a[228:231], a[72:75]
v_exp_f32 v66, v66
v_mfma_f32_16x16x32_bf16 a[76:79], v[84:87], a[228:231], a[76:79]
ds_read_b64_tr_b16 a[228:229], v224 offset:8192
ds_read_b64_tr_b16 a[230:231], v224 offset:12288
v_mfma_f32_16x16x32_bf16 a[76:79], v[100:103], a[192:195], a[76:79]
v_exp_f32 v67, v67
v_mfma_f32_16x16x32_bf16 a[92:95], v[100:103], a[196:199], a[92:95]
buffer_load_dwordx4 a[248:251], v248, s[52:55], 0 offen offset:128
v_cvt_pk_bf16_f32 v117, v66, v67
v_mfma_f32_16x16x32_bf16 a[92:95], v[84:87], a[232:235], a[92:95]
v_exp_f32 v68, v68
v_mfma_f32_16x16x32_bf16 a[88:91], v[80:83], a[232:235], a[88:91]
ds_read_b64_tr_b16 a[232:233], v225 offset:8192
ds_read_b64_tr_b16 a[234:235], v225 offset:12288
v_mfma_f32_16x16x32_bf16 a[88:91], v[96:99], a[196:199], a[88:91]
v_exp_f32 v69, v69
v_mfma_f32_16x16x32_bf16 a[104:107], v[96:99], a[200:203], a[104:107]
v_cvt_pk_bf16_f32 v118, v68, v69
v_mfma_f32_16x16x32_bf16 a[104:107], v[80:83], a[236:239], a[104:107]
v_exp_f32 v70, v70
v_mfma_f32_16x16x32_bf16 a[108:111], v[84:87], a[236:239], a[108:111]
ds_read_b64_tr_b16 a[236:237], v226 offset:8192
ds_read_b64_tr_b16 a[238:239], v226 offset:12288
v_mfma_f32_16x16x32_bf16 a[108:111], v[100:103], a[200:203], a[108:111]
v_exp_f32 v71, v71
v_mfma_f32_16x16x32_bf16 a[124:127], v[100:103], a[204:207], a[124:127]
v_cvt_pk_bf16_f32 v119, v70, v71
v_mfma_f32_16x16x32_bf16 a[124:127], v[84:87], a[240:243], a[124:127]
buffer_load_dwordx4 v233, s[12:15], s39 offen offset:3072  lds
v_mfma_f32_16x16x32_bf16 a[120:123], v[80:83], a[240:243], a[120:123]
ds_read_b64_tr_b16 a[240:241], v227 offset:8192
ds_read_b64_tr_b16 a[242:243], v227 offset:12288
v_mfma_f32_16x16x32_bf16 a[120:123], v[96:99], a[204:207], a[120:123]
s_add_u32 m0, s88, 72576
s_lshl2_add_u32 s50, m0, s89
buffer_load_dwordx4 v243, s[56:59], s50 offen  lds
v_smfmac_f32_16x16x64_bf16 a[132:135], a[208:211], v[96:103], v245
s_add_u32 m0, s88, 76032
s_lshl2_add_u32 s50, m0, s89
buffer_load_dwordx4 v243, s[56:59], s50 offen  lds
v_mfma_f32_16x16x32_bf16 v[40:43], a[144:147], v[152:155], v[136:139]
v_exp_f32 v8, v8
v_mfma_f32_16x16x32_bf16 v[40:43], a[148:151], v[156:159], v[40:43]
v_exp_f32 v9, v9
v_mfma_f32_16x16x32_bf16 v[40:43], a[152:155], v[160:163], v[40:43]
v_cvt_pk_bf16_f32 v72, v8, v9
v_mfma_f32_16x16x32_bf16 v[40:43], a[156:159], v[164:167], v[40:43]
v_exp_f32 v10, v10
v_mfma_f32_16x16x32_bf16 v[48:51], a[156:159], v[180:183], v[140:143]
v_mfma_f32_16x16x32_bf16 v[48:51], a[152:155], v[176:179], v[48:51]
v_exp_f32 v11, v11
v_mfma_f32_16x16x32_bf16 v[48:51], a[148:151], v[172:175], v[48:51]
v_cvt_pk_bf16_f32 v73, v10, v11
v_mfma_f32_16x16x32_bf16 v[48:51], a[144:147], v[168:171], v[48:51]
v_exp_f32 v12, v12
v_mfma_f32_16x16x32_bf16 v[56:59], a[144:147], v[184:187], v[144:147]
v_mfma_f32_16x16x32_bf16 v[56:59], a[148:151], v[188:191], v[56:59]
v_exp_f32 v13, v13
v_mfma_f32_16x16x32_bf16 v[56:59], a[152:155], v[192:195], v[56:59]
v_cvt_pk_bf16_f32 v74, v12, v13
v_mfma_f32_16x16x32_bf16 v[56:59], a[156:159], v[196:199], v[56:59]
v_exp_f32 v14, v14
v_mfma_f32_16x16x32_bf16 v[64:67], a[156:159], v[212:215], v[148:151]
s_waitcnt vmcnt(13) lgkmcnt(0)
s_barrier
v_mfma_f32_16x16x32_bf16 v[64:67], a[152:155], v[208:211], v[64:67]
v_exp_f32 v15, v15
v_mfma_f32_16x16x32_bf16 v[64:67], a[148:151], v[204:207], v[64:67]
ds_read_b128 a[156:159], v219 offset:49152
v_cvt_pk_bf16_f32 v75, v14, v15
v_mfma_f32_16x16x32_bf16 v[64:67], a[144:147], v[200:203], v[64:67]
v_exp_f32 v16, v16
v_mfma_f32_16x16x32_bf16 a[0:3], v[104:107], a[212:215], a[0:3]
ds_read_b128 a[152:155], v218 offset:49152
ds_read_b128 a[148:151], v217 offset:49152
v_mfma_f32_16x16x32_bf16 a[0:3], v[88:91], a[176:179], a[0:3]
v_exp_f32 v17, v17
v_mfma_f32_16x16x32_bf16 a[4:7], v[92:95], a[176:179], a[4:7]
ds_read_b128 a[144:147], v216 offset:49152
v_cvt_pk_bf16_f32 v76, v16, v17
v_mfma_f32_16x16x32_bf16 a[4:7], v[108:111], a[212:215], a[4:7]
v_exp_f32 v18, v18
v_mfma_f32_16x16x32_bf16 a[20:23], v[108:111], a[216:219], a[20:23]
ds_read_b64_tr_b16 a[176:177], v220 offset:32768
ds_read_b64_tr_b16 a[178:179], v220 offset:36864
v_mfma_f32_16x16x32_bf16 a[20:23], v[92:95], a[180:183], a[20:23]
v_exp_f32 v19, v19
v_mfma_f32_16x16x32_bf16 a[16:19], v[88:91], a[180:183], a[16:19]
ds_read_b64_tr_b16 a[180:181], v221 offset:32768
v_cvt_pk_bf16_f32 v77, v18, v19
v_mfma_f32_16x16x32_bf16 a[16:19], v[104:107], a[216:219], a[16:19]
v_exp_f32 v20, v20
v_mfma_f32_16x16x32_bf16 a[32:35], v[104:107], a[220:223], a[32:35]
ds_read_b64_tr_b16 a[182:183], v221 offset:36864
buffer_load_dwordx2 a[252:253], v249, s[52:55], 0 offen
v_mfma_f32_16x16x32_bf16 a[32:35], v[88:91], a[184:187], a[32:35]
v_exp_f32 v21, v21
v_mfma_f32_16x16x32_bf16 a[36:39], v[92:95], a[184:187], a[36:39]
ds_read_b64_tr_b16 a[184:185], v222 offset:32768
v_cvt_pk_bf16_f32 v78, v20, v21
v_mfma_f32_16x16x32_bf16 a[36:39], v[108:111], a[220:223], a[36:39]
v_exp_f32 v22, v22
v_mfma_f32_16x16x32_bf16 a[52:55], v[108:111], a[224:227], a[52:55]
ds_read_b64_tr_b16 a[186:187], v222 offset:36864
v_mfma_f32_16x16x32_bf16 a[52:55], v[92:95], a[188:191], a[52:55]
v_exp_f32 v23, v23
v_mfma_f32_16x16x32_bf16 a[48:51], v[88:91], a[188:191], a[48:51]
ds_read_b64_tr_b16 a[188:189], v223 offset:32768
v_cvt_pk_bf16_f32 v79, v22, v23
v_mfma_f32_16x16x32_bf16 a[48:51], v[104:107], a[224:227], a[48:51]
v_exp_f32 v24, v24
v_smfmac_f32_16x16x64_bf16 a[128:131], a[208:211], v[104:111], v245
v_exp_f32 v25, v25
v_mfma_f32_16x16x32_bf16 v[44:47], a[160:163], v[152:155], v[136:139]
ds_read_b64_tr_b16 a[190:191], v223 offset:36864
v_cvt_pk_bf16_f32 v80, v24, v25
v_mfma_f32_16x16x32_bf16 v[44:47], a[164:167], v[156:159], v[44:47]
v_exp_f32 v26, v26
v_mfma_f32_16x16x32_bf16 v[44:47], a[168:171], v[160:163], v[44:47]
s_add_u32 m0, s88, 79488
s_lshl2_add_u32 s50, m0, s89
buffer_load_dwordx4 v243, s[56:59], s50 offen  lds
v_mfma_f32_16x16x32_bf16 v[44:47], a[172:175], v[164:167], v[44:47]
v_exp_f32 v27, v27
v_mfma_f32_16x16x32_bf16 v[52:55], a[172:175], v[180:183], v[140:143]
v_cvt_pk_bf16_f32 v81, v26, v27
v_mfma_f32_16x16x32_bf16 v[52:55], a[168:171], v[176:179], v[52:55]
v_exp_f32 v28, v28
v_mfma_f32_16x16x32_bf16 v[52:55], a[164:167], v[172:175], v[52:55]
s_add_u32 m0, s88, 82944
s_lshl2_add_u32 s50, m0, s89
buffer_load_dwordx4 v243, s[56:59], s50 offen  lds
v_mfma_f32_16x16x32_bf16 v[52:55], a[160:163], v[168:171], v[52:55]
v_exp_f32 v29, v29
v_mfma_f32_16x16x32_bf16 v[60:63], a[160:163], v[184:187], v[144:147]
v_cvt_pk_bf16_f32 v82, v28, v29
v_mfma_f32_16x16x32_bf16 v[60:63], a[164:167], v[188:191], v[60:63]
v_exp_f32 v30, v30
v_mfma_f32_16x16x32_bf16 v[60:63], a[168:171], v[192:195], v[60:63]
s_add_u32 m0, s88, 86400
s_lshl2_add_u32 s50, m0, s89
buffer_load_dwordx4 v243, s[56:59], s50 offen  lds
v_mfma_f32_16x16x32_bf16 v[60:63], a[172:175], v[196:199], v[60:63]
v_exp_f32 v31, v31
v_mfma_f32_16x16x32_bf16 v[68:71], a[172:175], v[212:215], v[148:151]
ds_read_b128 a[172:175], v219 offset:53248
v_cvt_pk_bf16_f32 v83, v30, v31
v_mfma_f32_16x16x32_bf16 v[68:71], a[168:171], v[208:211], v[68:71]
v_exp_f32 v32, v32
v_mfma_f32_16x16x32_bf16 v[68:71], a[164:167], v[204:207], v[68:71]
ds_read_b128 a[168:171], v218 offset:53248
ds_read_b128 a[164:167], v217 offset:53248
v_mfma_f32_16x16x32_bf16 v[68:71], a[160:163], v[200:203], v[68:71]
v_exp_f32 v33, v33
v_mfma_f32_16x16x32_bf16 a[64:67], v[104:107], a[228:231], a[64:67]
ds_read_b128 a[160:163], v216 offset:53248
v_cvt_pk_bf16_f32 v84, v32, v33
v_mfma_f32_16x16x32_bf16 a[64:67], v[88:91], a[192:195], a[64:67]
v_exp_f32 v34, v34
v_mfma_f32_16x16x32_bf16 a[68:71], v[92:95], a[192:195], a[68:71]
ds_read_b64_tr_b16 a[192:193], v224 offset:32768
ds_read_b64_tr_b16 a[194:195], v224 offset:36864
v_mfma_f32_16x16x32_bf16 a[68:71], v[108:111], a[228:231], a[68:71]
v_exp_f32 v35, v35
v_mfma_f32_16x16x32_bf16 a[84:87], v[108:111], a[232:235], a[84:87]
v_cvt_pk_bf16_f32 v85, v34, v35
v_mfma_f32_16x16x32_bf16 a[84:87], v[92:95], a[196:199], a[84:87]
v_exp_f32 v36, v36
v_mfma_f32_16x16x32_bf16 a[80:83], v[88:91], a[196:199], a[80:83]
ds_read_b64_tr_b16 a[196:197], v225 offset:32768
ds_read_b64_tr_b16 a[198:199], v225 offset:36864
v_mfma_f32_16x16x32_bf16 a[80:83], v[104:107], a[232:235], a[80:83]
v_exp_f32 v37, v37
v_mfma_f32_16x16x32_bf16 a[96:99], v[104:107], a[236:239], a[96:99]
v_cvt_pk_bf16_f32 v86, v36, v37
v_mfma_f32_16x16x32_bf16 a[96:99], v[88:91], a[200:203], a[96:99]
v_exp_f32 v38, v38
v_mfma_f32_16x16x32_bf16 a[100:103], v[92:95], a[200:203], a[100:103]
ds_read_b64_tr_b16 a[200:201], v226 offset:32768
ds_read_b64_tr_b16 a[202:203], v226 offset:36864
v_mfma_f32_16x16x32_bf16 a[100:103], v[108:111], a[236:239], a[100:103]
v_exp_f32 v39, v39
v_mfma_f32_16x16x32_bf16 a[116:119], v[108:111], a[240:243], a[116:119]
v_cvt_pk_bf16_f32 v87, v38, v39
v_mfma_f32_16x16x32_bf16 a[116:119], v[92:95], a[204:207], a[116:119]
s_add_u32 m0, s88, 89856
s_lshl2_add_u32 s50, m0, s89
buffer_load_dwordx4 v243, s[56:59], s50 offen  lds
v_mfma_f32_16x16x32_bf16 a[112:115], v[88:91], a[204:207], a[112:115]
ds_read_b64_tr_b16 a[204:205], v227 offset:32768
ds_read_b64_tr_b16 a[206:207], v227 offset:36864
v_mfma_f32_16x16x32_bf16 a[112:115], v[104:107], a[240:243], a[112:115]
s_add_u32 m0, s88, 93312
s_lshl2_add_u32 s50, m0, s89
buffer_load_dwordx4 v243, s[56:59], s50 offen  lds
v_smfmac_f32_16x16x64_bf16 a[132:135], a[208:211], v[112:119], v245
s_waitcnt vmcnt(16)
v_cmp_ne_u32 vcc, s47, v121
s_cbranch_vccnz SP_FK
SP_FK_RET:
s_waitcnt lgkmcnt(8)
v_mfma_f32_16x16x32_bf16 v[8:11], a[144:147], v[152:155], v[136:139]
v_exp_f32 v40, v40
v_mfma_f32_16x16x32_bf16 v[8:11], a[148:151], v[156:159], v[8:11]
v_exp_f32 v41, v41
v_mfma_f32_16x16x32_bf16 v[8:11], a[152:155], v[160:163], v[8:11]
v_cvt_pk_bf16_f32 v88, v40, v41
v_mfma_f32_16x16x32_bf16 v[8:11], a[156:159], v[164:167], v[8:11]
v_exp_f32 v42, v42
v_mfma_f32_16x16x32_bf16 v[16:19], a[156:159], v[180:183], v[140:143]
s_add_u32 m0, s88, 96768
s_lshl2_add_u32 s50, m0, s89
buffer_load_dwordx4 v243, s[56:59], s50 offen  lds
v_mfma_f32_16x16x32_bf16 v[16:19], a[152:155], v[176:179], v[16:19]
v_exp_f32 v43, v43
v_mfma_f32_16x16x32_bf16 v[16:19], a[148:151], v[172:175], v[16:19]
v_cvt_pk_bf16_f32 v89, v42, v43
v_mfma_f32_16x16x32_bf16 v[16:19], a[144:147], v[168:171], v[16:19]
v_exp_f32 v44, v44
v_mfma_f32_16x16x32_bf16 v[24:27], a[144:147], v[184:187], v[144:147]
s_mov_b32 s93, 0x243080
buffer_load_dword v246, v254, s[20:23], s93 offen sc0 sc1
v_mfma_f32_16x16x32_bf16 v[24:27], a[148:151], v[188:191], v[24:27]
s_mov_b32 s92, 0x1c00000
v_exp_f32 v45, v45
v_mfma_f32_16x16x32_bf16 v[24:27], a[152:155], v[192:195], v[24:27]
v_cvt_pk_bf16_f32 v90, v44, v45
v_mfma_f32_16x16x32_bf16 v[24:27], a[156:159], v[196:199], v[24:27]
v_exp_f32 v46, v46
v_mfma_f32_16x16x32_bf16 v[32:35], a[156:159], v[212:215], v[148:151]
ds_read_b128 a[156:159], v219 offset:57344
v_mfma_f32_16x16x32_bf16 v[32:35], a[152:155], v[208:211], v[32:35]
v_exp_f32 v47, v47
v_mfma_f32_16x16x32_bf16 v[32:35], a[148:151], v[204:207], v[32:35]
ds_read_b128 a[152:155], v218 offset:57344
v_cvt_pk_bf16_f32 v91, v46, v47
v_mfma_f32_16x16x32_bf16 v[32:35], a[144:147], v[200:203], v[32:35]
v_exp_f32 v48, v48
v_mfma_f32_16x16x32_bf16 a[8:11], v[80:83], a[176:179], a[8:11]
ds_read_b128 a[148:151], v217 offset:57344
ds_read_b128 a[144:147], v216 offset:57344
v_mfma_f32_16x16x32_bf16 a[8:11], v[112:115], a[212:215], a[8:11]
v_exp_f32 v49, v49
v_mfma_f32_16x16x32_bf16 a[12:15], v[116:119], a[212:215], a[12:15]
ds_read_b64_tr_b16 a[212:213], v220 offset:40960
v_cvt_pk_bf16_f32 v92, v48, v49
v_mfma_f32_16x16x32_bf16 a[12:15], v[84:87], a[176:179], a[12:15]
v_exp_f32 v50, v50
v_mfma_f32_16x16x32_bf16 a[28:31], v[84:87], a[180:183], a[28:31]
ds_read_b64_tr_b16 a[214:215], v220 offset:45056
buffer_load_dwordx4 a[136:139], v248, s[20:23], s92 offen offset:0 sc0 sc1
v_mfma_f32_16x16x32_bf16 a[28:31], v[116:119], a[216:219], a[28:31]
v_exp_f32 v51, v51
v_mfma_f32_16x16x32_bf16 a[24:27], v[112:115], a[216:219], a[24:27]
ds_read_b64_tr_b16 a[216:217], v221 offset:40960
v_cvt_pk_bf16_f32 v93, v50, v51
v_mfma_f32_16x16x32_bf16 a[24:27], v[80:83], a[180:183], a[24:27]
v_exp_f32 v52, v52
v_mfma_f32_16x16x32_bf16 a[40:43], v[80:83], a[184:187], a[40:43]
ds_read_b64_tr_b16 a[218:219], v221 offset:45056
v_mfma_f32_16x16x32_bf16 a[40:43], v[112:115], a[220:223], a[40:43]
v_exp_f32 v53, v53
v_mfma_f32_16x16x32_bf16 a[44:47], v[116:119], a[220:223], a[44:47]
ds_read_b64_tr_b16 a[220:221], v222 offset:40960
v_cvt_pk_bf16_f32 v94, v52, v53
v_mfma_f32_16x16x32_bf16 a[44:47], v[84:87], a[184:187], a[44:47]
v_exp_f32 v54, v54
v_mfma_f32_16x16x32_bf16 a[60:63], v[84:87], a[188:191], a[60:63]
ds_read_b64_tr_b16 a[222:223], v222 offset:45056
v_mfma_f32_16x16x32_bf16 a[60:63], v[116:119], a[224:227], a[60:63]
v_exp_f32 v55, v55
v_mfma_f32_16x16x32_bf16 a[56:59], v[112:115], a[224:227], a[56:59]
ds_read_b64_tr_b16 a[224:225], v223 offset:40960
v_cvt_pk_bf16_f32 v95, v54, v55
v_mfma_f32_16x16x32_bf16 a[56:59], v[80:83], a[188:191], a[56:59]
v_exp_f32 v56, v56
v_smfmac_f32_16x16x64_bf16 a[128:131], a[208:211], v[72:79], v245
v_exp_f32 v57, v57
v_mfma_f32_16x16x32_bf16 v[12:15], a[160:163], v[152:155], v[136:139]
ds_read_b64_tr_b16 a[226:227], v223 offset:45056
v_cvt_pk_bf16_f32 v96, v56, v57
v_mfma_f32_16x16x32_bf16 v[12:15], a[164:167], v[156:159], v[12:15]
v_exp_f32 v58, v58
v_mfma_f32_16x16x32_bf16 v[12:15], a[168:171], v[160:163], v[12:15]
s_add_u32 m0, s88, 100224
s_lshl2_add_u32 s50, m0, s89
buffer_load_dwordx4 v243, s[56:59], s50 offen  lds
v_mfma_f32_16x16x32_bf16 v[12:15], a[172:175], v[164:167], v[12:15]
v_exp_f32 v59, v59
v_mfma_f32_16x16x32_bf16 v[20:23], a[172:175], v[180:183], v[140:143]
buffer_load_dwordx4 a[140:143], v248, s[20:23], s92 offen offset:128 sc0 sc1
v_cvt_pk_bf16_f32 v97, v58, v59
v_mfma_f32_16x16x32_bf16 v[20:23], a[168:171], v[176:179], v[20:23]
v_exp_f32 v60, v60
v_mfma_f32_16x16x32_bf16 v[20:23], a[164:167], v[172:175], v[20:23]
s_add_u32 m0, s88, 103680
s_lshl2_add_u32 s50, m0, s89
buffer_load_dwordx4 v243, s[56:59], s50 offen  lds
v_mfma_f32_16x16x32_bf16 v[20:23], a[160:163], v[168:171], v[20:23]
v_exp_f32 v61, v61
v_mfma_f32_16x16x32_bf16 v[28:31], a[160:163], v[184:187], v[144:147]
v_cvt_pk_bf16_f32 v98, v60, v61
v_mfma_f32_16x16x32_bf16 v[28:31], a[164:167], v[188:191], v[28:31]
v_exp_f32 v62, v62
v_mfma_f32_16x16x32_bf16 v[28:31], a[168:171], v[192:195], v[28:31]
s_add_u32 m0, s88, 107136
s_lshl2_add_u32 s50, m0, s89
buffer_load_dwordx4 v243, s[56:59], s50 offen  lds
v_mfma_f32_16x16x32_bf16 v[28:31], a[172:175], v[196:199], v[28:31]
v_exp_f32 v63, v63
v_mfma_f32_16x16x32_bf16 v[36:39], a[172:175], v[212:215], v[148:151]
ds_read_b128 a[172:175], v219 offset:61440
STUB_12:
s_cbranch_execz HOP_RET1
v_cvt_pk_bf16_f32 v99, v62, v63
v_mfma_f32_16x16x32_bf16 v[36:39], a[168:171], v[208:211], v[36:39]
v_exp_f32 v64, v64
v_mfma_f32_16x16x32_bf16 v[36:39], a[164:167], v[204:207], v[36:39]
ds_read_b128 a[168:171], v218 offset:61440
ds_read_b128 a[164:167], v217 offset:61440
v_mfma_f32_16x16x32_bf16 v[36:39], a[160:163], v[200:203], v[36:39]
v_exp_f32 v65, v65
s_waitcnt lgkmcnt(8)
v_mfma_f32_16x16x32_bf16 a[72:75], v[80:83], a[192:195], a[72:75]
ds_read_b128 a[160:163], v216 offset:61440
v_cvt_pk_bf16_f32 v100, v64, v65
v_mfma_f32_16x16x32_bf16 a[72:75], v[112:115], a[228:231], a[72:75]
v_exp_f32 v66, v66
v_mfma_f32_16x16x32_bf16 a[76:79], v[116:119], a[228:231], a[76:79]
ds_read_b64_tr_b16 a[228:229], v224 offset:40960
ds_read_b64_tr_b16 a[230:231], v224 offset:45056
v_mfma_f32_16x16x32_bf16 a[76:79], v[84:87], a[192:195], a[76:79]
v_exp_f32 v67, v67
v_mfma_f32_16x16x32_bf16 a[92:95], v[84:87], a[196:199], a[92:95]
buffer_load_dwordx2 a[254:255], v249, s[20:23], s92 offen sc0 sc1
v_cvt_pk_bf16_f32 v101, v66, v67
v_mfma_f32_16x16x32_bf16 a[92:95], v[116:119], a[232:235], a[92:95]
v_sub_u32 v133, 0xffff, v132
v_exp_f32 v68, v68
v_mfma_f32_16x16x32_bf16 a[88:91], v[112:115], a[232:235], a[88:91]
ds_read_b64_tr_b16 a[232:233], v225 offset:40960
ds_read_b64_tr_b16 a[234:235], v225 offset:45056
v_and_b32 v120, 0xffff, v120
v_mfma_f32_16x16x32_bf16 a[88:91], v[80:83], a[196:199], a[88:91]
v_readlane_b32 s93, v120, 0
v_exp_f32 v69, v69
v_mfma_f32_16x16x32_bf16 a[104:107], v[80:83], a[200:203], a[104:107]
v_cvt_pk_bf16_f32 v102, v68, v69
v_mfma_f32_16x16x32_bf16 a[104:107], v[112:115], a[236:239], a[104:107]
v_cmp_eq_u32 s[90:91], s93, v133
v_exp_f32 v70, v70
v_mfma_f32_16x16x32_bf16 a[108:111], v[116:119], a[236:239], a[108:111]
ds_read_b64_tr_b16 a[236:237], v226 offset:40960
ds_read_b64_tr_b16 a[238:239], v226 offset:45056
v_mov_b32 v134, 0
v_mfma_f32_16x16x32_bf16 a[108:111], v[84:87], a[200:203], a[108:111]
v_cndmask_b32 v135, v135, v134, s[90:91]
v_exp_f32 v71, v71
v_mfma_f32_16x16x32_bf16 a[124:127], v[84:87], a[204:207], a[124:127]
v_cvt_pk_bf16_f32 v103, v70, v71
v_readlane_b32 s93, v120, 1
v_mfma_f32_16x16x32_bf16 a[124:127], v[116:119], a[240:243], a[124:127]
s_add_u32 m0, s88, 110592
s_lshl2_add_u32 s50, m0, s89
buffer_load_dwordx4 v243, s[56:59], s50 offen  lds
v_mfma_f32_16x16x32_bf16 a[120:123], v[112:115], a[240:243], a[120:123]
ds_read_b64_tr_b16 a[240:241], v227 offset:40960
ds_read_b64_tr_b16 a[242:243], v227 offset:45056
v_cmp_eq_u32 s[90:91], s93, v133
v_mfma_f32_16x16x32_bf16 a[120:123], v[80:83], a[204:207], a[120:123]
v_mov_b32 v134, 1152
v_smfmac_f32_16x16x64_bf16 a[132:135], a[208:211], v[80:87], v245
v_cndmask_b32 v135, v135, v134, s[90:91]
v_mfma_f32_16x16x32_bf16 v[40:43], a[144:147], v[152:155], v[136:139]
v_readlane_b32 s93, v120, 2
v_exp_f32 v8, v8
v_mfma_f32_16x16x32_bf16 v[40:43], a[148:151], v[156:159], v[40:43]
v_exp_f32 v9, v9
v_mfma_f32_16x16x32_bf16 v[40:43], a[152:155], v[160:163], v[40:43]
v_cvt_pk_bf16_f32 v104, v8, v9
v_cmp_eq_u32 s[90:91], s93, v133
v_mov_b32 v134, 2304
v_mfma_f32_16x16x32_bf16 v[40:43], a[156:159], v[164:167], v[40:43]
v_cndmask_b32 v135, v135, v134, s[90:91]
v_exp_f32 v10, v10
v_mfma_f32_16x16x32_bf16 v[48:51], a[156:159], v[180:183], v[140:143]
v_readlane_b32 s93, v120, 3
v_mfma_f32_16x16x32_bf16 v[48:51], a[152:155], v[176:179], v[48:51]
v_exp_f32 v11, v11
v_mfma_f32_16x16x32_bf16 v[48:51], a[148:151], v[172:175], v[48:51]
v_cvt_pk_bf16_f32 v105, v10, v11
v_cmp_eq_u32 s[90:91], s93, v133
v_mov_b32 v134, 3456
v_mfma_f32_16x16x32_bf16 v[48:51], a[144:147], v[168:171], v[48:51]
v_cndmask_b32 v135, v135, v134, s[90:91]
v_exp_f32 v12, v12
v_mfma_f32_16x16x32_bf16 v[56:59], a[144:147], v[184:187], v[144:147]
v_readlane_b32 s93, v120, 4
v_mfma_f32_16x16x32_bf16 v[56:59], a[148:151], v[188:191], v[56:59]
v_exp_f32 v13, v13
v_mfma_f32_16x16x32_bf16 v[56:59], a[152:155], v[192:195], v[56:59]
v_cvt_pk_bf16_f32 v106, v12, v13
v_cmp_eq_u32 s[90:91], s93, v133
v_mov_b32 v134, 4608
v_mfma_f32_16x16x32_bf16 v[56:59], a[156:159], v[196:199], v[56:59]
v_cndmask_b32 v135, v135, v134, s[90:91]
v_exp_f32 v14, v14
v_mfma_f32_16x16x32_bf16 v[64:67], a[156:159], v[212:215], v[148:151]
s_waitcnt vmcnt(15) lgkmcnt(0)
s_barrier
v_readlane_b32 s93, v120, 5
v_mfma_f32_16x16x32_bf16 v[64:67], a[152:155], v[208:211], v[64:67]
v_exp_f32 v15, v15
v_mfma_f32_16x16x32_bf16 v[64:67], a[148:151], v[204:207], v[64:67]
v_cvt_pk_bf16_f32 v107, v14, v15
v_cmp_eq_u32 s[90:91], s93, v133
v_mov_b32 v134, 5760
v_mfma_f32_16x16x32_bf16 v[64:67], a[144:147], v[200:203], v[64:67]
v_cndmask_b32 v135, v135, v134, s[90:91]
v_exp_f32 v16, v16
v_mfma_f32_16x16x32_bf16 a[0:3], v[88:91], a[212:215], a[0:3]
s_add_u32 m0, s88, 114048
s_lshl2_add_u32 s50, m0, s89
buffer_load_dwordx4 v243, s[56:59], s50 offen  lds
v_mfma_f32_16x16x32_bf16 a[0:3], v[72:75], a[176:179], a[0:3]
v_readlane_b32 s93, v120, 6
v_exp_f32 v17, v17
v_mfma_f32_16x16x32_bf16 a[4:7], v[76:79], a[176:179], a[4:7]
ds_read_b64_tr_b16 a[176:177], v220 offset:49152
v_cvt_pk_bf16_f32 v108, v16, v17
v_mfma_f32_16x16x32_bf16 a[4:7], v[92:95], a[212:215], a[4:7]
v_cmp_eq_u32 s[90:91], s93, v133
v_exp_f32 v18, v18
v_mfma_f32_16x16x32_bf16 a[20:23], v[92:95], a[216:219], a[20:23]
ds_read_b64_tr_b16 a[178:179], v220 offset:53248
v_mov_b32 v134, 6912
v_mfma_f32_16x16x32_bf16 a[20:23], v[76:79], a[180:183], a[20:23]
v_cndmask_b32 v135, v135, v134, s[90:91]
v_exp_f32 v19, v19
v_mfma_f32_16x16x32_bf16 a[16:19], v[72:75], a[180:183], a[16:19]
ds_read_b64_tr_b16 a[180:181], v221 offset:49152
v_cvt_pk_bf16_f32 v109, v18, v19
v_readlane_b32 s93, v120, 7
v_mfma_f32_16x16x32_bf16 a[16:19], v[88:91], a[216:219], a[16:19]
v_exp_f32 v20, v20
v_mfma_f32_16x16x32_bf16 a[32:35], v[88:91], a[220:223], a[32:35]
ds_read_b64_tr_b16 a[182:183], v221 offset:53248
v_cmp_eq_u32 s[90:91], s93, v133
v_mov_b32 v134, 8064
v_mfma_f32_16x16x32_bf16 a[32:35], v[72:75], a[184:187], a[32:35]
v_cndmask_b32 v135, v135, v134, s[90:91]
v_exp_f32 v21, v21
v_mfma_f32_16x16x32_bf16 a[36:39], v[76:79], a[184:187], a[36:39]
ds_read_b64_tr_b16 a[184:185], v222 offset:49152
v_cvt_pk_bf16_f32 v110, v20, v21
v_mfma_f32_16x16x32_bf16 a[36:39], v[92:95], a[220:223], a[36:39]
v_exp_f32 v22, v22
v_mfma_f32_16x16x32_bf16 a[52:55], v[92:95], a[224:227], a[52:55]
ds_read_b64_tr_b16 a[186:187], v222 offset:53248
v_add_u32 v250, v250, v135
v_mfma_f32_16x16x32_bf16 a[52:55], v[76:79], a[188:191], a[52:55]
v_exp_f32 v23, v23
v_mfma_f32_16x16x32_bf16 a[48:51], v[72:75], a[188:191], a[48:51]
ds_read_b64_tr_b16 a[188:189], v223 offset:49152
v_cvt_pk_bf16_f32 v111, v22, v23
v_mfma_f32_16x16x32_bf16 a[48:51], v[88:91], a[224:227], a[48:51]
v_exp_f32 v24, v24
v_smfmac_f32_16x16x64_bf16 a[128:131], a[208:211], v[88:95], v245
v_exp_f32 v25, v25
v_mfma_f32_16x16x32_bf16 v[44:47], a[160:163], v[152:155], v[136:139]
ds_read_b64_tr_b16 a[190:191], v223 offset:53248
v_cvt_pk_bf16_f32 v112, v24, v25
v_mfma_f32_16x16x32_bf16 v[44:47], a[164:167], v[156:159], v[44:47]
v_add_u32 v251, v251, v135
v_exp_f32 v26, v26
v_mfma_f32_16x16x32_bf16 v[44:47], a[168:171], v[160:163], v[44:47]
s_add_u32 m0, s88, 117504
s_lshl2_add_u32 s50, m0, s89
buffer_load_dwordx4 v243, s[56:59], s50 offen  lds
v_mfma_f32_16x16x32_bf16 v[44:47], a[172:175], v[164:167], v[44:47]
v_exp_f32 v27, v27
v_mfma_f32_16x16x32_bf16 v[52:55], a[172:175], v[180:183], v[140:143]
v_cvt_pk_bf16_f32 v113, v26, v27
v_lshrrev_b32 v134, 14, v135
v_mfma_f32_16x16x32_bf16 v[52:55], a[168:171], v[176:179], v[52:55]
v_exp_f32 v28, v28
v_mfma_f32_16x16x32_bf16 v[52:55], a[164:167], v[172:175], v[52:55]
s_add_u32 m0, s88, 120960
s_lshl2_add_u32 s50, m0, s89
buffer_load_dwordx4 v243, s[56:59], s50 offen  lds
v_mfma_f32_16x16x32_bf16 v[52:55], a[160:163], v[168:171], v[52:55]
v_exp_f32 v29, v29
v_mfma_f32_16x16x32_bf16 v[60:63], a[160:163], v[184:187], v[144:147]
v_cvt_pk_bf16_f32 v114, v28, v29
v_cmp_eq_u32 s[90:91], 0, v134
v_mfma_f32_16x16x32_bf16 v[60:63], a[164:167], v[188:191], v[60:63]
v_exp_f32 v30, v30
v_mfma_f32_16x16x32_bf16 v[60:63], a[168:171], v[192:195], v[60:63]
s_add_u32 m0, s88, 124416
s_lshl2_add_u32 s50, m0, s89
buffer_load_dwordx4 v243, s[56:59], s50 offen  lds
v_mfma_f32_16x16x32_bf16 v[60:63], a[172:175], v[196:199], v[60:63]
v_exp_f32 v31, v31
v_mfma_f32_16x16x32_bf16 v[68:71], a[172:175], v[212:215], v[148:151]
v_cvt_pk_bf16_f32 v115, v30, v31
v_mfma_f32_16x16x32_bf16 v[68:71], a[168:171], v[208:211], v[68:71]
v_exp_f32 v32, v32
v_mfma_f32_16x16x32_bf16 v[68:71], a[164:167], v[204:207], v[68:71]
s_add_u32 m0, s88, 127872
s_lshl2_add_u32 s50, m0, s89
buffer_load_dwordx4 v243, s[56:59], s50 offen  lds
v_mfma_f32_16x16x32_bf16 v[68:71], a[160:163], v[200:203], v[68:71]
v_exp_f32 v33, v33
v_mfma_f32_16x16x32_bf16 a[64:67], v[88:91], a[228:231], a[64:67]
v_cvt_pk_bf16_f32 v116, v32, v33
s_waitcnt vmcnt(12)
v_readfirstlane_b32 s93, v246
v_mfma_f32_16x16x32_bf16 a[64:67], v[72:75], a[192:195], a[64:67]
v_exp_f32 v34, v34
v_mfma_f32_16x16x32_bf16 a[68:71], v[76:79], a[192:195], a[68:71]
ds_read_b64_tr_b16 a[192:193], v224 offset:49152
ds_read_b64_tr_b16 a[194:195], v224 offset:53248
v_mfma_f32_16x16x32_bf16 a[68:71], v[92:95], a[228:231], a[68:71]
v_exp_f32 v35, v35
v_mfma_f32_16x16x32_bf16 a[84:87], v[92:95], a[232:235], a[84:87]
v_cvt_pk_bf16_f32 v117, v34, v35
v_mfma_f32_16x16x32_bf16 a[84:87], v[76:79], a[196:199], a[84:87]
v_exp_f32 v36, v36
v_mfma_f32_16x16x32_bf16 a[80:83], v[72:75], a[196:199], a[80:83]
ds_read_b64_tr_b16 a[196:197], v225 offset:49152
ds_read_b64_tr_b16 a[198:199], v225 offset:53248
v_mfma_f32_16x16x32_bf16 a[80:83], v[88:91], a[232:235], a[80:83]
v_exp_f32 v37, v37
v_mfma_f32_16x16x32_bf16 a[96:99], v[88:91], a[236:239], a[96:99]
s_cmp_eq_u64 s[90:91], 0
s_cselect_b32 s93, 144, s93
v_cvt_pk_bf16_f32 v118, v36, v37
v_mfma_f32_16x16x32_bf16 a[96:99], v[72:75], a[200:203], a[96:99]
v_exp_f32 v38, v38
v_mfma_f32_16x16x32_bf16 a[100:103], v[76:79], a[200:203], a[100:103]
ds_read_b64_tr_b16 a[200:201], v226 offset:49152
ds_read_b64_tr_b16 a[202:203], v226 offset:53248
v_mfma_f32_16x16x32_bf16 a[100:103], v[92:95], a[236:239], a[100:103]
v_exp_f32 v39, v39
v_mfma_f32_16x16x32_bf16 a[116:119], v[92:95], a[240:243], a[116:119]
v_cvt_pk_bf16_f32 v119, v38, v39
v_mfma_f32_16x16x32_bf16 a[116:119], v[76:79], a[204:207], a[116:119]
s_add_u32 m0, s88, 131328
s_lshl2_add_u32 s50, m0, s89
buffer_load_dwordx4 v243, s[56:59], s50 offen  lds
v_mfma_f32_16x16x32_bf16 a[112:115], v[72:75], a[204:207], a[112:115]
ds_read_b64_tr_b16 a[204:205], v227 offset:49152
ds_read_b64_tr_b16 a[206:207], v227 offset:53248
v_mfma_f32_16x16x32_bf16 a[112:115], v[88:91], a[240:243], a[112:115]
s_add_u32 m0, s88, 134784
s_lshl2_add_u32 s50, m0, s89
buffer_load_dwordx4 v243, s[56:59], s50 offen  lds
v_smfmac_f32_16x16x64_bf16 a[132:135], a[208:211], v[96:103], v245
s_cmp_lt_u32 s93, 144
s_cbranch_scc1 SP_Y
SP_Y_RET:
s_waitcnt lgkmcnt(8)
v_mfma_f32_16x16x32_bf16 a[0:3], v[104:107], a[176:179], a[0:3]
v_exp_f32 v40, v40
v_mfma_f32_16x16x32_bf16 a[4:7], v[108:111], a[176:179], a[4:7]
s_mov_b32 s93, 0x244000
v_exp_f32 v41, v41
v_mfma_f32_16x16x32_bf16 a[8:11], v[112:115], a[176:179], a[8:11]
v_cvt_pk_bf16_f32 v72, v40, v41
v_exp_f32 v42, v42
v_mfma_f32_16x16x32_bf16 a[8:11], v[96:99], a[212:215], a[8:11]
s_add_u32 m0, s88, 138240
s_lshl2_add_u32 s50, m0, s89
buffer_load_dwordx4 v243, s[56:59], s50 offen  lds
v_mfma_f32_16x16x32_bf16 a[12:15], v[100:103], a[212:215], a[12:15]
ds_read_b64_tr_b16 a[212:213], v220 offset:57344
v_exp_f32 v43, v43
v_mfma_f32_16x16x32_bf16 a[12:15], v[116:119], a[176:179], a[12:15]
v_cvt_pk_bf16_f32 v73, v42, v43
v_exp_f32 v44, v44
v_mfma_f32_16x16x32_bf16 a[28:31], v[116:119], a[180:183], a[28:31]
ds_read_b64_tr_b16 a[214:215], v220 offset:61440
buffer_load_dwordx4 a[144:147], v250, s[20:23], s93 offen offset:0 sc0 sc1
v_mfma_f32_16x16x32_bf16 a[28:31], v[100:103], a[216:219], a[28:31]
v_exp_f32 v45, v45
v_mfma_f32_16x16x32_bf16 a[24:27], v[96:99], a[216:219], a[24:27]
v_cvt_pk_bf16_f32 v74, v44, v45
v_exp_f32 v46, v46
v_mfma_f32_16x16x32_bf16 a[24:27], v[112:115], a[180:183], a[24:27]
ds_read_b64_tr_b16 a[216:217], v221 offset:57344
ds_read_b64_tr_b16 a[218:219], v221 offset:61440
v_mfma_f32_16x16x32_bf16 a[20:23], v[108:111], a[180:183], a[20:23]
v_exp_f32 v47, v47
v_mfma_f32_16x16x32_bf16 a[16:19], v[104:107], a[180:183], a[16:19]
v_cvt_pk_bf16_f32 v75, v46, v47
v_exp_f32 v48, v48
v_mfma_f32_16x16x32_bf16 a[32:35], v[104:107], a[184:187], a[32:35]
v_exp_f32 v49, v49
v_mfma_f32_16x16x32_bf16 a[36:39], v[108:111], a[184:187], a[36:39]
buffer_load_dwordx4 a[148:151], v250, s[20:23], s93 offen offset:128 sc0 sc1
v_cvt_pk_bf16_f32 v76, v48, v49
v_mfma_f32_16x16x32_bf16 a[40:43], v[112:115], a[184:187], a[40:43]
v_exp_f32 v50, v50
v_mfma_f32_16x16x32_bf16 a[40:43], v[96:99], a[220:223], a[40:43]
v_exp_f32 v51, v51
v_mfma_f32_16x16x32_bf16 a[44:47], v[100:103], a[220:223], a[44:47]
ds_read_b64_tr_b16 a[220:221], v222 offset:57344
ds_read_b64_tr_b16 a[222:223], v222 offset:61440
v_cvt_pk_bf16_f32 v77, v50, v51
v_mfma_f32_16x16x32_bf16 a[44:47], v[116:119], a[184:187], a[44:47]
v_exp_f32 v52, v52
v_mfma_f32_16x16x32_bf16 a[60:63], v[116:119], a[188:191], a[60:63]
v_exp_f32 v53, v53
v_mfma_f32_16x16x32_bf16 a[60:63], v[100:103], a[224:227], a[60:63]
buffer_load_dwordx2 a[152:153], v251, s[20:23], s93 offen sc0 sc1
v_cvt_pk_bf16_f32 v78, v52, v53
v_mfma_f32_16x16x32_bf16 a[56:59], v[96:99], a[224:227], a[56:59]
ds_read_b64_tr_b16 a[224:225], v223 offset:57344
v_exp_f32 v54, v54
v_mfma_f32_16x16x32_bf16 a[56:59], v[112:115], a[188:191], a[56:59]
ds_read_b64_tr_b16 a[226:227], v223 offset:61440
v_exp_f32 v55, v55
v_mfma_f32_16x16x32_bf16 a[52:55], v[108:111], a[188:191], a[52:55]
v_cvt_pk_bf16_f32 v79, v54, v55
v_mfma_f32_16x16x32_bf16 a[48:51], v[104:107], a[188:191], a[48:51]
v_exp_f32 v56, v56
v_smfmac_f32_16x16x64_bf16 a[128:131], a[208:211], v[104:111], v245
v_exp_f32 v57, v57
s_waitcnt lgkmcnt(8)
v_mfma_f32_16x16x32_bf16 a[64:67], v[104:107], a[192:195], a[64:67]
v_cvt_pk_bf16_f32 v80, v56, v57
v_exp_f32 v58, v58
v_mfma_f32_16x16x32_bf16 a[68:71], v[108:111], a[192:195], a[68:71]
s_add_u32 m0, s88, 141696
s_lshl2_add_u32 s50, m0, s89
buffer_load_dwordx4 v243, s[56:59], s50 offen  lds
v_mfma_f32_16x16x32_bf16 a[72:75], v[112:115], a[192:195], a[72:75]
v_exp_f32 v59, v59
v_mfma_f32_16x16x32_bf16 a[72:75], v[96:99], a[228:231], a[72:75]
v_cvt_pk_bf16_f32 v81, v58, v59
v_exp_f32 v60, v60
v_mfma_f32_16x16x32_bf16 a[76:79], v[100:103], a[228:231], a[76:79]
ds_read_b64_tr_b16 a[228:229], v224 offset:57344
ds_read_b64_tr_b16 a[230:231], v224 offset:61440
v_mfma_f32_16x16x32_bf16 a[76:79], v[116:119], a[192:195], a[76:79]
v_exp_f32 v61, v61
v_mfma_f32_16x16x32_bf16 a[92:95], v[116:119], a[196:199], a[92:95]
v_cvt_pk_bf16_f32 v82, v60, v61
v_exp_f32 v62, v62
v_mfma_f32_16x16x32_bf16 a[92:95], v[100:103], a[232:235], a[92:95]
s_add_u32 m0, s88, 145152
s_min_u32 m0, m0, 146880
s_lshl2_add_u32 s50, m0, s89
s_cmp_ge_u32 s37, 2
s_cselect_b32 exec_hi, 15, -1
buffer_load_dwordx4 v243, s[56:59], s50 offen  lds
s_mov_b32 exec_hi, -1
v_mfma_f32_16x16x32_bf16 a[88:91], v[96:99], a[232:235], a[88:91]
ds_read_b64_tr_b16 a[232:233], v225 offset:57344
v_exp_f32 v63, v63
v_mfma_f32_16x16x32_bf16 a[88:91], v[112:115], a[196:199], a[88:91]
v_cvt_pk_bf16_f32 v83, v62, v63
v_exp_f32 v64, v64
v_mfma_f32_16x16x32_bf16 a[84:87], v[108:111], a[196:199], a[84:87]
ds_read_b64_tr_b16 a[234:235], v225 offset:61440
v_exp_f32 v65, v65
v_mfma_f32_16x16x32_bf16 a[80:83], v[104:107], a[196:199], a[80:83]
v_cvt_pk_bf16_f32 v84, v64, v65
v_mfma_f32_16x16x32_bf16 a[96:99], v[104:107], a[200:203], a[96:99]
v_exp_f32 v66, v66
v_mfma_f32_16x16x32_bf16 a[100:103], v[108:111], a[200:203], a[100:103]
v_exp_f32 v67, v67
v_mfma_f32_16x16x32_bf16 a[104:107], v[112:115], a[200:203], a[104:107]
v_cvt_pk_bf16_f32 v85, v66, v67
v_mfma_f32_16x16x32_bf16 a[104:107], v[96:99], a[236:239], a[104:107]
v_exp_f32 v68, v68
v_mfma_f32_16x16x32_bf16 a[108:111], v[100:103], a[236:239], a[108:111]
ds_read_b64_tr_b16 a[236:237], v226 offset:57344
v_exp_f32 v69, v69
v_mfma_f32_16x16x32_bf16 a[108:111], v[116:119], a[200:203], a[108:111]
ds_read_b64_tr_b16 a[238:239], v226 offset:61440
v_cvt_pk_bf16_f32 v86, v68, v69
v_mfma_f32_16x16x32_bf16 a[124:127], v[116:119], a[204:207], a[124:127]
v_exp_f32 v70, v70
v_mfma_f32_16x16x32_bf16 a[124:127], v[100:103], a[240:243], a[124:127]
v_exp_f32 v71, v71
v_mfma_f32_16x16x32_bf16 a[120:123], v[96:99], a[240:243], a[120:123]
ds_read_b64_tr_b16 a[240:241], v227 offset:57344
ds_read_b64_tr_b16 a[242:243], v227 offset:61440
v_cvt_pk_bf16_f32 v87, v70, v71
v_mfma_f32_16x16x32_bf16 a[120:123], v[112:115], a[204:207], a[120:123]
v_mfma_f32_16x16x32_bf16 a[116:119], v[108:111], a[204:207], a[116:119]
v_mfma_f32_16x16x32_bf16 a[112:115], v[104:107], a[204:207], a[112:115]
v_smfmac_f32_16x16x64_bf16 a[132:135], a[208:211], v[112:119], v245
K_TAIL:
s_cmp_eq_u32 s48, 0
s_cbranch_scc1 K_MIXED
s_waitcnt lgkmcnt(0)
s_barrier
s_add_u32 s28, s30, 147456
v_smfmac_f32_16x16x64_bf16 a[128:131], a[208:211], v[72:79], v245
v_lshrrev_b32 v132, 1, v1
v_and_b32 v132, 8, v132
v_smfmac_f32_16x16x64_bf16 a[132:135], a[208:211], v[80:87], v245
v_xor_b32 v132, v132, v1
v_lshlrev_b32 v132, 4, v132
v_mfma_f32_16x16x32_bf16 a[0:3], v[72:75], a[212:215], a[0:3]
v_add_u32 v132, s28, v132
v_lshlrev_b32 v133, 3, v1
v_mfma_f32_16x16x32_bf16 a[16:19], v[72:75], a[216:219], a[16:19]
v_and_b32 v133, 8, v133
v_lshrrev_b32 v134, 2, v1
v_mfma_f32_16x16x32_bf16 a[32:35], v[72:75], a[220:223], a[32:35]
v_xor_b32 v133, v133, v134
v_and_b32 v134, 3, v1
v_mfma_f32_16x16x32_bf16 a[48:51], v[72:75], a[224:227], a[48:51]
v_lshl_add_u32 v133, v134, 4, v133
v_lshlrev_b32 v133, 4, v133
v_mfma_f32_16x16x32_bf16 a[64:67], v[72:75], a[228:231], a[64:67]
v_add_u32 v133, s28, v133
v_lshlrev_b32 v134, 2, v1
v_mfma_f32_16x16x32_bf16 a[80:83], v[72:75], a[232:235], a[80:83]
v_add_u32 v134, s28, v134
v_lshlrev_b32 v135, 4, v4
v_mfma_f32_16x16x32_bf16 a[96:99], v[72:75], a[236:239], a[96:99]
v_add_u32 v135, s28, v135
v_mfma_f32_16x16x32_bf16 a[112:115], v[72:75], a[240:243], a[112:115]
v_mfma_f32_16x16x32_bf16 a[4:7], v[76:79], a[212:215], a[4:7]
v_accvgpr_read_b32 v120, a128
v_accvgpr_read_b32 v124, a129
v_accvgpr_read_b32 v121, a130
v_mfma_f32_16x16x32_bf16 a[20:23], v[76:79], a[216:219], a[20:23]
v_accvgpr_read_b32 v125, a131
v_accvgpr_read_b32 v122, a132
v_accvgpr_read_b32 v126, a133
v_mfma_f32_16x16x32_bf16 a[36:39], v[76:79], a[220:223], a[36:39]
v_accvgpr_read_b32 v123, a134
v_accvgpr_read_b32 v127, a135
v_add_f32 v120, v120, v124
v_mfma_f32_16x16x32_bf16 a[52:55], v[76:79], a[224:227], a[52:55]
v_add_f32 v121, v121, v125
v_add_f32 v122, v122, v126
v_add_f32 v123, v123, v127
v_mfma_f32_16x16x32_bf16 a[68:71], v[76:79], a[228:231], a[68:71]
v_rcp_f32 v124, v120
v_rcp_f32 v125, v121
v_rcp_f32 v126, v122
v_mfma_f32_16x16x32_bf16 a[84:87], v[76:79], a[232:235], a[84:87]
v_rcp_f32 v127, v123
ds_write_b32 v134, v124 offset:0
ds_write_b32 v134, v125 offset:256
v_mfma_f32_16x16x32_bf16 a[100:103], v[76:79], a[236:239], a[100:103]
ds_write_b32 v134, v126 offset:512
ds_write_b32 v134, v127 offset:768
ds_read_b128 v[88:91], v135 offset:0
v_mfma_f32_16x16x32_bf16 a[116:119], v[76:79], a[240:243], a[116:119]
ds_read_b128 v[92:95], v135 offset:256
ds_read_b128 v[96:99], v135 offset:512
ds_read_b128 v[100:103], v135 offset:768
s_add_u32 s92, s44, 4096
s_add_u32 s93, s44, 8192
s_add_u32 s51, s44, 12288
v_mfma_f32_16x16x32_bf16 a[8:11], v[80:83], a[212:215], a[8:11]
v_accvgpr_read_b32 v104, a0
v_accvgpr_read_b32 v105, a1
v_accvgpr_read_b32 v106, a2
v_accvgpr_read_b32 v107, a3
v_mfma_f32_16x16x32_bf16 a[24:27], v[80:83], a[216:219], a[24:27]
v_accvgpr_read_b32 v108, a16
v_accvgpr_read_b32 v109, a17
v_accvgpr_read_b32 v110, a18
v_accvgpr_read_b32 v111, a19
s_waitcnt lgkmcnt(0)
v_pk_mul_f32 v[104:105], v[104:105], v[88:89]
v_pk_mul_f32 v[106:107], v[106:107], v[90:91]
v_pk_mul_f32 v[108:109], v[108:109], v[88:89]
v_pk_mul_f32 v[110:111], v[110:111], v[90:91]
v_cvt_pk_bf16_f32 v104, v104, v105
v_cvt_pk_bf16_f32 v105, v106, v107
v_cvt_pk_bf16_f32 v106, v108, v109
v_cvt_pk_bf16_f32 v107, v110, v111
v_mfma_f32_16x16x32_bf16 a[40:43], v[80:83], a[220:223], a[40:43]
v_accvgpr_read_b32 v112, a32
v_accvgpr_read_b32 v113, a33
v_accvgpr_read_b32 v114, a34
v_accvgpr_read_b32 v115, a35
ds_write_b128 v132, v[104:107] offset:0
v_mfma_f32_16x16x32_bf16 a[56:59], v[80:83], a[224:227], a[56:59]
v_accvgpr_read_b32 v116, a48
v_accvgpr_read_b32 v117, a49
v_accvgpr_read_b32 v118, a50
v_accvgpr_read_b32 v119, a51
ds_read_b64_tr_b16 v[8:9], v133 offset:0
ds_read_b64_tr_b16 v[10:11], v133 offset:8
v_pk_mul_f32 v[112:113], v[112:113], v[88:89]
v_pk_mul_f32 v[114:115], v[114:115], v[90:91]
v_pk_mul_f32 v[116:117], v[116:117], v[88:89]
v_pk_mul_f32 v[118:119], v[118:119], v[90:91]
v_cvt_pk_bf16_f32 v112, v112, v113
v_cvt_pk_bf16_f32 v113, v114, v115
v_cvt_pk_bf16_f32 v114, v116, v117
v_cvt_pk_bf16_f32 v115, v118, v119
v_mfma_f32_16x16x32_bf16 a[72:75], v[80:83], a[228:231], a[72:75]
v_accvgpr_read_b32 v104, a64
v_accvgpr_read_b32 v105, a65
v_accvgpr_read_b32 v106, a66
v_accvgpr_read_b32 v107, a67
ds_write_b128 v132, v[112:115] offset:1024
v_mfma_f32_16x16x32_bf16 a[88:91], v[80:83], a[232:235], a[88:91]
v_accvgpr_read_b32 v108, a80
v_accvgpr_read_b32 v109, a81
v_accvgpr_read_b32 v110, a82
v_accvgpr_read_b32 v111, a83
ds_read_b64_tr_b16 v[12:13], v133 offset:1024
ds_read_b64_tr_b16 v[14:15], v133 offset:1032
v_pk_mul_f32 v[104:105], v[104:105], v[88:89]
v_pk_mul_f32 v[106:107], v[106:107], v[90:91]
v_pk_mul_f32 v[108:109], v[108:109], v[88:89]
v_pk_mul_f32 v[110:111], v[110:111], v[90:91]
s_waitcnt lgkmcnt(3)
buffer_store_dwordx4 v[8:11], v244, s[20:23], s44 offen offset:0
v_cvt_pk_bf16_f32 v104, v104, v105
v_cvt_pk_bf16_f32 v105, v106, v107
v_cvt_pk_bf16_f32 v106, v108, v109
v_cvt_pk_bf16_f32 v107, v110, v111
v_mfma_f32_16x16x32_bf16 a[104:107], v[80:83], a[236:239], a[104:107]
v_accvgpr_read_b32 v112, a96
v_accvgpr_read_b32 v113, a97
v_accvgpr_read_b32 v114, a98
v_accvgpr_read_b32 v115, a99
ds_write_b128 v132, v[104:107] offset:2048
v_mfma_f32_16x16x32_bf16 a[120:123], v[80:83], a[240:243], a[120:123]
v_accvgpr_read_b32 v116, a112
v_accvgpr_read_b32 v117, a113
v_accvgpr_read_b32 v118, a114
v_accvgpr_read_b32 v119, a115
ds_read_b64_tr_b16 v[16:17], v133 offset:2048
ds_read_b64_tr_b16 v[18:19], v133 offset:2056
v_pk_mul_f32 v[112:113], v[112:113], v[88:89]
v_pk_mul_f32 v[114:115], v[114:115], v[90:91]
v_pk_mul_f32 v[116:117], v[116:117], v[88:89]
v_pk_mul_f32 v[118:119], v[118:119], v[90:91]
s_waitcnt lgkmcnt(3)
buffer_store_dwordx4 v[12:15], v244, s[20:23], s44 offen offset:1024
v_cvt_pk_bf16_f32 v112, v112, v113
v_cvt_pk_bf16_f32 v113, v114, v115
v_cvt_pk_bf16_f32 v114, v116, v117
v_cvt_pk_bf16_f32 v115, v118, v119
v_mfma_f32_16x16x32_bf16 a[12:15], v[84:87], a[212:215], a[12:15]
v_accvgpr_read_b32 v104, a4
v_accvgpr_read_b32 v105, a5
v_accvgpr_read_b32 v106, a6
v_accvgpr_read_b32 v107, a7
ds_write_b128 v132, v[112:115] offset:3072
v_mfma_f32_16x16x32_bf16 a[28:31], v[84:87], a[216:219], a[28:31]
v_accvgpr_read_b32 v108, a20
v_accvgpr_read_b32 v109, a21
v_accvgpr_read_b32 v110, a22
v_accvgpr_read_b32 v111, a23
ds_read_b64_tr_b16 v[20:21], v133 offset:3072
ds_read_b64_tr_b16 v[22:23], v133 offset:3080
v_pk_mul_f32 v[104:105], v[104:105], v[92:93]
v_pk_mul_f32 v[106:107], v[106:107], v[94:95]
v_pk_mul_f32 v[108:109], v[108:109], v[92:93]
v_pk_mul_f32 v[110:111], v[110:111], v[94:95]
s_waitcnt lgkmcnt(3)
buffer_store_dwordx4 v[16:19], v244, s[20:23], s44 offen offset:2048
v_cvt_pk_bf16_f32 v104, v104, v105
v_cvt_pk_bf16_f32 v105, v106, v107
v_cvt_pk_bf16_f32 v106, v108, v109
v_cvt_pk_bf16_f32 v107, v110, v111
v_mfma_f32_16x16x32_bf16 a[44:47], v[84:87], a[220:223], a[44:47]
v_accvgpr_read_b32 v112, a36
v_accvgpr_read_b32 v113, a37
v_accvgpr_read_b32 v114, a38
v_accvgpr_read_b32 v115, a39
ds_write_b128 v132, v[104:107] offset:0
v_mfma_f32_16x16x32_bf16 a[60:63], v[84:87], a[224:227], a[60:63]
v_accvgpr_read_b32 v116, a52
v_accvgpr_read_b32 v117, a53
v_accvgpr_read_b32 v118, a54
v_accvgpr_read_b32 v119, a55
ds_read_b64_tr_b16 v[24:25], v133 offset:0
ds_read_b64_tr_b16 v[26:27], v133 offset:8
v_pk_mul_f32 v[112:113], v[112:113], v[92:93]
v_pk_mul_f32 v[114:115], v[114:115], v[94:95]
v_pk_mul_f32 v[116:117], v[116:117], v[92:93]
v_pk_mul_f32 v[118:119], v[118:119], v[94:95]
s_waitcnt lgkmcnt(3)
buffer_store_dwordx4 v[20:23], v244, s[20:23], s44 offen offset:3072
v_cvt_pk_bf16_f32 v112, v112, v113
v_cvt_pk_bf16_f32 v113, v114, v115
v_cvt_pk_bf16_f32 v114, v116, v117
STUB_13:
STUB_B1:
s_cbranch_execz STUB_16
v_cvt_pk_bf16_f32 v115, v118, v119
v_mfma_f32_16x16x32_bf16 a[76:79], v[84:87], a[228:231], a[76:79]
v_accvgpr_read_b32 v104, a68
v_accvgpr_read_b32 v105, a69
v_accvgpr_read_b32 v106, a70
v_accvgpr_read_b32 v107, a71
ds_write_b128 v132, v[112:115] offset:1024
v_mfma_f32_16x16x32_bf16 a[92:95], v[84:87], a[232:235], a[92:95]
v_accvgpr_read_b32 v108, a84
v_accvgpr_read_b32 v109, a85
v_accvgpr_read_b32 v110, a86
v_accvgpr_read_b32 v111, a87
ds_read_b64_tr_b16 v[28:29], v133 offset:1024
ds_read_b64_tr_b16 v[30:31], v133 offset:1032
v_pk_mul_f32 v[104:105], v[104:105], v[92:93]
v_pk_mul_f32 v[106:107], v[106:107], v[94:95]
v_pk_mul_f32 v[108:109], v[108:109], v[92:93]
v_pk_mul_f32 v[110:111], v[110:111], v[94:95]
s_waitcnt lgkmcnt(3)
buffer_store_dwordx4 v[24:27], v244, s[20:23], s92 offen offset:0
v_cvt_pk_bf16_f32 v104, v104, v105
v_cvt_pk_bf16_f32 v105, v106, v107
v_cvt_pk_bf16_f32 v106, v108, v109
v_cvt_pk_bf16_f32 v107, v110, v111
v_mfma_f32_16x16x32_bf16 a[108:111], v[84:87], a[236:239], a[108:111]
v_accvgpr_read_b32 v112, a100
v_accvgpr_read_b32 v113, a101
v_accvgpr_read_b32 v114, a102
v_accvgpr_read_b32 v115, a103
ds_write_b128 v132, v[104:107] offset:2048
v_mfma_f32_16x16x32_bf16 a[124:127], v[84:87], a[240:243], a[124:127]
v_accvgpr_read_b32 v116, a116
v_accvgpr_read_b32 v117, a117
v_accvgpr_read_b32 v118, a118
v_accvgpr_read_b32 v119, a119
ds_read_b64_tr_b16 v[32:33], v133 offset:2048
ds_read_b64_tr_b16 v[34:35], v133 offset:2056
v_pk_mul_f32 v[112:113], v[112:113], v[92:93]
v_pk_mul_f32 v[114:115], v[114:115], v[94:95]
v_pk_mul_f32 v[116:117], v[116:117], v[92:93]
v_pk_mul_f32 v[118:119], v[118:119], v[94:95]
s_waitcnt lgkmcnt(3)
buffer_store_dwordx4 v[28:31], v244, s[20:23], s92 offen offset:1024
v_cvt_pk_bf16_f32 v112, v112, v113
v_cvt_pk_bf16_f32 v113, v114, v115
v_cvt_pk_bf16_f32 v114, v116, v117
v_cvt_pk_bf16_f32 v115, v118, v119
v_accvgpr_read_b32 v104, a8
v_accvgpr_read_b32 v105, a9
v_accvgpr_read_b32 v106, a10
v_accvgpr_read_b32 v107, a11
ds_write_b128 v132, v[112:115] offset:3072
v_accvgpr_read_b32 v108, a24
v_accvgpr_read_b32 v109, a25
v_accvgpr_read_b32 v110, a26
v_accvgpr_read_b32 v111, a27
ds_read_b64_tr_b16 v[36:37], v133 offset:3072
ds_read_b64_tr_b16 v[38:39], v133 offset:3080
v_pk_mul_f32 v[104:105], v[104:105], v[96:97]
v_pk_mul_f32 v[106:107], v[106:107], v[98:99]
v_pk_mul_f32 v[108:109], v[108:109], v[96:97]
v_pk_mul_f32 v[110:111], v[110:111], v[98:99]
s_waitcnt lgkmcnt(3)
buffer_store_dwordx4 v[32:35], v244, s[20:23], s92 offen offset:2048
v_cvt_pk_bf16_f32 v104, v104, v105
v_cvt_pk_bf16_f32 v105, v106, v107
v_cvt_pk_bf16_f32 v106, v108, v109
v_cvt_pk_bf16_f32 v107, v110, v111
v_accvgpr_read_b32 v112, a40
v_accvgpr_read_b32 v113, a41
v_accvgpr_read_b32 v114, a42
v_accvgpr_read_b32 v115, a43
ds_write_b128 v132, v[104:107] offset:0
v_accvgpr_read_b32 v116, a56
v_accvgpr_read_b32 v117, a57
v_accvgpr_read_b32 v118, a58
v_accvgpr_read_b32 v119, a59
ds_read_b64_tr_b16 v[40:41], v133 offset:0
ds_read_b64_tr_b16 v[42:43], v133 offset:8
v_pk_mul_f32 v[112:113], v[112:113], v[96:97]
v_pk_mul_f32 v[114:115], v[114:115], v[98:99]
v_pk_mul_f32 v[116:117], v[116:117], v[96:97]
v_pk_mul_f32 v[118:119], v[118:119], v[98:99]
s_waitcnt lgkmcnt(3)
buffer_store_dwordx4 v[36:39], v244, s[20:23], s92 offen offset:3072
v_cvt_pk_bf16_f32 v112, v112, v113
v_cvt_pk_bf16_f32 v113, v114, v115
v_cvt_pk_bf16_f32 v114, v116, v117
v_cvt_pk_bf16_f32 v115, v118, v119
v_accvgpr_read_b32 v104, a72
v_accvgpr_read_b32 v105, a73
v_accvgpr_read_b32 v106, a74
v_accvgpr_read_b32 v107, a75
ds_write_b128 v132, v[112:115] offset:1024
v_accvgpr_read_b32 v108, a88
v_accvgpr_read_b32 v109, a89
v_accvgpr_read_b32 v110, a90
v_accvgpr_read_b32 v111, a91
ds_read_b64_tr_b16 v[44:45], v133 offset:1024
ds_read_b64_tr_b16 v[46:47], v133 offset:1032
v_pk_mul_f32 v[104:105], v[104:105], v[96:97]
v_pk_mul_f32 v[106:107], v[106:107], v[98:99]
v_pk_mul_f32 v[108:109], v[108:109], v[96:97]
v_pk_mul_f32 v[110:111], v[110:111], v[98:99]
s_waitcnt lgkmcnt(3)
buffer_store_dwordx4 v[40:43], v244, s[20:23], s93 offen offset:0
v_cvt_pk_bf16_f32 v104, v104, v105
v_cvt_pk_bf16_f32 v105, v106, v107
v_cvt_pk_bf16_f32 v106, v108, v109
v_cvt_pk_bf16_f32 v107, v110, v111
v_accvgpr_read_b32 v112, a104
v_accvgpr_read_b32 v113, a105
v_accvgpr_read_b32 v114, a106
v_accvgpr_read_b32 v115, a107
ds_write_b128 v132, v[104:107] offset:2048
v_accvgpr_read_b32 v116, a120
v_accvgpr_read_b32 v117, a121
v_accvgpr_read_b32 v118, a122
v_accvgpr_read_b32 v119, a123
ds_read_b64_tr_b16 v[48:49], v133 offset:2048
ds_read_b64_tr_b16 v[50:51], v133 offset:2056
v_pk_mul_f32 v[112:113], v[112:113], v[96:97]
v_pk_mul_f32 v[114:115], v[114:115], v[98:99]
v_pk_mul_f32 v[116:117], v[116:117], v[96:97]
v_pk_mul_f32 v[118:119], v[118:119], v[98:99]
s_waitcnt lgkmcnt(3)
buffer_store_dwordx4 v[44:47], v244, s[20:23], s93 offen offset:1024
v_cvt_pk_bf16_f32 v112, v112, v113
v_cvt_pk_bf16_f32 v113, v114, v115
v_cvt_pk_bf16_f32 v114, v116, v117
v_cvt_pk_bf16_f32 v115, v118, v119
v_accvgpr_read_b32 v104, a12
v_accvgpr_read_b32 v105, a13
v_accvgpr_read_b32 v106, a14
v_accvgpr_read_b32 v107, a15
ds_write_b128 v132, v[112:115] offset:3072
v_accvgpr_read_b32 v108, a28
v_accvgpr_read_b32 v109, a29
v_accvgpr_read_b32 v110, a30
v_accvgpr_read_b32 v111, a31
ds_read_b64_tr_b16 v[52:53], v133 offset:3072
ds_read_b64_tr_b16 v[54:55], v133 offset:3080
v_pk_mul_f32 v[104:105], v[104:105], v[100:101]
v_pk_mul_f32 v[106:107], v[106:107], v[102:103]
v_pk_mul_f32 v[108:109], v[108:109], v[100:101]
v_pk_mul_f32 v[110:111], v[110:111], v[102:103]
s_waitcnt lgkmcnt(3)
buffer_store_dwordx4 v[48:51], v244, s[20:23], s93 offen offset:2048
v_cvt_pk_bf16_f32 v104, v104, v105
v_cvt_pk_bf16_f32 v105, v106, v107
v_cvt_pk_bf16_f32 v106, v108, v109
v_cvt_pk_bf16_f32 v107, v110, v111
v_accvgpr_read_b32 v112, a44
v_accvgpr_read_b32 v113, a45
v_accvgpr_read_b32 v114, a46
v_accvgpr_read_b32 v115, a47
ds_write_b128 v132, v[104:107] offset:0
v_accvgpr_read_b32 v116, a60
v_accvgpr_read_b32 v117, a61
v_accvgpr_read_b32 v118, a62
v_accvgpr_read_b32 v119, a63
ds_read_b64_tr_b16 v[56:57], v133 offset:0
ds_read_b64_tr_b16 v[58:59], v133 offset:8
v_pk_mul_f32 v[112:113], v[112:113], v[100:101]
v_pk_mul_f32 v[114:115], v[114:115], v[102:103]
v_pk_mul_f32 v[116:117], v[116:117], v[100:101]
v_pk_mul_f32 v[118:119], v[118:119], v[102:103]
s_waitcnt lgkmcnt(3)
buffer_store_dwordx4 v[52:55], v244, s[20:23], s93 offen offset:3072
v_cvt_pk_bf16_f32 v112, v112, v113
v_cvt_pk_bf16_f32 v113, v114, v115
v_cvt_pk_bf16_f32 v114, v116, v117
v_cvt_pk_bf16_f32 v115, v118, v119
v_accvgpr_read_b32 v104, a76
v_accvgpr_read_b32 v105, a77
v_accvgpr_read_b32 v106, a78
v_accvgpr_read_b32 v107, a79
ds_write_b128 v132, v[112:115] offset:1024
v_accvgpr_read_b32 v108, a92
v_accvgpr_read_b32 v109, a93
v_accvgpr_read_b32 v110, a94
v_accvgpr_read_b32 v111, a95
ds_read_b64_tr_b16 v[60:61], v133 offset:1024
ds_read_b64_tr_b16 v[62:63], v133 offset:1032
v_pk_mul_f32 v[104:105], v[104:105], v[100:101]
v_pk_mul_f32 v[106:107], v[106:107], v[102:103]
v_pk_mul_f32 v[108:109], v[108:109], v[100:101]
v_pk_mul_f32 v[110:111], v[110:111], v[102:103]
s_waitcnt lgkmcnt(3)
buffer_store_dwordx4 v[56:59], v244, s[20:23], s51 offen offset:0
v_cvt_pk_bf16_f32 v104, v104, v105
v_cvt_pk_bf16_f32 v105, v106, v107
v_cvt_pk_bf16_f32 v106, v108, v109
v_cvt_pk_bf16_f32 v107, v110, v111
v_accvgpr_read_b32 v112, a108
v_accvgpr_read_b32 v113, a109
v_accvgpr_read_b32 v114, a110
v_accvgpr_read_b32 v115, a111
ds_write_b128 v132, v[104:107] offset:2048
v_accvgpr_read_b32 v116, a124
v_accvgpr_read_b32 v117, a125
v_accvgpr_read_b32 v118, a126
v_accvgpr_read_b32 v119, a127
ds_read_b64_tr_b16 v[64:65], v133 offset:2048
ds_read_b64_tr_b16 v[66:67], v133 offset:2056
v_pk_mul_f32 v[112:113], v[112:113], v[100:101]
v_pk_mul_f32 v[114:115], v[114:115], v[102:103]
v_pk_mul_f32 v[116:117], v[116:117], v[100:101]
v_pk_mul_f32 v[118:119], v[118:119], v[102:103]
s_waitcnt lgkmcnt(3)
buffer_store_dwordx4 v[60:63], v244, s[20:23], s51 offen offset:1024
v_cvt_pk_bf16_f32 v112, v112, v113
v_cvt_pk_bf16_f32 v113, v114, v115
v_cvt_pk_bf16_f32 v114, v116, v117
v_cvt_pk_bf16_f32 v115, v118, v119
ds_write_b128 v132, v[112:115] offset:3072
ds_read_b64_tr_b16 v[68:69], v133 offset:3072
ds_read_b64_tr_b16 v[70:71], v133 offset:3080
s_waitcnt lgkmcnt(3)
buffer_store_dwordx4 v[64:67], v244, s[20:23], s51 offen offset:2048
v_max3_f32 v104, v120, v121, v122
v_max_f32 v104, v104, v123
v_add_f32 v105, v120, v121
v_add_f32 v105, v105, v122
v_add_f32 v105, v105, v123
v_cmp_nge_f32 vcc, s42, v104
v_cmp_u_f32 s[28:29], v105, v105
s_or_b64 vcc, vcc, s[28:29]
s_cmp_lg_u64 vcc, 0
s_cselect_b32 s28, 1, 0
v_mov_b32 v104, s28
v_mov_b32 v106, 147456
s_waitcnt lgkmcnt(0)
buffer_store_dwordx4 v[68:71], v244, s[20:23], s51 offen offset:3072
ds_write_b32 v134, v104
s_waitcnt vmcnt(16) lgkmcnt(0)
s_barrier
ds_read2st64_b32 v[110:111], v106 offset0:32 offset1:48
ds_read2st64_b32 v[108:109], v106 offset0:0 offset1:16
ds_read_b64_tr_b16 a[64:65], v237 offset:0
ds_read_b64_tr_b16 a[66:67], v237 offset:4608
ds_read_b64_tr_b16 a[68:69], v237 offset:9216
ds_read_b64_tr_b16 a[70:71], v237 offset:13824
ds_read_b64_tr_b16 a[72:73], v237 offset:8
ds_read_b64_tr_b16 a[74:75], v237 offset:4616
ds_read_b64_tr_b16 a[76:77], v237 offset:9224
ds_read_b64_tr_b16 a[78:79], v237 offset:13832
ds_read_b64_tr_b16 a[80:81], v238 offset:0
ds_read_b64_tr_b16 a[82:83], v238 offset:4608
ds_read_b64_tr_b16 a[84:85], v238 offset:9216
ds_read_b64_tr_b16 a[86:87], v238 offset:13824
s_waitcnt lgkmcnt(12)
v_or_b32 v108, v108, v109
v_or3_b32 v108, v108, v110, v111
s_nop 0
v_readfirstlane_b32 s28, v108
s_cmp_gt_u32 s28, s43
s_cbranch_scc1 K_FALLBACK
s_waitcnt lgkmcnt(8)
v_mfma_f32_16x16x32_bf16 v[96:99], a[64:67], v[56:59], 0
ds_read_b64_tr_b16 a[88:89], v238 offset:8
ds_read_b64_tr_b16 a[90:91], v238 offset:4616
v_mfma_f32_16x16x32_bf16 v[96:99], a[68:71], v[60:63], v[96:99]
s_lshr_b32 s32, s35, 2
s_and_b32 s33, s35, 3
v_mfma_f32_16x16x32_bf16 v[88:91], a[68:71], v[44:47], 0
s_lshl_b32 s94, s36, 9
s_lshl_b32 s28, s32, 6
v_mfma_f32_16x16x32_bf16 v[88:91], a[64:67], v[40:43], v[88:91]
s_lshr_b32 s34, s32, 2
v_mfma_f32_16x16x32_bf16 v[80:83], a[64:67], v[24:27], 0
ds_read_b64_tr_b16 a[92:93], v238 offset:9224
ds_read_b64_tr_b16 a[94:95], v238 offset:13832
v_mfma_f32_16x16x32_bf16 v[80:83], a[68:71], v[28:31], v[80:83]
s_add_u32 s94, s94, s28
s_lshl_b32 s28, s37, 4
v_mfma_f32_16x16x32_bf16 v[72:75], a[68:71], v[12:15], 0
s_add_u32 s94, s94, s28
s_add_u32 s94, s94, 0x248000
v_mfma_f32_16x16x32_bf16 v[72:75], a[64:67], v[8:11], v[72:75]
v_mov_b32 v231, 1
v_and_b32 v229, 7, v1
s_waitcnt lgkmcnt(8)
v_mfma_f32_16x16x32_bf16 v[76:79], a[72:75], v[8:11], 0
ds_read_b64_tr_b16 a[64:65], v237 offset:128
ds_read_b64_tr_b16 a[66:67], v237 offset:4736
v_mfma_f32_16x16x32_bf16 v[76:79], a[76:79], v[12:15], v[76:79]
v_lshlrev_b32 v229, 2, v229
v_lshlrev_b32 v226, 3, v1
v_mfma_f32_16x16x32_bf16 v[84:87], a[76:79], v[28:31], 0
s_lshl2_add_u32 s29, s33, s94
v_mfma_f32_16x16x32_bf16 v[84:87], a[72:75], v[24:27], v[84:87]
v_mfma_f32_16x16x32_bf16 v[92:95], a[72:75], v[40:43], 0
ds_read_b64_tr_b16 a[68:69], v237 offset:9344
ds_read_b64_tr_b16 a[70:71], v237 offset:13952
v_mfma_f32_16x16x32_bf16 v[92:95], a[76:79], v[44:47], v[92:95]
v_mfma_f32_16x16x32_bf16 v[100:103], a[76:79], v[60:63], 0
v_mfma_f32_16x16x32_bf16 v[100:103], a[72:75], v[56:59], v[100:103]
s_waitcnt lgkmcnt(8)
v_mfma_f32_16x16x32_bf16 v[128:131], a[80:83], v[56:59], 0
ds_read_b64_tr_b16 a[72:73], v237 offset:136
ds_read_b64_tr_b16 a[74:75], v237 offset:4744
v_mfma_f32_16x16x32_bf16 v[128:131], a[84:87], v[60:63], v[128:131]
v_mfma_f32_16x16x32_bf16 v[120:123], a[84:87], v[44:47], 0
v_mfma_f32_16x16x32_bf16 v[120:123], a[80:83], v[40:43], v[120:123]
v_mfma_f32_16x16x32_bf16 v[112:115], a[80:83], v[24:27], 0
ds_read_b64_tr_b16 a[76:77], v237 offset:9352
ds_read_b64_tr_b16 a[78:79], v237 offset:13960
v_mfma_f32_16x16x32_bf16 v[112:115], a[84:87], v[28:31], v[112:115]
s_waitcnt vmcnt(0)
buffer_store_dword v231, v254, s[20:23], s29 offen
v_mfma_f32_16x16x32_bf16 v[104:107], a[84:87], v[12:15], 0
s_add_u32 s28, s35, 1
s_and_b32 s28, s28, 3
v_mfma_f32_16x16x32_bf16 v[104:107], a[80:83], v[8:11], v[104:107]
s_mul_i32 s28, s28, 36864
s_waitcnt lgkmcnt(8)
v_mfma_f32_16x16x32_bf16 v[108:111], a[88:91], v[8:11], 0
ds_read_b64_tr_b16 a[80:81], v238 offset:128
ds_read_b64_tr_b16 a[82:83], v238 offset:4736
v_mfma_f32_16x16x32_bf16 v[108:111], a[92:95], v[12:15], v[108:111]
v_add_u32 v216, s28, v234
v_add_u32 v217, s28, v235
v_mfma_f32_16x16x32_bf16 v[116:119], a[92:95], v[28:31], 0
v_add_u32 v218, s28, v236
v_mfma_f32_16x16x32_bf16 v[116:119], a[88:91], v[24:27], v[116:119]
v_mfma_f32_16x16x32_bf16 v[124:127], a[88:91], v[40:43], 0
ds_read_b64_tr_b16 a[84:85], v238 offset:9344
ds_read_b64_tr_b16 a[86:87], v238 offset:13952
v_mfma_f32_16x16x32_bf16 v[124:127], a[92:95], v[44:47], v[124:127]
v_mfma_f32_16x16x32_bf16 v[132:135], a[92:95], v[60:63], 0
v_mfma_f32_16x16x32_bf16 v[132:135], a[88:91], v[56:59], v[132:135]
s_waitcnt lgkmcnt(8)
v_mfma_f32_16x16x32_bf16 v[160:163], a[64:67], v[56:59], 0
ds_read_b64_tr_b16 a[88:89], v238 offset:136
ds_read_b64_tr_b16 a[90:91], v238 offset:4744
v_mfma_f32_16x16x32_bf16 v[160:163], a[68:71], v[60:63], v[160:163]
v_mfma_f32_16x16x32_bf16 v[152:155], a[68:71], v[44:47], 0
v_mfma_f32_16x16x32_bf16 v[152:155], a[64:67], v[40:43], v[152:155]
v_mfma_f32_16x16x32_bf16 v[144:147], a[64:67], v[24:27], 0
ds_read_b64_tr_b16 a[92:93], v238 offset:9352
ds_read_b64_tr_b16 a[94:95], v238 offset:13960
v_mfma_f32_16x16x32_bf16 v[144:147], a[68:71], v[28:31], v[144:147]
v_mfma_f32_16x16x32_bf16 v[136:139], a[68:71], v[12:15], 0
v_mfma_f32_16x16x32_bf16 v[136:139], a[64:67], v[8:11], v[136:139]
s_waitcnt lgkmcnt(8)
v_mfma_f32_16x16x32_bf16 v[140:143], a[72:75], v[8:11], 0
ds_read_b64_tr_b16 a[64:65], v239 offset:0
ds_read_b64_tr_b16 a[66:67], v239 offset:4608
v_mfma_f32_16x16x32_bf16 v[140:143], a[76:79], v[12:15], v[140:143]
buffer_load_dword v230, v229, s[20:23], s94 offen sc0 sc1
v_mfma_f32_16x16x32_bf16 v[148:151], a[76:79], v[28:31], 0
s_add_u32 s39, s35, 1
s_and_b32 s39, s39, 3
v_mfma_f32_16x16x32_bf16 v[148:151], a[72:75], v[24:27], v[148:151]
s_add_u32 s28, s33, 1
s_and_b32 s28, s28, 3
v_mfma_f32_16x16x32_bf16 v[156:159], a[72:75], v[40:43], 0
ds_read_b64_tr_b16 a[68:69], v239 offset:9216
ds_read_b64_tr_b16 a[70:71], v239 offset:13824
v_mfma_f32_16x16x32_bf16 v[156:159], a[76:79], v[44:47], v[156:159]
s_sub_u32 s28, s28, s33
s_lshl_b32 s28, s28, 16
v_mfma_f32_16x16x32_bf16 v[164:167], a[76:79], v[60:63], 0
s_add_u32 s64, s28, s44
s_add_u32 s65, s64, 4096
v_mfma_f32_16x16x32_bf16 v[164:167], a[72:75], v[56:59], v[164:167]
s_add_u32 s66, s64, 8192
s_add_u32 s67, s64, 12288
s_waitcnt lgkmcnt(8)
v_mfma_f32_16x16x32_bf16 v[192:195], a[80:83], v[56:59], 0
ds_read_b64_tr_b16 a[72:73], v237 offset:18432
ds_read_b64_tr_b16 a[74:75], v237 offset:23040
v_mfma_f32_16x16x32_bf16 v[192:195], a[84:87], v[60:63], v[192:195]
s_add_u32 s28, s35, 2
s_and_b32 s28, s28, 3
v_mfma_f32_16x16x32_bf16 v[184:187], a[84:87], v[44:47], 0
s_mul_i32 s28, s28, 36864
v_mfma_f32_16x16x32_bf16 v[184:187], a[80:83], v[40:43], v[184:187]
v_add_u32 v219, s28, v234
v_add_u32 v220, s28, v235
v_mfma_f32_16x16x32_bf16 v[176:179], a[80:83], v[24:27], 0
ds_read_b64_tr_b16 a[76:77], v237 offset:27648
ds_read_b64_tr_b16 a[78:79], v237 offset:32256
v_mfma_f32_16x16x32_bf16 v[176:179], a[84:87], v[28:31], v[176:179]
v_add_u32 v221, s28, v236
v_mfma_f32_16x16x32_bf16 v[168:171], a[84:87], v[12:15], 0
s_add_u32 s28, s35, 3
s_and_b32 s28, s28, 3
v_mfma_f32_16x16x32_bf16 v[168:171], a[80:83], v[8:11], v[168:171]
s_mul_i32 s28, s28, 36864
s_waitcnt lgkmcnt(8)
v_mfma_f32_16x16x32_bf16 v[172:175], a[88:91], v[8:11], 0
ds_read_b64_tr_b16 a[80:81], v237 offset:18440
ds_read_b64_tr_b16 a[82:83], v237 offset:23048
v_mfma_f32_16x16x32_bf16 v[172:175], a[92:95], v[12:15], v[172:175]
v_add_u32 v222, s28, v234
v_add_u32 v223, s28, v235
v_mfma_f32_16x16x32_bf16 v[180:183], a[92:95], v[28:31], 0
v_add_u32 v224, s28, v236
v_mfma_f32_16x16x32_bf16 v[180:183], a[88:91], v[24:27], v[180:183]
v_mfma_f32_16x16x32_bf16 v[188:191], a[88:91], v[40:43], 0
ds_read_b64_tr_b16 a[84:85], v237 offset:27656
ds_read_b64_tr_b16 a[86:87], v237 offset:32264
v_mfma_f32_16x16x32_bf16 v[188:191], a[92:95], v[44:47], v[188:191]
v_mfma_f32_16x16x32_bf16 v[196:199], a[92:95], v[60:63], 0
s_waitcnt vmcnt(0)
v_cmp_gt_u32 vcc, 1, v230
v_mfma_f32_16x16x32_bf16 v[196:199], a[88:91], v[56:59], v[196:199]
s_waitcnt lgkmcnt(8)
v_mfma_f32_16x16x32_bf16 v[212:215], a[64:67], v[56:59], 0
ds_read_b64_tr_b16 a[88:89], v238 offset:18432
ds_read_b64_tr_b16 a[90:91], v238 offset:23040
v_mfma_f32_16x16x32_bf16 v[212:215], a[68:71], v[60:63], v[212:215]
s_bitcmp1_b32 vcc_lo, s39
s_cbranch_scc1 SP_O1A
SP_O1A_RET:
v_mfma_f32_16x16x32_bf16 v[208:211], a[68:71], v[44:47], 0
buffer_load_dwordx4 a[156:159], v244, s[20:23], s64 offen offset:0 sc0 sc1
v_mfma_f32_16x16x32_bf16 v[208:211], a[64:67], v[40:43], v[208:211]
v_mfma_f32_16x16x32_bf16 v[204:207], a[64:67], v[24:27], 0
ds_read_b64_tr_b16 a[92:93], v238 offset:27648
ds_read_b64_tr_b16 a[94:95], v238 offset:32256
v_mfma_f32_16x16x32_bf16 v[204:207], a[68:71], v[28:31], v[204:207]
v_mfma_f32_16x16x32_bf16 v[200:203], a[68:71], v[12:15], 0
buffer_load_dwordx4 a[172:175], v244, s[20:23], s65 offen offset:0 sc0 sc1
v_mfma_f32_16x16x32_bf16 v[200:203], a[64:67], v[8:11], v[200:203]
s_waitcnt lgkmcnt(8)
v_mfma_f32_16x16x32_bf16 v[72:75], a[72:75], v[16:19], v[72:75]
ds_read_b64_tr_b16 a[64:65], v238 offset:18440
ds_read_b64_tr_b16 a[66:67], v238 offset:23048
v_mfma_f32_16x16x32_bf16 v[72:75], a[76:79], v[20:23], v[72:75]
v_mfma_f32_16x16x32_bf16 v[80:83], a[76:79], v[36:39], v[80:83]
buffer_load_dwordx4 a[188:191], v244, s[20:23], s66 offen offset:0 sc0 sc1
v_mfma_f32_16x16x32_bf16 v[80:83], a[72:75], v[32:35], v[80:83]
v_mfma_f32_16x16x32_bf16 v[88:91], a[72:75], v[48:51], v[88:91]
ds_read_b64_tr_b16 a[68:69], v238 offset:27656
ds_read_b64_tr_b16 a[70:71], v238 offset:32264
v_mfma_f32_16x16x32_bf16 v[88:91], a[76:79], v[52:55], v[88:91]
v_mfma_f32_16x16x32_bf16 v[96:99], a[76:79], v[68:71], v[96:99]
buffer_load_dwordx4 a[204:207], v244, s[20:23], s67 offen offset:0 sc0 sc1
v_mfma_f32_16x16x32_bf16 v[96:99], a[72:75], v[64:67], v[96:99]
s_waitcnt lgkmcnt(8)
v_mfma_f32_16x16x32_bf16 v[100:103], a[80:83], v[64:67], v[100:103]
ds_read_b64_tr_b16 a[72:73], v237 offset:18560
ds_read_b64_tr_b16 a[74:75], v237 offset:23168
v_mfma_f32_16x16x32_bf16 v[100:103], a[84:87], v[68:71], v[100:103]
v_mfma_f32_16x16x32_bf16 v[92:95], a[84:87], v[52:55], v[92:95]
buffer_load_dwordx4 a[160:163], v244, s[20:23], s64 offen offset:1024 sc0 sc1
v_mfma_f32_16x16x32_bf16 v[92:95], a[80:83], v[48:51], v[92:95]
v_mfma_f32_16x16x32_bf16 v[84:87], a[80:83], v[32:35], v[84:87]
ds_read_b64_tr_b16 a[76:77], v237 offset:27776
ds_read_b64_tr_b16 a[78:79], v237 offset:32384
v_mfma_f32_16x16x32_bf16 v[84:87], a[84:87], v[36:39], v[84:87]
v_mfma_f32_16x16x32_bf16 v[76:79], a[84:87], v[20:23], v[76:79]
buffer_load_dwordx4 a[176:179], v244, s[20:23], s65 offen offset:1024 sc0 sc1
v_mfma_f32_16x16x32_bf16 v[76:79], a[80:83], v[16:19], v[76:79]
s_waitcnt lgkmcnt(8)
v_mfma_f32_16x16x32_bf16 v[104:107], a[88:91], v[16:19], v[104:107]
ds_read_b64_tr_b16 a[80:81], v237 offset:18568
ds_read_b64_tr_b16 a[82:83], v237 offset:23176
v_mfma_f32_16x16x32_bf16 v[104:107], a[92:95], v[20:23], v[104:107]
v_mfma_f32_16x16x32_bf16 v[112:115], a[92:95], v[36:39], v[112:115]
buffer_load_dwordx4 a[192:195], v244, s[20:23], s66 offen offset:1024 sc0 sc1
v_mfma_f32_16x16x32_bf16 v[112:115], a[88:91], v[32:35], v[112:115]
v_mfma_f32_16x16x32_bf16 v[120:123], a[88:91], v[48:51], v[120:123]
ds_read_b64_tr_b16 a[84:85], v237 offset:27784
ds_read_b64_tr_b16 a[86:87], v237 offset:32392
v_mfma_f32_16x16x32_bf16 v[120:123], a[92:95], v[52:55], v[120:123]
v_mfma_f32_16x16x32_bf16 v[128:131], a[92:95], v[68:71], v[128:131]
buffer_load_dwordx4 a[208:211], v244, s[20:23], s67 offen offset:1024 sc0 sc1
v_mfma_f32_16x16x32_bf16 v[128:131], a[88:91], v[64:67], v[128:131]
s_waitcnt lgkmcnt(8)
v_mfma_f32_16x16x32_bf16 v[132:135], a[64:67], v[64:67], v[132:135]
ds_read_b64_tr_b16 a[88:89], v238 offset:18560
ds_read_b64_tr_b16 a[90:91], v238 offset:23168
v_mfma_f32_16x16x32_bf16 v[132:135], a[68:71], v[68:71], v[132:135]
v_mfma_f32_16x16x32_bf16 v[124:127], a[68:71], v[52:55], v[124:127]
buffer_load_dwordx4 a[164:167], v244, s[20:23], s64 offen offset:2048 sc0 sc1
v_mfma_f32_16x16x32_bf16 v[124:127], a[64:67], v[48:51], v[124:127]
buffer_load_dword v230, v229, s[20:23], s94 offen sc0 sc1
v_mfma_f32_16x16x32_bf16 v[116:119], a[64:67], v[32:35], v[116:119]
ds_read_b64_tr_b16 a[92:93], v238 offset:27776
ds_read_b64_tr_b16 a[94:95], v238 offset:32384
v_mfma_f32_16x16x32_bf16 v[116:119], a[68:71], v[36:39], v[116:119]
v_mfma_f32_16x16x32_bf16 v[108:111], a[68:71], v[20:23], v[108:111]
v_mfma_f32_16x16x32_bf16 v[108:111], a[64:67], v[16:19], v[108:111]
buffer_load_dwordx4 a[180:183], v244, s[20:23], s65 offen offset:2048 sc0 sc1
s_waitcnt lgkmcnt(8)
v_mfma_f32_16x16x32_bf16 v[136:139], a[72:75], v[16:19], v[136:139]
ds_read_b64_tr_b16 a[64:65], v238 offset:18568
ds_read_b64_tr_b16 a[66:67], v238 offset:23176
v_mfma_f32_16x16x32_bf16 v[136:139], a[76:79], v[20:23], v[136:139]
v_mfma_f32_16x16x32_bf16 v[144:147], a[76:79], v[36:39], v[144:147]
v_mfma_f32_16x16x32_bf16 v[144:147], a[72:75], v[32:35], v[144:147]
buffer_load_dwordx4 a[196:199], v244, s[20:23], s66 offen offset:2048 sc0 sc1
v_mfma_f32_16x16x32_bf16 v[152:155], a[72:75], v[48:51], v[152:155]
ds_read_b64_tr_b16 a[68:69], v238 offset:27784
ds_read_b64_tr_b16 a[70:71], v238 offset:32392
v_mfma_f32_16x16x32_bf16 v[152:155], a[76:79], v[52:55], v[152:155]
v_mfma_f32_16x16x32_bf16 v[160:163], a[76:79], v[68:71], v[160:163]
v_mfma_f32_16x16x32_bf16 v[160:163], a[72:75], v[64:67], v[160:163]
buffer_load_dwordx4 a[212:215], v244, s[20:23], s67 offen offset:2048 sc0 sc1
s_waitcnt lgkmcnt(8)
v_mfma_f32_16x16x32_bf16 v[164:167], a[80:83], v[64:67], v[164:167]
ds_read_b64_tr_b16 a[72:73], v239 offset:18432
ds_read_b64_tr_b16 a[74:75], v239 offset:23040
v_mfma_f32_16x16x32_bf16 v[164:167], a[84:87], v[68:71], v[164:167]
v_mfma_f32_16x16x32_bf16 v[156:159], a[84:87], v[52:55], v[156:159]
v_mfma_f32_16x16x32_bf16 v[156:159], a[80:83], v[48:51], v[156:159]
buffer_load_dwordx4 a[168:171], v244, s[20:23], s64 offen offset:3072 sc0 sc1
v_mfma_f32_16x16x32_bf16 v[148:151], a[80:83], v[32:35], v[148:151]
ds_read_b64_tr_b16 a[76:77], v239 offset:27648
ds_read_b64_tr_b16 a[78:79], v239 offset:32256
v_mfma_f32_16x16x32_bf16 v[148:151], a[84:87], v[36:39], v[148:151]
v_mfma_f32_16x16x32_bf16 v[140:143], a[84:87], v[20:23], v[140:143]
v_mfma_f32_16x16x32_bf16 v[140:143], a[80:83], v[16:19], v[140:143]
buffer_load_dwordx4 a[184:187], v244, s[20:23], s65 offen offset:3072 sc0 sc1
s_waitcnt lgkmcnt(8)
v_mfma_f32_16x16x32_bf16 v[168:171], a[88:91], v[16:19], v[168:171]
ds_read_b64_tr_b16 a[80:81], v216 offset:0
ds_read_b64_tr_b16 a[82:83], v216 offset:4608
v_mfma_f32_16x16x32_bf16 v[168:171], a[92:95], v[20:23], v[168:171]
v_mfma_f32_16x16x32_bf16 v[176:179], a[92:95], v[36:39], v[176:179]
v_mfma_f32_16x16x32_bf16 v[176:179], a[88:91], v[32:35], v[176:179]
buffer_load_dwordx4 a[200:203], v244, s[20:23], s66 offen offset:3072 sc0 sc1
v_mfma_f32_16x16x32_bf16 v[184:187], a[88:91], v[48:51], v[184:187]
ds_read_b64_tr_b16 a[84:85], v216 offset:9216
ds_read_b64_tr_b16 a[86:87], v216 offset:13824
v_mfma_f32_16x16x32_bf16 v[184:187], a[92:95], v[52:55], v[184:187]
v_mfma_f32_16x16x32_bf16 v[192:195], a[92:95], v[68:71], v[192:195]
v_mfma_f32_16x16x32_bf16 v[192:195], a[88:91], v[64:67], v[192:195]
buffer_load_dwordx4 a[216:219], v244, s[20:23], s67 offen offset:3072 sc0 sc1
s_waitcnt lgkmcnt(8)
v_mfma_f32_16x16x32_bf16 v[196:199], a[64:67], v[64:67], v[196:199]
ds_read_b64_tr_b16 a[88:89], v216 offset:8
ds_read_b64_tr_b16 a[90:91], v216 offset:4616
v_mfma_f32_16x16x32_bf16 v[196:199], a[68:71], v[68:71], v[196:199]
s_add_u32 s28, s33, 2
s_and_b32 s28, s28, 3
v_mfma_f32_16x16x32_bf16 v[188:191], a[68:71], v[52:55], v[188:191]
s_sub_u32 s28, s28, s33
s_lshl_b32 s28, s28, 16
v_mfma_f32_16x16x32_bf16 v[188:191], a[64:67], v[48:51], v[188:191]
s_add_u32 s64, s28, s44
s_add_u32 s65, s64, 4096
v_mfma_f32_16x16x32_bf16 v[180:183], a[64:67], v[32:35], v[180:183]
ds_read_b64_tr_b16 a[92:93], v216 offset:9224
ds_read_b64_tr_b16 a[94:95], v216 offset:13832
v_mfma_f32_16x16x32_bf16 v[180:183], a[68:71], v[36:39], v[180:183]
s_add_u32 s66, s64, 8192
s_add_u32 s67, s64, 12288
v_mfma_f32_16x16x32_bf16 v[172:175], a[68:71], v[20:23], v[172:175]
s_waitcnt vmcnt(7)
v_cmp_gt_u32 vcc, 1, v230
v_mfma_f32_16x16x32_bf16 v[172:175], a[64:67], v[16:19], v[172:175]
s_waitcnt lgkmcnt(8)
v_mfma_f32_16x16x32_bf16 v[200:203], a[72:75], v[16:19], v[200:203]
ds_read_b64_tr_b16 a[64:65], v217 offset:0
ds_read_b64_tr_b16 a[66:67], v217 offset:4608
STUB_14:
STUB_B2:
s_cbranch_execz STUB_17
v_mfma_f32_16x16x32_bf16 v[200:203], a[76:79], v[20:23], v[200:203]
s_and_b32 s29, vcc_lo, 15
s_cbranch_scc1 SP_O2A
SP_O2A_RET:
v_mfma_f32_16x16x32_bf16 v[204:207], a[76:79], v[36:39], v[204:207]
buffer_load_dwordx4 a[220:223], v244, s[20:23], s64 offen offset:0 sc0 sc1
v_mfma_f32_16x16x32_bf16 v[204:207], a[72:75], v[32:35], v[204:207]
v_mfma_f32_16x16x32_bf16 v[208:211], a[72:75], v[48:51], v[208:211]
ds_read_b64_tr_b16 a[68:69], v217 offset:9216
ds_read_b64_tr_b16 a[70:71], v217 offset:13824
v_mfma_f32_16x16x32_bf16 v[208:211], a[76:79], v[52:55], v[208:211]
v_mfma_f32_16x16x32_bf16 v[212:215], a[76:79], v[68:71], v[212:215]
buffer_load_dwordx4 a[236:239], v244, s[20:23], s65 offen offset:0 sc0 sc1
v_mfma_f32_16x16x32_bf16 v[212:215], a[72:75], v[64:67], v[212:215]
s_waitcnt vmcnt(15)
s_waitcnt lgkmcnt(8)
v_mfma_f32_16x16x32_bf16 v[96:99], a[80:83], a[204:207], v[96:99]
ds_read_b64_tr_b16 a[72:73], v217 offset:8
ds_read_b64_tr_b16 a[74:75], v217 offset:4616
s_waitcnt vmcnt(11)
v_mfma_f32_16x16x32_bf16 v[96:99], a[84:87], a[208:211], v[96:99]
v_mfma_f32_16x16x32_bf16 v[88:91], a[84:87], a[192:195], v[88:91]
buffer_load_dwordx4 a[96:99], v244, s[20:23], s66 offen offset:0 sc0 sc1
v_mfma_f32_16x16x32_bf16 v[88:91], a[80:83], a[188:191], v[88:91]
v_accvgpr_read_b32 v39, a136
v_accvgpr_read_b32 v59, a144
v_mfma_f32_16x16x32_bf16 v[80:83], a[80:83], a[172:175], v[80:83]
ds_read_b64_tr_b16 a[76:77], v217 offset:9224
ds_read_b64_tr_b16 a[78:79], v217 offset:13832
v_mfma_f32_16x16x32_bf16 v[80:83], a[84:87], a[176:179], v[80:83]
v_lshlrev_b32 v38, 16, v39
v_and_b32 v39, 0xffff0000, v39
v_mfma_f32_16x16x32_bf16 v[72:75], a[84:87], a[160:163], v[72:75]
buffer_load_dwordx4 a[112:115], v244, s[20:23], s67 offen offset:0 sc0 sc1
v_mfma_f32_16x16x32_bf16 v[72:75], a[80:83], a[156:159], v[72:75]
v_lshlrev_b32 v58, 16, v59
v_and_b32 v59, 0xffff0000, v59
s_waitcnt lgkmcnt(8)
v_mfma_f32_16x16x32_bf16 v[76:79], a[88:91], a[156:159], v[76:79]
ds_read_b64_tr_b16 a[80:81], v216 offset:128
ds_read_b64_tr_b16 a[82:83], v216 offset:4736
v_mfma_f32_16x16x32_bf16 v[76:79], a[92:95], a[160:163], v[76:79]
v_add_f32 v38, v38, v58
v_add_f32 v39, v39, v59
v_mfma_f32_16x16x32_bf16 v[84:87], a[92:95], a[176:179], v[84:87]
buffer_load_dwordx4 a[224:227], v244, s[20:23], s64 offen offset:1024 sc0 sc1
v_mfma_f32_16x16x32_bf16 v[84:87], a[88:91], a[172:175], v[84:87]
v_cvt_pk_bf16_f32 v58, v38, v39
v_lshlrev_b32 v38, 16, v58
v_mfma_f32_16x16x32_bf16 v[92:95], a[88:91], a[188:191], v[92:95]
ds_read_b64_tr_b16 a[84:85], v216 offset:9344
ds_read_b64_tr_b16 a[86:87], v216 offset:13952
v_mfma_f32_16x16x32_bf16 v[92:95], a[92:95], a[192:195], v[92:95]
v_and_b32 v39, 0xffff0000, v58
v_mul_f32 v58, 0xbfb8aa3b, v38
v_mfma_f32_16x16x32_bf16 v[100:103], a[92:95], a[208:211], v[100:103]
buffer_load_dwordx4 a[240:243], v244, s[20:23], s65 offen offset:1024 sc0 sc1
v_mfma_f32_16x16x32_bf16 v[100:103], a[88:91], a[204:207], v[100:103]
v_mul_f32 v59, 0xbfb8aa3b, v39
s_waitcnt lgkmcnt(8)
v_mfma_f32_16x16x32_bf16 v[128:131], a[64:67], a[204:207], v[128:131]
ds_read_b64_tr_b16 a[88:89], v216 offset:136
ds_read_b64_tr_b16 a[90:91], v216 offset:4744
v_mfma_f32_16x16x32_bf16 v[128:131], a[68:71], a[208:211], v[128:131]
v_exp_f32 v58, v58
v_mfma_f32_16x16x32_bf16 v[120:123], a[68:71], a[192:195], v[120:123]
buffer_load_dwordx4 a[100:103], v244, s[20:23], s66 offen offset:1024 sc0 sc1
v_mfma_f32_16x16x32_bf16 v[120:123], a[64:67], a[188:191], v[120:123]
v_exp_f32 v59, v59
v_mfma_f32_16x16x32_bf16 v[112:115], a[64:67], a[172:175], v[112:115]
ds_read_b64_tr_b16 a[92:93], v216 offset:9352
ds_read_b64_tr_b16 a[94:95], v216 offset:13960
v_mfma_f32_16x16x32_bf16 v[112:115], a[68:71], a[176:179], v[112:115]
v_add_f32 v58, 1.0, v58
v_add_f32 v59, 1.0, v59
v_mfma_f32_16x16x32_bf16 v[104:107], a[68:71], a[160:163], v[104:107]
buffer_load_dwordx4 a[116:119], v244, s[20:23], s67 offen offset:1024 sc0 sc1
v_mfma_f32_16x16x32_bf16 v[104:107], a[64:67], a[156:159], v[104:107]
v_rcp_f32 v58, v58
s_waitcnt lgkmcnt(8)
v_mfma_f32_16x16x32_bf16 v[108:111], a[72:75], a[156:159], v[108:111]
ds_read_b64_tr_b16 a[64:65], v217 offset:128
ds_read_b64_tr_b16 a[66:67], v217 offset:4736
v_mfma_f32_16x16x32_bf16 v[108:111], a[76:79], a[160:163], v[108:111]
v_rcp_f32 v59, v59
v_mfma_f32_16x16x32_bf16 v[116:119], a[76:79], a[176:179], v[116:119]
buffer_load_dwordx4 a[228:231], v244, s[20:23], s64 offen offset:2048 sc0 sc1
v_mfma_f32_16x16x32_bf16 v[116:119], a[72:75], a[172:175], v[116:119]
v_mul_f32 v38, v38, v58
v_mul_f32 v39, v39, v59
v_mfma_f32_16x16x32_bf16 v[124:127], a[72:75], a[188:191], v[124:127]
ds_read_b64_tr_b16 a[68:69], v217 offset:9344
ds_read_b64_tr_b16 a[70:71], v217 offset:13952
v_mfma_f32_16x16x32_bf16 v[124:127], a[76:79], a[192:195], v[124:127]
v_cvt_pk_bf16_f32 v58, v38, v39
v_lshlrev_b32 v38, 16, v58
v_mfma_f32_16x16x32_bf16 v[132:135], a[76:79], a[208:211], v[132:135]
buffer_load_dwordx4 a[128:131], v244, s[20:23], s65 offen offset:2048 sc0 sc1
v_mfma_f32_16x16x32_bf16 v[132:135], a[72:75], a[204:207], v[132:135]
v_and_b32 v39, 0xffff0000, v58
v_accvgpr_read_b32 v41, a137
s_waitcnt lgkmcnt(8)
v_mfma_f32_16x16x32_bf16 v[160:163], a[80:83], a[204:207], v[160:163]
ds_read_b64_tr_b16 a[72:73], v217 offset:136
ds_read_b64_tr_b16 a[74:75], v217 offset:4744
v_mfma_f32_16x16x32_bf16 v[160:163], a[84:87], a[208:211], v[160:163]
v_accvgpr_read_b32 v59, a145
v_lshlrev_b32 v40, 16, v41
v_mfma_f32_16x16x32_bf16 v[152:155], a[84:87], a[192:195], v[152:155]
buffer_load_dwordx4 a[104:107], v244, s[20:23], s66 offen offset:2048 sc0 sc1
v_mfma_f32_16x16x32_bf16 v[152:155], a[80:83], a[188:191], v[152:155]
v_and_b32 v41, 0xffff0000, v41
v_lshlrev_b32 v58, 16, v59
v_mfma_f32_16x16x32_bf16 v[144:147], a[80:83], a[172:175], v[144:147]
ds_read_b64_tr_b16 a[76:77], v217 offset:9352
ds_read_b64_tr_b16 a[78:79], v217 offset:13960
v_mfma_f32_16x16x32_bf16 v[144:147], a[84:87], a[176:179], v[144:147]
v_and_b32 v59, 0xffff0000, v59
v_add_f32 v40, v40, v58
v_mfma_f32_16x16x32_bf16 v[136:139], a[84:87], a[160:163], v[136:139]
buffer_load_dwordx4 a[120:123], v244, s[20:23], s67 offen offset:2048 sc0 sc1
v_mfma_f32_16x16x32_bf16 v[136:139], a[80:83], a[156:159], v[136:139]
v_add_f32 v41, v41, v59
v_cvt_pk_bf16_f32 v58, v40, v41
s_waitcnt lgkmcnt(8)
v_mfma_f32_16x16x32_bf16 v[140:143], a[88:91], a[156:159], v[140:143]
ds_read_b64_tr_b16 a[80:81], v218 offset:0
ds_read_b64_tr_b16 a[82:83], v218 offset:4608
v_mfma_f32_16x16x32_bf16 v[140:143], a[92:95], a[160:163], v[140:143]
v_lshlrev_b32 v40, 16, v58
v_and_b32 v41, 0xffff0000, v58
v_mfma_f32_16x16x32_bf16 v[148:151], a[92:95], a[176:179], v[148:151]
buffer_load_dwordx4 a[232:235], v244, s[20:23], s64 offen offset:3072 sc0 sc1
v_mfma_f32_16x16x32_bf16 v[148:151], a[88:91], a[172:175], v[148:151]
v_mul_f32 v58, 0xbfb8aa3b, v40
v_mul_f32 v59, 0xbfb8aa3b, v41
v_mfma_f32_16x16x32_bf16 v[156:159], a[88:91], a[188:191], v[156:159]
ds_read_b64_tr_b16 a[84:85], v218 offset:9216
ds_read_b64_tr_b16 a[86:87], v218 offset:13824
v_mfma_f32_16x16x32_bf16 v[156:159], a[92:95], a[192:195], v[156:159]
v_exp_f32 v58, v58
v_mfma_f32_16x16x32_bf16 v[164:167], a[92:95], a[208:211], v[164:167]
buffer_load_dwordx4 a[132:135], v244, s[20:23], s65 offen offset:3072 sc0 sc1
v_mfma_f32_16x16x32_bf16 v[164:167], a[88:91], a[204:207], v[164:167]
v_exp_f32 v59, v59
s_waitcnt lgkmcnt(8)
v_mfma_f32_16x16x32_bf16 v[192:195], a[64:67], a[204:207], v[192:195]
ds_read_b64_tr_b16 a[88:89], v216 offset:18432
ds_read_b64_tr_b16 a[90:91], v216 offset:23040
v_mfma_f32_16x16x32_bf16 v[192:195], a[68:71], a[208:211], v[192:195]
v_add_f32 v58, 1.0, v58
v_add_f32 v59, 1.0, v59
v_mfma_f32_16x16x32_bf16 v[184:187], a[68:71], a[192:195], v[184:187]
buffer_load_dwordx4 a[108:111], v244, s[20:23], s66 offen offset:3072 sc0 sc1
v_mfma_f32_16x16x32_bf16 v[184:187], a[64:67], a[188:191], v[184:187]
v_rcp_f32 v58, v58
v_mfma_f32_16x16x32_bf16 v[176:179], a[64:67], a[172:175], v[176:179]
ds_read_b64_tr_b16 a[92:93], v216 offset:27648
ds_read_b64_tr_b16 a[94:95], v216 offset:32256
v_mfma_f32_16x16x32_bf16 v[176:179], a[68:71], a[176:179], v[176:179]
v_rcp_f32 v59, v59
v_mfma_f32_16x16x32_bf16 v[168:171], a[68:71], a[160:163], v[168:171]
buffer_load_dwordx4 a[124:127], v244, s[20:23], s67 offen offset:3072 sc0 sc1
v_mfma_f32_16x16x32_bf16 v[168:171], a[64:67], a[156:159], v[168:171]
s_add_u32 s28, s33, 3
s_and_b32 s28, s28, 3
s_waitcnt lgkmcnt(8)
v_mfma_f32_16x16x32_bf16 v[172:175], a[72:75], a[156:159], v[172:175]
ds_read_b64_tr_b16 a[64:65], v216 offset:18440
ds_read_b64_tr_b16 a[66:67], v216 offset:23048
v_mfma_f32_16x16x32_bf16 v[172:175], a[76:79], a[160:163], v[172:175]
s_sub_u32 s28, s28, s33
s_lshl_b32 s28, s28, 16
v_mfma_f32_16x16x32_bf16 v[180:183], a[76:79], a[176:179], v[180:183]
s_add_u32 s64, s28, s44
s_add_u32 s65, s64, 4096
v_mfma_f32_16x16x32_bf16 v[180:183], a[72:75], a[172:175], v[180:183]
s_add_u32 s66, s64, 8192
s_add_u32 s67, s64, 12288
v_mfma_f32_16x16x32_bf16 v[188:191], a[72:75], a[188:191], v[188:191]
ds_read_b64_tr_b16 a[68:69], v216 offset:27656
ds_read_b64_tr_b16 a[70:71], v216 offset:32264
v_mfma_f32_16x16x32_bf16 v[188:191], a[76:79], a[192:195], v[188:191]
buffer_load_dwordx4 a[0:3], v244, s[20:23], s64 offen offset:0 sc0 sc1
v_mfma_f32_16x16x32_bf16 v[196:199], a[76:79], a[208:211], v[196:199]
v_mul_f32 v40, v40, v58
v_mul_f32 v41, v41, v59
v_mfma_f32_16x16x32_bf16 v[196:199], a[72:75], a[204:207], v[196:199]
v_cvt_pk_bf16_f32 v58, v40, v41
v_lshlrev_b32 v40, 16, v58
s_waitcnt lgkmcnt(8)
v_mfma_f32_16x16x32_bf16 v[212:215], a[80:83], a[204:207], v[212:215]
ds_read_b64_tr_b16 a[72:73], v217 offset:18432
ds_read_b64_tr_b16 a[74:75], v217 offset:23040
v_mfma_f32_16x16x32_bf16 v[212:215], a[84:87], a[208:211], v[212:215]
buffer_load_dwordx4 a[16:19], v244, s[20:23], s65 offen offset:0 sc0 sc1
v_mfma_f32_16x16x32_bf16 v[208:211], a[84:87], a[192:195], v[208:211]
v_and_b32 v41, 0xffff0000, v58
v_accvgpr_read_b32 v43, a138
v_mfma_f32_16x16x32_bf16 v[208:211], a[80:83], a[188:191], v[208:211]
v_accvgpr_read_b32 v59, a146
v_lshlrev_b32 v42, 16, v43
v_mfma_f32_16x16x32_bf16 v[204:207], a[80:83], a[172:175], v[204:207]
ds_read_b64_tr_b16 a[76:77], v217 offset:27648
ds_read_b64_tr_b16 a[78:79], v217 offset:32256
v_mfma_f32_16x16x32_bf16 v[204:207], a[84:87], a[176:179], v[204:207]
buffer_load_dwordx4 a[32:35], v244, s[20:23], s66 offen offset:0 sc0 sc1
v_mfma_f32_16x16x32_bf16 v[200:203], a[84:87], a[160:163], v[200:203]
v_and_b32 v43, 0xffff0000, v43
v_lshlrev_b32 v58, 16, v59
v_mfma_f32_16x16x32_bf16 v[200:203], a[80:83], a[156:159], v[200:203]
v_and_b32 v59, 0xffff0000, v59
v_add_f32 v42, v42, v58
s_waitcnt vmcnt(23)
s_waitcnt lgkmcnt(8)
v_mfma_f32_16x16x32_bf16 v[72:75], a[88:91], a[164:167], v[72:75]
ds_read_b64_tr_b16 a[80:81], v217 offset:18440
ds_read_b64_tr_b16 a[82:83], v217 offset:23048
s_waitcnt vmcnt(19)
v_mfma_f32_16x16x32_bf16 v[72:75], a[92:95], a[168:171], v[72:75]
buffer_load_dwordx4 a[48:51], v244, s[20:23], s67 offen offset:0 sc0 sc1
v_mfma_f32_16x16x32_bf16 v[80:83], a[92:95], a[184:187], v[80:83]
v_add_f32 v43, v43, v59
v_cvt_pk_bf16_f32 v58, v42, v43
v_mfma_f32_16x16x32_bf16 v[80:83], a[88:91], a[180:183], v[80:83]
v_lshlrev_b32 v42, 16, v58
v_and_b32 v43, 0xffff0000, v58
v_mfma_f32_16x16x32_bf16 v[88:91], a[88:91], a[196:199], v[88:91]
ds_read_b64_tr_b16 a[84:85], v217 offset:27656
ds_read_b64_tr_b16 a[86:87], v217 offset:32264
v_mfma_f32_16x16x32_bf16 v[88:91], a[92:95], a[200:203], v[88:91]
buffer_load_dwordx4 a[4:7], v244, s[20:23], s64 offen offset:1024 sc0 sc1
v_mfma_f32_16x16x32_bf16 v[96:99], a[92:95], a[216:219], v[96:99]
v_mul_f32 v58, 0xbfb8aa3b, v42
v_mul_f32 v59, 0xbfb8aa3b, v43
v_mfma_f32_16x16x32_bf16 v[96:99], a[88:91], a[212:215], v[96:99]
v_exp_f32 v58, v58
s_waitcnt lgkmcnt(8)
v_mfma_f32_16x16x32_bf16 v[100:103], a[64:67], a[212:215], v[100:103]
ds_read_b64_tr_b16 a[88:89], v216 offset:18560
ds_read_b64_tr_b16 a[90:91], v216 offset:23168
v_mfma_f32_16x16x32_bf16 v[100:103], a[68:71], a[216:219], v[100:103]
buffer_load_dwordx4 a[20:23], v244, s[20:23], s65 offen offset:1024 sc0 sc1
v_mfma_f32_16x16x32_bf16 v[92:95], a[68:71], a[200:203], v[92:95]
v_exp_f32 v59, v59
v_mfma_f32_16x16x32_bf16 v[92:95], a[64:67], a[196:199], v[92:95]
v_add_f32 v58, 1.0, v58
v_add_f32 v59, 1.0, v59
v_mfma_f32_16x16x32_bf16 v[84:87], a[64:67], a[180:183], v[84:87]
ds_read_b64_tr_b16 a[92:93], v216 offset:27776
ds_read_b64_tr_b16 a[94:95], v216 offset:32384
v_mfma_f32_16x16x32_bf16 v[84:87], a[68:71], a[184:187], v[84:87]
buffer_load_dwordx4 a[36:39], v244, s[20:23], s66 offen offset:1024 sc0 sc1
v_mfma_f32_16x16x32_bf16 v[76:79], a[68:71], a[168:171], v[76:79]
v_rcp_f32 v58, v58
v_mfma_f32_16x16x32_bf16 v[76:79], a[64:67], a[164:167], v[76:79]
v_rcp_f32 v59, v59
s_waitcnt lgkmcnt(8)
v_mfma_f32_16x16x32_bf16 v[104:107], a[72:75], a[164:167], v[104:107]
ds_read_b64_tr_b16 a[64:65], v216 offset:18568
ds_read_b64_tr_b16 a[66:67], v216 offset:23176
v_mfma_f32_16x16x32_bf16 v[104:107], a[76:79], a[168:171], v[104:107]
buffer_load_dwordx4 a[52:55], v244, s[20:23], s67 offen offset:1024 sc0 sc1
v_mfma_f32_16x16x32_bf16 v[112:115], a[76:79], a[184:187], v[112:115]
v_mul_f32 v42, v42, v58
v_mul_f32 v43, v43, v59
v_mfma_f32_16x16x32_bf16 v[112:115], a[72:75], a[180:183], v[112:115]
v_cvt_pk_bf16_f32 v58, v42, v43
v_lshlrev_b32 v42, 16, v58
v_mfma_f32_16x16x32_bf16 v[120:123], a[72:75], a[196:199], v[120:123]
ds_read_b64_tr_b16 a[68:69], v216 offset:27784
ds_read_b64_tr_b16 a[70:71], v216 offset:32392
v_mfma_f32_16x16x32_bf16 v[120:123], a[76:79], a[200:203], v[120:123]
buffer_load_dwordx4 a[8:11], v244, s[20:23], s64 offen offset:2048 sc0 sc1
v_mfma_f32_16x16x32_bf16 v[128:131], a[76:79], a[216:219], v[128:131]
v_and_b32 v43, 0xffff0000, v58
v_accvgpr_read_b32 v45, a139
v_mfma_f32_16x16x32_bf16 v[128:131], a[72:75], a[212:215], v[128:131]
v_accvgpr_read_b32 v59, a147
v_lshlrev_b32 v44, 16, v45
s_waitcnt lgkmcnt(8)
v_mfma_f32_16x16x32_bf16 v[132:135], a[80:83], a[212:215], v[132:135]
ds_read_b64_tr_b16 a[72:73], v217 offset:18560
ds_read_b64_tr_b16 a[74:75], v217 offset:23168
v_mfma_f32_16x16x32_bf16 v[132:135], a[84:87], a[216:219], v[132:135]
buffer_load_dwordx4 a[24:27], v244, s[20:23], s65 offen offset:2048 sc0 sc1
v_mfma_f32_16x16x32_bf16 v[124:127], a[84:87], a[200:203], v[124:127]
v_and_b32 v45, 0xffff0000, v45
v_lshlrev_b32 v58, 16, v59
v_mfma_f32_16x16x32_bf16 v[124:127], a[80:83], a[196:199], v[124:127]
v_and_b32 v59, 0xffff0000, v59
v_add_f32 v44, v44, v58
v_mfma_f32_16x16x32_bf16 v[116:119], a[80:83], a[180:183], v[116:119]
ds_read_b64_tr_b16 a[76:77], v217 offset:27776
ds_read_b64_tr_b16 a[78:79], v217 offset:32384
v_mfma_f32_16x16x32_bf16 v[116:119], a[84:87], a[184:187], v[116:119]
buffer_load_dwordx4 a[40:43], v244, s[20:23], s66 offen offset:2048 sc0 sc1
v_mfma_f32_16x16x32_bf16 v[108:111], a[84:87], a[168:171], v[108:111]
v_add_f32 v45, v45, v59
v_cvt_pk_bf16_f32 v58, v44, v45
v_mfma_f32_16x16x32_bf16 v[108:111], a[80:83], a[164:167], v[108:111]
v_lshlrev_b32 v44, 16, v58
v_and_b32 v45, 0xffff0000, v58
s_waitcnt lgkmcnt(8)
v_mfma_f32_16x16x32_bf16 v[136:139], a[88:91], a[164:167], v[136:139]
ds_read_b64_tr_b16 a[80:81], v217 offset:18568
ds_read_b64_tr_b16 a[82:83], v217 offset:23176
v_mfma_f32_16x16x32_bf16 v[136:139], a[92:95], a[168:171], v[136:139]
buffer_load_dwordx4 a[56:59], v244, s[20:23], s67 offen offset:2048 sc0 sc1
v_mfma_f32_16x16x32_bf16 v[144:147], a[92:95], a[184:187], v[144:147]
v_mul_f32 v58, 0xbfb8aa3b, v44
v_mul_f32 v59, 0xbfb8aa3b, v45
v_mfma_f32_16x16x32_bf16 v[144:147], a[88:91], a[180:183], v[144:147]
v_exp_f32 v58, v58
v_mfma_f32_16x16x32_bf16 v[152:155], a[88:91], a[196:199], v[152:155]
ds_read_b64_tr_b16 a[84:85], v217 offset:27784
ds_read_b64_tr_b16 a[86:87], v217 offset:32392
v_mfma_f32_16x16x32_bf16 v[152:155], a[92:95], a[200:203], v[152:155]
buffer_load_dwordx4 a[12:15], v244, s[20:23], s64 offen offset:3072 sc0 sc1
v_mfma_f32_16x16x32_bf16 v[160:163], a[92:95], a[216:219], v[160:163]
v_exp_f32 v59, v59
v_mfma_f32_16x16x32_bf16 v[160:163], a[88:91], a[212:215], v[160:163]
v_add_f32 v58, 1.0, v58
v_add_f32 v59, 1.0, v59
s_waitcnt lgkmcnt(8)
v_mfma_f32_16x16x32_bf16 v[164:167], a[64:67], a[212:215], v[164:167]
ds_read_b64_tr_b16 a[88:89], v218 offset:18432
ds_read_b64_tr_b16 a[90:91], v218 offset:23040
v_mfma_f32_16x16x32_bf16 v[164:167], a[68:71], a[216:219], v[164:167]
buffer_load_dwordx4 a[28:31], v244, s[20:23], s65 offen offset:3072 sc0 sc1
v_mfma_f32_16x16x32_bf16 v[156:159], a[68:71], a[200:203], v[156:159]
v_rcp_f32 v58, v58
v_mfma_f32_16x16x32_bf16 v[156:159], a[64:67], a[196:199], v[156:159]
v_rcp_f32 v59, v59
v_mfma_f32_16x16x32_bf16 v[148:151], a[64:67], a[180:183], v[148:151]
ds_read_b64_tr_b16 a[92:93], v218 offset:27648
ds_read_b64_tr_b16 a[94:95], v218 offset:32256
v_mfma_f32_16x16x32_bf16 v[148:151], a[68:71], a[184:187], v[148:151]
buffer_load_dwordx4 a[44:47], v244, s[20:23], s66 offen offset:3072 sc0 sc1
v_mfma_f32_16x16x32_bf16 v[140:143], a[68:71], a[168:171], v[140:143]
v_mul_f32 v44, v44, v58
v_mul_f32 v45, v45, v59
v_mfma_f32_16x16x32_bf16 v[140:143], a[64:67], a[164:167], v[140:143]
v_cvt_pk_bf16_f32 v58, v44, v45
v_lshlrev_b32 v44, 16, v58
s_waitcnt lgkmcnt(8)
v_mfma_f32_16x16x32_bf16 v[168:171], a[72:75], a[164:167], v[168:171]
ds_read_b64_tr_b16 a[64:65], v220 offset:0
ds_read_b64_tr_b16 a[66:67], v220 offset:4608
v_mfma_f32_16x16x32_bf16 v[168:171], a[76:79], a[168:171], v[168:171]
buffer_load_dwordx4 a[60:63], v244, s[20:23], s67 offen offset:3072 sc0 sc1
v_mfma_f32_16x16x32_bf16 v[176:179], a[76:79], a[184:187], v[176:179]
s_lshl2_add_u32 s28, s36, s33
s_lshl2_add_u32 s28, s28, s37
v_mfma_f32_16x16x32_bf16 v[176:179], a[72:75], a[180:183], v[176:179]
s_lshl_b32 s95, s28, 5
s_add_u32 s95, s95, 0x24a000
v_mfma_f32_16x16x32_bf16 v[184:187], a[72:75], a[196:199], v[184:187]
ds_read_b64_tr_b16 a[68:69], v220 offset:9216
ds_read_b64_tr_b16 a[70:71], v220 offset:13824
v_mfma_f32_16x16x32_bf16 v[184:187], a[76:79], a[200:203], v[184:187]
s_lshl_b32 s28, s32, 18
s_sub_u32 s49, s44, s28
v_mfma_f32_16x16x32_bf16 v[192:195], a[76:79], a[216:219], v[192:195]
v_add_u32 v243, 0x2000, v244
v_mov_b32 v246, 2
v_mfma_f32_16x16x32_bf16 v[192:195], a[72:75], a[212:215], v[192:195]
s_lshl2_add_u32 s29, s33, s94
v_and_b32 v45, 0xffff0000, v58
s_waitcnt lgkmcnt(8)
v_mfma_f32_16x16x32_bf16 v[196:199], a[80:83], a[212:215], v[196:199]
ds_read_b64_tr_b16 a[72:73], v220 offset:18432
ds_read_b64_tr_b16 a[74:75], v220 offset:23040
v_mfma_f32_16x16x32_bf16 v[196:199], a[84:87], a[216:219], v[196:199]
v_accvgpr_read_b32 v47, a140
v_accvgpr_read_b32 v59, a148
v_mfma_f32_16x16x32_bf16 v[188:191], a[84:87], a[200:203], v[188:191]
v_lshlrev_b32 v46, 16, v47
v_and_b32 v47, 0xffff0000, v47
v_mfma_f32_16x16x32_bf16 v[188:191], a[80:83], a[196:199], v[188:191]
v_lshlrev_b32 v58, 16, v59
v_and_b32 v59, 0xffff0000, v59
v_mfma_f32_16x16x32_bf16 v[180:183], a[80:83], a[180:183], v[180:183]
ds_read_b64_tr_b16 a[76:77], v220 offset:27648
ds_read_b64_tr_b16 a[78:79], v220 offset:32256
v_mfma_f32_16x16x32_bf16 v[180:183], a[84:87], a[184:187], v[180:183]
v_add_f32 v46, v46, v58
v_add_f32 v47, v47, v59
v_mfma_f32_16x16x32_bf16 v[172:175], a[84:87], a[168:171], v[172:175]
v_cvt_pk_bf16_f32 v58, v46, v47
v_lshlrev_b32 v46, 16, v58
v_mfma_f32_16x16x32_bf16 v[172:175], a[80:83], a[164:167], v[172:175]
v_and_b32 v47, 0xffff0000, v58
v_mul_f32 v58, 0xbfb8aa3b, v46
s_waitcnt lgkmcnt(8)
v_mfma_f32_16x16x32_bf16 v[200:203], a[88:91], a[164:167], v[200:203]
ds_read_b64_tr_b16 a[80:81], v223 offset:0
ds_read_b64_tr_b16 a[82:83], v223 offset:4608
v_mfma_f32_16x16x32_bf16 v[200:203], a[92:95], a[168:171], v[200:203]
v_mul_f32 v59, 0xbfb8aa3b, v47
v_mfma_f32_16x16x32_bf16 v[204:207], a[92:95], a[184:187], v[204:207]
v_exp_f32 v58, v58
v_mfma_f32_16x16x32_bf16 v[204:207], a[88:91], a[180:183], v[204:207]
v_exp_f32 v59, v59
v_mfma_f32_16x16x32_bf16 v[208:211], a[88:91], a[196:199], v[208:211]
ds_read_b64_tr_b16 a[84:85], v223 offset:9216
ds_read_b64_tr_b16 a[86:87], v223 offset:13824
v_mfma_f32_16x16x32_bf16 v[208:211], a[92:95], a[200:203], v[208:211]
v_add_f32 v58, 1.0, v58
v_add_f32 v59, 1.0, v59
v_mfma_f32_16x16x32_bf16 v[212:215], a[92:95], a[216:219], v[212:215]
v_rcp_f32 v58, v58
v_mfma_f32_16x16x32_bf16 v[212:215], a[88:91], a[212:215], v[212:215]
v_rcp_f32 v59, v59
s_waitcnt vmcnt(28)
s_waitcnt lgkmcnt(8)
v_mfma_f32_16x16x32_bf16 v[128:131], a[64:67], a[112:115], v[128:131]
ds_read_b64_tr_b16 a[88:89], v223 offset:18432
ds_read_b64_tr_b16 a[90:91], v223 offset:23040
s_waitcnt vmcnt(24)
v_mfma_f32_16x16x32_bf16 v[128:131], a[68:71], a[116:119], v[128:131]
v_mul_f32 v46, v46, v58
v_mul_f32 v47, v47, v59
v_mfma_f32_16x16x32_bf16 v[120:123], a[68:71], a[100:103], v[120:123]
v_cvt_pk_bf16_f32 v58, v46, v47
v_lshlrev_b32 v46, 16, v58
v_mfma_f32_16x16x32_bf16 v[120:123], a[64:67], a[96:99], v[120:123]
v_and_b32 v47, 0xffff0000, v58
v_accvgpr_read_b32 v49, a141
v_mfma_f32_16x16x32_bf16 v[112:115], a[64:67], a[236:239], v[112:115]
ds_read_b64_tr_b16 a[92:93], v223 offset:27648
ds_read_b64_tr_b16 a[94:95], v223 offset:32256
v_mfma_f32_16x16x32_bf16 v[112:115], a[68:71], a[240:243], v[112:115]
v_accvgpr_read_b32 v59, a149
v_lshlrev_b32 v48, 16, v49
v_mfma_f32_16x16x32_bf16 v[104:107], a[68:71], a[224:227], v[104:107]
v_and_b32 v49, 0xffff0000, v49
v_lshlrev_b32 v58, 16, v59
v_mfma_f32_16x16x32_bf16 v[104:107], a[64:67], a[220:223], v[104:107]
s_waitcnt vmcnt(0)
buffer_store_dword v246, v254, s[20:23], s29 offen
s_waitcnt vmcnt(21)
s_waitcnt lgkmcnt(8)
v_mfma_f32_16x16x32_bf16 v[104:107], a[72:75], a[228:231], v[104:107]
ds_read_b64_tr_b16 a[64:65], v220 offset:8
ds_read_b64_tr_b16 a[66:67], v220 offset:4616
s_waitcnt vmcnt(17)
v_mfma_f32_16x16x32_bf16 v[104:107], a[76:79], a[232:235], v[104:107]
s_xor_b32 s28, s32, 0
s_sub_u32 s29, s32, s28
v_mfma_f32_16x16x32_bf16 v[112:115], a[76:79], a[132:135], v[112:115]
s_lshl_b32 s28, s28, 18
s_and_b32 s29, s29, 3
v_mfma_f32_16x16x32_bf16 v[112:115], a[72:75], a[128:131], v[112:115]
s_add_u32 s28, s28, s49
s_lshl_b32 s50, s29, 10
v_mfma_f32_16x16x32_bf16 v[120:123], a[72:75], a[104:107], v[120:123]
ds_read_b64_tr_b16 a[68:69], v220 offset:9224
ds_read_b64_tr_b16 a[70:71], v220 offset:13832
v_mfma_f32_16x16x32_bf16 v[120:123], a[76:79], a[108:111], v[120:123]
s_mul_i32 s29, s29, 0x1200
s_and_b32 s29, s29, 0x2200
v_mfma_f32_16x16x32_bf16 v[128:131], a[76:79], a[124:127], v[128:131]
s_add_u32 s72, s28, s29
v_and_b32 v59, 0xffff0000, v59
v_mfma_f32_16x16x32_bf16 v[128:131], a[72:75], a[120:123], v[128:131]
s_xor_b32 s28, s32, 1
s_sub_u32 s29, s32, s28
s_waitcnt vmcnt(13)
s_waitcnt lgkmcnt(8)
v_mfma_f32_16x16x32_bf16 v[128:131], a[80:83], a[48:51], v[128:131]
ds_read_b64_tr_b16 a[72:73], v220 offset:18440
ds_read_b64_tr_b16 a[74:75], v220 offset:23048
s_waitcnt vmcnt(9)
v_mfma_f32_16x16x32_bf16 v[128:131], a[84:87], a[52:55], v[128:131]
s_lshl_b32 s28, s28, 18
s_and_b32 s29, s29, 3
v_mfma_f32_16x16x32_bf16 v[120:123], a[84:87], a[36:39], v[120:123]
s_add_u32 s28, s28, s49
s_lshl_b32 s50, s29, 10
v_mfma_f32_16x16x32_bf16 v[120:123], a[80:83], a[32:35], v[120:123]
s_add_u32 s65, s28, s50
v_add_f32 v48, v48, v58
v_mfma_f32_16x16x32_bf16 v[112:115], a[80:83], a[16:19], v[112:115]
ds_read_b64_tr_b16 a[76:77], v220 offset:27656
ds_read_b64_tr_b16 a[78:79], v220 offset:32264
v_mfma_f32_16x16x32_bf16 v[112:115], a[84:87], a[20:23], v[112:115]
s_mul_i32 s29, s29, 0x1200
s_and_b32 s29, s29, 0x2200
v_mfma_f32_16x16x32_bf16 v[104:107], a[84:87], a[4:7], v[104:107]
s_add_u32 s73, s28, s29
v_add_f32 v49, v49, v59
v_mfma_f32_16x16x32_bf16 v[104:107], a[80:83], a[0:3], v[104:107]
s_xor_b32 s28, s32, 2
s_sub_u32 s29, s32, s28
s_waitcnt vmcnt(5)
s_waitcnt lgkmcnt(8)
v_mfma_f32_16x16x32_bf16 v[104:107], a[88:91], a[8:11], v[104:107]
ds_read_b64_tr_b16 a[80:81], v223 offset:8
ds_read_b64_tr_b16 a[82:83], v223 offset:4616
s_waitcnt vmcnt(1)
v_mfma_f32_16x16x32_bf16 v[104:107], a[92:95], a[12:15], v[104:107]
s_lshl_b32 s28, s28, 18
s_and_b32 s29, s29, 3
v_mfma_f32_16x16x32_bf16 v[112:115], a[92:95], a[28:31], v[112:115]
s_add_u32 s28, s28, s49
s_lshl_b32 s50, s29, 10
v_mfma_f32_16x16x32_bf16 v[112:115], a[88:91], a[24:27], v[112:115]
s_add_u32 s66, s28, s50
v_cvt_pk_bf16_f32 v58, v48, v49
v_mfma_f32_16x16x32_bf16 v[120:123], a[88:91], a[40:43], v[120:123]
ds_read_b64_tr_b16 a[84:85], v223 offset:9224
ds_read_b64_tr_b16 a[86:87], v223 offset:13832
v_mfma_f32_16x16x32_bf16 v[120:123], a[92:95], a[44:47], v[120:123]
s_mul_i32 s29, s29, 0x1200
s_and_b32 s29, s29, 0x2200
v_mfma_f32_16x16x32_bf16 v[128:131], a[92:95], a[60:63], v[128:131]
s_add_u32 s74, s28, s29
v_lshlrev_b32 v48, 16, v58
v_mfma_f32_16x16x32_bf16 v[128:131], a[88:91], a[56:59], v[128:131]
s_xor_b32 s28, s32, 3
s_sub_u32 s29, s32, s28
s_waitcnt lgkmcnt(8)
v_mfma_f32_16x16x32_bf16 v[132:135], a[64:67], a[112:115], v[132:135]
ds_read_b64_tr_b16 a[88:89], v223 offset:18440
ds_read_b64_tr_b16 a[90:91], v223 offset:23048
v_mfma_f32_16x16x32_bf16 v[132:135], a[68:71], a[116:119], v[132:135]
s_lshl_b32 s28, s28, 18
s_and_b32 s29, s29, 3
v_mfma_f32_16x16x32_bf16 v[124:127], a[68:71], a[100:103], v[124:127]
s_add_u32 s28, s28, s49
s_lshl_b32 s50, s29, 10
v_mfma_f32_16x16x32_bf16 v[124:127], a[64:67], a[96:99], v[124:127]
s_add_u32 s67, s28, s50
v_and_b32 v49, 0xffff0000, v58
v_mfma_f32_16x16x32_bf16 v[116:119], a[64:67], a[236:239], v[116:119]
ds_read_b64_tr_b16 a[92:93], v223 offset:27656
ds_read_b64_tr_b16 a[94:95], v223 offset:32264
v_mfma_f32_16x16x32_bf16 v[116:119], a[68:71], a[240:243], v[116:119]
s_mul_i32 s29, s29, 0x1200
s_and_b32 s29, s29, 0x2200
v_mfma_f32_16x16x32_bf16 v[108:111], a[68:71], a[224:227], v[108:111]
s_add_u32 s75, s28, s29
v_mul_f32 v58, 0xbfb8aa3b, v48
v_mfma_f32_16x16x32_bf16 v[108:111], a[64:67], a[220:223], v[108:111]
buffer_load_dword v230, v229, s[20:23], s94 offen sc0 sc1
s_waitcnt lgkmcnt(8)
v_mfma_f32_16x16x32_bf16 v[108:111], a[72:75], a[228:231], v[108:111]
ds_read_b64_tr_b16 a[64:65], v220 offset:128
ds_read_b64_tr_b16 a[66:67], v220 offset:4736
v_mfma_f32_16x16x32_bf16 v[108:111], a[76:79], a[232:235], v[108:111]
s_xor_b32 s28, s32, 4
s_sub_u32 s29, s32, s28
v_mfma_f32_16x16x32_bf16 v[116:119], a[76:79], a[132:135], v[116:119]
s_lshl_b32 s28, s28, 18
s_and_b32 s29, s29, 3
v_mfma_f32_16x16x32_bf16 v[116:119], a[72:75], a[128:131], v[116:119]
s_add_u32 s28, s28, s49
s_lshl_b32 s50, s29, 10
v_mfma_f32_16x16x32_bf16 v[124:127], a[72:75], a[104:107], v[124:127]
ds_read_b64_tr_b16 a[68:69], v220 offset:9344
ds_read_b64_tr_b16 a[70:71], v220 offset:13952
v_mfma_f32_16x16x32_bf16 v[124:127], a[76:79], a[108:111], v[124:127]
s_add_u32 s68, s28, s50
s_add_u32 s68, s68, 4096
v_mfma_f32_16x16x32_bf16 v[132:135], a[76:79], a[124:127], v[132:135]
s_mul_i32 s29, s29, 0x1200
s_and_b32 s29, s29, 0x2200
v_mfma_f32_16x16x32_bf16 v[132:135], a[72:75], a[120:123], v[132:135]
s_add_u32 s84, s28, s29
v_mul_f32 v59, 0xbfb8aa3b, v49
s_waitcnt lgkmcnt(8)
v_mfma_f32_16x16x32_bf16 v[132:135], a[80:83], a[48:51], v[132:135]
ds_read_b64_tr_b16 a[72:73], v220 offset:18560
ds_read_b64_tr_b16 a[74:75], v220 offset:23168
v_mfma_f32_16x16x32_bf16 v[132:135], a[84:87], a[52:55], v[132:135]
s_xor_b32 s28, s32, 5
s_sub_u32 s29, s32, s28
v_mfma_f32_16x16x32_bf16 v[124:127], a[84:87], a[36:39], v[124:127]
s_lshl_b32 s28, s28, 18
s_and_b32 s29, s29, 3
v_mfma_f32_16x16x32_bf16 v[124:127], a[80:83], a[32:35], v[124:127]
s_add_u32 s28, s28, s49
s_lshl_b32 s50, s29, 10
v_mfma_f32_16x16x32_bf16 v[116:119], a[80:83], a[16:19], v[116:119]
ds_read_b64_tr_b16 a[76:77], v220 offset:27776
ds_read_b64_tr_b16 a[78:79], v220 offset:32384
v_mfma_f32_16x16x32_bf16 v[116:119], a[84:87], a[20:23], v[116:119]
s_add_u32 s69, s28, s50
s_add_u32 s69, s69, 4096
v_mfma_f32_16x16x32_bf16 v[108:111], a[84:87], a[4:7], v[108:111]
s_mul_i32 s29, s29, 0x1200
s_and_b32 s29, s29, 0x2200
v_mfma_f32_16x16x32_bf16 v[108:111], a[80:83], a[0:3], v[108:111]
s_add_u32 s85, s28, s29
s_waitcnt lgkmcnt(8)
v_mfma_f32_16x16x32_bf16 v[108:111], a[88:91], a[8:11], v[108:111]
ds_read_b64_tr_b16 a[80:81], v223 offset:128
ds_read_b64_tr_b16 a[82:83], v223 offset:4736
v_mfma_f32_16x16x32_bf16 v[108:111], a[92:95], a[12:15], v[108:111]
STUB_15:
STUB_B3:
s_cbranch_execz STUB_18
s_xor_b32 s28, s32, 6
s_sub_u32 s29, s32, s28
v_mfma_f32_16x16x32_bf16 v[116:119], a[92:95], a[28:31], v[116:119]
s_lshl_b32 s28, s28, 18
s_and_b32 s29, s29, 3
v_mfma_f32_16x16x32_bf16 v[116:119], a[88:91], a[24:27], v[116:119]
s_add_u32 s28, s28, s49
s_lshl_b32 s50, s29, 10
v_mfma_f32_16x16x32_bf16 v[124:127], a[88:91], a[40:43], v[124:127]
ds_read_b64_tr_b16 a[84:85], v223 offset:9344
ds_read_b64_tr_b16 a[86:87], v223 offset:13952
v_mfma_f32_16x16x32_bf16 v[124:127], a[92:95], a[44:47], v[124:127]
s_add_u32 s70, s28, s50
s_add_u32 s70, s70, 4096
v_mfma_f32_16x16x32_bf16 v[132:135], a[92:95], a[60:63], v[132:135]
s_mul_i32 s29, s29, 0x1200
s_and_b32 s29, s29, 0x2200
v_mfma_f32_16x16x32_bf16 v[132:135], a[88:91], a[56:59], v[132:135]
s_add_u32 s86, s28, s29
s_waitcnt lgkmcnt(8)
v_mfma_f32_16x16x32_bf16 v[192:195], a[64:67], a[112:115], v[192:195]
ds_read_b64_tr_b16 a[88:89], v223 offset:18560
ds_read_b64_tr_b16 a[90:91], v223 offset:23168
v_mfma_f32_16x16x32_bf16 v[192:195], a[68:71], a[116:119], v[192:195]
s_xor_b32 s28, s32, 7
s_sub_u32 s29, s32, s28
v_mfma_f32_16x16x32_bf16 v[184:187], a[68:71], a[100:103], v[184:187]
s_lshl_b32 s28, s28, 18
s_and_b32 s29, s29, 3
v_mfma_f32_16x16x32_bf16 v[184:187], a[64:67], a[96:99], v[184:187]
s_add_u32 s28, s28, s49
s_lshl_b32 s50, s29, 10
v_mfma_f32_16x16x32_bf16 v[176:179], a[64:67], a[236:239], v[176:179]
ds_read_b64_tr_b16 a[92:93], v223 offset:27776
ds_read_b64_tr_b16 a[94:95], v223 offset:32384
v_mfma_f32_16x16x32_bf16 v[176:179], a[68:71], a[240:243], v[176:179]
s_add_u32 s71, s28, s50
s_add_u32 s71, s71, 4096
v_mfma_f32_16x16x32_bf16 v[168:171], a[68:71], a[224:227], v[168:171]
s_mul_i32 s29, s29, 0x1200
s_and_b32 s29, s29, 0x2200
v_mfma_f32_16x16x32_bf16 v[168:171], a[64:67], a[220:223], v[168:171]
s_add_u32 s87, s28, s29
s_waitcnt lgkmcnt(8)
v_mfma_f32_16x16x32_bf16 v[168:171], a[72:75], a[228:231], v[168:171]
ds_read_b64_tr_b16 a[64:65], v220 offset:136
ds_read_b64_tr_b16 a[66:67], v220 offset:4744
v_mfma_f32_16x16x32_bf16 v[168:171], a[76:79], a[232:235], v[168:171]
s_waitcnt vmcnt(0)
v_cmp_gt_u32 vcc, 2, v230
v_mfma_f32_16x16x32_bf16 v[176:179], a[76:79], a[132:135], v[176:179]
v_exp_f32 v58, v58
v_mfma_f32_16x16x32_bf16 v[176:179], a[72:75], a[128:131], v[176:179]
s_and_b32 s29, vcc_lo, 15
s_cbranch_scc1 SP_O3A
SP_O3A_RET:
v_mfma_f32_16x16x32_bf16 v[184:187], a[72:75], a[104:107], v[184:187]
ds_read_b64_tr_b16 a[68:69], v220 offset:9352
ds_read_b64_tr_b16 a[70:71], v220 offset:13960
v_mfma_f32_16x16x32_bf16 v[184:187], a[76:79], a[108:111], v[184:187]
s_add_u32 s39, s44, 4096
v_mfma_f32_16x16x32_bf16 v[192:195], a[76:79], a[124:127], v[192:195]
v_cvt_pk_bf16_f32 v104, v104, v105
v_cvt_pk_bf16_f32 v105, v106, v107
v_mfma_f32_16x16x32_bf16 v[192:195], a[72:75], a[120:123], v[192:195]
v_cvt_pk_bf16_f32 v106, v108, v109
v_cvt_pk_bf16_f32 v107, v110, v111
s_waitcnt lgkmcnt(8)
v_mfma_f32_16x16x32_bf16 v[192:195], a[80:83], a[48:51], v[192:195]
ds_read_b64_tr_b16 a[72:73], v220 offset:18568
ds_read_b64_tr_b16 a[74:75], v220 offset:23176
v_mfma_f32_16x16x32_bf16 v[192:195], a[84:87], a[52:55], v[192:195]
buffer_store_dwordx4 v[104:107], v244, s[20:23], s39 offen offset:0
v_mfma_f32_16x16x32_bf16 v[184:187], a[84:87], a[36:39], v[184:187]
v_cvt_pk_bf16_f32 v112, v112, v113
v_cvt_pk_bf16_f32 v113, v114, v115
v_mfma_f32_16x16x32_bf16 v[184:187], a[80:83], a[32:35], v[184:187]
v_cvt_pk_bf16_f32 v114, v116, v117
v_cvt_pk_bf16_f32 v115, v118, v119
v_mfma_f32_16x16x32_bf16 v[176:179], a[80:83], a[16:19], v[176:179]
ds_read_b64_tr_b16 a[76:77], v220 offset:27784
ds_read_b64_tr_b16 a[78:79], v220 offset:32392
v_mfma_f32_16x16x32_bf16 v[176:179], a[84:87], a[20:23], v[176:179]
buffer_store_dwordx4 v[112:115], v244, s[20:23], s39 offen offset:1024
v_mfma_f32_16x16x32_bf16 v[168:171], a[84:87], a[4:7], v[168:171]
v_cvt_pk_bf16_f32 v120, v120, v121
v_cvt_pk_bf16_f32 v121, v122, v123
v_mfma_f32_16x16x32_bf16 v[168:171], a[80:83], a[0:3], v[168:171]
v_cvt_pk_bf16_f32 v122, v124, v125
v_cvt_pk_bf16_f32 v123, v126, v127
s_waitcnt lgkmcnt(8)
v_mfma_f32_16x16x32_bf16 v[168:171], a[88:91], a[8:11], v[168:171]
ds_read_b64_tr_b16 a[80:81], v223 offset:136
ds_read_b64_tr_b16 a[82:83], v223 offset:4744
v_mfma_f32_16x16x32_bf16 v[168:171], a[92:95], a[12:15], v[168:171]
buffer_store_dwordx4 v[120:123], v244, s[20:23], s39 offen offset:2048
v_mfma_f32_16x16x32_bf16 v[176:179], a[92:95], a[28:31], v[176:179]
v_cvt_pk_bf16_f32 v128, v128, v129
v_cvt_pk_bf16_f32 v129, v130, v131
v_mfma_f32_16x16x32_bf16 v[176:179], a[88:91], a[24:27], v[176:179]
v_cvt_pk_bf16_f32 v130, v132, v133
v_cvt_pk_bf16_f32 v131, v134, v135
v_mfma_f32_16x16x32_bf16 v[184:187], a[88:91], a[40:43], v[184:187]
ds_read_b64_tr_b16 a[84:85], v223 offset:9352
ds_read_b64_tr_b16 a[86:87], v223 offset:13960
v_mfma_f32_16x16x32_bf16 v[184:187], a[92:95], a[44:47], v[184:187]
buffer_store_dwordx4 v[128:131], v244, s[20:23], s39 offen offset:3072
v_mfma_f32_16x16x32_bf16 v[192:195], a[92:95], a[60:63], v[192:195]
v_exp_f32 v59, v59
v_mfma_f32_16x16x32_bf16 v[192:195], a[88:91], a[56:59], v[192:195]
v_add_f32 v58, 1.0, v58
v_add_f32 v59, 1.0, v59
s_waitcnt lgkmcnt(8)
v_mfma_f32_16x16x32_bf16 v[196:199], a[64:67], a[112:115], v[196:199]
ds_read_b64_tr_b16 a[88:89], v223 offset:18568
ds_read_b64_tr_b16 a[90:91], v223 offset:23176
v_mfma_f32_16x16x32_bf16 v[196:199], a[68:71], a[116:119], v[196:199]
v_rcp_f32 v58, v58
v_mfma_f32_16x16x32_bf16 v[188:191], a[68:71], a[100:103], v[188:191]
v_rcp_f32 v59, v59
v_mfma_f32_16x16x32_bf16 v[188:191], a[64:67], a[96:99], v[188:191]
v_mul_f32 v48, v48, v58
v_mul_f32 v49, v49, v59
v_mfma_f32_16x16x32_bf16 v[180:183], a[64:67], a[236:239], v[180:183]
ds_read_b64_tr_b16 a[92:93], v223 offset:27784
ds_read_b64_tr_b16 a[94:95], v223 offset:32392
v_mfma_f32_16x16x32_bf16 v[180:183], a[68:71], a[240:243], v[180:183]
v_cvt_pk_bf16_f32 v58, v48, v49
v_lshlrev_b32 v48, 16, v58
v_mfma_f32_16x16x32_bf16 v[172:175], a[68:71], a[224:227], v[172:175]
v_and_b32 v49, 0xffff0000, v58
v_accvgpr_read_b32 v51, a142
v_mfma_f32_16x16x32_bf16 v[172:175], a[64:67], a[220:223], v[172:175]
v_accvgpr_read_b32 v59, a150
v_lshlrev_b32 v50, 16, v51
s_waitcnt lgkmcnt(8)
v_mfma_f32_16x16x32_bf16 v[172:175], a[72:75], a[228:231], v[172:175]
ds_read_b64_tr_b16 a[64:65], v221 offset:0
ds_read_b64_tr_b16 a[66:67], v221 offset:4608
v_mfma_f32_16x16x32_bf16 v[172:175], a[76:79], a[232:235], v[172:175]
v_and_b32 v51, 0xffff0000, v51
v_lshlrev_b32 v58, 16, v59
v_mfma_f32_16x16x32_bf16 v[180:183], a[76:79], a[132:135], v[180:183]
v_and_b32 v59, 0xffff0000, v59
v_add_f32 v50, v50, v58
v_mfma_f32_16x16x32_bf16 v[180:183], a[72:75], a[128:131], v[180:183]
v_add_f32 v51, v51, v59
v_cvt_pk_bf16_f32 v58, v50, v51
v_mfma_f32_16x16x32_bf16 v[188:191], a[72:75], a[104:107], v[188:191]
ds_read_b64_tr_b16 a[68:69], v221 offset:9216
ds_read_b64_tr_b16 a[70:71], v221 offset:13824
v_mfma_f32_16x16x32_bf16 v[188:191], a[76:79], a[108:111], v[188:191]
v_lshlrev_b32 v50, 16, v58
v_and_b32 v51, 0xffff0000, v58
v_mfma_f32_16x16x32_bf16 v[196:199], a[76:79], a[124:127], v[196:199]
v_mul_f32 v58, 0xbfb8aa3b, v50
v_mul_f32 v59, 0xbfb8aa3b, v51
v_mfma_f32_16x16x32_bf16 v[196:199], a[72:75], a[120:123], v[196:199]
v_exp_f32 v58, v58
s_waitcnt lgkmcnt(8)
v_mfma_f32_16x16x32_bf16 v[196:199], a[80:83], a[48:51], v[196:199]
ds_read_b64_tr_b16 a[72:73], v221 offset:18432
ds_read_b64_tr_b16 a[74:75], v221 offset:23040
v_mfma_f32_16x16x32_bf16 v[196:199], a[84:87], a[52:55], v[196:199]
v_exp_f32 v59, v59
v_mfma_f32_16x16x32_bf16 v[188:191], a[84:87], a[36:39], v[188:191]
v_add_f32 v58, 1.0, v58
v_add_f32 v59, 1.0, v59
v_mfma_f32_16x16x32_bf16 v[188:191], a[80:83], a[32:35], v[188:191]
v_rcp_f32 v58, v58
v_mfma_f32_16x16x32_bf16 v[180:183], a[80:83], a[16:19], v[180:183]
ds_read_b64_tr_b16 a[76:77], v221 offset:27648
ds_read_b64_tr_b16 a[78:79], v221 offset:32256
v_mfma_f32_16x16x32_bf16 v[180:183], a[84:87], a[20:23], v[180:183]
v_rcp_f32 v59, v59
v_mfma_f32_16x16x32_bf16 v[172:175], a[84:87], a[4:7], v[172:175]
v_mul_f32 v50, v50, v58
v_mul_f32 v51, v51, v59
v_mfma_f32_16x16x32_bf16 v[172:175], a[80:83], a[0:3], v[172:175]
v_cvt_pk_bf16_f32 v58, v50, v51
v_lshlrev_b32 v50, 16, v58
s_waitcnt lgkmcnt(8)
v_mfma_f32_16x16x32_bf16 v[172:175], a[88:91], a[8:11], v[172:175]
ds_read_b64_tr_b16 a[80:81], v224 offset:0
ds_read_b64_tr_b16 a[82:83], v224 offset:4608
v_mfma_f32_16x16x32_bf16 v[172:175], a[92:95], a[12:15], v[172:175]
v_and_b32 v51, 0xffff0000, v58
v_accvgpr_read_b32 v53, a143
v_mfma_f32_16x16x32_bf16 v[180:183], a[92:95], a[28:31], v[180:183]
v_accvgpr_read_b32 v59, a151
v_lshlrev_b32 v52, 16, v53
v_mfma_f32_16x16x32_bf16 v[180:183], a[88:91], a[24:27], v[180:183]
v_and_b32 v53, 0xffff0000, v53
v_lshlrev_b32 v58, 16, v59
v_mfma_f32_16x16x32_bf16 v[188:191], a[88:91], a[40:43], v[188:191]
ds_read_b64_tr_b16 a[84:85], v224 offset:9216
ds_read_b64_tr_b16 a[86:87], v224 offset:13824
v_mfma_f32_16x16x32_bf16 v[188:191], a[92:95], a[44:47], v[188:191]
v_and_b32 v59, 0xffff0000, v59
v_add_f32 v52, v52, v58
v_mfma_f32_16x16x32_bf16 v[196:199], a[92:95], a[60:63], v[196:199]
v_add_f32 v53, v53, v59
v_cvt_pk_bf16_f32 v58, v52, v53
v_mfma_f32_16x16x32_bf16 v[196:199], a[88:91], a[56:59], v[196:199]
v_lshlrev_b32 v52, 16, v58
v_and_b32 v53, 0xffff0000, v58
s_waitcnt lgkmcnt(8)
v_mfma_f32_16x16x32_bf16 v[212:215], a[64:67], a[112:115], v[212:215]
ds_read_b64_tr_b16 a[88:89], v224 offset:18432
ds_read_b64_tr_b16 a[90:91], v224 offset:23040
v_mfma_f32_16x16x32_bf16 v[212:215], a[68:71], a[116:119], v[212:215]
v_mul_f32 v58, 0xbfb8aa3b, v52
v_mul_f32 v59, 0xbfb8aa3b, v53
v_mfma_f32_16x16x32_bf16 v[208:211], a[68:71], a[100:103], v[208:211]
v_exp_f32 v58, v58
v_mfma_f32_16x16x32_bf16 v[208:211], a[64:67], a[96:99], v[208:211]
v_exp_f32 v59, v59
v_mfma_f32_16x16x32_bf16 v[204:207], a[64:67], a[236:239], v[204:207]
ds_read_b64_tr_b16 a[92:93], v224 offset:27648
ds_read_b64_tr_b16 a[94:95], v224 offset:32256
v_mfma_f32_16x16x32_bf16 v[204:207], a[68:71], a[240:243], v[204:207]
v_add_f32 v58, 1.0, v58
v_add_f32 v59, 1.0, v59
v_mfma_f32_16x16x32_bf16 v[200:203], a[68:71], a[224:227], v[200:203]
v_rcp_f32 v58, v58
v_mfma_f32_16x16x32_bf16 v[200:203], a[64:67], a[220:223], v[200:203]
v_rcp_f32 v59, v59
s_waitcnt lgkmcnt(8)
v_mfma_f32_16x16x32_bf16 v[200:203], a[72:75], a[228:231], v[200:203]
ds_read_b64_tr_b16 a[64:65], v219 offset:0
ds_read_b64_tr_b16 a[66:67], v219 offset:4608
v_mfma_f32_16x16x32_bf16 v[200:203], a[76:79], a[232:235], v[200:203]
s_add_u32 s39, s44, 12288
v_mul_f32 v52, v52, v58
v_mfma_f32_16x16x32_bf16 v[204:207], a[76:79], a[132:135], v[204:207]
v_cvt_pk_bf16_f32 v168, v168, v169
v_cvt_pk_bf16_f32 v169, v170, v171
v_mfma_f32_16x16x32_bf16 v[204:207], a[72:75], a[128:131], v[204:207]
v_cvt_pk_bf16_f32 v170, v172, v173
v_cvt_pk_bf16_f32 v171, v174, v175
v_mfma_f32_16x16x32_bf16 v[208:211], a[72:75], a[104:107], v[208:211]
ds_read_b64_tr_b16 a[68:69], v219 offset:9216
ds_read_b64_tr_b16 a[70:71], v219 offset:13824
v_mfma_f32_16x16x32_bf16 v[208:211], a[76:79], a[108:111], v[208:211]
buffer_store_dwordx4 v[168:171], v244, s[20:23], s39 offen offset:0
v_mfma_f32_16x16x32_bf16 v[212:215], a[76:79], a[124:127], v[212:215]
v_cvt_pk_bf16_f32 v176, v176, v177
v_cvt_pk_bf16_f32 v177, v178, v179
v_mfma_f32_16x16x32_bf16 v[212:215], a[72:75], a[120:123], v[212:215]
v_cvt_pk_bf16_f32 v178, v180, v181
v_cvt_pk_bf16_f32 v179, v182, v183
s_waitcnt lgkmcnt(8)
v_mfma_f32_16x16x32_bf16 v[212:215], a[80:83], a[48:51], v[212:215]
ds_read_b64_tr_b16 a[72:73], v219 offset:18432
ds_read_b64_tr_b16 a[74:75], v219 offset:23040
v_mfma_f32_16x16x32_bf16 v[212:215], a[84:87], a[52:55], v[212:215]
buffer_store_dwordx4 v[176:179], v244, s[20:23], s39 offen offset:1024
v_mfma_f32_16x16x32_bf16 v[208:211], a[84:87], a[36:39], v[208:211]
v_cvt_pk_bf16_f32 v184, v184, v185
v_cvt_pk_bf16_f32 v185, v186, v187
v_mfma_f32_16x16x32_bf16 v[208:211], a[80:83], a[32:35], v[208:211]
v_cvt_pk_bf16_f32 v186, v188, v189
v_cvt_pk_bf16_f32 v187, v190, v191
v_mfma_f32_16x16x32_bf16 v[204:207], a[80:83], a[16:19], v[204:207]
ds_read_b64_tr_b16 a[76:77], v219 offset:27648
ds_read_b64_tr_b16 a[78:79], v219 offset:32256
v_mfma_f32_16x16x32_bf16 v[204:207], a[84:87], a[20:23], v[204:207]
buffer_store_dwordx4 v[184:187], v244, s[20:23], s39 offen offset:2048
v_mfma_f32_16x16x32_bf16 v[200:203], a[84:87], a[4:7], v[200:203]
v_cvt_pk_bf16_f32 v192, v192, v193
v_cvt_pk_bf16_f32 v193, v194, v195
v_mfma_f32_16x16x32_bf16 v[200:203], a[80:83], a[0:3], v[200:203]
v_cvt_pk_bf16_f32 v194, v196, v197
v_cvt_pk_bf16_f32 v195, v198, v199
s_waitcnt lgkmcnt(8)
v_mfma_f32_16x16x32_bf16 v[200:203], a[88:91], a[8:11], v[200:203]
ds_read_b64_tr_b16 a[80:81], v222 offset:0
ds_read_b64_tr_b16 a[82:83], v222 offset:4608
v_mfma_f32_16x16x32_bf16 v[200:203], a[92:95], a[12:15], v[200:203]
buffer_store_dwordx4 v[192:195], v244, s[20:23], s39 offen offset:3072
v_mfma_f32_16x16x32_bf16 v[204:207], a[92:95], a[28:31], v[204:207]
ds_read_b64_tr_b16 a[156:157], v219 offset:128
ds_read_b64_tr_b16 a[158:159], v219 offset:4736
v_mfma_f32_16x16x32_bf16 v[204:207], a[88:91], a[24:27], v[204:207]
v_mul_f32 v53, v53, v59
v_cvt_pk_bf16_f32 v58, v52, v53
v_mfma_f32_16x16x32_bf16 v[208:211], a[88:91], a[40:43], v[208:211]
ds_read_b64_tr_b16 a[84:85], v222 offset:9216
ds_read_b64_tr_b16 a[86:87], v222 offset:13824
v_mfma_f32_16x16x32_bf16 v[208:211], a[92:95], a[44:47], v[208:211]
v_lshlrev_b32 v52, 16, v58
v_and_b32 v53, 0xffff0000, v58
v_mfma_f32_16x16x32_bf16 v[212:215], a[92:95], a[60:63], v[212:215]
ds_read_b64_tr_b16 a[160:161], v219 offset:9344
ds_read_b64_tr_b16 a[162:163], v219 offset:13952
v_mfma_f32_16x16x32_bf16 v[212:215], a[88:91], a[56:59], v[212:215]
v_accvgpr_read_b32 v55, a254
v_accvgpr_read_b32 v59, a152
s_waitcnt lgkmcnt(8)
v_mfma_f32_16x16x32_bf16 v[96:99], a[64:67], a[112:115], v[96:99]
ds_read_b64_tr_b16 a[88:89], v222 offset:18432
ds_read_b64_tr_b16 a[90:91], v222 offset:23040
v_mfma_f32_16x16x32_bf16 v[96:99], a[68:71], a[116:119], v[96:99]
v_lshlrev_b32 v54, 16, v55
v_and_b32 v55, 0xffff0000, v55
v_mfma_f32_16x16x32_bf16 v[88:91], a[68:71], a[100:103], v[88:91]
ds_read_b64_tr_b16 a[164:165], v219 offset:18560
ds_read_b64_tr_b16 a[166:167], v219 offset:23168
v_mfma_f32_16x16x32_bf16 v[88:91], a[64:67], a[96:99], v[88:91]
v_lshlrev_b32 v58, 16, v59
v_and_b32 v59, 0xffff0000, v59
v_mfma_f32_16x16x32_bf16 v[80:83], a[64:67], a[236:239], v[80:83]
ds_read_b64_tr_b16 a[92:93], v222 offset:27648
ds_read_b64_tr_b16 a[94:95], v222 offset:32256
v_mfma_f32_16x16x32_bf16 v[80:83], a[68:71], a[240:243], v[80:83]
v_add_f32 v54, v54, v58
v_add_f32 v55, v55, v59
v_mfma_f32_16x16x32_bf16 v[72:75], a[68:71], a[224:227], v[72:75]
ds_read_b64_tr_b16 a[168:169], v219 offset:27776
ds_read_b64_tr_b16 a[170:171], v219 offset:32384
v_mfma_f32_16x16x32_bf16 v[72:75], a[64:67], a[220:223], v[72:75]
v_cvt_pk_bf16_f32 v58, v54, v55
v_lshlrev_b32 v54, 16, v58
v_mfma_f32_16x16x32_bf16 v[72:75], a[72:75], a[228:231], v[72:75]
ds_read_b64_tr_b16 a[64:65], v219 offset:8
ds_read_b64_tr_b16 a[66:67], v219 offset:4616
v_mfma_f32_16x16x32_bf16 v[72:75], a[76:79], a[232:235], v[72:75]
s_add_u32 s39, s44, 8192
v_and_b32 v55, 0xffff0000, v58
v_mfma_f32_16x16x32_bf16 v[80:83], a[76:79], a[132:135], v[80:83]
ds_read_b64_tr_b16 a[172:173], v222 offset:128
ds_read_b64_tr_b16 a[174:175], v222 offset:4736
v_mfma_f32_16x16x32_bf16 v[80:83], a[72:75], a[128:131], v[80:83]
v_cvt_pk_bf16_f32 v200, v200, v201
v_cvt_pk_bf16_f32 v201, v202, v203
v_mfma_f32_16x16x32_bf16 v[88:91], a[72:75], a[104:107], v[88:91]
ds_read_b64_tr_b16 a[68:69], v219 offset:9224
ds_read_b64_tr_b16 a[70:71], v219 offset:13832
v_mfma_f32_16x16x32_bf16 v[88:91], a[76:79], a[108:111], v[88:91]
buffer_store_dwordx2 v[200:201], v226, s[20:23], s44 offen offset:0
v_mfma_f32_16x16x32_bf16 v[96:99], a[76:79], a[124:127], v[96:99]
ds_read_b64_tr_b16 a[176:177], v222 offset:9344
ds_read_b64_tr_b16 a[178:179], v222 offset:13952
v_mfma_f32_16x16x32_bf16 v[96:99], a[72:75], a[120:123], v[96:99]
v_cvt_pk_bf16_f32 v204, v204, v205
v_cvt_pk_bf16_f32 v205, v206, v207
s_waitcnt lgkmcnt(8)
v_mfma_f32_16x16x32_bf16 v[96:99], a[80:83], a[48:51], v[96:99]
ds_read_b64_tr_b16 a[72:73], v219 offset:18440
ds_read_b64_tr_b16 a[74:75], v219 offset:23048
v_mfma_f32_16x16x32_bf16 v[96:99], a[84:87], a[52:55], v[96:99]
buffer_store_dwordx2 v[204:205], v226, s[20:23], s44 offen offset:512
v_mfma_f32_16x16x32_bf16 v[88:91], a[84:87], a[36:39], v[88:91]
ds_read_b64_tr_b16 a[180:181], v222 offset:18560
ds_read_b64_tr_b16 a[182:183], v222 offset:23168
v_mfma_f32_16x16x32_bf16 v[88:91], a[80:83], a[32:35], v[88:91]
v_cvt_pk_bf16_f32 v208, v208, v209
v_cvt_pk_bf16_f32 v209, v210, v211
v_mfma_f32_16x16x32_bf16 v[80:83], a[80:83], a[16:19], v[80:83]
ds_read_b64_tr_b16 a[76:77], v219 offset:27656
ds_read_b64_tr_b16 a[78:79], v219 offset:32264
v_mfma_f32_16x16x32_bf16 v[80:83], a[84:87], a[20:23], v[80:83]
buffer_store_dwordx2 v[208:209], v226, s[20:23], s39 offen offset:0
v_mfma_f32_16x16x32_bf16 v[72:75], a[84:87], a[4:7], v[72:75]
ds_read_b64_tr_b16 a[184:185], v222 offset:27776
ds_read_b64_tr_b16 a[186:187], v222 offset:32384
v_mfma_f32_16x16x32_bf16 v[72:75], a[80:83], a[0:3], v[72:75]
v_cvt_pk_bf16_f32 v212, v212, v213
v_cvt_pk_bf16_f32 v213, v214, v215
v_mfma_f32_16x16x32_bf16 v[72:75], a[88:91], a[8:11], v[72:75]
ds_read_b64_tr_b16 a[80:81], v222 offset:8
ds_read_b64_tr_b16 a[82:83], v222 offset:4616
v_mfma_f32_16x16x32_bf16 v[72:75], a[92:95], a[12:15], v[72:75]
buffer_store_dwordx2 v[212:213], v226, s[20:23], s39 offen offset:512
v_mfma_f32_16x16x32_bf16 v[80:83], a[92:95], a[28:31], v[80:83]
ds_read_b64_tr_b16 a[188:189], v219 offset:136
ds_read_b64_tr_b16 a[190:191], v219 offset:4744
v_mfma_f32_16x16x32_bf16 v[80:83], a[88:91], a[24:27], v[80:83]
s_lshl2_add_u32 s28, s32, s95
v_mul_f32 v58, 0xbfb8aa3b, v54
v_mfma_f32_16x16x32_bf16 v[88:91], a[88:91], a[40:43], v[88:91]
ds_read_b64_tr_b16 a[84:85], v222 offset:9224
ds_read_b64_tr_b16 a[86:87], v222 offset:13832
v_mfma_f32_16x16x32_bf16 v[88:91], a[92:95], a[44:47], v[88:91]
v_mul_f32 v59, 0xbfb8aa3b, v55
v_mfma_f32_16x16x32_bf16 v[96:99], a[92:95], a[60:63], v[96:99]
ds_read_b64_tr_b16 a[192:193], v219 offset:9352
ds_read_b64_tr_b16 a[194:195], v219 offset:13960
v_mfma_f32_16x16x32_bf16 v[96:99], a[88:91], a[56:59], v[96:99]
v_exp_f32 v58, v58
s_waitcnt lgkmcnt(8)
v_mfma_f32_16x16x32_bf16 v[100:103], a[64:67], a[112:115], v[100:103]
ds_read_b64_tr_b16 a[88:89], v222 offset:18440
ds_read_b64_tr_b16 a[90:91], v222 offset:23048
v_mfma_f32_16x16x32_bf16 v[100:103], a[68:71], a[116:119], v[100:103]
v_exp_f32 v59, v59
v_mfma_f32_16x16x32_bf16 v[92:95], a[68:71], a[100:103], v[92:95]
ds_read_b64_tr_b16 a[196:197], v219 offset:18568
ds_read_b64_tr_b16 a[198:199], v219 offset:23176
v_mfma_f32_16x16x32_bf16 v[92:95], a[64:67], a[96:99], v[92:95]
v_add_f32 v58, 1.0, v58
v_add_f32 v59, 1.0, v59
v_mfma_f32_16x16x32_bf16 v[84:87], a[64:67], a[236:239], v[84:87]
ds_read_b64_tr_b16 a[92:93], v222 offset:27656
ds_read_b64_tr_b16 a[94:95], v222 offset:32264
v_mfma_f32_16x16x32_bf16 v[84:87], a[68:71], a[240:243], v[84:87]
v_rcp_f32 v58, v58
v_mfma_f32_16x16x32_bf16 v[76:79], a[68:71], a[224:227], v[76:79]
ds_read_b64_tr_b16 a[200:201], v219 offset:27784
ds_read_b64_tr_b16 a[202:203], v219 offset:32392
v_mfma_f32_16x16x32_bf16 v[76:79], a[64:67], a[220:223], v[76:79]
v_rcp_f32 v59, v59
v_mfma_f32_16x16x32_bf16 v[76:79], a[72:75], a[228:231], v[76:79]
v_mul_f32 v54, v54, v58
v_mul_f32 v55, v55, v59
v_mfma_f32_16x16x32_bf16 v[76:79], a[76:79], a[232:235], v[76:79]
v_cvt_pk_bf16_f32 v58, v54, v55
v_lshlrev_b32 v54, 16, v58
v_mfma_f32_16x16x32_bf16 v[84:87], a[76:79], a[132:135], v[84:87]
ds_read_b64_tr_b16 a[204:205], v222 offset:136
ds_read_b64_tr_b16 a[206:207], v222 offset:4744
v_mfma_f32_16x16x32_bf16 v[84:87], a[72:75], a[128:131], v[84:87]
v_and_b32 v55, 0xffff0000, v58
v_accvgpr_read_b32 v57, a255
v_mfma_f32_16x16x32_bf16 v[92:95], a[72:75], a[104:107], v[92:95]
v_accvgpr_read_b32 v59, a153
v_lshlrev_b32 v56, 16, v57
v_mfma_f32_16x16x32_bf16 v[92:95], a[76:79], a[108:111], v[92:95]
s_waitcnt vmcnt(0)
buffer_store_dword v231, v254, s[20:23], s28 offen
v_mfma_f32_16x16x32_bf16 v[100:103], a[76:79], a[124:127], v[100:103]
ds_read_b64_tr_b16 a[208:209], v222 offset:9352
ds_read_b64_tr_b16 a[210:211], v222 offset:13960
v_mfma_f32_16x16x32_bf16 v[100:103], a[72:75], a[120:123], v[100:103]
v_and_b32 v57, 0xffff0000, v57
v_lshlrev_b32 v58, 16, v59
s_waitcnt lgkmcnt(8)
v_mfma_f32_16x16x32_bf16 v[100:103], a[80:83], a[48:51], v[100:103]
v_and_b32 v59, 0xffff0000, v59
v_add_f32 v56, v56, v58
v_mfma_f32_16x16x32_bf16 v[100:103], a[84:87], a[52:55], v[100:103]
v_add_f32 v57, v57, v59
v_cvt_pk_bf16_f32 v58, v56, v57
v_mfma_f32_16x16x32_bf16 v[92:95], a[84:87], a[36:39], v[92:95]
ds_read_b64_tr_b16 a[212:213], v222 offset:18568
ds_read_b64_tr_b16 a[214:215], v222 offset:23176
v_mfma_f32_16x16x32_bf16 v[92:95], a[80:83], a[32:35], v[92:95]
v_lshlrev_b32 v56, 16, v58
v_and_b32 v57, 0xffff0000, v58
v_mfma_f32_16x16x32_bf16 v[84:87], a[80:83], a[16:19], v[84:87]
v_mul_f32 v58, 0xbfb8aa3b, v56
v_mul_f32 v59, 0xbfb8aa3b, v57
v_mfma_f32_16x16x32_bf16 v[84:87], a[84:87], a[20:23], v[84:87]
v_exp_f32 v58, v58
v_mfma_f32_16x16x32_bf16 v[76:79], a[84:87], a[4:7], v[76:79]
ds_read_b64_tr_b16 a[216:217], v222 offset:27784
ds_read_b64_tr_b16 a[218:219], v222 offset:32392
v_mfma_f32_16x16x32_bf16 v[76:79], a[80:83], a[0:3], v[76:79]
s_waitcnt vmcnt(1)
buffer_load_dword v230, v229, s[20:23], s95 offen sc0 sc1
v_mfma_f32_16x16x32_bf16 v[76:79], a[88:91], a[8:11], v[76:79]
v_exp_f32 v59, v59
s_waitcnt lgkmcnt(8)
v_mfma_f32_16x16x32_bf16 v[76:79], a[92:95], a[12:15], v[76:79]
v_add_f32 v58, 1.0, v58
v_add_f32 v59, 1.0, v59
v_mfma_f32_16x16x32_bf16 v[84:87], a[92:95], a[28:31], v[84:87]
v_rcp_f32 v58, v58
v_mfma_f32_16x16x32_bf16 v[84:87], a[88:91], a[24:27], v[84:87]
v_rcp_f32 v59, v59
v_mfma_f32_16x16x32_bf16 v[92:95], a[88:91], a[40:43], v[92:95]
v_mul_f32 v56, v56, v58
v_mul_f32 v57, v57, v59
v_mfma_f32_16x16x32_bf16 v[92:95], a[92:95], a[44:47], v[92:95]
v_cvt_pk_bf16_f32 v58, v56, v57
v_lshlrev_b32 v56, 16, v58
v_mfma_f32_16x16x32_bf16 v[100:103], a[92:95], a[60:63], v[100:103]
v_and_b32 v57, 0xffff0000, v58
v_accvgpr_read_b32 v19, a244
v_mfma_f32_16x16x32_bf16 v[100:103], a[88:91], a[56:59], v[100:103]
v_lshlrev_b32 v18, 16, v19
v_and_b32 v19, 0xffff0000, v19
v_mfma_f32_16x16x32_bf16 v[144:147], a[156:159], a[236:239], v[144:147]
v_accvgpr_read_b32 v21, a245
v_lshlrev_b32 v20, 16, v21
v_mfma_f32_16x16x32_bf16 v[144:147], a[160:163], a[240:243], v[144:147]
v_and_b32 v21, 0xffff0000, v21
v_accvgpr_read_b32 v23, a246
v_mfma_f32_16x16x32_bf16 v[144:147], a[164:167], a[128:131], v[144:147]
v_lshlrev_b32 v22, 16, v23
v_and_b32 v23, 0xffff0000, v23
v_mfma_f32_16x16x32_bf16 v[144:147], a[168:171], a[132:135], v[144:147]
v_accvgpr_read_b32 v25, a247
v_lshlrev_b32 v24, 16, v25
v_mfma_f32_16x16x32_bf16 v[144:147], a[172:175], a[16:19], v[144:147]
v_and_b32 v25, 0xffff0000, v25
v_accvgpr_read_b32 v27, a248
v_mfma_f32_16x16x32_bf16 v[144:147], a[176:179], a[20:23], v[144:147]
v_lshlrev_b32 v26, 16, v27
v_and_b32 v27, 0xffff0000, v27
v_mfma_f32_16x16x32_bf16 v[144:147], a[180:183], a[24:27], v[144:147]
v_accvgpr_read_b32 v29, a249
v_lshlrev_b32 v28, 16, v29
v_mfma_f32_16x16x32_bf16 v[144:147], a[184:187], a[28:31], v[144:147]
v_and_b32 v29, 0xffff0000, v29
v_accvgpr_read_b32 v31, a250
s_waitcnt lgkmcnt(0)
v_mfma_f32_16x16x32_bf16 v[148:151], a[216:219], a[28:31], v[148:151]
s_add_u32 s39, s44, 0
v_lshlrev_b32 v30, 16, v31
v_mfma_f32_16x16x32_bf16 v[148:151], a[212:215], a[24:27], v[148:151]
v_cvt_pk_bf16_f32 v80, v80, v81
v_cvt_pk_bf16_f32 v81, v82, v83
v_mfma_f32_16x16x32_bf16 v[148:151], a[208:211], a[20:23], v[148:151]
v_cvt_pk_bf16_f32 v82, v84, v85
v_cvt_pk_bf16_f32 v83, v86, v87
v_mfma_f32_16x16x32_bf16 v[148:151], a[204:207], a[16:19], v[148:151]
buffer_store_dwordx4 v[80:83], v244, s[20:23], s39 offen offset:1024
v_mfma_f32_16x16x32_bf16 v[148:151], a[200:203], a[132:135], v[148:151]
v_cvt_pk_bf16_f32 v88, v88, v89
v_cvt_pk_bf16_f32 v89, v90, v91
v_mfma_f32_16x16x32_bf16 v[148:151], a[196:199], a[128:131], v[148:151]
v_cvt_pk_bf16_f32 v90, v92, v93
v_cvt_pk_bf16_f32 v91, v94, v95
v_mfma_f32_16x16x32_bf16 v[148:151], a[192:195], a[240:243], v[148:151]
buffer_store_dwordx4 v[88:91], v244, s[20:23], s39 offen offset:2048
v_mfma_f32_16x16x32_bf16 v[148:151], a[188:191], a[236:239], v[148:151]
v_cvt_pk_bf16_f32 v96, v96, v97
v_cvt_pk_bf16_f32 v97, v98, v99
v_mfma_f32_16x16x32_bf16 v[156:159], a[188:191], a[96:99], v[156:159]
v_cvt_pk_bf16_f32 v98, v100, v101
v_cvt_pk_bf16_f32 v99, v102, v103
v_mfma_f32_16x16x32_bf16 v[156:159], a[192:195], a[100:103], v[156:159]
buffer_store_dwordx4 v[96:99], v244, s[20:23], s39 offen offset:3072
v_mfma_f32_16x16x32_bf16 v[156:159], a[196:199], a[104:107], v[156:159]
s_add_u32 s39, s44, 8192
v_and_b32 v31, 0xffff0000, v31
v_mfma_f32_16x16x32_bf16 v[156:159], a[200:203], a[108:111], v[156:159]
s_waitcnt vmcnt(3)
v_cmp_gt_u32 vcc, 1, v230
v_mfma_f32_16x16x32_bf16 v[156:159], a[204:207], a[32:35], v[156:159]
v_accvgpr_read_b32 v33, a251
v_lshlrev_b32 v32, 16, v33
v_mfma_f32_16x16x32_bf16 v[156:159], a[208:211], a[36:39], v[156:159]
s_and_b32 s29, vcc_lo, 0xff
s_cbranch_scc1 SP_P1A
SP_P1A_RET:
v_mfma_f32_16x16x32_bf16 v[156:159], a[212:215], a[40:43], v[156:159]
v_and_b32 v33, 0xffff0000, v33
v_accvgpr_read_b32 v35, a252
v_mfma_f32_16x16x32_bf16 v[156:159], a[216:219], a[44:47], v[156:159]
v_cvt_pk_bf16_f32 v144, v144, v145
v_cvt_pk_bf16_f32 v145, v146, v147
v_mfma_f32_16x16x32_bf16 v[152:155], a[184:187], a[44:47], v[152:155]
v_cvt_pk_bf16_f32 v146, v148, v149
v_cvt_pk_bf16_f32 v147, v150, v151
v_mfma_f32_16x16x32_bf16 v[152:155], a[180:183], a[40:43], v[152:155]
buffer_store_dwordx4 v[144:147], v244, s[20:23], s39 offen offset:1024
v_mfma_f32_16x16x32_bf16 v[152:155], a[176:179], a[36:39], v[152:155]
buffer_load_dwordx4 v[104:107], v244, s[20:23], s68 offen sc0 sc1
v_mfma_f32_16x16x32_bf16 v[152:155], a[172:175], a[32:35], v[152:155]
v_lshlrev_b32 v34, 16, v35
v_and_b32 v35, 0xffff0000, v35
v_mfma_f32_16x16x32_bf16 v[152:155], a[168:171], a[108:111], v[152:155]
v_accvgpr_read_b32 v37, a253
v_lshlrev_b32 v36, 16, v37
v_mfma_f32_16x16x32_bf16 v[152:155], a[164:167], a[104:107], v[152:155]
buffer_load_dwordx4 v[108:111], v244, s[20:23], s69 offen sc0 sc1
v_mfma_f32_16x16x32_bf16 v[152:155], a[160:163], a[100:103], v[152:155]
v_and_b32 v37, 0xffff0000, v37
v_mfma_f32_16x16x32_bf16 v[152:155], a[156:159], a[96:99], v[152:155]
s_mov_b32 s90, 0x3f80
s_mov_b32 s91, 0x3f800000
v_mfma_f32_16x16x32_bf16 v[160:163], a[156:159], a[112:115], v[160:163]
STUB_16:
s_cbranch_execz HOP_RET2
buffer_load_dwordx4 v[112:115], v244, s[20:23], s70 offen sc0 sc1
v_mfma_f32_16x16x32_bf16 v[160:163], a[160:163], a[116:119], v[160:163]
v_mov_b32 v66, 0
v_mov_b32 v67, 0
v_mfma_f32_16x16x32_bf16 v[160:163], a[164:167], a[120:123], v[160:163]
v_mov_b32 v68, 0
v_mov_b32 v69, 0
v_mfma_f32_16x16x32_bf16 v[160:163], a[168:171], a[124:127], v[160:163]
buffer_load_dwordx4 v[116:119], v244, s[20:23], s71 offen sc0 sc1
v_mfma_f32_16x16x32_bf16 v[160:163], a[172:175], a[48:51], v[160:163]
v_mfma_f32_16x16x32_bf16 v[160:163], a[176:179], a[52:55], v[160:163]
v_mfma_f32_16x16x32_bf16 v[160:163], a[180:183], a[56:59], v[160:163]
buffer_load_dwordx2 v[200:201], v226, s[20:23], s72 offen sc0 sc1
v_mfma_f32_16x16x32_bf16 v[160:163], a[184:187], a[60:63], v[160:163]
v_cvt_pk_bf16_f32 v152, v152, v153
v_cvt_pk_bf16_f32 v153, v154, v155
v_mfma_f32_16x16x32_bf16 v[164:167], a[216:219], a[60:63], v[164:167]
v_cvt_pk_bf16_f32 v154, v156, v157
v_cvt_pk_bf16_f32 v155, v158, v159
v_mfma_f32_16x16x32_bf16 v[164:167], a[212:215], a[56:59], v[164:167]
buffer_store_dwordx4 v[152:155], v244, s[20:23], s39 offen offset:2048
v_mfma_f32_16x16x32_bf16 v[164:167], a[208:211], a[52:55], v[164:167]
buffer_load_dwordx2 v[202:203], v226, s[20:23], s73 offen sc0 sc1
v_mfma_f32_16x16x32_bf16 v[164:167], a[204:207], a[48:51], v[164:167]
v_mfma_f32_16x16x32_bf16 v[164:167], a[200:203], a[124:127], v[164:167]
v_mfma_f32_16x16x32_bf16 v[164:167], a[196:199], a[120:123], v[164:167]
buffer_load_dwordx2 v[204:205], v226, s[20:23], s74 offen sc0 sc1
v_mfma_f32_16x16x32_bf16 v[164:167], a[192:195], a[116:119], v[164:167]
v_mfma_f32_16x16x32_bf16 v[164:167], a[188:191], a[112:115], v[164:167]
v_mfma_f32_16x16x32_bf16 v[140:143], a[188:191], a[220:223], v[140:143]
buffer_load_dwordx2 v[206:207], v226, s[20:23], s75 offen sc0 sc1
v_mfma_f32_16x16x32_bf16 v[140:143], a[192:195], a[224:227], v[140:143]
v_mfma_f32_16x16x32_bf16 v[140:143], a[196:199], a[228:231], v[140:143]
v_mfma_f32_16x16x32_bf16 v[140:143], a[200:203], a[232:235], v[140:143]
buffer_load_dwordx2 v[208:209], v226, s[20:23], s84 offen sc0 sc1
v_mfma_f32_16x16x32_bf16 v[140:143], a[204:207], a[0:3], v[140:143]
v_mfma_f32_16x16x32_bf16 v[140:143], a[208:211], a[4:7], v[140:143]
v_mfma_f32_16x16x32_bf16 v[140:143], a[212:215], a[8:11], v[140:143]
buffer_load_dwordx2 v[210:211], v226, s[20:23], s85 offen sc0 sc1
v_mfma_f32_16x16x32_bf16 v[140:143], a[216:219], a[12:15], v[140:143]
v_cvt_pk_bf16_f32 v160, v160, v161
v_cvt_pk_bf16_f32 v161, v162, v163
v_mfma_f32_16x16x32_bf16 v[136:139], a[184:187], a[12:15], v[136:139]
v_cvt_pk_bf16_f32 v162, v164, v165
v_cvt_pk_bf16_f32 v163, v166, v167
v_mfma_f32_16x16x32_bf16 v[136:139], a[180:183], a[8:11], v[136:139]
buffer_store_dwordx4 v[160:163], v244, s[20:23], s39 offen offset:3072
v_mfma_f32_16x16x32_bf16 v[136:139], a[176:179], a[4:7], v[136:139]
buffer_load_dwordx2 v[212:213], v226, s[20:23], s86 offen sc0 sc1
v_mfma_f32_16x16x32_bf16 v[136:139], a[172:175], a[0:3], v[136:139]
v_mfma_f32_16x16x32_bf16 v[136:139], a[168:171], a[232:235], v[136:139]
v_mfma_f32_16x16x32_bf16 v[136:139], a[164:167], a[228:231], v[136:139]
buffer_load_dwordx2 v[214:215], v226, s[20:23], s87 offen sc0 sc1
v_mfma_f32_16x16x32_bf16 v[136:139], a[160:163], a[224:227], v[136:139]
v_mfma_f32_16x16x32_bf16 v[136:139], a[156:159], a[220:223], v[136:139]
buffer_load_dwordx4 v[120:123], v243, s[20:23], s68 offen sc0 sc1
buffer_load_dwordx4 v[124:127], v243, s[20:23], s69 offen sc0 sc1
buffer_load_dwordx4 v[128:131], v243, s[20:23], s70 offen sc0 sc1
buffer_load_dwordx4 v[132:135], v243, s[20:23], s71 offen sc0 sc1
s_lshl_b32 s50, s34, 2
s_lshl_b32 s50, 15, s50
s_waitcnt vmcnt(6)
buffer_store_dword v246, v254, s[20:23], s28 offen
s_waitcnt vmcnt(18)
v_dot2c_f32_bf16 v72, s90, v104
v_dot2c_f32_bf16 v73, s91, v104
v_dot2c_f32_bf16 v74, s90, v105
v_dot2c_f32_bf16 v75, s91, v105
v_dot2c_f32_bf16 v76, s90, v106
v_dot2c_f32_bf16 v77, s91, v106
v_dot2c_f32_bf16 v78, s90, v107
v_dot2c_f32_bf16 v79, s91, v107
s_waitcnt vmcnt(17)
v_dot2c_f32_bf16 v72, s90, v108
v_dot2c_f32_bf16 v73, s91, v108
v_dot2c_f32_bf16 v74, s90, v109
v_dot2c_f32_bf16 v75, s91, v109
v_dot2c_f32_bf16 v76, s90, v110
v_dot2c_f32_bf16 v77, s91, v110
v_dot2c_f32_bf16 v78, s90, v111
v_dot2c_f32_bf16 v79, s91, v111
s_waitcnt vmcnt(16)
v_dot2c_f32_bf16 v72, s90, v112
v_dot2c_f32_bf16 v73, s91, v112
v_dot2c_f32_bf16 v74, s90, v113
v_dot2c_f32_bf16 v75, s91, v113
v_dot2c_f32_bf16 v76, s90, v114
v_dot2c_f32_bf16 v77, s91, v114
v_dot2c_f32_bf16 v78, s90, v115
v_dot2c_f32_bf16 v79, s91, v115
s_waitcnt vmcnt(15)
v_dot2c_f32_bf16 v72, s90, v116
v_dot2c_f32_bf16 v73, s91, v116
v_dot2c_f32_bf16 v74, s90, v117
v_dot2c_f32_bf16 v75, s91, v117
v_dot2c_f32_bf16 v76, s90, v118
v_dot2c_f32_bf16 v77, s91, v118
v_dot2c_f32_bf16 v78, s90, v119
v_dot2c_f32_bf16 v79, s91, v119
buffer_load_dword v230, v229, s[20:23], s95 offen sc0 sc1
s_waitcnt vmcnt(5)
v_dot2c_f32_bf16 v136, s90, v120
v_dot2c_f32_bf16 v137, s91, v120
v_dot2c_f32_bf16 v138, s90, v121
v_dot2c_f32_bf16 v139, s91, v121
v_dot2c_f32_bf16 v140, s90, v122
v_dot2c_f32_bf16 v141, s91, v122
v_dot2c_f32_bf16 v142, s90, v123
v_dot2c_f32_bf16 v143, s91, v123
s_waitcnt vmcnt(4)
v_dot2c_f32_bf16 v136, s90, v124
v_dot2c_f32_bf16 v137, s91, v124
v_dot2c_f32_bf16 v138, s90, v125
v_dot2c_f32_bf16 v139, s91, v125
v_dot2c_f32_bf16 v140, s90, v126
v_dot2c_f32_bf16 v141, s91, v126
v_dot2c_f32_bf16 v142, s90, v127
v_dot2c_f32_bf16 v143, s91, v127
s_waitcnt vmcnt(3)
v_dot2c_f32_bf16 v136, s90, v128
v_dot2c_f32_bf16 v137, s91, v128
v_dot2c_f32_bf16 v138, s90, v129
v_dot2c_f32_bf16 v139, s91, v129
v_dot2c_f32_bf16 v140, s90, v130
v_dot2c_f32_bf16 v141, s91, v130
v_dot2c_f32_bf16 v142, s90, v131
v_dot2c_f32_bf16 v143, s91, v131
s_waitcnt vmcnt(2)
v_dot2c_f32_bf16 v136, s90, v132
v_dot2c_f32_bf16 v137, s91, v132
v_dot2c_f32_bf16 v138, s90, v133
v_dot2c_f32_bf16 v139, s91, v133
v_dot2c_f32_bf16 v140, s90, v134
v_dot2c_f32_bf16 v141, s91, v134
v_dot2c_f32_bf16 v142, s90, v135
v_dot2c_f32_bf16 v143, s91, v135
s_waitcnt vmcnt(0)
v_cmp_gt_u32 vcc, 2, v230
s_nop 0
s_and_b32 s29, vcc_lo, s50
s_cbranch_scc0 SP_P2A_RET
SP_P2A:
s_sleep 0
s_add_u32 s100, s100, 1
s_bitcmp1_b32 s100, 19
s_cbranch_scc1 K_END
buffer_load_dword v230, v229, s[20:23], s95 offen sc0 sc1
s_waitcnt vmcnt(0)
v_cmp_gt_u32 vcc, 2, v230
s_nop 0
s_and_b32 s29, vcc_lo, s50
s_cbranch_scc1 SP_P2A
SP_P2A_RET:
buffer_load_dwordx4 v[168:171], v244, s[20:23], s65 offen sc0 sc1
buffer_load_dwordx4 v[172:175], v244, s[20:23], s66 offen sc0 sc1
buffer_load_dwordx4 v[176:179], v244, s[20:23], s67 offen sc0 sc1
buffer_load_dwordx4 v[180:183], v243, s[20:23], s65 offen sc0 sc1
buffer_load_dwordx4 v[184:187], v243, s[20:23], s66 offen sc0 sc1
buffer_load_dwordx4 v[188:191], v243, s[20:23], s67 offen sc0 sc1
s_waitcnt vmcnt(21)
v_dot2c_f32_bf16 v66, s90, v200
v_dot2c_f32_bf16 v67, s91, v200
v_dot2c_f32_bf16 v68, s90, v201
v_dot2c_f32_bf16 v69, s91, v201
s_waitcnt vmcnt(19)
v_dot2c_f32_bf16 v66, s90, v202
v_dot2c_f32_bf16 v67, s91, v202
v_dot2c_f32_bf16 v68, s90, v203
v_dot2c_f32_bf16 v69, s91, v203
s_waitcnt vmcnt(18)
v_dot2c_f32_bf16 v66, s90, v204
v_dot2c_f32_bf16 v67, s91, v204
v_dot2c_f32_bf16 v68, s90, v205
v_dot2c_f32_bf16 v69, s91, v205
s_waitcnt vmcnt(17)
v_dot2c_f32_bf16 v66, s90, v206
v_dot2c_f32_bf16 v67, s91, v206
v_dot2c_f32_bf16 v68, s90, v207
v_dot2c_f32_bf16 v69, s91, v207
s_waitcnt vmcnt(16)
v_dot2c_f32_bf16 v66, s90, v208
v_dot2c_f32_bf16 v67, s91, v208
v_dot2c_f32_bf16 v68, s90, v209
v_dot2c_f32_bf16 v69, s91, v209
s_waitcnt vmcnt(15)
v_dot2c_f32_bf16 v66, s90, v210
v_dot2c_f32_bf16 v67, s91, v210
v_dot2c_f32_bf16 v68, s90, v211
v_dot2c_f32_bf16 v69, s91, v211
s_waitcnt vmcnt(13)
v_dot2c_f32_bf16 v66, s90, v212
v_dot2c_f32_bf16 v67, s91, v212
v_dot2c_f32_bf16 v68, s90, v213
v_dot2c_f32_bf16 v69, s91, v213
s_waitcnt vmcnt(12)
v_dot2c_f32_bf16 v66, s90, v214
v_dot2c_f32_bf16 v67, s91, v214
v_dot2c_f32_bf16 v68, s90, v215
v_dot2c_f32_bf16 v69, s91, v215
s_cmp_eq_u32 s34, 0
s_cselect_b32 s29, 0, 0x7fbffff0
s_nop 2
v_cvt_pk_bf16_f32 v58, v66, v67
v_cvt_pk_bf16_f32 v59, v68, v69
v_lshlrev_b32 v66, 16, v58
v_and_b32 v67, 0xffff0000, v58
v_lshlrev_b32 v68, 16, v59
v_and_b32 v69, 0xffff0000, v59
v_pk_mul_f32 v[66:67], v[66:67], v[54:55]
v_pk_mul_f32 v[68:69], v[68:69], v[56:57]
v_cvt_pk_bf16_f32 v58, v66, v67
v_cvt_pk_bf16_f32 v59, v68, v69
v_lshlrev_b32 v66, 16, v58
v_and_b32 v67, 0xffff0000, v58
v_lshlrev_b32 v68, 16, v59
v_and_b32 v69, 0xffff0000, v59
v_pk_add_f32 v[66:67], v[66:67], v[34:35]
v_pk_add_f32 v[68:69], v[68:69], v[36:37]
v_cvt_pk_bf16_f32 v66, v66, v67
v_cvt_pk_bf16_f32 v67, v68, v69
buffer_store_dwordx2 v[66:67], v249, s[60:63], s29 offen
s_waitcnt vmcnt(6)
v_dot2c_f32_bf16 v72, s90, v168
v_dot2c_f32_bf16 v73, s91, v168
v_dot2c_f32_bf16 v74, s90, v169
v_dot2c_f32_bf16 v75, s91, v169
v_dot2c_f32_bf16 v76, s90, v170
v_dot2c_f32_bf16 v77, s91, v170
v_dot2c_f32_bf16 v78, s90, v171
v_dot2c_f32_bf16 v79, s91, v171
s_waitcnt vmcnt(5)
v_dot2c_f32_bf16 v72, s90, v172
v_dot2c_f32_bf16 v73, s91, v172
v_dot2c_f32_bf16 v74, s90, v173
v_dot2c_f32_bf16 v75, s91, v173
v_dot2c_f32_bf16 v76, s90, v174
v_dot2c_f32_bf16 v77, s91, v174
v_dot2c_f32_bf16 v78, s90, v175
v_dot2c_f32_bf16 v79, s91, v175
s_waitcnt vmcnt(4)
v_dot2c_f32_bf16 v72, s90, v176
v_dot2c_f32_bf16 v73, s91, v176
v_dot2c_f32_bf16 v74, s90, v177
v_dot2c_f32_bf16 v75, s91, v177
v_dot2c_f32_bf16 v76, s90, v178
v_dot2c_f32_bf16 v77, s91, v178
v_dot2c_f32_bf16 v78, s90, v179
v_dot2c_f32_bf16 v79, s91, v179
s_nop 2
v_cvt_pk_bf16_f32 v58, v72, v73
v_cvt_pk_bf16_f32 v59, v74, v75
v_cvt_pk_bf16_f32 v60, v76, v77
v_cvt_pk_bf16_f32 v61, v78, v79
v_lshlrev_b32 v72, 16, v58
v_and_b32 v73, 0xffff0000, v58
v_lshlrev_b32 v74, 16, v59
v_and_b32 v75, 0xffff0000, v59
v_lshlrev_b32 v76, 16, v60
v_and_b32 v77, 0xffff0000, v60
v_lshlrev_b32 v78, 16, v61
v_and_b32 v79, 0xffff0000, v61
v_pk_mul_f32 v[72:73], v[72:73], v[38:39]
v_pk_mul_f32 v[74:75], v[74:75], v[40:41]
v_pk_mul_f32 v[76:77], v[76:77], v[42:43]
v_pk_mul_f32 v[78:79], v[78:79], v[44:45]
v_cvt_pk_bf16_f32 v58, v72, v73
v_cvt_pk_bf16_f32 v59, v74, v75
v_cvt_pk_bf16_f32 v60, v76, v77
v_cvt_pk_bf16_f32 v61, v78, v79
v_lshlrev_b32 v72, 16, v58
v_and_b32 v73, 0xffff0000, v58
v_lshlrev_b32 v74, 16, v59
v_and_b32 v75, 0xffff0000, v59
v_lshlrev_b32 v76, 16, v60
v_and_b32 v77, 0xffff0000, v60
v_lshlrev_b32 v78, 16, v61
v_and_b32 v79, 0xffff0000, v61
v_pk_add_f32 v[72:73], v[72:73], v[18:19]
v_pk_add_f32 v[74:75], v[74:75], v[20:21]
v_pk_add_f32 v[76:77], v[76:77], v[22:23]
v_pk_add_f32 v[78:79], v[78:79], v[24:25]
v_cvt_pk_bf16_f32 v72, v72, v73
v_cvt_pk_bf16_f32 v73, v74, v75
v_cvt_pk_bf16_f32 v74, v76, v77
v_cvt_pk_bf16_f32 v75, v78, v79
buffer_store_dwordx4 v[72:75], v248, s[60:63], 0 offen
s_waitcnt vmcnt(4)
v_dot2c_f32_bf16 v136, s90, v180
v_dot2c_f32_bf16 v137, s91, v180
v_dot2c_f32_bf16 v138, s90, v181
v_dot2c_f32_bf16 v139, s91, v181
v_dot2c_f32_bf16 v140, s90, v182
v_dot2c_f32_bf16 v141, s91, v182
v_dot2c_f32_bf16 v142, s90, v183
v_dot2c_f32_bf16 v143, s91, v183
s_waitcnt vmcnt(3)
v_dot2c_f32_bf16 v136, s90, v184
v_dot2c_f32_bf16 v137, s91, v184
v_dot2c_f32_bf16 v138, s90, v185
v_dot2c_f32_bf16 v139, s91, v185
v_dot2c_f32_bf16 v140, s90, v186
v_dot2c_f32_bf16 v141, s91, v186
v_dot2c_f32_bf16 v142, s90, v187
v_dot2c_f32_bf16 v143, s91, v187
s_waitcnt vmcnt(2)
v_dot2c_f32_bf16 v136, s90, v188
v_dot2c_f32_bf16 v137, s91, v188
v_dot2c_f32_bf16 v138, s90, v189
v_dot2c_f32_bf16 v139, s91, v189
v_dot2c_f32_bf16 v140, s90, v190
v_dot2c_f32_bf16 v141, s91, v190
v_dot2c_f32_bf16 v142, s90, v191
v_dot2c_f32_bf16 v143, s91, v191
s_nop 2
v_cvt_pk_bf16_f32 v58, v136, v137
v_cvt_pk_bf16_f32 v59, v138, v139
v_cvt_pk_bf16_f32 v60, v140, v141
v_cvt_pk_bf16_f32 v61, v142, v143
v_lshlrev_b32 v136, 16, v58
v_and_b32 v137, 0xffff0000, v58
v_lshlrev_b32 v138, 16, v59
v_and_b32 v139, 0xffff0000, v59
v_lshlrev_b32 v140, 16, v60
v_and_b32 v141, 0xffff0000, v60
v_lshlrev_b32 v142, 16, v61
v_and_b32 v143, 0xffff0000, v61
v_pk_mul_f32 v[136:137], v[136:137], v[46:47]
v_pk_mul_f32 v[138:139], v[138:139], v[48:49]
v_pk_mul_f32 v[140:141], v[140:141], v[50:51]
v_pk_mul_f32 v[142:143], v[142:143], v[52:53]
v_cvt_pk_bf16_f32 v58, v136, v137
v_cvt_pk_bf16_f32 v59, v138, v139
v_cvt_pk_bf16_f32 v60, v140, v141
v_cvt_pk_bf16_f32 v61, v142, v143
v_lshlrev_b32 v136, 16, v58
v_and_b32 v137, 0xffff0000, v58
v_lshlrev_b32 v138, 16, v59
v_and_b32 v139, 0xffff0000, v59
v_lshlrev_b32 v140, 16, v60
v_and_b32 v141, 0xffff0000, v60
v_lshlrev_b32 v142, 16, v61
v_and_b32 v143, 0xffff0000, v61
v_pk_add_f32 v[136:137], v[136:137], v[26:27]
v_pk_add_f32 v[138:139], v[138:139], v[28:29]
v_pk_add_f32 v[140:141], v[140:141], v[30:31]
v_pk_add_f32 v[142:143], v[142:143], v[32:33]
v_cvt_pk_bf16_f32 v136, v136, v137
v_cvt_pk_bf16_f32 v137, v138, v139
v_cvt_pk_bf16_f32 v138, v140, v141
v_cvt_pk_bf16_f32 v139, v142, v143
buffer_store_dwordx4 v[136:139], v248, s[60:63], 0 offen offset:128
K_END:
s_endpgm
K_EVT:
STUB_17:
s_cbranch_execz HOP_RET2
s_sub_u32 s3, s33, 1
s_cmp_eq_u32 s33, 5
s_cbranch_scc0 EV_Y
s_sub_u32 s28, s40, 0
s_cmp_lt_u32 s28, 72
s_cselect_b32 s3, 4, 0
s_cmp_eq_u32 s37, 0
s_cbranch_scc0 K_EVT_RET
s_mov_b32 s28, 0x243000
EV_INC:
v_mov_b32 v246, 0
v_mov_b32 v247, 1
s_mov_b64 exec, 1
buffer_atomic_add v247, v246, s[20:23], s28 offen sc1
s_mov_b64 exec, -1
s_branch K_EVT_RET
EV_Y:
s_cmp_eq_u32 s33, 4
s_cbranch_scc0 EV_Y4
v_mov_b32 v246, 0
s_mov_b32 s28, 0x243000
buffer_load_dword v247, v246, s[20:23], s28 offen sc0 sc1
s_branch K_EVT_RET
EV_Y4:
s_cmp_eq_u32 s33, 1
s_cbranch_scc0 EV_Y5
s_mov_b32 s28, 0x243080
s_bitcmp0_b32 s37, 0
s_cbranch_scc1 EV_INC
s_branch K_EVT_RET
EV_Y5:
s_sub_u32 s29, s40, 0
s_lshr_b32 s28, s37, 1
s_lshl1_add_u32 s29, s29, s28
s_cmp_eq_u32 s33, 3
s_cbranch_scc0 EV_Y3
v_readfirstlane_b32 s28, v247
s_cmp_ge_u32 s28, 144
s_cbranch_scc0 EV_Y4SP
EV_Y4OK:
v_lshrrev_b32 v246, 3, v1
v_mul_u32_u24 v246, 18432, v246
v_and_b32 v247, 7, v1
v_lshl_add_u32 v246, v247, 4, v246
s_lshl_b32 s28, s29, 7
s_and_b32 s29, s37, 1
s_mul_i32 s29, s29, 1327104
s_add_u32 s28, s28, s29
s_add_u32 s28, s28, 0x2000000
buffer_load_dwordx4 v[120:123], v246, s[20:23], s28 offen sc0 sc1
s_add_u32 s28, s28, 147456
buffer_load_dwordx4 v[124:127], v246, s[20:23], s28 offen sc0 sc1
s_add_u32 s28, s28, 147456
buffer_load_dwordx4 v[128:131], v246, s[20:23], s28 offen sc0 sc1
s_add_u32 s28, s28, 147456
buffer_load_dwordx4 v[132:135], v246, s[20:23], s28 offen sc0 sc1
s_add_u32 s28, s28, 147456
buffer_load_dwordx4 v[248:251], v246, s[20:23], s28 offen sc0 sc1
s_add_u32 s28, s28, 147456
buffer_load_dwordx4 v[252:255], v246, s[20:23], s28 offen sc0 sc1
s_add_u32 s28, s28, 147456
buffer_load_dwordx4 a[136:139], v246, s[20:23], s28 offen sc0 sc1
s_add_u32 s28, s28, 147456
buffer_load_dwordx4 a[140:143], v246, s[20:23], s28 offen sc0 sc1
s_add_u32 s28, s28, 147456
buffer_load_dwordx4 a[244:247], v246, s[20:23], s28 offen sc0 sc1
s_branch K_EVT_RET
EV_Y3:
STUB_18:
s_cbranch_execz HOP_RET2
v_pk_add_f32 v[120:121], v[120:121], v[124:125]
v_pk_add_f32 v[122:123], v[122:123], v[126:127]
v_pk_add_f32 v[128:129], v[128:129], v[132:133]
v_pk_add_f32 v[130:131], v[130:131], v[134:135]
v_pk_add_f32 v[248:249], v[248:249], v[252:253]
v_pk_add_f32 v[250:251], v[250:251], v[254:255]
v_accvgpr_read_b32 v124, a136
v_accvgpr_read_b32 v125, a137
v_accvgpr_read_b32 v126, a138
v_accvgpr_read_b32 v127, a139
v_accvgpr_read_b32 v132, a140
v_accvgpr_read_b32 v133, a141
v_accvgpr_read_b32 v134, a142
v_accvgpr_read_b32 v135, a143
v_accvgpr_read_b32 v252, a244
v_accvgpr_read_b32 v253, a245
v_accvgpr_read_b32 v254, a246
v_accvgpr_read_b32 v255, a247
v_pk_add_f32 v[124:125], v[124:125], v[132:133]
v_pk_add_f32 v[126:127], v[126:127], v[134:135]
v_pk_add_f32 v[120:121], v[120:121], v[128:129]
v_pk_add_f32 v[122:123], v[122:123], v[130:131]
v_pk_add_f32 v[248:249], v[248:249], v[124:125]
v_pk_add_f32 v[250:251], v[250:251], v[126:127]
v_pk_add_f32 v[120:121], v[120:121], v[252:253]
v_pk_add_f32 v[122:123], v[122:123], v[254:255]
v_pk_add_f32 v[120:121], v[120:121], v[248:249]
v_pk_add_f32 v[122:123], v[122:123], v[250:251]
v_and_b32 v246, 7, v1
s_lshr_b32 s28, s37, 1
s_lshl_b32 s28, s28, 7
v_add_f32_dpp v124, v120, v120 row_ror:8 row_mask:0xf bank_mask:0xf
v_add_f32_dpp v125, v121, v121 row_ror:8 row_mask:0xf bank_mask:0xf
v_add_f32_dpp v126, v122, v122 row_ror:8 row_mask:0xf bank_mask:0xf
v_add_f32_dpp v127, v123, v123 row_ror:8 row_mask:0xf bank_mask:0xf
v_mov_b32 v120, v124
v_mov_b32 v121, v125
v_mov_b32 v122, v126
v_mov_b32 v123, v127
v_permlane16_swap_b32 v120, v124
v_permlane16_swap_b32 v121, v125
v_permlane16_swap_b32 v122, v126
v_permlane16_swap_b32 v123, v127
v_add_f32 v124, v120, v124
v_add_f32 v125, v121, v125
v_add_f32 v126, v122, v126
v_add_f32 v127, v123, v127
v_mov_b32 v120, v124
v_mov_b32 v121, v125
v_mov_b32 v122, v126
v_mov_b32 v123, v127
v_permlane32_swap_b32 v120, v124
v_permlane32_swap_b32 v121, v125
v_permlane32_swap_b32 v122, v126
v_permlane32_swap_b32 v123, v127
v_add_f32 v124, v120, v124
v_add_f32 v125, v121, v125
v_add_f32 v126, v122, v126
v_add_f32 v127, v123, v127
v_lshlrev_b32 v247, 4, v246
v_add_u32 v247, s28, v247
s_bitcmp1_b32 s37, 0
s_cbranch_scc0 EV_YE
ds_write_b128 v247, v[124:127] offset:65024
s_waitcnt lgkmcnt(0)
s_barrier
s_branch K_EVT_RET
EV_YE:
s_barrier
ds_read_b128 v[120:123], v247 offset:65024
v_mul_u32_u24 v246, 0x480, v246
s_lshl_b32 s28, s29, 3
s_add_u32 s28, s28, 0x244000
s_waitcnt lgkmcnt(0)
v_pk_add_f32 v[120:121], v[120:121], v[124:125]
v_pk_add_f32 v[122:123], v[122:123], v[126:127]
v_cvt_pk_bf16_f32 v124, v120, v121
v_cvt_pk_bf16_f32 v125, v122, v123
v_lshlrev_b32 v120, 16, v124
v_and_b32 v121, 0xffff0000, v124
v_lshlrev_b32 v122, 16, v125
v_and_b32 v123, 0xffff0000, v125
v_mul_f32 v120, v120, v236
v_mul_f32 v121, v121, v236
v_mul_f32 v122, v122, v236
v_mul_f32 v123, v123, v236
v_cvt_pk_bf16_f32 v124, v120, v121
v_cvt_pk_bf16_f32 v125, v122, v123
s_mov_b64 exec, 0xff
buffer_store_dwordx2 v[124:125], v246, s[20:23], s28 offen sc0 sc1
s_mov_b64 exec, -1
s_branch K_EVT_RET
SP_X0:
s_sleep 2
s_add_u32 s100, s100, 1
s_bitcmp1_b32 s100, 19
s_cbranch_scc1 K_END
buffer_load_dword v193, v192, s[24:27], 0 offen sc0 sc1
s_waitcnt vmcnt(0)
v_readfirstlane_b32 s92, v193
s_and_b32 s93, s92, 0xf0
s_cbranch_scc0 SP_X0
s_branch SP_X0_RET
SP_CAND:
s_sleep 2
s_add_u32 s100, s100, 1
s_bitcmp1_b32 s100, 19
s_cbranch_scc1 K_END
s_mov_b32 s29, 0x242000
buffer_load_dwordx2 v[248:249], v250, s[20:23], s29 offen sc0 sc1
s_waitcnt vmcnt(0)
v_cmp_ne_u32 vcc, s47, v249
s_cbranch_vccnz SP_CAND
s_branch SP_CAND_RET
SP_FL:
s_sleep 2
s_add_u32 s100, s100, 1
s_bitcmp1_b32 s100, 19
s_cbranch_scc1 K_END
buffer_load_dword v253, v246, s[24:27], 0 offen sc0 sc1
s_waitcnt vmcnt(0)
v_and_b32 v253, 0x20202020, v253
v_cmp_ne_u32 vcc, 0x20202020, v253
s_cbranch_vccnz SP_FL
s_branch SP_FL_RET
SP_FK:
s_sleep 4
s_add_u32 s100, s100, 1
s_bitcmp1_b32 s100, 19
s_cbranch_scc1 K_END
s_mov_b32 s93, 0x242800
buffer_load_dwordx2 v[120:121], v122, s[20:23], s93 offen sc0 sc1
s_waitcnt vmcnt(0)
v_cmp_ne_u32 vcc, s47, v121
s_cbranch_vccnz SP_FK
s_branch SP_FK_RET
SP_Y:
s_sleep 4
s_add_u32 s100, s100, 1
s_bitcmp1_b32 s100, 19
s_cbranch_scc1 K_END
s_mov_b32 s93, 0x243080
buffer_load_dword v246, v254, s[20:23], s93 offen sc0 sc1
s_waitcnt vmcnt(0)
v_readfirstlane_b32 s93, v246
s_cmp_lt_u32 s93, 144
s_cbranch_scc1 SP_Y
s_branch SP_Y_RET
SP_O1A:
s_sleep 1
s_add_u32 s100, s100, 1
s_bitcmp1_b32 s100, 19
s_cbranch_scc1 K_END
buffer_load_dword v230, v229, s[20:23], s94 offen sc0 sc1
s_waitcnt vmcnt(0)
v_cmp_gt_u32 vcc, 1, v230
s_bitcmp1_b32 vcc_lo, s39
s_cbranch_scc1 SP_O1A
s_branch SP_O1A_RET
SP_O2A:
s_sleep 1
s_add_u32 s100, s100, 1
s_bitcmp1_b32 s100, 19
s_cbranch_scc1 K_END
buffer_load_dword v230, v229, s[20:23], s94 offen sc0 sc1
s_waitcnt vmcnt(0)
v_cmp_gt_u32 vcc, 1, v230
s_and_b32 s29, vcc_lo, 15
s_cbranch_scc1 SP_O2A
s_branch SP_O2A_RET
SP_O3A:
s_sleep 1
s_add_u32 s100, s100, 1
s_bitcmp1_b32 s100, 19
s_cbranch_scc1 K_END
buffer_load_dword v230, v229, s[20:23], s94 offen sc0 sc1
s_waitcnt vmcnt(0)
v_cmp_gt_u32 vcc, 2, v230
s_and_b32 s29, vcc_lo, 15
s_cbranch_scc1 SP_O3A
s_branch SP_O3A_RET
SP_P1A:
s_sleep 1
s_add_u32 s100, s100, 1
s_bitcmp1_b32 s100, 19
s_cbranch_scc1 K_END
buffer_load_dword v230, v229, s[20:23], s95 offen sc0 sc1
s_waitcnt vmcnt(0)
v_cmp_gt_u32 vcc, 1, v230
s_and_b32 s29, vcc_lo, 0xff
s_cbranch_scc1 SP_P1A
s_branch SP_P1A_RET
EV_Y4SP:
s_sleep 8
s_add_u32 s100, s100, 1
s_bitcmp1_b32 s100, 19
s_cbranch_scc1 K_END
v_mov_b32 v246, 0
s_mov_b32 s28, 0x243000
buffer_load_dword v247, v246, s[20:23], s28 offen sc0 sc1
s_waitcnt vmcnt(0)
v_readfirstlane_b32 s28, v247
s_cmp_ge_u32 s28, 144
s_cbranch_scc0 EV_Y4SP
s_branch EV_Y4OK
K_HOT_END:
K_MIXED:
s_waitcnt lgkmcnt(0)
s_barrier
s_add_u32 s28, s30, 147456
v_smfmac_f32_16x16x64_bf16 a[128:131], a[208:211], v[72:79], v245
v_lshrrev_b32 v132, 1, v1
v_and_b32 v132, 8, v132
v_smfmac_f32_16x16x64_bf16 a[132:135], a[208:211], v[80:87], v245
v_xor_b32 v132, v132, v1
v_lshlrev_b32 v132, 4, v132
v_mfma_f32_16x16x32_bf16 a[0:3], v[72:75], a[212:215], a[0:3]
v_add_u32 v132, s28, v132
v_lshlrev_b32 v133, 3, v1
v_mfma_f32_16x16x32_bf16 a[16:19], v[72:75], a[216:219], a[16:19]
v_and_b32 v133, 8, v133
v_lshrrev_b32 v134, 2, v1
v_mfma_f32_16x16x32_bf16 a[32:35], v[72:75], a[220:223], a[32:35]
v_xor_b32 v133, v133, v134
v_and_b32 v134, 3, v1
v_mfma_f32_16x16x32_bf16 a[48:51], v[72:75], a[224:227], a[48:51]
v_lshl_add_u32 v133, v134, 4, v133
v_lshlrev_b32 v133, 4, v133
v_mfma_f32_16x16x32_bf16 a[64:67], v[72:75], a[228:231], a[64:67]
v_add_u32 v133, s28, v133
v_lshlrev_b32 v134, 2, v1
v_mfma_f32_16x16x32_bf16 a[80:83], v[72:75], a[232:235], a[80:83]
v_add_u32 v134, s28, v134
v_lshlrev_b32 v135, 4, v4
v_mfma_f32_16x16x32_bf16 a[96:99], v[72:75], a[236:239], a[96:99]
v_add_u32 v135, s28, v135
v_mfma_f32_16x16x32_bf16 a[112:115], v[72:75], a[240:243], a[112:115]
v_mfma_f32_16x16x32_bf16 a[4:7], v[76:79], a[212:215], a[4:7]
v_accvgpr_read_b32 v120, a128
v_accvgpr_read_b32 v124, a129
v_accvgpr_read_b32 v121, a130
v_mfma_f32_16x16x32_bf16 a[20:23], v[76:79], a[216:219], a[20:23]
v_accvgpr_read_b32 v125, a131
v_accvgpr_read_b32 v122, a132
v_accvgpr_read_b32 v126, a133
v_mfma_f32_16x16x32_bf16 a[36:39], v[76:79], a[220:223], a[36:39]
v_accvgpr_read_b32 v123, a134
v_accvgpr_read_b32 v127, a135
v_add_f32 v120, v120, v124
v_mfma_f32_16x16x32_bf16 a[52:55], v[76:79], a[224:227], a[52:55]
v_add_f32 v121, v121, v125
v_add_f32 v122, v122, v126
v_add_f32 v123, v123, v127
v_mfma_f32_16x16x32_bf16 a[68:71], v[76:79], a[228:231], a[68:71]
v_rcp_f32 v124, v120
v_rcp_f32 v125, v121
v_rcp_f32 v126, v122
v_mfma_f32_16x16x32_bf16 a[84:87], v[76:79], a[232:235], a[84:87]
v_rcp_f32 v127, v123
ds_write_b32 v134, v124 offset:0
ds_write_b32 v134, v125 offset:256
v_mfma_f32_16x16x32_bf16 a[100:103], v[76:79], a[236:239], a[100:103]
ds_write_b32 v134, v126 offset:512
ds_write_b32 v134, v127 offset:768
ds_read_b128 v[88:91], v135 offset:0
v_mfma_f32_16x16x32_bf16 a[116:119], v[76:79], a[240:243], a[116:119]
ds_read_b128 v[92:95], v135 offset:256
ds_read_b128 v[96:99], v135 offset:512
ds_read_b128 v[100:103], v135 offset:768
s_add_u32 s92, s44, 4096
s_add_u32 s93, s44, 8192
s_add_u32 s51, s44, 12288
v_mfma_f32_16x16x32_bf16 a[8:11], v[80:83], a[212:215], a[8:11]
v_accvgpr_read_b32 v104, a0
v_accvgpr_read_b32 v105, a1
v_accvgpr_read_b32 v106, a2
v_accvgpr_read_b32 v107, a3
v_mfma_f32_16x16x32_bf16 a[24:27], v[80:83], a[216:219], a[24:27]
v_accvgpr_read_b32 v108, a16
v_accvgpr_read_b32 v109, a17
v_accvgpr_read_b32 v110, a18
v_accvgpr_read_b32 v111, a19
s_waitcnt lgkmcnt(0)
v_pk_mul_f32 v[104:105], v[104:105], v[88:89]
v_pk_mul_f32 v[106:107], v[106:107], v[90:91]
v_pk_mul_f32 v[108:109], v[108:109], v[88:89]
v_pk_mul_f32 v[110:111], v[110:111], v[90:91]
v_cvt_pk_bf16_f32 v104, v104, v105
v_cvt_pk_bf16_f32 v105, v106, v107
v_cvt_pk_bf16_f32 v106, v108, v109
v_cvt_pk_bf16_f32 v107, v110, v111
v_mfma_f32_16x16x32_bf16 a[40:43], v[80:83], a[220:223], a[40:43]
v_accvgpr_read_b32 v112, a32
v_accvgpr_read_b32 v113, a33
v_accvgpr_read_b32 v114, a34
v_accvgpr_read_b32 v115, a35
ds_write_b128 v132, v[104:107] offset:0
v_mfma_f32_16x16x32_bf16 a[56:59], v[80:83], a[224:227], a[56:59]
v_accvgpr_read_b32 v116, a48
v_accvgpr_read_b32 v117, a49
v_accvgpr_read_b32 v118, a50
v_accvgpr_read_b32 v119, a51
ds_read_b64_tr_b16 v[8:9], v133 offset:0
ds_read_b64_tr_b16 v[10:11], v133 offset:8
v_pk_mul_f32 v[112:113], v[112:113], v[88:89]
v_pk_mul_f32 v[114:115], v[114:115], v[90:91]
v_pk_mul_f32 v[116:117], v[116:117], v[88:89]
v_pk_mul_f32 v[118:119], v[118:119], v[90:91]
v_cvt_pk_bf16_f32 v112, v112, v113
v_cvt_pk_bf16_f32 v113, v114, v115
v_cvt_pk_bf16_f32 v114, v116, v117
v_cvt_pk_bf16_f32 v115, v118, v119
v_mfma_f32_16x16x32_bf16 a[72:75], v[80:83], a[228:231], a[72:75]
v_accvgpr_read_b32 v104, a64
v_accvgpr_read_b32 v105, a65
v_accvgpr_read_b32 v106, a66
v_accvgpr_read_b32 v107, a67
ds_write_b128 v132, v[112:115] offset:1024
v_mfma_f32_16x16x32_bf16 a[88:91], v[80:83], a[232:235], a[88:91]
v_accvgpr_read_b32 v108, a80
v_accvgpr_read_b32 v109, a81
v_accvgpr_read_b32 v110, a82
v_accvgpr_read_b32 v111, a83
ds_read_b64_tr_b16 v[12:13], v133 offset:1024
ds_read_b64_tr_b16 v[14:15], v133 offset:1032
v_pk_mul_f32 v[104:105], v[104:105], v[88:89]
v_pk_mul_f32 v[106:107], v[106:107], v[90:91]
v_pk_mul_f32 v[108:109], v[108:109], v[88:89]
v_pk_mul_f32 v[110:111], v[110:111], v[90:91]
s_waitcnt lgkmcnt(3)
buffer_store_dwordx4 v[8:11], v244, s[20:23], s44 offen offset:0 sc0 sc1
v_cvt_pk_bf16_f32 v104, v104, v105
v_cvt_pk_bf16_f32 v105, v106, v107
v_cvt_pk_bf16_f32 v106, v108, v109
v_cvt_pk_bf16_f32 v107, v110, v111
v_mfma_f32_16x16x32_bf16 a[104:107], v[80:83], a[236:239], a[104:107]
v_accvgpr_read_b32 v112, a96
v_accvgpr_read_b32 v113, a97
v_accvgpr_read_b32 v114, a98
v_accvgpr_read_b32 v115, a99
ds_write_b128 v132, v[104:107] offset:2048
v_mfma_f32_16x16x32_bf16 a[120:123], v[80:83], a[240:243], a[120:123]
v_accvgpr_read_b32 v116, a112
v_accvgpr_read_b32 v117, a113
v_accvgpr_read_b32 v118, a114
v_accvgpr_read_b32 v119, a115
ds_read_b64_tr_b16 v[16:17], v133 offset:2048
ds_read_b64_tr_b16 v[18:19], v133 offset:2056
v_pk_mul_f32 v[112:113], v[112:113], v[88:89]
v_pk_mul_f32 v[114:115], v[114:115], v[90:91]
v_pk_mul_f32 v[116:117], v[116:117], v[88:89]
v_pk_mul_f32 v[118:119], v[118:119], v[90:91]
s_waitcnt lgkmcnt(3)
buffer_store_dwordx4 v[12:15], v244, s[20:23], s44 offen offset:1024 sc0 sc1
v_cvt_pk_bf16_f32 v112, v112, v113
v_cvt_pk_bf16_f32 v113, v114, v115
v_cvt_pk_bf16_f32 v114, v116, v117
v_cvt_pk_bf16_f32 v115, v118, v119
v_mfma_f32_16x16x32_bf16 a[12:15], v[84:87], a[212:215], a[12:15]
v_accvgpr_read_b32 v104, a4
v_accvgpr_read_b32 v105, a5
v_accvgpr_read_b32 v106, a6
v_accvgpr_read_b32 v107, a7
ds_write_b128 v132, v[112:115] offset:3072
v_mfma_f32_16x16x32_bf16 a[28:31], v[84:87], a[216:219], a[28:31]
v_accvgpr_read_b32 v108, a20
v_accvgpr_read_b32 v109, a21
v_accvgpr_read_b32 v110, a22
v_accvgpr_read_b32 v111, a23
ds_read_b64_tr_b16 v[20:21], v133 offset:3072
ds_read_b64_tr_b16 v[22:23], v133 offset:3080
v_pk_mul_f32 v[104:105], v[104:105], v[92:93]
v_pk_mul_f32 v[106:107], v[106:107], v[94:95]
v_pk_mul_f32 v[108:109], v[108:109], v[92:93]
v_pk_mul_f32 v[110:111], v[110:111], v[94:95]
s_waitcnt lgkmcnt(3)
buffer_store_dwordx4 v[16:19], v244, s[20:23], s44 offen offset:2048 sc0 sc1
v_cvt_pk_bf16_f32 v104, v104, v105
v_cvt_pk_bf16_f32 v105, v106, v107
v_cvt_pk_bf16_f32 v106, v108, v109
v_cvt_pk_bf16_f32 v107, v110, v111
v_mfma_f32_16x16x32_bf16 a[44:47], v[84:87], a[220:223], a[44:47]
v_accvgpr_read_b32 v112, a36
v_accvgpr_read_b32 v113, a37
v_accvgpr_read_b32 v114, a38
v_accvgpr_read_b32 v115, a39
ds_write_b128 v132, v[104:107] offset:0
v_mfma_f32_16x16x32_bf16 a[60:63], v[84:87], a[224:227], a[60:63]
v_accvgpr_read_b32 v116, a52
v_accvgpr_read_b32 v117, a53
v_accvgpr_read_b32 v118, a54
v_accvgpr_read_b32 v119, a55
ds_read_b64_tr_b16 v[24:25], v133 offset:0
ds_read_b64_tr_b16 v[26:27], v133 offset:8
v_pk_mul_f32 v[112:113], v[112:113], v[92:93]
v_pk_mul_f32 v[114:115], v[114:115], v[94:95]
v_pk_mul_f32 v[116:117], v[116:117], v[92:93]
v_pk_mul_f32 v[118:119], v[118:119], v[94:95]
s_waitcnt lgkmcnt(3)
buffer_store_dwordx4 v[20:23], v244, s[20:23], s44 offen offset:3072 sc0 sc1
v_cvt_pk_bf16_f32 v112, v112, v113
v_cvt_pk_bf16_f32 v113, v114, v115
v_cvt_pk_bf16_f32 v114, v116, v117
v_cvt_pk_bf16_f32 v115, v118, v119
v_mfma_f32_16x16x32_bf16 a[76:79], v[84:87], a[228:231], a[76:79]
v_accvgpr_read_b32 v104, a68
v_accvgpr_read_b32 v105, a69
v_accvgpr_read_b32 v106, a70
v_accvgpr_read_b32 v107, a71
ds_write_b128 v132, v[112:115] offset:1024
v_mfma_f32_16x16x32_bf16 a[92:95], v[84:87], a[232:235], a[92:95]
v_accvgpr_read_b32 v108, a84
v_accvgpr_read_b32 v109, a85
v_accvgpr_read_b32 v110, a86
v_accvgpr_read_b32 v111, a87
ds_read_b64_tr_b16 v[28:29], v133 offset:1024
ds_read_b64_tr_b16 v[30:31], v133 offset:1032
v_pk_mul_f32 v[104:105], v[104:105], v[92:93]
v_pk_mul_f32 v[106:107], v[106:107], v[94:95]
v_pk_mul_f32 v[108:109], v[108:109], v[92:93]
v_pk_mul_f32 v[110:111], v[110:111], v[94:95]
s_waitcnt lgkmcnt(3)
buffer_store_dwordx4 v[24:27], v244, s[20:23], s92 offen offset:0 sc0 sc1
v_cvt_pk_bf16_f32 v104, v104, v105
v_cvt_pk_bf16_f32 v105, v106, v107
v_cvt_pk_bf16_f32 v106, v108, v109
v_cvt_pk_bf16_f32 v107, v110, v111
v_mfma_f32_16x16x32_bf16 a[108:111], v[84:87], a[236:239], a[108:111]
v_accvgpr_read_b32 v112, a100
v_accvgpr_read_b32 v113, a101
v_accvgpr_read_b32 v114, a102
v_accvgpr_read_b32 v115, a103
ds_write_b128 v132, v[104:107] offset:2048
v_mfma_f32_16x16x32_bf16 a[124:127], v[84:87], a[240:243], a[124:127]
v_accvgpr_read_b32 v116, a116
v_accvgpr_read_b32 v117, a117
v_accvgpr_read_b32 v118, a118
v_accvgpr_read_b32 v119, a119
ds_read_b64_tr_b16 v[32:33], v133 offset:2048
ds_read_b64_tr_b16 v[34:35], v133 offset:2056
v_pk_mul_f32 v[112:113], v[112:113], v[92:93]
v_pk_mul_f32 v[114:115], v[114:115], v[94:95]
v_pk_mul_f32 v[116:117], v[116:117], v[92:93]
v_pk_mul_f32 v[118:119], v[118:119], v[94:95]
s_waitcnt lgkmcnt(3)
buffer_store_dwordx4 v[28:31], v244, s[20:23], s92 offen offset:1024 sc0 sc1
v_cvt_pk_bf16_f32 v112, v112, v113
v_cvt_pk_bf16_f32 v113, v114, v115
v_cvt_pk_bf16_f32 v114, v116, v117
v_cvt_pk_bf16_f32 v115, v118, v119
v_accvgpr_read_b32 v104, a8
v_accvgpr_read_b32 v105, a9
v_accvgpr_read_b32 v106, a10
v_accvgpr_read_b32 v107, a11
ds_write_b128 v132, v[112:115] offset:3072
v_accvgpr_read_b32 v108, a24
v_accvgpr_read_b32 v109, a25
v_accvgpr_read_b32 v110, a26
v_accvgpr_read_b32 v111, a27
ds_read_b64_tr_b16 v[36:37], v133 offset:3072
ds_read_b64_tr_b16 v[38:39], v133 offset:3080
v_pk_mul_f32 v[104:105], v[104:105], v[96:97]
v_pk_mul_f32 v[106:107], v[106:107], v[98:99]
v_pk_mul_f32 v[108:109], v[108:109], v[96:97]
v_pk_mul_f32 v[110:111], v[110:111], v[98:99]
s_waitcnt lgkmcnt(3)
buffer_store_dwordx4 v[32:35], v244, s[20:23], s92 offen offset:2048 sc0 sc1
v_cvt_pk_bf16_f32 v104, v104, v105
v_cvt_pk_bf16_f32 v105, v106, v107
v_cvt_pk_bf16_f32 v106, v108, v109
v_cvt_pk_bf16_f32 v107, v110, v111
v_accvgpr_read_b32 v112, a40
v_accvgpr_read_b32 v113, a41
v_accvgpr_read_b32 v114, a42
v_accvgpr_read_b32 v115, a43
ds_write_b128 v132, v[104:107] offset:0
v_accvgpr_read_b32 v116, a56
v_accvgpr_read_b32 v117, a57
v_accvgpr_read_b32 v118, a58
v_accvgpr_read_b32 v119, a59
ds_read_b64_tr_b16 v[40:41], v133 offset:0
ds_read_b64_tr_b16 v[42:43], v133 offset:8
v_pk_mul_f32 v[112:113], v[112:113], v[96:97]
v_pk_mul_f32 v[114:115], v[114:115], v[98:99]
v_pk_mul_f32 v[116:117], v[116:117], v[96:97]
v_pk_mul_f32 v[118:119], v[118:119], v[98:99]
s_waitcnt lgkmcnt(3)
buffer_store_dwordx4 v[36:39], v244, s[20:23], s92 offen offset:3072 sc0 sc1
v_cvt_pk_bf16_f32 v112, v112, v113
v_cvt_pk_bf16_f32 v113, v114, v115
v_cvt_pk_bf16_f32 v114, v116, v117
v_cvt_pk_bf16_f32 v115, v118, v119
v_accvgpr_read_b32 v104, a72
v_accvgpr_read_b32 v105, a73
v_accvgpr_read_b32 v106, a74
v_accvgpr_read_b32 v107, a75
ds_write_b128 v132, v[112:115] offset:1024
v_accvgpr_read_b32 v108, a88
v_accvgpr_read_b32 v109, a89
v_accvgpr_read_b32 v110, a90
v_accvgpr_read_b32 v111, a91
ds_read_b64_tr_b16 v[44:45], v133 offset:1024
ds_read_b64_tr_b16 v[46:47], v133 offset:1032
v_pk_mul_f32 v[104:105], v[104:105], v[96:97]
v_pk_mul_f32 v[106:107], v[106:107], v[98:99]
v_pk_mul_f32 v[108:109], v[108:109], v[96:97]
v_pk_mul_f32 v[110:111], v[110:111], v[98:99]
s_waitcnt lgkmcnt(3)
buffer_store_dwordx4 v[40:43], v244, s[20:23], s93 offen offset:0 sc0 sc1
v_cvt_pk_bf16_f32 v104, v104, v105
v_cvt_pk_bf16_f32 v105, v106, v107
v_cvt_pk_bf16_f32 v106, v108, v109
v_cvt_pk_bf16_f32 v107, v110, v111
v_accvgpr_read_b32 v112, a104
v_accvgpr_read_b32 v113, a105
v_accvgpr_read_b32 v114, a106
v_accvgpr_read_b32 v115, a107
ds_write_b128 v132, v[104:107] offset:2048
v_accvgpr_read_b32 v116, a120
v_accvgpr_read_b32 v117, a121
v_accvgpr_read_b32 v118, a122
v_accvgpr_read_b32 v119, a123
ds_read_b64_tr_b16 v[48:49], v133 offset:2048
ds_read_b64_tr_b16 v[50:51], v133 offset:2056
v_pk_mul_f32 v[112:113], v[112:113], v[96:97]
v_pk_mul_f32 v[114:115], v[114:115], v[98:99]
v_pk_mul_f32 v[116:117], v[116:117], v[96:97]
v_pk_mul_f32 v[118:119], v[118:119], v[98:99]
s_waitcnt lgkmcnt(3)
buffer_store_dwordx4 v[44:47], v244, s[20:23], s93 offen offset:1024 sc0 sc1
v_cvt_pk_bf16_f32 v112, v112, v113
v_cvt_pk_bf16_f32 v113, v114, v115
v_cvt_pk_bf16_f32 v114, v116, v117
v_cvt_pk_bf16_f32 v115, v118, v119
v_accvgpr_read_b32 v104, a12
v_accvgpr_read_b32 v105, a13
v_accvgpr_read_b32 v106, a14
v_accvgpr_read_b32 v107, a15
ds_write_b128 v132, v[112:115] offset:3072
v_accvgpr_read_b32 v108, a28
v_accvgpr_read_b32 v109, a29
v_accvgpr_read_b32 v110, a30
v_accvgpr_read_b32 v111, a31
ds_read_b64_tr_b16 v[52:53], v133 offset:3072
ds_read_b64_tr_b16 v[54:55], v133 offset:3080
v_pk_mul_f32 v[104:105], v[104:105], v[100:101]
v_pk_mul_f32 v[106:107], v[106:107], v[102:103]
v_pk_mul_f32 v[108:109], v[108:109], v[100:101]
v_pk_mul_f32 v[110:111], v[110:111], v[102:103]
s_waitcnt lgkmcnt(3)
buffer_store_dwordx4 v[48:51], v244, s[20:23], s93 offen offset:2048 sc0 sc1
v_cvt_pk_bf16_f32 v104, v104, v105
v_cvt_pk_bf16_f32 v105, v106, v107
v_cvt_pk_bf16_f32 v106, v108, v109
v_cvt_pk_bf16_f32 v107, v110, v111
v_accvgpr_read_b32 v112, a44
v_accvgpr_read_b32 v113, a45
v_accvgpr_read_b32 v114, a46
v_accvgpr_read_b32 v115, a47
ds_write_b128 v132, v[104:107] offset:0
v_accvgpr_read_b32 v116, a60
v_accvgpr_read_b32 v117, a61
v_accvgpr_read_b32 v118, a62
v_accvgpr_read_b32 v119, a63
ds_read_b64_tr_b16 v[56:57], v133 offset:0
ds_read_b64_tr_b16 v[58:59], v133 offset:8
v_pk_mul_f32 v[112:113], v[112:113], v[100:101]
v_pk_mul_f32 v[114:115], v[114:115], v[102:103]
v_pk_mul_f32 v[116:117], v[116:117], v[100:101]
v_pk_mul_f32 v[118:119], v[118:119], v[102:103]
s_waitcnt lgkmcnt(3)
buffer_store_dwordx4 v[52:55], v244, s[20:23], s93 offen offset:3072 sc0 sc1
v_cvt_pk_bf16_f32 v112, v112, v113
v_cvt_pk_bf16_f32 v113, v114, v115
v_cvt_pk_bf16_f32 v114, v116, v117
v_cvt_pk_bf16_f32 v115, v118, v119
v_accvgpr_read_b32 v104, a76
v_accvgpr_read_b32 v105, a77
v_accvgpr_read_b32 v106, a78
v_accvgpr_read_b32 v107, a79
ds_write_b128 v132, v[112:115] offset:1024
v_accvgpr_read_b32 v108, a92
v_accvgpr_read_b32 v109, a93
v_accvgpr_read_b32 v110, a94
v_accvgpr_read_b32 v111, a95
ds_read_b64_tr_b16 v[60:61], v133 offset:1024
ds_read_b64_tr_b16 v[62:63], v133 offset:1032
v_pk_mul_f32 v[104:105], v[104:105], v[100:101]
v_pk_mul_f32 v[106:107], v[106:107], v[102:103]
v_pk_mul_f32 v[108:109], v[108:109], v[100:101]
v_pk_mul_f32 v[110:111], v[110:111], v[102:103]
s_waitcnt lgkmcnt(3)
buffer_store_dwordx4 v[56:59], v244, s[20:23], s51 offen offset:0 sc0 sc1
v_cvt_pk_bf16_f32 v104, v104, v105
v_cvt_pk_bf16_f32 v105, v106, v107
v_cvt_pk_bf16_f32 v106, v108, v109
v_cvt_pk_bf16_f32 v107, v110, v111
v_accvgpr_read_b32 v112, a108
v_accvgpr_read_b32 v113, a109
v_accvgpr_read_b32 v114, a110
v_accvgpr_read_b32 v115, a111
ds_write_b128 v132, v[104:107] offset:2048
v_accvgpr_read_b32 v116, a124
v_accvgpr_read_b32 v117, a125
v_accvgpr_read_b32 v118, a126
v_accvgpr_read_b32 v119, a127
ds_read_b64_tr_b16 v[64:65], v133 offset:2048
ds_read_b64_tr_b16 v[66:67], v133 offset:2056
v_pk_mul_f32 v[112:113], v[112:113], v[100:101]
v_pk_mul_f32 v[114:115], v[114:115], v[102:103]
v_pk_mul_f32 v[116:117], v[116:117], v[100:101]
v_pk_mul_f32 v[118:119], v[118:119], v[102:103]
s_waitcnt lgkmcnt(3)
buffer_store_dwordx4 v[60:63], v244, s[20:23], s51 offen offset:1024 sc0 sc1
v_cvt_pk_bf16_f32 v112, v112, v113
v_cvt_pk_bf16_f32 v113, v114, v115
v_cvt_pk_bf16_f32 v114, v116, v117
v_cvt_pk_bf16_f32 v115, v118, v119
ds_write_b128 v132, v[112:115] offset:3072
ds_read_b64_tr_b16 v[68:69], v133 offset:3072
ds_read_b64_tr_b16 v[70:71], v133 offset:3080
s_waitcnt lgkmcnt(3)
buffer_store_dwordx4 v[64:67], v244, s[20:23], s51 offen offset:2048 sc0 sc1
v_max3_f32 v104, v120, v121, v122
v_max_f32 v104, v104, v123
v_add_f32 v105, v120, v121
v_add_f32 v105, v105, v122
v_add_f32 v105, v105, v123
v_cmp_nge_f32 vcc, s42, v104
v_cmp_u_f32 s[28:29], v105, v105
s_or_b64 vcc, vcc, s[28:29]
s_cmp_lg_u64 vcc, 0
s_cselect_b32 s28, 1, 0
v_mov_b32 v104, s28
v_mov_b32 v106, 147456
s_waitcnt lgkmcnt(0)
buffer_store_dwordx4 v[68:71], v244, s[20:23], s51 offen offset:3072 sc0 sc1
ds_write_b32 v134, v104
s_waitcnt vmcnt(16) lgkmcnt(0)
s_barrier
ds_read2st64_b32 v[110:111], v106 offset0:32 offset1:48
ds_read2st64_b32 v[108:109], v106 offset0:0 offset1:16
ds_read_b64_tr_b16 a[64:65], v237 offset:0
ds_read_b64_tr_b16 a[66:67], v237 offset:4608
ds_read_b64_tr_b16 a[68:69], v237 offset:9216
ds_read_b64_tr_b16 a[70:71], v237 offset:13824
ds_read_b64_tr_b16 a[72:73], v237 offset:8
ds_read_b64_tr_b16 a[74:75], v237 offset:4616
ds_read_b64_tr_b16 a[76:77], v237 offset:9224
ds_read_b64_tr_b16 a[78:79], v237 offset:13832
ds_read_b64_tr_b16 a[80:81], v238 offset:0
ds_read_b64_tr_b16 a[82:83], v238 offset:4608
ds_read_b64_tr_b16 a[84:85], v238 offset:9216
ds_read_b64_tr_b16 a[86:87], v238 offset:13824
s_waitcnt lgkmcnt(12)
v_or_b32 v108, v108, v109
v_or3_b32 v108, v108, v110, v111
s_nop 0
v_readfirstlane_b32 s28, v108
s_cmp_gt_u32 s28, s43
s_cbranch_scc1 K_FALLBACK
s_waitcnt lgkmcnt(8)
v_mfma_f32_16x16x32_bf16 v[96:99], a[64:67], v[56:59], 0
ds_read_b64_tr_b16 a[88:89], v238 offset:8
ds_read_b64_tr_b16 a[90:91], v238 offset:4616
v_mfma_f32_16x16x32_bf16 v[96:99], a[68:71], v[60:63], v[96:99]
s_lshr_b32 s32, s35, 2
s_and_b32 s33, s35, 3
v_mfma_f32_16x16x32_bf16 v[88:91], a[68:71], v[44:47], 0
s_lshl_b32 s94, s36, 9
s_lshl_b32 s28, s32, 6
v_mfma_f32_16x16x32_bf16 v[88:91], a[64:67], v[40:43], v[88:91]
s_lshr_b32 s34, s32, 2
v_mfma_f32_16x16x32_bf16 v[80:83], a[64:67], v[24:27], 0
ds_read_b64_tr_b16 a[92:93], v238 offset:9224
ds_read_b64_tr_b16 a[94:95], v238 offset:13832
v_mfma_f32_16x16x32_bf16 v[80:83], a[68:71], v[28:31], v[80:83]
s_add_u32 s94, s94, s28
s_lshl_b32 s28, s37, 4
v_mfma_f32_16x16x32_bf16 v[72:75], a[68:71], v[12:15], 0
s_add_u32 s94, s94, s28
s_add_u32 s94, s94, 0x248000
v_mfma_f32_16x16x32_bf16 v[72:75], a[64:67], v[8:11], v[72:75]
v_mov_b32 v231, 1
v_and_b32 v229, 7, v1
s_waitcnt lgkmcnt(8)
v_mfma_f32_16x16x32_bf16 v[76:79], a[72:75], v[8:11], 0
ds_read_b64_tr_b16 a[64:65], v237 offset:128
ds_read_b64_tr_b16 a[66:67], v237 offset:4736
v_mfma_f32_16x16x32_bf16 v[76:79], a[76:79], v[12:15], v[76:79]
v_lshlrev_b32 v229, 2, v229
v_lshlrev_b32 v226, 3, v1
v_mfma_f32_16x16x32_bf16 v[84:87], a[76:79], v[28:31], 0
s_lshl2_add_u32 s29, s33, s94
v_mfma_f32_16x16x32_bf16 v[84:87], a[72:75], v[24:27], v[84:87]
v_mfma_f32_16x16x32_bf16 v[92:95], a[72:75], v[40:43], 0
ds_read_b64_tr_b16 a[68:69], v237 offset:9344
ds_read_b64_tr_b16 a[70:71], v237 offset:13952
v_mfma_f32_16x16x32_bf16 v[92:95], a[76:79], v[44:47], v[92:95]
v_mfma_f32_16x16x32_bf16 v[100:103], a[76:79], v[60:63], 0
v_mfma_f32_16x16x32_bf16 v[100:103], a[72:75], v[56:59], v[100:103]
s_waitcnt lgkmcnt(8)
v_mfma_f32_16x16x32_bf16 v[128:131], a[80:83], v[56:59], 0
ds_read_b64_tr_b16 a[72:73], v237 offset:136
ds_read_b64_tr_b16 a[74:75], v237 offset:4744
v_mfma_f32_16x16x32_bf16 v[128:131], a[84:87], v[60:63], v[128:131]
v_mfma_f32_16x16x32_bf16 v[120:123], a[84:87], v[44:47], 0
v_mfma_f32_16x16x32_bf16 v[120:123], a[80:83], v[40:43], v[120:123]
v_mfma_f32_16x16x32_bf16 v[112:115], a[80:83], v[24:27], 0
ds_read_b64_tr_b16 a[76:77], v237 offset:9352
ds_read_b64_tr_b16 a[78:79], v237 offset:13960
v_mfma_f32_16x16x32_bf16 v[112:115], a[84:87], v[28:31], v[112:115]
s_waitcnt vmcnt(0)
buffer_store_dword v231, v254, s[20:23], s29 offen sc0 sc1
v_mfma_f32_16x16x32_bf16 v[104:107], a[84:87], v[12:15], 0
s_add_u32 s28, s35, 1
s_and_b32 s28, s28, 3
v_mfma_f32_16x16x32_bf16 v[104:107], a[80:83], v[8:11], v[104:107]
s_mul_i32 s28, s28, 36864
s_waitcnt lgkmcnt(8)
v_mfma_f32_16x16x32_bf16 v[108:111], a[88:91], v[8:11], 0
ds_read_b64_tr_b16 a[80:81], v238 offset:128
ds_read_b64_tr_b16 a[82:83], v238 offset:4736
v_mfma_f32_16x16x32_bf16 v[108:111], a[92:95], v[12:15], v[108:111]
v_add_u32 v216, s28, v234
v_add_u32 v217, s28, v235
v_mfma_f32_16x16x32_bf16 v[116:119], a[92:95], v[28:31], 0
v_add_u32 v218, s28, v236
v_mfma_f32_16x16x32_bf16 v[116:119], a[88:91], v[24:27], v[116:119]
v_mfma_f32_16x16x32_bf16 v[124:127], a[88:91], v[40:43], 0
ds_read_b64_tr_b16 a[84:85], v238 offset:9344
ds_read_b64_tr_b16 a[86:87], v238 offset:13952
v_mfma_f32_16x16x32_bf16 v[124:127], a[92:95], v[44:47], v[124:127]
v_mfma_f32_16x16x32_bf16 v[132:135], a[92:95], v[60:63], 0
v_mfma_f32_16x16x32_bf16 v[132:135], a[88:91], v[56:59], v[132:135]
s_waitcnt lgkmcnt(8)
v_mfma_f32_16x16x32_bf16 v[160:163], a[64:67], v[56:59], 0
ds_read_b64_tr_b16 a[88:89], v238 offset:136
ds_read_b64_tr_b16 a[90:91], v238 offset:4744
v_mfma_f32_16x16x32_bf16 v[160:163], a[68:71], v[60:63], v[160:163]
v_mfma_f32_16x16x32_bf16 v[152:155], a[68:71], v[44:47], 0
v_mfma_f32_16x16x32_bf16 v[152:155], a[64:67], v[40:43], v[152:155]
v_mfma_f32_16x16x32_bf16 v[144:147], a[64:67], v[24:27], 0
ds_read_b64_tr_b16 a[92:93], v238 offset:9352
ds_read_b64_tr_b16 a[94:95], v238 offset:13960
v_mfma_f32_16x16x32_bf16 v[144:147], a[68:71], v[28:31], v[144:147]
v_mfma_f32_16x16x32_bf16 v[136:139], a[68:71], v[12:15], 0
v_mfma_f32_16x16x32_bf16 v[136:139], a[64:67], v[8:11], v[136:139]
s_waitcnt lgkmcnt(8)
v_mfma_f32_16x16x32_bf16 v[140:143], a[72:75], v[8:11], 0
ds_read_b64_tr_b16 a[64:65], v239 offset:0
ds_read_b64_tr_b16 a[66:67], v239 offset:4608
v_mfma_f32_16x16x32_bf16 v[140:143], a[76:79], v[12:15], v[140:143]
buffer_load_dword v230, v229, s[20:23], s94 offen sc0 sc1
v_mfma_f32_16x16x32_bf16 v[148:151], a[76:79], v[28:31], 0
s_add_u32 s39, s35, 1
s_and_b32 s39, s39, 3
v_mfma_f32_16x16x32_bf16 v[148:151], a[72:75], v[24:27], v[148:151]
s_add_u32 s28, s33, 1
s_and_b32 s28, s28, 3
v_mfma_f32_16x16x32_bf16 v[156:159], a[72:75], v[40:43], 0
ds_read_b64_tr_b16 a[68:69], v239 offset:9216
ds_read_b64_tr_b16 a[70:71], v239 offset:13824
v_mfma_f32_16x16x32_bf16 v[156:159], a[76:79], v[44:47], v[156:159]
s_sub_u32 s28, s28, s33
s_lshl_b32 s28, s28, 16
v_mfma_f32_16x16x32_bf16 v[164:167], a[76:79], v[60:63], 0
s_add_u32 s64, s28, s44
s_add_u32 s65, s64, 4096
v_mfma_f32_16x16x32_bf16 v[164:167], a[72:75], v[56:59], v[164:167]
s_add_u32 s66, s64, 8192
s_add_u32 s67, s64, 12288
s_waitcnt lgkmcnt(8)
v_mfma_f32_16x16x32_bf16 v[192:195], a[80:83], v[56:59], 0
ds_read_b64_tr_b16 a[72:73], v237 offset:18432
ds_read_b64_tr_b16 a[74:75], v237 offset:23040
v_mfma_f32_16x16x32_bf16 v[192:195], a[84:87], v[60:63], v[192:195]
s_add_u32 s28, s35, 2
s_and_b32 s28, s28, 3
v_mfma_f32_16x16x32_bf16 v[184:187], a[84:87], v[44:47], 0
s_mul_i32 s28, s28, 36864
v_mfma_f32_16x16x32_bf16 v[184:187], a[80:83], v[40:43], v[184:187]
v_add_u32 v219, s28, v234
v_add_u32 v220, s28, v235
v_mfma_f32_16x16x32_bf16 v[176:179], a[80:83], v[24:27], 0
ds_read_b64_tr_b16 a[76:77], v237 offset:27648
ds_read_b64_tr_b16 a[78:79], v237 offset:32256
v_mfma_f32_16x16x32_bf16 v[176:179], a[84:87], v[28:31], v[176:179]
v_add_u32 v221, s28, v236
v_mfma_f32_16x16x32_bf16 v[168:171], a[84:87], v[12:15], 0
s_add_u32 s28, s35, 3
s_and_b32 s28, s28, 3
v_mfma_f32_16x16x32_bf16 v[168:171], a[80:83], v[8:11], v[168:171]
s_mul_i32 s28, s28, 36864
s_waitcnt lgkmcnt(8)
v_mfma_f32_16x16x32_bf16 v[172:175], a[88:91], v[8:11], 0
ds_read_b64_tr_b16 a[80:81], v237 offset:18440
ds_read_b64_tr_b16 a[82:83], v237 offset:23048
v_mfma_f32_16x16x32_bf16 v[172:175], a[92:95], v[12:15], v[172:175]
v_add_u32 v222, s28, v234
v_add_u32 v223, s28, v235
v_mfma_f32_16x16x32_bf16 v[180:183], a[92:95], v[28:31], 0
v_add_u32 v224, s28, v236
v_mfma_f32_16x16x32_bf16 v[180:183], a[88:91], v[24:27], v[180:183]
v_mfma_f32_16x16x32_bf16 v[188:191], a[88:91], v[40:43], 0
ds_read_b64_tr_b16 a[84:85], v237 offset:27656
ds_read_b64_tr_b16 a[86:87], v237 offset:32264
v_mfma_f32_16x16x32_bf16 v[188:191], a[92:95], v[44:47], v[188:191]
v_mfma_f32_16x16x32_bf16 v[196:199], a[92:95], v[60:63], 0
s_waitcnt vmcnt(0)
v_cmp_gt_u32 vcc, 1, v230
v_mfma_f32_16x16x32_bf16 v[196:199], a[88:91], v[56:59], v[196:199]
s_waitcnt lgkmcnt(8)
v_mfma_f32_16x16x32_bf16 v[212:215], a[64:67], v[56:59], 0
ds_read_b64_tr_b16 a[88:89], v238 offset:18432
ds_read_b64_tr_b16 a[90:91], v238 offset:23040
v_mfma_f32_16x16x32_bf16 v[212:215], a[68:71], v[60:63], v[212:215]
s_bitcmp1_b32 vcc_lo, s39
s_cbranch_scc1 SP_O1B
SP_O1B_RET:
v_mfma_f32_16x16x32_bf16 v[208:211], a[68:71], v[44:47], 0
buffer_load_dwordx4 a[156:159], v244, s[20:23], s64 offen offset:0 sc0 sc1
v_mfma_f32_16x16x32_bf16 v[208:211], a[64:67], v[40:43], v[208:211]
v_mfma_f32_16x16x32_bf16 v[204:207], a[64:67], v[24:27], 0
ds_read_b64_tr_b16 a[92:93], v238 offset:27648
ds_read_b64_tr_b16 a[94:95], v238 offset:32256
v_mfma_f32_16x16x32_bf16 v[204:207], a[68:71], v[28:31], v[204:207]
v_mfma_f32_16x16x32_bf16 v[200:203], a[68:71], v[12:15], 0
buffer_load_dwordx4 a[172:175], v244, s[20:23], s65 offen offset:0 sc0 sc1
v_mfma_f32_16x16x32_bf16 v[200:203], a[64:67], v[8:11], v[200:203]
s_waitcnt lgkmcnt(8)
v_mfma_f32_16x16x32_bf16 v[72:75], a[72:75], v[16:19], v[72:75]
ds_read_b64_tr_b16 a[64:65], v238 offset:18440
ds_read_b64_tr_b16 a[66:67], v238 offset:23048
v_mfma_f32_16x16x32_bf16 v[72:75], a[76:79], v[20:23], v[72:75]
v_mfma_f32_16x16x32_bf16 v[80:83], a[76:79], v[36:39], v[80:83]
buffer_load_dwordx4 a[188:191], v244, s[20:23], s66 offen offset:0 sc0 sc1
v_mfma_f32_16x16x32_bf16 v[80:83], a[72:75], v[32:35], v[80:83]
v_mfma_f32_16x16x32_bf16 v[88:91], a[72:75], v[48:51], v[88:91]
ds_read_b64_tr_b16 a[68:69], v238 offset:27656
ds_read_b64_tr_b16 a[70:71], v238 offset:32264
v_mfma_f32_16x16x32_bf16 v[88:91], a[76:79], v[52:55], v[88:91]
v_mfma_f32_16x16x32_bf16 v[96:99], a[76:79], v[68:71], v[96:99]
buffer_load_dwordx4 a[204:207], v244, s[20:23], s67 offen offset:0 sc0 sc1
v_mfma_f32_16x16x32_bf16 v[96:99], a[72:75], v[64:67], v[96:99]
s_waitcnt lgkmcnt(8)
v_mfma_f32_16x16x32_bf16 v[100:103], a[80:83], v[64:67], v[100:103]
ds_read_b64_tr_b16 a[72:73], v237 offset:18560
ds_read_b64_tr_b16 a[74:75], v237 offset:23168
v_mfma_f32_16x16x32_bf16 v[100:103], a[84:87], v[68:71], v[100:103]
v_mfma_f32_16x16x32_bf16 v[92:95], a[84:87], v[52:55], v[92:95]
buffer_load_dwordx4 a[160:163], v244, s[20:23], s64 offen offset:1024 sc0 sc1
v_mfma_f32_16x16x32_bf16 v[92:95], a[80:83], v[48:51], v[92:95]
v_mfma_f32_16x16x32_bf16 v[84:87], a[80:83], v[32:35], v[84:87]
ds_read_b64_tr_b16 a[76:77], v237 offset:27776
ds_read_b64_tr_b16 a[78:79], v237 offset:32384
v_mfma_f32_16x16x32_bf16 v[84:87], a[84:87], v[36:39], v[84:87]
v_mfma_f32_16x16x32_bf16 v[76:79], a[84:87], v[20:23], v[76:79]
buffer_load_dwordx4 a[176:179], v244, s[20:23], s65 offen offset:1024 sc0 sc1
v_mfma_f32_16x16x32_bf16 v[76:79], a[80:83], v[16:19], v[76:79]
s_waitcnt lgkmcnt(8)
v_mfma_f32_16x16x32_bf16 v[104:107], a[88:91], v[16:19], v[104:107]
ds_read_b64_tr_b16 a[80:81], v237 offset:18568
ds_read_b64_tr_b16 a[82:83], v237 offset:23176
v_mfma_f32_16x16x32_bf16 v[104:107], a[92:95], v[20:23], v[104:107]
v_mfma_f32_16x16x32_bf16 v[112:115], a[92:95], v[36:39], v[112:115]
buffer_load_dwordx4 a[192:195], v244, s[20:23], s66 offen offset:1024 sc0 sc1
v_mfma_f32_16x16x32_bf16 v[112:115], a[88:91], v[32:35], v[112:115]
v_mfma_f32_16x16x32_bf16 v[120:123], a[88:91], v[48:51], v[120:123]
ds_read_b64_tr_b16 a[84:85], v237 offset:27784
ds_read_b64_tr_b16 a[86:87], v237 offset:32392
v_mfma_f32_16x16x32_bf16 v[120:123], a[92:95], v[52:55], v[120:123]
v_mfma_f32_16x16x32_bf16 v[128:131], a[92:95], v[68:71], v[128:131]
buffer_load_dwordx4 a[208:211], v244, s[20:23], s67 offen offset:1024 sc0 sc1
v_mfma_f32_16x16x32_bf16 v[128:131], a[88:91], v[64:67], v[128:131]
s_waitcnt lgkmcnt(8)
v_mfma_f32_16x16x32_bf16 v[132:135], a[64:67], v[64:67], v[132:135]
ds_read_b64_tr_b16 a[88:89], v238 offset:18560
ds_read_b64_tr_b16 a[90:91], v238 offset:23168
v_mfma_f32_16x16x32_bf16 v[132:135], a[68:71], v[68:71], v[132:135]
v_mfma_f32_16x16x32_bf16 v[124:127], a[68:71], v[52:55], v[124:127]
buffer_load_dwordx4 a[164:167], v244, s[20:23], s64 offen offset:2048 sc0 sc1
v_mfma_f32_16x16x32_bf16 v[124:127], a[64:67], v[48:51], v[124:127]
buffer_load_dword v230, v229, s[20:23], s94 offen sc0 sc1
v_mfma_f32_16x16x32_bf16 v[116:119], a[64:67], v[32:35], v[116:119]
ds_read_b64_tr_b16 a[92:93], v238 offset:27776
ds_read_b64_tr_b16 a[94:95], v238 offset:32384
v_mfma_f32_16x16x32_bf16 v[116:119], a[68:71], v[36:39], v[116:119]
v_mfma_f32_16x16x32_bf16 v[108:111], a[68:71], v[20:23], v[108:111]
v_mfma_f32_16x16x32_bf16 v[108:111], a[64:67], v[16:19], v[108:111]
buffer_load_dwordx4 a[180:183], v244, s[20:23], s65 offen offset:2048 sc0 sc1
s_waitcnt lgkmcnt(8)
v_mfma_f32_16x16x32_bf16 v[136:139], a[72:75], v[16:19], v[136:139]
ds_read_b64_tr_b16 a[64:65], v238 offset:18568
ds_read_b64_tr_b16 a[66:67], v238 offset:23176
v_mfma_f32_16x16x32_bf16 v[136:139], a[76:79], v[20:23], v[136:139]
v_mfma_f32_16x16x32_bf16 v[144:147], a[76:79], v[36:39], v[144:147]
v_mfma_f32_16x16x32_bf16 v[144:147], a[72:75], v[32:35], v[144:147]
buffer_load_dwordx4 a[196:199], v244, s[20:23], s66 offen offset:2048 sc0 sc1
v_mfma_f32_16x16x32_bf16 v[152:155], a[72:75], v[48:51], v[152:155]
ds_read_b64_tr_b16 a[68:69], v238 offset:27784
ds_read_b64_tr_b16 a[70:71], v238 offset:32392
v_mfma_f32_16x16x32_bf16 v[152:155], a[76:79], v[52:55], v[152:155]
v_mfma_f32_16x16x32_bf16 v[160:163], a[76:79], v[68:71], v[160:163]
v_mfma_f32_16x16x32_bf16 v[160:163], a[72:75], v[64:67], v[160:163]
buffer_load_dwordx4 a[212:215], v244, s[20:23], s67 offen offset:2048 sc0 sc1
s_waitcnt lgkmcnt(8)
v_mfma_f32_16x16x32_bf16 v[164:167], a[80:83], v[64:67], v[164:167]
ds_read_b64_tr_b16 a[72:73], v239 offset:18432
ds_read_b64_tr_b16 a[74:75], v239 offset:23040
v_mfma_f32_16x16x32_bf16 v[164:167], a[84:87], v[68:71], v[164:167]
v_mfma_f32_16x16x32_bf16 v[156:159], a[84:87], v[52:55], v[156:159]
v_mfma_f32_16x16x32_bf16 v[156:159], a[80:83], v[48:51], v[156:159]
buffer_load_dwordx4 a[168:171], v244, s[20:23], s64 offen offset:3072 sc0 sc1
v_mfma_f32_16x16x32_bf16 v[148:151], a[80:83], v[32:35], v[148:151]
ds_read_b64_tr_b16 a[76:77], v239 offset:27648
ds_read_b64_tr_b16 a[78:79], v239 offset:32256
v_mfma_f32_16x16x32_bf16 v[148:151], a[84:87], v[36:39], v[148:151]
v_mfma_f32_16x16x32_bf16 v[140:143], a[84:87], v[20:23], v[140:143]
v_mfma_f32_16x16x32_bf16 v[140:143], a[80:83], v[16:19], v[140:143]
buffer_load_dwordx4 a[184:187], v244, s[20:23], s65 offen offset:3072 sc0 sc1
s_waitcnt lgkmcnt(8)
v_mfma_f32_16x16x32_bf16 v[168:171], a[88:91], v[16:19], v[168:171]
ds_read_b64_tr_b16 a[80:81], v216 offset:0
ds_read_b64_tr_b16 a[82:83], v216 offset:4608
v_mfma_f32_16x16x32_bf16 v[168:171], a[92:95], v[20:23], v[168:171]
v_mfma_f32_16x16x32_bf16 v[176:179], a[92:95], v[36:39], v[176:179]
v_mfma_f32_16x16x32_bf16 v[176:179], a[88:91], v[32:35], v[176:179]
buffer_load_dwordx4 a[200:203], v244, s[20:23], s66 offen offset:3072 sc0 sc1
v_mfma_f32_16x16x32_bf16 v[184:187], a[88:91], v[48:51], v[184:187]
ds_read_b64_tr_b16 a[84:85], v216 offset:9216
ds_read_b64_tr_b16 a[86:87], v216 offset:13824
v_mfma_f32_16x16x32_bf16 v[184:187], a[92:95], v[52:55], v[184:187]
v_mfma_f32_16x16x32_bf16 v[192:195], a[92:95], v[68:71], v[192:195]
v_mfma_f32_16x16x32_bf16 v[192:195], a[88:91], v[64:67], v[192:195]
buffer_load_dwordx4 a[216:219], v244, s[20:23], s67 offen offset:3072 sc0 sc1
s_waitcnt lgkmcnt(8)
v_mfma_f32_16x16x32_bf16 v[196:199], a[64:67], v[64:67], v[196:199]
ds_read_b64_tr_b16 a[88:89], v216 offset:8
ds_read_b64_tr_b16 a[90:91], v216 offset:4616
v_mfma_f32_16x16x32_bf16 v[196:199], a[68:71], v[68:71], v[196:199]
s_add_u32 s28, s33, 2
s_and_b32 s28, s28, 3
v_mfma_f32_16x16x32_bf16 v[188:191], a[68:71], v[52:55], v[188:191]
s_sub_u32 s28, s28, s33
s_lshl_b32 s28, s28, 16
v_mfma_f32_16x16x32_bf16 v[188:191], a[64:67], v[48:51], v[188:191]
s_add_u32 s64, s28, s44
s_add_u32 s65, s64, 4096
v_mfma_f32_16x16x32_bf16 v[180:183], a[64:67], v[32:35], v[180:183]
ds_read_b64_tr_b16 a[92:93], v216 offset:9224
ds_read_b64_tr_b16 a[94:95], v216 offset:13832
v_mfma_f32_16x16x32_bf16 v[180:183], a[68:71], v[36:39], v[180:183]
s_add_u32 s66, s64, 8192
s_add_u32 s67, s64, 12288
v_mfma_f32_16x16x32_bf16 v[172:175], a[68:71], v[20:23], v[172:175]
s_waitcnt vmcnt(7)
v_cmp_gt_u32 vcc, 1, v230
v_mfma_f32_16x16x32_bf16 v[172:175], a[64:67], v[16:19], v[172:175]
s_waitcnt lgkmcnt(8)
v_mfma_f32_16x16x32_bf16 v[200:203], a[72:75], v[16:19], v[200:203]
ds_read_b64_tr_b16 a[64:65], v217 offset:0
ds_read_b64_tr_b16 a[66:67], v217 offset:4608
v_mfma_f32_16x16x32_bf16 v[200:203], a[76:79], v[20:23], v[200:203]
s_and_b32 s29, vcc_lo, 15
s_cbranch_scc1 SP_O2B
SP_O2B_RET:
v_mfma_f32_16x16x32_bf16 v[204:207], a[76:79], v[36:39], v[204:207]
buffer_load_dwordx4 a[220:223], v244, s[20:23], s64 offen offset:0 sc0 sc1
v_mfma_f32_16x16x32_bf16 v[204:207], a[72:75], v[32:35], v[204:207]
v_mfma_f32_16x16x32_bf16 v[208:211], a[72:75], v[48:51], v[208:211]
ds_read_b64_tr_b16 a[68:69], v217 offset:9216
ds_read_b64_tr_b16 a[70:71], v217 offset:13824
v_mfma_f32_16x16x32_bf16 v[208:211], a[76:79], v[52:55], v[208:211]
v_mfma_f32_16x16x32_bf16 v[212:215], a[76:79], v[68:71], v[212:215]
buffer_load_dwordx4 a[236:239], v244, s[20:23], s65 offen offset:0 sc0 sc1
v_mfma_f32_16x16x32_bf16 v[212:215], a[72:75], v[64:67], v[212:215]
s_waitcnt vmcnt(15)
s_waitcnt lgkmcnt(8)
v_mfma_f32_16x16x32_bf16 v[96:99], a[80:83], a[204:207], v[96:99]
ds_read_b64_tr_b16 a[72:73], v217 offset:8
ds_read_b64_tr_b16 a[74:75], v217 offset:4616
s_waitcnt vmcnt(11)
v_mfma_f32_16x16x32_bf16 v[96:99], a[84:87], a[208:211], v[96:99]
v_mfma_f32_16x16x32_bf16 v[88:91], a[84:87], a[192:195], v[88:91]
buffer_load_dwordx4 a[96:99], v244, s[20:23], s66 offen offset:0 sc0 sc1
v_mfma_f32_16x16x32_bf16 v[88:91], a[80:83], a[188:191], v[88:91]
v_accvgpr_read_b32 v39, a136
v_accvgpr_read_b32 v59, a144
v_mfma_f32_16x16x32_bf16 v[80:83], a[80:83], a[172:175], v[80:83]
ds_read_b64_tr_b16 a[76:77], v217 offset:9224
ds_read_b64_tr_b16 a[78:79], v217 offset:13832
v_mfma_f32_16x16x32_bf16 v[80:83], a[84:87], a[176:179], v[80:83]
v_lshlrev_b32 v38, 16, v39
v_and_b32 v39, 0xffff0000, v39
v_mfma_f32_16x16x32_bf16 v[72:75], a[84:87], a[160:163], v[72:75]
buffer_load_dwordx4 a[112:115], v244, s[20:23], s67 offen offset:0 sc0 sc1
v_mfma_f32_16x16x32_bf16 v[72:75], a[80:83], a[156:159], v[72:75]
v_lshlrev_b32 v58, 16, v59
v_and_b32 v59, 0xffff0000, v59
s_waitcnt lgkmcnt(8)
v_mfma_f32_16x16x32_bf16 v[76:79], a[88:91], a[156:159], v[76:79]
ds_read_b64_tr_b16 a[80:81], v216 offset:128
ds_read_b64_tr_b16 a[82:83], v216 offset:4736
v_mfma_f32_16x16x32_bf16 v[76:79], a[92:95], a[160:163], v[76:79]
v_add_f32 v38, v38, v58
v_add_f32 v39, v39, v59
v_mfma_f32_16x16x32_bf16 v[84:87], a[92:95], a[176:179], v[84:87]
buffer_load_dwordx4 a[224:227], v244, s[20:23], s64 offen offset:1024 sc0 sc1
v_mfma_f32_16x16x32_bf16 v[84:87], a[88:91], a[172:175], v[84:87]
v_cvt_pk_bf16_f32 v58, v38, v39
v_lshlrev_b32 v38, 16, v58
v_mfma_f32_16x16x32_bf16 v[92:95], a[88:91], a[188:191], v[92:95]
ds_read_b64_tr_b16 a[84:85], v216 offset:9344
ds_read_b64_tr_b16 a[86:87], v216 offset:13952
v_mfma_f32_16x16x32_bf16 v[92:95], a[92:95], a[192:195], v[92:95]
v_and_b32 v39, 0xffff0000, v58
v_mul_f32 v58, 0xbfb8aa3b, v38
v_mfma_f32_16x16x32_bf16 v[100:103], a[92:95], a[208:211], v[100:103]
buffer_load_dwordx4 a[240:243], v244, s[20:23], s65 offen offset:1024 sc0 sc1
v_mfma_f32_16x16x32_bf16 v[100:103], a[88:91], a[204:207], v[100:103]
v_mul_f32 v59, 0xbfb8aa3b, v39
s_waitcnt lgkmcnt(8)
v_mfma_f32_16x16x32_bf16 v[128:131], a[64:67], a[204:207], v[128:131]
ds_read_b64_tr_b16 a[88:89], v216 offset:136
ds_read_b64_tr_b16 a[90:91], v216 offset:4744
v_mfma_f32_16x16x32_bf16 v[128:131], a[68:71], a[208:211], v[128:131]
v_exp_f32 v58, v58
v_mfma_f32_16x16x32_bf16 v[120:123], a[68:71], a[192:195], v[120:123]
buffer_load_dwordx4 a[100:103], v244, s[20:23], s66 offen offset:1024 sc0 sc1
v_mfma_f32_16x16x32_bf16 v[120:123], a[64:67], a[188:191], v[120:123]
v_exp_f32 v59, v59
v_mfma_f32_16x16x32_bf16 v[112:115], a[64:67], a[172:175], v[112:115]
ds_read_b64_tr_b16 a[92:93], v216 offset:9352
ds_read_b64_tr_b16 a[94:95], v216 offset:13960
v_mfma_f32_16x16x32_bf16 v[112:115], a[68:71], a[176:179], v[112:115]
v_add_f32 v58, 1.0, v58
v_add_f32 v59, 1.0, v59
v_mfma_f32_16x16x32_bf16 v[104:107], a[68:71], a[160:163], v[104:107]
buffer_load_dwordx4 a[116:119], v244, s[20:23], s67 offen offset:1024 sc0 sc1
v_mfma_f32_16x16x32_bf16 v[104:107], a[64:67], a[156:159], v[104:107]
v_rcp_f32 v58, v58
s_waitcnt lgkmcnt(8)
v_mfma_f32_16x16x32_bf16 v[108:111], a[72:75], a[156:159], v[108:111]
ds_read_b64_tr_b16 a[64:65], v217 offset:128
ds_read_b64_tr_b16 a[66:67], v217 offset:4736
v_mfma_f32_16x16x32_bf16 v[108:111], a[76:79], a[160:163], v[108:111]
v_rcp_f32 v59, v59
v_mfma_f32_16x16x32_bf16 v[116:119], a[76:79], a[176:179], v[116:119]
buffer_load_dwordx4 a[228:231], v244, s[20:23], s64 offen offset:2048 sc0 sc1
v_mfma_f32_16x16x32_bf16 v[116:119], a[72:75], a[172:175], v[116:119]
v_mul_f32 v38, v38, v58
v_mul_f32 v39, v39, v59
v_mfma_f32_16x16x32_bf16 v[124:127], a[72:75], a[188:191], v[124:127]
ds_read_b64_tr_b16 a[68:69], v217 offset:9344
ds_read_b64_tr_b16 a[70:71], v217 offset:13952
v_mfma_f32_16x16x32_bf16 v[124:127], a[76:79], a[192:195], v[124:127]
v_cvt_pk_bf16_f32 v58, v38, v39
v_lshlrev_b32 v38, 16, v58
v_mfma_f32_16x16x32_bf16 v[132:135], a[76:79], a[208:211], v[132:135]
buffer_load_dwordx4 a[128:131], v244, s[20:23], s65 offen offset:2048 sc0 sc1
v_mfma_f32_16x16x32_bf16 v[132:135], a[72:75], a[204:207], v[132:135]
v_and_b32 v39, 0xffff0000, v58
v_accvgpr_read_b32 v41, a137
s_waitcnt lgkmcnt(8)
v_mfma_f32_16x16x32_bf16 v[160:163], a[80:83], a[204:207], v[160:163]
ds_read_b64_tr_b16 a[72:73], v217 offset:136
ds_read_b64_tr_b16 a[74:75], v217 offset:4744
v_mfma_f32_16x16x32_bf16 v[160:163], a[84:87], a[208:211], v[160:163]
v_accvgpr_read_b32 v59, a145
v_lshlrev_b32 v40, 16, v41
v_mfma_f32_16x16x32_bf16 v[152:155], a[84:87], a[192:195], v[152:155]
buffer_load_dwordx4 a[104:107], v244, s[20:23], s66 offen offset:2048 sc0 sc1
v_mfma_f32_16x16x32_bf16 v[152:155], a[80:83], a[188:191], v[152:155]
v_and_b32 v41, 0xffff0000, v41
v_lshlrev_b32 v58, 16, v59
v_mfma_f32_16x16x32_bf16 v[144:147], a[80:83], a[172:175], v[144:147]
ds_read_b64_tr_b16 a[76:77], v217 offset:9352
ds_read_b64_tr_b16 a[78:79], v217 offset:13960
v_mfma_f32_16x16x32_bf16 v[144:147], a[84:87], a[176:179], v[144:147]
v_and_b32 v59, 0xffff0000, v59
v_add_f32 v40, v40, v58
v_mfma_f32_16x16x32_bf16 v[136:139], a[84:87], a[160:163], v[136:139]
buffer_load_dwordx4 a[120:123], v244, s[20:23], s67 offen offset:2048 sc0 sc1
v_mfma_f32_16x16x32_bf16 v[136:139], a[80:83], a[156:159], v[136:139]
v_add_f32 v41, v41, v59
v_cvt_pk_bf16_f32 v58, v40, v41
s_waitcnt lgkmcnt(8)
v_mfma_f32_16x16x32_bf16 v[140:143], a[88:91], a[156:159], v[140:143]
ds_read_b64_tr_b16 a[80:81], v218 offset:0
ds_read_b64_tr_b16 a[82:83], v218 offset:4608
v_mfma_f32_16x16x32_bf16 v[140:143], a[92:95], a[160:163], v[140:143]
v_lshlrev_b32 v40, 16, v58
v_and_b32 v41, 0xffff0000, v58
v_mfma_f32_16x16x32_bf16 v[148:151], a[92:95], a[176:179], v[148:151]
buffer_load_dwordx4 a[232:235], v244, s[20:23], s64 offen offset:3072 sc0 sc1
v_mfma_f32_16x16x32_bf16 v[148:151], a[88:91], a[172:175], v[148:151]
v_mul_f32 v58, 0xbfb8aa3b, v40
v_mul_f32 v59, 0xbfb8aa3b, v41
v_mfma_f32_16x16x32_bf16 v[156:159], a[88:91], a[188:191], v[156:159]
ds_read_b64_tr_b16 a[84:85], v218 offset:9216
ds_read_b64_tr_b16 a[86:87], v218 offset:13824
v_mfma_f32_16x16x32_bf16 v[156:159], a[92:95], a[192:195], v[156:159]
v_exp_f32 v58, v58
v_mfma_f32_16x16x32_bf16 v[164:167], a[92:95], a[208:211], v[164:167]
buffer_load_dwordx4 a[132:135], v244, s[20:23], s65 offen offset:3072 sc0 sc1
v_mfma_f32_16x16x32_bf16 v[164:167], a[88:91], a[204:207], v[164:167]
v_exp_f32 v59, v59
s_waitcnt lgkmcnt(8)
v_mfma_f32_16x16x32_bf16 v[192:195], a[64:67], a[204:207], v[192:195]
ds_read_b64_tr_b16 a[88:89], v216 offset:18432
ds_read_b64_tr_b16 a[90:91], v216 offset:23040
v_mfma_f32_16x16x32_bf16 v[192:195], a[68:71], a[208:211], v[192:195]
v_add_f32 v58, 1.0, v58
v_add_f32 v59, 1.0, v59
v_mfma_f32_16x16x32_bf16 v[184:187], a[68:71], a[192:195], v[184:187]
buffer_load_dwordx4 a[108:111], v244, s[20:23], s66 offen offset:3072 sc0 sc1
v_mfma_f32_16x16x32_bf16 v[184:187], a[64:67], a[188:191], v[184:187]
v_rcp_f32 v58, v58
v_mfma_f32_16x16x32_bf16 v[176:179], a[64:67], a[172:175], v[176:179]
ds_read_b64_tr_b16 a[92:93], v216 offset:27648
ds_read_b64_tr_b16 a[94:95], v216 offset:32256
v_mfma_f32_16x16x32_bf16 v[176:179], a[68:71], a[176:179], v[176:179]
v_rcp_f32 v59, v59
v_mfma_f32_16x16x32_bf16 v[168:171], a[68:71], a[160:163], v[168:171]
buffer_load_dwordx4 a[124:127], v244, s[20:23], s67 offen offset:3072 sc0 sc1
v_mfma_f32_16x16x32_bf16 v[168:171], a[64:67], a[156:159], v[168:171]
s_add_u32 s28, s33, 3
s_and_b32 s28, s28, 3
s_waitcnt lgkmcnt(8)
v_mfma_f32_16x16x32_bf16 v[172:175], a[72:75], a[156:159], v[172:175]
ds_read_b64_tr_b16 a[64:65], v216 offset:18440
ds_read_b64_tr_b16 a[66:67], v216 offset:23048
v_mfma_f32_16x16x32_bf16 v[172:175], a[76:79], a[160:163], v[172:175]
s_sub_u32 s28, s28, s33
s_lshl_b32 s28, s28, 16
v_mfma_f32_16x16x32_bf16 v[180:183], a[76:79], a[176:179], v[180:183]
s_add_u32 s64, s28, s44
s_add_u32 s65, s64, 4096
v_mfma_f32_16x16x32_bf16 v[180:183], a[72:75], a[172:175], v[180:183]
s_add_u32 s66, s64, 8192
s_add_u32 s67, s64, 12288
v_mfma_f32_16x16x32_bf16 v[188:191], a[72:75], a[188:191], v[188:191]
ds_read_b64_tr_b16 a[68:69], v216 offset:27656
ds_read_b64_tr_b16 a[70:71], v216 offset:32264
v_mfma_f32_16x16x32_bf16 v[188:191], a[76:79], a[192:195], v[188:191]
buffer_load_dwordx4 a[0:3], v244, s[20:23], s64 offen offset:0 sc0 sc1
v_mfma_f32_16x16x32_bf16 v[196:199], a[76:79], a[208:211], v[196:199]
v_mul_f32 v40, v40, v58
v_mul_f32 v41, v41, v59
v_mfma_f32_16x16x32_bf16 v[196:199], a[72:75], a[204:207], v[196:199]
v_cvt_pk_bf16_f32 v58, v40, v41
v_lshlrev_b32 v40, 16, v58
s_waitcnt lgkmcnt(8)
v_mfma_f32_16x16x32_bf16 v[212:215], a[80:83], a[204:207], v[212:215]
ds_read_b64_tr_b16 a[72:73], v217 offset:18432
ds_read_b64_tr_b16 a[74:75], v217 offset:23040
v_mfma_f32_16x16x32_bf16 v[212:215], a[84:87], a[208:211], v[212:215]
buffer_load_dwordx4 a[16:19], v244, s[20:23], s65 offen offset:0 sc0 sc1
v_mfma_f32_16x16x32_bf16 v[208:211], a[84:87], a[192:195], v[208:211]
v_and_b32 v41, 0xffff0000, v58
v_accvgpr_read_b32 v43, a138
v_mfma_f32_16x16x32_bf16 v[208:211], a[80:83], a[188:191], v[208:211]
v_accvgpr_read_b32 v59, a146
v_lshlrev_b32 v42, 16, v43
v_mfma_f32_16x16x32_bf16 v[204:207], a[80:83], a[172:175], v[204:207]
ds_read_b64_tr_b16 a[76:77], v217 offset:27648
ds_read_b64_tr_b16 a[78:79], v217 offset:32256
v_mfma_f32_16x16x32_bf16 v[204:207], a[84:87], a[176:179], v[204:207]
buffer_load_dwordx4 a[32:35], v244, s[20:23], s66 offen offset:0 sc0 sc1
v_mfma_f32_16x16x32_bf16 v[200:203], a[84:87], a[160:163], v[200:203]
v_and_b32 v43, 0xffff0000, v43
v_lshlrev_b32 v58, 16, v59
v_mfma_f32_16x16x32_bf16 v[200:203], a[80:83], a[156:159], v[200:203]
v_and_b32 v59, 0xffff0000, v59
v_add_f32 v42, v42, v58
s_waitcnt vmcnt(23)
s_waitcnt lgkmcnt(8)
v_mfma_f32_16x16x32_bf16 v[72:75], a[88:91], a[164:167], v[72:75]
ds_read_b64_tr_b16 a[80:81], v217 offset:18440
ds_read_b64_tr_b16 a[82:83], v217 offset:23048
s_waitcnt vmcnt(19)
v_mfma_f32_16x16x32_bf16 v[72:75], a[92:95], a[168:171], v[72:75]
buffer_load_dwordx4 a[48:51], v244, s[20:23], s67 offen offset:0 sc0 sc1
v_mfma_f32_16x16x32_bf16 v[80:83], a[92:95], a[184:187], v[80:83]
v_add_f32 v43, v43, v59
v_cvt_pk_bf16_f32 v58, v42, v43
v_mfma_f32_16x16x32_bf16 v[80:83], a[88:91], a[180:183], v[80:83]
v_lshlrev_b32 v42, 16, v58
v_and_b32 v43, 0xffff0000, v58
v_mfma_f32_16x16x32_bf16 v[88:91], a[88:91], a[196:199], v[88:91]
ds_read_b64_tr_b16 a[84:85], v217 offset:27656
ds_read_b64_tr_b16 a[86:87], v217 offset:32264
v_mfma_f32_16x16x32_bf16 v[88:91], a[92:95], a[200:203], v[88:91]
buffer_load_dwordx4 a[4:7], v244, s[20:23], s64 offen offset:1024 sc0 sc1
v_mfma_f32_16x16x32_bf16 v[96:99], a[92:95], a[216:219], v[96:99]
v_mul_f32 v58, 0xbfb8aa3b, v42
v_mul_f32 v59, 0xbfb8aa3b, v43
v_mfma_f32_16x16x32_bf16 v[96:99], a[88:91], a[212:215], v[96:99]
v_exp_f32 v58, v58
s_waitcnt lgkmcnt(8)
v_mfma_f32_16x16x32_bf16 v[100:103], a[64:67], a[212:215], v[100:103]
ds_read_b64_tr_b16 a[88:89], v216 offset:18560
ds_read_b64_tr_b16 a[90:91], v216 offset:23168
v_mfma_f32_16x16x32_bf16 v[100:103], a[68:71], a[216:219], v[100:103]
buffer_load_dwordx4 a[20:23], v244, s[20:23], s65 offen offset:1024 sc0 sc1
v_mfma_f32_16x16x32_bf16 v[92:95], a[68:71], a[200:203], v[92:95]
v_exp_f32 v59, v59
v_mfma_f32_16x16x32_bf16 v[92:95], a[64:67], a[196:199], v[92:95]
v_add_f32 v58, 1.0, v58
v_add_f32 v59, 1.0, v59
v_mfma_f32_16x16x32_bf16 v[84:87], a[64:67], a[180:183], v[84:87]
ds_read_b64_tr_b16 a[92:93], v216 offset:27776
ds_read_b64_tr_b16 a[94:95], v216 offset:32384
v_mfma_f32_16x16x32_bf16 v[84:87], a[68:71], a[184:187], v[84:87]
buffer_load_dwordx4 a[36:39], v244, s[20:23], s66 offen offset:1024 sc0 sc1
v_mfma_f32_16x16x32_bf16 v[76:79], a[68:71], a[168:171], v[76:79]
v_rcp_f32 v58, v58
v_mfma_f32_16x16x32_bf16 v[76:79], a[64:67], a[164:167], v[76:79]
v_rcp_f32 v59, v59
s_waitcnt lgkmcnt(8)
v_mfma_f32_16x16x32_bf16 v[104:107], a[72:75], a[164:167], v[104:107]
ds_read_b64_tr_b16 a[64:65], v216 offset:18568
ds_read_b64_tr_b16 a[66:67], v216 offset:23176
v_mfma_f32_16x16x32_bf16 v[104:107], a[76:79], a[168:171], v[104:107]
buffer_load_dwordx4 a[52:55], v244, s[20:23], s67 offen offset:1024 sc0 sc1
v_mfma_f32_16x16x32_bf16 v[112:115], a[76:79], a[184:187], v[112:115]
v_mul_f32 v42, v42, v58
v_mul_f32 v43, v43, v59
v_mfma_f32_16x16x32_bf16 v[112:115], a[72:75], a[180:183], v[112:115]
v_cvt_pk_bf16_f32 v58, v42, v43
v_lshlrev_b32 v42, 16, v58
v_mfma_f32_16x16x32_bf16 v[120:123], a[72:75], a[196:199], v[120:123]
ds_read_b64_tr_b16 a[68:69], v216 offset:27784
ds_read_b64_tr_b16 a[70:71], v216 offset:32392
v_mfma_f32_16x16x32_bf16 v[120:123], a[76:79], a[200:203], v[120:123]
buffer_load_dwordx4 a[8:11], v244, s[20:23], s64 offen offset:2048 sc0 sc1
v_mfma_f32_16x16x32_bf16 v[128:131], a[76:79], a[216:219], v[128:131]
v_and_b32 v43, 0xffff0000, v58
v_accvgpr_read_b32 v45, a139
v_mfma_f32_16x16x32_bf16 v[128:131], a[72:75], a[212:215], v[128:131]
v_accvgpr_read_b32 v59, a147
v_lshlrev_b32 v44, 16, v45
s_waitcnt lgkmcnt(8)
v_mfma_f32_16x16x32_bf16 v[132:135], a[80:83], a[212:215], v[132:135]
ds_read_b64_tr_b16 a[72:73], v217 offset:18560
ds_read_b64_tr_b16 a[74:75], v217 offset:23168
v_mfma_f32_16x16x32_bf16 v[132:135], a[84:87], a[216:219], v[132:135]
buffer_load_dwordx4 a[24:27], v244, s[20:23], s65 offen offset:2048 sc0 sc1
v_mfma_f32_16x16x32_bf16 v[124:127], a[84:87], a[200:203], v[124:127]
v_and_b32 v45, 0xffff0000, v45
v_lshlrev_b32 v58, 16, v59
v_mfma_f32_16x16x32_bf16 v[124:127], a[80:83], a[196:199], v[124:127]
v_and_b32 v59, 0xffff0000, v59
v_add_f32 v44, v44, v58
v_mfma_f32_16x16x32_bf16 v[116:119], a[80:83], a[180:183], v[116:119]
ds_read_b64_tr_b16 a[76:77], v217 offset:27776
ds_read_b64_tr_b16 a[78:79], v217 offset:32384
v_mfma_f32_16x16x32_bf16 v[116:119], a[84:87], a[184:187], v[116:119]
buffer_load_dwordx4 a[40:43], v244, s[20:23], s66 offen offset:2048 sc0 sc1
v_mfma_f32_16x16x32_bf16 v[108:111], a[84:87], a[168:171], v[108:111]
v_add_f32 v45, v45, v59
v_cvt_pk_bf16_f32 v58, v44, v45
v_mfma_f32_16x16x32_bf16 v[108:111], a[80:83], a[164:167], v[108:111]
v_lshlrev_b32 v44, 16, v58
v_and_b32 v45, 0xffff0000, v58
s_waitcnt lgkmcnt(8)
v_mfma_f32_16x16x32_bf16 v[136:139], a[88:91], a[164:167], v[136:139]
ds_read_b64_tr_b16 a[80:81], v217 offset:18568
ds_read_b64_tr_b16 a[82:83], v217 offset:23176
v_mfma_f32_16x16x32_bf16 v[136:139], a[92:95], a[168:171], v[136:139]
buffer_load_dwordx4 a[56:59], v244, s[20:23], s67 offen offset:2048 sc0 sc1
v_mfma_f32_16x16x32_bf16 v[144:147], a[92:95], a[184:187], v[144:147]
v_mul_f32 v58, 0xbfb8aa3b, v44
v_mul_f32 v59, 0xbfb8aa3b, v45
v_mfma_f32_16x16x32_bf16 v[144:147], a[88:91], a[180:183], v[144:147]
v_exp_f32 v58, v58
v_mfma_f32_16x16x32_bf16 v[152:155], a[88:91], a[196:199], v[152:155]
ds_read_b64_tr_b16 a[84:85], v217 offset:27784
ds_read_b64_tr_b16 a[86:87], v217 offset:32392
v_mfma_f32_16x16x32_bf16 v[152:155], a[92:95], a[200:203], v[152:155]
buffer_load_dwordx4 a[12:15], v244, s[20:23], s64 offen offset:3072 sc0 sc1
v_mfma_f32_16x16x32_bf16 v[160:163], a[92:95], a[216:219], v[160:163]
v_exp_f32 v59, v59
v_mfma_f32_16x16x32_bf16 v[160:163], a[88:91], a[212:215], v[160:163]
v_add_f32 v58, 1.0, v58
v_add_f32 v59, 1.0, v59
s_waitcnt lgkmcnt(8)
v_mfma_f32_16x16x32_bf16 v[164:167], a[64:67], a[212:215], v[164:167]
ds_read_b64_tr_b16 a[88:89], v218 offset:18432
ds_read_b64_tr_b16 a[90:91], v218 offset:23040
v_mfma_f32_16x16x32_bf16 v[164:167], a[68:71], a[216:219], v[164:167]
buffer_load_dwordx4 a[28:31], v244, s[20:23], s65 offen offset:3072 sc0 sc1
v_mfma_f32_16x16x32_bf16 v[156:159], a[68:71], a[200:203], v[156:159]
v_rcp_f32 v58, v58
v_mfma_f32_16x16x32_bf16 v[156:159], a[64:67], a[196:199], v[156:159]
v_rcp_f32 v59, v59
v_mfma_f32_16x16x32_bf16 v[148:151], a[64:67], a[180:183], v[148:151]
ds_read_b64_tr_b16 a[92:93], v218 offset:27648
ds_read_b64_tr_b16 a[94:95], v218 offset:32256
v_mfma_f32_16x16x32_bf16 v[148:151], a[68:71], a[184:187], v[148:151]
buffer_load_dwordx4 a[44:47], v244, s[20:23], s66 offen offset:3072 sc0 sc1
v_mfma_f32_16x16x32_bf16 v[140:143], a[68:71], a[168:171], v[140:143]
v_mul_f32 v44, v44, v58
v_mul_f32 v45, v45, v59
v_mfma_f32_16x16x32_bf16 v[140:143], a[64:67], a[164:167], v[140:143]
v_cvt_pk_bf16_f32 v58, v44, v45
v_lshlrev_b32 v44, 16, v58
s_waitcnt lgkmcnt(8)
v_mfma_f32_16x16x32_bf16 v[168:171], a[72:75], a[164:167], v[168:171]
ds_read_b64_tr_b16 a[64:65], v220 offset:0
ds_read_b64_tr_b16 a[66:67], v220 offset:4608
v_mfma_f32_16x16x32_bf16 v[168:171], a[76:79], a[168:171], v[168:171]
buffer_load_dwordx4 a[60:63], v244, s[20:23], s67 offen offset:3072 sc0 sc1
v_mfma_f32_16x16x32_bf16 v[176:179], a[76:79], a[184:187], v[176:179]
s_lshl2_add_u32 s28, s36, s33
s_lshl2_add_u32 s28, s28, s37
v_mfma_f32_16x16x32_bf16 v[176:179], a[72:75], a[180:183], v[176:179]
s_lshl_b32 s95, s28, 5
s_add_u32 s95, s95, 0x24a000
v_mfma_f32_16x16x32_bf16 v[184:187], a[72:75], a[196:199], v[184:187]
ds_read_b64_tr_b16 a[68:69], v220 offset:9216
ds_read_b64_tr_b16 a[70:71], v220 offset:13824
v_mfma_f32_16x16x32_bf16 v[184:187], a[76:79], a[200:203], v[184:187]
s_lshl_b32 s28, s32, 18
s_sub_u32 s49, s44, s28
v_mfma_f32_16x16x32_bf16 v[192:195], a[76:79], a[216:219], v[192:195]
v_add_u32 v243, 0x2000, v244
v_mov_b32 v246, 2
v_mfma_f32_16x16x32_bf16 v[192:195], a[72:75], a[212:215], v[192:195]
s_lshl2_add_u32 s29, s33, s94
v_and_b32 v45, 0xffff0000, v58
s_waitcnt lgkmcnt(8)
v_mfma_f32_16x16x32_bf16 v[196:199], a[80:83], a[212:215], v[196:199]
ds_read_b64_tr_b16 a[72:73], v220 offset:18432
ds_read_b64_tr_b16 a[74:75], v220 offset:23040
v_mfma_f32_16x16x32_bf16 v[196:199], a[84:87], a[216:219], v[196:199]
v_accvgpr_read_b32 v47, a140
v_accvgpr_read_b32 v59, a148
v_mfma_f32_16x16x32_bf16 v[188:191], a[84:87], a[200:203], v[188:191]
v_lshlrev_b32 v46, 16, v47
v_and_b32 v47, 0xffff0000, v47
v_mfma_f32_16x16x32_bf16 v[188:191], a[80:83], a[196:199], v[188:191]
v_lshlrev_b32 v58, 16, v59
v_and_b32 v59, 0xffff0000, v59
v_mfma_f32_16x16x32_bf16 v[180:183], a[80:83], a[180:183], v[180:183]
ds_read_b64_tr_b16 a[76:77], v220 offset:27648
ds_read_b64_tr_b16 a[78:79], v220 offset:32256
v_mfma_f32_16x16x32_bf16 v[180:183], a[84:87], a[184:187], v[180:183]
v_add_f32 v46, v46, v58
v_add_f32 v47, v47, v59
v_mfma_f32_16x16x32_bf16 v[172:175], a[84:87], a[168:171], v[172:175]
v_cvt_pk_bf16_f32 v58, v46, v47
v_lshlrev_b32 v46, 16, v58
v_mfma_f32_16x16x32_bf16 v[172:175], a[80:83], a[164:167], v[172:175]
v_and_b32 v47, 0xffff0000, v58
v_mul_f32 v58, 0xbfb8aa3b, v46
s_waitcnt lgkmcnt(8)
v_mfma_f32_16x16x32_bf16 v[200:203], a[88:91], a[164:167], v[200:203]
ds_read_b64_tr_b16 a[80:81], v223 offset:0
ds_read_b64_tr_b16 a[82:83], v223 offset:4608
v_mfma_f32_16x16x32_bf16 v[200:203], a[92:95], a[168:171], v[200:203]
v_mul_f32 v59, 0xbfb8aa3b, v47
v_mfma_f32_16x16x32_bf16 v[204:207], a[92:95], a[184:187], v[204:207]
v_exp_f32 v58, v58
v_mfma_f32_16x16x32_bf16 v[204:207], a[88:91], a[180:183], v[204:207]
v_exp_f32 v59, v59
v_mfma_f32_16x16x32_bf16 v[208:211], a[88:91], a[196:199], v[208:211]
ds_read_b64_tr_b16 a[84:85], v223 offset:9216
ds_read_b64_tr_b16 a[86:87], v223 offset:13824
v_mfma_f32_16x16x32_bf16 v[208:211], a[92:95], a[200:203], v[208:211]
v_add_f32 v58, 1.0, v58
v_add_f32 v59, 1.0, v59
v_mfma_f32_16x16x32_bf16 v[212:215], a[92:95], a[216:219], v[212:215]
v_rcp_f32 v58, v58
v_mfma_f32_16x16x32_bf16 v[212:215], a[88:91], a[212:215], v[212:215]
v_rcp_f32 v59, v59
s_waitcnt vmcnt(28)
s_waitcnt lgkmcnt(8)
v_mfma_f32_16x16x32_bf16 v[128:131], a[64:67], a[112:115], v[128:131]
ds_read_b64_tr_b16 a[88:89], v223 offset:18432
ds_read_b64_tr_b16 a[90:91], v223 offset:23040
s_waitcnt vmcnt(24)
v_mfma_f32_16x16x32_bf16 v[128:131], a[68:71], a[116:119], v[128:131]
v_mul_f32 v46, v46, v58
v_mul_f32 v47, v47, v59
v_mfma_f32_16x16x32_bf16 v[120:123], a[68:71], a[100:103], v[120:123]
v_cvt_pk_bf16_f32 v58, v46, v47
v_lshlrev_b32 v46, 16, v58
v_mfma_f32_16x16x32_bf16 v[120:123], a[64:67], a[96:99], v[120:123]
v_and_b32 v47, 0xffff0000, v58
v_accvgpr_read_b32 v49, a141
v_mfma_f32_16x16x32_bf16 v[112:115], a[64:67], a[236:239], v[112:115]
ds_read_b64_tr_b16 a[92:93], v223 offset:27648
ds_read_b64_tr_b16 a[94:95], v223 offset:32256
v_mfma_f32_16x16x32_bf16 v[112:115], a[68:71], a[240:243], v[112:115]
v_accvgpr_read_b32 v59, a149
v_lshlrev_b32 v48, 16, v49
v_mfma_f32_16x16x32_bf16 v[104:107], a[68:71], a[224:227], v[104:107]
v_and_b32 v49, 0xffff0000, v49
v_lshlrev_b32 v58, 16, v59
v_mfma_f32_16x16x32_bf16 v[104:107], a[64:67], a[220:223], v[104:107]
s_waitcnt vmcnt(0)
buffer_store_dword v246, v254, s[20:23], s29 offen sc0 sc1
s_waitcnt vmcnt(21)
s_waitcnt lgkmcnt(8)
v_mfma_f32_16x16x32_bf16 v[104:107], a[72:75], a[228:231], v[104:107]
ds_read_b64_tr_b16 a[64:65], v220 offset:8
ds_read_b64_tr_b16 a[66:67], v220 offset:4616
s_waitcnt vmcnt(17)
v_mfma_f32_16x16x32_bf16 v[104:107], a[76:79], a[232:235], v[104:107]
s_xor_b32 s28, s32, 0
s_sub_u32 s29, s32, s28
v_mfma_f32_16x16x32_bf16 v[112:115], a[76:79], a[132:135], v[112:115]
s_lshl_b32 s28, s28, 18
s_and_b32 s29, s29, 3
v_mfma_f32_16x16x32_bf16 v[112:115], a[72:75], a[128:131], v[112:115]
s_add_u32 s28, s28, s49
s_lshl_b32 s50, s29, 10
v_mfma_f32_16x16x32_bf16 v[120:123], a[72:75], a[104:107], v[120:123]
ds_read_b64_tr_b16 a[68:69], v220 offset:9224
ds_read_b64_tr_b16 a[70:71], v220 offset:13832
v_mfma_f32_16x16x32_bf16 v[120:123], a[76:79], a[108:111], v[120:123]
s_mul_i32 s29, s29, 0x1200
s_and_b32 s29, s29, 0x2200
v_mfma_f32_16x16x32_bf16 v[128:131], a[76:79], a[124:127], v[128:131]
s_add_u32 s72, s28, s29
v_and_b32 v59, 0xffff0000, v59
v_mfma_f32_16x16x32_bf16 v[128:131], a[72:75], a[120:123], v[128:131]
s_xor_b32 s28, s32, 1
s_sub_u32 s29, s32, s28
s_waitcnt vmcnt(13)
s_waitcnt lgkmcnt(8)
v_mfma_f32_16x16x32_bf16 v[128:131], a[80:83], a[48:51], v[128:131]
ds_read_b64_tr_b16 a[72:73], v220 offset:18440
ds_read_b64_tr_b16 a[74:75], v220 offset:23048
s_waitcnt vmcnt(9)
v_mfma_f32_16x16x32_bf16 v[128:131], a[84:87], a[52:55], v[128:131]
s_lshl_b32 s28, s28, 18
s_and_b32 s29, s29, 3
v_mfma_f32_16x16x32_bf16 v[120:123], a[84:87], a[36:39], v[120:123]
s_add_u32 s28, s28, s49
s_lshl_b32 s50, s29, 10
v_mfma_f32_16x16x32_bf16 v[120:123], a[80:83], a[32:35], v[120:123]
s_add_u32 s65, s28, s50
v_add_f32 v48, v48, v58
v_mfma_f32_16x16x32_bf16 v[112:115], a[80:83], a[16:19], v[112:115]
ds_read_b64_tr_b16 a[76:77], v220 offset:27656
ds_read_b64_tr_b16 a[78:79], v220 offset:32264
v_mfma_f32_16x16x32_bf16 v[112:115], a[84:87], a[20:23], v[112:115]
s_mul_i32 s29, s29, 0x1200
s_and_b32 s29, s29, 0x2200
v_mfma_f32_16x16x32_bf16 v[104:107], a[84:87], a[4:7], v[104:107]
s_add_u32 s73, s28, s29
v_add_f32 v49, v49, v59
v_mfma_f32_16x16x32_bf16 v[104:107], a[80:83], a[0:3], v[104:107]
s_xor_b32 s28, s32, 2
s_sub_u32 s29, s32, s28
s_waitcnt vmcnt(5)
s_waitcnt lgkmcnt(8)
v_mfma_f32_16x16x32_bf16 v[104:107], a[88:91], a[8:11], v[104:107]
ds_read_b64_tr_b16 a[80:81], v223 offset:8
ds_read_b64_tr_b16 a[82:83], v223 offset:4616
s_waitcnt vmcnt(1)
v_mfma_f32_16x16x32_bf16 v[104:107], a[92:95], a[12:15], v[104:107]
s_lshl_b32 s28, s28, 18
s_and_b32 s29, s29, 3
v_mfma_f32_16x16x32_bf16 v[112:115], a[92:95], a[28:31], v[112:115]
s_add_u32 s28, s28, s49
s_lshl_b32 s50, s29, 10
v_mfma_f32_16x16x32_bf16 v[112:115], a[88:91], a[24:27], v[112:115]
s_add_u32 s66, s28, s50
v_cvt_pk_bf16_f32 v58, v48, v49
v_mfma_f32_16x16x32_bf16 v[120:123], a[88:91], a[40:43], v[120:123]
ds_read_b64_tr_b16 a[84:85], v223 offset:9224
ds_read_b64_tr_b16 a[86:87], v223 offset:13832
v_mfma_f32_16x16x32_bf16 v[120:123], a[92:95], a[44:47], v[120:123]
s_mul_i32 s29, s29, 0x1200
s_and_b32 s29, s29, 0x2200
v_mfma_f32_16x16x32_bf16 v[128:131], a[92:95], a[60:63], v[128:131]
s_add_u32 s74, s28, s29
v_lshlrev_b32 v48, 16, v58
v_mfma_f32_16x16x32_bf16 v[128:131], a[88:91], a[56:59], v[128:131]
s_xor_b32 s28, s32, 3
s_sub_u32 s29, s32, s28
s_waitcnt lgkmcnt(8)
v_mfma_f32_16x16x32_bf16 v[132:135], a[64:67], a[112:115], v[132:135]
ds_read_b64_tr_b16 a[88:89], v223 offset:18440
ds_read_b64_tr_b16 a[90:91], v223 offset:23048
v_mfma_f32_16x16x32_bf16 v[132:135], a[68:71], a[116:119], v[132:135]
s_lshl_b32 s28, s28, 18
s_and_b32 s29, s29, 3
v_mfma_f32_16x16x32_bf16 v[124:127], a[68:71], a[100:103], v[124:127]
s_add_u32 s28, s28, s49
s_lshl_b32 s50, s29, 10
v_mfma_f32_16x16x32_bf16 v[124:127], a[64:67], a[96:99], v[124:127]
s_add_u32 s67, s28, s50
v_and_b32 v49, 0xffff0000, v58
v_mfma_f32_16x16x32_bf16 v[116:119], a[64:67], a[236:239], v[116:119]
ds_read_b64_tr_b16 a[92:93], v223 offset:27656
ds_read_b64_tr_b16 a[94:95], v223 offset:32264
v_mfma_f32_16x16x32_bf16 v[116:119], a[68:71], a[240:243], v[116:119]
s_mul_i32 s29, s29, 0x1200
s_and_b32 s29, s29, 0x2200
v_mfma_f32_16x16x32_bf16 v[108:111], a[68:71], a[224:227], v[108:111]
s_add_u32 s75, s28, s29
v_mul_f32 v58, 0xbfb8aa3b, v48
v_mfma_f32_16x16x32_bf16 v[108:111], a[64:67], a[220:223], v[108:111]
buffer_load_dword v230, v229, s[20:23], s94 offen sc0 sc1
s_waitcnt lgkmcnt(8)
v_mfma_f32_16x16x32_bf16 v[108:111], a[72:75], a[228:231], v[108:111]
ds_read_b64_tr_b16 a[64:65], v220 offset:128
ds_read_b64_tr_b16 a[66:67], v220 offset:4736
v_mfma_f32_16x16x32_bf16 v[108:111], a[76:79], a[232:235], v[108:111]
s_xor_b32 s28, s32, 4
s_sub_u32 s29, s32, s28
v_mfma_f32_16x16x32_bf16 v[116:119], a[76:79], a[132:135], v[116:119]
s_lshl_b32 s28, s28, 18
s_and_b32 s29, s29, 3
v_mfma_f32_16x16x32_bf16 v[116:119], a[72:75], a[128:131], v[116:119]
s_add_u32 s28, s28, s49
s_lshl_b32 s50, s29, 10
v_mfma_f32_16x16x32_bf16 v[124:127], a[72:75], a[104:107], v[124:127]
ds_read_b64_tr_b16 a[68:69], v220 offset:9344
ds_read_b64_tr_b16 a[70:71], v220 offset:13952
v_mfma_f32_16x16x32_bf16 v[124:127], a[76:79], a[108:111], v[124:127]
s_add_u32 s68, s28, s50
s_add_u32 s68, s68, 4096
v_mfma_f32_16x16x32_bf16 v[132:135], a[76:79], a[124:127], v[132:135]
s_mul_i32 s29, s29, 0x1200
s_and_b32 s29, s29, 0x2200
v_mfma_f32_16x16x32_bf16 v[132:135], a[72:75], a[120:123], v[132:135]
s_add_u32 s84, s28, s29
v_mul_f32 v59, 0xbfb8aa3b, v49
s_waitcnt lgkmcnt(8)
v_mfma_f32_16x16x32_bf16 v[132:135], a[80:83], a[48:51], v[132:135]
ds_read_b64_tr_b16 a[72:73], v220 offset:18560
ds_read_b64_tr_b16 a[74:75], v220 offset:23168
v_mfma_f32_16x16x32_bf16 v[132:135], a[84:87], a[52:55], v[132:135]
s_xor_b32 s28, s32, 5
s_sub_u32 s29, s32, s28
v_mfma_f32_16x16x32_bf16 v[124:127], a[84:87], a[36:39], v[124:127]
s_lshl_b32 s28, s28, 18
s_and_b32 s29, s29, 3
v_mfma_f32_16x16x32_bf16 v[124:127], a[80:83], a[32:35], v[124:127]
s_add_u32 s28, s28, s49
s_lshl_b32 s50, s29, 10
v_mfma_f32_16x16x32_bf16 v[116:119], a[80:83], a[16:19], v[116:119]
ds_read_b64_tr_b16 a[76:77], v220 offset:27776
ds_read_b64_tr_b16 a[78:79], v220 offset:32384
v_mfma_f32_16x16x32_bf16 v[116:119], a[84:87], a[20:23], v[116:119]
s_add_u32 s69, s28, s50
s_add_u32 s69, s69, 4096
v_mfma_f32_16x16x32_bf16 v[108:111], a[84:87], a[4:7], v[108:111]
s_mul_i32 s29, s29, 0x1200
s_and_b32 s29, s29, 0x2200
v_mfma_f32_16x16x32_bf16 v[108:111], a[80:83], a[0:3], v[108:111]
s_add_u32 s85, s28, s29
s_waitcnt lgkmcnt(8)
v_mfma_f32_16x16x32_bf16 v[108:111], a[88:91], a[8:11], v[108:111]
ds_read_b64_tr_b16 a[80:81], v223 offset:128
ds_read_b64_tr_b16 a[82:83], v223 offset:4736
v_mfma_f32_16x16x32_bf16 v[108:111], a[92:95], a[12:15], v[108:111]
s_xor_b32 s28, s32, 6
s_sub_u32 s29, s32, s28
v_mfma_f32_16x16x32_bf16 v[116:119], a[92:95], a[28:31], v[116:119]
s_lshl_b32 s28, s28, 18
s_and_b32 s29, s29, 3
v_mfma_f32_16x16x32_bf16 v[116:119], a[88:91], a[24:27], v[116:119]
s_add_u32 s28, s28, s49
s_lshl_b32 s50, s29, 10
v_mfma_f32_16x16x32_bf16 v[124:127], a[88:91], a[40:43], v[124:127]
ds_read_b64_tr_b16 a[84:85], v223 offset:9344
ds_read_b64_tr_b16 a[86:87], v223 offset:13952
v_mfma_f32_16x16x32_bf16 v[124:127], a[92:95], a[44:47], v[124:127]
s_add_u32 s70, s28, s50
s_add_u32 s70, s70, 4096
v_mfma_f32_16x16x32_bf16 v[132:135], a[92:95], a[60:63], v[132:135]
s_mul_i32 s29, s29, 0x1200
s_and_b32 s29, s29, 0x2200
v_mfma_f32_16x16x32_bf16 v[132:135], a[88:91], a[56:59], v[132:135]
s_add_u32 s86, s28, s29
s_waitcnt lgkmcnt(8)
v_mfma_f32_16x16x32_bf16 v[192:195], a[64:67], a[112:115], v[192:195]
ds_read_b64_tr_b16 a[88:89], v223 offset:18560
ds_read_b64_tr_b16 a[90:91], v223 offset:23168
v_mfma_f32_16x16x32_bf16 v[192:195], a[68:71], a[116:119], v[192:195]
s_xor_b32 s28, s32, 7
s_sub_u32 s29, s32, s28
v_mfma_f32_16x16x32_bf16 v[184:187], a[68:71], a[100:103], v[184:187]
s_lshl_b32 s28, s28, 18
s_and_b32 s29, s29, 3
v_mfma_f32_16x16x32_bf16 v[184:187], a[64:67], a[96:99], v[184:187]
s_add_u32 s28, s28, s49
s_lshl_b32 s50, s29, 10
v_mfma_f32_16x16x32_bf16 v[176:179], a[64:67], a[236:239], v[176:179]
ds_read_b64_tr_b16 a[92:93], v223 offset:27776
ds_read_b64_tr_b16 a[94:95], v223 offset:32384
v_mfma_f32_16x16x32_bf16 v[176:179], a[68:71], a[240:243], v[176:179]
s_add_u32 s71, s28, s50
s_add_u32 s71, s71, 4096
v_mfma_f32_16x16x32_bf16 v[168:171], a[68:71], a[224:227], v[168:171]
s_mul_i32 s29, s29, 0x1200
s_and_b32 s29, s29, 0x2200
v_mfma_f32_16x16x32_bf16 v[168:171], a[64:67], a[220:223], v[168:171]
s_add_u32 s87, s28, s29
s_waitcnt lgkmcnt(8)
v_mfma_f32_16x16x32_bf16 v[168:171], a[72:75], a[228:231], v[168:171]
ds_read_b64_tr_b16 a[64:65], v220 offset:136
ds_read_b64_tr_b16 a[66:67], v220 offset:4744
v_mfma_f32_16x16x32_bf16 v[168:171], a[76:79], a[232:235], v[168:171]
s_waitcnt vmcnt(0)
v_cmp_gt_u32 vcc, 2, v230
v_mfma_f32_16x16x32_bf16 v[176:179], a[76:79], a[132:135], v[176:179]
v_exp_f32 v58, v58
v_mfma_f32_16x16x32_bf16 v[176:179], a[72:75], a[128:131], v[176:179]
s_and_b32 s29, vcc_lo, 15
s_cbranch_scc1 SP_O3B
SP_O3B_RET:
v_mfma_f32_16x16x32_bf16 v[184:187], a[72:75], a[104:107], v[184:187]
ds_read_b64_tr_b16 a[68:69], v220 offset:9352
ds_read_b64_tr_b16 a[70:71], v220 offset:13960
v_mfma_f32_16x16x32_bf16 v[184:187], a[76:79], a[108:111], v[184:187]
s_add_u32 s39, s44, 4096
v_mfma_f32_16x16x32_bf16 v[192:195], a[76:79], a[124:127], v[192:195]
v_cvt_pk_bf16_f32 v104, v104, v105
v_cvt_pk_bf16_f32 v105, v106, v107
v_mfma_f32_16x16x32_bf16 v[192:195], a[72:75], a[120:123], v[192:195]
v_cvt_pk_bf16_f32 v106, v108, v109
v_cvt_pk_bf16_f32 v107, v110, v111
s_waitcnt lgkmcnt(8)
v_mfma_f32_16x16x32_bf16 v[192:195], a[80:83], a[48:51], v[192:195]
ds_read_b64_tr_b16 a[72:73], v220 offset:18568
ds_read_b64_tr_b16 a[74:75], v220 offset:23176
v_mfma_f32_16x16x32_bf16 v[192:195], a[84:87], a[52:55], v[192:195]
buffer_store_dwordx4 v[104:107], v244, s[20:23], s39 offen offset:0 sc0 sc1
v_mfma_f32_16x16x32_bf16 v[184:187], a[84:87], a[36:39], v[184:187]
v_cvt_pk_bf16_f32 v112, v112, v113
v_cvt_pk_bf16_f32 v113, v114, v115
v_mfma_f32_16x16x32_bf16 v[184:187], a[80:83], a[32:35], v[184:187]
v_cvt_pk_bf16_f32 v114, v116, v117
v_cvt_pk_bf16_f32 v115, v118, v119
v_mfma_f32_16x16x32_bf16 v[176:179], a[80:83], a[16:19], v[176:179]
ds_read_b64_tr_b16 a[76:77], v220 offset:27784
ds_read_b64_tr_b16 a[78:79], v220 offset:32392
v_mfma_f32_16x16x32_bf16 v[176:179], a[84:87], a[20:23], v[176:179]
buffer_store_dwordx4 v[112:115], v244, s[20:23], s39 offen offset:1024 sc0 sc1
v_mfma_f32_16x16x32_bf16 v[168:171], a[84:87], a[4:7], v[168:171]
v_cvt_pk_bf16_f32 v120, v120, v121
v_cvt_pk_bf16_f32 v121, v122, v123
v_mfma_f32_16x16x32_bf16 v[168:171], a[80:83], a[0:3], v[168:171]
v_cvt_pk_bf16_f32 v122, v124, v125
v_cvt_pk_bf16_f32 v123, v126, v127
s_waitcnt lgkmcnt(8)
v_mfma_f32_16x16x32_bf16 v[168:171], a[88:91], a[8:11], v[168:171]
ds_read_b64_tr_b16 a[80:81], v223 offset:136
ds_read_b64_tr_b16 a[82:83], v223 offset:4744
v_mfma_f32_16x16x32_bf16 v[168:171], a[92:95], a[12:15], v[168:171]
buffer_store_dwordx4 v[120:123], v244, s[20:23], s39 offen offset:2048 sc0 sc1
v_mfma_f32_16x16x32_bf16 v[176:179], a[92:95], a[28:31], v[176:179]
v_cvt_pk_bf16_f32 v128, v128, v129
v_cvt_pk_bf16_f32 v129, v130, v131
v_mfma_f32_16x16x32_bf16 v[176:179], a[88:91], a[24:27], v[176:179]
v_cvt_pk_bf16_f32 v130, v132, v133
v_cvt_pk_bf16_f32 v131, v134, v135
v_mfma_f32_16x16x32_bf16 v[184:187], a[88:91], a[40:43], v[184:187]
ds_read_b64_tr_b16 a[84:85], v223 offset:9352
ds_read_b64_tr_b16 a[86:87], v223 offset:13960
v_mfma_f32_16x16x32_bf16 v[184:187], a[92:95], a[44:47], v[184:187]
buffer_store_dwordx4 v[128:131], v244, s[20:23], s39 offen offset:3072 sc0 sc1
v_mfma_f32_16x16x32_bf16 v[192:195], a[92:95], a[60:63], v[192:195]
v_exp_f32 v59, v59
v_mfma_f32_16x16x32_bf16 v[192:195], a[88:91], a[56:59], v[192:195]
v_add_f32 v58, 1.0, v58
v_add_f32 v59, 1.0, v59
s_waitcnt lgkmcnt(8)
v_mfma_f32_16x16x32_bf16 v[196:199], a[64:67], a[112:115], v[196:199]
ds_read_b64_tr_b16 a[88:89], v223 offset:18568
ds_read_b64_tr_b16 a[90:91], v223 offset:23176
v_mfma_f32_16x16x32_bf16 v[196:199], a[68:71], a[116:119], v[196:199]
v_rcp_f32 v58, v58
v_mfma_f32_16x16x32_bf16 v[188:191], a[68:71], a[100:103], v[188:191]
v_rcp_f32 v59, v59
v_mfma_f32_16x16x32_bf16 v[188:191], a[64:67], a[96:99], v[188:191]
v_mul_f32 v48, v48, v58
v_mul_f32 v49, v49, v59
v_mfma_f32_16x16x32_bf16 v[180:183], a[64:67], a[236:239], v[180:183]
ds_read_b64_tr_b16 a[92:93], v223 offset:27784
ds_read_b64_tr_b16 a[94:95], v223 offset:32392
v_mfma_f32_16x16x32_bf16 v[180:183], a[68:71], a[240:243], v[180:183]
v_cvt_pk_bf16_f32 v58, v48, v49
v_lshlrev_b32 v48, 16, v58
v_mfma_f32_16x16x32_bf16 v[172:175], a[68:71], a[224:227], v[172:175]
v_and_b32 v49, 0xffff0000, v58
v_accvgpr_read_b32 v51, a142
v_mfma_f32_16x16x32_bf16 v[172:175], a[64:67], a[220:223], v[172:175]
v_accvgpr_read_b32 v59, a150
v_lshlrev_b32 v50, 16, v51
s_waitcnt lgkmcnt(8)
v_mfma_f32_16x16x32_bf16 v[172:175], a[72:75], a[228:231], v[172:175]
ds_read_b64_tr_b16 a[64:65], v221 offset:0
ds_read_b64_tr_b16 a[66:67], v221 offset:4608
v_mfma_f32_16x16x32_bf16 v[172:175], a[76:79], a[232:235], v[172:175]
v_and_b32 v51, 0xffff0000, v51
v_lshlrev_b32 v58, 16, v59
v_mfma_f32_16x16x32_bf16 v[180:183], a[76:79], a[132:135], v[180:183]
v_and_b32 v59, 0xffff0000, v59
v_add_f32 v50, v50, v58
v_mfma_f32_16x16x32_bf16 v[180:183], a[72:75], a[128:131], v[180:183]
v_add_f32 v51, v51, v59
v_cvt_pk_bf16_f32 v58, v50, v51
v_mfma_f32_16x16x32_bf16 v[188:191], a[72:75], a[104:107], v[188:191]
ds_read_b64_tr_b16 a[68:69], v221 offset:9216
ds_read_b64_tr_b16 a[70:71], v221 offset:13824
v_mfma_f32_16x16x32_bf16 v[188:191], a[76:79], a[108:111], v[188:191]
v_lshlrev_b32 v50, 16, v58
v_and_b32 v51, 0xffff0000, v58
v_mfma_f32_16x16x32_bf16 v[196:199], a[76:79], a[124:127], v[196:199]
v_mul_f32 v58, 0xbfb8aa3b, v50
v_mul_f32 v59, 0xbfb8aa3b, v51
v_mfma_f32_16x16x32_bf16 v[196:199], a[72:75], a[120:123], v[196:199]
v_exp_f32 v58, v58
s_waitcnt lgkmcnt(8)
v_mfma_f32_16x16x32_bf16 v[196:199], a[80:83], a[48:51], v[196:199]
ds_read_b64_tr_b16 a[72:73], v221 offset:18432
ds_read_b64_tr_b16 a[74:75], v221 offset:23040
v_mfma_f32_16x16x32_bf16 v[196:199], a[84:87], a[52:55], v[196:199]
v_exp_f32 v59, v59
v_mfma_f32_16x16x32_bf16 v[188:191], a[84:87], a[36:39], v[188:191]
v_add_f32 v58, 1.0, v58
v_add_f32 v59, 1.0, v59
v_mfma_f32_16x16x32_bf16 v[188:191], a[80:83], a[32:35], v[188:191]
v_rcp_f32 v58, v58
v_mfma_f32_16x16x32_bf16 v[180:183], a[80:83], a[16:19], v[180:183]
ds_read_b64_tr_b16 a[76:77], v221 offset:27648
ds_read_b64_tr_b16 a[78:79], v221 offset:32256
v_mfma_f32_16x16x32_bf16 v[180:183], a[84:87], a[20:23], v[180:183]
v_rcp_f32 v59, v59
v_mfma_f32_16x16x32_bf16 v[172:175], a[84:87], a[4:7], v[172:175]
v_mul_f32 v50, v50, v58
v_mul_f32 v51, v51, v59
v_mfma_f32_16x16x32_bf16 v[172:175], a[80:83], a[0:3], v[172:175]
v_cvt_pk_bf16_f32 v58, v50, v51
v_lshlrev_b32 v50, 16, v58
s_waitcnt lgkmcnt(8)
v_mfma_f32_16x16x32_bf16 v[172:175], a[88:91], a[8:11], v[172:175]
ds_read_b64_tr_b16 a[80:81], v224 offset:0
ds_read_b64_tr_b16 a[82:83], v224 offset:4608
v_mfma_f32_16x16x32_bf16 v[172:175], a[92:95], a[12:15], v[172:175]
v_and_b32 v51, 0xffff0000, v58
v_accvgpr_read_b32 v53, a143
v_mfma_f32_16x16x32_bf16 v[180:183], a[92:95], a[28:31], v[180:183]
v_accvgpr_read_b32 v59, a151
v_lshlrev_b32 v52, 16, v53
v_mfma_f32_16x16x32_bf16 v[180:183], a[88:91], a[24:27], v[180:183]
v_and_b32 v53, 0xffff0000, v53
v_lshlrev_b32 v58, 16, v59
v_mfma_f32_16x16x32_bf16 v[188:191], a[88:91], a[40:43], v[188:191]
ds_read_b64_tr_b16 a[84:85], v224 offset:9216
ds_read_b64_tr_b16 a[86:87], v224 offset:13824
v_mfma_f32_16x16x32_bf16 v[188:191], a[92:95], a[44:47], v[188:191]
v_and_b32 v59, 0xffff0000, v59
v_add_f32 v52, v52, v58
v_mfma_f32_16x16x32_bf16 v[196:199], a[92:95], a[60:63], v[196:199]
v_add_f32 v53, v53, v59
v_cvt_pk_bf16_f32 v58, v52, v53
v_mfma_f32_16x16x32_bf16 v[196:199], a[88:91], a[56:59], v[196:199]
v_lshlrev_b32 v52, 16, v58
v_and_b32 v53, 0xffff0000, v58
s_waitcnt lgkmcnt(8)
v_mfma_f32_16x16x32_bf16 v[212:215], a[64:67], a[112:115], v[212:215]
ds_read_b64_tr_b16 a[88:89], v224 offset:18432
ds_read_b64_tr_b16 a[90:91], v224 offset:23040
v_mfma_f32_16x16x32_bf16 v[212:215], a[68:71], a[116:119], v[212:215]
v_mul_f32 v58, 0xbfb8aa3b, v52
v_mul_f32 v59, 0xbfb8aa3b, v53
v_mfma_f32_16x16x32_bf16 v[208:211], a[68:71], a[100:103], v[208:211]
v_exp_f32 v58, v58
v_mfma_f32_16x16x32_bf16 v[208:211], a[64:67], a[96:99], v[208:211]
v_exp_f32 v59, v59
v_mfma_f32_16x16x32_bf16 v[204:207], a[64:67], a[236:239], v[204:207]
ds_read_b64_tr_b16 a[92:93], v224 offset:27648
ds_read_b64_tr_b16 a[94:95], v224 offset:32256
v_mfma_f32_16x16x32_bf16 v[204:207], a[68:71], a[240:243], v[204:207]
v_add_f32 v58, 1.0, v58
v_add_f32 v59, 1.0, v59
v_mfma_f32_16x16x32_bf16 v[200:203], a[68:71], a[224:227], v[200:203]
v_rcp_f32 v58, v58
v_mfma_f32_16x16x32_bf16 v[200:203], a[64:67], a[220:223], v[200:203]
v_rcp_f32 v59, v59
s_waitcnt lgkmcnt(8)
v_mfma_f32_16x16x32_bf16 v[200:203], a[72:75], a[228:231], v[200:203]
ds_read_b64_tr_b16 a[64:65], v219 offset:0
ds_read_b64_tr_b16 a[66:67], v219 offset:4608
v_mfma_f32_16x16x32_bf16 v[200:203], a[76:79], a[232:235], v[200:203]
s_add_u32 s39, s44, 12288
v_mul_f32 v52, v52, v58
v_mfma_f32_16x16x32_bf16 v[204:207], a[76:79], a[132:135], v[204:207]
v_cvt_pk_bf16_f32 v168, v168, v169
v_cvt_pk_bf16_f32 v169, v170, v171
v_mfma_f32_16x16x32_bf16 v[204:207], a[72:75], a[128:131], v[204:207]
v_cvt_pk_bf16_f32 v170, v172, v173
v_cvt_pk_bf16_f32 v171, v174, v175
v_mfma_f32_16x16x32_bf16 v[208:211], a[72:75], a[104:107], v[208:211]
ds_read_b64_tr_b16 a[68:69], v219 offset:9216
ds_read_b64_tr_b16 a[70:71], v219 offset:13824
v_mfma_f32_16x16x32_bf16 v[208:211], a[76:79], a[108:111], v[208:211]
buffer_store_dwordx4 v[168:171], v244, s[20:23], s39 offen offset:0 sc0 sc1
v_mfma_f32_16x16x32_bf16 v[212:215], a[76:79], a[124:127], v[212:215]
v_cvt_pk_bf16_f32 v176, v176, v177
v_cvt_pk_bf16_f32 v177, v178, v179
v_mfma_f32_16x16x32_bf16 v[212:215], a[72:75], a[120:123], v[212:215]
v_cvt_pk_bf16_f32 v178, v180, v181
v_cvt_pk_bf16_f32 v179, v182, v183
s_waitcnt lgkmcnt(8)
v_mfma_f32_16x16x32_bf16 v[212:215], a[80:83], a[48:51], v[212:215]
ds_read_b64_tr_b16 a[72:73], v219 offset:18432
ds_read_b64_tr_b16 a[74:75], v219 offset:23040
v_mfma_f32_16x16x32_bf16 v[212:215], a[84:87], a[52:55], v[212:215]
buffer_store_dwordx4 v[176:179], v244, s[20:23], s39 offen offset:1024 sc0 sc1
v_mfma_f32_16x16x32_bf16 v[208:211], a[84:87], a[36:39], v[208:211]
v_cvt_pk_bf16_f32 v184, v184, v185
v_cvt_pk_bf16_f32 v185, v186, v187
v_mfma_f32_16x16x32_bf16 v[208:211], a[80:83], a[32:35], v[208:211]
v_cvt_pk_bf16_f32 v186, v188, v189
v_cvt_pk_bf16_f32 v187, v190, v191
v_mfma_f32_16x16x32_bf16 v[204:207], a[80:83], a[16:19], v[204:207]
ds_read_b64_tr_b16 a[76:77], v219 offset:27648
ds_read_b64_tr_b16 a[78:79], v219 offset:32256
v_mfma_f32_16x16x32_bf16 v[204:207], a[84:87], a[20:23], v[204:207]
buffer_store_dwordx4 v[184:187], v244, s[20:23], s39 offen offset:2048 sc0 sc1
v_mfma_f32_16x16x32_bf16 v[200:203], a[84:87], a[4:7], v[200:203]
v_cvt_pk_bf16_f32 v192, v192, v193
v_cvt_pk_bf16_f32 v193, v194, v195
v_mfma_f32_16x16x32_bf16 v[200:203], a[80:83], a[0:3], v[200:203]
v_cvt_pk_bf16_f32 v194, v196, v197
v_cvt_pk_bf16_f32 v195, v198, v199
s_waitcnt lgkmcnt(8)
v_mfma_f32_16x16x32_bf16 v[200:203], a[88:91], a[8:11], v[200:203]
ds_read_b64_tr_b16 a[80:81], v222 offset:0
ds_read_b64_tr_b16 a[82:83], v222 offset:4608
v_mfma_f32_16x16x32_bf16 v[200:203], a[92:95], a[12:15], v[200:203]
buffer_store_dwordx4 v[192:195], v244, s[20:23], s39 offen offset:3072 sc0 sc1
v_mfma_f32_16x16x32_bf16 v[204:207], a[92:95], a[28:31], v[204:207]
ds_read_b64_tr_b16 a[156:157], v219 offset:128
ds_read_b64_tr_b16 a[158:159], v219 offset:4736
v_mfma_f32_16x16x32_bf16 v[204:207], a[88:91], a[24:27], v[204:207]
v_mul_f32 v53, v53, v59
v_cvt_pk_bf16_f32 v58, v52, v53
v_mfma_f32_16x16x32_bf16 v[208:211], a[88:91], a[40:43], v[208:211]
ds_read_b64_tr_b16 a[84:85], v222 offset:9216
ds_read_b64_tr_b16 a[86:87], v222 offset:13824
v_mfma_f32_16x16x32_bf16 v[208:211], a[92:95], a[44:47], v[208:211]
v_lshlrev_b32 v52, 16, v58
v_and_b32 v53, 0xffff0000, v58
v_mfma_f32_16x16x32_bf16 v[212:215], a[92:95], a[60:63], v[212:215]
ds_read_b64_tr_b16 a[160:161], v219 offset:9344
ds_read_b64_tr_b16 a[162:163], v219 offset:13952
v_mfma_f32_16x16x32_bf16 v[212:215], a[88:91], a[56:59], v[212:215]
v_accvgpr_read_b32 v55, a254
v_accvgpr_read_b32 v59, a152
s_waitcnt lgkmcnt(8)
v_mfma_f32_16x16x32_bf16 v[96:99], a[64:67], a[112:115], v[96:99]
ds_read_b64_tr_b16 a[88:89], v222 offset:18432
ds_read_b64_tr_b16 a[90:91], v222 offset:23040
v_mfma_f32_16x16x32_bf16 v[96:99], a[68:71], a[116:119], v[96:99]
v_lshlrev_b32 v54, 16, v55
v_and_b32 v55, 0xffff0000, v55
v_mfma_f32_16x16x32_bf16 v[88:91], a[68:71], a[100:103], v[88:91]
ds_read_b64_tr_b16 a[164:165], v219 offset:18560
ds_read_b64_tr_b16 a[166:167], v219 offset:23168
v_mfma_f32_16x16x32_bf16 v[88:91], a[64:67], a[96:99], v[88:91]
v_lshlrev_b32 v58, 16, v59
v_and_b32 v59, 0xffff0000, v59
v_mfma_f32_16x16x32_bf16 v[80:83], a[64:67], a[236:239], v[80:83]
ds_read_b64_tr_b16 a[92:93], v222 offset:27648
ds_read_b64_tr_b16 a[94:95], v222 offset:32256
v_mfma_f32_16x16x32_bf16 v[80:83], a[68:71], a[240:243], v[80:83]
v_add_f32 v54, v54, v58
v_add_f32 v55, v55, v59
v_mfma_f32_16x16x32_bf16 v[72:75], a[68:71], a[224:227], v[72:75]
ds_read_b64_tr_b16 a[168:169], v219 offset:27776
ds_read_b64_tr_b16 a[170:171], v219 offset:32384
v_mfma_f32_16x16x32_bf16 v[72:75], a[64:67], a[220:223], v[72:75]
v_cvt_pk_bf16_f32 v58, v54, v55
v_lshlrev_b32 v54, 16, v58
v_mfma_f32_16x16x32_bf16 v[72:75], a[72:75], a[228:231], v[72:75]
ds_read_b64_tr_b16 a[64:65], v219 offset:8
ds_read_b64_tr_b16 a[66:67], v219 offset:4616
v_mfma_f32_16x16x32_bf16 v[72:75], a[76:79], a[232:235], v[72:75]
s_add_u32 s39, s44, 8192
v_and_b32 v55, 0xffff0000, v58
v_mfma_f32_16x16x32_bf16 v[80:83], a[76:79], a[132:135], v[80:83]
ds_read_b64_tr_b16 a[172:173], v222 offset:128
ds_read_b64_tr_b16 a[174:175], v222 offset:4736
v_mfma_f32_16x16x32_bf16 v[80:83], a[72:75], a[128:131], v[80:83]
v_cvt_pk_bf16_f32 v200, v200, v201
v_cvt_pk_bf16_f32 v201, v202, v203
v_mfma_f32_16x16x32_bf16 v[88:91], a[72:75], a[104:107], v[88:91]
ds_read_b64_tr_b16 a[68:69], v219 offset:9224
ds_read_b64_tr_b16 a[70:71], v219 offset:13832
v_mfma_f32_16x16x32_bf16 v[88:91], a[76:79], a[108:111], v[88:91]
buffer_store_dwordx2 v[200:201], v226, s[20:23], s44 offen offset:0 sc0 sc1
v_mfma_f32_16x16x32_bf16 v[96:99], a[76:79], a[124:127], v[96:99]
ds_read_b64_tr_b16 a[176:177], v222 offset:9344
ds_read_b64_tr_b16 a[178:179], v222 offset:13952
v_mfma_f32_16x16x32_bf16 v[96:99], a[72:75], a[120:123], v[96:99]
v_cvt_pk_bf16_f32 v204, v204, v205
v_cvt_pk_bf16_f32 v205, v206, v207
s_waitcnt lgkmcnt(8)
v_mfma_f32_16x16x32_bf16 v[96:99], a[80:83], a[48:51], v[96:99]
ds_read_b64_tr_b16 a[72:73], v219 offset:18440
ds_read_b64_tr_b16 a[74:75], v219 offset:23048
v_mfma_f32_16x16x32_bf16 v[96:99], a[84:87], a[52:55], v[96:99]
buffer_store_dwordx2 v[204:205], v226, s[20:23], s44 offen offset:512 sc0 sc1
v_mfma_f32_16x16x32_bf16 v[88:91], a[84:87], a[36:39], v[88:91]
ds_read_b64_tr_b16 a[180:181], v222 offset:18560
ds_read_b64_tr_b16 a[182:183], v222 offset:23168
v_mfma_f32_16x16x32_bf16 v[88:91], a[80:83], a[32:35], v[88:91]
v_cvt_pk_bf16_f32 v208, v208, v209
v_cvt_pk_bf16_f32 v209, v210, v211
v_mfma_f32_16x16x32_bf16 v[80:83], a[80:83], a[16:19], v[80:83]
ds_read_b64_tr_b16 a[76:77], v219 offset:27656
ds_read_b64_tr_b16 a[78:79], v219 offset:32264
v_mfma_f32_16x16x32_bf16 v[80:83], a[84:87], a[20:23], v[80:83]
buffer_store_dwordx2 v[208:209], v226, s[20:23], s39 offen offset:0 sc0 sc1
v_mfma_f32_16x16x32_bf16 v[72:75], a[84:87], a[4:7], v[72:75]
ds_read_b64_tr_b16 a[184:185], v222 offset:27776
ds_read_b64_tr_b16 a[186:187], v222 offset:32384
v_mfma_f32_16x16x32_bf16 v[72:75], a[80:83], a[0:3], v[72:75]
v_cvt_pk_bf16_f32 v212, v212, v213
v_cvt_pk_bf16_f32 v213, v214, v215
v_mfma_f32_16x16x32_bf16 v[72:75], a[88:91], a[8:11], v[72:75]
ds_read_b64_tr_b16 a[80:81], v222 offset:8
ds_read_b64_tr_b16 a[82:83], v222 offset:4616
v_mfma_f32_16x16x32_bf16 v[72:75], a[92:95], a[12:15], v[72:75]
buffer_store_dwordx2 v[212:213], v226, s[20:23], s39 offen offset:512 sc0 sc1
v_mfma_f32_16x16x32_bf16 v[80:83], a[92:95], a[28:31], v[80:83]
ds_read_b64_tr_b16 a[188:189], v219 offset:136
ds_read_b64_tr_b16 a[190:191], v219 offset:4744
v_mfma_f32_16x16x32_bf16 v[80:83], a[88:91], a[24:27], v[80:83]
s_lshl2_add_u32 s28, s32, s95
v_mul_f32 v58, 0xbfb8aa3b, v54
v_mfma_f32_16x16x32_bf16 v[88:91], a[88:91], a[40:43], v[88:91]
ds_read_b64_tr_b16 a[84:85], v222 offset:9224
ds_read_b64_tr_b16 a[86:87], v222 offset:13832
v_mfma_f32_16x16x32_bf16 v[88:91], a[92:95], a[44:47], v[88:91]
v_mul_f32 v59, 0xbfb8aa3b, v55
v_mfma_f32_16x16x32_bf16 v[96:99], a[92:95], a[60:63], v[96:99]
ds_read_b64_tr_b16 a[192:193], v219 offset:9352
ds_read_b64_tr_b16 a[194:195], v219 offset:13960
v_mfma_f32_16x16x32_bf16 v[96:99], a[88:91], a[56:59], v[96:99]
v_exp_f32 v58, v58
s_waitcnt lgkmcnt(8)
v_mfma_f32_16x16x32_bf16 v[100:103], a[64:67], a[112:115], v[100:103]
ds_read_b64_tr_b16 a[88:89], v222 offset:18440
ds_read_b64_tr_b16 a[90:91], v222 offset:23048
v_mfma_f32_16x16x32_bf16 v[100:103], a[68:71], a[116:119], v[100:103]
v_exp_f32 v59, v59
v_mfma_f32_16x16x32_bf16 v[92:95], a[68:71], a[100:103], v[92:95]
ds_read_b64_tr_b16 a[196:197], v219 offset:18568
ds_read_b64_tr_b16 a[198:199], v219 offset:23176
v_mfma_f32_16x16x32_bf16 v[92:95], a[64:67], a[96:99], v[92:95]
v_add_f32 v58, 1.0, v58
v_add_f32 v59, 1.0, v59
v_mfma_f32_16x16x32_bf16 v[84:87], a[64:67], a[236:239], v[84:87]
ds_read_b64_tr_b16 a[92:93], v222 offset:27656
ds_read_b64_tr_b16 a[94:95], v222 offset:32264
v_mfma_f32_16x16x32_bf16 v[84:87], a[68:71], a[240:243], v[84:87]
v_rcp_f32 v58, v58
v_mfma_f32_16x16x32_bf16 v[76:79], a[68:71], a[224:227], v[76:79]
ds_read_b64_tr_b16 a[200:201], v219 offset:27784
ds_read_b64_tr_b16 a[202:203], v219 offset:32392
v_mfma_f32_16x16x32_bf16 v[76:79], a[64:67], a[220:223], v[76:79]
v_rcp_f32 v59, v59
v_mfma_f32_16x16x32_bf16 v[76:79], a[72:75], a[228:231], v[76:79]
v_mul_f32 v54, v54, v58
v_mul_f32 v55, v55, v59
v_mfma_f32_16x16x32_bf16 v[76:79], a[76:79], a[232:235], v[76:79]
v_cvt_pk_bf16_f32 v58, v54, v55
v_lshlrev_b32 v54, 16, v58
v_mfma_f32_16x16x32_bf16 v[84:87], a[76:79], a[132:135], v[84:87]
ds_read_b64_tr_b16 a[204:205], v222 offset:136
ds_read_b64_tr_b16 a[206:207], v222 offset:4744
v_mfma_f32_16x16x32_bf16 v[84:87], a[72:75], a[128:131], v[84:87]
v_and_b32 v55, 0xffff0000, v58
v_accvgpr_read_b32 v57, a255
v_mfma_f32_16x16x32_bf16 v[92:95], a[72:75], a[104:107], v[92:95]
v_accvgpr_read_b32 v59, a153
v_lshlrev_b32 v56, 16, v57
v_mfma_f32_16x16x32_bf16 v[92:95], a[76:79], a[108:111], v[92:95]
s_waitcnt vmcnt(0)
buffer_store_dword v231, v254, s[20:23], s28 offen sc0 sc1
v_mfma_f32_16x16x32_bf16 v[100:103], a[76:79], a[124:127], v[100:103]
ds_read_b64_tr_b16 a[208:209], v222 offset:9352
ds_read_b64_tr_b16 a[210:211], v222 offset:13960
v_mfma_f32_16x16x32_bf16 v[100:103], a[72:75], a[120:123], v[100:103]
v_and_b32 v57, 0xffff0000, v57
v_lshlrev_b32 v58, 16, v59
s_waitcnt lgkmcnt(8)
v_mfma_f32_16x16x32_bf16 v[100:103], a[80:83], a[48:51], v[100:103]
v_and_b32 v59, 0xffff0000, v59
v_add_f32 v56, v56, v58
v_mfma_f32_16x16x32_bf16 v[100:103], a[84:87], a[52:55], v[100:103]
v_add_f32 v57, v57, v59
v_cvt_pk_bf16_f32 v58, v56, v57
v_mfma_f32_16x16x32_bf16 v[92:95], a[84:87], a[36:39], v[92:95]
ds_read_b64_tr_b16 a[212:213], v222 offset:18568
ds_read_b64_tr_b16 a[214:215], v222 offset:23176
v_mfma_f32_16x16x32_bf16 v[92:95], a[80:83], a[32:35], v[92:95]
v_lshlrev_b32 v56, 16, v58
v_and_b32 v57, 0xffff0000, v58
v_mfma_f32_16x16x32_bf16 v[84:87], a[80:83], a[16:19], v[84:87]
v_mul_f32 v58, 0xbfb8aa3b, v56
v_mul_f32 v59, 0xbfb8aa3b, v57
v_mfma_f32_16x16x32_bf16 v[84:87], a[84:87], a[20:23], v[84:87]
v_exp_f32 v58, v58
v_mfma_f32_16x16x32_bf16 v[76:79], a[84:87], a[4:7], v[76:79]
ds_read_b64_tr_b16 a[216:217], v222 offset:27784
ds_read_b64_tr_b16 a[218:219], v222 offset:32392
v_mfma_f32_16x16x32_bf16 v[76:79], a[80:83], a[0:3], v[76:79]
s_waitcnt vmcnt(1)
buffer_load_dword v230, v229, s[20:23], s95 offen sc0 sc1
v_mfma_f32_16x16x32_bf16 v[76:79], a[88:91], a[8:11], v[76:79]
v_exp_f32 v59, v59
s_waitcnt lgkmcnt(8)
v_mfma_f32_16x16x32_bf16 v[76:79], a[92:95], a[12:15], v[76:79]
v_add_f32 v58, 1.0, v58
v_add_f32 v59, 1.0, v59
v_mfma_f32_16x16x32_bf16 v[84:87], a[92:95], a[28:31], v[84:87]
v_rcp_f32 v58, v58
v_mfma_f32_16x16x32_bf16 v[84:87], a[88:91], a[24:27], v[84:87]
v_rcp_f32 v59, v59
v_mfma_f32_16x16x32_bf16 v[92:95], a[88:91], a[40:43], v[92:95]
v_mul_f32 v56, v56, v58
v_mul_f32 v57, v57, v59
v_mfma_f32_16x16x32_bf16 v[92:95], a[92:95], a[44:47], v[92:95]
v_cvt_pk_bf16_f32 v58, v56, v57
v_lshlrev_b32 v56, 16, v58
v_mfma_f32_16x16x32_bf16 v[100:103], a[92:95], a[60:63], v[100:103]
v_and_b32 v57, 0xffff0000, v58
v_accvgpr_read_b32 v19, a244
v_mfma_f32_16x16x32_bf16 v[100:103], a[88:91], a[56:59], v[100:103]
v_lshlrev_b32 v18, 16, v19
v_and_b32 v19, 0xffff0000, v19
v_mfma_f32_16x16x32_bf16 v[144:147], a[156:159], a[236:239], v[144:147]
v_accvgpr_read_b32 v21, a245
v_lshlrev_b32 v20, 16, v21
v_mfma_f32_16x16x32_bf16 v[144:147], a[160:163], a[240:243], v[144:147]
v_and_b32 v21, 0xffff0000, v21
v_accvgpr_read_b32 v23, a246
v_mfma_f32_16x16x32_bf16 v[144:147], a[164:167], a[128:131], v[144:147]
v_lshlrev_b32 v22, 16, v23
v_and_b32 v23, 0xffff0000, v23
v_mfma_f32_16x16x32_bf16 v[144:147], a[168:171], a[132:135], v[144:147]
v_accvgpr_read_b32 v25, a247
v_lshlrev_b32 v24, 16, v25
v_mfma_f32_16x16x32_bf16 v[144:147], a[172:175], a[16:19], v[144:147]
v_and_b32 v25, 0xffff0000, v25
v_accvgpr_read_b32 v27, a248
v_mfma_f32_16x16x32_bf16 v[144:147], a[176:179], a[20:23], v[144:147]
v_lshlrev_b32 v26, 16, v27
v_and_b32 v27, 0xffff0000, v27
v_mfma_f32_16x16x32_bf16 v[144:147], a[180:183], a[24:27], v[144:147]
v_accvgpr_read_b32 v29, a249
v_lshlrev_b32 v28, 16, v29
v_mfma_f32_16x16x32_bf16 v[144:147], a[184:187], a[28:31], v[144:147]
v_and_b32 v29, 0xffff0000, v29
v_accvgpr_read_b32 v31, a250
s_waitcnt lgkmcnt(0)
v_mfma_f32_16x16x32_bf16 v[148:151], a[216:219], a[28:31], v[148:151]
s_add_u32 s39, s44, 0
v_lshlrev_b32 v30, 16, v31
v_mfma_f32_16x16x32_bf16 v[148:151], a[212:215], a[24:27], v[148:151]
v_cvt_pk_bf16_f32 v80, v80, v81
v_cvt_pk_bf16_f32 v81, v82, v83
v_mfma_f32_16x16x32_bf16 v[148:151], a[208:211], a[20:23], v[148:151]
v_cvt_pk_bf16_f32 v82, v84, v85
v_cvt_pk_bf16_f32 v83, v86, v87
v_mfma_f32_16x16x32_bf16 v[148:151], a[204:207], a[16:19], v[148:151]
buffer_store_dwordx4 v[80:83], v244, s[20:23], s39 offen offset:1024 sc0 sc1
v_mfma_f32_16x16x32_bf16 v[148:151], a[200:203], a[132:135], v[148:151]
v_cvt_pk_bf16_f32 v88, v88, v89
v_cvt_pk_bf16_f32 v89, v90, v91
v_mfma_f32_16x16x32_bf16 v[148:151], a[196:199], a[128:131], v[148:151]
v_cvt_pk_bf16_f32 v90, v92, v93
v_cvt_pk_bf16_f32 v91, v94, v95
v_mfma_f32_16x16x32_bf16 v[148:151], a[192:195], a[240:243], v[148:151]
buffer_store_dwordx4 v[88:91], v244, s[20:23], s39 offen offset:2048 sc0 sc1
v_mfma_f32_16x16x32_bf16 v[148:151], a[188:191], a[236:239], v[148:151]
v_cvt_pk_bf16_f32 v96, v96, v97
v_cvt_pk_bf16_f32 v97, v98, v99
v_mfma_f32_16x16x32_bf16 v[156:159], a[188:191], a[96:99], v[156:159]
v_cvt_pk_bf16_f32 v98, v100, v101
v_cvt_pk_bf16_f32 v99, v102, v103
v_mfma_f32_16x16x32_bf16 v[156:159], a[192:195], a[100:103], v[156:159]
buffer_store_dwordx4 v[96:99], v244, s[20:23], s39 offen offset:3072 sc0 sc1
v_mfma_f32_16x16x32_bf16 v[156:159], a[196:199], a[104:107], v[156:159]
s_add_u32 s39, s44, 8192
v_and_b32 v31, 0xffff0000, v31
v_mfma_f32_16x16x32_bf16 v[156:159], a[200:203], a[108:111], v[156:159]
s_waitcnt vmcnt(3)
v_cmp_gt_u32 vcc, 1, v230
v_mfma_f32_16x16x32_bf16 v[156:159], a[204:207], a[32:35], v[156:159]
v_accvgpr_read_b32 v33, a251
v_lshlrev_b32 v32, 16, v33
v_mfma_f32_16x16x32_bf16 v[156:159], a[208:211], a[36:39], v[156:159]
s_and_b32 s29, vcc_lo, 0xff
s_cbranch_scc1 SP_P1B
SP_P1B_RET:
v_mfma_f32_16x16x32_bf16 v[156:159], a[212:215], a[40:43], v[156:159]
v_and_b32 v33, 0xffff0000, v33
v_accvgpr_read_b32 v35, a252
v_mfma_f32_16x16x32_bf16 v[156:159], a[216:219], a[44:47], v[156:159]
v_cvt_pk_bf16_f32 v144, v144, v145
v_cvt_pk_bf16_f32 v145, v146, v147
v_mfma_f32_16x16x32_bf16 v[152:155], a[184:187], a[44:47], v[152:155]
v_cvt_pk_bf16_f32 v146, v148, v149
v_cvt_pk_bf16_f32 v147, v150, v151
v_mfma_f32_16x16x32_bf16 v[152:155], a[180:183], a[40:43], v[152:155]
buffer_store_dwordx4 v[144:147], v244, s[20:23], s39 offen offset:1024 sc0 sc1
v_mfma_f32_16x16x32_bf16 v[152:155], a[176:179], a[36:39], v[152:155]
buffer_load_dwordx4 v[104:107], v244, s[20:23], s68 offen sc0 sc1
v_mfma_f32_16x16x32_bf16 v[152:155], a[172:175], a[32:35], v[152:155]
v_lshlrev_b32 v34, 16, v35
v_and_b32 v35, 0xffff0000, v35
v_mfma_f32_16x16x32_bf16 v[152:155], a[168:171], a[108:111], v[152:155]
v_accvgpr_read_b32 v37, a253
v_lshlrev_b32 v36, 16, v37
v_mfma_f32_16x16x32_bf16 v[152:155], a[164:167], a[104:107], v[152:155]
buffer_load_dwordx4 v[108:111], v244, s[20:23], s69 offen sc0 sc1
v_mfma_f32_16x16x32_bf16 v[152:155], a[160:163], a[100:103], v[152:155]
v_and_b32 v37, 0xffff0000, v37
v_mfma_f32_16x16x32_bf16 v[152:155], a[156:159], a[96:99], v[152:155]
s_mov_b32 s90, 0x3f80
s_mov_b32 s91, 0x3f800000
v_mfma_f32_16x16x32_bf16 v[160:163], a[156:159], a[112:115], v[160:163]
buffer_load_dwordx4 v[112:115], v244, s[20:23], s70 offen sc0 sc1
v_mfma_f32_16x16x32_bf16 v[160:163], a[160:163], a[116:119], v[160:163]
v_mov_b32 v66, 0
v_mov_b32 v67, 0
v_mfma_f32_16x16x32_bf16 v[160:163], a[164:167], a[120:123], v[160:163]
v_mov_b32 v68, 0
v_mov_b32 v69, 0
v_mfma_f32_16x16x32_bf16 v[160:163], a[168:171], a[124:127], v[160:163]
buffer_load_dwordx4 v[116:119], v244, s[20:23], s71 offen sc0 sc1
v_mfma_f32_16x16x32_bf16 v[160:163], a[172:175], a[48:51], v[160:163]
v_mfma_f32_16x16x32_bf16 v[160:163], a[176:179], a[52:55], v[160:163]
v_mfma_f32_16x16x32_bf16 v[160:163], a[180:183], a[56:59], v[160:163]
buffer_load_dwordx2 v[200:201], v226, s[20:23], s72 offen sc0 sc1
v_mfma_f32_16x16x32_bf16 v[160:163], a[184:187], a[60:63], v[160:163]
v_cvt_pk_bf16_f32 v152, v152, v153
v_cvt_pk_bf16_f32 v153, v154, v155
v_mfma_f32_16x16x32_bf16 v[164:167], a[216:219], a[60:63], v[164:167]
v_cvt_pk_bf16_f32 v154, v156, v157
v_cvt_pk_bf16_f32 v155, v158, v159
v_mfma_f32_16x16x32_bf16 v[164:167], a[212:215], a[56:59], v[164:167]
buffer_store_dwordx4 v[152:155], v244, s[20:23], s39 offen offset:2048 sc0 sc1
v_mfma_f32_16x16x32_bf16 v[164:167], a[208:211], a[52:55], v[164:167]
buffer_load_dwordx2 v[202:203], v226, s[20:23], s73 offen sc0 sc1
v_mfma_f32_16x16x32_bf16 v[164:167], a[204:207], a[48:51], v[164:167]
v_mfma_f32_16x16x32_bf16 v[164:167], a[200:203], a[124:127], v[164:167]
v_mfma_f32_16x16x32_bf16 v[164:167], a[196:199], a[120:123], v[164:167]
buffer_load_dwordx2 v[204:205], v226, s[20:23], s74 offen sc0 sc1
v_mfma_f32_16x16x32_bf16 v[164:167], a[192:195], a[116:119], v[164:167]
v_mfma_f32_16x16x32_bf16 v[164:167], a[188:191], a[112:115], v[164:167]
v_mfma_f32_16x16x32_bf16 v[140:143], a[188:191], a[220:223], v[140:143]
buffer_load_dwordx2 v[206:207], v226, s[20:23], s75 offen sc0 sc1
v_mfma_f32_16x16x32_bf16 v[140:143], a[192:195], a[224:227], v[140:143]
v_mfma_f32_16x16x32_bf16 v[140:143], a[196:199], a[228:231], v[140:143]
v_mfma_f32_16x16x32_bf16 v[140:143], a[200:203], a[232:235], v[140:143]
buffer_load_dwordx2 v[208:209], v226, s[20:23], s84 offen sc0 sc1
v_mfma_f32_16x16x32_bf16 v[140:143], a[204:207], a[0:3], v[140:143]
v_mfma_f32_16x16x32_bf16 v[140:143], a[208:211], a[4:7], v[140:143]
v_mfma_f32_16x16x32_bf16 v[140:143], a[212:215], a[8:11], v[140:143]
buffer_load_dwordx2 v[210:211], v226, s[20:23], s85 offen sc0 sc1
v_mfma_f32_16x16x32_bf16 v[140:143], a[216:219], a[12:15], v[140:143]
v_cvt_pk_bf16_f32 v160, v160, v161
v_cvt_pk_bf16_f32 v161, v162, v163
v_mfma_f32_16x16x32_bf16 v[136:139], a[184:187], a[12:15], v[136:139]
v_cvt_pk_bf16_f32 v162, v164, v165
v_cvt_pk_bf16_f32 v163, v166, v167
v_mfma_f32_16x16x32_bf16 v[136:139], a[180:183], a[8:11], v[136:139]
buffer_store_dwordx4 v[160:163], v244, s[20:23], s39 offen offset:3072 sc0 sc1
v_mfma_f32_16x16x32_bf16 v[136:139], a[176:179], a[4:7], v[136:139]
buffer_load_dwordx2 v[212:213], v226, s[20:23], s86 offen sc0 sc1
v_mfma_f32_16x16x32_bf16 v[136:139], a[172:175], a[0:3], v[136:139]
v_mfma_f32_16x16x32_bf16 v[136:139], a[168:171], a[232:235], v[136:139]
v_mfma_f32_16x16x32_bf16 v[136:139], a[164:167], a[228:231], v[136:139]
buffer_load_dwordx2 v[214:215], v226, s[20:23], s87 offen sc0 sc1
v_mfma_f32_16x16x32_bf16 v[136:139], a[160:163], a[224:227], v[136:139]
v_mfma_f32_16x16x32_bf16 v[136:139], a[156:159], a[220:223], v[136:139]
buffer_load_dwordx4 v[120:123], v243, s[20:23], s68 offen sc0 sc1
buffer_load_dwordx4 v[124:127], v243, s[20:23], s69 offen sc0 sc1
buffer_load_dwordx4 v[128:131], v243, s[20:23], s70 offen sc0 sc1
buffer_load_dwordx4 v[132:135], v243, s[20:23], s71 offen sc0 sc1
s_lshl_b32 s50, s34, 2
s_lshl_b32 s50, 15, s50
s_waitcnt vmcnt(6)
buffer_store_dword v246, v254, s[20:23], s28 offen sc0 sc1
s_waitcnt vmcnt(18)
v_dot2c_f32_bf16 v72, s90, v104
v_dot2c_f32_bf16 v73, s91, v104
v_dot2c_f32_bf16 v74, s90, v105
v_dot2c_f32_bf16 v75, s91, v105
v_dot2c_f32_bf16 v76, s90, v106
v_dot2c_f32_bf16 v77, s91, v106
v_dot2c_f32_bf16 v78, s90, v107
v_dot2c_f32_bf16 v79, s91, v107
s_waitcnt vmcnt(17)
v_dot2c_f32_bf16 v72, s90, v108
v_dot2c_f32_bf16 v73, s91, v108
v_dot2c_f32_bf16 v74, s90, v109
v_dot2c_f32_bf16 v75, s91, v109
v_dot2c_f32_bf16 v76, s90, v110
v_dot2c_f32_bf16 v77, s91, v110
v_dot2c_f32_bf16 v78, s90, v111
v_dot2c_f32_bf16 v79, s91, v111
s_waitcnt vmcnt(16)
v_dot2c_f32_bf16 v72, s90, v112
v_dot2c_f32_bf16 v73, s91, v112
v_dot2c_f32_bf16 v74, s90, v113
v_dot2c_f32_bf16 v75, s91, v113
v_dot2c_f32_bf16 v76, s90, v114
v_dot2c_f32_bf16 v77, s91, v114
v_dot2c_f32_bf16 v78, s90, v115
v_dot2c_f32_bf16 v79, s91, v115
s_waitcnt vmcnt(15)
v_dot2c_f32_bf16 v72, s90, v116
v_dot2c_f32_bf16 v73, s91, v116
v_dot2c_f32_bf16 v74, s90, v117
v_dot2c_f32_bf16 v75, s91, v117
v_dot2c_f32_bf16 v76, s90, v118
v_dot2c_f32_bf16 v77, s91, v118
v_dot2c_f32_bf16 v78, s90, v119
v_dot2c_f32_bf16 v79, s91, v119
buffer_load_dword v230, v229, s[20:23], s95 offen sc0 sc1
s_waitcnt vmcnt(5)
v_dot2c_f32_bf16 v136, s90, v120
v_dot2c_f32_bf16 v137, s91, v120
v_dot2c_f32_bf16 v138, s90, v121
v_dot2c_f32_bf16 v139, s91, v121
v_dot2c_f32_bf16 v140, s90, v122
v_dot2c_f32_bf16 v141, s91, v122
v_dot2c_f32_bf16 v142, s90, v123
v_dot2c_f32_bf16 v143, s91, v123
s_waitcnt vmcnt(4)
v_dot2c_f32_bf16 v136, s90, v124
v_dot2c_f32_bf16 v137, s91, v124
v_dot2c_f32_bf16 v138, s90, v125
v_dot2c_f32_bf16 v139, s91, v125
v_dot2c_f32_bf16 v140, s90, v126
v_dot2c_f32_bf16 v141, s91, v126
v_dot2c_f32_bf16 v142, s90, v127
v_dot2c_f32_bf16 v143, s91, v127
s_waitcnt vmcnt(3)
v_dot2c_f32_bf16 v136, s90, v128
v_dot2c_f32_bf16 v137, s91, v128
v_dot2c_f32_bf16 v138, s90, v129
v_dot2c_f32_bf16 v139, s91, v129
v_dot2c_f32_bf16 v140, s90, v130
v_dot2c_f32_bf16 v141, s91, v130
v_dot2c_f32_bf16 v142, s90, v131
v_dot2c_f32_bf16 v143, s91, v131
s_waitcnt vmcnt(2)
v_dot2c_f32_bf16 v136, s90, v132
v_dot2c_f32_bf16 v137, s91, v132
v_dot2c_f32_bf16 v138, s90, v133
v_dot2c_f32_bf16 v139, s91, v133
v_dot2c_f32_bf16 v140, s90, v134
v_dot2c_f32_bf16 v141, s91, v134
v_dot2c_f32_bf16 v142, s90, v135
v_dot2c_f32_bf16 v143, s91, v135
s_waitcnt vmcnt(0)
v_cmp_gt_u32 vcc, 2, v230
s_nop 0
s_and_b32 s29, vcc_lo, s50
s_cbranch_scc0 SP_P2B_RET
SP_P2B:
s_sleep 0
s_add_u32 s100, s100, 1
s_bitcmp1_b32 s100, 19
s_cbranch_scc1 K_END
buffer_load_dword v230, v229, s[20:23], s95 offen sc0 sc1
s_waitcnt vmcnt(0)
v_cmp_gt_u32 vcc, 2, v230
s_nop 0
s_and_b32 s29, vcc_lo, s50
s_cbranch_scc1 SP_P2B
SP_P2B_RET:
buffer_load_dwordx4 v[168:171], v244, s[20:23], s65 offen sc0 sc1
buffer_load_dwordx4 v[172:175], v244, s[20:23], s66 offen sc0 sc1
buffer_load_dwordx4 v[176:179], v244, s[20:23], s67 offen sc0 sc1
buffer_load_dwordx4 v[180:183], v243, s[20:23], s65 offen sc0 sc1
buffer_load_dwordx4 v[184:187], v243, s[20:23], s66 offen sc0 sc1
buffer_load_dwordx4 v[188:191], v243, s[20:23], s67 offen sc0 sc1
s_waitcnt vmcnt(21)
v_dot2c_f32_bf16 v66, s90, v200
v_dot2c_f32_bf16 v67, s91, v200
v_dot2c_f32_bf16 v68, s90, v201
v_dot2c_f32_bf16 v69, s91, v201
s_waitcnt vmcnt(19)
v_dot2c_f32_bf16 v66, s90, v202
v_dot2c_f32_bf16 v67, s91, v202
v_dot2c_f32_bf16 v68, s90, v203
v_dot2c_f32_bf16 v69, s91, v203
s_waitcnt vmcnt(18)
v_dot2c_f32_bf16 v66, s90, v204
v_dot2c_f32_bf16 v67, s91, v204
v_dot2c_f32_bf16 v68, s90, v205
v_dot2c_f32_bf16 v69, s91, v205
s_waitcnt vmcnt(17)
v_dot2c_f32_bf16 v66, s90, v206
v_dot2c_f32_bf16 v67, s91, v206
v_dot2c_f32_bf16 v68, s90, v207
v_dot2c_f32_bf16 v69, s91, v207
s_waitcnt vmcnt(16)
v_dot2c_f32_bf16 v66, s90, v208
v_dot2c_f32_bf16 v67, s91, v208
v_dot2c_f32_bf16 v68, s90, v209
v_dot2c_f32_bf16 v69, s91, v209
s_waitcnt vmcnt(15)
v_dot2c_f32_bf16 v66, s90, v210
v_dot2c_f32_bf16 v67, s91, v210
v_dot2c_f32_bf16 v68, s90, v211
v_dot2c_f32_bf16 v69, s91, v211
s_waitcnt vmcnt(13)
v_dot2c_f32_bf16 v66, s90, v212
v_dot2c_f32_bf16 v67, s91, v212
v_dot2c_f32_bf16 v68, s90, v213
v_dot2c_f32_bf16 v69, s91, v213
s_waitcnt vmcnt(12)
v_dot2c_f32_bf16 v66, s90, v214
v_dot2c_f32_bf16 v67, s91, v214
v_dot2c_f32_bf16 v68, s90, v215
v_dot2c_f32_bf16 v69, s91, v215
s_cmp_eq_u32 s34, 0
s_cselect_b32 s29, 0, 0x7fbffff0
s_nop 2
v_cvt_pk_bf16_f32 v58, v66, v67
v_cvt_pk_bf16_f32 v59, v68, v69
v_lshlrev_b32 v66, 16, v58
v_and_b32 v67, 0xffff0000, v58
v_lshlrev_b32 v68, 16, v59
v_and_b32 v69, 0xffff0000, v59
v_pk_mul_f32 v[66:67], v[66:67], v[54:55]
v_pk_mul_f32 v[68:69], v[68:69], v[56:57]
v_cvt_pk_bf16_f32 v58, v66, v67
v_cvt_pk_bf16_f32 v59, v68, v69
v_lshlrev_b32 v66, 16, v58
v_and_b32 v67, 0xffff0000, v58
v_lshlrev_b32 v68, 16, v59
v_and_b32 v69, 0xffff0000, v59
v_pk_add_f32 v[66:67], v[66:67], v[34:35]
v_pk_add_f32 v[68:69], v[68:69], v[36:37]
v_cvt_pk_bf16_f32 v66, v66, v67
v_cvt_pk_bf16_f32 v67, v68, v69
buffer_store_dwordx2 v[66:67], v249, s[60:63], s29 offen
s_waitcnt vmcnt(6)
v_dot2c_f32_bf16 v72, s90, v168
v_dot2c_f32_bf16 v73, s91, v168
v_dot2c_f32_bf16 v74, s90, v169
v_dot2c_f32_bf16 v75, s91, v169
v_dot2c_f32_bf16 v76, s90, v170
v_dot2c_f32_bf16 v77, s91, v170
v_dot2c_f32_bf16 v78, s90, v171
v_dot2c_f32_bf16 v79, s91, v171
s_waitcnt vmcnt(5)
v_dot2c_f32_bf16 v72, s90, v172
v_dot2c_f32_bf16 v73, s91, v172
v_dot2c_f32_bf16 v74, s90, v173
v_dot2c_f32_bf16 v75, s91, v173
v_dot2c_f32_bf16 v76, s90, v174
v_dot2c_f32_bf16 v77, s91, v174
v_dot2c_f32_bf16 v78, s90, v175
v_dot2c_f32_bf16 v79, s91, v175
s_waitcnt vmcnt(4)
v_dot2c_f32_bf16 v72, s90, v176
v_dot2c_f32_bf16 v73, s91, v176
v_dot2c_f32_bf16 v74, s90, v177
v_dot2c_f32_bf16 v75, s91, v177
v_dot2c_f32_bf16 v76, s90, v178
v_dot2c_f32_bf16 v77, s91, v178
v_dot2c_f32_bf16 v78, s90, v179
v_dot2c_f32_bf16 v79, s91, v179
s_nop 2
v_cvt_pk_bf16_f32 v58, v72, v73
v_cvt_pk_bf16_f32 v59, v74, v75
v_cvt_pk_bf16_f32 v60, v76, v77
v_cvt_pk_bf16_f32 v61, v78, v79
v_lshlrev_b32 v72, 16, v58
v_and_b32 v73, 0xffff0000, v58
v_lshlrev_b32 v74, 16, v59
v_and_b32 v75, 0xffff0000, v59
v_lshlrev_b32 v76, 16, v60
v_and_b32 v77, 0xffff0000, v60
v_lshlrev_b32 v78, 16, v61
v_and_b32 v79, 0xffff0000, v61
v_pk_mul_f32 v[72:73], v[72:73], v[38:39]
v_pk_mul_f32 v[74:75], v[74:75], v[40:41]
v_pk_mul_f32 v[76:77], v[76:77], v[42:43]
v_pk_mul_f32 v[78:79], v[78:79], v[44:45]
v_cvt_pk_bf16_f32 v58, v72, v73
v_cvt_pk_bf16_f32 v59, v74, v75
v_cvt_pk_bf16_f32 v60, v76, v77
v_cvt_pk_bf16_f32 v61, v78, v79
v_lshlrev_b32 v72, 16, v58
v_and_b32 v73, 0xffff0000, v58
v_lshlrev_b32 v74, 16, v59
v_and_b32 v75, 0xffff0000, v59
v_lshlrev_b32 v76, 16, v60
v_and_b32 v77, 0xffff0000, v60
v_lshlrev_b32 v78, 16, v61
v_and_b32 v79, 0xffff0000, v61
v_pk_add_f32 v[72:73], v[72:73], v[18:19]
v_pk_add_f32 v[74:75], v[74:75], v[20:21]
v_pk_add_f32 v[76:77], v[76:77], v[22:23]
v_pk_add_f32 v[78:79], v[78:79], v[24:25]
v_cvt_pk_bf16_f32 v72, v72, v73
v_cvt_pk_bf16_f32 v73, v74, v75
v_cvt_pk_bf16_f32 v74, v76, v77
v_cvt_pk_bf16_f32 v75, v78, v79
buffer_store_dwordx4 v[72:75], v248, s[60:63], 0 offen
s_waitcnt vmcnt(4)
v_dot2c_f32_bf16 v136, s90, v180
v_dot2c_f32_bf16 v137, s91, v180
v_dot2c_f32_bf16 v138, s90, v181
v_dot2c_f32_bf16 v139, s91, v181
v_dot2c_f32_bf16 v140, s90, v182
v_dot2c_f32_bf16 v141, s91, v182
v_dot2c_f32_bf16 v142, s90, v183
v_dot2c_f32_bf16 v143, s91, v183
s_waitcnt vmcnt(3)
v_dot2c_f32_bf16 v136, s90, v184
v_dot2c_f32_bf16 v137, s91, v184
v_dot2c_f32_bf16 v138, s90, v185
v_dot2c_f32_bf16 v139, s91, v185
v_dot2c_f32_bf16 v140, s90, v186
v_dot2c_f32_bf16 v141, s91, v186
v_dot2c_f32_bf16 v142, s90, v187
v_dot2c_f32_bf16 v143, s91, v187
s_waitcnt vmcnt(2)
v_dot2c_f32_bf16 v136, s90, v188
v_dot2c_f32_bf16 v137, s91, v188
v_dot2c_f32_bf16 v138, s90, v189
v_dot2c_f32_bf16 v139, s91, v189
v_dot2c_f32_bf16 v140, s90, v190
v_dot2c_f32_bf16 v141, s91, v190
v_dot2c_f32_bf16 v142, s90, v191
v_dot2c_f32_bf16 v143, s91, v191
s_nop 2
v_cvt_pk_bf16_f32 v58, v136, v137
v_cvt_pk_bf16_f32 v59, v138, v139
v_cvt_pk_bf16_f32 v60, v140, v141
v_cvt_pk_bf16_f32 v61, v142, v143
v_lshlrev_b32 v136, 16, v58
v_and_b32 v137, 0xffff0000, v58
v_lshlrev_b32 v138, 16, v59
v_and_b32 v139, 0xffff0000, v59
v_lshlrev_b32 v140, 16, v60
v_and_b32 v141, 0xffff0000, v60
v_lshlrev_b32 v142, 16, v61
v_and_b32 v143, 0xffff0000, v61
v_pk_mul_f32 v[136:137], v[136:137], v[46:47]
v_pk_mul_f32 v[138:139], v[138:139], v[48:49]
v_pk_mul_f32 v[140:141], v[140:141], v[50:51]
v_pk_mul_f32 v[142:143], v[142:143], v[52:53]
v_cvt_pk_bf16_f32 v58, v136, v137
v_cvt_pk_bf16_f32 v59, v138, v139
v_cvt_pk_bf16_f32 v60, v140, v141
v_cvt_pk_bf16_f32 v61, v142, v143
v_lshlrev_b32 v136, 16, v58
v_and_b32 v137, 0xffff0000, v58
v_lshlrev_b32 v138, 16, v59
v_and_b32 v139, 0xffff0000, v59
v_lshlrev_b32 v140, 16, v60
v_and_b32 v141, 0xffff0000, v60
v_lshlrev_b32 v142, 16, v61
v_and_b32 v143, 0xffff0000, v61
v_pk_add_f32 v[136:137], v[136:137], v[26:27]
v_pk_add_f32 v[138:139], v[138:139], v[28:29]
v_pk_add_f32 v[140:141], v[140:141], v[30:31]
v_pk_add_f32 v[142:143], v[142:143], v[32:33]
v_cvt_pk_bf16_f32 v136, v136, v137
v_cvt_pk_bf16_f32 v137, v138, v139
v_cvt_pk_bf16_f32 v138, v140, v141
v_cvt_pk_bf16_f32 v139, v142, v143
buffer_store_dwordx4 v[136:139], v248, s[60:63], 0 offen offset:128
s_endpgm
SP_O1B:
s_sleep 1
s_add_u32 s100, s100, 1
s_bitcmp1_b32 s100, 19
s_cbranch_scc1 K_END
buffer_load_dword v230, v229, s[20:23], s94 offen sc0 sc1
s_waitcnt vmcnt(0)
v_cmp_gt_u32 vcc, 1, v230
s_bitcmp1_b32 vcc_lo, s39
s_cbranch_scc1 SP_O1B
s_branch SP_O1B_RET
SP_O2B:
s_sleep 1
s_add_u32 s100, s100, 1
s_bitcmp1_b32 s100, 19
s_cbranch_scc1 K_END
buffer_load_dword v230, v229, s[20:23], s94 offen sc0 sc1
s_waitcnt vmcnt(0)
v_cmp_gt_u32 vcc, 1, v230
s_and_b32 s29, vcc_lo, 15
s_cbranch_scc1 SP_O2B
s_branch SP_O2B_RET
SP_O3B:
s_sleep 1
s_add_u32 s100, s100, 1
s_bitcmp1_b32 s100, 19
s_cbranch_scc1 K_END
buffer_load_dword v230, v229, s[20:23], s94 offen sc0 sc1
s_waitcnt vmcnt(0)
v_cmp_gt_u32 vcc, 2, v230
s_and_b32 s29, vcc_lo, 15
s_cbranch_scc1 SP_O3B
s_branch SP_O3B_RET
SP_P1B:
s_sleep 1
s_add_u32 s100, s100, 1
s_bitcmp1_b32 s100, 19
s_cbranch_scc1 K_END
buffer_load_dword v230, v229, s[20:23], s95 offen sc0 sc1
s_waitcnt vmcnt(0)
v_cmp_gt_u32 vcc, 1, v230
s_and_b32 s29, vcc_lo, 0xff
s_cbranch_scc1 SP_P1B
s_branch SP_P1B_RET
F_NOTYET:
s_bitcmp1_b32 s51, 30
s_cbranch_scc1 F_BSENT
s_bitset1_b32 s51, 30
s_mov_b32 s46, 0x60
s_mov_b32 s50, s28
s_add_u32 s28, s45, 0x0
buffer_store_dwordx4 v[72:75], v169, s[20:23], s28 offen offset:0 sc0 sc1
buffer_store_dwordx4 v[76:79], v169, s[20:23], s28 offen offset:2048 sc0 sc1
s_add_u32 s28, s28, 4096
buffer_store_dwordx4 v[80:83], v169, s[20:23], s28 offen offset:0 sc0 sc1
buffer_store_dwordx4 v[84:87], v169, s[20:23], s28 offen offset:2048 sc0 sc1
s_add_u32 s28, s28, 4096
buffer_store_dwordx4 v[88:91], v169, s[20:23], s28 offen offset:0 sc0 sc1
buffer_store_dwordx4 v[92:95], v169, s[20:23], s28 offen offset:2048 sc0 sc1
s_add_u32 s28, s28, 4096
buffer_store_dwordx4 v[96:99], v169, s[20:23], s28 offen offset:0 sc0 sc1
buffer_store_dwordx4 v[100:103], v169, s[20:23], s28 offen offset:2048 sc0 sc1
s_add_u32 s28, s28, 4096
buffer_store_dwordx4 v[104:107], v169, s[20:23], s28 offen offset:0 sc0 sc1
s_lshl_b32 s28, s3, 2
s_add_u32 s28, s28, 0x240000
buffer_store_dword v65, v64, s[20:23], s28 offen sc0 sc1
s_mov_b32 s28, s50
s_or_b32 s29, s38, 0x40
v_mov_b32 v62, s29
v_mov_b32 v63, s35
s_lshl_b32 s29, s36, 5
s_waitcnt vmcnt(0)
s_mov_b64 exec, 1
buffer_store_byte v62, v63, s[24:27], s29 offen sc0 sc1
s_mov_b64 exec, -1
F_BSENT:
s_lshl_b32 s29, s36, 5
buffer_load_dword v62, v64, s[24:27], s29 offen sc0 sc1
s_waitcnt vmcnt(0)
v_and_b32 v63, 0x40404040, v62
v_cmp_ne_u32 vcc, 0x40404040, v63
s_cbranch_vccnz F_NOB
s_mul_i32 s29, s38, 0x01010101
v_and_b32 v62, 0x0f0f0f0f, v62
v_cmp_ne_u32 vcc, s29, v62
v_mov_b32 v60, 0
s_cbranch_vccnz F_GO
v_mov_b32 v60, 1
s_branch F_GO
F_NOB:
s_sleep 1
s_add_u32 s100, s100, 1
s_bitcmp1_b32 s100, 19
s_cbranch_scc1 K_END
s_branch F_POLL
Q_REDO:
s_mov_b32 s4, 0
s_mov_b32 s51, 0
s_waitcnt vmcnt(0) lgkmcnt(0)
s_branch Q_START
K_FALLBACK:
s_mov_b32 s43, 1
s_mov_b32 s3, 0
s_mov_b32 s86, 0x30000
s_mov_b32 s66, 0
s_mov_b32 s70, 0
s_mov_b32 s74, 0
s_waitcnt vmcnt(0) lgkmcnt(0)
s_barrier
v_mov_b32 v254, 0x7ffffff0
v_mov_b32 v136, 0xff800000
v_mov_b32 v140, 0xff800000
v_mov_b32 v144, 0xff800000
v_mov_b32 v148, 0xff800000
s_mov_b32 s32, 0
s_mov_b32 s33, 32
K_FBLOOP:
s_add_u32 m0, s30, 81920
s_nop 0
buffer_load_dwordx4 v228, s[8:11], s32 offen offset:0  lds
buffer_load_dwordx4 v229, s[8:11], s32 offen offset:1024  lds
buffer_load_dwordx4 v230, s[8:11], s32 offen offset:2048  lds
buffer_load_dwordx4 v231, s[8:11], s32 offen offset:3072  lds
s_waitcnt vmcnt(0)
s_barrier
ds_read_b128 a[144:147], v216 offset:16384
ds_read_b128 a[148:151], v217 offset:16384
ds_read_b128 a[152:155], v218 offset:16384
ds_read_b128 a[156:159], v219 offset:16384
ds_read_b128 a[160:163], v216 offset:20480
ds_read_b128 a[164:167], v217 offset:20480
ds_read_b128 a[168:171], v218 offset:20480
ds_read_b128 a[172:175], v219 offset:20480
s_waitcnt lgkmcnt(0)
v_mfma_f32_16x16x32_bf16 v[8:11], a[144:147], v[152:155], 0
v_mfma_f32_16x16x32_bf16 v[16:19], a[144:147], v[168:171], 0
v_mfma_f32_16x16x32_bf16 v[24:27], a[144:147], v[184:187], 0
v_mfma_f32_16x16x32_bf16 v[32:35], a[144:147], v[200:203], 0
v_mfma_f32_16x16x32_bf16 v[8:11], a[148:151], v[156:159], v[8:11]
v_mfma_f32_16x16x32_bf16 v[16:19], a[148:151], v[172:175], v[16:19]
v_mfma_f32_16x16x32_bf16 v[24:27], a[148:151], v[188:191], v[24:27]
v_mfma_f32_16x16x32_bf16 v[32:35], a[148:151], v[204:207], v[32:35]
v_mfma_f32_16x16x32_bf16 v[8:11], a[152:155], v[160:163], v[8:11]
v_mfma_f32_16x16x32_bf16 v[16:19], a[152:155], v[176:179], v[16:19]
v_mfma_f32_16x16x32_bf16 v[24:27], a[152:155], v[192:195], v[24:27]
v_mfma_f32_16x16x32_bf16 v[32:35], a[152:155], v[208:211], v[32:35]
v_mfma_f32_16x16x32_bf16 v[8:11], a[156:159], v[164:167], v[8:11]
v_mfma_f32_16x16x32_bf16 v[16:19], a[156:159], v[180:183], v[16:19]
v_mfma_f32_16x16x32_bf16 v[24:27], a[156:159], v[196:199], v[24:27]
v_mfma_f32_16x16x32_bf16 v[32:35], a[156:159], v[212:215], v[32:35]
v_mfma_f32_16x16x32_bf16 v[12:15], a[160:163], v[152:155], 0
v_mfma_f32_16x16x32_bf16 v[20:23], a[160:163], v[168:171], 0
v_mfma_f32_16x16x32_bf16 v[28:31], a[160:163], v[184:187], 0
v_mfma_f32_16x16x32_bf16 v[36:39], a[160:163], v[200:203], 0
v_mfma_f32_16x16x32_bf16 v[12:15], a[164:167], v[156:159], v[12:15]
v_mfma_f32_16x16x32_bf16 v[20:23], a[164:167], v[172:175], v[20:23]
v_mfma_f32_16x16x32_bf16 v[28:31], a[164:167], v[188:191], v[28:31]
v_mfma_f32_16x16x32_bf16 v[36:39], a[164:167], v[204:207], v[36:39]
v_mfma_f32_16x16x32_bf16 v[12:15], a[168:171], v[160:163], v[12:15]
v_mfma_f32_16x16x32_bf16 v[20:23], a[168:171], v[176:179], v[20:23]
v_mfma_f32_16x16x32_bf16 v[28:31], a[168:171], v[192:195], v[28:31]
v_mfma_f32_16x16x32_bf16 v[36:39], a[168:171], v[208:211], v[36:39]
v_mfma_f32_16x16x32_bf16 v[12:15], a[172:175], v[164:167], v[12:15]
v_mfma_f32_16x16x32_bf16 v[20:23], a[172:175], v[180:183], v[20:23]
v_mfma_f32_16x16x32_bf16 v[28:31], a[172:175], v[196:199], v[28:31]
v_mfma_f32_16x16x32_bf16 v[36:39], a[172:175], v[212:215], v[36:39]
s_nop 7
s_nop 3
v_max3_f32 v136, v136, v8, v9
v_max3_f32 v136, v136, v10, v11
v_max3_f32 v136, v136, v12, v13
v_max3_f32 v136, v136, v14, v15
v_max3_f32 v140, v140, v16, v17
v_max3_f32 v140, v140, v18, v19
v_max3_f32 v140, v140, v20, v21
v_max3_f32 v140, v140, v22, v23
v_max3_f32 v144, v144, v24, v25
v_max3_f32 v144, v144, v26, v27
v_max3_f32 v144, v144, v28, v29
v_max3_f32 v144, v144, v30, v31
v_max3_f32 v148, v148, v32, v33
v_max3_f32 v148, v148, v34, v35
v_max3_f32 v148, v148, v36, v37
v_max3_f32 v148, v148, v38, v39
ds_read_b128 a[144:147], v216 offset:24576
ds_read_b128 a[148:151], v217 offset:24576
ds_read_b128 a[152:155], v218 offset:24576
ds_read_b128 a[156:159], v219 offset:24576
ds_read_b128 a[160:163], v216 offset:28672
ds_read_b128 a[164:167], v217 offset:28672
ds_read_b128 a[168:171], v218 offset:28672
ds_read_b128 a[172:175], v219 offset:28672
s_waitcnt lgkmcnt(0)
v_mfma_f32_16x16x32_bf16 v[8:11], a[144:147], v[152:155], 0
v_mfma_f32_16x16x32_bf16 v[16:19], a[144:147], v[168:171], 0
v_mfma_f32_16x16x32_bf16 v[24:27], a[144:147], v[184:187], 0
v_mfma_f32_16x16x32_bf16 v[32:35], a[144:147], v[200:203], 0
v_mfma_f32_16x16x32_bf16 v[8:11], a[148:151], v[156:159], v[8:11]
v_mfma_f32_16x16x32_bf16 v[16:19], a[148:151], v[172:175], v[16:19]
v_mfma_f32_16x16x32_bf16 v[24:27], a[148:151], v[188:191], v[24:27]
v_mfma_f32_16x16x32_bf16 v[32:35], a[148:151], v[204:207], v[32:35]
v_mfma_f32_16x16x32_bf16 v[8:11], a[152:155], v[160:163], v[8:11]
v_mfma_f32_16x16x32_bf16 v[16:19], a[152:155], v[176:179], v[16:19]
v_mfma_f32_16x16x32_bf16 v[24:27], a[152:155], v[192:195], v[24:27]
v_mfma_f32_16x16x32_bf16 v[32:35], a[152:155], v[208:211], v[32:35]
v_mfma_f32_16x16x32_bf16 v[8:11], a[156:159], v[164:167], v[8:11]
v_mfma_f32_16x16x32_bf16 v[16:19], a[156:159], v[180:183], v[16:19]
v_mfma_f32_16x16x32_bf16 v[24:27], a[156:159], v[196:199], v[24:27]
v_mfma_f32_16x16x32_bf16 v[32:35], a[156:159], v[212:215], v[32:35]
v_mfma_f32_16x16x32_bf16 v[12:15], a[160:163], v[152:155], 0
v_mfma_f32_16x16x32_bf16 v[20:23], a[160:163], v[168:171], 0
v_mfma_f32_16x16x32_bf16 v[28:31], a[160:163], v[184:187], 0
v_mfma_f32_16x16x32_bf16 v[36:39], a[160:163], v[200:203], 0
v_mfma_f32_16x16x32_bf16 v[12:15], a[164:167], v[156:159], v[12:15]
v_mfma_f32_16x16x32_bf16 v[20:23], a[164:167], v[172:175], v[20:23]
v_mfma_f32_16x16x32_bf16 v[28:31], a[164:167], v[188:191], v[28:31]
v_mfma_f32_16x16x32_bf16 v[36:39], a[164:167], v[204:207], v[36:39]
v_mfma_f32_16x16x32_bf16 v[12:15], a[168:171], v[160:163], v[12:15]
v_mfma_f32_16x16x32_bf16 v[20:23], a[168:171], v[176:179], v[20:23]
v_mfma_f32_16x16x32_bf16 v[28:31], a[168:171], v[192:195], v[28:31]
v_mfma_f32_16x16x32_bf16 v[36:39], a[168:171], v[208:211], v[36:39]
v_mfma_f32_16x16x32_bf16 v[12:15], a[172:175], v[164:167], v[12:15]
v_mfma_f32_16x16x32_bf16 v[20:23], a[172:175], v[180:183], v[20:23]
v_mfma_f32_16x16x32_bf16 v[28:31], a[172:175], v[196:199], v[28:31]
v_mfma_f32_16x16x32_bf16 v[36:39], a[172:175], v[212:215], v[36:39]
s_nop 7
s_nop 3
v_max3_f32 v136, v136, v8, v9
v_max3_f32 v136, v136, v10, v11
v_max3_f32 v136, v136, v12, v13
v_max3_f32 v136, v136, v14, v15
v_max3_f32 v140, v140, v16, v17
v_max3_f32 v140, v140, v18, v19
v_max3_f32 v140, v140, v20, v21
v_max3_f32 v140, v140, v22, v23
v_max3_f32 v144, v144, v24, v25
v_max3_f32 v144, v144, v26, v27
v_max3_f32 v144, v144, v28, v29
v_max3_f32 v144, v144, v30, v31
v_max3_f32 v148, v148, v32, v33
v_max3_f32 v148, v148, v34, v35
v_max3_f32 v148, v148, v36, v37
v_max3_f32 v148, v148, v38, v39
s_barrier
s_add_u32 s32, s32, 16384
s_sub_u32 s33, s33, 1
s_cmp_lg_u32 s33, 0
s_cbranch_scc1 K_FBLOOP
v_mov_b32 v246, v136
s_nop 1
v_permlane16_swap_b32 v136, v246
v_max_f32 v136, v136, v246
v_mov_b32 v246, v136
s_nop 1
v_permlane32_swap_b32 v136, v246
v_max_f32 v136, v136, v246
v_sub_f32 v136, 0, v136
v_mov_b32 v137, v136
v_mov_b32 v138, v136
v_mov_b32 v139, v136
v_mov_b32 v246, v140
s_nop 1
v_permlane16_swap_b32 v140, v246
v_max_f32 v140, v140, v246
v_mov_b32 v246, v140
s_nop 1
v_permlane32_swap_b32 v140, v246
v_max_f32 v140, v140, v246
v_sub_f32 v140, 0, v140
v_mov_b32 v141, v140
v_mov_b32 v142, v140
v_mov_b32 v143, v140
v_mov_b32 v246, v144
s_nop 1
v_permlane16_swap_b32 v144, v246
v_max_f32 v144, v144, v246
v_mov_b32 v246, v144
s_nop 1
v_permlane32_swap_b32 v144, v246
v_max_f32 v144, v144, v246
v_sub_f32 v144, 0, v144
v_mov_b32 v145, v144
v_mov_b32 v146, v144
v_mov_b32 v147, v144
v_mov_b32 v246, v148
s_nop 1
v_permlane16_swap_b32 v148, v246
v_max_f32 v148, v148, v246
v_mov_b32 v246, v148
s_nop 1
v_permlane32_swap_b32 v148, v246
v_max_f32 v148, v148, v246
v_sub_f32 v148, 0, v148
v_mov_b32 v149, v148
v_mov_b32 v150, v148
v_mov_b32 v151, v148
s_add_u32 s32, s7, 0
s_add_u32 m0, s30, 81920
s_nop 0
buffer_load_dwordx4 v228, s[8:11], s32 offen offset:0  lds
buffer_load_dwordx4 v229, s[8:11], s32 offen offset:1024  lds
buffer_load_dwordx4 v230, s[8:11], s32 offen offset:2048  lds
buffer_load_dwordx4 v231, s[8:11], s32 offen offset:3072  lds
s_add_u32 s32, s7, 16384
s_add_u32 m0, s30, 114688
s_nop 0
buffer_load_dwordx4 v228, s[8:11], s32 offen offset:0  lds
buffer_load_dwordx4 v229, s[8:11], s32 offen offset:1024  lds
buffer_load_dwordx4 v230, s[8:11], s32 offen offset:2048  lds
buffer_load_dwordx4 v231, s[8:11], s32 offen offset:3072  lds
s_add_u32 s39, s7, 0
s_add_u32 m0, s30, 131072
s_nop 0
buffer_load_dwordx4 v232, s[12:15], s39 offen offset:0  lds
buffer_load_dwordx4 v233, s[12:15], s39 offen offset:1024  lds
buffer_load_dwordx4 v232, s[12:15], s39 offen offset:2048  lds
buffer_load_dwordx4 v233, s[12:15], s39 offen offset:3072  lds
s_add_u32 s32, s7, 32768
s_add_u32 m0, s30, 65536
s_nop 0
buffer_load_dwordx4 v228, s[8:11], s32 offen offset:0  lds
buffer_load_dwordx4 v229, s[8:11], s32 offen offset:1024  lds
buffer_load_dwordx4 v230, s[8:11], s32 offen offset:2048  lds
buffer_load_dwordx4 v231, s[8:11], s32 offen offset:3072  lds
s_add_u32 s39, s7, 16384
s_add_u32 m0, s30, 147456
s_nop 0
buffer_load_dwordx4 v232, s[12:15], s39 offen offset:0  lds
buffer_load_dwordx4 v233, s[12:15], s39 offen offset:1024  lds
buffer_load_dwordx4 v232, s[12:15], s39 offen offset:2048  lds
buffer_load_dwordx4 v233, s[12:15], s39 offen offset:3072  lds
s_waitcnt vmcnt(0)
s_barrier
ds_read_b128 a[144:147], v216 offset:16384
ds_read_b128 a[148:151], v217 offset:16384
ds_read_b128 a[152:155], v218 offset:16384
ds_read_b128 a[156:159], v219 offset:16384
ds_read_b128 a[160:163], v216 offset:20480
ds_read_b128 a[164:167], v217 offset:20480
ds_read_b128 a[168:171], v218 offset:20480
ds_read_b128 a[172:175], v219 offset:20480
s_add_u32 s32, s7, 32768
s_add_u32 s39, s7, 16384
s_mul_i32 s88, s37, 864
s_mov_b32 s87, s88
v_accvgpr_write_b32 a128, 0
v_accvgpr_write_b32 a129, 0
v_accvgpr_write_b32 a130, 0
v_accvgpr_write_b32 a131, 0
v_accvgpr_write_b32 a132, 0
v_accvgpr_write_b32 a133, 0
v_accvgpr_write_b32 a134, 0
v_accvgpr_write_b32 a135, 0
v_lshrrev_b32 v240, 2, v1
v_mul_u32_u24 v240, 0x2400, v240
v_and_b32 v246, 3, v1
v_lshl_add_u32 v240, v246, 4, v240
v_mul_u32_u24 v243, 3641, v1
v_lshrrev_b32 v243, 16, v243
v_mul_u32_u24 v243, 864, v243
v_add_u32 v243, v243, v244
s_waitcnt lgkmcnt(0)
v_mfma_f32_16x16x32_bf16 v[8:11], a[144:147], v[152:155], v[136:139]
v_mfma_f32_16x16x32_bf16 v[16:19], a[144:147], v[168:171], v[140:143]
v_mfma_f32_16x16x32_bf16 v[24:27], a[144:147], v[184:187], v[144:147]
v_mfma_f32_16x16x32_bf16 v[32:35], a[144:147], v[200:203], v[148:151]
ds_read_b128 a[144:147], v216 offset:24576
v_mfma_f32_16x16x32_bf16 v[8:11], a[148:151], v[156:159], v[8:11]
v_mfma_f32_16x16x32_bf16 v[16:19], a[148:151], v[172:175], v[16:19]
v_mfma_f32_16x16x32_bf16 v[24:27], a[148:151], v[188:191], v[24:27]
v_mfma_f32_16x16x32_bf16 v[32:35], a[148:151], v[204:207], v[32:35]
ds_read_b128 a[148:151], v217 offset:24576
v_mfma_f32_16x16x32_bf16 v[8:11], a[152:155], v[160:163], v[8:11]
v_mfma_f32_16x16x32_bf16 v[16:19], a[152:155], v[176:179], v[16:19]
v_mfma_f32_16x16x32_bf16 v[24:27], a[152:155], v[192:195], v[24:27]
v_mfma_f32_16x16x32_bf16 v[32:35], a[152:155], v[208:211], v[32:35]
ds_read_b128 a[152:155], v218 offset:24576
v_mfma_f32_16x16x32_bf16 v[8:11], a[156:159], v[164:167], v[8:11]
v_mfma_f32_16x16x32_bf16 v[16:19], a[156:159], v[180:183], v[16:19]
v_mfma_f32_16x16x32_bf16 v[24:27], a[156:159], v[196:199], v[24:27]
v_mfma_f32_16x16x32_bf16 v[32:35], a[156:159], v[212:215], v[32:35]
ds_read_b128 a[156:159], v219 offset:24576
v_mfma_f32_16x16x32_bf16 v[12:15], a[160:163], v[152:155], v[136:139]
v_mfma_f32_16x16x32_bf16 v[20:23], a[160:163], v[168:171], v[140:143]
v_mfma_f32_16x16x32_bf16 v[28:31], a[160:163], v[184:187], v[144:147]
v_mfma_f32_16x16x32_bf16 v[36:39], a[160:163], v[200:203], v[148:151]
ds_read_b128 a[160:163], v216 offset:28672
v_mfma_f32_16x16x32_bf16 v[12:15], a[164:167], v[156:159], v[12:15]
v_mfma_f32_16x16x32_bf16 v[20:23], a[164:167], v[172:175], v[20:23]
v_mfma_f32_16x16x32_bf16 v[28:31], a[164:167], v[188:191], v[28:31]
v_mfma_f32_16x16x32_bf16 v[36:39], a[164:167], v[204:207], v[36:39]
ds_read_b128 a[164:167], v217 offset:28672
v_mfma_f32_16x16x32_bf16 v[12:15], a[168:171], v[160:163], v[12:15]
v_mfma_f32_16x16x32_bf16 v[20:23], a[168:171], v[176:179], v[20:23]
v_mfma_f32_16x16x32_bf16 v[28:31], a[168:171], v[192:195], v[28:31]
v_mfma_f32_16x16x32_bf16 v[36:39], a[168:171], v[208:211], v[36:39]
ds_read_b128 a[168:171], v218 offset:28672
v_mfma_f32_16x16x32_bf16 v[12:15], a[172:175], v[164:167], v[12:15]
v_mfma_f32_16x16x32_bf16 v[20:23], a[172:175], v[180:183], v[20:23]
v_mfma_f32_16x16x32_bf16 v[28:31], a[172:175], v[196:199], v[28:31]
v_mfma_f32_16x16x32_bf16 v[36:39], a[172:175], v[212:215], v[36:39]
ds_read_b128 a[172:175], v219 offset:28672
s_waitcnt lgkmcnt(0)
s_nop 7
s_branch K_BODY0
K_CODE_END:
.section .rodata,"a"
.p2align 6
.amdhsa_kernel recurrent_scan__gqa_block_cached__moe_arch_mod__prompt_kernel
  .amdhsa_next_free_vgpr 512
  .amdhsa_next_free_sgpr 102
  .amdhsa_accum_offset 256
  .amdhsa_group_segment_fixed_size 0
  .amdhsa_kernarg_size 104
  .amdhsa_user_sgpr_count 2
  .amdhsa_user_sgpr_kernarg_segment_ptr 1
  .amdhsa_system_sgpr_workgroup_id_x 1
  .amdhsa_float_denorm_mode_32 3
.end_amdhsa_kernel
```

```asm
; @launch grid=(256,1,1) block=(256,1,1) lds=163840
.amdgcn_target "amdgcn-amd-amdhsa--gfx950"
.text
.globl recurrent_scan__gqa_block_cached__moe_arch_mod__prompt_kernel
.p2align 8
.type recurrent_scan__gqa_block_cached__moe_arch_mod__prompt_kernel,@function
recurrent_scan__gqa_block_cached__moe_arch_mod__prompt_kernel:
s_cmp_ge_u32 s2, 256
s_cbranch_scc1 K_END
s_mov_b32 s100, 0
s_load_dwordx16 s[64:79], s[0:1], 0
s_load_dwordx8 s[80:87], s[0:1], 64
s_load_dwordx2 s[88:89], s[0:1], 96
s_lshr_b32 s35, s2, 3
s_and_b32 s36, s2, 7
s_mul_i32 s5, s36, 9
s_lshr_b32 s5, s5, 2
s_lshl_b32 s3, s36, 8
s_lshl_b32 s28, s35, 3
s_add_u32 s3, s3, s28
v_lshrrev_b32 v5, 5, v0
v_add_u32 v5, s3, v5
v_and_b32 v6, 31, v0
v_mul_u32_u24 v7, 0x480, v5
v_lshl_add_u32 v7, v6, 2, v7
v_and_b32 v1, 63, v0
v_lshrrev_b32 v2, 6, v0
v_lshlrev_b32 v8, 2, v6
v_readfirstlane_b32 s37, v2
v_and_b32 v3, 15, v1
v_lshrrev_b32 v4, 4, v1
s_getpc_b64 s[96:97]
PC_a:
s_sub_u32 s96, s96, PC_a-recurrent_scan__gqa_block_cached__moe_arch_mod__prompt_kernel
s_subb_u32 s97, s97, 0
s_lshl_b32 s50, s35, 2
s_add_u32 s50, s50, s37
s_min_u32 s50, s50, ((K_HOT_END-recurrent_scan__gqa_block_cached__moe_arch_mod__prompt_kernel)>>10)-1
s_lshl_b32 s50, s50, 10
v_lshlrev_b32 v11, 4, v1
v_add_u32 v11, s50, v11
global_load_dwordx4 v[172:175], v11, s[96:97]
s_waitcnt lgkmcnt(0)
s_mov_b32 s52, s64
s_and_b32 s53, s65, 0xffff
s_mov_b32 s54, 0x240000
s_mov_b32 s55, 0x00020000
buffer_load_dword v18, v7, s[52:55], 0 offen offset:0
buffer_load_dword v19, v7, s[52:55], 0 offen offset:128
buffer_load_dword v20, v7, s[52:55], 0 offen offset:256
buffer_load_dword v21, v7, s[52:55], 0 offen offset:384
buffer_load_dword v22, v7, s[52:55], 0 offen offset:512
buffer_load_dword v23, v7, s[52:55], 0 offen offset:640
buffer_load_dword v24, v7, s[52:55], 0 offen offset:768
buffer_load_dword v25, v7, s[52:55], 0 offen offset:896
buffer_load_dword v26, v7, s[52:55], 0 offen offset:1024
s_mov_b32 s28, 0x24c000
s_load_dwordx2 s[6:7], s[88:89], s28
s_mov_b32 s92, s76
s_and_b32 s93, s77, 0xffff
s_mov_b32 s94, 0x480
s_mov_b32 s95, 0x00020000
buffer_load_dword v28, v8, s[92:95], 0 offen offset:0
buffer_load_dword v29, v8, s[92:95], 0 offen offset:128
buffer_load_dword v30, v8, s[92:95], 0 offen offset:256
buffer_load_dword v31, v8, s[92:95], 0 offen offset:384
buffer_load_dword v32, v8, s[92:95], 0 offen offset:512
buffer_load_dword v33, v8, s[92:95], 0 offen offset:640
buffer_load_dword v34, v8, s[92:95], 0 offen offset:768
buffer_load_dword v35, v8, s[92:95], 0 offen offset:896
buffer_load_dword v36, v8, s[92:95], 0 offen offset:1024
s_mov_b32 s20, s88
s_and_b32 s21, s89, 0xffff
s_mov_b32 s22, 0x8000000
s_mov_b32 s23, 0x00020000
s_lshr_b32 s45, s3, 4
s_mul_i32 s45, s45, 18432
s_and_b32 s29, s3, 15
s_lshl_b32 s29, s29, 4
s_add_u32 s45, s45, s29
v_lshrrev_b32 v9, 1, v0
v_lshlrev_b32 v9, 8, v9
v_and_b32 v10, 1, v0
v_lshl_add_u32 v9, v10, 6, v9
s_add_u32 s29, s45, 0x1800000
v_add_u32 v9, s29, v9
s_lshl_b32 s28, s36, 8
s_add_u32 s28, s28, 0x24ac00
v_lshlrev_b32 v10, 6, v0
v_add_u32 v10, s28, v10
v_cmp_lt_u32 vcc, 143, v0
s_lshl_b32 s29, s3, 2
s_add_u32 s29, s29, 0x1a40000
v_cndmask_b32 v9, v9, v10, vcc
v_mov_b32 v10, s29
v_cmp_lt_u32 vcc, 147, v0
s_nop 1
v_cndmask_b32 v9, v9, v10, vcc
buffer_load_dword v176, v9, s[20:23], 0 offen sc1
s_mov_b32 s16, s70
s_and_b32 s17, s71, 0xffff
s_mov_b32 s18, 0x480000
s_mov_b32 s19, 0x00020000
v_add_u32 v9, 0, v4
v_lshlrev_b32 v10, 1, v9
v_xor_b32 v10, v10, v3
v_lshlrev_b32 v10, 4, v10
v_lshl_add_u32 v238, v9, 13, v10
v_add_u32 v9, 4, v4
v_lshlrev_b32 v10, 1, v9
v_xor_b32 v10, v10, v3
v_lshlrev_b32 v10, 4, v10
v_lshl_add_u32 v239, v9, 13, v10
v_subrev_u32 v239, 1024, v239
s_cmp_eq_u32 s37, 0
s_cbranch_scc1 F_NOWQ
s_sub_u32 s28, s37, 1
s_lshl_b32 s49, s28, 11
s_lshl_b32 s28, s28, 16
s_lshl_b32 s34, s35, 8
s_add_u32 s34, s34, s28
s_lshl_b32 s28, s5, 18
s_add_u32 s34, s34, s28
s_add_u32 m0, s49, 65536
s_nop 0
buffer_load_dwordx4 v238, s[16:19], s34 offen offset:0 lds
buffer_load_dwordx4 v239, s[16:19], s34 offen offset:1024 lds
s_add_u32 s34, s34, 196608
s_sub_u32 s51, s34, 4718592
s_cselect_b32 s34, s34, s51
s_add_u32 m0, s49, 71680
s_nop 0
buffer_load_dwordx4 v238, s[16:19], s34 offen offset:0 lds
buffer_load_dwordx4 v239, s[16:19], s34 offen offset:1024 lds
s_add_u32 s34, s34, 196608
s_sub_u32 s51, s34, 4718592
s_cselect_b32 s34, s34, s51
s_add_u32 m0, s49, 77824
s_nop 0
buffer_load_dwordx4 v238, s[16:19], s34 offen offset:0 lds
buffer_load_dwordx4 v239, s[16:19], s34 offen offset:1024 lds
s_add_u32 s34, s34, 196608
s_sub_u32 s51, s34, 4718592
s_cselect_b32 s34, s34, s51
s_add_u32 m0, s49, 83968
s_nop 0
buffer_load_dwordx4 v238, s[16:19], s34 offen offset:0 lds
buffer_load_dwordx4 v239, s[16:19], s34 offen offset:1024 lds
s_add_u32 s34, s34, 196608
s_sub_u32 s51, s34, 4718592
s_cselect_b32 s34, s34, s51
s_add_u32 m0, s49, 90112
s_nop 0
buffer_load_dwordx4 v238, s[16:19], s34 offen offset:0 lds
buffer_load_dwordx4 v239, s[16:19], s34 offen offset:1024 lds
s_add_u32 s34, s34, 196608
s_sub_u32 s51, s34, 4718592
s_cselect_b32 s34, s34, s51
F_NOWQ:
s_getreg_b32 s38, hwreg(HW_REG_XCC_ID, 0, 4)
s_mov_b32 s24, s86
s_and_b32 s25, s87, 0xffff
s_mov_b32 s26, 0x100
s_mov_b32 s27, 0x00020000
s_add_u32 s28, s2, s37
s_cbranch_scc1 F_NOX
s_cmp_eq_u32 s28, 0
s_cbranch_scc0 F_NOX
s_or_b32 s28, s38, 0x80
v_mov_b32 v9, s28
v_mov_b32 v10, 0
s_mov_b64 exec, 1
buffer_store_byte v9, v10, s[24:27], 0 offen sc0 sc1
s_mov_b64 exec, -1
s_waitcnt vmcnt(2)
F_NOX:
v_and_b32 v66, 7, v1
v_mul_u32_u24 v67, 1168, v66
v_lshrrev_b32 v68, 5, v1
v_lshl_add_u32 v67, v68, 6, v67
v_bfe_u32 v69, v1, 3, 2
v_lshl_add_u32 v67, v69, 3, v67
v_add_u32 v168, 0x24000, v67
v_lshlrev_b32 v70, 10, v68
v_lshl_add_u32 v71, v69, 4, v66
v_lshl_add_u32 v169, v71, 4, v70
v_lshlrev_b32 v244, 4, v1
v_bfe_u32 v9, v1, 2, 2
v_and_b32 v10, 3, v1
v_lshl_add_u32 v11, v4, 2, v9
v_and_b32 v12, 7, v11
v_lshrrev_b32 v14, 1, v10
v_xor_b32 v14, v14, v12
v_and_b32 v15, 1, v10
v_lshlrev_b32 v15, 4, v15
v_lshl_add_u32 v15, v11, 8, v15
v_add_u32 v15, 0x10000, v15
v_xor_b32 v16, 0, v14
v_lshl_add_u32 v234, v16, 5, v15
v_xor_b32 v16, 2, v14
v_lshl_add_u32 v235, v16, 5, v15
v_xor_b32 v16, 4, v14
v_lshl_add_u32 v236, v16, 5, v15
v_xor_b32 v16, 6, v14
v_lshl_add_u32 v237, v16, 5, v15
s_lshl2_add_u32 s50, s36, s37
s_lshr_b32 s29, s35, 2
s_add_u32 s28, s29, 0
s_and_b32 s28, s28, 3
s_lshl2_add_u32 s28, s50, s28
s_mul_i32 s28, s28, 18432
v_add_u32 v240, s28, v244
s_add_u32 s28, s29, 1
s_and_b32 s28, s28, 3
s_lshl2_add_u32 s28, s50, s28
s_mul_i32 s28, s28, 18432
v_add_u32 v241, s28, v244
s_add_u32 s28, s29, 2
s_and_b32 s28, s28, 3
s_lshl2_add_u32 s28, s50, s28
s_mul_i32 s28, s28, 18432
v_add_u32 v242, s28, v244
s_add_u32 s28, s29, 3
s_and_b32 s28, s28, 3
s_lshl2_add_u32 s28, s50, s28
s_mul_i32 s28, s28, 18432
v_add_u32 v243, s28, v244
s_mov_b32 s40, 0x3e0293ee
s_mov_b32 s41, 0x3e0293ee
s_mov_b32 s76, 0x3ae38e39
s_mov_b32 s77, 0x3727c5ac
s_mov_b32 s75, 0xffff0000
s_cmp_eq_u32 s37, 0
s_cbranch_scc0 F_W1
s_waitcnt vmcnt(10)
s_branch F_W2
F_W1:
s_waitcnt vmcnt(20)
F_W2:
v_lshlrev_b32 v40, 16, v18
v_and_b32 v41, s75, v18
v_lshlrev_b32 v42, 16, v19
v_and_b32 v43, s75, v19
v_lshlrev_b32 v44, 16, v20
v_and_b32 v45, s75, v20
v_lshlrev_b32 v46, 16, v21
v_and_b32 v47, s75, v21
v_lshlrev_b32 v48, 16, v22
v_and_b32 v49, s75, v22
v_lshlrev_b32 v50, 16, v23
v_and_b32 v51, s75, v23
v_lshlrev_b32 v52, 16, v24
v_and_b32 v53, s75, v24
v_lshlrev_b32 v54, 16, v25
v_and_b32 v55, s75, v25
v_lshlrev_b32 v56, 16, v26
v_and_b32 v57, s75, v26
v_pk_add_f32 v[60:61], v[40:41], v[42:43]
v_pk_add_f32 v[62:63], v[44:45], v[46:47]
v_pk_add_f32 v[60:61], v[60:61], v[48:49]
v_pk_add_f32 v[62:63], v[62:63], v[50:51]
v_pk_add_f32 v[60:61], v[60:61], v[52:53]
v_pk_add_f32 v[62:63], v[62:63], v[54:55]
v_pk_add_f32 v[60:61], v[60:61], v[56:57]
v_pk_add_f32 v[60:61], v[60:61], v[62:63]
v_add_f32 v60, v60, v61
s_nop 1
v_add_f32_dpp v61, v60, v60 row_ror:8 row_mask:0xf bank_mask:0xf
s_nop 1
v_add_f32_dpp v60, v61, v61 row_ror:4 row_mask:0xf bank_mask:0xf
s_nop 1
v_add_f32_dpp v61, v60, v60 row_ror:2 row_mask:0xf bank_mask:0xf
s_nop 1
v_add_f32_dpp v60, v61, v61 row_ror:1 row_mask:0xf bank_mask:0xf
v_mov_b32 v61, v60
s_nop 1
v_permlane16_swap_b32 v60, v61
v_add_f32 v60, v60, v61
v_mul_f32 v60, s76, v60
v_mov_b32 v61, v60
v_pk_add_f32 v[66:67], v[40:41], v[60:61] neg_lo:[0,1] neg_hi:[0,1]
v_pk_mul_f32 v[62:63], v[66:67], v[66:67]
v_pk_add_f32 v[68:69], v[42:43], v[60:61] neg_lo:[0,1] neg_hi:[0,1]
v_pk_fma_f32 v[62:63], v[68:69], v[68:69], v[62:63]
v_pk_add_f32 v[66:67], v[44:45], v[60:61] neg_lo:[0,1] neg_hi:[0,1]
v_pk_fma_f32 v[62:63], v[66:67], v[66:67], v[62:63]
v_pk_add_f32 v[68:69], v[46:47], v[60:61] neg_lo:[0,1] neg_hi:[0,1]
v_pk_fma_f32 v[62:63], v[68:69], v[68:69], v[62:63]
v_pk_add_f32 v[66:67], v[48:49], v[60:61] neg_lo:[0,1] neg_hi:[0,1]
v_pk_fma_f32 v[62:63], v[66:67], v[66:67], v[62:63]
v_pk_add_f32 v[68:69], v[50:51], v[60:61] neg_lo:[0,1] neg_hi:[0,1]
v_pk_fma_f32 v[62:63], v[68:69], v[68:69], v[62:63]
v_pk_add_f32 v[66:67], v[52:53], v[60:61] neg_lo:[0,1] neg_hi:[0,1]
v_pk_fma_f32 v[62:63], v[66:67], v[66:67], v[62:63]
v_pk_add_f32 v[68:69], v[54:55], v[60:61] neg_lo:[0,1] neg_hi:[0,1]
v_pk_fma_f32 v[62:63], v[68:69], v[68:69], v[62:63]
v_pk_add_f32 v[66:67], v[56:57], v[60:61] neg_lo:[0,1] neg_hi:[0,1]
v_pk_fma_f32 v[62:63], v[66:67], v[66:67], v[62:63]
v_add_f32 v61, v62, v63
s_nop 1
v_add_f32_dpp v62, v61, v61 row_ror:8 row_mask:0xf bank_mask:0xf
s_nop 1
v_add_f32_dpp v61, v62, v62 row_ror:4 row_mask:0xf bank_mask:0xf
s_nop 1
v_add_f32_dpp v62, v61, v61 row_ror:2 row_mask:0xf bank_mask:0xf
s_nop 1
v_add_f32_dpp v61, v62, v62 row_ror:1 row_mask:0xf bank_mask:0xf
v_mov_b32 v62, v61
s_nop 1
v_permlane16_swap_b32 v61, v62
v_add_f32 v61, v61, v62
v_mul_f32 v61, s76, v61
v_cvt_pk_bf16_f32 v60, v60, v60
v_lshlrev_b32 v60, 16, v60
v_cvt_pk_bf16_f32 v61, v61, v61
v_lshlrev_b32 v61, 16, v61
v_add_f32 v61, s77, v61
v_cvt_pk_bf16_f32 v61, v61, v61
v_lshlrev_b32 v61, 16, v61
v_sqrt_f32 v61, v61
s_nop 0
v_cvt_pk_bf16_f32 v61, v61, v61
v_lshlrev_b32 v61, 16, v61
v_rcp_f32 v62, v61
v_mov_b32 v63, 0
v_lshrrev_b32 v69, 5, v0
v_mul_u32_u24 v65, 1168, v69
v_lshl_add_u32 v65, v6, 2, v65
v_add_u32 v209, 0x24000, v65
s_cmp_eq_u32 s37, 0
s_cbranch_scc0 F_W3
s_waitcnt vmcnt(1)
s_branch F_W4
F_W3:
s_waitcnt vmcnt(11)
F_W4:
v_mov_b32 v70, v60
v_mov_b32 v71, v60
v_mov_b32 v72, v61
v_mov_b32 v73, v61
v_mov_b32 v74, v62
v_mov_b32 v75, v62
v_pk_add_f32 v[40:41], v[40:41], v[70:71] neg_lo:[0,1] neg_hi:[0,1]
v_cvt_pk_bf16_f32 v68, v40, v41
v_lshlrev_b32 v40, 16, v68
v_and_b32 v41, s75, v68
v_pk_mul_f32 v[66:67], v[40:41], v[74:75]
v_pk_fma_f32 v[40:41], v[66:67], v[72:73], v[40:41] neg_lo:[1,0,0] neg_hi:[1,0,0]
v_pk_fma_f32 v[66:67], v[40:41], v[74:75], v[66:67]
v_cvt_pk_bf16_f32 v200, v66, v67
v_pk_mul_f32 v[66:67], v[66:67], s[40:41]
v_dot2_f32_bf16 v63, v200, v28, v63
v_cvt_pk_bf16_f32 v18, v66, v67
ds_write_b32 v209, v18 offset:0
v_pk_add_f32 v[42:43], v[42:43], v[70:71] neg_lo:[0,1] neg_hi:[0,1]
v_cvt_pk_bf16_f32 v68, v42, v43
v_lshlrev_b32 v42, 16, v68
v_and_b32 v43, s75, v68
v_pk_mul_f32 v[66:67], v[42:43], v[74:75]
v_pk_fma_f32 v[42:43], v[66:67], v[72:73], v[42:43] neg_lo:[1,0,0] neg_hi:[1,0,0]
v_pk_fma_f32 v[66:67], v[42:43], v[74:75], v[66:67]
v_cvt_pk_bf16_f32 v201, v66, v67
v_pk_mul_f32 v[66:67], v[66:67], s[40:41]
v_dot2_f32_bf16 v63, v201, v29, v63
v_cvt_pk_bf16_f32 v19, v66, v67
ds_write_b32 v209, v19 offset:128
v_pk_add_f32 v[44:45], v[44:45], v[70:71] neg_lo:[0,1] neg_hi:[0,1]
v_cvt_pk_bf16_f32 v68, v44, v45
v_lshlrev_b32 v44, 16, v68
v_and_b32 v45, s75, v68
v_pk_mul_f32 v[66:67], v[44:45], v[74:75]
v_pk_fma_f32 v[44:45], v[66:67], v[72:73], v[44:45] neg_lo:[1,0,0] neg_hi:[1,0,0]
v_pk_fma_f32 v[66:67], v[44:45], v[74:75], v[66:67]
v_cvt_pk_bf16_f32 v202, v66, v67
v_pk_mul_f32 v[66:67], v[66:67], s[40:41]
v_dot2_f32_bf16 v63, v202, v30, v63
v_cvt_pk_bf16_f32 v20, v66, v67
ds_write_b32 v209, v20 offset:256
v_pk_add_f32 v[46:47], v[46:47], v[70:71] neg_lo:[0,1] neg_hi:[0,1]
v_cvt_pk_bf16_f32 v68, v46, v47
v_lshlrev_b32 v46, 16, v68
v_and_b32 v47, s75, v68
v_pk_mul_f32 v[66:67], v[46:47], v[74:75]
v_pk_fma_f32 v[46:47], v[66:67], v[72:73], v[46:47] neg_lo:[1,0,0] neg_hi:[1,0,0]
v_pk_fma_f32 v[66:67], v[46:47], v[74:75], v[66:67]
v_cvt_pk_bf16_f32 v203, v66, v67
v_pk_mul_f32 v[66:67], v[66:67], s[40:41]
v_dot2_f32_bf16 v63, v203, v31, v63
v_cvt_pk_bf16_f32 v21, v66, v67
ds_write_b32 v209, v21 offset:384
v_pk_add_f32 v[48:49], v[48:49], v[70:71] neg_lo:[0,1] neg_hi:[0,1]
v_cvt_pk_bf16_f32 v68, v48, v49
v_lshlrev_b32 v48, 16, v68
v_and_b32 v49, s75, v68
v_pk_mul_f32 v[66:67], v[48:49], v[74:75]
v_pk_fma_f32 v[48:49], v[66:67], v[72:73], v[48:49] neg_lo:[1,0,0] neg_hi:[1,0,0]
v_pk_fma_f32 v[66:67], v[48:49], v[74:75], v[66:67]
v_cvt_pk_bf16_f32 v204, v66, v67
v_pk_mul_f32 v[66:67], v[66:67], s[40:41]
v_dot2_f32_bf16 v63, v204, v32, v63
v_cvt_pk_bf16_f32 v22, v66, v67
ds_write_b32 v209, v22 offset:512
v_pk_add_f32 v[50:51], v[50:51], v[70:71] neg_lo:[0,1] neg_hi:[0,1]
v_cvt_pk_bf16_f32 v68, v50, v51
v_lshlrev_b32 v50, 16, v68
v_and_b32 v51, s75, v68
v_pk_mul_f32 v[66:67], v[50:51], v[74:75]
v_pk_fma_f32 v[50:51], v[66:67], v[72:73], v[50:51] neg_lo:[1,0,0] neg_hi:[1,0,0]
v_pk_fma_f32 v[66:67], v[50:51], v[74:75], v[66:67]
v_cvt_pk_bf16_f32 v205, v66, v67
v_pk_mul_f32 v[66:67], v[66:67], s[40:41]
v_dot2_f32_bf16 v63, v205, v33, v63
v_cvt_pk_bf16_f32 v23, v66, v67
ds_write_b32 v209, v23 offset:640
v_pk_add_f32 v[52:53], v[52:53], v[70:71] neg_lo:[0,1] neg_hi:[0,1]
v_cvt_pk_bf16_f32 v68, v52, v53
v_lshlrev_b32 v52, 16, v68
v_and_b32 v53, s75, v68
v_pk_mul_f32 v[66:67], v[52:53], v[74:75]
v_pk_fma_f32 v[52:53], v[66:67], v[72:73], v[52:53] neg_lo:[1,0,0] neg_hi:[1,0,0]
v_pk_fma_f32 v[66:67], v[52:53], v[74:75], v[66:67]
v_cvt_pk_bf16_f32 v206, v66, v67
v_pk_mul_f32 v[66:67], v[66:67], s[40:41]
v_dot2_f32_bf16 v63, v206, v34, v63
v_cvt_pk_bf16_f32 v24, v66, v67
ds_write_b32 v209, v24 offset:768
v_pk_add_f32 v[54:55], v[54:55], v[70:71] neg_lo:[0,1] neg_hi:[0,1]
v_cvt_pk_bf16_f32 v68, v54, v55
v_lshlrev_b32 v54, 16, v68
v_and_b32 v55, s75, v68
v_pk_mul_f32 v[66:67], v[54:55], v[74:75]
v_pk_fma_f32 v[54:55], v[66:67], v[72:73], v[54:55] neg_lo:[1,0,0] neg_hi:[1,0,0]
v_pk_fma_f32 v[66:67], v[54:55], v[74:75], v[66:67]
v_cvt_pk_bf16_f32 v207, v66, v67
v_pk_mul_f32 v[66:67], v[66:67], s[40:41]
v_dot2_f32_bf16 v63, v207, v35, v63
v_cvt_pk_bf16_f32 v25, v66, v67
ds_write_b32 v209, v25 offset:896
v_pk_add_f32 v[56:57], v[56:57], v[70:71] neg_lo:[0,1] neg_hi:[0,1]
v_cvt_pk_bf16_f32 v68, v56, v57
v_lshlrev_b32 v56, 16, v68
v_and_b32 v57, s75, v68
v_pk_mul_f32 v[66:67], v[56:57], v[74:75]
v_pk_fma_f32 v[56:57], v[66:67], v[72:73], v[56:57] neg_lo:[1,0,0] neg_hi:[1,0,0]
v_pk_fma_f32 v[66:67], v[56:57], v[74:75], v[66:67]
v_cvt_pk_bf16_f32 v208, v66, v67
v_pk_mul_f32 v[66:67], v[66:67], s[40:41]
v_dot2_f32_bf16 v63, v208, v36, v63
v_cvt_pk_bf16_f32 v26, v66, v67
ds_write_b32 v209, v26 offset:1024
s_nop 2
s_nop 1
v_add_f32_dpp v62, v63, v63 row_ror:8 row_mask:0xf bank_mask:0xf
s_nop 1
v_add_f32_dpp v63, v62, v62 row_ror:4 row_mask:0xf bank_mask:0xf
s_nop 1
v_add_f32_dpp v62, v63, v63 row_ror:2 row_mask:0xf bank_mask:0xf
s_nop 1
v_add_f32_dpp v63, v62, v62 row_ror:1 row_mask:0xf bank_mask:0xf
v_mov_b32 v62, v63
s_nop 1
v_permlane16_swap_b32 v63, v62
v_add_f32 v63, v63, v62
v_cvt_pk_bf16_f32 v63, v63, v63
v_lshlrev_b32 v63, 16, v63
v_ashrrev_i32 v66, 31, v63
v_or_b32 v66, 0x80000000, v66
v_xor_b32 v63, v63, v66
v_and_b32 v63, s75, v63
v_sub_u32 v66, 0xffff, v5
v_or_b32 v63, v63, v66
v_lshlrev_b32 v66, 2, v69
v_add_u32 v66, 0x26480, v66
ds_write_b32 v66, v63
v_and_b32 v64, 7, v1
v_lshlrev_b32 v64, 2, v64
s_waitcnt lgkmcnt(0)
s_barrier
s_mul_i32 s101, s6, 0x9e3779b1
s_add_u32 s101, s101, 0x7f4a7c15
s_mul_i32 s47, s7, 0x85ebca6b
s_add_u32 s47, s47, 0x165667b1
s_cmp_eq_u32 s37, 0
s_cbranch_scc0 F_OTHER
ds_read2_b64 v[72:75], v168 offset0:0 offset1:4
ds_read2_b64 v[76:79], v168 offset0:16 offset1:20
ds_read2_b64 v[80:83], v168 offset0:32 offset1:36
ds_read2_b64 v[84:87], v168 offset0:48 offset1:52
ds_read2_b64 v[88:91], v168 offset0:64 offset1:68
ds_read2_b64 v[92:95], v168 offset0:80 offset1:84
ds_read2_b64 v[96:99], v168 offset0:96 offset1:100
ds_read2_b64 v[100:103], v168 offset0:112 offset1:116
ds_read2_b64 v[104:107], v168 offset0:128 offset1:132
v_add_u32 v65, 0x26480, v64
ds_read_b32 v65, v65
s_add_u32 s28, s45, 0x1800000
s_waitcnt lgkmcnt(9)
buffer_store_dwordx4 v[72:75], v169, s[20:23], s28 offen offset:0
s_waitcnt lgkmcnt(8)
buffer_store_dwordx4 v[76:79], v169, s[20:23], s28 offen offset:2048
s_add_u32 s28, s28, 4096
s_waitcnt lgkmcnt(7)
buffer_store_dwordx4 v[80:83], v169, s[20:23], s28 offen offset:0
s_waitcnt lgkmcnt(6)
buffer_store_dwordx4 v[84:87], v169, s[20:23], s28 offen offset:2048
s_add_u32 s28, s28, 4096
s_waitcnt lgkmcnt(5)
buffer_store_dwordx4 v[88:91], v169, s[20:23], s28 offen offset:0
s_waitcnt lgkmcnt(4)
buffer_store_dwordx4 v[92:95], v169, s[20:23], s28 offen offset:2048
s_add_u32 s28, s28, 4096
s_waitcnt lgkmcnt(3)
buffer_store_dwordx4 v[96:99], v169, s[20:23], s28 offen offset:0
s_waitcnt lgkmcnt(2)
buffer_store_dwordx4 v[100:103], v169, s[20:23], s28 offen offset:2048
s_add_u32 s28, s28, 4096
s_waitcnt lgkmcnt(1)
buffer_store_dwordx4 v[104:107], v169, s[20:23], s28 offen offset:0
s_lshl_b32 s28, s3, 2
s_add_u32 s28, s28, 0x1a40000
s_waitcnt lgkmcnt(0)
buffer_store_dword v65, v64, s[20:23], s28 offen
s_and_b32 s29, s101, -16
s_or_b32 s29, s29, s38
v_mov_b32 v58, s29
v_mov_b32 v59, s47
s_lshl_b32 s29, s35, 3
v_mov_b32 v61, s29
s_lshl_b32 s28, s36, 8
s_add_u32 s28, s28, 0x24d000
s_waitcnt vmcnt(0)
s_mov_b64 exec, 1
buffer_store_dwordx2 v[58:59], v61, s[20:23], s28 offen
s_mov_b64 exec, -1
s_branch F_JOIN
F_END0:
.p2align 12
K_P1:
F_OTHER:
STUB_0:
s_mov_b64 exec, 0
s_cmp_eq_u32 s37, 1
s_cbranch_scc1 STUB_A1
s_cmp_eq_u32 s37, 2
s_cbranch_scc1 STUB_A2
s_cmp_eq_u32 s37, 3
s_cbranch_scc1 STUB_A3
s_mov_b64 exec, -1
HOP_R1:
s_add_u32 m0, s49, 96256
s_nop 0
buffer_load_dwordx4 v238, s[16:19], s34 offen offset:0 lds
buffer_load_dwordx4 v239, s[16:19], s34 offen offset:1024 lds
s_add_u32 s34, s34, 196608
s_sub_u32 s51, s34, 4718592
s_cselect_b32 s34, s34, s51
s_add_u32 m0, s49, 102400
s_nop 0
buffer_load_dwordx4 v238, s[16:19], s34 offen offset:0 lds
buffer_load_dwordx4 v239, s[16:19], s34 offen offset:1024 lds
s_add_u32 s34, s34, 196608
s_sub_u32 s51, s34, 4718592
s_cselect_b32 s34, s34, s51
s_add_u32 m0, s49, 108544
s_nop 0
buffer_load_dwordx4 v238, s[16:19], s34 offen offset:0 lds
buffer_load_dwordx4 v239, s[16:19], s34 offen offset:1024 lds
s_add_u32 s34, s34, 196608
s_sub_u32 s51, s34, 4718592
s_cselect_b32 s34, s34, s51
s_mov_b64 exec, 0
s_cmp_eq_u32 s37, 1
s_cbranch_scc1 STUB_B1
s_cmp_eq_u32 s37, 2
s_cbranch_scc1 STUB_B2
s_cmp_eq_u32 s37, 3
s_cbranch_scc1 STUB_B3
s_mov_b64 exec, -1
HOP_R2:
F_JOIN:
s_lshl_b32 s49, s37, 11
s_lshl_b32 s28, s37, 16
s_lshl_b32 s34, s35, 8
s_add_u32 s34, s34, s28
s_lshl_b32 s28, s5, 18
s_add_u32 s34, s34, s28
s_add_u32 s34, s34, 1572864
s_sub_u32 s51, s34, 4718592
s_cselect_b32 s34, s34, s51
s_lshl_b32 s30, s37, 12
s_lshl_b32 s31, s37, 10
s_lshl_b32 s92, s36, 5
s_add_u32 s92, s92, s35
s_lshl2_add_u32 s92, s92, s37
s_lshl_b32 s44, s92, 14
s_add_u32 s44, s44, 0x400000
s_mov_b32 s42, 0x5f800000
s_mov_b32 s43, 0
s_lshr_b32 s92, s35, 1
s_lshl_b32 s92, s92, 19
s_add_u32 s66, s66, s92
s_addc_u32 s67, s67, 0
s_add_u32 s68, s68, s92
s_addc_u32 s69, s69, 0
s_mov_b32 s8, s66
s_and_b32 s9, s67, 0xffff
s_mov_b32 s10, 0x80000
s_mov_b32 s11, 0x00020000
s_mov_b32 s12, s68
s_and_b32 s13, s69, 0xffff
s_mov_b32 s14, 0x80000
s_mov_b32 s15, 0x00020000
s_mov_b32 s56, s72
s_and_b32 s57, s73, 0xffff
s_mov_b32 s58, 0x480000
s_mov_b32 s59, 0x00020000
s_mov_b32 s60, s84
s_and_b32 s61, s85, 0xffff
s_mov_b32 s62, 0x240000
s_mov_b32 s63, 0x00020000
s_mov_b32 s64, s78
s_and_b32 s65, s79, 0xffff
s_mov_b32 s66, 0x510000
s_mov_b32 s67, 0x00020000
s_mov_b32 s68, s80
s_and_b32 s69, s81, 0xffff
s_mov_b32 s70, 0x510000
s_mov_b32 s71, 0x00020000
s_mov_b32 s72, s82
s_and_b32 s73, s83, 0xffff
s_mov_b32 s74, 0x510000
s_mov_b32 s75, 0x00020000
s_cmp_eq_u32 s37, 0
s_cbranch_scc1 F_W0P
s_waitcnt vmcnt(0)
s_branch F_BAR2
HOP_RET1:
s_mov_b64 exec, -1
s_branch HOP_R1
HOP_RET2:
s_mov_b64 exec, -1
s_branch HOP_R2
F_W0P:
s_mov_b32 s46, 0x20
s_lshl_b32 s28, s36, 8
s_add_u32 s28, s28, 0x24d000
v_and_b32 v61, 31, v1
v_lshlrev_b32 v61, 3, v61
s_mov_b32 s51, 0
v_mov_b32 v60, 3
F_POLL:
buffer_load_dwordx2 v[62:63], v61, s[20:23], s28 offen sc0 sc1
s_waitcnt vmcnt(0)
v_cmp_ne_u64 vcc, v[62:63], v[58:59]
s_cbranch_vccz F_GO
s_add_u32 s51, s51, 1
s_and_b32 s29, s51, 31
s_cbranch_scc1 F_POLL
s_branch F_NOTYET
F_GO:
v_mov_b32 v61, 156864
ds_write_b32 v61, v60
s_waitcnt lgkmcnt(0)
F_BAR2:
s_barrier
s_lshl_b32 s7, s36, 31
s_mov_b32 s7, 0
v_mov_b32 v246, 156864
ds_read_b32 v246, v246
s_mov_b32 s4, 0x1800000
s_mov_b32 s51, 3
Q_START:
s_lshl_b32 s28, s5, 10
s_add_u32 s28, s28, s4
s_add_u32 s6, s4, 18432
buffer_load_dwordx4 a[0:3], v240, s[20:23], s28 offen sc0 sc1
buffer_load_dwordx4 a[4:7], v241, s[20:23], s28 offen sc0 sc1
buffer_load_dwordx4 a[8:11], v242, s[20:23], s28 offen sc0 sc1
buffer_load_dwordx4 a[12:15], v243, s[20:23], s28 offen sc0 sc1
s_waitcnt lgkmcnt(0)
v_readfirstlane_b32 s48, v246
ds_read_b64_tr_b16 a[144:145], v234 offset:0
ds_read_b64_tr_b16 a[146:147], v234 offset:4096
ds_read_b64_tr_b16 a[148:149], v234 offset:8
ds_read_b64_tr_b16 a[150:151], v234 offset:4104
ds_read_b64_tr_b16 a[152:153], v235 offset:0
ds_read_b64_tr_b16 a[154:155], v235 offset:4096
ds_read_b64_tr_b16 a[156:157], v235 offset:8
ds_read_b64_tr_b16 a[158:159], v235 offset:4104
ds_read_b64_tr_b16 a[160:161], v236 offset:0
ds_read_b64_tr_b16 a[162:163], v236 offset:4096
ds_read_b64_tr_b16 a[164:165], v236 offset:8
ds_read_b64_tr_b16 a[166:167], v236 offset:4104
ds_read_b64_tr_b16 a[168:169], v237 offset:0
ds_read_b64_tr_b16 a[170:171], v237 offset:4096
ds_read_b64_tr_b16 a[172:173], v237 offset:8
ds_read_b64_tr_b16 a[174:175], v237 offset:4104
s_cmp_lt_u32 s48, s51
s_cbranch_scc1 Q_REDO
s_add_u32 s28, s28, 1024
s_cmp_lt_u32 s28, s6
s_cselect_b32 s28, s28, s4
buffer_load_dwordx4 a[16:19], v240, s[20:23], s28 offen sc0 sc1
buffer_load_dwordx4 a[20:23], v241, s[20:23], s28 offen sc0 sc1
buffer_load_dwordx4 a[24:27], v242, s[20:23], s28 offen sc0 sc1
buffer_load_dwordx4 a[28:31], v243, s[20:23], s28 offen sc0 sc1
s_lshl_b32 s29, s36, 10
s_add_u32 s29, s29, s4
s_add_u32 s29, s29, 0x240000
buffer_load_dwordx4 v[136:139], v244, s[20:23], s29 offen sc0 sc1
s_add_u32 s28, s28, 1024
s_cmp_lt_u32 s28, s6
s_cselect_b32 s28, s28, s4
buffer_load_dwordx4 a[32:35], v240, s[20:23], s28 offen sc0 sc1
buffer_load_dwordx4 a[36:39], v241, s[20:23], s28 offen sc0 sc1
buffer_load_dwordx4 a[40:43], v242, s[20:23], s28 offen sc0 sc1
buffer_load_dwordx4 a[44:47], v243, s[20:23], s28 offen sc0 sc1
s_waitcnt vmcnt(9)
s_waitcnt lgkmcnt(8)
v_mfma_f32_16x16x32_bf16 v[8:11], a[144:147], a[0:3], 0
ds_read_b64_tr_b16 a[176:177], v234 offset:8192
v_mov_b32 v143, 0
v_mfma_f32_16x16x32_bf16 v[40:43], a[144:147], a[4:7], 0
ds_read_b64_tr_b16 a[178:179], v234 offset:12288
ds_write_b32 v209, v200 offset:0
v_mfma_f32_16x16x32_bf16 v[72:75], a[144:147], a[8:11], 0
s_add_u32 s28, s28, 1024
s_cmp_lt_u32 s28, s6
s_cselect_b32 s28, s28, s4
v_mfma_f32_16x16x32_bf16 v[104:107], a[144:147], a[12:15], 0
ds_read_b64_tr_b16 a[180:181], v234 offset:8200
ds_write_b32 v209, v201 offset:128
v_mfma_f32_16x16x32_bf16 v[108:111], a[148:151], a[12:15], 0
ds_read_b64_tr_b16 a[182:183], v234 offset:12296
ds_write_b32 v209, v202 offset:256
v_mfma_f32_16x16x32_bf16 v[76:79], a[148:151], a[8:11], 0
buffer_load_dwordx4 a[48:51], v240, s[20:23], s28 offen sc0 sc1
v_mfma_f32_16x16x32_bf16 v[44:47], a[148:151], a[4:7], 0
ds_read_b64_tr_b16 a[184:185], v235 offset:8192
ds_write_b32 v209, v203 offset:384
v_mfma_f32_16x16x32_bf16 v[12:15], a[148:151], a[0:3], 0
ds_read_b64_tr_b16 a[186:187], v235 offset:12288
ds_write_b32 v209, v204 offset:512
v_mfma_f32_16x16x32_bf16 v[16:19], a[152:155], a[0:3], 0
buffer_load_dwordx4 a[52:55], v241, s[20:23], s28 offen sc0 sc1
v_mfma_f32_16x16x32_bf16 v[48:51], a[152:155], a[4:7], 0
ds_read_b64_tr_b16 a[188:189], v235 offset:8200
ds_write_b32 v209, v205 offset:640
v_mfma_f32_16x16x32_bf16 v[80:83], a[152:155], a[8:11], 0
ds_read_b64_tr_b16 a[190:191], v235 offset:12296
ds_write_b32 v209, v206 offset:768
v_mfma_f32_16x16x32_bf16 v[112:115], a[152:155], a[12:15], 0
buffer_load_dwordx4 a[56:59], v242, s[20:23], s28 offen sc0 sc1
v_mfma_f32_16x16x32_bf16 v[116:119], a[156:159], a[12:15], 0
ds_read_b64_tr_b16 a[192:193], v236 offset:8192
ds_write_b32 v209, v207 offset:896
v_mfma_f32_16x16x32_bf16 v[84:87], a[156:159], a[8:11], 0
buffer_load_dwordx4 a[60:63], v243, s[20:23], s28 offen sc0 sc1
v_mfma_f32_16x16x32_bf16 v[52:55], a[156:159], a[4:7], 0
ds_read_b64_tr_b16 a[194:195], v236 offset:12288
ds_write_b32 v209, v208 offset:1024
v_mfma_f32_16x16x32_bf16 v[20:23], a[156:159], a[0:3], 0
ds_read_b64_tr_b16 a[196:197], v236 offset:8200
v_add_u32 v184, 0, v4
s_waitcnt lgkmcnt(8)
v_mfma_f32_16x16x32_bf16 v[24:27], a[160:163], a[0:3], 0
s_add_u32 s28, s28, 1024
s_cmp_lt_u32 s28, s6
s_cselect_b32 s28, s28, s4
v_mfma_f32_16x16x32_bf16 v[56:59], a[160:163], a[4:7], 0
ds_read_b64_tr_b16 a[198:199], v236 offset:12296
v_xor_b32 v184, v184, v3
v_mfma_f32_16x16x32_bf16 v[88:91], a[160:163], a[8:11], 0
ds_read_b64_tr_b16 a[200:201], v237 offset:8192
v_lshlrev_b32 v184, 4, v184
v_mfma_f32_16x16x32_bf16 v[120:123], a[160:163], a[12:15], 0
buffer_load_dwordx4 a[64:67], v240, s[20:23], s28 offen sc0 sc1
v_mfma_f32_16x16x32_bf16 v[124:127], a[164:167], a[12:15], 0
ds_read_b64_tr_b16 a[202:203], v237 offset:12288
v_lshl_add_u32 v184, v3, 8, v184
v_mfma_f32_16x16x32_bf16 v[92:95], a[164:167], a[8:11], 0
ds_read_b64_tr_b16 a[204:205], v237 offset:8200
v_add_u32 v216, 0x10000, v184
v_mfma_f32_16x16x32_bf16 v[60:63], a[164:167], a[4:7], 0
buffer_load_dwordx4 a[68:71], v241, s[20:23], s28 offen sc0 sc1
v_mfma_f32_16x16x32_bf16 v[28:31], a[164:167], a[0:3], 0
ds_read_b64_tr_b16 a[206:207], v237 offset:12296
v_add_u32 v184, 4, v4
v_mfma_f32_16x16x32_bf16 v[32:35], a[168:171], a[0:3], 0
buffer_load_dwordx4 a[72:75], v242, s[20:23], s28 offen sc0 sc1
v_mfma_f32_16x16x32_bf16 v[64:67], a[168:171], a[4:7], 0
buffer_load_dwordx4 a[76:79], v243, s[20:23], s28 offen sc0 sc1
v_mfma_f32_16x16x32_bf16 v[96:99], a[168:171], a[8:11], 0
s_add_u32 m0, s49, 114688
v_xor_b32 v184, v184, v3
v_mfma_f32_16x16x32_bf16 v[128:131], a[168:171], a[12:15], 0
buffer_load_dwordx4 v238, s[16:19], s34 offen offset:0 lds
v_mfma_f32_16x16x32_bf16 v[132:135], a[172:175], a[12:15], 0
buffer_load_dwordx4 v239, s[16:19], s34 offen offset:1024 lds
v_mfma_f32_16x16x32_bf16 v[100:103], a[172:175], a[8:11], 0
s_add_u32 s34, s34, 262144
s_sub_u32 s51, s34, 4718592
s_cselect_b32 s34, s34, s51
v_mfma_f32_16x16x32_bf16 v[68:71], a[172:175], a[4:7], 0
s_mov_b32 s90, 0x01010101
s_mov_b32 s91, 0x01010101
v_mfma_f32_16x16x32_bf16 v[36:39], a[172:175], a[0:3], 0
v_lshlrev_b32 v184, 4, v184
v_lshl_add_u32 v184, v3, 8, v184
s_waitcnt vmcnt(15)
v_mfma_f32_16x16x32_bf16 v[8:11], a[176:179], a[16:19], v[8:11]
ds_read_b64_tr_b16 a[144:145], v234 offset:16384
v_add_u32 v217, 0x10000, v184
v_mfma_f32_16x16x32_bf16 v[40:43], a[176:179], a[20:23], v[40:43]
ds_read_b64_tr_b16 a[146:147], v234 offset:20480
v_add_u32 v184, 8, v4
v_mfma_f32_16x16x32_bf16 v[72:75], a[176:179], a[24:27], v[72:75]
s_add_u32 s28, s28, 1024
s_cmp_lt_u32 s28, s6
s_cselect_b32 s28, s28, s4
v_mfma_f32_16x16x32_bf16 v[104:107], a[176:179], a[28:31], v[104:107]
ds_read_b64_tr_b16 a[148:149], v234 offset:16392
v_xor_b32 v184, v184, v3
v_mfma_f32_16x16x32_bf16 v[108:111], a[180:183], a[28:31], v[108:111]
ds_read_b64_tr_b16 a[150:151], v234 offset:20488
v_lshlrev_b32 v184, 4, v184
v_mfma_f32_16x16x32_bf16 v[76:79], a[180:183], a[24:27], v[76:79]
buffer_load_dwordx4 a[80:83], v240, s[20:23], s28 offen sc0 sc1
v_mfma_f32_16x16x32_bf16 v[44:47], a[180:183], a[20:23], v[44:47]
ds_read_b64_tr_b16 a[152:153], v235 offset:16384
v_lshl_add_u32 v184, v3, 8, v184
v_mfma_f32_16x16x32_bf16 v[12:15], a[180:183], a[16:19], v[12:15]
ds_read_b64_tr_b16 a[154:155], v235 offset:20480
v_add_u32 v218, 0x10000, v184
v_mfma_f32_16x16x32_bf16 v[16:19], a[184:187], a[16:19], v[16:19]
buffer_load_dwordx4 a[84:87], v241, s[20:23], s28 offen sc0 sc1
v_mfma_f32_16x16x32_bf16 v[48:51], a[184:187], a[20:23], v[48:51]
ds_read_b64_tr_b16 a[156:157], v235 offset:16392
v_add_u32 v184, 12, v4
v_mfma_f32_16x16x32_bf16 v[80:83], a[184:187], a[24:27], v[80:83]
ds_read_b64_tr_b16 a[158:159], v235 offset:20488
v_xor_b32 v184, v184, v3
v_mfma_f32_16x16x32_bf16 v[112:115], a[184:187], a[28:31], v[112:115]
buffer_load_dwordx4 a[88:91], v242, s[20:23], s28 offen sc0 sc1
s_waitcnt lgkmcnt(8)
v_mfma_f32_16x16x32_bf16 v[116:119], a[188:191], a[28:31], v[116:119]
ds_read_b64_tr_b16 a[160:161], v236 offset:16384
v_lshlrev_b32 v184, 4, v184
v_mfma_f32_16x16x32_bf16 v[84:87], a[188:191], a[24:27], v[84:87]
buffer_load_dwordx4 a[92:95], v243, s[20:23], s28 offen sc0 sc1
v_mfma_f32_16x16x32_bf16 v[52:55], a[188:191], a[20:23], v[52:55]
ds_read_b64_tr_b16 a[162:163], v236 offset:20480
v_lshl_add_u32 v184, v3, 8, v184
v_mfma_f32_16x16x32_bf16 v[20:23], a[188:191], a[16:19], v[20:23]
ds_read_b64_tr_b16 a[164:165], v236 offset:16392
v_add_u32 v219, 0x10000, v184
v_mfma_f32_16x16x32_bf16 v[24:27], a[192:195], a[16:19], v[24:27]
s_add_u32 m0, s49, 122880
v_bfe_u32 v184, v1, 2, 2
v_mfma_f32_16x16x32_bf16 v[56:59], a[192:195], a[20:23], v[56:59]
ds_read_b64_tr_b16 a[166:167], v236 offset:20488
v_and_b32 v185, 3, v1
v_mfma_f32_16x16x32_bf16 v[88:91], a[192:195], a[24:27], v[88:91]
ds_read_b64_tr_b16 a[168:169], v237 offset:16384
v_lshl_add_u32 v186, v4, 2, v184
v_mfma_f32_16x16x32_bf16 v[120:123], a[192:195], a[28:31], v[120:123]
s_waitcnt vmcnt(18)
v_max3_u32 v140, v136, v137, v138
v_mfma_f32_16x16x32_bf16 v[124:127], a[196:199], a[28:31], v[124:127]
ds_read_b64_tr_b16 a[170:171], v237 offset:20480
v_max_u32 v140, v140, v139
v_mfma_f32_16x16x32_bf16 v[92:95], a[196:199], a[24:27], v[92:95]
ds_read_b64_tr_b16 a[172:173], v237 offset:16392
v_and_b32 v187, 7, v186
v_mfma_f32_16x16x32_bf16 v[60:63], a[196:199], a[20:23], v[60:63]
buffer_load_dwordx4 v238, s[16:19], s34 offen offset:0 lds
v_mfma_f32_16x16x32_bf16 v[28:31], a[196:199], a[16:19], v[28:31]
ds_read_b64_tr_b16 a[174:175], v237 offset:20488
v_max_u32_dpp v141, v140, v140 row_ror:8 row_mask:0xf bank_mask:0xf
v_mfma_f32_16x16x32_bf16 v[32:35], a[200:203], a[16:19], v[32:35]
buffer_load_dwordx4 v239, s[16:19], s34 offen offset:1024 lds
v_mfma_f32_16x16x32_bf16 v[64:67], a[200:203], a[20:23], v[64:67]
v_max_u32_dpp v140, v141, v141 row_ror:4 row_mask:0xf bank_mask:0xf
v_lshlrev_b32 v188, 8, v186
v_mfma_f32_16x16x32_bf16 v[96:99], a[200:203], a[24:27], v[96:99]
s_add_u32 s34, s34, 262144
s_sub_u32 s51, s34, 4718592
s_cselect_b32 s34, s34, s51
v_mfma_f32_16x16x32_bf16 v[128:131], a[200:203], a[28:31], v[128:131]
v_max_u32_dpp v141, v140, v140 row_ror:2 row_mask:0xf bank_mask:0xf
v_lshl_add_u32 v188, v185, 3, v188
v_mfma_f32_16x16x32_bf16 v[132:135], a[204:207], a[28:31], v[132:135]
v_add_u32 v188, 0x18000, v188
v_xor_b32 v189, 0, v187
v_mfma_f32_16x16x32_bf16 v[100:103], a[204:207], a[24:27], v[100:103]
v_max_u32_dpp v140, v141, v141 row_ror:1 row_mask:0xf bank_mask:0xf
v_mov_b32 v141, v140
v_mfma_f32_16x16x32_bf16 v[68:71], a[204:207], a[20:23], v[68:71]
v_lshl_add_u32 v220, v189, 5, v188
v_xor_b32 v189, 1, v187
v_mfma_f32_16x16x32_bf16 v[36:39], a[204:207], a[16:19], v[36:39]
v_permlane16_swap_b32 v140, v141
v_max_u32 v140, v140, v141
s_waitcnt vmcnt(16)
s_waitcnt lgkmcnt(8)
v_mfma_f32_16x16x32_bf16 v[8:11], a[144:147], a[32:35], v[8:11]
ds_read_b64_tr_b16 a[176:177], v234 offset:24576
v_mov_b32 v141, v140
v_mfma_f32_16x16x32_bf16 v[40:43], a[144:147], a[36:39], v[40:43]
ds_read_b64_tr_b16 a[178:179], v234 offset:28672
v_lshl_add_u32 v221, v189, 5, v188
v_mfma_f32_16x16x32_bf16 v[72:75], a[144:147], a[40:43], v[72:75]
s_add_u32 s28, s28, 1024
s_cmp_lt_u32 s28, s6
s_cselect_b32 s28, s28, s4
v_mfma_f32_16x16x32_bf16 v[104:107], a[144:147], a[44:47], v[104:107]
ds_read_b64_tr_b16 a[180:181], v234 offset:24584
v_permlane32_swap_b32 v140, v141
v_mfma_f32_16x16x32_bf16 v[108:111], a[148:151], a[44:47], v[108:111]
ds_read_b64_tr_b16 a[182:183], v234 offset:28680
v_max_u32 v140, v140, v141
v_mfma_f32_16x16x32_bf16 v[76:79], a[148:151], a[40:43], v[76:79]
buffer_load_dwordx4 a[96:99], v240, s[20:23], s28 offen sc0 sc1
v_mfma_f32_16x16x32_bf16 v[44:47], a[148:151], a[36:39], v[44:47]
ds_read_b64_tr_b16 a[184:185], v235 offset:24576
v_add_u32 v143, v143, v140
v_mfma_f32_16x16x32_bf16 v[12:15], a[148:151], a[32:35], v[12:15]
ds_read_b64_tr_b16 a[186:187], v235 offset:28672
v_sub_u32 v136, v136, v140
v_mfma_f32_16x16x32_bf16 v[16:19], a[152:155], a[32:35], v[16:19]
buffer_load_dwordx4 a[100:103], v241, s[20:23], s28 offen sc0 sc1
v_mfma_f32_16x16x32_bf16 v[48:51], a[152:155], a[36:39], v[48:51]
ds_read_b64_tr_b16 a[188:189], v235 offset:24584
v_sub_u32 v137, v137, v140
v_mfma_f32_16x16x32_bf16 v[80:83], a[152:155], a[40:43], v[80:83]
ds_read_b64_tr_b16 a[190:191], v235 offset:28680
v_sub_u32 v138, v138, v140
v_mfma_f32_16x16x32_bf16 v[112:115], a[152:155], a[44:47], v[112:115]
buffer_load_dwordx4 a[104:107], v242, s[20:23], s28 offen sc0 sc1
v_mfma_f32_16x16x32_bf16 v[116:119], a[156:159], a[44:47], v[116:119]
ds_read_b64_tr_b16 a[192:193], v236 offset:24576
v_sub_u32 v139, v139, v140
v_mfma_f32_16x16x32_bf16 v[84:87], a[156:159], a[40:43], v[84:87]
buffer_load_dwordx4 a[108:111], v243, s[20:23], s28 offen sc0 sc1
v_mfma_f32_16x16x32_bf16 v[52:55], a[156:159], a[36:39], v[52:55]
ds_read_b64_tr_b16 a[194:195], v236 offset:28672
v_cndmask_b32 v142, v142, v143, s[90:91]
v_mfma_f32_16x16x32_bf16 v[20:23], a[156:159], a[32:35], v[20:23]
ds_read_b64_tr_b16 a[196:197], v236 offset:24584
s_lshl_b64 s[90:91], s[90:91], 1
s_waitcnt lgkmcnt(8)
v_mfma_f32_16x16x32_bf16 v[24:27], a[160:163], a[32:35], v[24:27]
s_add_u32 m0, s49, 131072
v_max3_u32 v140, v136, v137, v138
v_mfma_f32_16x16x32_bf16 v[56:59], a[160:163], a[36:39], v[56:59]
ds_read_b64_tr_b16 a[198:199], v236 offset:28680
v_max_u32 v140, v140, v139
v_mfma_f32_16x16x32_bf16 v[88:91], a[160:163], a[40:43], v[88:91]
ds_read_b64_tr_b16 a[200:201], v237 offset:24576
v_xor_b32 v189, 2, v187
v_mfma_f32_16x16x32_bf16 v[120:123], a[160:163], a[44:47], v[120:123]
v_max_u32_dpp v141, v140, v140 row_ror:8 row_mask:0xf bank_mask:0xf
v_lshl_add_u32 v222, v189, 5, v188
v_mfma_f32_16x16x32_bf16 v[124:127], a[164:167], a[44:47], v[124:127]
ds_read_b64_tr_b16 a[202:203], v237 offset:28672
v_xor_b32 v189, 3, v187
v_mfma_f32_16x16x32_bf16 v[92:95], a[164:167], a[40:43], v[92:95]
ds_read_b64_tr_b16 a[204:205], v237 offset:24584
v_max_u32_dpp v140, v141, v141 row_ror:4 row_mask:0xf bank_mask:0xf
v_mfma_f32_16x16x32_bf16 v[60:63], a[164:167], a[36:39], v[60:63]
buffer_load_dwordx4 v238, s[16:19], s34 offen offset:0 lds
v_mfma_f32_16x16x32_bf16 v[28:31], a[164:167], a[32:35], v[28:31]
ds_read_b64_tr_b16 a[206:207], v237 offset:28680
v_max_u32_dpp v141, v140, v140 row_ror:2 row_mask:0xf bank_mask:0xf
v_mfma_f32_16x16x32_bf16 v[32:35], a[168:171], a[32:35], v[32:35]
buffer_load_dwordx4 v239, s[16:19], s34 offen offset:1024 lds
v_mfma_f32_16x16x32_bf16 v[64:67], a[168:171], a[36:39], v[64:67]
v_max_u32_dpp v140, v141, v141 row_ror:1 row_mask:0xf bank_mask:0xf
v_mov_b32 v141, v140
v_mfma_f32_16x16x32_bf16 v[96:99], a[168:171], a[40:43], v[96:99]
s_add_u32 s34, s34, 262144
s_sub_u32 s51, s34, 4718592
s_cselect_b32 s34, s34, s51
v_mfma_f32_16x16x32_bf16 v[128:131], a[168:171], a[44:47], v[128:131]
v_permlane16_swap_b32 v140, v141
v_max_u32 v140, v140, v141
v_mfma_f32_16x16x32_bf16 v[132:135], a[172:175], a[44:47], v[132:135]
v_mov_b32 v141, v140
v_lshl_add_u32 v223, v189, 5, v188
v_mfma_f32_16x16x32_bf16 v[100:103], a[172:175], a[40:43], v[100:103]
v_xor_b32 v189, 4, v187
v_lshl_add_u32 v224, v189, 5, v188
v_mfma_f32_16x16x32_bf16 v[68:71], a[172:175], a[36:39], v[68:71]
v_permlane32_swap_b32 v140, v141
v_max_u32 v140, v140, v141
v_mfma_f32_16x16x32_bf16 v[36:39], a[172:175], a[32:35], v[36:39]
v_add_u32 v143, v143, v140
v_sub_u32 v136, v136, v140
s_waitcnt vmcnt(18)
v_mfma_f32_16x16x32_bf16 v[8:11], a[176:179], a[48:51], v[8:11]
ds_read_b64_tr_b16 a[144:145], v234 offset:32768
v_sub_u32 v137, v137, v140
v_mfma_f32_16x16x32_bf16 v[40:43], a[176:179], a[52:55], v[40:43]
ds_read_b64_tr_b16 a[146:147], v234 offset:36864
v_sub_u32 v138, v138, v140
v_mfma_f32_16x16x32_bf16 v[72:75], a[176:179], a[56:59], v[72:75]
s_add_u32 s28, s28, 1024
s_cmp_lt_u32 s28, s6
s_cselect_b32 s28, s28, s4
v_mfma_f32_16x16x32_bf16 v[104:107], a[176:179], a[60:63], v[104:107]
ds_read_b64_tr_b16 a[148:149], v234 offset:32776
v_sub_u32 v139, v139, v140
s_waitcnt lgkmcnt(8)
v_mfma_f32_16x16x32_bf16 v[108:111], a[180:183], a[60:63], v[108:111]
ds_read_b64_tr_b16 a[150:151], v234 offset:36872
v_cndmask_b32 v142, v142, v143, s[90:91]
v_mfma_f32_16x16x32_bf16 v[76:79], a[180:183], a[56:59], v[76:79]
buffer_load_dwordx4 a[112:115], v240, s[20:23], s28 offen sc0 sc1
v_mfma_f32_16x16x32_bf16 v[44:47], a[180:183], a[52:55], v[44:47]
ds_read_b64_tr_b16 a[152:153], v235 offset:32768
s_lshl_b64 s[90:91], s[90:91], 1
v_mfma_f32_16x16x32_bf16 v[12:15], a[180:183], a[48:51], v[12:15]
ds_read_b64_tr_b16 a[154:155], v235 offset:36864
v_max3_u32 v140, v136, v137, v138
v_mfma_f32_16x16x32_bf16 v[16:19], a[184:187], a[48:51], v[16:19]
buffer_load_dwordx4 a[116:119], v241, s[20:23], s28 offen sc0 sc1
v_mfma_f32_16x16x32_bf16 v[48:51], a[184:187], a[52:55], v[48:51]
ds_read_b64_tr_b16 a[156:157], v235 offset:32776
v_max_u32 v140, v140, v139
v_mfma_f32_16x16x32_bf16 v[80:83], a[184:187], a[56:59], v[80:83]
ds_read_b64_tr_b16 a[158:159], v235 offset:36872
v_xor_b32 v189, 5, v187
v_mfma_f32_16x16x32_bf16 v[112:115], a[184:187], a[60:63], v[112:115]
buffer_load_dwordx4 a[120:123], v242, s[20:23], s28 offen sc0 sc1
v_mfma_f32_16x16x32_bf16 v[116:119], a[188:191], a[60:63], v[116:119]
ds_read_b64_tr_b16 a[160:161], v236 offset:32768
v_max_u32_dpp v141, v140, v140 row_ror:8 row_mask:0xf bank_mask:0xf
v_mfma_f32_16x16x32_bf16 v[84:87], a[188:191], a[56:59], v[84:87]
buffer_load_dwordx4 a[124:127], v243, s[20:23], s28 offen sc0 sc1
v_mfma_f32_16x16x32_bf16 v[52:55], a[188:191], a[52:55], v[52:55]
ds_read_b64_tr_b16 a[162:163], v236 offset:36864
v_max_u32_dpp v140, v141, v141 row_ror:4 row_mask:0xf bank_mask:0xf
v_mfma_f32_16x16x32_bf16 v[20:23], a[188:191], a[48:51], v[20:23]
ds_read_b64_tr_b16 a[164:165], v236 offset:32776
v_lshl_add_u32 v225, v189, 5, v188
v_mfma_f32_16x16x32_bf16 v[24:27], a[192:195], a[48:51], v[24:27]
s_add_u32 m0, s49, 139264
v_max_u32_dpp v141, v140, v140 row_ror:2 row_mask:0xf bank_mask:0xf
v_mfma_f32_16x16x32_bf16 v[56:59], a[192:195], a[52:55], v[56:59]
ds_read_b64_tr_b16 a[166:167], v236 offset:36872
v_xor_b32 v189, 6, v187
v_mfma_f32_16x16x32_bf16 v[88:91], a[192:195], a[56:59], v[88:91]
ds_read_b64_tr_b16 a[168:169], v237 offset:32768
v_max_u32_dpp v140, v141, v141 row_ror:1 row_mask:0xf bank_mask:0xf
v_mfma_f32_16x16x32_bf16 v[120:123], a[192:195], a[60:63], v[120:123]
v_mov_b32 v141, v140
v_lshl_add_u32 v226, v189, 5, v188
s_waitcnt lgkmcnt(8)
v_mfma_f32_16x16x32_bf16 v[124:127], a[196:199], a[60:63], v[124:127]
ds_read_b64_tr_b16 a[170:171], v237 offset:36864
v_xor_b32 v189, 7, v187
v_mfma_f32_16x16x32_bf16 v[92:95], a[196:199], a[56:59], v[92:95]
ds_read_b64_tr_b16 a[172:173], v237 offset:32776
v_permlane16_swap_b32 v140, v141
v_mfma_f32_16x16x32_bf16 v[60:63], a[196:199], a[52:55], v[60:63]
buffer_load_dwordx4 v238, s[16:19], s34 offen offset:0 lds
v_mfma_f32_16x16x32_bf16 v[28:31], a[196:199], a[48:51], v[28:31]
ds_read_b64_tr_b16 a[174:175], v237 offset:36872
v_max_u32 v140, v140, v141
v_mfma_f32_16x16x32_bf16 v[32:35], a[200:203], a[48:51], v[32:35]
buffer_load_dwordx4 v239, s[16:19], s34 offen offset:1024 lds
v_mfma_f32_16x16x32_bf16 v[64:67], a[200:203], a[52:55], v[64:67]
v_mov_b32 v141, v140
v_lshl_add_u32 v227, v189, 5, v188
v_mfma_f32_16x16x32_bf16 v[96:99], a[200:203], a[56:59], v[96:99]
s_add_u32 s34, s34, 262144
s_sub_u32 s51, s34, 4718592
s_cselect_b32 s34, s34, s51
v_mfma_f32_16x16x32_bf16 v[128:131], a[200:203], a[60:63], v[128:131]
v_permlane32_swap_b32 v140, v141
v_max_u32 v140, v140, v141
v_mfma_f32_16x16x32_bf16 v[132:135], a[204:207], a[60:63], v[132:135]
v_add_u32 v143, v143, v140
v_sub_u32 v136, v136, v140
v_mfma_f32_16x16x32_bf16 v[100:103], a[204:207], a[56:59], v[100:103]
v_sub_u32 v137, v137, v140
v_sub_u32 v138, v138, v140
v_mfma_f32_16x16x32_bf16 v[68:71], a[204:207], a[52:55], v[68:71]
v_sub_u32 v139, v139, v140
v_cndmask_b32 v142, v142, v143, s[90:91]
v_mfma_f32_16x16x32_bf16 v[36:39], a[204:207], a[48:51], v[36:39]
s_lshl_b64 s[90:91], s[90:91], 1
v_add_u32 v184, 0, v4
s_waitcnt vmcnt(20)
v_mfma_f32_16x16x32_bf16 v[8:11], a[144:147], a[64:67], v[8:11]
ds_read_b64_tr_b16 a[176:177], v234 offset:40960
v_max3_u32 v140, v136, v137, v138
v_mfma_f32_16x16x32_bf16 v[40:43], a[144:147], a[68:71], v[40:43]
ds_read_b64_tr_b16 a[178:179], v234 offset:45056
v_max_u32 v140, v140, v139
v_mfma_f32_16x16x32_bf16 v[72:75], a[144:147], a[72:75], v[72:75]
s_add_u32 s28, s28, 1024
s_cmp_lt_u32 s28, s6
s_cselect_b32 s28, s28, s4
v_mfma_f32_16x16x32_bf16 v[104:107], a[144:147], a[76:79], v[104:107]
ds_read_b64_tr_b16 a[180:181], v234 offset:40968
v_max_u32_dpp v141, v140, v140 row_ror:8 row_mask:0xf bank_mask:0xf
v_mfma_f32_16x16x32_bf16 v[108:111], a[148:151], a[76:79], v[108:111]
ds_read_b64_tr_b16 a[182:183], v234 offset:45064
v_xor_b32 v184, v184, v3
v_mfma_f32_16x16x32_bf16 v[76:79], a[148:151], a[72:75], v[76:79]
buffer_load_dwordx4 a[0:3], v240, s[20:23], s28 offen sc0 sc1
v_mfma_f32_16x16x32_bf16 v[44:47], a[148:151], a[68:71], v[44:47]
ds_read_b64_tr_b16 a[184:185], v235 offset:40960
v_max_u32_dpp v140, v141, v141 row_ror:4 row_mask:0xf bank_mask:0xf
v_mfma_f32_16x16x32_bf16 v[12:15], a[148:151], a[64:67], v[12:15]
ds_read_b64_tr_b16 a[186:187], v235 offset:45056
v_lshlrev_b32 v184, 4, v184
s_waitcnt lgkmcnt(8)
v_mfma_f32_16x16x32_bf16 v[16:19], a[152:155], a[64:67], v[16:19]
buffer_load_dwordx4 a[4:7], v241, s[20:23], s28 offen sc0 sc1
v_mfma_f32_16x16x32_bf16 v[48:51], a[152:155], a[68:71], v[48:51]
ds_read_b64_tr_b16 a[188:189], v235 offset:40968
v_max_u32_dpp v141, v140, v140 row_ror:2 row_mask:0xf bank_mask:0xf
v_mfma_f32_16x16x32_bf16 v[80:83], a[152:155], a[72:75], v[80:83]
ds_read_b64_tr_b16 a[190:191], v235 offset:45064
v_lshl_add_u32 v184, v4, 8, v184
v_mfma_f32_16x16x32_bf16 v[112:115], a[152:155], a[76:79], v[112:115]
buffer_load_dwordx4 a[8:11], v242, s[20:23], s28 offen sc0 sc1
v_mfma_f32_16x16x32_bf16 v[116:119], a[156:159], a[76:79], v[116:119]
ds_read_b64_tr_b16 a[192:193], v236 offset:40960
v_max_u32_dpp v140, v141, v141 row_ror:1 row_mask:0xf bank_mask:0xf
v_mfma_f32_16x16x32_bf16 v[84:87], a[156:159], a[72:75], v[84:87]
buffer_load_dwordx4 a[12:15], v243, s[20:23], s28 offen sc0 sc1
v_mfma_f32_16x16x32_bf16 v[52:55], a[156:159], a[68:71], v[52:55]
ds_read_b64_tr_b16 a[194:195], v236 offset:45056
v_mov_b32 v141, v140
v_mfma_f32_16x16x32_bf16 v[20:23], a[156:159], a[64:67], v[20:23]
ds_read_b64_tr_b16 a[196:197], v236 offset:40968
v_add_u32 v228, s30, v184
v_mfma_f32_16x16x32_bf16 v[24:27], a[160:163], a[64:67], v[24:27]
s_add_u32 m0, s49, 0
v_permlane16_swap_b32 v140, v141
v_mfma_f32_16x16x32_bf16 v[56:59], a[160:163], a[68:71], v[56:59]
ds_read_b64_tr_b16 a[198:199], v236 offset:45064
v_max_u32 v140, v140, v141
v_mfma_f32_16x16x32_bf16 v[88:91], a[160:163], a[72:75], v[88:91]
ds_read_b64_tr_b16 a[200:201], v237 offset:40960
v_mov_b32 v141, v140
v_mfma_f32_16x16x32_bf16 v[120:123], a[160:163], a[76:79], v[120:123]
v_add_u32 v184, 4, v4
v_xor_b32 v184, v184, v3
v_mfma_f32_16x16x32_bf16 v[124:127], a[164:167], a[76:79], v[124:127]
ds_read_b64_tr_b16 a[202:203], v237 offset:45056
v_permlane32_swap_b32 v140, v141
v_mfma_f32_16x16x32_bf16 v[92:95], a[164:167], a[72:75], v[92:95]
ds_read_b64_tr_b16 a[204:205], v237 offset:40968
v_max_u32 v140, v140, v141
v_mfma_f32_16x16x32_bf16 v[60:63], a[164:167], a[68:71], v[60:63]
STUB_1:
STUB_A1:
s_cbranch_execz STUB_4
buffer_load_dwordx4 v238, s[16:19], s34 offen offset:0 lds
v_mfma_f32_16x16x32_bf16 v[28:31], a[164:167], a[64:67], v[28:31]
ds_read_b64_tr_b16 a[206:207], v237 offset:45064
v_add_u32 v143, v143, v140
v_mfma_f32_16x16x32_bf16 v[32:35], a[168:171], a[64:67], v[32:35]
buffer_load_dwordx4 v239, s[16:19], s34 offen offset:1024 lds
v_mfma_f32_16x16x32_bf16 v[64:67], a[168:171], a[68:71], v[64:67]
v_sub_u32 v136, v136, v140
v_sub_u32 v137, v137, v140
v_mfma_f32_16x16x32_bf16 v[96:99], a[168:171], a[72:75], v[96:99]
s_add_u32 s34, s34, 262144
s_sub_u32 s51, s34, 4718592
s_cselect_b32 s34, s34, s51
v_mfma_f32_16x16x32_bf16 v[128:131], a[168:171], a[76:79], v[128:131]
v_sub_u32 v138, v138, v140
v_sub_u32 v139, v139, v140
s_waitcnt lgkmcnt(8)
v_mfma_f32_16x16x32_bf16 v[132:135], a[172:175], a[76:79], v[132:135]
v_cndmask_b32 v142, v142, v143, s[90:91]
v_lshlrev_b32 v184, 4, v184
v_mfma_f32_16x16x32_bf16 v[100:103], a[172:175], a[72:75], v[100:103]
s_lshl_b64 s[90:91], s[90:91], 1
v_lshl_add_u32 v184, v4, 8, v184
v_mfma_f32_16x16x32_bf16 v[68:71], a[172:175], a[68:71], v[68:71]
v_max3_u32 v140, v136, v137, v138
v_max_u32 v140, v140, v139
v_mfma_f32_16x16x32_bf16 v[36:39], a[172:175], a[64:67], v[36:39]
v_add_u32 v229, s30, v184
v_add_u32 v184, 8, v4
s_waitcnt vmcnt(20)
v_mfma_f32_16x16x32_bf16 v[8:11], a[176:179], a[80:83], v[8:11]
v_max_u32_dpp v141, v140, v140 row_ror:8 row_mask:0xf bank_mask:0xf
v_xor_b32 v184, v184, v3
v_mfma_f32_16x16x32_bf16 v[40:43], a[176:179], a[84:87], v[40:43]
s_waitcnt vmcnt(12) lgkmcnt(0)
s_barrier
v_mfma_f32_16x16x32_bf16 v[72:75], a[176:179], a[88:91], v[72:75]
ds_read_b64_tr_b16 a[144:145], v234 offset:49152
v_max_u32_dpp v140, v141, v141 row_ror:4 row_mask:0xf bank_mask:0xf
v_mfma_f32_16x16x32_bf16 v[104:107], a[176:179], a[92:95], v[104:107]
ds_read_b64_tr_b16 a[146:147], v234 offset:53248
v_lshlrev_b32 v184, 4, v184
v_mfma_f32_16x16x32_bf16 v[108:111], a[180:183], a[92:95], v[108:111]
ds_read_b64_tr_b16 a[148:149], v234 offset:49160
v_max_u32_dpp v141, v140, v140 row_ror:2 row_mask:0xf bank_mask:0xf
v_mfma_f32_16x16x32_bf16 v[76:79], a[180:183], a[88:91], v[76:79]
s_add_u32 s28, s28, 1024
s_cmp_lt_u32 s28, s6
s_cselect_b32 s28, s28, s4
v_mfma_f32_16x16x32_bf16 v[44:47], a[180:183], a[84:87], v[44:47]
ds_read_b64_tr_b16 a[150:151], v234 offset:53256
v_max_u32_dpp v140, v141, v141 row_ror:1 row_mask:0xf bank_mask:0xf
v_mfma_f32_16x16x32_bf16 v[12:15], a[180:183], a[80:83], v[12:15]
ds_read_b64_tr_b16 a[152:153], v235 offset:49152
v_mov_b32 v141, v140
v_mfma_f32_16x16x32_bf16 v[16:19], a[184:187], a[80:83], v[16:19]
buffer_load_dwordx4 a[16:19], v240, s[20:23], s28 offen sc0 sc1
v_mfma_f32_16x16x32_bf16 v[48:51], a[184:187], a[84:87], v[48:51]
ds_read_b64_tr_b16 a[154:155], v235 offset:53248
v_permlane16_swap_b32 v140, v141
v_mfma_f32_16x16x32_bf16 v[80:83], a[184:187], a[88:91], v[80:83]
ds_read_b64_tr_b16 a[156:157], v235 offset:49160
v_max_u32 v140, v140, v141
v_mfma_f32_16x16x32_bf16 v[112:115], a[184:187], a[92:95], v[112:115]
buffer_load_dwordx4 a[20:23], v241, s[20:23], s28 offen sc0 sc1
v_mfma_f32_16x16x32_bf16 v[116:119], a[188:191], a[92:95], v[116:119]
ds_read_b64_tr_b16 a[158:159], v235 offset:53256
v_mov_b32 v141, v140
v_mfma_f32_16x16x32_bf16 v[84:87], a[188:191], a[88:91], v[84:87]
ds_read_b64_tr_b16 a[160:161], v236 offset:49152
v_lshl_add_u32 v184, v4, 8, v184
v_mfma_f32_16x16x32_bf16 v[52:55], a[188:191], a[84:87], v[52:55]
ds_read_b64_tr_b16 a[162:163], v236 offset:53248
v_permlane32_swap_b32 v140, v141
v_mfma_f32_16x16x32_bf16 v[20:23], a[188:191], a[80:83], v[20:23]
buffer_load_dwordx4 a[24:27], v242, s[20:23], s28 offen sc0 sc1
v_mfma_f32_16x16x32_bf16 v[24:27], a[192:195], a[80:83], v[24:27]
ds_read_b64_tr_b16 a[164:165], v236 offset:49160
v_max_u32 v140, v140, v141
v_mfma_f32_16x16x32_bf16 v[56:59], a[192:195], a[84:87], v[56:59]
ds_read_b64_tr_b16 a[166:167], v236 offset:53256
v_add_u32 v143, v143, v140
v_mfma_f32_16x16x32_bf16 v[88:91], a[192:195], a[88:91], v[88:91]
buffer_load_dwordx4 a[28:31], v243, s[20:23], s28 offen sc0 sc1
v_mfma_f32_16x16x32_bf16 v[120:123], a[192:195], a[92:95], v[120:123]
ds_read_b64_tr_b16 a[168:169], v237 offset:49152
s_add_u32 m0, s49, 8192
v_mfma_f32_16x16x32_bf16 v[124:127], a[196:199], a[92:95], v[124:127]
ds_read_b64_tr_b16 a[170:171], v237 offset:53248
v_sub_u32 v136, v136, v140
v_mfma_f32_16x16x32_bf16 v[92:95], a[196:199], a[88:91], v[92:95]
buffer_load_dwordx4 v238, s[16:19], s34 offen offset:0 lds
v_mfma_f32_16x16x32_bf16 v[60:63], a[196:199], a[84:87], v[60:63]
ds_read_b64_tr_b16 a[172:173], v237 offset:49160
v_sub_u32 v137, v137, v140
v_mfma_f32_16x16x32_bf16 v[28:31], a[196:199], a[80:83], v[28:31]
ds_read_b64_tr_b16 a[174:175], v237 offset:53256
v_sub_u32 v138, v138, v140
v_mfma_f32_16x16x32_bf16 v[32:35], a[200:203], a[80:83], v[32:35]
buffer_load_dwordx4 v239, s[16:19], s34 offen offset:1024 lds
v_mfma_f32_16x16x32_bf16 v[64:67], a[200:203], a[84:87], v[64:67]
v_sub_u32 v139, v139, v140
v_cndmask_b32 v142, v142, v143, s[90:91]
v_mfma_f32_16x16x32_bf16 v[96:99], a[200:203], a[88:91], v[96:99]
s_add_u32 s34, s34, 262144
s_sub_u32 s51, s34, 4718592
s_cselect_b32 s34, s34, s51
v_mfma_f32_16x16x32_bf16 v[128:131], a[200:203], a[92:95], v[128:131]
s_lshl_b64 s[90:91], s[90:91], 1
v_add_u32 v230, s30, v184
v_mfma_f32_16x16x32_bf16 v[132:135], a[204:207], a[92:95], v[132:135]
v_max3_u32 v140, v136, v137, v138
v_max_u32 v140, v140, v139
v_mfma_f32_16x16x32_bf16 v[100:103], a[204:207], a[88:91], v[100:103]
v_add_u32 v184, 12, v4
v_xor_b32 v184, v184, v3
v_mfma_f32_16x16x32_bf16 v[68:71], a[204:207], a[84:87], v[68:71]
v_max_u32_dpp v141, v140, v140 row_ror:8 row_mask:0xf bank_mask:0xf
v_mov_b32 v192, 0
v_mfma_f32_16x16x32_bf16 v[36:39], a[204:207], a[80:83], v[36:39]
buffer_load_dword v193, v192, s[24:27], 0 offen sc0 sc1
s_waitcnt vmcnt(21)
s_waitcnt lgkmcnt(8)
v_mfma_f32_16x16x32_bf16 v[8:11], a[144:147], a[96:99], v[8:11]
ds_read_b64_tr_b16 a[176:177], v234 offset:57344
v_max_u32_dpp v140, v141, v141 row_ror:4 row_mask:0xf bank_mask:0xf
v_mfma_f32_16x16x32_bf16 v[40:43], a[144:147], a[100:103], v[40:43]
ds_read_b64_tr_b16 a[178:179], v234 offset:61440
v_lshlrev_b32 v184, 4, v184
v_mfma_f32_16x16x32_bf16 v[72:75], a[144:147], a[104:107], v[72:75]
s_add_u32 s28, s28, 1024
s_cmp_lt_u32 s28, s6
s_cselect_b32 s28, s28, s4
v_mfma_f32_16x16x32_bf16 v[104:107], a[144:147], a[108:111], v[104:107]
ds_read_b64_tr_b16 a[180:181], v234 offset:57352
v_max_u32_dpp v141, v140, v140 row_ror:2 row_mask:0xf bank_mask:0xf
v_mfma_f32_16x16x32_bf16 v[108:111], a[148:151], a[108:111], v[108:111]
ds_read_b64_tr_b16 a[182:183], v234 offset:61448
v_lshl_add_u32 v184, v4, 8, v184
v_mfma_f32_16x16x32_bf16 v[76:79], a[148:151], a[104:107], v[76:79]
buffer_load_dwordx4 a[32:35], v240, s[20:23], s28 offen sc0 sc1
v_mfma_f32_16x16x32_bf16 v[44:47], a[148:151], a[100:103], v[44:47]
ds_read_b64_tr_b16 a[184:185], v235 offset:57344
v_max_u32_dpp v140, v141, v141 row_ror:1 row_mask:0xf bank_mask:0xf
v_mfma_f32_16x16x32_bf16 v[12:15], a[148:151], a[96:99], v[12:15]
ds_read_b64_tr_b16 a[186:187], v235 offset:61440
v_mov_b32 v141, v140
v_mfma_f32_16x16x32_bf16 v[16:19], a[152:155], a[96:99], v[16:19]
buffer_load_dwordx4 a[36:39], v241, s[20:23], s28 offen sc0 sc1
v_mfma_f32_16x16x32_bf16 v[48:51], a[152:155], a[100:103], v[48:51]
ds_read_b64_tr_b16 a[188:189], v235 offset:57352
v_permlane16_swap_b32 v140, v141
v_mfma_f32_16x16x32_bf16 v[80:83], a[152:155], a[104:107], v[80:83]
ds_read_b64_tr_b16 a[190:191], v235 offset:61448
v_max_u32 v140, v140, v141
v_mfma_f32_16x16x32_bf16 v[112:115], a[152:155], a[108:111], v[112:115]
buffer_load_dwordx4 a[40:43], v242, s[20:23], s28 offen sc0 sc1
v_mfma_f32_16x16x32_bf16 v[116:119], a[156:159], a[108:111], v[116:119]
ds_read_b64_tr_b16 a[192:193], v236 offset:57344
v_mov_b32 v141, v140
v_mfma_f32_16x16x32_bf16 v[84:87], a[156:159], a[104:107], v[84:87]
buffer_load_dwordx4 a[44:47], v243, s[20:23], s28 offen sc0 sc1
v_mfma_f32_16x16x32_bf16 v[52:55], a[156:159], a[100:103], v[52:55]
ds_read_b64_tr_b16 a[194:195], v236 offset:61440
v_permlane32_swap_b32 v140, v141
v_mfma_f32_16x16x32_bf16 v[20:23], a[156:159], a[96:99], v[20:23]
ds_read_b64_tr_b16 a[196:197], v236 offset:57352
v_max_u32 v140, v140, v141
s_waitcnt lgkmcnt(8)
v_mfma_f32_16x16x32_bf16 v[24:27], a[160:163], a[96:99], v[24:27]
s_add_u32 m0, s49, 16384
v_add_u32 v143, v143, v140
v_mfma_f32_16x16x32_bf16 v[56:59], a[160:163], a[100:103], v[56:59]
ds_read_b64_tr_b16 a[198:199], v236 offset:61448
v_sub_u32 v136, v136, v140
v_mfma_f32_16x16x32_bf16 v[88:91], a[160:163], a[104:107], v[88:91]
ds_read_b64_tr_b16 a[200:201], v237 offset:57344
v_sub_u32 v137, v137, v140
v_mfma_f32_16x16x32_bf16 v[120:123], a[160:163], a[108:111], v[120:123]
v_sub_u32 v138, v138, v140
v_sub_u32 v139, v139, v140
v_mfma_f32_16x16x32_bf16 v[124:127], a[164:167], a[108:111], v[124:127]
ds_read_b64_tr_b16 a[202:203], v237 offset:61440
v_cndmask_b32 v142, v142, v143, s[90:91]
v_mfma_f32_16x16x32_bf16 v[92:95], a[164:167], a[104:107], v[92:95]
ds_read_b64_tr_b16 a[204:205], v237 offset:57352
s_lshl_b64 s[90:91], s[90:91], 1
v_mfma_f32_16x16x32_bf16 v[60:63], a[164:167], a[100:103], v[60:63]
buffer_load_dwordx4 v238, s[16:19], s34 offen offset:0 lds
v_mfma_f32_16x16x32_bf16 v[28:31], a[164:167], a[96:99], v[28:31]
ds_read_b64_tr_b16 a[206:207], v237 offset:61448
v_max3_u32 v140, v136, v137, v138
v_mfma_f32_16x16x32_bf16 v[32:35], a[168:171], a[96:99], v[32:35]
buffer_load_dwordx4 v239, s[16:19], s34 offen offset:1024 lds
v_mfma_f32_16x16x32_bf16 v[64:67], a[168:171], a[100:103], v[64:67]
v_max_u32 v140, v140, v139
v_add_u32 v231, s30, v184
v_mfma_f32_16x16x32_bf16 v[96:99], a[168:171], a[104:107], v[96:99]
s_add_u32 s34, s34, 262144
s_sub_u32 s51, s34, 4718592
s_cselect_b32 s34, s34, s51
v_mfma_f32_16x16x32_bf16 v[128:131], a[168:171], a[108:111], v[128:131]
v_max_u32_dpp v141, v140, v140 row_ror:8 row_mask:0xf bank_mask:0xf
v_add_u32 v184, 0, v4
v_mfma_f32_16x16x32_bf16 v[132:135], a[172:175], a[108:111], v[132:135]
v_lshlrev_b32 v184, 1, v184
v_xor_b32 v184, v184, v3
v_mfma_f32_16x16x32_bf16 v[100:103], a[172:175], a[104:107], v[100:103]
v_max_u32_dpp v140, v141, v141 row_ror:4 row_mask:0xf bank_mask:0xf
v_lshlrev_b32 v184, 4, v184
v_mfma_f32_16x16x32_bf16 v[68:71], a[172:175], a[100:103], v[68:71]
v_lshl_add_u32 v184, v4, 8, v184
v_add_u32 v232, s30, v184
v_mfma_f32_16x16x32_bf16 v[36:39], a[172:175], a[96:99], v[36:39]
v_max_u32_dpp v141, v140, v140 row_ror:2 row_mask:0xf bank_mask:0xf
v_add_u32 v184, 4, v4
s_waitcnt vmcnt(21)
v_mfma_f32_16x16x32_bf16 v[8:11], a[176:179], a[112:115], v[8:11]
v_add_u32 v234, 0x10000, v234
v_add_u32 v235, 0x10000, v235
v_mfma_f32_16x16x32_bf16 v[40:43], a[176:179], a[116:119], v[40:43]
v_add_u32 v236, 0x10000, v236
v_add_u32 v237, 0x10000, v237
v_mfma_f32_16x16x32_bf16 v[72:75], a[176:179], a[120:123], v[72:75]
v_max_u32_dpp v140, v141, v141 row_ror:1 row_mask:0xf bank_mask:0xf
v_mov_b32 v141, v140
v_mfma_f32_16x16x32_bf16 v[104:107], a[176:179], a[124:127], v[104:107]
ds_read_b64_tr_b16 a[144:145], v234 offset:0
v_lshlrev_b32 v184, 1, v184
s_waitcnt lgkmcnt(8)
v_mfma_f32_16x16x32_bf16 v[108:111], a[180:183], a[124:127], v[108:111]
ds_read_b64_tr_b16 a[146:147], v234 offset:4096
v_permlane16_swap_b32 v140, v141
v_mfma_f32_16x16x32_bf16 v[76:79], a[180:183], a[120:123], v[76:79]
ds_read_b64_tr_b16 a[148:149], v234 offset:8
v_max_u32 v140, v140, v141
v_mfma_f32_16x16x32_bf16 v[44:47], a[180:183], a[116:119], v[44:47]
s_add_u32 s28, s28, 1024
s_cmp_lt_u32 s28, s6
s_cselect_b32 s28, s28, s4
v_mfma_f32_16x16x32_bf16 v[12:15], a[180:183], a[112:115], v[12:15]
ds_read_b64_tr_b16 a[150:151], v234 offset:4104
v_mov_b32 v141, v140
v_mfma_f32_16x16x32_bf16 v[16:19], a[184:187], a[112:115], v[16:19]
ds_read_b64_tr_b16 a[152:153], v235 offset:0
v_xor_b32 v184, v184, v3
v_mfma_f32_16x16x32_bf16 v[48:51], a[184:187], a[116:119], v[48:51]
ds_read_b64_tr_b16 a[154:155], v235 offset:4096
v_permlane32_swap_b32 v140, v141
v_mfma_f32_16x16x32_bf16 v[80:83], a[184:187], a[120:123], v[80:83]
buffer_load_dwordx4 a[48:51], v240, s[20:23], s28 offen sc0 sc1
v_mfma_f32_16x16x32_bf16 v[112:115], a[184:187], a[124:127], v[112:115]
ds_read_b64_tr_b16 a[156:157], v235 offset:8
v_max_u32 v140, v140, v141
v_mfma_f32_16x16x32_bf16 v[116:119], a[188:191], a[124:127], v[116:119]
ds_read_b64_tr_b16 a[158:159], v235 offset:4104
v_add_u32 v143, v143, v140
v_mfma_f32_16x16x32_bf16 v[84:87], a[188:191], a[120:123], v[84:87]
buffer_load_dwordx4 a[52:55], v241, s[20:23], s28 offen sc0 sc1
v_mfma_f32_16x16x32_bf16 v[52:55], a[188:191], a[116:119], v[52:55]
ds_read_b64_tr_b16 a[160:161], v236 offset:0
v_sub_u32 v136, v136, v140
v_mfma_f32_16x16x32_bf16 v[20:23], a[188:191], a[112:115], v[20:23]
ds_read_b64_tr_b16 a[162:163], v236 offset:4096
v_sub_u32 v137, v137, v140
s_waitcnt lgkmcnt(8)
v_mfma_f32_16x16x32_bf16 v[24:27], a[192:195], a[112:115], v[24:27]
ds_read_b64_tr_b16 a[164:165], v236 offset:8
v_sub_u32 v138, v138, v140
v_mfma_f32_16x16x32_bf16 v[56:59], a[192:195], a[116:119], v[56:59]
buffer_load_dwordx4 a[56:59], v242, s[20:23], s28 offen sc0 sc1
v_mfma_f32_16x16x32_bf16 v[88:91], a[192:195], a[120:123], v[88:91]
ds_read_b64_tr_b16 a[166:167], v236 offset:4104
v_sub_u32 v139, v139, v140
v_mfma_f32_16x16x32_bf16 v[120:123], a[192:195], a[124:127], v[120:123]
ds_read_b64_tr_b16 a[168:169], v237 offset:0
v_cndmask_b32 v142, v142, v143, s[90:91]
v_mfma_f32_16x16x32_bf16 v[124:127], a[196:199], a[124:127], v[124:127]
ds_read_b64_tr_b16 a[170:171], v237 offset:4096
s_lshl_b64 s[90:91], s[90:91], 1
v_mfma_f32_16x16x32_bf16 v[92:95], a[196:199], a[120:123], v[92:95]
buffer_load_dwordx4 a[60:63], v243, s[20:23], s28 offen sc0 sc1
v_mfma_f32_16x16x32_bf16 v[60:63], a[196:199], a[116:119], v[60:63]
ds_read_b64_tr_b16 a[172:173], v237 offset:8
s_add_u32 m0, s49, 24576
v_mfma_f32_16x16x32_bf16 v[28:31], a[196:199], a[112:115], v[28:31]
ds_read_b64_tr_b16 a[174:175], v237 offset:4104
v_max3_u32 v140, v136, v137, v138
v_mfma_f32_16x16x32_bf16 v[32:35], a[200:203], a[112:115], v[32:35]
buffer_load_dwordx4 v238, s[16:19], s34 offen offset:0 lds
v_mfma_f32_16x16x32_bf16 v[64:67], a[200:203], a[116:119], v[64:67]
buffer_load_dwordx4 v239, s[16:19], s34 offen offset:1024 lds
v_mfma_f32_16x16x32_bf16 v[96:99], a[200:203], a[120:123], v[96:99]
v_max_u32 v140, v140, v139
v_lshlrev_b32 v184, 4, v184
v_mfma_f32_16x16x32_bf16 v[128:131], a[200:203], a[124:127], v[128:131]
s_add_u32 s34, s34, 262144
s_sub_u32 s51, s34, 4718592
s_cselect_b32 s34, s34, s51
v_mfma_f32_16x16x32_bf16 v[132:135], a[204:207], a[124:127], v[132:135]
v_max_u32_dpp v141, v140, v140 row_ror:8 row_mask:0xf bank_mask:0xf
v_lshl_add_u32 v184, v4, 8, v184
v_mfma_f32_16x16x32_bf16 v[100:103], a[204:207], a[120:123], v[100:103]
v_add_u32 v233, s30, v184
v_bfe_u32 v184, v1, 1, 1
v_mfma_f32_16x16x32_bf16 v[68:71], a[204:207], a[116:119], v[68:71]
v_max_u32_dpp v140, v141, v141 row_ror:4 row_mask:0xf bank_mask:0xf
v_lshrrev_b32 v185, 5, v1
v_mfma_f32_16x16x32_bf16 v[36:39], a[204:207], a[112:115], v[36:39]
v_cmp_eq_u32 vcc, v184, v185
v_mov_b32 v186, 0x3f803f80
s_waitcnt vmcnt(21)
v_mfma_f32_16x16x32_bf16 v[8:11], a[144:147], a[0:3], v[8:11]
v_max_u32_dpp v141, v140, v140 row_ror:2 row_mask:0xf bank_mask:0xf
v_mfma_f32_16x16x32_bf16 v[40:43], a[144:147], a[4:7], v[40:43]
s_waitcnt vmcnt(13) lgkmcnt(0)
s_barrier
v_mfma_f32_16x16x32_bf16 v[72:75], a[144:147], a[8:11], v[72:75]
ds_read_b64_tr_b16 a[176:177], v234 offset:8192
v_max_u32_dpp v140, v141, v141 row_ror:1 row_mask:0xf bank_mask:0xf
v_mfma_f32_16x16x32_bf16 v[104:107], a[144:147], a[12:15], v[104:107]
ds_read_b64_tr_b16 a[178:179], v234 offset:12288
v_mov_b32 v141, v140
v_mfma_f32_16x16x32_bf16 v[108:111], a[148:151], a[12:15], v[108:111]
ds_read_b64_tr_b16 a[180:181], v234 offset:8200
v_cndmask_b32 v186, 0, v186, vcc
v_mfma_f32_16x16x32_bf16 v[76:79], a[148:151], a[8:11], v[76:79]
s_add_u32 s28, s28, 1024
s_cmp_lt_u32 s28, s6
s_cselect_b32 s28, s28, s4
v_mfma_f32_16x16x32_bf16 v[44:47], a[148:151], a[4:7], v[44:47]
ds_read_b64_tr_b16 a[182:183], v234 offset:12296
v_permlane16_swap_b32 v140, v141
v_mfma_f32_16x16x32_bf16 v[12:15], a[148:151], a[0:3], v[12:15]
ds_read_b64_tr_b16 a[184:185], v235 offset:8192
v_max_u32 v140, v140, v141
v_mfma_f32_16x16x32_bf16 v[16:19], a[152:155], a[0:3], v[16:19]
buffer_load_dwordx4 a[64:67], v240, s[20:23], s28 offen sc0 sc1
v_mfma_f32_16x16x32_bf16 v[48:51], a[152:155], a[4:7], v[48:51]
ds_read_b64_tr_b16 a[186:187], v235 offset:12288
v_mov_b32 v141, v140
v_mfma_f32_16x16x32_bf16 v[80:83], a[152:155], a[8:11], v[80:83]
ds_read_b64_tr_b16 a[188:189], v235 offset:8200
v_and_b32 v184, 1, v1
v_mfma_f32_16x16x32_bf16 v[112:115], a[152:155], a[12:15], v[112:115]
buffer_load_dwordx4 a[68:71], v241, s[20:23], s28 offen sc0 sc1
v_mfma_f32_16x16x32_bf16 v[116:119], a[156:159], a[12:15], v[116:119]
ds_read_b64_tr_b16 a[190:191], v235 offset:12296
v_permlane32_swap_b32 v140, v141
v_mfma_f32_16x16x32_bf16 v[84:87], a[156:159], a[8:11], v[84:87]
ds_read_b64_tr_b16 a[192:193], v236 offset:8192
v_max_u32 v140, v140, v141
v_mfma_f32_16x16x32_bf16 v[52:55], a[156:159], a[4:7], v[52:55]
ds_read_b64_tr_b16 a[194:195], v236 offset:12288
v_add_u32 v143, v143, v140
v_mfma_f32_16x16x32_bf16 v[20:23], a[156:159], a[0:3], v[20:23]
buffer_load_dwordx4 a[72:75], v242, s[20:23], s28 offen sc0 sc1
v_mfma_f32_16x16x32_bf16 v[24:27], a[160:163], a[0:3], v[24:27]
ds_read_b64_tr_b16 a[196:197], v236 offset:8200
v_cndmask_b32 v142, v142, v143, s[90:91]
v_mfma_f32_16x16x32_bf16 v[56:59], a[160:163], a[4:7], v[56:59]
ds_read_b64_tr_b16 a[198:199], v236 offset:12296
v_cmp_eq_u32 vcc, 1, v184
v_mfma_f32_16x16x32_bf16 v[88:91], a[160:163], a[8:11], v[88:91]
buffer_load_dwordx4 a[76:79], v243, s[20:23], s28 offen sc0 sc1
v_mfma_f32_16x16x32_bf16 v[120:123], a[160:163], a[12:15], v[120:123]
ds_read_b64_tr_b16 a[200:201], v237 offset:8192
s_add_u32 m0, s49, 32768
v_mfma_f32_16x16x32_bf16 v[124:127], a[164:167], a[12:15], v[124:127]
ds_read_b64_tr_b16 a[202:203], v237 offset:12288
v_mov_b32 v184, 0x44444444
v_mfma_f32_16x16x32_bf16 v[92:95], a[164:167], a[8:11], v[92:95]
buffer_load_dwordx4 v238, s[16:19], s34 offen offset:0 lds
v_mfma_f32_16x16x32_bf16 v[60:63], a[164:167], a[4:7], v[60:63]
ds_read_b64_tr_b16 a[204:205], v237 offset:8200
v_mov_b32 v185, 0xeeeeeeee
v_mfma_f32_16x16x32_bf16 v[28:31], a[164:167], a[0:3], v[28:31]
ds_read_b64_tr_b16 a[206:207], v237 offset:12296
v_mfma_f32_16x16x32_bf16 v[32:35], a[168:171], a[0:3], v[32:35]
buffer_load_dwordx4 v239, s[16:19], s34 offen offset:1024 lds
v_mfma_f32_16x16x32_bf16 v[64:67], a[168:171], a[4:7], v[64:67]
v_cndmask_b32 v245, v184, v185, vcc
v_accvgpr_write_b32 a208, v186
v_mfma_f32_16x16x32_bf16 v[96:99], a[168:171], a[8:11], v[96:99]
s_add_u32 s34, s34, 262144
s_sub_u32 s51, s34, 4718592
s_cselect_b32 s34, s34, s51
v_mfma_f32_16x16x32_bf16 v[128:131], a[168:171], a[12:15], v[128:131]
v_accvgpr_write_b32 a209, v186
v_accvgpr_write_b32 a210, v186
v_mfma_f32_16x16x32_bf16 v[132:135], a[172:175], a[12:15], v[132:135]
v_accvgpr_write_b32 a211, v186
v_mfma_f32_16x16x32_bf16 v[100:103], a[172:175], a[8:11], v[100:103]
s_lshl_b32 s92, s36, 9
s_lshr_b32 s93, s35, 2
v_mfma_f32_16x16x32_bf16 v[68:71], a[172:175], a[4:7], v[68:71]
s_and_b32 s94, s35, 3
s_lshl_b32 s95, s93, 6
v_mfma_f32_16x16x32_bf16 v[36:39], a[172:175], a[0:3], v[36:39]
s_add_u32 s95, s95, s92
s_lshl2_add_u32 s95, s94, s95
s_waitcnt vmcnt(21)
s_waitcnt lgkmcnt(8)
v_mfma_f32_16x16x32_bf16 v[8:11], a[176:179], a[16:19], v[8:11]
v_add_u32 v234, 0xfffe0000, v234
v_add_u32 v235, 0xfffe0000, v235
v_mfma_f32_16x16x32_bf16 v[40:43], a[176:179], a[20:23], v[40:43]
v_add_u32 v236, 0xfffe0000, v236
v_add_u32 v237, 0xfffe0000, v237
v_mfma_f32_16x16x32_bf16 v[72:75], a[176:179], a[24:27], v[72:75]
s_add_u32 s95, s95, 0x248000
v_mfma_f32_16x16x32_bf16 v[104:107], a[176:179], a[28:31], v[104:107]
ds_read_b64_tr_b16 a[144:145], v234 offset:0
v_lshlrev_b32 v170, 4, v1
v_mfma_f32_16x16x32_bf16 v[108:111], a[180:183], a[28:31], v[108:111]
ds_read_b64_tr_b16 a[146:147], v234 offset:4096
v_add_u32 v170, s95, v170
v_mfma_f32_16x16x32_bf16 v[76:79], a[180:183], a[24:27], v[76:79]
ds_read_b64_tr_b16 a[148:149], v234 offset:8
s_lshl_b32 s95, s94, 7
v_mfma_f32_16x16x32_bf16 v[44:47], a[180:183], a[20:23], v[44:47]
s_add_u32 s28, s28, 1024
s_cmp_lt_u32 s28, s6
s_cselect_b32 s28, s28, s4
v_mfma_f32_16x16x32_bf16 v[12:15], a[180:183], a[16:19], v[12:15]
ds_read_b64_tr_b16 a[150:151], v234 offset:4104
s_add_u32 s95, s95, s92
v_mfma_f32_16x16x32_bf16 v[16:19], a[184:187], a[16:19], v[16:19]
ds_read_b64_tr_b16 a[152:153], v235 offset:0
s_lshl2_add_u32 s95, s93, s95
v_mfma_f32_16x16x32_bf16 v[48:51], a[184:187], a[20:23], v[48:51]
ds_read_b64_tr_b16 a[154:155], v235 offset:4096
s_add_u32 s95, s95, 0x249f80
v_mfma_f32_16x16x32_bf16 v[80:83], a[184:187], a[24:27], v[80:83]
buffer_load_dwordx4 a[80:83], v240, s[20:23], s28 offen sc0 sc1
v_mfma_f32_16x16x32_bf16 v[112:115], a[184:187], a[28:31], v[112:115]
ds_read_b64_tr_b16 a[156:157], v235 offset:8
v_lshlrev_b32 v184, 5, v1
v_mfma_f32_16x16x32_bf16 v[116:119], a[188:191], a[28:31], v[116:119]
ds_read_b64_tr_b16 a[158:159], v235 offset:4104
v_add_u32 v184, s95, v184
v_mfma_f32_16x16x32_bf16 v[84:87], a[188:191], a[24:27], v[84:87]
buffer_load_dwordx4 a[84:87], v241, s[20:23], s28 offen sc0 sc1
v_mfma_f32_16x16x32_bf16 v[52:55], a[188:191], a[20:23], v[52:55]
ds_read_b64_tr_b16 a[160:161], v236 offset:0
v_cmp_lt_u32 vcc, 3, v1
v_mfma_f32_16x16x32_bf16 v[20:23], a[188:191], a[16:19], v[20:23]
ds_read_b64_tr_b16 a[162:163], v236 offset:4096
s_waitcnt lgkmcnt(8)
v_mfma_f32_16x16x32_bf16 v[24:27], a[192:195], a[16:19], v[24:27]
ds_read_b64_tr_b16 a[164:165], v236 offset:8
v_cndmask_b32 v170, v170, v184, vcc
v_mfma_f32_16x16x32_bf16 v[56:59], a[192:195], a[20:23], v[56:59]
buffer_load_dwordx4 a[88:91], v242, s[20:23], s28 offen sc0 sc1
v_mfma_f32_16x16x32_bf16 v[88:91], a[192:195], a[24:27], v[88:91]
ds_read_b64_tr_b16 a[166:167], v236 offset:4104
s_mov_b32 s95, 0x7fffbff0
v_mfma_f32_16x16x32_bf16 v[120:123], a[192:195], a[28:31], v[120:123]
ds_read_b64_tr_b16 a[168:169], v237 offset:0
v_mfma_f32_16x16x32_bf16 v[124:127], a[196:199], a[28:31], v[124:127]
ds_read_b64_tr_b16 a[170:171], v237 offset:4096
v_mfma_f32_16x16x32_bf16 v[92:95], a[196:199], a[24:27], v[92:95]
buffer_load_dwordx4 a[92:95], v243, s[20:23], s28 offen sc0 sc1
v_mfma_f32_16x16x32_bf16 v[60:63], a[196:199], a[20:23], v[60:63]
ds_read_b64_tr_b16 a[172:173], v237 offset:8
s_add_u32 m0, s49, 40960
v_mfma_f32_16x16x32_bf16 v[28:31], a[196:199], a[16:19], v[28:31]
ds_read_b64_tr_b16 a[174:175], v237 offset:4104
v_mfma_f32_16x16x32_bf16 v[32:35], a[200:203], a[16:19], v[32:35]
buffer_load_dwordx4 v238, s[16:19], s34 offen offset:0 lds
v_mfma_f32_16x16x32_bf16 v[64:67], a[200:203], a[20:23], v[64:67]
buffer_load_dwordx4 v239, s[16:19], s34 offen offset:1024 lds
v_mfma_f32_16x16x32_bf16 v[96:99], a[200:203], a[24:27], v[96:99]
s_cmp_eq_u32 s2, 0
s_cselect_b32 s95, 0x242c00, s95
v_mfma_f32_16x16x32_bf16 v[128:131], a[200:203], a[28:31], v[128:131]
s_add_u32 s34, s34, 262144
s_sub_u32 s51, s34, 4718592
s_cselect_b32 s34, s34, s51
v_mfma_f32_16x16x32_bf16 v[132:135], a[204:207], a[28:31], v[132:135]
v_lshlrev_b32 v184, 7, v1
v_add_u32 v184, s95, v184
v_mfma_f32_16x16x32_bf16 v[100:103], a[204:207], a[24:27], v[100:103]
v_cmp_lt_u32 vcc, 7, v1
v_mfma_f32_16x16x32_bf16 v[68:71], a[204:207], a[20:23], v[68:71]
v_mfma_f32_16x16x32_bf16 v[36:39], a[204:207], a[16:19], v[36:39]
v_cndmask_b32 v170, v170, v184, vcc
v_mov_b32 v184, 0x7ffffff0
s_waitcnt vmcnt(20)
v_mfma_f32_16x16x32_bf16 v[8:11], a[144:147], a[32:35], v[8:11]
ds_read_b64_tr_b16 a[176:177], v234 offset:8192
v_mov_b32 v171, 0
v_mfma_f32_16x16x32_bf16 v[40:43], a[144:147], a[36:39], v[40:43]
ds_read_b64_tr_b16 a[178:179], v234 offset:12288
v_cmp_lt_u32 vcc, 9, v0
v_mfma_f32_16x16x32_bf16 v[72:75], a[144:147], a[40:43], v[72:75]
s_add_u32 s28, s28, 1024
s_cmp_lt_u32 s28, s6
s_cselect_b32 s28, s28, s4
v_mfma_f32_16x16x32_bf16 v[104:107], a[144:147], a[44:47], v[104:107]
ds_read_b64_tr_b16 a[180:181], v234 offset:8200
v_cndmask_b32 v170, v170, v184, vcc
s_waitcnt lgkmcnt(8)
v_mfma_f32_16x16x32_bf16 v[108:111], a[148:151], a[44:47], v[108:111]
ds_read_b64_tr_b16 a[182:183], v234 offset:12296
v_mov_b32 v254, 0x7ffffff0
v_mfma_f32_16x16x32_bf16 v[76:79], a[148:151], a[40:43], v[76:79]
buffer_load_dwordx4 a[96:99], v240, s[20:23], s28 offen sc0 sc1
v_mfma_f32_16x16x32_bf16 v[44:47], a[148:151], a[36:39], v[44:47]
ds_read_b64_tr_b16 a[184:185], v235 offset:8192
s_lshl_b32 s92, s36, 5
v_mfma_f32_16x16x32_bf16 v[12:15], a[148:151], a[32:35], v[12:15]
ds_read_b64_tr_b16 a[186:187], v235 offset:12288
s_add_u32 s92, s92, s35
v_mfma_f32_16x16x32_bf16 v[16:19], a[152:155], a[32:35], v[16:19]
buffer_load_dwordx4 a[100:103], v241, s[20:23], s28 offen sc0 sc1
v_mfma_f32_16x16x32_bf16 v[48:51], a[152:155], a[36:39], v[48:51]
ds_read_b64_tr_b16 a[188:189], v235 offset:8200
v_mfma_f32_16x16x32_bf16 v[80:83], a[152:155], a[40:43], v[80:83]
ds_read_b64_tr_b16 a[190:191], v235 offset:12296
v_mfma_f32_16x16x32_bf16 v[112:115], a[152:155], a[44:47], v[112:115]
buffer_load_dwordx4 a[104:107], v242, s[20:23], s28 offen sc0 sc1
v_mfma_f32_16x16x32_bf16 v[116:119], a[156:159], a[44:47], v[116:119]
ds_read_b64_tr_b16 a[192:193], v236 offset:8192
v_mfma_f32_16x16x32_bf16 v[84:87], a[156:159], a[40:43], v[84:87]
buffer_load_dwordx4 a[108:111], v243, s[20:23], s28 offen sc0 sc1
v_mfma_f32_16x16x32_bf16 v[52:55], a[156:159], a[36:39], v[52:55]
ds_read_b64_tr_b16 a[194:195], v236 offset:12288
v_mfma_f32_16x16x32_bf16 v[20:23], a[156:159], a[32:35], v[20:23]
ds_read_b64_tr_b16 a[196:197], v236 offset:8200
v_mfma_f32_16x16x32_bf16 v[24:27], a[160:163], a[32:35], v[24:27]
s_add_u32 m0, s49, 49152
v_mfma_f32_16x16x32_bf16 v[56:59], a[160:163], a[36:39], v[56:59]
ds_read_b64_tr_b16 a[198:199], v236 offset:12296
v_mfma_f32_16x16x32_bf16 v[88:91], a[160:163], a[40:43], v[88:91]
ds_read_b64_tr_b16 a[200:201], v237 offset:8192
v_mfma_f32_16x16x32_bf16 v[120:123], a[160:163], a[44:47], v[120:123]
s_cmp_eq_u32 s37, 0
s_cselect_b32 s92, s92, 0x7ffffff0
s_waitcnt lgkmcnt(8)
v_mfma_f32_16x16x32_bf16 v[124:127], a[164:167], a[44:47], v[124:127]
ds_read_b64_tr_b16 a[202:203], v237 offset:12288
v_mfma_f32_16x16x32_bf16 v[92:95], a[164:167], a[40:43], v[92:95]
ds_read_b64_tr_b16 a[204:205], v237 offset:8200
v_writelane_b32 v254, s92, 0
v_mfma_f32_16x16x32_bf16 v[60:63], a[164:167], a[36:39], v[60:63]
buffer_load_dwordx4 v238, s[16:19], s34 offen offset:0 lds
v_mfma_f32_16x16x32_bf16 v[28:31], a[164:167], a[32:35], v[28:31]
ds_read_b64_tr_b16 a[206:207], v237 offset:12296
s_or_b32 s92, s38, s46
v_mfma_f32_16x16x32_bf16 v[32:35], a[168:171], a[32:35], v[32:35]
buffer_load_dwordx4 v239, s[16:19], s34 offen offset:1024 lds
v_mfma_f32_16x16x32_bf16 v[64:67], a[168:171], a[36:39], v[64:67]
v_mov_b32 v255, s92
v_add_u32 v184, 0, v0
v_mfma_f32_16x16x32_bf16 v[96:99], a[168:171], a[40:43], v[96:99]
s_add_u32 s34, s34, 262144
s_sub_u32 s51, s34, 4718592
s_cselect_b32 s34, s34, s51
v_mfma_f32_16x16x32_bf16 v[128:131], a[168:171], a[44:47], v[128:131]
v_mul_u32_u24 v185, 911, v184
v_lshrrev_b32 v185, 16, v185
v_mfma_f32_16x16x32_bf16 v[132:135], a[172:175], a[44:47], v[132:135]
v_add_u32 v184, v184, v185
v_lshlrev_b32 v184, 4, v184
v_mfma_f32_16x16x32_bf16 v[100:103], a[172:175], a[40:43], v[100:103]
v_add_u32 v178, 0x24000, v184
v_add_u32 v184, 256, v0
v_mfma_f32_16x16x32_bf16 v[68:71], a[172:175], a[36:39], v[68:71]
v_mul_u32_u24 v185, 911, v184
v_lshrrev_b32 v185, 16, v185
v_mfma_f32_16x16x32_bf16 v[36:39], a[172:175], a[32:35], v[36:39]
v_add_u32 v184, v184, v185
v_lshlrev_b32 v184, 4, v184
s_waitcnt vmcnt(20)
v_mfma_f32_16x16x32_bf16 v[8:11], a[176:179], a[48:51], v[8:11]
v_add_u32 v179, 0x24000, v184
v_add_u32 v184, 512, v0
v_mfma_f32_16x16x32_bf16 v[40:43], a[176:179], a[52:55], v[40:43]
s_waitcnt vmcnt(12) lgkmcnt(0)
s_barrier
v_mfma_f32_16x16x32_bf16 v[72:75], a[176:179], a[56:59], v[72:75]
ds_read_b64_tr_b16 a[144:145], v234 offset:16384
v_mul_u32_u24 v185, 911, v184
v_mfma_f32_16x16x32_bf16 v[104:107], a[176:179], a[60:63], v[104:107]
ds_read_b64_tr_b16 a[146:147], v234 offset:20480
v_lshrrev_b32 v185, 16, v185
v_mfma_f32_16x16x32_bf16 v[108:111], a[180:183], a[60:63], v[108:111]
ds_read_b64_tr_b16 a[148:149], v234 offset:16392
v_add_u32 v184, v184, v185
v_mfma_f32_16x16x32_bf16 v[76:79], a[180:183], a[56:59], v[76:79]
STUB_2:
STUB_A2:
s_cbranch_execz STUB_5
s_add_u32 s28, s28, 1024
s_cmp_lt_u32 s28, s6
s_cselect_b32 s28, s28, s4
v_mfma_f32_16x16x32_bf16 v[44:47], a[180:183], a[52:55], v[44:47]
ds_read_b64_tr_b16 a[150:151], v234 offset:20488
v_lshlrev_b32 v184, 4, v184
v_mfma_f32_16x16x32_bf16 v[12:15], a[180:183], a[48:51], v[12:15]
ds_read_b64_tr_b16 a[152:153], v235 offset:16384
v_add_u32 v180, 0x24000, v184
v_mfma_f32_16x16x32_bf16 v[16:19], a[184:187], a[48:51], v[16:19]
buffer_load_dwordx4 a[112:115], v240, s[20:23], s28 offen sc0 sc1
v_mfma_f32_16x16x32_bf16 v[48:51], a[184:187], a[52:55], v[48:51]
ds_read_b64_tr_b16 a[154:155], v235 offset:20480
v_mfma_f32_16x16x32_bf16 v[80:83], a[184:187], a[56:59], v[80:83]
ds_read_b64_tr_b16 a[156:157], v235 offset:16392
v_mfma_f32_16x16x32_bf16 v[112:115], a[184:187], a[60:63], v[112:115]
buffer_load_dwordx4 a[116:119], v241, s[20:23], s28 offen sc0 sc1
v_mfma_f32_16x16x32_bf16 v[116:119], a[188:191], a[60:63], v[116:119]
ds_read_b64_tr_b16 a[158:159], v235 offset:20488
v_mfma_f32_16x16x32_bf16 v[84:87], a[188:191], a[56:59], v[84:87]
ds_read_b64_tr_b16 a[160:161], v236 offset:16384
v_mfma_f32_16x16x32_bf16 v[52:55], a[188:191], a[52:55], v[52:55]
ds_read_b64_tr_b16 a[162:163], v236 offset:20480
v_mfma_f32_16x16x32_bf16 v[20:23], a[188:191], a[48:51], v[20:23]
buffer_load_dwordx4 a[120:123], v242, s[20:23], s28 offen sc0 sc1
v_mfma_f32_16x16x32_bf16 v[24:27], a[192:195], a[48:51], v[24:27]
ds_read_b64_tr_b16 a[164:165], v236 offset:16392
v_mfma_f32_16x16x32_bf16 v[56:59], a[192:195], a[52:55], v[56:59]
ds_read_b64_tr_b16 a[166:167], v236 offset:20488
v_mfma_f32_16x16x32_bf16 v[88:91], a[192:195], a[56:59], v[88:91]
buffer_load_dwordx4 a[124:127], v243, s[20:23], s28 offen sc0 sc1
v_mfma_f32_16x16x32_bf16 v[120:123], a[192:195], a[60:63], v[120:123]
ds_read_b64_tr_b16 a[168:169], v237 offset:16384
s_add_u32 m0, s49, 57344
v_mfma_f32_16x16x32_bf16 v[124:127], a[196:199], a[60:63], v[124:127]
ds_read_b64_tr_b16 a[170:171], v237 offset:20480
v_mfma_f32_16x16x32_bf16 v[92:95], a[196:199], a[56:59], v[92:95]
buffer_load_dwordx4 v238, s[16:19], s34 offen offset:0 lds
v_mfma_f32_16x16x32_bf16 v[60:63], a[196:199], a[52:55], v[60:63]
ds_read_b64_tr_b16 a[172:173], v237 offset:16392
v_mfma_f32_16x16x32_bf16 v[28:31], a[196:199], a[48:51], v[28:31]
ds_read_b64_tr_b16 a[174:175], v237 offset:20488
v_mfma_f32_16x16x32_bf16 v[32:35], a[200:203], a[48:51], v[32:35]
buffer_load_dwordx4 v239, s[16:19], s34 offen offset:1024 lds
v_mfma_f32_16x16x32_bf16 v[64:67], a[200:203], a[52:55], v[64:67]
s_waitcnt vmcnt(36)
v_readfirstlane_b32 s92, v193
v_mfma_f32_16x16x32_bf16 v[96:99], a[200:203], a[56:59], v[96:99]
s_add_u32 s34, s34, 262144
s_sub_u32 s51, s34, 4718592
s_cselect_b32 s34, s34, s51
v_mfma_f32_16x16x32_bf16 v[128:131], a[200:203], a[60:63], v[128:131]
s_and_b32 s93, s92, 0xf0
s_cbranch_scc0 SP_X0
SP_X0_RET:
v_mfma_f32_16x16x32_bf16 v[132:135], a[204:207], a[60:63], v[132:135]
s_add_u32 s92, s92, s36
s_and_b32 s92, s92, 7
v_mfma_f32_16x16x32_bf16 v[100:103], a[204:207], a[56:59], v[100:103]
s_lshl_b32 s92, s92, 2
s_lshr_b32 s92, 0x63724150, s92
v_mfma_f32_16x16x32_bf16 v[68:71], a[204:207], a[52:55], v[68:71]
s_and_b32 s92, s92, 7
s_lshl_b32 s93, s92, 5
v_mfma_f32_16x16x32_bf16 v[36:39], a[204:207], a[48:51], v[36:39]
s_add_u32 s40, s93, s35
s_lshr_b32 s93, s35, 1
s_waitcnt vmcnt(20)
s_waitcnt lgkmcnt(8)
v_mfma_f32_16x16x32_bf16 v[8:11], a[144:147], a[64:67], v[8:11]
ds_read_b64_tr_b16 a[176:177], v234 offset:24576
s_lshl2_add_u32 s93, s93, s92
v_mfma_f32_16x16x32_bf16 v[40:43], a[144:147], a[68:71], v[40:43]
ds_read_b64_tr_b16 a[178:179], v234 offset:28672
s_and_b32 s94, s35, 1
v_mfma_f32_16x16x32_bf16 v[72:75], a[144:147], a[72:75], v[72:75]
s_add_u32 s28, s28, 1024
s_cmp_lt_u32 s28, s6
s_cselect_b32 s28, s28, s4
v_mfma_f32_16x16x32_bf16 v[104:107], a[144:147], a[76:79], v[104:107]
ds_read_b64_tr_b16 a[180:181], v234 offset:24584
s_lshl1_add_u32 s93, s93, s94
v_mfma_f32_16x16x32_bf16 v[108:111], a[148:151], a[76:79], v[108:111]
ds_read_b64_tr_b16 a[182:183], v234 offset:28680
v_mfma_f32_16x16x32_bf16 v[76:79], a[148:151], a[72:75], v[76:79]
buffer_load_dwordx4 a[0:3], v240, s[20:23], s28 offen sc0 sc1
v_mfma_f32_16x16x32_bf16 v[44:47], a[148:151], a[68:71], v[44:47]
ds_read_b64_tr_b16 a[184:185], v235 offset:24576
v_mfma_f32_16x16x32_bf16 v[12:15], a[148:151], a[64:67], v[12:15]
ds_read_b64_tr_b16 a[186:187], v235 offset:28672
v_mfma_f32_16x16x32_bf16 v[16:19], a[152:155], a[64:67], v[16:19]
buffer_load_dwordx4 a[4:7], v241, s[20:23], s28 offen sc0 sc1
v_mfma_f32_16x16x32_bf16 v[48:51], a[152:155], a[68:71], v[48:51]
ds_read_b64_tr_b16 a[188:189], v235 offset:24584
v_mfma_f32_16x16x32_bf16 v[80:83], a[152:155], a[72:75], v[80:83]
ds_read_b64_tr_b16 a[190:191], v235 offset:28680
v_mfma_f32_16x16x32_bf16 v[112:115], a[152:155], a[76:79], v[112:115]
buffer_load_dwordx4 a[8:11], v242, s[20:23], s28 offen sc0 sc1
v_mfma_f32_16x16x32_bf16 v[116:119], a[156:159], a[76:79], v[116:119]
ds_read_b64_tr_b16 a[192:193], v236 offset:24576
v_mfma_f32_16x16x32_bf16 v[84:87], a[156:159], a[72:75], v[84:87]
buffer_load_dwordx4 a[12:15], v243, s[20:23], s28 offen sc0 sc1
v_mfma_f32_16x16x32_bf16 v[52:55], a[156:159], a[68:71], v[52:55]
ds_read_b64_tr_b16 a[194:195], v236 offset:28672
s_add_u32 s32, s7, 0
v_mfma_f32_16x16x32_bf16 v[20:23], a[156:159], a[64:67], v[20:23]
ds_read_b64_tr_b16 a[196:197], v236 offset:24584
s_waitcnt lgkmcnt(8)
v_mfma_f32_16x16x32_bf16 v[24:27], a[160:163], a[64:67], v[24:27]
s_add_u32 m0, s30, 81920
v_mfma_f32_16x16x32_bf16 v[56:59], a[160:163], a[68:71], v[56:59]
ds_read_b64_tr_b16 a[198:199], v236 offset:28680
v_mfma_f32_16x16x32_bf16 v[88:91], a[160:163], a[72:75], v[88:91]
ds_read_b64_tr_b16 a[200:201], v237 offset:24576
v_mfma_f32_16x16x32_bf16 v[120:123], a[160:163], a[76:79], v[120:123]
buffer_load_dwordx4 v228, s[8:11], s32 offen offset:0  lds
v_mfma_f32_16x16x32_bf16 v[124:127], a[164:167], a[76:79], v[124:127]
ds_read_b64_tr_b16 a[202:203], v237 offset:28672
v_mfma_f32_16x16x32_bf16 v[92:95], a[164:167], a[72:75], v[92:95]
ds_read_b64_tr_b16 a[204:205], v237 offset:24584
v_mfma_f32_16x16x32_bf16 v[60:63], a[164:167], a[68:71], v[60:63]
buffer_load_dwordx4 v229, s[8:11], s32 offen offset:1024  lds
v_mfma_f32_16x16x32_bf16 v[28:31], a[164:167], a[64:67], v[28:31]
ds_read_b64_tr_b16 a[206:207], v237 offset:28680
v_mfma_f32_16x16x32_bf16 v[32:35], a[168:171], a[64:67], v[32:35]
buffer_load_dwordx4 v230, s[8:11], s32 offen offset:2048  lds
v_mfma_f32_16x16x32_bf16 v[64:67], a[168:171], a[68:71], v[64:67]
s_cmp_lt_u32 s92, 4
s_cselect_b32 s40, s93, s40
v_mfma_f32_16x16x32_bf16 v[96:99], a[168:171], a[72:75], v[96:99]
s_mov_b32 s92, s40
s_lshl_b32 s84, s92, 6
v_mfma_f32_16x16x32_bf16 v[128:131], a[168:171], a[76:79], v[128:131]
buffer_load_dwordx4 v231, s[8:11], s32 offen offset:3072  lds
v_mfma_f32_16x16x32_bf16 v[132:135], a[172:175], a[76:79], v[132:135]
s_mul_i32 s93, s37, 147456
s_add_u32 s84, s84, s93
v_mfma_f32_16x16x32_bf16 v[100:103], a[172:175], a[72:75], v[100:103]
s_mul_i32 s85, s92, 36864
s_add_u32 s85, s85, s31
v_mfma_f32_16x16x32_bf16 v[68:71], a[172:175], a[68:71], v[68:71]
s_cmp_lt_u32 s40, 144
s_cselect_b32 s86, s31, 0x30000
s_cselect_b32 s84, s84, 0x40000000
s_cselect_b32 s85, s85, 0x40000000
v_mfma_f32_16x16x32_bf16 v[36:39], a[172:175], a[64:67], v[36:39]
s_waitcnt vmcnt(22)
v_mfma_f32_16x16x32_bf16 v[8:11], a[176:179], a[80:83], v[8:11]
ds_read_b64_tr_b16 a[144:145], v234 offset:32768
v_mfma_f32_16x16x32_bf16 v[40:43], a[176:179], a[84:87], v[40:43]
ds_read_b64_tr_b16 a[146:147], v234 offset:36864
v_mfma_f32_16x16x32_bf16 v[72:75], a[176:179], a[88:91], v[72:75]
s_add_u32 s28, s28, 1024
s_cmp_lt_u32 s28, s6
s_cselect_b32 s28, s28, s4
v_mfma_f32_16x16x32_bf16 v[104:107], a[176:179], a[92:95], v[104:107]
ds_read_b64_tr_b16 a[148:149], v234 offset:32776
s_waitcnt lgkmcnt(8)
v_mfma_f32_16x16x32_bf16 v[108:111], a[180:183], a[92:95], v[108:111]
ds_read_b64_tr_b16 a[150:151], v234 offset:36872
v_mfma_f32_16x16x32_bf16 v[76:79], a[180:183], a[88:91], v[76:79]
v_mfma_f32_16x16x32_bf16 v[44:47], a[180:183], a[84:87], v[44:47]
ds_read_b64_tr_b16 a[152:153], v235 offset:32768
v_mfma_f32_16x16x32_bf16 v[12:15], a[180:183], a[80:83], v[12:15]
ds_read_b64_tr_b16 a[154:155], v235 offset:36864
v_mfma_f32_16x16x32_bf16 v[16:19], a[184:187], a[80:83], v[16:19]
buffer_load_dwordx4 a[16:19], v240, s[20:23], s28 offen sc0 sc1
v_mfma_f32_16x16x32_bf16 v[48:51], a[184:187], a[84:87], v[48:51]
ds_read_b64_tr_b16 a[156:157], v235 offset:32776
v_mfma_f32_16x16x32_bf16 v[80:83], a[184:187], a[88:91], v[80:83]
ds_read_b64_tr_b16 a[158:159], v235 offset:36872
v_mfma_f32_16x16x32_bf16 v[112:115], a[184:187], a[92:95], v[112:115]
v_mfma_f32_16x16x32_bf16 v[116:119], a[188:191], a[92:95], v[116:119]
ds_read_b64_tr_b16 a[160:161], v236 offset:32768
v_mfma_f32_16x16x32_bf16 v[84:87], a[188:191], a[88:91], v[84:87]
buffer_load_dwordx4 a[20:23], v241, s[20:23], s28 offen sc0 sc1
v_mfma_f32_16x16x32_bf16 v[52:55], a[188:191], a[84:87], v[52:55]
ds_read_b64_tr_b16 a[162:163], v236 offset:36864
v_mfma_f32_16x16x32_bf16 v[20:23], a[188:191], a[80:83], v[20:23]
ds_read_b64_tr_b16 a[164:165], v236 offset:32776
v_mfma_f32_16x16x32_bf16 v[24:27], a[192:195], a[80:83], v[24:27]
v_mfma_f32_16x16x32_bf16 v[56:59], a[192:195], a[84:87], v[56:59]
ds_read_b64_tr_b16 a[166:167], v236 offset:36872
v_mfma_f32_16x16x32_bf16 v[88:91], a[192:195], a[88:91], v[88:91]
ds_read_b64_tr_b16 a[168:169], v237 offset:32768
v_mfma_f32_16x16x32_bf16 v[120:123], a[192:195], a[92:95], v[120:123]
buffer_load_dwordx4 a[24:27], v242, s[20:23], s28 offen sc0 sc1
s_waitcnt lgkmcnt(8)
v_mfma_f32_16x16x32_bf16 v[124:127], a[196:199], a[92:95], v[124:127]
ds_read_b64_tr_b16 a[170:171], v237 offset:36864
v_mfma_f32_16x16x32_bf16 v[92:95], a[196:199], a[88:91], v[92:95]
ds_read_b64_tr_b16 a[172:173], v237 offset:32776
v_mfma_f32_16x16x32_bf16 v[60:63], a[196:199], a[84:87], v[60:63]
v_lshlrev_b32 v136, 3, v1
v_mov_b32 v137, 0x7ffffff0
v_mfma_f32_16x16x32_bf16 v[28:31], a[196:199], a[80:83], v[28:31]
ds_read_b64_tr_b16 a[174:175], v237 offset:36872
v_mfma_f32_16x16x32_bf16 v[32:35], a[200:203], a[80:83], v[32:35]
buffer_load_dwordx4 a[28:31], v243, s[20:23], s28 offen sc0 sc1
v_mfma_f32_16x16x32_bf16 v[64:67], a[200:203], a[84:87], v[64:67]
v_cmp_lt_u32 vcc, 7, v1
v_mov_b32 v143, s47
v_mfma_f32_16x16x32_bf16 v[96:99], a[200:203], a[88:91], v[96:99]
v_mfma_f32_16x16x32_bf16 v[128:131], a[200:203], a[92:95], v[128:131]
v_cndmask_b32 v136, v136, v137, vcc
v_mfma_f32_16x16x32_bf16 v[132:135], a[204:207], a[92:95], v[132:135]
s_lshl_b32 s29, s36, 6
s_add_u32 s29, s29, 0x242000
v_mfma_f32_16x16x32_bf16 v[100:103], a[204:207], a[88:91], v[100:103]
s_add_u32 s50, s35, s37
s_cmp_eq_u32 s50, 0
s_cselect_b32 s29, s29, 0x7ffffff0
v_mfma_f32_16x16x32_bf16 v[68:71], a[204:207], a[84:87], v[68:71]
v_mfma_f32_16x16x32_bf16 v[36:39], a[204:207], a[80:83], v[36:39]
s_waitcnt vmcnt(20)
v_mfma_f32_16x16x32_bf16 v[8:11], a[144:147], a[96:99], v[8:11]
v_mfma_f32_16x16x32_bf16 v[40:43], a[144:147], a[100:103], v[40:43]
s_waitcnt vmcnt(12) lgkmcnt(0)
s_barrier
v_mfma_f32_16x16x32_bf16 v[72:75], a[144:147], a[104:107], v[72:75]
ds_read_b64_tr_b16 a[176:177], v234 offset:40960
s_add_u32 s32, s7, 16384
v_mfma_f32_16x16x32_bf16 v[104:107], a[144:147], a[108:111], v[104:107]
ds_read_b64_tr_b16 a[178:179], v234 offset:45056
v_mfma_f32_16x16x32_bf16 v[108:111], a[148:151], a[108:111], v[108:111]
ds_read_b64_tr_b16 a[180:181], v234 offset:40968
v_mfma_f32_16x16x32_bf16 v[76:79], a[148:151], a[104:107], v[76:79]
buffer_store_dwordx2 v[142:143], v136, s[20:23], s29 offen sc0 sc1
v_mfma_f32_16x16x32_bf16 v[44:47], a[148:151], a[100:103], v[44:47]
ds_read_b64_tr_b16 a[182:183], v234 offset:45064
s_add_u32 m0, s30, 114688
v_mfma_f32_16x16x32_bf16 v[12:15], a[148:151], a[96:99], v[12:15]
ds_read_b64_tr_b16 a[184:185], v235 offset:40960
v_mfma_f32_16x16x32_bf16 v[16:19], a[152:155], a[96:99], v[16:19]
buffer_store_dword v171, v170, s[20:23], 0 offen sc0 sc1
v_mfma_f32_16x16x32_bf16 v[48:51], a[152:155], a[100:103], v[48:51]
ds_read_b64_tr_b16 a[186:187], v235 offset:45056
ds_read_b128 v[152:155], v178
v_mfma_f32_16x16x32_bf16 v[80:83], a[152:155], a[104:107], v[80:83]
ds_read_b64_tr_b16 a[188:189], v235 offset:40968
ds_read_b128 v[156:159], v179
v_mfma_f32_16x16x32_bf16 v[112:115], a[152:155], a[108:111], v[112:115]
buffer_load_dwordx4 v228, s[8:11], s32 offen offset:0  lds
v_mfma_f32_16x16x32_bf16 v[116:119], a[156:159], a[108:111], v[116:119]
ds_read_b64_tr_b16 a[190:191], v235 offset:45064
ds_read_b128 v[160:163], v180
v_mfma_f32_16x16x32_bf16 v[84:87], a[156:159], a[104:107], v[84:87]
ds_read_b64_tr_b16 a[192:193], v236 offset:40960
v_mfma_f32_16x16x32_bf16 v[52:55], a[156:159], a[100:103], v[52:55]
ds_read_b64_tr_b16 a[194:195], v236 offset:45056
v_mfma_f32_16x16x32_bf16 v[20:23], a[156:159], a[96:99], v[20:23]
s_mul_i32 s45, s3, 1152
s_add_u32 s45, s45, s31
v_mfma_f32_16x16x32_bf16 v[24:27], a[160:163], a[96:99], v[24:27]
ds_read_b64_tr_b16 a[196:197], v236 offset:40968
s_add_u32 s45, s45, 0x1c00000
v_mfma_f32_16x16x32_bf16 v[56:59], a[160:163], a[100:103], v[56:59]
ds_read_b64_tr_b16 a[198:199], v236 offset:45064
v_mfma_f32_16x16x32_bf16 v[88:91], a[160:163], a[104:107], v[88:91]
buffer_load_dwordx4 v229, s[8:11], s32 offen offset:1024  lds
v_mfma_f32_16x16x32_bf16 v[120:123], a[160:163], a[108:111], v[120:123]
ds_read_b64_tr_b16 a[200:201], v237 offset:40960
v_mfma_f32_16x16x32_bf16 v[124:127], a[164:167], a[108:111], v[124:127]
ds_read_b64_tr_b16 a[202:203], v237 offset:45056
v_mfma_f32_16x16x32_bf16 v[92:95], a[164:167], a[104:107], v[92:95]
buffer_load_dwordx4 v230, s[8:11], s32 offen offset:2048  lds
v_mfma_f32_16x16x32_bf16 v[60:63], a[164:167], a[100:103], v[60:63]
ds_read_b64_tr_b16 a[204:205], v237 offset:40968
v_mfma_f32_16x16x32_bf16 v[28:31], a[164:167], a[96:99], v[28:31]
ds_read_b64_tr_b16 a[206:207], v237 offset:45064
v_mfma_f32_16x16x32_bf16 v[32:35], a[168:171], a[96:99], v[32:35]
s_waitcnt lgkmcnt(8)
buffer_store_dwordx4 v[152:155], v244, s[20:23], s45 offen sc0 sc1
v_mfma_f32_16x16x32_bf16 v[64:67], a[168:171], a[100:103], v[64:67]
buffer_load_dwordx4 v231, s[8:11], s32 offen offset:3072  lds
v_mfma_f32_16x16x32_bf16 v[96:99], a[168:171], a[104:107], v[96:99]
v_mfma_f32_16x16x32_bf16 v[128:131], a[168:171], a[108:111], v[128:131]
v_mfma_f32_16x16x32_bf16 v[132:135], a[172:175], a[108:111], v[132:135]
v_mfma_f32_16x16x32_bf16 v[100:103], a[172:175], a[104:107], v[100:103]
v_mfma_f32_16x16x32_bf16 v[68:71], a[172:175], a[100:103], v[68:71]
s_add_u32 s45, s45, 4096
buffer_store_dwordx4 v[156:159], v244, s[20:23], s45 offen sc0 sc1
v_mfma_f32_16x16x32_bf16 v[36:39], a[172:175], a[96:99], v[36:39]
s_waitcnt vmcnt(22)
v_mfma_f32_16x16x32_bf16 v[8:11], a[176:179], a[112:115], v[8:11]
ds_read_b64_tr_b16 a[144:145], v234 offset:49152
v_mfma_f32_16x16x32_bf16 v[40:43], a[176:179], a[116:119], v[40:43]
ds_read_b64_tr_b16 a[146:147], v234 offset:53248
v_mfma_f32_16x16x32_bf16 v[72:75], a[176:179], a[120:123], v[72:75]
v_mfma_f32_16x16x32_bf16 v[104:107], a[176:179], a[124:127], v[104:107]
ds_read_b64_tr_b16 a[148:149], v234 offset:49160
v_mfma_f32_16x16x32_bf16 v[108:111], a[180:183], a[124:127], v[108:111]
ds_read_b64_tr_b16 a[150:151], v234 offset:53256
v_mfma_f32_16x16x32_bf16 v[76:79], a[180:183], a[120:123], v[76:79]
s_add_u32 s45, s45, 4096
s_cmp_eq_u32 s37, 0
s_cselect_b32 s45, s45, 0x7ffffff0
buffer_store_dwordx4 v[160:163], v244, s[20:23], s45 offen sc0 sc1
v_mfma_f32_16x16x32_bf16 v[44:47], a[180:183], a[116:119], v[44:47]
ds_read_b64_tr_b16 a[152:153], v235 offset:49152
s_mul_i32 s88, s37, 864
v_mfma_f32_16x16x32_bf16 v[12:15], a[180:183], a[112:115], v[12:15]
ds_read_b64_tr_b16 a[154:155], v235 offset:53248
s_mov_b32 s87, s88
v_mfma_f32_16x16x32_bf16 v[16:19], a[184:187], a[112:115], v[16:19]
v_accvgpr_write_b32 a128, 0
v_accvgpr_write_b32 a129, 0
v_mfma_f32_16x16x32_bf16 v[48:51], a[184:187], a[116:119], v[48:51]
ds_read_b64_tr_b16 a[156:157], v235 offset:49160
v_accvgpr_write_b32 a130, 0
v_mfma_f32_16x16x32_bf16 v[80:83], a[184:187], a[120:123], v[80:83]
ds_read_b64_tr_b16 a[158:159], v235 offset:53256
v_accvgpr_write_b32 a131, 0
v_mfma_f32_16x16x32_bf16 v[112:115], a[184:187], a[124:127], v[112:115]
v_accvgpr_write_b32 a132, 0
v_accvgpr_write_b32 a133, 0
v_mfma_f32_16x16x32_bf16 v[116:119], a[188:191], a[124:127], v[116:119]
ds_read_b64_tr_b16 a[160:161], v236 offset:49152
v_accvgpr_write_b32 a134, 0
v_mfma_f32_16x16x32_bf16 v[84:87], a[188:191], a[120:123], v[84:87]
v_accvgpr_write_b32 a135, 0
v_lshrrev_b32 v240, 2, v1
v_mfma_f32_16x16x32_bf16 v[52:55], a[188:191], a[116:119], v[52:55]
ds_read_b64_tr_b16 a[162:163], v236 offset:53248
v_mul_u32_u24 v240, 0x2400, v240
v_mfma_f32_16x16x32_bf16 v[20:23], a[188:191], a[112:115], v[20:23]
ds_read_b64_tr_b16 a[164:165], v236 offset:49160
v_and_b32 v246, 3, v1
s_waitcnt lgkmcnt(8)
v_mfma_f32_16x16x32_bf16 v[24:27], a[192:195], a[112:115], v[24:27]
v_lshl_add_u32 v240, v246, 4, v240
v_mul_u32_u24 v243, 3641, v1
v_mfma_f32_16x16x32_bf16 v[56:59], a[192:195], a[116:119], v[56:59]
ds_read_b64_tr_b16 a[166:167], v236 offset:53256
v_lshrrev_b32 v243, 16, v243
v_mfma_f32_16x16x32_bf16 v[88:91], a[192:195], a[120:123], v[88:91]
ds_read_b64_tr_b16 a[168:169], v237 offset:49152
v_mul_u32_u24 v243, 864, v243
v_mfma_f32_16x16x32_bf16 v[120:123], a[192:195], a[124:127], v[120:123]
v_add_u32 v243, v243, v244
v_mfma_f32_16x16x32_bf16 v[124:127], a[196:199], a[124:127], v[124:127]
ds_read_b64_tr_b16 a[170:171], v237 offset:53248
s_sub_u32 s92, s40, 0
v_mfma_f32_16x16x32_bf16 v[92:95], a[196:199], a[120:123], v[92:95]
ds_read_b64_tr_b16 a[172:173], v237 offset:49160
v_mfma_f32_16x16x32_bf16 v[60:63], a[196:199], a[116:119], v[60:63]
s_cmp_lt_u32 s92, 72
s_cselect_b32 s3, 4, 0
v_mfma_f32_16x16x32_bf16 v[28:31], a[196:199], a[112:115], v[28:31]
ds_read_b64_tr_b16 a[174:175], v237 offset:53256
v_mfma_f32_16x16x32_bf16 v[32:35], a[200:203], a[112:115], v[32:35]
s_cmp_lt_u32 s40, 144
s_cselect_b32 s3, 5, s3
v_mfma_f32_16x16x32_bf16 v[64:67], a[200:203], a[116:119], v[64:67]
s_lshr_b32 s92, s35, 2
s_mul_i32 s89, s92, 589824
v_mfma_f32_16x16x32_bf16 v[96:99], a[200:203], a[120:123], v[96:99]
s_and_b32 s92, s35, 3
s_mul_i32 s92, s92, 288
v_mfma_f32_16x16x32_bf16 v[128:131], a[200:203], a[124:127], v[128:131]
s_add_u32 s89, s89, s92
v_mfma_f32_16x16x32_bf16 v[132:135], a[204:207], a[124:127], v[132:135]
v_mfma_f32_16x16x32_bf16 v[100:103], a[204:207], a[120:123], v[100:103]
v_mfma_f32_16x16x32_bf16 v[68:71], a[204:207], a[116:119], v[68:71]
v_mfma_f32_16x16x32_bf16 v[36:39], a[204:207], a[112:115], v[36:39]
s_waitcnt vmcnt(17)
v_mfma_f32_16x16x32_bf16 v[8:11], a[144:147], a[0:3], v[8:11]
ds_read_b64_tr_b16 a[176:177], v234 offset:57344
s_add_u32 s39, s7, 0
v_mfma_f32_16x16x32_bf16 v[40:43], a[144:147], a[4:7], v[40:43]
ds_read_b64_tr_b16 a[178:179], v234 offset:61440
v_mfma_f32_16x16x32_bf16 v[72:75], a[144:147], a[8:11], v[72:75]
v_mfma_f32_16x16x32_bf16 v[104:107], a[144:147], a[12:15], v[104:107]
ds_read_b64_tr_b16 a[180:181], v234 offset:57352
s_waitcnt lgkmcnt(8)
v_mfma_f32_16x16x32_bf16 v[108:111], a[148:151], a[12:15], v[108:111]
ds_read_b64_tr_b16 a[182:183], v234 offset:61448
v_mfma_f32_16x16x32_bf16 v[76:79], a[148:151], a[8:11], v[76:79]
s_add_u32 m0, s30, 131072
v_mfma_f32_16x16x32_bf16 v[44:47], a[148:151], a[4:7], v[44:47]
ds_read_b64_tr_b16 a[184:185], v235 offset:57344
v_mfma_f32_16x16x32_bf16 v[12:15], a[148:151], a[0:3], v[12:15]
ds_read_b64_tr_b16 a[186:187], v235 offset:61440
v_mfma_f32_16x16x32_bf16 v[16:19], a[152:155], a[0:3], v[16:19]
v_mfma_f32_16x16x32_bf16 v[48:51], a[152:155], a[4:7], v[48:51]
ds_read_b64_tr_b16 a[188:189], v235 offset:57352
v_mfma_f32_16x16x32_bf16 v[80:83], a[152:155], a[8:11], v[80:83]
ds_read_b64_tr_b16 a[190:191], v235 offset:61448
v_mfma_f32_16x16x32_bf16 v[112:115], a[152:155], a[12:15], v[112:115]
buffer_load_dwordx4 v232, s[12:15], s39 offen offset:0  lds
v_mfma_f32_16x16x32_bf16 v[116:119], a[156:159], a[12:15], v[116:119]
ds_read_b64_tr_b16 a[192:193], v236 offset:57344
v_mfma_f32_16x16x32_bf16 v[84:87], a[156:159], a[8:11], v[84:87]
v_mfma_f32_16x16x32_bf16 v[52:55], a[156:159], a[4:7], v[52:55]
ds_read_b64_tr_b16 a[194:195], v236 offset:61440
v_mfma_f32_16x16x32_bf16 v[20:23], a[156:159], a[0:3], v[20:23]
ds_read_b64_tr_b16 a[196:197], v236 offset:57352
v_mfma_f32_16x16x32_bf16 v[24:27], a[160:163], a[0:3], v[24:27]
buffer_load_dwordx4 v233, s[12:15], s39 offen offset:1024  lds
v_mfma_f32_16x16x32_bf16 v[56:59], a[160:163], a[4:7], v[56:59]
ds_read_b64_tr_b16 a[198:199], v236 offset:61448
v_mfma_f32_16x16x32_bf16 v[88:91], a[160:163], a[8:11], v[88:91]
ds_read_b64_tr_b16 a[200:201], v237 offset:57344
v_mfma_f32_16x16x32_bf16 v[120:123], a[160:163], a[12:15], v[120:123]
s_waitcnt lgkmcnt(8)
v_mfma_f32_16x16x32_bf16 v[124:127], a[164:167], a[12:15], v[124:127]
ds_read_b64_tr_b16 a[202:203], v237 offset:61440
v_mfma_f32_16x16x32_bf16 v[92:95], a[164:167], a[8:11], v[92:95]
ds_read_b64_tr_b16 a[204:205], v237 offset:57352
v_mfma_f32_16x16x32_bf16 v[60:63], a[164:167], a[4:7], v[60:63]
buffer_load_dwordx4 v232, s[12:15], s39 offen offset:2048  lds
v_mfma_f32_16x16x32_bf16 v[28:31], a[164:167], a[0:3], v[28:31]
ds_read_b64_tr_b16 a[206:207], v237 offset:61448
v_mfma_f32_16x16x32_bf16 v[32:35], a[168:171], a[0:3], v[32:35]
v_mfma_f32_16x16x32_bf16 v[64:67], a[168:171], a[4:7], v[64:67]
buffer_load_dwordx4 v233, s[12:15], s39 offen offset:3072  lds
v_mfma_f32_16x16x32_bf16 v[96:99], a[168:171], a[8:11], v[96:99]
v_mfma_f32_16x16x32_bf16 v[128:131], a[168:171], a[12:15], v[128:131]
v_mfma_f32_16x16x32_bf16 v[132:135], a[172:175], a[12:15], v[132:135]
v_mfma_f32_16x16x32_bf16 v[100:103], a[172:175], a[8:11], v[100:103]
v_mfma_f32_16x16x32_bf16 v[68:71], a[172:175], a[4:7], v[68:71]
v_mfma_f32_16x16x32_bf16 v[36:39], a[172:175], a[0:3], v[36:39]
s_waitcnt vmcnt(13)
v_mfma_f32_16x16x32_bf16 v[8:11], a[176:179], a[16:19], v[8:11]
v_mfma_f32_16x16x32_bf16 v[12:15], a[180:183], a[16:19], v[12:15]
s_waitcnt vmcnt(17) lgkmcnt(0)
s_barrier
v_mfma_f32_16x16x32_bf16 v[16:19], a[184:187], a[16:19], v[16:19]
ds_read_b128 a[144:147], v216 offset:16384
ds_read_b128 a[148:151], v217 offset:16384
v_mfma_f32_16x16x32_bf16 v[20:23], a[188:191], a[16:19], v[20:23]
ds_read_b128 a[152:155], v218 offset:16384
ds_read_b128 a[156:159], v219 offset:16384
v_mfma_f32_16x16x32_bf16 v[24:27], a[192:195], a[16:19], v[24:27]
ds_read_b128 a[160:163], v216 offset:20480
ds_read_b128 a[164:167], v217 offset:20480
v_mfma_f32_16x16x32_bf16 v[28:31], a[196:199], a[16:19], v[28:31]
ds_read_b128 a[168:171], v218 offset:20480
ds_read_b128 a[172:175], v219 offset:20480
v_mfma_f32_16x16x32_bf16 v[32:35], a[200:203], a[16:19], v[32:35]
s_add_u32 s32, s7, 32768
v_mfma_f32_16x16x32_bf16 v[36:39], a[204:207], a[16:19], v[36:39]
s_add_u32 m0, s30, 65536
v_mfma_f32_16x16x32_bf16 v[40:43], a[176:179], a[20:23], v[40:43]
v_cvt_pk_bf16_f32 v152, v8, v9
v_cvt_pk_bf16_f32 v153, v10, v11
v_mfma_f32_16x16x32_bf16 v[44:47], a[180:183], a[20:23], v[44:47]
v_cvt_pk_bf16_f32 v154, v12, v13
v_cvt_pk_bf16_f32 v155, v14, v15
v_mfma_f32_16x16x32_bf16 v[48:51], a[184:187], a[20:23], v[48:51]
v_cvt_pk_bf16_f32 v156, v16, v17
v_cvt_pk_bf16_f32 v157, v18, v19
v_mfma_f32_16x16x32_bf16 v[52:55], a[188:191], a[20:23], v[52:55]
v_cvt_pk_bf16_f32 v158, v20, v21
v_cvt_pk_bf16_f32 v159, v22, v23
v_mfma_f32_16x16x32_bf16 v[56:59], a[192:195], a[20:23], v[56:59]
v_cvt_pk_bf16_f32 v160, v24, v25
v_cvt_pk_bf16_f32 v161, v26, v27
v_mfma_f32_16x16x32_bf16 v[60:63], a[196:199], a[20:23], v[60:63]
v_cvt_pk_bf16_f32 v162, v28, v29
v_cvt_pk_bf16_f32 v163, v30, v31
v_mfma_f32_16x16x32_bf16 v[64:67], a[200:203], a[20:23], v[64:67]
v_cvt_pk_bf16_f32 v164, v32, v33
v_cvt_pk_bf16_f32 v165, v34, v35
v_mfma_f32_16x16x32_bf16 v[68:71], a[204:207], a[20:23], v[68:71]
v_cvt_pk_bf16_f32 v166, v36, v37
v_cvt_pk_bf16_f32 v167, v38, v39
v_mfma_f32_16x16x32_bf16 v[72:75], a[176:179], a[24:27], v[72:75]
v_cvt_pk_bf16_f32 v168, v40, v41
v_cvt_pk_bf16_f32 v169, v42, v43
v_mfma_f32_16x16x32_bf16 v[76:79], a[180:183], a[24:27], v[76:79]
v_cvt_pk_bf16_f32 v170, v44, v45
v_cvt_pk_bf16_f32 v171, v46, v47
v_mfma_f32_16x16x32_bf16 v[80:83], a[184:187], a[24:27], v[80:83]
v_cvt_pk_bf16_f32 v172, v48, v49
v_cvt_pk_bf16_f32 v173, v50, v51
v_mfma_f32_16x16x32_bf16 v[84:87], a[188:191], a[24:27], v[84:87]
v_cvt_pk_bf16_f32 v174, v52, v53
v_cvt_pk_bf16_f32 v175, v54, v55
v_mfma_f32_16x16x32_bf16 v[88:91], a[192:195], a[24:27], v[88:91]
v_cvt_pk_bf16_f32 v176, v56, v57
v_cvt_pk_bf16_f32 v177, v58, v59
v_mfma_f32_16x16x32_bf16 v[92:95], a[196:199], a[24:27], v[92:95]
v_cvt_pk_bf16_f32 v178, v60, v61
v_cvt_pk_bf16_f32 v179, v62, v63
v_mfma_f32_16x16x32_bf16 v[96:99], a[200:203], a[24:27], v[96:99]
v_cvt_pk_bf16_f32 v180, v64, v65
v_cvt_pk_bf16_f32 v181, v66, v67
v_mfma_f32_16x16x32_bf16 v[100:103], a[204:207], a[24:27], v[100:103]
v_cvt_pk_bf16_f32 v182, v68, v69
v_cvt_pk_bf16_f32 v183, v70, v71
v_mfma_f32_16x16x32_bf16 v[104:107], a[176:179], a[28:31], v[104:107]
v_cvt_pk_bf16_f32 v184, v72, v73
v_cvt_pk_bf16_f32 v185, v74, v75
v_mfma_f32_16x16x32_bf16 v[108:111], a[180:183], a[28:31], v[108:111]
v_cvt_pk_bf16_f32 v186, v76, v77
v_cvt_pk_bf16_f32 v187, v78, v79
v_mfma_f32_16x16x32_bf16 v[112:115], a[184:187], a[28:31], v[112:115]
v_cvt_pk_bf16_f32 v188, v80, v81
v_cvt_pk_bf16_f32 v189, v82, v83
v_mfma_f32_16x16x32_bf16 v[116:119], a[188:191], a[28:31], v[116:119]
v_cvt_pk_bf16_f32 v190, v84, v85
v_cvt_pk_bf16_f32 v191, v86, v87
v_mfma_f32_16x16x32_bf16 v[120:123], a[192:195], a[28:31], v[120:123]
v_cvt_pk_bf16_f32 v192, v88, v89
v_cvt_pk_bf16_f32 v193, v90, v91
v_mfma_f32_16x16x32_bf16 v[124:127], a[196:199], a[28:31], v[124:127]
v_cvt_pk_bf16_f32 v194, v92, v93
v_cvt_pk_bf16_f32 v195, v94, v95
v_mfma_f32_16x16x32_bf16 v[128:131], a[200:203], a[28:31], v[128:131]
v_cvt_pk_bf16_f32 v196, v96, v97
v_cvt_pk_bf16_f32 v197, v98, v99
v_mfma_f32_16x16x32_bf16 v[132:135], a[204:207], a[28:31], v[132:135]
v_cvt_pk_bf16_f32 v198, v100, v101
v_cvt_pk_bf16_f32 v199, v102, v103
s_waitcnt lgkmcnt(7)
v_mfma_f32_16x16x32_bf16 v[8:11], a[144:147], v[152:155], 0
v_cvt_pk_bf16_f32 v200, v104, v105
v_cvt_pk_bf16_f32 v201, v106, v107
s_waitcnt lgkmcnt(6)
v_mfma_f32_16x16x32_bf16 v[8:11], a[148:151], v[156:159], v[8:11]
v_cvt_pk_bf16_f32 v202, v108, v109
v_cvt_pk_bf16_f32 v203, v110, v111
s_waitcnt lgkmcnt(5)
v_mfma_f32_16x16x32_bf16 v[8:11], a[152:155], v[160:163], v[8:11]
v_cvt_pk_bf16_f32 v204, v112, v113
v_cvt_pk_bf16_f32 v205, v114, v115
s_waitcnt lgkmcnt(4)
v_mfma_f32_16x16x32_bf16 v[8:11], a[156:159], v[164:167], v[8:11]
v_cvt_pk_bf16_f32 v206, v116, v117
v_cvt_pk_bf16_f32 v207, v118, v119
s_waitcnt lgkmcnt(3)
v_mfma_f32_16x16x32_bf16 v[12:15], a[160:163], v[152:155], 0
v_cvt_pk_bf16_f32 v208, v120, v121
v_cvt_pk_bf16_f32 v209, v122, v123
s_waitcnt lgkmcnt(2)
v_mfma_f32_16x16x32_bf16 v[12:15], a[164:167], v[156:159], v[12:15]
v_cvt_pk_bf16_f32 v210, v124, v125
v_cvt_pk_bf16_f32 v211, v126, v127
s_waitcnt lgkmcnt(1)
v_mfma_f32_16x16x32_bf16 v[12:15], a[168:171], v[160:163], v[12:15]
v_cvt_pk_bf16_f32 v212, v128, v129
v_cvt_pk_bf16_f32 v213, v130, v131
s_waitcnt lgkmcnt(0)
v_mfma_f32_16x16x32_bf16 v[12:15], a[172:175], v[164:167], v[12:15]
v_cvt_pk_bf16_f32 v214, v132, v133
v_cvt_pk_bf16_f32 v215, v134, v135
v_mfma_f32_16x16x32_bf16 v[16:19], a[144:147], v[168:171], 0
buffer_load_dwordx4 v228, s[8:11], s32 offen offset:0  lds
v_mfma_f32_16x16x32_bf16 v[16:19], a[148:151], v[172:175], v[16:19]
buffer_load_dwordx4 v229, s[8:11], s32 offen offset:1024  lds
STUB_3:
STUB_A3:
s_cbranch_execz STUB_6
v_mfma_f32_16x16x32_bf16 v[16:19], a[152:155], v[176:179], v[16:19]
buffer_load_dwordx4 v230, s[8:11], s32 offen offset:2048  lds
v_mfma_f32_16x16x32_bf16 v[16:19], a[156:159], v[180:183], v[16:19]
buffer_load_dwordx4 v231, s[8:11], s32 offen offset:3072  lds
v_max3_f32 v248, v8, v9, v10
v_mfma_f32_16x16x32_bf16 v[20:23], a[160:163], v[168:171], 0
s_add_u32 s39, s7, 16384
s_add_u32 m0, s30, 147456
v_mfma_f32_16x16x32_bf16 v[20:23], a[164:167], v[172:175], v[20:23]
buffer_load_dwordx4 v232, s[12:15], s39 offen offset:0  lds
v_mfma_f32_16x16x32_bf16 v[20:23], a[168:171], v[176:179], v[20:23]
buffer_load_dwordx4 v233, s[12:15], s39 offen offset:1024  lds
v_mfma_f32_16x16x32_bf16 v[20:23], a[172:175], v[180:183], v[20:23]
v_max3_f32 v248, v248, v11, v12
v_max3_f32 v248, v248, v13, v14
v_mfma_f32_16x16x32_bf16 v[24:27], a[144:147], v[184:187], 0
v_max_f32 v248, v248, v15
v_mov_b32 v249, v248
v_mfma_f32_16x16x32_bf16 v[24:27], a[148:151], v[188:191], v[24:27]
s_nop 0
v_permlane16_swap_b32 v248, v249
v_mfma_f32_16x16x32_bf16 v[24:27], a[152:155], v[192:195], v[24:27]
v_max_f32 v248, v248, v249
v_mov_b32 v249, v248
v_mfma_f32_16x16x32_bf16 v[24:27], a[156:159], v[196:199], v[24:27]
s_nop 0
v_permlane32_swap_b32 v248, v249
v_mfma_f32_16x16x32_bf16 v[28:31], a[160:163], v[184:187], 0
v_max_f32 v248, v248, v249
v_sub_f32 v136, 0, v248
v_sub_f32 v137, 0, v248
v_mfma_f32_16x16x32_bf16 v[28:31], a[164:167], v[188:191], v[28:31]
v_sub_f32 v138, 0, v248
v_sub_f32 v139, 0, v248
v_sub_f32 v8, v8, v248
v_mfma_f32_16x16x32_bf16 v[28:31], a[168:171], v[192:195], v[28:31]
v_sub_f32 v9, v9, v248
v_sub_f32 v10, v10, v248
v_sub_f32 v11, v11, v248
v_mfma_f32_16x16x32_bf16 v[28:31], a[172:175], v[196:199], v[28:31]
v_sub_f32 v12, v12, v248
v_sub_f32 v13, v13, v248
v_sub_f32 v14, v14, v248
v_mfma_f32_16x16x32_bf16 v[32:35], a[144:147], v[200:203], 0
v_sub_f32 v15, v15, v248
v_max3_f32 v250, v16, v17, v18
v_max3_f32 v250, v250, v19, v20
v_mfma_f32_16x16x32_bf16 v[32:35], a[148:151], v[204:207], v[32:35]
v_max3_f32 v250, v250, v21, v22
v_max_f32 v250, v250, v23
v_mov_b32 v251, v250
v_mfma_f32_16x16x32_bf16 v[32:35], a[152:155], v[208:211], v[32:35]
s_nop 0
v_permlane16_swap_b32 v250, v251
v_max_f32 v250, v250, v251
v_mfma_f32_16x16x32_bf16 v[32:35], a[156:159], v[212:215], v[32:35]
v_mov_b32 v251, v250
s_nop 1
v_permlane32_swap_b32 v250, v251
v_mfma_f32_16x16x32_bf16 v[36:39], a[160:163], v[200:203], 0
v_max_f32 v250, v250, v251
v_sub_f32 v140, 0, v250
v_sub_f32 v141, 0, v250
v_mfma_f32_16x16x32_bf16 v[36:39], a[164:167], v[204:207], v[36:39]
v_sub_f32 v142, 0, v250
v_sub_f32 v143, 0, v250
v_sub_f32 v16, v16, v250
v_mfma_f32_16x16x32_bf16 v[36:39], a[168:171], v[208:211], v[36:39]
v_sub_f32 v17, v17, v250
v_sub_f32 v18, v18, v250
v_sub_f32 v19, v19, v250
v_mfma_f32_16x16x32_bf16 v[36:39], a[172:175], v[212:215], v[36:39]
v_sub_f32 v20, v20, v250
v_sub_f32 v21, v21, v250
v_sub_f32 v22, v22, v250
ds_read_b128 a[144:147], v216 offset:24576
ds_read_b128 a[148:151], v217 offset:24576
ds_read_b128 a[152:155], v218 offset:24576
ds_read_b128 a[156:159], v219 offset:24576
ds_read_b128 a[160:163], v216 offset:28672
ds_read_b128 a[164:167], v217 offset:28672
ds_read_b128 a[168:171], v218 offset:28672
ds_read_b128 a[172:175], v219 offset:28672
buffer_load_dwordx4 v232, s[12:15], s39 offen offset:2048  lds
buffer_load_dwordx4 v233, s[12:15], s39 offen offset:3072  lds
s_add_u32 s32, s7, 32768
s_add_u32 s39, s7, 16384
v_sub_f32 v23, v23, v250
v_max3_f32 v248, v24, v25, v26
v_max3_f32 v248, v248, v27, v28
v_max3_f32 v248, v248, v29, v30
v_max_f32 v248, v248, v31
s_nop 3
v_max3_f32 v250, v32, v33, v34
v_max3_f32 v250, v250, v35, v36
v_max3_f32 v250, v250, v37, v38
v_max_f32 v250, v250, v39
v_mov_b32 v249, v248
v_mov_b32 v251, v250
s_nop 0
v_permlane16_swap_b32 v248, v249
v_permlane16_swap_b32 v250, v251
v_max_f32 v248, v248, v249
v_max_f32 v250, v250, v251
v_mov_b32 v249, v248
v_mov_b32 v251, v250
s_nop 0
v_permlane32_swap_b32 v248, v249
v_permlane32_swap_b32 v250, v251
v_max_f32 v248, v248, v249
v_max_f32 v250, v250, v251
v_sub_f32 v144, 0, v248
v_sub_f32 v148, 0, v250
v_sub_f32 v145, 0, v248
v_sub_f32 v149, 0, v250
v_sub_f32 v146, 0, v248
v_sub_f32 v150, 0, v250
v_sub_f32 v147, 0, v248
v_sub_f32 v151, 0, v250
v_sub_f32 v24, v24, v248
v_sub_f32 v32, v32, v250
v_sub_f32 v25, v25, v248
v_sub_f32 v33, v33, v250
v_sub_f32 v26, v26, v248
v_sub_f32 v34, v34, v250
v_sub_f32 v27, v27, v248
v_sub_f32 v35, v35, v250
v_sub_f32 v28, v28, v248
v_sub_f32 v36, v36, v250
v_sub_f32 v29, v29, v248
v_sub_f32 v37, v37, v250
v_sub_f32 v30, v30, v248
v_sub_f32 v38, v38, v250
v_sub_f32 v31, v31, v248
v_sub_f32 v39, v39, v250
K_BODY0:
s_waitcnt lgkmcnt(7)
v_mfma_f32_16x16x32_bf16 v[40:43], a[144:147], v[152:155], v[136:139]
v_exp_f32 v8, v8
v_exp_f32 v9, v9
s_waitcnt lgkmcnt(6)
v_mfma_f32_16x16x32_bf16 v[40:43], a[148:151], v[156:159], v[40:43]
v_cvt_pk_bf16_f32 v72, v8, v9
v_exp_f32 v10, v10
s_waitcnt lgkmcnt(5)
v_mfma_f32_16x16x32_bf16 v[40:43], a[152:155], v[160:163], v[40:43]
v_exp_f32 v11, v11
s_waitcnt lgkmcnt(4)
v_mfma_f32_16x16x32_bf16 v[40:43], a[156:159], v[164:167], v[40:43]
v_cvt_pk_bf16_f32 v73, v10, v11
v_exp_f32 v12, v12
v_mfma_f32_16x16x32_bf16 v[48:51], a[156:159], v[180:183], v[140:143]
v_exp_f32 v13, v13
v_mfma_f32_16x16x32_bf16 v[48:51], a[152:155], v[176:179], v[48:51]
v_cvt_pk_bf16_f32 v74, v12, v13
v_exp_f32 v14, v14
v_mfma_f32_16x16x32_bf16 v[48:51], a[148:151], v[172:175], v[48:51]
v_exp_f32 v15, v15
v_mfma_f32_16x16x32_bf16 v[48:51], a[144:147], v[168:171], v[48:51]
v_exp_f32 v16, v16
v_exp_f32 v17, v17
v_mfma_f32_16x16x32_bf16 v[56:59], a[144:147], v[184:187], v[144:147]
v_cvt_pk_bf16_f32 v75, v14, v15
v_cvt_pk_bf16_f32 v76, v16, v17
v_exp_f32 v18, v18
v_mfma_f32_16x16x32_bf16 v[56:59], a[148:151], v[188:191], v[56:59]
v_exp_f32 v19, v19
v_mfma_f32_16x16x32_bf16 v[56:59], a[152:155], v[192:195], v[56:59]
v_cvt_pk_bf16_f32 v77, v18, v19
v_exp_f32 v20, v20
v_mfma_f32_16x16x32_bf16 v[56:59], a[156:159], v[196:199], v[56:59]
v_exp_f32 v21, v21
v_mfma_f32_16x16x32_bf16 v[64:67], a[156:159], v[212:215], v[148:151]
s_waitcnt vmcnt(8) lgkmcnt(0)
s_barrier
v_exp_f32 v22, v22
v_mfma_f32_16x16x32_bf16 v[64:67], a[152:155], v[208:211], v[64:67]
ds_read_b64_tr_b16 a[176:177], v220 offset:32768
v_cvt_pk_bf16_f32 v78, v20, v21
v_exp_f32 v23, v23
v_mfma_f32_16x16x32_bf16 v[64:67], a[148:151], v[204:207], v[64:67]
v_exp_f32 v24, v24
v_exp_f32 v25, v25
v_mfma_f32_16x16x32_bf16 v[64:67], a[144:147], v[200:203], v[64:67]
v_cvt_pk_bf16_f32 v79, v22, v23
v_cvt_pk_bf16_f32 v80, v24, v25
v_exp_f32 v26, v26
v_mfma_f32_16x16x32_bf16 v[44:47], a[160:163], v[152:155], v[136:139]
ds_read_b64_tr_b16 a[178:179], v220 offset:36864
ds_read_b64_tr_b16 a[180:181], v221 offset:32768
v_exp_f32 v27, v27
v_mfma_f32_16x16x32_bf16 v[44:47], a[164:167], v[156:159], v[44:47]
ds_read_b64_tr_b16 a[182:183], v221 offset:36864
v_cvt_pk_bf16_f32 v81, v26, v27
v_exp_f32 v28, v28
v_mfma_f32_16x16x32_bf16 v[44:47], a[168:171], v[160:163], v[44:47]
ds_read_b64_tr_b16 a[184:185], v222 offset:32768
ds_read_b64_tr_b16 a[186:187], v222 offset:36864
v_exp_f32 v29, v29
v_mfma_f32_16x16x32_bf16 v[44:47], a[172:175], v[164:167], v[44:47]
ds_read_b64_tr_b16 a[188:189], v223 offset:32768
v_cvt_pk_bf16_f32 v82, v28, v29
v_exp_f32 v30, v30
v_mfma_f32_16x16x32_bf16 v[52:55], a[172:175], v[180:183], v[140:143]
ds_read_b64_tr_b16 a[190:191], v223 offset:36864
ds_read_b128 a[156:159], v219 offset:49152
v_exp_f32 v31, v31
v_mfma_f32_16x16x32_bf16 v[52:55], a[168:171], v[176:179], v[52:55]
v_exp_f32 v32, v32
v_exp_f32 v33, v33
v_mfma_f32_16x16x32_bf16 v[52:55], a[164:167], v[172:175], v[52:55]
v_cvt_pk_bf16_f32 v83, v30, v31
v_cvt_pk_bf16_f32 v84, v32, v33
v_exp_f32 v34, v34
v_mfma_f32_16x16x32_bf16 v[52:55], a[160:163], v[168:171], v[52:55]
ds_read_b64_tr_b16 a[192:193], v224 offset:32768
ds_read_b64_tr_b16 a[194:195], v224 offset:36864
v_exp_f32 v35, v35
v_mfma_f32_16x16x32_bf16 v[60:63], a[160:163], v[184:187], v[144:147]
ds_read_b128 a[152:155], v218 offset:49152
v_cvt_pk_bf16_f32 v85, v34, v35
v_exp_f32 v36, v36
v_mfma_f32_16x16x32_bf16 v[60:63], a[164:167], v[188:191], v[60:63]
ds_read_b128 a[148:151], v217 offset:49152
ds_read_b128 a[144:147], v216 offset:49152
v_exp_f32 v37, v37
v_mfma_f32_16x16x32_bf16 v[60:63], a[168:171], v[192:195], v[60:63]
ds_read_b64_tr_b16 a[196:197], v225 offset:32768
v_cvt_pk_bf16_f32 v86, v36, v37
v_exp_f32 v38, v38
v_mfma_f32_16x16x32_bf16 v[60:63], a[172:175], v[196:199], v[60:63]
ds_read_b64_tr_b16 a[198:199], v225 offset:36864
ds_read_b64_tr_b16 a[200:201], v226 offset:32768
v_exp_f32 v39, v39
v_mfma_f32_16x16x32_bf16 v[68:71], a[172:175], v[212:215], v[148:151]
ds_read_b64_tr_b16 a[202:203], v226 offset:36864
ds_read_b64_tr_b16 a[204:205], v227 offset:32768
ds_read_b64_tr_b16 a[206:207], v227 offset:36864
v_cvt_pk_bf16_f32 v87, v38, v39
v_mfma_f32_16x16x32_bf16 v[68:71], a[168:171], v[208:211], v[68:71]
ds_read_b128 a[172:175], v219 offset:53248
ds_read_b128 a[168:171], v218 offset:53248
s_add_u32 s32, s32, 16384
s_add_u32 m0, s30, 81920
v_mfma_f32_16x16x32_bf16 v[68:71], a[164:167], v[204:207], v[68:71]
ds_read_b128 a[164:167], v217 offset:53248
buffer_load_dwordx4 v228, s[8:11], s32 offen offset:0  lds
v_mfma_f32_16x16x32_bf16 v[68:71], a[160:163], v[200:203], v[68:71]
ds_read_b128 a[160:163], v216 offset:53248
buffer_load_dwordx4 v229, s[8:11], s32 offen offset:1024  lds
buffer_load_dwordx4 v230, s[8:11], s32 offen offset:2048  lds
buffer_load_dwordx4 v231, s[8:11], s32 offen offset:3072  lds
buffer_store_byte v255, v254, s[24:27], 0 offen sc0 sc1
s_waitcnt lgkmcnt(8)
v_mfma_f32_16x16x32_bf16 v[8:11], a[144:147], v[152:155], v[136:139]
ds_read_b64_tr_b16 a[212:213], v220 offset:40960
v_exp_f32 v40, v40
v_mfma_f32_16x16x32_bf16 v[8:11], a[148:151], v[156:159], v[8:11]
ds_read_b64_tr_b16 a[214:215], v220 offset:45056
v_exp_f32 v41, v41
v_mfma_f32_16x16x32_bf16 v[8:11], a[152:155], v[160:163], v[8:11]
v_cvt_pk_bf16_f32 v88, v40, v41
v_exp_f32 v42, v42
v_mfma_f32_16x16x32_bf16 v[8:11], a[156:159], v[164:167], v[8:11]
s_add_u32 s39, s39, 16384
v_mfma_f32_16x16x32_bf16 v[16:19], a[156:159], v[180:183], v[140:143]
ds_read_b64_tr_b16 a[216:217], v221 offset:40960
v_exp_f32 v43, v43
v_mfma_f32_16x16x32_bf16 v[16:19], a[152:155], v[176:179], v[16:19]
v_cvt_pk_bf16_f32 v89, v42, v43
v_exp_f32 v44, v44
v_mfma_f32_16x16x32_bf16 v[16:19], a[148:151], v[172:175], v[16:19]
ds_read_b64_tr_b16 a[218:219], v221 offset:45056
v_mfma_f32_16x16x32_bf16 v[16:19], a[144:147], v[168:171], v[16:19]
v_exp_f32 v45, v45
v_mfma_f32_16x16x32_bf16 v[24:27], a[144:147], v[184:187], v[144:147]
v_cvt_pk_bf16_f32 v90, v44, v45
v_exp_f32 v46, v46
v_mfma_f32_16x16x32_bf16 v[24:27], a[148:151], v[188:191], v[24:27]
ds_read_b64_tr_b16 a[220:221], v222 offset:40960
v_exp_f32 v47, v47
v_mfma_f32_16x16x32_bf16 v[24:27], a[152:155], v[192:195], v[24:27]
ds_read_b64_tr_b16 a[222:223], v222 offset:45056
s_add_u32 m0, s30, 98304
v_cvt_pk_bf16_f32 v91, v46, v47
v_mfma_f32_16x16x32_bf16 v[24:27], a[156:159], v[196:199], v[24:27]
v_exp_f32 v48, v48
v_mfma_f32_16x16x32_bf16 v[32:35], a[156:159], v[212:215], v[148:151]
ds_read_b128 a[156:159], v219 offset:57344
v_exp_f32 v49, v49
v_mfma_f32_16x16x32_bf16 v[32:35], a[152:155], v[208:211], v[32:35]
ds_read_b128 a[152:155], v218 offset:57344
v_cvt_pk_bf16_f32 v92, v48, v49
v_mfma_f32_16x16x32_bf16 v[32:35], a[148:151], v[204:207], v[32:35]
ds_read_b128 a[148:151], v217 offset:57344
v_exp_f32 v50, v50
v_mfma_f32_16x16x32_bf16 v[32:35], a[144:147], v[200:203], v[32:35]
ds_read_b64_tr_b16 a[224:225], v223 offset:40960
v_exp_f32 v51, v51
v_mfma_f32_16x16x32_bf16 a[8:11], v[80:83], a[176:179], 0
v_cvt_pk_bf16_f32 v93, v50, v51
v_exp_f32 v52, v52
v_mfma_f32_16x16x32_bf16 a[12:15], v[84:87], a[176:179], 0
ds_read_b64_tr_b16 a[226:227], v223 offset:45056
ds_read_b128 a[144:147], v216 offset:57344
v_mfma_f32_16x16x32_bf16 a[28:31], v[84:87], a[180:183], 0
v_exp_f32 v53, v53
v_mfma_f32_16x16x32_bf16 a[24:27], v[80:83], a[180:183], 0
v_cvt_pk_bf16_f32 v94, v52, v53
v_exp_f32 v54, v54
v_mfma_f32_16x16x32_bf16 a[40:43], v[80:83], a[184:187], 0
ds_read_b64_tr_b16 a[228:229], v224 offset:40960
ds_read_b64_tr_b16 a[230:231], v224 offset:45056
v_mfma_f32_16x16x32_bf16 a[44:47], v[84:87], a[184:187], 0
v_exp_f32 v55, v55
v_mfma_f32_16x16x32_bf16 a[60:63], v[84:87], a[188:191], 0
v_cvt_pk_bf16_f32 v95, v54, v55
v_exp_f32 v56, v56
v_mfma_f32_16x16x32_bf16 a[56:59], v[80:83], a[188:191], 0
v_exp_f32 v57, v57
s_waitcnt lgkmcnt(8)
v_mfma_f32_16x16x32_bf16 v[12:15], a[160:163], v[152:155], v[136:139]
ds_read_b64_tr_b16 a[232:233], v225 offset:40960
ds_read_b64_tr_b16 a[234:235], v225 offset:45056
v_cvt_pk_bf16_f32 v96, v56, v57
v_mfma_f32_16x16x32_bf16 v[12:15], a[164:167], v[156:159], v[12:15]
v_exp_f32 v58, v58
v_mfma_f32_16x16x32_bf16 v[12:15], a[168:171], v[160:163], v[12:15]
v_exp_f32 v59, v59
v_mfma_f32_16x16x32_bf16 v[12:15], a[172:175], v[164:167], v[12:15]
buffer_load_dwordx4 v232, s[12:15], s39 offen offset:0  lds
v_cvt_pk_bf16_f32 v97, v58, v59
v_mfma_f32_16x16x32_bf16 v[20:23], a[172:175], v[180:183], v[140:143]
v_exp_f32 v60, v60
v_mfma_f32_16x16x32_bf16 v[20:23], a[168:171], v[176:179], v[20:23]
ds_read_b64_tr_b16 a[236:237], v226 offset:40960
v_exp_f32 v61, v61
v_mfma_f32_16x16x32_bf16 v[20:23], a[164:167], v[172:175], v[20:23]
v_cvt_pk_bf16_f32 v98, v60, v61
v_exp_f32 v62, v62
v_mfma_f32_16x16x32_bf16 v[20:23], a[160:163], v[168:171], v[20:23]
ds_read_b64_tr_b16 a[238:239], v226 offset:45056
buffer_load_dwordx4 v233, s[12:15], s39 offen offset:1024  lds
v_mfma_f32_16x16x32_bf16 v[28:31], a[160:163], v[184:187], v[144:147]
v_exp_f32 v63, v63
v_mfma_f32_16x16x32_bf16 v[28:31], a[164:167], v[188:191], v[28:31]
v_cvt_pk_bf16_f32 v99, v62, v63
v_exp_f32 v64, v64
v_mfma_f32_16x16x32_bf16 v[28:31], a[168:171], v[192:195], v[28:31]
ds_read_b64_tr_b16 a[240:241], v227 offset:40960
ds_read_b64_tr_b16 a[242:243], v227 offset:45056
v_mfma_f32_16x16x32_bf16 v[28:31], a[172:175], v[196:199], v[28:31]
v_exp_f32 v65, v65
v_mfma_f32_16x16x32_bf16 v[36:39], a[172:175], v[212:215], v[148:151]
v_cvt_pk_bf16_f32 v100, v64, v65
v_exp_f32 v66, v66
v_mfma_f32_16x16x32_bf16 v[36:39], a[168:171], v[208:211], v[36:39]
ds_read_b128 a[172:175], v219 offset:61440
v_exp_f32 v67, v67
v_mfma_f32_16x16x32_bf16 v[36:39], a[164:167], v[204:207], v[36:39]
ds_read_b128 a[168:171], v218 offset:61440
ds_read_b128 a[164:167], v217 offset:61440
v_cvt_pk_bf16_f32 v101, v66, v67
v_mfma_f32_16x16x32_bf16 v[36:39], a[160:163], v[200:203], v[36:39]
ds_read_b128 a[160:163], v216 offset:61440
v_exp_f32 v68, v68
v_mfma_f32_16x16x32_bf16 a[72:75], v[80:83], a[192:195], 0
v_exp_f32 v69, v69
v_mfma_f32_16x16x32_bf16 a[76:79], v[84:87], a[192:195], 0
buffer_load_dwordx4 v232, s[12:15], s39 offen offset:2048  lds
v_cvt_pk_bf16_f32 v102, v68, v69
v_mfma_f32_16x16x32_bf16 a[92:95], v[84:87], a[196:199], 0
v_exp_f32 v70, v70
v_mfma_f32_16x16x32_bf16 a[88:91], v[80:83], a[196:199], 0
v_exp_f32 v71, v71
v_mfma_f32_16x16x32_bf16 a[104:107], v[80:83], a[200:203], 0
buffer_load_dwordx4 v233, s[12:15], s39 offen offset:3072  lds
v_cvt_pk_bf16_f32 v103, v70, v71
v_mfma_f32_16x16x32_bf16 a[108:111], v[84:87], a[200:203], 0
v_mfma_f32_16x16x32_bf16 a[124:127], v[84:87], a[204:207], 0
v_mfma_f32_16x16x32_bf16 a[120:123], v[80:83], a[204:207], 0
v_smfmac_f32_16x16x64_bf16 a[132:135], a[208:211], v[80:87], v245
s_waitcnt lgkmcnt(8)
v_mfma_f32_16x16x32_bf16 v[40:43], a[144:147], v[152:155], v[136:139]
v_exp_f32 v8, v8
v_mfma_f32_16x16x32_bf16 v[40:43], a[148:151], v[156:159], v[40:43]
v_exp_f32 v9, v9
v_mfma_f32_16x16x32_bf16 v[40:43], a[152:155], v[160:163], v[40:43]
v_cvt_pk_bf16_f32 v104, v8, v9
v_lshlrev_b32 v250, 3, v1
v_mfma_f32_16x16x32_bf16 v[40:43], a[156:159], v[164:167], v[40:43]
v_exp_f32 v10, v10
v_mfma_f32_16x16x32_bf16 v[48:51], a[156:159], v[180:183], v[140:143]
v_mfma_f32_16x16x32_bf16 v[48:51], a[152:155], v[176:179], v[48:51]
v_exp_f32 v11, v11
v_mfma_f32_16x16x32_bf16 v[48:51], a[148:151], v[172:175], v[48:51]
v_cvt_pk_bf16_f32 v105, v10, v11
v_mfma_f32_16x16x32_bf16 v[48:51], a[144:147], v[168:171], v[48:51]
v_exp_f32 v12, v12
v_mfma_f32_16x16x32_bf16 v[56:59], a[144:147], v[184:187], v[144:147]
v_mfma_f32_16x16x32_bf16 v[56:59], a[148:151], v[188:191], v[56:59]
v_exp_f32 v13, v13
v_mfma_f32_16x16x32_bf16 v[56:59], a[152:155], v[192:195], v[56:59]
v_cvt_pk_bf16_f32 v106, v12, v13
v_mfma_f32_16x16x32_bf16 v[56:59], a[156:159], v[196:199], v[56:59]
v_exp_f32 v14, v14
v_mfma_f32_16x16x32_bf16 v[64:67], a[156:159], v[212:215], v[148:151]
s_waitcnt vmcnt(9) lgkmcnt(0)
s_barrier
v_mfma_f32_16x16x32_bf16 v[64:67], a[152:155], v[208:211], v[64:67]
v_exp_f32 v15, v15
v_mfma_f32_16x16x32_bf16 v[64:67], a[148:151], v[204:207], v[64:67]
ds_read_b128 a[156:159], v219 offset:0
v_cvt_pk_bf16_f32 v107, v14, v15
v_mfma_f32_16x16x32_bf16 v[64:67], a[144:147], v[200:203], v[64:67]
v_exp_f32 v16, v16
v_mfma_f32_16x16x32_bf16 a[0:3], v[88:91], a[212:215], 0
ds_read_b128 a[152:155], v218 offset:0
ds_read_b128 a[148:151], v217 offset:0
v_mfma_f32_16x16x32_bf16 a[0:3], v[72:75], a[176:179], a[0:3]
v_exp_f32 v17, v17
v_mfma_f32_16x16x32_bf16 a[4:7], v[76:79], a[176:179], 0
ds_read_b128 a[144:147], v216 offset:0
v_cvt_pk_bf16_f32 v108, v16, v17
v_mfma_f32_16x16x32_bf16 a[4:7], v[92:95], a[212:215], a[4:7]
v_exp_f32 v18, v18
v_mfma_f32_16x16x32_bf16 a[20:23], v[92:95], a[216:219], 0
ds_read_b64_tr_b16 a[176:177], v220 offset:49152
ds_read_b64_tr_b16 a[178:179], v220 offset:53248
v_mfma_f32_16x16x32_bf16 a[20:23], v[76:79], a[180:183], a[20:23]
v_exp_f32 v19, v19
v_mfma_f32_16x16x32_bf16 a[16:19], v[72:75], a[180:183], 0
ds_read_b64_tr_b16 a[180:181], v221 offset:49152
v_cvt_pk_bf16_f32 v109, v18, v19
v_mfma_f32_16x16x32_bf16 a[16:19], v[88:91], a[216:219], a[16:19]
v_exp_f32 v20, v20
v_mfma_f32_16x16x32_bf16 a[32:35], v[88:91], a[220:223], 0
ds_read_b64_tr_b16 a[182:183], v221 offset:53248
s_add_u32 s32, s32, 16384
v_mfma_f32_16x16x32_bf16 a[32:35], v[72:75], a[184:187], a[32:35]
v_exp_f32 v21, v21
v_mfma_f32_16x16x32_bf16 a[36:39], v[76:79], a[184:187], 0
ds_read_b64_tr_b16 a[184:185], v222 offset:49152
v_cvt_pk_bf16_f32 v110, v20, v21
v_mfma_f32_16x16x32_bf16 a[36:39], v[92:95], a[220:223], a[36:39]
v_exp_f32 v22, v22
v_mfma_f32_16x16x32_bf16 a[52:55], v[92:95], a[224:227], 0
ds_read_b64_tr_b16 a[186:187], v222 offset:53248
s_add_u32 m0, s30, 114688
v_mfma_f32_16x16x32_bf16 a[52:55], v[76:79], a[188:191], a[52:55]
v_exp_f32 v23, v23
v_mfma_f32_16x16x32_bf16 a[48:51], v[72:75], a[188:191], 0
ds_read_b64_tr_b16 a[188:189], v223 offset:49152
v_cvt_pk_bf16_f32 v111, v22, v23
v_mfma_f32_16x16x32_bf16 a[48:51], v[88:91], a[224:227], a[48:51]
v_exp_f32 v24, v24
v_mfma_f32_16x16x32_bf16 v[44:47], a[160:163], v[152:155], v[136:139]
v_exp_f32 v25, v25
v_mfma_f32_16x16x32_bf16 v[44:47], a[164:167], v[156:159], v[44:47]
ds_read_b64_tr_b16 a[190:191], v223 offset:53248
v_cvt_pk_bf16_f32 v112, v24, v25
v_mfma_f32_16x16x32_bf16 v[44:47], a[168:171], v[160:163], v[44:47]
v_exp_f32 v26, v26
v_mfma_f32_16x16x32_bf16 v[44:47], a[172:175], v[164:167], v[44:47]
buffer_load_dwordx4 v228, s[8:11], s32 offen offset:0  lds
v_mfma_f32_16x16x32_bf16 v[52:55], a[172:175], v[180:183], v[140:143]
v_exp_f32 v27, v27
v_mfma_f32_16x16x32_bf16 v[52:55], a[168:171], v[176:179], v[52:55]
v_cvt_pk_bf16_f32 v113, v26, v27
v_mfma_f32_16x16x32_bf16 v[52:55], a[164:167], v[172:175], v[52:55]
v_exp_f32 v28, v28
v_mfma_f32_16x16x32_bf16 v[52:55], a[160:163], v[168:171], v[52:55]
buffer_load_dwordx4 v229, s[8:11], s32 offen offset:1024  lds
v_mfma_f32_16x16x32_bf16 v[60:63], a[160:163], v[184:187], v[144:147]
v_exp_f32 v29, v29
v_mfma_f32_16x16x32_bf16 v[60:63], a[164:167], v[188:191], v[60:63]
v_cvt_pk_bf16_f32 v114, v28, v29
v_mfma_f32_16x16x32_bf16 v[60:63], a[168:171], v[192:195], v[60:63]
v_exp_f32 v30, v30
v_mfma_f32_16x16x32_bf16 v[60:63], a[172:175], v[196:199], v[60:63]
buffer_load_dwordx4 v230, s[8:11], s32 offen offset:2048  lds
v_mfma_f32_16x16x32_bf16 v[68:71], a[172:175], v[212:215], v[148:151]
v_exp_f32 v31, v31
v_mfma_f32_16x16x32_bf16 v[68:71], a[168:171], v[208:211], v[68:71]
ds_read_b128 a[172:175], v219 offset:4096
v_cvt_pk_bf16_f32 v115, v30, v31
v_mfma_f32_16x16x32_bf16 v[68:71], a[164:167], v[204:207], v[68:71]
v_exp_f32 v32, v32
v_mfma_f32_16x16x32_bf16 v[68:71], a[160:163], v[200:203], v[68:71]
ds_read_b128 a[168:171], v218 offset:4096
ds_read_b128 a[164:167], v217 offset:4096
v_mfma_f32_16x16x32_bf16 a[64:67], v[88:91], a[228:231], 0
v_exp_f32 v33, v33
v_mfma_f32_16x16x32_bf16 a[64:67], v[72:75], a[192:195], a[64:67]
ds_read_b128 a[160:163], v216 offset:4096
v_cvt_pk_bf16_f32 v116, v32, v33
v_mfma_f32_16x16x32_bf16 a[68:71], v[76:79], a[192:195], 0
v_exp_f32 v34, v34
v_mfma_f32_16x16x32_bf16 a[68:71], v[92:95], a[228:231], a[68:71]
ds_read_b64_tr_b16 a[192:193], v224 offset:49152
ds_read_b64_tr_b16 a[194:195], v224 offset:53248
v_mfma_f32_16x16x32_bf16 a[84:87], v[92:95], a[232:235], 0
v_exp_f32 v35, v35
v_mfma_f32_16x16x32_bf16 a[84:87], v[76:79], a[196:199], a[84:87]
v_cvt_pk_bf16_f32 v117, v34, v35
v_mfma_f32_16x16x32_bf16 a[80:83], v[72:75], a[196:199], 0
v_exp_f32 v36, v36
v_mfma_f32_16x16x32_bf16 a[80:83], v[88:91], a[232:235], a[80:83]
ds_read_b64_tr_b16 a[196:197], v225 offset:49152
ds_read_b64_tr_b16 a[198:199], v225 offset:53248
v_mfma_f32_16x16x32_bf16 a[96:99], v[88:91], a[236:239], 0
v_exp_f32 v37, v37
v_mfma_f32_16x16x32_bf16 a[96:99], v[72:75], a[200:203], a[96:99]
v_cvt_pk_bf16_f32 v118, v36, v37
v_mfma_f32_16x16x32_bf16 a[100:103], v[76:79], a[200:203], 0
v_exp_f32 v38, v38
v_mfma_f32_16x16x32_bf16 a[100:103], v[92:95], a[236:239], a[100:103]
ds_read_b64_tr_b16 a[200:201], v226 offset:49152
ds_read_b64_tr_b16 a[202:203], v226 offset:53248
v_mfma_f32_16x16x32_bf16 a[116:119], v[92:95], a[240:243], 0
v_exp_f32 v39, v39
v_mfma_f32_16x16x32_bf16 a[116:119], v[76:79], a[204:207], a[116:119]
v_cvt_pk_bf16_f32 v119, v38, v39
v_mfma_f32_16x16x32_bf16 a[112:115], v[72:75], a[204:207], 0
ds_read_b64_tr_b16 a[204:205], v227 offset:49152
ds_read_b64_tr_b16 a[206:207], v227 offset:53248
v_mfma_f32_16x16x32_bf16 a[112:115], v[88:91], a[240:243], a[112:115]
buffer_load_dwordx4 v231, s[8:11], s32 offen offset:3072  lds
v_smfmac_f32_16x16x64_bf16 a[128:131], a[208:211], v[88:95], v245
s_add_u32 m0, s86, 0
s_add_u32 s50, s84, 0
buffer_load_dwordx4 v240, s[64:67], s50 offen lds
v_smfmac_f32_16x16x64_bf16 a[128:131], a[208:211], v[72:79], v245
s_add_u32 m0, s86, 4096
s_add_u32 s50, s84, 589824
buffer_load_dwordx4 v240, s[64:67], s50 offen lds
s_waitcnt lgkmcnt(8)
v_mfma_f32_16x16x32_bf16 v[8:11], a[144:147], v[152:155], v[136:139]
v_exp_f32 v40, v40
v_mfma_f32_16x16x32_bf16 v[8:11], a[148:151], v[156:159], v[8:11]
v_exp_f32 v41, v41
v_mfma_f32_16x16x32_bf16 v[8:11], a[152:155], v[160:163], v[8:11]
v_cvt_pk_bf16_f32 v72, v40, v41
v_mfma_f32_16x16x32_bf16 v[8:11], a[156:159], v[164:167], v[8:11]
v_exp_f32 v42, v42
v_mfma_f32_16x16x32_bf16 v[16:19], a[156:159], v[180:183], v[140:143]
s_add_u32 s39, s39, 16384
v_mfma_f32_16x16x32_bf16 v[16:19], a[152:155], v[176:179], v[16:19]
v_exp_f32 v43, v43
v_mfma_f32_16x16x32_bf16 v[16:19], a[148:151], v[172:175], v[16:19]
v_cvt_pk_bf16_f32 v73, v42, v43
v_mfma_f32_16x16x32_bf16 v[16:19], a[144:147], v[168:171], v[16:19]
v_exp_f32 v44, v44
v_mfma_f32_16x16x32_bf16 v[24:27], a[144:147], v[184:187], v[144:147]
s_mov_b32 s29, 0x242000
buffer_load_dwordx2 v[248:249], v250, s[20:23], s29 offen sc0 sc1
v_mfma_f32_16x16x32_bf16 v[24:27], a[148:151], v[188:191], v[24:27]
v_exp_f32 v45, v45
v_mfma_f32_16x16x32_bf16 v[24:27], a[152:155], v[192:195], v[24:27]
s_add_u32 m0, s30, 131072
v_cvt_pk_bf16_f32 v74, v44, v45
v_mfma_f32_16x16x32_bf16 v[24:27], a[156:159], v[196:199], v[24:27]
v_exp_f32 v46, v46
v_mfma_f32_16x16x32_bf16 v[32:35], a[156:159], v[212:215], v[148:151]
ds_read_b128 a[156:159], v219 offset:8192
v_mfma_f32_16x16x32_bf16 v[32:35], a[152:155], v[208:211], v[32:35]
v_exp_f32 v47, v47
v_mfma_f32_16x16x32_bf16 v[32:35], a[148:151], v[204:207], v[32:35]
ds_read_b128 a[152:155], v218 offset:8192
v_cvt_pk_bf16_f32 v75, v46, v47
v_mfma_f32_16x16x32_bf16 v[32:35], a[144:147], v[200:203], v[32:35]
v_exp_f32 v48, v48
v_mfma_f32_16x16x32_bf16 a[8:11], v[112:115], a[176:179], a[8:11]
ds_read_b128 a[148:151], v217 offset:8192
ds_read_b128 a[144:147], v216 offset:8192
v_mfma_f32_16x16x32_bf16 a[8:11], v[96:99], a[212:215], a[8:11]
v_exp_f32 v49, v49
v_mfma_f32_16x16x32_bf16 a[12:15], v[100:103], a[212:215], a[12:15]
ds_read_b64_tr_b16 a[212:213], v220 offset:57344
v_cvt_pk_bf16_f32 v76, v48, v49
v_mfma_f32_16x16x32_bf16 a[12:15], v[116:119], a[176:179], a[12:15]
v_exp_f32 v50, v50
v_mfma_f32_16x16x32_bf16 a[28:31], v[116:119], a[180:183], a[28:31]
ds_read_b64_tr_b16 a[214:215], v220 offset:61440
v_mfma_f32_16x16x32_bf16 a[28:31], v[100:103], a[216:219], a[28:31]
v_exp_f32 v51, v51
v_mfma_f32_16x16x32_bf16 a[24:27], v[96:99], a[216:219], a[24:27]
ds_read_b64_tr_b16 a[216:217], v221 offset:57344
v_cvt_pk_bf16_f32 v77, v50, v51
v_mfma_f32_16x16x32_bf16 a[24:27], v[112:115], a[180:183], a[24:27]
v_exp_f32 v52, v52
v_mfma_f32_16x16x32_bf16 a[40:43], v[112:115], a[184:187], a[40:43]
ds_read_b64_tr_b16 a[218:219], v221 offset:61440
v_mfma_f32_16x16x32_bf16 a[40:43], v[96:99], a[220:223], a[40:43]
v_exp_f32 v53, v53
v_mfma_f32_16x16x32_bf16 a[44:47], v[100:103], a[220:223], a[44:47]
ds_read_b64_tr_b16 a[220:221], v222 offset:57344
v_cvt_pk_bf16_f32 v78, v52, v53
v_mfma_f32_16x16x32_bf16 a[44:47], v[116:119], a[184:187], a[44:47]
v_exp_f32 v54, v54
v_mfma_f32_16x16x32_bf16 a[60:63], v[116:119], a[188:191], a[60:63]
ds_read_b64_tr_b16 a[222:223], v222 offset:61440
v_mfma_f32_16x16x32_bf16 a[60:63], v[100:103], a[224:227], a[60:63]
v_exp_f32 v55, v55
v_mfma_f32_16x16x32_bf16 a[56:59], v[96:99], a[224:227], a[56:59]
ds_read_b64_tr_b16 a[224:225], v223 offset:57344
v_cvt_pk_bf16_f32 v79, v54, v55
v_mfma_f32_16x16x32_bf16 a[56:59], v[112:115], a[188:191], a[56:59]
v_exp_f32 v56, v56
v_mfma_f32_16x16x32_bf16 v[12:15], a[160:163], v[152:155], v[136:139]
v_exp_f32 v57, v57
v_mfma_f32_16x16x32_bf16 v[12:15], a[164:167], v[156:159], v[12:15]
ds_read_b64_tr_b16 a[226:227], v223 offset:61440
v_cvt_pk_bf16_f32 v80, v56, v57
v_mfma_f32_16x16x32_bf16 v[12:15], a[168:171], v[160:163], v[12:15]
v_exp_f32 v58, v58
v_mfma_f32_16x16x32_bf16 v[12:15], a[172:175], v[164:167], v[12:15]
buffer_load_dwordx4 v232, s[12:15], s39 offen offset:0  lds
v_mfma_f32_16x16x32_bf16 v[20:23], a[172:175], v[180:183], v[140:143]
STUB_4:
s_cbranch_execz STUB_7
v_exp_f32 v59, v59
v_mfma_f32_16x16x32_bf16 v[20:23], a[168:171], v[176:179], v[20:23]
v_cvt_pk_bf16_f32 v81, v58, v59
v_mfma_f32_16x16x32_bf16 v[20:23], a[164:167], v[172:175], v[20:23]
v_exp_f32 v60, v60
v_mfma_f32_16x16x32_bf16 v[20:23], a[160:163], v[168:171], v[20:23]
buffer_load_dwordx4 v233, s[12:15], s39 offen offset:1024  lds
v_mfma_f32_16x16x32_bf16 v[28:31], a[160:163], v[184:187], v[144:147]
v_exp_f32 v61, v61
v_mfma_f32_16x16x32_bf16 v[28:31], a[164:167], v[188:191], v[28:31]
v_cvt_pk_bf16_f32 v82, v60, v61
v_mfma_f32_16x16x32_bf16 v[28:31], a[168:171], v[192:195], v[28:31]
v_exp_f32 v62, v62
v_mfma_f32_16x16x32_bf16 v[28:31], a[172:175], v[196:199], v[28:31]
buffer_load_dwordx4 v232, s[12:15], s39 offen offset:2048  lds
v_mfma_f32_16x16x32_bf16 v[36:39], a[172:175], v[212:215], v[148:151]
v_exp_f32 v63, v63
v_mfma_f32_16x16x32_bf16 v[36:39], a[168:171], v[208:211], v[36:39]
ds_read_b128 a[172:175], v219 offset:12288
v_cvt_pk_bf16_f32 v83, v62, v63
v_mfma_f32_16x16x32_bf16 v[36:39], a[164:167], v[204:207], v[36:39]
v_exp_f32 v64, v64
v_mfma_f32_16x16x32_bf16 v[36:39], a[160:163], v[200:203], v[36:39]
ds_read_b128 a[168:171], v218 offset:12288
ds_read_b128 a[164:167], v217 offset:12288
s_waitcnt lgkmcnt(8)
v_mfma_f32_16x16x32_bf16 a[72:75], v[112:115], a[192:195], a[72:75]
v_exp_f32 v65, v65
v_mfma_f32_16x16x32_bf16 a[72:75], v[96:99], a[228:231], a[72:75]
ds_read_b128 a[160:163], v216 offset:12288
v_cvt_pk_bf16_f32 v84, v64, v65
v_mfma_f32_16x16x32_bf16 a[76:79], v[100:103], a[228:231], a[76:79]
v_exp_f32 v66, v66
v_mfma_f32_16x16x32_bf16 a[76:79], v[116:119], a[192:195], a[76:79]
ds_read_b64_tr_b16 a[228:229], v224 offset:57344
ds_read_b64_tr_b16 a[230:231], v224 offset:61440
v_mfma_f32_16x16x32_bf16 a[92:95], v[116:119], a[196:199], a[92:95]
v_exp_f32 v67, v67
v_mfma_f32_16x16x32_bf16 a[92:95], v[100:103], a[232:235], a[92:95]
v_cvt_pk_bf16_f32 v85, v66, v67
v_mfma_f32_16x16x32_bf16 a[88:91], v[96:99], a[232:235], a[88:91]
v_exp_f32 v68, v68
v_mfma_f32_16x16x32_bf16 a[88:91], v[112:115], a[196:199], a[88:91]
ds_read_b64_tr_b16 a[232:233], v225 offset:57344
ds_read_b64_tr_b16 a[234:235], v225 offset:61440
v_mfma_f32_16x16x32_bf16 a[104:107], v[112:115], a[200:203], a[104:107]
v_exp_f32 v69, v69
v_mfma_f32_16x16x32_bf16 a[104:107], v[96:99], a[236:239], a[104:107]
v_cvt_pk_bf16_f32 v86, v68, v69
v_mfma_f32_16x16x32_bf16 a[108:111], v[100:103], a[236:239], a[108:111]
v_exp_f32 v70, v70
v_mfma_f32_16x16x32_bf16 a[108:111], v[116:119], a[200:203], a[108:111]
ds_read_b64_tr_b16 a[236:237], v226 offset:57344
ds_read_b64_tr_b16 a[238:239], v226 offset:61440
v_mfma_f32_16x16x32_bf16 a[124:127], v[116:119], a[204:207], a[124:127]
v_exp_f32 v71, v71
v_mfma_f32_16x16x32_bf16 a[124:127], v[100:103], a[240:243], a[124:127]
v_cvt_pk_bf16_f32 v87, v70, v71
v_mfma_f32_16x16x32_bf16 a[120:123], v[96:99], a[240:243], a[120:123]
ds_read_b64_tr_b16 a[240:241], v227 offset:57344
ds_read_b64_tr_b16 a[242:243], v227 offset:61440
v_mfma_f32_16x16x32_bf16 a[120:123], v[112:115], a[204:207], a[120:123]
buffer_load_dwordx4 v233, s[12:15], s39 offen offset:3072  lds
v_smfmac_f32_16x16x64_bf16 a[132:135], a[208:211], v[112:119], v245
s_add_u32 m0, s86, 8192
s_add_u32 s50, s84, 1179648
buffer_load_dwordx4 v240, s[64:67], s50 offen lds
v_smfmac_f32_16x16x64_bf16 a[132:135], a[208:211], v[96:103], v245
s_add_u32 m0, s86, 12288
s_add_u32 s50, s84, 1769472
buffer_load_dwordx4 v240, s[64:67], s50 offen lds
s_mov_b32 s33, 9
s_cmp_lt_u32 s86, 0x10000
s_cbranch_scc0 K_LOOPIN
v_mfma_f32_16x16x32_bf16 v[40:43], a[144:147], v[152:155], v[136:139]
v_exp_f32 v8, v8
v_mfma_f32_16x16x32_bf16 v[40:43], a[148:151], v[156:159], v[40:43]
v_bfe_u32 v246, v1, 2, 2
v_lshl_add_u32 v241, v4, 3, v246
v_mfma_f32_16x16x32_bf16 v[40:43], a[152:155], v[160:163], v[40:43]
v_exp_f32 v9, v9
v_mfma_f32_16x16x32_bf16 v[40:43], a[156:159], v[164:167], v[40:43]
v_cvt_pk_bf16_f32 v88, v8, v9
v_lshl_add_u32 v246, v4, 2, v246
v_mfma_f32_16x16x32_bf16 v[48:51], a[156:159], v[180:183], v[140:143]
v_exp_f32 v10, v10
v_mfma_f32_16x16x32_bf16 v[48:51], a[152:155], v[176:179], v[48:51]
v_and_b32 v247, 3, v1
v_lshlrev_b32 v247, 3, v247
v_mfma_f32_16x16x32_bf16 v[48:51], a[148:151], v[172:175], v[48:51]
v_lshl_add_u32 v241, v241, 6, v247
v_mfma_f32_16x16x32_bf16 v[48:51], a[144:147], v[168:171], v[48:51]
v_exp_f32 v11, v11
v_mfma_f32_16x16x32_bf16 v[56:59], a[144:147], v[184:187], v[144:147]
s_and_b32 s28, s37, 1
v_cvt_pk_bf16_f32 v89, v10, v11
v_mfma_f32_16x16x32_bf16 v[56:59], a[148:151], v[188:191], v[56:59]
v_exp_f32 v12, v12
v_mfma_f32_16x16x32_bf16 v[56:59], a[152:155], v[192:195], v[56:59]
s_lshl_b32 s28, s28, 5
s_lshr_b32 s29, s37, 1
v_mfma_f32_16x16x32_bf16 v[56:59], a[156:159], v[196:199], v[56:59]
s_lshl_b32 s29, s29, 15
s_add_u32 s28, s28, s29
v_mfma_f32_16x16x32_bf16 v[64:67], a[156:159], v[212:215], v[148:151]
s_waitcnt vmcnt(13) lgkmcnt(0)
s_barrier
v_mfma_f32_16x16x32_bf16 v[64:67], a[152:155], v[208:211], v[64:67]
v_exp_f32 v13, v13
v_mfma_f32_16x16x32_bf16 v[64:67], a[148:151], v[204:207], v[64:67]
v_exp_f32 v14, v14
v_mfma_f32_16x16x32_bf16 v[64:67], a[144:147], v[200:203], v[64:67]
ds_read_b128 a[156:159], v219 offset:16384
v_cvt_pk_bf16_f32 v90, v12, v13
v_mfma_f32_16x16x32_bf16 a[0:3], v[72:75], a[212:215], a[0:3]
ds_read_b128 a[152:155], v218 offset:16384
ds_read_b128 a[148:151], v217 offset:16384
v_mfma_f32_16x16x32_bf16 a[0:3], v[104:107], a[176:179], a[0:3]
v_exp_f32 v15, v15
v_mfma_f32_16x16x32_bf16 a[4:7], v[108:111], a[176:179], a[4:7]
ds_read_b128 a[144:147], v216 offset:16384
v_cvt_pk_bf16_f32 v91, v14, v15
v_mfma_f32_16x16x32_bf16 a[4:7], v[76:79], a[212:215], a[4:7]
v_exp_f32 v16, v16
v_mfma_f32_16x16x32_bf16 a[8:11], v[80:83], a[212:215], a[8:11]
ds_read_b64_tr_b16 a[176:177], v220 offset:0
ds_read_b64_tr_b16 a[178:179], v220 offset:4096
v_mfma_f32_16x16x32_bf16 a[12:15], v[84:87], a[212:215], a[12:15]
s_add_u32 s32, s32, 16384
v_add_u32 v241, s28, v241
v_mfma_f32_16x16x32_bf16 a[28:31], v[84:87], a[216:219], a[28:31]
v_exp_f32 v17, v17
v_mfma_f32_16x16x32_bf16 a[24:27], v[80:83], a[216:219], a[24:27]
s_add_u32 m0, s30, 65536
v_cvt_pk_bf16_f32 v92, v16, v17
v_mfma_f32_16x16x32_bf16 a[20:23], v[76:79], a[216:219], a[20:23]
v_exp_f32 v18, v18
v_mfma_f32_16x16x32_bf16 a[20:23], v[108:111], a[180:183], a[20:23]
v_mul_u32_u24 v242, 0x480, v246
v_add_u32 v242, v242, v247
v_mfma_f32_16x16x32_bf16 a[16:19], v[104:107], a[180:183], a[16:19]
ds_read_b64_tr_b16 a[180:181], v221 offset:0
ds_read_b64_tr_b16 a[182:183], v221 offset:4096
v_mfma_f32_16x16x32_bf16 a[16:19], v[72:75], a[216:219], a[16:19]
v_exp_f32 v19, v19
v_mfma_f32_16x16x32_bf16 a[32:35], v[72:75], a[220:223], a[32:35]
s_mul_i32 s28, s37, 288
v_cvt_pk_bf16_f32 v93, v18, v19
v_mfma_f32_16x16x32_bf16 a[32:35], v[104:107], a[184:187], a[32:35]
v_exp_f32 v20, v20
v_mfma_f32_16x16x32_bf16 a[36:39], v[108:111], a[184:187], a[36:39]
ds_read_b64_tr_b16 a[184:185], v222 offset:0
ds_read_b64_tr_b16 a[186:187], v222 offset:4096
v_mfma_f32_16x16x32_bf16 a[36:39], v[76:79], a[220:223], a[36:39]
buffer_load_dwordx4 v228, s[8:11], s32 offen offset:0  lds
v_mfma_f32_16x16x32_bf16 a[40:43], v[80:83], a[220:223], a[40:43]
v_exp_f32 v21, v21
v_mfma_f32_16x16x32_bf16 a[44:47], v[84:87], a[220:223], a[44:47]
s_add_u32 s28, s28, 8192
v_cvt_pk_bf16_f32 v94, v20, v21
v_mfma_f32_16x16x32_bf16 a[60:63], v[84:87], a[224:227], a[60:63]
v_exp_f32 v22, v22
v_mfma_f32_16x16x32_bf16 a[56:59], v[80:83], a[224:227], a[56:59]
v_add_u32 v242, s28, v242
v_mfma_f32_16x16x32_bf16 a[52:55], v[76:79], a[224:227], a[52:55]
v_mfma_f32_16x16x32_bf16 a[52:55], v[108:111], a[188:191], a[52:55]
v_exp_f32 v23, v23
v_mfma_f32_16x16x32_bf16 a[48:51], v[104:107], a[188:191], a[48:51]
ds_read_b64_tr_b16 a[188:189], v223 offset:0
v_cvt_pk_bf16_f32 v95, v22, v23
v_mfma_f32_16x16x32_bf16 a[48:51], v[72:75], a[224:227], a[48:51]
v_exp_f32 v24, v24
v_mfma_f32_16x16x32_bf16 v[44:47], a[160:163], v[152:155], v[136:139]
ds_read_b64_tr_b16 a[190:191], v223 offset:4096
v_mfma_f32_16x16x32_bf16 v[44:47], a[164:167], v[156:159], v[44:47]
v_exp_f32 v25, v25
v_mfma_f32_16x16x32_bf16 v[44:47], a[168:171], v[160:163], v[44:47]
v_cvt_pk_bf16_f32 v96, v24, v25
v_mfma_f32_16x16x32_bf16 v[44:47], a[172:175], v[164:167], v[44:47]
buffer_load_dwordx4 v229, s[8:11], s32 offen offset:1024  lds
v_mfma_f32_16x16x32_bf16 v[52:55], a[172:175], v[180:183], v[140:143]
v_exp_f32 v26, v26
v_mfma_f32_16x16x32_bf16 v[52:55], a[168:171], v[176:179], v[52:55]
buffer_load_dwordx4 v230, s[8:11], s32 offen offset:2048  lds
v_mfma_f32_16x16x32_bf16 v[52:55], a[164:167], v[172:175], v[52:55]
v_exp_f32 v27, v27
v_mfma_f32_16x16x32_bf16 v[52:55], a[160:163], v[168:171], v[52:55]
v_cvt_pk_bf16_f32 v97, v26, v27
v_mfma_f32_16x16x32_bf16 v[60:63], a[160:163], v[184:187], v[144:147]
v_mfma_f32_16x16x32_bf16 v[60:63], a[164:167], v[188:191], v[60:63]
v_exp_f32 v28, v28
v_mfma_f32_16x16x32_bf16 v[60:63], a[168:171], v[192:195], v[60:63]
v_mfma_f32_16x16x32_bf16 v[60:63], a[172:175], v[196:199], v[60:63]
v_exp_f32 v29, v29
v_mfma_f32_16x16x32_bf16 v[68:71], a[172:175], v[212:215], v[148:151]
ds_read_b128 a[172:175], v219 offset:20480
v_cvt_pk_bf16_f32 v98, v28, v29
v_mfma_f32_16x16x32_bf16 v[68:71], a[168:171], v[208:211], v[68:71]
ds_read_b128 a[168:171], v218 offset:20480
v_mfma_f32_16x16x32_bf16 v[68:71], a[164:167], v[204:207], v[68:71]
v_exp_f32 v30, v30
v_mfma_f32_16x16x32_bf16 v[68:71], a[160:163], v[200:203], v[68:71]
ds_read_b128 a[164:167], v217 offset:20480
ds_read_b128 a[160:163], v216 offset:20480
v_mfma_f32_16x16x32_bf16 a[64:67], v[72:75], a[228:231], a[64:67]
v_exp_f32 v31, v31
v_mfma_f32_16x16x32_bf16 a[64:67], v[104:107], a[192:195], a[64:67]
v_cvt_pk_bf16_f32 v99, v30, v31
v_mfma_f32_16x16x32_bf16 a[68:71], v[108:111], a[192:195], a[68:71]
ds_read_b64_tr_b16 a[192:193], v224 offset:0
ds_read_b64_tr_b16 a[194:195], v224 offset:4096
v_mfma_f32_16x16x32_bf16 a[68:71], v[76:79], a[228:231], a[68:71]
v_exp_f32 v32, v32
v_mfma_f32_16x16x32_bf16 a[72:75], v[80:83], a[228:231], a[72:75]
buffer_load_dwordx4 v231, s[8:11], s32 offen offset:3072  lds
v_mfma_f32_16x16x32_bf16 a[76:79], v[84:87], a[228:231], a[76:79]
v_exp_f32 v33, v33
v_mfma_f32_16x16x32_bf16 a[92:95], v[84:87], a[232:235], a[92:95]
v_cvt_pk_bf16_f32 v100, v32, v33
v_mfma_f32_16x16x32_bf16 a[88:91], v[80:83], a[232:235], a[88:91]
s_add_u32 m0, s86, 16384
s_add_u32 s50, s84, 2359296
buffer_load_dwordx4 v240, s[64:67], s50 offen lds
v_mfma_f32_16x16x32_bf16 a[84:87], v[76:79], a[232:235], a[84:87]
v_exp_f32 v34, v34
v_mfma_f32_16x16x32_bf16 a[84:87], v[108:111], a[196:199], a[84:87]
v_mfma_f32_16x16x32_bf16 a[80:83], v[104:107], a[196:199], a[80:83]
v_exp_f32 v35, v35
v_mfma_f32_16x16x32_bf16 a[80:83], v[72:75], a[232:235], a[80:83]
ds_read_b64_tr_b16 a[196:197], v225 offset:0
v_cvt_pk_bf16_f32 v101, v34, v35
v_mfma_f32_16x16x32_bf16 a[96:99], v[72:75], a[236:239], a[96:99]
ds_read_b64_tr_b16 a[198:199], v225 offset:4096
v_mfma_f32_16x16x32_bf16 a[96:99], v[104:107], a[200:203], a[96:99]
v_exp_f32 v36, v36
v_mfma_f32_16x16x32_bf16 a[100:103], v[108:111], a[200:203], a[100:103]
ds_read_b64_tr_b16 a[200:201], v226 offset:0
ds_read_b64_tr_b16 a[202:203], v226 offset:4096
v_mfma_f32_16x16x32_bf16 a[100:103], v[76:79], a[236:239], a[100:103]
v_exp_f32 v37, v37
v_mfma_f32_16x16x32_bf16 a[104:107], v[80:83], a[236:239], a[104:107]
v_cvt_pk_bf16_f32 v102, v36, v37
v_mfma_f32_16x16x32_bf16 a[108:111], v[84:87], a[236:239], a[108:111]
s_add_u32 m0, s86, 20480
s_add_u32 s50, s84, 2949120
buffer_load_dwordx4 v240, s[64:67], s50 offen lds
v_mfma_f32_16x16x32_bf16 a[124:127], v[84:87], a[240:243], a[124:127]
v_exp_f32 v38, v38
v_mfma_f32_16x16x32_bf16 a[120:123], v[80:83], a[240:243], a[120:123]
v_mfma_f32_16x16x32_bf16 a[116:119], v[76:79], a[240:243], a[116:119]
v_exp_f32 v39, v39
v_mfma_f32_16x16x32_bf16 a[116:119], v[108:111], a[204:207], a[116:119]
v_cvt_pk_bf16_f32 v103, v38, v39
v_mfma_f32_16x16x32_bf16 a[112:115], v[104:107], a[204:207], a[112:115]
ds_read_b64_tr_b16 a[204:205], v227 offset:0
ds_read_b64_tr_b16 a[206:207], v227 offset:4096
v_mfma_f32_16x16x32_bf16 a[112:115], v[72:75], a[240:243], a[112:115]
v_smfmac_f32_16x16x64_bf16 a[128:131], a[208:211], v[72:79], v245
v_smfmac_f32_16x16x64_bf16 a[128:131], a[208:211], v[104:111], v245
v_smfmac_f32_16x16x64_bf16 a[132:135], a[208:211], v[80:87], v245
s_waitcnt lgkmcnt(8)
v_mfma_f32_16x16x32_bf16 v[8:11], a[144:147], v[152:155], v[136:139]
v_exp_f32 v40, v40
v_mfma_f32_16x16x32_bf16 v[8:11], a[148:151], v[156:159], v[8:11]
v_exp_f32 v41, v41
v_mfma_f32_16x16x32_bf16 v[8:11], a[152:155], v[160:163], v[8:11]
v_cvt_pk_bf16_f32 v72, v40, v41
v_mfma_f32_16x16x32_bf16 v[8:11], a[156:159], v[164:167], v[8:11]
v_exp_f32 v42, v42
v_mfma_f32_16x16x32_bf16 v[16:19], a[156:159], v[180:183], v[140:143]
s_add_u32 s39, s39, 16384
v_mfma_f32_16x16x32_bf16 v[16:19], a[152:155], v[176:179], v[16:19]
v_exp_f32 v43, v43
v_mfma_f32_16x16x32_bf16 v[16:19], a[148:151], v[172:175], v[16:19]
v_cvt_pk_bf16_f32 v73, v42, v43
v_mfma_f32_16x16x32_bf16 v[16:19], a[144:147], v[168:171], v[16:19]
v_exp_f32 v44, v44
v_mfma_f32_16x16x32_bf16 v[24:27], a[144:147], v[184:187], v[144:147]
v_mfma_f32_16x16x32_bf16 v[24:27], a[148:151], v[188:191], v[24:27]
v_exp_f32 v45, v45
v_mfma_f32_16x16x32_bf16 v[24:27], a[152:155], v[192:195], v[24:27]
s_add_u32 m0, s30, 147456
v_cvt_pk_bf16_f32 v74, v44, v45
v_mfma_f32_16x16x32_bf16 v[24:27], a[156:159], v[196:199], v[24:27]
v_exp_f32 v46, v46
v_mfma_f32_16x16x32_bf16 v[32:35], a[156:159], v[212:215], v[148:151]
ds_read_b128 a[156:159], v219 offset:24576
v_mfma_f32_16x16x32_bf16 v[32:35], a[152:155], v[208:211], v[32:35]
v_exp_f32 v47, v47
v_mfma_f32_16x16x32_bf16 v[32:35], a[148:151], v[204:207], v[32:35]
ds_read_b128 a[152:155], v218 offset:24576
v_cvt_pk_bf16_f32 v75, v46, v47
v_mfma_f32_16x16x32_bf16 v[32:35], a[144:147], v[200:203], v[32:35]
v_exp_f32 v48, v48
v_mfma_f32_16x16x32_bf16 a[0:3], v[88:91], a[176:179], a[0:3]
ds_read_b128 a[148:151], v217 offset:24576
ds_read_b128 a[144:147], v216 offset:24576
v_mfma_f32_16x16x32_bf16 a[4:7], v[92:95], a[176:179], a[4:7]
v_exp_f32 v49, v49
v_mfma_f32_16x16x32_bf16 a[8:11], v[96:99], a[176:179], a[8:11]
v_cvt_pk_bf16_f32 v76, v48, v49
v_mfma_f32_16x16x32_bf16 a[12:15], v[100:103], a[176:179], a[12:15]
v_exp_f32 v50, v50
v_mfma_f32_16x16x32_bf16 a[28:31], v[100:103], a[180:183], a[28:31]
ds_read_b64_tr_b16 a[176:177], v220 offset:8192
ds_read_b64_tr_b16 a[178:179], v220 offset:12288
v_mfma_f32_16x16x32_bf16 a[24:27], v[96:99], a[180:183], a[24:27]
v_exp_f32 v51, v51
v_mfma_f32_16x16x32_bf16 a[20:23], v[92:95], a[180:183], a[20:23]
v_cvt_pk_bf16_f32 v77, v50, v51
v_mfma_f32_16x16x32_bf16 a[16:19], v[88:91], a[180:183], a[16:19]
v_exp_f32 v52, v52
v_mfma_f32_16x16x32_bf16 a[32:35], v[88:91], a[184:187], a[32:35]
ds_read_b64_tr_b16 a[180:181], v221 offset:8192
ds_read_b64_tr_b16 a[182:183], v221 offset:12288
v_mfma_f32_16x16x32_bf16 a[36:39], v[92:95], a[184:187], a[36:39]
v_exp_f32 v53, v53
v_mfma_f32_16x16x32_bf16 a[40:43], v[96:99], a[184:187], a[40:43]
v_cvt_pk_bf16_f32 v78, v52, v53
v_mfma_f32_16x16x32_bf16 a[44:47], v[100:103], a[184:187], a[44:47]
v_exp_f32 v54, v54
v_mfma_f32_16x16x32_bf16 a[60:63], v[100:103], a[188:191], a[60:63]
ds_read_b64_tr_b16 a[184:185], v222 offset:8192
ds_read_b64_tr_b16 a[186:187], v222 offset:12288
v_mfma_f32_16x16x32_bf16 a[56:59], v[96:99], a[188:191], a[56:59]
v_exp_f32 v55, v55
v_mfma_f32_16x16x32_bf16 a[52:55], v[92:95], a[188:191], a[52:55]
v_cvt_pk_bf16_f32 v79, v54, v55
v_mfma_f32_16x16x32_bf16 a[48:51], v[88:91], a[188:191], a[48:51]
v_exp_f32 v56, v56
v_mfma_f32_16x16x32_bf16 v[12:15], a[160:163], v[152:155], v[136:139]
v_exp_f32 v57, v57
v_mfma_f32_16x16x32_bf16 v[12:15], a[164:167], v[156:159], v[12:15]
ds_read_b64_tr_b16 a[188:189], v223 offset:8192
v_cvt_pk_bf16_f32 v80, v56, v57
v_mfma_f32_16x16x32_bf16 v[12:15], a[168:171], v[160:163], v[12:15]
v_exp_f32 v58, v58
v_mfma_f32_16x16x32_bf16 v[12:15], a[172:175], v[164:167], v[12:15]
ds_read_b64_tr_b16 a[190:191], v223 offset:12288
v_mfma_f32_16x16x32_bf16 v[20:23], a[172:175], v[180:183], v[140:143]
v_exp_f32 v59, v59
v_mfma_f32_16x16x32_bf16 v[20:23], a[168:171], v[176:179], v[20:23]
v_cvt_pk_bf16_f32 v81, v58, v59
v_mfma_f32_16x16x32_bf16 v[20:23], a[164:167], v[172:175], v[20:23]
v_exp_f32 v60, v60
v_mfma_f32_16x16x32_bf16 v[20:23], a[160:163], v[168:171], v[20:23]
buffer_load_dwordx4 v232, s[12:15], s39 offen offset:0  lds
v_mfma_f32_16x16x32_bf16 v[28:31], a[160:163], v[184:187], v[144:147]
v_exp_f32 v61, v61
v_mfma_f32_16x16x32_bf16 v[28:31], a[164:167], v[188:191], v[28:31]
v_cvt_pk_bf16_f32 v82, v60, v61
v_mfma_f32_16x16x32_bf16 v[28:31], a[168:171], v[192:195], v[28:31]
v_exp_f32 v62, v62
v_mfma_f32_16x16x32_bf16 v[28:31], a[172:175], v[196:199], v[28:31]
buffer_load_dwordx4 v233, s[12:15], s39 offen offset:1024  lds
v_mfma_f32_16x16x32_bf16 v[36:39], a[172:175], v[212:215], v[148:151]
v_exp_f32 v63, v63
v_mfma_f32_16x16x32_bf16 v[36:39], a[168:171], v[208:211], v[36:39]
ds_read_b128 a[172:175], v219 offset:28672
v_cvt_pk_bf16_f32 v83, v62, v63
v_mfma_f32_16x16x32_bf16 v[36:39], a[164:167], v[204:207], v[36:39]
v_exp_f32 v64, v64
v_mfma_f32_16x16x32_bf16 v[36:39], a[160:163], v[200:203], v[36:39]
ds_read_b128 a[168:171], v218 offset:28672
ds_read_b128 a[164:167], v217 offset:28672
s_waitcnt lgkmcnt(8)
v_mfma_f32_16x16x32_bf16 a[64:67], v[88:91], a[192:195], a[64:67]
v_exp_f32 v65, v65
v_mfma_f32_16x16x32_bf16 a[68:71], v[92:95], a[192:195], a[68:71]
ds_read_b128 a[160:163], v216 offset:28672
v_cvt_pk_bf16_f32 v84, v64, v65
v_mfma_f32_16x16x32_bf16 a[72:75], v[96:99], a[192:195], a[72:75]
v_exp_f32 v66, v66
v_mfma_f32_16x16x32_bf16 a[76:79], v[100:103], a[192:195], a[76:79]
ds_read_b64_tr_b16 a[192:193], v224 offset:8192
ds_read_b64_tr_b16 a[194:195], v224 offset:12288
v_mfma_f32_16x16x32_bf16 a[92:95], v[100:103], a[196:199], a[92:95]
v_exp_f32 v67, v67
v_mfma_f32_16x16x32_bf16 a[88:91], v[96:99], a[196:199], a[88:91]
v_cvt_pk_bf16_f32 v85, v66, v67
v_mfma_f32_16x16x32_bf16 a[84:87], v[92:95], a[196:199], a[84:87]
v_exp_f32 v68, v68
v_mfma_f32_16x16x32_bf16 a[80:83], v[88:91], a[196:199], a[80:83]
ds_read_b64_tr_b16 a[196:197], v225 offset:8192
ds_read_b64_tr_b16 a[198:199], v225 offset:12288
v_mfma_f32_16x16x32_bf16 a[96:99], v[88:91], a[200:203], a[96:99]
v_exp_f32 v69, v69
v_mfma_f32_16x16x32_bf16 a[100:103], v[92:95], a[200:203], a[100:103]
v_cvt_pk_bf16_f32 v86, v68, v69
v_mfma_f32_16x16x32_bf16 a[104:107], v[96:99], a[200:203], a[104:107]
v_exp_f32 v70, v70
v_mfma_f32_16x16x32_bf16 a[108:111], v[100:103], a[200:203], a[108:111]
ds_read_b64_tr_b16 a[200:201], v226 offset:8192
ds_read_b64_tr_b16 a[202:203], v226 offset:12288
v_mfma_f32_16x16x32_bf16 a[124:127], v[100:103], a[204:207], a[124:127]
v_exp_f32 v71, v71
v_mfma_f32_16x16x32_bf16 a[120:123], v[96:99], a[204:207], a[120:123]
v_cvt_pk_bf16_f32 v87, v70, v71
v_mfma_f32_16x16x32_bf16 a[116:119], v[92:95], a[204:207], a[116:119]
buffer_load_dwordx4 v232, s[12:15], s39 offen offset:2048  lds
v_mfma_f32_16x16x32_bf16 a[112:115], v[88:91], a[204:207], a[112:115]
ds_read_b64_tr_b16 a[204:205], v227 offset:8192
ds_read_b64_tr_b16 a[206:207], v227 offset:12288
v_smfmac_f32_16x16x64_bf16 a[128:131], a[208:211], v[88:95], v245
buffer_load_dwordx4 v233, s[12:15], s39 offen offset:3072  lds
v_smfmac_f32_16x16x64_bf16 a[132:135], a[208:211], v[96:103], v245
s_add_u32 m0, s86, 24576
s_add_u32 s50, s84, 3538944
buffer_load_dwordx4 v240, s[64:67], s50 offen lds
s_add_u32 m0, s86, 28672
s_add_u32 s50, s84, 4128768
buffer_load_dwordx4 v240, s[64:67], s50 offen lds
v_mfma_f32_16x16x32_bf16 v[40:43], a[144:147], v[152:155], v[136:139]
v_exp_f32 v8, v8
v_mfma_f32_16x16x32_bf16 v[40:43], a[148:151], v[156:159], v[40:43]
v_exp_f32 v9, v9
v_mfma_f32_16x16x32_bf16 v[40:43], a[152:155], v[160:163], v[40:43]
v_cvt_pk_bf16_f32 v88, v8, v9
v_mfma_f32_16x16x32_bf16 v[40:43], a[156:159], v[164:167], v[40:43]
v_exp_f32 v10, v10
v_mfma_f32_16x16x32_bf16 v[48:51], a[156:159], v[180:183], v[140:143]
v_mfma_f32_16x16x32_bf16 v[48:51], a[152:155], v[176:179], v[48:51]
v_exp_f32 v11, v11
v_mfma_f32_16x16x32_bf16 v[48:51], a[148:151], v[172:175], v[48:51]
v_cvt_pk_bf16_f32 v89, v10, v11
v_mfma_f32_16x16x32_bf16 v[48:51], a[144:147], v[168:171], v[48:51]
v_exp_f32 v12, v12
v_mfma_f32_16x16x32_bf16 v[56:59], a[144:147], v[184:187], v[144:147]
v_mfma_f32_16x16x32_bf16 v[56:59], a[148:151], v[188:191], v[56:59]
v_exp_f32 v13, v13
v_mfma_f32_16x16x32_bf16 v[56:59], a[152:155], v[192:195], v[56:59]
v_cvt_pk_bf16_f32 v90, v12, v13
v_mfma_f32_16x16x32_bf16 v[56:59], a[156:159], v[196:199], v[56:59]
v_exp_f32 v14, v14
v_mfma_f32_16x16x32_bf16 v[64:67], a[156:159], v[212:215], v[148:151]
s_waitcnt vmcnt(12) lgkmcnt(0)
s_barrier
v_mfma_f32_16x16x32_bf16 v[64:67], a[152:155], v[208:211], v[64:67]
v_exp_f32 v15, v15
v_mfma_f32_16x16x32_bf16 v[64:67], a[148:151], v[204:207], v[64:67]
ds_read_b128 a[156:159], v219 offset:49152
v_cvt_pk_bf16_f32 v91, v14, v15
v_mfma_f32_16x16x32_bf16 v[64:67], a[144:147], v[200:203], v[64:67]
v_exp_f32 v16, v16
v_mfma_f32_16x16x32_bf16 a[0:3], v[72:75], a[176:179], a[0:3]
ds_read_b128 a[152:155], v218 offset:49152
ds_read_b128 a[148:151], v217 offset:49152
v_mfma_f32_16x16x32_bf16 a[4:7], v[76:79], a[176:179], a[4:7]
v_exp_f32 v17, v17
v_mfma_f32_16x16x32_bf16 a[8:11], v[80:83], a[176:179], a[8:11]
ds_read_b128 a[144:147], v216 offset:49152
v_cvt_pk_bf16_f32 v92, v16, v17
v_mfma_f32_16x16x32_bf16 a[12:15], v[84:87], a[176:179], a[12:15]
v_exp_f32 v18, v18
v_mfma_f32_16x16x32_bf16 a[28:31], v[84:87], a[180:183], a[28:31]
ds_read_b64_tr_b16 a[176:177], v220 offset:32768
ds_read_b64_tr_b16 a[178:179], v220 offset:36864
v_mfma_f32_16x16x32_bf16 a[24:27], v[80:83], a[180:183], a[24:27]
v_exp_f32 v19, v19
v_mfma_f32_16x16x32_bf16 a[20:23], v[76:79], a[180:183], a[20:23]
s_add_u32 s32, s32, 16384
v_cvt_pk_bf16_f32 v93, v18, v19
v_mfma_f32_16x16x32_bf16 a[16:19], v[72:75], a[180:183], a[16:19]
v_exp_f32 v20, v20
v_mfma_f32_16x16x32_bf16 a[32:35], v[72:75], a[184:187], a[32:35]
ds_read_b64_tr_b16 a[180:181], v221 offset:32768
ds_read_b64_tr_b16 a[182:183], v221 offset:36864
v_mfma_f32_16x16x32_bf16 a[36:39], v[76:79], a[184:187], a[36:39]
v_exp_f32 v21, v21
v_mfma_f32_16x16x32_bf16 a[40:43], v[80:83], a[184:187], a[40:43]
s_add_u32 m0, s30, 81920
v_cvt_pk_bf16_f32 v94, v20, v21
v_mfma_f32_16x16x32_bf16 a[44:47], v[84:87], a[184:187], a[44:47]
v_exp_f32 v22, v22
v_mfma_f32_16x16x32_bf16 a[60:63], v[84:87], a[188:191], a[60:63]
ds_read_b64_tr_b16 a[184:185], v222 offset:32768
ds_read_b64_tr_b16 a[186:187], v222 offset:36864
v_mfma_f32_16x16x32_bf16 a[56:59], v[80:83], a[188:191], a[56:59]
v_exp_f32 v23, v23
v_mfma_f32_16x16x32_bf16 a[52:55], v[76:79], a[188:191], a[52:55]
v_cvt_pk_bf16_f32 v95, v22, v23
v_mfma_f32_16x16x32_bf16 a[48:51], v[72:75], a[188:191], a[48:51]
v_exp_f32 v24, v24
v_mfma_f32_16x16x32_bf16 v[44:47], a[160:163], v[152:155], v[136:139]
v_exp_f32 v25, v25
v_mfma_f32_16x16x32_bf16 v[44:47], a[164:167], v[156:159], v[44:47]
ds_read_b64_tr_b16 a[188:189], v223 offset:32768
v_cvt_pk_bf16_f32 v96, v24, v25
v_mfma_f32_16x16x32_bf16 v[44:47], a[168:171], v[160:163], v[44:47]
v_exp_f32 v26, v26
v_mfma_f32_16x16x32_bf16 v[44:47], a[172:175], v[164:167], v[44:47]
ds_read_b64_tr_b16 a[190:191], v223 offset:36864
v_mfma_f32_16x16x32_bf16 v[52:55], a[172:175], v[180:183], v[140:143]
v_exp_f32 v27, v27
v_mfma_f32_16x16x32_bf16 v[52:55], a[168:171], v[176:179], v[52:55]
v_cvt_pk_bf16_f32 v97, v26, v27
v_mfma_f32_16x16x32_bf16 v[52:55], a[164:167], v[172:175], v[52:55]
v_exp_f32 v28, v28
v_mfma_f32_16x16x32_bf16 v[52:55], a[160:163], v[168:171], v[52:55]
buffer_load_dwordx4 v228, s[8:11], s32 offen offset:0  lds
v_mfma_f32_16x16x32_bf16 v[60:63], a[160:163], v[184:187], v[144:147]
v_exp_f32 v29, v29
v_mfma_f32_16x16x32_bf16 v[60:63], a[164:167], v[188:191], v[60:63]
v_cmp_ne_u32 vcc, s47, v249
s_cbranch_vccnz SP_CAND
SP_CAND_RET:
v_cvt_pk_bf16_f32 v98, v28, v29
v_mfma_f32_16x16x32_bf16 v[60:63], a[168:171], v[192:195], v[60:63]
v_exp_f32 v30, v30
v_mfma_f32_16x16x32_bf16 v[60:63], a[172:175], v[196:199], v[60:63]
buffer_load_dwordx4 v229, s[8:11], s32 offen offset:1024  lds
v_mfma_f32_16x16x32_bf16 v[68:71], a[172:175], v[212:215], v[148:151]
v_exp_f32 v31, v31
v_mfma_f32_16x16x32_bf16 v[68:71], a[168:171], v[208:211], v[68:71]
ds_read_b128 a[172:175], v219 offset:53248
v_cvt_pk_bf16_f32 v99, v30, v31
v_mfma_f32_16x16x32_bf16 v[68:71], a[164:167], v[204:207], v[68:71]
v_exp_f32 v32, v32
v_mfma_f32_16x16x32_bf16 v[68:71], a[160:163], v[200:203], v[68:71]
ds_read_b128 a[168:171], v218 offset:53248
ds_read_b128 a[164:167], v217 offset:53248
v_mfma_f32_16x16x32_bf16 a[64:67], v[72:75], a[192:195], a[64:67]
v_mov_b32 v251, 0
v_exp_f32 v33, v33
v_mfma_f32_16x16x32_bf16 a[68:71], v[76:79], a[192:195], a[68:71]
ds_read_b128 a[160:163], v216 offset:53248
v_cvt_pk_bf16_f32 v100, v32, v33
v_mfma_f32_16x16x32_bf16 a[72:75], v[80:83], a[192:195], a[72:75]
v_exp_f32 v34, v34
v_mfma_f32_16x16x32_bf16 a[76:79], v[84:87], a[192:195], a[76:79]
ds_read_b64_tr_b16 a[192:193], v224 offset:32768
ds_read_b64_tr_b16 a[194:195], v224 offset:36864
v_mfma_f32_16x16x32_bf16 a[92:95], v[84:87], a[196:199], a[92:95]
v_exp_f32 v35, v35
v_mfma_f32_16x16x32_bf16 a[88:91], v[80:83], a[196:199], a[88:91]
s_mov_b32 s90, 0x01010101
s_mov_b32 s91, 0x01010101
v_cvt_pk_bf16_f32 v101, v34, v35
v_mfma_f32_16x16x32_bf16 a[84:87], v[76:79], a[196:199], a[84:87]
v_exp_f32 v36, v36
v_mfma_f32_16x16x32_bf16 a[80:83], v[72:75], a[196:199], a[80:83]
ds_read_b64_tr_b16 a[196:197], v225 offset:32768
ds_read_b64_tr_b16 a[198:199], v225 offset:36864
v_mfma_f32_16x16x32_bf16 a[96:99], v[72:75], a[200:203], a[96:99]
v_exp_f32 v37, v37
v_mfma_f32_16x16x32_bf16 a[100:103], v[76:79], a[200:203], a[100:103]
v_cvt_pk_bf16_f32 v102, v36, v37
v_max_u32_dpp v250, v248, v248 row_ror:8 row_mask:0xf bank_mask:0xf
v_mfma_f32_16x16x32_bf16 a[104:107], v[80:83], a[200:203], a[104:107]
v_exp_f32 v38, v38
v_mfma_f32_16x16x32_bf16 a[108:111], v[84:87], a[200:203], a[108:111]
ds_read_b64_tr_b16 a[200:201], v226 offset:32768
ds_read_b64_tr_b16 a[202:203], v226 offset:36864
v_mfma_f32_16x16x32_bf16 a[124:127], v[84:87], a[204:207], a[124:127]
v_exp_f32 v39, v39
v_mfma_f32_16x16x32_bf16 a[120:123], v[80:83], a[204:207], a[120:123]
v_cvt_pk_bf16_f32 v103, v38, v39
v_max_u32_dpp v249, v250, v250 row_ror:4 row_mask:0xf bank_mask:0xf
v_mfma_f32_16x16x32_bf16 a[116:119], v[76:79], a[204:207], a[116:119]
buffer_load_dwordx4 v230, s[8:11], s32 offen offset:2048  lds
v_mfma_f32_16x16x32_bf16 a[112:115], v[72:75], a[204:207], a[112:115]
ds_read_b64_tr_b16 a[204:205], v227 offset:32768
ds_read_b64_tr_b16 a[206:207], v227 offset:36864
v_smfmac_f32_16x16x64_bf16 a[128:131], a[208:211], v[72:79], v245
buffer_load_dwordx4 v231, s[8:11], s32 offen offset:3072  lds
v_smfmac_f32_16x16x64_bf16 a[132:135], a[208:211], v[80:87], v245
s_add_u32 m0, s86, 32768
s_add_u32 s50, s84, 0
buffer_load_dwordx4 v240, s[68:71], s50 offen lds
s_add_u32 m0, s86, 36864
s_add_u32 s50, s84, 589824
buffer_load_dwordx4 v240, s[68:71], s50 offen lds
s_waitcnt lgkmcnt(8)
v_mfma_f32_16x16x32_bf16 v[8:11], a[144:147], v[152:155], v[136:139]
v_exp_f32 v40, v40
v_mfma_f32_16x16x32_bf16 v[8:11], a[148:151], v[156:159], v[8:11]
v_exp_f32 v41, v41
v_mfma_f32_16x16x32_bf16 v[8:11], a[152:155], v[160:163], v[8:11]
v_cvt_pk_bf16_f32 v72, v40, v41
v_max_u32_dpp v250, v249, v249 row_ror:2 row_mask:0xf bank_mask:0xf
STUB_5:
s_cbranch_execz STUB_8
v_mfma_f32_16x16x32_bf16 v[8:11], a[156:159], v[164:167], v[8:11]
v_exp_f32 v42, v42
v_mfma_f32_16x16x32_bf16 v[16:19], a[156:159], v[180:183], v[140:143]
s_add_u32 s39, s39, 16384
v_max_u32_dpp v249, v250, v250 row_ror:1 row_mask:0xf bank_mask:0xf
v_mfma_f32_16x16x32_bf16 v[16:19], a[152:155], v[176:179], v[16:19]
v_exp_f32 v43, v43
v_mfma_f32_16x16x32_bf16 v[16:19], a[148:151], v[172:175], v[16:19]
v_cvt_pk_bf16_f32 v73, v42, v43
v_mov_b32 v250, v249
v_mfma_f32_16x16x32_bf16 v[16:19], a[144:147], v[168:171], v[16:19]
v_exp_f32 v44, v44
v_mfma_f32_16x16x32_bf16 v[24:27], a[144:147], v[184:187], v[144:147]
v_permlane16_swap_b32 v249, v250
v_max_u32 v249, v249, v250
v_mfma_f32_16x16x32_bf16 v[24:27], a[148:151], v[188:191], v[24:27]
v_exp_f32 v45, v45
v_mfma_f32_16x16x32_bf16 v[24:27], a[152:155], v[192:195], v[24:27]
s_add_u32 m0, s30, 98304
v_cvt_pk_bf16_f32 v74, v44, v45
v_mfma_f32_16x16x32_bf16 v[24:27], a[156:159], v[196:199], v[24:27]
v_exp_f32 v46, v46
v_mfma_f32_16x16x32_bf16 v[32:35], a[156:159], v[212:215], v[148:151]
ds_read_b128 a[156:159], v219 offset:57344
v_mov_b32 v250, v249
v_mfma_f32_16x16x32_bf16 v[32:35], a[152:155], v[208:211], v[32:35]
v_exp_f32 v47, v47
v_mfma_f32_16x16x32_bf16 v[32:35], a[148:151], v[204:207], v[32:35]
ds_read_b128 a[152:155], v218 offset:57344
v_cvt_pk_bf16_f32 v75, v46, v47
v_mfma_f32_16x16x32_bf16 v[32:35], a[144:147], v[200:203], v[32:35]
v_exp_f32 v48, v48
v_mfma_f32_16x16x32_bf16 a[0:3], v[88:91], a[176:179], a[0:3]
ds_read_b128 a[148:151], v217 offset:57344
ds_read_b128 a[144:147], v216 offset:57344
v_mfma_f32_16x16x32_bf16 a[4:7], v[92:95], a[176:179], a[4:7]
v_exp_f32 v49, v49
v_mfma_f32_16x16x32_bf16 a[8:11], v[96:99], a[176:179], a[8:11]
v_cvt_pk_bf16_f32 v76, v48, v49
v_permlane32_swap_b32 v249, v250
v_mfma_f32_16x16x32_bf16 a[12:15], v[100:103], a[176:179], a[12:15]
v_exp_f32 v50, v50
v_mfma_f32_16x16x32_bf16 a[28:31], v[100:103], a[180:183], a[28:31]
ds_read_b64_tr_b16 a[176:177], v220 offset:40960
ds_read_b64_tr_b16 a[178:179], v220 offset:45056
v_mfma_f32_16x16x32_bf16 a[24:27], v[96:99], a[180:183], a[24:27]
v_exp_f32 v51, v51
v_mfma_f32_16x16x32_bf16 a[20:23], v[92:95], a[180:183], a[20:23]
v_cvt_pk_bf16_f32 v77, v50, v51
v_max_u32 v249, v249, v250
v_mfma_f32_16x16x32_bf16 a[16:19], v[88:91], a[180:183], a[16:19]
v_exp_f32 v52, v52
v_mfma_f32_16x16x32_bf16 a[32:35], v[88:91], a[184:187], a[32:35]
ds_read_b64_tr_b16 a[180:181], v221 offset:40960
ds_read_b64_tr_b16 a[182:183], v221 offset:45056
v_mfma_f32_16x16x32_bf16 a[36:39], v[92:95], a[184:187], a[36:39]
v_exp_f32 v53, v53
v_mfma_f32_16x16x32_bf16 a[40:43], v[96:99], a[184:187], a[40:43]
v_cvt_pk_bf16_f32 v78, v52, v53
v_add_u32 v251, v251, v249
v_mfma_f32_16x16x32_bf16 a[44:47], v[100:103], a[184:187], a[44:47]
v_exp_f32 v54, v54
v_mfma_f32_16x16x32_bf16 a[60:63], v[100:103], a[188:191], a[60:63]
ds_read_b64_tr_b16 a[184:185], v222 offset:40960
ds_read_b64_tr_b16 a[186:187], v222 offset:45056
v_mfma_f32_16x16x32_bf16 a[56:59], v[96:99], a[188:191], a[56:59]
v_exp_f32 v55, v55
v_mfma_f32_16x16x32_bf16 a[52:55], v[92:95], a[188:191], a[52:55]
v_cvt_pk_bf16_f32 v79, v54, v55
v_sub_u32 v248, v248, v249
v_mfma_f32_16x16x32_bf16 a[48:51], v[88:91], a[188:191], a[48:51]
v_exp_f32 v56, v56
v_mfma_f32_16x16x32_bf16 v[12:15], a[160:163], v[152:155], v[136:139]
v_exp_f32 v57, v57
v_mfma_f32_16x16x32_bf16 v[12:15], a[164:167], v[156:159], v[12:15]
ds_read_b64_tr_b16 a[188:189], v223 offset:40960
v_cvt_pk_bf16_f32 v80, v56, v57
v_mfma_f32_16x16x32_bf16 v[12:15], a[168:171], v[160:163], v[12:15]
v_exp_f32 v58, v58
v_mfma_f32_16x16x32_bf16 v[12:15], a[172:175], v[164:167], v[12:15]
ds_read_b64_tr_b16 a[190:191], v223 offset:45056
v_cndmask_b32 v252, v252, v251, s[90:91]
v_mfma_f32_16x16x32_bf16 v[20:23], a[172:175], v[180:183], v[140:143]
v_exp_f32 v59, v59
v_mfma_f32_16x16x32_bf16 v[20:23], a[168:171], v[176:179], v[20:23]
s_lshl_b64 s[90:91], s[90:91], 1
v_cvt_pk_bf16_f32 v81, v58, v59
v_mfma_f32_16x16x32_bf16 v[20:23], a[164:167], v[172:175], v[20:23]
v_exp_f32 v60, v60
v_mfma_f32_16x16x32_bf16 v[20:23], a[160:163], v[168:171], v[20:23]
buffer_load_dwordx4 v232, s[12:15], s39 offen offset:0  lds
v_mfma_f32_16x16x32_bf16 v[28:31], a[160:163], v[184:187], v[144:147]
v_exp_f32 v61, v61
v_mfma_f32_16x16x32_bf16 v[28:31], a[164:167], v[188:191], v[28:31]
v_cvt_pk_bf16_f32 v82, v60, v61
v_max_u32_dpp v250, v248, v248 row_ror:8 row_mask:0xf bank_mask:0xf
v_mfma_f32_16x16x32_bf16 v[28:31], a[168:171], v[192:195], v[28:31]
v_exp_f32 v62, v62
v_mfma_f32_16x16x32_bf16 v[28:31], a[172:175], v[196:199], v[28:31]
buffer_load_dwordx4 v233, s[12:15], s39 offen offset:1024  lds
v_mfma_f32_16x16x32_bf16 v[36:39], a[172:175], v[212:215], v[148:151]
v_exp_f32 v63, v63
v_mfma_f32_16x16x32_bf16 v[36:39], a[168:171], v[208:211], v[36:39]
ds_read_b128 a[172:175], v219 offset:61440
v_cvt_pk_bf16_f32 v83, v62, v63
v_mfma_f32_16x16x32_bf16 v[36:39], a[164:167], v[204:207], v[36:39]
v_exp_f32 v64, v64
v_mfma_f32_16x16x32_bf16 v[36:39], a[160:163], v[200:203], v[36:39]
ds_read_b128 a[168:171], v218 offset:61440
ds_read_b128 a[164:167], v217 offset:61440
s_waitcnt lgkmcnt(8)
v_mfma_f32_16x16x32_bf16 a[64:67], v[88:91], a[192:195], a[64:67]
v_exp_f32 v65, v65
v_mfma_f32_16x16x32_bf16 a[68:71], v[92:95], a[192:195], a[68:71]
ds_read_b128 a[160:163], v216 offset:61440
v_cvt_pk_bf16_f32 v84, v64, v65
v_mfma_f32_16x16x32_bf16 a[72:75], v[96:99], a[192:195], a[72:75]
v_exp_f32 v66, v66
v_mfma_f32_16x16x32_bf16 a[76:79], v[100:103], a[192:195], a[76:79]
ds_read_b64_tr_b16 a[192:193], v224 offset:40960
ds_read_b64_tr_b16 a[194:195], v224 offset:45056
v_mfma_f32_16x16x32_bf16 a[92:95], v[100:103], a[196:199], a[92:95]
v_exp_f32 v67, v67
v_mfma_f32_16x16x32_bf16 a[88:91], v[96:99], a[196:199], a[88:91]
v_cvt_pk_bf16_f32 v85, v66, v67
v_max_u32_dpp v249, v250, v250 row_ror:4 row_mask:0xf bank_mask:0xf
v_mfma_f32_16x16x32_bf16 a[84:87], v[92:95], a[196:199], a[84:87]
v_exp_f32 v68, v68
v_mfma_f32_16x16x32_bf16 a[80:83], v[88:91], a[196:199], a[80:83]
ds_read_b64_tr_b16 a[196:197], v225 offset:40960
ds_read_b64_tr_b16 a[198:199], v225 offset:45056
v_mfma_f32_16x16x32_bf16 a[96:99], v[88:91], a[200:203], a[96:99]
v_exp_f32 v69, v69
v_mfma_f32_16x16x32_bf16 a[100:103], v[92:95], a[200:203], a[100:103]
v_cvt_pk_bf16_f32 v86, v68, v69
v_max_u32_dpp v250, v249, v249 row_ror:2 row_mask:0xf bank_mask:0xf
v_mfma_f32_16x16x32_bf16 a[104:107], v[96:99], a[200:203], a[104:107]
v_exp_f32 v70, v70
v_mfma_f32_16x16x32_bf16 a[108:111], v[100:103], a[200:203], a[108:111]
ds_read_b64_tr_b16 a[200:201], v226 offset:40960
ds_read_b64_tr_b16 a[202:203], v226 offset:45056
v_mfma_f32_16x16x32_bf16 a[124:127], v[100:103], a[204:207], a[124:127]
v_exp_f32 v71, v71
v_mfma_f32_16x16x32_bf16 a[120:123], v[96:99], a[204:207], a[120:123]
v_cvt_pk_bf16_f32 v87, v70, v71
v_max_u32_dpp v249, v250, v250 row_ror:1 row_mask:0xf bank_mask:0xf
v_mfma_f32_16x16x32_bf16 a[116:119], v[92:95], a[204:207], a[116:119]
buffer_load_dwordx4 v232, s[12:15], s39 offen offset:2048  lds
v_mfma_f32_16x16x32_bf16 a[112:115], v[88:91], a[204:207], a[112:115]
ds_read_b64_tr_b16 a[204:205], v227 offset:40960
ds_read_b64_tr_b16 a[206:207], v227 offset:45056
v_smfmac_f32_16x16x64_bf16 a[128:131], a[208:211], v[88:95], v245
buffer_load_dwordx4 v233, s[12:15], s39 offen offset:3072  lds
v_smfmac_f32_16x16x64_bf16 a[132:135], a[208:211], v[96:103], v245
s_add_u32 m0, s86, 40960
s_add_u32 s50, s84, 1179648
buffer_load_dwordx4 v240, s[68:71], s50 offen lds
s_add_u32 m0, s86, 45056
s_add_u32 s50, s84, 1769472
buffer_load_dwordx4 v240, s[68:71], s50 offen lds
v_mfma_f32_16x16x32_bf16 v[40:43], a[144:147], v[152:155], v[136:139]
v_exp_f32 v8, v8
v_mfma_f32_16x16x32_bf16 v[40:43], a[148:151], v[156:159], v[40:43]
v_exp_f32 v9, v9
v_mfma_f32_16x16x32_bf16 v[40:43], a[152:155], v[160:163], v[40:43]
v_cvt_pk_bf16_f32 v88, v8, v9
v_lshlrev_b32 v246, 2, v1
v_mfma_f32_16x16x32_bf16 v[40:43], a[156:159], v[164:167], v[40:43]
v_exp_f32 v10, v10
v_mfma_f32_16x16x32_bf16 v[48:51], a[156:159], v[180:183], v[140:143]
v_mov_b32 v250, v249
v_mfma_f32_16x16x32_bf16 v[48:51], a[152:155], v[176:179], v[48:51]
v_exp_f32 v11, v11
v_mfma_f32_16x16x32_bf16 v[48:51], a[148:151], v[172:175], v[48:51]
v_cvt_pk_bf16_f32 v89, v10, v11
v_permlane16_swap_b32 v249, v250
v_mfma_f32_16x16x32_bf16 v[48:51], a[144:147], v[168:171], v[48:51]
v_exp_f32 v12, v12
v_mfma_f32_16x16x32_bf16 v[56:59], a[144:147], v[184:187], v[144:147]
v_max_u32 v249, v249, v250
v_mov_b32 v250, v249
v_mfma_f32_16x16x32_bf16 v[56:59], a[148:151], v[188:191], v[56:59]
v_exp_f32 v13, v13
v_mfma_f32_16x16x32_bf16 v[56:59], a[152:155], v[192:195], v[56:59]
v_cvt_pk_bf16_f32 v90, v12, v13
v_permlane32_swap_b32 v249, v250
v_mfma_f32_16x16x32_bf16 v[56:59], a[156:159], v[196:199], v[56:59]
v_exp_f32 v14, v14
v_mfma_f32_16x16x32_bf16 v[64:67], a[156:159], v[212:215], v[148:151]
s_waitcnt vmcnt(12) lgkmcnt(0)
s_barrier
v_mfma_f32_16x16x32_bf16 v[64:67], a[152:155], v[208:211], v[64:67]
v_exp_f32 v15, v15
v_mfma_f32_16x16x32_bf16 v[64:67], a[148:151], v[204:207], v[64:67]
ds_read_b128 a[156:159], v219 offset:0
v_cvt_pk_bf16_f32 v91, v14, v15
v_mfma_f32_16x16x32_bf16 v[64:67], a[144:147], v[200:203], v[64:67]
v_exp_f32 v16, v16
v_mfma_f32_16x16x32_bf16 a[0:3], v[72:75], a[176:179], a[0:3]
ds_read_b128 a[152:155], v218 offset:0
ds_read_b128 a[148:151], v217 offset:0
v_mfma_f32_16x16x32_bf16 a[4:7], v[76:79], a[176:179], a[4:7]
v_exp_f32 v17, v17
v_mfma_f32_16x16x32_bf16 a[8:11], v[80:83], a[176:179], a[8:11]
ds_read_b128 a[144:147], v216 offset:0
v_cvt_pk_bf16_f32 v92, v16, v17
v_mfma_f32_16x16x32_bf16 a[12:15], v[84:87], a[176:179], a[12:15]
v_exp_f32 v18, v18
v_mfma_f32_16x16x32_bf16 a[28:31], v[84:87], a[180:183], a[28:31]
ds_read_b64_tr_b16 a[176:177], v220 offset:49152
ds_read_b64_tr_b16 a[178:179], v220 offset:53248
v_mfma_f32_16x16x32_bf16 a[24:27], v[80:83], a[180:183], a[24:27]
v_exp_f32 v19, v19
v_mfma_f32_16x16x32_bf16 a[20:23], v[76:79], a[180:183], a[20:23]
s_add_u32 s32, s32, 16384
v_cvt_pk_bf16_f32 v93, v18, v19
v_mfma_f32_16x16x32_bf16 a[16:19], v[72:75], a[180:183], a[16:19]
v_exp_f32 v20, v20
v_mfma_f32_16x16x32_bf16 a[32:35], v[72:75], a[184:187], a[32:35]
ds_read_b64_tr_b16 a[180:181], v221 offset:49152
ds_read_b64_tr_b16 a[182:183], v221 offset:53248
v_mfma_f32_16x16x32_bf16 a[36:39], v[76:79], a[184:187], a[36:39]
v_exp_f32 v21, v21
v_mfma_f32_16x16x32_bf16 a[40:43], v[80:83], a[184:187], a[40:43]
s_add_u32 m0, s30, 114688
v_cvt_pk_bf16_f32 v94, v20, v21
v_mfma_f32_16x16x32_bf16 a[44:47], v[84:87], a[184:187], a[44:47]
v_exp_f32 v22, v22
v_mfma_f32_16x16x32_bf16 a[60:63], v[84:87], a[188:191], a[60:63]
ds_read_b64_tr_b16 a[184:185], v222 offset:49152
ds_read_b64_tr_b16 a[186:187], v222 offset:53248
v_mfma_f32_16x16x32_bf16 a[56:59], v[80:83], a[188:191], a[56:59]
v_exp_f32 v23, v23
v_mfma_f32_16x16x32_bf16 a[52:55], v[76:79], a[188:191], a[52:55]
v_cvt_pk_bf16_f32 v95, v22, v23
v_max_u32 v249, v249, v250
v_mfma_f32_16x16x32_bf16 a[48:51], v[72:75], a[188:191], a[48:51]
v_exp_f32 v24, v24
v_mfma_f32_16x16x32_bf16 v[44:47], a[160:163], v[152:155], v[136:139]
v_exp_f32 v25, v25
v_mfma_f32_16x16x32_bf16 v[44:47], a[164:167], v[156:159], v[44:47]
ds_read_b64_tr_b16 a[188:189], v223 offset:49152
v_cvt_pk_bf16_f32 v96, v24, v25
v_mfma_f32_16x16x32_bf16 v[44:47], a[168:171], v[160:163], v[44:47]
v_exp_f32 v26, v26
v_mfma_f32_16x16x32_bf16 v[44:47], a[172:175], v[164:167], v[44:47]
ds_read_b64_tr_b16 a[190:191], v223 offset:53248
v_add_u32 v251, v251, v249
v_mfma_f32_16x16x32_bf16 v[52:55], a[172:175], v[180:183], v[140:143]
v_exp_f32 v27, v27
v_mfma_f32_16x16x32_bf16 v[52:55], a[168:171], v[176:179], v[52:55]
v_cvt_pk_bf16_f32 v97, v26, v27
v_sub_u32 v248, v248, v249
v_mfma_f32_16x16x32_bf16 v[52:55], a[164:167], v[172:175], v[52:55]
v_exp_f32 v28, v28
v_mfma_f32_16x16x32_bf16 v[52:55], a[160:163], v[168:171], v[52:55]
buffer_load_dwordx4 v228, s[8:11], s32 offen offset:0  lds
v_mfma_f32_16x16x32_bf16 v[60:63], a[160:163], v[184:187], v[144:147]
v_exp_f32 v29, v29
v_mfma_f32_16x16x32_bf16 v[60:63], a[164:167], v[188:191], v[60:63]
v_cvt_pk_bf16_f32 v98, v28, v29
v_cndmask_b32 v252, v252, v251, s[90:91]
v_mfma_f32_16x16x32_bf16 v[60:63], a[168:171], v[192:195], v[60:63]
v_exp_f32 v30, v30
v_mfma_f32_16x16x32_bf16 v[60:63], a[172:175], v[196:199], v[60:63]
buffer_load_dwordx4 v229, s[8:11], s32 offen offset:1024  lds
v_mfma_f32_16x16x32_bf16 v[68:71], a[172:175], v[212:215], v[148:151]
v_exp_f32 v31, v31
v_mfma_f32_16x16x32_bf16 v[68:71], a[168:171], v[208:211], v[68:71]
ds_read_b128 a[172:175], v219 offset:4096
v_cvt_pk_bf16_f32 v99, v30, v31
v_mfma_f32_16x16x32_bf16 v[68:71], a[164:167], v[204:207], v[68:71]
v_exp_f32 v32, v32
v_mfma_f32_16x16x32_bf16 v[68:71], a[160:163], v[200:203], v[68:71]
ds_read_b128 a[168:171], v218 offset:4096
ds_read_b128 a[164:167], v217 offset:4096
v_mfma_f32_16x16x32_bf16 a[64:67], v[72:75], a[192:195], a[64:67]
v_exp_f32 v33, v33
v_mfma_f32_16x16x32_bf16 a[68:71], v[76:79], a[192:195], a[68:71]
ds_read_b128 a[160:163], v216 offset:4096
v_cvt_pk_bf16_f32 v100, v32, v33
v_mfma_f32_16x16x32_bf16 a[72:75], v[80:83], a[192:195], a[72:75]
v_exp_f32 v34, v34
v_mfma_f32_16x16x32_bf16 a[76:79], v[84:87], a[192:195], a[76:79]
ds_read_b64_tr_b16 a[192:193], v224 offset:49152
ds_read_b64_tr_b16 a[194:195], v224 offset:53248
v_mfma_f32_16x16x32_bf16 a[92:95], v[84:87], a[196:199], a[92:95]
s_lshl_b64 s[90:91], s[90:91], 1
v_exp_f32 v35, v35
v_mfma_f32_16x16x32_bf16 a[88:91], v[80:83], a[196:199], a[88:91]
v_cvt_pk_bf16_f32 v101, v34, v35
v_mfma_f32_16x16x32_bf16 a[84:87], v[76:79], a[196:199], a[84:87]
v_exp_f32 v36, v36
v_mfma_f32_16x16x32_bf16 a[80:83], v[72:75], a[196:199], a[80:83]
ds_read_b64_tr_b16 a[196:197], v225 offset:49152
ds_read_b64_tr_b16 a[198:199], v225 offset:53248
v_mfma_f32_16x16x32_bf16 a[96:99], v[72:75], a[200:203], a[96:99]
v_exp_f32 v37, v37
v_mfma_f32_16x16x32_bf16 a[100:103], v[76:79], a[200:203], a[100:103]
v_cvt_pk_bf16_f32 v102, v36, v37
v_max_u32_dpp v250, v248, v248 row_ror:8 row_mask:0xf bank_mask:0xf
v_mfma_f32_16x16x32_bf16 a[104:107], v[80:83], a[200:203], a[104:107]
v_exp_f32 v38, v38
v_mfma_f32_16x16x32_bf16 a[108:111], v[84:87], a[200:203], a[108:111]
ds_read_b64_tr_b16 a[200:201], v226 offset:49152
ds_read_b64_tr_b16 a[202:203], v226 offset:53248
v_mfma_f32_16x16x32_bf16 a[124:127], v[84:87], a[204:207], a[124:127]
v_exp_f32 v39, v39
v_mfma_f32_16x16x32_bf16 a[120:123], v[80:83], a[204:207], a[120:123]
v_cvt_pk_bf16_f32 v103, v38, v39
v_max_u32_dpp v249, v250, v250 row_ror:4 row_mask:0xf bank_mask:0xf
v_mfma_f32_16x16x32_bf16 a[116:119], v[76:79], a[204:207], a[116:119]
buffer_load_dwordx4 v230, s[8:11], s32 offen offset:2048  lds
v_mfma_f32_16x16x32_bf16 a[112:115], v[72:75], a[204:207], a[112:115]
ds_read_b64_tr_b16 a[204:205], v227 offset:49152
ds_read_b64_tr_b16 a[206:207], v227 offset:53248
v_smfmac_f32_16x16x64_bf16 a[128:131], a[208:211], v[72:79], v245
buffer_load_dwordx4 v231, s[8:11], s32 offen offset:3072  lds
v_smfmac_f32_16x16x64_bf16 a[132:135], a[208:211], v[80:87], v245
s_add_u32 m0, s86, 49152
s_add_u32 s50, s84, 2359296
buffer_load_dwordx4 v240, s[68:71], s50 offen lds
s_add_u32 m0, s86, 53248
s_add_u32 s50, s84, 2949120
buffer_load_dwordx4 v240, s[68:71], s50 offen lds
s_waitcnt lgkmcnt(8)
v_mfma_f32_16x16x32_bf16 v[8:11], a[144:147], v[152:155], v[136:139]
v_max_u32_dpp v250, v249, v249 row_ror:2 row_mask:0xf bank_mask:0xf
v_exp_f32 v40, v40
v_mfma_f32_16x16x32_bf16 v[8:11], a[148:151], v[156:159], v[8:11]
v_exp_f32 v41, v41
v_mfma_f32_16x16x32_bf16 v[8:11], a[152:155], v[160:163], v[8:11]
v_cvt_pk_bf16_f32 v72, v40, v41
v_max_u32_dpp v249, v250, v250 row_ror:1 row_mask:0xf bank_mask:0xf
v_mfma_f32_16x16x32_bf16 v[8:11], a[156:159], v[164:167], v[8:11]
v_exp_f32 v42, v42
v_mfma_f32_16x16x32_bf16 v[16:19], a[156:159], v[180:183], v[140:143]
s_add_u32 s39, s39, 16384
v_mov_b32 v250, v249
v_mfma_f32_16x16x32_bf16 v[16:19], a[152:155], v[176:179], v[16:19]
v_exp_f32 v43, v43
v_mfma_f32_16x16x32_bf16 v[16:19], a[148:151], v[172:175], v[16:19]
v_cvt_pk_bf16_f32 v73, v42, v43
v_permlane16_swap_b32 v249, v250
v_mfma_f32_16x16x32_bf16 v[16:19], a[144:147], v[168:171], v[16:19]
v_exp_f32 v44, v44
v_mfma_f32_16x16x32_bf16 v[24:27], a[144:147], v[184:187], v[144:147]
buffer_load_dword v253, v246, s[24:27], 0 offen sc0 sc1
v_mfma_f32_16x16x32_bf16 v[24:27], a[148:151], v[188:191], v[24:27]
v_exp_f32 v45, v45
v_mfma_f32_16x16x32_bf16 v[24:27], a[152:155], v[192:195], v[24:27]
s_add_u32 m0, s30, 131072
v_cvt_pk_bf16_f32 v74, v44, v45
v_mfma_f32_16x16x32_bf16 v[24:27], a[156:159], v[196:199], v[24:27]
v_exp_f32 v46, v46
v_mfma_f32_16x16x32_bf16 v[32:35], a[156:159], v[212:215], v[148:151]
ds_read_b128 a[156:159], v219 offset:8192
v_max_u32 v249, v249, v250
v_mfma_f32_16x16x32_bf16 v[32:35], a[152:155], v[208:211], v[32:35]
v_exp_f32 v47, v47
v_mfma_f32_16x16x32_bf16 v[32:35], a[148:151], v[204:207], v[32:35]
ds_read_b128 a[152:155], v218 offset:8192
v_cvt_pk_bf16_f32 v75, v46, v47
v_mfma_f32_16x16x32_bf16 v[32:35], a[144:147], v[200:203], v[32:35]
v_exp_f32 v48, v48
v_mfma_f32_16x16x32_bf16 a[0:3], v[88:91], a[176:179], a[0:3]
ds_read_b128 a[148:151], v217 offset:8192
ds_read_b128 a[144:147], v216 offset:8192
v_mfma_f32_16x16x32_bf16 a[4:7], v[92:95], a[176:179], a[4:7]
v_exp_f32 v49, v49
v_mfma_f32_16x16x32_bf16 a[8:11], v[96:99], a[176:179], a[8:11]
v_cvt_pk_bf16_f32 v76, v48, v49
v_mov_b32 v250, v249
v_mfma_f32_16x16x32_bf16 a[12:15], v[100:103], a[176:179], a[12:15]
v_exp_f32 v50, v50
v_mfma_f32_16x16x32_bf16 a[28:31], v[100:103], a[180:183], a[28:31]
ds_read_b64_tr_b16 a[176:177], v220 offset:57344
ds_read_b64_tr_b16 a[178:179], v220 offset:61440
v_mfma_f32_16x16x32_bf16 a[24:27], v[96:99], a[180:183], a[24:27]
v_exp_f32 v51, v51
v_mfma_f32_16x16x32_bf16 a[20:23], v[92:95], a[180:183], a[20:23]
v_cvt_pk_bf16_f32 v77, v50, v51
v_permlane32_swap_b32 v249, v250
v_mfma_f32_16x16x32_bf16 a[16:19], v[88:91], a[180:183], a[16:19]
v_exp_f32 v52, v52
v_mfma_f32_16x16x32_bf16 a[32:35], v[88:91], a[184:187], a[32:35]
ds_read_b64_tr_b16 a[180:181], v221 offset:57344
ds_read_b64_tr_b16 a[182:183], v221 offset:61440
v_mfma_f32_16x16x32_bf16 a[36:39], v[92:95], a[184:187], a[36:39]
v_exp_f32 v53, v53
v_mfma_f32_16x16x32_bf16 a[40:43], v[96:99], a[184:187], a[40:43]
v_cvt_pk_bf16_f32 v78, v52, v53
v_max_u32 v249, v249, v250
v_mfma_f32_16x16x32_bf16 a[44:47], v[100:103], a[184:187], a[44:47]
v_exp_f32 v54, v54
v_mfma_f32_16x16x32_bf16 a[60:63], v[100:103], a[188:191], a[60:63]
ds_read_b64_tr_b16 a[184:185], v222 offset:57344
ds_read_b64_tr_b16 a[186:187], v222 offset:61440
v_mfma_f32_16x16x32_bf16 a[56:59], v[96:99], a[188:191], a[56:59]
v_exp_f32 v55, v55
v_mfma_f32_16x16x32_bf16 a[52:55], v[92:95], a[188:191], a[52:55]
v_cvt_pk_bf16_f32 v79, v54, v55
v_add_u32 v251, v251, v249
v_mfma_f32_16x16x32_bf16 a[48:51], v[88:91], a[188:191], a[48:51]
v_exp_f32 v56, v56
v_mfma_f32_16x16x32_bf16 v[12:15], a[160:163], v[152:155], v[136:139]
v_exp_f32 v57, v57
v_mfma_f32_16x16x32_bf16 v[12:15], a[164:167], v[156:159], v[12:15]
ds_read_b64_tr_b16 a[188:189], v223 offset:57344
v_cvt_pk_bf16_f32 v80, v56, v57
v_mfma_f32_16x16x32_bf16 v[12:15], a[168:171], v[160:163], v[12:15]
v_exp_f32 v58, v58
v_mfma_f32_16x16x32_bf16 v[12:15], a[172:175], v[164:167], v[12:15]
ds_read_b64_tr_b16 a[190:191], v223 offset:61440
v_sub_u32 v248, v248, v249
v_mfma_f32_16x16x32_bf16 v[20:23], a[172:175], v[180:183], v[140:143]
v_exp_f32 v59, v59
v_mfma_f32_16x16x32_bf16 v[20:23], a[168:171], v[176:179], v[20:23]
v_cvt_pk_bf16_f32 v81, v58, v59
v_cndmask_b32 v252, v252, v251, s[90:91]
v_mfma_f32_16x16x32_bf16 v[20:23], a[164:167], v[172:175], v[20:23]
v_exp_f32 v60, v60
v_mfma_f32_16x16x32_bf16 v[20:23], a[160:163], v[168:171], v[20:23]
buffer_load_dwordx4 v232, s[12:15], s39 offen offset:0  lds
v_mfma_f32_16x16x32_bf16 v[28:31], a[160:163], v[184:187], v[144:147]
v_exp_f32 v61, v61
v_mfma_f32_16x16x32_bf16 v[28:31], a[164:167], v[188:191], v[28:31]
s_lshl_b64 s[90:91], s[90:91], 1
v_cvt_pk_bf16_f32 v82, v60, v61
v_mfma_f32_16x16x32_bf16 v[28:31], a[168:171], v[192:195], v[28:31]
v_exp_f32 v62, v62
v_mfma_f32_16x16x32_bf16 v[28:31], a[172:175], v[196:199], v[28:31]
buffer_load_dwordx4 v233, s[12:15], s39 offen offset:1024  lds
v_mfma_f32_16x16x32_bf16 v[36:39], a[172:175], v[212:215], v[148:151]
v_exp_f32 v63, v63
v_mfma_f32_16x16x32_bf16 v[36:39], a[168:171], v[208:211], v[36:39]
ds_read_b128 a[172:175], v219 offset:12288
v_cvt_pk_bf16_f32 v83, v62, v63
v_mfma_f32_16x16x32_bf16 v[36:39], a[164:167], v[204:207], v[36:39]
v_exp_f32 v64, v64
v_mfma_f32_16x16x32_bf16 v[36:39], a[160:163], v[200:203], v[36:39]
ds_read_b128 a[168:171], v218 offset:12288
ds_read_b128 a[164:167], v217 offset:12288
s_waitcnt lgkmcnt(8)
v_mfma_f32_16x16x32_bf16 a[64:67], v[88:91], a[192:195], a[64:67]
v_exp_f32 v65, v65
v_mfma_f32_16x16x32_bf16 a[68:71], v[92:95], a[192:195], a[68:71]
ds_read_b128 a[160:163], v216 offset:12288
v_cvt_pk_bf16_f32 v84, v64, v65
v_mfma_f32_16x16x32_bf16 a[72:75], v[96:99], a[192:195], a[72:75]
v_exp_f32 v66, v66
v_mfma_f32_16x16x32_bf16 a[76:79], v[100:103], a[192:195], a[76:79]
ds_read_b64_tr_b16 a[192:193], v224 offset:57344
ds_read_b64_tr_b16 a[194:195], v224 offset:61440
v_mfma_f32_16x16x32_bf16 a[92:95], v[100:103], a[196:199], a[92:95]
v_exp_f32 v67, v67
v_mfma_f32_16x16x32_bf16 a[88:91], v[96:99], a[196:199], a[88:91]
v_cvt_pk_bf16_f32 v85, v66, v67
v_max_u32_dpp v250, v248, v248 row_ror:8 row_mask:0xf bank_mask:0xf
v_mfma_f32_16x16x32_bf16 a[84:87], v[92:95], a[196:199], a[84:87]
v_exp_f32 v68, v68
v_mfma_f32_16x16x32_bf16 a[80:83], v[88:91], a[196:199], a[80:83]
ds_read_b64_tr_b16 a[196:197], v225 offset:57344
ds_read_b64_tr_b16 a[198:199], v225 offset:61440
v_mfma_f32_16x16x32_bf16 a[96:99], v[88:91], a[200:203], a[96:99]
v_exp_f32 v69, v69
v_mfma_f32_16x16x32_bf16 a[100:103], v[92:95], a[200:203], a[100:103]
v_cvt_pk_bf16_f32 v86, v68, v69
v_max_u32_dpp v249, v250, v250 row_ror:4 row_mask:0xf bank_mask:0xf
v_mfma_f32_16x16x32_bf16 a[104:107], v[96:99], a[200:203], a[104:107]
v_exp_f32 v70, v70
v_mfma_f32_16x16x32_bf16 a[108:111], v[100:103], a[200:203], a[108:111]
ds_read_b64_tr_b16 a[200:201], v226 offset:57344
ds_read_b64_tr_b16 a[202:203], v226 offset:61440
v_mfma_f32_16x16x32_bf16 a[124:127], v[100:103], a[204:207], a[124:127]
v_exp_f32 v71, v71
v_mfma_f32_16x16x32_bf16 a[120:123], v[96:99], a[204:207], a[120:123]
v_cvt_pk_bf16_f32 v87, v70, v71
v_max_u32_dpp v250, v249, v249 row_ror:2 row_mask:0xf bank_mask:0xf
v_mfma_f32_16x16x32_bf16 a[116:119], v[92:95], a[204:207], a[116:119]
buffer_load_dwordx4 v232, s[12:15], s39 offen offset:2048  lds
v_mfma_f32_16x16x32_bf16 a[112:115], v[88:91], a[204:207], a[112:115]
ds_read_b64_tr_b16 a[204:205], v227 offset:57344
ds_read_b64_tr_b16 a[206:207], v227 offset:61440
v_smfmac_f32_16x16x64_bf16 a[128:131], a[208:211], v[88:95], v245
buffer_load_dwordx4 v233, s[12:15], s39 offen offset:3072  lds
v_smfmac_f32_16x16x64_bf16 a[132:135], a[208:211], v[96:103], v245
s_add_u32 m0, s86, 57344
s_add_u32 s50, s84, 3538944
buffer_load_dwordx4 v240, s[68:71], s50 offen lds
s_add_u32 m0, s86, 61440
s_add_u32 s50, s84, 4128768
buffer_load_dwordx4 v240, s[68:71], s50 offen lds
v_mfma_f32_16x16x32_bf16 v[40:43], a[144:147], v[152:155], v[136:139]
v_exp_f32 v8, v8
v_mfma_f32_16x16x32_bf16 v[40:43], a[148:151], v[156:159], v[40:43]
v_exp_f32 v9, v9
v_mfma_f32_16x16x32_bf16 v[40:43], a[152:155], v[160:163], v[40:43]
v_cvt_pk_bf16_f32 v88, v8, v9
v_max_u32_dpp v249, v250, v250 row_ror:1 row_mask:0xf bank_mask:0xf
v_mfma_f32_16x16x32_bf16 v[40:43], a[156:159], v[164:167], v[40:43]
v_exp_f32 v10, v10
v_mfma_f32_16x16x32_bf16 v[48:51], a[156:159], v[180:183], v[140:143]
v_mov_b32 v250, v249
v_mfma_f32_16x16x32_bf16 v[48:51], a[152:155], v[176:179], v[48:51]
v_exp_f32 v11, v11
v_mfma_f32_16x16x32_bf16 v[48:51], a[148:151], v[172:175], v[48:51]
v_cvt_pk_bf16_f32 v89, v10, v11
v_permlane16_swap_b32 v249, v250
v_mfma_f32_16x16x32_bf16 v[48:51], a[144:147], v[168:171], v[48:51]
v_exp_f32 v12, v12
v_mfma_f32_16x16x32_bf16 v[56:59], a[144:147], v[184:187], v[144:147]
v_max_u32 v249, v249, v250
v_mov_b32 v250, v249
v_mfma_f32_16x16x32_bf16 v[56:59], a[148:151], v[188:191], v[56:59]
v_exp_f32 v13, v13
v_mfma_f32_16x16x32_bf16 v[56:59], a[152:155], v[192:195], v[56:59]
v_cvt_pk_bf16_f32 v90, v12, v13
v_permlane32_swap_b32 v249, v250
v_mfma_f32_16x16x32_bf16 v[56:59], a[156:159], v[196:199], v[56:59]
v_exp_f32 v14, v14
v_mfma_f32_16x16x32_bf16 v[64:67], a[156:159], v[212:215], v[148:151]
s_waitcnt vmcnt(13) lgkmcnt(0)
s_barrier
v_mfma_f32_16x16x32_bf16 v[64:67], a[152:155], v[208:211], v[64:67]
v_exp_f32 v15, v15
v_mfma_f32_16x16x32_bf16 v[64:67], a[148:151], v[204:207], v[64:67]
ds_read_b128 a[156:159], v219 offset:16384
v_cvt_pk_bf16_f32 v91, v14, v15
v_mfma_f32_16x16x32_bf16 v[64:67], a[144:147], v[200:203], v[64:67]
v_exp_f32 v16, v16
v_mfma_f32_16x16x32_bf16 a[0:3], v[72:75], a[176:179], a[0:3]
ds_read_b128 a[152:155], v218 offset:16384
ds_read_b128 a[148:151], v217 offset:16384
v_mfma_f32_16x16x32_bf16 a[4:7], v[76:79], a[176:179], a[4:7]
v_exp_f32 v17, v17
v_mfma_f32_16x16x32_bf16 a[8:11], v[80:83], a[176:179], a[8:11]
ds_read_b128 a[144:147], v216 offset:16384
v_cvt_pk_bf16_f32 v92, v16, v17
v_mfma_f32_16x16x32_bf16 a[12:15], v[84:87], a[176:179], a[12:15]
v_exp_f32 v18, v18
v_mfma_f32_16x16x32_bf16 a[28:31], v[84:87], a[180:183], a[28:31]
ds_read_b64_tr_b16 a[176:177], v220 offset:0
ds_read_b64_tr_b16 a[178:179], v220 offset:4096
v_mfma_f32_16x16x32_bf16 a[24:27], v[80:83], a[180:183], a[24:27]
v_exp_f32 v19, v19
v_mfma_f32_16x16x32_bf16 a[20:23], v[76:79], a[180:183], a[20:23]
s_add_u32 s32, s32, 16384
v_cvt_pk_bf16_f32 v93, v18, v19
v_mfma_f32_16x16x32_bf16 a[16:19], v[72:75], a[180:183], a[16:19]
v_exp_f32 v20, v20
v_mfma_f32_16x16x32_bf16 a[32:35], v[72:75], a[184:187], a[32:35]
ds_read_b64_tr_b16 a[180:181], v221 offset:0
ds_read_b64_tr_b16 a[182:183], v221 offset:4096
v_mfma_f32_16x16x32_bf16 a[36:39], v[76:79], a[184:187], a[36:39]
v_exp_f32 v21, v21
v_mfma_f32_16x16x32_bf16 a[40:43], v[80:83], a[184:187], a[40:43]
s_add_u32 m0, s30, 65536
v_cvt_pk_bf16_f32 v94, v20, v21
v_mfma_f32_16x16x32_bf16 a[44:47], v[84:87], a[184:187], a[44:47]
v_exp_f32 v22, v22
v_mfma_f32_16x16x32_bf16 a[60:63], v[84:87], a[188:191], a[60:63]
ds_read_b64_tr_b16 a[184:185], v222 offset:0
ds_read_b64_tr_b16 a[186:187], v222 offset:4096
v_mfma_f32_16x16x32_bf16 a[56:59], v[80:83], a[188:191], a[56:59]
v_max_u32 v249, v249, v250
v_exp_f32 v23, v23
v_mfma_f32_16x16x32_bf16 a[52:55], v[76:79], a[188:191], a[52:55]
v_cvt_pk_bf16_f32 v95, v22, v23
v_add_u32 v251, v251, v249
v_mfma_f32_16x16x32_bf16 a[48:51], v[72:75], a[188:191], a[48:51]
v_exp_f32 v24, v24
v_mfma_f32_16x16x32_bf16 v[44:47], a[160:163], v[152:155], v[136:139]
v_exp_f32 v25, v25
v_mfma_f32_16x16x32_bf16 v[44:47], a[164:167], v[156:159], v[44:47]
ds_read_b64_tr_b16 a[188:189], v223 offset:0
v_cvt_pk_bf16_f32 v96, v24, v25
v_mfma_f32_16x16x32_bf16 v[44:47], a[168:171], v[160:163], v[44:47]
v_exp_f32 v26, v26
v_mfma_f32_16x16x32_bf16 v[44:47], a[172:175], v[164:167], v[44:47]
ds_read_b64_tr_b16 a[190:191], v223 offset:4096
v_sub_u32 v248, v248, v249
v_mfma_f32_16x16x32_bf16 v[52:55], a[172:175], v[180:183], v[140:143]
v_exp_f32 v27, v27
v_mfma_f32_16x16x32_bf16 v[52:55], a[168:171], v[176:179], v[52:55]
v_cvt_pk_bf16_f32 v97, v26, v27
v_cndmask_b32 v252, v252, v251, s[90:91]
v_mfma_f32_16x16x32_bf16 v[52:55], a[164:167], v[172:175], v[52:55]
v_exp_f32 v28, v28
v_mfma_f32_16x16x32_bf16 v[52:55], a[160:163], v[168:171], v[52:55]
STUB_6:
s_cbranch_execz STUB_9
buffer_load_dwordx4 v228, s[8:11], s32 offen offset:0  lds
v_mfma_f32_16x16x32_bf16 v[60:63], a[160:163], v[184:187], v[144:147]
v_exp_f32 v29, v29
v_mfma_f32_16x16x32_bf16 v[60:63], a[164:167], v[188:191], v[60:63]
s_lshl_b64 s[90:91], s[90:91], 1
v_cvt_pk_bf16_f32 v98, v28, v29
v_mfma_f32_16x16x32_bf16 v[60:63], a[168:171], v[192:195], v[60:63]
v_exp_f32 v30, v30
v_mfma_f32_16x16x32_bf16 v[60:63], a[172:175], v[196:199], v[60:63]
buffer_load_dwordx4 v229, s[8:11], s32 offen offset:1024  lds
v_mfma_f32_16x16x32_bf16 v[68:71], a[172:175], v[212:215], v[148:151]
v_exp_f32 v31, v31
v_mfma_f32_16x16x32_bf16 v[68:71], a[168:171], v[208:211], v[68:71]
ds_read_b128 a[172:175], v219 offset:20480
v_cvt_pk_bf16_f32 v99, v30, v31
v_mfma_f32_16x16x32_bf16 v[68:71], a[164:167], v[204:207], v[68:71]
v_exp_f32 v32, v32
v_mfma_f32_16x16x32_bf16 v[68:71], a[160:163], v[200:203], v[68:71]
ds_read_b128 a[168:171], v218 offset:20480
ds_read_b128 a[164:167], v217 offset:20480
v_mfma_f32_16x16x32_bf16 a[64:67], v[72:75], a[192:195], a[64:67]
v_exp_f32 v33, v33
v_mfma_f32_16x16x32_bf16 a[68:71], v[76:79], a[192:195], a[68:71]
ds_read_b128 a[160:163], v216 offset:20480
v_cvt_pk_bf16_f32 v100, v32, v33
v_mfma_f32_16x16x32_bf16 a[72:75], v[80:83], a[192:195], a[72:75]
v_exp_f32 v34, v34
v_mfma_f32_16x16x32_bf16 a[76:79], v[84:87], a[192:195], a[76:79]
ds_read_b64_tr_b16 a[192:193], v224 offset:0
ds_read_b64_tr_b16 a[194:195], v224 offset:4096
v_mfma_f32_16x16x32_bf16 a[92:95], v[84:87], a[196:199], a[92:95]
v_max_u32_dpp v250, v248, v248 row_ror:8 row_mask:0xf bank_mask:0xf
v_exp_f32 v35, v35
v_mfma_f32_16x16x32_bf16 a[88:91], v[80:83], a[196:199], a[88:91]
v_cvt_pk_bf16_f32 v101, v34, v35
v_mfma_f32_16x16x32_bf16 a[84:87], v[76:79], a[196:199], a[84:87]
v_exp_f32 v36, v36
v_mfma_f32_16x16x32_bf16 a[80:83], v[72:75], a[196:199], a[80:83]
ds_read_b64_tr_b16 a[196:197], v225 offset:0
ds_read_b64_tr_b16 a[198:199], v225 offset:4096
v_mfma_f32_16x16x32_bf16 a[96:99], v[72:75], a[200:203], a[96:99]
v_max_u32_dpp v249, v250, v250 row_ror:4 row_mask:0xf bank_mask:0xf
v_exp_f32 v37, v37
v_mfma_f32_16x16x32_bf16 a[100:103], v[76:79], a[200:203], a[100:103]
v_cvt_pk_bf16_f32 v102, v36, v37
v_mfma_f32_16x16x32_bf16 a[104:107], v[80:83], a[200:203], a[104:107]
v_exp_f32 v38, v38
v_mfma_f32_16x16x32_bf16 a[108:111], v[84:87], a[200:203], a[108:111]
ds_read_b64_tr_b16 a[200:201], v226 offset:0
ds_read_b64_tr_b16 a[202:203], v226 offset:4096
v_mfma_f32_16x16x32_bf16 a[124:127], v[84:87], a[204:207], a[124:127]
v_exp_f32 v39, v39
v_mfma_f32_16x16x32_bf16 a[120:123], v[80:83], a[204:207], a[120:123]
v_cvt_pk_bf16_f32 v103, v38, v39
v_max_u32_dpp v250, v249, v249 row_ror:2 row_mask:0xf bank_mask:0xf
v_mfma_f32_16x16x32_bf16 a[116:119], v[76:79], a[204:207], a[116:119]
buffer_load_dwordx4 v230, s[8:11], s32 offen offset:2048  lds
v_mfma_f32_16x16x32_bf16 a[112:115], v[72:75], a[204:207], a[112:115]
ds_read_b64_tr_b16 a[204:205], v227 offset:0
ds_read_b64_tr_b16 a[206:207], v227 offset:4096
v_smfmac_f32_16x16x64_bf16 a[128:131], a[208:211], v[72:79], v245
buffer_load_dwordx4 v231, s[8:11], s32 offen offset:3072  lds
v_smfmac_f32_16x16x64_bf16 a[132:135], a[208:211], v[80:87], v245
v_max_u32_dpp v249, v250, v250 row_ror:1 row_mask:0xf bank_mask:0xf
v_mov_b32 v250, v249
s_waitcnt lgkmcnt(8)
v_mfma_f32_16x16x32_bf16 v[8:11], a[144:147], v[152:155], v[136:139]
v_exp_f32 v40, v40
v_mfma_f32_16x16x32_bf16 v[8:11], a[148:151], v[156:159], v[8:11]
v_exp_f32 v41, v41
v_mfma_f32_16x16x32_bf16 v[8:11], a[152:155], v[160:163], v[8:11]
v_cvt_pk_bf16_f32 v72, v40, v41
v_permlane16_swap_b32 v249, v250
v_mfma_f32_16x16x32_bf16 v[8:11], a[156:159], v[164:167], v[8:11]
v_exp_f32 v42, v42
v_mfma_f32_16x16x32_bf16 v[16:19], a[156:159], v[180:183], v[140:143]
s_add_u32 s39, s39, 16384
v_max_u32 v249, v249, v250
v_mfma_f32_16x16x32_bf16 v[16:19], a[152:155], v[176:179], v[16:19]
v_exp_f32 v43, v43
v_mfma_f32_16x16x32_bf16 v[16:19], a[148:151], v[172:175], v[16:19]
v_cvt_pk_bf16_f32 v73, v42, v43
v_mov_b32 v250, v249
v_mfma_f32_16x16x32_bf16 v[16:19], a[144:147], v[168:171], v[16:19]
v_exp_f32 v44, v44
v_mfma_f32_16x16x32_bf16 v[24:27], a[144:147], v[184:187], v[144:147]
v_permlane32_swap_b32 v249, v250
v_max_u32 v249, v249, v250
v_mfma_f32_16x16x32_bf16 v[24:27], a[148:151], v[188:191], v[24:27]
v_exp_f32 v45, v45
v_mfma_f32_16x16x32_bf16 v[24:27], a[152:155], v[192:195], v[24:27]
v_cvt_pk_bf16_f32 v74, v44, v45
v_add_u32 v251, v251, v249
v_mfma_f32_16x16x32_bf16 v[24:27], a[156:159], v[196:199], v[24:27]
v_exp_f32 v46, v46
v_mfma_f32_16x16x32_bf16 v[32:35], a[156:159], v[212:215], v[148:151]
ds_read_b128 a[156:159], v219 offset:24576
s_add_u32 m0, s30, 147456
v_mfma_f32_16x16x32_bf16 v[32:35], a[152:155], v[208:211], v[32:35]
v_exp_f32 v47, v47
v_mfma_f32_16x16x32_bf16 v[32:35], a[148:151], v[204:207], v[32:35]
ds_read_b128 a[152:155], v218 offset:24576
v_cvt_pk_bf16_f32 v75, v46, v47
v_mfma_f32_16x16x32_bf16 v[32:35], a[144:147], v[200:203], v[32:35]
v_exp_f32 v48, v48
v_mfma_f32_16x16x32_bf16 a[0:3], v[88:91], a[176:179], a[0:3]
ds_read_b128 a[148:151], v217 offset:24576
ds_read_b128 a[144:147], v216 offset:24576
v_mfma_f32_16x16x32_bf16 a[4:7], v[92:95], a[176:179], a[4:7]
v_exp_f32 v49, v49
v_mfma_f32_16x16x32_bf16 a[8:11], v[96:99], a[176:179], a[8:11]
v_cvt_pk_bf16_f32 v76, v48, v49
v_sub_u32 v248, v248, v249
v_mfma_f32_16x16x32_bf16 a[12:15], v[100:103], a[176:179], a[12:15]
v_exp_f32 v50, v50
v_mfma_f32_16x16x32_bf16 a[28:31], v[100:103], a[180:183], a[28:31]
ds_read_b64_tr_b16 a[176:177], v220 offset:8192
ds_read_b64_tr_b16 a[178:179], v220 offset:12288
v_mfma_f32_16x16x32_bf16 a[24:27], v[96:99], a[180:183], a[24:27]
v_exp_f32 v51, v51
v_mfma_f32_16x16x32_bf16 a[20:23], v[92:95], a[180:183], a[20:23]
v_cvt_pk_bf16_f32 v77, v50, v51
v_cndmask_b32 v252, v252, v251, s[90:91]
v_mfma_f32_16x16x32_bf16 a[16:19], v[88:91], a[180:183], a[16:19]
v_exp_f32 v52, v52
v_mfma_f32_16x16x32_bf16 a[32:35], v[88:91], a[184:187], a[32:35]
ds_read_b64_tr_b16 a[180:181], v221 offset:8192
ds_read_b64_tr_b16 a[182:183], v221 offset:12288
v_mfma_f32_16x16x32_bf16 a[36:39], v[92:95], a[184:187], a[36:39]
v_exp_f32 v53, v53
v_mfma_f32_16x16x32_bf16 a[40:43], v[96:99], a[184:187], a[40:43]
s_lshl_b64 s[90:91], s[90:91], 1
v_cvt_pk_bf16_f32 v78, v52, v53
v_mfma_f32_16x16x32_bf16 a[44:47], v[100:103], a[184:187], a[44:47]
v_exp_f32 v54, v54
v_mfma_f32_16x16x32_bf16 a[60:63], v[100:103], a[188:191], a[60:63]
ds_read_b64_tr_b16 a[184:185], v222 offset:8192
ds_read_b64_tr_b16 a[186:187], v222 offset:12288
v_mfma_f32_16x16x32_bf16 a[56:59], v[96:99], a[188:191], a[56:59]
v_exp_f32 v55, v55
v_mfma_f32_16x16x32_bf16 a[52:55], v[92:95], a[188:191], a[52:55]
v_cvt_pk_bf16_f32 v79, v54, v55
v_max_u32_dpp v250, v248, v248 row_ror:8 row_mask:0xf bank_mask:0xf
v_mfma_f32_16x16x32_bf16 a[48:51], v[88:91], a[188:191], a[48:51]
v_exp_f32 v56, v56
v_mfma_f32_16x16x32_bf16 v[12:15], a[160:163], v[152:155], v[136:139]
v_exp_f32 v57, v57
v_mfma_f32_16x16x32_bf16 v[12:15], a[164:167], v[156:159], v[12:15]
ds_read_b64_tr_b16 a[188:189], v223 offset:8192
v_cvt_pk_bf16_f32 v80, v56, v57
v_mfma_f32_16x16x32_bf16 v[12:15], a[168:171], v[160:163], v[12:15]
v_exp_f32 v58, v58
v_mfma_f32_16x16x32_bf16 v[12:15], a[172:175], v[164:167], v[12:15]
ds_read_b64_tr_b16 a[190:191], v223 offset:12288
v_max_u32_dpp v249, v250, v250 row_ror:4 row_mask:0xf bank_mask:0xf
v_mfma_f32_16x16x32_bf16 v[20:23], a[172:175], v[180:183], v[140:143]
v_exp_f32 v59, v59
v_mfma_f32_16x16x32_bf16 v[20:23], a[168:171], v[176:179], v[20:23]
v_cvt_pk_bf16_f32 v81, v58, v59
v_max_u32_dpp v250, v249, v249 row_ror:2 row_mask:0xf bank_mask:0xf
v_mfma_f32_16x16x32_bf16 v[20:23], a[164:167], v[172:175], v[20:23]
v_exp_f32 v60, v60
v_mfma_f32_16x16x32_bf16 v[20:23], a[160:163], v[168:171], v[20:23]
buffer_load_dwordx4 v232, s[12:15], s39 offen offset:0  lds
v_mfma_f32_16x16x32_bf16 v[28:31], a[160:163], v[184:187], v[144:147]
v_exp_f32 v61, v61
v_mfma_f32_16x16x32_bf16 v[28:31], a[164:167], v[188:191], v[28:31]
v_cvt_pk_bf16_f32 v82, v60, v61
v_max_u32_dpp v249, v250, v250 row_ror:1 row_mask:0xf bank_mask:0xf
v_mfma_f32_16x16x32_bf16 v[28:31], a[168:171], v[192:195], v[28:31]
v_exp_f32 v62, v62
v_mfma_f32_16x16x32_bf16 v[28:31], a[172:175], v[196:199], v[28:31]
buffer_load_dwordx4 v233, s[12:15], s39 offen offset:1024  lds
v_mfma_f32_16x16x32_bf16 v[36:39], a[172:175], v[212:215], v[148:151]
v_exp_f32 v63, v63
v_mfma_f32_16x16x32_bf16 v[36:39], a[168:171], v[208:211], v[36:39]
ds_read_b128 a[172:175], v219 offset:28672
v_cvt_pk_bf16_f32 v83, v62, v63
v_mfma_f32_16x16x32_bf16 v[36:39], a[164:167], v[204:207], v[36:39]
v_exp_f32 v64, v64
v_mfma_f32_16x16x32_bf16 v[36:39], a[160:163], v[200:203], v[36:39]
ds_read_b128 a[168:171], v218 offset:28672
ds_read_b128 a[164:167], v217 offset:28672
s_waitcnt lgkmcnt(8)
v_mfma_f32_16x16x32_bf16 a[64:67], v[88:91], a[192:195], a[64:67]
v_exp_f32 v65, v65
v_mfma_f32_16x16x32_bf16 a[68:71], v[92:95], a[192:195], a[68:71]
ds_read_b128 a[160:163], v216 offset:28672
v_cvt_pk_bf16_f32 v84, v64, v65
v_mfma_f32_16x16x32_bf16 a[72:75], v[96:99], a[192:195], a[72:75]
v_exp_f32 v66, v66
v_mfma_f32_16x16x32_bf16 a[76:79], v[100:103], a[192:195], a[76:79]
ds_read_b64_tr_b16 a[192:193], v224 offset:8192
ds_read_b64_tr_b16 a[194:195], v224 offset:12288
v_mfma_f32_16x16x32_bf16 a[92:95], v[100:103], a[196:199], a[92:95]
v_exp_f32 v67, v67
v_mfma_f32_16x16x32_bf16 a[88:91], v[96:99], a[196:199], a[88:91]
v_cvt_pk_bf16_f32 v85, v66, v67
v_mov_b32 v250, v249
v_mfma_f32_16x16x32_bf16 a[84:87], v[92:95], a[196:199], a[84:87]
v_exp_f32 v68, v68
v_mfma_f32_16x16x32_bf16 a[80:83], v[88:91], a[196:199], a[80:83]
ds_read_b64_tr_b16 a[196:197], v225 offset:8192
ds_read_b64_tr_b16 a[198:199], v225 offset:12288
v_mfma_f32_16x16x32_bf16 a[96:99], v[88:91], a[200:203], a[96:99]
v_exp_f32 v69, v69
v_mfma_f32_16x16x32_bf16 a[100:103], v[92:95], a[200:203], a[100:103]
v_cvt_pk_bf16_f32 v86, v68, v69
v_permlane16_swap_b32 v249, v250
v_mfma_f32_16x16x32_bf16 a[104:107], v[96:99], a[200:203], a[104:107]
v_exp_f32 v70, v70
v_mfma_f32_16x16x32_bf16 a[108:111], v[100:103], a[200:203], a[108:111]
ds_read_b64_tr_b16 a[200:201], v226 offset:8192
ds_read_b64_tr_b16 a[202:203], v226 offset:12288
v_mfma_f32_16x16x32_bf16 a[124:127], v[100:103], a[204:207], a[124:127]
v_exp_f32 v71, v71
v_mfma_f32_16x16x32_bf16 a[120:123], v[96:99], a[204:207], a[120:123]
v_cvt_pk_bf16_f32 v87, v70, v71
v_max_u32 v249, v249, v250
v_mfma_f32_16x16x32_bf16 a[116:119], v[92:95], a[204:207], a[116:119]
buffer_load_dwordx4 v232, s[12:15], s39 offen offset:2048  lds
v_mfma_f32_16x16x32_bf16 a[112:115], v[88:91], a[204:207], a[112:115]
ds_read_b64_tr_b16 a[204:205], v227 offset:8192
ds_read_b64_tr_b16 a[206:207], v227 offset:12288
v_smfmac_f32_16x16x64_bf16 a[128:131], a[208:211], v[88:95], v245
buffer_load_dwordx4 v233, s[12:15], s39 offen offset:3072  lds
v_smfmac_f32_16x16x64_bf16 a[132:135], a[208:211], v[96:103], v245
v_mov_b32 v250, v249
v_mfma_f32_16x16x32_bf16 v[40:43], a[144:147], v[152:155], v[136:139]
v_exp_f32 v8, v8
v_mfma_f32_16x16x32_bf16 v[40:43], a[148:151], v[156:159], v[40:43]
v_exp_f32 v9, v9
v_mfma_f32_16x16x32_bf16 v[40:43], a[152:155], v[160:163], v[40:43]
v_cvt_pk_bf16_f32 v88, v8, v9
v_permlane32_swap_b32 v249, v250
v_mfma_f32_16x16x32_bf16 v[40:43], a[156:159], v[164:167], v[40:43]
v_exp_f32 v10, v10
v_mfma_f32_16x16x32_bf16 v[48:51], a[156:159], v[180:183], v[140:143]
v_max_u32 v249, v249, v250
v_add_u32 v251, v251, v249
v_mfma_f32_16x16x32_bf16 v[48:51], a[152:155], v[176:179], v[48:51]
v_exp_f32 v11, v11
v_mfma_f32_16x16x32_bf16 v[48:51], a[148:151], v[172:175], v[48:51]
v_cvt_pk_bf16_f32 v89, v10, v11
v_sub_u32 v248, v248, v249
v_mfma_f32_16x16x32_bf16 v[48:51], a[144:147], v[168:171], v[48:51]
v_exp_f32 v12, v12
v_mfma_f32_16x16x32_bf16 v[56:59], a[144:147], v[184:187], v[144:147]
v_cndmask_b32 v252, v252, v251, s[90:91]
v_mfma_f32_16x16x32_bf16 v[56:59], a[148:151], v[188:191], v[56:59]
v_exp_f32 v13, v13
v_mfma_f32_16x16x32_bf16 v[56:59], a[152:155], v[192:195], v[56:59]
s_lshl_b64 s[90:91], s[90:91], 1
v_cvt_pk_bf16_f32 v90, v12, v13
v_mfma_f32_16x16x32_bf16 v[56:59], a[156:159], v[196:199], v[56:59]
v_exp_f32 v14, v14
v_mfma_f32_16x16x32_bf16 v[64:67], a[156:159], v[212:215], v[148:151]
s_waitcnt vmcnt(8) lgkmcnt(0)
s_barrier
v_mfma_f32_16x16x32_bf16 v[64:67], a[152:155], v[208:211], v[64:67]
ds_read_b64_tr_b16 a[212:213], v241 offset:0
v_exp_f32 v15, v15
v_mfma_f32_16x16x32_bf16 v[64:67], a[148:151], v[204:207], v[64:67]
ds_read_b128 a[156:159], v219 offset:49152
ds_read_b64_tr_b16 a[214:215], v241 offset:256
v_cvt_pk_bf16_f32 v91, v14, v15
v_mfma_f32_16x16x32_bf16 v[64:67], a[144:147], v[200:203], v[64:67]
ds_read_b64_tr_b16 a[216:217], v241 offset:2048
v_exp_f32 v16, v16
v_mfma_f32_16x16x32_bf16 a[0:3], v[72:75], a[176:179], a[0:3]
ds_read_b128 a[152:155], v218 offset:49152
ds_read_b128 a[148:151], v217 offset:49152
ds_read_b64_tr_b16 a[218:219], v241 offset:2304
v_mfma_f32_16x16x32_bf16 a[4:7], v[76:79], a[176:179], a[4:7]
ds_read_b64_tr_b16 a[220:221], v241 offset:4096
v_exp_f32 v17, v17
v_mfma_f32_16x16x32_bf16 a[8:11], v[80:83], a[176:179], a[8:11]
ds_read_b128 a[144:147], v216 offset:49152
ds_read_b64_tr_b16 a[222:223], v241 offset:4352
v_cvt_pk_bf16_f32 v92, v16, v17
v_mfma_f32_16x16x32_bf16 a[12:15], v[84:87], a[176:179], a[12:15]
ds_read_b64_tr_b16 a[224:225], v241 offset:6144
v_exp_f32 v18, v18
v_mfma_f32_16x16x32_bf16 a[28:31], v[84:87], a[180:183], a[28:31]
ds_read_b64_tr_b16 a[176:177], v220 offset:32768
ds_read_b64_tr_b16 a[178:179], v220 offset:36864
ds_read_b64_tr_b16 a[226:227], v241 offset:6400
v_mfma_f32_16x16x32_bf16 a[24:27], v[80:83], a[180:183], a[24:27]
ds_read_b64_tr_b16 a[228:229], v241 offset:8192
v_exp_f32 v19, v19
v_mfma_f32_16x16x32_bf16 a[20:23], v[76:79], a[180:183], a[20:23]
s_add_u32 s32, s32, 16384
ds_read_b64_tr_b16 a[230:231], v241 offset:8448
v_cvt_pk_bf16_f32 v93, v18, v19
v_mfma_f32_16x16x32_bf16 a[16:19], v[72:75], a[180:183], a[16:19]
ds_read_b64_tr_b16 a[232:233], v241 offset:10240
v_exp_f32 v20, v20
v_mfma_f32_16x16x32_bf16 a[32:35], v[72:75], a[184:187], a[32:35]
ds_read_b64_tr_b16 a[180:181], v221 offset:32768
ds_read_b64_tr_b16 a[182:183], v221 offset:36864
ds_read_b64_tr_b16 a[234:235], v241 offset:10496
v_mfma_f32_16x16x32_bf16 a[36:39], v[76:79], a[184:187], a[36:39]
ds_read_b64_tr_b16 a[236:237], v241 offset:12288
v_exp_f32 v21, v21
v_mfma_f32_16x16x32_bf16 a[40:43], v[80:83], a[184:187], a[40:43]
s_add_u32 m0, s30, 81920
ds_read_b64_tr_b16 a[238:239], v241 offset:12544
v_cvt_pk_bf16_f32 v94, v20, v21
v_mfma_f32_16x16x32_bf16 a[44:47], v[84:87], a[184:187], a[44:47]
ds_read_b64_tr_b16 a[240:241], v241 offset:14336
v_exp_f32 v22, v22
v_mfma_f32_16x16x32_bf16 a[60:63], v[84:87], a[188:191], a[60:63]
ds_read_b64_tr_b16 a[184:185], v222 offset:32768
ds_read_b64_tr_b16 a[186:187], v222 offset:36864
ds_read_b64_tr_b16 a[242:243], v241 offset:14592
v_mfma_f32_16x16x32_bf16 a[56:59], v[80:83], a[188:191], a[56:59]
ds_read_b64_tr_b16 a[244:245], v241 offset:16384
v_exp_f32 v23, v23
v_mfma_f32_16x16x32_bf16 a[52:55], v[76:79], a[188:191], a[52:55]
ds_read_b64_tr_b16 a[246:247], v241 offset:16640
ds_read_b64_tr_b16 a[248:249], v241 offset:18432
v_cvt_pk_bf16_f32 v95, v22, v23
v_mfma_f32_16x16x32_bf16 a[48:51], v[72:75], a[188:191], a[48:51]
ds_read_b64_tr_b16 a[250:251], v241 offset:18688
v_exp_f32 v24, v24
v_mfma_f32_16x16x32_bf16 v[44:47], a[160:163], v[152:155], v[136:139]
ds_read_b64_tr_b16 a[252:253], v241 offset:20480
v_exp_f32 v25, v25
v_mfma_f32_16x16x32_bf16 v[44:47], a[164:167], v[156:159], v[44:47]
ds_read_b64_tr_b16 a[188:189], v223 offset:32768
ds_read_b64_tr_b16 a[254:255], v241 offset:20736
v_cvt_pk_bf16_f32 v96, v24, v25
v_mfma_f32_16x16x32_bf16 v[44:47], a[168:171], v[160:163], v[44:47]
ds_read_b64_tr_b16 a[136:137], v241 offset:22528
v_exp_f32 v26, v26
v_mfma_f32_16x16x32_bf16 v[44:47], a[172:175], v[164:167], v[44:47]
ds_read_b64_tr_b16 a[190:191], v223 offset:36864
ds_read_b64_tr_b16 a[138:139], v241 offset:22784
v_mfma_f32_16x16x32_bf16 v[52:55], a[172:175], v[180:183], v[140:143]
v_exp_f32 v27, v27
v_mfma_f32_16x16x32_bf16 v[52:55], a[168:171], v[176:179], v[52:55]
ds_read_b64_tr_b16 a[140:141], v241 offset:24576
v_cvt_pk_bf16_f32 v97, v26, v27
v_mfma_f32_16x16x32_bf16 v[52:55], a[164:167], v[172:175], v[52:55]
v_exp_f32 v28, v28
v_mfma_f32_16x16x32_bf16 v[52:55], a[160:163], v[168:171], v[52:55]
buffer_load_dwordx4 v228, s[8:11], s32 offen offset:0  lds
v_mfma_f32_16x16x32_bf16 v[60:63], a[160:163], v[184:187], v[144:147]
v_exp_f32 v29, v29
v_mfma_f32_16x16x32_bf16 v[60:63], a[164:167], v[188:191], v[60:63]
ds_read_b64_tr_b16 a[142:143], v241 offset:24832
v_cvt_pk_bf16_f32 v98, v28, v29
v_mfma_f32_16x16x32_bf16 v[60:63], a[168:171], v[192:195], v[60:63]
v_exp_f32 v30, v30
v_mfma_f32_16x16x32_bf16 v[60:63], a[172:175], v[196:199], v[60:63]
buffer_load_dwordx4 v229, s[8:11], s32 offen offset:1024  lds
v_mfma_f32_16x16x32_bf16 v[68:71], a[172:175], v[212:215], v[148:151]
v_exp_f32 v31, v31
v_mfma_f32_16x16x32_bf16 v[68:71], a[168:171], v[208:211], v[68:71]
ds_read_b128 a[172:175], v219 offset:53248
v_cvt_pk_bf16_f32 v99, v30, v31
v_mfma_f32_16x16x32_bf16 v[68:71], a[164:167], v[204:207], v[68:71]
v_exp_f32 v32, v32
v_mfma_f32_16x16x32_bf16 v[68:71], a[160:163], v[200:203], v[68:71]
ds_read_b128 a[168:171], v218 offset:53248
ds_read_b128 a[164:167], v217 offset:53248
v_max_u32_dpp v250, v248, v248 row_ror:8 row_mask:0xf bank_mask:0xf
v_mfma_f32_16x16x32_bf16 a[64:67], v[72:75], a[192:195], a[64:67]
v_exp_f32 v33, v33
v_mfma_f32_16x16x32_bf16 a[68:71], v[76:79], a[192:195], a[68:71]
ds_read_b128 a[160:163], v216 offset:53248
ds_read_b64_tr_b16 v[104:105], v241 offset:26624
v_cvt_pk_bf16_f32 v100, v32, v33
v_mfma_f32_16x16x32_bf16 a[72:75], v[80:83], a[192:195], a[72:75]
v_exp_f32 v34, v34
v_mfma_f32_16x16x32_bf16 a[76:79], v[84:87], a[192:195], a[76:79]
ds_read_b64_tr_b16 a[192:193], v224 offset:32768
ds_read_b64_tr_b16 a[194:195], v224 offset:36864
v_mfma_f32_16x16x32_bf16 a[92:95], v[84:87], a[196:199], a[92:95]
v_max_u32_dpp v249, v250, v250 row_ror:4 row_mask:0xf bank_mask:0xf
v_exp_f32 v35, v35
v_mfma_f32_16x16x32_bf16 a[88:91], v[80:83], a[196:199], a[88:91]
ds_read_b64_tr_b16 v[106:107], v241 offset:26880
v_cvt_pk_bf16_f32 v101, v34, v35
v_mfma_f32_16x16x32_bf16 a[84:87], v[76:79], a[196:199], a[84:87]
v_exp_f32 v36, v36
v_mfma_f32_16x16x32_bf16 a[80:83], v[72:75], a[196:199], a[80:83]
ds_read_b64_tr_b16 a[196:197], v225 offset:32768
ds_read_b64_tr_b16 a[198:199], v225 offset:36864
v_mfma_f32_16x16x32_bf16 a[96:99], v[72:75], a[200:203], a[96:99]
v_max_u32_dpp v250, v249, v249 row_ror:2 row_mask:0xf bank_mask:0xf
v_exp_f32 v37, v37
v_mfma_f32_16x16x32_bf16 a[100:103], v[76:79], a[200:203], a[100:103]
ds_read_b64_tr_b16 v[108:109], v241 offset:28672
v_cvt_pk_bf16_f32 v102, v36, v37
v_mfma_f32_16x16x32_bf16 a[104:107], v[80:83], a[200:203], a[104:107]
v_exp_f32 v38, v38
v_mfma_f32_16x16x32_bf16 a[108:111], v[84:87], a[200:203], a[108:111]
ds_read_b64_tr_b16 a[200:201], v226 offset:32768
ds_read_b64_tr_b16 a[202:203], v226 offset:36864
v_mfma_f32_16x16x32_bf16 a[124:127], v[84:87], a[204:207], a[124:127]
v_exp_f32 v39, v39
v_mfma_f32_16x16x32_bf16 a[120:123], v[80:83], a[204:207], a[120:123]
ds_read_b64_tr_b16 v[110:111], v241 offset:28928
v_cvt_pk_bf16_f32 v103, v38, v39
v_max_u32_dpp v249, v250, v250 row_ror:1 row_mask:0xf bank_mask:0xf
v_mfma_f32_16x16x32_bf16 a[116:119], v[76:79], a[204:207], a[116:119]
buffer_load_dwordx4 v230, s[8:11], s32 offen offset:2048  lds
v_mfma_f32_16x16x32_bf16 a[112:115], v[72:75], a[204:207], a[112:115]
ds_read_b64_tr_b16 a[204:205], v227 offset:32768
ds_read_b64_tr_b16 a[206:207], v227 offset:36864
v_smfmac_f32_16x16x64_bf16 a[128:131], a[208:211], v[72:79], v245
buffer_load_dwordx4 v231, s[8:11], s32 offen offset:3072  lds
v_smfmac_f32_16x16x64_bf16 a[132:135], a[208:211], v[80:87], v245
ds_read_b64_tr_b16 v[112:113], v241 offset:30720
ds_read_b64_tr_b16 v[114:115], v241 offset:30976
v_mov_b32 v250, v249
s_waitcnt lgkmcnt(8)
v_mfma_f32_16x16x32_bf16 v[8:11], a[144:147], v[152:155], v[136:139]
v_exp_f32 v40, v40
v_mfma_f32_16x16x32_bf16 v[8:11], a[148:151], v[156:159], v[8:11]
v_exp_f32 v41, v41
v_mfma_f32_16x16x32_bf16 v[8:11], a[152:155], v[160:163], v[8:11]
v_and_b32 v253, 0x20202020, v253
v_cvt_pk_bf16_f32 v72, v40, v41
v_mfma_f32_16x16x32_bf16 v[8:11], a[156:159], v[164:167], v[8:11]
v_exp_f32 v42, v42
v_mfma_f32_16x16x32_bf16 v[16:19], a[156:159], v[180:183], v[140:143]
s_add_u32 s39, s39, 16384
v_permlane16_swap_b32 v249, v250
v_mfma_f32_16x16x32_bf16 v[16:19], a[152:155], v[176:179], v[16:19]
v_exp_f32 v43, v43
v_mfma_f32_16x16x32_bf16 v[16:19], a[148:151], v[172:175], v[16:19]
v_cvt_pk_bf16_f32 v73, v42, v43
v_max_u32 v249, v249, v250
v_mfma_f32_16x16x32_bf16 v[16:19], a[144:147], v[168:171], v[16:19]
v_exp_f32 v44, v44
v_mfma_f32_16x16x32_bf16 v[24:27], a[144:147], v[184:187], v[144:147]
v_cmp_ne_u32 vcc, 0x20202020, v253
s_cbranch_vccnz SP_FL
SP_FL_RET:
v_mfma_f32_16x16x32_bf16 v[24:27], a[148:151], v[188:191], v[24:27]
v_exp_f32 v45, v45
v_mfma_f32_16x16x32_bf16 v[24:27], a[152:155], v[192:195], v[24:27]
v_cvt_pk_bf16_f32 v74, v44, v45
v_mov_b32 v246, s101
v_mfma_f32_16x16x32_bf16 v[24:27], a[156:159], v[196:199], v[24:27]
v_exp_f32 v46, v46
v_mfma_f32_16x16x32_bf16 v[32:35], a[156:159], v[212:215], v[148:151]
ds_read_b128 a[156:159], v219 offset:57344
s_add_u32 m0, s30, 98304
v_mfma_f32_16x16x32_bf16 v[32:35], a[152:155], v[208:211], v[32:35]
v_mov_b32 v250, v249
v_exp_f32 v47, v47
v_mfma_f32_16x16x32_bf16 v[32:35], a[148:151], v[204:207], v[32:35]
ds_read_b128 a[152:155], v218 offset:57344
v_cvt_pk_bf16_f32 v75, v46, v47
v_mfma_f32_16x16x32_bf16 v[32:35], a[144:147], v[200:203], v[32:35]
v_exp_f32 v48, v48
v_mfma_f32_16x16x32_bf16 a[0:3], v[88:91], a[176:179], a[0:3]
ds_read_b128 a[148:151], v217 offset:57344
ds_read_b128 a[144:147], v216 offset:57344
v_mfma_f32_16x16x32_bf16 a[4:7], v[92:95], a[176:179], a[4:7]
v_permlane32_swap_b32 v249, v250
v_exp_f32 v49, v49
v_mfma_f32_16x16x32_bf16 a[8:11], v[96:99], a[176:179], a[8:11]
v_cvt_pk_bf16_f32 v76, v48, v49
v_mov_b32 v247, s47
v_mfma_f32_16x16x32_bf16 a[12:15], v[100:103], a[176:179], a[12:15]
v_exp_f32 v50, v50
v_mfma_f32_16x16x32_bf16 a[28:31], v[100:103], a[180:183], a[28:31]
ds_read_b64_tr_b16 a[176:177], v220 offset:40960
ds_read_b64_tr_b16 a[178:179], v220 offset:45056
v_mfma_f32_16x16x32_bf16 a[24:27], v[96:99], a[180:183], a[24:27]
v_exp_f32 v51, v51
v_mfma_f32_16x16x32_bf16 a[20:23], v[92:95], a[180:183], a[20:23]
v_cvt_pk_bf16_f32 v77, v50, v51
v_mov_b32 v253, 0
v_max_u32 v249, v249, v250
v_mfma_f32_16x16x32_bf16 a[16:19], v[88:91], a[180:183], a[16:19]
v_exp_f32 v52, v52
v_mfma_f32_16x16x32_bf16 a[32:35], v[88:91], a[184:187], a[32:35]
ds_read_b64_tr_b16 a[180:181], v221 offset:40960
ds_read_b64_tr_b16 a[182:183], v221 offset:45056
v_mfma_f32_16x16x32_bf16 a[36:39], v[92:95], a[184:187], a[36:39]
v_exp_f32 v53, v53
v_mfma_f32_16x16x32_bf16 a[40:43], v[96:99], a[184:187], a[40:43]
s_add_u32 s29, s40, s37
v_cvt_pk_bf16_f32 v78, v52, v53
v_mfma_f32_16x16x32_bf16 a[44:47], v[100:103], a[184:187], a[44:47]
v_add_u32 v251, v251, v249
v_exp_f32 v54, v54
v_mfma_f32_16x16x32_bf16 a[60:63], v[100:103], a[188:191], a[60:63]
ds_read_b64_tr_b16 a[184:185], v222 offset:40960
ds_read_b64_tr_b16 a[186:187], v222 offset:45056
v_mfma_f32_16x16x32_bf16 a[56:59], v[96:99], a[188:191], a[56:59]
v_exp_f32 v55, v55
v_mfma_f32_16x16x32_bf16 a[52:55], v[92:95], a[188:191], a[52:55]
v_cvt_pk_bf16_f32 v79, v54, v55
v_sub_u32 v248, v248, v249
v_mfma_f32_16x16x32_bf16 a[48:51], v[88:91], a[188:191], a[48:51]
v_exp_f32 v56, v56
v_mfma_f32_16x16x32_bf16 v[12:15], a[160:163], v[152:155], v[136:139]
v_exp_f32 v57, v57
v_mfma_f32_16x16x32_bf16 v[12:15], a[164:167], v[156:159], v[12:15]
ds_read_b64_tr_b16 a[188:189], v223 offset:40960
v_cvt_pk_bf16_f32 v80, v56, v57
v_mfma_f32_16x16x32_bf16 v[12:15], a[168:171], v[160:163], v[12:15]
v_exp_f32 v58, v58
v_mfma_f32_16x16x32_bf16 v[12:15], a[172:175], v[164:167], v[12:15]
ds_read_b64_tr_b16 a[190:191], v223 offset:45056
v_cndmask_b32 v252, v252, v251, s[90:91]
v_mfma_f32_16x16x32_bf16 v[20:23], a[172:175], v[180:183], v[140:143]
v_exp_f32 v59, v59
v_mfma_f32_16x16x32_bf16 v[20:23], a[168:171], v[176:179], v[20:23]
s_lshl_b64 s[90:91], s[90:91], 1
v_cvt_pk_bf16_f32 v81, v58, v59
v_mfma_f32_16x16x32_bf16 v[20:23], a[164:167], v[172:175], v[20:23]
v_exp_f32 v60, v60
v_mfma_f32_16x16x32_bf16 v[20:23], a[160:163], v[168:171], v[20:23]
buffer_load_dwordx4 v232, s[12:15], s39 offen offset:0  lds
v_mfma_f32_16x16x32_bf16 v[28:31], a[160:163], v[184:187], v[144:147]
v_exp_f32 v61, v61
v_mfma_f32_16x16x32_bf16 v[28:31], a[164:167], v[188:191], v[28:31]
v_cvt_pk_bf16_f32 v82, v60, v61
v_max_u32_dpp v250, v248, v248 row_ror:8 row_mask:0xf bank_mask:0xf
v_mfma_f32_16x16x32_bf16 v[28:31], a[168:171], v[192:195], v[28:31]
v_exp_f32 v62, v62
v_mfma_f32_16x16x32_bf16 v[28:31], a[172:175], v[196:199], v[28:31]
buffer_load_dwordx4 v233, s[12:15], s39 offen offset:1024  lds
v_mfma_f32_16x16x32_bf16 v[36:39], a[172:175], v[212:215], v[148:151]
v_exp_f32 v63, v63
v_mfma_f32_16x16x32_bf16 v[36:39], a[168:171], v[208:211], v[36:39]
ds_read_b128 a[172:175], v219 offset:61440
v_cvt_pk_bf16_f32 v83, v62, v63
v_mfma_f32_16x16x32_bf16 v[36:39], a[164:167], v[204:207], v[36:39]
v_exp_f32 v64, v64
v_mfma_f32_16x16x32_bf16 v[36:39], a[160:163], v[200:203], v[36:39]
ds_read_b128 a[168:171], v218 offset:61440
ds_read_b128 a[164:167], v217 offset:61440
v_mfma_f32_16x16x32_bf16 a[64:67], v[88:91], a[192:195], a[64:67]
v_exp_f32 v65, v65
v_mfma_f32_16x16x32_bf16 a[68:71], v[92:95], a[192:195], a[68:71]
ds_read_b128 a[160:163], v216 offset:61440
v_cvt_pk_bf16_f32 v84, v64, v65
v_max_u32_dpp v249, v250, v250 row_ror:4 row_mask:0xf bank_mask:0xf
v_mfma_f32_16x16x32_bf16 a[72:75], v[96:99], a[192:195], a[72:75]
v_exp_f32 v66, v66
v_mfma_f32_16x16x32_bf16 a[76:79], v[100:103], a[192:195], a[76:79]
ds_read_b64_tr_b16 a[192:193], v224 offset:40960
ds_read_b64_tr_b16 a[194:195], v224 offset:45056
v_mfma_f32_16x16x32_bf16 a[92:95], v[100:103], a[196:199], a[92:95]
v_exp_f32 v67, v67
v_mfma_f32_16x16x32_bf16 a[88:91], v[96:99], a[196:199], a[88:91]
s_cmp_eq_u32 s29, 0
s_cselect_b32 s29, 0x24c000, -16
v_cvt_pk_bf16_f32 v85, v66, v67
v_mfma_f32_16x16x32_bf16 a[84:87], v[92:95], a[196:199], a[84:87]
v_max_u32_dpp v250, v249, v249 row_ror:2 row_mask:0xf bank_mask:0xf
v_exp_f32 v68, v68
v_mfma_f32_16x16x32_bf16 a[80:83], v[88:91], a[196:199], a[80:83]
ds_read_b64_tr_b16 a[196:197], v225 offset:40960
ds_read_b64_tr_b16 a[198:199], v225 offset:45056
s_waitcnt lgkmcnt(8)
v_mfma_f32_16x16x32_bf16 a[96:99], v[88:91], a[200:203], a[96:99]
v_exp_f32 v69, v69
v_mfma_f32_16x16x32_bf16 a[100:103], v[92:95], a[200:203], a[100:103]
buffer_store_dwordx2 v[246:247], v253, s[20:23], s29 offen
v_cvt_pk_bf16_f32 v86, v68, v69
v_mfma_f32_16x16x32_bf16 a[104:107], v[96:99], a[200:203], a[104:107]
v_max_u32_dpp v249, v250, v250 row_ror:1 row_mask:0xf bank_mask:0xf
v_exp_f32 v70, v70
v_mfma_f32_16x16x32_bf16 a[108:111], v[100:103], a[200:203], a[108:111]
ds_read_b64_tr_b16 a[200:201], v226 offset:40960
ds_read_b64_tr_b16 a[202:203], v226 offset:45056
v_mfma_f32_16x16x32_bf16 a[124:127], v[100:103], a[204:207], a[124:127]
v_exp_f32 v71, v71
v_mfma_f32_16x16x32_bf16 a[120:123], v[96:99], a[204:207], a[120:123]
v_cvt_pk_bf16_f32 v87, v70, v71
v_mov_b32 v250, v249
v_mfma_f32_16x16x32_bf16 a[116:119], v[92:95], a[204:207], a[116:119]
buffer_load_dwordx4 v232, s[12:15], s39 offen offset:2048  lds
v_mfma_f32_16x16x32_bf16 a[112:115], v[88:91], a[204:207], a[112:115]
ds_read_b64_tr_b16 a[204:205], v227 offset:40960
ds_read_b64_tr_b16 a[206:207], v227 offset:45056
v_smfmac_f32_16x16x64_bf16 a[128:131], a[208:211], v[88:95], v245
buffer_load_dwordx4 v233, s[12:15], s39 offen offset:3072  lds
STUB_7:
s_cbranch_execz STUB_10
v_smfmac_f32_16x16x64_bf16 a[132:135], a[208:211], v[96:103], v245
v_permlane16_swap_b32 v249, v250
v_max_u32 v249, v249, v250
v_mfma_f32_16x16x32_bf16 v[40:43], a[144:147], v[152:155], v[136:139]
v_exp_f32 v8, v8
v_mfma_f32_16x16x32_bf16 v[40:43], a[148:151], v[156:159], v[40:43]
v_exp_f32 v9, v9
v_mfma_f32_16x16x32_bf16 v[40:43], a[152:155], v[160:163], v[40:43]
v_cvt_pk_bf16_f32 v88, v8, v9
v_mov_b32 v250, v249
v_mfma_f32_16x16x32_bf16 v[40:43], a[156:159], v[164:167], v[40:43]
v_exp_f32 v10, v10
v_mfma_f32_16x16x32_bf16 v[48:51], a[156:159], v[180:183], v[140:143]
v_permlane32_swap_b32 v249, v250
v_max_u32 v249, v249, v250
v_mfma_f32_16x16x32_bf16 v[48:51], a[152:155], v[176:179], v[48:51]
v_exp_f32 v11, v11
v_mfma_f32_16x16x32_bf16 v[48:51], a[148:151], v[172:175], v[48:51]
v_cvt_pk_bf16_f32 v89, v10, v11
v_add_u32 v251, v251, v249
v_mfma_f32_16x16x32_bf16 v[48:51], a[144:147], v[168:171], v[48:51]
v_exp_f32 v12, v12
v_mfma_f32_16x16x32_bf16 v[56:59], a[144:147], v[184:187], v[144:147]
v_cndmask_b32 v252, v252, v251, s[90:91]
v_mfma_f32_16x16x32_bf16 v[56:59], a[148:151], v[188:191], v[56:59]
v_exp_f32 v13, v13
v_mfma_f32_16x16x32_bf16 v[56:59], a[152:155], v[192:195], v[56:59]
v_cvt_pk_bf16_f32 v90, v12, v13
v_mov_b32 v236, v252
v_mfma_f32_16x16x32_bf16 v[56:59], a[156:159], v[196:199], v[56:59]
v_exp_f32 v14, v14
v_mfma_f32_16x16x32_bf16 v[64:67], a[156:159], v[212:215], v[148:151]
s_waitcnt vmcnt(9) lgkmcnt(0)
s_barrier
v_mfma_f32_16x16x32_bf16 v[64:67], a[152:155], v[208:211], v[64:67]
v_exp_f32 v15, v15
v_mfma_f32_16x16x32_bf16 v[64:67], a[148:151], v[204:207], v[64:67]
ds_read_b128 a[156:159], v219 offset:0
v_cvt_pk_bf16_f32 v91, v14, v15
v_mfma_f32_16x16x32_bf16 v[64:67], a[144:147], v[200:203], v[64:67]
v_exp_f32 v16, v16
v_mfma_f32_16x16x32_bf16 a[0:3], v[72:75], a[176:179], a[0:3]
ds_read_b128 a[152:155], v218 offset:0
ds_read_b128 a[148:151], v217 offset:0
v_mfma_f32_16x16x32_bf16 a[4:7], v[76:79], a[176:179], a[4:7]
v_exp_f32 v17, v17
v_mfma_f32_16x16x32_bf16 a[8:11], v[80:83], a[176:179], a[8:11]
ds_read_b128 a[144:147], v216 offset:0
v_cvt_pk_bf16_f32 v92, v16, v17
v_mfma_f32_16x16x32_bf16 a[12:15], v[84:87], a[176:179], a[12:15]
v_exp_f32 v18, v18
v_mfma_f32_16x16x32_bf16 a[28:31], v[84:87], a[180:183], a[28:31]
ds_read_b64_tr_b16 a[176:177], v220 offset:49152
ds_read_b64_tr_b16 a[178:179], v220 offset:53248
v_mfma_f32_16x16x32_bf16 a[24:27], v[80:83], a[180:183], a[24:27]
v_exp_f32 v19, v19
v_mfma_f32_16x16x32_bf16 a[20:23], v[76:79], a[180:183], a[20:23]
s_add_u32 s32, s32, 16384
v_cvt_pk_bf16_f32 v93, v18, v19
v_mfma_f32_16x16x32_bf16 a[16:19], v[72:75], a[180:183], a[16:19]
v_exp_f32 v20, v20
v_mfma_f32_16x16x32_bf16 a[32:35], v[72:75], a[184:187], a[32:35]
ds_read_b64_tr_b16 a[180:181], v221 offset:49152
ds_read_b64_tr_b16 a[182:183], v221 offset:53248
v_mfma_f32_16x16x32_bf16 a[36:39], v[76:79], a[184:187], a[36:39]
v_exp_f32 v21, v21
v_mfma_f32_16x16x32_bf16 a[40:43], v[80:83], a[184:187], a[40:43]
s_add_u32 m0, s30, 114688
v_cvt_pk_bf16_f32 v94, v20, v21
v_mfma_f32_16x16x32_bf16 a[44:47], v[84:87], a[184:187], a[44:47]
v_exp_f32 v22, v22
v_mfma_f32_16x16x32_bf16 a[60:63], v[84:87], a[188:191], a[60:63]
ds_read_b64_tr_b16 a[184:185], v222 offset:49152
ds_read_b64_tr_b16 a[186:187], v222 offset:53248
v_mfma_f32_16x16x32_bf16 a[56:59], v[80:83], a[188:191], a[56:59]
v_exp_f32 v23, v23
v_mfma_f32_16x16x32_bf16 a[52:55], v[76:79], a[188:191], a[52:55]
v_cvt_pk_bf16_f32 v95, v22, v23
v_and_b32 v252, 0xffff, v252
v_mfma_f32_16x16x32_bf16 a[48:51], v[72:75], a[188:191], a[48:51]
v_exp_f32 v24, v24
v_mfma_f32_16x16x32_bf16 v[44:47], a[160:163], v[152:155], v[136:139]
v_exp_f32 v25, v25
v_mfma_f32_16x16x32_bf16 v[44:47], a[164:167], v[156:159], v[44:47]
ds_read_b64_tr_b16 a[188:189], v223 offset:49152
v_cvt_pk_bf16_f32 v96, v24, v25
v_mfma_f32_16x16x32_bf16 v[44:47], a[168:171], v[160:163], v[44:47]
v_exp_f32 v26, v26
v_mfma_f32_16x16x32_bf16 v[44:47], a[172:175], v[164:167], v[44:47]
ds_read_b64_tr_b16 a[190:191], v223 offset:53248
v_sub_u32 v252, 0xffff, v252
v_mfma_f32_16x16x32_bf16 v[52:55], a[172:175], v[180:183], v[140:143]
v_exp_f32 v27, v27
v_mfma_f32_16x16x32_bf16 v[52:55], a[168:171], v[176:179], v[52:55]
v_cvt_pk_bf16_f32 v97, v26, v27
v_mul_u32_u24 v252, 0x480, v252
v_mfma_f32_16x16x32_bf16 v[52:55], a[164:167], v[172:175], v[52:55]
v_exp_f32 v28, v28
v_mfma_f32_16x16x32_bf16 v[52:55], a[160:163], v[168:171], v[52:55]
buffer_load_dwordx4 v228, s[8:11], s32 offen offset:0  lds
v_mfma_f32_16x16x32_bf16 v[60:63], a[160:163], v[184:187], v[144:147]
v_exp_f32 v29, v29
v_mfma_f32_16x16x32_bf16 v[60:63], a[164:167], v[188:191], v[60:63]
v_cvt_pk_bf16_f32 v98, v28, v29
v_lshrrev_b32 v249, 3, v0
v_mfma_f32_16x16x32_bf16 v[60:63], a[168:171], v[192:195], v[60:63]
v_exp_f32 v30, v30
v_mfma_f32_16x16x32_bf16 v[60:63], a[172:175], v[196:199], v[60:63]
buffer_load_dwordx4 v229, s[8:11], s32 offen offset:1024  lds
v_mfma_f32_16x16x32_bf16 v[68:71], a[172:175], v[212:215], v[148:151]
v_exp_f32 v31, v31
v_mfma_f32_16x16x32_bf16 v[68:71], a[168:171], v[208:211], v[68:71]
ds_read_b128 a[172:175], v219 offset:4096
v_cvt_pk_bf16_f32 v99, v30, v31
v_mfma_f32_16x16x32_bf16 v[68:71], a[164:167], v[204:207], v[68:71]
v_exp_f32 v32, v32
v_mfma_f32_16x16x32_bf16 v[68:71], a[160:163], v[200:203], v[68:71]
ds_read_b128 a[168:171], v218 offset:4096
ds_read_b128 a[164:167], v217 offset:4096
v_mfma_f32_16x16x32_bf16 a[64:67], v[72:75], a[192:195], a[64:67]
v_exp_f32 v33, v33
v_mfma_f32_16x16x32_bf16 a[68:71], v[76:79], a[192:195], a[68:71]
ds_read_b128 a[160:163], v216 offset:4096
v_cvt_pk_bf16_f32 v100, v32, v33
v_mfma_f32_16x16x32_bf16 a[72:75], v[80:83], a[192:195], a[72:75]
v_exp_f32 v34, v34
v_mfma_f32_16x16x32_bf16 a[76:79], v[84:87], a[192:195], a[76:79]
ds_read_b64_tr_b16 a[192:193], v224 offset:49152
ds_read_b64_tr_b16 a[194:195], v224 offset:53248
v_mfma_f32_16x16x32_bf16 a[92:95], v[84:87], a[196:199], a[92:95]
v_exp_f32 v35, v35
v_mfma_f32_16x16x32_bf16 a[88:91], v[80:83], a[196:199], a[88:91]
v_cvt_pk_bf16_f32 v101, v34, v35
v_lshl_add_u32 v252, v249, 4, v252
v_mfma_f32_16x16x32_bf16 a[84:87], v[76:79], a[196:199], a[84:87]
v_exp_f32 v36, v36
v_mfma_f32_16x16x32_bf16 a[80:83], v[72:75], a[196:199], a[80:83]
ds_read_b64_tr_b16 a[196:197], v225 offset:49152
ds_read_b64_tr_b16 a[198:199], v225 offset:53248
v_mfma_f32_16x16x32_bf16 a[96:99], v[72:75], a[200:203], a[96:99]
v_exp_f32 v37, v37
v_mfma_f32_16x16x32_bf16 a[100:103], v[76:79], a[200:203], a[100:103]
v_cvt_pk_bf16_f32 v102, v36, v37
v_mfma_f32_16x16x32_bf16 a[104:107], v[80:83], a[200:203], a[104:107]
v_exp_f32 v38, v38
v_mfma_f32_16x16x32_bf16 a[108:111], v[84:87], a[200:203], a[108:111]
ds_read_b64_tr_b16 a[200:201], v226 offset:49152
ds_read_b64_tr_b16 a[202:203], v226 offset:53248
v_mfma_f32_16x16x32_bf16 a[124:127], v[84:87], a[204:207], a[124:127]
v_exp_f32 v39, v39
v_mfma_f32_16x16x32_bf16 a[120:123], v[80:83], a[204:207], a[120:123]
v_cvt_pk_bf16_f32 v103, v38, v39
v_mfma_f32_16x16x32_bf16 a[116:119], v[76:79], a[204:207], a[116:119]
buffer_load_dwordx4 v230, s[8:11], s32 offen offset:2048  lds
v_mfma_f32_16x16x32_bf16 a[112:115], v[72:75], a[204:207], a[112:115]
ds_read_b64_tr_b16 a[204:205], v227 offset:49152
ds_read_b64_tr_b16 a[206:207], v227 offset:53248
v_smfmac_f32_16x16x64_bf16 a[128:131], a[208:211], v[72:79], v245
buffer_load_dwordx4 v231, s[8:11], s32 offen offset:3072  lds
v_smfmac_f32_16x16x64_bf16 a[132:135], a[208:211], v[80:87], v245
s_add_u32 m0, s86, 0
s_add_u32 s50, s84, 4718592
buffer_load_dwordx4 v240, s[64:67], s50 offen lds
s_add_u32 m0, s86, 4096
s_add_u32 s50, s84, 4718592
buffer_load_dwordx4 v240, s[68:71], s50 offen lds
s_add_u32 m0, s86, 8192
s_add_u32 s50, s85, 0
buffer_load_dwordx4 v244, s[72:75], s50 offen lds
s_add_u32 m0, s86, 12288
s_add_u32 s50, s85, 4096
buffer_load_dwordx4 v244, s[72:75], s50 offen lds
s_waitcnt lgkmcnt(8)
v_mfma_f32_16x16x32_bf16 v[8:11], a[144:147], v[152:155], v[136:139]
v_exp_f32 v40, v40
v_mfma_f32_16x16x32_bf16 v[8:11], a[148:151], v[156:159], v[8:11]
v_exp_f32 v41, v41
v_mfma_f32_16x16x32_bf16 v[8:11], a[152:155], v[160:163], v[8:11]
v_cvt_pk_bf16_f32 v72, v40, v41
v_mfma_f32_16x16x32_bf16 v[8:11], a[156:159], v[164:167], v[8:11]
v_exp_f32 v42, v42
v_mfma_f32_16x16x32_bf16 v[16:19], a[156:159], v[180:183], v[140:143]
s_add_u32 s39, s39, 16384
v_mfma_f32_16x16x32_bf16 v[16:19], a[152:155], v[176:179], v[16:19]
v_exp_f32 v43, v43
v_mfma_f32_16x16x32_bf16 v[16:19], a[148:151], v[172:175], v[16:19]
v_cvt_pk_bf16_f32 v73, v42, v43
v_mfma_f32_16x16x32_bf16 v[16:19], a[144:147], v[168:171], v[16:19]
v_exp_f32 v44, v44
v_mfma_f32_16x16x32_bf16 v[24:27], a[144:147], v[184:187], v[144:147]
s_add_u32 m0, s30, 131072
v_mfma_f32_16x16x32_bf16 v[24:27], a[148:151], v[188:191], v[24:27]
v_exp_f32 v45, v45
v_mfma_f32_16x16x32_bf16 v[24:27], a[152:155], v[192:195], v[24:27]
v_cvt_pk_bf16_f32 v74, v44, v45
v_mfma_f32_16x16x32_bf16 v[24:27], a[156:159], v[196:199], v[24:27]
v_exp_f32 v46, v46
v_mfma_f32_16x16x32_bf16 v[32:35], a[156:159], v[212:215], v[148:151]
ds_read_b128 a[156:159], v219 offset:8192
v_mfma_f32_16x16x32_bf16 v[32:35], a[152:155], v[208:211], v[32:35]
v_exp_f32 v47, v47
v_mfma_f32_16x16x32_bf16 v[32:35], a[148:151], v[204:207], v[32:35]
ds_read_b128 a[152:155], v218 offset:8192
v_cvt_pk_bf16_f32 v75, v46, v47
v_mfma_f32_16x16x32_bf16 v[32:35], a[144:147], v[200:203], v[32:35]
v_exp_f32 v48, v48
v_mfma_f32_16x16x32_bf16 a[0:3], v[88:91], a[176:179], a[0:3]
ds_read_b128 a[148:151], v217 offset:8192
ds_read_b128 a[144:147], v216 offset:8192
v_mfma_f32_16x16x32_bf16 a[4:7], v[92:95], a[176:179], a[4:7]
v_exp_f32 v49, v49
v_mfma_f32_16x16x32_bf16 a[8:11], v[96:99], a[176:179], a[8:11]
v_cvt_pk_bf16_f32 v76, v48, v49
v_mfma_f32_16x16x32_bf16 a[12:15], v[100:103], a[176:179], a[12:15]
v_exp_f32 v50, v50
v_mfma_f32_16x16x32_bf16 a[28:31], v[100:103], a[180:183], a[28:31]
ds_read_b64_tr_b16 a[176:177], v220 offset:57344
ds_read_b64_tr_b16 a[178:179], v220 offset:61440
v_mfma_f32_16x16x32_bf16 a[24:27], v[96:99], a[180:183], a[24:27]
v_exp_f32 v51, v51
v_mfma_f32_16x16x32_bf16 a[20:23], v[92:95], a[180:183], a[20:23]
v_cvt_pk_bf16_f32 v77, v50, v51
v_mfma_f32_16x16x32_bf16 a[16:19], v[88:91], a[180:183], a[16:19]
v_exp_f32 v52, v52
v_mfma_f32_16x16x32_bf16 a[32:35], v[88:91], a[184:187], a[32:35]
ds_read_b64_tr_b16 a[180:181], v221 offset:57344
ds_read_b64_tr_b16 a[182:183], v221 offset:61440
v_mfma_f32_16x16x32_bf16 a[36:39], v[92:95], a[184:187], a[36:39]
v_exp_f32 v53, v53
v_mfma_f32_16x16x32_bf16 a[40:43], v[96:99], a[184:187], a[40:43]
v_cvt_pk_bf16_f32 v78, v52, v53
v_mfma_f32_16x16x32_bf16 a[44:47], v[100:103], a[184:187], a[44:47]
v_exp_f32 v54, v54
v_mfma_f32_16x16x32_bf16 a[60:63], v[100:103], a[188:191], a[60:63]
ds_read_b64_tr_b16 a[184:185], v222 offset:57344
ds_read_b64_tr_b16 a[186:187], v222 offset:61440
v_mfma_f32_16x16x32_bf16 a[56:59], v[96:99], a[188:191], a[56:59]
v_exp_f32 v55, v55
v_mfma_f32_16x16x32_bf16 a[52:55], v[92:95], a[188:191], a[52:55]
v_cvt_pk_bf16_f32 v79, v54, v55
v_mfma_f32_16x16x32_bf16 a[48:51], v[88:91], a[188:191], a[48:51]
v_exp_f32 v56, v56
v_mfma_f32_16x16x32_bf16 v[12:15], a[160:163], v[152:155], v[136:139]
v_exp_f32 v57, v57
v_mfma_f32_16x16x32_bf16 v[12:15], a[164:167], v[156:159], v[12:15]
ds_read_b64_tr_b16 a[188:189], v223 offset:57344
v_cvt_pk_bf16_f32 v80, v56, v57
v_mfma_f32_16x16x32_bf16 v[12:15], a[168:171], v[160:163], v[12:15]
v_exp_f32 v58, v58
v_mfma_f32_16x16x32_bf16 v[12:15], a[172:175], v[164:167], v[12:15]
ds_read_b64_tr_b16 a[190:191], v223 offset:61440
v_mfma_f32_16x16x32_bf16 v[20:23], a[172:175], v[180:183], v[140:143]
v_exp_f32 v59, v59
v_mfma_f32_16x16x32_bf16 v[20:23], a[168:171], v[176:179], v[20:23]
v_cvt_pk_bf16_f32 v81, v58, v59
v_mfma_f32_16x16x32_bf16 v[20:23], a[164:167], v[172:175], v[20:23]
v_exp_f32 v60, v60
v_mfma_f32_16x16x32_bf16 v[20:23], a[160:163], v[168:171], v[20:23]
buffer_load_dwordx4 v232, s[12:15], s39 offen offset:0  lds
v_mfma_f32_16x16x32_bf16 v[28:31], a[160:163], v[184:187], v[144:147]
v_exp_f32 v61, v61
v_mfma_f32_16x16x32_bf16 v[28:31], a[164:167], v[188:191], v[28:31]
v_cvt_pk_bf16_f32 v82, v60, v61
v_mfma_f32_16x16x32_bf16 v[28:31], a[168:171], v[192:195], v[28:31]
v_exp_f32 v62, v62
v_mfma_f32_16x16x32_bf16 v[28:31], a[172:175], v[196:199], v[28:31]
buffer_load_dwordx4 v233, s[12:15], s39 offen offset:1024  lds
v_mfma_f32_16x16x32_bf16 v[36:39], a[172:175], v[212:215], v[148:151]
v_exp_f32 v63, v63
v_mfma_f32_16x16x32_bf16 v[36:39], a[168:171], v[208:211], v[36:39]
ds_read_b128 a[172:175], v219 offset:12288
v_cvt_pk_bf16_f32 v83, v62, v63
v_mfma_f32_16x16x32_bf16 v[36:39], a[164:167], v[204:207], v[36:39]
v_exp_f32 v64, v64
v_mfma_f32_16x16x32_bf16 v[36:39], a[160:163], v[200:203], v[36:39]
ds_read_b128 a[168:171], v218 offset:12288
ds_read_b128 a[164:167], v217 offset:12288
s_waitcnt lgkmcnt(8)
v_mfma_f32_16x16x32_bf16 a[64:67], v[88:91], a[192:195], a[64:67]
v_exp_f32 v65, v65
v_mfma_f32_16x16x32_bf16 a[68:71], v[92:95], a[192:195], a[68:71]
ds_read_b128 a[160:163], v216 offset:12288
v_cvt_pk_bf16_f32 v84, v64, v65
v_mfma_f32_16x16x32_bf16 a[72:75], v[96:99], a[192:195], a[72:75]
v_exp_f32 v66, v66
v_mfma_f32_16x16x32_bf16 a[76:79], v[100:103], a[192:195], a[76:79]
ds_read_b64_tr_b16 a[192:193], v224 offset:57344
ds_read_b64_tr_b16 a[194:195], v224 offset:61440
v_mfma_f32_16x16x32_bf16 a[92:95], v[100:103], a[196:199], a[92:95]
v_exp_f32 v67, v67
v_mfma_f32_16x16x32_bf16 a[88:91], v[96:99], a[196:199], a[88:91]
v_cvt_pk_bf16_f32 v85, v66, v67
v_mfma_f32_16x16x32_bf16 a[84:87], v[92:95], a[196:199], a[84:87]
v_exp_f32 v68, v68
v_mfma_f32_16x16x32_bf16 a[80:83], v[88:91], a[196:199], a[80:83]
ds_read_b64_tr_b16 a[196:197], v225 offset:57344
ds_read_b64_tr_b16 a[198:199], v225 offset:61440
v_mfma_f32_16x16x32_bf16 a[96:99], v[88:91], a[200:203], a[96:99]
v_exp_f32 v69, v69
v_mfma_f32_16x16x32_bf16 a[100:103], v[92:95], a[200:203], a[100:103]
v_cvt_pk_bf16_f32 v86, v68, v69
v_mfma_f32_16x16x32_bf16 a[104:107], v[96:99], a[200:203], a[104:107]
v_exp_f32 v70, v70
v_mfma_f32_16x16x32_bf16 a[108:111], v[100:103], a[200:203], a[108:111]
ds_read_b64_tr_b16 a[200:201], v226 offset:57344
ds_read_b64_tr_b16 a[202:203], v226 offset:61440
v_mfma_f32_16x16x32_bf16 a[124:127], v[100:103], a[204:207], a[124:127]
v_exp_f32 v71, v71
v_mfma_f32_16x16x32_bf16 a[120:123], v[96:99], a[204:207], a[120:123]
v_cvt_pk_bf16_f32 v87, v70, v71
v_mfma_f32_16x16x32_bf16 a[116:119], v[92:95], a[204:207], a[116:119]
buffer_load_dwordx4 v232, s[12:15], s39 offen offset:2048  lds
v_mfma_f32_16x16x32_bf16 a[112:115], v[88:91], a[204:207], a[112:115]
ds_read_b64_tr_b16 a[204:205], v227 offset:57344
ds_read_b64_tr_b16 a[206:207], v227 offset:61440
v_smfmac_f32_16x16x64_bf16 a[128:131], a[208:211], v[88:95], v245
buffer_load_dwordx4 v233, s[12:15], s39 offen offset:3072  lds
v_smfmac_f32_16x16x64_bf16 a[132:135], a[208:211], v[96:103], v245
s_add_u32 m0, s86, 45056
s_mov_b32 s50, 29360128
buffer_load_dwordx4 v252, s[20:23], s50 offen sc0 sc1 lds
s_add_u32 m0, s86, 49152
s_mov_b32 s50, 29360640
buffer_load_dwordx4 v252, s[20:23], s50 offen sc0 sc1 lds
s_add_u32 m0, s86, 53248
s_mov_b32 s50, 29361152
buffer_load_dwordx4 v252, s[20:23], s50 offen sc0 sc1 lds
s_add_u32 m0, s86, 16384
s_add_u32 s50, s85, 8192
buffer_load_dwordx4 v244, s[72:75], s50 offen lds
v_mfma_f32_16x16x32_bf16 v[40:43], a[144:147], v[152:155], v[136:139]
v_mov_b32 v248, v236
v_exp_f32 v8, v8
v_mfma_f32_16x16x32_bf16 v[40:43], a[148:151], v[156:159], v[40:43]
v_mov_b32 v249, s47
v_exp_f32 v9, v9
v_mfma_f32_16x16x32_bf16 v[40:43], a[152:155], v[160:163], v[40:43]
v_cvt_pk_bf16_f32 v88, v8, v9
v_and_b32 v250, 7, v1
v_lshlrev_b32 v250, 3, v250
v_mfma_f32_16x16x32_bf16 v[40:43], a[156:159], v[164:167], v[40:43]
s_add_u32 s29, s40, s37
v_exp_f32 v10, v10
v_mfma_f32_16x16x32_bf16 v[48:51], a[156:159], v[180:183], v[140:143]
s_cmp_eq_u32 s29, 0
s_mov_b32 s29, 0x7ffffff0
s_cselect_b32 s29, 0x242800, s29
v_mfma_f32_16x16x32_bf16 v[48:51], a[152:155], v[176:179], v[48:51]
v_exp_f32 v11, v11
v_mfma_f32_16x16x32_bf16 v[48:51], a[148:151], v[172:175], v[48:51]
v_cvt_pk_bf16_f32 v89, v10, v11
v_mfma_f32_16x16x32_bf16 v[48:51], a[144:147], v[168:171], v[48:51]
v_exp_f32 v12, v12
v_mfma_f32_16x16x32_bf16 v[56:59], a[144:147], v[184:187], v[144:147]
v_mfma_f32_16x16x32_bf16 v[56:59], a[148:151], v[188:191], v[56:59]
v_exp_f32 v13, v13
v_mfma_f32_16x16x32_bf16 v[56:59], a[152:155], v[192:195], v[56:59]
v_cvt_pk_bf16_f32 v90, v12, v13
v_mfma_f32_16x16x32_bf16 v[56:59], a[156:159], v[196:199], v[56:59]
v_exp_f32 v14, v14
v_mfma_f32_16x16x32_bf16 v[64:67], a[156:159], v[212:215], v[148:151]
s_waitcnt vmcnt(16) lgkmcnt(0)
s_barrier
v_mfma_f32_16x16x32_bf16 v[64:67], a[152:155], v[208:211], v[64:67]
v_exp_f32 v15, v15
v_mfma_f32_16x16x32_bf16 v[64:67], a[148:151], v[204:207], v[64:67]
ds_read_b128 a[156:159], v219 offset:16384
v_cvt_pk_bf16_f32 v91, v14, v15
v_mfma_f32_16x16x32_bf16 v[64:67], a[144:147], v[200:203], v[64:67]
v_exp_f32 v16, v16
v_mfma_f32_16x16x32_bf16 a[0:3], v[72:75], a[176:179], a[0:3]
ds_read_b128 a[152:155], v218 offset:16384
ds_read_b128 a[148:151], v217 offset:16384
v_mfma_f32_16x16x32_bf16 a[4:7], v[76:79], a[176:179], a[4:7]
v_exp_f32 v17, v17
v_mfma_f32_16x16x32_bf16 a[8:11], v[80:83], a[176:179], a[8:11]
ds_read_b128 a[144:147], v216 offset:16384
v_cvt_pk_bf16_f32 v92, v16, v17
v_mfma_f32_16x16x32_bf16 a[12:15], v[84:87], a[176:179], a[12:15]
v_exp_f32 v18, v18
v_mfma_f32_16x16x32_bf16 a[28:31], v[84:87], a[180:183], a[28:31]
ds_read_b64_tr_b16 a[176:177], v220 offset:0
ds_read_b64_tr_b16 a[178:179], v220 offset:4096
v_mfma_f32_16x16x32_bf16 a[24:27], v[80:83], a[180:183], a[24:27]
v_exp_f32 v19, v19
v_mfma_f32_16x16x32_bf16 a[20:23], v[76:79], a[180:183], a[20:23]
s_add_u32 s32, s32, 16384
v_cvt_pk_bf16_f32 v93, v18, v19
v_mfma_f32_16x16x32_bf16 a[16:19], v[72:75], a[180:183], a[16:19]
v_exp_f32 v20, v20
v_mfma_f32_16x16x32_bf16 a[32:35], v[72:75], a[184:187], a[32:35]
ds_read_b64_tr_b16 a[180:181], v221 offset:0
ds_read_b64_tr_b16 a[182:183], v221 offset:4096
v_mfma_f32_16x16x32_bf16 a[36:39], v[76:79], a[184:187], a[36:39]
v_exp_f32 v21, v21
v_mfma_f32_16x16x32_bf16 a[40:43], v[80:83], a[184:187], a[40:43]
s_add_u32 m0, s30, 65536
v_cvt_pk_bf16_f32 v94, v20, v21
v_mfma_f32_16x16x32_bf16 a[44:47], v[84:87], a[184:187], a[44:47]
v_exp_f32 v22, v22
v_mfma_f32_16x16x32_bf16 a[60:63], v[84:87], a[188:191], a[60:63]
ds_read_b64_tr_b16 a[184:185], v222 offset:0
ds_read_b64_tr_b16 a[186:187], v222 offset:4096
v_mfma_f32_16x16x32_bf16 a[56:59], v[80:83], a[188:191], a[56:59]
v_exp_f32 v23, v23
v_mfma_f32_16x16x32_bf16 a[52:55], v[76:79], a[188:191], a[52:55]
buffer_store_dwordx2 v[248:249], v250, s[20:23], s29 offen sc0 sc1
v_cvt_pk_bf16_f32 v95, v22, v23
v_mfma_f32_16x16x32_bf16 a[48:51], v[72:75], a[188:191], a[48:51]
v_ashrrev_i32 v246, 31, v236
v_exp_f32 v24, v24
v_mfma_f32_16x16x32_bf16 v[44:47], a[160:163], v[152:155], v[136:139]
v_not_b32 v246, v246
v_exp_f32 v25, v25
v_mfma_f32_16x16x32_bf16 v[44:47], a[164:167], v[156:159], v[44:47]
ds_read_b64_tr_b16 a[188:189], v223 offset:0
v_cvt_pk_bf16_f32 v96, v24, v25
v_or_b32 v246, 0x80000000, v246
v_mfma_f32_16x16x32_bf16 v[44:47], a[168:171], v[160:163], v[44:47]
v_xor_b32 v236, v236, v246
v_exp_f32 v26, v26
v_mfma_f32_16x16x32_bf16 v[44:47], a[172:175], v[164:167], v[44:47]
ds_read_b64_tr_b16 a[190:191], v223 offset:4096
v_and_b32 v236, 0xffff0000, v236
v_mul_f32 v236, 0xbfb8aa3b, v236
v_mfma_f32_16x16x32_bf16 v[52:55], a[172:175], v[180:183], v[140:143]
v_exp_f32 v27, v27
v_mfma_f32_16x16x32_bf16 v[52:55], a[168:171], v[176:179], v[52:55]
v_cvt_pk_bf16_f32 v97, v26, v27
v_exp_f32 v236, v236
v_mfma_f32_16x16x32_bf16 v[52:55], a[164:167], v[172:175], v[52:55]
v_add_f32 v236, 1.0, v236
v_exp_f32 v28, v28
v_mfma_f32_16x16x32_bf16 v[52:55], a[160:163], v[168:171], v[52:55]
buffer_load_dwordx4 v228, s[8:11], s32 offen offset:0  lds
v_mfma_f32_16x16x32_bf16 v[60:63], a[160:163], v[184:187], v[144:147]
v_exp_f32 v29, v29
v_mfma_f32_16x16x32_bf16 v[60:63], a[164:167], v[188:191], v[60:63]
v_cvt_pk_bf16_f32 v98, v28, v29
v_rcp_f32 v236, v236
v_mfma_f32_16x16x32_bf16 v[60:63], a[168:171], v[192:195], v[60:63]
v_cvt_pk_bf16_f32 v236, v236, v236
v_exp_f32 v30, v30
v_mfma_f32_16x16x32_bf16 v[60:63], a[172:175], v[196:199], v[60:63]
buffer_load_dwordx4 v229, s[8:11], s32 offen offset:1024  lds
v_lshlrev_b32 v236, 16, v236
v_mfma_f32_16x16x32_bf16 v[68:71], a[172:175], v[212:215], v[148:151]
v_exp_f32 v31, v31
v_mfma_f32_16x16x32_bf16 v[68:71], a[168:171], v[208:211], v[68:71]
ds_read_b128 a[172:175], v219 offset:20480
s_lshr_b32 s28, s37, 1
v_cvt_pk_bf16_f32 v99, v30, v31
v_mfma_f32_16x16x32_bf16 v[68:71], a[164:167], v[204:207], v[68:71]
v_exp_f32 v32, v32
v_mfma_f32_16x16x32_bf16 v[68:71], a[160:163], v[200:203], v[68:71]
ds_read_b128 a[168:171], v218 offset:20480
ds_read_b128 a[164:167], v217 offset:20480
v_mfma_f32_16x16x32_bf16 a[64:67], v[72:75], a[192:195], a[64:67]
v_exp_f32 v33, v33
v_mfma_f32_16x16x32_bf16 a[68:71], v[76:79], a[192:195], a[68:71]
ds_read_b128 a[160:163], v216 offset:20480
s_mul_i32 s28, s28, 28672
v_cvt_pk_bf16_f32 v100, v32, v33
v_mfma_f32_16x16x32_bf16 a[72:75], v[80:83], a[192:195], a[72:75]
v_exp_f32 v34, v34
v_mfma_f32_16x16x32_bf16 a[76:79], v[84:87], a[192:195], a[76:79]
ds_read_b64_tr_b16 a[192:193], v224 offset:0
ds_read_b64_tr_b16 a[194:195], v224 offset:4096
v_mfma_f32_16x16x32_bf16 a[92:95], v[84:87], a[196:199], a[92:95]
v_exp_f32 v35, v35
v_mfma_f32_16x16x32_bf16 a[88:91], v[80:83], a[196:199], a[88:91]
v_cvt_pk_bf16_f32 v101, v34, v35
v_subrev_u32 v241, s28, v241
v_mfma_f32_16x16x32_bf16 a[84:87], v[76:79], a[196:199], a[84:87]
v_exp_f32 v36, v36
v_mfma_f32_16x16x32_bf16 a[80:83], v[72:75], a[196:199], a[80:83]
ds_read_b64_tr_b16 a[196:197], v225 offset:0
ds_read_b64_tr_b16 a[198:199], v225 offset:4096
v_mfma_f32_16x16x32_bf16 a[96:99], v[72:75], a[200:203], a[96:99]
v_exp_f32 v37, v37
v_mfma_f32_16x16x32_bf16 a[100:103], v[76:79], a[200:203], a[100:103]
v_cvt_pk_bf16_f32 v102, v36, v37
v_and_b32 v239, 7, v1
v_mfma_f32_16x16x32_bf16 a[104:107], v[80:83], a[200:203], a[104:107]
v_exp_f32 v38, v38
v_mfma_f32_16x16x32_bf16 a[108:111], v[84:87], a[200:203], a[108:111]
ds_read_b64_tr_b16 a[200:201], v226 offset:0
ds_read_b64_tr_b16 a[202:203], v226 offset:4096
v_mfma_f32_16x16x32_bf16 a[124:127], v[84:87], a[204:207], a[124:127]
v_exp_f32 v39, v39
v_mfma_f32_16x16x32_bf16 a[120:123], v[80:83], a[204:207], a[120:123]
v_cvt_pk_bf16_f32 v103, v38, v39
v_lshl_add_u32 v239, v4, 3, v239
v_mfma_f32_16x16x32_bf16 a[116:119], v[76:79], a[204:207], a[116:119]
buffer_load_dwordx4 v230, s[8:11], s32 offen offset:2048  lds
v_mfma_f32_16x16x32_bf16 a[112:115], v[72:75], a[204:207], a[112:115]
ds_read_b64_tr_b16 a[204:205], v227 offset:0
ds_read_b64_tr_b16 a[206:207], v227 offset:4096
v_smfmac_f32_16x16x64_bf16 a[128:131], a[208:211], v[72:79], v245
buffer_load_dwordx4 v231, s[8:11], s32 offen offset:3072  lds
v_smfmac_f32_16x16x64_bf16 a[132:135], a[208:211], v[80:87], v245
s_add_u32 m0, s86, 20480
s_add_u32 s50, s85, 12288
buffer_load_dwordx4 v244, s[72:75], s50 offen lds
s_add_u32 m0, s86, 24576
s_add_u32 s50, s85, 16384
buffer_load_dwordx4 v244, s[72:75], s50 offen lds
s_add_u32 m0, s86, 28672
s_add_u32 s50, s85, 20480
buffer_load_dwordx4 v244, s[72:75], s50 offen lds
s_waitcnt lgkmcnt(8)
v_mfma_f32_16x16x32_bf16 v[8:11], a[144:147], v[152:155], v[136:139]
v_exp_f32 v40, v40
v_mfma_f32_16x16x32_bf16 v[8:11], a[148:151], v[156:159], v[8:11]
v_lshlrev_b32 v239, 4, v239
v_exp_f32 v41, v41
v_mfma_f32_16x16x32_bf16 v[8:11], a[152:155], v[160:163], v[8:11]
v_cvt_pk_bf16_f32 v72, v40, v41
v_add_u32 v237, s31, v244
v_mfma_f32_16x16x32_bf16 v[8:11], a[156:159], v[164:167], v[8:11]
v_exp_f32 v42, v42
v_mfma_f32_16x16x32_bf16 v[16:19], a[156:159], v[180:183], v[140:143]
s_add_u32 s39, s39, 16384
v_lshl_add_u32 v238, v4, 3, v3
v_mfma_f32_16x16x32_bf16 v[16:19], a[152:155], v[176:179], v[16:19]
v_exp_f32 v43, v43
v_mfma_f32_16x16x32_bf16 v[16:19], a[148:151], v[172:175], v[16:19]
v_cvt_pk_bf16_f32 v73, v42, v43
v_lshlrev_b32 v238, 4, v238
v_mfma_f32_16x16x32_bf16 v[16:19], a[144:147], v[168:171], v[16:19]
v_exp_f32 v44, v44
v_mfma_f32_16x16x32_bf16 v[24:27], a[144:147], v[184:187], v[144:147]
v_mov_b32 v246, 0x7ffffff0
v_cmp_lt_u32 vcc, 7, v3
v_mfma_f32_16x16x32_bf16 v[24:27], a[148:151], v[188:191], v[24:27]
v_exp_f32 v45, v45
v_mfma_f32_16x16x32_bf16 v[24:27], a[152:155], v[192:195], v[24:27]
s_add_u32 m0, s30, 147456
v_cvt_pk_bf16_f32 v74, v44, v45
v_mfma_f32_16x16x32_bf16 v[24:27], a[156:159], v[196:199], v[24:27]
v_exp_f32 v46, v46
v_mfma_f32_16x16x32_bf16 v[32:35], a[156:159], v[212:215], v[148:151]
ds_read_b128 a[156:159], v219 offset:24576
v_cndmask_b32 v238, v238, v246, vcc
v_mfma_f32_16x16x32_bf16 v[32:35], a[152:155], v[208:211], v[32:35]
v_exp_f32 v47, v47
v_mfma_f32_16x16x32_bf16 v[32:35], a[148:151], v[204:207], v[32:35]
ds_read_b128 a[152:155], v218 offset:24576
v_cvt_pk_bf16_f32 v75, v46, v47
v_mfma_f32_16x16x32_bf16 v[32:35], a[144:147], v[200:203], v[32:35]
v_exp_f32 v48, v48
v_mfma_f32_16x16x32_bf16 a[0:3], v[88:91], a[176:179], a[0:3]
ds_read_b128 a[148:151], v217 offset:24576
ds_read_b128 a[144:147], v216 offset:24576
v_mfma_f32_16x16x32_bf16 a[4:7], v[92:95], a[176:179], a[4:7]
v_exp_f32 v49, v49
v_mfma_f32_16x16x32_bf16 a[8:11], v[96:99], a[176:179], a[8:11]
s_mul_i32 s28, s40, 18432
v_cvt_pk_bf16_f32 v76, v48, v49
v_mfma_f32_16x16x32_bf16 a[12:15], v[100:103], a[176:179], a[12:15]
v_exp_f32 v50, v50
v_mfma_f32_16x16x32_bf16 a[28:31], v[100:103], a[180:183], a[28:31]
ds_read_b64_tr_b16 a[176:177], v220 offset:8192
ds_read_b64_tr_b16 a[178:179], v220 offset:12288
v_mfma_f32_16x16x32_bf16 a[24:27], v[96:99], a[180:183], a[24:27]
v_exp_f32 v51, v51
v_mfma_f32_16x16x32_bf16 a[20:23], v[92:95], a[180:183], a[20:23]
s_mul_i32 s29, s37, 4608
v_cvt_pk_bf16_f32 v77, v50, v51
v_mfma_f32_16x16x32_bf16 a[16:19], v[88:91], a[180:183], a[16:19]
v_exp_f32 v52, v52
v_mfma_f32_16x16x32_bf16 a[32:35], v[88:91], a[184:187], a[32:35]
ds_read_b64_tr_b16 a[180:181], v221 offset:8192
ds_read_b64_tr_b16 a[182:183], v221 offset:12288
v_mfma_f32_16x16x32_bf16 a[36:39], v[92:95], a[184:187], a[36:39]
v_exp_f32 v53, v53
v_mfma_f32_16x16x32_bf16 a[40:43], v[96:99], a[184:187], a[40:43]
s_add_u32 s28, s28, s29
v_cvt_pk_bf16_f32 v78, v52, v53
v_mfma_f32_16x16x32_bf16 a[44:47], v[100:103], a[184:187], a[44:47]
v_exp_f32 v54, v54
v_mfma_f32_16x16x32_bf16 a[60:63], v[100:103], a[188:191], a[60:63]
ds_read_b64_tr_b16 a[184:185], v222 offset:8192
ds_read_b64_tr_b16 a[186:187], v222 offset:12288
v_mfma_f32_16x16x32_bf16 a[56:59], v[96:99], a[188:191], a[56:59]
v_exp_f32 v55, v55
v_mfma_f32_16x16x32_bf16 a[52:55], v[92:95], a[188:191], a[52:55]
STUB_8:
s_cbranch_execz STUB_11
s_add_u32 s28, s28, 0x2000000
v_cvt_pk_bf16_f32 v79, v54, v55
v_mfma_f32_16x16x32_bf16 a[48:51], v[88:91], a[188:191], a[48:51]
v_exp_f32 v56, v56
v_mfma_f32_16x16x32_bf16 v[12:15], a[160:163], v[152:155], v[136:139]
v_exp_f32 v57, v57
v_mfma_f32_16x16x32_bf16 v[12:15], a[164:167], v[156:159], v[12:15]
ds_read_b64_tr_b16 a[188:189], v223 offset:8192
v_cvt_pk_bf16_f32 v80, v56, v57
v_mfma_f32_16x16x32_bf16 v[12:15], a[168:171], v[160:163], v[12:15]
v_exp_f32 v58, v58
v_mfma_f32_16x16x32_bf16 v[12:15], a[172:175], v[164:167], v[12:15]
ds_read_b64_tr_b16 a[190:191], v223 offset:12288
v_mfma_f32_16x16x32_bf16 v[20:23], a[172:175], v[180:183], v[140:143]
v_exp_f32 v59, v59
v_mfma_f32_16x16x32_bf16 v[20:23], a[168:171], v[176:179], v[20:23]
v_cvt_pk_bf16_f32 v81, v58, v59
v_mfma_f32_16x16x32_bf16 v[20:23], a[164:167], v[172:175], v[20:23]
v_exp_f32 v60, v60
v_mfma_f32_16x16x32_bf16 v[20:23], a[160:163], v[168:171], v[20:23]
buffer_load_dwordx4 v232, s[12:15], s39 offen offset:0  lds
v_mfma_f32_16x16x32_bf16 v[28:31], a[160:163], v[184:187], v[144:147]
v_exp_f32 v61, v61
v_mfma_f32_16x16x32_bf16 v[28:31], a[164:167], v[188:191], v[28:31]
v_cvt_pk_bf16_f32 v82, v60, v61
v_mfma_f32_16x16x32_bf16 v[28:31], a[168:171], v[192:195], v[28:31]
v_exp_f32 v62, v62
v_mfma_f32_16x16x32_bf16 v[28:31], a[172:175], v[196:199], v[28:31]
buffer_load_dwordx4 v233, s[12:15], s39 offen offset:1024  lds
v_mfma_f32_16x16x32_bf16 v[36:39], a[172:175], v[212:215], v[148:151]
v_exp_f32 v63, v63
v_mfma_f32_16x16x32_bf16 v[36:39], a[168:171], v[208:211], v[36:39]
ds_read_b128 a[172:175], v219 offset:28672
v_cvt_pk_bf16_f32 v83, v62, v63
v_mfma_f32_16x16x32_bf16 v[36:39], a[164:167], v[204:207], v[36:39]
v_exp_f32 v64, v64
v_mfma_f32_16x16x32_bf16 v[36:39], a[160:163], v[200:203], v[36:39]
ds_read_b128 a[168:171], v218 offset:28672
ds_read_b128 a[164:167], v217 offset:28672
s_waitcnt lgkmcnt(8)
v_mfma_f32_16x16x32_bf16 a[64:67], v[88:91], a[192:195], a[64:67]
v_exp_f32 v65, v65
v_mfma_f32_16x16x32_bf16 a[68:71], v[92:95], a[192:195], a[68:71]
ds_read_b128 a[160:163], v216 offset:28672
v_cvt_pk_bf16_f32 v84, v64, v65
v_mfma_f32_16x16x32_bf16 a[72:75], v[96:99], a[192:195], a[72:75]
v_exp_f32 v66, v66
v_mfma_f32_16x16x32_bf16 a[76:79], v[100:103], a[192:195], a[76:79]
ds_read_b64_tr_b16 a[192:193], v224 offset:8192
ds_read_b64_tr_b16 a[194:195], v224 offset:12288
v_mfma_f32_16x16x32_bf16 a[92:95], v[100:103], a[196:199], a[92:95]
v_exp_f32 v67, v67
v_mfma_f32_16x16x32_bf16 a[88:91], v[96:99], a[196:199], a[88:91]
s_cmp_lt_u32 s37, 2
s_cselect_b64 s[90:91], -1, 0
v_cvt_pk_bf16_f32 v85, v66, v67
v_mfma_f32_16x16x32_bf16 a[84:87], v[92:95], a[196:199], a[84:87]
v_exp_f32 v68, v68
v_mfma_f32_16x16x32_bf16 a[80:83], v[88:91], a[196:199], a[80:83]
ds_read_b64_tr_b16 a[196:197], v225 offset:8192
ds_read_b64_tr_b16 a[198:199], v225 offset:12288
v_mfma_f32_16x16x32_bf16 a[96:99], v[88:91], a[200:203], a[96:99]
v_exp_f32 v69, v69
v_mfma_f32_16x16x32_bf16 a[100:103], v[92:95], a[200:203], a[100:103]
v_cvt_pk_bf16_f32 v86, v68, v69
v_mfma_f32_16x16x32_bf16 a[104:107], v[96:99], a[200:203], a[104:107]
v_exp_f32 v70, v70
v_mfma_f32_16x16x32_bf16 a[108:111], v[100:103], a[200:203], a[108:111]
ds_read_b64_tr_b16 a[200:201], v226 offset:8192
ds_read_b64_tr_b16 a[202:203], v226 offset:12288
v_mfma_f32_16x16x32_bf16 a[124:127], v[100:103], a[204:207], a[124:127]
v_exp_f32 v71, v71
v_mfma_f32_16x16x32_bf16 a[120:123], v[96:99], a[204:207], a[120:123]
v_cvt_pk_bf16_f32 v87, v70, v71
v_mfma_f32_16x16x32_bf16 a[116:119], v[92:95], a[204:207], a[116:119]
buffer_load_dwordx4 v232, s[12:15], s39 offen offset:2048  lds
v_mfma_f32_16x16x32_bf16 a[112:115], v[88:91], a[204:207], a[112:115]
ds_read_b64_tr_b16 a[204:205], v227 offset:8192
ds_read_b64_tr_b16 a[206:207], v227 offset:12288
v_smfmac_f32_16x16x64_bf16 a[128:131], a[208:211], v[88:95], v245
buffer_load_dwordx4 v233, s[12:15], s39 offen offset:3072  lds
v_smfmac_f32_16x16x64_bf16 a[132:135], a[208:211], v[96:103], v245
s_add_u32 m0, s86, 32768
s_add_u32 s50, s85, 24576
buffer_load_dwordx4 v244, s[72:75], s50 offen lds
s_add_u32 m0, s86, 36864
s_add_u32 s50, s85, 28672
buffer_load_dwordx4 v244, s[72:75], s50 offen lds
s_add_u32 m0, s86, 40960
s_add_u32 s50, s85, 32768
buffer_load_dwordx4 v244, s[72:75], s50 offen lds
v_mfma_f32_16x16x32_bf16 v[40:43], a[144:147], v[152:155], v[136:139]
v_exp_f32 v8, v8
v_mfma_f32_16x16x32_bf16 v[40:43], a[148:151], v[156:159], v[40:43]
v_exp_f32 v9, v9
v_mfma_f32_16x16x32_bf16 v[40:43], a[152:155], v[160:163], v[40:43]
v_cvt_pk_bf16_f32 v88, v8, v9
v_mfma_f32_16x16x32_bf16 v[40:43], a[156:159], v[164:167], v[40:43]
v_exp_f32 v10, v10
v_mfma_f32_16x16x32_bf16 v[48:51], a[156:159], v[180:183], v[140:143]
v_mfma_f32_16x16x32_bf16 v[48:51], a[152:155], v[176:179], v[48:51]
v_exp_f32 v11, v11
v_mfma_f32_16x16x32_bf16 v[48:51], a[148:151], v[172:175], v[48:51]
v_cvt_pk_bf16_f32 v89, v10, v11
v_mfma_f32_16x16x32_bf16 v[48:51], a[144:147], v[168:171], v[48:51]
v_exp_f32 v12, v12
v_mfma_f32_16x16x32_bf16 v[56:59], a[144:147], v[184:187], v[144:147]
v_mfma_f32_16x16x32_bf16 v[56:59], a[148:151], v[188:191], v[56:59]
v_exp_f32 v13, v13
v_mfma_f32_16x16x32_bf16 v[56:59], a[152:155], v[192:195], v[56:59]
v_cvt_pk_bf16_f32 v90, v12, v13
v_mfma_f32_16x16x32_bf16 v[56:59], a[156:159], v[196:199], v[56:59]
v_exp_f32 v14, v14
v_mfma_f32_16x16x32_bf16 v[64:67], a[156:159], v[212:215], v[148:151]
s_waitcnt vmcnt(15) lgkmcnt(0)
s_barrier
v_mfma_f32_16x16x32_bf16 v[64:67], a[152:155], v[208:211], v[64:67]
ds_read_b128 v[124:127], v239 offset:45056
v_exp_f32 v15, v15
v_mfma_f32_16x16x32_bf16 v[64:67], a[148:151], v[204:207], v[64:67]
ds_read_b128 a[156:159], v219 offset:49152
ds_read_b128 v[128:131], v239 offset:45568
v_cvt_pk_bf16_f32 v91, v14, v15
v_mfma_f32_16x16x32_bf16 v[64:67], a[144:147], v[200:203], v[64:67]
ds_read_b128 v[248:251], v239 offset:46080
v_exp_f32 v16, v16
v_mfma_f32_16x16x32_bf16 a[0:3], v[72:75], a[176:179], a[0:3]
ds_read_b128 a[152:155], v218 offset:49152
ds_read_b128 a[148:151], v217 offset:49152
ds_read_b128 v[252:255], v239 offset:46592
v_mfma_f32_16x16x32_bf16 a[4:7], v[76:79], a[176:179], a[4:7]
ds_read_b64_tr_b16 v[116:117], v241 offset:0
v_exp_f32 v17, v17
v_mfma_f32_16x16x32_bf16 a[8:11], v[80:83], a[176:179], a[8:11]
ds_read_b128 a[144:147], v216 offset:49152
ds_read_b64_tr_b16 v[118:119], v241 offset:256
v_cvt_pk_bf16_f32 v92, v16, v17
v_mfma_f32_16x16x32_bf16 a[12:15], v[84:87], a[176:179], a[12:15]
ds_read_b64_tr_b16 v[120:121], v241 offset:2048
v_exp_f32 v18, v18
v_mfma_f32_16x16x32_bf16 a[28:31], v[84:87], a[180:183], a[28:31]
ds_read_b64_tr_b16 a[176:177], v220 offset:32768
ds_read_b64_tr_b16 a[178:179], v220 offset:36864
ds_read_b64_tr_b16 v[122:123], v241 offset:2304
v_mfma_f32_16x16x32_bf16 a[24:27], v[80:83], a[180:183], a[24:27]
v_exp_f32 v19, v19
v_mfma_f32_16x16x32_bf16 a[20:23], v[76:79], a[180:183], a[20:23]
s_add_u32 s32, s32, 16384
v_cvt_pk_bf16_f32 v93, v18, v19
v_mfma_f32_16x16x32_bf16 a[16:19], v[72:75], a[180:183], a[16:19]
v_exp_f32 v20, v20
v_mfma_f32_16x16x32_bf16 a[32:35], v[72:75], a[184:187], a[32:35]
ds_read_b64_tr_b16 a[180:181], v221 offset:32768
ds_read_b64_tr_b16 a[182:183], v221 offset:36864
v_mfma_f32_16x16x32_bf16 a[36:39], v[76:79], a[184:187], a[36:39]
v_exp_f32 v21, v21
v_mfma_f32_16x16x32_bf16 a[40:43], v[80:83], a[184:187], a[40:43]
s_add_u32 m0, s30, 81920
v_cvt_pk_bf16_f32 v94, v20, v21
s_waitcnt lgkmcnt(8)
v_mfma_f32_16x16x32_bf16 v[132:135], a[212:215], v[124:127], 0
ds_read_b128 v[124:127], v239 offset:47104
v_mfma_f32_16x16x32_bf16 a[44:47], v[84:87], a[184:187], a[44:47]
v_exp_f32 v22, v22
v_mfma_f32_16x16x32_bf16 a[60:63], v[84:87], a[188:191], a[60:63]
ds_read_b64_tr_b16 a[184:185], v222 offset:32768
ds_read_b64_tr_b16 a[186:187], v222 offset:36864
v_mfma_f32_16x16x32_bf16 v[132:135], a[216:219], v[128:131], v[132:135]
ds_read_b128 v[128:131], v239 offset:47616
v_mfma_f32_16x16x32_bf16 a[56:59], v[80:83], a[188:191], a[56:59]
v_exp_f32 v23, v23
v_mfma_f32_16x16x32_bf16 a[52:55], v[76:79], a[188:191], a[52:55]
v_cvt_pk_bf16_f32 v95, v22, v23
v_mfma_f32_16x16x32_bf16 v[132:135], a[220:223], v[248:251], v[132:135]
buffer_load_dwordx4 v228, s[8:11], s32 offen offset:0  lds
ds_read_b128 v[248:251], v239 offset:48128
v_mfma_f32_16x16x32_bf16 a[48:51], v[72:75], a[188:191], a[48:51]
v_exp_f32 v24, v24
v_mfma_f32_16x16x32_bf16 v[44:47], a[160:163], v[152:155], v[136:139]
v_exp_f32 v25, v25
v_mfma_f32_16x16x32_bf16 v[132:135], a[224:227], v[252:255], v[132:135]
ds_read_b64_tr_b16 a[188:189], v223 offset:32768
ds_read_b64_tr_b16 a[190:191], v223 offset:36864
ds_read_b128 v[252:255], v239 offset:48640
v_mfma_f32_16x16x32_bf16 v[44:47], a[164:167], v[156:159], v[44:47]
v_cvt_pk_bf16_f32 v96, v24, v25
v_mfma_f32_16x16x32_bf16 v[44:47], a[168:171], v[160:163], v[44:47]
v_exp_f32 v26, v26
s_waitcnt lgkmcnt(7)
v_mfma_f32_16x16x32_bf16 v[132:135], a[228:231], v[124:127], v[132:135]
ds_read_b128 v[124:127], v239 offset:49152
v_mfma_f32_16x16x32_bf16 v[44:47], a[172:175], v[164:167], v[44:47]
v_mfma_f32_16x16x32_bf16 v[52:55], a[172:175], v[180:183], v[140:143]
v_exp_f32 v27, v27
s_waitcnt lgkmcnt(5)
v_mfma_f32_16x16x32_bf16 v[132:135], a[232:235], v[128:131], v[132:135]
ds_read_b128 v[128:131], v239 offset:49664
v_mfma_f32_16x16x32_bf16 v[52:55], a[168:171], v[176:179], v[52:55]
v_cvt_pk_bf16_f32 v97, v26, v27
v_mfma_f32_16x16x32_bf16 v[52:55], a[164:167], v[172:175], v[52:55]
v_exp_f32 v28, v28
s_waitcnt lgkmcnt(5)
v_mfma_f32_16x16x32_bf16 v[132:135], a[236:239], v[248:251], v[132:135]
buffer_load_dwordx4 v229, s[8:11], s32 offen offset:1024  lds
ds_read_b128 v[248:251], v239 offset:50176
v_mfma_f32_16x16x32_bf16 v[52:55], a[160:163], v[168:171], v[52:55]
v_mfma_f32_16x16x32_bf16 v[60:63], a[160:163], v[184:187], v[144:147]
v_exp_f32 v29, v29
s_waitcnt lgkmcnt(3)
v_mfma_f32_16x16x32_bf16 v[132:135], a[240:243], v[252:255], v[132:135]
ds_read_b128 v[252:255], v239 offset:50688
v_mfma_f32_16x16x32_bf16 v[60:63], a[164:167], v[188:191], v[60:63]
v_cvt_pk_bf16_f32 v98, v28, v29
v_mfma_f32_16x16x32_bf16 v[60:63], a[168:171], v[192:195], v[60:63]
v_exp_f32 v30, v30
s_waitcnt lgkmcnt(3)
v_mfma_f32_16x16x32_bf16 v[132:135], a[244:247], v[124:127], v[132:135]
ds_read_b128 v[124:127], v239 offset:51200
v_mfma_f32_16x16x32_bf16 v[60:63], a[172:175], v[196:199], v[60:63]
v_mfma_f32_16x16x32_bf16 v[68:71], a[172:175], v[212:215], v[148:151]
v_exp_f32 v31, v31
s_waitcnt lgkmcnt(3)
v_mfma_f32_16x16x32_bf16 v[132:135], a[248:251], v[128:131], v[132:135]
ds_read_b128 a[172:175], v219 offset:53248
ds_read_b128 v[128:131], v239 offset:51712
v_mfma_f32_16x16x32_bf16 v[68:71], a[168:171], v[208:211], v[68:71]
ds_read_b128 a[168:171], v218 offset:53248
v_cvt_pk_bf16_f32 v99, v30, v31
v_mfma_f32_16x16x32_bf16 v[68:71], a[164:167], v[204:207], v[68:71]
v_exp_f32 v32, v32
s_waitcnt lgkmcnt(5)
v_mfma_f32_16x16x32_bf16 v[132:135], a[252:255], v[248:251], v[132:135]
ds_read_b128 a[164:167], v217 offset:53248
ds_read_b128 v[248:251], v239 offset:52224
v_mfma_f32_16x16x32_bf16 v[68:71], a[160:163], v[200:203], v[68:71]
ds_read_b128 a[160:163], v216 offset:53248
v_mfma_f32_16x16x32_bf16 a[64:67], v[72:75], a[192:195], a[64:67]
v_exp_f32 v33, v33
s_waitcnt lgkmcnt(7)
v_mfma_f32_16x16x32_bf16 v[132:135], a[136:139], v[252:255], v[132:135]
buffer_load_dwordx4 v230, s[8:11], s32 offen offset:2048  lds
ds_read_b128 v[252:255], v239 offset:52736
v_mfma_f32_16x16x32_bf16 a[68:71], v[76:79], a[192:195], a[68:71]
v_cvt_pk_bf16_f32 v100, v32, v33
v_mfma_f32_16x16x32_bf16 a[72:75], v[80:83], a[192:195], a[72:75]
v_exp_f32 v34, v34
s_waitcnt lgkmcnt(7)
v_mfma_f32_16x16x32_bf16 v[132:135], a[140:143], v[124:127], v[132:135]
ds_read_b128 v[124:127], v239 offset:53248
v_mfma_f32_16x16x32_bf16 a[76:79], v[84:87], a[192:195], a[76:79]
ds_read_b64_tr_b16 a[192:193], v224 offset:32768
ds_read_b64_tr_b16 a[194:195], v224 offset:36864
v_mfma_f32_16x16x32_bf16 a[92:95], v[84:87], a[196:199], a[92:95]
v_exp_f32 v35, v35
s_waitcnt lgkmcnt(8)
v_mfma_f32_16x16x32_bf16 v[132:135], v[104:107], v[128:131], v[132:135]
buffer_load_dwordx4 v231, s[8:11], s32 offen offset:3072  lds
ds_read_b128 v[128:131], v239 offset:53760
v_mfma_f32_16x16x32_bf16 a[88:91], v[80:83], a[196:199], a[88:91]
v_cvt_pk_bf16_f32 v101, v34, v35
v_mfma_f32_16x16x32_bf16 a[84:87], v[76:79], a[196:199], a[84:87]
v_exp_f32 v36, v36
s_waitcnt lgkmcnt(6)
v_mfma_f32_16x16x32_bf16 v[132:135], v[108:111], v[248:251], v[132:135]
v_mfma_f32_16x16x32_bf16 a[80:83], v[72:75], a[196:199], a[80:83]
ds_read_b64_tr_b16 a[196:197], v225 offset:32768
ds_read_b64_tr_b16 a[198:199], v225 offset:36864
v_mfma_f32_16x16x32_bf16 a[96:99], v[72:75], a[200:203], a[96:99]
v_exp_f32 v37, v37
s_waitcnt lgkmcnt(6)
v_mfma_f32_16x16x32_bf16 v[132:135], v[112:115], v[252:255], v[132:135]
v_mfma_f32_16x16x32_bf16 a[100:103], v[76:79], a[200:203], a[100:103]
v_cvt_pk_bf16_f32 v102, v36, v37
v_mfma_f32_16x16x32_bf16 a[104:107], v[80:83], a[200:203], a[104:107]
v_exp_f32 v38, v38
s_waitcnt lgkmcnt(5)
v_mfma_f32_16x16x32_bf16 v[132:135], v[116:119], v[124:127], v[132:135]
v_mfma_f32_16x16x32_bf16 a[108:111], v[84:87], a[200:203], a[108:111]
ds_read_b64_tr_b16 a[200:201], v226 offset:32768
ds_read_b64_tr_b16 a[202:203], v226 offset:36864
v_mfma_f32_16x16x32_bf16 a[124:127], v[84:87], a[204:207], a[124:127]
v_exp_f32 v39, v39
s_waitcnt lgkmcnt(4)
v_mfma_f32_16x16x32_bf16 v[132:135], v[120:123], v[128:131], v[132:135]
v_mfma_f32_16x16x32_bf16 a[120:123], v[80:83], a[204:207], a[120:123]
v_cvt_pk_bf16_f32 v103, v38, v39
v_mfma_f32_16x16x32_bf16 a[116:119], v[76:79], a[204:207], a[116:119]
v_mfma_f32_16x16x32_bf16 a[112:115], v[72:75], a[204:207], a[112:115]
ds_read_b64_tr_b16 a[204:205], v227 offset:32768
ds_read_b64_tr_b16 a[206:207], v227 offset:36864
v_smfmac_f32_16x16x64_bf16 a[128:131], a[208:211], v[72:79], v245
v_smfmac_f32_16x16x64_bf16 a[132:135], a[208:211], v[80:87], v245
v_mfma_f32_16x16x32_bf16 v[8:11], a[144:147], v[152:155], v[136:139]
v_exp_f32 v40, v40
v_mfma_f32_16x16x32_bf16 v[8:11], a[148:151], v[156:159], v[8:11]
v_exp_f32 v41, v41
v_mfma_f32_16x16x32_bf16 v[8:11], a[152:155], v[160:163], v[8:11]
v_cvt_pk_bf16_f32 v72, v40, v41
v_cvt_pk_bf16_f32 v104, v132, v133
v_cvt_pk_bf16_f32 v105, v134, v135
v_mfma_f32_16x16x32_bf16 v[8:11], a[156:159], v[164:167], v[8:11]
v_lshlrev_b32 v132, 16, v104
v_exp_f32 v42, v42
v_mfma_f32_16x16x32_bf16 v[16:19], a[156:159], v[180:183], v[140:143]
s_add_u32 s39, s39, 16384
v_and_b32 v133, 0xffff0000, v104
v_lshlrev_b32 v134, 16, v105
v_mfma_f32_16x16x32_bf16 v[16:19], a[152:155], v[176:179], v[16:19]
v_and_b32 v135, 0xffff0000, v105
v_exp_f32 v43, v43
v_mfma_f32_16x16x32_bf16 v[16:19], a[148:151], v[172:175], v[16:19]
v_cvt_pk_bf16_f32 v73, v42, v43
v_mul_f32 v104, 0xbfb8aa3b, v132
v_mul_f32 v105, 0xbfb8aa3b, v133
v_mfma_f32_16x16x32_bf16 v[16:19], a[144:147], v[168:171], v[16:19]
v_mul_f32 v106, 0xbfb8aa3b, v134
v_exp_f32 v44, v44
v_mfma_f32_16x16x32_bf16 v[24:27], a[144:147], v[184:187], v[144:147]
v_mul_f32 v107, 0xbfb8aa3b, v135
v_exp_f32 v104, v104
v_mfma_f32_16x16x32_bf16 v[24:27], a[148:151], v[188:191], v[24:27]
v_exp_f32 v45, v45
v_mfma_f32_16x16x32_bf16 v[24:27], a[152:155], v[192:195], v[24:27]
v_cvt_pk_bf16_f32 v74, v44, v45
v_exp_f32 v105, v105
v_mfma_f32_16x16x32_bf16 v[24:27], a[156:159], v[196:199], v[24:27]
v_exp_f32 v46, v46
v_mfma_f32_16x16x32_bf16 v[32:35], a[156:159], v[212:215], v[148:151]
ds_read_b128 a[156:159], v219 offset:57344
s_add_u32 m0, s30, 98304
v_mfma_f32_16x16x32_bf16 v[32:35], a[152:155], v[208:211], v[32:35]
v_exp_f32 v47, v47
v_mfma_f32_16x16x32_bf16 v[32:35], a[148:151], v[204:207], v[32:35]
ds_read_b128 a[152:155], v218 offset:57344
v_cvt_pk_bf16_f32 v75, v46, v47
v_mfma_f32_16x16x32_bf16 v[32:35], a[144:147], v[200:203], v[32:35]
v_exp_f32 v48, v48
v_mfma_f32_16x16x32_bf16 a[0:3], v[88:91], a[176:179], a[0:3]
ds_read_b128 a[148:151], v217 offset:57344
ds_read_b128 a[144:147], v216 offset:57344
v_mfma_f32_16x16x32_bf16 a[4:7], v[92:95], a[176:179], a[4:7]
v_exp_f32 v49, v49
v_mfma_f32_16x16x32_bf16 a[8:11], v[96:99], a[176:179], a[8:11]
v_cvt_pk_bf16_f32 v76, v48, v49
v_exp_f32 v106, v106
v_mfma_f32_16x16x32_bf16 a[12:15], v[100:103], a[176:179], a[12:15]
v_exp_f32 v50, v50
v_mfma_f32_16x16x32_bf16 a[28:31], v[100:103], a[180:183], a[28:31]
ds_read_b64_tr_b16 a[176:177], v220 offset:40960
ds_read_b64_tr_b16 a[178:179], v220 offset:45056
v_mfma_f32_16x16x32_bf16 a[24:27], v[96:99], a[180:183], a[24:27]
v_exp_f32 v51, v51
v_mfma_f32_16x16x32_bf16 a[20:23], v[92:95], a[180:183], a[20:23]
v_cvt_pk_bf16_f32 v77, v50, v51
v_exp_f32 v107, v107
v_mfma_f32_16x16x32_bf16 a[16:19], v[88:91], a[180:183], a[16:19]
v_add_f32 v104, 1.0, v104
v_exp_f32 v52, v52
v_mfma_f32_16x16x32_bf16 a[32:35], v[88:91], a[184:187], a[32:35]
ds_read_b64_tr_b16 a[180:181], v221 offset:40960
ds_read_b64_tr_b16 a[182:183], v221 offset:45056
v_add_f32 v105, 1.0, v105
v_mfma_f32_16x16x32_bf16 a[36:39], v[92:95], a[184:187], a[36:39]
v_add_f32 v106, 1.0, v106
v_exp_f32 v53, v53
v_mfma_f32_16x16x32_bf16 a[40:43], v[96:99], a[184:187], a[40:43]
v_cvt_pk_bf16_f32 v78, v52, v53
v_add_f32 v107, 1.0, v107
v_mfma_f32_16x16x32_bf16 a[44:47], v[100:103], a[184:187], a[44:47]
v_exp_f32 v54, v54
v_mfma_f32_16x16x32_bf16 a[60:63], v[100:103], a[188:191], a[60:63]
ds_read_b64_tr_b16 a[184:185], v222 offset:40960
ds_read_b64_tr_b16 a[186:187], v222 offset:45056
v_mfma_f32_16x16x32_bf16 a[56:59], v[96:99], a[188:191], a[56:59]
v_exp_f32 v55, v55
v_mfma_f32_16x16x32_bf16 a[52:55], v[92:95], a[188:191], a[52:55]
v_cvt_pk_bf16_f32 v79, v54, v55
v_rcp_f32 v104, v104
v_mfma_f32_16x16x32_bf16 a[48:51], v[88:91], a[188:191], a[48:51]
v_exp_f32 v56, v56
v_mfma_f32_16x16x32_bf16 v[12:15], a[160:163], v[152:155], v[136:139]
v_exp_f32 v57, v57
v_mfma_f32_16x16x32_bf16 v[12:15], a[164:167], v[156:159], v[12:15]
ds_read_b64_tr_b16 a[188:189], v223 offset:40960
v_cvt_pk_bf16_f32 v80, v56, v57
v_mfma_f32_16x16x32_bf16 v[12:15], a[168:171], v[160:163], v[12:15]
v_exp_f32 v58, v58
v_mfma_f32_16x16x32_bf16 v[12:15], a[172:175], v[164:167], v[12:15]
ds_read_b64_tr_b16 a[190:191], v223 offset:45056
v_rcp_f32 v105, v105
v_mfma_f32_16x16x32_bf16 v[20:23], a[172:175], v[180:183], v[140:143]
v_exp_f32 v59, v59
v_mfma_f32_16x16x32_bf16 v[20:23], a[168:171], v[176:179], v[20:23]
v_cvt_pk_bf16_f32 v81, v58, v59
v_rcp_f32 v106, v106
v_mfma_f32_16x16x32_bf16 v[20:23], a[164:167], v[172:175], v[20:23]
v_exp_f32 v60, v60
v_mfma_f32_16x16x32_bf16 v[20:23], a[160:163], v[168:171], v[20:23]
buffer_load_dwordx4 v232, s[12:15], s39 offen offset:0  lds
v_mfma_f32_16x16x32_bf16 v[28:31], a[160:163], v[184:187], v[144:147]
v_exp_f32 v61, v61
v_mfma_f32_16x16x32_bf16 v[28:31], a[164:167], v[188:191], v[28:31]
v_cvt_pk_bf16_f32 v82, v60, v61
v_rcp_f32 v107, v107
v_mfma_f32_16x16x32_bf16 v[28:31], a[168:171], v[192:195], v[28:31]
v_mul_f32 v104, v132, v104
v_exp_f32 v62, v62
v_mfma_f32_16x16x32_bf16 v[28:31], a[172:175], v[196:199], v[28:31]
buffer_load_dwordx4 v233, s[12:15], s39 offen offset:1024  lds
v_mul_f32 v105, v133, v105
v_mfma_f32_16x16x32_bf16 v[36:39], a[172:175], v[212:215], v[148:151]
v_mul_f32 v106, v134, v106
v_exp_f32 v63, v63
v_mfma_f32_16x16x32_bf16 v[36:39], a[168:171], v[208:211], v[36:39]
ds_read_b128 a[172:175], v219 offset:61440
v_cvt_pk_bf16_f32 v83, v62, v63
v_mul_f32 v107, v135, v107
v_mfma_f32_16x16x32_bf16 v[36:39], a[164:167], v[204:207], v[36:39]
v_cvt_pk_bf16_f32 v108, v104, v105
v_exp_f32 v64, v64
v_mfma_f32_16x16x32_bf16 v[36:39], a[160:163], v[200:203], v[36:39]
ds_read_b128 a[168:171], v218 offset:61440
ds_read_b128 a[164:167], v217 offset:61440
v_cvt_pk_bf16_f32 v109, v106, v107
v_mfma_f32_16x16x32_bf16 a[64:67], v[88:91], a[192:195], a[64:67]
v_lshlrev_b32 v104, 16, v108
v_exp_f32 v65, v65
v_mfma_f32_16x16x32_bf16 a[68:71], v[92:95], a[192:195], a[68:71]
ds_read_b128 a[160:163], v216 offset:61440
v_cvt_pk_bf16_f32 v84, v64, v65
v_and_b32 v105, 0xffff0000, v108
v_mfma_f32_16x16x32_bf16 a[72:75], v[96:99], a[192:195], a[72:75]
v_lshlrev_b32 v106, 16, v109
v_exp_f32 v66, v66
v_mfma_f32_16x16x32_bf16 a[76:79], v[100:103], a[192:195], a[76:79]
ds_read_b64_tr_b16 a[192:193], v224 offset:40960
ds_read_b64_tr_b16 a[194:195], v224 offset:45056
v_and_b32 v107, 0xffff0000, v109
s_waitcnt lgkmcnt(8)
v_mfma_f32_16x16x32_bf16 a[92:95], v[100:103], a[196:199], a[92:95]
v_cndmask_b32 v132, v132, v104, s[90:91]
v_exp_f32 v67, v67
v_mfma_f32_16x16x32_bf16 a[88:91], v[96:99], a[196:199], a[88:91]
v_cvt_pk_bf16_f32 v85, v66, v67
v_cndmask_b32 v133, v133, v105, s[90:91]
v_cndmask_b32 v134, v134, v106, s[90:91]
v_mfma_f32_16x16x32_bf16 a[84:87], v[92:95], a[196:199], a[84:87]
v_cndmask_b32 v135, v135, v107, s[90:91]
v_exp_f32 v68, v68
v_mfma_f32_16x16x32_bf16 a[80:83], v[88:91], a[196:199], a[80:83]
ds_read_b64_tr_b16 a[196:197], v225 offset:40960
ds_read_b64_tr_b16 a[198:199], v225 offset:45056
v_mfma_f32_16x16x32_bf16 a[96:99], v[88:91], a[200:203], a[96:99]
ds_write_b128 v237, v[132:135] offset:54272
v_exp_f32 v69, v69
v_mfma_f32_16x16x32_bf16 a[100:103], v[92:95], a[200:203], a[100:103]
v_cvt_pk_bf16_f32 v86, v68, v69
v_mfma_f32_16x16x32_bf16 a[104:107], v[96:99], a[200:203], a[104:107]
v_exp_f32 v70, v70
v_mfma_f32_16x16x32_bf16 a[108:111], v[100:103], a[200:203], a[108:111]
ds_read_b64_tr_b16 a[200:201], v226 offset:40960
ds_read_b64_tr_b16 a[202:203], v226 offset:45056
v_mfma_f32_16x16x32_bf16 a[124:127], v[100:103], a[204:207], a[124:127]
v_exp_f32 v71, v71
v_mfma_f32_16x16x32_bf16 a[120:123], v[96:99], a[204:207], a[120:123]
v_cvt_pk_bf16_f32 v87, v70, v71
v_mfma_f32_16x16x32_bf16 a[116:119], v[92:95], a[204:207], a[116:119]
buffer_load_dwordx4 v232, s[12:15], s39 offen offset:2048  lds
v_mfma_f32_16x16x32_bf16 a[112:115], v[88:91], a[204:207], a[112:115]
ds_read_b64_tr_b16 a[204:205], v227 offset:40960
ds_read_b64_tr_b16 a[206:207], v227 offset:45056
v_smfmac_f32_16x16x64_bf16 a[128:131], a[208:211], v[88:95], v245
buffer_load_dwordx4 v233, s[12:15], s39 offen offset:3072  lds
v_smfmac_f32_16x16x64_bf16 a[132:135], a[208:211], v[96:103], v245
v_mfma_f32_16x16x32_bf16 v[40:43], a[144:147], v[152:155], v[136:139]
v_exp_f32 v8, v8
v_mfma_f32_16x16x32_bf16 v[40:43], a[148:151], v[156:159], v[40:43]
v_exp_f32 v9, v9
v_mfma_f32_16x16x32_bf16 v[40:43], a[152:155], v[160:163], v[40:43]
v_cvt_pk_bf16_f32 v104, v8, v9
v_mfma_f32_16x16x32_bf16 v[40:43], a[156:159], v[164:167], v[40:43]
v_exp_f32 v10, v10
v_mfma_f32_16x16x32_bf16 v[48:51], a[156:159], v[180:183], v[140:143]
v_mfma_f32_16x16x32_bf16 v[48:51], a[152:155], v[176:179], v[48:51]
v_exp_f32 v11, v11
v_mfma_f32_16x16x32_bf16 v[48:51], a[148:151], v[172:175], v[48:51]
v_cvt_pk_bf16_f32 v105, v10, v11
v_mfma_f32_16x16x32_bf16 v[48:51], a[144:147], v[168:171], v[48:51]
v_exp_f32 v12, v12
v_mfma_f32_16x16x32_bf16 v[56:59], a[144:147], v[184:187], v[144:147]
v_mfma_f32_16x16x32_bf16 v[56:59], a[148:151], v[188:191], v[56:59]
v_exp_f32 v13, v13
v_mfma_f32_16x16x32_bf16 v[56:59], a[152:155], v[192:195], v[56:59]
v_cvt_pk_bf16_f32 v106, v12, v13
v_mfma_f32_16x16x32_bf16 v[56:59], a[156:159], v[196:199], v[56:59]
v_exp_f32 v14, v14
v_mfma_f32_16x16x32_bf16 v[64:67], a[156:159], v[212:215], v[148:151]
s_waitcnt vmcnt(8) lgkmcnt(0)
s_barrier
v_mfma_f32_16x16x32_bf16 v[64:67], a[152:155], v[208:211], v[64:67]
ds_read_b128 v[120:123], v244 offset:54272
v_exp_f32 v15, v15
v_mfma_f32_16x16x32_bf16 v[64:67], a[148:151], v[204:207], v[64:67]
ds_read_b128 a[156:159], v219 offset:0
ds_read_b128 v[124:127], v244 offset:55296
v_cvt_pk_bf16_f32 v107, v14, v15
v_mfma_f32_16x16x32_bf16 v[64:67], a[144:147], v[200:203], v[64:67]
ds_read_b128 v[128:131], v244 offset:56320
v_exp_f32 v16, v16
v_mfma_f32_16x16x32_bf16 a[0:3], v[72:75], a[176:179], a[0:3]
ds_read_b128 a[152:155], v218 offset:0
ds_read_b128 a[148:151], v217 offset:0
ds_read_b128 v[132:135], v244 offset:57344
v_mfma_f32_16x16x32_bf16 a[4:7], v[76:79], a[176:179], a[4:7]
ds_read_b64_tr_b16 a[212:213], v242 offset:0
v_exp_f32 v17, v17
v_mfma_f32_16x16x32_bf16 a[8:11], v[80:83], a[176:179], a[8:11]
ds_read_b128 a[144:147], v216 offset:0
ds_read_b64_tr_b16 a[214:215], v242 offset:18432
v_cvt_pk_bf16_f32 v108, v16, v17
v_mfma_f32_16x16x32_bf16 a[12:15], v[84:87], a[176:179], a[12:15]
ds_read_b64_tr_b16 a[216:217], v242 offset:32
v_exp_f32 v18, v18
v_mfma_f32_16x16x32_bf16 a[28:31], v[84:87], a[180:183], a[28:31]
ds_read_b64_tr_b16 a[176:177], v220 offset:49152
ds_read_b64_tr_b16 a[178:179], v220 offset:53248
ds_read_b64_tr_b16 a[218:219], v242 offset:18464
v_mfma_f32_16x16x32_bf16 a[24:27], v[80:83], a[180:183], a[24:27]
ds_read_b64_tr_b16 a[220:221], v242 offset:64
v_exp_f32 v19, v19
v_mfma_f32_16x16x32_bf16 a[20:23], v[76:79], a[180:183], a[20:23]
s_add_u32 s32, s32, 16384
ds_read_b64_tr_b16 a[222:223], v242 offset:18496
v_cvt_pk_bf16_f32 v109, v18, v19
v_mfma_f32_16x16x32_bf16 a[16:19], v[72:75], a[180:183], a[16:19]
ds_read_b64_tr_b16 a[224:225], v242 offset:96
v_exp_f32 v20, v20
v_mfma_f32_16x16x32_bf16 a[32:35], v[72:75], a[184:187], a[32:35]
ds_read_b64_tr_b16 a[180:181], v221 offset:49152
ds_read_b64_tr_b16 a[182:183], v221 offset:53248
ds_read_b64_tr_b16 a[226:227], v242 offset:18528
v_mfma_f32_16x16x32_bf16 a[36:39], v[76:79], a[184:187], a[36:39]
ds_read_b64_tr_b16 a[228:229], v242 offset:128
v_exp_f32 v21, v21
v_mfma_f32_16x16x32_bf16 a[40:43], v[80:83], a[184:187], a[40:43]
s_add_u32 m0, s30, 114688
ds_read_b64_tr_b16 a[230:231], v242 offset:18560
v_cvt_pk_bf16_f32 v110, v20, v21
v_mfma_f32_16x16x32_bf16 a[44:47], v[84:87], a[184:187], a[44:47]
ds_read_b64_tr_b16 a[232:233], v242 offset:160
v_exp_f32 v22, v22
v_mfma_f32_16x16x32_bf16 a[60:63], v[84:87], a[188:191], a[60:63]
ds_read_b64_tr_b16 a[184:185], v222 offset:49152
ds_read_b64_tr_b16 a[186:187], v222 offset:53248
ds_read_b64_tr_b16 a[234:235], v242 offset:18592
v_mfma_f32_16x16x32_bf16 a[56:59], v[80:83], a[188:191], a[56:59]
ds_read_b64_tr_b16 a[236:237], v242 offset:192
v_exp_f32 v23, v23
v_mfma_f32_16x16x32_bf16 a[52:55], v[76:79], a[188:191], a[52:55]
ds_read_b64_tr_b16 a[238:239], v242 offset:18624
ds_read_b64_tr_b16 a[240:241], v242 offset:224
v_cvt_pk_bf16_f32 v111, v22, v23
v_mfma_f32_16x16x32_bf16 a[48:51], v[72:75], a[188:191], a[48:51]
ds_read_b64_tr_b16 a[242:243], v242 offset:18656
v_exp_f32 v24, v24
v_mfma_f32_16x16x32_bf16 v[44:47], a[160:163], v[152:155], v[136:139]
ds_read_b64_tr_b16 a[244:245], v242 offset:256
v_exp_f32 v25, v25
v_mfma_f32_16x16x32_bf16 v[44:47], a[164:167], v[156:159], v[44:47]
ds_read_b64_tr_b16 a[188:189], v223 offset:49152
ds_read_b64_tr_b16 a[246:247], v242 offset:18688
v_cvt_pk_bf16_f32 v112, v24, v25
v_mfma_f32_16x16x32_bf16 v[44:47], a[168:171], v[160:163], v[44:47]
s_waitcnt lgkmcnt(8)
v_mul_f32 v120, v120, v128
v_exp_f32 v26, v26
v_mfma_f32_16x16x32_bf16 v[44:47], a[172:175], v[164:167], v[44:47]
ds_read_b64_tr_b16 a[190:191], v223 offset:53248
v_mul_f32 v121, v121, v129
v_mul_f32 v122, v122, v130
v_mfma_f32_16x16x32_bf16 v[52:55], a[172:175], v[180:183], v[140:143]
v_mul_f32 v123, v123, v131
v_exp_f32 v27, v27
v_mfma_f32_16x16x32_bf16 v[52:55], a[168:171], v[176:179], v[52:55]
v_cvt_pk_bf16_f32 v113, v26, v27
STUB_9:
s_cbranch_execz STUB_12
v_mul_f32 v124, v124, v132
v_mul_f32 v125, v125, v133
v_mfma_f32_16x16x32_bf16 v[52:55], a[164:167], v[172:175], v[52:55]
v_mul_f32 v126, v126, v134
v_exp_f32 v28, v28
v_mfma_f32_16x16x32_bf16 v[52:55], a[160:163], v[168:171], v[52:55]
buffer_load_dwordx4 v228, s[8:11], s32 offen offset:0  lds
v_mul_f32 v127, v127, v135
v_mfma_f32_16x16x32_bf16 v[60:63], a[160:163], v[184:187], v[144:147]
v_cvt_pk_bf16_f32 v248, v120, v121
v_exp_f32 v29, v29
v_mfma_f32_16x16x32_bf16 v[60:63], a[164:167], v[188:191], v[60:63]
v_cvt_pk_bf16_f32 v114, v28, v29
v_cvt_pk_bf16_f32 v249, v122, v123
v_cvt_pk_bf16_f32 v250, v124, v125
v_mfma_f32_16x16x32_bf16 v[60:63], a[168:171], v[192:195], v[60:63]
v_cvt_pk_bf16_f32 v251, v126, v127
v_exp_f32 v30, v30
v_mfma_f32_16x16x32_bf16 v[60:63], a[172:175], v[196:199], v[60:63]
buffer_load_dwordx4 v229, s[8:11], s32 offen offset:1024  lds
v_mfma_f32_16x16x32_bf16 v[68:71], a[172:175], v[212:215], v[148:151]
v_exp_f32 v31, v31
v_mfma_f32_16x16x32_bf16 a[248:251], a[212:215], v[248:251], 0
ds_read_b128 a[172:175], v219 offset:4096
v_mfma_f32_16x16x32_bf16 v[68:71], a[168:171], v[208:211], v[68:71]
ds_read_b128 a[168:171], v218 offset:4096
v_cvt_pk_bf16_f32 v115, v30, v31
v_mfma_f32_16x16x32_bf16 a[212:215], a[216:219], v[248:251], 0
buffer_load_dwordx4 v230, s[8:11], s32 offen offset:2048  lds
v_mfma_f32_16x16x32_bf16 v[68:71], a[164:167], v[204:207], v[68:71]
v_exp_f32 v32, v32
v_mfma_f32_16x16x32_bf16 a[216:219], a[220:223], v[248:251], 0
ds_read_b128 a[164:167], v217 offset:4096
v_mfma_f32_16x16x32_bf16 v[68:71], a[160:163], v[200:203], v[68:71]
ds_read_b128 a[160:163], v216 offset:4096
v_mfma_f32_16x16x32_bf16 a[220:223], a[224:227], v[248:251], 0
v_mfma_f32_16x16x32_bf16 a[64:67], v[72:75], a[192:195], a[64:67]
v_exp_f32 v33, v33
v_mfma_f32_16x16x32_bf16 a[224:227], a[228:231], v[248:251], 0
v_mfma_f32_16x16x32_bf16 a[68:71], v[76:79], a[192:195], a[68:71]
v_cvt_pk_bf16_f32 v116, v32, v33
s_waitcnt lgkmcnt(8)
v_mfma_f32_16x16x32_bf16 a[228:231], a[232:235], v[248:251], 0
v_mfma_f32_16x16x32_bf16 a[72:75], v[80:83], a[192:195], a[72:75]
v_exp_f32 v34, v34
v_mfma_f32_16x16x32_bf16 a[232:235], a[236:239], v[248:251], 0
v_mfma_f32_16x16x32_bf16 a[76:79], v[84:87], a[192:195], a[76:79]
ds_read_b64_tr_b16 a[192:193], v224 offset:49152
ds_read_b64_tr_b16 a[194:195], v224 offset:53248
v_mfma_f32_16x16x32_bf16 a[236:239], a[240:243], v[248:251], 0
buffer_load_dwordx4 v231, s[8:11], s32 offen offset:3072  lds
v_mfma_f32_16x16x32_bf16 a[92:95], v[84:87], a[196:199], a[92:95]
v_exp_f32 v35, v35
s_waitcnt lgkmcnt(7)
v_mfma_f32_16x16x32_bf16 a[240:243], a[244:247], v[248:251], 0
v_mfma_f32_16x16x32_bf16 a[88:91], v[80:83], a[196:199], a[88:91]
v_cvt_pk_bf16_f32 v117, v34, v35
v_mfma_f32_16x16x32_bf16 a[84:87], v[76:79], a[196:199], a[84:87]
v_exp_f32 v36, v36
v_mfma_f32_16x16x32_bf16 a[80:83], v[72:75], a[196:199], a[80:83]
ds_read_b64_tr_b16 a[196:197], v225 offset:49152
ds_read_b64_tr_b16 a[198:199], v225 offset:53248
v_mfma_f32_16x16x32_bf16 a[96:99], v[72:75], a[200:203], a[96:99]
v_exp_f32 v37, v37
v_mfma_f32_16x16x32_bf16 a[100:103], v[76:79], a[200:203], a[100:103]
v_cvt_pk_bf16_f32 v118, v36, v37
v_mfma_f32_16x16x32_bf16 a[104:107], v[80:83], a[200:203], a[104:107]
v_exp_f32 v38, v38
v_mfma_f32_16x16x32_bf16 a[108:111], v[84:87], a[200:203], a[108:111]
ds_read_b64_tr_b16 a[200:201], v226 offset:49152
ds_read_b64_tr_b16 a[202:203], v226 offset:53248
v_mfma_f32_16x16x32_bf16 a[124:127], v[84:87], a[204:207], a[124:127]
v_exp_f32 v39, v39
v_mfma_f32_16x16x32_bf16 a[120:123], v[80:83], a[204:207], a[120:123]
buffer_store_dwordx4 a[248:251], v238, s[20:23], s28 offen offset:0 sc0 sc1
v_cvt_pk_bf16_f32 v119, v38, v39
v_mfma_f32_16x16x32_bf16 a[116:119], v[76:79], a[204:207], a[116:119]
v_mfma_f32_16x16x32_bf16 a[112:115], v[72:75], a[204:207], a[112:115]
ds_read_b64_tr_b16 a[204:205], v227 offset:49152
ds_read_b64_tr_b16 a[206:207], v227 offset:53248
v_smfmac_f32_16x16x64_bf16 a[128:131], a[208:211], v[72:79], v245
buffer_store_dwordx4 a[212:215], v238, s[20:23], s28 offen offset:512 sc0 sc1
v_smfmac_f32_16x16x64_bf16 a[132:135], a[208:211], v[80:87], v245
v_mfma_f32_16x16x32_bf16 v[8:11], a[144:147], v[152:155], v[136:139]
buffer_store_dwordx4 a[216:219], v238, s[20:23], s28 offen offset:1024 sc0 sc1
v_exp_f32 v40, v40
v_mfma_f32_16x16x32_bf16 v[8:11], a[148:151], v[156:159], v[8:11]
v_exp_f32 v41, v41
v_mfma_f32_16x16x32_bf16 v[8:11], a[152:155], v[160:163], v[8:11]
v_cvt_pk_bf16_f32 v72, v40, v41
v_exp_f32 v42, v42
v_mfma_f32_16x16x32_bf16 v[8:11], a[156:159], v[164:167], v[8:11]
s_add_u32 s39, s39, 16384
buffer_store_dwordx4 a[220:223], v238, s[20:23], s28 offen offset:1536 sc0 sc1
v_mfma_f32_16x16x32_bf16 v[16:19], a[156:159], v[180:183], v[140:143]
v_exp_f32 v43, v43
v_mfma_f32_16x16x32_bf16 v[16:19], a[152:155], v[176:179], v[16:19]
v_cvt_pk_bf16_f32 v73, v42, v43
v_exp_f32 v44, v44
v_mfma_f32_16x16x32_bf16 v[16:19], a[148:151], v[172:175], v[16:19]
buffer_store_dwordx4 a[224:227], v238, s[20:23], s28 offen offset:2048 sc0 sc1
v_mfma_f32_16x16x32_bf16 v[16:19], a[144:147], v[168:171], v[16:19]
v_exp_f32 v45, v45
v_mfma_f32_16x16x32_bf16 v[24:27], a[144:147], v[184:187], v[144:147]
v_cvt_pk_bf16_f32 v74, v44, v45
v_exp_f32 v46, v46
v_mfma_f32_16x16x32_bf16 v[24:27], a[148:151], v[188:191], v[24:27]
s_add_u32 m0, s30, 131072
v_exp_f32 v47, v47
v_mfma_f32_16x16x32_bf16 v[24:27], a[152:155], v[192:195], v[24:27]
buffer_store_dwordx4 a[228:231], v238, s[20:23], s28 offen offset:2560 sc0 sc1
v_cvt_pk_bf16_f32 v75, v46, v47
v_mfma_f32_16x16x32_bf16 v[24:27], a[156:159], v[196:199], v[24:27]
v_exp_f32 v48, v48
v_mfma_f32_16x16x32_bf16 v[32:35], a[156:159], v[212:215], v[148:151]
ds_read_b128 a[156:159], v219 offset:8192
v_exp_f32 v49, v49
v_mfma_f32_16x16x32_bf16 v[32:35], a[152:155], v[208:211], v[32:35]
ds_read_b128 a[152:155], v218 offset:8192
buffer_store_dwordx4 a[232:235], v238, s[20:23], s28 offen offset:3072 sc0 sc1
v_cvt_pk_bf16_f32 v76, v48, v49
v_mfma_f32_16x16x32_bf16 v[32:35], a[148:151], v[204:207], v[32:35]
ds_read_b128 a[148:151], v217 offset:8192
v_exp_f32 v50, v50
v_mfma_f32_16x16x32_bf16 v[32:35], a[144:147], v[200:203], v[32:35]
ds_read_b128 a[144:147], v216 offset:8192
v_exp_f32 v51, v51
v_mfma_f32_16x16x32_bf16 a[8:11], v[112:115], a[176:179], a[8:11]
v_cvt_pk_bf16_f32 v77, v50, v51
v_exp_f32 v52, v52
v_mfma_f32_16x16x32_bf16 a[12:15], v[116:119], a[176:179], a[12:15]
buffer_load_dwordx4 v232, s[12:15], s39 offen offset:0  lds
buffer_store_dwordx4 a[236:239], v238, s[20:23], s28 offen offset:3584 sc0 sc1
v_mfma_f32_16x16x32_bf16 a[28:31], v[116:119], a[180:183], a[28:31]
s_add_u32 s28, s28, 4096
v_exp_f32 v53, v53
v_mfma_f32_16x16x32_bf16 a[24:27], v[112:115], a[180:183], a[24:27]
v_cvt_pk_bf16_f32 v78, v52, v53
v_exp_f32 v54, v54
v_mfma_f32_16x16x32_bf16 a[40:43], v[112:115], a[184:187], a[40:43]
buffer_store_dwordx4 a[240:243], v238, s[20:23], s28 offen offset:0 sc0 sc1
v_mfma_f32_16x16x32_bf16 a[44:47], v[116:119], a[184:187], a[44:47]
v_exp_f32 v55, v55
s_waitcnt lgkmcnt(8)
v_mfma_f32_16x16x32_bf16 a[60:63], v[116:119], a[188:191], a[60:63]
v_cvt_pk_bf16_f32 v79, v54, v55
v_exp_f32 v56, v56
v_mfma_f32_16x16x32_bf16 a[56:59], v[112:115], a[188:191], a[56:59]
ds_read_b64_tr_b16 a[212:213], v220 offset:57344
v_exp_f32 v57, v57
v_mfma_f32_16x16x32_bf16 v[12:15], a[160:163], v[152:155], v[136:139]
ds_read_b64_tr_b16 a[214:215], v220 offset:61440
ds_read_b64_tr_b16 a[216:217], v221 offset:57344
v_cvt_pk_bf16_f32 v80, v56, v57
v_mfma_f32_16x16x32_bf16 v[12:15], a[164:167], v[156:159], v[12:15]
ds_read_b64_tr_b16 a[218:219], v221 offset:61440
v_exp_f32 v58, v58
v_mfma_f32_16x16x32_bf16 v[12:15], a[168:171], v[160:163], v[12:15]
v_exp_f32 v59, v59
v_mfma_f32_16x16x32_bf16 v[12:15], a[172:175], v[164:167], v[12:15]
ds_read_b64_tr_b16 a[220:221], v222 offset:57344
ds_read_b64_tr_b16 a[222:223], v222 offset:61440
v_cvt_pk_bf16_f32 v81, v58, v59
v_mfma_f32_16x16x32_bf16 v[20:23], a[172:175], v[180:183], v[140:143]
v_exp_f32 v60, v60
v_mfma_f32_16x16x32_bf16 v[20:23], a[168:171], v[176:179], v[20:23]
v_exp_f32 v61, v61
v_mfma_f32_16x16x32_bf16 v[20:23], a[164:167], v[172:175], v[20:23]
v_cvt_pk_bf16_f32 v82, v60, v61
v_exp_f32 v62, v62
v_mfma_f32_16x16x32_bf16 v[20:23], a[160:163], v[168:171], v[20:23]
ds_read_b64_tr_b16 a[224:225], v223 offset:57344
ds_read_b64_tr_b16 a[226:227], v223 offset:61440
v_mfma_f32_16x16x32_bf16 v[28:31], a[160:163], v[184:187], v[144:147]
ds_read_b64_tr_b16 a[228:229], v224 offset:57344
v_exp_f32 v63, v63
v_mfma_f32_16x16x32_bf16 v[28:31], a[164:167], v[188:191], v[28:31]
v_cvt_pk_bf16_f32 v83, v62, v63
v_exp_f32 v64, v64
v_mfma_f32_16x16x32_bf16 v[28:31], a[168:171], v[192:195], v[28:31]
ds_read_b64_tr_b16 a[230:231], v224 offset:61440
buffer_load_dwordx4 v233, s[12:15], s39 offen offset:1024  lds
v_mfma_f32_16x16x32_bf16 v[28:31], a[172:175], v[196:199], v[28:31]
ds_read_b64_tr_b16 a[232:233], v225 offset:57344
v_exp_f32 v65, v65
v_mfma_f32_16x16x32_bf16 v[36:39], a[172:175], v[212:215], v[148:151]
v_cvt_pk_bf16_f32 v84, v64, v65
v_exp_f32 v66, v66
v_mfma_f32_16x16x32_bf16 v[36:39], a[168:171], v[208:211], v[36:39]
ds_read_b64_tr_b16 a[234:235], v225 offset:61440
v_exp_f32 v67, v67
v_mfma_f32_16x16x32_bf16 v[36:39], a[164:167], v[204:207], v[36:39]
ds_read_b128 a[172:175], v219 offset:12288
ds_read_b128 a[168:171], v218 offset:12288
v_cvt_pk_bf16_f32 v85, v66, v67
v_mfma_f32_16x16x32_bf16 v[36:39], a[160:163], v[200:203], v[36:39]
ds_read_b128 a[164:167], v217 offset:12288
v_exp_f32 v68, v68
v_mfma_f32_16x16x32_bf16 a[72:75], v[112:115], a[192:195], a[72:75]
ds_read_b64_tr_b16 a[236:237], v226 offset:57344
v_exp_f32 v69, v69
v_mfma_f32_16x16x32_bf16 a[76:79], v[116:119], a[192:195], a[76:79]
ds_read_b64_tr_b16 a[238:239], v226 offset:61440
ds_read_b128 a[160:163], v216 offset:12288
v_cvt_pk_bf16_f32 v86, v68, v69
v_mfma_f32_16x16x32_bf16 a[92:95], v[116:119], a[196:199], a[92:95]
ds_read_b64_tr_b16 a[240:241], v227 offset:57344
v_exp_f32 v70, v70
v_mfma_f32_16x16x32_bf16 a[88:91], v[112:115], a[196:199], a[88:91]
ds_read_b64_tr_b16 a[242:243], v227 offset:61440
v_exp_f32 v71, v71
s_waitcnt lgkmcnt(8)
v_mfma_f32_16x16x32_bf16 a[104:107], v[112:115], a[200:203], a[104:107]
buffer_load_dwordx4 v232, s[12:15], s39 offen offset:2048  lds
v_cvt_pk_bf16_f32 v87, v70, v71
v_mfma_f32_16x16x32_bf16 a[108:111], v[116:119], a[200:203], a[108:111]
buffer_load_dwordx4 v233, s[12:15], s39 offen offset:3072  lds
v_mfma_f32_16x16x32_bf16 a[124:127], v[116:119], a[204:207], a[124:127]
v_mfma_f32_16x16x32_bf16 a[120:123], v[112:115], a[204:207], a[120:123]
v_smfmac_f32_16x16x64_bf16 a[132:135], a[208:211], v[112:119], v245
s_mov_b32 s33, 6
K_LOOPIN:
s_waitcnt lgkmcnt(0)
v_lshlrev_b32 v241, 4, v1
s_mov_b32 s46, s44
.p2align 6
K_LOOP:
s_cmp_eq_u32 s33, s3
s_cbranch_scc1 K_EVT
K_EVT_RET:
v_mfma_f32_16x16x32_bf16 v[40:43], a[144:147], v[152:155], v[136:139]
v_exp_f32 v8, v8
v_mfma_f32_16x16x32_bf16 v[40:43], a[148:151], v[156:159], v[40:43]
v_exp_f32 v9, v9
v_mfma_f32_16x16x32_bf16 v[40:43], a[152:155], v[160:163], v[40:43]
v_cvt_pk_bf16_f32 v88, v8, v9
v_mfma_f32_16x16x32_bf16 v[40:43], a[156:159], v[164:167], v[40:43]
v_exp_f32 v10, v10
v_mfma_f32_16x16x32_bf16 v[48:51], a[156:159], v[180:183], v[140:143]
v_mfma_f32_16x16x32_bf16 v[48:51], a[152:155], v[176:179], v[48:51]
v_exp_f32 v11, v11
v_mfma_f32_16x16x32_bf16 v[48:51], a[148:151], v[172:175], v[48:51]
v_cvt_pk_bf16_f32 v89, v10, v11
v_mfma_f32_16x16x32_bf16 v[48:51], a[144:147], v[168:171], v[48:51]
v_exp_f32 v12, v12
v_mfma_f32_16x16x32_bf16 v[56:59], a[144:147], v[184:187], v[144:147]
v_mfma_f32_16x16x32_bf16 v[56:59], a[148:151], v[188:191], v[56:59]
v_exp_f32 v13, v13
v_mfma_f32_16x16x32_bf16 v[56:59], a[152:155], v[192:195], v[56:59]
v_cvt_pk_bf16_f32 v90, v12, v13
v_mfma_f32_16x16x32_bf16 v[56:59], a[156:159], v[196:199], v[56:59]
v_exp_f32 v14, v14
v_mfma_f32_16x16x32_bf16 v[64:67], a[156:159], v[212:215], v[148:151]
s_waitcnt vmcnt(10) lgkmcnt(0)
s_barrier
v_mfma_f32_16x16x32_bf16 v[64:67], a[152:155], v[208:211], v[64:67]
v_exp_f32 v15, v15
v_mfma_f32_16x16x32_bf16 v[64:67], a[148:151], v[204:207], v[64:67]
ds_read_b128 a[156:159], v219 offset:16384
v_cvt_pk_bf16_f32 v91, v14, v15
v_mfma_f32_16x16x32_bf16 v[64:67], a[144:147], v[200:203], v[64:67]
v_exp_f32 v16, v16
v_mfma_f32_16x16x32_bf16 a[0:3], v[72:75], a[212:215], a[0:3]
ds_read_b128 a[152:155], v218 offset:16384
ds_read_b128 a[148:151], v217 offset:16384
v_mfma_f32_16x16x32_bf16 a[0:3], v[104:107], a[176:179], a[0:3]
v_exp_f32 v17, v17
v_mfma_f32_16x16x32_bf16 a[4:7], v[108:111], a[176:179], a[4:7]
ds_read_b128 a[144:147], v216 offset:16384
v_cvt_pk_bf16_f32 v92, v16, v17
v_mfma_f32_16x16x32_bf16 a[4:7], v[76:79], a[212:215], a[4:7]
v_exp_f32 v18, v18
v_mfma_f32_16x16x32_bf16 a[20:23], v[76:79], a[216:219], a[20:23]
ds_read_b64_tr_b16 a[176:177], v220 offset:0
ds_read_b64_tr_b16 a[178:179], v220 offset:4096
v_mfma_f32_16x16x32_bf16 a[20:23], v[108:111], a[180:183], a[20:23]
v_exp_f32 v19, v19
v_mfma_f32_16x16x32_bf16 a[16:19], v[104:107], a[180:183], a[16:19]
ds_read_b64_tr_b16 a[180:181], v221 offset:0
v_cvt_pk_bf16_f32 v93, v18, v19
v_mfma_f32_16x16x32_bf16 a[16:19], v[72:75], a[216:219], a[16:19]
v_exp_f32 v20, v20
v_mfma_f32_16x16x32_bf16 a[32:35], v[72:75], a[220:223], a[32:35]
ds_read_b64_tr_b16 a[182:183], v221 offset:4096
s_add_u32 s32, s32, 16384
v_mfma_f32_16x16x32_bf16 a[32:35], v[104:107], a[184:187], a[32:35]
v_exp_f32 v21, v21
v_mfma_f32_16x16x32_bf16 a[36:39], v[108:111], a[184:187], a[36:39]
ds_read_b64_tr_b16 a[184:185], v222 offset:0
v_cvt_pk_bf16_f32 v94, v20, v21
v_mfma_f32_16x16x32_bf16 a[36:39], v[76:79], a[220:223], a[36:39]
v_exp_f32 v22, v22
v_mfma_f32_16x16x32_bf16 a[52:55], v[76:79], a[224:227], a[52:55]
ds_read_b64_tr_b16 a[186:187], v222 offset:4096
s_add_u32 m0, s30, 65536
v_mfma_f32_16x16x32_bf16 a[52:55], v[108:111], a[188:191], a[52:55]
v_exp_f32 v23, v23
v_mfma_f32_16x16x32_bf16 a[48:51], v[104:107], a[188:191], a[48:51]
ds_read_b64_tr_b16 a[188:189], v223 offset:0
v_cvt_pk_bf16_f32 v95, v22, v23
v_mfma_f32_16x16x32_bf16 a[48:51], v[72:75], a[224:227], a[48:51]
v_exp_f32 v24, v24
v_mfma_f32_16x16x32_bf16 v[44:47], a[160:163], v[152:155], v[136:139]
v_exp_f32 v25, v25
v_mfma_f32_16x16x32_bf16 v[44:47], a[164:167], v[156:159], v[44:47]
ds_read_b64_tr_b16 a[190:191], v223 offset:4096
v_cvt_pk_bf16_f32 v96, v24, v25
v_mfma_f32_16x16x32_bf16 v[44:47], a[168:171], v[160:163], v[44:47]
v_exp_f32 v26, v26
v_mfma_f32_16x16x32_bf16 v[44:47], a[172:175], v[164:167], v[44:47]
buffer_load_dwordx4 v228, s[8:11], s32 offen offset:0  lds
v_mfma_f32_16x16x32_bf16 v[52:55], a[172:175], v[180:183], v[140:143]
v_exp_f32 v27, v27
v_mfma_f32_16x16x32_bf16 v[52:55], a[168:171], v[176:179], v[52:55]
v_cvt_pk_bf16_f32 v97, v26, v27
v_mfma_f32_16x16x32_bf16 v[52:55], a[164:167], v[172:175], v[52:55]
v_exp_f32 v28, v28
v_mfma_f32_16x16x32_bf16 v[52:55], a[160:163], v[168:171], v[52:55]
buffer_load_dwordx4 v229, s[8:11], s32 offen offset:1024  lds
v_mfma_f32_16x16x32_bf16 v[60:63], a[160:163], v[184:187], v[144:147]
v_exp_f32 v29, v29
v_mfma_f32_16x16x32_bf16 v[60:63], a[164:167], v[188:191], v[60:63]
v_cvt_pk_bf16_f32 v98, v28, v29
v_mfma_f32_16x16x32_bf16 v[60:63], a[168:171], v[192:195], v[60:63]
v_exp_f32 v30, v30
v_mfma_f32_16x16x32_bf16 v[60:63], a[172:175], v[196:199], v[60:63]
buffer_load_dwordx4 v230, s[8:11], s32 offen offset:2048  lds
v_mfma_f32_16x16x32_bf16 v[68:71], a[172:175], v[212:215], v[148:151]
v_exp_f32 v31, v31
v_mfma_f32_16x16x32_bf16 v[68:71], a[168:171], v[208:211], v[68:71]
ds_read_b128 a[172:175], v219 offset:20480
v_cvt_pk_bf16_f32 v99, v30, v31
v_mfma_f32_16x16x32_bf16 v[68:71], a[164:167], v[204:207], v[68:71]
v_exp_f32 v32, v32
v_mfma_f32_16x16x32_bf16 v[68:71], a[160:163], v[200:203], v[68:71]
ds_read_b128 a[168:171], v218 offset:20480
ds_read_b128 a[164:167], v217 offset:20480
v_mfma_f32_16x16x32_bf16 a[64:67], v[72:75], a[228:231], a[64:67]
v_exp_f32 v33, v33
v_mfma_f32_16x16x32_bf16 a[64:67], v[104:107], a[192:195], a[64:67]
ds_read_b128 a[160:163], v216 offset:20480
v_cvt_pk_bf16_f32 v100, v32, v33
v_mfma_f32_16x16x32_bf16 a[68:71], v[108:111], a[192:195], a[68:71]
v_exp_f32 v34, v34
v_mfma_f32_16x16x32_bf16 a[68:71], v[76:79], a[228:231], a[68:71]
ds_read_b64_tr_b16 a[192:193], v224 offset:0
ds_read_b64_tr_b16 a[194:195], v224 offset:4096
v_mfma_f32_16x16x32_bf16 a[84:87], v[76:79], a[232:235], a[84:87]
v_exp_f32 v35, v35
v_mfma_f32_16x16x32_bf16 a[84:87], v[108:111], a[196:199], a[84:87]
v_cvt_pk_bf16_f32 v101, v34, v35
v_mfma_f32_16x16x32_bf16 a[80:83], v[104:107], a[196:199], a[80:83]
v_exp_f32 v36, v36
v_mfma_f32_16x16x32_bf16 a[80:83], v[72:75], a[232:235], a[80:83]
ds_read_b64_tr_b16 a[196:197], v225 offset:0
ds_read_b64_tr_b16 a[198:199], v225 offset:4096
v_mfma_f32_16x16x32_bf16 a[96:99], v[72:75], a[236:239], a[96:99]
v_exp_f32 v37, v37
v_mfma_f32_16x16x32_bf16 a[96:99], v[104:107], a[200:203], a[96:99]
v_cvt_pk_bf16_f32 v102, v36, v37
v_mfma_f32_16x16x32_bf16 a[100:103], v[108:111], a[200:203], a[100:103]
v_exp_f32 v38, v38
v_mfma_f32_16x16x32_bf16 a[100:103], v[76:79], a[236:239], a[100:103]
ds_read_b64_tr_b16 a[200:201], v226 offset:0
ds_read_b64_tr_b16 a[202:203], v226 offset:4096
v_mfma_f32_16x16x32_bf16 a[116:119], v[76:79], a[240:243], a[116:119]
v_exp_f32 v39, v39
v_mfma_f32_16x16x32_bf16 a[116:119], v[108:111], a[204:207], a[116:119]
v_cvt_pk_bf16_f32 v103, v38, v39
v_mfma_f32_16x16x32_bf16 a[112:115], v[104:107], a[204:207], a[112:115]
ds_read_b64_tr_b16 a[204:205], v227 offset:0
ds_read_b64_tr_b16 a[206:207], v227 offset:4096
v_mfma_f32_16x16x32_bf16 a[112:115], v[72:75], a[240:243], a[112:115]
buffer_load_dwordx4 v231, s[8:11], s32 offen offset:3072  lds
v_smfmac_f32_16x16x64_bf16 a[128:131], a[208:211], v[72:79], v245
s_mov_b32 m0, s87
s_lshl2_add_u32 s50, s87, s89
buffer_load_dwordx4 v243, s[56:59], s50 offen  lds
v_smfmac_f32_16x16x64_bf16 a[128:131], a[208:211], v[104:111], v245
s_add_u32 s87, s87, 3456
s_min_u32 s87, s87, 63936
s_waitcnt lgkmcnt(8)
v_mfma_f32_16x16x32_bf16 v[8:11], a[144:147], v[152:155], v[136:139]
v_exp_f32 v40, v40
v_mfma_f32_16x16x32_bf16 v[8:11], a[148:151], v[156:159], v[8:11]
v_exp_f32 v41, v41
v_mfma_f32_16x16x32_bf16 v[8:11], a[152:155], v[160:163], v[8:11]
v_cvt_pk_bf16_f32 v104, v40, v41
v_mfma_f32_16x16x32_bf16 v[8:11], a[156:159], v[164:167], v[8:11]
v_exp_f32 v42, v42
v_mfma_f32_16x16x32_bf16 v[16:19], a[156:159], v[180:183], v[140:143]
s_add_u32 s39, s39, 16384
v_mfma_f32_16x16x32_bf16 v[16:19], a[152:155], v[176:179], v[16:19]
v_exp_f32 v43, v43
v_mfma_f32_16x16x32_bf16 v[16:19], a[148:151], v[172:175], v[16:19]
v_cvt_pk_bf16_f32 v105, v42, v43
v_mfma_f32_16x16x32_bf16 v[16:19], a[144:147], v[168:171], v[16:19]
v_exp_f32 v44, v44
v_mfma_f32_16x16x32_bf16 v[24:27], a[144:147], v[184:187], v[144:147]
v_mfma_f32_16x16x32_bf16 v[24:27], a[148:151], v[188:191], v[24:27]
v_exp_f32 v45, v45
v_mfma_f32_16x16x32_bf16 v[24:27], a[152:155], v[192:195], v[24:27]
s_add_u32 m0, s30, 147456
v_cvt_pk_bf16_f32 v106, v44, v45
v_mfma_f32_16x16x32_bf16 v[24:27], a[156:159], v[196:199], v[24:27]
v_exp_f32 v46, v46
v_mfma_f32_16x16x32_bf16 v[32:35], a[156:159], v[212:215], v[148:151]
ds_read_b128 a[156:159], v219 offset:24576
v_mfma_f32_16x16x32_bf16 v[32:35], a[152:155], v[208:211], v[32:35]
v_exp_f32 v47, v47
v_mfma_f32_16x16x32_bf16 v[32:35], a[148:151], v[204:207], v[32:35]
ds_read_b128 a[152:155], v218 offset:24576
v_cvt_pk_bf16_f32 v107, v46, v47
v_mfma_f32_16x16x32_bf16 v[32:35], a[144:147], v[200:203], v[32:35]
v_exp_f32 v48, v48
v_mfma_f32_16x16x32_bf16 a[8:11], v[96:99], a[176:179], a[8:11]
ds_read_b128 a[148:151], v217 offset:24576
ds_read_b128 a[144:147], v216 offset:24576
v_mfma_f32_16x16x32_bf16 a[8:11], v[80:83], a[212:215], a[8:11]
v_exp_f32 v49, v49
v_mfma_f32_16x16x32_bf16 a[12:15], v[84:87], a[212:215], a[12:15]
ds_read_b64_tr_b16 a[212:213], v220 offset:8192
v_cvt_pk_bf16_f32 v108, v48, v49
v_mfma_f32_16x16x32_bf16 a[12:15], v[100:103], a[176:179], a[12:15]
v_exp_f32 v50, v50
v_mfma_f32_16x16x32_bf16 a[28:31], v[100:103], a[180:183], a[28:31]
ds_read_b64_tr_b16 a[214:215], v220 offset:12288
v_mfma_f32_16x16x32_bf16 a[28:31], v[84:87], a[216:219], a[28:31]
v_exp_f32 v51, v51
v_mfma_f32_16x16x32_bf16 a[24:27], v[80:83], a[216:219], a[24:27]
ds_read_b64_tr_b16 a[216:217], v221 offset:8192
v_cvt_pk_bf16_f32 v109, v50, v51
v_mfma_f32_16x16x32_bf16 a[24:27], v[96:99], a[180:183], a[24:27]
v_exp_f32 v52, v52
v_mfma_f32_16x16x32_bf16 a[40:43], v[96:99], a[184:187], a[40:43]
ds_read_b64_tr_b16 a[218:219], v221 offset:12288
v_mfma_f32_16x16x32_bf16 a[40:43], v[80:83], a[220:223], a[40:43]
v_exp_f32 v53, v53
v_mfma_f32_16x16x32_bf16 a[44:47], v[84:87], a[220:223], a[44:47]
ds_read_b64_tr_b16 a[220:221], v222 offset:8192
v_cvt_pk_bf16_f32 v110, v52, v53
v_mfma_f32_16x16x32_bf16 a[44:47], v[100:103], a[184:187], a[44:47]
v_exp_f32 v54, v54
v_mfma_f32_16x16x32_bf16 a[60:63], v[100:103], a[188:191], a[60:63]
ds_read_b64_tr_b16 a[222:223], v222 offset:12288
v_mfma_f32_16x16x32_bf16 a[60:63], v[84:87], a[224:227], a[60:63]
v_exp_f32 v55, v55
v_mfma_f32_16x16x32_bf16 a[56:59], v[80:83], a[224:227], a[56:59]
ds_read_b64_tr_b16 a[224:225], v223 offset:8192
v_cvt_pk_bf16_f32 v111, v54, v55
v_mfma_f32_16x16x32_bf16 a[56:59], v[96:99], a[188:191], a[56:59]
v_exp_f32 v56, v56
v_mfma_f32_16x16x32_bf16 v[12:15], a[160:163], v[152:155], v[136:139]
v_exp_f32 v57, v57
v_mfma_f32_16x16x32_bf16 v[12:15], a[164:167], v[156:159], v[12:15]
ds_read_b64_tr_b16 a[226:227], v223 offset:12288
v_cvt_pk_bf16_f32 v112, v56, v57
v_mfma_f32_16x16x32_bf16 v[12:15], a[168:171], v[160:163], v[12:15]
v_exp_f32 v58, v58
v_mfma_f32_16x16x32_bf16 v[12:15], a[172:175], v[164:167], v[12:15]
buffer_load_dwordx4 v232, s[12:15], s39 offen offset:0  lds
v_mfma_f32_16x16x32_bf16 v[20:23], a[172:175], v[180:183], v[140:143]
v_exp_f32 v59, v59
v_mfma_f32_16x16x32_bf16 v[20:23], a[168:171], v[176:179], v[20:23]
v_cvt_pk_bf16_f32 v113, v58, v59
v_mfma_f32_16x16x32_bf16 v[20:23], a[164:167], v[172:175], v[20:23]
v_exp_f32 v60, v60
v_mfma_f32_16x16x32_bf16 v[20:23], a[160:163], v[168:171], v[20:23]
buffer_load_dwordx4 v233, s[12:15], s39 offen offset:1024  lds
v_mfma_f32_16x16x32_bf16 v[28:31], a[160:163], v[184:187], v[144:147]
v_exp_f32 v61, v61
v_mfma_f32_16x16x32_bf16 v[28:31], a[164:167], v[188:191], v[28:31]
v_cvt_pk_bf16_f32 v114, v60, v61
v_mfma_f32_16x16x32_bf16 v[28:31], a[168:171], v[192:195], v[28:31]
v_exp_f32 v62, v62
v_mfma_f32_16x16x32_bf16 v[28:31], a[172:175], v[196:199], v[28:31]
buffer_load_dwordx4 v232, s[12:15], s39 offen offset:2048  lds
v_mfma_f32_16x16x32_bf16 v[36:39], a[172:175], v[212:215], v[148:151]
v_exp_f32 v63, v63
v_mfma_f32_16x16x32_bf16 v[36:39], a[168:171], v[208:211], v[36:39]
ds_read_b128 a[172:175], v219 offset:28672
v_cvt_pk_bf16_f32 v115, v62, v63
v_mfma_f32_16x16x32_bf16 v[36:39], a[164:167], v[204:207], v[36:39]
v_exp_f32 v64, v64
v_mfma_f32_16x16x32_bf16 v[36:39], a[160:163], v[200:203], v[36:39]
ds_read_b128 a[168:171], v218 offset:28672
ds_read_b128 a[164:167], v217 offset:28672
s_waitcnt lgkmcnt(8)
v_mfma_f32_16x16x32_bf16 a[72:75], v[96:99], a[192:195], a[72:75]
v_exp_f32 v65, v65
v_mfma_f32_16x16x32_bf16 a[72:75], v[80:83], a[228:231], a[72:75]
ds_read_b128 a[160:163], v216 offset:28672
v_cvt_pk_bf16_f32 v116, v64, v65
v_mfma_f32_16x16x32_bf16 a[76:79], v[84:87], a[228:231], a[76:79]
v_exp_f32 v66, v66
v_mfma_f32_16x16x32_bf16 a[76:79], v[100:103], a[192:195], a[76:79]
ds_read_b64_tr_b16 a[228:229], v224 offset:8192
ds_read_b64_tr_b16 a[230:231], v224 offset:12288
v_mfma_f32_16x16x32_bf16 a[92:95], v[100:103], a[196:199], a[92:95]
v_exp_f32 v67, v67
v_mfma_f32_16x16x32_bf16 a[92:95], v[84:87], a[232:235], a[92:95]
v_cvt_pk_bf16_f32 v117, v66, v67
v_mfma_f32_16x16x32_bf16 a[88:91], v[80:83], a[232:235], a[88:91]
v_exp_f32 v68, v68
v_mfma_f32_16x16x32_bf16 a[88:91], v[96:99], a[196:199], a[88:91]
ds_read_b64_tr_b16 a[232:233], v225 offset:8192
ds_read_b64_tr_b16 a[234:235], v225 offset:12288
v_mfma_f32_16x16x32_bf16 a[104:107], v[96:99], a[200:203], a[104:107]
v_exp_f32 v69, v69
v_mfma_f32_16x16x32_bf16 a[104:107], v[80:83], a[236:239], a[104:107]
v_cvt_pk_bf16_f32 v118, v68, v69
v_mfma_f32_16x16x32_bf16 a[108:111], v[84:87], a[236:239], a[108:111]
v_exp_f32 v70, v70
v_mfma_f32_16x16x32_bf16 a[108:111], v[100:103], a[200:203], a[108:111]
ds_read_b64_tr_b16 a[236:237], v226 offset:8192
ds_read_b64_tr_b16 a[238:239], v226 offset:12288
v_mfma_f32_16x16x32_bf16 a[124:127], v[100:103], a[204:207], a[124:127]
v_exp_f32 v71, v71
v_mfma_f32_16x16x32_bf16 a[124:127], v[84:87], a[240:243], a[124:127]
v_cvt_pk_bf16_f32 v119, v70, v71
v_mfma_f32_16x16x32_bf16 a[120:123], v[80:83], a[240:243], a[120:123]
ds_read_b64_tr_b16 a[240:241], v227 offset:8192
ds_read_b64_tr_b16 a[242:243], v227 offset:12288
v_mfma_f32_16x16x32_bf16 a[120:123], v[96:99], a[204:207], a[120:123]
buffer_load_dwordx4 v233, s[12:15], s39 offen offset:3072  lds
v_smfmac_f32_16x16x64_bf16 a[132:135], a[208:211], v[96:103], v245
buffer_load_dword v242, v241, s[20:23], s46 offen sc1
v_smfmac_f32_16x16x64_bf16 a[132:135], a[208:211], v[80:87], v245
v_add_u32 v241, 1024, v241
v_and_b32 v241, 0x3fff, v241
v_mfma_f32_16x16x32_bf16 v[40:43], a[144:147], v[152:155], v[136:139]
v_exp_f32 v8, v8
v_mfma_f32_16x16x32_bf16 v[40:43], a[148:151], v[156:159], v[40:43]
v_exp_f32 v9, v9
v_mfma_f32_16x16x32_bf16 v[40:43], a[152:155], v[160:163], v[40:43]
v_cvt_pk_bf16_f32 v72, v8, v9
v_mfma_f32_16x16x32_bf16 v[40:43], a[156:159], v[164:167], v[40:43]
v_exp_f32 v10, v10
v_mfma_f32_16x16x32_bf16 v[48:51], a[156:159], v[180:183], v[140:143]
v_mfma_f32_16x16x32_bf16 v[48:51], a[152:155], v[176:179], v[48:51]
v_exp_f32 v11, v11
v_mfma_f32_16x16x32_bf16 v[48:51], a[148:151], v[172:175], v[48:51]
v_cvt_pk_bf16_f32 v73, v10, v11
v_mfma_f32_16x16x32_bf16 v[48:51], a[144:147], v[168:171], v[48:51]
v_exp_f32 v12, v12
v_mfma_f32_16x16x32_bf16 v[56:59], a[144:147], v[184:187], v[144:147]
v_mfma_f32_16x16x32_bf16 v[56:59], a[148:151], v[188:191], v[56:59]
v_exp_f32 v13, v13
v_mfma_f32_16x16x32_bf16 v[56:59], a[152:155], v[192:195], v[56:59]
v_cvt_pk_bf16_f32 v74, v12, v13
v_mfma_f32_16x16x32_bf16 v[56:59], a[156:159], v[196:199], v[56:59]
v_exp_f32 v14, v14
v_mfma_f32_16x16x32_bf16 v[64:67], a[156:159], v[212:215], v[148:151]
s_waitcnt vmcnt(10) lgkmcnt(0)
s_barrier
v_mfma_f32_16x16x32_bf16 v[64:67], a[152:155], v[208:211], v[64:67]
v_exp_f32 v15, v15
v_mfma_f32_16x16x32_bf16 v[64:67], a[148:151], v[204:207], v[64:67]
ds_read_b128 a[156:159], v219 offset:49152
v_cvt_pk_bf16_f32 v75, v14, v15
v_mfma_f32_16x16x32_bf16 v[64:67], a[144:147], v[200:203], v[64:67]
v_exp_f32 v16, v16
v_mfma_f32_16x16x32_bf16 a[0:3], v[104:107], a[212:215], a[0:3]
ds_read_b128 a[152:155], v218 offset:49152
ds_read_b128 a[148:151], v217 offset:49152
v_mfma_f32_16x16x32_bf16 a[0:3], v[88:91], a[176:179], a[0:3]
v_exp_f32 v17, v17
v_mfma_f32_16x16x32_bf16 a[4:7], v[92:95], a[176:179], a[4:7]
ds_read_b128 a[144:147], v216 offset:49152
v_cvt_pk_bf16_f32 v76, v16, v17
v_mfma_f32_16x16x32_bf16 a[4:7], v[108:111], a[212:215], a[4:7]
v_exp_f32 v18, v18
v_mfma_f32_16x16x32_bf16 a[20:23], v[108:111], a[216:219], a[20:23]
ds_read_b64_tr_b16 a[176:177], v220 offset:32768
ds_read_b64_tr_b16 a[178:179], v220 offset:36864
v_mfma_f32_16x16x32_bf16 a[20:23], v[92:95], a[180:183], a[20:23]
v_exp_f32 v19, v19
v_mfma_f32_16x16x32_bf16 a[16:19], v[88:91], a[180:183], a[16:19]
ds_read_b64_tr_b16 a[180:181], v221 offset:32768
v_cvt_pk_bf16_f32 v77, v18, v19
v_mfma_f32_16x16x32_bf16 a[16:19], v[104:107], a[216:219], a[16:19]
v_exp_f32 v20, v20
v_mfma_f32_16x16x32_bf16 a[32:35], v[104:107], a[220:223], a[32:35]
ds_read_b64_tr_b16 a[182:183], v221 offset:36864
STUB_10:
s_cbranch_execz HOP_RET1
s_add_u32 s32, s32, 16384
v_mfma_f32_16x16x32_bf16 a[32:35], v[88:91], a[184:187], a[32:35]
v_exp_f32 v21, v21
v_mfma_f32_16x16x32_bf16 a[36:39], v[92:95], a[184:187], a[36:39]
ds_read_b64_tr_b16 a[184:185], v222 offset:32768
v_cvt_pk_bf16_f32 v78, v20, v21
v_mfma_f32_16x16x32_bf16 a[36:39], v[108:111], a[220:223], a[36:39]
v_exp_f32 v22, v22
v_mfma_f32_16x16x32_bf16 a[52:55], v[108:111], a[224:227], a[52:55]
ds_read_b64_tr_b16 a[186:187], v222 offset:36864
s_add_u32 m0, s30, 81920
v_mfma_f32_16x16x32_bf16 a[52:55], v[92:95], a[188:191], a[52:55]
v_exp_f32 v23, v23
v_mfma_f32_16x16x32_bf16 a[48:51], v[88:91], a[188:191], a[48:51]
ds_read_b64_tr_b16 a[188:189], v223 offset:32768
v_cvt_pk_bf16_f32 v79, v22, v23
v_mfma_f32_16x16x32_bf16 a[48:51], v[104:107], a[224:227], a[48:51]
v_exp_f32 v24, v24
v_mfma_f32_16x16x32_bf16 v[44:47], a[160:163], v[152:155], v[136:139]
v_exp_f32 v25, v25
v_mfma_f32_16x16x32_bf16 v[44:47], a[164:167], v[156:159], v[44:47]
ds_read_b64_tr_b16 a[190:191], v223 offset:36864
v_cvt_pk_bf16_f32 v80, v24, v25
v_mfma_f32_16x16x32_bf16 v[44:47], a[168:171], v[160:163], v[44:47]
v_exp_f32 v26, v26
v_mfma_f32_16x16x32_bf16 v[44:47], a[172:175], v[164:167], v[44:47]
buffer_load_dwordx4 v228, s[8:11], s32 offen offset:0  lds
v_mfma_f32_16x16x32_bf16 v[52:55], a[172:175], v[180:183], v[140:143]
v_exp_f32 v27, v27
v_mfma_f32_16x16x32_bf16 v[52:55], a[168:171], v[176:179], v[52:55]
v_cvt_pk_bf16_f32 v81, v26, v27
v_mfma_f32_16x16x32_bf16 v[52:55], a[164:167], v[172:175], v[52:55]
v_exp_f32 v28, v28
v_mfma_f32_16x16x32_bf16 v[52:55], a[160:163], v[168:171], v[52:55]
buffer_load_dwordx4 v229, s[8:11], s32 offen offset:1024  lds
v_mfma_f32_16x16x32_bf16 v[60:63], a[160:163], v[184:187], v[144:147]
v_exp_f32 v29, v29
v_mfma_f32_16x16x32_bf16 v[60:63], a[164:167], v[188:191], v[60:63]
v_cvt_pk_bf16_f32 v82, v28, v29
v_mfma_f32_16x16x32_bf16 v[60:63], a[168:171], v[192:195], v[60:63]
v_exp_f32 v30, v30
v_mfma_f32_16x16x32_bf16 v[60:63], a[172:175], v[196:199], v[60:63]
buffer_load_dwordx4 v230, s[8:11], s32 offen offset:2048  lds
v_mfma_f32_16x16x32_bf16 v[68:71], a[172:175], v[212:215], v[148:151]
v_exp_f32 v31, v31
v_mfma_f32_16x16x32_bf16 v[68:71], a[168:171], v[208:211], v[68:71]
ds_read_b128 a[172:175], v219 offset:53248
v_cvt_pk_bf16_f32 v83, v30, v31
v_mfma_f32_16x16x32_bf16 v[68:71], a[164:167], v[204:207], v[68:71]
v_exp_f32 v32, v32
v_mfma_f32_16x16x32_bf16 v[68:71], a[160:163], v[200:203], v[68:71]
ds_read_b128 a[168:171], v218 offset:53248
ds_read_b128 a[164:167], v217 offset:53248
v_mfma_f32_16x16x32_bf16 a[64:67], v[104:107], a[228:231], a[64:67]
v_exp_f32 v33, v33
v_mfma_f32_16x16x32_bf16 a[64:67], v[88:91], a[192:195], a[64:67]
ds_read_b128 a[160:163], v216 offset:53248
v_cvt_pk_bf16_f32 v84, v32, v33
v_mfma_f32_16x16x32_bf16 a[68:71], v[92:95], a[192:195], a[68:71]
v_exp_f32 v34, v34
v_mfma_f32_16x16x32_bf16 a[68:71], v[108:111], a[228:231], a[68:71]
ds_read_b64_tr_b16 a[192:193], v224 offset:32768
ds_read_b64_tr_b16 a[194:195], v224 offset:36864
v_mfma_f32_16x16x32_bf16 a[84:87], v[108:111], a[232:235], a[84:87]
v_exp_f32 v35, v35
v_mfma_f32_16x16x32_bf16 a[84:87], v[92:95], a[196:199], a[84:87]
v_cvt_pk_bf16_f32 v85, v34, v35
v_mfma_f32_16x16x32_bf16 a[80:83], v[88:91], a[196:199], a[80:83]
v_exp_f32 v36, v36
v_mfma_f32_16x16x32_bf16 a[80:83], v[104:107], a[232:235], a[80:83]
ds_read_b64_tr_b16 a[196:197], v225 offset:32768
ds_read_b64_tr_b16 a[198:199], v225 offset:36864
v_mfma_f32_16x16x32_bf16 a[96:99], v[104:107], a[236:239], a[96:99]
v_exp_f32 v37, v37
v_mfma_f32_16x16x32_bf16 a[96:99], v[88:91], a[200:203], a[96:99]
v_cvt_pk_bf16_f32 v86, v36, v37
v_mfma_f32_16x16x32_bf16 a[100:103], v[92:95], a[200:203], a[100:103]
v_exp_f32 v38, v38
v_mfma_f32_16x16x32_bf16 a[100:103], v[108:111], a[236:239], a[100:103]
ds_read_b64_tr_b16 a[200:201], v226 offset:32768
ds_read_b64_tr_b16 a[202:203], v226 offset:36864
v_mfma_f32_16x16x32_bf16 a[116:119], v[108:111], a[240:243], a[116:119]
v_exp_f32 v39, v39
v_mfma_f32_16x16x32_bf16 a[116:119], v[92:95], a[204:207], a[116:119]
v_cvt_pk_bf16_f32 v87, v38, v39
v_mfma_f32_16x16x32_bf16 a[112:115], v[88:91], a[204:207], a[112:115]
ds_read_b64_tr_b16 a[204:205], v227 offset:32768
ds_read_b64_tr_b16 a[206:207], v227 offset:36864
v_mfma_f32_16x16x32_bf16 a[112:115], v[104:107], a[240:243], a[112:115]
buffer_load_dwordx4 v231, s[8:11], s32 offen offset:3072  lds
v_smfmac_f32_16x16x64_bf16 a[128:131], a[208:211], v[104:111], v245
s_mov_b32 m0, s87
s_lshl2_add_u32 s50, s87, s89
buffer_load_dwordx4 v243, s[56:59], s50 offen  lds
v_smfmac_f32_16x16x64_bf16 a[128:131], a[208:211], v[88:95], v245
s_add_u32 s87, s87, 3456
s_min_u32 s87, s87, 63936
s_waitcnt lgkmcnt(8)
v_mfma_f32_16x16x32_bf16 v[8:11], a[144:147], v[152:155], v[136:139]
v_exp_f32 v40, v40
v_mfma_f32_16x16x32_bf16 v[8:11], a[148:151], v[156:159], v[8:11]
v_exp_f32 v41, v41
v_mfma_f32_16x16x32_bf16 v[8:11], a[152:155], v[160:163], v[8:11]
v_cvt_pk_bf16_f32 v88, v40, v41
v_mfma_f32_16x16x32_bf16 v[8:11], a[156:159], v[164:167], v[8:11]
v_exp_f32 v42, v42
v_mfma_f32_16x16x32_bf16 v[16:19], a[156:159], v[180:183], v[140:143]
s_add_u32 s39, s39, 16384
v_mfma_f32_16x16x32_bf16 v[16:19], a[152:155], v[176:179], v[16:19]
v_exp_f32 v43, v43
v_mfma_f32_16x16x32_bf16 v[16:19], a[148:151], v[172:175], v[16:19]
v_cvt_pk_bf16_f32 v89, v42, v43
v_mfma_f32_16x16x32_bf16 v[16:19], a[144:147], v[168:171], v[16:19]
v_exp_f32 v44, v44
v_mfma_f32_16x16x32_bf16 v[24:27], a[144:147], v[184:187], v[144:147]
v_mfma_f32_16x16x32_bf16 v[24:27], a[148:151], v[188:191], v[24:27]
v_exp_f32 v45, v45
v_mfma_f32_16x16x32_bf16 v[24:27], a[152:155], v[192:195], v[24:27]
s_add_u32 m0, s30, 98304
v_cvt_pk_bf16_f32 v90, v44, v45
v_mfma_f32_16x16x32_bf16 v[24:27], a[156:159], v[196:199], v[24:27]
v_exp_f32 v46, v46
v_mfma_f32_16x16x32_bf16 v[32:35], a[156:159], v[212:215], v[148:151]
ds_read_b128 a[156:159], v219 offset:57344
v_mfma_f32_16x16x32_bf16 v[32:35], a[152:155], v[208:211], v[32:35]
v_exp_f32 v47, v47
v_mfma_f32_16x16x32_bf16 v[32:35], a[148:151], v[204:207], v[32:35]
ds_read_b128 a[152:155], v218 offset:57344
v_cvt_pk_bf16_f32 v91, v46, v47
v_mfma_f32_16x16x32_bf16 v[32:35], a[144:147], v[200:203], v[32:35]
v_exp_f32 v48, v48
v_mfma_f32_16x16x32_bf16 a[8:11], v[80:83], a[176:179], a[8:11]
ds_read_b128 a[148:151], v217 offset:57344
ds_read_b128 a[144:147], v216 offset:57344
v_mfma_f32_16x16x32_bf16 a[8:11], v[112:115], a[212:215], a[8:11]
v_exp_f32 v49, v49
v_mfma_f32_16x16x32_bf16 a[12:15], v[116:119], a[212:215], a[12:15]
ds_read_b64_tr_b16 a[212:213], v220 offset:40960
v_cvt_pk_bf16_f32 v92, v48, v49
v_mfma_f32_16x16x32_bf16 a[12:15], v[84:87], a[176:179], a[12:15]
v_exp_f32 v50, v50
v_mfma_f32_16x16x32_bf16 a[28:31], v[84:87], a[180:183], a[28:31]
ds_read_b64_tr_b16 a[214:215], v220 offset:45056
v_mfma_f32_16x16x32_bf16 a[28:31], v[116:119], a[216:219], a[28:31]
v_exp_f32 v51, v51
v_mfma_f32_16x16x32_bf16 a[24:27], v[112:115], a[216:219], a[24:27]
ds_read_b64_tr_b16 a[216:217], v221 offset:40960
v_cvt_pk_bf16_f32 v93, v50, v51
v_mfma_f32_16x16x32_bf16 a[24:27], v[80:83], a[180:183], a[24:27]
v_exp_f32 v52, v52
v_mfma_f32_16x16x32_bf16 a[40:43], v[80:83], a[184:187], a[40:43]
ds_read_b64_tr_b16 a[218:219], v221 offset:45056
v_mfma_f32_16x16x32_bf16 a[40:43], v[112:115], a[220:223], a[40:43]
v_exp_f32 v53, v53
v_mfma_f32_16x16x32_bf16 a[44:47], v[116:119], a[220:223], a[44:47]
ds_read_b64_tr_b16 a[220:221], v222 offset:40960
v_cvt_pk_bf16_f32 v94, v52, v53
v_mfma_f32_16x16x32_bf16 a[44:47], v[84:87], a[184:187], a[44:47]
v_exp_f32 v54, v54
v_mfma_f32_16x16x32_bf16 a[60:63], v[84:87], a[188:191], a[60:63]
ds_read_b64_tr_b16 a[222:223], v222 offset:45056
v_mfma_f32_16x16x32_bf16 a[60:63], v[116:119], a[224:227], a[60:63]
v_exp_f32 v55, v55
v_mfma_f32_16x16x32_bf16 a[56:59], v[112:115], a[224:227], a[56:59]
ds_read_b64_tr_b16 a[224:225], v223 offset:40960
v_cvt_pk_bf16_f32 v95, v54, v55
v_mfma_f32_16x16x32_bf16 a[56:59], v[80:83], a[188:191], a[56:59]
v_exp_f32 v56, v56
v_mfma_f32_16x16x32_bf16 v[12:15], a[160:163], v[152:155], v[136:139]
v_exp_f32 v57, v57
v_mfma_f32_16x16x32_bf16 v[12:15], a[164:167], v[156:159], v[12:15]
ds_read_b64_tr_b16 a[226:227], v223 offset:45056
v_cvt_pk_bf16_f32 v96, v56, v57
v_mfma_f32_16x16x32_bf16 v[12:15], a[168:171], v[160:163], v[12:15]
v_exp_f32 v58, v58
v_mfma_f32_16x16x32_bf16 v[12:15], a[172:175], v[164:167], v[12:15]
buffer_load_dwordx4 v232, s[12:15], s39 offen offset:0  lds
v_mfma_f32_16x16x32_bf16 v[20:23], a[172:175], v[180:183], v[140:143]
v_exp_f32 v59, v59
v_mfma_f32_16x16x32_bf16 v[20:23], a[168:171], v[176:179], v[20:23]
v_cvt_pk_bf16_f32 v97, v58, v59
v_mfma_f32_16x16x32_bf16 v[20:23], a[164:167], v[172:175], v[20:23]
v_exp_f32 v60, v60
v_mfma_f32_16x16x32_bf16 v[20:23], a[160:163], v[168:171], v[20:23]
buffer_load_dwordx4 v233, s[12:15], s39 offen offset:1024  lds
v_mfma_f32_16x16x32_bf16 v[28:31], a[160:163], v[184:187], v[144:147]
v_exp_f32 v61, v61
v_mfma_f32_16x16x32_bf16 v[28:31], a[164:167], v[188:191], v[28:31]
v_cvt_pk_bf16_f32 v98, v60, v61
v_mfma_f32_16x16x32_bf16 v[28:31], a[168:171], v[192:195], v[28:31]
v_exp_f32 v62, v62
v_mfma_f32_16x16x32_bf16 v[28:31], a[172:175], v[196:199], v[28:31]
buffer_load_dwordx4 v232, s[12:15], s39 offen offset:2048  lds
v_mfma_f32_16x16x32_bf16 v[36:39], a[172:175], v[212:215], v[148:151]
v_exp_f32 v63, v63
v_mfma_f32_16x16x32_bf16 v[36:39], a[168:171], v[208:211], v[36:39]
ds_read_b128 a[172:175], v219 offset:61440
v_cvt_pk_bf16_f32 v99, v62, v63
v_mfma_f32_16x16x32_bf16 v[36:39], a[164:167], v[204:207], v[36:39]
v_exp_f32 v64, v64
v_mfma_f32_16x16x32_bf16 v[36:39], a[160:163], v[200:203], v[36:39]
ds_read_b128 a[168:171], v218 offset:61440
ds_read_b128 a[164:167], v217 offset:61440
s_waitcnt lgkmcnt(8)
v_mfma_f32_16x16x32_bf16 a[72:75], v[80:83], a[192:195], a[72:75]
v_exp_f32 v65, v65
v_mfma_f32_16x16x32_bf16 a[72:75], v[112:115], a[228:231], a[72:75]
ds_read_b128 a[160:163], v216 offset:61440
v_cvt_pk_bf16_f32 v100, v64, v65
v_mfma_f32_16x16x32_bf16 a[76:79], v[116:119], a[228:231], a[76:79]
v_exp_f32 v66, v66
v_mfma_f32_16x16x32_bf16 a[76:79], v[84:87], a[192:195], a[76:79]
ds_read_b64_tr_b16 a[228:229], v224 offset:40960
ds_read_b64_tr_b16 a[230:231], v224 offset:45056
v_mfma_f32_16x16x32_bf16 a[92:95], v[84:87], a[196:199], a[92:95]
v_exp_f32 v67, v67
v_mfma_f32_16x16x32_bf16 a[92:95], v[116:119], a[232:235], a[92:95]
v_cvt_pk_bf16_f32 v101, v66, v67
v_mfma_f32_16x16x32_bf16 a[88:91], v[112:115], a[232:235], a[88:91]
v_exp_f32 v68, v68
v_mfma_f32_16x16x32_bf16 a[88:91], v[80:83], a[196:199], a[88:91]
ds_read_b64_tr_b16 a[232:233], v225 offset:40960
ds_read_b64_tr_b16 a[234:235], v225 offset:45056
v_mfma_f32_16x16x32_bf16 a[104:107], v[80:83], a[200:203], a[104:107]
v_exp_f32 v69, v69
v_mfma_f32_16x16x32_bf16 a[104:107], v[112:115], a[236:239], a[104:107]
v_cvt_pk_bf16_f32 v102, v68, v69
v_mfma_f32_16x16x32_bf16 a[108:111], v[116:119], a[236:239], a[108:111]
v_exp_f32 v70, v70
v_mfma_f32_16x16x32_bf16 a[108:111], v[84:87], a[200:203], a[108:111]
ds_read_b64_tr_b16 a[236:237], v226 offset:40960
ds_read_b64_tr_b16 a[238:239], v226 offset:45056
v_mfma_f32_16x16x32_bf16 a[124:127], v[84:87], a[204:207], a[124:127]
v_exp_f32 v71, v71
v_mfma_f32_16x16x32_bf16 a[124:127], v[116:119], a[240:243], a[124:127]
v_cvt_pk_bf16_f32 v103, v70, v71
v_mfma_f32_16x16x32_bf16 a[120:123], v[112:115], a[240:243], a[120:123]
ds_read_b64_tr_b16 a[240:241], v227 offset:40960
ds_read_b64_tr_b16 a[242:243], v227 offset:45056
v_mfma_f32_16x16x32_bf16 a[120:123], v[80:83], a[204:207], a[120:123]
buffer_load_dwordx4 v233, s[12:15], s39 offen offset:3072  lds
v_smfmac_f32_16x16x64_bf16 a[132:135], a[208:211], v[80:87], v245
buffer_load_dword v242, v241, s[20:23], s46 offen sc1
v_smfmac_f32_16x16x64_bf16 a[132:135], a[208:211], v[112:119], v245
v_add_u32 v241, 1024, v241
v_and_b32 v241, 0x3fff, v241
v_mfma_f32_16x16x32_bf16 v[40:43], a[144:147], v[152:155], v[136:139]
v_exp_f32 v8, v8
v_mfma_f32_16x16x32_bf16 v[40:43], a[148:151], v[156:159], v[40:43]
v_exp_f32 v9, v9
v_mfma_f32_16x16x32_bf16 v[40:43], a[152:155], v[160:163], v[40:43]
v_cvt_pk_bf16_f32 v104, v8, v9
v_mfma_f32_16x16x32_bf16 v[40:43], a[156:159], v[164:167], v[40:43]
v_exp_f32 v10, v10
v_mfma_f32_16x16x32_bf16 v[48:51], a[156:159], v[180:183], v[140:143]
v_mfma_f32_16x16x32_bf16 v[48:51], a[152:155], v[176:179], v[48:51]
v_exp_f32 v11, v11
v_mfma_f32_16x16x32_bf16 v[48:51], a[148:151], v[172:175], v[48:51]
v_cvt_pk_bf16_f32 v105, v10, v11
v_mfma_f32_16x16x32_bf16 v[48:51], a[144:147], v[168:171], v[48:51]
v_exp_f32 v12, v12
v_mfma_f32_16x16x32_bf16 v[56:59], a[144:147], v[184:187], v[144:147]
v_mfma_f32_16x16x32_bf16 v[56:59], a[148:151], v[188:191], v[56:59]
v_exp_f32 v13, v13
v_mfma_f32_16x16x32_bf16 v[56:59], a[152:155], v[192:195], v[56:59]
v_cvt_pk_bf16_f32 v106, v12, v13
v_mfma_f32_16x16x32_bf16 v[56:59], a[156:159], v[196:199], v[56:59]
v_exp_f32 v14, v14
v_mfma_f32_16x16x32_bf16 v[64:67], a[156:159], v[212:215], v[148:151]
s_waitcnt vmcnt(10) lgkmcnt(0)
s_barrier
v_mfma_f32_16x16x32_bf16 v[64:67], a[152:155], v[208:211], v[64:67]
v_exp_f32 v15, v15
v_mfma_f32_16x16x32_bf16 v[64:67], a[148:151], v[204:207], v[64:67]
ds_read_b128 a[156:159], v219 offset:0
v_cvt_pk_bf16_f32 v107, v14, v15
v_mfma_f32_16x16x32_bf16 v[64:67], a[144:147], v[200:203], v[64:67]
v_exp_f32 v16, v16
v_mfma_f32_16x16x32_bf16 a[0:3], v[88:91], a[212:215], a[0:3]
ds_read_b128 a[152:155], v218 offset:0
ds_read_b128 a[148:151], v217 offset:0
v_mfma_f32_16x16x32_bf16 a[0:3], v[72:75], a[176:179], a[0:3]
v_exp_f32 v17, v17
v_mfma_f32_16x16x32_bf16 a[4:7], v[76:79], a[176:179], a[4:7]
ds_read_b128 a[144:147], v216 offset:0
v_cvt_pk_bf16_f32 v108, v16, v17
v_mfma_f32_16x16x32_bf16 a[4:7], v[92:95], a[212:215], a[4:7]
v_exp_f32 v18, v18
v_mfma_f32_16x16x32_bf16 a[20:23], v[92:95], a[216:219], a[20:23]
ds_read_b64_tr_b16 a[176:177], v220 offset:49152
ds_read_b64_tr_b16 a[178:179], v220 offset:53248
v_mfma_f32_16x16x32_bf16 a[20:23], v[76:79], a[180:183], a[20:23]
v_exp_f32 v19, v19
v_mfma_f32_16x16x32_bf16 a[16:19], v[72:75], a[180:183], a[16:19]
ds_read_b64_tr_b16 a[180:181], v221 offset:49152
v_cvt_pk_bf16_f32 v109, v18, v19
v_mfma_f32_16x16x32_bf16 a[16:19], v[88:91], a[216:219], a[16:19]
v_exp_f32 v20, v20
v_mfma_f32_16x16x32_bf16 a[32:35], v[88:91], a[220:223], a[32:35]
ds_read_b64_tr_b16 a[182:183], v221 offset:53248
s_add_u32 s32, s32, 16384
v_mfma_f32_16x16x32_bf16 a[32:35], v[72:75], a[184:187], a[32:35]
v_exp_f32 v21, v21
v_mfma_f32_16x16x32_bf16 a[36:39], v[76:79], a[184:187], a[36:39]
ds_read_b64_tr_b16 a[184:185], v222 offset:49152
v_cvt_pk_bf16_f32 v110, v20, v21
v_mfma_f32_16x16x32_bf16 a[36:39], v[92:95], a[220:223], a[36:39]
v_exp_f32 v22, v22
v_mfma_f32_16x16x32_bf16 a[52:55], v[92:95], a[224:227], a[52:55]
ds_read_b64_tr_b16 a[186:187], v222 offset:53248
s_add_u32 m0, s30, 114688
v_mfma_f32_16x16x32_bf16 a[52:55], v[76:79], a[188:191], a[52:55]
v_exp_f32 v23, v23
v_mfma_f32_16x16x32_bf16 a[48:51], v[72:75], a[188:191], a[48:51]
ds_read_b64_tr_b16 a[188:189], v223 offset:49152
v_cvt_pk_bf16_f32 v111, v22, v23
v_mfma_f32_16x16x32_bf16 a[48:51], v[88:91], a[224:227], a[48:51]
v_exp_f32 v24, v24
v_mfma_f32_16x16x32_bf16 v[44:47], a[160:163], v[152:155], v[136:139]
v_exp_f32 v25, v25
v_mfma_f32_16x16x32_bf16 v[44:47], a[164:167], v[156:159], v[44:47]
ds_read_b64_tr_b16 a[190:191], v223 offset:53248
v_cvt_pk_bf16_f32 v112, v24, v25
v_mfma_f32_16x16x32_bf16 v[44:47], a[168:171], v[160:163], v[44:47]
v_exp_f32 v26, v26
v_mfma_f32_16x16x32_bf16 v[44:47], a[172:175], v[164:167], v[44:47]
buffer_load_dwordx4 v228, s[8:11], s32 offen offset:0  lds
v_mfma_f32_16x16x32_bf16 v[52:55], a[172:175], v[180:183], v[140:143]
v_exp_f32 v27, v27
v_mfma_f32_16x16x32_bf16 v[52:55], a[168:171], v[176:179], v[52:55]
v_cvt_pk_bf16_f32 v113, v26, v27
v_mfma_f32_16x16x32_bf16 v[52:55], a[164:167], v[172:175], v[52:55]
v_exp_f32 v28, v28
v_mfma_f32_16x16x32_bf16 v[52:55], a[160:163], v[168:171], v[52:55]
buffer_load_dwordx4 v229, s[8:11], s32 offen offset:1024  lds
v_mfma_f32_16x16x32_bf16 v[60:63], a[160:163], v[184:187], v[144:147]
v_exp_f32 v29, v29
v_mfma_f32_16x16x32_bf16 v[60:63], a[164:167], v[188:191], v[60:63]
v_cvt_pk_bf16_f32 v114, v28, v29
v_mfma_f32_16x16x32_bf16 v[60:63], a[168:171], v[192:195], v[60:63]
v_exp_f32 v30, v30
v_mfma_f32_16x16x32_bf16 v[60:63], a[172:175], v[196:199], v[60:63]
buffer_load_dwordx4 v230, s[8:11], s32 offen offset:2048  lds
v_mfma_f32_16x16x32_bf16 v[68:71], a[172:175], v[212:215], v[148:151]
v_exp_f32 v31, v31
v_mfma_f32_16x16x32_bf16 v[68:71], a[168:171], v[208:211], v[68:71]
ds_read_b128 a[172:175], v219 offset:4096
v_cvt_pk_bf16_f32 v115, v30, v31
v_mfma_f32_16x16x32_bf16 v[68:71], a[164:167], v[204:207], v[68:71]
v_exp_f32 v32, v32
v_mfma_f32_16x16x32_bf16 v[68:71], a[160:163], v[200:203], v[68:71]
ds_read_b128 a[168:171], v218 offset:4096
ds_read_b128 a[164:167], v217 offset:4096
v_mfma_f32_16x16x32_bf16 a[64:67], v[88:91], a[228:231], a[64:67]
v_exp_f32 v33, v33
v_mfma_f32_16x16x32_bf16 a[64:67], v[72:75], a[192:195], a[64:67]
ds_read_b128 a[160:163], v216 offset:4096
v_cvt_pk_bf16_f32 v116, v32, v33
v_mfma_f32_16x16x32_bf16 a[68:71], v[76:79], a[192:195], a[68:71]
v_exp_f32 v34, v34
v_mfma_f32_16x16x32_bf16 a[68:71], v[92:95], a[228:231], a[68:71]
ds_read_b64_tr_b16 a[192:193], v224 offset:49152
ds_read_b64_tr_b16 a[194:195], v224 offset:53248
v_mfma_f32_16x16x32_bf16 a[84:87], v[92:95], a[232:235], a[84:87]
v_exp_f32 v35, v35
v_mfma_f32_16x16x32_bf16 a[84:87], v[76:79], a[196:199], a[84:87]
v_cvt_pk_bf16_f32 v117, v34, v35
v_mfma_f32_16x16x32_bf16 a[80:83], v[72:75], a[196:199], a[80:83]
v_exp_f32 v36, v36
v_mfma_f32_16x16x32_bf16 a[80:83], v[88:91], a[232:235], a[80:83]
ds_read_b64_tr_b16 a[196:197], v225 offset:49152
ds_read_b64_tr_b16 a[198:199], v225 offset:53248
v_mfma_f32_16x16x32_bf16 a[96:99], v[88:91], a[236:239], a[96:99]
v_exp_f32 v37, v37
v_mfma_f32_16x16x32_bf16 a[96:99], v[72:75], a[200:203], a[96:99]
v_cvt_pk_bf16_f32 v118, v36, v37
v_mfma_f32_16x16x32_bf16 a[100:103], v[76:79], a[200:203], a[100:103]
v_exp_f32 v38, v38
v_mfma_f32_16x16x32_bf16 a[100:103], v[92:95], a[236:239], a[100:103]
ds_read_b64_tr_b16 a[200:201], v226 offset:49152
ds_read_b64_tr_b16 a[202:203], v226 offset:53248
v_mfma_f32_16x16x32_bf16 a[116:119], v[92:95], a[240:243], a[116:119]
v_exp_f32 v39, v39
v_mfma_f32_16x16x32_bf16 a[116:119], v[76:79], a[204:207], a[116:119]
v_cvt_pk_bf16_f32 v119, v38, v39
v_mfma_f32_16x16x32_bf16 a[112:115], v[72:75], a[204:207], a[112:115]
ds_read_b64_tr_b16 a[204:205], v227 offset:49152
ds_read_b64_tr_b16 a[206:207], v227 offset:53248
v_mfma_f32_16x16x32_bf16 a[112:115], v[88:91], a[240:243], a[112:115]
buffer_load_dwordx4 v231, s[8:11], s32 offen offset:3072  lds
v_smfmac_f32_16x16x64_bf16 a[128:131], a[208:211], v[88:95], v245
s_mov_b32 m0, s87
s_lshl2_add_u32 s50, s87, s89
buffer_load_dwordx4 v243, s[56:59], s50 offen  lds
v_smfmac_f32_16x16x64_bf16 a[128:131], a[208:211], v[72:79], v245
s_add_u32 s87, s87, 3456
s_min_u32 s87, s87, 63936
s_waitcnt lgkmcnt(8)
v_mfma_f32_16x16x32_bf16 v[8:11], a[144:147], v[152:155], v[136:139]
v_exp_f32 v40, v40
v_mfma_f32_16x16x32_bf16 v[8:11], a[148:151], v[156:159], v[8:11]
v_exp_f32 v41, v41
v_mfma_f32_16x16x32_bf16 v[8:11], a[152:155], v[160:163], v[8:11]
v_cvt_pk_bf16_f32 v72, v40, v41
v_mfma_f32_16x16x32_bf16 v[8:11], a[156:159], v[164:167], v[8:11]
v_exp_f32 v42, v42
v_mfma_f32_16x16x32_bf16 v[16:19], a[156:159], v[180:183], v[140:143]
s_add_u32 s39, s39, 16384
v_mfma_f32_16x16x32_bf16 v[16:19], a[152:155], v[176:179], v[16:19]
v_exp_f32 v43, v43
v_mfma_f32_16x16x32_bf16 v[16:19], a[148:151], v[172:175], v[16:19]
v_cvt_pk_bf16_f32 v73, v42, v43
v_mfma_f32_16x16x32_bf16 v[16:19], a[144:147], v[168:171], v[16:19]
v_exp_f32 v44, v44
v_mfma_f32_16x16x32_bf16 v[24:27], a[144:147], v[184:187], v[144:147]
v_mfma_f32_16x16x32_bf16 v[24:27], a[148:151], v[188:191], v[24:27]
v_exp_f32 v45, v45
v_mfma_f32_16x16x32_bf16 v[24:27], a[152:155], v[192:195], v[24:27]
s_add_u32 m0, s30, 131072
v_cvt_pk_bf16_f32 v74, v44, v45
v_mfma_f32_16x16x32_bf16 v[24:27], a[156:159], v[196:199], v[24:27]
v_exp_f32 v46, v46
v_mfma_f32_16x16x32_bf16 v[32:35], a[156:159], v[212:215], v[148:151]
ds_read_b128 a[156:159], v219 offset:8192
v_mfma_f32_16x16x32_bf16 v[32:35], a[152:155], v[208:211], v[32:35]
v_exp_f32 v47, v47
v_mfma_f32_16x16x32_bf16 v[32:35], a[148:151], v[204:207], v[32:35]
ds_read_b128 a[152:155], v218 offset:8192
v_cvt_pk_bf16_f32 v75, v46, v47
v_mfma_f32_16x16x32_bf16 v[32:35], a[144:147], v[200:203], v[32:35]
v_exp_f32 v48, v48
v_mfma_f32_16x16x32_bf16 a[8:11], v[112:115], a[176:179], a[8:11]
ds_read_b128 a[148:151], v217 offset:8192
ds_read_b128 a[144:147], v216 offset:8192
v_mfma_f32_16x16x32_bf16 a[8:11], v[96:99], a[212:215], a[8:11]
v_exp_f32 v49, v49
v_mfma_f32_16x16x32_bf16 a[12:15], v[100:103], a[212:215], a[12:15]
ds_read_b64_tr_b16 a[212:213], v220 offset:57344
v_cvt_pk_bf16_f32 v76, v48, v49
v_mfma_f32_16x16x32_bf16 a[12:15], v[116:119], a[176:179], a[12:15]
v_exp_f32 v50, v50
v_mfma_f32_16x16x32_bf16 a[28:31], v[116:119], a[180:183], a[28:31]
ds_read_b64_tr_b16 a[214:215], v220 offset:61440
v_mfma_f32_16x16x32_bf16 a[28:31], v[100:103], a[216:219], a[28:31]
v_exp_f32 v51, v51
v_mfma_f32_16x16x32_bf16 a[24:27], v[96:99], a[216:219], a[24:27]
ds_read_b64_tr_b16 a[216:217], v221 offset:57344
v_cvt_pk_bf16_f32 v77, v50, v51
v_mfma_f32_16x16x32_bf16 a[24:27], v[112:115], a[180:183], a[24:27]
v_exp_f32 v52, v52
v_mfma_f32_16x16x32_bf16 a[40:43], v[112:115], a[184:187], a[40:43]
ds_read_b64_tr_b16 a[218:219], v221 offset:61440
v_mfma_f32_16x16x32_bf16 a[40:43], v[96:99], a[220:223], a[40:43]
v_exp_f32 v53, v53
v_mfma_f32_16x16x32_bf16 a[44:47], v[100:103], a[220:223], a[44:47]
ds_read_b64_tr_b16 a[220:221], v222 offset:57344
v_cvt_pk_bf16_f32 v78, v52, v53
v_mfma_f32_16x16x32_bf16 a[44:47], v[116:119], a[184:187], a[44:47]
v_exp_f32 v54, v54
v_mfma_f32_16x16x32_bf16 a[60:63], v[116:119], a[188:191], a[60:63]
ds_read_b64_tr_b16 a[222:223], v222 offset:61440
v_mfma_f32_16x16x32_bf16 a[60:63], v[100:103], a[224:227], a[60:63]
v_exp_f32 v55, v55
v_mfma_f32_16x16x32_bf16 a[56:59], v[96:99], a[224:227], a[56:59]
ds_read_b64_tr_b16 a[224:225], v223 offset:57344
v_cvt_pk_bf16_f32 v79, v54, v55
v_mfma_f32_16x16x32_bf16 a[56:59], v[112:115], a[188:191], a[56:59]
v_exp_f32 v56, v56
v_mfma_f32_16x16x32_bf16 v[12:15], a[160:163], v[152:155], v[136:139]
v_exp_f32 v57, v57
v_mfma_f32_16x16x32_bf16 v[12:15], a[164:167], v[156:159], v[12:15]
ds_read_b64_tr_b16 a[226:227], v223 offset:61440
v_cvt_pk_bf16_f32 v80, v56, v57
v_mfma_f32_16x16x32_bf16 v[12:15], a[168:171], v[160:163], v[12:15]
v_exp_f32 v58, v58
v_mfma_f32_16x16x32_bf16 v[12:15], a[172:175], v[164:167], v[12:15]
buffer_load_dwordx4 v232, s[12:15], s39 offen offset:0  lds
v_mfma_f32_16x16x32_bf16 v[20:23], a[172:175], v[180:183], v[140:143]
v_exp_f32 v59, v59
v_mfma_f32_16x16x32_bf16 v[20:23], a[168:171], v[176:179], v[20:23]
v_cvt_pk_bf16_f32 v81, v58, v59
v_mfma_f32_16x16x32_bf16 v[20:23], a[164:167], v[172:175], v[20:23]
v_exp_f32 v60, v60
v_mfma_f32_16x16x32_bf16 v[20:23], a[160:163], v[168:171], v[20:23]
buffer_load_dwordx4 v233, s[12:15], s39 offen offset:1024  lds
v_mfma_f32_16x16x32_bf16 v[28:31], a[160:163], v[184:187], v[144:147]
v_exp_f32 v61, v61
v_mfma_f32_16x16x32_bf16 v[28:31], a[164:167], v[188:191], v[28:31]
v_cvt_pk_bf16_f32 v82, v60, v61
v_mfma_f32_16x16x32_bf16 v[28:31], a[168:171], v[192:195], v[28:31]
v_exp_f32 v62, v62
v_mfma_f32_16x16x32_bf16 v[28:31], a[172:175], v[196:199], v[28:31]
buffer_load_dwordx4 v232, s[12:15], s39 offen offset:2048  lds
v_mfma_f32_16x16x32_bf16 v[36:39], a[172:175], v[212:215], v[148:151]
v_exp_f32 v63, v63
v_mfma_f32_16x16x32_bf16 v[36:39], a[168:171], v[208:211], v[36:39]
ds_read_b128 a[172:175], v219 offset:12288
v_cvt_pk_bf16_f32 v83, v62, v63
v_mfma_f32_16x16x32_bf16 v[36:39], a[164:167], v[204:207], v[36:39]
v_exp_f32 v64, v64
v_mfma_f32_16x16x32_bf16 v[36:39], a[160:163], v[200:203], v[36:39]
ds_read_b128 a[168:171], v218 offset:12288
ds_read_b128 a[164:167], v217 offset:12288
s_waitcnt lgkmcnt(8)
v_mfma_f32_16x16x32_bf16 a[72:75], v[112:115], a[192:195], a[72:75]
v_exp_f32 v65, v65
v_mfma_f32_16x16x32_bf16 a[72:75], v[96:99], a[228:231], a[72:75]
ds_read_b128 a[160:163], v216 offset:12288
v_cvt_pk_bf16_f32 v84, v64, v65
v_mfma_f32_16x16x32_bf16 a[76:79], v[100:103], a[228:231], a[76:79]
v_exp_f32 v66, v66
v_mfma_f32_16x16x32_bf16 a[76:79], v[116:119], a[192:195], a[76:79]
ds_read_b64_tr_b16 a[228:229], v224 offset:57344
ds_read_b64_tr_b16 a[230:231], v224 offset:61440
v_mfma_f32_16x16x32_bf16 a[92:95], v[116:119], a[196:199], a[92:95]
v_exp_f32 v67, v67
v_mfma_f32_16x16x32_bf16 a[92:95], v[100:103], a[232:235], a[92:95]
v_cvt_pk_bf16_f32 v85, v66, v67
v_mfma_f32_16x16x32_bf16 a[88:91], v[96:99], a[232:235], a[88:91]
v_exp_f32 v68, v68
v_mfma_f32_16x16x32_bf16 a[88:91], v[112:115], a[196:199], a[88:91]
ds_read_b64_tr_b16 a[232:233], v225 offset:57344
ds_read_b64_tr_b16 a[234:235], v225 offset:61440
v_mfma_f32_16x16x32_bf16 a[104:107], v[112:115], a[200:203], a[104:107]
v_exp_f32 v69, v69
v_mfma_f32_16x16x32_bf16 a[104:107], v[96:99], a[236:239], a[104:107]
v_cvt_pk_bf16_f32 v86, v68, v69
v_mfma_f32_16x16x32_bf16 a[108:111], v[100:103], a[236:239], a[108:111]
v_exp_f32 v70, v70
v_mfma_f32_16x16x32_bf16 a[108:111], v[116:119], a[200:203], a[108:111]
ds_read_b64_tr_b16 a[236:237], v226 offset:57344
ds_read_b64_tr_b16 a[238:239], v226 offset:61440
v_mfma_f32_16x16x32_bf16 a[124:127], v[116:119], a[204:207], a[124:127]
v_exp_f32 v71, v71
v_mfma_f32_16x16x32_bf16 a[124:127], v[100:103], a[240:243], a[124:127]
v_cvt_pk_bf16_f32 v87, v70, v71
v_mfma_f32_16x16x32_bf16 a[120:123], v[96:99], a[240:243], a[120:123]
ds_read_b64_tr_b16 a[240:241], v227 offset:57344
ds_read_b64_tr_b16 a[242:243], v227 offset:61440
v_mfma_f32_16x16x32_bf16 a[120:123], v[112:115], a[204:207], a[120:123]
buffer_load_dwordx4 v233, s[12:15], s39 offen offset:3072  lds
v_smfmac_f32_16x16x64_bf16 a[132:135], a[208:211], v[112:119], v245
buffer_load_dword v242, v241, s[20:23], s46 offen sc1
v_smfmac_f32_16x16x64_bf16 a[132:135], a[208:211], v[96:103], v245
v_add_u32 v241, 1024, v241
v_and_b32 v241, 0x3fff, v241
s_sub_u32 s33, s33, 1
s_cmp_lg_u32 s33, 0
s_cbranch_scc1 K_LOOP
K_LAST:
v_mfma_f32_16x16x32_bf16 v[40:43], a[144:147], v[152:155], v[136:139]
v_and_b32 v122, 7, v1
v_exp_f32 v8, v8
v_mfma_f32_16x16x32_bf16 v[40:43], a[148:151], v[156:159], v[40:43]
v_lshlrev_b32 v122, 3, v122
v_exp_f32 v9, v9
v_mfma_f32_16x16x32_bf16 v[40:43], a[152:155], v[160:163], v[40:43]
v_cvt_pk_bf16_f32 v88, v8, v9
v_mfma_f32_16x16x32_bf16 v[40:43], a[156:159], v[164:167], v[40:43]
v_exp_f32 v10, v10
v_mfma_f32_16x16x32_bf16 v[48:51], a[156:159], v[180:183], v[140:143]
v_mfma_f32_16x16x32_bf16 v[48:51], a[152:155], v[176:179], v[48:51]
v_exp_f32 v11, v11
v_mfma_f32_16x16x32_bf16 v[48:51], a[148:151], v[172:175], v[48:51]
v_cvt_pk_bf16_f32 v89, v10, v11
v_mfma_f32_16x16x32_bf16 v[48:51], a[144:147], v[168:171], v[48:51]
v_exp_f32 v12, v12
v_mfma_f32_16x16x32_bf16 v[56:59], a[144:147], v[184:187], v[144:147]
v_mfma_f32_16x16x32_bf16 v[56:59], a[148:151], v[188:191], v[56:59]
v_exp_f32 v13, v13
v_mfma_f32_16x16x32_bf16 v[56:59], a[152:155], v[192:195], v[56:59]
v_cvt_pk_bf16_f32 v90, v12, v13
v_mfma_f32_16x16x32_bf16 v[56:59], a[156:159], v[196:199], v[56:59]
v_exp_f32 v14, v14
v_mfma_f32_16x16x32_bf16 v[64:67], a[156:159], v[212:215], v[148:151]
s_waitcnt vmcnt(10) lgkmcnt(0)
s_barrier
v_mfma_f32_16x16x32_bf16 v[64:67], a[152:155], v[208:211], v[64:67]
v_exp_f32 v15, v15
v_mfma_f32_16x16x32_bf16 v[64:67], a[148:151], v[204:207], v[64:67]
ds_read_b128 a[156:159], v219 offset:16384
v_cvt_pk_bf16_f32 v91, v14, v15
STUB_11:
s_cbranch_execz HOP_RET1
v_mfma_f32_16x16x32_bf16 v[64:67], a[144:147], v[200:203], v[64:67]
v_exp_f32 v16, v16
v_mfma_f32_16x16x32_bf16 a[0:3], v[72:75], a[212:215], a[0:3]
ds_read_b128 a[152:155], v218 offset:16384
ds_read_b128 a[148:151], v217 offset:16384
v_mfma_f32_16x16x32_bf16 a[0:3], v[104:107], a[176:179], a[0:3]
v_exp_f32 v17, v17
v_mfma_f32_16x16x32_bf16 a[4:7], v[108:111], a[176:179], a[4:7]
ds_read_b128 a[144:147], v216 offset:16384
v_cvt_pk_bf16_f32 v92, v16, v17
v_mfma_f32_16x16x32_bf16 a[4:7], v[76:79], a[212:215], a[4:7]
v_exp_f32 v18, v18
v_mfma_f32_16x16x32_bf16 a[20:23], v[76:79], a[216:219], a[20:23]
ds_read_b64_tr_b16 a[176:177], v220 offset:0
ds_read_b64_tr_b16 a[178:179], v220 offset:4096
v_mfma_f32_16x16x32_bf16 a[20:23], v[108:111], a[180:183], a[20:23]
v_exp_f32 v19, v19
v_mfma_f32_16x16x32_bf16 a[16:19], v[104:107], a[180:183], a[16:19]
ds_read_b64_tr_b16 a[180:181], v221 offset:0
v_cvt_pk_bf16_f32 v93, v18, v19
v_mfma_f32_16x16x32_bf16 a[16:19], v[72:75], a[216:219], a[16:19]
v_exp_f32 v20, v20
v_mfma_f32_16x16x32_bf16 a[32:35], v[72:75], a[220:223], a[32:35]
ds_read_b64_tr_b16 a[182:183], v221 offset:4096
v_mfma_f32_16x16x32_bf16 a[32:35], v[104:107], a[184:187], a[32:35]
v_exp_f32 v21, v21
v_mfma_f32_16x16x32_bf16 a[36:39], v[108:111], a[184:187], a[36:39]
ds_read_b64_tr_b16 a[184:185], v222 offset:0
v_cvt_pk_bf16_f32 v94, v20, v21
v_mfma_f32_16x16x32_bf16 a[36:39], v[76:79], a[220:223], a[36:39]
v_exp_f32 v22, v22
v_mfma_f32_16x16x32_bf16 a[52:55], v[76:79], a[224:227], a[52:55]
ds_read_b64_tr_b16 a[186:187], v222 offset:4096
v_mfma_f32_16x16x32_bf16 a[52:55], v[108:111], a[188:191], a[52:55]
v_exp_f32 v23, v23
v_mfma_f32_16x16x32_bf16 a[48:51], v[104:107], a[188:191], a[48:51]
ds_read_b64_tr_b16 a[188:189], v223 offset:0
v_cvt_pk_bf16_f32 v95, v22, v23
v_mfma_f32_16x16x32_bf16 a[48:51], v[72:75], a[224:227], a[48:51]
v_exp_f32 v24, v24
v_mfma_f32_16x16x32_bf16 v[44:47], a[160:163], v[152:155], v[136:139]
v_exp_f32 v25, v25
v_mfma_f32_16x16x32_bf16 v[44:47], a[164:167], v[156:159], v[44:47]
ds_read_b64_tr_b16 a[190:191], v223 offset:4096
v_cvt_pk_bf16_f32 v96, v24, v25
v_mfma_f32_16x16x32_bf16 v[44:47], a[168:171], v[160:163], v[44:47]
v_exp_f32 v26, v26
v_mfma_f32_16x16x32_bf16 v[44:47], a[172:175], v[164:167], v[44:47]
s_add_u32 m0, s88, 62208
s_lshl2_add_u32 s50, m0, s89
buffer_load_dwordx4 v243, s[56:59], s50 offen  lds
v_mfma_f32_16x16x32_bf16 v[52:55], a[172:175], v[180:183], v[140:143]
v_exp_f32 v27, v27
v_mfma_f32_16x16x32_bf16 v[52:55], a[168:171], v[176:179], v[52:55]
v_cvt_pk_bf16_f32 v97, v26, v27
v_mfma_f32_16x16x32_bf16 v[52:55], a[164:167], v[172:175], v[52:55]
v_exp_f32 v28, v28
v_mfma_f32_16x16x32_bf16 v[52:55], a[160:163], v[168:171], v[52:55]
s_add_u32 m0, s88, 65664
s_lshl2_add_u32 s50, m0, s89
buffer_load_dwordx4 v243, s[56:59], s50 offen  lds
v_mfma_f32_16x16x32_bf16 v[60:63], a[160:163], v[184:187], v[144:147]
v_exp_f32 v29, v29
v_mfma_f32_16x16x32_bf16 v[60:63], a[164:167], v[188:191], v[60:63]
v_cvt_pk_bf16_f32 v98, v28, v29
v_mfma_f32_16x16x32_bf16 v[60:63], a[168:171], v[192:195], v[60:63]
v_exp_f32 v30, v30
v_mfma_f32_16x16x32_bf16 v[60:63], a[172:175], v[196:199], v[60:63]
s_mov_b32 s93, 0x242800
buffer_load_dwordx2 v[120:121], v122, s[20:23], s93 offen sc0 sc1
v_mfma_f32_16x16x32_bf16 v[68:71], a[172:175], v[212:215], v[148:151]
v_and_b32 v246, 15, v1
v_exp_f32 v31, v31
v_mfma_f32_16x16x32_bf16 v[68:71], a[168:171], v[208:211], v[68:71]
ds_read_b128 a[172:175], v219 offset:20480
v_cvt_pk_bf16_f32 v99, v30, v31
v_lshrrev_b32 v247, 3, v246
v_mfma_f32_16x16x32_bf16 v[68:71], a[164:167], v[204:207], v[68:71]
v_and_b32 v246, 7, v246
v_exp_f32 v32, v32
v_mfma_f32_16x16x32_bf16 v[68:71], a[160:163], v[200:203], v[68:71]
ds_read_b128 a[168:171], v218 offset:20480
ds_read_b128 a[164:167], v217 offset:20480
v_lshlrev_b32 v246, 6, v246
v_mfma_f32_16x16x32_bf16 a[64:67], v[72:75], a[228:231], a[64:67]
v_lshl_add_u32 v246, v247, 13, v246
v_exp_f32 v33, v33
v_mfma_f32_16x16x32_bf16 a[64:67], v[104:107], a[192:195], a[64:67]
ds_read_b128 a[160:163], v216 offset:20480
v_cvt_pk_bf16_f32 v100, v32, v33
v_mfma_f32_16x16x32_bf16 a[68:71], v[108:111], a[192:195], a[68:71]
v_exp_f32 v34, v34
v_mfma_f32_16x16x32_bf16 a[68:71], v[76:79], a[228:231], a[68:71]
ds_read_b64_tr_b16 a[192:193], v224 offset:0
ds_read_b64_tr_b16 a[194:195], v224 offset:4096
v_mfma_f32_16x16x32_bf16 a[84:87], v[76:79], a[232:235], a[84:87]
v_exp_f32 v35, v35
v_mfma_f32_16x16x32_bf16 a[84:87], v[108:111], a[196:199], a[84:87]
s_lshl_b32 s28, s36, 9
s_add_u32 s28, s28, 0x248000
v_cvt_pk_bf16_f32 v101, v34, v35
v_mfma_f32_16x16x32_bf16 a[80:83], v[104:107], a[196:199], a[80:83]
v_exp_f32 v36, v36
v_mfma_f32_16x16x32_bf16 a[80:83], v[72:75], a[232:235], a[80:83]
ds_read_b64_tr_b16 a[196:197], v225 offset:0
ds_read_b64_tr_b16 a[198:199], v225 offset:4096
v_mfma_f32_16x16x32_bf16 a[96:99], v[72:75], a[236:239], a[96:99]
v_exp_f32 v37, v37
v_mfma_f32_16x16x32_bf16 a[96:99], v[104:107], a[200:203], a[96:99]
buffer_load_dword v242, v246, s[20:23], s28 offen sc1
v_cvt_pk_bf16_f32 v102, v36, v37
v_mfma_f32_16x16x32_bf16 a[100:103], v[108:111], a[200:203], a[100:103]
v_bfe_u32 v246, v1, 2, 2
v_exp_f32 v38, v38
v_mfma_f32_16x16x32_bf16 a[100:103], v[76:79], a[236:239], a[100:103]
ds_read_b64_tr_b16 a[200:201], v226 offset:0
ds_read_b64_tr_b16 a[202:203], v226 offset:4096
v_lshl_add_u32 v246, v4, 2, v246
v_mfma_f32_16x16x32_bf16 a[116:119], v[76:79], a[240:243], a[116:119]
v_mul_u32_u24 v246, 288, v246
v_exp_f32 v39, v39
v_mfma_f32_16x16x32_bf16 a[116:119], v[108:111], a[204:207], a[116:119]
v_cvt_pk_bf16_f32 v103, v38, v39
v_and_b32 v247, 3, v1
v_lshl_add_u32 v236, v247, 3, v246
v_mfma_f32_16x16x32_bf16 a[112:115], v[104:107], a[204:207], a[112:115]
ds_read_b64_tr_b16 a[204:205], v227 offset:0
ds_read_b64_tr_b16 a[206:207], v227 offset:4096
v_add_u32 v236, 256, v236
v_mfma_f32_16x16x32_bf16 a[112:115], v[72:75], a[240:243], a[112:115]
s_add_u32 m0, s88, 69120
s_lshl2_add_u32 s50, m0, s89
buffer_load_dwordx4 v243, s[56:59], s50 offen  lds
v_smfmac_f32_16x16x64_bf16 a[128:131], a[208:211], v[72:79], v245
v_lshl_add_u32 v246, v247, 4, v246
v_smfmac_f32_16x16x64_bf16 a[128:131], a[208:211], v[104:111], v245
s_lshr_b32 s28, s35, 4
s_lshl_b32 s28, s28, 6
s_waitcnt lgkmcnt(8)
v_mfma_f32_16x16x32_bf16 v[8:11], a[144:147], v[152:155], v[136:139]
v_add_u32 v234, s28, v246
v_exp_f32 v40, v40
v_mfma_f32_16x16x32_bf16 v[8:11], a[148:151], v[156:159], v[8:11]
s_xor_b32 s28, s28, 64
v_exp_f32 v41, v41
v_mfma_f32_16x16x32_bf16 v[8:11], a[152:155], v[160:163], v[8:11]
v_cvt_pk_bf16_f32 v104, v40, v41
v_add_u32 v235, s28, v246
v_mfma_f32_16x16x32_bf16 v[8:11], a[156:159], v[164:167], v[8:11]
v_exp_f32 v42, v42
v_mfma_f32_16x16x32_bf16 v[16:19], a[156:159], v[180:183], v[140:143]
s_add_u32 s39, s39, 16384
s_add_u32 s28, s35, 0
s_and_b32 s28, s28, 3
v_mfma_f32_16x16x32_bf16 v[16:19], a[152:155], v[176:179], v[16:19]
s_mul_i32 s28, s28, 36864
v_exp_f32 v43, v43
v_mfma_f32_16x16x32_bf16 v[16:19], a[148:151], v[172:175], v[16:19]
v_cvt_pk_bf16_f32 v105, v42, v43
v_add_u32 v237, s28, v234
v_add_u32 v238, s28, v235
v_mfma_f32_16x16x32_bf16 v[16:19], a[144:147], v[168:171], v[16:19]
v_add_u32 v239, s28, v236
v_exp_f32 v44, v44
v_mfma_f32_16x16x32_bf16 v[24:27], a[144:147], v[184:187], v[144:147]
v_mov_b32 v254, 0x7ffffff0
v_mfma_f32_16x16x32_bf16 v[24:27], a[148:151], v[188:191], v[24:27]
s_lshl2_add_u32 s92, s36, s37
v_exp_f32 v45, v45
v_mfma_f32_16x16x32_bf16 v[24:27], a[152:155], v[192:195], v[24:27]
s_add_u32 m0, s30, 147456
s_bfe_u32 s93, s35, 0x20002
v_cvt_pk_bf16_f32 v106, v44, v45
v_mfma_f32_16x16x32_bf16 v[24:27], a[156:159], v[196:199], v[24:27]
s_lshl2_add_u32 s92, s92, s93
v_exp_f32 v46, v46
v_mfma_f32_16x16x32_bf16 v[32:35], a[156:159], v[212:215], v[148:151]
ds_read_b128 a[156:159], v219 offset:24576
s_lshl_b32 s93, s92, 4
v_mfma_f32_16x16x32_bf16 v[32:35], a[152:155], v[208:211], v[32:35]
v_add_u32 v132, s93, v3
v_exp_f32 v47, v47
v_mfma_f32_16x16x32_bf16 v[32:35], a[148:151], v[204:207], v[32:35]
ds_read_b128 a[152:155], v218 offset:24576
v_cvt_pk_bf16_f32 v107, v46, v47
v_writelane_b32 v254, 0, 0
v_mfma_f32_16x16x32_bf16 v[32:35], a[144:147], v[200:203], v[32:35]
s_and_b32 s93, s35, 3
v_exp_f32 v48, v48
v_mfma_f32_16x16x32_bf16 a[8:11], v[96:99], a[176:179], a[8:11]
ds_read_b128 a[148:151], v217 offset:24576
ds_read_b128 a[144:147], v216 offset:24576
s_mul_i32 s93, s93, 144
v_mfma_f32_16x16x32_bf16 a[8:11], v[80:83], a[212:215], a[8:11]
v_lshlrev_b32 v251, 2, v4
v_exp_f32 v49, v49
v_mfma_f32_16x16x32_bf16 a[12:15], v[84:87], a[212:215], a[12:15]
ds_read_b64_tr_b16 a[212:213], v220 offset:8192
v_cvt_pk_bf16_f32 v108, v48, v49
v_add_u32 v251, s93, v251
v_mfma_f32_16x16x32_bf16 a[12:15], v[100:103], a[176:179], a[12:15]
v_add_u32 v251, 128, v251
v_exp_f32 v50, v50
v_mfma_f32_16x16x32_bf16 a[28:31], v[100:103], a[180:183], a[28:31]
ds_read_b64_tr_b16 a[214:215], v220 offset:12288
v_lshlrev_b32 v250, 3, v4
v_mfma_f32_16x16x32_bf16 a[28:31], v[84:87], a[216:219], a[28:31]
s_lshr_b32 s90, s35, 4
v_exp_f32 v51, v51
v_mfma_f32_16x16x32_bf16 a[24:27], v[80:83], a[216:219], a[24:27]
ds_read_b64_tr_b16 a[216:217], v221 offset:8192
s_lshl_b32 s90, s90, 5
v_cvt_pk_bf16_f32 v109, v50, v51
v_mfma_f32_16x16x32_bf16 a[24:27], v[96:99], a[180:183], a[24:27]
s_add_u32 s93, s93, s90
v_exp_f32 v52, v52
v_mfma_f32_16x16x32_bf16 a[40:43], v[96:99], a[184:187], a[40:43]
ds_read_b64_tr_b16 a[218:219], v221 offset:12288
v_add_u32 v250, s93, v250
v_lshlrev_b32 v250, 1, v250
v_mfma_f32_16x16x32_bf16 a[40:43], v[80:83], a[220:223], a[40:43]
v_lshlrev_b32 v251, 1, v251
v_exp_f32 v53, v53
v_mfma_f32_16x16x32_bf16 a[44:47], v[84:87], a[220:223], a[44:47]
ds_read_b64_tr_b16 a[220:221], v222 offset:8192
v_cvt_pk_bf16_f32 v110, v52, v53
v_mul_u32_u24 v133, 0x480, v132
v_mfma_f32_16x16x32_bf16 a[44:47], v[100:103], a[184:187], a[44:47]
v_add_u32 v248, v133, v250
v_exp_f32 v54, v54
v_mfma_f32_16x16x32_bf16 a[60:63], v[100:103], a[188:191], a[60:63]
ds_read_b64_tr_b16 a[222:223], v222 offset:12288
v_add_u32 v249, v133, v251
v_mov_b32 v135, 0x7fffbff0
v_mfma_f32_16x16x32_bf16 a[60:63], v[84:87], a[224:227], a[60:63]
v_exp_f32 v55, v55
v_mfma_f32_16x16x32_bf16 a[56:59], v[80:83], a[224:227], a[56:59]
ds_read_b64_tr_b16 a[224:225], v223 offset:8192
v_cvt_pk_bf16_f32 v111, v54, v55
v_mfma_f32_16x16x32_bf16 a[56:59], v[96:99], a[188:191], a[56:59]
v_exp_f32 v56, v56
v_mfma_f32_16x16x32_bf16 v[12:15], a[160:163], v[152:155], v[136:139]
v_exp_f32 v57, v57
v_mfma_f32_16x16x32_bf16 v[12:15], a[164:167], v[156:159], v[12:15]
ds_read_b64_tr_b16 a[226:227], v223 offset:12288
v_cvt_pk_bf16_f32 v112, v56, v57
v_mfma_f32_16x16x32_bf16 v[12:15], a[168:171], v[160:163], v[12:15]
v_exp_f32 v58, v58
v_mfma_f32_16x16x32_bf16 v[12:15], a[172:175], v[164:167], v[12:15]
buffer_load_dwordx4 v232, s[12:15], s39 offen offset:0  lds
v_mfma_f32_16x16x32_bf16 v[20:23], a[172:175], v[180:183], v[140:143]
v_exp_f32 v59, v59
v_mfma_f32_16x16x32_bf16 v[20:23], a[168:171], v[176:179], v[20:23]
v_cvt_pk_bf16_f32 v113, v58, v59
v_mfma_f32_16x16x32_bf16 v[20:23], a[164:167], v[172:175], v[20:23]
v_exp_f32 v60, v60
v_mfma_f32_16x16x32_bf16 v[20:23], a[160:163], v[168:171], v[20:23]
buffer_load_dwordx4 v233, s[12:15], s39 offen offset:1024  lds
v_mfma_f32_16x16x32_bf16 v[28:31], a[160:163], v[184:187], v[144:147]
v_exp_f32 v61, v61
v_mfma_f32_16x16x32_bf16 v[28:31], a[164:167], v[188:191], v[28:31]
buffer_load_dwordx4 a[244:247], v248, s[52:55], 0 offen offset:0
v_cvt_pk_bf16_f32 v114, v60, v61
v_mfma_f32_16x16x32_bf16 v[28:31], a[168:171], v[192:195], v[28:31]
v_exp_f32 v62, v62
v_mfma_f32_16x16x32_bf16 v[28:31], a[172:175], v[196:199], v[28:31]
buffer_load_dwordx4 v232, s[12:15], s39 offen offset:2048  lds
v_mfma_f32_16x16x32_bf16 v[36:39], a[172:175], v[212:215], v[148:151]
v_exp_f32 v63, v63
v_mfma_f32_16x16x32_bf16 v[36:39], a[168:171], v[208:211], v[36:39]
ds_read_b128 a[172:175], v219 offset:28672
v_cvt_pk_bf16_f32 v115, v62, v63
v_mfma_f32_16x16x32_bf16 v[36:39], a[164:167], v[204:207], v[36:39]
v_exp_f32 v64, v64
v_mfma_f32_16x16x32_bf16 v[36:39], a[160:163], v[200:203], v[36:39]
ds_read_b128 a[168:171], v218 offset:28672
ds_read_b128 a[164:167], v217 offset:28672
s_waitcnt lgkmcnt(8)
v_mfma_f32_16x16x32_bf16 a[72:75], v[96:99], a[192:195], a[72:75]
v_exp_f32 v65, v65
v_mfma_f32_16x16x32_bf16 a[72:75], v[80:83], a[228:231], a[72:75]
ds_read_b128 a[160:163], v216 offset:28672
v_cvt_pk_bf16_f32 v116, v64, v65
v_mfma_f32_16x16x32_bf16 a[76:79], v[84:87], a[228:231], a[76:79]
v_exp_f32 v66, v66
v_mfma_f32_16x16x32_bf16 a[76:79], v[100:103], a[192:195], a[76:79]
ds_read_b64_tr_b16 a[228:229], v224 offset:8192
ds_read_b64_tr_b16 a[230:231], v224 offset:12288
v_mfma_f32_16x16x32_bf16 a[92:95], v[100:103], a[196:199], a[92:95]
v_exp_f32 v67, v67
v_mfma_f32_16x16x32_bf16 a[92:95], v[84:87], a[232:235], a[92:95]
buffer_load_dwordx4 a[248:251], v248, s[52:55], 0 offen offset:128
v_cvt_pk_bf16_f32 v117, v66, v67
v_mfma_f32_16x16x32_bf16 a[88:91], v[80:83], a[232:235], a[88:91]
v_exp_f32 v68, v68
v_mfma_f32_16x16x32_bf16 a[88:91], v[96:99], a[196:199], a[88:91]
ds_read_b64_tr_b16 a[232:233], v225 offset:8192
ds_read_b64_tr_b16 a[234:235], v225 offset:12288
v_mfma_f32_16x16x32_bf16 a[104:107], v[96:99], a[200:203], a[104:107]
v_exp_f32 v69, v69
v_mfma_f32_16x16x32_bf16 a[104:107], v[80:83], a[236:239], a[104:107]
v_cvt_pk_bf16_f32 v118, v68, v69
v_mfma_f32_16x16x32_bf16 a[108:111], v[84:87], a[236:239], a[108:111]
v_exp_f32 v70, v70
v_mfma_f32_16x16x32_bf16 a[108:111], v[100:103], a[200:203], a[108:111]
ds_read_b64_tr_b16 a[236:237], v226 offset:8192
ds_read_b64_tr_b16 a[238:239], v226 offset:12288
v_mfma_f32_16x16x32_bf16 a[124:127], v[100:103], a[204:207], a[124:127]
v_exp_f32 v71, v71
v_mfma_f32_16x16x32_bf16 a[124:127], v[84:87], a[240:243], a[124:127]
v_cvt_pk_bf16_f32 v119, v70, v71
v_mfma_f32_16x16x32_bf16 a[120:123], v[80:83], a[240:243], a[120:123]
ds_read_b64_tr_b16 a[240:241], v227 offset:8192
ds_read_b64_tr_b16 a[242:243], v227 offset:12288
v_mfma_f32_16x16x32_bf16 a[120:123], v[96:99], a[204:207], a[120:123]
buffer_load_dwordx4 v233, s[12:15], s39 offen offset:3072  lds
v_smfmac_f32_16x16x64_bf16 a[132:135], a[208:211], v[96:103], v245
s_add_u32 m0, s88, 72576
s_lshl2_add_u32 s50, m0, s89
buffer_load_dwordx4 v243, s[56:59], s50 offen  lds
v_smfmac_f32_16x16x64_bf16 a[132:135], a[208:211], v[80:87], v245
s_add_u32 m0, s88, 76032
s_lshl2_add_u32 s50, m0, s89
buffer_load_dwordx4 v243, s[56:59], s50 offen  lds
v_mfma_f32_16x16x32_bf16 v[40:43], a[144:147], v[152:155], v[136:139]
v_exp_f32 v8, v8
v_mfma_f32_16x16x32_bf16 v[40:43], a[148:151], v[156:159], v[40:43]
v_exp_f32 v9, v9
v_mfma_f32_16x16x32_bf16 v[40:43], a[152:155], v[160:163], v[40:43]
v_cvt_pk_bf16_f32 v72, v8, v9
v_mfma_f32_16x16x32_bf16 v[40:43], a[156:159], v[164:167], v[40:43]
v_exp_f32 v10, v10
v_mfma_f32_16x16x32_bf16 v[48:51], a[156:159], v[180:183], v[140:143]
v_mfma_f32_16x16x32_bf16 v[48:51], a[152:155], v[176:179], v[48:51]
v_exp_f32 v11, v11
v_mfma_f32_16x16x32_bf16 v[48:51], a[148:151], v[172:175], v[48:51]
v_cvt_pk_bf16_f32 v73, v10, v11
v_mfma_f32_16x16x32_bf16 v[48:51], a[144:147], v[168:171], v[48:51]
v_exp_f32 v12, v12
v_mfma_f32_16x16x32_bf16 v[56:59], a[144:147], v[184:187], v[144:147]
v_mfma_f32_16x16x32_bf16 v[56:59], a[148:151], v[188:191], v[56:59]
v_exp_f32 v13, v13
v_mfma_f32_16x16x32_bf16 v[56:59], a[152:155], v[192:195], v[56:59]
v_cvt_pk_bf16_f32 v74, v12, v13
v_mfma_f32_16x16x32_bf16 v[56:59], a[156:159], v[196:199], v[56:59]
v_exp_f32 v14, v14
v_mfma_f32_16x16x32_bf16 v[64:67], a[156:159], v[212:215], v[148:151]
s_waitcnt vmcnt(13) lgkmcnt(0)
s_barrier
v_mfma_f32_16x16x32_bf16 v[64:67], a[152:155], v[208:211], v[64:67]
v_exp_f32 v15, v15
v_mfma_f32_16x16x32_bf16 v[64:67], a[148:151], v[204:207], v[64:67]
ds_read_b128 a[156:159], v219 offset:49152
v_cvt_pk_bf16_f32 v75, v14, v15
v_mfma_f32_16x16x32_bf16 v[64:67], a[144:147], v[200:203], v[64:67]
v_exp_f32 v16, v16
v_mfma_f32_16x16x32_bf16 a[0:3], v[104:107], a[212:215], a[0:3]
ds_read_b128 a[152:155], v218 offset:49152
ds_read_b128 a[148:151], v217 offset:49152
v_mfma_f32_16x16x32_bf16 a[0:3], v[88:91], a[176:179], a[0:3]
v_exp_f32 v17, v17
v_mfma_f32_16x16x32_bf16 a[4:7], v[92:95], a[176:179], a[4:7]
ds_read_b128 a[144:147], v216 offset:49152
v_cvt_pk_bf16_f32 v76, v16, v17
v_mfma_f32_16x16x32_bf16 a[4:7], v[108:111], a[212:215], a[4:7]
v_exp_f32 v18, v18
v_mfma_f32_16x16x32_bf16 a[20:23], v[108:111], a[216:219], a[20:23]
ds_read_b64_tr_b16 a[176:177], v220 offset:32768
ds_read_b64_tr_b16 a[178:179], v220 offset:36864
v_mfma_f32_16x16x32_bf16 a[20:23], v[92:95], a[180:183], a[20:23]
v_exp_f32 v19, v19
v_mfma_f32_16x16x32_bf16 a[16:19], v[88:91], a[180:183], a[16:19]
ds_read_b64_tr_b16 a[180:181], v221 offset:32768
v_cvt_pk_bf16_f32 v77, v18, v19
v_mfma_f32_16x16x32_bf16 a[16:19], v[104:107], a[216:219], a[16:19]
v_exp_f32 v20, v20
v_mfma_f32_16x16x32_bf16 a[32:35], v[104:107], a[220:223], a[32:35]
ds_read_b64_tr_b16 a[182:183], v221 offset:36864
buffer_load_dwordx2 a[252:253], v249, s[52:55], 0 offen
v_mfma_f32_16x16x32_bf16 a[32:35], v[88:91], a[184:187], a[32:35]
v_exp_f32 v21, v21
v_mfma_f32_16x16x32_bf16 a[36:39], v[92:95], a[184:187], a[36:39]
ds_read_b64_tr_b16 a[184:185], v222 offset:32768
v_cvt_pk_bf16_f32 v78, v20, v21
v_mfma_f32_16x16x32_bf16 a[36:39], v[108:111], a[220:223], a[36:39]
v_exp_f32 v22, v22
v_mfma_f32_16x16x32_bf16 a[52:55], v[108:111], a[224:227], a[52:55]
ds_read_b64_tr_b16 a[186:187], v222 offset:36864
v_mfma_f32_16x16x32_bf16 a[52:55], v[92:95], a[188:191], a[52:55]
v_exp_f32 v23, v23
v_mfma_f32_16x16x32_bf16 a[48:51], v[88:91], a[188:191], a[48:51]
ds_read_b64_tr_b16 a[188:189], v223 offset:32768
v_cvt_pk_bf16_f32 v79, v22, v23
v_mfma_f32_16x16x32_bf16 a[48:51], v[104:107], a[224:227], a[48:51]
v_exp_f32 v24, v24
v_mfma_f32_16x16x32_bf16 v[44:47], a[160:163], v[152:155], v[136:139]
v_exp_f32 v25, v25
v_mfma_f32_16x16x32_bf16 v[44:47], a[164:167], v[156:159], v[44:47]
ds_read_b64_tr_b16 a[190:191], v223 offset:36864
v_cvt_pk_bf16_f32 v80, v24, v25
v_mfma_f32_16x16x32_bf16 v[44:47], a[168:171], v[160:163], v[44:47]
v_exp_f32 v26, v26
v_mfma_f32_16x16x32_bf16 v[44:47], a[172:175], v[164:167], v[44:47]
s_add_u32 m0, s88, 79488
s_lshl2_add_u32 s50, m0, s89
buffer_load_dwordx4 v243, s[56:59], s50 offen  lds
v_mfma_f32_16x16x32_bf16 v[52:55], a[172:175], v[180:183], v[140:143]
v_exp_f32 v27, v27
v_mfma_f32_16x16x32_bf16 v[52:55], a[168:171], v[176:179], v[52:55]
v_cvt_pk_bf16_f32 v81, v26, v27
v_mfma_f32_16x16x32_bf16 v[52:55], a[164:167], v[172:175], v[52:55]
v_exp_f32 v28, v28
v_mfma_f32_16x16x32_bf16 v[52:55], a[160:163], v[168:171], v[52:55]
s_add_u32 m0, s88, 82944
s_lshl2_add_u32 s50, m0, s89
buffer_load_dwordx4 v243, s[56:59], s50 offen  lds
v_mfma_f32_16x16x32_bf16 v[60:63], a[160:163], v[184:187], v[144:147]
v_exp_f32 v29, v29
v_mfma_f32_16x16x32_bf16 v[60:63], a[164:167], v[188:191], v[60:63]
v_cvt_pk_bf16_f32 v82, v28, v29
v_mfma_f32_16x16x32_bf16 v[60:63], a[168:171], v[192:195], v[60:63]
v_exp_f32 v30, v30
v_mfma_f32_16x16x32_bf16 v[60:63], a[172:175], v[196:199], v[60:63]
s_add_u32 m0, s88, 86400
s_lshl2_add_u32 s50, m0, s89
buffer_load_dwordx4 v243, s[56:59], s50 offen  lds
v_mfma_f32_16x16x32_bf16 v[68:71], a[172:175], v[212:215], v[148:151]
v_exp_f32 v31, v31
v_mfma_f32_16x16x32_bf16 v[68:71], a[168:171], v[208:211], v[68:71]
ds_read_b128 a[172:175], v219 offset:53248
v_cvt_pk_bf16_f32 v83, v30, v31
v_mfma_f32_16x16x32_bf16 v[68:71], a[164:167], v[204:207], v[68:71]
v_exp_f32 v32, v32
v_mfma_f32_16x16x32_bf16 v[68:71], a[160:163], v[200:203], v[68:71]
ds_read_b128 a[168:171], v218 offset:53248
ds_read_b128 a[164:167], v217 offset:53248
v_mfma_f32_16x16x32_bf16 a[64:67], v[104:107], a[228:231], a[64:67]
v_exp_f32 v33, v33
v_mfma_f32_16x16x32_bf16 a[64:67], v[88:91], a[192:195], a[64:67]
ds_read_b128 a[160:163], v216 offset:53248
v_cvt_pk_bf16_f32 v84, v32, v33
v_mfma_f32_16x16x32_bf16 a[68:71], v[92:95], a[192:195], a[68:71]
v_exp_f32 v34, v34
v_mfma_f32_16x16x32_bf16 a[68:71], v[108:111], a[228:231], a[68:71]
ds_read_b64_tr_b16 a[192:193], v224 offset:32768
ds_read_b64_tr_b16 a[194:195], v224 offset:36864
v_mfma_f32_16x16x32_bf16 a[84:87], v[108:111], a[232:235], a[84:87]
v_exp_f32 v35, v35
v_mfma_f32_16x16x32_bf16 a[84:87], v[92:95], a[196:199], a[84:87]
v_cvt_pk_bf16_f32 v85, v34, v35
v_mfma_f32_16x16x32_bf16 a[80:83], v[88:91], a[196:199], a[80:83]
v_exp_f32 v36, v36
v_mfma_f32_16x16x32_bf16 a[80:83], v[104:107], a[232:235], a[80:83]
ds_read_b64_tr_b16 a[196:197], v225 offset:32768
ds_read_b64_tr_b16 a[198:199], v225 offset:36864
v_mfma_f32_16x16x32_bf16 a[96:99], v[104:107], a[236:239], a[96:99]
v_exp_f32 v37, v37
v_mfma_f32_16x16x32_bf16 a[96:99], v[88:91], a[200:203], a[96:99]
v_cvt_pk_bf16_f32 v86, v36, v37
v_mfma_f32_16x16x32_bf16 a[100:103], v[92:95], a[200:203], a[100:103]
v_exp_f32 v38, v38
v_mfma_f32_16x16x32_bf16 a[100:103], v[108:111], a[236:239], a[100:103]
ds_read_b64_tr_b16 a[200:201], v226 offset:32768
ds_read_b64_tr_b16 a[202:203], v226 offset:36864
v_mfma_f32_16x16x32_bf16 a[116:119], v[108:111], a[240:243], a[116:119]
v_exp_f32 v39, v39
v_mfma_f32_16x16x32_bf16 a[116:119], v[92:95], a[204:207], a[116:119]
v_cvt_pk_bf16_f32 v87, v38, v39
v_mfma_f32_16x16x32_bf16 a[112:115], v[88:91], a[204:207], a[112:115]
ds_read_b64_tr_b16 a[204:205], v227 offset:32768
ds_read_b64_tr_b16 a[206:207], v227 offset:36864
v_mfma_f32_16x16x32_bf16 a[112:115], v[104:107], a[240:243], a[112:115]
s_add_u32 m0, s88, 89856
s_lshl2_add_u32 s50, m0, s89
buffer_load_dwordx4 v243, s[56:59], s50 offen  lds
v_smfmac_f32_16x16x64_bf16 a[128:131], a[208:211], v[104:111], v245
s_add_u32 m0, s88, 93312
s_lshl2_add_u32 s50, m0, s89
buffer_load_dwordx4 v243, s[56:59], s50 offen  lds
v_smfmac_f32_16x16x64_bf16 a[128:131], a[208:211], v[88:95], v245
s_waitcnt vmcnt(16)
v_cmp_ne_u32 vcc, s47, v121
s_cbranch_vccnz SP_FK
SP_FK_RET:
s_waitcnt lgkmcnt(8)
v_mfma_f32_16x16x32_bf16 v[8:11], a[144:147], v[152:155], v[136:139]
v_exp_f32 v40, v40
v_mfma_f32_16x16x32_bf16 v[8:11], a[148:151], v[156:159], v[8:11]
v_exp_f32 v41, v41
v_mfma_f32_16x16x32_bf16 v[8:11], a[152:155], v[160:163], v[8:11]
v_cvt_pk_bf16_f32 v88, v40, v41
v_mfma_f32_16x16x32_bf16 v[8:11], a[156:159], v[164:167], v[8:11]
v_exp_f32 v42, v42
v_mfma_f32_16x16x32_bf16 v[16:19], a[156:159], v[180:183], v[140:143]
s_add_u32 m0, s88, 96768
s_lshl2_add_u32 s50, m0, s89
buffer_load_dwordx4 v243, s[56:59], s50 offen  lds
v_mfma_f32_16x16x32_bf16 v[16:19], a[152:155], v[176:179], v[16:19]
v_exp_f32 v43, v43
v_mfma_f32_16x16x32_bf16 v[16:19], a[148:151], v[172:175], v[16:19]
v_cvt_pk_bf16_f32 v89, v42, v43
v_mfma_f32_16x16x32_bf16 v[16:19], a[144:147], v[168:171], v[16:19]
v_exp_f32 v44, v44
v_mfma_f32_16x16x32_bf16 v[24:27], a[144:147], v[184:187], v[144:147]
s_mov_b32 s93, 0x243080
buffer_load_dword v246, v254, s[20:23], s93 offen sc0 sc1
v_mfma_f32_16x16x32_bf16 v[24:27], a[148:151], v[188:191], v[24:27]
s_mov_b32 s92, 0x1c00000
v_exp_f32 v45, v45
v_mfma_f32_16x16x32_bf16 v[24:27], a[152:155], v[192:195], v[24:27]
v_cvt_pk_bf16_f32 v90, v44, v45
v_mfma_f32_16x16x32_bf16 v[24:27], a[156:159], v[196:199], v[24:27]
v_exp_f32 v46, v46
v_mfma_f32_16x16x32_bf16 v[32:35], a[156:159], v[212:215], v[148:151]
ds_read_b128 a[156:159], v219 offset:57344
v_mfma_f32_16x16x32_bf16 v[32:35], a[152:155], v[208:211], v[32:35]
v_exp_f32 v47, v47
v_mfma_f32_16x16x32_bf16 v[32:35], a[148:151], v[204:207], v[32:35]
ds_read_b128 a[152:155], v218 offset:57344
v_cvt_pk_bf16_f32 v91, v46, v47
v_mfma_f32_16x16x32_bf16 v[32:35], a[144:147], v[200:203], v[32:35]
v_exp_f32 v48, v48
v_mfma_f32_16x16x32_bf16 a[8:11], v[80:83], a[176:179], a[8:11]
ds_read_b128 a[148:151], v217 offset:57344
ds_read_b128 a[144:147], v216 offset:57344
v_mfma_f32_16x16x32_bf16 a[8:11], v[112:115], a[212:215], a[8:11]
v_exp_f32 v49, v49
v_mfma_f32_16x16x32_bf16 a[12:15], v[116:119], a[212:215], a[12:15]
ds_read_b64_tr_b16 a[212:213], v220 offset:40960
v_cvt_pk_bf16_f32 v92, v48, v49
v_mfma_f32_16x16x32_bf16 a[12:15], v[84:87], a[176:179], a[12:15]
v_exp_f32 v50, v50
v_mfma_f32_16x16x32_bf16 a[28:31], v[84:87], a[180:183], a[28:31]
ds_read_b64_tr_b16 a[214:215], v220 offset:45056
buffer_load_dwordx4 a[136:139], v248, s[20:23], s92 offen offset:0 sc0 sc1
v_mfma_f32_16x16x32_bf16 a[28:31], v[116:119], a[216:219], a[28:31]
v_exp_f32 v51, v51
v_mfma_f32_16x16x32_bf16 a[24:27], v[112:115], a[216:219], a[24:27]
ds_read_b64_tr_b16 a[216:217], v221 offset:40960
v_cvt_pk_bf16_f32 v93, v50, v51
v_mfma_f32_16x16x32_bf16 a[24:27], v[80:83], a[180:183], a[24:27]
v_exp_f32 v52, v52
v_mfma_f32_16x16x32_bf16 a[40:43], v[80:83], a[184:187], a[40:43]
ds_read_b64_tr_b16 a[218:219], v221 offset:45056
v_mfma_f32_16x16x32_bf16 a[40:43], v[112:115], a[220:223], a[40:43]
v_exp_f32 v53, v53
v_mfma_f32_16x16x32_bf16 a[44:47], v[116:119], a[220:223], a[44:47]
ds_read_b64_tr_b16 a[220:221], v222 offset:40960
v_cvt_pk_bf16_f32 v94, v52, v53
v_mfma_f32_16x16x32_bf16 a[44:47], v[84:87], a[184:187], a[44:47]
v_exp_f32 v54, v54
v_mfma_f32_16x16x32_bf16 a[60:63], v[84:87], a[188:191], a[60:63]
ds_read_b64_tr_b16 a[222:223], v222 offset:45056
v_mfma_f32_16x16x32_bf16 a[60:63], v[116:119], a[224:227], a[60:63]
v_exp_f32 v55, v55
v_mfma_f32_16x16x32_bf16 a[56:59], v[112:115], a[224:227], a[56:59]
ds_read_b64_tr_b16 a[224:225], v223 offset:40960
v_cvt_pk_bf16_f32 v95, v54, v55
v_mfma_f32_16x16x32_bf16 a[56:59], v[80:83], a[188:191], a[56:59]
v_exp_f32 v56, v56
v_mfma_f32_16x16x32_bf16 v[12:15], a[160:163], v[152:155], v[136:139]
v_exp_f32 v57, v57
v_mfma_f32_16x16x32_bf16 v[12:15], a[164:167], v[156:159], v[12:15]
ds_read_b64_tr_b16 a[226:227], v223 offset:45056
v_cvt_pk_bf16_f32 v96, v56, v57
v_mfma_f32_16x16x32_bf16 v[12:15], a[168:171], v[160:163], v[12:15]
v_exp_f32 v58, v58
v_mfma_f32_16x16x32_bf16 v[12:15], a[172:175], v[164:167], v[12:15]
s_add_u32 m0, s88, 100224
s_lshl2_add_u32 s50, m0, s89
buffer_load_dwordx4 v243, s[56:59], s50 offen  lds
v_mfma_f32_16x16x32_bf16 v[20:23], a[172:175], v[180:183], v[140:143]
v_exp_f32 v59, v59
v_mfma_f32_16x16x32_bf16 v[20:23], a[168:171], v[176:179], v[20:23]
buffer_load_dwordx4 a[140:143], v248, s[20:23], s92 offen offset:128 sc0 sc1
v_cvt_pk_bf16_f32 v97, v58, v59
v_mfma_f32_16x16x32_bf16 v[20:23], a[164:167], v[172:175], v[20:23]
v_exp_f32 v60, v60
v_mfma_f32_16x16x32_bf16 v[20:23], a[160:163], v[168:171], v[20:23]
s_add_u32 m0, s88, 103680
s_lshl2_add_u32 s50, m0, s89
buffer_load_dwordx4 v243, s[56:59], s50 offen  lds
v_mfma_f32_16x16x32_bf16 v[28:31], a[160:163], v[184:187], v[144:147]
v_exp_f32 v61, v61
v_mfma_f32_16x16x32_bf16 v[28:31], a[164:167], v[188:191], v[28:31]
v_cvt_pk_bf16_f32 v98, v60, v61
v_mfma_f32_16x16x32_bf16 v[28:31], a[168:171], v[192:195], v[28:31]
v_exp_f32 v62, v62
v_mfma_f32_16x16x32_bf16 v[28:31], a[172:175], v[196:199], v[28:31]
s_add_u32 m0, s88, 107136
s_lshl2_add_u32 s50, m0, s89
buffer_load_dwordx4 v243, s[56:59], s50 offen  lds
v_mfma_f32_16x16x32_bf16 v[36:39], a[172:175], v[212:215], v[148:151]
v_exp_f32 v63, v63
v_mfma_f32_16x16x32_bf16 v[36:39], a[168:171], v[208:211], v[36:39]
ds_read_b128 a[172:175], v219 offset:61440
STUB_12:
s_cbranch_execz HOP_RET1
v_cvt_pk_bf16_f32 v99, v62, v63
v_mfma_f32_16x16x32_bf16 v[36:39], a[164:167], v[204:207], v[36:39]
v_exp_f32 v64, v64
v_mfma_f32_16x16x32_bf16 v[36:39], a[160:163], v[200:203], v[36:39]
ds_read_b128 a[168:171], v218 offset:61440
ds_read_b128 a[164:167], v217 offset:61440
s_waitcnt lgkmcnt(8)
v_mfma_f32_16x16x32_bf16 a[72:75], v[80:83], a[192:195], a[72:75]
v_exp_f32 v65, v65
v_mfma_f32_16x16x32_bf16 a[72:75], v[112:115], a[228:231], a[72:75]
ds_read_b128 a[160:163], v216 offset:61440
v_cvt_pk_bf16_f32 v100, v64, v65
v_mfma_f32_16x16x32_bf16 a[76:79], v[116:119], a[228:231], a[76:79]
v_exp_f32 v66, v66
v_mfma_f32_16x16x32_bf16 a[76:79], v[84:87], a[192:195], a[76:79]
ds_read_b64_tr_b16 a[228:229], v224 offset:40960
ds_read_b64_tr_b16 a[230:231], v224 offset:45056
v_mfma_f32_16x16x32_bf16 a[92:95], v[84:87], a[196:199], a[92:95]
v_exp_f32 v67, v67
v_mfma_f32_16x16x32_bf16 a[92:95], v[116:119], a[232:235], a[92:95]
buffer_load_dwordx2 a[254:255], v249, s[20:23], s92 offen sc0 sc1
v_cvt_pk_bf16_f32 v101, v66, v67
v_mfma_f32_16x16x32_bf16 a[88:91], v[112:115], a[232:235], a[88:91]
v_sub_u32 v133, 0xffff, v132
v_exp_f32 v68, v68
v_mfma_f32_16x16x32_bf16 a[88:91], v[80:83], a[196:199], a[88:91]
ds_read_b64_tr_b16 a[232:233], v225 offset:40960
ds_read_b64_tr_b16 a[234:235], v225 offset:45056
v_and_b32 v120, 0xffff, v120
v_mfma_f32_16x16x32_bf16 a[104:107], v[80:83], a[200:203], a[104:107]
v_readlane_b32 s93, v120, 0
v_exp_f32 v69, v69
v_mfma_f32_16x16x32_bf16 a[104:107], v[112:115], a[236:239], a[104:107]
v_cvt_pk_bf16_f32 v102, v68, v69
v_mfma_f32_16x16x32_bf16 a[108:111], v[116:119], a[236:239], a[108:111]
v_cmp_eq_u32 s[90:91], s93, v133
v_exp_f32 v70, v70
v_mfma_f32_16x16x32_bf16 a[108:111], v[84:87], a[200:203], a[108:111]
ds_read_b64_tr_b16 a[236:237], v226 offset:40960
ds_read_b64_tr_b16 a[238:239], v226 offset:45056
v_mov_b32 v134, 0
v_mfma_f32_16x16x32_bf16 a[124:127], v[84:87], a[204:207], a[124:127]
v_cndmask_b32 v135, v135, v134, s[90:91]
v_exp_f32 v71, v71
v_mfma_f32_16x16x32_bf16 a[124:127], v[116:119], a[240:243], a[124:127]
v_cvt_pk_bf16_f32 v103, v70, v71
v_readlane_b32 s93, v120, 1
v_mfma_f32_16x16x32_bf16 a[120:123], v[112:115], a[240:243], a[120:123]
ds_read_b64_tr_b16 a[240:241], v227 offset:40960
ds_read_b64_tr_b16 a[242:243], v227 offset:45056
v_mfma_f32_16x16x32_bf16 a[120:123], v[80:83], a[204:207], a[120:123]
s_add_u32 m0, s88, 110592
s_lshl2_add_u32 s50, m0, s89
buffer_load_dwordx4 v243, s[56:59], s50 offen  lds
v_smfmac_f32_16x16x64_bf16 a[132:135], a[208:211], v[80:87], v245
v_cmp_eq_u32 s[90:91], s93, v133
v_mov_b32 v134, 1152
v_smfmac_f32_16x16x64_bf16 a[132:135], a[208:211], v[112:119], v245
v_cndmask_b32 v135, v135, v134, s[90:91]
v_mfma_f32_16x16x32_bf16 v[40:43], a[144:147], v[152:155], v[136:139]
v_readlane_b32 s93, v120, 2
v_exp_f32 v8, v8
v_mfma_f32_16x16x32_bf16 v[40:43], a[148:151], v[156:159], v[40:43]
v_exp_f32 v9, v9
v_mfma_f32_16x16x32_bf16 v[40:43], a[152:155], v[160:163], v[40:43]
v_cvt_pk_bf16_f32 v104, v8, v9
v_cmp_eq_u32 s[90:91], s93, v133
v_mov_b32 v134, 2304
v_mfma_f32_16x16x32_bf16 v[40:43], a[156:159], v[164:167], v[40:43]
v_cndmask_b32 v135, v135, v134, s[90:91]
v_exp_f32 v10, v10
v_mfma_f32_16x16x32_bf16 v[48:51], a[156:159], v[180:183], v[140:143]
v_readlane_b32 s93, v120, 3
v_mfma_f32_16x16x32_bf16 v[48:51], a[152:155], v[176:179], v[48:51]
v_exp_f32 v11, v11
v_mfma_f32_16x16x32_bf16 v[48:51], a[148:151], v[172:175], v[48:51]
v_cvt_pk_bf16_f32 v105, v10, v11
v_cmp_eq_u32 s[90:91], s93, v133
v_mov_b32 v134, 3456
v_mfma_f32_16x16x32_bf16 v[48:51], a[144:147], v[168:171], v[48:51]
v_cndmask_b32 v135, v135, v134, s[90:91]
v_exp_f32 v12, v12
v_mfma_f32_16x16x32_bf16 v[56:59], a[144:147], v[184:187], v[144:147]
v_readlane_b32 s93, v120, 4
v_mfma_f32_16x16x32_bf16 v[56:59], a[148:151], v[188:191], v[56:59]
v_exp_f32 v13, v13
v_mfma_f32_16x16x32_bf16 v[56:59], a[152:155], v[192:195], v[56:59]
v_cvt_pk_bf16_f32 v106, v12, v13
v_cmp_eq_u32 s[90:91], s93, v133
v_mov_b32 v134, 4608
v_mfma_f32_16x16x32_bf16 v[56:59], a[156:159], v[196:199], v[56:59]
v_cndmask_b32 v135, v135, v134, s[90:91]
v_exp_f32 v14, v14
v_mfma_f32_16x16x32_bf16 v[64:67], a[156:159], v[212:215], v[148:151]
s_waitcnt vmcnt(15) lgkmcnt(0)
s_barrier
v_readlane_b32 s93, v120, 5
v_mfma_f32_16x16x32_bf16 v[64:67], a[152:155], v[208:211], v[64:67]
v_exp_f32 v15, v15
v_mfma_f32_16x16x32_bf16 v[64:67], a[148:151], v[204:207], v[64:67]
v_cvt_pk_bf16_f32 v107, v14, v15
v_cmp_eq_u32 s[90:91], s93, v133
v_mov_b32 v134, 5760
v_mfma_f32_16x16x32_bf16 v[64:67], a[144:147], v[200:203], v[64:67]
v_cndmask_b32 v135, v135, v134, s[90:91]
v_exp_f32 v16, v16
v_mfma_f32_16x16x32_bf16 a[0:3], v[88:91], a[212:215], a[0:3]
s_add_u32 m0, s88, 114048
s_lshl2_add_u32 s50, m0, s89
buffer_load_dwordx4 v243, s[56:59], s50 offen  lds
v_mfma_f32_16x16x32_bf16 a[0:3], v[72:75], a[176:179], a[0:3]
v_readlane_b32 s93, v120, 6
v_exp_f32 v17, v17
v_mfma_f32_16x16x32_bf16 a[4:7], v[76:79], a[176:179], a[4:7]
ds_read_b64_tr_b16 a[176:177], v220 offset:49152
v_cvt_pk_bf16_f32 v108, v16, v17
v_mfma_f32_16x16x32_bf16 a[4:7], v[92:95], a[212:215], a[4:7]
v_cmp_eq_u32 s[90:91], s93, v133
v_exp_f32 v18, v18
v_mfma_f32_16x16x32_bf16 a[20:23], v[92:95], a[216:219], a[20:23]
ds_read_b64_tr_b16 a[178:179], v220 offset:53248
v_mov_b32 v134, 6912
v_mfma_f32_16x16x32_bf16 a[20:23], v[76:79], a[180:183], a[20:23]
v_cndmask_b32 v135, v135, v134, s[90:91]
v_exp_f32 v19, v19
v_mfma_f32_16x16x32_bf16 a[16:19], v[72:75], a[180:183], a[16:19]
ds_read_b64_tr_b16 a[180:181], v221 offset:49152
v_cvt_pk_bf16_f32 v109, v18, v19
v_readlane_b32 s93, v120, 7
v_mfma_f32_16x16x32_bf16 a[16:19], v[88:91], a[216:219], a[16:19]
v_exp_f32 v20, v20
v_mfma_f32_16x16x32_bf16 a[32:35], v[88:91], a[220:223], a[32:35]
ds_read_b64_tr_b16 a[182:183], v221 offset:53248
v_cmp_eq_u32 s[90:91], s93, v133
v_mov_b32 v134, 8064
v_mfma_f32_16x16x32_bf16 a[32:35], v[72:75], a[184:187], a[32:35]
v_cndmask_b32 v135, v135, v134, s[90:91]
v_exp_f32 v21, v21
v_mfma_f32_16x16x32_bf16 a[36:39], v[76:79], a[184:187], a[36:39]
ds_read_b64_tr_b16 a[184:185], v222 offset:49152
v_cvt_pk_bf16_f32 v110, v20, v21
v_mfma_f32_16x16x32_bf16 a[36:39], v[92:95], a[220:223], a[36:39]
v_exp_f32 v22, v22
v_mfma_f32_16x16x32_bf16 a[52:55], v[92:95], a[224:227], a[52:55]
ds_read_b64_tr_b16 a[186:187], v222 offset:53248
v_add_u32 v250, v250, v135
v_mfma_f32_16x16x32_bf16 a[52:55], v[76:79], a[188:191], a[52:55]
v_exp_f32 v23, v23
v_mfma_f32_16x16x32_bf16 a[48:51], v[72:75], a[188:191], a[48:51]
ds_read_b64_tr_b16 a[188:189], v223 offset:49152
v_cvt_pk_bf16_f32 v111, v22, v23
v_mfma_f32_16x16x32_bf16 a[48:51], v[88:91], a[224:227], a[48:51]
v_exp_f32 v24, v24
v_mfma_f32_16x16x32_bf16 v[44:47], a[160:163], v[152:155], v[136:139]
v_exp_f32 v25, v25
v_mfma_f32_16x16x32_bf16 v[44:47], a[164:167], v[156:159], v[44:47]
ds_read_b64_tr_b16 a[190:191], v223 offset:53248
v_cvt_pk_bf16_f32 v112, v24, v25
v_mfma_f32_16x16x32_bf16 v[44:47], a[168:171], v[160:163], v[44:47]
v_add_u32 v251, v251, v135
v_exp_f32 v26, v26
v_mfma_f32_16x16x32_bf16 v[44:47], a[172:175], v[164:167], v[44:47]
s_add_u32 m0, s88, 117504
s_lshl2_add_u32 s50, m0, s89
buffer_load_dwordx4 v243, s[56:59], s50 offen  lds
v_mfma_f32_16x16x32_bf16 v[52:55], a[172:175], v[180:183], v[140:143]
v_exp_f32 v27, v27
v_mfma_f32_16x16x32_bf16 v[52:55], a[168:171], v[176:179], v[52:55]
v_cvt_pk_bf16_f32 v113, v26, v27
v_lshrrev_b32 v134, 14, v135
v_mfma_f32_16x16x32_bf16 v[52:55], a[164:167], v[172:175], v[52:55]
v_exp_f32 v28, v28
v_mfma_f32_16x16x32_bf16 v[52:55], a[160:163], v[168:171], v[52:55]
s_add_u32 m0, s88, 120960
s_lshl2_add_u32 s50, m0, s89
buffer_load_dwordx4 v243, s[56:59], s50 offen  lds
v_mfma_f32_16x16x32_bf16 v[60:63], a[160:163], v[184:187], v[144:147]
v_exp_f32 v29, v29
v_mfma_f32_16x16x32_bf16 v[60:63], a[164:167], v[188:191], v[60:63]
v_cvt_pk_bf16_f32 v114, v28, v29
v_cmp_eq_u32 s[90:91], 0, v134
v_mfma_f32_16x16x32_bf16 v[60:63], a[168:171], v[192:195], v[60:63]
v_exp_f32 v30, v30
v_mfma_f32_16x16x32_bf16 v[60:63], a[172:175], v[196:199], v[60:63]
s_add_u32 m0, s88, 124416
s_lshl2_add_u32 s50, m0, s89
buffer_load_dwordx4 v243, s[56:59], s50 offen  lds
v_mfma_f32_16x16x32_bf16 v[68:71], a[172:175], v[212:215], v[148:151]
v_exp_f32 v31, v31
v_mfma_f32_16x16x32_bf16 v[68:71], a[168:171], v[208:211], v[68:71]
v_cvt_pk_bf16_f32 v115, v30, v31
v_mfma_f32_16x16x32_bf16 v[68:71], a[164:167], v[204:207], v[68:71]
v_exp_f32 v32, v32
v_mfma_f32_16x16x32_bf16 v[68:71], a[160:163], v[200:203], v[68:71]
s_add_u32 m0, s88, 127872
s_lshl2_add_u32 s50, m0, s89
buffer_load_dwordx4 v243, s[56:59], s50 offen  lds
v_mfma_f32_16x16x32_bf16 a[64:67], v[88:91], a[228:231], a[64:67]
v_exp_f32 v33, v33
v_mfma_f32_16x16x32_bf16 a[64:67], v[72:75], a[192:195], a[64:67]
v_cvt_pk_bf16_f32 v116, v32, v33
s_waitcnt vmcnt(12)
v_readfirstlane_b32 s93, v246
v_mfma_f32_16x16x32_bf16 a[68:71], v[76:79], a[192:195], a[68:71]
v_exp_f32 v34, v34
v_mfma_f32_16x16x32_bf16 a[68:71], v[92:95], a[228:231], a[68:71]
ds_read_b64_tr_b16 a[192:193], v224 offset:49152
ds_read_b64_tr_b16 a[194:195], v224 offset:53248
v_mfma_f32_16x16x32_bf16 a[84:87], v[92:95], a[232:235], a[84:87]
v_exp_f32 v35, v35
v_mfma_f32_16x16x32_bf16 a[84:87], v[76:79], a[196:199], a[84:87]
v_cvt_pk_bf16_f32 v117, v34, v35
v_mfma_f32_16x16x32_bf16 a[80:83], v[72:75], a[196:199], a[80:83]
v_exp_f32 v36, v36
v_mfma_f32_16x16x32_bf16 a[80:83], v[88:91], a[232:235], a[80:83]
ds_read_b64_tr_b16 a[196:197], v225 offset:49152
ds_read_b64_tr_b16 a[198:199], v225 offset:53248
v_mfma_f32_16x16x32_bf16 a[96:99], v[88:91], a[236:239], a[96:99]
v_exp_f32 v37, v37
v_mfma_f32_16x16x32_bf16 a[96:99], v[72:75], a[200:203], a[96:99]
s_cmp_eq_u64 s[90:91], 0
s_cselect_b32 s93, 144, s93
v_cvt_pk_bf16_f32 v118, v36, v37
v_mfma_f32_16x16x32_bf16 a[100:103], v[76:79], a[200:203], a[100:103]
v_exp_f32 v38, v38
v_mfma_f32_16x16x32_bf16 a[100:103], v[92:95], a[236:239], a[100:103]
ds_read_b64_tr_b16 a[200:201], v226 offset:49152
ds_read_b64_tr_b16 a[202:203], v226 offset:53248
v_mfma_f32_16x16x32_bf16 a[116:119], v[92:95], a[240:243], a[116:119]
v_exp_f32 v39, v39
v_mfma_f32_16x16x32_bf16 a[116:119], v[76:79], a[204:207], a[116:119]
v_cvt_pk_bf16_f32 v119, v38, v39
v_mfma_f32_16x16x32_bf16 a[112:115], v[72:75], a[204:207], a[112:115]
ds_read_b64_tr_b16 a[204:205], v227 offset:49152
ds_read_b64_tr_b16 a[206:207], v227 offset:53248
v_mfma_f32_16x16x32_bf16 a[112:115], v[88:91], a[240:243], a[112:115]
s_add_u32 m0, s88, 131328
s_lshl2_add_u32 s50, m0, s89
buffer_load_dwordx4 v243, s[56:59], s50 offen  lds
v_smfmac_f32_16x16x64_bf16 a[128:131], a[208:211], v[88:95], v245
s_add_u32 m0, s88, 134784
s_lshl2_add_u32 s50, m0, s89
buffer_load_dwordx4 v243, s[56:59], s50 offen  lds
v_smfmac_f32_16x16x64_bf16 a[128:131], a[208:211], v[72:79], v245
s_cmp_lt_u32 s93, 144
s_cbranch_scc1 SP_Y
SP_Y_RET:
s_waitcnt lgkmcnt(8)
v_mfma_f32_16x16x32_bf16 a[0:3], v[104:107], a[176:179], a[0:3]
v_exp_f32 v40, v40
v_mfma_f32_16x16x32_bf16 a[4:7], v[108:111], a[176:179], a[4:7]
s_mov_b32 s93, 0x244000
v_exp_f32 v41, v41
v_mfma_f32_16x16x32_bf16 a[8:11], v[112:115], a[176:179], a[8:11]
v_cvt_pk_bf16_f32 v72, v40, v41
v_exp_f32 v42, v42
v_mfma_f32_16x16x32_bf16 a[8:11], v[96:99], a[212:215], a[8:11]
s_add_u32 m0, s88, 138240
s_lshl2_add_u32 s50, m0, s89
buffer_load_dwordx4 v243, s[56:59], s50 offen  lds
v_mfma_f32_16x16x32_bf16 a[12:15], v[100:103], a[212:215], a[12:15]
ds_read_b64_tr_b16 a[212:213], v220 offset:57344
v_exp_f32 v43, v43
v_mfma_f32_16x16x32_bf16 a[12:15], v[116:119], a[176:179], a[12:15]
v_cvt_pk_bf16_f32 v73, v42, v43
v_exp_f32 v44, v44
v_mfma_f32_16x16x32_bf16 a[28:31], v[116:119], a[180:183], a[28:31]
ds_read_b64_tr_b16 a[214:215], v220 offset:61440
buffer_load_dwordx4 a[144:147], v250, s[20:23], s93 offen offset:0 sc0 sc1
v_mfma_f32_16x16x32_bf16 a[28:31], v[100:103], a[216:219], a[28:31]
v_exp_f32 v45, v45
v_mfma_f32_16x16x32_bf16 a[24:27], v[96:99], a[216:219], a[24:27]
v_cvt_pk_bf16_f32 v74, v44, v45
v_exp_f32 v46, v46
v_mfma_f32_16x16x32_bf16 a[24:27], v[112:115], a[180:183], a[24:27]
ds_read_b64_tr_b16 a[216:217], v221 offset:57344
ds_read_b64_tr_b16 a[218:219], v221 offset:61440
v_mfma_f32_16x16x32_bf16 a[20:23], v[108:111], a[180:183], a[20:23]
v_exp_f32 v47, v47
v_mfma_f32_16x16x32_bf16 a[16:19], v[104:107], a[180:183], a[16:19]
v_cvt_pk_bf16_f32 v75, v46, v47
v_exp_f32 v48, v48
v_mfma_f32_16x16x32_bf16 a[32:35], v[104:107], a[184:187], a[32:35]
buffer_load_dwordx4 a[148:151], v250, s[20:23], s93 offen offset:128 sc0 sc1
v_mfma_f32_16x16x32_bf16 a[36:39], v[108:111], a[184:187], a[36:39]
v_exp_f32 v49, v49
v_mfma_f32_16x16x32_bf16 a[40:43], v[112:115], a[184:187], a[40:43]
v_cvt_pk_bf16_f32 v76, v48, v49
v_exp_f32 v50, v50
v_mfma_f32_16x16x32_bf16 a[40:43], v[96:99], a[220:223], a[40:43]
buffer_load_dwordx2 a[152:153], v251, s[20:23], s93 offen sc0 sc1
v_mfma_f32_16x16x32_bf16 a[44:47], v[100:103], a[220:223], a[44:47]
ds_read_b64_tr_b16 a[220:221], v222 offset:57344
v_exp_f32 v51, v51
v_mfma_f32_16x16x32_bf16 a[44:47], v[116:119], a[184:187], a[44:47]
v_cvt_pk_bf16_f32 v77, v50, v51
v_exp_f32 v52, v52
v_mfma_f32_16x16x32_bf16 a[60:63], v[116:119], a[188:191], a[60:63]
ds_read_b64_tr_b16 a[222:223], v222 offset:61440
v_mfma_f32_16x16x32_bf16 a[60:63], v[100:103], a[224:227], a[60:63]
v_exp_f32 v53, v53
v_mfma_f32_16x16x32_bf16 a[56:59], v[96:99], a[224:227], a[56:59]
v_cvt_pk_bf16_f32 v78, v52, v53
v_exp_f32 v54, v54
v_mfma_f32_16x16x32_bf16 a[56:59], v[112:115], a[188:191], a[56:59]
ds_read_b64_tr_b16 a[224:225], v223 offset:57344
ds_read_b64_tr_b16 a[226:227], v223 offset:61440
v_mfma_f32_16x16x32_bf16 a[52:55], v[108:111], a[188:191], a[52:55]
v_exp_f32 v55, v55
v_mfma_f32_16x16x32_bf16 a[48:51], v[104:107], a[188:191], a[48:51]
v_cvt_pk_bf16_f32 v79, v54, v55
v_exp_f32 v56, v56
s_waitcnt lgkmcnt(8)
v_mfma_f32_16x16x32_bf16 a[64:67], v[104:107], a[192:195], a[64:67]
v_exp_f32 v57, v57
v_mfma_f32_16x16x32_bf16 a[68:71], v[108:111], a[192:195], a[68:71]
v_cvt_pk_bf16_f32 v80, v56, v57
v_mfma_f32_16x16x32_bf16 a[72:75], v[112:115], a[192:195], a[72:75]
v_exp_f32 v58, v58
v_mfma_f32_16x16x32_bf16 a[72:75], v[96:99], a[228:231], a[72:75]
v_exp_f32 v59, v59
v_mfma_f32_16x16x32_bf16 a[76:79], v[100:103], a[228:231], a[76:79]
ds_read_b64_tr_b16 a[228:229], v224 offset:57344
ds_read_b64_tr_b16 a[230:231], v224 offset:61440
v_cvt_pk_bf16_f32 v81, v58, v59
v_mfma_f32_16x16x32_bf16 a[76:79], v[116:119], a[192:195], a[76:79]
v_exp_f32 v60, v60
v_mfma_f32_16x16x32_bf16 a[92:95], v[116:119], a[196:199], a[92:95]
v_exp_f32 v61, v61
v_mfma_f32_16x16x32_bf16 a[92:95], v[100:103], a[232:235], a[92:95]
v_cvt_pk_bf16_f32 v82, v60, v61
v_mfma_f32_16x16x32_bf16 a[88:91], v[96:99], a[232:235], a[88:91]
ds_read_b64_tr_b16 a[232:233], v225 offset:57344
v_exp_f32 v62, v62
v_mfma_f32_16x16x32_bf16 a[88:91], v[112:115], a[196:199], a[88:91]
ds_read_b64_tr_b16 a[234:235], v225 offset:61440
v_exp_f32 v63, v63
v_mfma_f32_16x16x32_bf16 a[84:87], v[108:111], a[196:199], a[84:87]
v_cvt_pk_bf16_f32 v83, v62, v63
v_mfma_f32_16x16x32_bf16 a[80:83], v[104:107], a[196:199], a[80:83]
v_exp_f32 v64, v64
v_mfma_f32_16x16x32_bf16 a[96:99], v[104:107], a[200:203], a[96:99]
v_exp_f32 v65, v65
v_mfma_f32_16x16x32_bf16 a[100:103], v[108:111], a[200:203], a[100:103]
v_cvt_pk_bf16_f32 v84, v64, v65
v_mfma_f32_16x16x32_bf16 a[104:107], v[112:115], a[200:203], a[104:107]
v_exp_f32 v66, v66
v_mfma_f32_16x16x32_bf16 a[104:107], v[96:99], a[236:239], a[104:107]
v_exp_f32 v67, v67
v_mfma_f32_16x16x32_bf16 a[108:111], v[100:103], a[236:239], a[108:111]
ds_read_b64_tr_b16 a[236:237], v226 offset:57344
ds_read_b64_tr_b16 a[238:239], v226 offset:61440
v_cvt_pk_bf16_f32 v85, v66, v67
v_mfma_f32_16x16x32_bf16 a[108:111], v[116:119], a[200:203], a[108:111]
v_exp_f32 v68, v68
v_mfma_f32_16x16x32_bf16 a[124:127], v[116:119], a[204:207], a[124:127]
v_exp_f32 v69, v69
v_mfma_f32_16x16x32_bf16 a[124:127], v[100:103], a[240:243], a[124:127]
v_cvt_pk_bf16_f32 v86, v68, v69
v_mfma_f32_16x16x32_bf16 a[120:123], v[96:99], a[240:243], a[120:123]
ds_read_b64_tr_b16 a[240:241], v227 offset:57344
v_exp_f32 v70, v70
v_mfma_f32_16x16x32_bf16 a[120:123], v[112:115], a[204:207], a[120:123]
ds_read_b64_tr_b16 a[242:243], v227 offset:61440
v_exp_f32 v71, v71
v_mfma_f32_16x16x32_bf16 a[116:119], v[108:111], a[204:207], a[116:119]
v_cvt_pk_bf16_f32 v87, v70, v71
v_mfma_f32_16x16x32_bf16 a[112:115], v[104:107], a[204:207], a[112:115]
s_add_u32 m0, s88, 141696
s_lshl2_add_u32 s50, m0, s89
buffer_load_dwordx4 v243, s[56:59], s50 offen  lds
v_smfmac_f32_16x16x64_bf16 a[128:131], a[208:211], v[104:111], v245
s_add_u32 m0, s88, 145152
s_min_u32 m0, m0, 146880
s_lshl2_add_u32 s50, m0, s89
s_cmp_ge_u32 s37, 2
s_cselect_b32 exec_hi, 15, -1
buffer_load_dwordx4 v243, s[56:59], s50 offen  lds
s_mov_b32 exec_hi, -1
v_smfmac_f32_16x16x64_bf16 a[132:135], a[208:211], v[112:119], v245
v_smfmac_f32_16x16x64_bf16 a[132:135], a[208:211], v[96:103], v245
K_TAIL:
s_cmp_eq_u32 s48, 0
s_cbranch_scc1 K_MIXED
s_waitcnt lgkmcnt(0)
s_barrier
s_add_u32 s28, s30, 147456
v_smfmac_f32_16x16x64_bf16 a[128:131], a[208:211], v[72:79], v245
v_lshrrev_b32 v132, 1, v1
v_and_b32 v132, 8, v132
v_smfmac_f32_16x16x64_bf16 a[132:135], a[208:211], v[80:87], v245
v_xor_b32 v132, v132, v1
v_lshlrev_b32 v132, 4, v132
v_mfma_f32_16x16x32_bf16 a[0:3], v[72:75], a[212:215], a[0:3]
v_add_u32 v132, s28, v132
v_lshlrev_b32 v133, 3, v1
v_mfma_f32_16x16x32_bf16 a[16:19], v[72:75], a[216:219], a[16:19]
v_and_b32 v133, 8, v133
v_lshrrev_b32 v134, 2, v1
v_mfma_f32_16x16x32_bf16 a[32:35], v[72:75], a[220:223], a[32:35]
v_xor_b32 v133, v133, v134
v_and_b32 v134, 3, v1
v_mfma_f32_16x16x32_bf16 a[48:51], v[72:75], a[224:227], a[48:51]
v_lshl_add_u32 v133, v134, 4, v133
v_lshlrev_b32 v133, 4, v133
v_mfma_f32_16x16x32_bf16 a[64:67], v[72:75], a[228:231], a[64:67]
v_add_u32 v133, s28, v133
v_lshlrev_b32 v134, 2, v1
v_mfma_f32_16x16x32_bf16 a[80:83], v[72:75], a[232:235], a[80:83]
v_add_u32 v134, s28, v134
v_lshlrev_b32 v135, 4, v4
v_mfma_f32_16x16x32_bf16 a[96:99], v[72:75], a[236:239], a[96:99]
v_add_u32 v135, s28, v135
v_mfma_f32_16x16x32_bf16 a[112:115], v[72:75], a[240:243], a[112:115]
v_mfma_f32_16x16x32_bf16 a[4:7], v[76:79], a[212:215], a[4:7]
v_accvgpr_read_b32 v120, a128
v_accvgpr_read_b32 v124, a129
v_accvgpr_read_b32 v121, a130
v_mfma_f32_16x16x32_bf16 a[20:23], v[76:79], a[216:219], a[20:23]
v_accvgpr_read_b32 v125, a131
v_accvgpr_read_b32 v122, a132
v_accvgpr_read_b32 v126, a133
v_mfma_f32_16x16x32_bf16 a[36:39], v[76:79], a[220:223], a[36:39]
v_accvgpr_read_b32 v123, a134
v_accvgpr_read_b32 v127, a135
v_add_f32 v120, v120, v124
v_mfma_f32_16x16x32_bf16 a[52:55], v[76:79], a[224:227], a[52:55]
v_add_f32 v121, v121, v125
v_add_f32 v122, v122, v126
v_add_f32 v123, v123, v127
v_mfma_f32_16x16x32_bf16 a[68:71], v[76:79], a[228:231], a[68:71]
v_rcp_f32 v124, v120
v_rcp_f32 v125, v121
v_rcp_f32 v126, v122
v_mfma_f32_16x16x32_bf16 a[84:87], v[76:79], a[232:235], a[84:87]
v_rcp_f32 v127, v123
ds_write_b32 v134, v124 offset:0
ds_write_b32 v134, v125 offset:256
v_mfma_f32_16x16x32_bf16 a[100:103], v[76:79], a[236:239], a[100:103]
ds_write_b32 v134, v126 offset:512
ds_write_b32 v134, v127 offset:768
ds_read_b128 v[88:91], v135 offset:0
v_mfma_f32_16x16x32_bf16 a[116:119], v[76:79], a[240:243], a[116:119]
ds_read_b128 v[92:95], v135 offset:256
ds_read_b128 v[96:99], v135 offset:512
ds_read_b128 v[100:103], v135 offset:768
s_add_u32 s92, s44, 4096
s_add_u32 s93, s44, 8192
s_add_u32 s51, s44, 12288
v_mfma_f32_16x16x32_bf16 a[8:11], v[80:83], a[212:215], a[8:11]
v_accvgpr_read_b32 v104, a0
v_accvgpr_read_b32 v105, a1
v_accvgpr_read_b32 v106, a2
v_accvgpr_read_b32 v107, a3
v_mfma_f32_16x16x32_bf16 a[24:27], v[80:83], a[216:219], a[24:27]
v_accvgpr_read_b32 v108, a16
v_accvgpr_read_b32 v109, a17
v_accvgpr_read_b32 v110, a18
v_accvgpr_read_b32 v111, a19
s_waitcnt lgkmcnt(0)
v_pk_mul_f32 v[104:105], v[104:105], v[88:89]
v_pk_mul_f32 v[106:107], v[106:107], v[90:91]
v_pk_mul_f32 v[108:109], v[108:109], v[88:89]
v_pk_mul_f32 v[110:111], v[110:111], v[90:91]
v_cvt_pk_bf16_f32 v104, v104, v105
v_cvt_pk_bf16_f32 v105, v106, v107
v_cvt_pk_bf16_f32 v106, v108, v109
v_cvt_pk_bf16_f32 v107, v110, v111
v_mfma_f32_16x16x32_bf16 a[40:43], v[80:83], a[220:223], a[40:43]
v_accvgpr_read_b32 v112, a32
v_accvgpr_read_b32 v113, a33
v_accvgpr_read_b32 v114, a34
v_accvgpr_read_b32 v115, a35
ds_write_b128 v132, v[104:107] offset:0
v_mfma_f32_16x16x32_bf16 a[56:59], v[80:83], a[224:227], a[56:59]
v_accvgpr_read_b32 v116, a48
v_accvgpr_read_b32 v117, a49
v_accvgpr_read_b32 v118, a50
v_accvgpr_read_b32 v119, a51
ds_read_b64_tr_b16 v[8:9], v133 offset:0
ds_read_b64_tr_b16 v[10:11], v133 offset:8
v_pk_mul_f32 v[112:113], v[112:113], v[88:89]
v_pk_mul_f32 v[114:115], v[114:115], v[90:91]
v_pk_mul_f32 v[116:117], v[116:117], v[88:89]
v_pk_mul_f32 v[118:119], v[118:119], v[90:91]
v_cvt_pk_bf16_f32 v112, v112, v113
v_cvt_pk_bf16_f32 v113, v114, v115
v_cvt_pk_bf16_f32 v114, v116, v117
v_cvt_pk_bf16_f32 v115, v118, v119
v_mfma_f32_16x16x32_bf16 a[72:75], v[80:83], a[228:231], a[72:75]
v_accvgpr_read_b32 v104, a64
v_accvgpr_read_b32 v105, a65
v_accvgpr_read_b32 v106, a66
v_accvgpr_read_b32 v107, a67
ds_write_b128 v132, v[112:115] offset:1024
v_mfma_f32_16x16x32_bf16 a[88:91], v[80:83], a[232:235], a[88:91]
v_accvgpr_read_b32 v108, a80
v_accvgpr_read_b32 v109, a81
v_accvgpr_read_b32 v110, a82
v_accvgpr_read_b32 v111, a83
ds_read_b64_tr_b16 v[12:13], v133 offset:1024
ds_read_b64_tr_b16 v[14:15], v133 offset:1032
v_pk_mul_f32 v[104:105], v[104:105], v[88:89]
v_pk_mul_f32 v[106:107], v[106:107], v[90:91]
v_pk_mul_f32 v[108:109], v[108:109], v[88:89]
v_pk_mul_f32 v[110:111], v[110:111], v[90:91]
s_waitcnt lgkmcnt(3)
buffer_store_dwordx4 v[8:11], v244, s[20:23], s44 offen offset:0
v_cvt_pk_bf16_f32 v104, v104, v105
v_cvt_pk_bf16_f32 v105, v106, v107
v_cvt_pk_bf16_f32 v106, v108, v109
v_cvt_pk_bf16_f32 v107, v110, v111
v_mfma_f32_16x16x32_bf16 a[104:107], v[80:83], a[236:239], a[104:107]
v_accvgpr_read_b32 v112, a96
v_accvgpr_read_b32 v113, a97
v_accvgpr_read_b32 v114, a98
v_accvgpr_read_b32 v115, a99
ds_write_b128 v132, v[104:107] offset:2048
v_mfma_f32_16x16x32_bf16 a[120:123], v[80:83], a[240:243], a[120:123]
v_accvgpr_read_b32 v116, a112
v_accvgpr_read_b32 v117, a113
v_accvgpr_read_b32 v118, a114
v_accvgpr_read_b32 v119, a115
ds_read_b64_tr_b16 v[16:17], v133 offset:2048
ds_read_b64_tr_b16 v[18:19], v133 offset:2056
v_pk_mul_f32 v[112:113], v[112:113], v[88:89]
v_pk_mul_f32 v[114:115], v[114:115], v[90:91]
v_pk_mul_f32 v[116:117], v[116:117], v[88:89]
v_pk_mul_f32 v[118:119], v[118:119], v[90:91]
s_waitcnt lgkmcnt(3)
buffer_store_dwordx4 v[12:15], v244, s[20:23], s44 offen offset:1024
v_cvt_pk_bf16_f32 v112, v112, v113
v_cvt_pk_bf16_f32 v113, v114, v115
v_cvt_pk_bf16_f32 v114, v116, v117
v_cvt_pk_bf16_f32 v115, v118, v119
v_mfma_f32_16x16x32_bf16 a[12:15], v[84:87], a[212:215], a[12:15]
v_accvgpr_read_b32 v104, a4
v_accvgpr_read_b32 v105, a5
v_accvgpr_read_b32 v106, a6
v_accvgpr_read_b32 v107, a7
ds_write_b128 v132, v[112:115] offset:3072
v_mfma_f32_16x16x32_bf16 a[28:31], v[84:87], a[216:219], a[28:31]
v_accvgpr_read_b32 v108, a20
v_accvgpr_read_b32 v109, a21
v_accvgpr_read_b32 v110, a22
v_accvgpr_read_b32 v111, a23
ds_read_b64_tr_b16 v[20:21], v133 offset:3072
ds_read_b64_tr_b16 v[22:23], v133 offset:3080
v_pk_mul_f32 v[104:105], v[104:105], v[92:93]
v_pk_mul_f32 v[106:107], v[106:107], v[94:95]
v_pk_mul_f32 v[108:109], v[108:109], v[92:93]
v_pk_mul_f32 v[110:111], v[110:111], v[94:95]
s_waitcnt lgkmcnt(3)
buffer_store_dwordx4 v[16:19], v244, s[20:23], s44 offen offset:2048
v_cvt_pk_bf16_f32 v104, v104, v105
v_cvt_pk_bf16_f32 v105, v106, v107
v_cvt_pk_bf16_f32 v106, v108, v109
v_cvt_pk_bf16_f32 v107, v110, v111
v_mfma_f32_16x16x32_bf16 a[44:47], v[84:87], a[220:223], a[44:47]
v_accvgpr_read_b32 v112, a36
v_accvgpr_read_b32 v113, a37
v_accvgpr_read_b32 v114, a38
v_accvgpr_read_b32 v115, a39
ds_write_b128 v132, v[104:107] offset:0
v_mfma_f32_16x16x32_bf16 a[60:63], v[84:87], a[224:227], a[60:63]
v_accvgpr_read_b32 v116, a52
v_accvgpr_read_b32 v117, a53
v_accvgpr_read_b32 v118, a54
v_accvgpr_read_b32 v119, a55
ds_read_b64_tr_b16 v[24:25], v133 offset:0
ds_read_b64_tr_b16 v[26:27], v133 offset:8
v_pk_mul_f32 v[112:113], v[112:113], v[92:93]
v_pk_mul_f32 v[114:115], v[114:115], v[94:95]
v_pk_mul_f32 v[116:117], v[116:117], v[92:93]
v_pk_mul_f32 v[118:119], v[118:119], v[94:95]
s_waitcnt lgkmcnt(3)
buffer_store_dwordx4 v[20:23], v244, s[20:23], s44 offen offset:3072
v_cvt_pk_bf16_f32 v112, v112, v113
v_cvt_pk_bf16_f32 v113, v114, v115
STUB_13:
STUB_B1:
s_cbranch_execz STUB_16
v_cvt_pk_bf16_f32 v114, v116, v117
v_cvt_pk_bf16_f32 v115, v118, v119
v_mfma_f32_16x16x32_bf16 a[76:79], v[84:87], a[228:231], a[76:79]
v_accvgpr_read_b32 v104, a68
v_accvgpr_read_b32 v105, a69
v_accvgpr_read_b32 v106, a70
v_accvgpr_read_b32 v107, a71
ds_write_b128 v132, v[112:115] offset:1024
v_mfma_f32_16x16x32_bf16 a[92:95], v[84:87], a[232:235], a[92:95]
v_accvgpr_read_b32 v108, a84
v_accvgpr_read_b32 v109, a85
v_accvgpr_read_b32 v110, a86
v_accvgpr_read_b32 v111, a87
ds_read_b64_tr_b16 v[28:29], v133 offset:1024
ds_read_b64_tr_b16 v[30:31], v133 offset:1032
v_pk_mul_f32 v[104:105], v[104:105], v[92:93]
v_pk_mul_f32 v[106:107], v[106:107], v[94:95]
v_pk_mul_f32 v[108:109], v[108:109], v[92:93]
v_pk_mul_f32 v[110:111], v[110:111], v[94:95]
s_waitcnt lgkmcnt(3)
buffer_store_dwordx4 v[24:27], v244, s[20:23], s92 offen offset:0
v_cvt_pk_bf16_f32 v104, v104, v105
v_cvt_pk_bf16_f32 v105, v106, v107
v_cvt_pk_bf16_f32 v106, v108, v109
v_cvt_pk_bf16_f32 v107, v110, v111
v_mfma_f32_16x16x32_bf16 a[108:111], v[84:87], a[236:239], a[108:111]
v_accvgpr_read_b32 v112, a100
v_accvgpr_read_b32 v113, a101
v_accvgpr_read_b32 v114, a102
v_accvgpr_read_b32 v115, a103
ds_write_b128 v132, v[104:107] offset:2048
v_mfma_f32_16x16x32_bf16 a[124:127], v[84:87], a[240:243], a[124:127]
v_accvgpr_read_b32 v116, a116
v_accvgpr_read_b32 v117, a117
v_accvgpr_read_b32 v118, a118
v_accvgpr_read_b32 v119, a119
ds_read_b64_tr_b16 v[32:33], v133 offset:2048
ds_read_b64_tr_b16 v[34:35], v133 offset:2056
v_pk_mul_f32 v[112:113], v[112:113], v[92:93]
v_pk_mul_f32 v[114:115], v[114:115], v[94:95]
v_pk_mul_f32 v[116:117], v[116:117], v[92:93]
v_pk_mul_f32 v[118:119], v[118:119], v[94:95]
s_waitcnt lgkmcnt(3)
buffer_store_dwordx4 v[28:31], v244, s[20:23], s92 offen offset:1024
v_cvt_pk_bf16_f32 v112, v112, v113
v_cvt_pk_bf16_f32 v113, v114, v115
v_cvt_pk_bf16_f32 v114, v116, v117
v_cvt_pk_bf16_f32 v115, v118, v119
v_accvgpr_read_b32 v104, a8
v_accvgpr_read_b32 v105, a9
v_accvgpr_read_b32 v106, a10
v_accvgpr_read_b32 v107, a11
ds_write_b128 v132, v[112:115] offset:3072
v_accvgpr_read_b32 v108, a24
v_accvgpr_read_b32 v109, a25
v_accvgpr_read_b32 v110, a26
v_accvgpr_read_b32 v111, a27
ds_read_b64_tr_b16 v[36:37], v133 offset:3072
ds_read_b64_tr_b16 v[38:39], v133 offset:3080
v_pk_mul_f32 v[104:105], v[104:105], v[96:97]
v_pk_mul_f32 v[106:107], v[106:107], v[98:99]
v_pk_mul_f32 v[108:109], v[108:109], v[96:97]
v_pk_mul_f32 v[110:111], v[110:111], v[98:99]
s_waitcnt lgkmcnt(3)
buffer_store_dwordx4 v[32:35], v244, s[20:23], s92 offen offset:2048
v_cvt_pk_bf16_f32 v104, v104, v105
v_cvt_pk_bf16_f32 v105, v106, v107
v_cvt_pk_bf16_f32 v106, v108, v109
v_cvt_pk_bf16_f32 v107, v110, v111
v_accvgpr_read_b32 v112, a40
v_accvgpr_read_b32 v113, a41
v_accvgpr_read_b32 v114, a42
v_accvgpr_read_b32 v115, a43
ds_write_b128 v132, v[104:107] offset:0
v_accvgpr_read_b32 v116, a56
v_accvgpr_read_b32 v117, a57
v_accvgpr_read_b32 v118, a58
v_accvgpr_read_b32 v119, a59
ds_read_b64_tr_b16 v[40:41], v133 offset:0
ds_read_b64_tr_b16 v[42:43], v133 offset:8
v_pk_mul_f32 v[112:113], v[112:113], v[96:97]
v_pk_mul_f32 v[114:115], v[114:115], v[98:99]
v_pk_mul_f32 v[116:117], v[116:117], v[96:97]
v_pk_mul_f32 v[118:119], v[118:119], v[98:99]
s_waitcnt lgkmcnt(3)
buffer_store_dwordx4 v[36:39], v244, s[20:23], s92 offen offset:3072
v_cvt_pk_bf16_f32 v112, v112, v113
v_cvt_pk_bf16_f32 v113, v114, v115
v_cvt_pk_bf16_f32 v114, v116, v117
v_cvt_pk_bf16_f32 v115, v118, v119
v_accvgpr_read_b32 v104, a72
v_accvgpr_read_b32 v105, a73
v_accvgpr_read_b32 v106, a74
v_accvgpr_read_b32 v107, a75
ds_write_b128 v132, v[112:115] offset:1024
v_accvgpr_read_b32 v108, a88
v_accvgpr_read_b32 v109, a89
v_accvgpr_read_b32 v110, a90
v_accvgpr_read_b32 v111, a91
ds_read_b64_tr_b16 v[44:45], v133 offset:1024
ds_read_b64_tr_b16 v[46:47], v133 offset:1032
v_pk_mul_f32 v[104:105], v[104:105], v[96:97]
v_pk_mul_f32 v[106:107], v[106:107], v[98:99]
v_pk_mul_f32 v[108:109], v[108:109], v[96:97]
v_pk_mul_f32 v[110:111], v[110:111], v[98:99]
s_waitcnt lgkmcnt(3)
buffer_store_dwordx4 v[40:43], v244, s[20:23], s93 offen offset:0
v_cvt_pk_bf16_f32 v104, v104, v105
v_cvt_pk_bf16_f32 v105, v106, v107
v_cvt_pk_bf16_f32 v106, v108, v109
v_cvt_pk_bf16_f32 v107, v110, v111
v_accvgpr_read_b32 v112, a104
v_accvgpr_read_b32 v113, a105
v_accvgpr_read_b32 v114, a106
v_accvgpr_read_b32 v115, a107
ds_write_b128 v132, v[104:107] offset:2048
v_accvgpr_read_b32 v116, a120
v_accvgpr_read_b32 v117, a121
v_accvgpr_read_b32 v118, a122
v_accvgpr_read_b32 v119, a123
ds_read_b64_tr_b16 v[48:49], v133 offset:2048
ds_read_b64_tr_b16 v[50:51], v133 offset:2056
v_pk_mul_f32 v[112:113], v[112:113], v[96:97]
v_pk_mul_f32 v[114:115], v[114:115], v[98:99]
v_pk_mul_f32 v[116:117], v[116:117], v[96:97]
v_pk_mul_f32 v[118:119], v[118:119], v[98:99]
s_waitcnt lgkmcnt(3)
buffer_store_dwordx4 v[44:47], v244, s[20:23], s93 offen offset:1024
v_cvt_pk_bf16_f32 v112, v112, v113
v_cvt_pk_bf16_f32 v113, v114, v115
v_cvt_pk_bf16_f32 v114, v116, v117
v_cvt_pk_bf16_f32 v115, v118, v119
v_accvgpr_read_b32 v104, a12
v_accvgpr_read_b32 v105, a13
v_accvgpr_read_b32 v106, a14
v_accvgpr_read_b32 v107, a15
ds_write_b128 v132, v[112:115] offset:3072
v_accvgpr_read_b32 v108, a28
v_accvgpr_read_b32 v109, a29
v_accvgpr_read_b32 v110, a30
v_accvgpr_read_b32 v111, a31
ds_read_b64_tr_b16 v[52:53], v133 offset:3072
ds_read_b64_tr_b16 v[54:55], v133 offset:3080
v_pk_mul_f32 v[104:105], v[104:105], v[100:101]
v_pk_mul_f32 v[106:107], v[106:107], v[102:103]
v_pk_mul_f32 v[108:109], v[108:109], v[100:101]
v_pk_mul_f32 v[110:111], v[110:111], v[102:103]
s_waitcnt lgkmcnt(3)
buffer_store_dwordx4 v[48:51], v244, s[20:23], s93 offen offset:2048
v_cvt_pk_bf16_f32 v104, v104, v105
v_cvt_pk_bf16_f32 v105, v106, v107
v_cvt_pk_bf16_f32 v106, v108, v109
v_cvt_pk_bf16_f32 v107, v110, v111
v_accvgpr_read_b32 v112, a44
v_accvgpr_read_b32 v113, a45
v_accvgpr_read_b32 v114, a46
v_accvgpr_read_b32 v115, a47
ds_write_b128 v132, v[104:107] offset:0
v_accvgpr_read_b32 v116, a60
v_accvgpr_read_b32 v117, a61
v_accvgpr_read_b32 v118, a62
v_accvgpr_read_b32 v119, a63
ds_read_b64_tr_b16 v[56:57], v133 offset:0
ds_read_b64_tr_b16 v[58:59], v133 offset:8
v_pk_mul_f32 v[112:113], v[112:113], v[100:101]
v_pk_mul_f32 v[114:115], v[114:115], v[102:103]
v_pk_mul_f32 v[116:117], v[116:117], v[100:101]
v_pk_mul_f32 v[118:119], v[118:119], v[102:103]
s_waitcnt lgkmcnt(3)
buffer_store_dwordx4 v[52:55], v244, s[20:23], s93 offen offset:3072
v_cvt_pk_bf16_f32 v112, v112, v113
v_cvt_pk_bf16_f32 v113, v114, v115
v_cvt_pk_bf16_f32 v114, v116, v117
v_cvt_pk_bf16_f32 v115, v118, v119
v_accvgpr_read_b32 v104, a76
v_accvgpr_read_b32 v105, a77
v_accvgpr_read_b32 v106, a78
v_accvgpr_read_b32 v107, a79
ds_write_b128 v132, v[112:115] offset:1024
v_accvgpr_read_b32 v108, a92
v_accvgpr_read_b32 v109, a93
v_accvgpr_read_b32 v110, a94
v_accvgpr_read_b32 v111, a95
ds_read_b64_tr_b16 v[60:61], v133 offset:1024
ds_read_b64_tr_b16 v[62:63], v133 offset:1032
v_pk_mul_f32 v[104:105], v[104:105], v[100:101]
v_pk_mul_f32 v[106:107], v[106:107], v[102:103]
v_pk_mul_f32 v[108:109], v[108:109], v[100:101]
v_pk_mul_f32 v[110:111], v[110:111], v[102:103]
s_waitcnt lgkmcnt(3)
buffer_store_dwordx4 v[56:59], v244, s[20:23], s51 offen offset:0
v_cvt_pk_bf16_f32 v104, v104, v105
v_cvt_pk_bf16_f32 v105, v106, v107
v_cvt_pk_bf16_f32 v106, v108, v109
v_cvt_pk_bf16_f32 v107, v110, v111
v_accvgpr_read_b32 v112, a108
v_accvgpr_read_b32 v113, a109
v_accvgpr_read_b32 v114, a110
v_accvgpr_read_b32 v115, a111
ds_write_b128 v132, v[104:107] offset:2048
v_accvgpr_read_b32 v116, a124
v_accvgpr_read_b32 v117, a125
v_accvgpr_read_b32 v118, a126
v_accvgpr_read_b32 v119, a127
ds_read_b64_tr_b16 v[64:65], v133 offset:2048
ds_read_b64_tr_b16 v[66:67], v133 offset:2056
v_pk_mul_f32 v[112:113], v[112:113], v[100:101]
v_pk_mul_f32 v[114:115], v[114:115], v[102:103]
v_pk_mul_f32 v[116:117], v[116:117], v[100:101]
v_pk_mul_f32 v[118:119], v[118:119], v[102:103]
s_waitcnt lgkmcnt(3)
buffer_store_dwordx4 v[60:63], v244, s[20:23], s51 offen offset:1024
v_cvt_pk_bf16_f32 v112, v112, v113
v_cvt_pk_bf16_f32 v113, v114, v115
v_cvt_pk_bf16_f32 v114, v116, v117
v_cvt_pk_bf16_f32 v115, v118, v119
ds_write_b128 v132, v[112:115] offset:3072
ds_read_b64_tr_b16 v[68:69], v133 offset:3072
ds_read_b64_tr_b16 v[70:71], v133 offset:3080
s_waitcnt lgkmcnt(3)
buffer_store_dwordx4 v[64:67], v244, s[20:23], s51 offen offset:2048
v_max3_f32 v104, v120, v121, v122
v_max_f32 v104, v104, v123
v_add_f32 v105, v120, v121
v_add_f32 v105, v105, v122
v_add_f32 v105, v105, v123
v_cmp_nge_f32 vcc, s42, v104
v_cmp_u_f32 s[28:29], v105, v105
s_or_b64 vcc, vcc, s[28:29]
s_cmp_lg_u64 vcc, 0
s_cselect_b32 s28, 1, 0
v_mov_b32 v104, s28
v_mov_b32 v106, 147456
s_waitcnt lgkmcnt(0)
buffer_store_dwordx4 v[68:71], v244, s[20:23], s51 offen offset:3072
ds_write_b32 v134, v104
s_waitcnt vmcnt(16) lgkmcnt(0)
s_barrier
ds_read2st64_b32 v[110:111], v106 offset0:32 offset1:48
ds_read2st64_b32 v[108:109], v106 offset0:0 offset1:16
ds_read_b64_tr_b16 a[64:65], v237 offset:0
ds_read_b64_tr_b16 a[66:67], v237 offset:4608
ds_read_b64_tr_b16 a[68:69], v237 offset:9216
ds_read_b64_tr_b16 a[70:71], v237 offset:13824
ds_read_b64_tr_b16 a[72:73], v237 offset:8
ds_read_b64_tr_b16 a[74:75], v237 offset:4616
ds_read_b64_tr_b16 a[76:77], v237 offset:9224
ds_read_b64_tr_b16 a[78:79], v237 offset:13832
ds_read_b64_tr_b16 a[80:81], v238 offset:0
ds_read_b64_tr_b16 a[82:83], v238 offset:4608
ds_read_b64_tr_b16 a[84:85], v238 offset:9216
ds_read_b64_tr_b16 a[86:87], v238 offset:13824
s_waitcnt lgkmcnt(12)
v_or_b32 v108, v108, v109
v_or3_b32 v108, v108, v110, v111
s_nop 0
v_readfirstlane_b32 s28, v108
s_cmp_gt_u32 s28, s43
s_cbranch_scc1 K_FALLBACK
s_waitcnt lgkmcnt(8)
v_mfma_f32_16x16x32_bf16 v[96:99], a[64:67], v[56:59], 0
ds_read_b64_tr_b16 a[88:89], v238 offset:8
ds_read_b64_tr_b16 a[90:91], v238 offset:4616
v_mfma_f32_16x16x32_bf16 v[96:99], a[68:71], v[60:63], v[96:99]
s_lshr_b32 s32, s35, 2
s_and_b32 s33, s35, 3
v_mfma_f32_16x16x32_bf16 v[88:91], a[68:71], v[44:47], 0
s_lshl_b32 s94, s36, 9
s_lshl_b32 s28, s32, 6
v_mfma_f32_16x16x32_bf16 v[88:91], a[64:67], v[40:43], v[88:91]
s_lshr_b32 s34, s32, 2
v_mfma_f32_16x16x32_bf16 v[80:83], a[64:67], v[24:27], 0
ds_read_b64_tr_b16 a[92:93], v238 offset:9224
ds_read_b64_tr_b16 a[94:95], v238 offset:13832
v_mfma_f32_16x16x32_bf16 v[80:83], a[68:71], v[28:31], v[80:83]
s_add_u32 s94, s94, s28
s_lshl_b32 s28, s37, 4
v_mfma_f32_16x16x32_bf16 v[72:75], a[68:71], v[12:15], 0
s_add_u32 s94, s94, s28
s_add_u32 s94, s94, 0x248000
v_mfma_f32_16x16x32_bf16 v[72:75], a[64:67], v[8:11], v[72:75]
v_mov_b32 v231, 1
v_and_b32 v229, 7, v1
s_waitcnt lgkmcnt(8)
v_mfma_f32_16x16x32_bf16 v[76:79], a[72:75], v[8:11], 0
ds_read_b64_tr_b16 a[64:65], v237 offset:128
ds_read_b64_tr_b16 a[66:67], v237 offset:4736
v_mfma_f32_16x16x32_bf16 v[76:79], a[76:79], v[12:15], v[76:79]
v_lshlrev_b32 v229, 2, v229
v_lshlrev_b32 v226, 3, v1
v_mfma_f32_16x16x32_bf16 v[84:87], a[76:79], v[28:31], 0
s_lshl2_add_u32 s29, s33, s94
v_mfma_f32_16x16x32_bf16 v[84:87], a[72:75], v[24:27], v[84:87]
v_mfma_f32_16x16x32_bf16 v[92:95], a[72:75], v[40:43], 0
ds_read_b64_tr_b16 a[68:69], v237 offset:9344
ds_read_b64_tr_b16 a[70:71], v237 offset:13952
v_mfma_f32_16x16x32_bf16 v[92:95], a[76:79], v[44:47], v[92:95]
v_mfma_f32_16x16x32_bf16 v[100:103], a[76:79], v[60:63], 0
v_mfma_f32_16x16x32_bf16 v[100:103], a[72:75], v[56:59], v[100:103]
s_waitcnt lgkmcnt(8)
v_mfma_f32_16x16x32_bf16 v[128:131], a[80:83], v[56:59], 0
ds_read_b64_tr_b16 a[72:73], v237 offset:136
ds_read_b64_tr_b16 a[74:75], v237 offset:4744
v_mfma_f32_16x16x32_bf16 v[128:131], a[84:87], v[60:63], v[128:131]
v_mfma_f32_16x16x32_bf16 v[120:123], a[84:87], v[44:47], 0
v_mfma_f32_16x16x32_bf16 v[120:123], a[80:83], v[40:43], v[120:123]
v_mfma_f32_16x16x32_bf16 v[112:115], a[80:83], v[24:27], 0
ds_read_b64_tr_b16 a[76:77], v237 offset:9352
ds_read_b64_tr_b16 a[78:79], v237 offset:13960
v_mfma_f32_16x16x32_bf16 v[112:115], a[84:87], v[28:31], v[112:115]
s_waitcnt vmcnt(0)
buffer_store_dword v231, v254, s[20:23], s29 offen
v_mfma_f32_16x16x32_bf16 v[104:107], a[84:87], v[12:15], 0
s_add_u32 s28, s35, 1
s_and_b32 s28, s28, 3
v_mfma_f32_16x16x32_bf16 v[104:107], a[80:83], v[8:11], v[104:107]
s_mul_i32 s28, s28, 36864
s_waitcnt lgkmcnt(8)
v_mfma_f32_16x16x32_bf16 v[108:111], a[88:91], v[8:11], 0
ds_read_b64_tr_b16 a[80:81], v238 offset:128
ds_read_b64_tr_b16 a[82:83], v238 offset:4736
v_mfma_f32_16x16x32_bf16 v[108:111], a[92:95], v[12:15], v[108:111]
v_add_u32 v216, s28, v234
v_add_u32 v217, s28, v235
v_mfma_f32_16x16x32_bf16 v[116:119], a[92:95], v[28:31], 0
v_add_u32 v218, s28, v236
v_mfma_f32_16x16x32_bf16 v[116:119], a[88:91], v[24:27], v[116:119]
v_mfma_f32_16x16x32_bf16 v[124:127], a[88:91], v[40:43], 0
ds_read_b64_tr_b16 a[84:85], v238 offset:9344
ds_read_b64_tr_b16 a[86:87], v238 offset:13952
v_mfma_f32_16x16x32_bf16 v[124:127], a[92:95], v[44:47], v[124:127]
v_mfma_f32_16x16x32_bf16 v[132:135], a[92:95], v[60:63], 0
v_mfma_f32_16x16x32_bf16 v[132:135], a[88:91], v[56:59], v[132:135]
s_waitcnt lgkmcnt(8)
v_mfma_f32_16x16x32_bf16 v[160:163], a[64:67], v[56:59], 0
ds_read_b64_tr_b16 a[88:89], v238 offset:136
ds_read_b64_tr_b16 a[90:91], v238 offset:4744
v_mfma_f32_16x16x32_bf16 v[160:163], a[68:71], v[60:63], v[160:163]
v_mfma_f32_16x16x32_bf16 v[152:155], a[68:71], v[44:47], 0
v_mfma_f32_16x16x32_bf16 v[152:155], a[64:67], v[40:43], v[152:155]
v_mfma_f32_16x16x32_bf16 v[144:147], a[64:67], v[24:27], 0
ds_read_b64_tr_b16 a[92:93], v238 offset:9352
ds_read_b64_tr_b16 a[94:95], v238 offset:13960
v_mfma_f32_16x16x32_bf16 v[144:147], a[68:71], v[28:31], v[144:147]
v_mfma_f32_16x16x32_bf16 v[136:139], a[68:71], v[12:15], 0
v_mfma_f32_16x16x32_bf16 v[136:139], a[64:67], v[8:11], v[136:139]
s_waitcnt lgkmcnt(8)
v_mfma_f32_16x16x32_bf16 v[140:143], a[72:75], v[8:11], 0
ds_read_b64_tr_b16 a[64:65], v239 offset:0
ds_read_b64_tr_b16 a[66:67], v239 offset:4608
v_mfma_f32_16x16x32_bf16 v[140:143], a[76:79], v[12:15], v[140:143]
buffer_load_dword v230, v229, s[20:23], s94 offen sc0 sc1
v_mfma_f32_16x16x32_bf16 v[148:151], a[76:79], v[28:31], 0
s_add_u32 s39, s35, 1
s_and_b32 s39, s39, 3
v_mfma_f32_16x16x32_bf16 v[148:151], a[72:75], v[24:27], v[148:151]
s_add_u32 s28, s33, 1
s_and_b32 s28, s28, 3
v_mfma_f32_16x16x32_bf16 v[156:159], a[72:75], v[40:43], 0
ds_read_b64_tr_b16 a[68:69], v239 offset:9216
ds_read_b64_tr_b16 a[70:71], v239 offset:13824
v_mfma_f32_16x16x32_bf16 v[156:159], a[76:79], v[44:47], v[156:159]
s_sub_u32 s28, s28, s33
s_lshl_b32 s28, s28, 16
v_mfma_f32_16x16x32_bf16 v[164:167], a[76:79], v[60:63], 0
s_add_u32 s64, s28, s44
s_add_u32 s65, s64, 4096
v_mfma_f32_16x16x32_bf16 v[164:167], a[72:75], v[56:59], v[164:167]
s_add_u32 s66, s64, 8192
s_add_u32 s67, s64, 12288
s_waitcnt lgkmcnt(8)
v_mfma_f32_16x16x32_bf16 v[192:195], a[80:83], v[56:59], 0
ds_read_b64_tr_b16 a[72:73], v237 offset:18432
ds_read_b64_tr_b16 a[74:75], v237 offset:23040
v_mfma_f32_16x16x32_bf16 v[192:195], a[84:87], v[60:63], v[192:195]
s_add_u32 s28, s35, 2
s_and_b32 s28, s28, 3
v_mfma_f32_16x16x32_bf16 v[184:187], a[84:87], v[44:47], 0
s_mul_i32 s28, s28, 36864
v_mfma_f32_16x16x32_bf16 v[184:187], a[80:83], v[40:43], v[184:187]
v_add_u32 v219, s28, v234
v_add_u32 v220, s28, v235
v_mfma_f32_16x16x32_bf16 v[176:179], a[80:83], v[24:27], 0
ds_read_b64_tr_b16 a[76:77], v237 offset:27648
ds_read_b64_tr_b16 a[78:79], v237 offset:32256
v_mfma_f32_16x16x32_bf16 v[176:179], a[84:87], v[28:31], v[176:179]
v_add_u32 v221, s28, v236
v_mfma_f32_16x16x32_bf16 v[168:171], a[84:87], v[12:15], 0
s_add_u32 s28, s35, 3
s_and_b32 s28, s28, 3
v_mfma_f32_16x16x32_bf16 v[168:171], a[80:83], v[8:11], v[168:171]
s_mul_i32 s28, s28, 36864
s_waitcnt lgkmcnt(8)
v_mfma_f32_16x16x32_bf16 v[172:175], a[88:91], v[8:11], 0
ds_read_b64_tr_b16 a[80:81], v237 offset:18440
ds_read_b64_tr_b16 a[82:83], v237 offset:23048
v_mfma_f32_16x16x32_bf16 v[172:175], a[92:95], v[12:15], v[172:175]
v_add_u32 v222, s28, v234
v_add_u32 v223, s28, v235
v_mfma_f32_16x16x32_bf16 v[180:183], a[92:95], v[28:31], 0
v_add_u32 v224, s28, v236
v_mfma_f32_16x16x32_bf16 v[180:183], a[88:91], v[24:27], v[180:183]
v_mfma_f32_16x16x32_bf16 v[188:191], a[88:91], v[40:43], 0
ds_read_b64_tr_b16 a[84:85], v237 offset:27656
ds_read_b64_tr_b16 a[86:87], v237 offset:32264
v_mfma_f32_16x16x32_bf16 v[188:191], a[92:95], v[44:47], v[188:191]
v_mfma_f32_16x16x32_bf16 v[196:199], a[92:95], v[60:63], 0
s_waitcnt vmcnt(0)
v_cmp_gt_u32 vcc, 1, v230
v_mfma_f32_16x16x32_bf16 v[196:199], a[88:91], v[56:59], v[196:199]
s_waitcnt lgkmcnt(8)
v_mfma_f32_16x16x32_bf16 v[212:215], a[64:67], v[56:59], 0
ds_read_b64_tr_b16 a[88:89], v238 offset:18432
ds_read_b64_tr_b16 a[90:91], v238 offset:23040
v_mfma_f32_16x16x32_bf16 v[212:215], a[68:71], v[60:63], v[212:215]
s_bitcmp1_b32 vcc_lo, s39
s_cbranch_scc1 SP_O1A
SP_O1A_RET:
v_mfma_f32_16x16x32_bf16 v[208:211], a[68:71], v[44:47], 0
buffer_load_dwordx4 a[156:159], v244, s[20:23], s64 offen offset:0 sc0 sc1
v_mfma_f32_16x16x32_bf16 v[208:211], a[64:67], v[40:43], v[208:211]
v_mfma_f32_16x16x32_bf16 v[204:207], a[64:67], v[24:27], 0
ds_read_b64_tr_b16 a[92:93], v238 offset:27648
ds_read_b64_tr_b16 a[94:95], v238 offset:32256
v_mfma_f32_16x16x32_bf16 v[204:207], a[68:71], v[28:31], v[204:207]
v_mfma_f32_16x16x32_bf16 v[200:203], a[68:71], v[12:15], 0
buffer_load_dwordx4 a[172:175], v244, s[20:23], s65 offen offset:0 sc0 sc1
v_mfma_f32_16x16x32_bf16 v[200:203], a[64:67], v[8:11], v[200:203]
s_waitcnt lgkmcnt(8)
v_mfma_f32_16x16x32_bf16 v[72:75], a[72:75], v[16:19], v[72:75]
ds_read_b64_tr_b16 a[64:65], v238 offset:18440
ds_read_b64_tr_b16 a[66:67], v238 offset:23048
v_mfma_f32_16x16x32_bf16 v[72:75], a[76:79], v[20:23], v[72:75]
v_mfma_f32_16x16x32_bf16 v[80:83], a[76:79], v[36:39], v[80:83]
buffer_load_dwordx4 a[188:191], v244, s[20:23], s66 offen offset:0 sc0 sc1
v_mfma_f32_16x16x32_bf16 v[80:83], a[72:75], v[32:35], v[80:83]
v_mfma_f32_16x16x32_bf16 v[88:91], a[72:75], v[48:51], v[88:91]
ds_read_b64_tr_b16 a[68:69], v238 offset:27656
ds_read_b64_tr_b16 a[70:71], v238 offset:32264
v_mfma_f32_16x16x32_bf16 v[88:91], a[76:79], v[52:55], v[88:91]
v_mfma_f32_16x16x32_bf16 v[96:99], a[76:79], v[68:71], v[96:99]
buffer_load_dwordx4 a[204:207], v244, s[20:23], s67 offen offset:0 sc0 sc1
v_mfma_f32_16x16x32_bf16 v[96:99], a[72:75], v[64:67], v[96:99]
s_waitcnt lgkmcnt(8)
v_mfma_f32_16x16x32_bf16 v[100:103], a[80:83], v[64:67], v[100:103]
ds_read_b64_tr_b16 a[72:73], v237 offset:18560
ds_read_b64_tr_b16 a[74:75], v237 offset:23168
v_mfma_f32_16x16x32_bf16 v[100:103], a[84:87], v[68:71], v[100:103]
v_mfma_f32_16x16x32_bf16 v[92:95], a[84:87], v[52:55], v[92:95]
buffer_load_dwordx4 a[160:163], v244, s[20:23], s64 offen offset:1024 sc0 sc1
v_mfma_f32_16x16x32_bf16 v[92:95], a[80:83], v[48:51], v[92:95]
v_mfma_f32_16x16x32_bf16 v[84:87], a[80:83], v[32:35], v[84:87]
ds_read_b64_tr_b16 a[76:77], v237 offset:27776
ds_read_b64_tr_b16 a[78:79], v237 offset:32384
v_mfma_f32_16x16x32_bf16 v[84:87], a[84:87], v[36:39], v[84:87]
v_mfma_f32_16x16x32_bf16 v[76:79], a[84:87], v[20:23], v[76:79]
buffer_load_dwordx4 a[176:179], v244, s[20:23], s65 offen offset:1024 sc0 sc1
v_mfma_f32_16x16x32_bf16 v[76:79], a[80:83], v[16:19], v[76:79]
s_waitcnt lgkmcnt(8)
v_mfma_f32_16x16x32_bf16 v[104:107], a[88:91], v[16:19], v[104:107]
ds_read_b64_tr_b16 a[80:81], v237 offset:18568
ds_read_b64_tr_b16 a[82:83], v237 offset:23176
v_mfma_f32_16x16x32_bf16 v[104:107], a[92:95], v[20:23], v[104:107]
v_mfma_f32_16x16x32_bf16 v[112:115], a[92:95], v[36:39], v[112:115]
buffer_load_dwordx4 a[192:195], v244, s[20:23], s66 offen offset:1024 sc0 sc1
v_mfma_f32_16x16x32_bf16 v[112:115], a[88:91], v[32:35], v[112:115]
v_mfma_f32_16x16x32_bf16 v[120:123], a[88:91], v[48:51], v[120:123]
ds_read_b64_tr_b16 a[84:85], v237 offset:27784
ds_read_b64_tr_b16 a[86:87], v237 offset:32392
v_mfma_f32_16x16x32_bf16 v[120:123], a[92:95], v[52:55], v[120:123]
v_mfma_f32_16x16x32_bf16 v[128:131], a[92:95], v[68:71], v[128:131]
buffer_load_dwordx4 a[208:211], v244, s[20:23], s67 offen offset:1024 sc0 sc1
v_mfma_f32_16x16x32_bf16 v[128:131], a[88:91], v[64:67], v[128:131]
s_waitcnt lgkmcnt(8)
v_mfma_f32_16x16x32_bf16 v[132:135], a[64:67], v[64:67], v[132:135]
ds_read_b64_tr_b16 a[88:89], v238 offset:18560
ds_read_b64_tr_b16 a[90:91], v238 offset:23168
v_mfma_f32_16x16x32_bf16 v[132:135], a[68:71], v[68:71], v[132:135]
v_mfma_f32_16x16x32_bf16 v[124:127], a[68:71], v[52:55], v[124:127]
buffer_load_dwordx4 a[164:167], v244, s[20:23], s64 offen offset:2048 sc0 sc1
v_mfma_f32_16x16x32_bf16 v[124:127], a[64:67], v[48:51], v[124:127]
buffer_load_dword v230, v229, s[20:23], s94 offen sc0 sc1
v_mfma_f32_16x16x32_bf16 v[116:119], a[64:67], v[32:35], v[116:119]
ds_read_b64_tr_b16 a[92:93], v238 offset:27776
ds_read_b64_tr_b16 a[94:95], v238 offset:32384
v_mfma_f32_16x16x32_bf16 v[116:119], a[68:71], v[36:39], v[116:119]
v_mfma_f32_16x16x32_bf16 v[108:111], a[68:71], v[20:23], v[108:111]
v_mfma_f32_16x16x32_bf16 v[108:111], a[64:67], v[16:19], v[108:111]
buffer_load_dwordx4 a[180:183], v244, s[20:23], s65 offen offset:2048 sc0 sc1
s_waitcnt lgkmcnt(8)
v_mfma_f32_16x16x32_bf16 v[136:139], a[72:75], v[16:19], v[136:139]
ds_read_b64_tr_b16 a[64:65], v238 offset:18568
ds_read_b64_tr_b16 a[66:67], v238 offset:23176
v_mfma_f32_16x16x32_bf16 v[136:139], a[76:79], v[20:23], v[136:139]
v_mfma_f32_16x16x32_bf16 v[144:147], a[76:79], v[36:39], v[144:147]
v_mfma_f32_16x16x32_bf16 v[144:147], a[72:75], v[32:35], v[144:147]
buffer_load_dwordx4 a[196:199], v244, s[20:23], s66 offen offset:2048 sc0 sc1
v_mfma_f32_16x16x32_bf16 v[152:155], a[72:75], v[48:51], v[152:155]
ds_read_b64_tr_b16 a[68:69], v238 offset:27784
ds_read_b64_tr_b16 a[70:71], v238 offset:32392
v_mfma_f32_16x16x32_bf16 v[152:155], a[76:79], v[52:55], v[152:155]
v_mfma_f32_16x16x32_bf16 v[160:163], a[76:79], v[68:71], v[160:163]
v_mfma_f32_16x16x32_bf16 v[160:163], a[72:75], v[64:67], v[160:163]
buffer_load_dwordx4 a[212:215], v244, s[20:23], s67 offen offset:2048 sc0 sc1
s_waitcnt lgkmcnt(8)
v_mfma_f32_16x16x32_bf16 v[164:167], a[80:83], v[64:67], v[164:167]
ds_read_b64_tr_b16 a[72:73], v239 offset:18432
ds_read_b64_tr_b16 a[74:75], v239 offset:23040
v_mfma_f32_16x16x32_bf16 v[164:167], a[84:87], v[68:71], v[164:167]
v_mfma_f32_16x16x32_bf16 v[156:159], a[84:87], v[52:55], v[156:159]
v_mfma_f32_16x16x32_bf16 v[156:159], a[80:83], v[48:51], v[156:159]
buffer_load_dwordx4 a[168:171], v244, s[20:23], s64 offen offset:3072 sc0 sc1
v_mfma_f32_16x16x32_bf16 v[148:151], a[80:83], v[32:35], v[148:151]
ds_read_b64_tr_b16 a[76:77], v239 offset:27648
ds_read_b64_tr_b16 a[78:79], v239 offset:32256
v_mfma_f32_16x16x32_bf16 v[148:151], a[84:87], v[36:39], v[148:151]
v_mfma_f32_16x16x32_bf16 v[140:143], a[84:87], v[20:23], v[140:143]
v_mfma_f32_16x16x32_bf16 v[140:143], a[80:83], v[16:19], v[140:143]
buffer_load_dwordx4 a[184:187], v244, s[20:23], s65 offen offset:3072 sc0 sc1
s_waitcnt lgkmcnt(8)
v_mfma_f32_16x16x32_bf16 v[168:171], a[88:91], v[16:19], v[168:171]
ds_read_b64_tr_b16 a[80:81], v216 offset:0
ds_read_b64_tr_b16 a[82:83], v216 offset:4608
v_mfma_f32_16x16x32_bf16 v[168:171], a[92:95], v[20:23], v[168:171]
v_mfma_f32_16x16x32_bf16 v[176:179], a[92:95], v[36:39], v[176:179]
v_mfma_f32_16x16x32_bf16 v[176:179], a[88:91], v[32:35], v[176:179]
buffer_load_dwordx4 a[200:203], v244, s[20:23], s66 offen offset:3072 sc0 sc1
v_mfma_f32_16x16x32_bf16 v[184:187], a[88:91], v[48:51], v[184:187]
ds_read_b64_tr_b16 a[84:85], v216 offset:9216
ds_read_b64_tr_b16 a[86:87], v216 offset:13824
v_mfma_f32_16x16x32_bf16 v[184:187], a[92:95], v[52:55], v[184:187]
v_mfma_f32_16x16x32_bf16 v[192:195], a[92:95], v[68:71], v[192:195]
v_mfma_f32_16x16x32_bf16 v[192:195], a[88:91], v[64:67], v[192:195]
buffer_load_dwordx4 a[216:219], v244, s[20:23], s67 offen offset:3072 sc0 sc1
s_waitcnt lgkmcnt(8)
v_mfma_f32_16x16x32_bf16 v[196:199], a[64:67], v[64:67], v[196:199]
ds_read_b64_tr_b16 a[88:89], v216 offset:8
ds_read_b64_tr_b16 a[90:91], v216 offset:4616
v_mfma_f32_16x16x32_bf16 v[196:199], a[68:71], v[68:71], v[196:199]
s_add_u32 s28, s33, 2
s_and_b32 s28, s28, 3
v_mfma_f32_16x16x32_bf16 v[188:191], a[68:71], v[52:55], v[188:191]
s_sub_u32 s28, s28, s33
s_lshl_b32 s28, s28, 16
v_mfma_f32_16x16x32_bf16 v[188:191], a[64:67], v[48:51], v[188:191]
s_add_u32 s64, s28, s44
s_add_u32 s65, s64, 4096
v_mfma_f32_16x16x32_bf16 v[180:183], a[64:67], v[32:35], v[180:183]
ds_read_b64_tr_b16 a[92:93], v216 offset:9224
ds_read_b64_tr_b16 a[94:95], v216 offset:13832
v_mfma_f32_16x16x32_bf16 v[180:183], a[68:71], v[36:39], v[180:183]
s_add_u32 s66, s64, 8192
s_add_u32 s67, s64, 12288
v_mfma_f32_16x16x32_bf16 v[172:175], a[68:71], v[20:23], v[172:175]
s_waitcnt vmcnt(7)
v_cmp_gt_u32 vcc, 1, v230
v_mfma_f32_16x16x32_bf16 v[172:175], a[64:67], v[16:19], v[172:175]
s_waitcnt lgkmcnt(8)
v_mfma_f32_16x16x32_bf16 v[200:203], a[72:75], v[16:19], v[200:203]
ds_read_b64_tr_b16 a[64:65], v217 offset:0
STUB_14:
STUB_B2:
s_cbranch_execz STUB_17
ds_read_b64_tr_b16 a[66:67], v217 offset:4608
v_mfma_f32_16x16x32_bf16 v[200:203], a[76:79], v[20:23], v[200:203]
s_and_b32 s29, vcc_lo, 15
s_cbranch_scc1 SP_O2A
SP_O2A_RET:
v_mfma_f32_16x16x32_bf16 v[204:207], a[76:79], v[36:39], v[204:207]
buffer_load_dwordx4 a[220:223], v244, s[20:23], s64 offen offset:0 sc0 sc1
v_mfma_f32_16x16x32_bf16 v[204:207], a[72:75], v[32:35], v[204:207]
v_mfma_f32_16x16x32_bf16 v[208:211], a[72:75], v[48:51], v[208:211]
ds_read_b64_tr_b16 a[68:69], v217 offset:9216
ds_read_b64_tr_b16 a[70:71], v217 offset:13824
v_mfma_f32_16x16x32_bf16 v[208:211], a[76:79], v[52:55], v[208:211]
v_mfma_f32_16x16x32_bf16 v[212:215], a[76:79], v[68:71], v[212:215]
buffer_load_dwordx4 a[236:239], v244, s[20:23], s65 offen offset:0 sc0 sc1
v_mfma_f32_16x16x32_bf16 v[212:215], a[72:75], v[64:67], v[212:215]
s_waitcnt vmcnt(15)
s_waitcnt lgkmcnt(8)
v_mfma_f32_16x16x32_bf16 v[96:99], a[80:83], a[204:207], v[96:99]
ds_read_b64_tr_b16 a[72:73], v217 offset:8
ds_read_b64_tr_b16 a[74:75], v217 offset:4616
s_waitcnt vmcnt(11)
v_mfma_f32_16x16x32_bf16 v[96:99], a[84:87], a[208:211], v[96:99]
v_mfma_f32_16x16x32_bf16 v[88:91], a[84:87], a[192:195], v[88:91]
buffer_load_dwordx4 a[96:99], v244, s[20:23], s66 offen offset:0 sc0 sc1
v_mfma_f32_16x16x32_bf16 v[88:91], a[80:83], a[188:191], v[88:91]
v_accvgpr_read_b32 v39, a136
v_accvgpr_read_b32 v59, a144
v_mfma_f32_16x16x32_bf16 v[80:83], a[80:83], a[172:175], v[80:83]
ds_read_b64_tr_b16 a[76:77], v217 offset:9224
ds_read_b64_tr_b16 a[78:79], v217 offset:13832
v_mfma_f32_16x16x32_bf16 v[80:83], a[84:87], a[176:179], v[80:83]
v_lshlrev_b32 v38, 16, v39
v_and_b32 v39, 0xffff0000, v39
v_mfma_f32_16x16x32_bf16 v[72:75], a[84:87], a[160:163], v[72:75]
buffer_load_dwordx4 a[112:115], v244, s[20:23], s67 offen offset:0 sc0 sc1
v_mfma_f32_16x16x32_bf16 v[72:75], a[80:83], a[156:159], v[72:75]
v_lshlrev_b32 v58, 16, v59
v_and_b32 v59, 0xffff0000, v59
s_waitcnt lgkmcnt(8)
v_mfma_f32_16x16x32_bf16 v[76:79], a[88:91], a[156:159], v[76:79]
ds_read_b64_tr_b16 a[80:81], v216 offset:128
ds_read_b64_tr_b16 a[82:83], v216 offset:4736
v_mfma_f32_16x16x32_bf16 v[76:79], a[92:95], a[160:163], v[76:79]
v_add_f32 v38, v38, v58
v_add_f32 v39, v39, v59
v_mfma_f32_16x16x32_bf16 v[84:87], a[92:95], a[176:179], v[84:87]
buffer_load_dwordx4 a[224:227], v244, s[20:23], s64 offen offset:1024 sc0 sc1
v_mfma_f32_16x16x32_bf16 v[84:87], a[88:91], a[172:175], v[84:87]
v_cvt_pk_bf16_f32 v58, v38, v39
v_lshlrev_b32 v38, 16, v58
v_mfma_f32_16x16x32_bf16 v[92:95], a[88:91], a[188:191], v[92:95]
ds_read_b64_tr_b16 a[84:85], v216 offset:9344
ds_read_b64_tr_b16 a[86:87], v216 offset:13952
v_mfma_f32_16x16x32_bf16 v[92:95], a[92:95], a[192:195], v[92:95]
v_and_b32 v39, 0xffff0000, v58
v_mul_f32 v58, 0xbfb8aa3b, v38
v_mfma_f32_16x16x32_bf16 v[100:103], a[92:95], a[208:211], v[100:103]
buffer_load_dwordx4 a[240:243], v244, s[20:23], s65 offen offset:1024 sc0 sc1
v_mfma_f32_16x16x32_bf16 v[100:103], a[88:91], a[204:207], v[100:103]
v_mul_f32 v59, 0xbfb8aa3b, v39
s_waitcnt lgkmcnt(8)
v_mfma_f32_16x16x32_bf16 v[128:131], a[64:67], a[204:207], v[128:131]
ds_read_b64_tr_b16 a[88:89], v216 offset:136
ds_read_b64_tr_b16 a[90:91], v216 offset:4744
v_mfma_f32_16x16x32_bf16 v[128:131], a[68:71], a[208:211], v[128:131]
v_exp_f32 v58, v58
v_mfma_f32_16x16x32_bf16 v[120:123], a[68:71], a[192:195], v[120:123]
buffer_load_dwordx4 a[100:103], v244, s[20:23], s66 offen offset:1024 sc0 sc1
v_mfma_f32_16x16x32_bf16 v[120:123], a[64:67], a[188:191], v[120:123]
v_exp_f32 v59, v59
v_mfma_f32_16x16x32_bf16 v[112:115], a[64:67], a[172:175], v[112:115]
ds_read_b64_tr_b16 a[92:93], v216 offset:9352
ds_read_b64_tr_b16 a[94:95], v216 offset:13960
v_mfma_f32_16x16x32_bf16 v[112:115], a[68:71], a[176:179], v[112:115]
v_add_f32 v58, 1.0, v58
v_add_f32 v59, 1.0, v59
v_mfma_f32_16x16x32_bf16 v[104:107], a[68:71], a[160:163], v[104:107]
buffer_load_dwordx4 a[116:119], v244, s[20:23], s67 offen offset:1024 sc0 sc1
v_mfma_f32_16x16x32_bf16 v[104:107], a[64:67], a[156:159], v[104:107]
v_rcp_f32 v58, v58
s_waitcnt lgkmcnt(8)
v_mfma_f32_16x16x32_bf16 v[108:111], a[72:75], a[156:159], v[108:111]
ds_read_b64_tr_b16 a[64:65], v217 offset:128
ds_read_b64_tr_b16 a[66:67], v217 offset:4736
v_mfma_f32_16x16x32_bf16 v[108:111], a[76:79], a[160:163], v[108:111]
v_rcp_f32 v59, v59
v_mfma_f32_16x16x32_bf16 v[116:119], a[76:79], a[176:179], v[116:119]
buffer_load_dwordx4 a[228:231], v244, s[20:23], s64 offen offset:2048 sc0 sc1
v_mfma_f32_16x16x32_bf16 v[116:119], a[72:75], a[172:175], v[116:119]
v_mul_f32 v38, v38, v58
v_mul_f32 v39, v39, v59
v_mfma_f32_16x16x32_bf16 v[124:127], a[72:75], a[188:191], v[124:127]
ds_read_b64_tr_b16 a[68:69], v217 offset:9344
ds_read_b64_tr_b16 a[70:71], v217 offset:13952
v_mfma_f32_16x16x32_bf16 v[124:127], a[76:79], a[192:195], v[124:127]
v_cvt_pk_bf16_f32 v58, v38, v39
v_lshlrev_b32 v38, 16, v58
v_mfma_f32_16x16x32_bf16 v[132:135], a[76:79], a[208:211], v[132:135]
buffer_load_dwordx4 a[128:131], v244, s[20:23], s65 offen offset:2048 sc0 sc1
v_mfma_f32_16x16x32_bf16 v[132:135], a[72:75], a[204:207], v[132:135]
v_and_b32 v39, 0xffff0000, v58
v_accvgpr_read_b32 v41, a137
s_waitcnt lgkmcnt(8)
v_mfma_f32_16x16x32_bf16 v[160:163], a[80:83], a[204:207], v[160:163]
ds_read_b64_tr_b16 a[72:73], v217 offset:136
ds_read_b64_tr_b16 a[74:75], v217 offset:4744
v_mfma_f32_16x16x32_bf16 v[160:163], a[84:87], a[208:211], v[160:163]
v_accvgpr_read_b32 v59, a145
v_lshlrev_b32 v40, 16, v41
v_mfma_f32_16x16x32_bf16 v[152:155], a[84:87], a[192:195], v[152:155]
buffer_load_dwordx4 a[104:107], v244, s[20:23], s66 offen offset:2048 sc0 sc1
v_mfma_f32_16x16x32_bf16 v[152:155], a[80:83], a[188:191], v[152:155]
v_and_b32 v41, 0xffff0000, v41
v_lshlrev_b32 v58, 16, v59
v_mfma_f32_16x16x32_bf16 v[144:147], a[80:83], a[172:175], v[144:147]
ds_read_b64_tr_b16 a[76:77], v217 offset:9352
ds_read_b64_tr_b16 a[78:79], v217 offset:13960
v_mfma_f32_16x16x32_bf16 v[144:147], a[84:87], a[176:179], v[144:147]
v_and_b32 v59, 0xffff0000, v59
v_add_f32 v40, v40, v58
v_mfma_f32_16x16x32_bf16 v[136:139], a[84:87], a[160:163], v[136:139]
buffer_load_dwordx4 a[120:123], v244, s[20:23], s67 offen offset:2048 sc0 sc1
v_mfma_f32_16x16x32_bf16 v[136:139], a[80:83], a[156:159], v[136:139]
v_add_f32 v41, v41, v59
v_cvt_pk_bf16_f32 v58, v40, v41
s_waitcnt lgkmcnt(8)
v_mfma_f32_16x16x32_bf16 v[140:143], a[88:91], a[156:159], v[140:143]
ds_read_b64_tr_b16 a[80:81], v218 offset:0
ds_read_b64_tr_b16 a[82:83], v218 offset:4608
v_mfma_f32_16x16x32_bf16 v[140:143], a[92:95], a[160:163], v[140:143]
v_lshlrev_b32 v40, 16, v58
v_and_b32 v41, 0xffff0000, v58
v_mfma_f32_16x16x32_bf16 v[148:151], a[92:95], a[176:179], v[148:151]
buffer_load_dwordx4 a[232:235], v244, s[20:23], s64 offen offset:3072 sc0 sc1
v_mfma_f32_16x16x32_bf16 v[148:151], a[88:91], a[172:175], v[148:151]
v_mul_f32 v58, 0xbfb8aa3b, v40
v_mul_f32 v59, 0xbfb8aa3b, v41
v_mfma_f32_16x16x32_bf16 v[156:159], a[88:91], a[188:191], v[156:159]
ds_read_b64_tr_b16 a[84:85], v218 offset:9216
ds_read_b64_tr_b16 a[86:87], v218 offset:13824
v_mfma_f32_16x16x32_bf16 v[156:159], a[92:95], a[192:195], v[156:159]
v_exp_f32 v58, v58
v_mfma_f32_16x16x32_bf16 v[164:167], a[92:95], a[208:211], v[164:167]
buffer_load_dwordx4 a[132:135], v244, s[20:23], s65 offen offset:3072 sc0 sc1
v_mfma_f32_16x16x32_bf16 v[164:167], a[88:91], a[204:207], v[164:167]
v_exp_f32 v59, v59
s_waitcnt lgkmcnt(8)
v_mfma_f32_16x16x32_bf16 v[192:195], a[64:67], a[204:207], v[192:195]
ds_read_b64_tr_b16 a[88:89], v216 offset:18432
ds_read_b64_tr_b16 a[90:91], v216 offset:23040
v_mfma_f32_16x16x32_bf16 v[192:195], a[68:71], a[208:211], v[192:195]
v_add_f32 v58, 1.0, v58
v_add_f32 v59, 1.0, v59
v_mfma_f32_16x16x32_bf16 v[184:187], a[68:71], a[192:195], v[184:187]
buffer_load_dwordx4 a[108:111], v244, s[20:23], s66 offen offset:3072 sc0 sc1
v_mfma_f32_16x16x32_bf16 v[184:187], a[64:67], a[188:191], v[184:187]
v_rcp_f32 v58, v58
v_mfma_f32_16x16x32_bf16 v[176:179], a[64:67], a[172:175], v[176:179]
ds_read_b64_tr_b16 a[92:93], v216 offset:27648
ds_read_b64_tr_b16 a[94:95], v216 offset:32256
v_mfma_f32_16x16x32_bf16 v[176:179], a[68:71], a[176:179], v[176:179]
v_rcp_f32 v59, v59
v_mfma_f32_16x16x32_bf16 v[168:171], a[68:71], a[160:163], v[168:171]
buffer_load_dwordx4 a[124:127], v244, s[20:23], s67 offen offset:3072 sc0 sc1
v_mfma_f32_16x16x32_bf16 v[168:171], a[64:67], a[156:159], v[168:171]
s_add_u32 s28, s33, 3
s_and_b32 s28, s28, 3
s_waitcnt lgkmcnt(8)
v_mfma_f32_16x16x32_bf16 v[172:175], a[72:75], a[156:159], v[172:175]
ds_read_b64_tr_b16 a[64:65], v216 offset:18440
ds_read_b64_tr_b16 a[66:67], v216 offset:23048
v_mfma_f32_16x16x32_bf16 v[172:175], a[76:79], a[160:163], v[172:175]
s_sub_u32 s28, s28, s33
s_lshl_b32 s28, s28, 16
v_mfma_f32_16x16x32_bf16 v[180:183], a[76:79], a[176:179], v[180:183]
s_add_u32 s64, s28, s44
s_add_u32 s65, s64, 4096
v_mfma_f32_16x16x32_bf16 v[180:183], a[72:75], a[172:175], v[180:183]
s_add_u32 s66, s64, 8192
s_add_u32 s67, s64, 12288
v_mfma_f32_16x16x32_bf16 v[188:191], a[72:75], a[188:191], v[188:191]
ds_read_b64_tr_b16 a[68:69], v216 offset:27656
ds_read_b64_tr_b16 a[70:71], v216 offset:32264
v_mfma_f32_16x16x32_bf16 v[188:191], a[76:79], a[192:195], v[188:191]
buffer_load_dwordx4 a[0:3], v244, s[20:23], s64 offen offset:0 sc0 sc1
v_mfma_f32_16x16x32_bf16 v[196:199], a[76:79], a[208:211], v[196:199]
v_mul_f32 v40, v40, v58
v_mul_f32 v41, v41, v59
v_mfma_f32_16x16x32_bf16 v[196:199], a[72:75], a[204:207], v[196:199]
v_cvt_pk_bf16_f32 v58, v40, v41
v_lshlrev_b32 v40, 16, v58
s_waitcnt lgkmcnt(8)
v_mfma_f32_16x16x32_bf16 v[212:215], a[80:83], a[204:207], v[212:215]
ds_read_b64_tr_b16 a[72:73], v217 offset:18432
ds_read_b64_tr_b16 a[74:75], v217 offset:23040
v_mfma_f32_16x16x32_bf16 v[212:215], a[84:87], a[208:211], v[212:215]
buffer_load_dwordx4 a[16:19], v244, s[20:23], s65 offen offset:0 sc0 sc1
v_mfma_f32_16x16x32_bf16 v[208:211], a[84:87], a[192:195], v[208:211]
v_and_b32 v41, 0xffff0000, v58
v_accvgpr_read_b32 v43, a138
v_mfma_f32_16x16x32_bf16 v[208:211], a[80:83], a[188:191], v[208:211]
v_accvgpr_read_b32 v59, a146
v_lshlrev_b32 v42, 16, v43
v_mfma_f32_16x16x32_bf16 v[204:207], a[80:83], a[172:175], v[204:207]
ds_read_b64_tr_b16 a[76:77], v217 offset:27648
ds_read_b64_tr_b16 a[78:79], v217 offset:32256
v_mfma_f32_16x16x32_bf16 v[204:207], a[84:87], a[176:179], v[204:207]
buffer_load_dwordx4 a[32:35], v244, s[20:23], s66 offen offset:0 sc0 sc1
v_mfma_f32_16x16x32_bf16 v[200:203], a[84:87], a[160:163], v[200:203]
v_and_b32 v43, 0xffff0000, v43
v_lshlrev_b32 v58, 16, v59
v_mfma_f32_16x16x32_bf16 v[200:203], a[80:83], a[156:159], v[200:203]
v_and_b32 v59, 0xffff0000, v59
v_add_f32 v42, v42, v58
s_waitcnt vmcnt(23)
s_waitcnt lgkmcnt(8)
v_mfma_f32_16x16x32_bf16 v[72:75], a[88:91], a[164:167], v[72:75]
ds_read_b64_tr_b16 a[80:81], v217 offset:18440
ds_read_b64_tr_b16 a[82:83], v217 offset:23048
s_waitcnt vmcnt(19)
v_mfma_f32_16x16x32_bf16 v[72:75], a[92:95], a[168:171], v[72:75]
buffer_load_dwordx4 a[48:51], v244, s[20:23], s67 offen offset:0 sc0 sc1
v_mfma_f32_16x16x32_bf16 v[80:83], a[92:95], a[184:187], v[80:83]
v_add_f32 v43, v43, v59
v_cvt_pk_bf16_f32 v58, v42, v43
v_mfma_f32_16x16x32_bf16 v[80:83], a[88:91], a[180:183], v[80:83]
v_lshlrev_b32 v42, 16, v58
v_and_b32 v43, 0xffff0000, v58
v_mfma_f32_16x16x32_bf16 v[88:91], a[88:91], a[196:199], v[88:91]
ds_read_b64_tr_b16 a[84:85], v217 offset:27656
ds_read_b64_tr_b16 a[86:87], v217 offset:32264
v_mfma_f32_16x16x32_bf16 v[88:91], a[92:95], a[200:203], v[88:91]
buffer_load_dwordx4 a[4:7], v244, s[20:23], s64 offen offset:1024 sc0 sc1
v_mfma_f32_16x16x32_bf16 v[96:99], a[92:95], a[216:219], v[96:99]
v_mul_f32 v58, 0xbfb8aa3b, v42
v_mul_f32 v59, 0xbfb8aa3b, v43
v_mfma_f32_16x16x32_bf16 v[96:99], a[88:91], a[212:215], v[96:99]
v_exp_f32 v58, v58
s_waitcnt lgkmcnt(8)
v_mfma_f32_16x16x32_bf16 v[100:103], a[64:67], a[212:215], v[100:103]
ds_read_b64_tr_b16 a[88:89], v216 offset:18560
ds_read_b64_tr_b16 a[90:91], v216 offset:23168
v_mfma_f32_16x16x32_bf16 v[100:103], a[68:71], a[216:219], v[100:103]
buffer_load_dwordx4 a[20:23], v244, s[20:23], s65 offen offset:1024 sc0 sc1
v_mfma_f32_16x16x32_bf16 v[92:95], a[68:71], a[200:203], v[92:95]
v_exp_f32 v59, v59
v_mfma_f32_16x16x32_bf16 v[92:95], a[64:67], a[196:199], v[92:95]
v_add_f32 v58, 1.0, v58
v_add_f32 v59, 1.0, v59
v_mfma_f32_16x16x32_bf16 v[84:87], a[64:67], a[180:183], v[84:87]
ds_read_b64_tr_b16 a[92:93], v216 offset:27776
ds_read_b64_tr_b16 a[94:95], v216 offset:32384
v_mfma_f32_16x16x32_bf16 v[84:87], a[68:71], a[184:187], v[84:87]
buffer_load_dwordx4 a[36:39], v244, s[20:23], s66 offen offset:1024 sc0 sc1
v_mfma_f32_16x16x32_bf16 v[76:79], a[68:71], a[168:171], v[76:79]
v_rcp_f32 v58, v58
v_mfma_f32_16x16x32_bf16 v[76:79], a[64:67], a[164:167], v[76:79]
v_rcp_f32 v59, v59
s_waitcnt lgkmcnt(8)
v_mfma_f32_16x16x32_bf16 v[104:107], a[72:75], a[164:167], v[104:107]
ds_read_b64_tr_b16 a[64:65], v216 offset:18568
ds_read_b64_tr_b16 a[66:67], v216 offset:23176
v_mfma_f32_16x16x32_bf16 v[104:107], a[76:79], a[168:171], v[104:107]
buffer_load_dwordx4 a[52:55], v244, s[20:23], s67 offen offset:1024 sc0 sc1
v_mfma_f32_16x16x32_bf16 v[112:115], a[76:79], a[184:187], v[112:115]
v_mul_f32 v42, v42, v58
v_mul_f32 v43, v43, v59
v_mfma_f32_16x16x32_bf16 v[112:115], a[72:75], a[180:183], v[112:115]
v_cvt_pk_bf16_f32 v58, v42, v43
v_lshlrev_b32 v42, 16, v58
v_mfma_f32_16x16x32_bf16 v[120:123], a[72:75], a[196:199], v[120:123]
ds_read_b64_tr_b16 a[68:69], v216 offset:27784
ds_read_b64_tr_b16 a[70:71], v216 offset:32392
v_mfma_f32_16x16x32_bf16 v[120:123], a[76:79], a[200:203], v[120:123]
buffer_load_dwordx4 a[8:11], v244, s[20:23], s64 offen offset:2048 sc0 sc1
v_mfma_f32_16x16x32_bf16 v[128:131], a[76:79], a[216:219], v[128:131]
v_and_b32 v43, 0xffff0000, v58
v_accvgpr_read_b32 v45, a139
v_mfma_f32_16x16x32_bf16 v[128:131], a[72:75], a[212:215], v[128:131]
v_accvgpr_read_b32 v59, a147
v_lshlrev_b32 v44, 16, v45
s_waitcnt lgkmcnt(8)
v_mfma_f32_16x16x32_bf16 v[132:135], a[80:83], a[212:215], v[132:135]
ds_read_b64_tr_b16 a[72:73], v217 offset:18560
ds_read_b64_tr_b16 a[74:75], v217 offset:23168
v_mfma_f32_16x16x32_bf16 v[132:135], a[84:87], a[216:219], v[132:135]
buffer_load_dwordx4 a[24:27], v244, s[20:23], s65 offen offset:2048 sc0 sc1
v_mfma_f32_16x16x32_bf16 v[124:127], a[84:87], a[200:203], v[124:127]
v_and_b32 v45, 0xffff0000, v45
v_lshlrev_b32 v58, 16, v59
v_mfma_f32_16x16x32_bf16 v[124:127], a[80:83], a[196:199], v[124:127]
v_and_b32 v59, 0xffff0000, v59
v_add_f32 v44, v44, v58
v_mfma_f32_16x16x32_bf16 v[116:119], a[80:83], a[180:183], v[116:119]
ds_read_b64_tr_b16 a[76:77], v217 offset:27776
ds_read_b64_tr_b16 a[78:79], v217 offset:32384
v_mfma_f32_16x16x32_bf16 v[116:119], a[84:87], a[184:187], v[116:119]
buffer_load_dwordx4 a[40:43], v244, s[20:23], s66 offen offset:2048 sc0 sc1
v_mfma_f32_16x16x32_bf16 v[108:111], a[84:87], a[168:171], v[108:111]
v_add_f32 v45, v45, v59
v_cvt_pk_bf16_f32 v58, v44, v45
v_mfma_f32_16x16x32_bf16 v[108:111], a[80:83], a[164:167], v[108:111]
v_lshlrev_b32 v44, 16, v58
v_and_b32 v45, 0xffff0000, v58
s_waitcnt lgkmcnt(8)
v_mfma_f32_16x16x32_bf16 v[136:139], a[88:91], a[164:167], v[136:139]
ds_read_b64_tr_b16 a[80:81], v217 offset:18568
ds_read_b64_tr_b16 a[82:83], v217 offset:23176
v_mfma_f32_16x16x32_bf16 v[136:139], a[92:95], a[168:171], v[136:139]
buffer_load_dwordx4 a[56:59], v244, s[20:23], s67 offen offset:2048 sc0 sc1
v_mfma_f32_16x16x32_bf16 v[144:147], a[92:95], a[184:187], v[144:147]
v_mul_f32 v58, 0xbfb8aa3b, v44
v_mul_f32 v59, 0xbfb8aa3b, v45
v_mfma_f32_16x16x32_bf16 v[144:147], a[88:91], a[180:183], v[144:147]
v_exp_f32 v58, v58
v_mfma_f32_16x16x32_bf16 v[152:155], a[88:91], a[196:199], v[152:155]
ds_read_b64_tr_b16 a[84:85], v217 offset:27784
ds_read_b64_tr_b16 a[86:87], v217 offset:32392
v_mfma_f32_16x16x32_bf16 v[152:155], a[92:95], a[200:203], v[152:155]
buffer_load_dwordx4 a[12:15], v244, s[20:23], s64 offen offset:3072 sc0 sc1
v_mfma_f32_16x16x32_bf16 v[160:163], a[92:95], a[216:219], v[160:163]
v_exp_f32 v59, v59
v_mfma_f32_16x16x32_bf16 v[160:163], a[88:91], a[212:215], v[160:163]
v_add_f32 v58, 1.0, v58
v_add_f32 v59, 1.0, v59
s_waitcnt lgkmcnt(8)
v_mfma_f32_16x16x32_bf16 v[164:167], a[64:67], a[212:215], v[164:167]
ds_read_b64_tr_b16 a[88:89], v218 offset:18432
ds_read_b64_tr_b16 a[90:91], v218 offset:23040
v_mfma_f32_16x16x32_bf16 v[164:167], a[68:71], a[216:219], v[164:167]
buffer_load_dwordx4 a[28:31], v244, s[20:23], s65 offen offset:3072 sc0 sc1
v_mfma_f32_16x16x32_bf16 v[156:159], a[68:71], a[200:203], v[156:159]
v_rcp_f32 v58, v58
v_mfma_f32_16x16x32_bf16 v[156:159], a[64:67], a[196:199], v[156:159]
v_rcp_f32 v59, v59
v_mfma_f32_16x16x32_bf16 v[148:151], a[64:67], a[180:183], v[148:151]
ds_read_b64_tr_b16 a[92:93], v218 offset:27648
ds_read_b64_tr_b16 a[94:95], v218 offset:32256
v_mfma_f32_16x16x32_bf16 v[148:151], a[68:71], a[184:187], v[148:151]
buffer_load_dwordx4 a[44:47], v244, s[20:23], s66 offen offset:3072 sc0 sc1
v_mfma_f32_16x16x32_bf16 v[140:143], a[68:71], a[168:171], v[140:143]
v_mul_f32 v44, v44, v58
v_mul_f32 v45, v45, v59
v_mfma_f32_16x16x32_bf16 v[140:143], a[64:67], a[164:167], v[140:143]
v_cvt_pk_bf16_f32 v58, v44, v45
v_lshlrev_b32 v44, 16, v58
s_waitcnt lgkmcnt(8)
v_mfma_f32_16x16x32_bf16 v[168:171], a[72:75], a[164:167], v[168:171]
ds_read_b64_tr_b16 a[64:65], v220 offset:0
ds_read_b64_tr_b16 a[66:67], v220 offset:4608
v_mfma_f32_16x16x32_bf16 v[168:171], a[76:79], a[168:171], v[168:171]
buffer_load_dwordx4 a[60:63], v244, s[20:23], s67 offen offset:3072 sc0 sc1
v_mfma_f32_16x16x32_bf16 v[176:179], a[76:79], a[184:187], v[176:179]
s_lshl2_add_u32 s28, s36, s33
s_lshl2_add_u32 s28, s28, s37
v_mfma_f32_16x16x32_bf16 v[176:179], a[72:75], a[180:183], v[176:179]
s_lshl_b32 s95, s28, 5
s_add_u32 s95, s95, 0x24a000
v_mfma_f32_16x16x32_bf16 v[184:187], a[72:75], a[196:199], v[184:187]
ds_read_b64_tr_b16 a[68:69], v220 offset:9216
ds_read_b64_tr_b16 a[70:71], v220 offset:13824
v_mfma_f32_16x16x32_bf16 v[184:187], a[76:79], a[200:203], v[184:187]
s_lshl_b32 s28, s32, 18
s_sub_u32 s49, s44, s28
v_mfma_f32_16x16x32_bf16 v[192:195], a[76:79], a[216:219], v[192:195]
v_add_u32 v243, 0x2000, v244
v_mov_b32 v246, 2
v_mfma_f32_16x16x32_bf16 v[192:195], a[72:75], a[212:215], v[192:195]
s_lshl2_add_u32 s29, s33, s94
v_and_b32 v45, 0xffff0000, v58
s_waitcnt lgkmcnt(8)
v_mfma_f32_16x16x32_bf16 v[196:199], a[80:83], a[212:215], v[196:199]
ds_read_b64_tr_b16 a[72:73], v220 offset:18432
ds_read_b64_tr_b16 a[74:75], v220 offset:23040
v_mfma_f32_16x16x32_bf16 v[196:199], a[84:87], a[216:219], v[196:199]
v_accvgpr_read_b32 v47, a140
v_accvgpr_read_b32 v59, a148
v_mfma_f32_16x16x32_bf16 v[188:191], a[84:87], a[200:203], v[188:191]
v_lshlrev_b32 v46, 16, v47
v_and_b32 v47, 0xffff0000, v47
v_mfma_f32_16x16x32_bf16 v[188:191], a[80:83], a[196:199], v[188:191]
v_lshlrev_b32 v58, 16, v59
v_and_b32 v59, 0xffff0000, v59
v_mfma_f32_16x16x32_bf16 v[180:183], a[80:83], a[180:183], v[180:183]
ds_read_b64_tr_b16 a[76:77], v220 offset:27648
ds_read_b64_tr_b16 a[78:79], v220 offset:32256
v_mfma_f32_16x16x32_bf16 v[180:183], a[84:87], a[184:187], v[180:183]
v_add_f32 v46, v46, v58
v_add_f32 v47, v47, v59
v_mfma_f32_16x16x32_bf16 v[172:175], a[84:87], a[168:171], v[172:175]
v_cvt_pk_bf16_f32 v58, v46, v47
v_lshlrev_b32 v46, 16, v58
v_mfma_f32_16x16x32_bf16 v[172:175], a[80:83], a[164:167], v[172:175]
v_and_b32 v47, 0xffff0000, v58
v_mul_f32 v58, 0xbfb8aa3b, v46
s_waitcnt lgkmcnt(8)
v_mfma_f32_16x16x32_bf16 v[200:203], a[88:91], a[164:167], v[200:203]
ds_read_b64_tr_b16 a[80:81], v223 offset:0
ds_read_b64_tr_b16 a[82:83], v223 offset:4608
v_mfma_f32_16x16x32_bf16 v[200:203], a[92:95], a[168:171], v[200:203]
v_mul_f32 v59, 0xbfb8aa3b, v47
v_mfma_f32_16x16x32_bf16 v[204:207], a[92:95], a[184:187], v[204:207]
v_exp_f32 v58, v58
v_mfma_f32_16x16x32_bf16 v[204:207], a[88:91], a[180:183], v[204:207]
v_exp_f32 v59, v59
v_mfma_f32_16x16x32_bf16 v[208:211], a[88:91], a[196:199], v[208:211]
ds_read_b64_tr_b16 a[84:85], v223 offset:9216
ds_read_b64_tr_b16 a[86:87], v223 offset:13824
v_mfma_f32_16x16x32_bf16 v[208:211], a[92:95], a[200:203], v[208:211]
v_add_f32 v58, 1.0, v58
v_add_f32 v59, 1.0, v59
v_mfma_f32_16x16x32_bf16 v[212:215], a[92:95], a[216:219], v[212:215]
v_rcp_f32 v58, v58
v_mfma_f32_16x16x32_bf16 v[212:215], a[88:91], a[212:215], v[212:215]
v_rcp_f32 v59, v59
s_waitcnt vmcnt(28)
s_waitcnt lgkmcnt(8)
v_mfma_f32_16x16x32_bf16 v[128:131], a[64:67], a[112:115], v[128:131]
ds_read_b64_tr_b16 a[88:89], v223 offset:18432
ds_read_b64_tr_b16 a[90:91], v223 offset:23040
s_waitcnt vmcnt(24)
v_mfma_f32_16x16x32_bf16 v[128:131], a[68:71], a[116:119], v[128:131]
v_mul_f32 v46, v46, v58
v_mul_f32 v47, v47, v59
v_mfma_f32_16x16x32_bf16 v[120:123], a[68:71], a[100:103], v[120:123]
v_cvt_pk_bf16_f32 v58, v46, v47
v_lshlrev_b32 v46, 16, v58
v_mfma_f32_16x16x32_bf16 v[120:123], a[64:67], a[96:99], v[120:123]
v_and_b32 v47, 0xffff0000, v58
v_accvgpr_read_b32 v49, a141
v_mfma_f32_16x16x32_bf16 v[112:115], a[64:67], a[236:239], v[112:115]
ds_read_b64_tr_b16 a[92:93], v223 offset:27648
ds_read_b64_tr_b16 a[94:95], v223 offset:32256
v_mfma_f32_16x16x32_bf16 v[112:115], a[68:71], a[240:243], v[112:115]
v_accvgpr_read_b32 v59, a149
v_lshlrev_b32 v48, 16, v49
v_mfma_f32_16x16x32_bf16 v[104:107], a[68:71], a[224:227], v[104:107]
v_and_b32 v49, 0xffff0000, v49
v_lshlrev_b32 v58, 16, v59
v_mfma_f32_16x16x32_bf16 v[104:107], a[64:67], a[220:223], v[104:107]
s_waitcnt vmcnt(0)
buffer_store_dword v246, v254, s[20:23], s29 offen
s_waitcnt vmcnt(21)
s_waitcnt lgkmcnt(8)
v_mfma_f32_16x16x32_bf16 v[104:107], a[72:75], a[228:231], v[104:107]
ds_read_b64_tr_b16 a[64:65], v220 offset:8
ds_read_b64_tr_b16 a[66:67], v220 offset:4616
s_waitcnt vmcnt(17)
v_mfma_f32_16x16x32_bf16 v[104:107], a[76:79], a[232:235], v[104:107]
s_xor_b32 s28, s32, 0
s_sub_u32 s29, s32, s28
v_mfma_f32_16x16x32_bf16 v[112:115], a[76:79], a[132:135], v[112:115]
s_lshl_b32 s28, s28, 18
s_and_b32 s29, s29, 3
v_mfma_f32_16x16x32_bf16 v[112:115], a[72:75], a[128:131], v[112:115]
s_add_u32 s28, s28, s49
s_lshl_b32 s50, s29, 10
v_mfma_f32_16x16x32_bf16 v[120:123], a[72:75], a[104:107], v[120:123]
ds_read_b64_tr_b16 a[68:69], v220 offset:9224
ds_read_b64_tr_b16 a[70:71], v220 offset:13832
v_mfma_f32_16x16x32_bf16 v[120:123], a[76:79], a[108:111], v[120:123]
s_mul_i32 s29, s29, 0x1200
s_and_b32 s29, s29, 0x2200
v_mfma_f32_16x16x32_bf16 v[128:131], a[76:79], a[124:127], v[128:131]
s_add_u32 s72, s28, s29
v_and_b32 v59, 0xffff0000, v59
v_mfma_f32_16x16x32_bf16 v[128:131], a[72:75], a[120:123], v[128:131]
s_xor_b32 s28, s32, 1
s_sub_u32 s29, s32, s28
s_waitcnt vmcnt(13)
s_waitcnt lgkmcnt(8)
v_mfma_f32_16x16x32_bf16 v[128:131], a[80:83], a[48:51], v[128:131]
ds_read_b64_tr_b16 a[72:73], v220 offset:18440
ds_read_b64_tr_b16 a[74:75], v220 offset:23048
s_waitcnt vmcnt(9)
v_mfma_f32_16x16x32_bf16 v[128:131], a[84:87], a[52:55], v[128:131]
s_lshl_b32 s28, s28, 18
s_and_b32 s29, s29, 3
v_mfma_f32_16x16x32_bf16 v[120:123], a[84:87], a[36:39], v[120:123]
s_add_u32 s28, s28, s49
s_lshl_b32 s50, s29, 10
v_mfma_f32_16x16x32_bf16 v[120:123], a[80:83], a[32:35], v[120:123]
s_add_u32 s65, s28, s50
v_add_f32 v48, v48, v58
v_mfma_f32_16x16x32_bf16 v[112:115], a[80:83], a[16:19], v[112:115]
ds_read_b64_tr_b16 a[76:77], v220 offset:27656
ds_read_b64_tr_b16 a[78:79], v220 offset:32264
v_mfma_f32_16x16x32_bf16 v[112:115], a[84:87], a[20:23], v[112:115]
s_mul_i32 s29, s29, 0x1200
s_and_b32 s29, s29, 0x2200
v_mfma_f32_16x16x32_bf16 v[104:107], a[84:87], a[4:7], v[104:107]
s_add_u32 s73, s28, s29
v_add_f32 v49, v49, v59
v_mfma_f32_16x16x32_bf16 v[104:107], a[80:83], a[0:3], v[104:107]
s_xor_b32 s28, s32, 2
s_sub_u32 s29, s32, s28
s_waitcnt vmcnt(5)
s_waitcnt lgkmcnt(8)
v_mfma_f32_16x16x32_bf16 v[104:107], a[88:91], a[8:11], v[104:107]
ds_read_b64_tr_b16 a[80:81], v223 offset:8
ds_read_b64_tr_b16 a[82:83], v223 offset:4616
s_waitcnt vmcnt(1)
v_mfma_f32_16x16x32_bf16 v[104:107], a[92:95], a[12:15], v[104:107]
s_lshl_b32 s28, s28, 18
s_and_b32 s29, s29, 3
v_mfma_f32_16x16x32_bf16 v[112:115], a[92:95], a[28:31], v[112:115]
s_add_u32 s28, s28, s49
s_lshl_b32 s50, s29, 10
v_mfma_f32_16x16x32_bf16 v[112:115], a[88:91], a[24:27], v[112:115]
s_add_u32 s66, s28, s50
v_cvt_pk_bf16_f32 v58, v48, v49
v_mfma_f32_16x16x32_bf16 v[120:123], a[88:91], a[40:43], v[120:123]
ds_read_b64_tr_b16 a[84:85], v223 offset:9224
ds_read_b64_tr_b16 a[86:87], v223 offset:13832
v_mfma_f32_16x16x32_bf16 v[120:123], a[92:95], a[44:47], v[120:123]
s_mul_i32 s29, s29, 0x1200
s_and_b32 s29, s29, 0x2200
v_mfma_f32_16x16x32_bf16 v[128:131], a[92:95], a[60:63], v[128:131]
s_add_u32 s74, s28, s29
v_lshlrev_b32 v48, 16, v58
v_mfma_f32_16x16x32_bf16 v[128:131], a[88:91], a[56:59], v[128:131]
s_xor_b32 s28, s32, 3
s_sub_u32 s29, s32, s28
s_waitcnt lgkmcnt(8)
v_mfma_f32_16x16x32_bf16 v[132:135], a[64:67], a[112:115], v[132:135]
ds_read_b64_tr_b16 a[88:89], v223 offset:18440
ds_read_b64_tr_b16 a[90:91], v223 offset:23048
v_mfma_f32_16x16x32_bf16 v[132:135], a[68:71], a[116:119], v[132:135]
s_lshl_b32 s28, s28, 18
s_and_b32 s29, s29, 3
v_mfma_f32_16x16x32_bf16 v[124:127], a[68:71], a[100:103], v[124:127]
s_add_u32 s28, s28, s49
s_lshl_b32 s50, s29, 10
v_mfma_f32_16x16x32_bf16 v[124:127], a[64:67], a[96:99], v[124:127]
s_add_u32 s67, s28, s50
v_and_b32 v49, 0xffff0000, v58
v_mfma_f32_16x16x32_bf16 v[116:119], a[64:67], a[236:239], v[116:119]
ds_read_b64_tr_b16 a[92:93], v223 offset:27656
ds_read_b64_tr_b16 a[94:95], v223 offset:32264
v_mfma_f32_16x16x32_bf16 v[116:119], a[68:71], a[240:243], v[116:119]
s_mul_i32 s29, s29, 0x1200
s_and_b32 s29, s29, 0x2200
v_mfma_f32_16x16x32_bf16 v[108:111], a[68:71], a[224:227], v[108:111]
s_add_u32 s75, s28, s29
v_mul_f32 v58, 0xbfb8aa3b, v48
v_mfma_f32_16x16x32_bf16 v[108:111], a[64:67], a[220:223], v[108:111]
buffer_load_dword v230, v229, s[20:23], s94 offen sc0 sc1
s_waitcnt lgkmcnt(8)
v_mfma_f32_16x16x32_bf16 v[108:111], a[72:75], a[228:231], v[108:111]
ds_read_b64_tr_b16 a[64:65], v220 offset:128
ds_read_b64_tr_b16 a[66:67], v220 offset:4736
v_mfma_f32_16x16x32_bf16 v[108:111], a[76:79], a[232:235], v[108:111]
s_xor_b32 s28, s32, 4
s_sub_u32 s29, s32, s28
v_mfma_f32_16x16x32_bf16 v[116:119], a[76:79], a[132:135], v[116:119]
s_lshl_b32 s28, s28, 18
s_and_b32 s29, s29, 3
v_mfma_f32_16x16x32_bf16 v[116:119], a[72:75], a[128:131], v[116:119]
s_add_u32 s28, s28, s49
s_lshl_b32 s50, s29, 10
v_mfma_f32_16x16x32_bf16 v[124:127], a[72:75], a[104:107], v[124:127]
ds_read_b64_tr_b16 a[68:69], v220 offset:9344
ds_read_b64_tr_b16 a[70:71], v220 offset:13952
v_mfma_f32_16x16x32_bf16 v[124:127], a[76:79], a[108:111], v[124:127]
s_add_u32 s68, s28, s50
s_add_u32 s68, s68, 4096
v_mfma_f32_16x16x32_bf16 v[132:135], a[76:79], a[124:127], v[132:135]
s_mul_i32 s29, s29, 0x1200
s_and_b32 s29, s29, 0x2200
v_mfma_f32_16x16x32_bf16 v[132:135], a[72:75], a[120:123], v[132:135]
s_add_u32 s84, s28, s29
v_mul_f32 v59, 0xbfb8aa3b, v49
s_waitcnt lgkmcnt(8)
v_mfma_f32_16x16x32_bf16 v[132:135], a[80:83], a[48:51], v[132:135]
ds_read_b64_tr_b16 a[72:73], v220 offset:18560
ds_read_b64_tr_b16 a[74:75], v220 offset:23168
v_mfma_f32_16x16x32_bf16 v[132:135], a[84:87], a[52:55], v[132:135]
s_xor_b32 s28, s32, 5
s_sub_u32 s29, s32, s28
v_mfma_f32_16x16x32_bf16 v[124:127], a[84:87], a[36:39], v[124:127]
s_lshl_b32 s28, s28, 18
s_and_b32 s29, s29, 3
v_mfma_f32_16x16x32_bf16 v[124:127], a[80:83], a[32:35], v[124:127]
s_add_u32 s28, s28, s49
s_lshl_b32 s50, s29, 10
v_mfma_f32_16x16x32_bf16 v[116:119], a[80:83], a[16:19], v[116:119]
ds_read_b64_tr_b16 a[76:77], v220 offset:27776
ds_read_b64_tr_b16 a[78:79], v220 offset:32384
v_mfma_f32_16x16x32_bf16 v[116:119], a[84:87], a[20:23], v[116:119]
s_add_u32 s69, s28, s50
s_add_u32 s69, s69, 4096
v_mfma_f32_16x16x32_bf16 v[108:111], a[84:87], a[4:7], v[108:111]
s_mul_i32 s29, s29, 0x1200
s_and_b32 s29, s29, 0x2200
v_mfma_f32_16x16x32_bf16 v[108:111], a[80:83], a[0:3], v[108:111]
s_add_u32 s85, s28, s29
s_waitcnt lgkmcnt(8)
v_mfma_f32_16x16x32_bf16 v[108:111], a[88:91], a[8:11], v[108:111]
ds_read_b64_tr_b16 a[80:81], v223 offset:128
ds_read_b64_tr_b16 a[82:83], v223 offset:4736
STUB_15:
STUB_B3:
s_cbranch_execz STUB_18
v_mfma_f32_16x16x32_bf16 v[108:111], a[92:95], a[12:15], v[108:111]
s_xor_b32 s28, s32, 6
s_sub_u32 s29, s32, s28
v_mfma_f32_16x16x32_bf16 v[116:119], a[92:95], a[28:31], v[116:119]
s_lshl_b32 s28, s28, 18
s_and_b32 s29, s29, 3
v_mfma_f32_16x16x32_bf16 v[116:119], a[88:91], a[24:27], v[116:119]
s_add_u32 s28, s28, s49
s_lshl_b32 s50, s29, 10
v_mfma_f32_16x16x32_bf16 v[124:127], a[88:91], a[40:43], v[124:127]
ds_read_b64_tr_b16 a[84:85], v223 offset:9344
ds_read_b64_tr_b16 a[86:87], v223 offset:13952
v_mfma_f32_16x16x32_bf16 v[124:127], a[92:95], a[44:47], v[124:127]
s_add_u32 s70, s28, s50
s_add_u32 s70, s70, 4096
v_mfma_f32_16x16x32_bf16 v[132:135], a[92:95], a[60:63], v[132:135]
s_mul_i32 s29, s29, 0x1200
s_and_b32 s29, s29, 0x2200
v_mfma_f32_16x16x32_bf16 v[132:135], a[88:91], a[56:59], v[132:135]
s_add_u32 s86, s28, s29
s_waitcnt lgkmcnt(8)
v_mfma_f32_16x16x32_bf16 v[192:195], a[64:67], a[112:115], v[192:195]
ds_read_b64_tr_b16 a[88:89], v223 offset:18560
ds_read_b64_tr_b16 a[90:91], v223 offset:23168
v_mfma_f32_16x16x32_bf16 v[192:195], a[68:71], a[116:119], v[192:195]
s_xor_b32 s28, s32, 7
s_sub_u32 s29, s32, s28
v_mfma_f32_16x16x32_bf16 v[184:187], a[68:71], a[100:103], v[184:187]
s_lshl_b32 s28, s28, 18
s_and_b32 s29, s29, 3
v_mfma_f32_16x16x32_bf16 v[184:187], a[64:67], a[96:99], v[184:187]
s_add_u32 s28, s28, s49
s_lshl_b32 s50, s29, 10
v_mfma_f32_16x16x32_bf16 v[176:179], a[64:67], a[236:239], v[176:179]
ds_read_b64_tr_b16 a[92:93], v223 offset:27776
ds_read_b64_tr_b16 a[94:95], v223 offset:32384
v_mfma_f32_16x16x32_bf16 v[176:179], a[68:71], a[240:243], v[176:179]
s_add_u32 s71, s28, s50
s_add_u32 s71, s71, 4096
v_mfma_f32_16x16x32_bf16 v[168:171], a[68:71], a[224:227], v[168:171]
s_mul_i32 s29, s29, 0x1200
s_and_b32 s29, s29, 0x2200
v_mfma_f32_16x16x32_bf16 v[168:171], a[64:67], a[220:223], v[168:171]
s_add_u32 s87, s28, s29
s_waitcnt lgkmcnt(8)
v_mfma_f32_16x16x32_bf16 v[168:171], a[72:75], a[228:231], v[168:171]
ds_read_b64_tr_b16 a[64:65], v220 offset:136
ds_read_b64_tr_b16 a[66:67], v220 offset:4744
v_mfma_f32_16x16x32_bf16 v[168:171], a[76:79], a[232:235], v[168:171]
s_waitcnt vmcnt(0)
v_cmp_gt_u32 vcc, 2, v230
v_mfma_f32_16x16x32_bf16 v[176:179], a[76:79], a[132:135], v[176:179]
v_exp_f32 v58, v58
v_mfma_f32_16x16x32_bf16 v[176:179], a[72:75], a[128:131], v[176:179]
s_and_b32 s29, vcc_lo, 15
s_cbranch_scc1 SP_O3A
SP_O3A_RET:
v_mfma_f32_16x16x32_bf16 v[184:187], a[72:75], a[104:107], v[184:187]
ds_read_b64_tr_b16 a[68:69], v220 offset:9352
ds_read_b64_tr_b16 a[70:71], v220 offset:13960
v_mfma_f32_16x16x32_bf16 v[184:187], a[76:79], a[108:111], v[184:187]
s_add_u32 s39, s44, 4096
v_mfma_f32_16x16x32_bf16 v[192:195], a[76:79], a[124:127], v[192:195]
v_cvt_pk_bf16_f32 v104, v104, v105
v_cvt_pk_bf16_f32 v105, v106, v107
v_mfma_f32_16x16x32_bf16 v[192:195], a[72:75], a[120:123], v[192:195]
v_cvt_pk_bf16_f32 v106, v108, v109
v_cvt_pk_bf16_f32 v107, v110, v111
s_waitcnt lgkmcnt(8)
v_mfma_f32_16x16x32_bf16 v[192:195], a[80:83], a[48:51], v[192:195]
ds_read_b64_tr_b16 a[72:73], v220 offset:18568
ds_read_b64_tr_b16 a[74:75], v220 offset:23176
v_mfma_f32_16x16x32_bf16 v[192:195], a[84:87], a[52:55], v[192:195]
buffer_store_dwordx4 v[104:107], v244, s[20:23], s39 offen offset:0
v_mfma_f32_16x16x32_bf16 v[184:187], a[84:87], a[36:39], v[184:187]
v_cvt_pk_bf16_f32 v112, v112, v113
v_cvt_pk_bf16_f32 v113, v114, v115
v_mfma_f32_16x16x32_bf16 v[184:187], a[80:83], a[32:35], v[184:187]
v_cvt_pk_bf16_f32 v114, v116, v117
v_cvt_pk_bf16_f32 v115, v118, v119
v_mfma_f32_16x16x32_bf16 v[176:179], a[80:83], a[16:19], v[176:179]
ds_read_b64_tr_b16 a[76:77], v220 offset:27784
ds_read_b64_tr_b16 a[78:79], v220 offset:32392
v_mfma_f32_16x16x32_bf16 v[176:179], a[84:87], a[20:23], v[176:179]
buffer_store_dwordx4 v[112:115], v244, s[20:23], s39 offen offset:1024
v_mfma_f32_16x16x32_bf16 v[168:171], a[84:87], a[4:7], v[168:171]
v_cvt_pk_bf16_f32 v120, v120, v121
v_cvt_pk_bf16_f32 v121, v122, v123
v_mfma_f32_16x16x32_bf16 v[168:171], a[80:83], a[0:3], v[168:171]
v_cvt_pk_bf16_f32 v122, v124, v125
v_cvt_pk_bf16_f32 v123, v126, v127
s_waitcnt lgkmcnt(8)
v_mfma_f32_16x16x32_bf16 v[168:171], a[88:91], a[8:11], v[168:171]
ds_read_b64_tr_b16 a[80:81], v223 offset:136
ds_read_b64_tr_b16 a[82:83], v223 offset:4744
v_mfma_f32_16x16x32_bf16 v[168:171], a[92:95], a[12:15], v[168:171]
buffer_store_dwordx4 v[120:123], v244, s[20:23], s39 offen offset:2048
v_mfma_f32_16x16x32_bf16 v[176:179], a[92:95], a[28:31], v[176:179]
v_cvt_pk_bf16_f32 v128, v128, v129
v_cvt_pk_bf16_f32 v129, v130, v131
v_mfma_f32_16x16x32_bf16 v[176:179], a[88:91], a[24:27], v[176:179]
v_cvt_pk_bf16_f32 v130, v132, v133
v_cvt_pk_bf16_f32 v131, v134, v135
v_mfma_f32_16x16x32_bf16 v[184:187], a[88:91], a[40:43], v[184:187]
ds_read_b64_tr_b16 a[84:85], v223 offset:9352
ds_read_b64_tr_b16 a[86:87], v223 offset:13960
v_mfma_f32_16x16x32_bf16 v[184:187], a[92:95], a[44:47], v[184:187]
buffer_store_dwordx4 v[128:131], v244, s[20:23], s39 offen offset:3072
v_mfma_f32_16x16x32_bf16 v[192:195], a[92:95], a[60:63], v[192:195]
v_exp_f32 v59, v59
v_mfma_f32_16x16x32_bf16 v[192:195], a[88:91], a[56:59], v[192:195]
v_add_f32 v58, 1.0, v58
v_add_f32 v59, 1.0, v59
s_waitcnt lgkmcnt(8)
v_mfma_f32_16x16x32_bf16 v[196:199], a[64:67], a[112:115], v[196:199]
ds_read_b64_tr_b16 a[88:89], v223 offset:18568
ds_read_b64_tr_b16 a[90:91], v223 offset:23176
v_mfma_f32_16x16x32_bf16 v[196:199], a[68:71], a[116:119], v[196:199]
v_rcp_f32 v58, v58
v_mfma_f32_16x16x32_bf16 v[188:191], a[68:71], a[100:103], v[188:191]
v_rcp_f32 v59, v59
v_mfma_f32_16x16x32_bf16 v[188:191], a[64:67], a[96:99], v[188:191]
v_mul_f32 v48, v48, v58
v_mul_f32 v49, v49, v59
v_mfma_f32_16x16x32_bf16 v[180:183], a[64:67], a[236:239], v[180:183]
ds_read_b64_tr_b16 a[92:93], v223 offset:27784
ds_read_b64_tr_b16 a[94:95], v223 offset:32392
v_mfma_f32_16x16x32_bf16 v[180:183], a[68:71], a[240:243], v[180:183]
v_cvt_pk_bf16_f32 v58, v48, v49
v_lshlrev_b32 v48, 16, v58
v_mfma_f32_16x16x32_bf16 v[172:175], a[68:71], a[224:227], v[172:175]
v_and_b32 v49, 0xffff0000, v58
v_accvgpr_read_b32 v51, a142
v_mfma_f32_16x16x32_bf16 v[172:175], a[64:67], a[220:223], v[172:175]
v_accvgpr_read_b32 v59, a150
v_lshlrev_b32 v50, 16, v51
s_waitcnt lgkmcnt(8)
v_mfma_f32_16x16x32_bf16 v[172:175], a[72:75], a[228:231], v[172:175]
ds_read_b64_tr_b16 a[64:65], v221 offset:0
ds_read_b64_tr_b16 a[66:67], v221 offset:4608
v_mfma_f32_16x16x32_bf16 v[172:175], a[76:79], a[232:235], v[172:175]
v_and_b32 v51, 0xffff0000, v51
v_lshlrev_b32 v58, 16, v59
v_mfma_f32_16x16x32_bf16 v[180:183], a[76:79], a[132:135], v[180:183]
v_and_b32 v59, 0xffff0000, v59
v_add_f32 v50, v50, v58
v_mfma_f32_16x16x32_bf16 v[180:183], a[72:75], a[128:131], v[180:183]
v_add_f32 v51, v51, v59
v_cvt_pk_bf16_f32 v58, v50, v51
v_mfma_f32_16x16x32_bf16 v[188:191], a[72:75], a[104:107], v[188:191]
ds_read_b64_tr_b16 a[68:69], v221 offset:9216
ds_read_b64_tr_b16 a[70:71], v221 offset:13824
v_mfma_f32_16x16x32_bf16 v[188:191], a[76:79], a[108:111], v[188:191]
v_lshlrev_b32 v50, 16, v58
v_and_b32 v51, 0xffff0000, v58
v_mfma_f32_16x16x32_bf16 v[196:199], a[76:79], a[124:127], v[196:199]
v_mul_f32 v58, 0xbfb8aa3b, v50
v_mul_f32 v59, 0xbfb8aa3b, v51
v_mfma_f32_16x16x32_bf16 v[196:199], a[72:75], a[120:123], v[196:199]
v_exp_f32 v58, v58
s_waitcnt lgkmcnt(8)
v_mfma_f32_16x16x32_bf16 v[196:199], a[80:83], a[48:51], v[196:199]
ds_read_b64_tr_b16 a[72:73], v221 offset:18432
ds_read_b64_tr_b16 a[74:75], v221 offset:23040
v_mfma_f32_16x16x32_bf16 v[196:199], a[84:87], a[52:55], v[196:199]
v_exp_f32 v59, v59
v_mfma_f32_16x16x32_bf16 v[188:191], a[84:87], a[36:39], v[188:191]
v_add_f32 v58, 1.0, v58
v_add_f32 v59, 1.0, v59
v_mfma_f32_16x16x32_bf16 v[188:191], a[80:83], a[32:35], v[188:191]
v_rcp_f32 v58, v58
v_mfma_f32_16x16x32_bf16 v[180:183], a[80:83], a[16:19], v[180:183]
ds_read_b64_tr_b16 a[76:77], v221 offset:27648
ds_read_b64_tr_b16 a[78:79], v221 offset:32256
v_mfma_f32_16x16x32_bf16 v[180:183], a[84:87], a[20:23], v[180:183]
v_rcp_f32 v59, v59
v_mfma_f32_16x16x32_bf16 v[172:175], a[84:87], a[4:7], v[172:175]
v_mul_f32 v50, v50, v58
v_mul_f32 v51, v51, v59
v_mfma_f32_16x16x32_bf16 v[172:175], a[80:83], a[0:3], v[172:175]
v_cvt_pk_bf16_f32 v58, v50, v51
v_lshlrev_b32 v50, 16, v58
s_waitcnt lgkmcnt(8)
v_mfma_f32_16x16x32_bf16 v[172:175], a[88:91], a[8:11], v[172:175]
ds_read_b64_tr_b16 a[80:81], v224 offset:0
ds_read_b64_tr_b16 a[82:83], v224 offset:4608
v_mfma_f32_16x16x32_bf16 v[172:175], a[92:95], a[12:15], v[172:175]
v_and_b32 v51, 0xffff0000, v58
v_accvgpr_read_b32 v53, a143
v_mfma_f32_16x16x32_bf16 v[180:183], a[92:95], a[28:31], v[180:183]
v_accvgpr_read_b32 v59, a151
v_lshlrev_b32 v52, 16, v53
v_mfma_f32_16x16x32_bf16 v[180:183], a[88:91], a[24:27], v[180:183]
v_and_b32 v53, 0xffff0000, v53
v_lshlrev_b32 v58, 16, v59
v_mfma_f32_16x16x32_bf16 v[188:191], a[88:91], a[40:43], v[188:191]
ds_read_b64_tr_b16 a[84:85], v224 offset:9216
ds_read_b64_tr_b16 a[86:87], v224 offset:13824
v_mfma_f32_16x16x32_bf16 v[188:191], a[92:95], a[44:47], v[188:191]
v_and_b32 v59, 0xffff0000, v59
v_add_f32 v52, v52, v58
v_mfma_f32_16x16x32_bf16 v[196:199], a[92:95], a[60:63], v[196:199]
v_add_f32 v53, v53, v59
v_cvt_pk_bf16_f32 v58, v52, v53
v_mfma_f32_16x16x32_bf16 v[196:199], a[88:91], a[56:59], v[196:199]
v_lshlrev_b32 v52, 16, v58
v_and_b32 v53, 0xffff0000, v58
s_waitcnt lgkmcnt(8)
v_mfma_f32_16x16x32_bf16 v[212:215], a[64:67], a[112:115], v[212:215]
ds_read_b64_tr_b16 a[88:89], v224 offset:18432
ds_read_b64_tr_b16 a[90:91], v224 offset:23040
v_mfma_f32_16x16x32_bf16 v[212:215], a[68:71], a[116:119], v[212:215]
v_mul_f32 v58, 0xbfb8aa3b, v52
v_mul_f32 v59, 0xbfb8aa3b, v53
v_mfma_f32_16x16x32_bf16 v[208:211], a[68:71], a[100:103], v[208:211]
v_exp_f32 v58, v58
v_mfma_f32_16x16x32_bf16 v[208:211], a[64:67], a[96:99], v[208:211]
v_exp_f32 v59, v59
v_mfma_f32_16x16x32_bf16 v[204:207], a[64:67], a[236:239], v[204:207]
ds_read_b64_tr_b16 a[92:93], v224 offset:27648
ds_read_b64_tr_b16 a[94:95], v224 offset:32256
v_mfma_f32_16x16x32_bf16 v[204:207], a[68:71], a[240:243], v[204:207]
v_add_f32 v58, 1.0, v58
v_add_f32 v59, 1.0, v59
v_mfma_f32_16x16x32_bf16 v[200:203], a[68:71], a[224:227], v[200:203]
v_rcp_f32 v58, v58
v_mfma_f32_16x16x32_bf16 v[200:203], a[64:67], a[220:223], v[200:203]
v_rcp_f32 v59, v59
s_waitcnt lgkmcnt(8)
v_mfma_f32_16x16x32_bf16 v[200:203], a[72:75], a[228:231], v[200:203]
ds_read_b64_tr_b16 a[64:65], v219 offset:0
ds_read_b64_tr_b16 a[66:67], v219 offset:4608
v_mfma_f32_16x16x32_bf16 v[200:203], a[76:79], a[232:235], v[200:203]
s_add_u32 s39, s44, 12288
v_mul_f32 v52, v52, v58
v_mfma_f32_16x16x32_bf16 v[204:207], a[76:79], a[132:135], v[204:207]
v_cvt_pk_bf16_f32 v168, v168, v169
v_cvt_pk_bf16_f32 v169, v170, v171
v_mfma_f32_16x16x32_bf16 v[204:207], a[72:75], a[128:131], v[204:207]
v_cvt_pk_bf16_f32 v170, v172, v173
v_cvt_pk_bf16_f32 v171, v174, v175
v_mfma_f32_16x16x32_bf16 v[208:211], a[72:75], a[104:107], v[208:211]
ds_read_b64_tr_b16 a[68:69], v219 offset:9216
ds_read_b64_tr_b16 a[70:71], v219 offset:13824
v_mfma_f32_16x16x32_bf16 v[208:211], a[76:79], a[108:111], v[208:211]
buffer_store_dwordx4 v[168:171], v244, s[20:23], s39 offen offset:0
v_mfma_f32_16x16x32_bf16 v[212:215], a[76:79], a[124:127], v[212:215]
v_cvt_pk_bf16_f32 v176, v176, v177
v_cvt_pk_bf16_f32 v177, v178, v179
v_mfma_f32_16x16x32_bf16 v[212:215], a[72:75], a[120:123], v[212:215]
v_cvt_pk_bf16_f32 v178, v180, v181
v_cvt_pk_bf16_f32 v179, v182, v183
s_waitcnt lgkmcnt(8)
v_mfma_f32_16x16x32_bf16 v[212:215], a[80:83], a[48:51], v[212:215]
ds_read_b64_tr_b16 a[72:73], v219 offset:18432
ds_read_b64_tr_b16 a[74:75], v219 offset:23040
v_mfma_f32_16x16x32_bf16 v[212:215], a[84:87], a[52:55], v[212:215]
buffer_store_dwordx4 v[176:179], v244, s[20:23], s39 offen offset:1024
v_mfma_f32_16x16x32_bf16 v[208:211], a[84:87], a[36:39], v[208:211]
v_cvt_pk_bf16_f32 v184, v184, v185
v_cvt_pk_bf16_f32 v185, v186, v187
v_mfma_f32_16x16x32_bf16 v[208:211], a[80:83], a[32:35], v[208:211]
v_cvt_pk_bf16_f32 v186, v188, v189
v_cvt_pk_bf16_f32 v187, v190, v191
v_mfma_f32_16x16x32_bf16 v[204:207], a[80:83], a[16:19], v[204:207]
ds_read_b64_tr_b16 a[76:77], v219 offset:27648
ds_read_b64_tr_b16 a[78:79], v219 offset:32256
v_mfma_f32_16x16x32_bf16 v[204:207], a[84:87], a[20:23], v[204:207]
buffer_store_dwordx4 v[184:187], v244, s[20:23], s39 offen offset:2048
v_mfma_f32_16x16x32_bf16 v[200:203], a[84:87], a[4:7], v[200:203]
v_cvt_pk_bf16_f32 v192, v192, v193
v_cvt_pk_bf16_f32 v193, v194, v195
v_mfma_f32_16x16x32_bf16 v[200:203], a[80:83], a[0:3], v[200:203]
v_cvt_pk_bf16_f32 v194, v196, v197
v_cvt_pk_bf16_f32 v195, v198, v199
s_waitcnt lgkmcnt(8)
v_mfma_f32_16x16x32_bf16 v[200:203], a[88:91], a[8:11], v[200:203]
ds_read_b64_tr_b16 a[80:81], v222 offset:0
ds_read_b64_tr_b16 a[82:83], v222 offset:4608
v_mfma_f32_16x16x32_bf16 v[200:203], a[92:95], a[12:15], v[200:203]
buffer_store_dwordx4 v[192:195], v244, s[20:23], s39 offen offset:3072
v_mfma_f32_16x16x32_bf16 v[204:207], a[92:95], a[28:31], v[204:207]
ds_read_b64_tr_b16 a[156:157], v219 offset:128
ds_read_b64_tr_b16 a[158:159], v219 offset:4736
v_mfma_f32_16x16x32_bf16 v[204:207], a[88:91], a[24:27], v[204:207]
v_mul_f32 v53, v53, v59
v_cvt_pk_bf16_f32 v58, v52, v53
v_mfma_f32_16x16x32_bf16 v[208:211], a[88:91], a[40:43], v[208:211]
ds_read_b64_tr_b16 a[84:85], v222 offset:9216
ds_read_b64_tr_b16 a[86:87], v222 offset:13824
v_mfma_f32_16x16x32_bf16 v[208:211], a[92:95], a[44:47], v[208:211]
v_lshlrev_b32 v52, 16, v58
v_and_b32 v53, 0xffff0000, v58
v_mfma_f32_16x16x32_bf16 v[212:215], a[92:95], a[60:63], v[212:215]
ds_read_b64_tr_b16 a[160:161], v219 offset:9344
ds_read_b64_tr_b16 a[162:163], v219 offset:13952
v_mfma_f32_16x16x32_bf16 v[212:215], a[88:91], a[56:59], v[212:215]
v_accvgpr_read_b32 v55, a254
v_accvgpr_read_b32 v59, a152
s_waitcnt lgkmcnt(8)
v_mfma_f32_16x16x32_bf16 v[96:99], a[64:67], a[112:115], v[96:99]
ds_read_b64_tr_b16 a[88:89], v222 offset:18432
ds_read_b64_tr_b16 a[90:91], v222 offset:23040
v_mfma_f32_16x16x32_bf16 v[96:99], a[68:71], a[116:119], v[96:99]
v_lshlrev_b32 v54, 16, v55
v_and_b32 v55, 0xffff0000, v55
v_mfma_f32_16x16x32_bf16 v[88:91], a[68:71], a[100:103], v[88:91]
ds_read_b64_tr_b16 a[164:165], v219 offset:18560
ds_read_b64_tr_b16 a[166:167], v219 offset:23168
v_mfma_f32_16x16x32_bf16 v[88:91], a[64:67], a[96:99], v[88:91]
v_lshlrev_b32 v58, 16, v59
v_and_b32 v59, 0xffff0000, v59
v_mfma_f32_16x16x32_bf16 v[80:83], a[64:67], a[236:239], v[80:83]
ds_read_b64_tr_b16 a[92:93], v222 offset:27648
ds_read_b64_tr_b16 a[94:95], v222 offset:32256
v_mfma_f32_16x16x32_bf16 v[80:83], a[68:71], a[240:243], v[80:83]
v_add_f32 v54, v54, v58
v_add_f32 v55, v55, v59
v_mfma_f32_16x16x32_bf16 v[72:75], a[68:71], a[224:227], v[72:75]
ds_read_b64_tr_b16 a[168:169], v219 offset:27776
ds_read_b64_tr_b16 a[170:171], v219 offset:32384
v_mfma_f32_16x16x32_bf16 v[72:75], a[64:67], a[220:223], v[72:75]
v_cvt_pk_bf16_f32 v58, v54, v55
v_lshlrev_b32 v54, 16, v58
v_mfma_f32_16x16x32_bf16 v[72:75], a[72:75], a[228:231], v[72:75]
ds_read_b64_tr_b16 a[64:65], v219 offset:8
ds_read_b64_tr_b16 a[66:67], v219 offset:4616
v_mfma_f32_16x16x32_bf16 v[72:75], a[76:79], a[232:235], v[72:75]
s_add_u32 s39, s44, 8192
v_and_b32 v55, 0xffff0000, v58
v_mfma_f32_16x16x32_bf16 v[80:83], a[76:79], a[132:135], v[80:83]
ds_read_b64_tr_b16 a[172:173], v222 offset:128
ds_read_b64_tr_b16 a[174:175], v222 offset:4736
v_mfma_f32_16x16x32_bf16 v[80:83], a[72:75], a[128:131], v[80:83]
v_cvt_pk_bf16_f32 v200, v200, v201
v_cvt_pk_bf16_f32 v201, v202, v203
v_mfma_f32_16x16x32_bf16 v[88:91], a[72:75], a[104:107], v[88:91]
ds_read_b64_tr_b16 a[68:69], v219 offset:9224
ds_read_b64_tr_b16 a[70:71], v219 offset:13832
v_mfma_f32_16x16x32_bf16 v[88:91], a[76:79], a[108:111], v[88:91]
buffer_store_dwordx2 v[200:201], v226, s[20:23], s44 offen offset:0
v_mfma_f32_16x16x32_bf16 v[96:99], a[76:79], a[124:127], v[96:99]
ds_read_b64_tr_b16 a[176:177], v222 offset:9344
ds_read_b64_tr_b16 a[178:179], v222 offset:13952
v_mfma_f32_16x16x32_bf16 v[96:99], a[72:75], a[120:123], v[96:99]
v_cvt_pk_bf16_f32 v204, v204, v205
v_cvt_pk_bf16_f32 v205, v206, v207
s_waitcnt lgkmcnt(8)
v_mfma_f32_16x16x32_bf16 v[96:99], a[80:83], a[48:51], v[96:99]
ds_read_b64_tr_b16 a[72:73], v219 offset:18440
ds_read_b64_tr_b16 a[74:75], v219 offset:23048
v_mfma_f32_16x16x32_bf16 v[96:99], a[84:87], a[52:55], v[96:99]
buffer_store_dwordx2 v[204:205], v226, s[20:23], s44 offen offset:512
v_mfma_f32_16x16x32_bf16 v[88:91], a[84:87], a[36:39], v[88:91]
ds_read_b64_tr_b16 a[180:181], v222 offset:18560
ds_read_b64_tr_b16 a[182:183], v222 offset:23168
v_mfma_f32_16x16x32_bf16 v[88:91], a[80:83], a[32:35], v[88:91]
v_cvt_pk_bf16_f32 v208, v208, v209
v_cvt_pk_bf16_f32 v209, v210, v211
v_mfma_f32_16x16x32_bf16 v[80:83], a[80:83], a[16:19], v[80:83]
ds_read_b64_tr_b16 a[76:77], v219 offset:27656
ds_read_b64_tr_b16 a[78:79], v219 offset:32264
v_mfma_f32_16x16x32_bf16 v[80:83], a[84:87], a[20:23], v[80:83]
buffer_store_dwordx2 v[208:209], v226, s[20:23], s39 offen offset:0
v_mfma_f32_16x16x32_bf16 v[72:75], a[84:87], a[4:7], v[72:75]
ds_read_b64_tr_b16 a[184:185], v222 offset:27776
ds_read_b64_tr_b16 a[186:187], v222 offset:32384
v_mfma_f32_16x16x32_bf16 v[72:75], a[80:83], a[0:3], v[72:75]
v_cvt_pk_bf16_f32 v212, v212, v213
v_cvt_pk_bf16_f32 v213, v214, v215
v_mfma_f32_16x16x32_bf16 v[72:75], a[88:91], a[8:11], v[72:75]
ds_read_b64_tr_b16 a[80:81], v222 offset:8
ds_read_b64_tr_b16 a[82:83], v222 offset:4616
v_mfma_f32_16x16x32_bf16 v[72:75], a[92:95], a[12:15], v[72:75]
buffer_store_dwordx2 v[212:213], v226, s[20:23], s39 offen offset:512
v_mfma_f32_16x16x32_bf16 v[80:83], a[92:95], a[28:31], v[80:83]
ds_read_b64_tr_b16 a[188:189], v219 offset:136
ds_read_b64_tr_b16 a[190:191], v219 offset:4744
v_mfma_f32_16x16x32_bf16 v[80:83], a[88:91], a[24:27], v[80:83]
s_lshl2_add_u32 s28, s32, s95
v_mul_f32 v58, 0xbfb8aa3b, v54
v_mfma_f32_16x16x32_bf16 v[88:91], a[88:91], a[40:43], v[88:91]
ds_read_b64_tr_b16 a[84:85], v222 offset:9224
ds_read_b64_tr_b16 a[86:87], v222 offset:13832
v_mfma_f32_16x16x32_bf16 v[88:91], a[92:95], a[44:47], v[88:91]
v_mul_f32 v59, 0xbfb8aa3b, v55
v_mfma_f32_16x16x32_bf16 v[96:99], a[92:95], a[60:63], v[96:99]
ds_read_b64_tr_b16 a[192:193], v219 offset:9352
ds_read_b64_tr_b16 a[194:195], v219 offset:13960
v_mfma_f32_16x16x32_bf16 v[96:99], a[88:91], a[56:59], v[96:99]
v_exp_f32 v58, v58
s_waitcnt lgkmcnt(8)
v_mfma_f32_16x16x32_bf16 v[100:103], a[64:67], a[112:115], v[100:103]
ds_read_b64_tr_b16 a[88:89], v222 offset:18440
ds_read_b64_tr_b16 a[90:91], v222 offset:23048
v_mfma_f32_16x16x32_bf16 v[100:103], a[68:71], a[116:119], v[100:103]
v_exp_f32 v59, v59
v_mfma_f32_16x16x32_bf16 v[92:95], a[68:71], a[100:103], v[92:95]
ds_read_b64_tr_b16 a[196:197], v219 offset:18568
ds_read_b64_tr_b16 a[198:199], v219 offset:23176
v_mfma_f32_16x16x32_bf16 v[92:95], a[64:67], a[96:99], v[92:95]
v_add_f32 v58, 1.0, v58
v_add_f32 v59, 1.0, v59
v_mfma_f32_16x16x32_bf16 v[84:87], a[64:67], a[236:239], v[84:87]
ds_read_b64_tr_b16 a[92:93], v222 offset:27656
ds_read_b64_tr_b16 a[94:95], v222 offset:32264
v_mfma_f32_16x16x32_bf16 v[84:87], a[68:71], a[240:243], v[84:87]
v_rcp_f32 v58, v58
v_mfma_f32_16x16x32_bf16 v[76:79], a[68:71], a[224:227], v[76:79]
ds_read_b64_tr_b16 a[200:201], v219 offset:27784
ds_read_b64_tr_b16 a[202:203], v219 offset:32392
v_mfma_f32_16x16x32_bf16 v[76:79], a[64:67], a[220:223], v[76:79]
v_rcp_f32 v59, v59
v_mfma_f32_16x16x32_bf16 v[76:79], a[72:75], a[228:231], v[76:79]
v_mul_f32 v54, v54, v58
v_mul_f32 v55, v55, v59
v_mfma_f32_16x16x32_bf16 v[76:79], a[76:79], a[232:235], v[76:79]
v_cvt_pk_bf16_f32 v58, v54, v55
v_lshlrev_b32 v54, 16, v58
v_mfma_f32_16x16x32_bf16 v[84:87], a[76:79], a[132:135], v[84:87]
ds_read_b64_tr_b16 a[204:205], v222 offset:136
ds_read_b64_tr_b16 a[206:207], v222 offset:4744
v_mfma_f32_16x16x32_bf16 v[84:87], a[72:75], a[128:131], v[84:87]
v_and_b32 v55, 0xffff0000, v58
v_accvgpr_read_b32 v57, a255
v_mfma_f32_16x16x32_bf16 v[92:95], a[72:75], a[104:107], v[92:95]
v_accvgpr_read_b32 v59, a153
v_lshlrev_b32 v56, 16, v57
v_mfma_f32_16x16x32_bf16 v[92:95], a[76:79], a[108:111], v[92:95]
s_waitcnt vmcnt(0)
buffer_store_dword v231, v254, s[20:23], s28 offen
v_mfma_f32_16x16x32_bf16 v[100:103], a[76:79], a[124:127], v[100:103]
ds_read_b64_tr_b16 a[208:209], v222 offset:9352
ds_read_b64_tr_b16 a[210:211], v222 offset:13960
v_mfma_f32_16x16x32_bf16 v[100:103], a[72:75], a[120:123], v[100:103]
v_and_b32 v57, 0xffff0000, v57
v_lshlrev_b32 v58, 16, v59
s_waitcnt lgkmcnt(8)
v_mfma_f32_16x16x32_bf16 v[100:103], a[80:83], a[48:51], v[100:103]
v_and_b32 v59, 0xffff0000, v59
v_add_f32 v56, v56, v58
v_mfma_f32_16x16x32_bf16 v[100:103], a[84:87], a[52:55], v[100:103]
v_add_f32 v57, v57, v59
v_cvt_pk_bf16_f32 v58, v56, v57
v_mfma_f32_16x16x32_bf16 v[92:95], a[84:87], a[36:39], v[92:95]
ds_read_b64_tr_b16 a[212:213], v222 offset:18568
ds_read_b64_tr_b16 a[214:215], v222 offset:23176
v_mfma_f32_16x16x32_bf16 v[92:95], a[80:83], a[32:35], v[92:95]
v_lshlrev_b32 v56, 16, v58
v_and_b32 v57, 0xffff0000, v58
v_mfma_f32_16x16x32_bf16 v[84:87], a[80:83], a[16:19], v[84:87]
v_mul_f32 v58, 0xbfb8aa3b, v56
v_mul_f32 v59, 0xbfb8aa3b, v57
v_mfma_f32_16x16x32_bf16 v[84:87], a[84:87], a[20:23], v[84:87]
v_exp_f32 v58, v58
v_mfma_f32_16x16x32_bf16 v[76:79], a[84:87], a[4:7], v[76:79]
ds_read_b64_tr_b16 a[216:217], v222 offset:27784
ds_read_b64_tr_b16 a[218:219], v222 offset:32392
v_mfma_f32_16x16x32_bf16 v[76:79], a[80:83], a[0:3], v[76:79]
s_waitcnt vmcnt(1)
buffer_load_dword v230, v229, s[20:23], s95 offen sc0 sc1
v_mfma_f32_16x16x32_bf16 v[76:79], a[88:91], a[8:11], v[76:79]
v_exp_f32 v59, v59
s_waitcnt lgkmcnt(8)
v_mfma_f32_16x16x32_bf16 v[76:79], a[92:95], a[12:15], v[76:79]
v_add_f32 v58, 1.0, v58
v_add_f32 v59, 1.0, v59
v_mfma_f32_16x16x32_bf16 v[84:87], a[92:95], a[28:31], v[84:87]
v_rcp_f32 v58, v58
v_mfma_f32_16x16x32_bf16 v[84:87], a[88:91], a[24:27], v[84:87]
v_rcp_f32 v59, v59
v_mfma_f32_16x16x32_bf16 v[92:95], a[88:91], a[40:43], v[92:95]
v_mul_f32 v56, v56, v58
v_mul_f32 v57, v57, v59
v_mfma_f32_16x16x32_bf16 v[92:95], a[92:95], a[44:47], v[92:95]
v_cvt_pk_bf16_f32 v58, v56, v57
v_lshlrev_b32 v56, 16, v58
v_mfma_f32_16x16x32_bf16 v[100:103], a[92:95], a[60:63], v[100:103]
v_and_b32 v57, 0xffff0000, v58
v_accvgpr_read_b32 v19, a244
v_mfma_f32_16x16x32_bf16 v[100:103], a[88:91], a[56:59], v[100:103]
v_lshlrev_b32 v18, 16, v19
v_and_b32 v19, 0xffff0000, v19
v_mfma_f32_16x16x32_bf16 v[144:147], a[156:159], a[236:239], v[144:147]
v_accvgpr_read_b32 v21, a245
v_lshlrev_b32 v20, 16, v21
v_mfma_f32_16x16x32_bf16 v[144:147], a[160:163], a[240:243], v[144:147]
v_and_b32 v21, 0xffff0000, v21
v_accvgpr_read_b32 v23, a246
v_mfma_f32_16x16x32_bf16 v[144:147], a[164:167], a[128:131], v[144:147]
v_lshlrev_b32 v22, 16, v23
v_and_b32 v23, 0xffff0000, v23
v_mfma_f32_16x16x32_bf16 v[144:147], a[168:171], a[132:135], v[144:147]
v_accvgpr_read_b32 v25, a247
v_lshlrev_b32 v24, 16, v25
v_mfma_f32_16x16x32_bf16 v[144:147], a[172:175], a[16:19], v[144:147]
v_and_b32 v25, 0xffff0000, v25
v_accvgpr_read_b32 v27, a248
v_mfma_f32_16x16x32_bf16 v[144:147], a[176:179], a[20:23], v[144:147]
v_lshlrev_b32 v26, 16, v27
v_and_b32 v27, 0xffff0000, v27
v_mfma_f32_16x16x32_bf16 v[144:147], a[180:183], a[24:27], v[144:147]
v_accvgpr_read_b32 v29, a249
v_lshlrev_b32 v28, 16, v29
v_mfma_f32_16x16x32_bf16 v[144:147], a[184:187], a[28:31], v[144:147]
v_and_b32 v29, 0xffff0000, v29
v_accvgpr_read_b32 v31, a250
s_waitcnt lgkmcnt(0)
v_mfma_f32_16x16x32_bf16 v[148:151], a[216:219], a[28:31], v[148:151]
s_add_u32 s39, s44, 0
v_lshlrev_b32 v30, 16, v31
v_mfma_f32_16x16x32_bf16 v[148:151], a[212:215], a[24:27], v[148:151]
v_cvt_pk_bf16_f32 v80, v80, v81
v_cvt_pk_bf16_f32 v81, v82, v83
v_mfma_f32_16x16x32_bf16 v[148:151], a[208:211], a[20:23], v[148:151]
v_cvt_pk_bf16_f32 v82, v84, v85
v_cvt_pk_bf16_f32 v83, v86, v87
v_mfma_f32_16x16x32_bf16 v[148:151], a[204:207], a[16:19], v[148:151]
buffer_store_dwordx4 v[80:83], v244, s[20:23], s39 offen offset:1024
v_mfma_f32_16x16x32_bf16 v[148:151], a[200:203], a[132:135], v[148:151]
v_cvt_pk_bf16_f32 v88, v88, v89
v_cvt_pk_bf16_f32 v89, v90, v91
v_mfma_f32_16x16x32_bf16 v[148:151], a[196:199], a[128:131], v[148:151]
v_cvt_pk_bf16_f32 v90, v92, v93
v_cvt_pk_bf16_f32 v91, v94, v95
v_mfma_f32_16x16x32_bf16 v[148:151], a[192:195], a[240:243], v[148:151]
buffer_store_dwordx4 v[88:91], v244, s[20:23], s39 offen offset:2048
v_mfma_f32_16x16x32_bf16 v[148:151], a[188:191], a[236:239], v[148:151]
v_cvt_pk_bf16_f32 v96, v96, v97
v_cvt_pk_bf16_f32 v97, v98, v99
v_mfma_f32_16x16x32_bf16 v[156:159], a[188:191], a[96:99], v[156:159]
v_cvt_pk_bf16_f32 v98, v100, v101
v_cvt_pk_bf16_f32 v99, v102, v103
v_mfma_f32_16x16x32_bf16 v[156:159], a[192:195], a[100:103], v[156:159]
buffer_store_dwordx4 v[96:99], v244, s[20:23], s39 offen offset:3072
v_mfma_f32_16x16x32_bf16 v[156:159], a[196:199], a[104:107], v[156:159]
s_add_u32 s39, s44, 8192
v_and_b32 v31, 0xffff0000, v31
v_mfma_f32_16x16x32_bf16 v[156:159], a[200:203], a[108:111], v[156:159]
s_waitcnt vmcnt(3)
v_cmp_gt_u32 vcc, 1, v230
v_mfma_f32_16x16x32_bf16 v[156:159], a[204:207], a[32:35], v[156:159]
v_accvgpr_read_b32 v33, a251
v_lshlrev_b32 v32, 16, v33
v_mfma_f32_16x16x32_bf16 v[156:159], a[208:211], a[36:39], v[156:159]
s_and_b32 s29, vcc_lo, 0xff
s_cbranch_scc1 SP_P1A
SP_P1A_RET:
v_mfma_f32_16x16x32_bf16 v[156:159], a[212:215], a[40:43], v[156:159]
v_and_b32 v33, 0xffff0000, v33
v_accvgpr_read_b32 v35, a252
v_mfma_f32_16x16x32_bf16 v[156:159], a[216:219], a[44:47], v[156:159]
v_cvt_pk_bf16_f32 v144, v144, v145
v_cvt_pk_bf16_f32 v145, v146, v147
v_mfma_f32_16x16x32_bf16 v[152:155], a[184:187], a[44:47], v[152:155]
v_cvt_pk_bf16_f32 v146, v148, v149
v_cvt_pk_bf16_f32 v147, v150, v151
v_mfma_f32_16x16x32_bf16 v[152:155], a[180:183], a[40:43], v[152:155]
buffer_store_dwordx4 v[144:147], v244, s[20:23], s39 offen offset:1024
v_mfma_f32_16x16x32_bf16 v[152:155], a[176:179], a[36:39], v[152:155]
buffer_load_dwordx4 v[104:107], v244, s[20:23], s68 offen sc0 sc1
v_mfma_f32_16x16x32_bf16 v[152:155], a[172:175], a[32:35], v[152:155]
v_lshlrev_b32 v34, 16, v35
v_and_b32 v35, 0xffff0000, v35
v_mfma_f32_16x16x32_bf16 v[152:155], a[168:171], a[108:111], v[152:155]
v_accvgpr_read_b32 v37, a253
v_lshlrev_b32 v36, 16, v37
v_mfma_f32_16x16x32_bf16 v[152:155], a[164:167], a[104:107], v[152:155]
buffer_load_dwordx4 v[108:111], v244, s[20:23], s69 offen sc0 sc1
v_mfma_f32_16x16x32_bf16 v[152:155], a[160:163], a[100:103], v[152:155]
v_and_b32 v37, 0xffff0000, v37
v_mfma_f32_16x16x32_bf16 v[152:155], a[156:159], a[96:99], v[152:155]
s_mov_b32 s90, 0x3f80
STUB_16:
s_cbranch_execz HOP_RET2
s_mov_b32 s91, 0x3f800000
v_mfma_f32_16x16x32_bf16 v[160:163], a[156:159], a[112:115], v[160:163]
buffer_load_dwordx4 v[112:115], v244, s[20:23], s70 offen sc0 sc1
v_mfma_f32_16x16x32_bf16 v[160:163], a[160:163], a[116:119], v[160:163]
v_mov_b32 v66, 0
v_mov_b32 v67, 0
v_mfma_f32_16x16x32_bf16 v[160:163], a[164:167], a[120:123], v[160:163]
v_mov_b32 v68, 0
v_mov_b32 v69, 0
v_mfma_f32_16x16x32_bf16 v[160:163], a[168:171], a[124:127], v[160:163]
buffer_load_dwordx4 v[116:119], v244, s[20:23], s71 offen sc0 sc1
v_mfma_f32_16x16x32_bf16 v[160:163], a[172:175], a[48:51], v[160:163]
v_mfma_f32_16x16x32_bf16 v[160:163], a[176:179], a[52:55], v[160:163]
v_mfma_f32_16x16x32_bf16 v[160:163], a[180:183], a[56:59], v[160:163]
buffer_load_dwordx2 v[200:201], v226, s[20:23], s72 offen sc0 sc1
v_mfma_f32_16x16x32_bf16 v[160:163], a[184:187], a[60:63], v[160:163]
v_cvt_pk_bf16_f32 v152, v152, v153
v_cvt_pk_bf16_f32 v153, v154, v155
v_mfma_f32_16x16x32_bf16 v[164:167], a[216:219], a[60:63], v[164:167]
v_cvt_pk_bf16_f32 v154, v156, v157
v_cvt_pk_bf16_f32 v155, v158, v159
v_mfma_f32_16x16x32_bf16 v[164:167], a[212:215], a[56:59], v[164:167]
buffer_store_dwordx4 v[152:155], v244, s[20:23], s39 offen offset:2048
v_mfma_f32_16x16x32_bf16 v[164:167], a[208:211], a[52:55], v[164:167]
buffer_load_dwordx2 v[202:203], v226, s[20:23], s73 offen sc0 sc1
v_mfma_f32_16x16x32_bf16 v[164:167], a[204:207], a[48:51], v[164:167]
v_mfma_f32_16x16x32_bf16 v[164:167], a[200:203], a[124:127], v[164:167]
v_mfma_f32_16x16x32_bf16 v[164:167], a[196:199], a[120:123], v[164:167]
buffer_load_dwordx2 v[204:205], v226, s[20:23], s74 offen sc0 sc1
v_mfma_f32_16x16x32_bf16 v[164:167], a[192:195], a[116:119], v[164:167]
v_mfma_f32_16x16x32_bf16 v[164:167], a[188:191], a[112:115], v[164:167]
v_mfma_f32_16x16x32_bf16 v[140:143], a[188:191], a[220:223], v[140:143]
buffer_load_dwordx2 v[206:207], v226, s[20:23], s75 offen sc0 sc1
v_mfma_f32_16x16x32_bf16 v[140:143], a[192:195], a[224:227], v[140:143]
v_mfma_f32_16x16x32_bf16 v[140:143], a[196:199], a[228:231], v[140:143]
v_mfma_f32_16x16x32_bf16 v[140:143], a[200:203], a[232:235], v[140:143]
buffer_load_dwordx2 v[208:209], v226, s[20:23], s84 offen sc0 sc1
v_mfma_f32_16x16x32_bf16 v[140:143], a[204:207], a[0:3], v[140:143]
v_mfma_f32_16x16x32_bf16 v[140:143], a[208:211], a[4:7], v[140:143]
v_mfma_f32_16x16x32_bf16 v[140:143], a[212:215], a[8:11], v[140:143]
buffer_load_dwordx2 v[210:211], v226, s[20:23], s85 offen sc0 sc1
v_mfma_f32_16x16x32_bf16 v[140:143], a[216:219], a[12:15], v[140:143]
v_cvt_pk_bf16_f32 v160, v160, v161
v_cvt_pk_bf16_f32 v161, v162, v163
v_mfma_f32_16x16x32_bf16 v[136:139], a[184:187], a[12:15], v[136:139]
v_cvt_pk_bf16_f32 v162, v164, v165
v_cvt_pk_bf16_f32 v163, v166, v167
v_mfma_f32_16x16x32_bf16 v[136:139], a[180:183], a[8:11], v[136:139]
buffer_store_dwordx4 v[160:163], v244, s[20:23], s39 offen offset:3072
v_mfma_f32_16x16x32_bf16 v[136:139], a[176:179], a[4:7], v[136:139]
buffer_load_dwordx2 v[212:213], v226, s[20:23], s86 offen sc0 sc1
v_mfma_f32_16x16x32_bf16 v[136:139], a[172:175], a[0:3], v[136:139]
v_mfma_f32_16x16x32_bf16 v[136:139], a[168:171], a[232:235], v[136:139]
v_mfma_f32_16x16x32_bf16 v[136:139], a[164:167], a[228:231], v[136:139]
buffer_load_dwordx2 v[214:215], v226, s[20:23], s87 offen sc0 sc1
v_mfma_f32_16x16x32_bf16 v[136:139], a[160:163], a[224:227], v[136:139]
v_mfma_f32_16x16x32_bf16 v[136:139], a[156:159], a[220:223], v[136:139]
buffer_load_dwordx4 v[120:123], v243, s[20:23], s68 offen sc0 sc1
buffer_load_dwordx4 v[124:127], v243, s[20:23], s69 offen sc0 sc1
buffer_load_dwordx4 v[128:131], v243, s[20:23], s70 offen sc0 sc1
buffer_load_dwordx4 v[132:135], v243, s[20:23], s71 offen sc0 sc1
s_lshl_b32 s50, s34, 2
s_lshl_b32 s50, 15, s50
s_waitcnt vmcnt(6)
buffer_store_dword v246, v254, s[20:23], s28 offen
s_waitcnt vmcnt(18)
v_dot2c_f32_bf16 v72, s90, v104
v_dot2c_f32_bf16 v73, s91, v104
v_dot2c_f32_bf16 v74, s90, v105
v_dot2c_f32_bf16 v75, s91, v105
v_dot2c_f32_bf16 v76, s90, v106
v_dot2c_f32_bf16 v77, s91, v106
v_dot2c_f32_bf16 v78, s90, v107
v_dot2c_f32_bf16 v79, s91, v107
s_waitcnt vmcnt(17)
v_dot2c_f32_bf16 v72, s90, v108
v_dot2c_f32_bf16 v73, s91, v108
v_dot2c_f32_bf16 v74, s90, v109
v_dot2c_f32_bf16 v75, s91, v109
v_dot2c_f32_bf16 v76, s90, v110
v_dot2c_f32_bf16 v77, s91, v110
v_dot2c_f32_bf16 v78, s90, v111
v_dot2c_f32_bf16 v79, s91, v111
s_waitcnt vmcnt(16)
v_dot2c_f32_bf16 v72, s90, v112
v_dot2c_f32_bf16 v73, s91, v112
v_dot2c_f32_bf16 v74, s90, v113
v_dot2c_f32_bf16 v75, s91, v113
v_dot2c_f32_bf16 v76, s90, v114
v_dot2c_f32_bf16 v77, s91, v114
v_dot2c_f32_bf16 v78, s90, v115
v_dot2c_f32_bf16 v79, s91, v115
s_waitcnt vmcnt(15)
v_dot2c_f32_bf16 v72, s90, v116
v_dot2c_f32_bf16 v73, s91, v116
v_dot2c_f32_bf16 v74, s90, v117
v_dot2c_f32_bf16 v75, s91, v117
v_dot2c_f32_bf16 v76, s90, v118
v_dot2c_f32_bf16 v77, s91, v118
v_dot2c_f32_bf16 v78, s90, v119
v_dot2c_f32_bf16 v79, s91, v119
buffer_load_dword v230, v229, s[20:23], s95 offen sc0 sc1
s_waitcnt vmcnt(5)
v_dot2c_f32_bf16 v136, s90, v120
v_dot2c_f32_bf16 v137, s91, v120
v_dot2c_f32_bf16 v138, s90, v121
v_dot2c_f32_bf16 v139, s91, v121
v_dot2c_f32_bf16 v140, s90, v122
v_dot2c_f32_bf16 v141, s91, v122
v_dot2c_f32_bf16 v142, s90, v123
v_dot2c_f32_bf16 v143, s91, v123
s_waitcnt vmcnt(4)
v_dot2c_f32_bf16 v136, s90, v124
v_dot2c_f32_bf16 v137, s91, v124
v_dot2c_f32_bf16 v138, s90, v125
v_dot2c_f32_bf16 v139, s91, v125
v_dot2c_f32_bf16 v140, s90, v126
v_dot2c_f32_bf16 v141, s91, v126
v_dot2c_f32_bf16 v142, s90, v127
v_dot2c_f32_bf16 v143, s91, v127
s_waitcnt vmcnt(3)
v_dot2c_f32_bf16 v136, s90, v128
v_dot2c_f32_bf16 v137, s91, v128
v_dot2c_f32_bf16 v138, s90, v129
v_dot2c_f32_bf16 v139, s91, v129
v_dot2c_f32_bf16 v140, s90, v130
v_dot2c_f32_bf16 v141, s91, v130
v_dot2c_f32_bf16 v142, s90, v131
v_dot2c_f32_bf16 v143, s91, v131
s_waitcnt vmcnt(2)
v_dot2c_f32_bf16 v136, s90, v132
v_dot2c_f32_bf16 v137, s91, v132
v_dot2c_f32_bf16 v138, s90, v133
v_dot2c_f32_bf16 v139, s91, v133
v_dot2c_f32_bf16 v140, s90, v134
v_dot2c_f32_bf16 v141, s91, v134
v_dot2c_f32_bf16 v142, s90, v135
v_dot2c_f32_bf16 v143, s91, v135
s_waitcnt vmcnt(0)
v_cmp_gt_u32 vcc, 2, v230
s_nop 0
s_and_b32 s29, vcc_lo, s50
s_cbranch_scc0 SP_P2A_RET
SP_P2A:
s_sleep 0
s_add_u32 s100, s100, 1
s_bitcmp1_b32 s100, 19
s_cbranch_scc1 K_END
buffer_load_dword v230, v229, s[20:23], s95 offen sc0 sc1
s_waitcnt vmcnt(0)
v_cmp_gt_u32 vcc, 2, v230
s_nop 0
s_and_b32 s29, vcc_lo, s50
s_cbranch_scc1 SP_P2A
SP_P2A_RET:
buffer_load_dwordx4 v[168:171], v244, s[20:23], s65 offen sc0 sc1
buffer_load_dwordx4 v[172:175], v244, s[20:23], s66 offen sc0 sc1
buffer_load_dwordx4 v[176:179], v244, s[20:23], s67 offen sc0 sc1
buffer_load_dwordx4 v[180:183], v243, s[20:23], s65 offen sc0 sc1
buffer_load_dwordx4 v[184:187], v243, s[20:23], s66 offen sc0 sc1
buffer_load_dwordx4 v[188:191], v243, s[20:23], s67 offen sc0 sc1
s_waitcnt vmcnt(21)
v_dot2c_f32_bf16 v66, s90, v200
v_dot2c_f32_bf16 v67, s91, v200
v_dot2c_f32_bf16 v68, s90, v201
v_dot2c_f32_bf16 v69, s91, v201
s_waitcnt vmcnt(19)
v_dot2c_f32_bf16 v66, s90, v202
v_dot2c_f32_bf16 v67, s91, v202
v_dot2c_f32_bf16 v68, s90, v203
v_dot2c_f32_bf16 v69, s91, v203
s_waitcnt vmcnt(18)
v_dot2c_f32_bf16 v66, s90, v204
v_dot2c_f32_bf16 v67, s91, v204
v_dot2c_f32_bf16 v68, s90, v205
v_dot2c_f32_bf16 v69, s91, v205
s_waitcnt vmcnt(17)
v_dot2c_f32_bf16 v66, s90, v206
v_dot2c_f32_bf16 v67, s91, v206
v_dot2c_f32_bf16 v68, s90, v207
v_dot2c_f32_bf16 v69, s91, v207
s_waitcnt vmcnt(16)
v_dot2c_f32_bf16 v66, s90, v208
v_dot2c_f32_bf16 v67, s91, v208
v_dot2c_f32_bf16 v68, s90, v209
v_dot2c_f32_bf16 v69, s91, v209
s_waitcnt vmcnt(15)
v_dot2c_f32_bf16 v66, s90, v210
v_dot2c_f32_bf16 v67, s91, v210
v_dot2c_f32_bf16 v68, s90, v211
v_dot2c_f32_bf16 v69, s91, v211
s_waitcnt vmcnt(13)
v_dot2c_f32_bf16 v66, s90, v212
v_dot2c_f32_bf16 v67, s91, v212
v_dot2c_f32_bf16 v68, s90, v213
v_dot2c_f32_bf16 v69, s91, v213
s_waitcnt vmcnt(12)
v_dot2c_f32_bf16 v66, s90, v214
v_dot2c_f32_bf16 v67, s91, v214
v_dot2c_f32_bf16 v68, s90, v215
v_dot2c_f32_bf16 v69, s91, v215
s_cmp_eq_u32 s34, 0
s_cselect_b32 s29, 0, 0x7fbffff0
s_nop 2
v_cvt_pk_bf16_f32 v58, v66, v67
v_cvt_pk_bf16_f32 v59, v68, v69
v_lshlrev_b32 v66, 16, v58
v_and_b32 v67, 0xffff0000, v58
v_lshlrev_b32 v68, 16, v59
v_and_b32 v69, 0xffff0000, v59
v_pk_mul_f32 v[66:67], v[66:67], v[54:55]
v_pk_mul_f32 v[68:69], v[68:69], v[56:57]
v_cvt_pk_bf16_f32 v58, v66, v67
v_cvt_pk_bf16_f32 v59, v68, v69
v_lshlrev_b32 v66, 16, v58
v_and_b32 v67, 0xffff0000, v58
v_lshlrev_b32 v68, 16, v59
v_and_b32 v69, 0xffff0000, v59
v_pk_add_f32 v[66:67], v[66:67], v[34:35]
v_pk_add_f32 v[68:69], v[68:69], v[36:37]
v_cvt_pk_bf16_f32 v66, v66, v67
v_cvt_pk_bf16_f32 v67, v68, v69
buffer_store_dwordx2 v[66:67], v249, s[60:63], s29 offen
s_waitcnt vmcnt(6)
v_dot2c_f32_bf16 v72, s90, v168
v_dot2c_f32_bf16 v73, s91, v168
v_dot2c_f32_bf16 v74, s90, v169
v_dot2c_f32_bf16 v75, s91, v169
v_dot2c_f32_bf16 v76, s90, v170
v_dot2c_f32_bf16 v77, s91, v170
v_dot2c_f32_bf16 v78, s90, v171
v_dot2c_f32_bf16 v79, s91, v171
s_waitcnt vmcnt(5)
v_dot2c_f32_bf16 v72, s90, v172
v_dot2c_f32_bf16 v73, s91, v172
v_dot2c_f32_bf16 v74, s90, v173
v_dot2c_f32_bf16 v75, s91, v173
v_dot2c_f32_bf16 v76, s90, v174
v_dot2c_f32_bf16 v77, s91, v174
v_dot2c_f32_bf16 v78, s90, v175
v_dot2c_f32_bf16 v79, s91, v175
s_waitcnt vmcnt(4)
v_dot2c_f32_bf16 v72, s90, v176
v_dot2c_f32_bf16 v73, s91, v176
v_dot2c_f32_bf16 v74, s90, v177
v_dot2c_f32_bf16 v75, s91, v177
v_dot2c_f32_bf16 v76, s90, v178
v_dot2c_f32_bf16 v77, s91, v178
v_dot2c_f32_bf16 v78, s90, v179
v_dot2c_f32_bf16 v79, s91, v179
s_nop 2
v_cvt_pk_bf16_f32 v58, v72, v73
v_cvt_pk_bf16_f32 v59, v74, v75
v_cvt_pk_bf16_f32 v60, v76, v77
v_cvt_pk_bf16_f32 v61, v78, v79
v_lshlrev_b32 v72, 16, v58
v_and_b32 v73, 0xffff0000, v58
v_lshlrev_b32 v74, 16, v59
v_and_b32 v75, 0xffff0000, v59
v_lshlrev_b32 v76, 16, v60
v_and_b32 v77, 0xffff0000, v60
v_lshlrev_b32 v78, 16, v61
v_and_b32 v79, 0xffff0000, v61
v_pk_mul_f32 v[72:73], v[72:73], v[38:39]
v_pk_mul_f32 v[74:75], v[74:75], v[40:41]
v_pk_mul_f32 v[76:77], v[76:77], v[42:43]
v_pk_mul_f32 v[78:79], v[78:79], v[44:45]
v_cvt_pk_bf16_f32 v58, v72, v73
v_cvt_pk_bf16_f32 v59, v74, v75
v_cvt_pk_bf16_f32 v60, v76, v77
v_cvt_pk_bf16_f32 v61, v78, v79
v_lshlrev_b32 v72, 16, v58
v_and_b32 v73, 0xffff0000, v58
v_lshlrev_b32 v74, 16, v59
v_and_b32 v75, 0xffff0000, v59
v_lshlrev_b32 v76, 16, v60
v_and_b32 v77, 0xffff0000, v60
v_lshlrev_b32 v78, 16, v61
v_and_b32 v79, 0xffff0000, v61
v_pk_add_f32 v[72:73], v[72:73], v[18:19]
v_pk_add_f32 v[74:75], v[74:75], v[20:21]
v_pk_add_f32 v[76:77], v[76:77], v[22:23]
v_pk_add_f32 v[78:79], v[78:79], v[24:25]
v_cvt_pk_bf16_f32 v72, v72, v73
v_cvt_pk_bf16_f32 v73, v74, v75
v_cvt_pk_bf16_f32 v74, v76, v77
v_cvt_pk_bf16_f32 v75, v78, v79
buffer_store_dwordx4 v[72:75], v248, s[60:63], 0 offen
s_waitcnt vmcnt(4)
v_dot2c_f32_bf16 v136, s90, v180
v_dot2c_f32_bf16 v137, s91, v180
v_dot2c_f32_bf16 v138, s90, v181
v_dot2c_f32_bf16 v139, s91, v181
v_dot2c_f32_bf16 v140, s90, v182
v_dot2c_f32_bf16 v141, s91, v182
v_dot2c_f32_bf16 v142, s90, v183
v_dot2c_f32_bf16 v143, s91, v183
s_waitcnt vmcnt(3)
v_dot2c_f32_bf16 v136, s90, v184
v_dot2c_f32_bf16 v137, s91, v184
v_dot2c_f32_bf16 v138, s90, v185
v_dot2c_f32_bf16 v139, s91, v185
v_dot2c_f32_bf16 v140, s90, v186
v_dot2c_f32_bf16 v141, s91, v186
v_dot2c_f32_bf16 v142, s90, v187
v_dot2c_f32_bf16 v143, s91, v187
s_waitcnt vmcnt(2)
v_dot2c_f32_bf16 v136, s90, v188
v_dot2c_f32_bf16 v137, s91, v188
v_dot2c_f32_bf16 v138, s90, v189
v_dot2c_f32_bf16 v139, s91, v189
v_dot2c_f32_bf16 v140, s90, v190
v_dot2c_f32_bf16 v141, s91, v190
v_dot2c_f32_bf16 v142, s90, v191
v_dot2c_f32_bf16 v143, s91, v191
s_nop 2
v_cvt_pk_bf16_f32 v58, v136, v137
v_cvt_pk_bf16_f32 v59, v138, v139
v_cvt_pk_bf16_f32 v60, v140, v141
v_cvt_pk_bf16_f32 v61, v142, v143
v_lshlrev_b32 v136, 16, v58
v_and_b32 v137, 0xffff0000, v58
v_lshlrev_b32 v138, 16, v59
v_and_b32 v139, 0xffff0000, v59
v_lshlrev_b32 v140, 16, v60
v_and_b32 v141, 0xffff0000, v60
v_lshlrev_b32 v142, 16, v61
v_and_b32 v143, 0xffff0000, v61
v_pk_mul_f32 v[136:137], v[136:137], v[46:47]
v_pk_mul_f32 v[138:139], v[138:139], v[48:49]
v_pk_mul_f32 v[140:141], v[140:141], v[50:51]
v_pk_mul_f32 v[142:143], v[142:143], v[52:53]
v_cvt_pk_bf16_f32 v58, v136, v137
v_cvt_pk_bf16_f32 v59, v138, v139
v_cvt_pk_bf16_f32 v60, v140, v141
v_cvt_pk_bf16_f32 v61, v142, v143
v_lshlrev_b32 v136, 16, v58
v_and_b32 v137, 0xffff0000, v58
v_lshlrev_b32 v138, 16, v59
v_and_b32 v139, 0xffff0000, v59
v_lshlrev_b32 v140, 16, v60
v_and_b32 v141, 0xffff0000, v60
v_lshlrev_b32 v142, 16, v61
v_and_b32 v143, 0xffff0000, v61
v_pk_add_f32 v[136:137], v[136:137], v[26:27]
v_pk_add_f32 v[138:139], v[138:139], v[28:29]
v_pk_add_f32 v[140:141], v[140:141], v[30:31]
v_pk_add_f32 v[142:143], v[142:143], v[32:33]
v_cvt_pk_bf16_f32 v136, v136, v137
v_cvt_pk_bf16_f32 v137, v138, v139
v_cvt_pk_bf16_f32 v138, v140, v141
v_cvt_pk_bf16_f32 v139, v142, v143
buffer_store_dwordx4 v[136:139], v248, s[60:63], 0 offen offset:128
K_END:
s_endpgm
K_EVT:
STUB_17:
s_cbranch_execz HOP_RET2
s_sub_u32 s3, s33, 1
s_cmp_eq_u32 s33, 5
s_cbranch_scc0 EV_Y
s_sub_u32 s28, s40, 0
s_cmp_lt_u32 s28, 72
s_cselect_b32 s3, 4, 0
s_cmp_eq_u32 s37, 0
s_cbranch_scc0 K_EVT_RET
s_mov_b32 s28, 0x243000
EV_INC:
v_mov_b32 v246, 0
v_mov_b32 v247, 1
s_mov_b64 exec, 1
buffer_atomic_add v247, v246, s[20:23], s28 offen sc1
s_mov_b64 exec, -1
s_branch K_EVT_RET
EV_Y:
s_cmp_eq_u32 s33, 4
s_cbranch_scc0 EV_Y4
v_mov_b32 v246, 0
s_mov_b32 s28, 0x243000
buffer_load_dword v247, v246, s[20:23], s28 offen sc0 sc1
s_branch K_EVT_RET
EV_Y4:
s_cmp_eq_u32 s33, 1
s_cbranch_scc0 EV_Y5
s_mov_b32 s28, 0x243080
s_bitcmp0_b32 s37, 0
s_cbranch_scc1 EV_INC
s_branch K_EVT_RET
EV_Y5:
s_sub_u32 s29, s40, 0
s_lshr_b32 s28, s37, 1
s_lshl1_add_u32 s29, s29, s28
s_cmp_eq_u32 s33, 3
s_cbranch_scc0 EV_Y3
v_readfirstlane_b32 s28, v247
s_cmp_ge_u32 s28, 144
s_cbranch_scc0 EV_Y4SP
EV_Y4OK:
v_lshrrev_b32 v246, 3, v1
v_mul_u32_u24 v246, 18432, v246
v_and_b32 v247, 7, v1
v_lshl_add_u32 v246, v247, 4, v246
s_lshl_b32 s28, s29, 7
s_and_b32 s29, s37, 1
s_mul_i32 s29, s29, 1327104
s_add_u32 s28, s28, s29
s_add_u32 s28, s28, 0x2000000
buffer_load_dwordx4 v[120:123], v246, s[20:23], s28 offen sc0 sc1
s_add_u32 s28, s28, 147456
buffer_load_dwordx4 v[124:127], v246, s[20:23], s28 offen sc0 sc1
s_add_u32 s28, s28, 147456
buffer_load_dwordx4 v[128:131], v246, s[20:23], s28 offen sc0 sc1
s_add_u32 s28, s28, 147456
buffer_load_dwordx4 v[132:135], v246, s[20:23], s28 offen sc0 sc1
s_add_u32 s28, s28, 147456
buffer_load_dwordx4 v[248:251], v246, s[20:23], s28 offen sc0 sc1
s_add_u32 s28, s28, 147456
buffer_load_dwordx4 v[252:255], v246, s[20:23], s28 offen sc0 sc1
s_add_u32 s28, s28, 147456
buffer_load_dwordx4 a[136:139], v246, s[20:23], s28 offen sc0 sc1
s_add_u32 s28, s28, 147456
buffer_load_dwordx4 a[140:143], v246, s[20:23], s28 offen sc0 sc1
s_add_u32 s28, s28, 147456
buffer_load_dwordx4 a[244:247], v246, s[20:23], s28 offen sc0 sc1
s_branch K_EVT_RET
EV_Y3:
STUB_18:
s_cbranch_execz HOP_RET2
v_pk_add_f32 v[120:121], v[120:121], v[124:125]
v_pk_add_f32 v[122:123], v[122:123], v[126:127]
v_pk_add_f32 v[128:129], v[128:129], v[132:133]
v_pk_add_f32 v[130:131], v[130:131], v[134:135]
v_pk_add_f32 v[248:249], v[248:249], v[252:253]
v_pk_add_f32 v[250:251], v[250:251], v[254:255]
v_accvgpr_read_b32 v124, a136
v_accvgpr_read_b32 v125, a137
v_accvgpr_read_b32 v126, a138
v_accvgpr_read_b32 v127, a139
v_accvgpr_read_b32 v132, a140
v_accvgpr_read_b32 v133, a141
v_accvgpr_read_b32 v134, a142
v_accvgpr_read_b32 v135, a143
v_accvgpr_read_b32 v252, a244
v_accvgpr_read_b32 v253, a245
v_accvgpr_read_b32 v254, a246
v_accvgpr_read_b32 v255, a247
v_pk_add_f32 v[124:125], v[124:125], v[132:133]
v_pk_add_f32 v[126:127], v[126:127], v[134:135]
v_pk_add_f32 v[120:121], v[120:121], v[128:129]
v_pk_add_f32 v[122:123], v[122:123], v[130:131]
v_pk_add_f32 v[248:249], v[248:249], v[124:125]
v_pk_add_f32 v[250:251], v[250:251], v[126:127]
v_pk_add_f32 v[120:121], v[120:121], v[252:253]
v_pk_add_f32 v[122:123], v[122:123], v[254:255]
v_pk_add_f32 v[120:121], v[120:121], v[248:249]
v_pk_add_f32 v[122:123], v[122:123], v[250:251]
v_and_b32 v246, 7, v1
s_lshr_b32 s28, s37, 1
s_lshl_b32 s28, s28, 7
v_add_f32_dpp v124, v120, v120 row_ror:8 row_mask:0xf bank_mask:0xf
v_add_f32_dpp v125, v121, v121 row_ror:8 row_mask:0xf bank_mask:0xf
v_add_f32_dpp v126, v122, v122 row_ror:8 row_mask:0xf bank_mask:0xf
v_add_f32_dpp v127, v123, v123 row_ror:8 row_mask:0xf bank_mask:0xf
v_mov_b32 v120, v124
v_mov_b32 v121, v125
v_mov_b32 v122, v126
v_mov_b32 v123, v127
v_permlane16_swap_b32 v120, v124
v_permlane16_swap_b32 v121, v125
v_permlane16_swap_b32 v122, v126
v_permlane16_swap_b32 v123, v127
v_add_f32 v124, v120, v124
v_add_f32 v125, v121, v125
v_add_f32 v126, v122, v126
v_add_f32 v127, v123, v127
v_mov_b32 v120, v124
v_mov_b32 v121, v125
v_mov_b32 v122, v126
v_mov_b32 v123, v127
v_permlane32_swap_b32 v120, v124
v_permlane32_swap_b32 v121, v125
v_permlane32_swap_b32 v122, v126
v_permlane32_swap_b32 v123, v127
v_add_f32 v124, v120, v124
v_add_f32 v125, v121, v125
v_add_f32 v126, v122, v126
v_add_f32 v127, v123, v127
v_lshlrev_b32 v247, 4, v246
v_add_u32 v247, s28, v247
s_bitcmp1_b32 s37, 0
s_cbranch_scc0 EV_YE
ds_write_b128 v247, v[124:127] offset:65024
s_waitcnt lgkmcnt(0)
s_barrier
s_branch K_EVT_RET
EV_YE:
s_barrier
ds_read_b128 v[120:123], v247 offset:65024
v_mul_u32_u24 v246, 0x480, v246
s_lshl_b32 s28, s29, 3
s_add_u32 s28, s28, 0x244000
s_waitcnt lgkmcnt(0)
v_pk_add_f32 v[120:121], v[120:121], v[124:125]
v_pk_add_f32 v[122:123], v[122:123], v[126:127]
v_cvt_pk_bf16_f32 v124, v120, v121
v_cvt_pk_bf16_f32 v125, v122, v123
v_lshlrev_b32 v120, 16, v124
v_and_b32 v121, 0xffff0000, v124
v_lshlrev_b32 v122, 16, v125
v_and_b32 v123, 0xffff0000, v125
v_mul_f32 v120, v120, v236
v_mul_f32 v121, v121, v236
v_mul_f32 v122, v122, v236
v_mul_f32 v123, v123, v236
v_cvt_pk_bf16_f32 v124, v120, v121
v_cvt_pk_bf16_f32 v125, v122, v123
s_mov_b64 exec, 0xff
buffer_store_dwordx2 v[124:125], v246, s[20:23], s28 offen sc0 sc1
s_mov_b64 exec, -1
s_branch K_EVT_RET
SP_X0:
s_sleep 2
s_add_u32 s100, s100, 1
s_bitcmp1_b32 s100, 19
s_cbranch_scc1 K_END
buffer_load_dword v193, v192, s[24:27], 0 offen sc0 sc1
s_waitcnt vmcnt(0)
v_readfirstlane_b32 s92, v193
s_and_b32 s93, s92, 0xf0
s_cbranch_scc0 SP_X0
s_branch SP_X0_RET
SP_CAND:
s_sleep 2
s_add_u32 s100, s100, 1
s_bitcmp1_b32 s100, 19
s_cbranch_scc1 K_END
s_mov_b32 s29, 0x242000
buffer_load_dwordx2 v[248:249], v250, s[20:23], s29 offen sc0 sc1
s_waitcnt vmcnt(0)
v_cmp_ne_u32 vcc, s47, v249
s_cbranch_vccnz SP_CAND
s_branch SP_CAND_RET
SP_FL:
s_sleep 2
s_add_u32 s100, s100, 1
s_bitcmp1_b32 s100, 19
s_cbranch_scc1 K_END
buffer_load_dword v253, v246, s[24:27], 0 offen sc0 sc1
s_waitcnt vmcnt(0)
v_and_b32 v253, 0x20202020, v253
v_cmp_ne_u32 vcc, 0x20202020, v253
s_cbranch_vccnz SP_FL
s_branch SP_FL_RET
SP_FK:
s_sleep 4
s_add_u32 s100, s100, 1
s_bitcmp1_b32 s100, 19
s_cbranch_scc1 K_END
s_mov_b32 s93, 0x242800
buffer_load_dwordx2 v[120:121], v122, s[20:23], s93 offen sc0 sc1
s_waitcnt vmcnt(0)
v_cmp_ne_u32 vcc, s47, v121
s_cbranch_vccnz SP_FK
s_branch SP_FK_RET
SP_Y:
s_sleep 4
s_add_u32 s100, s100, 1
s_bitcmp1_b32 s100, 19
s_cbranch_scc1 K_END
s_mov_b32 s93, 0x243080
buffer_load_dword v246, v254, s[20:23], s93 offen sc0 sc1
s_waitcnt vmcnt(0)
v_readfirstlane_b32 s93, v246
s_cmp_lt_u32 s93, 144
s_cbranch_scc1 SP_Y
s_branch SP_Y_RET
SP_O1A:
s_sleep 1
s_add_u32 s100, s100, 1
s_bitcmp1_b32 s100, 19
s_cbranch_scc1 K_END
buffer_load_dword v230, v229, s[20:23], s94 offen sc0 sc1
s_waitcnt vmcnt(0)
v_cmp_gt_u32 vcc, 1, v230
s_bitcmp1_b32 vcc_lo, s39
s_cbranch_scc1 SP_O1A
s_branch SP_O1A_RET
SP_O2A:
s_sleep 1
s_add_u32 s100, s100, 1
s_bitcmp1_b32 s100, 19
s_cbranch_scc1 K_END
buffer_load_dword v230, v229, s[20:23], s94 offen sc0 sc1
s_waitcnt vmcnt(0)
v_cmp_gt_u32 vcc, 1, v230
s_and_b32 s29, vcc_lo, 15
s_cbranch_scc1 SP_O2A
s_branch SP_O2A_RET
SP_O3A:
s_sleep 1
s_add_u32 s100, s100, 1
s_bitcmp1_b32 s100, 19
s_cbranch_scc1 K_END
buffer_load_dword v230, v229, s[20:23], s94 offen sc0 sc1
s_waitcnt vmcnt(0)
v_cmp_gt_u32 vcc, 2, v230
s_and_b32 s29, vcc_lo, 15
s_cbranch_scc1 SP_O3A
s_branch SP_O3A_RET
SP_P1A:
s_sleep 1
s_add_u32 s100, s100, 1
s_bitcmp1_b32 s100, 19
s_cbranch_scc1 K_END
buffer_load_dword v230, v229, s[20:23], s95 offen sc0 sc1
s_waitcnt vmcnt(0)
v_cmp_gt_u32 vcc, 1, v230
s_and_b32 s29, vcc_lo, 0xff
s_cbranch_scc1 SP_P1A
s_branch SP_P1A_RET
EV_Y4SP:
s_sleep 8
s_add_u32 s100, s100, 1
s_bitcmp1_b32 s100, 19
s_cbranch_scc1 K_END
v_mov_b32 v246, 0
s_mov_b32 s28, 0x243000
buffer_load_dword v247, v246, s[20:23], s28 offen sc0 sc1
s_waitcnt vmcnt(0)
v_readfirstlane_b32 s28, v247
s_cmp_ge_u32 s28, 144
s_cbranch_scc0 EV_Y4SP
s_branch EV_Y4OK
K_HOT_END:
K_MIXED:
s_waitcnt lgkmcnt(0)
s_barrier
s_add_u32 s28, s30, 147456
v_smfmac_f32_16x16x64_bf16 a[128:131], a[208:211], v[72:79], v245
v_lshrrev_b32 v132, 1, v1
v_and_b32 v132, 8, v132
v_smfmac_f32_16x16x64_bf16 a[132:135], a[208:211], v[80:87], v245
v_xor_b32 v132, v132, v1
v_lshlrev_b32 v132, 4, v132
v_mfma_f32_16x16x32_bf16 a[0:3], v[72:75], a[212:215], a[0:3]
v_add_u32 v132, s28, v132
v_lshlrev_b32 v133, 3, v1
v_mfma_f32_16x16x32_bf16 a[16:19], v[72:75], a[216:219], a[16:19]
v_and_b32 v133, 8, v133
v_lshrrev_b32 v134, 2, v1
v_mfma_f32_16x16x32_bf16 a[32:35], v[72:75], a[220:223], a[32:35]
v_xor_b32 v133, v133, v134
v_and_b32 v134, 3, v1
v_mfma_f32_16x16x32_bf16 a[48:51], v[72:75], a[224:227], a[48:51]
v_lshl_add_u32 v133, v134, 4, v133
v_lshlrev_b32 v133, 4, v133
v_mfma_f32_16x16x32_bf16 a[64:67], v[72:75], a[228:231], a[64:67]
v_add_u32 v133, s28, v133
v_lshlrev_b32 v134, 2, v1
v_mfma_f32_16x16x32_bf16 a[80:83], v[72:75], a[232:235], a[80:83]
v_add_u32 v134, s28, v134
v_lshlrev_b32 v135, 4, v4
v_mfma_f32_16x16x32_bf16 a[96:99], v[72:75], a[236:239], a[96:99]
v_add_u32 v135, s28, v135
v_mfma_f32_16x16x32_bf16 a[112:115], v[72:75], a[240:243], a[112:115]
v_mfma_f32_16x16x32_bf16 a[4:7], v[76:79], a[212:215], a[4:7]
v_accvgpr_read_b32 v120, a128
v_accvgpr_read_b32 v124, a129
v_accvgpr_read_b32 v121, a130
v_mfma_f32_16x16x32_bf16 a[20:23], v[76:79], a[216:219], a[20:23]
v_accvgpr_read_b32 v125, a131
v_accvgpr_read_b32 v122, a132
v_accvgpr_read_b32 v126, a133
v_mfma_f32_16x16x32_bf16 a[36:39], v[76:79], a[220:223], a[36:39]
v_accvgpr_read_b32 v123, a134
v_accvgpr_read_b32 v127, a135
v_add_f32 v120, v120, v124
v_mfma_f32_16x16x32_bf16 a[52:55], v[76:79], a[224:227], a[52:55]
v_add_f32 v121, v121, v125
v_add_f32 v122, v122, v126
v_add_f32 v123, v123, v127
v_mfma_f32_16x16x32_bf16 a[68:71], v[76:79], a[228:231], a[68:71]
v_rcp_f32 v124, v120
v_rcp_f32 v125, v121
v_rcp_f32 v126, v122
v_mfma_f32_16x16x32_bf16 a[84:87], v[76:79], a[232:235], a[84:87]
v_rcp_f32 v127, v123
ds_write_b32 v134, v124 offset:0
ds_write_b32 v134, v125 offset:256
v_mfma_f32_16x16x32_bf16 a[100:103], v[76:79], a[236:239], a[100:103]
ds_write_b32 v134, v126 offset:512
ds_write_b32 v134, v127 offset:768
ds_read_b128 v[88:91], v135 offset:0
v_mfma_f32_16x16x32_bf16 a[116:119], v[76:79], a[240:243], a[116:119]
ds_read_b128 v[92:95], v135 offset:256
ds_read_b128 v[96:99], v135 offset:512
ds_read_b128 v[100:103], v135 offset:768
s_add_u32 s92, s44, 4096
s_add_u32 s93, s44, 8192
s_add_u32 s51, s44, 12288
v_mfma_f32_16x16x32_bf16 a[8:11], v[80:83], a[212:215], a[8:11]
v_accvgpr_read_b32 v104, a0
v_accvgpr_read_b32 v105, a1
v_accvgpr_read_b32 v106, a2
v_accvgpr_read_b32 v107, a3
v_mfma_f32_16x16x32_bf16 a[24:27], v[80:83], a[216:219], a[24:27]
v_accvgpr_read_b32 v108, a16
v_accvgpr_read_b32 v109, a17
v_accvgpr_read_b32 v110, a18
v_accvgpr_read_b32 v111, a19
s_waitcnt lgkmcnt(0)
v_pk_mul_f32 v[104:105], v[104:105], v[88:89]
v_pk_mul_f32 v[106:107], v[106:107], v[90:91]
v_pk_mul_f32 v[108:109], v[108:109], v[88:89]
v_pk_mul_f32 v[110:111], v[110:111], v[90:91]
v_cvt_pk_bf16_f32 v104, v104, v105
v_cvt_pk_bf16_f32 v105, v106, v107
v_cvt_pk_bf16_f32 v106, v108, v109
v_cvt_pk_bf16_f32 v107, v110, v111
v_mfma_f32_16x16x32_bf16 a[40:43], v[80:83], a[220:223], a[40:43]
v_accvgpr_read_b32 v112, a32
v_accvgpr_read_b32 v113, a33
v_accvgpr_read_b32 v114, a34
v_accvgpr_read_b32 v115, a35
ds_write_b128 v132, v[104:107] offset:0
v_mfma_f32_16x16x32_bf16 a[56:59], v[80:83], a[224:227], a[56:59]
v_accvgpr_read_b32 v116, a48
v_accvgpr_read_b32 v117, a49
v_accvgpr_read_b32 v118, a50
v_accvgpr_read_b32 v119, a51
ds_read_b64_tr_b16 v[8:9], v133 offset:0
ds_read_b64_tr_b16 v[10:11], v133 offset:8
v_pk_mul_f32 v[112:113], v[112:113], v[88:89]
v_pk_mul_f32 v[114:115], v[114:115], v[90:91]
v_pk_mul_f32 v[116:117], v[116:117], v[88:89]
v_pk_mul_f32 v[118:119], v[118:119], v[90:91]
v_cvt_pk_bf16_f32 v112, v112, v113
v_cvt_pk_bf16_f32 v113, v114, v115
v_cvt_pk_bf16_f32 v114, v116, v117
v_cvt_pk_bf16_f32 v115, v118, v119
v_mfma_f32_16x16x32_bf16 a[72:75], v[80:83], a[228:231], a[72:75]
v_accvgpr_read_b32 v104, a64
v_accvgpr_read_b32 v105, a65
v_accvgpr_read_b32 v106, a66
v_accvgpr_read_b32 v107, a67
ds_write_b128 v132, v[112:115] offset:1024
v_mfma_f32_16x16x32_bf16 a[88:91], v[80:83], a[232:235], a[88:91]
v_accvgpr_read_b32 v108, a80
v_accvgpr_read_b32 v109, a81
v_accvgpr_read_b32 v110, a82
v_accvgpr_read_b32 v111, a83
ds_read_b64_tr_b16 v[12:13], v133 offset:1024
ds_read_b64_tr_b16 v[14:15], v133 offset:1032
v_pk_mul_f32 v[104:105], v[104:105], v[88:89]
v_pk_mul_f32 v[106:107], v[106:107], v[90:91]
v_pk_mul_f32 v[108:109], v[108:109], v[88:89]
v_pk_mul_f32 v[110:111], v[110:111], v[90:91]
s_waitcnt lgkmcnt(3)
buffer_store_dwordx4 v[8:11], v244, s[20:23], s44 offen offset:0 sc0 sc1
v_cvt_pk_bf16_f32 v104, v104, v105
v_cvt_pk_bf16_f32 v105, v106, v107
v_cvt_pk_bf16_f32 v106, v108, v109
v_cvt_pk_bf16_f32 v107, v110, v111
v_mfma_f32_16x16x32_bf16 a[104:107], v[80:83], a[236:239], a[104:107]
v_accvgpr_read_b32 v112, a96
v_accvgpr_read_b32 v113, a97
v_accvgpr_read_b32 v114, a98
v_accvgpr_read_b32 v115, a99
ds_write_b128 v132, v[104:107] offset:2048
v_mfma_f32_16x16x32_bf16 a[120:123], v[80:83], a[240:243], a[120:123]
v_accvgpr_read_b32 v116, a112
v_accvgpr_read_b32 v117, a113
v_accvgpr_read_b32 v118, a114
v_accvgpr_read_b32 v119, a115
ds_read_b64_tr_b16 v[16:17], v133 offset:2048
ds_read_b64_tr_b16 v[18:19], v133 offset:2056
v_pk_mul_f32 v[112:113], v[112:113], v[88:89]
v_pk_mul_f32 v[114:115], v[114:115], v[90:91]
v_pk_mul_f32 v[116:117], v[116:117], v[88:89]
v_pk_mul_f32 v[118:119], v[118:119], v[90:91]
s_waitcnt lgkmcnt(3)
buffer_store_dwordx4 v[12:15], v244, s[20:23], s44 offen offset:1024 sc0 sc1
v_cvt_pk_bf16_f32 v112, v112, v113
v_cvt_pk_bf16_f32 v113, v114, v115
v_cvt_pk_bf16_f32 v114, v116, v117
v_cvt_pk_bf16_f32 v115, v118, v119
v_mfma_f32_16x16x32_bf16 a[12:15], v[84:87], a[212:215], a[12:15]
v_accvgpr_read_b32 v104, a4
v_accvgpr_read_b32 v105, a5
v_accvgpr_read_b32 v106, a6
v_accvgpr_read_b32 v107, a7
ds_write_b128 v132, v[112:115] offset:3072
v_mfma_f32_16x16x32_bf16 a[28:31], v[84:87], a[216:219], a[28:31]
v_accvgpr_read_b32 v108, a20
v_accvgpr_read_b32 v109, a21
v_accvgpr_read_b32 v110, a22
v_accvgpr_read_b32 v111, a23
ds_read_b64_tr_b16 v[20:21], v133 offset:3072
ds_read_b64_tr_b16 v[22:23], v133 offset:3080
v_pk_mul_f32 v[104:105], v[104:105], v[92:93]
v_pk_mul_f32 v[106:107], v[106:107], v[94:95]
v_pk_mul_f32 v[108:109], v[108:109], v[92:93]
v_pk_mul_f32 v[110:111], v[110:111], v[94:95]
s_waitcnt lgkmcnt(3)
buffer_store_dwordx4 v[16:19], v244, s[20:23], s44 offen offset:2048 sc0 sc1
v_cvt_pk_bf16_f32 v104, v104, v105
v_cvt_pk_bf16_f32 v105, v106, v107
v_cvt_pk_bf16_f32 v106, v108, v109
v_cvt_pk_bf16_f32 v107, v110, v111
v_mfma_f32_16x16x32_bf16 a[44:47], v[84:87], a[220:223], a[44:47]
v_accvgpr_read_b32 v112, a36
v_accvgpr_read_b32 v113, a37
v_accvgpr_read_b32 v114, a38
v_accvgpr_read_b32 v115, a39
ds_write_b128 v132, v[104:107] offset:0
v_mfma_f32_16x16x32_bf16 a[60:63], v[84:87], a[224:227], a[60:63]
v_accvgpr_read_b32 v116, a52
v_accvgpr_read_b32 v117, a53
v_accvgpr_read_b32 v118, a54
v_accvgpr_read_b32 v119, a55
ds_read_b64_tr_b16 v[24:25], v133 offset:0
ds_read_b64_tr_b16 v[26:27], v133 offset:8
v_pk_mul_f32 v[112:113], v[112:113], v[92:93]
v_pk_mul_f32 v[114:115], v[114:115], v[94:95]
v_pk_mul_f32 v[116:117], v[116:117], v[92:93]
v_pk_mul_f32 v[118:119], v[118:119], v[94:95]
s_waitcnt lgkmcnt(3)
buffer_store_dwordx4 v[20:23], v244, s[20:23], s44 offen offset:3072 sc0 sc1
v_cvt_pk_bf16_f32 v112, v112, v113
v_cvt_pk_bf16_f32 v113, v114, v115
v_cvt_pk_bf16_f32 v114, v116, v117
v_cvt_pk_bf16_f32 v115, v118, v119
v_mfma_f32_16x16x32_bf16 a[76:79], v[84:87], a[228:231], a[76:79]
v_accvgpr_read_b32 v104, a68
v_accvgpr_read_b32 v105, a69
v_accvgpr_read_b32 v106, a70
v_accvgpr_read_b32 v107, a71
ds_write_b128 v132, v[112:115] offset:1024
v_mfma_f32_16x16x32_bf16 a[92:95], v[84:87], a[232:235], a[92:95]
v_accvgpr_read_b32 v108, a84
v_accvgpr_read_b32 v109, a85
v_accvgpr_read_b32 v110, a86
v_accvgpr_read_b32 v111, a87
ds_read_b64_tr_b16 v[28:29], v133 offset:1024
ds_read_b64_tr_b16 v[30:31], v133 offset:1032
v_pk_mul_f32 v[104:105], v[104:105], v[92:93]
v_pk_mul_f32 v[106:107], v[106:107], v[94:95]
v_pk_mul_f32 v[108:109], v[108:109], v[92:93]
v_pk_mul_f32 v[110:111], v[110:111], v[94:95]
s_waitcnt lgkmcnt(3)
buffer_store_dwordx4 v[24:27], v244, s[20:23], s92 offen offset:0 sc0 sc1
v_cvt_pk_bf16_f32 v104, v104, v105
v_cvt_pk_bf16_f32 v105, v106, v107
v_cvt_pk_bf16_f32 v106, v108, v109
v_cvt_pk_bf16_f32 v107, v110, v111
v_mfma_f32_16x16x32_bf16 a[108:111], v[84:87], a[236:239], a[108:111]
v_accvgpr_read_b32 v112, a100
v_accvgpr_read_b32 v113, a101
v_accvgpr_read_b32 v114, a102
v_accvgpr_read_b32 v115, a103
ds_write_b128 v132, v[104:107] offset:2048
v_mfma_f32_16x16x32_bf16 a[124:127], v[84:87], a[240:243], a[124:127]
v_accvgpr_read_b32 v116, a116
v_accvgpr_read_b32 v117, a117
v_accvgpr_read_b32 v118, a118
v_accvgpr_read_b32 v119, a119
ds_read_b64_tr_b16 v[32:33], v133 offset:2048
ds_read_b64_tr_b16 v[34:35], v133 offset:2056
v_pk_mul_f32 v[112:113], v[112:113], v[92:93]
v_pk_mul_f32 v[114:115], v[114:115], v[94:95]
v_pk_mul_f32 v[116:117], v[116:117], v[92:93]
v_pk_mul_f32 v[118:119], v[118:119], v[94:95]
s_waitcnt lgkmcnt(3)
buffer_store_dwordx4 v[28:31], v244, s[20:23], s92 offen offset:1024 sc0 sc1
v_cvt_pk_bf16_f32 v112, v112, v113
v_cvt_pk_bf16_f32 v113, v114, v115
v_cvt_pk_bf16_f32 v114, v116, v117
v_cvt_pk_bf16_f32 v115, v118, v119
v_accvgpr_read_b32 v104, a8
v_accvgpr_read_b32 v105, a9
v_accvgpr_read_b32 v106, a10
v_accvgpr_read_b32 v107, a11
ds_write_b128 v132, v[112:115] offset:3072
v_accvgpr_read_b32 v108, a24
v_accvgpr_read_b32 v109, a25
v_accvgpr_read_b32 v110, a26
v_accvgpr_read_b32 v111, a27
ds_read_b64_tr_b16 v[36:37], v133 offset:3072
ds_read_b64_tr_b16 v[38:39], v133 offset:3080
v_pk_mul_f32 v[104:105], v[104:105], v[96:97]
v_pk_mul_f32 v[106:107], v[106:107], v[98:99]
v_pk_mul_f32 v[108:109], v[108:109], v[96:97]
v_pk_mul_f32 v[110:111], v[110:111], v[98:99]
s_waitcnt lgkmcnt(3)
buffer_store_dwordx4 v[32:35], v244, s[20:23], s92 offen offset:2048 sc0 sc1
v_cvt_pk_bf16_f32 v104, v104, v105
v_cvt_pk_bf16_f32 v105, v106, v107
v_cvt_pk_bf16_f32 v106, v108, v109
v_cvt_pk_bf16_f32 v107, v110, v111
v_accvgpr_read_b32 v112, a40
v_accvgpr_read_b32 v113, a41
v_accvgpr_read_b32 v114, a42
v_accvgpr_read_b32 v115, a43
ds_write_b128 v132, v[104:107] offset:0
v_accvgpr_read_b32 v116, a56
v_accvgpr_read_b32 v117, a57
v_accvgpr_read_b32 v118, a58
v_accvgpr_read_b32 v119, a59
ds_read_b64_tr_b16 v[40:41], v133 offset:0
ds_read_b64_tr_b16 v[42:43], v133 offset:8
v_pk_mul_f32 v[112:113], v[112:113], v[96:97]
v_pk_mul_f32 v[114:115], v[114:115], v[98:99]
v_pk_mul_f32 v[116:117], v[116:117], v[96:97]
v_pk_mul_f32 v[118:119], v[118:119], v[98:99]
s_waitcnt lgkmcnt(3)
buffer_store_dwordx4 v[36:39], v244, s[20:23], s92 offen offset:3072 sc0 sc1
v_cvt_pk_bf16_f32 v112, v112, v113
v_cvt_pk_bf16_f32 v113, v114, v115
v_cvt_pk_bf16_f32 v114, v116, v117
v_cvt_pk_bf16_f32 v115, v118, v119
v_accvgpr_read_b32 v104, a72
v_accvgpr_read_b32 v105, a73
v_accvgpr_read_b32 v106, a74
v_accvgpr_read_b32 v107, a75
ds_write_b128 v132, v[112:115] offset:1024
v_accvgpr_read_b32 v108, a88
v_accvgpr_read_b32 v109, a89
v_accvgpr_read_b32 v110, a90
v_accvgpr_read_b32 v111, a91
ds_read_b64_tr_b16 v[44:45], v133 offset:1024
ds_read_b64_tr_b16 v[46:47], v133 offset:1032
v_pk_mul_f32 v[104:105], v[104:105], v[96:97]
v_pk_mul_f32 v[106:107], v[106:107], v[98:99]
v_pk_mul_f32 v[108:109], v[108:109], v[96:97]
v_pk_mul_f32 v[110:111], v[110:111], v[98:99]
s_waitcnt lgkmcnt(3)
buffer_store_dwordx4 v[40:43], v244, s[20:23], s93 offen offset:0 sc0 sc1
v_cvt_pk_bf16_f32 v104, v104, v105
v_cvt_pk_bf16_f32 v105, v106, v107
v_cvt_pk_bf16_f32 v106, v108, v109
v_cvt_pk_bf16_f32 v107, v110, v111
v_accvgpr_read_b32 v112, a104
v_accvgpr_read_b32 v113, a105
v_accvgpr_read_b32 v114, a106
v_accvgpr_read_b32 v115, a107
ds_write_b128 v132, v[104:107] offset:2048
v_accvgpr_read_b32 v116, a120
v_accvgpr_read_b32 v117, a121
v_accvgpr_read_b32 v118, a122
v_accvgpr_read_b32 v119, a123
ds_read_b64_tr_b16 v[48:49], v133 offset:2048
ds_read_b64_tr_b16 v[50:51], v133 offset:2056
v_pk_mul_f32 v[112:113], v[112:113], v[96:97]
v_pk_mul_f32 v[114:115], v[114:115], v[98:99]
v_pk_mul_f32 v[116:117], v[116:117], v[96:97]
v_pk_mul_f32 v[118:119], v[118:119], v[98:99]
s_waitcnt lgkmcnt(3)
buffer_store_dwordx4 v[44:47], v244, s[20:23], s93 offen offset:1024 sc0 sc1
v_cvt_pk_bf16_f32 v112, v112, v113
v_cvt_pk_bf16_f32 v113, v114, v115
v_cvt_pk_bf16_f32 v114, v116, v117
v_cvt_pk_bf16_f32 v115, v118, v119
v_accvgpr_read_b32 v104, a12
v_accvgpr_read_b32 v105, a13
v_accvgpr_read_b32 v106, a14
v_accvgpr_read_b32 v107, a15
ds_write_b128 v132, v[112:115] offset:3072
v_accvgpr_read_b32 v108, a28
v_accvgpr_read_b32 v109, a29
v_accvgpr_read_b32 v110, a30
v_accvgpr_read_b32 v111, a31
ds_read_b64_tr_b16 v[52:53], v133 offset:3072
ds_read_b64_tr_b16 v[54:55], v133 offset:3080
v_pk_mul_f32 v[104:105], v[104:105], v[100:101]
v_pk_mul_f32 v[106:107], v[106:107], v[102:103]
v_pk_mul_f32 v[108:109], v[108:109], v[100:101]
v_pk_mul_f32 v[110:111], v[110:111], v[102:103]
s_waitcnt lgkmcnt(3)
buffer_store_dwordx4 v[48:51], v244, s[20:23], s93 offen offset:2048 sc0 sc1
v_cvt_pk_bf16_f32 v104, v104, v105
v_cvt_pk_bf16_f32 v105, v106, v107
v_cvt_pk_bf16_f32 v106, v108, v109
v_cvt_pk_bf16_f32 v107, v110, v111
v_accvgpr_read_b32 v112, a44
v_accvgpr_read_b32 v113, a45
v_accvgpr_read_b32 v114, a46
v_accvgpr_read_b32 v115, a47
ds_write_b128 v132, v[104:107] offset:0
v_accvgpr_read_b32 v116, a60
v_accvgpr_read_b32 v117, a61
v_accvgpr_read_b32 v118, a62
v_accvgpr_read_b32 v119, a63
ds_read_b64_tr_b16 v[56:57], v133 offset:0
ds_read_b64_tr_b16 v[58:59], v133 offset:8
v_pk_mul_f32 v[112:113], v[112:113], v[100:101]
v_pk_mul_f32 v[114:115], v[114:115], v[102:103]
v_pk_mul_f32 v[116:117], v[116:117], v[100:101]
v_pk_mul_f32 v[118:119], v[118:119], v[102:103]
s_waitcnt lgkmcnt(3)
buffer_store_dwordx4 v[52:55], v244, s[20:23], s93 offen offset:3072 sc0 sc1
v_cvt_pk_bf16_f32 v112, v112, v113
v_cvt_pk_bf16_f32 v113, v114, v115
v_cvt_pk_bf16_f32 v114, v116, v117
v_cvt_pk_bf16_f32 v115, v118, v119
v_accvgpr_read_b32 v104, a76
v_accvgpr_read_b32 v105, a77
v_accvgpr_read_b32 v106, a78
v_accvgpr_read_b32 v107, a79
ds_write_b128 v132, v[112:115] offset:1024
v_accvgpr_read_b32 v108, a92
v_accvgpr_read_b32 v109, a93
v_accvgpr_read_b32 v110, a94
v_accvgpr_read_b32 v111, a95
ds_read_b64_tr_b16 v[60:61], v133 offset:1024
ds_read_b64_tr_b16 v[62:63], v133 offset:1032
v_pk_mul_f32 v[104:105], v[104:105], v[100:101]
v_pk_mul_f32 v[106:107], v[106:107], v[102:103]
v_pk_mul_f32 v[108:109], v[108:109], v[100:101]
v_pk_mul_f32 v[110:111], v[110:111], v[102:103]
s_waitcnt lgkmcnt(3)
buffer_store_dwordx4 v[56:59], v244, s[20:23], s51 offen offset:0 sc0 sc1
v_cvt_pk_bf16_f32 v104, v104, v105
v_cvt_pk_bf16_f32 v105, v106, v107
v_cvt_pk_bf16_f32 v106, v108, v109
v_cvt_pk_bf16_f32 v107, v110, v111
v_accvgpr_read_b32 v112, a108
v_accvgpr_read_b32 v113, a109
v_accvgpr_read_b32 v114, a110
v_accvgpr_read_b32 v115, a111
ds_write_b128 v132, v[104:107] offset:2048
v_accvgpr_read_b32 v116, a124
v_accvgpr_read_b32 v117, a125
v_accvgpr_read_b32 v118, a126
v_accvgpr_read_b32 v119, a127
ds_read_b64_tr_b16 v[64:65], v133 offset:2048
ds_read_b64_tr_b16 v[66:67], v133 offset:2056
v_pk_mul_f32 v[112:113], v[112:113], v[100:101]
v_pk_mul_f32 v[114:115], v[114:115], v[102:103]
v_pk_mul_f32 v[116:117], v[116:117], v[100:101]
v_pk_mul_f32 v[118:119], v[118:119], v[102:103]
s_waitcnt lgkmcnt(3)
buffer_store_dwordx4 v[60:63], v244, s[20:23], s51 offen offset:1024 sc0 sc1
v_cvt_pk_bf16_f32 v112, v112, v113
v_cvt_pk_bf16_f32 v113, v114, v115
v_cvt_pk_bf16_f32 v114, v116, v117
v_cvt_pk_bf16_f32 v115, v118, v119
ds_write_b128 v132, v[112:115] offset:3072
ds_read_b64_tr_b16 v[68:69], v133 offset:3072
ds_read_b64_tr_b16 v[70:71], v133 offset:3080
s_waitcnt lgkmcnt(3)
buffer_store_dwordx4 v[64:67], v244, s[20:23], s51 offen offset:2048 sc0 sc1
v_max3_f32 v104, v120, v121, v122
v_max_f32 v104, v104, v123
v_add_f32 v105, v120, v121
v_add_f32 v105, v105, v122
v_add_f32 v105, v105, v123
v_cmp_nge_f32 vcc, s42, v104
v_cmp_u_f32 s[28:29], v105, v105
s_or_b64 vcc, vcc, s[28:29]
s_cmp_lg_u64 vcc, 0
s_cselect_b32 s28, 1, 0
v_mov_b32 v104, s28
v_mov_b32 v106, 147456
s_waitcnt lgkmcnt(0)
buffer_store_dwordx4 v[68:71], v244, s[20:23], s51 offen offset:3072 sc0 sc1
ds_write_b32 v134, v104
s_waitcnt vmcnt(16) lgkmcnt(0)
s_barrier
ds_read2st64_b32 v[110:111], v106 offset0:32 offset1:48
ds_read2st64_b32 v[108:109], v106 offset0:0 offset1:16
ds_read_b64_tr_b16 a[64:65], v237 offset:0
ds_read_b64_tr_b16 a[66:67], v237 offset:4608
ds_read_b64_tr_b16 a[68:69], v237 offset:9216
ds_read_b64_tr_b16 a[70:71], v237 offset:13824
ds_read_b64_tr_b16 a[72:73], v237 offset:8
ds_read_b64_tr_b16 a[74:75], v237 offset:4616
ds_read_b64_tr_b16 a[76:77], v237 offset:9224
ds_read_b64_tr_b16 a[78:79], v237 offset:13832
ds_read_b64_tr_b16 a[80:81], v238 offset:0
ds_read_b64_tr_b16 a[82:83], v238 offset:4608
ds_read_b64_tr_b16 a[84:85], v238 offset:9216
ds_read_b64_tr_b16 a[86:87], v238 offset:13824
s_waitcnt lgkmcnt(12)
v_or_b32 v108, v108, v109
v_or3_b32 v108, v108, v110, v111
s_nop 0
v_readfirstlane_b32 s28, v108
s_cmp_gt_u32 s28, s43
s_cbranch_scc1 K_FALLBACK
s_waitcnt lgkmcnt(8)
v_mfma_f32_16x16x32_bf16 v[96:99], a[64:67], v[56:59], 0
ds_read_b64_tr_b16 a[88:89], v238 offset:8
ds_read_b64_tr_b16 a[90:91], v238 offset:4616
v_mfma_f32_16x16x32_bf16 v[96:99], a[68:71], v[60:63], v[96:99]
s_lshr_b32 s32, s35, 2
s_and_b32 s33, s35, 3
v_mfma_f32_16x16x32_bf16 v[88:91], a[68:71], v[44:47], 0
s_lshl_b32 s94, s36, 9
s_lshl_b32 s28, s32, 6
v_mfma_f32_16x16x32_bf16 v[88:91], a[64:67], v[40:43], v[88:91]
s_lshr_b32 s34, s32, 2
v_mfma_f32_16x16x32_bf16 v[80:83], a[64:67], v[24:27], 0
ds_read_b64_tr_b16 a[92:93], v238 offset:9224
ds_read_b64_tr_b16 a[94:95], v238 offset:13832
v_mfma_f32_16x16x32_bf16 v[80:83], a[68:71], v[28:31], v[80:83]
s_add_u32 s94, s94, s28
s_lshl_b32 s28, s37, 4
v_mfma_f32_16x16x32_bf16 v[72:75], a[68:71], v[12:15], 0
s_add_u32 s94, s94, s28
s_add_u32 s94, s94, 0x248000
v_mfma_f32_16x16x32_bf16 v[72:75], a[64:67], v[8:11], v[72:75]
v_mov_b32 v231, 1
v_and_b32 v229, 7, v1
s_waitcnt lgkmcnt(8)
v_mfma_f32_16x16x32_bf16 v[76:79], a[72:75], v[8:11], 0
ds_read_b64_tr_b16 a[64:65], v237 offset:128
ds_read_b64_tr_b16 a[66:67], v237 offset:4736
v_mfma_f32_16x16x32_bf16 v[76:79], a[76:79], v[12:15], v[76:79]
v_lshlrev_b32 v229, 2, v229
v_lshlrev_b32 v226, 3, v1
v_mfma_f32_16x16x32_bf16 v[84:87], a[76:79], v[28:31], 0
s_lshl2_add_u32 s29, s33, s94
v_mfma_f32_16x16x32_bf16 v[84:87], a[72:75], v[24:27], v[84:87]
v_mfma_f32_16x16x32_bf16 v[92:95], a[72:75], v[40:43], 0
ds_read_b64_tr_b16 a[68:69], v237 offset:9344
ds_read_b64_tr_b16 a[70:71], v237 offset:13952
v_mfma_f32_16x16x32_bf16 v[92:95], a[76:79], v[44:47], v[92:95]
v_mfma_f32_16x16x32_bf16 v[100:103], a[76:79], v[60:63], 0
v_mfma_f32_16x16x32_bf16 v[100:103], a[72:75], v[56:59], v[100:103]
s_waitcnt lgkmcnt(8)
v_mfma_f32_16x16x32_bf16 v[128:131], a[80:83], v[56:59], 0
ds_read_b64_tr_b16 a[72:73], v237 offset:136
ds_read_b64_tr_b16 a[74:75], v237 offset:4744
v_mfma_f32_16x16x32_bf16 v[128:131], a[84:87], v[60:63], v[128:131]
v_mfma_f32_16x16x32_bf16 v[120:123], a[84:87], v[44:47], 0
v_mfma_f32_16x16x32_bf16 v[120:123], a[80:83], v[40:43], v[120:123]
v_mfma_f32_16x16x32_bf16 v[112:115], a[80:83], v[24:27], 0
ds_read_b64_tr_b16 a[76:77], v237 offset:9352
ds_read_b64_tr_b16 a[78:79], v237 offset:13960
v_mfma_f32_16x16x32_bf16 v[112:115], a[84:87], v[28:31], v[112:115]
s_waitcnt vmcnt(0)
buffer_store_dword v231, v254, s[20:23], s29 offen sc0 sc1
v_mfma_f32_16x16x32_bf16 v[104:107], a[84:87], v[12:15], 0
s_add_u32 s28, s35, 1
s_and_b32 s28, s28, 3
v_mfma_f32_16x16x32_bf16 v[104:107], a[80:83], v[8:11], v[104:107]
s_mul_i32 s28, s28, 36864
s_waitcnt lgkmcnt(8)
v_mfma_f32_16x16x32_bf16 v[108:111], a[88:91], v[8:11], 0
ds_read_b64_tr_b16 a[80:81], v238 offset:128
ds_read_b64_tr_b16 a[82:83], v238 offset:4736
v_mfma_f32_16x16x32_bf16 v[108:111], a[92:95], v[12:15], v[108:111]
v_add_u32 v216, s28, v234
v_add_u32 v217, s28, v235
v_mfma_f32_16x16x32_bf16 v[116:119], a[92:95], v[28:31], 0
v_add_u32 v218, s28, v236
v_mfma_f32_16x16x32_bf16 v[116:119], a[88:91], v[24:27], v[116:119]
v_mfma_f32_16x16x32_bf16 v[124:127], a[88:91], v[40:43], 0
ds_read_b64_tr_b16 a[84:85], v238 offset:9344
ds_read_b64_tr_b16 a[86:87], v238 offset:13952
v_mfma_f32_16x16x32_bf16 v[124:127], a[92:95], v[44:47], v[124:127]
v_mfma_f32_16x16x32_bf16 v[132:135], a[92:95], v[60:63], 0
v_mfma_f32_16x16x32_bf16 v[132:135], a[88:91], v[56:59], v[132:135]
s_waitcnt lgkmcnt(8)
v_mfma_f32_16x16x32_bf16 v[160:163], a[64:67], v[56:59], 0
ds_read_b64_tr_b16 a[88:89], v238 offset:136
ds_read_b64_tr_b16 a[90:91], v238 offset:4744
v_mfma_f32_16x16x32_bf16 v[160:163], a[68:71], v[60:63], v[160:163]
v_mfma_f32_16x16x32_bf16 v[152:155], a[68:71], v[44:47], 0
v_mfma_f32_16x16x32_bf16 v[152:155], a[64:67], v[40:43], v[152:155]
v_mfma_f32_16x16x32_bf16 v[144:147], a[64:67], v[24:27], 0
ds_read_b64_tr_b16 a[92:93], v238 offset:9352
ds_read_b64_tr_b16 a[94:95], v238 offset:13960
v_mfma_f32_16x16x32_bf16 v[144:147], a[68:71], v[28:31], v[144:147]
v_mfma_f32_16x16x32_bf16 v[136:139], a[68:71], v[12:15], 0
v_mfma_f32_16x16x32_bf16 v[136:139], a[64:67], v[8:11], v[136:139]
s_waitcnt lgkmcnt(8)
v_mfma_f32_16x16x32_bf16 v[140:143], a[72:75], v[8:11], 0
ds_read_b64_tr_b16 a[64:65], v239 offset:0
ds_read_b64_tr_b16 a[66:67], v239 offset:4608
v_mfma_f32_16x16x32_bf16 v[140:143], a[76:79], v[12:15], v[140:143]
buffer_load_dword v230, v229, s[20:23], s94 offen sc0 sc1
v_mfma_f32_16x16x32_bf16 v[148:151], a[76:79], v[28:31], 0
s_add_u32 s39, s35, 1
s_and_b32 s39, s39, 3
v_mfma_f32_16x16x32_bf16 v[148:151], a[72:75], v[24:27], v[148:151]
s_add_u32 s28, s33, 1
s_and_b32 s28, s28, 3
v_mfma_f32_16x16x32_bf16 v[156:159], a[72:75], v[40:43], 0
ds_read_b64_tr_b16 a[68:69], v239 offset:9216
ds_read_b64_tr_b16 a[70:71], v239 offset:13824
v_mfma_f32_16x16x32_bf16 v[156:159], a[76:79], v[44:47], v[156:159]
s_sub_u32 s28, s28, s33
s_lshl_b32 s28, s28, 16
v_mfma_f32_16x16x32_bf16 v[164:167], a[76:79], v[60:63], 0
s_add_u32 s64, s28, s44
s_add_u32 s65, s64, 4096
v_mfma_f32_16x16x32_bf16 v[164:167], a[72:75], v[56:59], v[164:167]
s_add_u32 s66, s64, 8192
s_add_u32 s67, s64, 12288
s_waitcnt lgkmcnt(8)
v_mfma_f32_16x16x32_bf16 v[192:195], a[80:83], v[56:59], 0
ds_read_b64_tr_b16 a[72:73], v237 offset:18432
ds_read_b64_tr_b16 a[74:75], v237 offset:23040
v_mfma_f32_16x16x32_bf16 v[192:195], a[84:87], v[60:63], v[192:195]
s_add_u32 s28, s35, 2
s_and_b32 s28, s28, 3
v_mfma_f32_16x16x32_bf16 v[184:187], a[84:87], v[44:47], 0
s_mul_i32 s28, s28, 36864
v_mfma_f32_16x16x32_bf16 v[184:187], a[80:83], v[40:43], v[184:187]
v_add_u32 v219, s28, v234
v_add_u32 v220, s28, v235
v_mfma_f32_16x16x32_bf16 v[176:179], a[80:83], v[24:27], 0
ds_read_b64_tr_b16 a[76:77], v237 offset:27648
ds_read_b64_tr_b16 a[78:79], v237 offset:32256
v_mfma_f32_16x16x32_bf16 v[176:179], a[84:87], v[28:31], v[176:179]
v_add_u32 v221, s28, v236
v_mfma_f32_16x16x32_bf16 v[168:171], a[84:87], v[12:15], 0
s_add_u32 s28, s35, 3
s_and_b32 s28, s28, 3
v_mfma_f32_16x16x32_bf16 v[168:171], a[80:83], v[8:11], v[168:171]
s_mul_i32 s28, s28, 36864
s_waitcnt lgkmcnt(8)
v_mfma_f32_16x16x32_bf16 v[172:175], a[88:91], v[8:11], 0
ds_read_b64_tr_b16 a[80:81], v237 offset:18440
ds_read_b64_tr_b16 a[82:83], v237 offset:23048
v_mfma_f32_16x16x32_bf16 v[172:175], a[92:95], v[12:15], v[172:175]
v_add_u32 v222, s28, v234
v_add_u32 v223, s28, v235
v_mfma_f32_16x16x32_bf16 v[180:183], a[92:95], v[28:31], 0
v_add_u32 v224, s28, v236
v_mfma_f32_16x16x32_bf16 v[180:183], a[88:91], v[24:27], v[180:183]
v_mfma_f32_16x16x32_bf16 v[188:191], a[88:91], v[40:43], 0
ds_read_b64_tr_b16 a[84:85], v237 offset:27656
ds_read_b64_tr_b16 a[86:87], v237 offset:32264
v_mfma_f32_16x16x32_bf16 v[188:191], a[92:95], v[44:47], v[188:191]
v_mfma_f32_16x16x32_bf16 v[196:199], a[92:95], v[60:63], 0
s_waitcnt vmcnt(0)
v_cmp_gt_u32 vcc, 1, v230
v_mfma_f32_16x16x32_bf16 v[196:199], a[88:91], v[56:59], v[196:199]
s_waitcnt lgkmcnt(8)
v_mfma_f32_16x16x32_bf16 v[212:215], a[64:67], v[56:59], 0
ds_read_b64_tr_b16 a[88:89], v238 offset:18432
ds_read_b64_tr_b16 a[90:91], v238 offset:23040
v_mfma_f32_16x16x32_bf16 v[212:215], a[68:71], v[60:63], v[212:215]
s_bitcmp1_b32 vcc_lo, s39
s_cbranch_scc1 SP_O1B
SP_O1B_RET:
v_mfma_f32_16x16x32_bf16 v[208:211], a[68:71], v[44:47], 0
buffer_load_dwordx4 a[156:159], v244, s[20:23], s64 offen offset:0 sc0 sc1
v_mfma_f32_16x16x32_bf16 v[208:211], a[64:67], v[40:43], v[208:211]
v_mfma_f32_16x16x32_bf16 v[204:207], a[64:67], v[24:27], 0
ds_read_b64_tr_b16 a[92:93], v238 offset:27648
ds_read_b64_tr_b16 a[94:95], v238 offset:32256
v_mfma_f32_16x16x32_bf16 v[204:207], a[68:71], v[28:31], v[204:207]
v_mfma_f32_16x16x32_bf16 v[200:203], a[68:71], v[12:15], 0
buffer_load_dwordx4 a[172:175], v244, s[20:23], s65 offen offset:0 sc0 sc1
v_mfma_f32_16x16x32_bf16 v[200:203], a[64:67], v[8:11], v[200:203]
s_waitcnt lgkmcnt(8)
v_mfma_f32_16x16x32_bf16 v[72:75], a[72:75], v[16:19], v[72:75]
ds_read_b64_tr_b16 a[64:65], v238 offset:18440
ds_read_b64_tr_b16 a[66:67], v238 offset:23048
v_mfma_f32_16x16x32_bf16 v[72:75], a[76:79], v[20:23], v[72:75]
v_mfma_f32_16x16x32_bf16 v[80:83], a[76:79], v[36:39], v[80:83]
buffer_load_dwordx4 a[188:191], v244, s[20:23], s66 offen offset:0 sc0 sc1
v_mfma_f32_16x16x32_bf16 v[80:83], a[72:75], v[32:35], v[80:83]
v_mfma_f32_16x16x32_bf16 v[88:91], a[72:75], v[48:51], v[88:91]
ds_read_b64_tr_b16 a[68:69], v238 offset:27656
ds_read_b64_tr_b16 a[70:71], v238 offset:32264
v_mfma_f32_16x16x32_bf16 v[88:91], a[76:79], v[52:55], v[88:91]
v_mfma_f32_16x16x32_bf16 v[96:99], a[76:79], v[68:71], v[96:99]
buffer_load_dwordx4 a[204:207], v244, s[20:23], s67 offen offset:0 sc0 sc1
v_mfma_f32_16x16x32_bf16 v[96:99], a[72:75], v[64:67], v[96:99]
s_waitcnt lgkmcnt(8)
v_mfma_f32_16x16x32_bf16 v[100:103], a[80:83], v[64:67], v[100:103]
ds_read_b64_tr_b16 a[72:73], v237 offset:18560
ds_read_b64_tr_b16 a[74:75], v237 offset:23168
v_mfma_f32_16x16x32_bf16 v[100:103], a[84:87], v[68:71], v[100:103]
v_mfma_f32_16x16x32_bf16 v[92:95], a[84:87], v[52:55], v[92:95]
buffer_load_dwordx4 a[160:163], v244, s[20:23], s64 offen offset:1024 sc0 sc1
v_mfma_f32_16x16x32_bf16 v[92:95], a[80:83], v[48:51], v[92:95]
v_mfma_f32_16x16x32_bf16 v[84:87], a[80:83], v[32:35], v[84:87]
ds_read_b64_tr_b16 a[76:77], v237 offset:27776
ds_read_b64_tr_b16 a[78:79], v237 offset:32384
v_mfma_f32_16x16x32_bf16 v[84:87], a[84:87], v[36:39], v[84:87]
v_mfma_f32_16x16x32_bf16 v[76:79], a[84:87], v[20:23], v[76:79]
buffer_load_dwordx4 a[176:179], v244, s[20:23], s65 offen offset:1024 sc0 sc1
v_mfma_f32_16x16x32_bf16 v[76:79], a[80:83], v[16:19], v[76:79]
s_waitcnt lgkmcnt(8)
v_mfma_f32_16x16x32_bf16 v[104:107], a[88:91], v[16:19], v[104:107]
ds_read_b64_tr_b16 a[80:81], v237 offset:18568
ds_read_b64_tr_b16 a[82:83], v237 offset:23176
v_mfma_f32_16x16x32_bf16 v[104:107], a[92:95], v[20:23], v[104:107]
v_mfma_f32_16x16x32_bf16 v[112:115], a[92:95], v[36:39], v[112:115]
buffer_load_dwordx4 a[192:195], v244, s[20:23], s66 offen offset:1024 sc0 sc1
v_mfma_f32_16x16x32_bf16 v[112:115], a[88:91], v[32:35], v[112:115]
v_mfma_f32_16x16x32_bf16 v[120:123], a[88:91], v[48:51], v[120:123]
ds_read_b64_tr_b16 a[84:85], v237 offset:27784
ds_read_b64_tr_b16 a[86:87], v237 offset:32392
v_mfma_f32_16x16x32_bf16 v[120:123], a[92:95], v[52:55], v[120:123]
v_mfma_f32_16x16x32_bf16 v[128:131], a[92:95], v[68:71], v[128:131]
buffer_load_dwordx4 a[208:211], v244, s[20:23], s67 offen offset:1024 sc0 sc1
v_mfma_f32_16x16x32_bf16 v[128:131], a[88:91], v[64:67], v[128:131]
s_waitcnt lgkmcnt(8)
v_mfma_f32_16x16x32_bf16 v[132:135], a[64:67], v[64:67], v[132:135]
ds_read_b64_tr_b16 a[88:89], v238 offset:18560
ds_read_b64_tr_b16 a[90:91], v238 offset:23168
v_mfma_f32_16x16x32_bf16 v[132:135], a[68:71], v[68:71], v[132:135]
v_mfma_f32_16x16x32_bf16 v[124:127], a[68:71], v[52:55], v[124:127]
buffer_load_dwordx4 a[164:167], v244, s[20:23], s64 offen offset:2048 sc0 sc1
v_mfma_f32_16x16x32_bf16 v[124:127], a[64:67], v[48:51], v[124:127]
buffer_load_dword v230, v229, s[20:23], s94 offen sc0 sc1
v_mfma_f32_16x16x32_bf16 v[116:119], a[64:67], v[32:35], v[116:119]
ds_read_b64_tr_b16 a[92:93], v238 offset:27776
ds_read_b64_tr_b16 a[94:95], v238 offset:32384
v_mfma_f32_16x16x32_bf16 v[116:119], a[68:71], v[36:39], v[116:119]
v_mfma_f32_16x16x32_bf16 v[108:111], a[68:71], v[20:23], v[108:111]
v_mfma_f32_16x16x32_bf16 v[108:111], a[64:67], v[16:19], v[108:111]
buffer_load_dwordx4 a[180:183], v244, s[20:23], s65 offen offset:2048 sc0 sc1
s_waitcnt lgkmcnt(8)
v_mfma_f32_16x16x32_bf16 v[136:139], a[72:75], v[16:19], v[136:139]
ds_read_b64_tr_b16 a[64:65], v238 offset:18568
ds_read_b64_tr_b16 a[66:67], v238 offset:23176
v_mfma_f32_16x16x32_bf16 v[136:139], a[76:79], v[20:23], v[136:139]
v_mfma_f32_16x16x32_bf16 v[144:147], a[76:79], v[36:39], v[144:147]
v_mfma_f32_16x16x32_bf16 v[144:147], a[72:75], v[32:35], v[144:147]
buffer_load_dwordx4 a[196:199], v244, s[20:23], s66 offen offset:2048 sc0 sc1
v_mfma_f32_16x16x32_bf16 v[152:155], a[72:75], v[48:51], v[152:155]
ds_read_b64_tr_b16 a[68:69], v238 offset:27784
ds_read_b64_tr_b16 a[70:71], v238 offset:32392
v_mfma_f32_16x16x32_bf16 v[152:155], a[76:79], v[52:55], v[152:155]
v_mfma_f32_16x16x32_bf16 v[160:163], a[76:79], v[68:71], v[160:163]
v_mfma_f32_16x16x32_bf16 v[160:163], a[72:75], v[64:67], v[160:163]
buffer_load_dwordx4 a[212:215], v244, s[20:23], s67 offen offset:2048 sc0 sc1
s_waitcnt lgkmcnt(8)
v_mfma_f32_16x16x32_bf16 v[164:167], a[80:83], v[64:67], v[164:167]
ds_read_b64_tr_b16 a[72:73], v239 offset:18432
ds_read_b64_tr_b16 a[74:75], v239 offset:23040
v_mfma_f32_16x16x32_bf16 v[164:167], a[84:87], v[68:71], v[164:167]
v_mfma_f32_16x16x32_bf16 v[156:159], a[84:87], v[52:55], v[156:159]
v_mfma_f32_16x16x32_bf16 v[156:159], a[80:83], v[48:51], v[156:159]
buffer_load_dwordx4 a[168:171], v244, s[20:23], s64 offen offset:3072 sc0 sc1
v_mfma_f32_16x16x32_bf16 v[148:151], a[80:83], v[32:35], v[148:151]
ds_read_b64_tr_b16 a[76:77], v239 offset:27648
ds_read_b64_tr_b16 a[78:79], v239 offset:32256
v_mfma_f32_16x16x32_bf16 v[148:151], a[84:87], v[36:39], v[148:151]
v_mfma_f32_16x16x32_bf16 v[140:143], a[84:87], v[20:23], v[140:143]
v_mfma_f32_16x16x32_bf16 v[140:143], a[80:83], v[16:19], v[140:143]
buffer_load_dwordx4 a[184:187], v244, s[20:23], s65 offen offset:3072 sc0 sc1
s_waitcnt lgkmcnt(8)
v_mfma_f32_16x16x32_bf16 v[168:171], a[88:91], v[16:19], v[168:171]
ds_read_b64_tr_b16 a[80:81], v216 offset:0
ds_read_b64_tr_b16 a[82:83], v216 offset:4608
v_mfma_f32_16x16x32_bf16 v[168:171], a[92:95], v[20:23], v[168:171]
v_mfma_f32_16x16x32_bf16 v[176:179], a[92:95], v[36:39], v[176:179]
v_mfma_f32_16x16x32_bf16 v[176:179], a[88:91], v[32:35], v[176:179]
buffer_load_dwordx4 a[200:203], v244, s[20:23], s66 offen offset:3072 sc0 sc1
v_mfma_f32_16x16x32_bf16 v[184:187], a[88:91], v[48:51], v[184:187]
ds_read_b64_tr_b16 a[84:85], v216 offset:9216
ds_read_b64_tr_b16 a[86:87], v216 offset:13824
v_mfma_f32_16x16x32_bf16 v[184:187], a[92:95], v[52:55], v[184:187]
v_mfma_f32_16x16x32_bf16 v[192:195], a[92:95], v[68:71], v[192:195]
v_mfma_f32_16x16x32_bf16 v[192:195], a[88:91], v[64:67], v[192:195]
buffer_load_dwordx4 a[216:219], v244, s[20:23], s67 offen offset:3072 sc0 sc1
s_waitcnt lgkmcnt(8)
v_mfma_f32_16x16x32_bf16 v[196:199], a[64:67], v[64:67], v[196:199]
ds_read_b64_tr_b16 a[88:89], v216 offset:8
ds_read_b64_tr_b16 a[90:91], v216 offset:4616
v_mfma_f32_16x16x32_bf16 v[196:199], a[68:71], v[68:71], v[196:199]
s_add_u32 s28, s33, 2
s_and_b32 s28, s28, 3
v_mfma_f32_16x16x32_bf16 v[188:191], a[68:71], v[52:55], v[188:191]
s_sub_u32 s28, s28, s33
s_lshl_b32 s28, s28, 16
v_mfma_f32_16x16x32_bf16 v[188:191], a[64:67], v[48:51], v[188:191]
s_add_u32 s64, s28, s44
s_add_u32 s65, s64, 4096
v_mfma_f32_16x16x32_bf16 v[180:183], a[64:67], v[32:35], v[180:183]
ds_read_b64_tr_b16 a[92:93], v216 offset:9224
ds_read_b64_tr_b16 a[94:95], v216 offset:13832
v_mfma_f32_16x16x32_bf16 v[180:183], a[68:71], v[36:39], v[180:183]
s_add_u32 s66, s64, 8192
s_add_u32 s67, s64, 12288
v_mfma_f32_16x16x32_bf16 v[172:175], a[68:71], v[20:23], v[172:175]
s_waitcnt vmcnt(7)
v_cmp_gt_u32 vcc, 1, v230
v_mfma_f32_16x16x32_bf16 v[172:175], a[64:67], v[16:19], v[172:175]
s_waitcnt lgkmcnt(8)
v_mfma_f32_16x16x32_bf16 v[200:203], a[72:75], v[16:19], v[200:203]
ds_read_b64_tr_b16 a[64:65], v217 offset:0
ds_read_b64_tr_b16 a[66:67], v217 offset:4608
v_mfma_f32_16x16x32_bf16 v[200:203], a[76:79], v[20:23], v[200:203]
s_and_b32 s29, vcc_lo, 15
s_cbranch_scc1 SP_O2B
SP_O2B_RET:
v_mfma_f32_16x16x32_bf16 v[204:207], a[76:79], v[36:39], v[204:207]
buffer_load_dwordx4 a[220:223], v244, s[20:23], s64 offen offset:0 sc0 sc1
v_mfma_f32_16x16x32_bf16 v[204:207], a[72:75], v[32:35], v[204:207]
v_mfma_f32_16x16x32_bf16 v[208:211], a[72:75], v[48:51], v[208:211]
ds_read_b64_tr_b16 a[68:69], v217 offset:9216
ds_read_b64_tr_b16 a[70:71], v217 offset:13824
v_mfma_f32_16x16x32_bf16 v[208:211], a[76:79], v[52:55], v[208:211]
v_mfma_f32_16x16x32_bf16 v[212:215], a[76:79], v[68:71], v[212:215]
buffer_load_dwordx4 a[236:239], v244, s[20:23], s65 offen offset:0 sc0 sc1
v_mfma_f32_16x16x32_bf16 v[212:215], a[72:75], v[64:67], v[212:215]
s_waitcnt vmcnt(15)
s_waitcnt lgkmcnt(8)
v_mfma_f32_16x16x32_bf16 v[96:99], a[80:83], a[204:207], v[96:99]
ds_read_b64_tr_b16 a[72:73], v217 offset:8
ds_read_b64_tr_b16 a[74:75], v217 offset:4616
s_waitcnt vmcnt(11)
v_mfma_f32_16x16x32_bf16 v[96:99], a[84:87], a[208:211], v[96:99]
v_mfma_f32_16x16x32_bf16 v[88:91], a[84:87], a[192:195], v[88:91]
buffer_load_dwordx4 a[96:99], v244, s[20:23], s66 offen offset:0 sc0 sc1
v_mfma_f32_16x16x32_bf16 v[88:91], a[80:83], a[188:191], v[88:91]
v_accvgpr_read_b32 v39, a136
v_accvgpr_read_b32 v59, a144
v_mfma_f32_16x16x32_bf16 v[80:83], a[80:83], a[172:175], v[80:83]
ds_read_b64_tr_b16 a[76:77], v217 offset:9224
ds_read_b64_tr_b16 a[78:79], v217 offset:13832
v_mfma_f32_16x16x32_bf16 v[80:83], a[84:87], a[176:179], v[80:83]
v_lshlrev_b32 v38, 16, v39
v_and_b32 v39, 0xffff0000, v39
v_mfma_f32_16x16x32_bf16 v[72:75], a[84:87], a[160:163], v[72:75]
buffer_load_dwordx4 a[112:115], v244, s[20:23], s67 offen offset:0 sc0 sc1
v_mfma_f32_16x16x32_bf16 v[72:75], a[80:83], a[156:159], v[72:75]
v_lshlrev_b32 v58, 16, v59
v_and_b32 v59, 0xffff0000, v59
s_waitcnt lgkmcnt(8)
v_mfma_f32_16x16x32_bf16 v[76:79], a[88:91], a[156:159], v[76:79]
ds_read_b64_tr_b16 a[80:81], v216 offset:128
ds_read_b64_tr_b16 a[82:83], v216 offset:4736
v_mfma_f32_16x16x32_bf16 v[76:79], a[92:95], a[160:163], v[76:79]
v_add_f32 v38, v38, v58
v_add_f32 v39, v39, v59
v_mfma_f32_16x16x32_bf16 v[84:87], a[92:95], a[176:179], v[84:87]
buffer_load_dwordx4 a[224:227], v244, s[20:23], s64 offen offset:1024 sc0 sc1
v_mfma_f32_16x16x32_bf16 v[84:87], a[88:91], a[172:175], v[84:87]
v_cvt_pk_bf16_f32 v58, v38, v39
v_lshlrev_b32 v38, 16, v58
v_mfma_f32_16x16x32_bf16 v[92:95], a[88:91], a[188:191], v[92:95]
ds_read_b64_tr_b16 a[84:85], v216 offset:9344
ds_read_b64_tr_b16 a[86:87], v216 offset:13952
v_mfma_f32_16x16x32_bf16 v[92:95], a[92:95], a[192:195], v[92:95]
v_and_b32 v39, 0xffff0000, v58
v_mul_f32 v58, 0xbfb8aa3b, v38
v_mfma_f32_16x16x32_bf16 v[100:103], a[92:95], a[208:211], v[100:103]
buffer_load_dwordx4 a[240:243], v244, s[20:23], s65 offen offset:1024 sc0 sc1
v_mfma_f32_16x16x32_bf16 v[100:103], a[88:91], a[204:207], v[100:103]
v_mul_f32 v59, 0xbfb8aa3b, v39
s_waitcnt lgkmcnt(8)
v_mfma_f32_16x16x32_bf16 v[128:131], a[64:67], a[204:207], v[128:131]
ds_read_b64_tr_b16 a[88:89], v216 offset:136
ds_read_b64_tr_b16 a[90:91], v216 offset:4744
v_mfma_f32_16x16x32_bf16 v[128:131], a[68:71], a[208:211], v[128:131]
v_exp_f32 v58, v58
v_mfma_f32_16x16x32_bf16 v[120:123], a[68:71], a[192:195], v[120:123]
buffer_load_dwordx4 a[100:103], v244, s[20:23], s66 offen offset:1024 sc0 sc1
v_mfma_f32_16x16x32_bf16 v[120:123], a[64:67], a[188:191], v[120:123]
v_exp_f32 v59, v59
v_mfma_f32_16x16x32_bf16 v[112:115], a[64:67], a[172:175], v[112:115]
ds_read_b64_tr_b16 a[92:93], v216 offset:9352
ds_read_b64_tr_b16 a[94:95], v216 offset:13960
v_mfma_f32_16x16x32_bf16 v[112:115], a[68:71], a[176:179], v[112:115]
v_add_f32 v58, 1.0, v58
v_add_f32 v59, 1.0, v59
v_mfma_f32_16x16x32_bf16 v[104:107], a[68:71], a[160:163], v[104:107]
buffer_load_dwordx4 a[116:119], v244, s[20:23], s67 offen offset:1024 sc0 sc1
v_mfma_f32_16x16x32_bf16 v[104:107], a[64:67], a[156:159], v[104:107]
v_rcp_f32 v58, v58
s_waitcnt lgkmcnt(8)
v_mfma_f32_16x16x32_bf16 v[108:111], a[72:75], a[156:159], v[108:111]
ds_read_b64_tr_b16 a[64:65], v217 offset:128
ds_read_b64_tr_b16 a[66:67], v217 offset:4736
v_mfma_f32_16x16x32_bf16 v[108:111], a[76:79], a[160:163], v[108:111]
v_rcp_f32 v59, v59
v_mfma_f32_16x16x32_bf16 v[116:119], a[76:79], a[176:179], v[116:119]
buffer_load_dwordx4 a[228:231], v244, s[20:23], s64 offen offset:2048 sc0 sc1
v_mfma_f32_16x16x32_bf16 v[116:119], a[72:75], a[172:175], v[116:119]
v_mul_f32 v38, v38, v58
v_mul_f32 v39, v39, v59
v_mfma_f32_16x16x32_bf16 v[124:127], a[72:75], a[188:191], v[124:127]
ds_read_b64_tr_b16 a[68:69], v217 offset:9344
ds_read_b64_tr_b16 a[70:71], v217 offset:13952
v_mfma_f32_16x16x32_bf16 v[124:127], a[76:79], a[192:195], v[124:127]
v_cvt_pk_bf16_f32 v58, v38, v39
v_lshlrev_b32 v38, 16, v58
v_mfma_f32_16x16x32_bf16 v[132:135], a[76:79], a[208:211], v[132:135]
buffer_load_dwordx4 a[128:131], v244, s[20:23], s65 offen offset:2048 sc0 sc1
v_mfma_f32_16x16x32_bf16 v[132:135], a[72:75], a[204:207], v[132:135]
v_and_b32 v39, 0xffff0000, v58
v_accvgpr_read_b32 v41, a137
s_waitcnt lgkmcnt(8)
v_mfma_f32_16x16x32_bf16 v[160:163], a[80:83], a[204:207], v[160:163]
ds_read_b64_tr_b16 a[72:73], v217 offset:136
ds_read_b64_tr_b16 a[74:75], v217 offset:4744
v_mfma_f32_16x16x32_bf16 v[160:163], a[84:87], a[208:211], v[160:163]
v_accvgpr_read_b32 v59, a145
v_lshlrev_b32 v40, 16, v41
v_mfma_f32_16x16x32_bf16 v[152:155], a[84:87], a[192:195], v[152:155]
buffer_load_dwordx4 a[104:107], v244, s[20:23], s66 offen offset:2048 sc0 sc1
v_mfma_f32_16x16x32_bf16 v[152:155], a[80:83], a[188:191], v[152:155]
v_and_b32 v41, 0xffff0000, v41
v_lshlrev_b32 v58, 16, v59
v_mfma_f32_16x16x32_bf16 v[144:147], a[80:83], a[172:175], v[144:147]
ds_read_b64_tr_b16 a[76:77], v217 offset:9352
ds_read_b64_tr_b16 a[78:79], v217 offset:13960
v_mfma_f32_16x16x32_bf16 v[144:147], a[84:87], a[176:179], v[144:147]
v_and_b32 v59, 0xffff0000, v59
v_add_f32 v40, v40, v58
v_mfma_f32_16x16x32_bf16 v[136:139], a[84:87], a[160:163], v[136:139]
buffer_load_dwordx4 a[120:123], v244, s[20:23], s67 offen offset:2048 sc0 sc1
v_mfma_f32_16x16x32_bf16 v[136:139], a[80:83], a[156:159], v[136:139]
v_add_f32 v41, v41, v59
v_cvt_pk_bf16_f32 v58, v40, v41
s_waitcnt lgkmcnt(8)
v_mfma_f32_16x16x32_bf16 v[140:143], a[88:91], a[156:159], v[140:143]
ds_read_b64_tr_b16 a[80:81], v218 offset:0
ds_read_b64_tr_b16 a[82:83], v218 offset:4608
v_mfma_f32_16x16x32_bf16 v[140:143], a[92:95], a[160:163], v[140:143]
v_lshlrev_b32 v40, 16, v58
v_and_b32 v41, 0xffff0000, v58
v_mfma_f32_16x16x32_bf16 v[148:151], a[92:95], a[176:179], v[148:151]
buffer_load_dwordx4 a[232:235], v244, s[20:23], s64 offen offset:3072 sc0 sc1
v_mfma_f32_16x16x32_bf16 v[148:151], a[88:91], a[172:175], v[148:151]
v_mul_f32 v58, 0xbfb8aa3b, v40
v_mul_f32 v59, 0xbfb8aa3b, v41
v_mfma_f32_16x16x32_bf16 v[156:159], a[88:91], a[188:191], v[156:159]
ds_read_b64_tr_b16 a[84:85], v218 offset:9216
ds_read_b64_tr_b16 a[86:87], v218 offset:13824
v_mfma_f32_16x16x32_bf16 v[156:159], a[92:95], a[192:195], v[156:159]
v_exp_f32 v58, v58
v_mfma_f32_16x16x32_bf16 v[164:167], a[92:95], a[208:211], v[164:167]
buffer_load_dwordx4 a[132:135], v244, s[20:23], s65 offen offset:3072 sc0 sc1
v_mfma_f32_16x16x32_bf16 v[164:167], a[88:91], a[204:207], v[164:167]
v_exp_f32 v59, v59
s_waitcnt lgkmcnt(8)
v_mfma_f32_16x16x32_bf16 v[192:195], a[64:67], a[204:207], v[192:195]
ds_read_b64_tr_b16 a[88:89], v216 offset:18432
ds_read_b64_tr_b16 a[90:91], v216 offset:23040
v_mfma_f32_16x16x32_bf16 v[192:195], a[68:71], a[208:211], v[192:195]
v_add_f32 v58, 1.0, v58
v_add_f32 v59, 1.0, v59
v_mfma_f32_16x16x32_bf16 v[184:187], a[68:71], a[192:195], v[184:187]
buffer_load_dwordx4 a[108:111], v244, s[20:23], s66 offen offset:3072 sc0 sc1
v_mfma_f32_16x16x32_bf16 v[184:187], a[64:67], a[188:191], v[184:187]
v_rcp_f32 v58, v58
v_mfma_f32_16x16x32_bf16 v[176:179], a[64:67], a[172:175], v[176:179]
ds_read_b64_tr_b16 a[92:93], v216 offset:27648
ds_read_b64_tr_b16 a[94:95], v216 offset:32256
v_mfma_f32_16x16x32_bf16 v[176:179], a[68:71], a[176:179], v[176:179]
v_rcp_f32 v59, v59
v_mfma_f32_16x16x32_bf16 v[168:171], a[68:71], a[160:163], v[168:171]
buffer_load_dwordx4 a[124:127], v244, s[20:23], s67 offen offset:3072 sc0 sc1
v_mfma_f32_16x16x32_bf16 v[168:171], a[64:67], a[156:159], v[168:171]
s_add_u32 s28, s33, 3
s_and_b32 s28, s28, 3
s_waitcnt lgkmcnt(8)
v_mfma_f32_16x16x32_bf16 v[172:175], a[72:75], a[156:159], v[172:175]
ds_read_b64_tr_b16 a[64:65], v216 offset:18440
ds_read_b64_tr_b16 a[66:67], v216 offset:23048
v_mfma_f32_16x16x32_bf16 v[172:175], a[76:79], a[160:163], v[172:175]
s_sub_u32 s28, s28, s33
s_lshl_b32 s28, s28, 16
v_mfma_f32_16x16x32_bf16 v[180:183], a[76:79], a[176:179], v[180:183]
s_add_u32 s64, s28, s44
s_add_u32 s65, s64, 4096
v_mfma_f32_16x16x32_bf16 v[180:183], a[72:75], a[172:175], v[180:183]
s_add_u32 s66, s64, 8192
s_add_u32 s67, s64, 12288
v_mfma_f32_16x16x32_bf16 v[188:191], a[72:75], a[188:191], v[188:191]
ds_read_b64_tr_b16 a[68:69], v216 offset:27656
ds_read_b64_tr_b16 a[70:71], v216 offset:32264
v_mfma_f32_16x16x32_bf16 v[188:191], a[76:79], a[192:195], v[188:191]
buffer_load_dwordx4 a[0:3], v244, s[20:23], s64 offen offset:0 sc0 sc1
v_mfma_f32_16x16x32_bf16 v[196:199], a[76:79], a[208:211], v[196:199]
v_mul_f32 v40, v40, v58
v_mul_f32 v41, v41, v59
v_mfma_f32_16x16x32_bf16 v[196:199], a[72:75], a[204:207], v[196:199]
v_cvt_pk_bf16_f32 v58, v40, v41
v_lshlrev_b32 v40, 16, v58
s_waitcnt lgkmcnt(8)
v_mfma_f32_16x16x32_bf16 v[212:215], a[80:83], a[204:207], v[212:215]
ds_read_b64_tr_b16 a[72:73], v217 offset:18432
ds_read_b64_tr_b16 a[74:75], v217 offset:23040
v_mfma_f32_16x16x32_bf16 v[212:215], a[84:87], a[208:211], v[212:215]
buffer_load_dwordx4 a[16:19], v244, s[20:23], s65 offen offset:0 sc0 sc1
v_mfma_f32_16x16x32_bf16 v[208:211], a[84:87], a[192:195], v[208:211]
v_and_b32 v41, 0xffff0000, v58
v_accvgpr_read_b32 v43, a138
v_mfma_f32_16x16x32_bf16 v[208:211], a[80:83], a[188:191], v[208:211]
v_accvgpr_read_b32 v59, a146
v_lshlrev_b32 v42, 16, v43
v_mfma_f32_16x16x32_bf16 v[204:207], a[80:83], a[172:175], v[204:207]
ds_read_b64_tr_b16 a[76:77], v217 offset:27648
ds_read_b64_tr_b16 a[78:79], v217 offset:32256
v_mfma_f32_16x16x32_bf16 v[204:207], a[84:87], a[176:179], v[204:207]
buffer_load_dwordx4 a[32:35], v244, s[20:23], s66 offen offset:0 sc0 sc1
v_mfma_f32_16x16x32_bf16 v[200:203], a[84:87], a[160:163], v[200:203]
v_and_b32 v43, 0xffff0000, v43
v_lshlrev_b32 v58, 16, v59
v_mfma_f32_16x16x32_bf16 v[200:203], a[80:83], a[156:159], v[200:203]
v_and_b32 v59, 0xffff0000, v59
v_add_f32 v42, v42, v58
s_waitcnt vmcnt(23)
s_waitcnt lgkmcnt(8)
v_mfma_f32_16x16x32_bf16 v[72:75], a[88:91], a[164:167], v[72:75]
ds_read_b64_tr_b16 a[80:81], v217 offset:18440
ds_read_b64_tr_b16 a[82:83], v217 offset:23048
s_waitcnt vmcnt(19)
v_mfma_f32_16x16x32_bf16 v[72:75], a[92:95], a[168:171], v[72:75]
buffer_load_dwordx4 a[48:51], v244, s[20:23], s67 offen offset:0 sc0 sc1
v_mfma_f32_16x16x32_bf16 v[80:83], a[92:95], a[184:187], v[80:83]
v_add_f32 v43, v43, v59
v_cvt_pk_bf16_f32 v58, v42, v43
v_mfma_f32_16x16x32_bf16 v[80:83], a[88:91], a[180:183], v[80:83]
v_lshlrev_b32 v42, 16, v58
v_and_b32 v43, 0xffff0000, v58
v_mfma_f32_16x16x32_bf16 v[88:91], a[88:91], a[196:199], v[88:91]
ds_read_b64_tr_b16 a[84:85], v217 offset:27656
ds_read_b64_tr_b16 a[86:87], v217 offset:32264
v_mfma_f32_16x16x32_bf16 v[88:91], a[92:95], a[200:203], v[88:91]
buffer_load_dwordx4 a[4:7], v244, s[20:23], s64 offen offset:1024 sc0 sc1
v_mfma_f32_16x16x32_bf16 v[96:99], a[92:95], a[216:219], v[96:99]
v_mul_f32 v58, 0xbfb8aa3b, v42
v_mul_f32 v59, 0xbfb8aa3b, v43
v_mfma_f32_16x16x32_bf16 v[96:99], a[88:91], a[212:215], v[96:99]
v_exp_f32 v58, v58
s_waitcnt lgkmcnt(8)
v_mfma_f32_16x16x32_bf16 v[100:103], a[64:67], a[212:215], v[100:103]
ds_read_b64_tr_b16 a[88:89], v216 offset:18560
ds_read_b64_tr_b16 a[90:91], v216 offset:23168
v_mfma_f32_16x16x32_bf16 v[100:103], a[68:71], a[216:219], v[100:103]
buffer_load_dwordx4 a[20:23], v244, s[20:23], s65 offen offset:1024 sc0 sc1
v_mfma_f32_16x16x32_bf16 v[92:95], a[68:71], a[200:203], v[92:95]
v_exp_f32 v59, v59
v_mfma_f32_16x16x32_bf16 v[92:95], a[64:67], a[196:199], v[92:95]
v_add_f32 v58, 1.0, v58
v_add_f32 v59, 1.0, v59
v_mfma_f32_16x16x32_bf16 v[84:87], a[64:67], a[180:183], v[84:87]
ds_read_b64_tr_b16 a[92:93], v216 offset:27776
ds_read_b64_tr_b16 a[94:95], v216 offset:32384
v_mfma_f32_16x16x32_bf16 v[84:87], a[68:71], a[184:187], v[84:87]
buffer_load_dwordx4 a[36:39], v244, s[20:23], s66 offen offset:1024 sc0 sc1
v_mfma_f32_16x16x32_bf16 v[76:79], a[68:71], a[168:171], v[76:79]
v_rcp_f32 v58, v58
v_mfma_f32_16x16x32_bf16 v[76:79], a[64:67], a[164:167], v[76:79]
v_rcp_f32 v59, v59
s_waitcnt lgkmcnt(8)
v_mfma_f32_16x16x32_bf16 v[104:107], a[72:75], a[164:167], v[104:107]
ds_read_b64_tr_b16 a[64:65], v216 offset:18568
ds_read_b64_tr_b16 a[66:67], v216 offset:23176
v_mfma_f32_16x16x32_bf16 v[104:107], a[76:79], a[168:171], v[104:107]
buffer_load_dwordx4 a[52:55], v244, s[20:23], s67 offen offset:1024 sc0 sc1
v_mfma_f32_16x16x32_bf16 v[112:115], a[76:79], a[184:187], v[112:115]
v_mul_f32 v42, v42, v58
v_mul_f32 v43, v43, v59
v_mfma_f32_16x16x32_bf16 v[112:115], a[72:75], a[180:183], v[112:115]
v_cvt_pk_bf16_f32 v58, v42, v43
v_lshlrev_b32 v42, 16, v58
v_mfma_f32_16x16x32_bf16 v[120:123], a[72:75], a[196:199], v[120:123]
ds_read_b64_tr_b16 a[68:69], v216 offset:27784
ds_read_b64_tr_b16 a[70:71], v216 offset:32392
v_mfma_f32_16x16x32_bf16 v[120:123], a[76:79], a[200:203], v[120:123]
buffer_load_dwordx4 a[8:11], v244, s[20:23], s64 offen offset:2048 sc0 sc1
v_mfma_f32_16x16x32_bf16 v[128:131], a[76:79], a[216:219], v[128:131]
v_and_b32 v43, 0xffff0000, v58
v_accvgpr_read_b32 v45, a139
v_mfma_f32_16x16x32_bf16 v[128:131], a[72:75], a[212:215], v[128:131]
v_accvgpr_read_b32 v59, a147
v_lshlrev_b32 v44, 16, v45
s_waitcnt lgkmcnt(8)
v_mfma_f32_16x16x32_bf16 v[132:135], a[80:83], a[212:215], v[132:135]
ds_read_b64_tr_b16 a[72:73], v217 offset:18560
ds_read_b64_tr_b16 a[74:75], v217 offset:23168
v_mfma_f32_16x16x32_bf16 v[132:135], a[84:87], a[216:219], v[132:135]
buffer_load_dwordx4 a[24:27], v244, s[20:23], s65 offen offset:2048 sc0 sc1
v_mfma_f32_16x16x32_bf16 v[124:127], a[84:87], a[200:203], v[124:127]
v_and_b32 v45, 0xffff0000, v45
v_lshlrev_b32 v58, 16, v59
v_mfma_f32_16x16x32_bf16 v[124:127], a[80:83], a[196:199], v[124:127]
v_and_b32 v59, 0xffff0000, v59
v_add_f32 v44, v44, v58
v_mfma_f32_16x16x32_bf16 v[116:119], a[80:83], a[180:183], v[116:119]
ds_read_b64_tr_b16 a[76:77], v217 offset:27776
ds_read_b64_tr_b16 a[78:79], v217 offset:32384
v_mfma_f32_16x16x32_bf16 v[116:119], a[84:87], a[184:187], v[116:119]
buffer_load_dwordx4 a[40:43], v244, s[20:23], s66 offen offset:2048 sc0 sc1
v_mfma_f32_16x16x32_bf16 v[108:111], a[84:87], a[168:171], v[108:111]
v_add_f32 v45, v45, v59
v_cvt_pk_bf16_f32 v58, v44, v45
v_mfma_f32_16x16x32_bf16 v[108:111], a[80:83], a[164:167], v[108:111]
v_lshlrev_b32 v44, 16, v58
v_and_b32 v45, 0xffff0000, v58
s_waitcnt lgkmcnt(8)
v_mfma_f32_16x16x32_bf16 v[136:139], a[88:91], a[164:167], v[136:139]
ds_read_b64_tr_b16 a[80:81], v217 offset:18568
ds_read_b64_tr_b16 a[82:83], v217 offset:23176
v_mfma_f32_16x16x32_bf16 v[136:139], a[92:95], a[168:171], v[136:139]
buffer_load_dwordx4 a[56:59], v244, s[20:23], s67 offen offset:2048 sc0 sc1
v_mfma_f32_16x16x32_bf16 v[144:147], a[92:95], a[184:187], v[144:147]
v_mul_f32 v58, 0xbfb8aa3b, v44
v_mul_f32 v59, 0xbfb8aa3b, v45
v_mfma_f32_16x16x32_bf16 v[144:147], a[88:91], a[180:183], v[144:147]
v_exp_f32 v58, v58
v_mfma_f32_16x16x32_bf16 v[152:155], a[88:91], a[196:199], v[152:155]
ds_read_b64_tr_b16 a[84:85], v217 offset:27784
ds_read_b64_tr_b16 a[86:87], v217 offset:32392
v_mfma_f32_16x16x32_bf16 v[152:155], a[92:95], a[200:203], v[152:155]
buffer_load_dwordx4 a[12:15], v244, s[20:23], s64 offen offset:3072 sc0 sc1
v_mfma_f32_16x16x32_bf16 v[160:163], a[92:95], a[216:219], v[160:163]
v_exp_f32 v59, v59
v_mfma_f32_16x16x32_bf16 v[160:163], a[88:91], a[212:215], v[160:163]
v_add_f32 v58, 1.0, v58
v_add_f32 v59, 1.0, v59
s_waitcnt lgkmcnt(8)
v_mfma_f32_16x16x32_bf16 v[164:167], a[64:67], a[212:215], v[164:167]
ds_read_b64_tr_b16 a[88:89], v218 offset:18432
ds_read_b64_tr_b16 a[90:91], v218 offset:23040
v_mfma_f32_16x16x32_bf16 v[164:167], a[68:71], a[216:219], v[164:167]
buffer_load_dwordx4 a[28:31], v244, s[20:23], s65 offen offset:3072 sc0 sc1
v_mfma_f32_16x16x32_bf16 v[156:159], a[68:71], a[200:203], v[156:159]
v_rcp_f32 v58, v58
v_mfma_f32_16x16x32_bf16 v[156:159], a[64:67], a[196:199], v[156:159]
v_rcp_f32 v59, v59
v_mfma_f32_16x16x32_bf16 v[148:151], a[64:67], a[180:183], v[148:151]
ds_read_b64_tr_b16 a[92:93], v218 offset:27648
ds_read_b64_tr_b16 a[94:95], v218 offset:32256
v_mfma_f32_16x16x32_bf16 v[148:151], a[68:71], a[184:187], v[148:151]
buffer_load_dwordx4 a[44:47], v244, s[20:23], s66 offen offset:3072 sc0 sc1
v_mfma_f32_16x16x32_bf16 v[140:143], a[68:71], a[168:171], v[140:143]
v_mul_f32 v44, v44, v58
v_mul_f32 v45, v45, v59
v_mfma_f32_16x16x32_bf16 v[140:143], a[64:67], a[164:167], v[140:143]
v_cvt_pk_bf16_f32 v58, v44, v45
v_lshlrev_b32 v44, 16, v58
s_waitcnt lgkmcnt(8)
v_mfma_f32_16x16x32_bf16 v[168:171], a[72:75], a[164:167], v[168:171]
ds_read_b64_tr_b16 a[64:65], v220 offset:0
ds_read_b64_tr_b16 a[66:67], v220 offset:4608
v_mfma_f32_16x16x32_bf16 v[168:171], a[76:79], a[168:171], v[168:171]
buffer_load_dwordx4 a[60:63], v244, s[20:23], s67 offen offset:3072 sc0 sc1
v_mfma_f32_16x16x32_bf16 v[176:179], a[76:79], a[184:187], v[176:179]
s_lshl2_add_u32 s28, s36, s33
s_lshl2_add_u32 s28, s28, s37
v_mfma_f32_16x16x32_bf16 v[176:179], a[72:75], a[180:183], v[176:179]
s_lshl_b32 s95, s28, 5
s_add_u32 s95, s95, 0x24a000
v_mfma_f32_16x16x32_bf16 v[184:187], a[72:75], a[196:199], v[184:187]
ds_read_b64_tr_b16 a[68:69], v220 offset:9216
ds_read_b64_tr_b16 a[70:71], v220 offset:13824
v_mfma_f32_16x16x32_bf16 v[184:187], a[76:79], a[200:203], v[184:187]
s_lshl_b32 s28, s32, 18
s_sub_u32 s49, s44, s28
v_mfma_f32_16x16x32_bf16 v[192:195], a[76:79], a[216:219], v[192:195]
v_add_u32 v243, 0x2000, v244
v_mov_b32 v246, 2
v_mfma_f32_16x16x32_bf16 v[192:195], a[72:75], a[212:215], v[192:195]
s_lshl2_add_u32 s29, s33, s94
v_and_b32 v45, 0xffff0000, v58
s_waitcnt lgkmcnt(8)
v_mfma_f32_16x16x32_bf16 v[196:199], a[80:83], a[212:215], v[196:199]
ds_read_b64_tr_b16 a[72:73], v220 offset:18432
ds_read_b64_tr_b16 a[74:75], v220 offset:23040
v_mfma_f32_16x16x32_bf16 v[196:199], a[84:87], a[216:219], v[196:199]
v_accvgpr_read_b32 v47, a140
v_accvgpr_read_b32 v59, a148
v_mfma_f32_16x16x32_bf16 v[188:191], a[84:87], a[200:203], v[188:191]
v_lshlrev_b32 v46, 16, v47
v_and_b32 v47, 0xffff0000, v47
v_mfma_f32_16x16x32_bf16 v[188:191], a[80:83], a[196:199], v[188:191]
v_lshlrev_b32 v58, 16, v59
v_and_b32 v59, 0xffff0000, v59
v_mfma_f32_16x16x32_bf16 v[180:183], a[80:83], a[180:183], v[180:183]
ds_read_b64_tr_b16 a[76:77], v220 offset:27648
ds_read_b64_tr_b16 a[78:79], v220 offset:32256
v_mfma_f32_16x16x32_bf16 v[180:183], a[84:87], a[184:187], v[180:183]
v_add_f32 v46, v46, v58
v_add_f32 v47, v47, v59
v_mfma_f32_16x16x32_bf16 v[172:175], a[84:87], a[168:171], v[172:175]
v_cvt_pk_bf16_f32 v58, v46, v47
v_lshlrev_b32 v46, 16, v58
v_mfma_f32_16x16x32_bf16 v[172:175], a[80:83], a[164:167], v[172:175]
v_and_b32 v47, 0xffff0000, v58
v_mul_f32 v58, 0xbfb8aa3b, v46
s_waitcnt lgkmcnt(8)
v_mfma_f32_16x16x32_bf16 v[200:203], a[88:91], a[164:167], v[200:203]
ds_read_b64_tr_b16 a[80:81], v223 offset:0
ds_read_b64_tr_b16 a[82:83], v223 offset:4608
v_mfma_f32_16x16x32_bf16 v[200:203], a[92:95], a[168:171], v[200:203]
v_mul_f32 v59, 0xbfb8aa3b, v47
v_mfma_f32_16x16x32_bf16 v[204:207], a[92:95], a[184:187], v[204:207]
v_exp_f32 v58, v58
v_mfma_f32_16x16x32_bf16 v[204:207], a[88:91], a[180:183], v[204:207]
v_exp_f32 v59, v59
v_mfma_f32_16x16x32_bf16 v[208:211], a[88:91], a[196:199], v[208:211]
ds_read_b64_tr_b16 a[84:85], v223 offset:9216
ds_read_b64_tr_b16 a[86:87], v223 offset:13824
v_mfma_f32_16x16x32_bf16 v[208:211], a[92:95], a[200:203], v[208:211]
v_add_f32 v58, 1.0, v58
v_add_f32 v59, 1.0, v59
v_mfma_f32_16x16x32_bf16 v[212:215], a[92:95], a[216:219], v[212:215]
v_rcp_f32 v58, v58
v_mfma_f32_16x16x32_bf16 v[212:215], a[88:91], a[212:215], v[212:215]
v_rcp_f32 v59, v59
s_waitcnt vmcnt(28)
s_waitcnt lgkmcnt(8)
v_mfma_f32_16x16x32_bf16 v[128:131], a[64:67], a[112:115], v[128:131]
ds_read_b64_tr_b16 a[88:89], v223 offset:18432
ds_read_b64_tr_b16 a[90:91], v223 offset:23040
s_waitcnt vmcnt(24)
v_mfma_f32_16x16x32_bf16 v[128:131], a[68:71], a[116:119], v[128:131]
v_mul_f32 v46, v46, v58
v_mul_f32 v47, v47, v59
v_mfma_f32_16x16x32_bf16 v[120:123], a[68:71], a[100:103], v[120:123]
v_cvt_pk_bf16_f32 v58, v46, v47
v_lshlrev_b32 v46, 16, v58
v_mfma_f32_16x16x32_bf16 v[120:123], a[64:67], a[96:99], v[120:123]
v_and_b32 v47, 0xffff0000, v58
v_accvgpr_read_b32 v49, a141
v_mfma_f32_16x16x32_bf16 v[112:115], a[64:67], a[236:239], v[112:115]
ds_read_b64_tr_b16 a[92:93], v223 offset:27648
ds_read_b64_tr_b16 a[94:95], v223 offset:32256
v_mfma_f32_16x16x32_bf16 v[112:115], a[68:71], a[240:243], v[112:115]
v_accvgpr_read_b32 v59, a149
v_lshlrev_b32 v48, 16, v49
v_mfma_f32_16x16x32_bf16 v[104:107], a[68:71], a[224:227], v[104:107]
v_and_b32 v49, 0xffff0000, v49
v_lshlrev_b32 v58, 16, v59
v_mfma_f32_16x16x32_bf16 v[104:107], a[64:67], a[220:223], v[104:107]
s_waitcnt vmcnt(0)
buffer_store_dword v246, v254, s[20:23], s29 offen sc0 sc1
s_waitcnt vmcnt(21)
s_waitcnt lgkmcnt(8)
v_mfma_f32_16x16x32_bf16 v[104:107], a[72:75], a[228:231], v[104:107]
ds_read_b64_tr_b16 a[64:65], v220 offset:8
ds_read_b64_tr_b16 a[66:67], v220 offset:4616
s_waitcnt vmcnt(17)
v_mfma_f32_16x16x32_bf16 v[104:107], a[76:79], a[232:235], v[104:107]
s_xor_b32 s28, s32, 0
s_sub_u32 s29, s32, s28
v_mfma_f32_16x16x32_bf16 v[112:115], a[76:79], a[132:135], v[112:115]
s_lshl_b32 s28, s28, 18
s_and_b32 s29, s29, 3
v_mfma_f32_16x16x32_bf16 v[112:115], a[72:75], a[128:131], v[112:115]
s_add_u32 s28, s28, s49
s_lshl_b32 s50, s29, 10
v_mfma_f32_16x16x32_bf16 v[120:123], a[72:75], a[104:107], v[120:123]
ds_read_b64_tr_b16 a[68:69], v220 offset:9224
ds_read_b64_tr_b16 a[70:71], v220 offset:13832
v_mfma_f32_16x16x32_bf16 v[120:123], a[76:79], a[108:111], v[120:123]
s_mul_i32 s29, s29, 0x1200
s_and_b32 s29, s29, 0x2200
v_mfma_f32_16x16x32_bf16 v[128:131], a[76:79], a[124:127], v[128:131]
s_add_u32 s72, s28, s29
v_and_b32 v59, 0xffff0000, v59
v_mfma_f32_16x16x32_bf16 v[128:131], a[72:75], a[120:123], v[128:131]
s_xor_b32 s28, s32, 1
s_sub_u32 s29, s32, s28
s_waitcnt vmcnt(13)
s_waitcnt lgkmcnt(8)
v_mfma_f32_16x16x32_bf16 v[128:131], a[80:83], a[48:51], v[128:131]
ds_read_b64_tr_b16 a[72:73], v220 offset:18440
ds_read_b64_tr_b16 a[74:75], v220 offset:23048
s_waitcnt vmcnt(9)
v_mfma_f32_16x16x32_bf16 v[128:131], a[84:87], a[52:55], v[128:131]
s_lshl_b32 s28, s28, 18
s_and_b32 s29, s29, 3
v_mfma_f32_16x16x32_bf16 v[120:123], a[84:87], a[36:39], v[120:123]
s_add_u32 s28, s28, s49
s_lshl_b32 s50, s29, 10
v_mfma_f32_16x16x32_bf16 v[120:123], a[80:83], a[32:35], v[120:123]
s_add_u32 s65, s28, s50
v_add_f32 v48, v48, v58
v_mfma_f32_16x16x32_bf16 v[112:115], a[80:83], a[16:19], v[112:115]
ds_read_b64_tr_b16 a[76:77], v220 offset:27656
ds_read_b64_tr_b16 a[78:79], v220 offset:32264
v_mfma_f32_16x16x32_bf16 v[112:115], a[84:87], a[20:23], v[112:115]
s_mul_i32 s29, s29, 0x1200
s_and_b32 s29, s29, 0x2200
v_mfma_f32_16x16x32_bf16 v[104:107], a[84:87], a[4:7], v[104:107]
s_add_u32 s73, s28, s29
v_add_f32 v49, v49, v59
v_mfma_f32_16x16x32_bf16 v[104:107], a[80:83], a[0:3], v[104:107]
s_xor_b32 s28, s32, 2
s_sub_u32 s29, s32, s28
s_waitcnt vmcnt(5)
s_waitcnt lgkmcnt(8)
v_mfma_f32_16x16x32_bf16 v[104:107], a[88:91], a[8:11], v[104:107]
ds_read_b64_tr_b16 a[80:81], v223 offset:8
ds_read_b64_tr_b16 a[82:83], v223 offset:4616
s_waitcnt vmcnt(1)
v_mfma_f32_16x16x32_bf16 v[104:107], a[92:95], a[12:15], v[104:107]
s_lshl_b32 s28, s28, 18
s_and_b32 s29, s29, 3
v_mfma_f32_16x16x32_bf16 v[112:115], a[92:95], a[28:31], v[112:115]
s_add_u32 s28, s28, s49
s_lshl_b32 s50, s29, 10
v_mfma_f32_16x16x32_bf16 v[112:115], a[88:91], a[24:27], v[112:115]
s_add_u32 s66, s28, s50
v_cvt_pk_bf16_f32 v58, v48, v49
v_mfma_f32_16x16x32_bf16 v[120:123], a[88:91], a[40:43], v[120:123]
ds_read_b64_tr_b16 a[84:85], v223 offset:9224
ds_read_b64_tr_b16 a[86:87], v223 offset:13832
v_mfma_f32_16x16x32_bf16 v[120:123], a[92:95], a[44:47], v[120:123]
s_mul_i32 s29, s29, 0x1200
s_and_b32 s29, s29, 0x2200
v_mfma_f32_16x16x32_bf16 v[128:131], a[92:95], a[60:63], v[128:131]
s_add_u32 s74, s28, s29
v_lshlrev_b32 v48, 16, v58
v_mfma_f32_16x16x32_bf16 v[128:131], a[88:91], a[56:59], v[128:131]
s_xor_b32 s28, s32, 3
s_sub_u32 s29, s32, s28
s_waitcnt lgkmcnt(8)
v_mfma_f32_16x16x32_bf16 v[132:135], a[64:67], a[112:115], v[132:135]
ds_read_b64_tr_b16 a[88:89], v223 offset:18440
ds_read_b64_tr_b16 a[90:91], v223 offset:23048
v_mfma_f32_16x16x32_bf16 v[132:135], a[68:71], a[116:119], v[132:135]
s_lshl_b32 s28, s28, 18
s_and_b32 s29, s29, 3
v_mfma_f32_16x16x32_bf16 v[124:127], a[68:71], a[100:103], v[124:127]
s_add_u32 s28, s28, s49
s_lshl_b32 s50, s29, 10
v_mfma_f32_16x16x32_bf16 v[124:127], a[64:67], a[96:99], v[124:127]
s_add_u32 s67, s28, s50
v_and_b32 v49, 0xffff0000, v58
v_mfma_f32_16x16x32_bf16 v[116:119], a[64:67], a[236:239], v[116:119]
ds_read_b64_tr_b16 a[92:93], v223 offset:27656
ds_read_b64_tr_b16 a[94:95], v223 offset:32264
v_mfma_f32_16x16x32_bf16 v[116:119], a[68:71], a[240:243], v[116:119]
s_mul_i32 s29, s29, 0x1200
s_and_b32 s29, s29, 0x2200
v_mfma_f32_16x16x32_bf16 v[108:111], a[68:71], a[224:227], v[108:111]
s_add_u32 s75, s28, s29
v_mul_f32 v58, 0xbfb8aa3b, v48
v_mfma_f32_16x16x32_bf16 v[108:111], a[64:67], a[220:223], v[108:111]
buffer_load_dword v230, v229, s[20:23], s94 offen sc0 sc1
s_waitcnt lgkmcnt(8)
v_mfma_f32_16x16x32_bf16 v[108:111], a[72:75], a[228:231], v[108:111]
ds_read_b64_tr_b16 a[64:65], v220 offset:128
ds_read_b64_tr_b16 a[66:67], v220 offset:4736
v_mfma_f32_16x16x32_bf16 v[108:111], a[76:79], a[232:235], v[108:111]
s_xor_b32 s28, s32, 4
s_sub_u32 s29, s32, s28
v_mfma_f32_16x16x32_bf16 v[116:119], a[76:79], a[132:135], v[116:119]
s_lshl_b32 s28, s28, 18
s_and_b32 s29, s29, 3
v_mfma_f32_16x16x32_bf16 v[116:119], a[72:75], a[128:131], v[116:119]
s_add_u32 s28, s28, s49
s_lshl_b32 s50, s29, 10
v_mfma_f32_16x16x32_bf16 v[124:127], a[72:75], a[104:107], v[124:127]
ds_read_b64_tr_b16 a[68:69], v220 offset:9344
ds_read_b64_tr_b16 a[70:71], v220 offset:13952
v_mfma_f32_16x16x32_bf16 v[124:127], a[76:79], a[108:111], v[124:127]
s_add_u32 s68, s28, s50
s_add_u32 s68, s68, 4096
v_mfma_f32_16x16x32_bf16 v[132:135], a[76:79], a[124:127], v[132:135]
s_mul_i32 s29, s29, 0x1200
s_and_b32 s29, s29, 0x2200
v_mfma_f32_16x16x32_bf16 v[132:135], a[72:75], a[120:123], v[132:135]
s_add_u32 s84, s28, s29
v_mul_f32 v59, 0xbfb8aa3b, v49
s_waitcnt lgkmcnt(8)
v_mfma_f32_16x16x32_bf16 v[132:135], a[80:83], a[48:51], v[132:135]
ds_read_b64_tr_b16 a[72:73], v220 offset:18560
ds_read_b64_tr_b16 a[74:75], v220 offset:23168
v_mfma_f32_16x16x32_bf16 v[132:135], a[84:87], a[52:55], v[132:135]
s_xor_b32 s28, s32, 5
s_sub_u32 s29, s32, s28
v_mfma_f32_16x16x32_bf16 v[124:127], a[84:87], a[36:39], v[124:127]
s_lshl_b32 s28, s28, 18
s_and_b32 s29, s29, 3
v_mfma_f32_16x16x32_bf16 v[124:127], a[80:83], a[32:35], v[124:127]
s_add_u32 s28, s28, s49
s_lshl_b32 s50, s29, 10
v_mfma_f32_16x16x32_bf16 v[116:119], a[80:83], a[16:19], v[116:119]
ds_read_b64_tr_b16 a[76:77], v220 offset:27776
ds_read_b64_tr_b16 a[78:79], v220 offset:32384
v_mfma_f32_16x16x32_bf16 v[116:119], a[84:87], a[20:23], v[116:119]
s_add_u32 s69, s28, s50
s_add_u32 s69, s69, 4096
v_mfma_f32_16x16x32_bf16 v[108:111], a[84:87], a[4:7], v[108:111]
s_mul_i32 s29, s29, 0x1200
s_and_b32 s29, s29, 0x2200
v_mfma_f32_16x16x32_bf16 v[108:111], a[80:83], a[0:3], v[108:111]
s_add_u32 s85, s28, s29
s_waitcnt lgkmcnt(8)
v_mfma_f32_16x16x32_bf16 v[108:111], a[88:91], a[8:11], v[108:111]
ds_read_b64_tr_b16 a[80:81], v223 offset:128
ds_read_b64_tr_b16 a[82:83], v223 offset:4736
v_mfma_f32_16x16x32_bf16 v[108:111], a[92:95], a[12:15], v[108:111]
s_xor_b32 s28, s32, 6
s_sub_u32 s29, s32, s28
v_mfma_f32_16x16x32_bf16 v[116:119], a[92:95], a[28:31], v[116:119]
s_lshl_b32 s28, s28, 18
s_and_b32 s29, s29, 3
v_mfma_f32_16x16x32_bf16 v[116:119], a[88:91], a[24:27], v[116:119]
s_add_u32 s28, s28, s49
s_lshl_b32 s50, s29, 10
v_mfma_f32_16x16x32_bf16 v[124:127], a[88:91], a[40:43], v[124:127]
ds_read_b64_tr_b16 a[84:85], v223 offset:9344
ds_read_b64_tr_b16 a[86:87], v223 offset:13952
v_mfma_f32_16x16x32_bf16 v[124:127], a[92:95], a[44:47], v[124:127]
s_add_u32 s70, s28, s50
s_add_u32 s70, s70, 4096
v_mfma_f32_16x16x32_bf16 v[132:135], a[92:95], a[60:63], v[132:135]
s_mul_i32 s29, s29, 0x1200
s_and_b32 s29, s29, 0x2200
v_mfma_f32_16x16x32_bf16 v[132:135], a[88:91], a[56:59], v[132:135]
s_add_u32 s86, s28, s29
s_waitcnt lgkmcnt(8)
v_mfma_f32_16x16x32_bf16 v[192:195], a[64:67], a[112:115], v[192:195]
ds_read_b64_tr_b16 a[88:89], v223 offset:18560
ds_read_b64_tr_b16 a[90:91], v223 offset:23168
v_mfma_f32_16x16x32_bf16 v[192:195], a[68:71], a[116:119], v[192:195]
s_xor_b32 s28, s32, 7
s_sub_u32 s29, s32, s28
v_mfma_f32_16x16x32_bf16 v[184:187], a[68:71], a[100:103], v[184:187]
s_lshl_b32 s28, s28, 18
s_and_b32 s29, s29, 3
v_mfma_f32_16x16x32_bf16 v[184:187], a[64:67], a[96:99], v[184:187]
s_add_u32 s28, s28, s49
s_lshl_b32 s50, s29, 10
v_mfma_f32_16x16x32_bf16 v[176:179], a[64:67], a[236:239], v[176:179]
ds_read_b64_tr_b16 a[92:93], v223 offset:27776
ds_read_b64_tr_b16 a[94:95], v223 offset:32384
v_mfma_f32_16x16x32_bf16 v[176:179], a[68:71], a[240:243], v[176:179]
s_add_u32 s71, s28, s50
s_add_u32 s71, s71, 4096
v_mfma_f32_16x16x32_bf16 v[168:171], a[68:71], a[224:227], v[168:171]
s_mul_i32 s29, s29, 0x1200
s_and_b32 s29, s29, 0x2200
v_mfma_f32_16x16x32_bf16 v[168:171], a[64:67], a[220:223], v[168:171]
s_add_u32 s87, s28, s29
s_waitcnt lgkmcnt(8)
v_mfma_f32_16x16x32_bf16 v[168:171], a[72:75], a[228:231], v[168:171]
ds_read_b64_tr_b16 a[64:65], v220 offset:136
ds_read_b64_tr_b16 a[66:67], v220 offset:4744
v_mfma_f32_16x16x32_bf16 v[168:171], a[76:79], a[232:235], v[168:171]
s_waitcnt vmcnt(0)
v_cmp_gt_u32 vcc, 2, v230
v_mfma_f32_16x16x32_bf16 v[176:179], a[76:79], a[132:135], v[176:179]
v_exp_f32 v58, v58
v_mfma_f32_16x16x32_bf16 v[176:179], a[72:75], a[128:131], v[176:179]
s_and_b32 s29, vcc_lo, 15
s_cbranch_scc1 SP_O3B
SP_O3B_RET:
v_mfma_f32_16x16x32_bf16 v[184:187], a[72:75], a[104:107], v[184:187]
ds_read_b64_tr_b16 a[68:69], v220 offset:9352
ds_read_b64_tr_b16 a[70:71], v220 offset:13960
v_mfma_f32_16x16x32_bf16 v[184:187], a[76:79], a[108:111], v[184:187]
s_add_u32 s39, s44, 4096
v_mfma_f32_16x16x32_bf16 v[192:195], a[76:79], a[124:127], v[192:195]
v_cvt_pk_bf16_f32 v104, v104, v105
v_cvt_pk_bf16_f32 v105, v106, v107
v_mfma_f32_16x16x32_bf16 v[192:195], a[72:75], a[120:123], v[192:195]
v_cvt_pk_bf16_f32 v106, v108, v109
v_cvt_pk_bf16_f32 v107, v110, v111
s_waitcnt lgkmcnt(8)
v_mfma_f32_16x16x32_bf16 v[192:195], a[80:83], a[48:51], v[192:195]
ds_read_b64_tr_b16 a[72:73], v220 offset:18568
ds_read_b64_tr_b16 a[74:75], v220 offset:23176
v_mfma_f32_16x16x32_bf16 v[192:195], a[84:87], a[52:55], v[192:195]
buffer_store_dwordx4 v[104:107], v244, s[20:23], s39 offen offset:0 sc0 sc1
v_mfma_f32_16x16x32_bf16 v[184:187], a[84:87], a[36:39], v[184:187]
v_cvt_pk_bf16_f32 v112, v112, v113
v_cvt_pk_bf16_f32 v113, v114, v115
v_mfma_f32_16x16x32_bf16 v[184:187], a[80:83], a[32:35], v[184:187]
v_cvt_pk_bf16_f32 v114, v116, v117
v_cvt_pk_bf16_f32 v115, v118, v119
v_mfma_f32_16x16x32_bf16 v[176:179], a[80:83], a[16:19], v[176:179]
ds_read_b64_tr_b16 a[76:77], v220 offset:27784
ds_read_b64_tr_b16 a[78:79], v220 offset:32392
v_mfma_f32_16x16x32_bf16 v[176:179], a[84:87], a[20:23], v[176:179]
buffer_store_dwordx4 v[112:115], v244, s[20:23], s39 offen offset:1024 sc0 sc1
v_mfma_f32_16x16x32_bf16 v[168:171], a[84:87], a[4:7], v[168:171]
v_cvt_pk_bf16_f32 v120, v120, v121
v_cvt_pk_bf16_f32 v121, v122, v123
v_mfma_f32_16x16x32_bf16 v[168:171], a[80:83], a[0:3], v[168:171]
v_cvt_pk_bf16_f32 v122, v124, v125
v_cvt_pk_bf16_f32 v123, v126, v127
s_waitcnt lgkmcnt(8)
v_mfma_f32_16x16x32_bf16 v[168:171], a[88:91], a[8:11], v[168:171]
ds_read_b64_tr_b16 a[80:81], v223 offset:136
ds_read_b64_tr_b16 a[82:83], v223 offset:4744
v_mfma_f32_16x16x32_bf16 v[168:171], a[92:95], a[12:15], v[168:171]
buffer_store_dwordx4 v[120:123], v244, s[20:23], s39 offen offset:2048 sc0 sc1
v_mfma_f32_16x16x32_bf16 v[176:179], a[92:95], a[28:31], v[176:179]
v_cvt_pk_bf16_f32 v128, v128, v129
v_cvt_pk_bf16_f32 v129, v130, v131
v_mfma_f32_16x16x32_bf16 v[176:179], a[88:91], a[24:27], v[176:179]
v_cvt_pk_bf16_f32 v130, v132, v133
v_cvt_pk_bf16_f32 v131, v134, v135
v_mfma_f32_16x16x32_bf16 v[184:187], a[88:91], a[40:43], v[184:187]
ds_read_b64_tr_b16 a[84:85], v223 offset:9352
ds_read_b64_tr_b16 a[86:87], v223 offset:13960
v_mfma_f32_16x16x32_bf16 v[184:187], a[92:95], a[44:47], v[184:187]
buffer_store_dwordx4 v[128:131], v244, s[20:23], s39 offen offset:3072 sc0 sc1
v_mfma_f32_16x16x32_bf16 v[192:195], a[92:95], a[60:63], v[192:195]
v_exp_f32 v59, v59
v_mfma_f32_16x16x32_bf16 v[192:195], a[88:91], a[56:59], v[192:195]
v_add_f32 v58, 1.0, v58
v_add_f32 v59, 1.0, v59
s_waitcnt lgkmcnt(8)
v_mfma_f32_16x16x32_bf16 v[196:199], a[64:67], a[112:115], v[196:199]
ds_read_b64_tr_b16 a[88:89], v223 offset:18568
ds_read_b64_tr_b16 a[90:91], v223 offset:23176
v_mfma_f32_16x16x32_bf16 v[196:199], a[68:71], a[116:119], v[196:199]
v_rcp_f32 v58, v58
v_mfma_f32_16x16x32_bf16 v[188:191], a[68:71], a[100:103], v[188:191]
v_rcp_f32 v59, v59
v_mfma_f32_16x16x32_bf16 v[188:191], a[64:67], a[96:99], v[188:191]
v_mul_f32 v48, v48, v58
v_mul_f32 v49, v49, v59
v_mfma_f32_16x16x32_bf16 v[180:183], a[64:67], a[236:239], v[180:183]
ds_read_b64_tr_b16 a[92:93], v223 offset:27784
ds_read_b64_tr_b16 a[94:95], v223 offset:32392
v_mfma_f32_16x16x32_bf16 v[180:183], a[68:71], a[240:243], v[180:183]
v_cvt_pk_bf16_f32 v58, v48, v49
v_lshlrev_b32 v48, 16, v58
v_mfma_f32_16x16x32_bf16 v[172:175], a[68:71], a[224:227], v[172:175]
v_and_b32 v49, 0xffff0000, v58
v_accvgpr_read_b32 v51, a142
v_mfma_f32_16x16x32_bf16 v[172:175], a[64:67], a[220:223], v[172:175]
v_accvgpr_read_b32 v59, a150
v_lshlrev_b32 v50, 16, v51
s_waitcnt lgkmcnt(8)
v_mfma_f32_16x16x32_bf16 v[172:175], a[72:75], a[228:231], v[172:175]
ds_read_b64_tr_b16 a[64:65], v221 offset:0
ds_read_b64_tr_b16 a[66:67], v221 offset:4608
v_mfma_f32_16x16x32_bf16 v[172:175], a[76:79], a[232:235], v[172:175]
v_and_b32 v51, 0xffff0000, v51
v_lshlrev_b32 v58, 16, v59
v_mfma_f32_16x16x32_bf16 v[180:183], a[76:79], a[132:135], v[180:183]
v_and_b32 v59, 0xffff0000, v59
v_add_f32 v50, v50, v58
v_mfma_f32_16x16x32_bf16 v[180:183], a[72:75], a[128:131], v[180:183]
v_add_f32 v51, v51, v59
v_cvt_pk_bf16_f32 v58, v50, v51
v_mfma_f32_16x16x32_bf16 v[188:191], a[72:75], a[104:107], v[188:191]
ds_read_b64_tr_b16 a[68:69], v221 offset:9216
ds_read_b64_tr_b16 a[70:71], v221 offset:13824
v_mfma_f32_16x16x32_bf16 v[188:191], a[76:79], a[108:111], v[188:191]
v_lshlrev_b32 v50, 16, v58
v_and_b32 v51, 0xffff0000, v58
v_mfma_f32_16x16x32_bf16 v[196:199], a[76:79], a[124:127], v[196:199]
v_mul_f32 v58, 0xbfb8aa3b, v50
v_mul_f32 v59, 0xbfb8aa3b, v51
v_mfma_f32_16x16x32_bf16 v[196:199], a[72:75], a[120:123], v[196:199]
v_exp_f32 v58, v58
s_waitcnt lgkmcnt(8)
v_mfma_f32_16x16x32_bf16 v[196:199], a[80:83], a[48:51], v[196:199]
ds_read_b64_tr_b16 a[72:73], v221 offset:18432
ds_read_b64_tr_b16 a[74:75], v221 offset:23040
v_mfma_f32_16x16x32_bf16 v[196:199], a[84:87], a[52:55], v[196:199]
v_exp_f32 v59, v59
v_mfma_f32_16x16x32_bf16 v[188:191], a[84:87], a[36:39], v[188:191]
v_add_f32 v58, 1.0, v58
v_add_f32 v59, 1.0, v59
v_mfma_f32_16x16x32_bf16 v[188:191], a[80:83], a[32:35], v[188:191]
v_rcp_f32 v58, v58
v_mfma_f32_16x16x32_bf16 v[180:183], a[80:83], a[16:19], v[180:183]
ds_read_b64_tr_b16 a[76:77], v221 offset:27648
ds_read_b64_tr_b16 a[78:79], v221 offset:32256
v_mfma_f32_16x16x32_bf16 v[180:183], a[84:87], a[20:23], v[180:183]
v_rcp_f32 v59, v59
v_mfma_f32_16x16x32_bf16 v[172:175], a[84:87], a[4:7], v[172:175]
v_mul_f32 v50, v50, v58
v_mul_f32 v51, v51, v59
v_mfma_f32_16x16x32_bf16 v[172:175], a[80:83], a[0:3], v[172:175]
v_cvt_pk_bf16_f32 v58, v50, v51
v_lshlrev_b32 v50, 16, v58
s_waitcnt lgkmcnt(8)
v_mfma_f32_16x16x32_bf16 v[172:175], a[88:91], a[8:11], v[172:175]
ds_read_b64_tr_b16 a[80:81], v224 offset:0
ds_read_b64_tr_b16 a[82:83], v224 offset:4608
v_mfma_f32_16x16x32_bf16 v[172:175], a[92:95], a[12:15], v[172:175]
v_and_b32 v51, 0xffff0000, v58
v_accvgpr_read_b32 v53, a143
v_mfma_f32_16x16x32_bf16 v[180:183], a[92:95], a[28:31], v[180:183]
v_accvgpr_read_b32 v59, a151
v_lshlrev_b32 v52, 16, v53
v_mfma_f32_16x16x32_bf16 v[180:183], a[88:91], a[24:27], v[180:183]
v_and_b32 v53, 0xffff0000, v53
v_lshlrev_b32 v58, 16, v59
v_mfma_f32_16x16x32_bf16 v[188:191], a[88:91], a[40:43], v[188:191]
ds_read_b64_tr_b16 a[84:85], v224 offset:9216
ds_read_b64_tr_b16 a[86:87], v224 offset:13824
v_mfma_f32_16x16x32_bf16 v[188:191], a[92:95], a[44:47], v[188:191]
v_and_b32 v59, 0xffff0000, v59
v_add_f32 v52, v52, v58
v_mfma_f32_16x16x32_bf16 v[196:199], a[92:95], a[60:63], v[196:199]
v_add_f32 v53, v53, v59
v_cvt_pk_bf16_f32 v58, v52, v53
v_mfma_f32_16x16x32_bf16 v[196:199], a[88:91], a[56:59], v[196:199]
v_lshlrev_b32 v52, 16, v58
v_and_b32 v53, 0xffff0000, v58
s_waitcnt lgkmcnt(8)
v_mfma_f32_16x16x32_bf16 v[212:215], a[64:67], a[112:115], v[212:215]
ds_read_b64_tr_b16 a[88:89], v224 offset:18432
ds_read_b64_tr_b16 a[90:91], v224 offset:23040
v_mfma_f32_16x16x32_bf16 v[212:215], a[68:71], a[116:119], v[212:215]
v_mul_f32 v58, 0xbfb8aa3b, v52
v_mul_f32 v59, 0xbfb8aa3b, v53
v_mfma_f32_16x16x32_bf16 v[208:211], a[68:71], a[100:103], v[208:211]
v_exp_f32 v58, v58
v_mfma_f32_16x16x32_bf16 v[208:211], a[64:67], a[96:99], v[208:211]
v_exp_f32 v59, v59
v_mfma_f32_16x16x32_bf16 v[204:207], a[64:67], a[236:239], v[204:207]
ds_read_b64_tr_b16 a[92:93], v224 offset:27648
ds_read_b64_tr_b16 a[94:95], v224 offset:32256
v_mfma_f32_16x16x32_bf16 v[204:207], a[68:71], a[240:243], v[204:207]
v_add_f32 v58, 1.0, v58
v_add_f32 v59, 1.0, v59
v_mfma_f32_16x16x32_bf16 v[200:203], a[68:71], a[224:227], v[200:203]
v_rcp_f32 v58, v58
v_mfma_f32_16x16x32_bf16 v[200:203], a[64:67], a[220:223], v[200:203]
v_rcp_f32 v59, v59
s_waitcnt lgkmcnt(8)
v_mfma_f32_16x16x32_bf16 v[200:203], a[72:75], a[228:231], v[200:203]
ds_read_b64_tr_b16 a[64:65], v219 offset:0
ds_read_b64_tr_b16 a[66:67], v219 offset:4608
v_mfma_f32_16x16x32_bf16 v[200:203], a[76:79], a[232:235], v[200:203]
s_add_u32 s39, s44, 12288
v_mul_f32 v52, v52, v58
v_mfma_f32_16x16x32_bf16 v[204:207], a[76:79], a[132:135], v[204:207]
v_cvt_pk_bf16_f32 v168, v168, v169
v_cvt_pk_bf16_f32 v169, v170, v171
v_mfma_f32_16x16x32_bf16 v[204:207], a[72:75], a[128:131], v[204:207]
v_cvt_pk_bf16_f32 v170, v172, v173
v_cvt_pk_bf16_f32 v171, v174, v175
v_mfma_f32_16x16x32_bf16 v[208:211], a[72:75], a[104:107], v[208:211]
ds_read_b64_tr_b16 a[68:69], v219 offset:9216
ds_read_b64_tr_b16 a[70:71], v219 offset:13824
v_mfma_f32_16x16x32_bf16 v[208:211], a[76:79], a[108:111], v[208:211]
buffer_store_dwordx4 v[168:171], v244, s[20:23], s39 offen offset:0 sc0 sc1
v_mfma_f32_16x16x32_bf16 v[212:215], a[76:79], a[124:127], v[212:215]
v_cvt_pk_bf16_f32 v176, v176, v177
v_cvt_pk_bf16_f32 v177, v178, v179
v_mfma_f32_16x16x32_bf16 v[212:215], a[72:75], a[120:123], v[212:215]
v_cvt_pk_bf16_f32 v178, v180, v181
v_cvt_pk_bf16_f32 v179, v182, v183
s_waitcnt lgkmcnt(8)
v_mfma_f32_16x16x32_bf16 v[212:215], a[80:83], a[48:51], v[212:215]
ds_read_b64_tr_b16 a[72:73], v219 offset:18432
ds_read_b64_tr_b16 a[74:75], v219 offset:23040
v_mfma_f32_16x16x32_bf16 v[212:215], a[84:87], a[52:55], v[212:215]
buffer_store_dwordx4 v[176:179], v244, s[20:23], s39 offen offset:1024 sc0 sc1
v_mfma_f32_16x16x32_bf16 v[208:211], a[84:87], a[36:39], v[208:211]
v_cvt_pk_bf16_f32 v184, v184, v185
v_cvt_pk_bf16_f32 v185, v186, v187
v_mfma_f32_16x16x32_bf16 v[208:211], a[80:83], a[32:35], v[208:211]
v_cvt_pk_bf16_f32 v186, v188, v189
v_cvt_pk_bf16_f32 v187, v190, v191
v_mfma_f32_16x16x32_bf16 v[204:207], a[80:83], a[16:19], v[204:207]
ds_read_b64_tr_b16 a[76:77], v219 offset:27648
ds_read_b64_tr_b16 a[78:79], v219 offset:32256
v_mfma_f32_16x16x32_bf16 v[204:207], a[84:87], a[20:23], v[204:207]
buffer_store_dwordx4 v[184:187], v244, s[20:23], s39 offen offset:2048 sc0 sc1
v_mfma_f32_16x16x32_bf16 v[200:203], a[84:87], a[4:7], v[200:203]
v_cvt_pk_bf16_f32 v192, v192, v193
v_cvt_pk_bf16_f32 v193, v194, v195
v_mfma_f32_16x16x32_bf16 v[200:203], a[80:83], a[0:3], v[200:203]
v_cvt_pk_bf16_f32 v194, v196, v197
v_cvt_pk_bf16_f32 v195, v198, v199
s_waitcnt lgkmcnt(8)
v_mfma_f32_16x16x32_bf16 v[200:203], a[88:91], a[8:11], v[200:203]
ds_read_b64_tr_b16 a[80:81], v222 offset:0
ds_read_b64_tr_b16 a[82:83], v222 offset:4608
v_mfma_f32_16x16x32_bf16 v[200:203], a[92:95], a[12:15], v[200:203]
buffer_store_dwordx4 v[192:195], v244, s[20:23], s39 offen offset:3072 sc0 sc1
v_mfma_f32_16x16x32_bf16 v[204:207], a[92:95], a[28:31], v[204:207]
ds_read_b64_tr_b16 a[156:157], v219 offset:128
ds_read_b64_tr_b16 a[158:159], v219 offset:4736
v_mfma_f32_16x16x32_bf16 v[204:207], a[88:91], a[24:27], v[204:207]
v_mul_f32 v53, v53, v59
v_cvt_pk_bf16_f32 v58, v52, v53
v_mfma_f32_16x16x32_bf16 v[208:211], a[88:91], a[40:43], v[208:211]
ds_read_b64_tr_b16 a[84:85], v222 offset:9216
ds_read_b64_tr_b16 a[86:87], v222 offset:13824
v_mfma_f32_16x16x32_bf16 v[208:211], a[92:95], a[44:47], v[208:211]
v_lshlrev_b32 v52, 16, v58
v_and_b32 v53, 0xffff0000, v58
v_mfma_f32_16x16x32_bf16 v[212:215], a[92:95], a[60:63], v[212:215]
ds_read_b64_tr_b16 a[160:161], v219 offset:9344
ds_read_b64_tr_b16 a[162:163], v219 offset:13952
v_mfma_f32_16x16x32_bf16 v[212:215], a[88:91], a[56:59], v[212:215]
v_accvgpr_read_b32 v55, a254
v_accvgpr_read_b32 v59, a152
s_waitcnt lgkmcnt(8)
v_mfma_f32_16x16x32_bf16 v[96:99], a[64:67], a[112:115], v[96:99]
ds_read_b64_tr_b16 a[88:89], v222 offset:18432
ds_read_b64_tr_b16 a[90:91], v222 offset:23040
v_mfma_f32_16x16x32_bf16 v[96:99], a[68:71], a[116:119], v[96:99]
v_lshlrev_b32 v54, 16, v55
v_and_b32 v55, 0xffff0000, v55
v_mfma_f32_16x16x32_bf16 v[88:91], a[68:71], a[100:103], v[88:91]
ds_read_b64_tr_b16 a[164:165], v219 offset:18560
ds_read_b64_tr_b16 a[166:167], v219 offset:23168
v_mfma_f32_16x16x32_bf16 v[88:91], a[64:67], a[96:99], v[88:91]
v_lshlrev_b32 v58, 16, v59
v_and_b32 v59, 0xffff0000, v59
v_mfma_f32_16x16x32_bf16 v[80:83], a[64:67], a[236:239], v[80:83]
ds_read_b64_tr_b16 a[92:93], v222 offset:27648
ds_read_b64_tr_b16 a[94:95], v222 offset:32256
v_mfma_f32_16x16x32_bf16 v[80:83], a[68:71], a[240:243], v[80:83]
v_add_f32 v54, v54, v58
v_add_f32 v55, v55, v59
v_mfma_f32_16x16x32_bf16 v[72:75], a[68:71], a[224:227], v[72:75]
ds_read_b64_tr_b16 a[168:169], v219 offset:27776
ds_read_b64_tr_b16 a[170:171], v219 offset:32384
v_mfma_f32_16x16x32_bf16 v[72:75], a[64:67], a[220:223], v[72:75]
v_cvt_pk_bf16_f32 v58, v54, v55
v_lshlrev_b32 v54, 16, v58
v_mfma_f32_16x16x32_bf16 v[72:75], a[72:75], a[228:231], v[72:75]
ds_read_b64_tr_b16 a[64:65], v219 offset:8
ds_read_b64_tr_b16 a[66:67], v219 offset:4616
v_mfma_f32_16x16x32_bf16 v[72:75], a[76:79], a[232:235], v[72:75]
s_add_u32 s39, s44, 8192
v_and_b32 v55, 0xffff0000, v58
v_mfma_f32_16x16x32_bf16 v[80:83], a[76:79], a[132:135], v[80:83]
ds_read_b64_tr_b16 a[172:173], v222 offset:128
ds_read_b64_tr_b16 a[174:175], v222 offset:4736
v_mfma_f32_16x16x32_bf16 v[80:83], a[72:75], a[128:131], v[80:83]
v_cvt_pk_bf16_f32 v200, v200, v201
v_cvt_pk_bf16_f32 v201, v202, v203
v_mfma_f32_16x16x32_bf16 v[88:91], a[72:75], a[104:107], v[88:91]
ds_read_b64_tr_b16 a[68:69], v219 offset:9224
ds_read_b64_tr_b16 a[70:71], v219 offset:13832
v_mfma_f32_16x16x32_bf16 v[88:91], a[76:79], a[108:111], v[88:91]
buffer_store_dwordx2 v[200:201], v226, s[20:23], s44 offen offset:0 sc0 sc1
v_mfma_f32_16x16x32_bf16 v[96:99], a[76:79], a[124:127], v[96:99]
ds_read_b64_tr_b16 a[176:177], v222 offset:9344
ds_read_b64_tr_b16 a[178:179], v222 offset:13952
v_mfma_f32_16x16x32_bf16 v[96:99], a[72:75], a[120:123], v[96:99]
v_cvt_pk_bf16_f32 v204, v204, v205
v_cvt_pk_bf16_f32 v205, v206, v207
s_waitcnt lgkmcnt(8)
v_mfma_f32_16x16x32_bf16 v[96:99], a[80:83], a[48:51], v[96:99]
ds_read_b64_tr_b16 a[72:73], v219 offset:18440
ds_read_b64_tr_b16 a[74:75], v219 offset:23048
v_mfma_f32_16x16x32_bf16 v[96:99], a[84:87], a[52:55], v[96:99]
buffer_store_dwordx2 v[204:205], v226, s[20:23], s44 offen offset:512 sc0 sc1
v_mfma_f32_16x16x32_bf16 v[88:91], a[84:87], a[36:39], v[88:91]
ds_read_b64_tr_b16 a[180:181], v222 offset:18560
ds_read_b64_tr_b16 a[182:183], v222 offset:23168
v_mfma_f32_16x16x32_bf16 v[88:91], a[80:83], a[32:35], v[88:91]
v_cvt_pk_bf16_f32 v208, v208, v209
v_cvt_pk_bf16_f32 v209, v210, v211
v_mfma_f32_16x16x32_bf16 v[80:83], a[80:83], a[16:19], v[80:83]
ds_read_b64_tr_b16 a[76:77], v219 offset:27656
ds_read_b64_tr_b16 a[78:79], v219 offset:32264
v_mfma_f32_16x16x32_bf16 v[80:83], a[84:87], a[20:23], v[80:83]
buffer_store_dwordx2 v[208:209], v226, s[20:23], s39 offen offset:0 sc0 sc1
v_mfma_f32_16x16x32_bf16 v[72:75], a[84:87], a[4:7], v[72:75]
ds_read_b64_tr_b16 a[184:185], v222 offset:27776
ds_read_b64_tr_b16 a[186:187], v222 offset:32384
v_mfma_f32_16x16x32_bf16 v[72:75], a[80:83], a[0:3], v[72:75]
v_cvt_pk_bf16_f32 v212, v212, v213
v_cvt_pk_bf16_f32 v213, v214, v215
v_mfma_f32_16x16x32_bf16 v[72:75], a[88:91], a[8:11], v[72:75]
ds_read_b64_tr_b16 a[80:81], v222 offset:8
ds_read_b64_tr_b16 a[82:83], v222 offset:4616
v_mfma_f32_16x16x32_bf16 v[72:75], a[92:95], a[12:15], v[72:75]
buffer_store_dwordx2 v[212:213], v226, s[20:23], s39 offen offset:512 sc0 sc1
v_mfma_f32_16x16x32_bf16 v[80:83], a[92:95], a[28:31], v[80:83]
ds_read_b64_tr_b16 a[188:189], v219 offset:136
ds_read_b64_tr_b16 a[190:191], v219 offset:4744
v_mfma_f32_16x16x32_bf16 v[80:83], a[88:91], a[24:27], v[80:83]
s_lshl2_add_u32 s28, s32, s95
v_mul_f32 v58, 0xbfb8aa3b, v54
v_mfma_f32_16x16x32_bf16 v[88:91], a[88:91], a[40:43], v[88:91]
ds_read_b64_tr_b16 a[84:85], v222 offset:9224
ds_read_b64_tr_b16 a[86:87], v222 offset:13832
v_mfma_f32_16x16x32_bf16 v[88:91], a[92:95], a[44:47], v[88:91]
v_mul_f32 v59, 0xbfb8aa3b, v55
v_mfma_f32_16x16x32_bf16 v[96:99], a[92:95], a[60:63], v[96:99]
ds_read_b64_tr_b16 a[192:193], v219 offset:9352
ds_read_b64_tr_b16 a[194:195], v219 offset:13960
v_mfma_f32_16x16x32_bf16 v[96:99], a[88:91], a[56:59], v[96:99]
v_exp_f32 v58, v58
s_waitcnt lgkmcnt(8)
v_mfma_f32_16x16x32_bf16 v[100:103], a[64:67], a[112:115], v[100:103]
ds_read_b64_tr_b16 a[88:89], v222 offset:18440
ds_read_b64_tr_b16 a[90:91], v222 offset:23048
v_mfma_f32_16x16x32_bf16 v[100:103], a[68:71], a[116:119], v[100:103]
v_exp_f32 v59, v59
v_mfma_f32_16x16x32_bf16 v[92:95], a[68:71], a[100:103], v[92:95]
ds_read_b64_tr_b16 a[196:197], v219 offset:18568
ds_read_b64_tr_b16 a[198:199], v219 offset:23176
v_mfma_f32_16x16x32_bf16 v[92:95], a[64:67], a[96:99], v[92:95]
v_add_f32 v58, 1.0, v58
v_add_f32 v59, 1.0, v59
v_mfma_f32_16x16x32_bf16 v[84:87], a[64:67], a[236:239], v[84:87]
ds_read_b64_tr_b16 a[92:93], v222 offset:27656
ds_read_b64_tr_b16 a[94:95], v222 offset:32264
v_mfma_f32_16x16x32_bf16 v[84:87], a[68:71], a[240:243], v[84:87]
v_rcp_f32 v58, v58
v_mfma_f32_16x16x32_bf16 v[76:79], a[68:71], a[224:227], v[76:79]
ds_read_b64_tr_b16 a[200:201], v219 offset:27784
ds_read_b64_tr_b16 a[202:203], v219 offset:32392
v_mfma_f32_16x16x32_bf16 v[76:79], a[64:67], a[220:223], v[76:79]
v_rcp_f32 v59, v59
v_mfma_f32_16x16x32_bf16 v[76:79], a[72:75], a[228:231], v[76:79]
v_mul_f32 v54, v54, v58
v_mul_f32 v55, v55, v59
v_mfma_f32_16x16x32_bf16 v[76:79], a[76:79], a[232:235], v[76:79]
v_cvt_pk_bf16_f32 v58, v54, v55
v_lshlrev_b32 v54, 16, v58
v_mfma_f32_16x16x32_bf16 v[84:87], a[76:79], a[132:135], v[84:87]
ds_read_b64_tr_b16 a[204:205], v222 offset:136
ds_read_b64_tr_b16 a[206:207], v222 offset:4744
v_mfma_f32_16x16x32_bf16 v[84:87], a[72:75], a[128:131], v[84:87]
v_and_b32 v55, 0xffff0000, v58
v_accvgpr_read_b32 v57, a255
v_mfma_f32_16x16x32_bf16 v[92:95], a[72:75], a[104:107], v[92:95]
v_accvgpr_read_b32 v59, a153
v_lshlrev_b32 v56, 16, v57
v_mfma_f32_16x16x32_bf16 v[92:95], a[76:79], a[108:111], v[92:95]
s_waitcnt vmcnt(0)
buffer_store_dword v231, v254, s[20:23], s28 offen sc0 sc1
v_mfma_f32_16x16x32_bf16 v[100:103], a[76:79], a[124:127], v[100:103]
ds_read_b64_tr_b16 a[208:209], v222 offset:9352
ds_read_b64_tr_b16 a[210:211], v222 offset:13960
v_mfma_f32_16x16x32_bf16 v[100:103], a[72:75], a[120:123], v[100:103]
v_and_b32 v57, 0xffff0000, v57
v_lshlrev_b32 v58, 16, v59
s_waitcnt lgkmcnt(8)
v_mfma_f32_16x16x32_bf16 v[100:103], a[80:83], a[48:51], v[100:103]
v_and_b32 v59, 0xffff0000, v59
v_add_f32 v56, v56, v58
v_mfma_f32_16x16x32_bf16 v[100:103], a[84:87], a[52:55], v[100:103]
v_add_f32 v57, v57, v59
v_cvt_pk_bf16_f32 v58, v56, v57
v_mfma_f32_16x16x32_bf16 v[92:95], a[84:87], a[36:39], v[92:95]
ds_read_b64_tr_b16 a[212:213], v222 offset:18568
ds_read_b64_tr_b16 a[214:215], v222 offset:23176
v_mfma_f32_16x16x32_bf16 v[92:95], a[80:83], a[32:35], v[92:95]
v_lshlrev_b32 v56, 16, v58
v_and_b32 v57, 0xffff0000, v58
v_mfma_f32_16x16x32_bf16 v[84:87], a[80:83], a[16:19], v[84:87]
v_mul_f32 v58, 0xbfb8aa3b, v56
v_mul_f32 v59, 0xbfb8aa3b, v57
v_mfma_f32_16x16x32_bf16 v[84:87], a[84:87], a[20:23], v[84:87]
v_exp_f32 v58, v58
v_mfma_f32_16x16x32_bf16 v[76:79], a[84:87], a[4:7], v[76:79]
ds_read_b64_tr_b16 a[216:217], v222 offset:27784
ds_read_b64_tr_b16 a[218:219], v222 offset:32392
v_mfma_f32_16x16x32_bf16 v[76:79], a[80:83], a[0:3], v[76:79]
s_waitcnt vmcnt(1)
buffer_load_dword v230, v229, s[20:23], s95 offen sc0 sc1
v_mfma_f32_16x16x32_bf16 v[76:79], a[88:91], a[8:11], v[76:79]
v_exp_f32 v59, v59
s_waitcnt lgkmcnt(8)
v_mfma_f32_16x16x32_bf16 v[76:79], a[92:95], a[12:15], v[76:79]
v_add_f32 v58, 1.0, v58
v_add_f32 v59, 1.0, v59
v_mfma_f32_16x16x32_bf16 v[84:87], a[92:95], a[28:31], v[84:87]
v_rcp_f32 v58, v58
v_mfma_f32_16x16x32_bf16 v[84:87], a[88:91], a[24:27], v[84:87]
v_rcp_f32 v59, v59
v_mfma_f32_16x16x32_bf16 v[92:95], a[88:91], a[40:43], v[92:95]
v_mul_f32 v56, v56, v58
v_mul_f32 v57, v57, v59
v_mfma_f32_16x16x32_bf16 v[92:95], a[92:95], a[44:47], v[92:95]
v_cvt_pk_bf16_f32 v58, v56, v57
v_lshlrev_b32 v56, 16, v58
v_mfma_f32_16x16x32_bf16 v[100:103], a[92:95], a[60:63], v[100:103]
v_and_b32 v57, 0xffff0000, v58
v_accvgpr_read_b32 v19, a244
v_mfma_f32_16x16x32_bf16 v[100:103], a[88:91], a[56:59], v[100:103]
v_lshlrev_b32 v18, 16, v19
v_and_b32 v19, 0xffff0000, v19
v_mfma_f32_16x16x32_bf16 v[144:147], a[156:159], a[236:239], v[144:147]
v_accvgpr_read_b32 v21, a245
v_lshlrev_b32 v20, 16, v21
v_mfma_f32_16x16x32_bf16 v[144:147], a[160:163], a[240:243], v[144:147]
v_and_b32 v21, 0xffff0000, v21
v_accvgpr_read_b32 v23, a246
v_mfma_f32_16x16x32_bf16 v[144:147], a[164:167], a[128:131], v[144:147]
v_lshlrev_b32 v22, 16, v23
v_and_b32 v23, 0xffff0000, v23
v_mfma_f32_16x16x32_bf16 v[144:147], a[168:171], a[132:135], v[144:147]
v_accvgpr_read_b32 v25, a247
v_lshlrev_b32 v24, 16, v25
v_mfma_f32_16x16x32_bf16 v[144:147], a[172:175], a[16:19], v[144:147]
v_and_b32 v25, 0xffff0000, v25
v_accvgpr_read_b32 v27, a248
v_mfma_f32_16x16x32_bf16 v[144:147], a[176:179], a[20:23], v[144:147]
v_lshlrev_b32 v26, 16, v27
v_and_b32 v27, 0xffff0000, v27
v_mfma_f32_16x16x32_bf16 v[144:147], a[180:183], a[24:27], v[144:147]
v_accvgpr_read_b32 v29, a249
v_lshlrev_b32 v28, 16, v29
v_mfma_f32_16x16x32_bf16 v[144:147], a[184:187], a[28:31], v[144:147]
v_and_b32 v29, 0xffff0000, v29
v_accvgpr_read_b32 v31, a250
s_waitcnt lgkmcnt(0)
v_mfma_f32_16x16x32_bf16 v[148:151], a[216:219], a[28:31], v[148:151]
s_add_u32 s39, s44, 0
v_lshlrev_b32 v30, 16, v31
v_mfma_f32_16x16x32_bf16 v[148:151], a[212:215], a[24:27], v[148:151]
v_cvt_pk_bf16_f32 v80, v80, v81
v_cvt_pk_bf16_f32 v81, v82, v83
v_mfma_f32_16x16x32_bf16 v[148:151], a[208:211], a[20:23], v[148:151]
v_cvt_pk_bf16_f32 v82, v84, v85
v_cvt_pk_bf16_f32 v83, v86, v87
v_mfma_f32_16x16x32_bf16 v[148:151], a[204:207], a[16:19], v[148:151]
buffer_store_dwordx4 v[80:83], v244, s[20:23], s39 offen offset:1024 sc0 sc1
v_mfma_f32_16x16x32_bf16 v[148:151], a[200:203], a[132:135], v[148:151]
v_cvt_pk_bf16_f32 v88, v88, v89
v_cvt_pk_bf16_f32 v89, v90, v91
v_mfma_f32_16x16x32_bf16 v[148:151], a[196:199], a[128:131], v[148:151]
v_cvt_pk_bf16_f32 v90, v92, v93
v_cvt_pk_bf16_f32 v91, v94, v95
v_mfma_f32_16x16x32_bf16 v[148:151], a[192:195], a[240:243], v[148:151]
buffer_store_dwordx4 v[88:91], v244, s[20:23], s39 offen offset:2048 sc0 sc1
v_mfma_f32_16x16x32_bf16 v[148:151], a[188:191], a[236:239], v[148:151]
v_cvt_pk_bf16_f32 v96, v96, v97
v_cvt_pk_bf16_f32 v97, v98, v99
v_mfma_f32_16x16x32_bf16 v[156:159], a[188:191], a[96:99], v[156:159]
v_cvt_pk_bf16_f32 v98, v100, v101
v_cvt_pk_bf16_f32 v99, v102, v103
v_mfma_f32_16x16x32_bf16 v[156:159], a[192:195], a[100:103], v[156:159]
buffer_store_dwordx4 v[96:99], v244, s[20:23], s39 offen offset:3072 sc0 sc1
v_mfma_f32_16x16x32_bf16 v[156:159], a[196:199], a[104:107], v[156:159]
s_add_u32 s39, s44, 8192
v_and_b32 v31, 0xffff0000, v31
v_mfma_f32_16x16x32_bf16 v[156:159], a[200:203], a[108:111], v[156:159]
s_waitcnt vmcnt(3)
v_cmp_gt_u32 vcc, 1, v230
v_mfma_f32_16x16x32_bf16 v[156:159], a[204:207], a[32:35], v[156:159]
v_accvgpr_read_b32 v33, a251
v_lshlrev_b32 v32, 16, v33
v_mfma_f32_16x16x32_bf16 v[156:159], a[208:211], a[36:39], v[156:159]
s_and_b32 s29, vcc_lo, 0xff
s_cbranch_scc1 SP_P1B
SP_P1B_RET:
v_mfma_f32_16x16x32_bf16 v[156:159], a[212:215], a[40:43], v[156:159]
v_and_b32 v33, 0xffff0000, v33
v_accvgpr_read_b32 v35, a252
v_mfma_f32_16x16x32_bf16 v[156:159], a[216:219], a[44:47], v[156:159]
v_cvt_pk_bf16_f32 v144, v144, v145
v_cvt_pk_bf16_f32 v145, v146, v147
v_mfma_f32_16x16x32_bf16 v[152:155], a[184:187], a[44:47], v[152:155]
v_cvt_pk_bf16_f32 v146, v148, v149
v_cvt_pk_bf16_f32 v147, v150, v151
v_mfma_f32_16x16x32_bf16 v[152:155], a[180:183], a[40:43], v[152:155]
buffer_store_dwordx4 v[144:147], v244, s[20:23], s39 offen offset:1024 sc0 sc1
v_mfma_f32_16x16x32_bf16 v[152:155], a[176:179], a[36:39], v[152:155]
buffer_load_dwordx4 v[104:107], v244, s[20:23], s68 offen sc0 sc1
v_mfma_f32_16x16x32_bf16 v[152:155], a[172:175], a[32:35], v[152:155]
v_lshlrev_b32 v34, 16, v35
v_and_b32 v35, 0xffff0000, v35
v_mfma_f32_16x16x32_bf16 v[152:155], a[168:171], a[108:111], v[152:155]
v_accvgpr_read_b32 v37, a253
v_lshlrev_b32 v36, 16, v37
v_mfma_f32_16x16x32_bf16 v[152:155], a[164:167], a[104:107], v[152:155]
buffer_load_dwordx4 v[108:111], v244, s[20:23], s69 offen sc0 sc1
v_mfma_f32_16x16x32_bf16 v[152:155], a[160:163], a[100:103], v[152:155]
v_and_b32 v37, 0xffff0000, v37
v_mfma_f32_16x16x32_bf16 v[152:155], a[156:159], a[96:99], v[152:155]
s_mov_b32 s90, 0x3f80
s_mov_b32 s91, 0x3f800000
v_mfma_f32_16x16x32_bf16 v[160:163], a[156:159], a[112:115], v[160:163]
buffer_load_dwordx4 v[112:115], v244, s[20:23], s70 offen sc0 sc1
v_mfma_f32_16x16x32_bf16 v[160:163], a[160:163], a[116:119], v[160:163]
v_mov_b32 v66, 0
v_mov_b32 v67, 0
v_mfma_f32_16x16x32_bf16 v[160:163], a[164:167], a[120:123], v[160:163]
v_mov_b32 v68, 0
v_mov_b32 v69, 0
v_mfma_f32_16x16x32_bf16 v[160:163], a[168:171], a[124:127], v[160:163]
buffer_load_dwordx4 v[116:119], v244, s[20:23], s71 offen sc0 sc1
v_mfma_f32_16x16x32_bf16 v[160:163], a[172:175], a[48:51], v[160:163]
v_mfma_f32_16x16x32_bf16 v[160:163], a[176:179], a[52:55], v[160:163]
v_mfma_f32_16x16x32_bf16 v[160:163], a[180:183], a[56:59], v[160:163]
buffer_load_dwordx2 v[200:201], v226, s[20:23], s72 offen sc0 sc1
v_mfma_f32_16x16x32_bf16 v[160:163], a[184:187], a[60:63], v[160:163]
v_cvt_pk_bf16_f32 v152, v152, v153
v_cvt_pk_bf16_f32 v153, v154, v155
v_mfma_f32_16x16x32_bf16 v[164:167], a[216:219], a[60:63], v[164:167]
v_cvt_pk_bf16_f32 v154, v156, v157
v_cvt_pk_bf16_f32 v155, v158, v159
v_mfma_f32_16x16x32_bf16 v[164:167], a[212:215], a[56:59], v[164:167]
buffer_store_dwordx4 v[152:155], v244, s[20:23], s39 offen offset:2048 sc0 sc1
v_mfma_f32_16x16x32_bf16 v[164:167], a[208:211], a[52:55], v[164:167]
buffer_load_dwordx2 v[202:203], v226, s[20:23], s73 offen sc0 sc1
v_mfma_f32_16x16x32_bf16 v[164:167], a[204:207], a[48:51], v[164:167]
v_mfma_f32_16x16x32_bf16 v[164:167], a[200:203], a[124:127], v[164:167]
v_mfma_f32_16x16x32_bf16 v[164:167], a[196:199], a[120:123], v[164:167]
buffer_load_dwordx2 v[204:205], v226, s[20:23], s74 offen sc0 sc1
v_mfma_f32_16x16x32_bf16 v[164:167], a[192:195], a[116:119], v[164:167]
v_mfma_f32_16x16x32_bf16 v[164:167], a[188:191], a[112:115], v[164:167]
v_mfma_f32_16x16x32_bf16 v[140:143], a[188:191], a[220:223], v[140:143]
buffer_load_dwordx2 v[206:207], v226, s[20:23], s75 offen sc0 sc1
v_mfma_f32_16x16x32_bf16 v[140:143], a[192:195], a[224:227], v[140:143]
v_mfma_f32_16x16x32_bf16 v[140:143], a[196:199], a[228:231], v[140:143]
v_mfma_f32_16x16x32_bf16 v[140:143], a[200:203], a[232:235], v[140:143]
buffer_load_dwordx2 v[208:209], v226, s[20:23], s84 offen sc0 sc1
v_mfma_f32_16x16x32_bf16 v[140:143], a[204:207], a[0:3], v[140:143]
v_mfma_f32_16x16x32_bf16 v[140:143], a[208:211], a[4:7], v[140:143]
v_mfma_f32_16x16x32_bf16 v[140:143], a[212:215], a[8:11], v[140:143]
buffer_load_dwordx2 v[210:211], v226, s[20:23], s85 offen sc0 sc1
v_mfma_f32_16x16x32_bf16 v[140:143], a[216:219], a[12:15], v[140:143]
v_cvt_pk_bf16_f32 v160, v160, v161
v_cvt_pk_bf16_f32 v161, v162, v163
v_mfma_f32_16x16x32_bf16 v[136:139], a[184:187], a[12:15], v[136:139]
v_cvt_pk_bf16_f32 v162, v164, v165
v_cvt_pk_bf16_f32 v163, v166, v167
v_mfma_f32_16x16x32_bf16 v[136:139], a[180:183], a[8:11], v[136:139]
buffer_store_dwordx4 v[160:163], v244, s[20:23], s39 offen offset:3072 sc0 sc1
v_mfma_f32_16x16x32_bf16 v[136:139], a[176:179], a[4:7], v[136:139]
buffer_load_dwordx2 v[212:213], v226, s[20:23], s86 offen sc0 sc1
v_mfma_f32_16x16x32_bf16 v[136:139], a[172:175], a[0:3], v[136:139]
v_mfma_f32_16x16x32_bf16 v[136:139], a[168:171], a[232:235], v[136:139]
v_mfma_f32_16x16x32_bf16 v[136:139], a[164:167], a[228:231], v[136:139]
buffer_load_dwordx2 v[214:215], v226, s[20:23], s87 offen sc0 sc1
v_mfma_f32_16x16x32_bf16 v[136:139], a[160:163], a[224:227], v[136:139]
v_mfma_f32_16x16x32_bf16 v[136:139], a[156:159], a[220:223], v[136:139]
buffer_load_dwordx4 v[120:123], v243, s[20:23], s68 offen sc0 sc1
buffer_load_dwordx4 v[124:127], v243, s[20:23], s69 offen sc0 sc1
buffer_load_dwordx4 v[128:131], v243, s[20:23], s70 offen sc0 sc1
buffer_load_dwordx4 v[132:135], v243, s[20:23], s71 offen sc0 sc1
s_lshl_b32 s50, s34, 2
s_lshl_b32 s50, 15, s50
s_waitcnt vmcnt(6)
buffer_store_dword v246, v254, s[20:23], s28 offen sc0 sc1
s_waitcnt vmcnt(18)
v_dot2c_f32_bf16 v72, s90, v104
v_dot2c_f32_bf16 v73, s91, v104
v_dot2c_f32_bf16 v74, s90, v105
v_dot2c_f32_bf16 v75, s91, v105
v_dot2c_f32_bf16 v76, s90, v106
v_dot2c_f32_bf16 v77, s91, v106
v_dot2c_f32_bf16 v78, s90, v107
v_dot2c_f32_bf16 v79, s91, v107
s_waitcnt vmcnt(17)
v_dot2c_f32_bf16 v72, s90, v108
v_dot2c_f32_bf16 v73, s91, v108
v_dot2c_f32_bf16 v74, s90, v109
v_dot2c_f32_bf16 v75, s91, v109
v_dot2c_f32_bf16 v76, s90, v110
v_dot2c_f32_bf16 v77, s91, v110
v_dot2c_f32_bf16 v78, s90, v111
v_dot2c_f32_bf16 v79, s91, v111
s_waitcnt vmcnt(16)
v_dot2c_f32_bf16 v72, s90, v112
v_dot2c_f32_bf16 v73, s91, v112
v_dot2c_f32_bf16 v74, s90, v113
v_dot2c_f32_bf16 v75, s91, v113
v_dot2c_f32_bf16 v76, s90, v114
v_dot2c_f32_bf16 v77, s91, v114
v_dot2c_f32_bf16 v78, s90, v115
v_dot2c_f32_bf16 v79, s91, v115
s_waitcnt vmcnt(15)
v_dot2c_f32_bf16 v72, s90, v116
v_dot2c_f32_bf16 v73, s91, v116
v_dot2c_f32_bf16 v74, s90, v117
v_dot2c_f32_bf16 v75, s91, v117
v_dot2c_f32_bf16 v76, s90, v118
v_dot2c_f32_bf16 v77, s91, v118
v_dot2c_f32_bf16 v78, s90, v119
v_dot2c_f32_bf16 v79, s91, v119
buffer_load_dword v230, v229, s[20:23], s95 offen sc0 sc1
s_waitcnt vmcnt(5)
v_dot2c_f32_bf16 v136, s90, v120
v_dot2c_f32_bf16 v137, s91, v120
v_dot2c_f32_bf16 v138, s90, v121
v_dot2c_f32_bf16 v139, s91, v121
v_dot2c_f32_bf16 v140, s90, v122
v_dot2c_f32_bf16 v141, s91, v122
v_dot2c_f32_bf16 v142, s90, v123
v_dot2c_f32_bf16 v143, s91, v123
s_waitcnt vmcnt(4)
v_dot2c_f32_bf16 v136, s90, v124
v_dot2c_f32_bf16 v137, s91, v124
v_dot2c_f32_bf16 v138, s90, v125
v_dot2c_f32_bf16 v139, s91, v125
v_dot2c_f32_bf16 v140, s90, v126
v_dot2c_f32_bf16 v141, s91, v126
v_dot2c_f32_bf16 v142, s90, v127
v_dot2c_f32_bf16 v143, s91, v127
s_waitcnt vmcnt(3)
v_dot2c_f32_bf16 v136, s90, v128
v_dot2c_f32_bf16 v137, s91, v128
v_dot2c_f32_bf16 v138, s90, v129
v_dot2c_f32_bf16 v139, s91, v129
v_dot2c_f32_bf16 v140, s90, v130
v_dot2c_f32_bf16 v141, s91, v130
v_dot2c_f32_bf16 v142, s90, v131
v_dot2c_f32_bf16 v143, s91, v131
s_waitcnt vmcnt(2)
v_dot2c_f32_bf16 v136, s90, v132
v_dot2c_f32_bf16 v137, s91, v132
v_dot2c_f32_bf16 v138, s90, v133
v_dot2c_f32_bf16 v139, s91, v133
v_dot2c_f32_bf16 v140, s90, v134
v_dot2c_f32_bf16 v141, s91, v134
v_dot2c_f32_bf16 v142, s90, v135
v_dot2c_f32_bf16 v143, s91, v135
s_waitcnt vmcnt(0)
v_cmp_gt_u32 vcc, 2, v230
s_nop 0
s_and_b32 s29, vcc_lo, s50
s_cbranch_scc0 SP_P2B_RET
SP_P2B:
s_sleep 0
s_add_u32 s100, s100, 1
s_bitcmp1_b32 s100, 19
s_cbranch_scc1 K_END
buffer_load_dword v230, v229, s[20:23], s95 offen sc0 sc1
s_waitcnt vmcnt(0)
v_cmp_gt_u32 vcc, 2, v230
s_nop 0
s_and_b32 s29, vcc_lo, s50
s_cbranch_scc1 SP_P2B
SP_P2B_RET:
buffer_load_dwordx4 v[168:171], v244, s[20:23], s65 offen sc0 sc1
buffer_load_dwordx4 v[172:175], v244, s[20:23], s66 offen sc0 sc1
buffer_load_dwordx4 v[176:179], v244, s[20:23], s67 offen sc0 sc1
buffer_load_dwordx4 v[180:183], v243, s[20:23], s65 offen sc0 sc1
buffer_load_dwordx4 v[184:187], v243, s[20:23], s66 offen sc0 sc1
buffer_load_dwordx4 v[188:191], v243, s[20:23], s67 offen sc0 sc1
s_waitcnt vmcnt(21)
v_dot2c_f32_bf16 v66, s90, v200
v_dot2c_f32_bf16 v67, s91, v200
v_dot2c_f32_bf16 v68, s90, v201
v_dot2c_f32_bf16 v69, s91, v201
s_waitcnt vmcnt(19)
v_dot2c_f32_bf16 v66, s90, v202
v_dot2c_f32_bf16 v67, s91, v202
v_dot2c_f32_bf16 v68, s90, v203
v_dot2c_f32_bf16 v69, s91, v203
s_waitcnt vmcnt(18)
v_dot2c_f32_bf16 v66, s90, v204
v_dot2c_f32_bf16 v67, s91, v204
v_dot2c_f32_bf16 v68, s90, v205
v_dot2c_f32_bf16 v69, s91, v205
s_waitcnt vmcnt(17)
v_dot2c_f32_bf16 v66, s90, v206
v_dot2c_f32_bf16 v67, s91, v206
v_dot2c_f32_bf16 v68, s90, v207
v_dot2c_f32_bf16 v69, s91, v207
s_waitcnt vmcnt(16)
v_dot2c_f32_bf16 v66, s90, v208
v_dot2c_f32_bf16 v67, s91, v208
v_dot2c_f32_bf16 v68, s90, v209
v_dot2c_f32_bf16 v69, s91, v209
s_waitcnt vmcnt(15)
v_dot2c_f32_bf16 v66, s90, v210
v_dot2c_f32_bf16 v67, s91, v210
v_dot2c_f32_bf16 v68, s90, v211
v_dot2c_f32_bf16 v69, s91, v211
s_waitcnt vmcnt(13)
v_dot2c_f32_bf16 v66, s90, v212
v_dot2c_f32_bf16 v67, s91, v212
v_dot2c_f32_bf16 v68, s90, v213
v_dot2c_f32_bf16 v69, s91, v213
s_waitcnt vmcnt(12)
v_dot2c_f32_bf16 v66, s90, v214
v_dot2c_f32_bf16 v67, s91, v214
v_dot2c_f32_bf16 v68, s90, v215
v_dot2c_f32_bf16 v69, s91, v215
s_cmp_eq_u32 s34, 0
s_cselect_b32 s29, 0, 0x7fbffff0
s_nop 2
v_cvt_pk_bf16_f32 v58, v66, v67
v_cvt_pk_bf16_f32 v59, v68, v69
v_lshlrev_b32 v66, 16, v58
v_and_b32 v67, 0xffff0000, v58
v_lshlrev_b32 v68, 16, v59
v_and_b32 v69, 0xffff0000, v59
v_pk_mul_f32 v[66:67], v[66:67], v[54:55]
v_pk_mul_f32 v[68:69], v[68:69], v[56:57]
v_cvt_pk_bf16_f32 v58, v66, v67
v_cvt_pk_bf16_f32 v59, v68, v69
v_lshlrev_b32 v66, 16, v58
v_and_b32 v67, 0xffff0000, v58
v_lshlrev_b32 v68, 16, v59
v_and_b32 v69, 0xffff0000, v59
v_pk_add_f32 v[66:67], v[66:67], v[34:35]
v_pk_add_f32 v[68:69], v[68:69], v[36:37]
v_cvt_pk_bf16_f32 v66, v66, v67
v_cvt_pk_bf16_f32 v67, v68, v69
buffer_store_dwordx2 v[66:67], v249, s[60:63], s29 offen
s_waitcnt vmcnt(6)
v_dot2c_f32_bf16 v72, s90, v168
v_dot2c_f32_bf16 v73, s91, v168
v_dot2c_f32_bf16 v74, s90, v169
v_dot2c_f32_bf16 v75, s91, v169
v_dot2c_f32_bf16 v76, s90, v170
v_dot2c_f32_bf16 v77, s91, v170
v_dot2c_f32_bf16 v78, s90, v171
v_dot2c_f32_bf16 v79, s91, v171
s_waitcnt vmcnt(5)
v_dot2c_f32_bf16 v72, s90, v172
v_dot2c_f32_bf16 v73, s91, v172
v_dot2c_f32_bf16 v74, s90, v173
v_dot2c_f32_bf16 v75, s91, v173
v_dot2c_f32_bf16 v76, s90, v174
v_dot2c_f32_bf16 v77, s91, v174
v_dot2c_f32_bf16 v78, s90, v175
v_dot2c_f32_bf16 v79, s91, v175
s_waitcnt vmcnt(4)
v_dot2c_f32_bf16 v72, s90, v176
v_dot2c_f32_bf16 v73, s91, v176
v_dot2c_f32_bf16 v74, s90, v177
v_dot2c_f32_bf16 v75, s91, v177
v_dot2c_f32_bf16 v76, s90, v178
v_dot2c_f32_bf16 v77, s91, v178
v_dot2c_f32_bf16 v78, s90, v179
v_dot2c_f32_bf16 v79, s91, v179
s_nop 2
v_cvt_pk_bf16_f32 v58, v72, v73
v_cvt_pk_bf16_f32 v59, v74, v75
v_cvt_pk_bf16_f32 v60, v76, v77
v_cvt_pk_bf16_f32 v61, v78, v79
v_lshlrev_b32 v72, 16, v58
v_and_b32 v73, 0xffff0000, v58
v_lshlrev_b32 v74, 16, v59
v_and_b32 v75, 0xffff0000, v59
v_lshlrev_b32 v76, 16, v60
v_and_b32 v77, 0xffff0000, v60
v_lshlrev_b32 v78, 16, v61
v_and_b32 v79, 0xffff0000, v61
v_pk_mul_f32 v[72:73], v[72:73], v[38:39]
v_pk_mul_f32 v[74:75], v[74:75], v[40:41]
v_pk_mul_f32 v[76:77], v[76:77], v[42:43]
v_pk_mul_f32 v[78:79], v[78:79], v[44:45]
v_cvt_pk_bf16_f32 v58, v72, v73
v_cvt_pk_bf16_f32 v59, v74, v75
v_cvt_pk_bf16_f32 v60, v76, v77
v_cvt_pk_bf16_f32 v61, v78, v79
v_lshlrev_b32 v72, 16, v58
v_and_b32 v73, 0xffff0000, v58
v_lshlrev_b32 v74, 16, v59
v_and_b32 v75, 0xffff0000, v59
v_lshlrev_b32 v76, 16, v60
v_and_b32 v77, 0xffff0000, v60
v_lshlrev_b32 v78, 16, v61
v_and_b32 v79, 0xffff0000, v61
v_pk_add_f32 v[72:73], v[72:73], v[18:19]
v_pk_add_f32 v[74:75], v[74:75], v[20:21]
v_pk_add_f32 v[76:77], v[76:77], v[22:23]
v_pk_add_f32 v[78:79], v[78:79], v[24:25]
v_cvt_pk_bf16_f32 v72, v72, v73
v_cvt_pk_bf16_f32 v73, v74, v75
v_cvt_pk_bf16_f32 v74, v76, v77
v_cvt_pk_bf16_f32 v75, v78, v79
buffer_store_dwordx4 v[72:75], v248, s[60:63], 0 offen
s_waitcnt vmcnt(4)
v_dot2c_f32_bf16 v136, s90, v180
v_dot2c_f32_bf16 v137, s91, v180
v_dot2c_f32_bf16 v138, s90, v181
v_dot2c_f32_bf16 v139, s91, v181
v_dot2c_f32_bf16 v140, s90, v182
v_dot2c_f32_bf16 v141, s91, v182
v_dot2c_f32_bf16 v142, s90, v183
v_dot2c_f32_bf16 v143, s91, v183
s_waitcnt vmcnt(3)
v_dot2c_f32_bf16 v136, s90, v184
v_dot2c_f32_bf16 v137, s91, v184
v_dot2c_f32_bf16 v138, s90, v185
v_dot2c_f32_bf16 v139, s91, v185
v_dot2c_f32_bf16 v140, s90, v186
v_dot2c_f32_bf16 v141, s91, v186
v_dot2c_f32_bf16 v142, s90, v187
v_dot2c_f32_bf16 v143, s91, v187
s_waitcnt vmcnt(2)
v_dot2c_f32_bf16 v136, s90, v188
v_dot2c_f32_bf16 v137, s91, v188
v_dot2c_f32_bf16 v138, s90, v189
v_dot2c_f32_bf16 v139, s91, v189
v_dot2c_f32_bf16 v140, s90, v190
v_dot2c_f32_bf16 v141, s91, v190
v_dot2c_f32_bf16 v142, s90, v191
v_dot2c_f32_bf16 v143, s91, v191
s_nop 2
v_cvt_pk_bf16_f32 v58, v136, v137
v_cvt_pk_bf16_f32 v59, v138, v139
v_cvt_pk_bf16_f32 v60, v140, v141
v_cvt_pk_bf16_f32 v61, v142, v143
v_lshlrev_b32 v136, 16, v58
v_and_b32 v137, 0xffff0000, v58
v_lshlrev_b32 v138, 16, v59
v_and_b32 v139, 0xffff0000, v59
v_lshlrev_b32 v140, 16, v60
v_and_b32 v141, 0xffff0000, v60
v_lshlrev_b32 v142, 16, v61
v_and_b32 v143, 0xffff0000, v61
v_pk_mul_f32 v[136:137], v[136:137], v[46:47]
v_pk_mul_f32 v[138:139], v[138:139], v[48:49]
v_pk_mul_f32 v[140:141], v[140:141], v[50:51]
v_pk_mul_f32 v[142:143], v[142:143], v[52:53]
v_cvt_pk_bf16_f32 v58, v136, v137
v_cvt_pk_bf16_f32 v59, v138, v139
v_cvt_pk_bf16_f32 v60, v140, v141
v_cvt_pk_bf16_f32 v61, v142, v143
v_lshlrev_b32 v136, 16, v58
v_and_b32 v137, 0xffff0000, v58
v_lshlrev_b32 v138, 16, v59
v_and_b32 v139, 0xffff0000, v59
v_lshlrev_b32 v140, 16, v60
v_and_b32 v141, 0xffff0000, v60
v_lshlrev_b32 v142, 16, v61
v_and_b32 v143, 0xffff0000, v61
v_pk_add_f32 v[136:137], v[136:137], v[26:27]
v_pk_add_f32 v[138:139], v[138:139], v[28:29]
v_pk_add_f32 v[140:141], v[140:141], v[30:31]
v_pk_add_f32 v[142:143], v[142:143], v[32:33]
v_cvt_pk_bf16_f32 v136, v136, v137
v_cvt_pk_bf16_f32 v137, v138, v139
v_cvt_pk_bf16_f32 v138, v140, v141
v_cvt_pk_bf16_f32 v139, v142, v143
buffer_store_dwordx4 v[136:139], v248, s[60:63], 0 offen offset:128
s_endpgm
SP_O1B:
s_sleep 1
s_add_u32 s100, s100, 1
s_bitcmp1_b32 s100, 19
s_cbranch_scc1 K_END
buffer_load_dword v230, v229, s[20:23], s94 offen sc0 sc1
s_waitcnt vmcnt(0)
v_cmp_gt_u32 vcc, 1, v230
s_bitcmp1_b32 vcc_lo, s39
s_cbranch_scc1 SP_O1B
s_branch SP_O1B_RET
SP_O2B:
s_sleep 1
s_add_u32 s100, s100, 1
s_bitcmp1_b32 s100, 19
s_cbranch_scc1 K_END
buffer_load_dword v230, v229, s[20:23], s94 offen sc0 sc1
s_waitcnt vmcnt(0)
v_cmp_gt_u32 vcc, 1, v230
s_and_b32 s29, vcc_lo, 15
s_cbranch_scc1 SP_O2B
s_branch SP_O2B_RET
SP_O3B:
s_sleep 1
s_add_u32 s100, s100, 1
s_bitcmp1_b32 s100, 19
s_cbranch_scc1 K_END
buffer_load_dword v230, v229, s[20:23], s94 offen sc0 sc1
s_waitcnt vmcnt(0)
v_cmp_gt_u32 vcc, 2, v230
s_and_b32 s29, vcc_lo, 15
s_cbranch_scc1 SP_O3B
s_branch SP_O3B_RET
SP_P1B:
s_sleep 1
s_add_u32 s100, s100, 1
s_bitcmp1_b32 s100, 19
s_cbranch_scc1 K_END
buffer_load_dword v230, v229, s[20:23], s95 offen sc0 sc1
s_waitcnt vmcnt(0)
v_cmp_gt_u32 vcc, 1, v230
s_and_b32 s29, vcc_lo, 0xff
s_cbranch_scc1 SP_P1B
s_branch SP_P1B_RET
F_NOTYET:
s_bitcmp1_b32 s51, 30
s_cbranch_scc1 F_BSENT
s_bitset1_b32 s51, 30
s_mov_b32 s46, 0x60
s_mov_b32 s50, s28
s_add_u32 s28, s45, 0x0
buffer_store_dwordx4 v[72:75], v169, s[20:23], s28 offen offset:0 sc0 sc1
buffer_store_dwordx4 v[76:79], v169, s[20:23], s28 offen offset:2048 sc0 sc1
s_add_u32 s28, s28, 4096
buffer_store_dwordx4 v[80:83], v169, s[20:23], s28 offen offset:0 sc0 sc1
buffer_store_dwordx4 v[84:87], v169, s[20:23], s28 offen offset:2048 sc0 sc1
s_add_u32 s28, s28, 4096
buffer_store_dwordx4 v[88:91], v169, s[20:23], s28 offen offset:0 sc0 sc1
buffer_store_dwordx4 v[92:95], v169, s[20:23], s28 offen offset:2048 sc0 sc1
s_add_u32 s28, s28, 4096
buffer_store_dwordx4 v[96:99], v169, s[20:23], s28 offen offset:0 sc0 sc1
buffer_store_dwordx4 v[100:103], v169, s[20:23], s28 offen offset:2048 sc0 sc1
s_add_u32 s28, s28, 4096
buffer_store_dwordx4 v[104:107], v169, s[20:23], s28 offen offset:0 sc0 sc1
s_lshl_b32 s28, s3, 2
s_add_u32 s28, s28, 0x240000
buffer_store_dword v65, v64, s[20:23], s28 offen sc0 sc1
s_mov_b32 s28, s50
s_or_b32 s29, s38, 0x40
v_mov_b32 v62, s29
v_mov_b32 v63, s35
s_lshl_b32 s29, s36, 5
s_waitcnt vmcnt(0)
s_mov_b64 exec, 1
buffer_store_byte v62, v63, s[24:27], s29 offen sc0 sc1
s_mov_b64 exec, -1
F_BSENT:
s_lshl_b32 s29, s36, 5
buffer_load_dword v62, v64, s[24:27], s29 offen sc0 sc1
s_waitcnt vmcnt(0)
v_and_b32 v63, 0x40404040, v62
v_cmp_ne_u32 vcc, 0x40404040, v63
s_cbranch_vccnz F_NOB
s_mul_i32 s29, s38, 0x01010101
v_and_b32 v62, 0x0f0f0f0f, v62
v_cmp_ne_u32 vcc, s29, v62
v_mov_b32 v60, 0
s_cbranch_vccnz F_GO
v_mov_b32 v60, 1
s_branch F_GO
F_NOB:
s_sleep 1
s_add_u32 s100, s100, 1
s_bitcmp1_b32 s100, 19
s_cbranch_scc1 K_END
s_branch F_POLL
Q_REDO:
s_mov_b32 s4, 0
s_mov_b32 s51, 0
s_waitcnt vmcnt(0) lgkmcnt(0)
s_branch Q_START
K_FALLBACK:
s_mov_b32 s43, 1
s_mov_b32 s3, 0
s_mov_b32 s86, 0x30000
s_mov_b32 s66, 0
s_mov_b32 s70, 0
s_mov_b32 s74, 0
s_waitcnt vmcnt(0) lgkmcnt(0)
s_barrier
v_mov_b32 v254, 0x7ffffff0
v_mov_b32 v136, 0xff800000
v_mov_b32 v140, 0xff800000
v_mov_b32 v144, 0xff800000
v_mov_b32 v148, 0xff800000
s_mov_b32 s32, 0
s_mov_b32 s33, 32
K_FBLOOP:
s_add_u32 m0, s30, 81920
s_nop 0
buffer_load_dwordx4 v228, s[8:11], s32 offen offset:0  lds
buffer_load_dwordx4 v229, s[8:11], s32 offen offset:1024  lds
buffer_load_dwordx4 v230, s[8:11], s32 offen offset:2048  lds
buffer_load_dwordx4 v231, s[8:11], s32 offen offset:3072  lds
s_waitcnt vmcnt(0)
s_barrier
ds_read_b128 a[144:147], v216 offset:16384
ds_read_b128 a[148:151], v217 offset:16384
ds_read_b128 a[152:155], v218 offset:16384
ds_read_b128 a[156:159], v219 offset:16384
ds_read_b128 a[160:163], v216 offset:20480
ds_read_b128 a[164:167], v217 offset:20480
ds_read_b128 a[168:171], v218 offset:20480
ds_read_b128 a[172:175], v219 offset:20480
s_waitcnt lgkmcnt(0)
v_mfma_f32_16x16x32_bf16 v[8:11], a[144:147], v[152:155], 0
v_mfma_f32_16x16x32_bf16 v[16:19], a[144:147], v[168:171], 0
v_mfma_f32_16x16x32_bf16 v[24:27], a[144:147], v[184:187], 0
v_mfma_f32_16x16x32_bf16 v[32:35], a[144:147], v[200:203], 0
v_mfma_f32_16x16x32_bf16 v[8:11], a[148:151], v[156:159], v[8:11]
v_mfma_f32_16x16x32_bf16 v[16:19], a[148:151], v[172:175], v[16:19]
v_mfma_f32_16x16x32_bf16 v[24:27], a[148:151], v[188:191], v[24:27]
v_mfma_f32_16x16x32_bf16 v[32:35], a[148:151], v[204:207], v[32:35]
v_mfma_f32_16x16x32_bf16 v[8:11], a[152:155], v[160:163], v[8:11]
v_mfma_f32_16x16x32_bf16 v[16:19], a[152:155], v[176:179], v[16:19]
v_mfma_f32_16x16x32_bf16 v[24:27], a[152:155], v[192:195], v[24:27]
v_mfma_f32_16x16x32_bf16 v[32:35], a[152:155], v[208:211], v[32:35]
v_mfma_f32_16x16x32_bf16 v[8:11], a[156:159], v[164:167], v[8:11]
v_mfma_f32_16x16x32_bf16 v[16:19], a[156:159], v[180:183], v[16:19]
v_mfma_f32_16x16x32_bf16 v[24:27], a[156:159], v[196:199], v[24:27]
v_mfma_f32_16x16x32_bf16 v[32:35], a[156:159], v[212:215], v[32:35]
v_mfma_f32_16x16x32_bf16 v[12:15], a[160:163], v[152:155], 0
v_mfma_f32_16x16x32_bf16 v[20:23], a[160:163], v[168:171], 0
v_mfma_f32_16x16x32_bf16 v[28:31], a[160:163], v[184:187], 0
v_mfma_f32_16x16x32_bf16 v[36:39], a[160:163], v[200:203], 0
v_mfma_f32_16x16x32_bf16 v[12:15], a[164:167], v[156:159], v[12:15]
v_mfma_f32_16x16x32_bf16 v[20:23], a[164:167], v[172:175], v[20:23]
v_mfma_f32_16x16x32_bf16 v[28:31], a[164:167], v[188:191], v[28:31]
v_mfma_f32_16x16x32_bf16 v[36:39], a[164:167], v[204:207], v[36:39]
v_mfma_f32_16x16x32_bf16 v[12:15], a[168:171], v[160:163], v[12:15]
v_mfma_f32_16x16x32_bf16 v[20:23], a[168:171], v[176:179], v[20:23]
v_mfma_f32_16x16x32_bf16 v[28:31], a[168:171], v[192:195], v[28:31]
v_mfma_f32_16x16x32_bf16 v[36:39], a[168:171], v[208:211], v[36:39]
v_mfma_f32_16x16x32_bf16 v[12:15], a[172:175], v[164:167], v[12:15]
v_mfma_f32_16x16x32_bf16 v[20:23], a[172:175], v[180:183], v[20:23]
v_mfma_f32_16x16x32_bf16 v[28:31], a[172:175], v[196:199], v[28:31]
v_mfma_f32_16x16x32_bf16 v[36:39], a[172:175], v[212:215], v[36:39]
s_nop 7
s_nop 3
v_max3_f32 v136, v136, v8, v9
v_max3_f32 v136, v136, v10, v11
v_max3_f32 v136, v136, v12, v13
v_max3_f32 v136, v136, v14, v15
v_max3_f32 v140, v140, v16, v17
v_max3_f32 v140, v140, v18, v19
v_max3_f32 v140, v140, v20, v21
v_max3_f32 v140, v140, v22, v23
v_max3_f32 v144, v144, v24, v25
v_max3_f32 v144, v144, v26, v27
v_max3_f32 v144, v144, v28, v29
v_max3_f32 v144, v144, v30, v31
v_max3_f32 v148, v148, v32, v33
v_max3_f32 v148, v148, v34, v35
v_max3_f32 v148, v148, v36, v37
v_max3_f32 v148, v148, v38, v39
ds_read_b128 a[144:147], v216 offset:24576
ds_read_b128 a[148:151], v217 offset:24576
ds_read_b128 a[152:155], v218 offset:24576
ds_read_b128 a[156:159], v219 offset:24576
ds_read_b128 a[160:163], v216 offset:28672
ds_read_b128 a[164:167], v217 offset:28672
ds_read_b128 a[168:171], v218 offset:28672
ds_read_b128 a[172:175], v219 offset:28672
s_waitcnt lgkmcnt(0)
v_mfma_f32_16x16x32_bf16 v[8:11], a[144:147], v[152:155], 0
v_mfma_f32_16x16x32_bf16 v[16:19], a[144:147], v[168:171], 0
v_mfma_f32_16x16x32_bf16 v[24:27], a[144:147], v[184:187], 0
v_mfma_f32_16x16x32_bf16 v[32:35], a[144:147], v[200:203], 0
v_mfma_f32_16x16x32_bf16 v[8:11], a[148:151], v[156:159], v[8:11]
v_mfma_f32_16x16x32_bf16 v[16:19], a[148:151], v[172:175], v[16:19]
v_mfma_f32_16x16x32_bf16 v[24:27], a[148:151], v[188:191], v[24:27]
v_mfma_f32_16x16x32_bf16 v[32:35], a[148:151], v[204:207], v[32:35]
v_mfma_f32_16x16x32_bf16 v[8:11], a[152:155], v[160:163], v[8:11]
v_mfma_f32_16x16x32_bf16 v[16:19], a[152:155], v[176:179], v[16:19]
v_mfma_f32_16x16x32_bf16 v[24:27], a[152:155], v[192:195], v[24:27]
v_mfma_f32_16x16x32_bf16 v[32:35], a[152:155], v[208:211], v[32:35]
v_mfma_f32_16x16x32_bf16 v[8:11], a[156:159], v[164:167], v[8:11]
v_mfma_f32_16x16x32_bf16 v[16:19], a[156:159], v[180:183], v[16:19]
v_mfma_f32_16x16x32_bf16 v[24:27], a[156:159], v[196:199], v[24:27]
v_mfma_f32_16x16x32_bf16 v[32:35], a[156:159], v[212:215], v[32:35]
v_mfma_f32_16x16x32_bf16 v[12:15], a[160:163], v[152:155], 0
v_mfma_f32_16x16x32_bf16 v[20:23], a[160:163], v[168:171], 0
v_mfma_f32_16x16x32_bf16 v[28:31], a[160:163], v[184:187], 0
v_mfma_f32_16x16x32_bf16 v[36:39], a[160:163], v[200:203], 0
v_mfma_f32_16x16x32_bf16 v[12:15], a[164:167], v[156:159], v[12:15]
v_mfma_f32_16x16x32_bf16 v[20:23], a[164:167], v[172:175], v[20:23]
v_mfma_f32_16x16x32_bf16 v[28:31], a[164:167], v[188:191], v[28:31]
v_mfma_f32_16x16x32_bf16 v[36:39], a[164:167], v[204:207], v[36:39]
v_mfma_f32_16x16x32_bf16 v[12:15], a[168:171], v[160:163], v[12:15]
v_mfma_f32_16x16x32_bf16 v[20:23], a[168:171], v[176:179], v[20:23]
v_mfma_f32_16x16x32_bf16 v[28:31], a[168:171], v[192:195], v[28:31]
v_mfma_f32_16x16x32_bf16 v[36:39], a[168:171], v[208:211], v[36:39]
v_mfma_f32_16x16x32_bf16 v[12:15], a[172:175], v[164:167], v[12:15]
v_mfma_f32_16x16x32_bf16 v[20:23], a[172:175], v[180:183], v[20:23]
v_mfma_f32_16x16x32_bf16 v[28:31], a[172:175], v[196:199], v[28:31]
v_mfma_f32_16x16x32_bf16 v[36:39], a[172:175], v[212:215], v[36:39]
s_nop 7
s_nop 3
v_max3_f32 v136, v136, v8, v9
v_max3_f32 v136, v136, v10, v11
v_max3_f32 v136, v136, v12, v13
v_max3_f32 v136, v136, v14, v15
v_max3_f32 v140, v140, v16, v17
v_max3_f32 v140, v140, v18, v19
v_max3_f32 v140, v140, v20, v21
v_max3_f32 v140, v140, v22, v23
v_max3_f32 v144, v144, v24, v25
v_max3_f32 v144, v144, v26, v27
v_max3_f32 v144, v144, v28, v29
v_max3_f32 v144, v144, v30, v31
v_max3_f32 v148, v148, v32, v33
v_max3_f32 v148, v148, v34, v35
v_max3_f32 v148, v148, v36, v37
v_max3_f32 v148, v148, v38, v39
s_barrier
s_add_u32 s32, s32, 16384
s_sub_u32 s33, s33, 1
s_cmp_lg_u32 s33, 0
s_cbranch_scc1 K_FBLOOP
v_mov_b32 v246, v136
s_nop 1
v_permlane16_swap_b32 v136, v246
v_max_f32 v136, v136, v246
v_mov_b32 v246, v136
s_nop 1
v_permlane32_swap_b32 v136, v246
v_max_f32 v136, v136, v246
v_sub_f32 v136, 0, v136
v_mov_b32 v137, v136
v_mov_b32 v138, v136
v_mov_b32 v139, v136
v_mov_b32 v246, v140
s_nop 1
v_permlane16_swap_b32 v140, v246
v_max_f32 v140, v140, v246
v_mov_b32 v246, v140
s_nop 1
v_permlane32_swap_b32 v140, v246
v_max_f32 v140, v140, v246
v_sub_f32 v140, 0, v140
v_mov_b32 v141, v140
v_mov_b32 v142, v140
v_mov_b32 v143, v140
v_mov_b32 v246, v144
s_nop 1
v_permlane16_swap_b32 v144, v246
v_max_f32 v144, v144, v246
v_mov_b32 v246, v144
s_nop 1
v_permlane32_swap_b32 v144, v246
v_max_f32 v144, v144, v246
v_sub_f32 v144, 0, v144
v_mov_b32 v145, v144
v_mov_b32 v146, v144
v_mov_b32 v147, v144
v_mov_b32 v246, v148
s_nop 1
v_permlane16_swap_b32 v148, v246
v_max_f32 v148, v148, v246
v_mov_b32 v246, v148
s_nop 1
v_permlane32_swap_b32 v148, v246
v_max_f32 v148, v148, v246
v_sub_f32 v148, 0, v148
v_mov_b32 v149, v148
v_mov_b32 v150, v148
v_mov_b32 v151, v148
s_add_u32 s32, s7, 0
s_add_u32 m0, s30, 81920
s_nop 0
buffer_load_dwordx4 v228, s[8:11], s32 offen offset:0  lds
buffer_load_dwordx4 v229, s[8:11], s32 offen offset:1024  lds
buffer_load_dwordx4 v230, s[8:11], s32 offen offset:2048  lds
buffer_load_dwordx4 v231, s[8:11], s32 offen offset:3072  lds
s_add_u32 s32, s7, 16384
s_add_u32 m0, s30, 114688
s_nop 0
buffer_load_dwordx4 v228, s[8:11], s32 offen offset:0  lds
buffer_load_dwordx4 v229, s[8:11], s32 offen offset:1024  lds
buffer_load_dwordx4 v230, s[8:11], s32 offen offset:2048  lds
buffer_load_dwordx4 v231, s[8:11], s32 offen offset:3072  lds
s_add_u32 s39, s7, 0
s_add_u32 m0, s30, 131072
s_nop 0
buffer_load_dwordx4 v232, s[12:15], s39 offen offset:0  lds
buffer_load_dwordx4 v233, s[12:15], s39 offen offset:1024  lds
buffer_load_dwordx4 v232, s[12:15], s39 offen offset:2048  lds
buffer_load_dwordx4 v233, s[12:15], s39 offen offset:3072  lds
s_add_u32 s32, s7, 32768
s_add_u32 m0, s30, 65536
s_nop 0
buffer_load_dwordx4 v228, s[8:11], s32 offen offset:0  lds
buffer_load_dwordx4 v229, s[8:11], s32 offen offset:1024  lds
buffer_load_dwordx4 v230, s[8:11], s32 offen offset:2048  lds
buffer_load_dwordx4 v231, s[8:11], s32 offen offset:3072  lds
s_add_u32 s39, s7, 16384
s_add_u32 m0, s30, 147456
s_nop 0
buffer_load_dwordx4 v232, s[12:15], s39 offen offset:0  lds
buffer_load_dwordx4 v233, s[12:15], s39 offen offset:1024  lds
buffer_load_dwordx4 v232, s[12:15], s39 offen offset:2048  lds
buffer_load_dwordx4 v233, s[12:15], s39 offen offset:3072  lds
s_waitcnt vmcnt(0)
s_barrier
ds_read_b128 a[144:147], v216 offset:16384
ds_read_b128 a[148:151], v217 offset:16384
ds_read_b128 a[152:155], v218 offset:16384
ds_read_b128 a[156:159], v219 offset:16384
ds_read_b128 a[160:163], v216 offset:20480
ds_read_b128 a[164:167], v217 offset:20480
ds_read_b128 a[168:171], v218 offset:20480
ds_read_b128 a[172:175], v219 offset:20480
s_add_u32 s32, s7, 32768
s_add_u32 s39, s7, 16384
s_mul_i32 s88, s37, 864
s_mov_b32 s87, s88
v_accvgpr_write_b32 a128, 0
v_accvgpr_write_b32 a129, 0
v_accvgpr_write_b32 a130, 0
v_accvgpr_write_b32 a131, 0
v_accvgpr_write_b32 a132, 0
v_accvgpr_write_b32 a133, 0
v_accvgpr_write_b32 a134, 0
v_accvgpr_write_b32 a135, 0
v_lshrrev_b32 v240, 2, v1
v_mul_u32_u24 v240, 0x2400, v240
v_and_b32 v246, 3, v1
v_lshl_add_u32 v240, v246, 4, v240
v_mul_u32_u24 v243, 3641, v1
v_lshrrev_b32 v243, 16, v243
v_mul_u32_u24 v243, 864, v243
v_add_u32 v243, v243, v244
s_waitcnt lgkmcnt(0)
v_mfma_f32_16x16x32_bf16 v[8:11], a[144:147], v[152:155], v[136:139]
v_mfma_f32_16x16x32_bf16 v[16:19], a[144:147], v[168:171], v[140:143]
v_mfma_f32_16x16x32_bf16 v[24:27], a[144:147], v[184:187], v[144:147]
v_mfma_f32_16x16x32_bf16 v[32:35], a[144:147], v[200:203], v[148:151]
ds_read_b128 a[144:147], v216 offset:24576
v_mfma_f32_16x16x32_bf16 v[8:11], a[148:151], v[156:159], v[8:11]
v_mfma_f32_16x16x32_bf16 v[16:19], a[148:151], v[172:175], v[16:19]
v_mfma_f32_16x16x32_bf16 v[24:27], a[148:151], v[188:191], v[24:27]
v_mfma_f32_16x16x32_bf16 v[32:35], a[148:151], v[204:207], v[32:35]
ds_read_b128 a[148:151], v217 offset:24576
v_mfma_f32_16x16x32_bf16 v[8:11], a[152:155], v[160:163], v[8:11]
v_mfma_f32_16x16x32_bf16 v[16:19], a[152:155], v[176:179], v[16:19]
v_mfma_f32_16x16x32_bf16 v[24:27], a[152:155], v[192:195], v[24:27]
v_mfma_f32_16x16x32_bf16 v[32:35], a[152:155], v[208:211], v[32:35]
ds_read_b128 a[152:155], v218 offset:24576
v_mfma_f32_16x16x32_bf16 v[8:11], a[156:159], v[164:167], v[8:11]
v_mfma_f32_16x16x32_bf16 v[16:19], a[156:159], v[180:183], v[16:19]
v_mfma_f32_16x16x32_bf16 v[24:27], a[156:159], v[196:199], v[24:27]
v_mfma_f32_16x16x32_bf16 v[32:35], a[156:159], v[212:215], v[32:35]
ds_read_b128 a[156:159], v219 offset:24576
v_mfma_f32_16x16x32_bf16 v[12:15], a[160:163], v[152:155], v[136:139]
v_mfma_f32_16x16x32_bf16 v[20:23], a[160:163], v[168:171], v[140:143]
v_mfma_f32_16x16x32_bf16 v[28:31], a[160:163], v[184:187], v[144:147]
v_mfma_f32_16x16x32_bf16 v[36:39], a[160:163], v[200:203], v[148:151]
ds_read_b128 a[160:163], v216 offset:28672
v_mfma_f32_16x16x32_bf16 v[12:15], a[164:167], v[156:159], v[12:15]
v_mfma_f32_16x16x32_bf16 v[20:23], a[164:167], v[172:175], v[20:23]
v_mfma_f32_16x16x32_bf16 v[28:31], a[164:167], v[188:191], v[28:31]
v_mfma_f32_16x16x32_bf16 v[36:39], a[164:167], v[204:207], v[36:39]
ds_read_b128 a[164:167], v217 offset:28672
v_mfma_f32_16x16x32_bf16 v[12:15], a[168:171], v[160:163], v[12:15]
v_mfma_f32_16x16x32_bf16 v[20:23], a[168:171], v[176:179], v[20:23]
v_mfma_f32_16x16x32_bf16 v[28:31], a[168:171], v[192:195], v[28:31]
v_mfma_f32_16x16x32_bf16 v[36:39], a[168:171], v[208:211], v[36:39]
ds_read_b128 a[168:171], v218 offset:28672
v_mfma_f32_16x16x32_bf16 v[12:15], a[172:175], v[164:167], v[12:15]
v_mfma_f32_16x16x32_bf16 v[20:23], a[172:175], v[180:183], v[20:23]
v_mfma_f32_16x16x32_bf16 v[28:31], a[172:175], v[196:199], v[28:31]
v_mfma_f32_16x16x32_bf16 v[36:39], a[172:175], v[212:215], v[36:39]
ds_read_b128 a[172:175], v219 offset:28672
s_waitcnt lgkmcnt(0)
s_nop 7
s_branch K_BODY0
K_CODE_END:
.section .rodata,"a"
.p2align 6
.amdhsa_kernel recurrent_scan__gqa_block_cached__moe_arch_mod__prompt_kernel
  .amdhsa_next_free_vgpr 512
  .amdhsa_next_free_sgpr 102
  .amdhsa_accum_offset 256
  .amdhsa_group_segment_fixed_size 0
  .amdhsa_kernarg_size 104
  .amdhsa_user_sgpr_count 2
  .amdhsa_user_sgpr_kernarg_segment_ptr 1
  .amdhsa_system_sgpr_workgroup_id_x 1
  .amdhsa_float_denorm_mode_32 3
.end_amdhsa_kernel
```
